```python
import torch

def _softmax(x, axis=-1):
    return torch.softmax(x, dim=axis)

def _gelu(x):
    return torch.nn.functional.gelu(x, approximate='tanh')

def _silu(x):
    return torch.nn.functional.silu(x)

def _sigmoid(x):
    return torch.sigmoid(x)

def _layernorm(x, axis=-1, eps=1e-05):
    m = x.mean(dim=axis, keepdim=True)
    v = x.var(dim=axis, keepdim=True, unbiased=False)
    return (x - m) / torch.sqrt(v + eps)

def _scatter_add(tgt, idx, src, axis=0):
    return tgt.clone().index_add_(axis, idx, src)

def _segment_sum(src, seg, n):
    out = torch.zeros((n,) + src.shape[1:], dtype=src.dtype)
    return out.index_add_(0, seg, src)

def _pad(x, pw):
    flat = tuple((v for pair in reversed(pw) for v in pair))
    return torch.nn.functional.pad(x, flat)
kernel_name = 'adaLN_cond__sliding_local_dilated__swiglu_ffn__prompt'

def setup_inputs():

    _w = lambda a: (lambda t: t.to(torch.bfloat16) if t.is_floating_point() else t)(torch.as_tensor(a))

    def _A_setup():
        B, S, D = (1, 2048, 1024)
        return {'x': _w((lambda *s: torch.randn(*s, dtype=torch.bfloat16) * 0.05)(B, S, D)), 'wqkv': _w((lambda *s: torch.randn(*s, dtype=torch.bfloat16) * 0.05)(D, 3 * D)), 'wo': _w((lambda *s: torch.randn(*s, dtype=torch.bfloat16) * 0.05)(D, D))}
    _A_in = _A_setup()

    def _B_setup():
        B, S, D, F = (1, 2048, 1024, 3584)
        return {'x': _w((lambda *s: torch.randn(*s, dtype=torch.bfloat16) * 0.05)(B, S, D)), 'w_gate': _w((lambda *s: torch.randn(*s, dtype=torch.bfloat16) * 0.05)(D, F)), 'w_up': _w((lambda *s: torch.randn(*s, dtype=torch.bfloat16) * 0.05)(D, F)), 'w_down': _w((lambda *s: torch.randn(*s, dtype=torch.bfloat16) * 0.05)(F, D))}
    _B_in = _B_setup()
    return {'A_x': _A_in['x'], 'A_wqkv': _A_in['wqkv'], 'A_wo': _A_in['wo'], 'B_x': _B_in['x'], 'B_w_gate': _B_in['w_gate'], 'B_w_up': _B_in['w_up'], 'B_w_down': _B_in['w_down'], 'c': _w((lambda *s: torch.randn(*s, dtype=torch.bfloat16) * 0.1)(1, 1024) * 8.0), 'w_mod': _w((lambda *s: torch.randn(*s, dtype=torch.bfloat16) * 0.1)(1024, 6 * 1024) * 1024 ** (-0.5) * 8.0)}

def reference(A_x, A_wqkv, A_wo, B_x, B_w_gate, B_w_up, B_w_down, c, w_mod):

    def _A_ref(x, wqkv, wo):
        B, S, D = x.shape
        H = 32
        Dh = D // H
        W, dil = (8, 2)
        qkv = (lambda x, *d: x.permute(*d))((x @ wqkv).reshape(B, S, 3, H, Dh), 2, 0, 3, 1, 4)
        q, k, v = (qkv[0], qkv[1], qkv[2])
        scale = Dh ** (-0.5)
        pos = torch.arange(S)
        off = torch.arange(W) * dil
        idx = pos[:, None] - off[None, :]
        mask = idx >= 0
        idx_c = torch.where(mask, idx, 0).reshape(-1)
        kg = k[:, :, idx_c, :].reshape(B, H, S, W, Dh)
        vg = v[:, :, idx_c, :].reshape(B, H, S, W, Dh)
        logits = torch.einsum('bhsd,bhswd->bhsw', q, kg) * scale
        logits = torch.where(mask[None, None, :, :], logits, -1000000000.0)
        attn = _softmax(logits, axis=-1)
        o = torch.einsum('bhsw,bhswd->bhsd', attn, vg)
        return (lambda x, *d: x.permute(*d))(o, 0, 2, 1, 3).reshape(B, S, D) @ wo

    def _B_ref(x, w_gate, w_up, w_down):
        g = _silu(x @ w_gate)
        u = x @ w_up
        return g * u @ w_down
    x = A_x
    mod = (_silu(c) @ w_mod).reshape(c.shape[0], 6, 1, -1)
    sa, ca, ga, sb, cb, gb = (mod[:, 0].clone(), mod[:, 1].clone(), mod[:, 2].clone(), mod[:, 3].clone(), mod[:, 4].clone(), mod[:, 5].clone())
    h = _layernorm(x, axis=-1) * (1 + ca) + sa
    x = x + ga * _A_ref(h, A_wqkv, A_wo)
    h = _layernorm(x, axis=-1) * (1 + cb) + sb
    x = x + gb * _B_ref(h, B_w_gate, B_w_up, B_w_down)
    return x
```

```asm
; @launch kernel=k1_mod_kernel grid=(256,1,1) block=(256,1,1) lds=1024
; @launch kernel=k3_main_kernel grid=(256,1,1) block=(256,1,1) lds=163840
.amdgcn_target "amdgcn-amd-amdhsa--gfx950"
.text
.globl k1_mod_kernel
.type k1_mod_kernel,@function
.p2align 8
k1_mod_kernel:
  s_cmp_ge_u32 s2, 256
  s_cbranch_scc1 X_k1_mod_kernel
  s_load_dwordx2 s[4:5], s[0:1], 64
  s_load_dwordx2 s[8:9], s[0:1], 56
  s_load_dwordx2 s[12:13], s[0:1], 88
  s_load_dwordx2 s[16:17], s[0:1], 0
  s_load_dwordx2 s[20:21], s[0:1], 8
  s_load_dwordx2 s[24:25], s[0:1], 88
  v_lshrrev_b32 v11, 6, v0
  v_and_b32 v10, 63, v0
  v_readfirstlane_b32 s30, v11
  s_mov_b32 s31, s2
  s_mov_b32 s6, 12582912
  s_mov_b32 s7, 0x20000
  s_mov_b32 s10, 2048
  s_mov_b32 s11, 0x20000
  s_mov_b32 s14, 98304
  s_mov_b32 s15, 0x20000
  s_mov_b32 s18, 4194304
  s_mov_b32 s19, 0x20000
  s_mov_b32 s22, 6291456
  s_mov_b32 s23, 0x20000
  s_mov_b32 s26, 262144
  s_mov_b32 s27, 0x20000
  s_waitcnt lgkmcnt(0)
  s_add_u32 s24, s24, 5242880
  s_addc_u32 s25, s25, 0
  s_cmp_lg_u32 s30, 2
  s_cbranch_scc1 F_zk1_mod_kernel
  s_lshl_b32 s28, s2, 7
  s_lshr_b32 s29, s2, 2
  s_lshl_b32 s29, s29, 7
  v_lshrrev_b32 v8, 3, v10
  v_mov_b32 v4, s28
  v_mov_b32 v5, s29
  v_cmp_eq_u32 vcc, 2, v8
  v_and_b32 v9, 7, v10
  v_lshlrev_b32 v8, 15, v8
  v_cndmask_b32 v4, v4, v5, vcc
  v_lshl_add_u32 v8, v9, 4, v8
  v_add_u32 v8, v8, v4
  v_mov_b32 v4, 0
  v_mov_b32 v5, 0
  v_mov_b32 v6, 0
  v_mov_b32 v7, 0
  buffer_store_dwordx4 v[4:7], v8, s[24:27], 0 offen
  s_nop 1
F_zk1_mod_kernel:
  s_cmp_ge_u32 s2, 128
  s_cbranch_scc1 T_k1_mod_kernel
  s_lshr_b32 s34, s31, 2
  s_add_u32 s34, s34, 0
  s_and_b32 s35, s31, 3
  s_lshl_b32 s32, s35, 8
  s_lshl_b32 s33, s30, 6
  s_add_u32 s32, s32, s33
  v_and_b32 v12, 0x38, v10
  v_add_u32 v12, s32, v12
  v_lshlrev_b32 v13, 1, v12
  v_mul_u32_u24 v16, 12288, v12
  v_and_b32 v14, 7, v10
  v_lshl_add_u32 v16, v14, 4, v16
  s_lshl_b32 s33, s34, 7
  buffer_load_dwordx4 v[20:23], v13, s[8:11], 0 offen
  buffer_load_dwordx4 v[32:35], v16, s[4:7], s33 offen nt
  s_add_u32 s33, s33, 12288
  buffer_load_dwordx4 v[36:39], v16, s[4:7], s33 offen nt
  s_add_u32 s33, s33, 12288
  buffer_load_dwordx4 v[40:43], v16, s[4:7], s33 offen nt
  s_add_u32 s33, s33, 12288
  buffer_load_dwordx4 v[44:47], v16, s[4:7], s33 offen nt
  s_add_u32 s33, s33, 12288
  buffer_load_dwordx4 v[48:51], v16, s[4:7], s33 offen nt
  s_add_u32 s33, s33, 12288
  buffer_load_dwordx4 v[52:55], v16, s[4:7], s33 offen nt
  s_add_u32 s33, s33, 12288
  buffer_load_dwordx4 v[56:59], v16, s[4:7], s33 offen nt
  s_add_u32 s33, s33, 12288
  buffer_load_dwordx4 v[60:63], v16, s[4:7], s33 offen nt
  s_lshr_b32 s38, s31, 3
  s_lshl_b32 s38, s38, 13
  s_cmp_lg_u32 s30, 3
  s_cbranch_scc1 TC1_k1_mod_kernel
  s_cmp_ge_u32 s38, code_end-k3_main_kernel
  s_cbranch_scc1 TC1_k1_mod_kernel
  s_getpc_b64 s[36:37]
TC1_k1_mod_kernelp:
  s_add_u32 s38, s38, k3_main_kernel-TC1_k1_mod_kernelp
  s_ashr_i32 vcc_hi, s38, 31
  s_add_u32 s36, s36, s38
  s_addc_u32 s37, s37, vcc_hi
  v_lshlrev_b32 v74, 7, v10
  v_mov_b32 v75, s37
  v_add_co_u32 v74, vcc, s36, v74
  s_nop 1
  v_addc_co_u32 v75, vcc, 0, v75, vcc
  global_load_dword v76, v[74:75], off
TC1_k1_mod_kernel:
  v_lshlrev_b32 v74, 7, v10
  s_lshl_b32 s36, s31, 1
  s_add_u32 s36, s36, s30
  s_lshl_b32 s36, s36, 13
  s_cmp_lt_u32 s30, 2
  s_cselect_b32 s36, s36, 0x40000000
  buffer_load_dword v76, v74, s[16:19], s36 offen
  v_lshlrev_b32 v74, 7, v10
  s_mul_i32 s36, s30, 256
  s_add_u32 s36, s36, s31
  s_lshl_b32 s36, s36, 13
  s_add_u32 s37, s36, 0
  s_cmp_lt_u32 s37, 2095104
  s_cselect_b32 s37, s37, 0x40000000
  buffer_load_dword v76, v74, s[20:23], s37 offen
  s_waitcnt vmcnt(10)
  v_lshlrev_b32 v24, 16, v20
  v_and_b32 v25, 0xffff0000, v20
  v_lshlrev_b32 v26, 16, v21
  v_and_b32 v27, 0xffff0000, v21
  v_lshlrev_b32 v28, 16, v22
  v_and_b32 v29, 0xffff0000, v22
  v_lshlrev_b32 v30, 16, v23
  v_and_b32 v31, 0xffff0000, v23
  v_mul_f32 v64, 0xbfb8aa3b, v24
  v_mul_f32 v65, 0xbfb8aa3b, v25
  v_mul_f32 v66, 0xbfb8aa3b, v26
  v_mul_f32 v67, 0xbfb8aa3b, v27
  v_mul_f32 v68, 0xbfb8aa3b, v28
  v_mul_f32 v69, 0xbfb8aa3b, v29
  v_mul_f32 v70, 0xbfb8aa3b, v30
  v_mul_f32 v71, 0xbfb8aa3b, v31
  v_exp_f32 v64, v64
  v_exp_f32 v65, v65
  v_exp_f32 v66, v66
  v_exp_f32 v67, v67
  v_exp_f32 v68, v68
  v_exp_f32 v69, v69
  v_exp_f32 v70, v70
  v_exp_f32 v71, v71
  v_add_f32 v64, 1.0, v64
  v_add_f32 v65, 1.0, v65
  v_add_f32 v66, 1.0, v66
  v_add_f32 v67, 1.0, v67
  v_add_f32 v68, 1.0, v68
  v_add_f32 v69, 1.0, v69
  v_add_f32 v70, 1.0, v70
  v_add_f32 v71, 1.0, v71
  v_rcp_f32 v64, v64
  v_rcp_f32 v65, v65
  v_rcp_f32 v66, v66
  v_rcp_f32 v67, v67
  v_rcp_f32 v68, v68
  v_rcp_f32 v69, v69
  v_rcp_f32 v70, v70
  v_rcp_f32 v71, v71
  v_mul_f32 v24, v24, v64
  v_mul_f32 v25, v25, v65
  v_mul_f32 v26, v26, v66
  v_mul_f32 v27, v27, v67
  v_mul_f32 v28, v28, v68
  v_mul_f32 v29, v29, v69
  v_mul_f32 v30, v30, v70
  v_mul_f32 v31, v31, v71
  v_cvt_pk_bf16_f32 v72, v24, v25
  v_lshlrev_b32 v24, 16, v72
  v_and_b32 v25, 0xffff0000, v72
  v_cvt_pk_bf16_f32 v72, v26, v27
  v_lshlrev_b32 v26, 16, v72
  v_and_b32 v27, 0xffff0000, v72
  v_cvt_pk_bf16_f32 v72, v28, v29
  v_lshlrev_b32 v28, 16, v72
  v_and_b32 v29, 0xffff0000, v72
  v_cvt_pk_bf16_f32 v72, v30, v31
  v_lshlrev_b32 v30, 16, v72
  v_and_b32 v31, 0xffff0000, v72
  v_and_b32 v12, 7, v10
  v_lshlrev_b32 v12, 5, v12
  v_lshrrev_b32 v13, 4, v10
  v_lshl_add_u32 v12, v13, 3, v12
  s_lshl_b32 s32, s30, 8
  v_add_u32 v12, s32, v12
  v_lshlrev_b32 v13, 2, v10
  s_mul_i32 s32, s35, 24576
  s_lshl_b32 s33, s34, 8
  s_add_u32 s32, s32, s33
  s_waitcnt vmcnt(9)
  v_lshlrev_b32 v72, 16, v32
  v_and_b32 v73, 0xffff0000, v32
  v_mul_f32 v64, v24, v72
  v_mul_f32 v65, v24, v73
  v_lshlrev_b32 v72, 16, v33
  v_and_b32 v73, 0xffff0000, v33
  v_mul_f32 v66, v24, v72
  v_mul_f32 v67, v24, v73
  v_lshlrev_b32 v72, 16, v34
  v_and_b32 v73, 0xffff0000, v34
  v_mul_f32 v68, v24, v72
  v_mul_f32 v69, v24, v73
  v_lshlrev_b32 v72, 16, v35
  v_and_b32 v73, 0xffff0000, v35
  v_mul_f32 v70, v24, v72
  v_mul_f32 v71, v24, v73
  s_waitcnt vmcnt(8)
  v_lshlrev_b32 v72, 16, v36
  v_and_b32 v73, 0xffff0000, v36
  v_fmac_f32 v64, v25, v72
  v_fmac_f32 v65, v25, v73
  v_lshlrev_b32 v72, 16, v37
  v_and_b32 v73, 0xffff0000, v37
  v_fmac_f32 v66, v25, v72
  v_fmac_f32 v67, v25, v73
  v_lshlrev_b32 v72, 16, v38
  v_and_b32 v73, 0xffff0000, v38
  v_fmac_f32 v68, v25, v72
  v_fmac_f32 v69, v25, v73
  v_lshlrev_b32 v72, 16, v39
  v_and_b32 v73, 0xffff0000, v39
  v_fmac_f32 v70, v25, v72
  v_fmac_f32 v71, v25, v73
  s_waitcnt vmcnt(7)
  v_lshlrev_b32 v72, 16, v40
  v_and_b32 v73, 0xffff0000, v40
  v_fmac_f32 v64, v26, v72
  v_fmac_f32 v65, v26, v73
  v_lshlrev_b32 v72, 16, v41
  v_and_b32 v73, 0xffff0000, v41
  v_fmac_f32 v66, v26, v72
  v_fmac_f32 v67, v26, v73
  v_lshlrev_b32 v72, 16, v42
  v_and_b32 v73, 0xffff0000, v42
  v_fmac_f32 v68, v26, v72
  v_fmac_f32 v69, v26, v73
  v_lshlrev_b32 v72, 16, v43
  v_and_b32 v73, 0xffff0000, v43
  v_fmac_f32 v70, v26, v72
  v_fmac_f32 v71, v26, v73
  s_waitcnt vmcnt(6)
  v_lshlrev_b32 v72, 16, v44
  v_and_b32 v73, 0xffff0000, v44
  v_fmac_f32 v64, v27, v72
  v_fmac_f32 v65, v27, v73
  v_lshlrev_b32 v72, 16, v45
  v_and_b32 v73, 0xffff0000, v45
  v_fmac_f32 v66, v27, v72
  v_fmac_f32 v67, v27, v73
  v_lshlrev_b32 v72, 16, v46
  v_and_b32 v73, 0xffff0000, v46
  v_fmac_f32 v68, v27, v72
  v_fmac_f32 v69, v27, v73
  v_lshlrev_b32 v72, 16, v47
  v_and_b32 v73, 0xffff0000, v47
  v_fmac_f32 v70, v27, v72
  v_fmac_f32 v71, v27, v73
  s_waitcnt vmcnt(5)
  v_lshlrev_b32 v72, 16, v48
  v_and_b32 v73, 0xffff0000, v48
  v_fmac_f32 v64, v28, v72
  v_fmac_f32 v65, v28, v73
  v_lshlrev_b32 v72, 16, v49
  v_and_b32 v73, 0xffff0000, v49
  v_fmac_f32 v66, v28, v72
  v_fmac_f32 v67, v28, v73
  v_lshlrev_b32 v72, 16, v50
  v_and_b32 v73, 0xffff0000, v50
  v_fmac_f32 v68, v28, v72
  v_fmac_f32 v69, v28, v73
  v_lshlrev_b32 v72, 16, v51
  v_and_b32 v73, 0xffff0000, v51
  v_fmac_f32 v70, v28, v72
  v_fmac_f32 v71, v28, v73
  s_waitcnt vmcnt(4)
  v_lshlrev_b32 v72, 16, v52
  v_and_b32 v73, 0xffff0000, v52
  v_fmac_f32 v64, v29, v72
  v_fmac_f32 v65, v29, v73
  v_lshlrev_b32 v72, 16, v53
  v_and_b32 v73, 0xffff0000, v53
  v_fmac_f32 v66, v29, v72
  v_fmac_f32 v67, v29, v73
  v_lshlrev_b32 v72, 16, v54
  v_and_b32 v73, 0xffff0000, v54
  v_fmac_f32 v68, v29, v72
  v_fmac_f32 v69, v29, v73
  v_lshlrev_b32 v72, 16, v55
  v_and_b32 v73, 0xffff0000, v55
  v_fmac_f32 v70, v29, v72
  v_fmac_f32 v71, v29, v73
  s_waitcnt vmcnt(3)
  v_lshlrev_b32 v72, 16, v56
  v_and_b32 v73, 0xffff0000, v56
  v_fmac_f32 v64, v30, v72
  v_fmac_f32 v65, v30, v73
  v_lshlrev_b32 v72, 16, v57
  v_and_b32 v73, 0xffff0000, v57
  v_fmac_f32 v66, v30, v72
  v_fmac_f32 v67, v30, v73
  v_lshlrev_b32 v72, 16, v58
  v_and_b32 v73, 0xffff0000, v58
  v_fmac_f32 v68, v30, v72
  v_fmac_f32 v69, v30, v73
  v_lshlrev_b32 v72, 16, v59
  v_and_b32 v73, 0xffff0000, v59
  v_fmac_f32 v70, v30, v72
  v_fmac_f32 v71, v30, v73
  s_waitcnt vmcnt(2)
  v_lshlrev_b32 v72, 16, v60
  v_and_b32 v73, 0xffff0000, v60
  v_fmac_f32 v64, v31, v72
  v_fmac_f32 v65, v31, v73
  v_lshlrev_b32 v72, 16, v61
  v_and_b32 v73, 0xffff0000, v61
  v_fmac_f32 v66, v31, v72
  v_fmac_f32 v67, v31, v73
  v_lshlrev_b32 v72, 16, v62
  v_and_b32 v73, 0xffff0000, v62
  v_fmac_f32 v68, v31, v72
  v_fmac_f32 v69, v31, v73
  v_lshlrev_b32 v72, 16, v63
  v_and_b32 v73, 0xffff0000, v63
  v_fmac_f32 v70, v31, v72
  v_fmac_f32 v71, v31, v73
  s_nop 1
  v_permlane32_swap_b32 v64, v68
  v_permlane32_swap_b32 v65, v69
  v_permlane32_swap_b32 v66, v70
  v_permlane32_swap_b32 v67, v71
  s_nop 0
  v_add_f32 v64, v64, v68
  v_add_f32 v65, v65, v69
  v_add_f32 v66, v66, v70
  v_add_f32 v67, v67, v71
  s_nop 1
  v_permlane16_swap_b32 v64, v66
  v_permlane16_swap_b32 v65, v67
  s_nop 0
  v_add_f32 v64, v64, v66
  v_add_f32 v65, v65, v67
  s_nop 1
  v_add_f32_dpp v64, v64, v64 row_ror:8 row_mask:0xf bank_mask:0xf
  v_add_f32_dpp v65, v65, v65 row_ror:8 row_mask:0xf bank_mask:0xf
  ds_write_b64 v12, v[64:65]
  s_waitcnt lgkmcnt(0)
  s_barrier
  s_cmp_lg_u32 s30, 0
  s_cbranch_scc1 E_k1_mod_kernel
  ds_read_b32 v64, v13 offset:0
  ds_read_b32 v65, v13 offset:256
  ds_read_b32 v66, v13 offset:512
  ds_read_b32 v67, v13 offset:768
  s_waitcnt lgkmcnt(0)
  v_add_f32 v64, v64, v65
  v_add_f32 v66, v66, v67
  v_add_f32 v64, v64, v66
  buffer_store_dword v64, v13, s[12:15], s32 offen
  s_branch E_k1_mod_kernel
T_k1_mod_kernel:
  s_lshr_b32 s38, s31, 3
  s_lshl_b32 s38, s38, 13
  s_cmp_lg_u32 s30, 3
  s_cbranch_scc1 TC2_k1_mod_kernel
  s_cmp_ge_u32 s38, code_end-k3_main_kernel
  s_cbranch_scc1 TC2_k1_mod_kernel
  s_getpc_b64 s[36:37]
TC2_k1_mod_kernelp:
  s_add_u32 s38, s38, k3_main_kernel-TC2_k1_mod_kernelp
  s_ashr_i32 vcc_hi, s38, 31
  s_add_u32 s36, s36, s38
  s_addc_u32 s37, s37, vcc_hi
  v_lshlrev_b32 v74, 7, v10
  v_mov_b32 v75, s37
  v_add_co_u32 v74, vcc, s36, v74
  s_nop 1
  v_addc_co_u32 v75, vcc, 0, v75, vcc
  global_load_dword v76, v[74:75], off
TC2_k1_mod_kernel:
  v_lshlrev_b32 v74, 7, v10
  s_lshl_b32 s36, s31, 1
  s_add_u32 s36, s36, s30
  s_lshl_b32 s36, s36, 13
  s_cmp_lt_u32 s30, 2
  s_cselect_b32 s36, s36, 0x40000000
  buffer_load_dword v76, v74, s[16:19], s36 offen
  v_lshlrev_b32 v74, 7, v10
  s_mul_i32 s36, s30, 256
  s_add_u32 s36, s36, s31
  s_lshl_b32 s36, s36, 13
  s_add_u32 s37, s36, 0
  s_cmp_lt_u32 s37, 2095104
  s_cselect_b32 s37, s37, 0x40000000
  buffer_load_dword v76, v74, s[20:23], s37 offen
  s_sub_u32 s31, s31, 128
  s_waitcnt vmcnt(0)
  v_lshlrev_b32 v74, 7, v10
  s_mul_i32 s36, s30, 128
  s_add_u32 s36, s36, s31
  s_lshl_b32 s36, s36, 13
  s_add_u32 s37, s36, 0
  s_cmp_lt_u32 s37, 4196352
  s_cselect_b32 s37, s37, 0x40000000
  s_add_u32 s37, s37, 2095104
  buffer_load_dword v76, v74, s[20:23], s37 offen
  s_add_u32 s37, s36, 4194304
  s_cmp_lt_u32 s37, 4196352
  s_cselect_b32 s37, s37, 0x40000000
  s_add_u32 s37, s37, 2095104
  buffer_load_dword v76, v74, s[20:23], s37 offen
E_k1_mod_kernel:
X_k1_mod_kernel:
  s_endpgm
.globl k3_main_kernel
.type k3_main_kernel,@function
.p2align 8
k3_main_kernel:
  s_cmp_ge_u32 s2, 256
  s_cbranch_scc1 X_k3_main_kernel
  s_load_dwordx2 s[4:5], s[0:1], 0
  s_load_dwordx2 s[36:37], s[0:1], 88
  s_load_dwordx2 s[8:9], s[0:1], 8
  s_load_dwordx2 s[28:29], s[0:1], 64
  s_load_dwordx2 s[40:41], s[0:1], 56
  s_load_dwordx2 s[12:13], s[0:1], 16
  s_load_dwordx2 s[16:17], s[0:1], 32
  s_load_dwordx2 s[20:21], s[0:1], 40
  s_load_dwordx2 s[24:25], s[0:1], 48
  s_load_dwordx2 s[32:33], s[0:1], 72
  v_lshrrev_b32 v1, 6, v0
  v_and_b32 v10, 63, v0
  v_readfirstlane_b32 s44, v1
  v_lshlrev_b32 v0, 4, v10
  s_mov_b32 s6, 4194304
  s_mov_b32 s7, 0x20000
  s_mov_b32 s38, 50331648
  s_mov_b32 s39, 0x20000
  s_mov_b32 s10, 6291456
  s_mov_b32 s11, 0x20000
  s_mov_b32 s30, 12582912
  s_mov_b32 s31, 0x20000
  s_mov_b32 s42, 2048
  s_mov_b32 s43, 0x20000
  s_mov_b32 s14, 2097152
  s_mov_b32 s15, 0x20000
  s_mov_b32 s18, 7340032
  s_mov_b32 s19, 0x20000
  s_mov_b32 s22, 7340032
  s_mov_b32 s23, 0x20000
  s_mov_b32 s26, 7340032
  s_mov_b32 s27, 0x20000
  s_mov_b32 s34, 4194304
  s_mov_b32 s35, 0x20000
  v_and_b32 v12, 7, v10
  v_lshrrev_b32 v13, 3, v10
  v_lshlrev_b32 v132, 11, v12
  v_lshl_add_u32 v132, v13, 4, v132
  s_lshl_b32 s48, s2, 14
  s_lshl_b32 s49, s44, 9
  s_add_u32 s48, s48, s49
  s_lshl_b32 s49, s44, 10
  s_waitcnt lgkmcnt(0)
  buffer_load_dwordx4 v[20:23], v132, s[4:7], s48 offen offset:0
  buffer_load_dwordx4 v[24:27], v132, s[4:7], s48 offen offset:128
  buffer_load_dwordx4 v[28:31], v132, s[4:7], s48 offen offset:256
  buffer_load_dwordx4 v[32:35], v132, s[4:7], s48 offen offset:384
  buffer_load_dwordx4 v[100:103], v0, s[36:39], s49 offen
  s_add_u32 s49, s49, 4096
  buffer_load_dwordx4 v[68:71], v0, s[36:39], s49 offen
  s_add_u32 s49, s49, 20480
  buffer_load_dwordx4 v[104:107], v0, s[36:39], s49 offen
  s_add_u32 s49, s49, 4096
  buffer_load_dwordx4 v[72:75], v0, s[36:39], s49 offen
  s_add_u32 s49, s49, 20480
  buffer_load_dwordx4 v[108:111], v0, s[36:39], s49 offen
  s_add_u32 s49, s49, 4096
  buffer_load_dwordx4 v[76:79], v0, s[36:39], s49 offen
  s_add_u32 s49, s49, 20480
  buffer_load_dwordx4 v[112:115], v0, s[36:39], s49 offen
  s_add_u32 s49, s49, 4096
  buffer_load_dwordx4 v[80:83], v0, s[36:39], s49 offen
  s_mul_i32 s48, s2, 7168
  s_lshl_b32 s49, s2, 13
  s_mov_b32 s55, 0x20000
  s_mov_b32 s54, 1835008
  s_cmp_eq_u32 s44, 1
  s_cselect_b64 s[52:53], s[16:17], s[20:21]
  s_cmp_eq_u32 s44, 0
  s_cselect_b64 s[52:53], s[12:13], s[52:53]
  s_cselect_b32 s54, s14, s54
  s_cselect_b32 s48, s49, s48
  s_add_u32 s49, s49, 6291456
  s_cmp_eq_u32 s44, 3
  s_cselect_b64 s[52:53], s[8:9], s[52:53]
  s_cselect_b32 s54, s10, s54
  s_cselect_b32 s46, s49, s48
  v_lshlrev_b32 v19, 3, v0
  buffer_load_dword a252, v19, s[52:55], s46 offen
  s_getpc_b64 s[92:93]
PC0:
  s_lshl_b32 s48, s44, 10
  s_sub_u32 s48, s48, PC0-k3_main_kernel
  s_ashr_i32 s49, s48, 31
  s_add_u32 s92, s92, s48
  s_addc_u32 s93, s93, s49
  s_and_b32 s48, s2, 7
  s_lshr_b32 s49, s2, 3
  s_and_b32 s56, s48, 3
  s_lshl_b32 s56, s56, 2
  s_and_b32 s51, s49, 3
  s_add_u32 s56, s56, s51
  s_lshr_b32 s51, s48, 2
  s_lshl_b32 s51, s51, 3
  s_lshr_b32 s49, s49, 2
  s_add_u32 s51, s51, s49
  s_add_u32 s57, s51, s56
  s_and_b32 s57, s57, 3
  s_lshr_b32 s58, s44, 1
  s_and_b32 s59, s44, 1
  s_mul_i32 s62, s44, 3072
  s_lshl_b32 s63, s44, 11
  s_lshl_b32 s64, s44, 8
  v_bfe_u32 v14, v10, 4, 2
  v_bfe_u32 v15, v10, 1, 2
  v_xor_b32 v14, v14, v15
  v_lshlrev_b32 v14, 5, v14
  v_and_b32 v15, 1, v10
  v_lshl_add_u32 v150, v15, 4, v14
  s_lshl_b32 s48, s56, 7
  s_mul_i32 s49, s44, 49152
  s_add_u32 s48, s48, s49
  v_mul_u32_u24 v14, 6144, v13
  v_add3_u32 v139, v14, v150, s48
  v_add_u32 v140, 1024, v139
  v_add_u32 v141, 2048, v139
  v_bfe_u32 v14, v10, 3, 2
  v_lshlrev_b32 v14, 5, v14
  v_and_b32 v15, 3, v10
  v_lshl_add_u32 v151, v15, 3, v14
  v_bfe_u32 v14, v10, 2, 3
  v_lshrrev_b32 v15, 5, v10
  v_mul_u32_u24 v15, 24, v15
  v_add_lshl_u32 v14, v14, v15, 7
  s_lshl_b32 s48, s59, 1
  s_add_u32 s48, s48, s58
  s_lshl_b32 s48, s48, 5
  v_xor_b32 v15, s48, v151
  v_add_u32 v133, v14, v15
  v_xor_b32 v134, 32, v133
  v_add_u32 v135, 64512, v133
  v_add_u32 v136, 64512, v134
  v_add_u32 v137, 129024, v133
  v_add_u32 v138, 129024, v134
  s_lshl_b32 s48, s51, 2
  s_add_u32 s49, s48, s44
  s_lshl_b32 s49, s49, 16
  s_add_u32 s49, s49, 1048576
  v_add_u32 v142, s49, v0
  s_max_u32 s48, s48, 1
  s_lshl_b32 s48, s48, 16
  s_add_u32 s48, s48, 984064
  s_add_u32 s48, s48, s64
  v_lshl_add_u32 v143, v10, 2, s48
  s_lshl_b32 s48, s58, 12
  v_add_u32 v147, 0, v0
  v_add_u32 v144, s48, v147
  v_add_u32 v148, 64512, v0
  v_add_u32 v145, s48, v148
  v_add_u32 v149, 129024, v0
  v_add_u32 v146, s48, v149
  s_lshl_b32 s48, s51, 4
  s_sub_u32 s48, s48, 2
  v_min_u32 v152, 17, v10
  v_add_u32 v152, s48, v152
  v_max_i32 v152, 0, v152
  v_lshlrev_b32 v152, 7, v152
  s_add_u32 s48, s63, 150528
  v_add_u32 v14, s48, v0
  v_lshl_add_u32 v15, v13, 5, s48
  v_lshlrev_b32 v17, 5, v12
  v_add_u32 v17, 158720, v17
  s_lshl_b32 s48, s44, 3
  v_add_u32 v16, s48, v17
  v_bfe_u32 v18, v10, 3, 1
  v_lshlrev_b32 v132, 9, v18
  v_bfe_u32 v18, v10, 4, 1
  v_lshl_add_u32 v132, v18, 8, v132
  v_lshrrev_b32 v18, 5, v10
  v_lshl_add_u32 v132, v18, 11, v132
  v_lshl_add_u32 v132, v12, 4, v132
  s_lshr_b32 s50, s2, 2
  s_lshl_b32 s50, s50, 16
  s_bfe_u32 s48, s2, 0x10001
  s_lshl_b32 s48, s48, 10
  s_add_u32 s50, s50, s48
  s_and_b32 s48, s2, 1
  s_lshl_b32 s48, s48, 7
  s_add_u32 s50, s50, s48
  s_lshl_b32 s48, s44, 14
  s_add_u32 s50, s50, s48
  s_add_u32 s50, s50, 1048576
  s_lshl_b32 s45, s2, 7
  s_add_u32 s45, s45, 5242880
  s_cmp_eq_u32 s44, 0
  s_cselect_b32 s45, s45, 1073741824
  s_waitcnt vmcnt(12)
  v_lshlrev_b32 v36, 16, v20
  v_and_b32 v37, 0xffff0000, v20
  v_lshlrev_b32 v38, 16, v21
  v_and_b32 v39, 0xffff0000, v21
  v_lshlrev_b32 v40, 16, v22
  v_and_b32 v41, 0xffff0000, v22
  v_lshlrev_b32 v42, 16, v23
  v_and_b32 v43, 0xffff0000, v23
  s_waitcnt vmcnt(11)
  v_lshlrev_b32 v44, 16, v24
  v_and_b32 v45, 0xffff0000, v24
  v_lshlrev_b32 v46, 16, v25
  v_and_b32 v47, 0xffff0000, v25
  v_lshlrev_b32 v48, 16, v26
  v_and_b32 v49, 0xffff0000, v26
  v_lshlrev_b32 v50, 16, v27
  v_and_b32 v51, 0xffff0000, v27
  s_waitcnt vmcnt(10)
  v_lshlrev_b32 v52, 16, v28
  v_and_b32 v53, 0xffff0000, v28
  v_lshlrev_b32 v54, 16, v29
  v_and_b32 v55, 0xffff0000, v29
  v_lshlrev_b32 v56, 16, v30
  v_and_b32 v57, 0xffff0000, v30
  v_lshlrev_b32 v58, 16, v31
  v_and_b32 v59, 0xffff0000, v31
  s_waitcnt vmcnt(9)
  v_lshlrev_b32 v60, 16, v32
  v_and_b32 v61, 0xffff0000, v32
  v_lshlrev_b32 v62, 16, v33
  v_and_b32 v63, 0xffff0000, v33
  v_lshlrev_b32 v64, 16, v34
  v_and_b32 v65, 0xffff0000, v34
  v_lshlrev_b32 v66, 16, v35
  v_and_b32 v67, 0xffff0000, v35
  v_add_f32 v20, v36, v37
  v_mul_f32 v21, v36, v36
  v_add_f32 v22, v38, v39
  v_mul_f32 v23, v37, v37
  v_fmac_f32 v21, v38, v38
  v_fmac_f32 v23, v39, v39
  v_fmac_f32 v21, v40, v40
  v_add_f32 v20, v20, v40
  v_fmac_f32 v23, v41, v41
  v_add_f32 v22, v22, v41
  v_fmac_f32 v21, v42, v42
  v_add_f32 v20, v20, v42
  v_fmac_f32 v23, v43, v43
  v_add_f32 v22, v22, v43
  v_fmac_f32 v21, v44, v44
  v_add_f32 v20, v20, v44
  v_fmac_f32 v23, v45, v45
  v_add_f32 v22, v22, v45
  v_fmac_f32 v21, v46, v46
  v_add_f32 v20, v20, v46
  v_fmac_f32 v23, v47, v47
  v_add_f32 v22, v22, v47
  v_fmac_f32 v21, v48, v48
  v_add_f32 v20, v20, v48
  v_fmac_f32 v23, v49, v49
  v_add_f32 v22, v22, v49
  v_fmac_f32 v21, v50, v50
  v_add_f32 v20, v20, v50
  v_fmac_f32 v23, v51, v51
  v_add_f32 v22, v22, v51
  v_fmac_f32 v21, v52, v52
  v_add_f32 v20, v20, v52
  v_fmac_f32 v23, v53, v53
  v_add_f32 v22, v22, v53
  v_fmac_f32 v21, v54, v54
  v_add_f32 v20, v20, v54
  v_fmac_f32 v23, v55, v55
  v_add_f32 v22, v22, v55
  v_fmac_f32 v21, v56, v56
  v_add_f32 v20, v20, v56
  v_fmac_f32 v23, v57, v57
  v_add_f32 v22, v22, v57
  v_fmac_f32 v21, v58, v58
  v_add_f32 v20, v20, v58
  v_fmac_f32 v23, v59, v59
  v_add_f32 v22, v22, v59
  v_fmac_f32 v21, v60, v60
  v_add_f32 v20, v20, v60
  v_fmac_f32 v23, v61, v61
  v_add_f32 v22, v22, v61
  v_fmac_f32 v21, v62, v62
  v_add_f32 v20, v20, v62
  v_fmac_f32 v23, v63, v63
  v_add_f32 v22, v22, v63
  v_fmac_f32 v21, v64, v64
  v_add_f32 v20, v20, v64
  v_fmac_f32 v23, v65, v65
  v_add_f32 v22, v22, v65
  v_fmac_f32 v21, v66, v66
  v_add_f32 v20, v20, v66
  v_fmac_f32 v23, v67, v67
  v_add_f32 v22, v22, v67
  v_add_f32 v20, v20, v22
  v_add_f32 v21, v21, v23
  s_nop 0
  v_add_f32_dpp v18, v20, v20 row_ror:8 row_mask:0xf bank_mask:0xf
  v_add_f32_dpp v19, v21, v21 row_ror:8 row_mask:0xf bank_mask:0xf
  v_mov_b32 v20, v18
  v_mov_b32 v21, v19
  s_nop 0
  v_permlane16_swap_b32 v18, v20
  v_permlane16_swap_b32 v19, v21
  v_add_f32 v18, v18, v20
  v_add_f32 v19, v19, v21
  v_mov_b32 v20, v18
  v_mov_b32 v21, v19
  s_nop 0
  v_permlane32_swap_b32 v18, v20
  v_permlane32_swap_b32 v19, v21
  v_add_f32 v18, v18, v20
  v_add_f32 v19, v19, v21
  ds_write_b64 v16, v[18:19]
  s_waitcnt vmcnt(1)
  v_add_f32 v68, v68, v76
  v_add_f32 v100, v100, v108
  v_add_f32 v69, v69, v77
  v_add_f32 v101, v101, v109
  v_add_f32 v70, v70, v78
  v_add_f32 v102, v102, v110
  v_add_f32 v71, v71, v79
  v_add_f32 v103, v103, v111
  v_add_f32 v72, v72, v80
  v_add_f32 v104, v104, v112
  v_add_f32 v73, v73, v81
  v_add_f32 v105, v105, v113
  v_add_f32 v74, v74, v82
  v_add_f32 v106, v106, v114
  v_add_f32 v75, v75, v83
  v_add_f32 v107, v107, v115
  v_add_f32 v68, v68, v72
  v_add_f32 v100, v100, v104
  v_add_f32 v69, v69, v73
  v_add_f32 v101, v101, v105
  v_add_f32 v70, v70, v74
  v_add_f32 v102, v102, v106
  v_add_f32 v71, v71, v75
  v_add_f32 v103, v103, v107
  v_cvt_pk_bf16_f32 v20, v68, v69
  v_lshlrev_b32 v68, 16, v20
  v_and_b32 v69, 0xffff0000, v20
  v_cvt_pk_bf16_f32 v20, v70, v71
  v_lshlrev_b32 v70, 16, v20
  v_and_b32 v71, 0xffff0000, v20
  v_cvt_pk_bf16_f32 v20, v100, v101
  v_lshlrev_b32 v100, 16, v20
  v_and_b32 v101, 0xffff0000, v20
  v_cvt_pk_bf16_f32 v20, v102, v103
  v_lshlrev_b32 v102, 16, v20
  v_and_b32 v103, 0xffff0000, v20
  v_add_f32 v68, 1.0, v68
  v_add_f32 v69, 1.0, v69
  v_add_f32 v70, 1.0, v70
  v_add_f32 v71, 1.0, v71
  v_cvt_pk_bf16_f32 v20, v68, v69
  v_lshlrev_b32 v68, 16, v20
  v_and_b32 v69, 0xffff0000, v20
  v_cvt_pk_bf16_f32 v20, v70, v71
  v_lshlrev_b32 v70, 16, v20
  v_and_b32 v71, 0xffff0000, v20
  ds_write_b128 v14, v[68:71]
  ds_write_b128 v14, v[100:103] offset:1024
  s_waitcnt lgkmcnt(0)
  s_barrier
  ds_read_b128 v[20:23], v17 offset:0
  ds_read_b128 v[24:27], v17 offset:16
  ds_read_b128 v[68:71], v15 offset:0
  ds_read_b128 v[100:103], v15 offset:1024
  ds_read_b128 v[72:75], v15 offset:16
  ds_read_b128 v[104:107], v15 offset:1040
  ds_read_b128 v[76:79], v15 offset:256
  ds_read_b128 v[108:111], v15 offset:1280
  ds_read_b128 v[80:83], v15 offset:272
  ds_read_b128 v[112:115], v15 offset:1296
  ds_read_b128 v[84:87], v15 offset:512
  ds_read_b128 v[116:119], v15 offset:1536
  ds_read_b128 v[88:91], v15 offset:528
  ds_read_b128 v[120:123], v15 offset:1552
  s_waitcnt lgkmcnt(12)
  v_add_f32 v20, v20, v24
  v_add_f32 v21, v21, v25
  v_add_f32 v22, v22, v26
  v_add_f32 v23, v23, v27
  v_add_f32 v20, v20, v22
  v_add_f32 v21, v21, v23
  ds_read_b128 v[92:95], v15 offset:768
  ds_read_b128 v[124:127], v15 offset:1792
  ds_read_b128 v[96:99], v15 offset:784
  ds_read_b128 v[128:131], v15 offset:1808
  v_mul_f32 v18, 0x3a800000, v20
  v_mul_f32 v19, 0x3a800000, v21
  v_fma_f32 v19, -v18, v18, v19
  v_max_f32 v19, 0, v19
  v_cvt_pk_bf16_f32 v19, v19, v19
  v_lshlrev_b32 v19, 16, v19
  v_add_f32 v19, 0x3727c5ac, v19
  v_cvt_pk_bf16_f32 v19, v19, v19
  v_lshlrev_b32 v19, 16, v19
  v_sqrt_f32 v19, v19
  v_cvt_pk_bf16_f32 v18, v18, v18
  v_lshlrev_b32 v18, 16, v18
  v_cvt_pk_bf16_f32 v19, v19, v19
  v_lshlrev_b32 v19, 16, v19
  v_rcp_f32 v19, v19
  s_nop 0
  v_mul_f32 v18, v18, v19
  v_fma_f32 v36, v36, v19, -v18
  v_fma_f32 v37, v37, v19, -v18
  v_fma_f32 v38, v38, v19, -v18
  v_fma_f32 v39, v39, v19, -v18
  v_fma_f32 v40, v40, v19, -v18
  v_fma_f32 v41, v41, v19, -v18
  v_fma_f32 v42, v42, v19, -v18
  v_fma_f32 v43, v43, v19, -v18
  s_waitcnt lgkmcnt(12)
  v_fma_f32 v36, v36, v68, v100
  v_fma_f32 v37, v37, v69, v101
  v_fma_f32 v38, v38, v70, v102
  v_fma_f32 v39, v39, v71, v103
  v_fma_f32 v40, v40, v72, v104
  v_fma_f32 v41, v41, v73, v105
  v_fma_f32 v42, v42, v74, v106
  v_fma_f32 v43, v43, v75, v107
  v_cvt_pk_bf16_f32 v20, v36, v37
  v_cvt_pk_bf16_f32 v21, v38, v39
  v_cvt_pk_bf16_f32 v22, v40, v41
  v_cvt_pk_bf16_f32 v23, v42, v43
  s_nop 1
  v_permlane16_swap_b32 v20, v22
  v_permlane16_swap_b32 v21, v23
  buffer_store_dwordx4 v[20:23], v132, s[36:39], s50 offen sc1
  s_add_u32 s50, s50, 4096
  v_fma_f32 v44, v44, v19, -v18
  v_fma_f32 v45, v45, v19, -v18
  v_fma_f32 v46, v46, v19, -v18
  v_fma_f32 v47, v47, v19, -v18
  v_fma_f32 v48, v48, v19, -v18
  v_fma_f32 v49, v49, v19, -v18
  v_fma_f32 v50, v50, v19, -v18
  v_fma_f32 v51, v51, v19, -v18
  s_waitcnt lgkmcnt(8)
  v_fma_f32 v44, v44, v76, v108
  v_fma_f32 v45, v45, v77, v109
  v_fma_f32 v46, v46, v78, v110
  v_fma_f32 v47, v47, v79, v111
  v_fma_f32 v48, v48, v80, v112
  v_fma_f32 v49, v49, v81, v113
  v_fma_f32 v50, v50, v82, v114
  v_fma_f32 v51, v51, v83, v115
  v_cvt_pk_bf16_f32 v24, v44, v45
  v_cvt_pk_bf16_f32 v25, v46, v47
  v_cvt_pk_bf16_f32 v26, v48, v49
  v_cvt_pk_bf16_f32 v27, v50, v51
  s_nop 1
  v_permlane16_swap_b32 v24, v26
  v_permlane16_swap_b32 v25, v27
  buffer_store_dwordx4 v[24:27], v132, s[36:39], s50 offen sc1
  s_add_u32 s50, s50, 4096
  v_fma_f32 v52, v52, v19, -v18
  v_fma_f32 v53, v53, v19, -v18
  v_fma_f32 v54, v54, v19, -v18
  v_fma_f32 v55, v55, v19, -v18
  v_fma_f32 v56, v56, v19, -v18
  v_fma_f32 v57, v57, v19, -v18
  v_fma_f32 v58, v58, v19, -v18
  v_fma_f32 v59, v59, v19, -v18
  s_waitcnt lgkmcnt(4)
  v_fma_f32 v52, v52, v84, v116
  v_fma_f32 v53, v53, v85, v117
  v_fma_f32 v54, v54, v86, v118
  v_fma_f32 v55, v55, v87, v119
  v_fma_f32 v56, v56, v88, v120
  v_fma_f32 v57, v57, v89, v121
  v_fma_f32 v58, v58, v90, v122
  v_fma_f32 v59, v59, v91, v123
  v_cvt_pk_bf16_f32 v28, v52, v53
  v_cvt_pk_bf16_f32 v29, v54, v55
  v_cvt_pk_bf16_f32 v30, v56, v57
  v_cvt_pk_bf16_f32 v31, v58, v59
  s_nop 1
  v_permlane16_swap_b32 v28, v30
  v_permlane16_swap_b32 v29, v31
  buffer_store_dwordx4 v[28:31], v132, s[36:39], s50 offen sc1
  s_add_u32 s50, s50, 4096
  v_fma_f32 v60, v60, v19, -v18
  v_fma_f32 v61, v61, v19, -v18
  v_fma_f32 v62, v62, v19, -v18
  v_fma_f32 v63, v63, v19, -v18
  v_fma_f32 v64, v64, v19, -v18
  v_fma_f32 v65, v65, v19, -v18
  v_fma_f32 v66, v66, v19, -v18
  v_fma_f32 v67, v67, v19, -v18
  s_waitcnt lgkmcnt(0)
  v_fma_f32 v60, v60, v92, v124
  v_fma_f32 v61, v61, v93, v125
  v_fma_f32 v62, v62, v94, v126
  v_fma_f32 v63, v63, v95, v127
  v_fma_f32 v64, v64, v96, v128
  v_fma_f32 v65, v65, v97, v129
  v_fma_f32 v66, v66, v98, v130
  v_fma_f32 v67, v67, v99, v131
  v_cvt_pk_bf16_f32 v32, v60, v61
  v_cvt_pk_bf16_f32 v33, v62, v63
  v_cvt_pk_bf16_f32 v34, v64, v65
  v_cvt_pk_bf16_f32 v35, v66, v67
  s_nop 1
  v_permlane16_swap_b32 v32, v34
  v_permlane16_swap_b32 v33, v35
  buffer_store_dwordx4 v[32:35], v132, s[36:39], s50 offen sc1
  v_mov_b32 v12, 1
  s_waitcnt vmcnt(0) lgkmcnt(0)
  s_barrier
  s_mov_b64 exec, 1
  buffer_store_dword v12, v0, s[36:39], s45 offen sc1
  s_mov_b64 exec, -1
  s_mov_b32 s65, 0
  s_mul_i32 s60, s65, 196608
  s_add_u32 m0, s62, 64512
  s_nop 0
  buffer_load_dwordx4 v139, s[8:11], s60 offen offset:0 lds
  buffer_load_dwordx4 v140, s[8:11], s60 offen offset:1024 lds
  buffer_load_dwordx4 v141, s[8:11], s60 offen offset:2048 lds
  s_mov_b32 s66, 1
  s_mul_i32 s60, s66, 196608
  s_add_u32 m0, s62, 86016
  s_nop 0
  buffer_load_dwordx4 v139, s[8:11], s60 offen offset:0 lds
  buffer_load_dwordx4 v140, s[8:11], s60 offen offset:1024 lds
  buffer_load_dwordx4 v141, s[8:11], s60 offen offset:2048 lds
  s_cmp_eq_u32 s57, 1
  s_cselect_b32 s67, 10, 2
  s_mul_i32 s60, s67, 196608
  s_add_u32 m0, s62, 107520
  s_nop 0
  buffer_load_dwordx4 v139, s[8:11], s60 offen offset:0 lds
  buffer_load_dwordx4 v140, s[8:11], s60 offen offset:1024 lds
  buffer_load_dwordx4 v141, s[8:11], s60 offen offset:2048 lds
  s_cmp_eq_u32 s57, 1
  s_cselect_b32 s68, 11, 3
  s_mul_i32 s60, s68, 196608
  s_add_u32 m0, s62, 129024
  s_nop 0
  buffer_load_dwordx4 v139, s[8:11], s60 offen offset:0 lds
  buffer_load_dwordx4 v140, s[8:11], s60 offen offset:1024 lds
  buffer_load_dwordx4 v141, s[8:11], s60 offen offset:2048 lds
  s_cmp_lg_u32 s44, 0
  s_cbranch_scc1 SM1x
  s_mov_b32 s46, 60000
  s_mov_b32 s47, 5242880
SM1:
  buffer_load_dword v12, v152, s[36:39], s47 offen sc1
  s_sub_u32 s46, s46, 1
  s_cmp_eq_u32 s46, 0
  s_waitcnt vmcnt(0)
  s_cbranch_scc1 SM1x
  v_cmp_ne_u32 vcc, 1, v12
  s_nop 4
  s_cbranch_vccnz SM1
SM1x:
  s_barrier
  s_lshl_b32 s61, s65, 11
  s_add_u32 m0, s63, 76800
  s_nop 0
  buffer_load_dwordx4 v142, s[36:39], s61 offen offset:0 sc1 lds
  buffer_load_dwordx4 v142, s[36:39], s61 offen offset:1024 sc1 lds
  s_add_u32 m0, s64, 84992
  s_nop 0
  buffer_load_dword v143, s[36:39], s61 offen sc1 lds
  s_lshl_b32 s61, s66, 11
  s_add_u32 m0, s63, 98304
  s_nop 0
  buffer_load_dwordx4 v142, s[36:39], s61 offen offset:0 sc1 lds
  buffer_load_dwordx4 v142, s[36:39], s61 offen offset:1024 sc1 lds
  s_add_u32 m0, s64, 106496
  s_nop 0
  buffer_load_dword v143, s[36:39], s61 offen sc1 lds
  s_lshl_b32 s61, s67, 11
  s_add_u32 m0, s63, 119808
  s_nop 0
  buffer_load_dwordx4 v142, s[36:39], s61 offen offset:0 sc1 lds
  buffer_load_dwordx4 v142, s[36:39], s61 offen offset:1024 sc1 lds
  s_add_u32 m0, s64, 128000
  s_nop 0
  buffer_load_dword v143, s[36:39], s61 offen sc1 lds
  s_waitcnt vmcnt(6)
  s_barrier
  ds_read_b64_tr_b16 a[40:41], v135 offset:1024
  ds_read_b64_tr_b16 a[42:43], v135 offset:7168
  ds_read_b64_tr_b16 a[44:45], v136 offset:1024
  ds_read_b64_tr_b16 a[46:47], v136 offset:7168
  ds_read_b128 a[0:3], v145 offset:12288
  ds_read_b128 a[4:7], v145 offset:13312
  ds_read_b128 a[8:11], v145 offset:14336
  ds_read_b128 a[12:15], v145 offset:15360
  ds_read_b128 a[16:19], v148 offset:20480
  s_waitcnt lgkmcnt(0)
  v_mfma_f32_16x16x32_bf16 v[20:23], a[40:43], a[0:3], 0
  s_waitcnt vmcnt(3)
  s_barrier
  v_mfma_f32_16x16x32_bf16 v[24:27], a[40:43], a[4:7], 0
  ds_read_b64_tr_b16 a[48:49], v135 offset:2048
  ds_read_b64_tr_b16 a[50:51], v135 offset:8192
  v_mfma_f32_16x16x32_bf16 v[28:31], a[40:43], a[8:11], 0
  ds_read_b64_tr_b16 a[52:53], v136 offset:2048
  ds_read_b64_tr_b16 a[54:55], v136 offset:8192
  v_mfma_f32_16x16x32_bf16 v[32:35], a[40:43], a[12:15], 0
  s_lshl_b32 s61, s68, 11
  s_add_u32 m0, s63, 141312
  v_mfma_f32_16x16x32_bf16 v[116:119], a[40:43], a[16:19], 0
  buffer_load_dwordx4 v142, s[36:39], s61 offen offset:0 sc1 lds
  ds_read_b64_tr_b16 a[56:57], v135 offset:0
  v_mfma_f32_16x16x32_bf16 v[48:51], a[44:47], a[12:15], 0
  ds_read_b64_tr_b16 a[58:59], v135 offset:6144
  ds_read_b64_tr_b16 a[60:61], v136 offset:0
  v_mfma_f32_16x16x32_bf16 v[44:47], a[44:47], a[8:11], 0
  ds_read_b64_tr_b16 a[62:63], v136 offset:6144
  v_mfma_f32_16x16x32_bf16 v[40:43], a[44:47], a[4:7], 0
  buffer_load_dwordx4 v142, s[36:39], s61 offen offset:1024 sc1 lds
  s_add_u32 m0, s64, 149504
  v_mfma_f32_16x16x32_bf16 v[36:39], a[44:47], a[0:3], 0
  ds_read_b64_tr_b16 a[64:65], v135 offset:22528
  s_waitcnt lgkmcnt(5)
  v_mfma_f32_16x16x32_bf16 v[52:55], a[0:3], a[48:51], 0
  ds_read_b128 a[20:23], v145 offset:33792
  v_mfma_f32_16x16x32_bf16 v[56:59], a[4:7], a[48:51], 0
  buffer_load_dword v143, s[36:39], s61 offen sc1 lds
  s_cmp_eq_u32 s57, 2
  v_mfma_f32_16x16x32_bf16 v[60:63], a[8:11], a[48:51], 0
  s_cselect_b32 s69, 12, 4
  s_mul_i32 s60, s69, 196608
  v_mfma_f32_16x16x32_bf16 v[64:67], a[12:15], a[48:51], 0
  s_add_u32 m0, s62, 0
  ds_read_b64_tr_b16 a[66:67], v135 offset:28672
  v_mfma_f32_16x16x32_bf16 v[120:123], a[16:19], a[48:51], 0
  buffer_load_dwordx4 v139, s[8:11], s60 offen offset:0 lds
  ds_read_b128 a[24:27], v145 offset:34816
  v_mfma_f32_16x16x32_bf16 v[80:83], a[12:15], a[52:55], 0
  ds_read_b64_tr_b16 a[68:69], v136 offset:22528
  ds_read_b128 a[28:31], v145 offset:35840
  v_mfma_f32_16x16x32_bf16 v[76:79], a[8:11], a[52:55], 0
  ds_read_b64_tr_b16 a[70:71], v136 offset:28672
  ds_read_b128 a[32:35], v145 offset:36864
  v_mfma_f32_16x16x32_bf16 v[72:75], a[4:7], a[52:55], 0
  buffer_load_dwordx4 v140, s[8:11], s60 offen offset:1024 lds
  v_mfma_f32_16x16x32_bf16 v[68:71], a[0:3], a[52:55], 0
  ds_read_b128 a[36:39], v148 offset:41984
  s_waitcnt lgkmcnt(9)
  v_mfma_f32_16x16x32_bf16 v[84:87], a[56:59], a[0:3], 0
  ds_read_b64_tr_b16 a[40:41], v135 offset:23552
  v_mfma_f32_16x16x32_bf16 v[88:91], a[56:59], a[4:7], 0
  buffer_load_dwordx4 v141, s[8:11], s60 offen offset:2048 lds
  s_lshl_b32 s61, s69, 11
  v_mfma_f32_16x16x32_bf16 v[92:95], a[56:59], a[8:11], 0
  s_add_u32 m0, s63, 12288
  ds_read_b64_tr_b16 a[42:43], v135 offset:29696
  v_mfma_f32_16x16x32_bf16 v[96:99], a[56:59], a[12:15], 0
  v_mfma_f32_16x16x32_bf16 v[112:115], a[60:63], a[12:15], 0
  buffer_load_dwordx4 v142, s[36:39], s61 offen offset:0 sc1 lds
  ds_read_b64_tr_b16 a[44:45], v136 offset:23552
  v_mfma_f32_16x16x32_bf16 v[108:111], a[60:63], a[8:11], 0
  v_mfma_f32_16x16x32_bf16 v[104:107], a[60:63], a[4:7], 0
  ds_read_b64_tr_b16 a[46:47], v136 offset:29696
  v_mfma_f32_16x16x32_bf16 v[100:103], a[60:63], a[0:3], 0
  s_waitcnt vmcnt(7) lgkmcnt(4)
  s_barrier
  v_mfma_f32_16x16x32_bf16 v[20:23], a[64:67], a[20:23], v[20:23]
  buffer_load_dwordx4 v142, s[36:39], s61 offen offset:1024 sc1 lds
  s_add_u32 m0, s64, 20480
  v_mfma_f32_16x16x32_bf16 v[24:27], a[64:67], a[24:27], v[24:27]
  ds_read_b64_tr_b16 a[48:49], v135 offset:21504
  v_mfma_f32_16x16x32_bf16 v[28:31], a[64:67], a[28:31], v[28:31]
  ds_read_b64_tr_b16 a[50:51], v135 offset:27648
  v_mfma_f32_16x16x32_bf16 v[32:35], a[64:67], a[32:35], v[32:35]
  buffer_load_dword v143, s[36:39], s61 offen sc1 lds
  s_cmp_eq_u32 s57, 2
  v_mfma_f32_16x16x32_bf16 v[116:119], a[64:67], a[36:39], v[116:119]
  s_cselect_b32 s70, 13, 5
  s_mul_i32 s60, s70, 196608
  v_mfma_f32_16x16x32_bf16 v[48:51], a[68:71], a[32:35], v[48:51]
  s_add_u32 m0, s62, 21504
  ds_read_b64_tr_b16 a[52:53], v136 offset:21504
  v_mfma_f32_16x16x32_bf16 v[44:47], a[68:71], a[28:31], v[44:47]
  buffer_load_dwordx4 v139, s[8:11], s60 offen offset:0 lds
  ds_read_b64_tr_b16 a[54:55], v136 offset:27648
  v_mfma_f32_16x16x32_bf16 v[40:43], a[68:71], a[24:27], v[40:43]
  v_mfma_f32_16x16x32_bf16 v[36:39], a[68:71], a[20:23], v[36:39]
  ds_read_b64_tr_b16 a[56:57], v135 offset:44032
  s_waitcnt lgkmcnt(5)
  v_mfma_f32_16x16x32_bf16 v[52:55], a[20:23], a[40:43], v[52:55]
  buffer_load_dwordx4 v140, s[8:11], s60 offen offset:1024 lds
  ds_read_b128 a[0:3], v145 offset:55296
  v_mfma_f32_16x16x32_bf16 v[56:59], a[24:27], a[40:43], v[56:59]
  ds_read_b64_tr_b16 a[58:59], v135 offset:50176
  v_mfma_f32_16x16x32_bf16 v[60:63], a[28:31], a[40:43], v[60:63]
  ds_read_b128 a[4:7], v145 offset:56320
  v_mfma_f32_16x16x32_bf16 v[64:67], a[32:35], a[40:43], v[64:67]
  buffer_load_dwordx4 v141, s[8:11], s60 offen offset:2048 lds
  s_lshl_b32 s61, s70, 11
  v_mfma_f32_16x16x32_bf16 v[120:123], a[36:39], a[40:43], v[120:123]
  s_add_u32 m0, s63, 33792
  ds_read_b64_tr_b16 a[60:61], v136 offset:44032
  v_mfma_f32_16x16x32_bf16 v[80:83], a[32:35], a[44:47], v[80:83]
  ds_read_b128 a[8:11], v145 offset:57344
CT2:
  s_add_u32 s94, s92, CT2-k3_main_kernel+3072
  s_addc_u32 s95, s93, 0
  v_mfma_f32_16x16x32_bf16 v[76:79], a[28:31], a[44:47], v[76:79]
  buffer_load_dwordx4 v142, s[36:39], s61 offen offset:0 sc1 lds
  ds_read_b64_tr_b16 a[62:63], v136 offset:50176
  v_mfma_f32_16x16x32_bf16 v[72:75], a[24:27], a[44:47], v[72:75]
  ds_read_b128 a[12:15], v145 offset:58368
  v_mfma_f32_16x16x32_bf16 v[68:71], a[20:23], a[44:47], v[68:71]
  ds_read_b128 a[16:19], v148 offset:63488
  s_waitcnt lgkmcnt(9)
  v_mfma_f32_16x16x32_bf16 v[84:87], a[48:51], a[20:23], v[84:87]
  buffer_load_dwordx4 v142, s[36:39], s61 offen offset:1024 sc1 lds
  s_add_u32 m0, s64, 41984
  v_mfma_f32_16x16x32_bf16 v[88:91], a[48:51], a[24:27], v[88:91]
  ds_read_b64_tr_b16 a[64:65], v135 offset:45056
  ds_read_b64_tr_b16 a[66:67], v135 offset:51200
  v_mfma_f32_16x16x32_bf16 v[92:95], a[48:51], a[28:31], v[92:95]
  v_mfma_f32_16x16x32_bf16 v[96:99], a[48:51], a[32:35], v[96:99]
  buffer_load_dword v143, s[36:39], s61 offen sc1 lds
  s_cmp_eq_u32 s57, 3
  v_mfma_f32_16x16x32_bf16 v[112:115], a[52:55], a[32:35], v[112:115]
  s_cselect_b32 s65, 14, 6
  s_mul_i32 s60, s65, 196608
  v_mfma_f32_16x16x32_bf16 v[108:111], a[52:55], a[28:31], v[108:111]
  s_add_u32 m0, s62, 43008
  ds_read_b64_tr_b16 a[68:69], v136 offset:45056
  v_mfma_f32_16x16x32_bf16 v[104:107], a[52:55], a[24:27], v[104:107]
  buffer_load_dwordx4 v139, s[8:11], s60 offen offset:0 lds
  ds_read_b64_tr_b16 a[70:71], v136 offset:51200
  v_mfma_f32_16x16x32_bf16 v[100:103], a[52:55], a[20:23], v[100:103]
  s_waitcnt vmcnt(13) lgkmcnt(4)
  s_barrier
  v_mfma_f32_16x16x32_bf16 v[20:23], a[56:59], a[0:3], v[20:23]
  ds_read_b64_tr_b16 a[40:41], v135 offset:43008
  v_mfma_f32_16x16x32_bf16 v[24:27], a[56:59], a[4:7], v[24:27]
  buffer_load_dwordx4 v140, s[8:11], s60 offen offset:1024 lds
  v_mfma_f32_16x16x32_bf16 v[28:31], a[56:59], a[8:11], v[28:31]
  ds_read_b64_tr_b16 a[42:43], v135 offset:49152
  v_mfma_f32_16x16x32_bf16 v[32:35], a[56:59], a[12:15], v[32:35]
  v_mfma_f32_16x16x32_bf16 v[116:119], a[56:59], a[16:19], v[116:119]
  buffer_load_dwordx4 v141, s[8:11], s60 offen offset:2048 lds
  s_lshl_b32 s61, s65, 11
  v_mfma_f32_16x16x32_bf16 v[48:51], a[60:63], a[12:15], v[48:51]
  s_add_u32 m0, s63, 55296
  ds_read_b64_tr_b16 a[44:45], v136 offset:43008
  v_mfma_f32_16x16x32_bf16 v[44:47], a[60:63], a[8:11], v[44:47]
  ds_read_b64_tr_b16 a[46:47], v136 offset:49152
  v_mfma_f32_16x16x32_bf16 v[40:43], a[60:63], a[4:7], v[40:43]
  buffer_load_dwordx4 v142, s[36:39], s61 offen offset:0 sc1 lds
  v_mfma_f32_16x16x32_bf16 v[36:39], a[60:63], a[0:3], v[36:39]
  ds_read_b64_tr_b16 a[48:49], v137 offset:1024
  s_waitcnt lgkmcnt(5)
  v_mfma_f32_16x16x32_bf16 v[52:55], a[0:3], a[64:67], v[52:55]
  ds_read_b128 a[20:23], v146 offset:12288
  v_mfma_f32_16x16x32_bf16 v[56:59], a[4:7], a[64:67], v[56:59]
  buffer_load_dwordx4 v142, s[36:39], s61 offen offset:1024 sc1 lds
  s_add_u32 m0, s64, 63488
  v_mfma_f32_16x16x32_bf16 v[60:63], a[8:11], a[64:67], v[60:63]
  ds_read_b64_tr_b16 a[50:51], v137 offset:7168
  ds_read_b128 a[24:27], v146 offset:13312
  v_mfma_f32_16x16x32_bf16 v[64:67], a[12:15], a[64:67], v[64:67]
  v_mfma_f32_16x16x32_bf16 v[120:123], a[16:19], a[64:67], v[120:123]
  buffer_load_dword v143, s[36:39], s61 offen sc1 lds
  s_cmp_eq_u32 s57, 3
  v_mfma_f32_16x16x32_bf16 v[80:83], a[12:15], a[68:71], v[80:83]
  s_cselect_b32 s66, 15, 7
  s_mul_i32 s60, s66, 196608
  v_mfma_f32_16x16x32_bf16 v[76:79], a[8:11], a[68:71], v[76:79]
  s_add_u32 m0, s62, 64512
  ds_read_b64_tr_b16 a[52:53], v138 offset:1024
  v_mfma_f32_16x16x32_bf16 v[72:75], a[4:7], a[68:71], v[72:75]
  buffer_load_dwordx4 v139, s[8:11], s60 offen offset:0 lds
  ds_read_b128 a[28:31], v146 offset:14336
  v_mfma_f32_16x16x32_bf16 v[68:71], a[0:3], a[68:71], v[68:71]
  ds_read_b64_tr_b16 a[54:55], v138 offset:7168
  s_waitcnt lgkmcnt(7)
  v_mfma_f32_16x16x32_bf16 v[84:87], a[40:43], a[0:3], v[84:87]
  ds_read_b128 a[32:35], v146 offset:15360
  ds_read_b128 a[36:39], v149 offset:20480
  v_mfma_f32_16x16x32_bf16 v[88:91], a[40:43], a[4:7], v[88:91]
  buffer_load_dwordx4 v140, s[8:11], s60 offen offset:1024 lds
  ds_read_b64_tr_b16 a[56:57], v137 offset:2048
  v_mfma_f32_16x16x32_bf16 v[92:95], a[40:43], a[8:11], v[92:95]
  ds_read_b64_tr_b16 a[58:59], v137 offset:8192
  v_mfma_f32_16x16x32_bf16 v[96:99], a[40:43], a[12:15], v[96:99]
  v_mfma_f32_16x16x32_bf16 v[112:115], a[44:47], a[12:15], v[112:115]
  buffer_load_dwordx4 v141, s[8:11], s60 offen offset:2048 lds
  s_lshl_b32 s61, s66, 11
  v_mfma_f32_16x16x32_bf16 v[108:111], a[44:47], a[8:11], v[108:111]
  s_add_u32 m0, s63, 76800
  ds_read_b64_tr_b16 a[60:61], v138 offset:2048
  v_mfma_f32_16x16x32_bf16 v[104:107], a[44:47], a[4:7], v[104:107]
  ds_read_b64_tr_b16 a[62:63], v138 offset:8192
  v_mfma_f32_16x16x32_bf16 v[100:103], a[44:47], a[0:3], v[100:103]
  s_waitcnt vmcnt(15) lgkmcnt(4)
  s_barrier
  v_mfma_f32_16x16x32_bf16 v[20:23], a[48:51], a[20:23], v[20:23]
  buffer_load_dwordx4 v142, s[36:39], s61 offen offset:0 sc1 lds
  ds_read_b64_tr_b16 a[64:65], v137 offset:0
  v_mfma_f32_16x16x32_bf16 v[24:27], a[48:51], a[24:27], v[24:27]
  v_mfma_f32_16x16x32_bf16 v[28:31], a[48:51], a[28:31], v[28:31]
  ds_read_b64_tr_b16 a[66:67], v137 offset:6144
  v_mfma_f32_16x16x32_bf16 v[32:35], a[48:51], a[32:35], v[32:35]
  global_load_dword a252, v0, s[94:95]
  v_mfma_f32_16x16x32_bf16 v[116:119], a[48:51], a[36:39], v[116:119]
  ds_read_b64_tr_b16 a[68:69], v138 offset:0
  v_mfma_f32_16x16x32_bf16 v[48:51], a[52:55], a[32:35], v[48:51]
  v_mfma_f32_16x16x32_bf16 v[44:47], a[52:55], a[28:31], v[44:47]
  buffer_load_dwordx4 v142, s[36:39], s61 offen offset:1024 sc1 lds
  s_add_u32 m0, s64, 84992
  v_mfma_f32_16x16x32_bf16 v[40:43], a[52:55], a[24:27], v[40:43]
  ds_read_b64_tr_b16 a[70:71], v138 offset:6144
  v_mfma_f32_16x16x32_bf16 v[36:39], a[52:55], a[20:23], v[36:39]
  ds_read_b64_tr_b16 a[40:41], v133 offset:1024
  s_waitcnt lgkmcnt(5)
  v_mfma_f32_16x16x32_bf16 v[52:55], a[20:23], a[56:59], v[52:55]
  buffer_load_dword v143, s[36:39], s61 offen sc1 lds
  s_cmp_eq_u32 s57, 0
  v_mfma_f32_16x16x32_bf16 v[56:59], a[24:27], a[56:59], v[56:59]
  s_cselect_b32 s67, 16, 8
  s_mul_i32 s60, s67, 196608
  v_mfma_f32_16x16x32_bf16 v[60:63], a[28:31], a[56:59], v[60:63]
  s_add_u32 m0, s62, 86016
  ds_read_b128 a[0:3], v144 offset:12288
  v_mfma_f32_16x16x32_bf16 v[64:67], a[32:35], a[56:59], v[64:67]
  buffer_load_dwordx4 v139, s[8:11], s60 offen offset:0 lds
  ds_read_b64_tr_b16 a[42:43], v133 offset:7168
  v_mfma_f32_16x16x32_bf16 v[120:123], a[36:39], a[56:59], v[120:123]
  ds_read_b128 a[4:7], v144 offset:13312
  ds_read_b64_tr_b16 a[44:45], v134 offset:1024
  v_mfma_f32_16x16x32_bf16 v[80:83], a[32:35], a[60:63], v[80:83]
  ds_read_b128 a[8:11], v144 offset:14336
  v_mfma_f32_16x16x32_bf16 v[76:79], a[28:31], a[60:63], v[76:79]
  buffer_load_dwordx4 v140, s[8:11], s60 offen offset:1024 lds
  ds_read_b64_tr_b16 a[46:47], v134 offset:7168
  v_mfma_f32_16x16x32_bf16 v[72:75], a[24:27], a[60:63], v[72:75]
  ds_read_b128 a[12:15], v144 offset:15360
  v_mfma_f32_16x16x32_bf16 v[68:71], a[20:23], a[60:63], v[68:71]
  ds_read_b128 a[16:19], v147 offset:20480
  s_waitcnt lgkmcnt(9)
  v_mfma_f32_16x16x32_bf16 v[84:87], a[64:67], a[20:23], v[84:87]
  buffer_load_dwordx4 v141, s[8:11], s60 offen offset:2048 lds
  s_lshl_b32 s61, s67, 11
  v_mfma_f32_16x16x32_bf16 v[88:91], a[64:67], a[24:27], v[88:91]
  s_add_u32 m0, s63, 98304
  ds_read_b64_tr_b16 a[48:49], v133 offset:2048
  v_mfma_f32_16x16x32_bf16 v[92:95], a[64:67], a[28:31], v[92:95]
  ds_read_b64_tr_b16 a[50:51], v133 offset:8192
  v_mfma_f32_16x16x32_bf16 v[96:99], a[64:67], a[32:35], v[96:99]
  buffer_load_dwordx4 v142, s[36:39], s61 offen offset:0 sc1 lds
  v_mfma_f32_16x16x32_bf16 v[112:115], a[68:71], a[32:35], v[112:115]
  ds_read_b64_tr_b16 a[52:53], v134 offset:2048
  s_and_b32 s48, s2, 3
  v_mfma_f32_16x16x32_bf16 v[108:111], a[68:71], a[28:31], v[108:111]
  s_lshl_b32 s48, s48, 8
  s_lshl_b32 s49, s44, 6
  v_mfma_f32_16x16x32_bf16 v[104:107], a[68:71], a[24:27], v[104:107]
  buffer_load_dwordx4 v142, s[36:39], s61 offen offset:1024 sc1 lds
  s_add_u32 m0, s64, 106496
  v_mfma_f32_16x16x32_bf16 v[100:103], a[68:71], a[20:23], v[100:103]
  s_waitcnt vmcnt(18) lgkmcnt(3)
  s_barrier
  v_mfma_f32_16x16x32_bf16 v[20:23], a[40:43], a[0:3], v[20:23]
  ds_read_b64_tr_b16 a[54:55], v134 offset:8192
  ds_read_b64_tr_b16 a[56:57], v133 offset:0
  v_mfma_f32_16x16x32_bf16 v[24:27], a[40:43], a[4:7], v[24:27]
  buffer_load_dword v143, s[36:39], s61 offen sc1 lds
  s_cmp_eq_u32 s57, 0
  v_mfma_f32_16x16x32_bf16 v[28:31], a[40:43], a[8:11], v[28:31]
  s_cselect_b32 s68, 17, 9
  s_mul_i32 s60, s68, 196608
  v_mfma_f32_16x16x32_bf16 v[32:35], a[40:43], a[12:15], v[32:35]
  s_add_u32 m0, s62, 107520
  ds_read_b64_tr_b16 a[58:59], v133 offset:6144
  v_mfma_f32_16x16x32_bf16 v[116:119], a[40:43], a[16:19], v[116:119]
  buffer_load_dwordx4 v139, s[8:11], s60 offen offset:0 lds
  ds_read_b64_tr_b16 a[60:61], v134 offset:0
  v_mfma_f32_16x16x32_bf16 v[48:51], a[44:47], a[12:15], v[48:51]
  s_add_u32 s48, s48, s49
  v_and_b32 v196, 0x38, v10
  v_mfma_f32_16x16x32_bf16 v[44:47], a[44:47], a[8:11], v[44:47]
  ds_read_b64_tr_b16 a[62:63], v134 offset:6144
  v_add_u32 v196, s48, v196
  v_mfma_f32_16x16x32_bf16 v[40:43], a[44:47], a[4:7], v[40:43]
  buffer_load_dwordx4 v140, s[8:11], s60 offen offset:1024 lds
  v_lshlrev_b32 v12, 1, v196
  v_mfma_f32_16x16x32_bf16 v[36:39], a[44:47], a[0:3], v[36:39]
  ds_read_b64_tr_b16 a[64:65], v133 offset:22528
  s_waitcnt lgkmcnt(5)
  v_mfma_f32_16x16x32_bf16 v[52:55], a[0:3], a[48:51], v[52:55]
  ds_read_b128 a[20:23], v144 offset:33792
  v_mfma_f32_16x16x32_bf16 v[56:59], a[4:7], a[48:51], v[56:59]
  buffer_load_dwordx4 v141, s[8:11], s60 offen offset:2048 lds
  s_lshl_b32 s61, s68, 11
  v_mfma_f32_16x16x32_bf16 v[60:63], a[8:11], a[48:51], v[60:63]
  s_add_u32 m0, s63, 119808
  ds_read_b64_tr_b16 a[66:67], v133 offset:28672
  v_mfma_f32_16x16x32_bf16 v[64:67], a[12:15], a[48:51], v[64:67]
  ds_read_b128 a[24:27], v144 offset:34816
  v_mfma_f32_16x16x32_bf16 v[120:123], a[16:19], a[48:51], v[120:123]
  buffer_load_dwordx4 v142, s[36:39], s61 offen offset:0 sc1 lds
  ds_read_b64_tr_b16 a[68:69], v134 offset:22528
  v_mfma_f32_16x16x32_bf16 v[80:83], a[12:15], a[52:55], v[80:83]
  ds_read_b128 a[28:31], v144 offset:35840
  v_mfma_f32_16x16x32_bf16 v[76:79], a[8:11], a[52:55], v[76:79]
  ds_read_b64_tr_b16 a[70:71], v134 offset:28672
  ds_read_b128 a[32:35], v144 offset:36864
  v_mfma_f32_16x16x32_bf16 v[72:75], a[4:7], a[52:55], v[72:75]
  buffer_load_dwordx4 v142, s[36:39], s61 offen offset:1024 sc1 lds
  s_add_u32 m0, s64, 128000
  v_mfma_f32_16x16x32_bf16 v[68:71], a[0:3], a[52:55], v[68:71]
  ds_read_b128 a[36:39], v147 offset:41984
  s_waitcnt lgkmcnt(9)
  v_mfma_f32_16x16x32_bf16 v[84:87], a[56:59], a[0:3], v[84:87]
  ds_read_b64_tr_b16 a[40:41], v133 offset:23552
  v_mfma_f32_16x16x32_bf16 v[88:91], a[56:59], a[4:7], v[88:91]
  buffer_load_dword v143, s[36:39], s61 offen sc1 lds
  s_cmp_eq_u32 s57, 1
  v_mfma_f32_16x16x32_bf16 v[92:95], a[56:59], a[8:11], v[92:95]
  s_cselect_b32 s69, 18, 10
  s_mul_i32 s60, s69, 196608
  v_mfma_f32_16x16x32_bf16 v[96:99], a[56:59], a[12:15], v[96:99]
  s_add_u32 m0, s62, 129024
  ds_read_b64_tr_b16 a[42:43], v133 offset:29696
  v_mfma_f32_16x16x32_bf16 v[112:115], a[60:63], a[12:15], v[112:115]
  buffer_load_dwordx4 v139, s[8:11], s60 offen offset:0 lds
  ds_read_b64_tr_b16 a[44:45], v134 offset:23552
  v_mfma_f32_16x16x32_bf16 v[108:111], a[60:63], a[8:11], v[108:111]
  v_mfma_f32_16x16x32_bf16 v[104:107], a[60:63], a[4:7], v[104:107]
  ds_read_b64_tr_b16 a[46:47], v134 offset:29696
  v_mfma_f32_16x16x32_bf16 v[100:103], a[60:63], a[0:3], v[100:103]
  s_waitcnt vmcnt(20) lgkmcnt(4)
  s_barrier
  v_mfma_f32_16x16x32_bf16 v[20:23], a[64:67], a[20:23], v[20:23]
  buffer_load_dwordx4 v140, s[8:11], s60 offen offset:1024 lds
  ds_read_b64_tr_b16 a[48:49], v133 offset:21504
  v_mfma_f32_16x16x32_bf16 v[24:27], a[64:67], a[24:27], v[24:27]
  v_mfma_f32_16x16x32_bf16 v[28:31], a[64:67], a[28:31], v[28:31]
  ds_read_b64_tr_b16 a[50:51], v133 offset:27648
  v_mfma_f32_16x16x32_bf16 v[32:35], a[64:67], a[32:35], v[32:35]
  buffer_load_dwordx4 v141, s[8:11], s60 offen offset:2048 lds
  s_lshl_b32 s61, s69, 11
  v_mfma_f32_16x16x32_bf16 v[116:119], a[64:67], a[36:39], v[116:119]
  s_add_u32 m0, s63, 141312
  ds_read_b64_tr_b16 a[52:53], v134 offset:21504
  v_mfma_f32_16x16x32_bf16 v[48:51], a[68:71], a[32:35], v[48:51]
  v_mfma_f32_16x16x32_bf16 v[44:47], a[68:71], a[28:31], v[44:47]
  buffer_load_dwordx4 v142, s[36:39], s61 offen offset:0 sc1 lds
  ds_read_b64_tr_b16 a[54:55], v134 offset:27648
  v_mfma_f32_16x16x32_bf16 v[40:43], a[68:71], a[24:27], v[40:43]
  v_mfma_f32_16x16x32_bf16 v[36:39], a[68:71], a[20:23], v[36:39]
  ds_read_b64_tr_b16 a[56:57], v133 offset:44032
  s_waitcnt lgkmcnt(5)
  v_mfma_f32_16x16x32_bf16 v[52:55], a[20:23], a[40:43], v[52:55]
  buffer_load_dwordx4 v142, s[36:39], s61 offen offset:1024 sc1 lds
  s_add_u32 m0, s64, 149504
  v_mfma_f32_16x16x32_bf16 v[56:59], a[24:27], a[40:43], v[56:59]
  ds_read_b128 a[0:3], v144 offset:55296
  ds_read_b64_tr_b16 a[58:59], v133 offset:50176
  v_mfma_f32_16x16x32_bf16 v[60:63], a[28:31], a[40:43], v[60:63]
  ds_read_b128 a[4:7], v144 offset:56320
  v_mfma_f32_16x16x32_bf16 v[64:67], a[32:35], a[40:43], v[64:67]
  buffer_load_dword v143, s[36:39], s61 offen sc1 lds
  s_cmp_eq_u32 s57, 1
  v_mfma_f32_16x16x32_bf16 v[120:123], a[36:39], a[40:43], v[120:123]
  s_cselect_b32 s70, 19, 11
  s_mul_i32 s60, s70, 196608
  v_mfma_f32_16x16x32_bf16 v[80:83], a[32:35], a[44:47], v[80:83]
  s_add_u32 m0, s62, 0
  ds_read_b64_tr_b16 a[60:61], v134 offset:44032
  v_mfma_f32_16x16x32_bf16 v[76:79], a[28:31], a[44:47], v[76:79]
  buffer_load_dwordx4 v139, s[8:11], s60 offen offset:0 lds
  ds_read_b128 a[8:11], v144 offset:57344
  v_mfma_f32_16x16x32_bf16 v[72:75], a[24:27], a[44:47], v[72:75]
  ds_read_b64_tr_b16 a[62:63], v134 offset:50176
  ds_read_b128 a[12:15], v144 offset:58368
  v_mfma_f32_16x16x32_bf16 v[68:71], a[20:23], a[44:47], v[68:71]
  ds_read_b128 a[16:19], v147 offset:63488
  s_waitcnt lgkmcnt(9)
  v_mfma_f32_16x16x32_bf16 v[84:87], a[48:51], a[20:23], v[84:87]
  buffer_load_dwordx4 v140, s[8:11], s60 offen offset:1024 lds
  ds_read_b64_tr_b16 a[64:65], v133 offset:45056
  v_mfma_f32_16x16x32_bf16 v[88:91], a[48:51], a[24:27], v[88:91]
  ds_read_b64_tr_b16 a[66:67], v133 offset:51200
  v_mfma_f32_16x16x32_bf16 v[92:95], a[48:51], a[28:31], v[92:95]
  v_mfma_f32_16x16x32_bf16 v[96:99], a[48:51], a[32:35], v[96:99]
  buffer_load_dwordx4 v141, s[8:11], s60 offen offset:2048 lds
  s_lshl_b32 s61, s70, 11
  v_mfma_f32_16x16x32_bf16 v[112:115], a[52:55], a[32:35], v[112:115]
  s_add_u32 m0, s63, 12288
  ds_read_b64_tr_b16 a[68:69], v134 offset:45056
  v_mfma_f32_16x16x32_bf16 v[108:111], a[52:55], a[28:31], v[108:111]
  v_mfma_f32_16x16x32_bf16 v[104:107], a[52:55], a[24:27], v[104:107]
  buffer_load_dwordx4 v142, s[36:39], s61 offen offset:0 sc1 lds
  ds_read_b64_tr_b16 a[70:71], v134 offset:51200
  v_mfma_f32_16x16x32_bf16 v[100:103], a[52:55], a[20:23], v[100:103]
  s_waitcnt vmcnt(22) lgkmcnt(4)
  s_barrier
  v_mfma_f32_16x16x32_bf16 v[20:23], a[56:59], a[0:3], v[20:23]
  ds_read_b64_tr_b16 a[40:41], v133 offset:43008
  v_mfma_f32_16x16x32_bf16 v[24:27], a[56:59], a[4:7], v[24:27]
  buffer_load_dwordx4 v142, s[36:39], s61 offen offset:1024 sc1 lds
  s_add_u32 m0, s64, 20480
  v_mfma_f32_16x16x32_bf16 v[28:31], a[56:59], a[8:11], v[28:31]
  ds_read_b64_tr_b16 a[42:43], v133 offset:49152
  v_mfma_f32_16x16x32_bf16 v[32:35], a[56:59], a[12:15], v[32:35]
  v_mfma_f32_16x16x32_bf16 v[116:119], a[56:59], a[16:19], v[116:119]
  buffer_load_dword v143, s[36:39], s61 offen sc1 lds
  s_cmp_eq_u32 s57, 2
  v_mfma_f32_16x16x32_bf16 v[48:51], a[60:63], a[12:15], v[48:51]
  s_cselect_b32 s65, 20, 12
  s_mul_i32 s60, s65, 196608
  v_mfma_f32_16x16x32_bf16 v[44:47], a[60:63], a[8:11], v[44:47]
  s_add_u32 m0, s62, 21504
  ds_read_b64_tr_b16 a[44:45], v134 offset:43008
  v_mfma_f32_16x16x32_bf16 v[40:43], a[60:63], a[4:7], v[40:43]
  buffer_load_dwordx4 v139, s[8:11], s60 offen offset:0 lds
  ds_read_b64_tr_b16 a[46:47], v134 offset:49152
  v_mfma_f32_16x16x32_bf16 v[36:39], a[60:63], a[0:3], v[36:39]
  ds_read_b64_tr_b16 a[48:49], v135 offset:1024
  s_waitcnt lgkmcnt(5)
  v_mfma_f32_16x16x32_bf16 v[52:55], a[0:3], a[64:67], v[52:55]
  ds_read_b128 a[20:23], v145 offset:12288
  v_mfma_f32_16x16x32_bf16 v[56:59], a[4:7], a[64:67], v[56:59]
  buffer_load_dwordx4 v140, s[8:11], s60 offen offset:1024 lds
  ds_read_b64_tr_b16 a[50:51], v135 offset:7168
  v_mfma_f32_16x16x32_bf16 v[60:63], a[8:11], a[64:67], v[60:63]
  ds_read_b128 a[24:27], v145 offset:13312
  v_mfma_f32_16x16x32_bf16 v[64:67], a[12:15], a[64:67], v[64:67]
  v_mfma_f32_16x16x32_bf16 v[120:123], a[16:19], a[64:67], v[120:123]
  buffer_load_dwordx4 v141, s[8:11], s60 offen offset:2048 lds
  s_lshl_b32 s61, s65, 11
  v_mfma_f32_16x16x32_bf16 v[80:83], a[12:15], a[68:71], v[80:83]
  s_add_u32 m0, s63, 33792
  ds_read_b64_tr_b16 a[52:53], v136 offset:1024
  v_mfma_f32_16x16x32_bf16 v[76:79], a[8:11], a[68:71], v[76:79]
  ds_read_b128 a[28:31], v145 offset:14336
  ds_read_b64_tr_b16 a[54:55], v136 offset:7168
  v_mfma_f32_16x16x32_bf16 v[72:75], a[4:7], a[68:71], v[72:75]
  buffer_load_dwordx4 v142, s[36:39], s61 offen offset:0 sc1 lds
  ds_read_b128 a[32:35], v145 offset:15360
  v_mfma_f32_16x16x32_bf16 v[68:71], a[0:3], a[68:71], v[68:71]
  ds_read_b128 a[36:39], v148 offset:20480
  s_waitcnt lgkmcnt(9)
  v_mfma_f32_16x16x32_bf16 v[84:87], a[40:43], a[0:3], v[84:87]
  ds_read_b64_tr_b16 a[56:57], v135 offset:2048
  v_mfma_f32_16x16x32_bf16 v[88:91], a[40:43], a[4:7], v[88:91]
  buffer_load_dwordx4 v142, s[36:39], s61 offen offset:1024 sc1 lds
  s_add_u32 m0, s64, 41984
  v_mfma_f32_16x16x32_bf16 v[92:95], a[40:43], a[8:11], v[92:95]
  ds_read_b64_tr_b16 a[58:59], v135 offset:8192
  v_mfma_f32_16x16x32_bf16 v[96:99], a[40:43], a[12:15], v[96:99]
  v_mfma_f32_16x16x32_bf16 v[112:115], a[44:47], a[12:15], v[112:115]
  buffer_load_dword v143, s[36:39], s61 offen sc1 lds
  ds_read_b64_tr_b16 a[60:61], v136 offset:2048
  v_mfma_f32_16x16x32_bf16 v[108:111], a[44:47], a[8:11], v[108:111]
  v_mfma_f32_16x16x32_bf16 v[104:107], a[44:47], a[4:7], v[104:107]
  s_cmp_eq_u32 s57, 2
  s_cselect_b32 s66, 21, 13
  v_mfma_f32_16x16x32_bf16 v[100:103], a[44:47], a[0:3], v[100:103]
  s_waitcnt vmcnt(24) lgkmcnt(3)
  s_barrier
  v_mfma_f32_16x16x32_bf16 v[20:23], a[48:51], a[20:23], v[20:23]
  s_mul_i32 s60, s66, 196608
  s_add_u32 m0, s62, 43008
  v_mfma_f32_16x16x32_bf16 v[24:27], a[48:51], a[24:27], v[24:27]
  ds_read_b64_tr_b16 a[62:63], v136 offset:8192
  ds_read_b64_tr_b16 a[64:65], v135 offset:0
  v_mfma_f32_16x16x32_bf16 v[28:31], a[48:51], a[28:31], v[28:31]
  buffer_load_dwordx4 v139, s[8:11], s60 offen offset:0 lds
  ds_read_b64_tr_b16 a[66:67], v135 offset:6144
  v_mfma_f32_16x16x32_bf16 v[32:35], a[48:51], a[32:35], v[32:35]
  v_mfma_f32_16x16x32_bf16 v[116:119], a[48:51], a[36:39], v[116:119]
  ds_read_b64_tr_b16 a[68:69], v136 offset:0
  v_mfma_f32_16x16x32_bf16 v[48:51], a[52:55], a[32:35], v[48:51]
  buffer_load_dwordx4 v140, s[8:11], s60 offen offset:1024 lds
  v_mfma_f32_16x16x32_bf16 v[44:47], a[52:55], a[28:31], v[44:47]
  ds_read_b64_tr_b16 a[70:71], v136 offset:6144
  v_mfma_f32_16x16x32_bf16 v[40:43], a[52:55], a[24:27], v[40:43]
  v_mfma_f32_16x16x32_bf16 v[36:39], a[52:55], a[20:23], v[36:39]
  ds_read_b64_tr_b16 a[40:41], v135 offset:22528
  s_waitcnt lgkmcnt(5)
  v_mfma_f32_16x16x32_bf16 v[52:55], a[20:23], a[56:59], v[52:55]
  buffer_load_dwordx4 v141, s[8:11], s60 offen offset:2048 lds
  ds_read_b128 a[0:3], v145 offset:33792
  v_mfma_f32_16x16x32_bf16 v[56:59], a[24:27], a[56:59], v[56:59]
  ds_read_b64_tr_b16 a[42:43], v135 offset:28672
  v_mfma_f32_16x16x32_bf16 v[60:63], a[28:31], a[56:59], v[60:63]
  s_lshl_b32 s61, s66, 11
  s_add_u32 m0, s63, 55296
  v_mfma_f32_16x16x32_bf16 v[64:67], a[32:35], a[56:59], v[64:67]
  ds_read_b128 a[4:7], v145 offset:34816
  buffer_load_dwordx4 v[208:211], v12, s[40:43], 0 offen
  v_mfma_f32_16x16x32_bf16 v[120:123], a[36:39], a[56:59], v[120:123]
  ds_read_b64_tr_b16 a[44:45], v136 offset:22528
  ds_read_b128 a[8:11], v145 offset:35840
  v_mfma_f32_16x16x32_bf16 v[80:83], a[32:35], a[60:63], v[80:83]
  v_mul_u32_u24 v196, 12288, v196
  v_and_b32 v12, 7, v10
  v_mfma_f32_16x16x32_bf16 v[76:79], a[28:31], a[60:63], v[76:79]
  buffer_load_dwordx4 v142, s[36:39], s61 offen offset:0 sc1 lds
  ds_read_b64_tr_b16 a[46:47], v136 offset:28672
  v_mfma_f32_16x16x32_bf16 v[72:75], a[24:27], a[60:63], v[72:75]
  ds_read_b128 a[12:15], v145 offset:36864
  v_lshl_add_u32 v196, v12, 4, v196
  v_mfma_f32_16x16x32_bf16 v[68:71], a[20:23], a[60:63], v[68:71]
  ds_read_b128 a[16:19], v148 offset:41984
  s_waitcnt lgkmcnt(9)
  v_mfma_f32_16x16x32_bf16 v[84:87], a[64:67], a[20:23], v[84:87]
  ds_read_b64_tr_b16 a[48:49], v135 offset:23552
  buffer_load_dwordx4 v142, s[36:39], s61 offen offset:1024 sc1 lds
  v_mfma_f32_16x16x32_bf16 v[88:91], a[64:67], a[24:27], v[88:91]
  s_add_u32 m0, s64, 63488
  ds_read_b64_tr_b16 a[50:51], v135 offset:29696
  v_mfma_f32_16x16x32_bf16 v[92:95], a[64:67], a[28:31], v[92:95]
  v_lshlrev_b32 v12, 5, v12
  v_lshrrev_b32 v13, 4, v10
  v_mfma_f32_16x16x32_bf16 v[96:99], a[64:67], a[32:35], v[96:99]
  v_lshl_add_u32 v12, v13, 3, v12
  s_add_u32 s48, s64, 162816
  v_mfma_f32_16x16x32_bf16 v[112:115], a[68:71], a[32:35], v[112:115]
  buffer_load_dword v143, s[36:39], s61 offen sc1 lds
  ds_read_b64_tr_b16 a[52:53], v136 offset:23552
  v_mfma_f32_16x16x32_bf16 v[108:111], a[68:71], a[28:31], v[108:111]
  v_add_u32 v197, s48, v12
  v_lshlrev_b32 v198, 2, v10
  v_mfma_f32_16x16x32_bf16 v[104:107], a[68:71], a[24:27], v[104:107]
  s_cmp_eq_u32 s57, 3
  s_cselect_b32 s67, 22, 14
  v_mfma_f32_16x16x32_bf16 v[100:103], a[68:71], a[20:23], v[100:103]
  s_waitcnt vmcnt(25) lgkmcnt(3)
  s_barrier
  v_mfma_f32_16x16x32_bf16 v[20:23], a[40:43], a[0:3], v[20:23]
  s_mul_i32 s60, s67, 196608
  s_add_u32 m0, s62, 64512
  v_mfma_f32_16x16x32_bf16 v[24:27], a[40:43], a[4:7], v[24:27]
  ds_read_b64_tr_b16 a[54:55], v136 offset:29696
  ds_read_b64_tr_b16 a[56:57], v135 offset:21504
  v_mfma_f32_16x16x32_bf16 v[28:31], a[40:43], a[8:11], v[28:31]
  buffer_load_dwordx4 v139, s[8:11], s60 offen offset:0 lds
  ds_read_b64_tr_b16 a[58:59], v135 offset:27648
  v_mfma_f32_16x16x32_bf16 v[32:35], a[40:43], a[12:15], v[32:35]
  s_lshr_b32 s48, s2, 2
  s_and_b32 s49, s2, 3
  v_mfma_f32_16x16x32_bf16 v[116:119], a[40:43], a[16:19], v[116:119]
  ds_read_b64_tr_b16 a[60:61], v136 offset:21504
  s_lshl_b32 s52, s48, 7
  v_mfma_f32_16x16x32_bf16 v[48:51], a[44:47], a[12:15], v[48:51]
  buffer_load_dwordx4 v140, s[8:11], s60 offen offset:1024 lds
  s_lshl2_add_u32 s54, s49, s52
  v_mfma_f32_16x16x32_bf16 v[44:47], a[44:47], a[8:11], v[44:47]
  ds_read_b64_tr_b16 a[62:63], v136 offset:27648
  s_add_u32 s54, s54, 5308416
  v_mfma_f32_16x16x32_bf16 v[40:43], a[44:47], a[4:7], v[40:43]
  s_mul_i32 s53, s49, 24576
  s_lshl1_add_u32 s53, s52, s53
  v_mfma_f32_16x16x32_bf16 v[36:39], a[44:47], a[0:3], v[36:39]
  ds_read_b64_tr_b16 a[64:65], v135 offset:44032
  s_waitcnt lgkmcnt(5)
  v_mfma_f32_16x16x32_bf16 v[52:55], a[0:3], a[48:51], v[52:55]
  buffer_load_dwordx4 v141, s[8:11], s60 offen offset:2048 lds
  ds_read_b128 a[20:23], v145 offset:55296
  v_mfma_f32_16x16x32_bf16 v[56:59], a[4:7], a[48:51], v[56:59]
  ds_read_b64_tr_b16 a[66:67], v135 offset:50176
  s_add_u32 s53, s53, 8192
  v_mfma_f32_16x16x32_bf16 v[60:63], a[8:11], a[48:51], v[60:63]
  s_lshl_b32 s61, s67, 11
  s_add_u32 m0, s63, 76800
  v_mfma_f32_16x16x32_bf16 v[64:67], a[12:15], a[48:51], v[64:67]
  ds_read_b128 a[24:27], v145 offset:56320
  s_add_u32 s52, s52, 4096
  v_mfma_f32_16x16x32_bf16 v[120:123], a[16:19], a[48:51], v[120:123]
  ds_read_b64_tr_b16 a[68:69], v136 offset:44032
  ds_read_b128 a[28:31], v145 offset:57344
  v_mfma_f32_16x16x32_bf16 v[80:83], a[12:15], a[52:55], v[80:83]
  buffer_load_dwordx4 v142, s[36:39], s61 offen offset:0 sc1 lds
  s_lshr_b32 s49, s2, 3
  v_mfma_f32_16x16x32_bf16 v[76:79], a[8:11], a[52:55], v[76:79]
  ds_read_b64_tr_b16 a[70:71], v136 offset:50176
  ds_read_b128 a[32:35], v145 offset:58368
  v_mfma_f32_16x16x32_bf16 v[72:75], a[4:7], a[52:55], v[72:75]
  s_and_b32 s72, s49, 7
  s_and_b32 s48, s2, 1
  v_mfma_f32_16x16x32_bf16 v[68:71], a[0:3], a[52:55], v[68:71]
  ds_read_b128 a[36:39], v148 offset:63488
  s_waitcnt lgkmcnt(9)
  v_mfma_f32_16x16x32_bf16 v[84:87], a[56:59], a[0:3], v[84:87]
  ds_read_b64_tr_b16 a[40:41], v135 offset:45056
  buffer_load_dwordx4 v142, s[36:39], s61 offen offset:1024 sc1 lds
  v_mfma_f32_16x16x32_bf16 v[88:91], a[56:59], a[4:7], v[88:91]
  s_add_u32 m0, s64, 84992
  ds_read_b64_tr_b16 a[42:43], v135 offset:51200
  v_mfma_f32_16x16x32_bf16 v[92:95], a[56:59], a[8:11], v[92:95]
  s_lshl1_add_u32 s71, s72, s48
  s_bfe_u32 s55, s2, 0x20001
  v_mfma_f32_16x16x32_bf16 v[96:99], a[56:59], a[12:15], v[96:99]
  s_lshr_b32 s49, s2, 6
  s_lshl2_add_u32 s55, s55, s49
  v_mfma_f32_16x16x32_bf16 v[112:115], a[60:63], a[12:15], v[112:115]
  buffer_load_dword v143, s[36:39], s61 offen sc1 lds
  ds_read_b64_tr_b16 a[44:45], v136 offset:45056
  v_mfma_f32_16x16x32_bf16 v[108:111], a[60:63], a[8:11], v[108:111]
  s_lshl_b32 s74, s44, 12
  s_lshl_b32 s48, s71, 7
  v_mfma_f32_16x16x32_bf16 v[104:107], a[60:63], a[4:7], v[104:107]
  s_cmp_eq_u32 s57, 3
  s_cselect_b32 s68, 23, 15
  v_mfma_f32_16x16x32_bf16 v[100:103], a[60:63], a[0:3], v[100:103]
  s_waitcnt vmcnt(25) lgkmcnt(3)
  s_barrier
  v_mfma_f32_16x16x32_bf16 v[20:23], a[64:67], a[20:23], v[20:23]
  s_mul_i32 s60, s68, 196608
  s_add_u32 m0, s62, 86016
  v_mfma_f32_16x16x32_bf16 v[24:27], a[64:67], a[24:27], v[24:27]
  ds_read_b64_tr_b16 a[46:47], v136 offset:51200
  ds_read_b64_tr_b16 a[48:49], v135 offset:43008
  v_mfma_f32_16x16x32_bf16 v[28:31], a[64:67], a[28:31], v[28:31]
  buffer_load_dwordx4 v139, s[8:11], s60 offen offset:0 lds
  ds_read_b64_tr_b16 a[50:51], v135 offset:49152
  v_mfma_f32_16x16x32_bf16 v[32:35], a[64:67], a[32:35], v[32:35]
  s_lshl_b32 s49, s44, 16
  s_add_u32 s48, s48, s49
  v_mfma_f32_16x16x32_bf16 v[116:119], a[64:67], a[36:39], v[116:119]
  ds_read_b64_tr_b16 a[52:53], v136 offset:43008
  v_lshrrev_b32 v12, 3, v10
  v_mfma_f32_16x16x32_bf16 v[48:51], a[68:71], a[32:35], v[48:51]
  buffer_load_dwordx4 v140, s[8:11], s60 offen offset:1024 lds
  v_lshlrev_b32 v12, 11, v12
  v_mfma_f32_16x16x32_bf16 v[44:47], a[68:71], a[28:31], v[44:47]
  ds_read_b64_tr_b16 a[54:55], v136 offset:49152
  v_add3_u32 v216, v12, v150, s48
  v_mfma_f32_16x16x32_bf16 v[40:43], a[68:71], a[24:27], v[40:43]
  v_add_u32 v217, 15360, v216
  v_add_u32 v218, 30720, v216
  v_mfma_f32_16x16x32_bf16 v[36:39], a[68:71], a[20:23], v[36:39]
  ds_read_b64_tr_b16 a[56:57], v137 offset:1024
  s_waitcnt lgkmcnt(5)
  v_mfma_f32_16x16x32_bf16 v[52:55], a[20:23], a[40:43], v[52:55]
  buffer_load_dwordx4 v141, s[8:11], s60 offen offset:2048 lds
  ds_read_b128 a[0:3], v146 offset:12288
  v_mfma_f32_16x16x32_bf16 v[56:59], a[24:27], a[40:43], v[56:59]
  ds_read_b64_tr_b16 a[58:59], v137 offset:7168
  v_add_u32 v219, 46080, v216
  v_mfma_f32_16x16x32_bf16 v[60:63], a[28:31], a[40:43], v[60:63]
  s_lshl_b32 s61, s68, 11
  s_add_u32 m0, s63, 98304
  v_mfma_f32_16x16x32_bf16 v[64:67], a[32:35], a[40:43], v[64:67]
  ds_read_b128 a[4:7], v146 offset:13312
  s_lshl_b32 s73, s55, 18
  v_mfma_f32_16x16x32_bf16 v[120:123], a[36:39], a[40:43], v[120:123]
  ds_read_b64_tr_b16 a[60:61], v138 offset:1024
  ds_read_b128 a[8:11], v146 offset:14336
  v_mfma_f32_16x16x32_bf16 v[80:83], a[32:35], a[44:47], v[80:83]
  buffer_load_dwordx4 v142, s[36:39], s61 offen offset:0 sc1 lds
  s_add_u32 s73, s73, s48
  v_mfma_f32_16x16x32_bf16 v[76:79], a[28:31], a[44:47], v[76:79]
  ds_read_b64_tr_b16 a[62:63], v138 offset:7168
  ds_read_b128 a[12:15], v146 offset:15360
  v_mfma_f32_16x16x32_bf16 v[72:75], a[24:27], a[44:47], v[72:75]
  v_and_b32 v13, 7, v10
  v_lshrrev_b32 v14, 4, v10
  v_mfma_f32_16x16x32_bf16 v[68:71], a[20:23], a[44:47], v[68:71]
  ds_read_b128 a[16:19], v149 offset:20480
  s_waitcnt lgkmcnt(9)
  v_mfma_f32_16x16x32_bf16 v[84:87], a[48:51], a[20:23], v[84:87]
  ds_read_b64_tr_b16 a[64:65], v137 offset:2048
  buffer_load_dwordx4 v142, s[36:39], s61 offen offset:1024 sc1 lds
  v_mfma_f32_16x16x32_bf16 v[88:91], a[48:51], a[24:27], v[88:91]
  s_add_u32 m0, s64, 106496
  ds_read_b64_tr_b16 a[66:67], v137 offset:8192
  v_mfma_f32_16x16x32_bf16 v[92:95], a[48:51], a[28:31], v[92:95]
  v_xor_b32 v13, v13, v14
  v_lshl_add_u32 v220, v13, 4, v12
  v_mfma_f32_16x16x32_bf16 v[96:99], a[48:51], a[32:35], v[96:99]
  v_xor_b32 v221, 64, v220
  v_add_u32 v221, 15360, v221
  v_mfma_f32_16x16x32_bf16 v[112:115], a[52:55], a[32:35], v[112:115]
  buffer_load_dword v143, s[36:39], s61 offen sc1 lds
  ds_read_b64_tr_b16 a[68:69], v138 offset:2048
  v_mfma_f32_16x16x32_bf16 v[108:111], a[52:55], a[28:31], v[108:111]
  s_lshl_b32 s48, s44, 10
  s_add_u32 s48, s48, 147456
  v_mfma_f32_16x16x32_bf16 v[104:107], a[52:55], a[24:27], v[104:107]
  s_cmp_eq_u32 s57, 0
  s_cselect_b32 s69, 24, 16
  v_mfma_f32_16x16x32_bf16 v[100:103], a[52:55], a[20:23], v[100:103]
  s_waitcnt vmcnt(25) lgkmcnt(3)
  s_barrier
  v_mfma_f32_16x16x32_bf16 v[20:23], a[56:59], a[0:3], v[20:23]
  s_mul_i32 s60, s69, 196608
  s_add_u32 m0, s62, 107520
  v_mfma_f32_16x16x32_bf16 v[24:27], a[56:59], a[4:7], v[24:27]
  ds_read_b64_tr_b16 a[70:71], v138 offset:8192
  ds_read_b64_tr_b16 a[40:41], v137 offset:0
  v_mfma_f32_16x16x32_bf16 v[28:31], a[56:59], a[8:11], v[28:31]
  buffer_load_dwordx4 v139, s[8:11], s60 offen offset:0 lds
  ds_read_b64_tr_b16 a[42:43], v137 offset:6144
  v_mfma_f32_16x16x32_bf16 v[32:35], a[56:59], a[12:15], v[32:35]
  v_add_u32 v246, s48, v0
  v_lshl_add_u32 v244, v14, 4, s48
  v_mfma_f32_16x16x32_bf16 v[116:119], a[56:59], a[16:19], v[116:119]
  ds_read_b64_tr_b16 a[44:45], v138 offset:0
  v_and_b32 v12, 1, v10
  v_mfma_f32_16x16x32_bf16 v[48:51], a[60:63], a[12:15], v[48:51]
  buffer_load_dwordx4 v140, s[8:11], s60 offen offset:1024 lds
  v_lshlrev_b32 v12, 8, v12
  v_mfma_f32_16x16x32_bf16 v[44:47], a[60:63], a[8:11], v[44:47]
  ds_read_b64_tr_b16 a[46:47], v138 offset:6144
  v_sub_u32 v245, v244, v12
  v_mfma_f32_16x16x32_bf16 v[40:43], a[60:63], a[4:7], v[40:43]
  s_lshl_b32 s48, s71, 7
  v_lshl_add_u32 v247, v14, 11, s48
  v_mfma_f32_16x16x32_bf16 v[36:39], a[60:63], a[0:3], v[36:39]
  ds_read_b64_tr_b16 a[48:49], v133 offset:1024
  s_waitcnt lgkmcnt(5)
  v_mfma_f32_16x16x32_bf16 v[52:55], a[0:3], a[64:67], v[52:55]
  buffer_load_dwordx4 v141, s[8:11], s60 offen offset:2048 lds
  ds_read_b128 a[20:23], v144 offset:12288
  v_mfma_f32_16x16x32_bf16 v[56:59], a[4:7], a[64:67], v[56:59]
  ds_read_b64_tr_b16 a[50:51], v133 offset:7168
  v_and_b32 v13, 0xf0, v0
  v_mfma_f32_16x16x32_bf16 v[60:63], a[8:11], a[64:67], v[60:63]
  s_lshl_b32 s61, s69, 11
  s_add_u32 m0, s63, 119808
  v_mfma_f32_16x16x32_bf16 v[64:67], a[12:15], a[64:67], v[64:67]
  ds_read_b128 a[24:27], v144 offset:13312
  v_lshl_add_u32 v13, v14, 12, v13
  v_mfma_f32_16x16x32_bf16 v[120:123], a[16:19], a[64:67], v[120:123]
  ds_read_b64_tr_b16 a[52:53], v134 offset:1024
  ds_read_b128 a[28:31], v144 offset:14336
  v_mfma_f32_16x16x32_bf16 v[80:83], a[12:15], a[68:71], v[80:83]
  buffer_load_dwordx4 v142, s[36:39], s61 offen offset:0 sc1 lds
  s_lshl1_add_u32 s48, s48, 8192
  v_mfma_f32_16x16x32_bf16 v[76:79], a[8:11], a[68:71], v[76:79]
  ds_read_b64_tr_b16 a[54:55], v134 offset:7168
  ds_read_b128 a[32:35], v144 offset:15360
  v_mfma_f32_16x16x32_bf16 v[72:75], a[4:7], a[68:71], v[72:75]
  v_add_u32 v248, s48, v13
  v_lshrrev_b32 v12, 2, v10
  v_mfma_f32_16x16x32_bf16 v[68:71], a[0:3], a[68:71], v[68:71]
  ds_read_b128 a[36:39], v147 offset:20480
  s_waitcnt lgkmcnt(9)
  v_mfma_f32_16x16x32_bf16 v[84:87], a[40:43], a[0:3], v[84:87]
  ds_read_b64_tr_b16 a[56:57], v133 offset:2048
  buffer_load_dwordx4 v142, s[36:39], s61 offen offset:1024 sc1 lds
  v_mfma_f32_16x16x32_bf16 v[88:91], a[40:43], a[4:7], v[88:91]
  s_add_u32 m0, s64, 128000
  ds_read_b64_tr_b16 a[58:59], v133 offset:8192
  v_mfma_f32_16x16x32_bf16 v[92:95], a[40:43], a[8:11], v[92:95]
  v_lshl_add_u32 v231, v12, 7, v151
  v_xor_b32 v232, 32, v231
  v_mfma_f32_16x16x32_bf16 v[96:99], a[40:43], a[12:15], v[96:99]
  v_xor_b32 v233, 64, v231
  v_xor_b32 v234, 96, v231
  v_mfma_f32_16x16x32_bf16 v[112:115], a[44:47], a[12:15], v[112:115]
  buffer_load_dword v143, s[36:39], s61 offen sc1 lds
  ds_read_b64_tr_b16 a[60:61], v134 offset:2048
  v_mfma_f32_16x16x32_bf16 v[108:111], a[44:47], a[8:11], v[108:111]
  v_xor_b32 v235, 65536, v231
  v_xor_b32 v236, 65568, v231
  v_mfma_f32_16x16x32_bf16 v[104:107], a[44:47], a[4:7], v[104:107]
  s_cmp_eq_u32 s57, 0
  s_cselect_b32 s70, 25, 17
  v_mfma_f32_16x16x32_bf16 v[100:103], a[44:47], a[0:3], v[100:103]
  s_waitcnt vmcnt(25) lgkmcnt(3)
  s_barrier
  v_mfma_f32_16x16x32_bf16 v[20:23], a[48:51], a[20:23], v[20:23]
  s_mul_i32 s60, s70, 196608
  s_add_u32 m0, s62, 129024
  v_mfma_f32_16x16x32_bf16 v[24:27], a[48:51], a[24:27], v[24:27]
  ds_read_b64_tr_b16 a[62:63], v134 offset:8192
  ds_read_b64_tr_b16 a[64:65], v133 offset:0
  v_mfma_f32_16x16x32_bf16 v[28:31], a[48:51], a[28:31], v[28:31]
  buffer_load_dwordx4 v139, s[8:11], s60 offen offset:0 lds
  ds_read_b64_tr_b16 a[66:67], v133 offset:6144
  v_mfma_f32_16x16x32_bf16 v[32:35], a[48:51], a[32:35], v[32:35]
  v_xor_b32 v237, 65600, v231
  v_xor_b32 v238, 65632, v231
  v_mfma_f32_16x16x32_bf16 v[116:119], a[48:51], a[36:39], v[116:119]
  ds_read_b64_tr_b16 a[68:69], v134 offset:0
  s_add_u32 s48, s74, 131072
  v_mfma_f32_16x16x32_bf16 v[48:51], a[52:55], a[32:35], v[48:51]
  buffer_load_dwordx4 v140, s[8:11], s60 offen offset:1024 lds
  v_and_b32 v12, 15, v10
  v_mfma_f32_16x16x32_bf16 v[44:47], a[52:55], a[28:31], v[44:47]
  ds_read_b64_tr_b16 a[70:71], v134 offset:6144
  v_lshrrev_b32 v14, 1, v12
  v_mfma_f32_16x16x32_bf16 v[40:43], a[52:55], a[24:27], v[40:43]
  v_lshrrev_b32 v13, 5, v10
  v_xor_b32 v14, v14, v13
  v_mfma_f32_16x16x32_bf16 v[36:39], a[52:55], a[20:23], v[36:39]
  ds_read_b64_tr_b16 a[40:41], v133 offset:22528
  s_waitcnt lgkmcnt(5)
  v_mfma_f32_16x16x32_bf16 v[52:55], a[20:23], a[56:59], v[52:55]
  buffer_load_dwordx4 v141, s[8:11], s60 offen offset:2048 lds
  ds_read_b128 a[0:3], v144 offset:33792
  v_mfma_f32_16x16x32_bf16 v[56:59], a[24:27], a[56:59], v[56:59]
  ds_read_b64_tr_b16 a[42:43], v133 offset:28672
  v_lshlrev_b32 v14, 4, v14
  v_mfma_f32_16x16x32_bf16 v[60:63], a[28:31], a[56:59], v[60:63]
  s_lshl_b32 s61, s70, 11
  s_add_u32 m0, s63, 141312
  v_mfma_f32_16x16x32_bf16 v[64:67], a[32:35], a[56:59], v[64:67]
  ds_read_b128 a[4:7], v144 offset:34816
  v_lshl_add_u32 v14, v12, 7, v14
  v_mfma_f32_16x16x32_bf16 v[120:123], a[36:39], a[56:59], v[120:123]
  ds_read_b64_tr_b16 a[44:45], v134 offset:22528
  ds_read_b128 a[8:11], v144 offset:35840
  v_mfma_f32_16x16x32_bf16 v[80:83], a[32:35], a[60:63], v[80:83]
  buffer_load_dwordx4 v142, s[36:39], s61 offen offset:0 sc1 lds
  v_bfe_u32 v13, v10, 4, 1
  v_mfma_f32_16x16x32_bf16 v[76:79], a[28:31], a[60:63], v[76:79]
  ds_read_b64_tr_b16 a[46:47], v134 offset:28672
  ds_read_b128 a[12:15], v144 offset:36864
  v_mfma_f32_16x16x32_bf16 v[72:75], a[24:27], a[60:63], v[72:75]
  v_lshl_add_u32 v14, v13, 3, v14
  v_add_u32 v239, s48, v14
  v_mfma_f32_16x16x32_bf16 v[68:71], a[20:23], a[60:63], v[68:71]
  ds_read_b128 a[16:19], v147 offset:41984
  s_waitcnt lgkmcnt(9)
  v_mfma_f32_16x16x32_bf16 v[84:87], a[64:67], a[20:23], v[84:87]
  ds_read_b64_tr_b16 a[48:49], v133 offset:23552
  buffer_load_dwordx4 v142, s[36:39], s61 offen offset:1024 sc1 lds
  v_mfma_f32_16x16x32_bf16 v[88:91], a[64:67], a[24:27], v[88:91]
  s_add_u32 m0, s64, 149504
  ds_read_b64_tr_b16 a[50:51], v133 offset:29696
  v_mfma_f32_16x16x32_bf16 v[92:95], a[64:67], a[28:31], v[92:95]
  v_xor_b32 v240, 32, v239
  v_xor_b32 v241, 64, v239
  v_mfma_f32_16x16x32_bf16 v[96:99], a[64:67], a[32:35], v[96:99]
  v_xor_b32 v242, 96, v239
  s_lshl2_add_u32 s48, s55, s44
  v_mfma_f32_16x16x32_bf16 v[112:115], a[68:71], a[32:35], v[112:115]
  buffer_load_dword v143, s[36:39], s61 offen sc1 lds
  ds_read_b64_tr_b16 a[52:53], v134 offset:23552
  v_mfma_f32_16x16x32_bf16 v[108:111], a[68:71], a[28:31], v[108:111]
  s_lshl_b32 s49, s48, 16
  s_add_u32 s49, s49, 7340032
  v_mfma_f32_16x16x32_bf16 v[104:107], a[68:71], a[24:27], v[104:107]
  s_cmp_eq_u32 s57, 1
  s_cselect_b32 s65, 26, 18
  v_mfma_f32_16x16x32_bf16 v[100:103], a[68:71], a[20:23], v[100:103]
  s_waitcnt vmcnt(24) lgkmcnt(3)
  s_barrier
  v_mfma_f32_16x16x32_bf16 v[20:23], a[40:43], a[0:3], v[20:23]
  s_mul_i32 s60, s65, 196608
  s_add_u32 m0, s62, 0
  v_mfma_f32_16x16x32_bf16 v[24:27], a[40:43], a[4:7], v[24:27]
  ds_read_b64_tr_b16 a[54:55], v134 offset:29696
CT3:
  s_add_u32 s94, s92, CT3-k3_main_kernel+3072
  s_addc_u32 s95, s93, 0
  v_mfma_f32_16x16x32_bf16 v[28:31], a[40:43], a[8:11], v[28:31]
  global_load_dword a252, v0, s[94:95]
  ds_read_b64_tr_b16 a[56:57], v133 offset:21504
  v_mfma_f32_16x16x32_bf16 v[32:35], a[40:43], a[12:15], v[32:35]
  ds_read_b64_tr_b16 a[58:59], v133 offset:27648
  v_add_u32 v243, s49, v0
  v_mfma_f32_16x16x32_bf16 v[116:119], a[40:43], a[16:19], v[116:119]
  ds_read_b64_tr_b16 a[60:61], v134 offset:21504
  s_lshl4_add_u32 s78, s48, s71
  v_mfma_f32_16x16x32_bf16 v[48:51], a[44:47], a[12:15], v[48:51]
  buffer_load_dwordx4 v139, s[8:11], s60 offen offset:0 lds
  s_lshl_b32 s78, s78, 8
  v_mfma_f32_16x16x32_bf16 v[44:47], a[44:47], a[8:11], v[44:47]
  ds_read_b64_tr_b16 a[62:63], v134 offset:27648
  s_add_u32 s78, s78, 262144
  v_mfma_f32_16x16x32_bf16 v[40:43], a[44:47], a[4:7], v[40:43]
  s_lshr_b32 s77, s48, 1
  s_lshl4_add_u32 s77, s77, s71
  v_mfma_f32_16x16x32_bf16 v[36:39], a[44:47], a[0:3], v[36:39]
  buffer_load_dwordx4 v140, s[8:11], s60 offen offset:1024 lds
  s_waitcnt lgkmcnt(4)
  v_mfma_f32_16x16x32_bf16 v[52:55], a[0:3], a[48:51], v[52:55]
  ds_read_b64_tr_b16 a[64:65], v133 offset:44032
  ds_read_b128 a[20:23], v144 offset:55296
  v_mfma_f32_16x16x32_bf16 v[56:59], a[4:7], a[48:51], v[56:59]
  ds_read_b64_tr_b16 a[66:67], v133 offset:50176
  s_and_b32 s49, s48, 1
  v_mfma_f32_16x16x32_bf16 v[60:63], a[8:11], a[48:51], v[60:63]
  buffer_load_dwordx4 v141, s[8:11], s60 offen offset:2048 lds
  s_lshl_b32 s61, s65, 11
  v_mfma_f32_16x16x32_bf16 v[64:67], a[12:15], a[48:51], v[64:67]
  s_add_u32 m0, s63, 12288
  ds_read_b128 a[24:27], v144 offset:56320
  v_mfma_f32_16x16x32_bf16 v[120:123], a[16:19], a[48:51], v[120:123]
  ds_read_b64_tr_b16 a[68:69], v134 offset:44032
  ds_read_b128 a[28:31], v144 offset:57344
  v_mfma_f32_16x16x32_bf16 v[80:83], a[12:15], a[52:55], v[80:83]
  buffer_load_dwordx4 v142, s[36:39], s61 offen offset:0 sc1 lds
  s_lshl2_add_u32 s77, s77, s49
  v_mfma_f32_16x16x32_bf16 v[76:79], a[8:11], a[52:55], v[76:79]
  ds_read_b64_tr_b16 a[70:71], v134 offset:50176
  ds_read_b128 a[32:35], v144 offset:58368
  v_mfma_f32_16x16x32_bf16 v[72:75], a[4:7], a[52:55], v[72:75]
  s_lshl_b32 s77, s77, 11
  s_add_u32 s77, s77, 36700160
  v_mfma_f32_16x16x32_bf16 v[68:71], a[0:3], a[52:55], v[68:71]
  ds_read_b128 a[36:39], v147 offset:63488
  s_waitcnt lgkmcnt(9)
  v_mfma_f32_16x16x32_bf16 v[84:87], a[56:59], a[0:3], v[84:87]
  ds_read_b64_tr_b16 a[40:41], v133 offset:45056
  buffer_load_dwordx4 v142, s[36:39], s61 offen offset:1024 sc1 lds
  v_mfma_f32_16x16x32_bf16 v[88:91], a[56:59], a[4:7], v[88:91]
  s_add_u32 m0, s64, 20480
  ds_read_b64_tr_b16 a[42:43], v133 offset:51200
  v_mfma_f32_16x16x32_bf16 v[92:95], a[56:59], a[8:11], v[92:95]
  s_lshl1_add_u32 s79, s48, s71
  s_lshl_b32 s79, s79, 11
  v_mfma_f32_16x16x32_bf16 v[96:99], a[56:59], a[12:15], v[96:99]
  s_add_u32 s79, s79, 5767168
  s_and_b32 s48, s48, 7
  v_mfma_f32_16x16x32_bf16 v[112:115], a[60:63], a[12:15], v[112:115]
  buffer_load_dword v143, s[36:39], s61 offen sc1 lds
  ds_read_b64_tr_b16 a[44:45], v134 offset:45056
  v_mfma_f32_16x16x32_bf16 v[108:111], a[60:63], a[8:11], v[108:111]
  s_cselect_b32 s79, 1073741824, s79
  s_and_b32 s48, s55, 7
  v_mfma_f32_16x16x32_bf16 v[104:107], a[60:63], a[4:7], v[104:107]
  s_cmp_eq_u32 s57, 1
  s_cselect_b32 s66, 27, 19
  v_mfma_f32_16x16x32_bf16 v[100:103], a[60:63], a[0:3], v[100:103]
  s_waitcnt vmcnt(25) lgkmcnt(3)
  s_barrier
  v_mfma_f32_16x16x32_bf16 v[20:23], a[64:67], a[20:23], v[20:23]
  s_mul_i32 s60, s66, 196608
  s_add_u32 m0, s62, 21504
  v_mfma_f32_16x16x32_bf16 v[24:27], a[64:67], a[24:27], v[24:27]
  ds_read_b64_tr_b16 a[46:47], v134 offset:51200
  ds_read_b64_tr_b16 a[48:49], v133 offset:43008
  v_mfma_f32_16x16x32_bf16 v[28:31], a[64:67], a[28:31], v[28:31]
  buffer_load_dwordx4 v139, s[8:11], s60 offen offset:0 lds
  ds_read_b64_tr_b16 a[50:51], v133 offset:49152
  v_mfma_f32_16x16x32_bf16 v[32:35], a[64:67], a[32:35], v[32:35]
  s_lshl_b32 s48, s48, 5
  s_lshr_b32 s49, s55, 3
  v_mfma_f32_16x16x32_bf16 v[116:119], a[64:67], a[36:39], v[116:119]
  ds_read_b64_tr_b16 a[52:53], v134 offset:43008
  s_lshl2_add_u32 s48, s49, s48
  v_mfma_f32_16x16x32_bf16 v[48:51], a[68:71], a[32:35], v[48:51]
  buffer_load_dwordx4 v140, s[8:11], s60 offen offset:1024 lds
  v_and_b32 v12, 3, v10
  v_mfma_f32_16x16x32_bf16 v[44:47], a[68:71], a[28:31], v[44:47]
  ds_read_b64_tr_b16 a[54:55], v134 offset:49152
  v_bfe_u32 v13, v10, 2, 2
  v_mfma_f32_16x16x32_bf16 v[40:43], a[68:71], a[24:27], v[40:43]
  v_lshl_add_u32 v12, v13, 3, v12
  v_add_lshl_u32 v249, v12, s48, 7
  v_mfma_f32_16x16x32_bf16 v[36:39], a[68:71], a[20:23], v[36:39]
  ds_read_b64_tr_b16 a[56:57], v135 offset:1024
  s_waitcnt lgkmcnt(5)
  v_mfma_f32_16x16x32_bf16 v[52:55], a[20:23], a[40:43], v[52:55]
  buffer_load_dwordx4 v141, s[8:11], s60 offen offset:2048 lds
  ds_read_b128 a[0:3], v145 offset:12288
  v_mfma_f32_16x16x32_bf16 v[56:59], a[24:27], a[40:43], v[56:59]
  ds_read_b64_tr_b16 a[58:59], v135 offset:7168
  s_waitcnt vmcnt(37)
  v_mfma_f32_16x16x32_bf16 v[60:63], a[28:31], a[40:43], v[60:63]
  s_lshl_b32 s61, s66, 11
  s_add_u32 m0, s63, 33792
  v_mfma_f32_16x16x32_bf16 v[64:67], a[32:35], a[40:43], v[64:67]
  ds_read_b128 a[4:7], v145 offset:13312
  v_lshlrev_b32 v188, 16, v208
  v_mfma_f32_16x16x32_bf16 v[120:123], a[36:39], a[40:43], v[120:123]
  ds_read_b64_tr_b16 a[60:61], v136 offset:1024
  ds_read_b128 a[8:11], v145 offset:14336
  v_mfma_f32_16x16x32_bf16 v[80:83], a[32:35], a[44:47], v[80:83]
  buffer_load_dwordx4 v142, s[36:39], s61 offen offset:0 sc1 lds
  v_and_b32 v189, 0xffff0000, v208
  v_mfma_f32_16x16x32_bf16 v[76:79], a[28:31], a[44:47], v[76:79]
  ds_read_b64_tr_b16 a[62:63], v136 offset:7168
  ds_read_b128 a[12:15], v145 offset:15360
  v_mfma_f32_16x16x32_bf16 v[72:75], a[24:27], a[44:47], v[72:75]
  v_lshlrev_b32 v190, 16, v209
  v_and_b32 v191, 0xffff0000, v209
  v_mfma_f32_16x16x32_bf16 v[68:71], a[20:23], a[44:47], v[68:71]
  ds_read_b128 a[16:19], v148 offset:20480
  s_waitcnt lgkmcnt(9)
  v_mfma_f32_16x16x32_bf16 v[84:87], a[48:51], a[20:23], v[84:87]
  ds_read_b64_tr_b16 a[64:65], v135 offset:2048
  buffer_load_dwordx4 v142, s[36:39], s61 offen offset:1024 sc1 lds
  v_mfma_f32_16x16x32_bf16 v[88:91], a[48:51], a[24:27], v[88:91]
  s_add_u32 m0, s64, 41984
  ds_read_b64_tr_b16 a[66:67], v135 offset:8192
  v_mfma_f32_16x16x32_bf16 v[92:95], a[48:51], a[28:31], v[92:95]
  v_lshlrev_b32 v192, 16, v210
  v_and_b32 v193, 0xffff0000, v210
  v_mfma_f32_16x16x32_bf16 v[96:99], a[48:51], a[32:35], v[96:99]
  v_lshlrev_b32 v194, 16, v211
  v_and_b32 v195, 0xffff0000, v211
  v_mfma_f32_16x16x32_bf16 v[112:115], a[52:55], a[32:35], v[112:115]
  buffer_load_dword v143, s[36:39], s61 offen sc1 lds
  ds_read_b64_tr_b16 a[68:69], v136 offset:2048
  v_mfma_f32_16x16x32_bf16 v[108:111], a[52:55], a[28:31], v[108:111]
  v_mul_f32 v200, 0xbfb8aa3b, v188
  v_mul_f32 v201, 0xbfb8aa3b, v189
  v_mfma_f32_16x16x32_bf16 v[104:107], a[52:55], a[24:27], v[104:107]
  s_cmp_eq_u32 s57, 2
  s_cselect_b32 s67, 28, 20
  v_mfma_f32_16x16x32_bf16 v[100:103], a[52:55], a[20:23], v[100:103]
  s_waitcnt vmcnt(25) lgkmcnt(3)
  s_barrier
  v_mfma_f32_16x16x32_bf16 v[20:23], a[56:59], a[0:3], v[20:23]
  s_mul_i32 s60, s67, 196608
  s_add_u32 m0, s62, 43008
  v_mfma_f32_16x16x32_bf16 v[24:27], a[56:59], a[4:7], v[24:27]
  ds_read_b64_tr_b16 a[70:71], v136 offset:8192
  ds_read_b64_tr_b16 a[40:41], v135 offset:0
  v_mfma_f32_16x16x32_bf16 v[28:31], a[56:59], a[8:11], v[28:31]
  buffer_load_dwordx4 v139, s[8:11], s60 offen offset:0 lds
  ds_read_b64_tr_b16 a[42:43], v135 offset:6144
  v_mfma_f32_16x16x32_bf16 v[32:35], a[56:59], a[12:15], v[32:35]
  v_mul_f32 v202, 0xbfb8aa3b, v190
  v_mul_f32 v203, 0xbfb8aa3b, v191
  v_mfma_f32_16x16x32_bf16 v[116:119], a[56:59], a[16:19], v[116:119]
  ds_read_b64_tr_b16 a[44:45], v136 offset:0
  v_mul_f32 v204, 0xbfb8aa3b, v192
  v_mfma_f32_16x16x32_bf16 v[48:51], a[60:63], a[12:15], v[48:51]
  buffer_load_dwordx4 v140, s[8:11], s60 offen offset:1024 lds
  v_mul_f32 v205, 0xbfb8aa3b, v193
  v_mfma_f32_16x16x32_bf16 v[44:47], a[60:63], a[8:11], v[44:47]
  ds_read_b64_tr_b16 a[46:47], v136 offset:6144
  v_mul_f32 v206, 0xbfb8aa3b, v194
  v_mfma_f32_16x16x32_bf16 v[40:43], a[60:63], a[4:7], v[40:43]
  v_mul_f32 v207, 0xbfb8aa3b, v195
  v_exp_f32 v200, v200
  v_mfma_f32_16x16x32_bf16 v[36:39], a[60:63], a[0:3], v[36:39]
  ds_read_b64_tr_b16 a[48:49], v135 offset:22528
  s_waitcnt lgkmcnt(5)
  v_mfma_f32_16x16x32_bf16 v[52:55], a[0:3], a[64:67], v[52:55]
  buffer_load_dwordx4 v141, s[8:11], s60 offen offset:2048 lds
  ds_read_b128 a[20:23], v145 offset:33792
  v_mfma_f32_16x16x32_bf16 v[56:59], a[4:7], a[64:67], v[56:59]
  ds_read_b64_tr_b16 a[50:51], v135 offset:28672
  v_exp_f32 v201, v201
  v_mfma_f32_16x16x32_bf16 v[60:63], a[8:11], a[64:67], v[60:63]
  s_lshl_b32 s61, s67, 11
  s_add_u32 m0, s63, 55296
  v_mfma_f32_16x16x32_bf16 v[64:67], a[12:15], a[64:67], v[64:67]
  ds_read_b128 a[24:27], v145 offset:34816
  v_exp_f32 v202, v202
  v_mfma_f32_16x16x32_bf16 v[120:123], a[16:19], a[64:67], v[120:123]
  ds_read_b64_tr_b16 a[52:53], v136 offset:22528
  ds_read_b128 a[28:31], v145 offset:35840
  v_mfma_f32_16x16x32_bf16 v[80:83], a[12:15], a[68:71], v[80:83]
  buffer_load_dwordx4 v142, s[36:39], s61 offen offset:0 sc1 lds
  v_exp_f32 v203, v203
  v_mfma_f32_16x16x32_bf16 v[76:79], a[8:11], a[68:71], v[76:79]
  ds_read_b64_tr_b16 a[54:55], v136 offset:28672
  ds_read_b128 a[32:35], v145 offset:36864
  v_mfma_f32_16x16x32_bf16 v[72:75], a[4:7], a[68:71], v[72:75]
  v_exp_f32 v204, v204
  v_mfma_f32_16x16x32_bf16 v[68:71], a[0:3], a[68:71], v[68:71]
  ds_read_b128 a[36:39], v148 offset:41984
  s_waitcnt lgkmcnt(9)
  v_mfma_f32_16x16x32_bf16 v[84:87], a[40:43], a[0:3], v[84:87]
  ds_read_b64_tr_b16 a[56:57], v135 offset:23552
  buffer_load_dwordx4 v142, s[36:39], s61 offen offset:1024 sc1 lds
  v_mfma_f32_16x16x32_bf16 v[88:91], a[40:43], a[4:7], v[88:91]
  s_add_u32 m0, s64, 63488
  ds_read_b64_tr_b16 a[58:59], v135 offset:29696
  v_mfma_f32_16x16x32_bf16 v[92:95], a[40:43], a[8:11], v[92:95]
  v_exp_f32 v205, v205
  v_mfma_f32_16x16x32_bf16 v[96:99], a[40:43], a[12:15], v[96:99]
  v_exp_f32 v206, v206
  v_mfma_f32_16x16x32_bf16 v[112:115], a[44:47], a[12:15], v[112:115]
  buffer_load_dword v143, s[36:39], s61 offen sc1 lds
  ds_read_b64_tr_b16 a[60:61], v136 offset:23552
  v_mfma_f32_16x16x32_bf16 v[108:111], a[44:47], a[8:11], v[108:111]
  v_exp_f32 v207, v207
  v_mfma_f32_16x16x32_bf16 v[104:107], a[44:47], a[4:7], v[104:107]
  s_cmp_eq_u32 s57, 2
  s_cselect_b32 s68, 29, 21
  v_mfma_f32_16x16x32_bf16 v[100:103], a[44:47], a[0:3], v[100:103]
  s_waitcnt vmcnt(25) lgkmcnt(3)
  s_barrier
  v_mfma_f32_16x16x32_bf16 v[20:23], a[48:51], a[20:23], v[20:23]
  s_mul_i32 s60, s68, 196608
  s_add_u32 m0, s62, 64512
  v_mfma_f32_16x16x32_bf16 v[24:27], a[48:51], a[24:27], v[24:27]
  ds_read_b64_tr_b16 a[62:63], v136 offset:29696
  ds_read_b64_tr_b16 a[64:65], v135 offset:21504
  v_mfma_f32_16x16x32_bf16 v[28:31], a[48:51], a[28:31], v[28:31]
  buffer_load_dwordx4 v139, s[8:11], s60 offen offset:0 lds
  ds_read_b64_tr_b16 a[66:67], v135 offset:27648
  v_mfma_f32_16x16x32_bf16 v[32:35], a[48:51], a[32:35], v[32:35]
  v_add_f32 v200, 1.0, v200
  v_add_f32 v201, 1.0, v201
  v_mfma_f32_16x16x32_bf16 v[116:119], a[48:51], a[36:39], v[116:119]
  ds_read_b64_tr_b16 a[68:69], v136 offset:21504
  v_add_f32 v202, 1.0, v202
  v_mfma_f32_16x16x32_bf16 v[48:51], a[52:55], a[32:35], v[48:51]
  buffer_load_dwordx4 v140, s[8:11], s60 offen offset:1024 lds
  v_add_f32 v203, 1.0, v203
  v_mfma_f32_16x16x32_bf16 v[44:47], a[52:55], a[28:31], v[44:47]
  ds_read_b64_tr_b16 a[70:71], v136 offset:27648
  v_add_f32 v204, 1.0, v204
  v_mfma_f32_16x16x32_bf16 v[40:43], a[52:55], a[24:27], v[40:43]
  v_add_f32 v205, 1.0, v205
  v_add_f32 v206, 1.0, v206
  v_mfma_f32_16x16x32_bf16 v[36:39], a[52:55], a[20:23], v[36:39]
  ds_read_b64_tr_b16 a[40:41], v135 offset:44032
  s_waitcnt lgkmcnt(5)
  v_mfma_f32_16x16x32_bf16 v[52:55], a[20:23], a[56:59], v[52:55]
  buffer_load_dwordx4 v141, s[8:11], s60 offen offset:2048 lds
  ds_read_b128 a[0:3], v145 offset:55296
  v_mfma_f32_16x16x32_bf16 v[56:59], a[24:27], a[56:59], v[56:59]
  ds_read_b64_tr_b16 a[42:43], v135 offset:50176
  v_add_f32 v207, 1.0, v207
  v_mfma_f32_16x16x32_bf16 v[60:63], a[28:31], a[56:59], v[60:63]
  s_lshl_b32 s61, s68, 11
  s_add_u32 m0, s63, 76800
  v_mfma_f32_16x16x32_bf16 v[64:67], a[32:35], a[56:59], v[64:67]
  ds_read_b128 a[4:7], v145 offset:56320
  v_rcp_f32 v200, v200
  v_mfma_f32_16x16x32_bf16 v[120:123], a[36:39], a[56:59], v[120:123]
  ds_read_b64_tr_b16 a[44:45], v136 offset:44032
  ds_read_b128 a[8:11], v145 offset:57344
  v_mfma_f32_16x16x32_bf16 v[80:83], a[32:35], a[60:63], v[80:83]
  buffer_load_dwordx4 v142, s[36:39], s61 offen offset:0 sc1 lds
  v_rcp_f32 v201, v201
  v_mfma_f32_16x16x32_bf16 v[76:79], a[28:31], a[60:63], v[76:79]
  ds_read_b64_tr_b16 a[46:47], v136 offset:50176
  ds_read_b128 a[12:15], v145 offset:58368
  v_mfma_f32_16x16x32_bf16 v[72:75], a[24:27], a[60:63], v[72:75]
  v_rcp_f32 v202, v202
  v_mfma_f32_16x16x32_bf16 v[68:71], a[20:23], a[60:63], v[68:71]
  ds_read_b128 a[16:19], v148 offset:63488
  s_waitcnt lgkmcnt(9)
  v_mfma_f32_16x16x32_bf16 v[84:87], a[64:67], a[20:23], v[84:87]
  ds_read_b64_tr_b16 a[48:49], v135 offset:45056
  buffer_load_dwordx4 v142, s[36:39], s61 offen offset:1024 sc1 lds
  v_mfma_f32_16x16x32_bf16 v[88:91], a[64:67], a[24:27], v[88:91]
  s_add_u32 m0, s64, 84992
  ds_read_b64_tr_b16 a[50:51], v135 offset:51200
  v_mfma_f32_16x16x32_bf16 v[92:95], a[64:67], a[28:31], v[92:95]
  v_rcp_f32 v203, v203
  v_mfma_f32_16x16x32_bf16 v[96:99], a[64:67], a[32:35], v[96:99]
  v_rcp_f32 v204, v204
  v_mfma_f32_16x16x32_bf16 v[112:115], a[68:71], a[32:35], v[112:115]
  buffer_load_dword v143, s[36:39], s61 offen sc1 lds
  ds_read_b64_tr_b16 a[52:53], v136 offset:45056
  v_mfma_f32_16x16x32_bf16 v[108:111], a[68:71], a[28:31], v[108:111]
  v_rcp_f32 v205, v205
  v_mfma_f32_16x16x32_bf16 v[104:107], a[68:71], a[24:27], v[104:107]
  s_cmp_eq_u32 s57, 3
  s_cselect_b32 s69, 30, 22
  v_mfma_f32_16x16x32_bf16 v[100:103], a[68:71], a[20:23], v[100:103]
  s_waitcnt vmcnt(25) lgkmcnt(3)
  s_barrier
  v_mfma_f32_16x16x32_bf16 v[20:23], a[40:43], a[0:3], v[20:23]
  s_mul_i32 s60, s69, 196608
  s_add_u32 m0, s62, 86016
  v_mfma_f32_16x16x32_bf16 v[24:27], a[40:43], a[4:7], v[24:27]
  ds_read_b64_tr_b16 a[54:55], v136 offset:51200
  ds_read_b64_tr_b16 a[56:57], v135 offset:43008
  v_mfma_f32_16x16x32_bf16 v[28:31], a[40:43], a[8:11], v[28:31]
  buffer_load_dwordx4 v139, s[8:11], s60 offen offset:0 lds
  ds_read_b64_tr_b16 a[58:59], v135 offset:49152
  v_mfma_f32_16x16x32_bf16 v[32:35], a[40:43], a[12:15], v[32:35]
  v_rcp_f32 v206, v206
  v_mfma_f32_16x16x32_bf16 v[116:119], a[40:43], a[16:19], v[116:119]
  ds_read_b64_tr_b16 a[60:61], v136 offset:43008
  v_rcp_f32 v207, v207
  v_mfma_f32_16x16x32_bf16 v[48:51], a[44:47], a[12:15], v[48:51]
  buffer_load_dwordx4 v140, s[8:11], s60 offen offset:1024 lds
  v_mul_f32 v188, v188, v200
  v_mfma_f32_16x16x32_bf16 v[44:47], a[44:47], a[8:11], v[44:47]
  ds_read_b64_tr_b16 a[62:63], v136 offset:49152
  v_mul_f32 v189, v189, v201
  v_mfma_f32_16x16x32_bf16 v[40:43], a[44:47], a[4:7], v[40:43]
  v_mul_f32 v190, v190, v202
  v_mul_f32 v191, v191, v203
  v_mfma_f32_16x16x32_bf16 v[36:39], a[44:47], a[0:3], v[36:39]
  ds_read_b64_tr_b16 a[64:65], v137 offset:1024
  s_waitcnt lgkmcnt(5)
  v_mfma_f32_16x16x32_bf16 v[52:55], a[0:3], a[48:51], v[52:55]
  buffer_load_dwordx4 v141, s[8:11], s60 offen offset:2048 lds
  ds_read_b128 a[20:23], v146 offset:12288
  v_mfma_f32_16x16x32_bf16 v[56:59], a[4:7], a[48:51], v[56:59]
  ds_read_b64_tr_b16 a[66:67], v137 offset:7168
  v_mul_f32 v192, v192, v204
  v_mfma_f32_16x16x32_bf16 v[60:63], a[8:11], a[48:51], v[60:63]
  s_lshl_b32 s61, s69, 11
  s_add_u32 m0, s63, 98304
  v_mfma_f32_16x16x32_bf16 v[64:67], a[12:15], a[48:51], v[64:67]
  ds_read_b128 a[24:27], v146 offset:13312
  v_mul_f32 v193, v193, v205
  v_mfma_f32_16x16x32_bf16 v[120:123], a[16:19], a[48:51], v[120:123]
  ds_read_b64_tr_b16 a[68:69], v138 offset:1024
  ds_read_b128 a[28:31], v146 offset:14336
  v_mfma_f32_16x16x32_bf16 v[80:83], a[12:15], a[52:55], v[80:83]
  buffer_load_dwordx4 v142, s[36:39], s61 offen offset:0 sc1 lds
  v_mul_f32 v194, v194, v206
  v_mfma_f32_16x16x32_bf16 v[76:79], a[8:11], a[52:55], v[76:79]
  ds_read_b64_tr_b16 a[70:71], v138 offset:7168
  ds_read_b128 a[32:35], v146 offset:15360
  v_mfma_f32_16x16x32_bf16 v[72:75], a[4:7], a[52:55], v[72:75]
  v_mul_f32 v195, v195, v207
  v_cvt_pk_bf16_f32 v212, v188, v189
  v_mfma_f32_16x16x32_bf16 v[68:71], a[0:3], a[52:55], v[68:71]
  ds_read_b128 a[36:39], v149 offset:20480
  s_waitcnt lgkmcnt(9)
  v_mfma_f32_16x16x32_bf16 v[84:87], a[56:59], a[0:3], v[84:87]
  ds_read_b64_tr_b16 a[40:41], v137 offset:2048
  buffer_load_dwordx4 v142, s[36:39], s61 offen offset:1024 sc1 lds
  v_mfma_f32_16x16x32_bf16 v[88:91], a[56:59], a[4:7], v[88:91]
  s_add_u32 m0, s64, 106496
  ds_read_b64_tr_b16 a[42:43], v137 offset:8192
  v_mfma_f32_16x16x32_bf16 v[92:95], a[56:59], a[8:11], v[92:95]
  v_lshlrev_b32 v188, 16, v212
  v_and_b32 v189, 0xffff0000, v212
  v_mfma_f32_16x16x32_bf16 v[96:99], a[56:59], a[12:15], v[96:99]
  v_cvt_pk_bf16_f32 v212, v190, v191
  v_lshlrev_b32 v190, 16, v212
  v_mfma_f32_16x16x32_bf16 v[112:115], a[60:63], a[12:15], v[112:115]
  buffer_load_dword v143, s[36:39], s61 offen sc1 lds
  ds_read_b64_tr_b16 a[44:45], v138 offset:2048
  v_mfma_f32_16x16x32_bf16 v[108:111], a[60:63], a[8:11], v[108:111]
  v_and_b32 v191, 0xffff0000, v212
  v_cvt_pk_bf16_f32 v212, v192, v193
  v_mfma_f32_16x16x32_bf16 v[104:107], a[60:63], a[4:7], v[104:107]
  s_cmp_eq_u32 s57, 3
  s_cselect_b32 s70, 31, 23
  v_mfma_f32_16x16x32_bf16 v[100:103], a[60:63], a[0:3], v[100:103]
  s_waitcnt vmcnt(24) lgkmcnt(3)
  s_barrier
  v_mfma_f32_16x16x32_bf16 v[20:23], a[64:67], a[20:23], v[20:23]
  s_mul_i32 s60, s70, 196608
  s_add_u32 m0, s62, 107520
  v_mfma_f32_16x16x32_bf16 v[24:27], a[64:67], a[24:27], v[24:27]
  ds_read_b64_tr_b16 a[46:47], v138 offset:8192
  ds_read_b64_tr_b16 a[48:49], v137 offset:0
  v_mfma_f32_16x16x32_bf16 v[28:31], a[64:67], a[28:31], v[28:31]
  buffer_load_dwordx4 v139, s[8:11], s60 offen offset:0 lds
  ds_read_b64_tr_b16 a[50:51], v137 offset:6144
  v_mfma_f32_16x16x32_bf16 v[32:35], a[64:67], a[32:35], v[32:35]
  v_lshlrev_b32 v192, 16, v212
  v_and_b32 v193, 0xffff0000, v212
  v_mfma_f32_16x16x32_bf16 v[116:119], a[64:67], a[36:39], v[116:119]
  ds_read_b64_tr_b16 a[52:53], v138 offset:0
  v_cvt_pk_bf16_f32 v212, v194, v195
  v_mfma_f32_16x16x32_bf16 v[48:51], a[68:71], a[32:35], v[48:51]
  buffer_load_dwordx4 v140, s[8:11], s60 offen offset:1024 lds
  v_lshlrev_b32 v194, 16, v212
  v_mfma_f32_16x16x32_bf16 v[44:47], a[68:71], a[28:31], v[44:47]
  ds_read_b64_tr_b16 a[54:55], v138 offset:6144
  v_and_b32 v195, 0xffff0000, v212
  v_mfma_f32_16x16x32_bf16 v[40:43], a[68:71], a[24:27], v[40:43]
  s_lshl_b32 s48, s58, 3
  s_add_u32 s48, s48, 150528
  v_mfma_f32_16x16x32_bf16 v[36:39], a[68:71], a[20:23], v[36:39]
  ds_read_b64_tr_b16 a[56:57], v133 offset:1024
  s_waitcnt lgkmcnt(5)
  v_mfma_f32_16x16x32_bf16 v[52:55], a[20:23], a[40:43], v[52:55]
  buffer_load_dwordx4 v141, s[8:11], s60 offen offset:2048 lds
  ds_read_b128 a[0:3], v144 offset:12288
  v_mfma_f32_16x16x32_bf16 v[56:59], a[24:27], a[40:43], v[56:59]
  ds_read_b64_tr_b16 a[58:59], v133 offset:7168
  v_add_u32 v12, s48, v0
  v_mfma_f32_16x16x32_bf16 v[60:63], a[28:31], a[40:43], v[60:63]
  s_lshl_b32 s61, s70, 11
  s_add_u32 m0, s63, 119808
  v_mfma_f32_16x16x32_bf16 v[64:67], a[32:35], a[40:43], v[64:67]
  ds_read_b128 a[4:7], v144 offset:13312
  v_add_u32 v222, s63, v12
  v_mfma_f32_16x16x32_bf16 v[120:123], a[36:39], a[40:43], v[120:123]
  ds_read_b64_tr_b16 a[60:61], v134 offset:1024
  ds_read_b128 a[8:11], v144 offset:14336
  v_mfma_f32_16x16x32_bf16 v[80:83], a[32:35], a[44:47], v[80:83]
  buffer_load_dwordx4 v142, s[36:39], s61 offen offset:0 sc1 lds
  v_xor_b32 v223, 8, v222
  v_mfma_f32_16x16x32_bf16 v[76:79], a[28:31], a[44:47], v[76:79]
  ds_read_b64_tr_b16 a[62:63], v134 offset:7168
  ds_read_b128 a[12:15], v144 offset:15360
  v_mfma_f32_16x16x32_bf16 v[72:75], a[24:27], a[44:47], v[72:75]
  s_lshl_b32 s48, s59, 11
  s_add_u32 s48, s48, 8192
  v_mfma_f32_16x16x32_bf16 v[68:71], a[20:23], a[44:47], v[68:71]
  ds_read_b128 a[16:19], v147 offset:20480
  s_waitcnt lgkmcnt(9)
  v_mfma_f32_16x16x32_bf16 v[84:87], a[48:51], a[20:23], v[84:87]
  ds_read_b64_tr_b16 a[64:65], v133 offset:2048
  buffer_load_dwordx4 v142, s[36:39], s61 offen offset:1024 sc1 lds
  v_mfma_f32_16x16x32_bf16 v[88:91], a[48:51], a[24:27], v[88:91]
  s_add_u32 m0, s64, 128000
  ds_read_b64_tr_b16 a[66:67], v133 offset:8192
  v_mfma_f32_16x16x32_bf16 v[92:95], a[48:51], a[28:31], v[92:95]
  v_add_u32 v224, s48, v12
  s_lshl_b32 s48, s58, 13
  v_mfma_f32_16x16x32_bf16 v[96:99], a[48:51], a[32:35], v[96:99]
  v_subrev_u32 v225, s48, v224
  v_xor_b32 v226, 8, v225
  v_mfma_f32_16x16x32_bf16 v[112:115], a[52:55], a[32:35], v[112:115]
  buffer_load_dword v143, s[36:39], s61 offen sc1 lds
  ds_read_b64_tr_b16 a[68:69], v134 offset:2048
  v_mfma_f32_16x16x32_bf16 v[108:111], a[52:55], a[28:31], v[108:111]
  s_mov_b32 s40, 0xaaaaaaaa
  s_mov_b32 s41, 0xaaaaaaaa
  v_mfma_f32_16x16x32_bf16 v[104:107], a[52:55], a[24:27], v[104:107]
  s_cmp_eq_u32 s57, 0
  s_cselect_b32 s65, 8, 24
  v_mfma_f32_16x16x32_bf16 v[100:103], a[52:55], a[20:23], v[100:103]
  s_waitcnt vmcnt(24) lgkmcnt(3)
  s_barrier
  v_mfma_f32_16x16x32_bf16 v[20:23], a[56:59], a[0:3], v[20:23]
  s_mul_i32 s60, s65, 196608
  s_add_u32 m0, s62, 129024
  v_mfma_f32_16x16x32_bf16 v[24:27], a[56:59], a[4:7], v[24:27]
  ds_read_b64_tr_b16 a[70:71], v134 offset:8192
  ds_read_b64_tr_b16 a[40:41], v133 offset:0
  v_mfma_f32_16x16x32_bf16 v[28:31], a[56:59], a[8:11], v[28:31]
  buffer_load_dwordx4 v139, s[8:11], s60 offen offset:0 lds
  ds_read_b64_tr_b16 a[42:43], v133 offset:6144
  v_mfma_f32_16x16x32_bf16 v[32:35], a[56:59], a[12:15], v[32:35]
  s_mov_b32 s42, 0x000f0000
  s_mov_b32 s43, 0x0fff00ff
  v_mfma_f32_16x16x32_bf16 v[116:119], a[56:59], a[16:19], v[116:119]
  ds_read_b64_tr_b16 a[44:45], v134 offset:0
  s_mov_b32 s80, 0x003f0003
  v_mfma_f32_16x16x32_bf16 v[48:51], a[60:63], a[12:15], v[48:51]
  buffer_load_dwordx4 v140, s[8:11], s60 offen offset:1024 lds
  s_mov_b32 s81, 0x3fff03ff
  v_mfma_f32_16x16x32_bf16 v[44:47], a[60:63], a[8:11], v[44:47]
  ds_read_b64_tr_b16 a[46:47], v134 offset:6144
  v_mov_b32 v12, 0xffff
  v_mfma_f32_16x16x32_bf16 v[40:43], a[60:63], a[4:7], v[40:43]
  v_mov_b32 v13, 0xffff0000
  v_cndmask_b32 v12, v12, v13, s[40:41]
  v_mfma_f32_16x16x32_bf16 v[36:39], a[60:63], a[0:3], v[36:39]
  ds_read_b64_tr_b16 a[48:49], v133 offset:22528
  s_waitcnt lgkmcnt(5)
  v_mfma_f32_16x16x32_bf16 v[52:55], a[0:3], a[64:67], v[52:55]
  buffer_load_dwordx4 v141, s[8:11], s60 offen offset:2048 lds
  ds_read_b128 a[20:23], v144 offset:33792
  v_mfma_f32_16x16x32_bf16 v[56:59], a[4:7], a[64:67], v[56:59]
  ds_read_b64_tr_b16 a[50:51], v133 offset:28672
  v_cndmask_b32 v227, 0, v12, s[42:43]
  v_mfma_f32_16x16x32_bf16 v[60:63], a[8:11], a[64:67], v[60:63]
  s_lshl_b32 s61, s65, 11
  s_add_u32 m0, s63, 141312
  v_mfma_f32_16x16x32_bf16 v[64:67], a[12:15], a[64:67], v[64:67]
  ds_read_b128 a[24:27], v144 offset:34816
  v_cndmask_b32 v228, 0, v12, s[80:81]
  v_mfma_f32_16x16x32_bf16 v[120:123], a[16:19], a[64:67], v[120:123]
  ds_read_b64_tr_b16 a[52:53], v134 offset:22528
  ds_read_b128 a[28:31], v144 offset:35840
  v_mfma_f32_16x16x32_bf16 v[80:83], a[12:15], a[68:71], v[80:83]
  buffer_load_dwordx4 v142, s[36:39], s61 offen offset:0 sc1 lds
  v_xor_b32 v229, v227, v12
  v_mfma_f32_16x16x32_bf16 v[76:79], a[8:11], a[68:71], v[76:79]
  ds_read_b64_tr_b16 a[54:55], v134 offset:28672
  ds_read_b128 a[32:35], v144 offset:36864
  v_mfma_f32_16x16x32_bf16 v[72:75], a[4:7], a[68:71], v[72:75]
  v_xor_b32 v230, v228, v12
  s_lshl1_add_u32 s48, s51, s58
  v_mfma_f32_16x16x32_bf16 v[68:71], a[0:3], a[68:71], v[68:71]
  ds_read_b128 a[36:39], v147 offset:41984
  s_waitcnt lgkmcnt(9)
  v_mfma_f32_16x16x32_bf16 v[84:87], a[40:43], a[0:3], v[84:87]
  ds_read_b64_tr_b16 a[56:57], v133 offset:23552
  buffer_load_dwordx4 v142, s[36:39], s61 offen offset:1024 sc1 lds
  v_mfma_f32_16x16x32_bf16 v[88:91], a[40:43], a[4:7], v[88:91]
  s_add_u32 m0, s64, 149504
  ds_read_b64_tr_b16 a[58:59], v133 offset:29696
  v_mfma_f32_16x16x32_bf16 v[92:95], a[40:43], a[8:11], v[92:95]
  s_lshl_b32 s75, s48, 17
  s_lshl1_add_u32 s48, s56, s59
  v_mfma_f32_16x16x32_bf16 v[96:99], a[40:43], a[12:15], v[96:99]
  s_lshl_b32 s48, s48, 11
  s_add_u32 s75, s75, s48
  v_mfma_f32_16x16x32_bf16 v[112:115], a[44:47], a[12:15], v[112:115]
  buffer_load_dword v143, s[36:39], s61 offen sc1 lds
  ds_read_b64_tr_b16 a[60:61], v134 offset:23552
  v_mfma_f32_16x16x32_bf16 v[108:111], a[44:47], a[8:11], v[108:111]
  s_add_u32 s75, s75, 7340032
  s_add_u32 s76, s75, 65536
  v_mfma_f32_16x16x32_bf16 v[104:107], a[44:47], a[4:7], v[104:107]
  s_cmp_eq_u32 s57, 0
  s_cselect_b32 s66, 9, 25
  v_mfma_f32_16x16x32_bf16 v[100:103], a[44:47], a[0:3], v[100:103]
  s_waitcnt vmcnt(24) lgkmcnt(3)
  s_barrier
  v_mfma_f32_16x16x32_bf16 v[20:23], a[48:51], a[20:23], v[20:23]
  s_mul_i32 s60, s66, 196608
  s_add_u32 m0, s62, 0
  v_mfma_f32_16x16x32_bf16 v[24:27], a[48:51], a[24:27], v[24:27]
  ds_read_b64_tr_b16 a[62:63], v134 offset:29696
  ds_read_b64_tr_b16 a[64:65], v133 offset:21504
  v_mfma_f32_16x16x32_bf16 v[28:31], a[48:51], a[28:31], v[28:31]
  buffer_load_dwordx4 v139, s[8:11], s60 offen offset:0 lds
  ds_read_b64_tr_b16 a[66:67], v133 offset:27648
  v_mfma_f32_16x16x32_bf16 v[32:35], a[48:51], a[32:35], v[32:35]
  s_or_b32 s51, s51, s58
  s_lshl_b32 s45, s2, 7
  v_mfma_f32_16x16x32_bf16 v[116:119], a[48:51], a[36:39], v[116:119]
  ds_read_b64_tr_b16 a[68:69], v134 offset:21504
  s_add_u32 s45, s45, 5275648
  v_mfma_f32_16x16x32_bf16 v[48:51], a[52:55], a[32:35], v[48:51]
  buffer_load_dwordx4 v140, s[8:11], s60 offen offset:1024 lds
  s_cmp_eq_u32 s44, 0
  v_mfma_f32_16x16x32_bf16 v[44:47], a[52:55], a[28:31], v[44:47]
  ds_read_b64_tr_b16 a[70:71], v134 offset:27648
  s_cselect_b32 s45, s45, 1073741824
  v_mfma_f32_16x16x32_bf16 v[40:43], a[52:55], a[24:27], v[40:43]
  s_lshr_b32 s49, s2, 3
  s_and_b32 s59, s49, 3
  v_mfma_f32_16x16x32_bf16 v[36:39], a[52:55], a[20:23], v[36:39]
  ds_read_b64_tr_b16 a[40:41], v133 offset:44032
  s_waitcnt lgkmcnt(5)
  v_mfma_f32_16x16x32_bf16 v[52:55], a[20:23], a[56:59], v[52:55]
  buffer_load_dwordx4 v141, s[8:11], s60 offen offset:2048 lds
  ds_read_b128 a[0:3], v144 offset:55296
  v_mfma_f32_16x16x32_bf16 v[56:59], a[24:27], a[56:59], v[56:59]
  ds_read_b64_tr_b16 a[42:43], v133 offset:50176
  s_lshr_b32 s56, s49, 2
  v_mfma_f32_16x16x32_bf16 v[60:63], a[28:31], a[56:59], v[60:63]
  s_lshl_b32 s61, s66, 11
  s_add_u32 m0, s63, 12288
  v_mfma_f32_16x16x32_bf16 v[64:67], a[32:35], a[56:59], v[64:67]
  ds_read_b128 a[4:7], v144 offset:56320
  s_lshl1_add_u32 s49, s59, s56
  v_mfma_f32_16x16x32_bf16 v[120:123], a[36:39], a[56:59], v[120:123]
  ds_read_b64_tr_b16 a[44:45], v134 offset:44032
  ds_read_b128 a[8:11], v144 offset:57344
  v_mfma_f32_16x16x32_bf16 v[80:83], a[32:35], a[60:63], v[80:83]
  buffer_load_dwordx4 v142, s[36:39], s61 offen offset:0 sc1 lds
  s_and_b32 s49, s49, 7
  v_mfma_f32_16x16x32_bf16 v[76:79], a[28:31], a[60:63], v[76:79]
  ds_read_b64_tr_b16 a[46:47], v134 offset:50176
  ds_read_b128 a[12:15], v144 offset:58368
  v_mfma_f32_16x16x32_bf16 v[72:75], a[24:27], a[60:63], v[72:75]
  s_and_b32 s48, s2, 7
  s_lshl2_add_u32 s59, s48, s59
  v_mfma_f32_16x16x32_bf16 v[68:71], a[20:23], a[60:63], v[68:71]
  ds_read_b128 a[16:19], v147 offset:63488
  s_waitcnt lgkmcnt(9)
  v_mfma_f32_16x16x32_bf16 v[84:87], a[64:67], a[20:23], v[84:87]
  ds_read_b64_tr_b16 a[48:49], v133 offset:45056
  buffer_load_dwordx4 v142, s[36:39], s61 offen offset:1024 sc1 lds
  v_mfma_f32_16x16x32_bf16 v[88:91], a[64:67], a[24:27], v[88:91]
  s_add_u32 m0, s64, 20480
  ds_read_b64_tr_b16 a[50:51], v133 offset:51200
  v_mfma_f32_16x16x32_bf16 v[92:95], a[64:67], a[28:31], v[92:95]
  s_mov_b32 s82, 0x70654321
  s_mov_b32 s83, 0xfedcba89
  v_mfma_f32_16x16x32_bf16 v[96:99], a[64:67], a[32:35], v[96:99]
  s_cmp_eq_u32 s49, 1
  s_cselect_b32 s82, 0x71654320, s82
  v_mfma_f32_16x16x32_bf16 v[112:115], a[68:71], a[32:35], v[112:115]
  buffer_load_dword v143, s[36:39], s61 offen sc1 lds
  ds_read_b64_tr_b16 a[52:53], v134 offset:45056
  v_mfma_f32_16x16x32_bf16 v[108:111], a[68:71], a[28:31], v[108:111]
  s_cselect_b32 s83, 0xfedcba98, s83
  s_cmp_eq_u32 s49, 2
  v_mfma_f32_16x16x32_bf16 v[104:107], a[68:71], a[24:27], v[104:107]
  ds_read_b64_tr_b16 a[54:55], v134 offset:51200
  s_cselect_b32 s82, 0x72654310, s82
  v_mfma_f32_16x16x32_bf16 v[100:103], a[68:71], a[20:23], v[100:103]
  s_waitcnt vmcnt(24) lgkmcnt(4)
  s_barrier
  v_mfma_f32_16x16x32_bf16 v[20:23], a[40:43], a[0:3], v[20:23]
  ds_read_b64_tr_b16 a[56:57], v133 offset:43008
  s_cselect_b32 s83, 0xfedcb9a8, s83
  v_mfma_f32_16x16x32_bf16 v[24:27], a[40:43], a[4:7], v[24:27]
  s_cmp_eq_u32 s57, 1
  s_cselect_b32 s67, 2, 26
  v_mfma_f32_16x16x32_bf16 v[28:31], a[40:43], a[8:11], v[28:31]
  s_mul_i32 s60, s67, 196608
  s_add_u32 m0, s62, 21504
  v_mfma_f32_16x16x32_bf16 v[32:35], a[40:43], a[12:15], v[32:35]
  buffer_load_dwordx4 v139, s[8:11], s60 offen offset:0 lds
  ds_read_b64_tr_b16 a[58:59], v133 offset:49152
  v_mfma_f32_16x16x32_bf16 v[116:119], a[40:43], a[16:19], v[116:119]
  ds_read_b64_tr_b16 a[60:61], v134 offset:43008
  s_cmp_eq_u32 s49, 3
  v_mfma_f32_16x16x32_bf16 v[48:51], a[44:47], a[12:15], v[48:51]
  s_cselect_b32 s82, 0x73654210, s82
  s_cselect_b32 s83, 0xfedca9b8, s83
  v_mfma_f32_16x16x32_bf16 v[44:47], a[44:47], a[8:11], v[44:47]
  buffer_load_dwordx4 v140, s[8:11], s60 offen offset:1024 lds
  ds_read_b64_tr_b16 a[62:63], v134 offset:49152
  v_mfma_f32_16x16x32_bf16 v[40:43], a[44:47], a[4:7], v[40:43]
  s_cmp_eq_u32 s49, 4
  s_cselect_b32 s82, 0x74653210, s82
  v_mfma_f32_16x16x32_bf16 v[36:39], a[44:47], a[0:3], v[36:39]
  ds_read_b64_tr_b16 a[64:65], v135 offset:1024
  s_waitcnt lgkmcnt(5)
  v_mfma_f32_16x16x32_bf16 v[52:55], a[0:3], a[48:51], v[52:55]
  buffer_load_dwordx4 v141, s[8:11], s60 offen offset:2048 lds
  ds_read_b128 a[20:23], v145 offset:12288
  v_mfma_f32_16x16x32_bf16 v[56:59], a[4:7], a[48:51], v[56:59]
  ds_read_b64_tr_b16 a[66:67], v135 offset:7168
  s_cselect_b32 s83, 0xfedba9c8, s83
  v_mfma_f32_16x16x32_bf16 v[60:63], a[8:11], a[48:51], v[60:63]
  s_lshl_b32 s61, s67, 11
  s_add_u32 m0, s63, 33792
  v_mfma_f32_16x16x32_bf16 v[64:67], a[12:15], a[48:51], v[64:67]
  ds_read_b128 a[24:27], v145 offset:13312
  s_cmp_eq_u32 s49, 5
  v_mfma_f32_16x16x32_bf16 v[120:123], a[16:19], a[48:51], v[120:123]
  ds_read_b64_tr_b16 a[68:69], v136 offset:1024
  ds_read_b128 a[28:31], v145 offset:14336
  v_mfma_f32_16x16x32_bf16 v[80:83], a[12:15], a[52:55], v[80:83]
  buffer_load_dwordx4 v142, s[36:39], s61 offen offset:0 sc1 lds
  s_cselect_b32 s82, 0x75643210, s82
  v_mfma_f32_16x16x32_bf16 v[76:79], a[8:11], a[52:55], v[76:79]
  ds_read_b64_tr_b16 a[70:71], v136 offset:7168
  ds_read_b128 a[32:35], v145 offset:15360
  v_mfma_f32_16x16x32_bf16 v[72:75], a[4:7], a[52:55], v[72:75]
  s_cselect_b32 s83, 0xfecba9d8, s83
  s_cmp_eq_u32 s49, 6
  v_mfma_f32_16x16x32_bf16 v[68:71], a[0:3], a[52:55], v[68:71]
  ds_read_b128 a[36:39], v148 offset:20480
  s_waitcnt lgkmcnt(9)
  v_mfma_f32_16x16x32_bf16 v[84:87], a[56:59], a[0:3], v[84:87]
  ds_read_b64_tr_b16 a[40:41], v135 offset:2048
  buffer_load_dwordx4 v142, s[36:39], s61 offen offset:1024 sc1 lds
  v_mfma_f32_16x16x32_bf16 v[88:91], a[56:59], a[4:7], v[88:91]
  ds_read_b64_tr_b16 a[42:43], v135 offset:8192
  s_cselect_b32 s82, 0x76543210, s82
  v_mfma_f32_16x16x32_bf16 v[92:95], a[56:59], a[8:11], v[92:95]
  s_cselect_b32 s83, 0xfdcba9e8, s83
  s_add_u32 m0, s64, 41984
  v_mfma_f32_16x16x32_bf16 v[96:99], a[56:59], a[12:15], v[96:99]
  s_cmp_eq_u32 s49, 7
  s_cselect_b32 s82, 0x67543210, s82
  v_mfma_f32_16x16x32_bf16 v[112:115], a[60:63], a[12:15], v[112:115]
  buffer_load_dword v143, s[36:39], s61 offen sc1 lds
  ds_read_b64_tr_b16 a[44:45], v136 offset:2048
  v_mfma_f32_16x16x32_bf16 v[108:111], a[60:63], a[8:11], v[108:111]
  s_cselect_b32 s83, 0xedcba9f8, s83
  s_mul_i32 s84, s44, 7168
  v_mfma_f32_16x16x32_bf16 v[104:107], a[60:63], a[4:7], v[104:107]
  s_cmp_eq_u32 s57, 1
  s_cselect_b32 s68, 3, 27
  v_mfma_f32_16x16x32_bf16 v[100:103], a[60:63], a[0:3], v[100:103]
  s_waitcnt vmcnt(24) lgkmcnt(3)
  s_barrier
  v_mfma_f32_16x16x32_bf16 v[20:23], a[64:67], a[20:23], v[20:23]
  s_mul_i32 s60, s68, 196608
  s_add_u32 m0, s62, 43008
  v_mfma_f32_16x16x32_bf16 v[24:27], a[64:67], a[24:27], v[24:27]
  ds_read_b64_tr_b16 a[46:47], v136 offset:8192
  ds_read_b64_tr_b16 a[48:49], v135 offset:0
  v_mfma_f32_16x16x32_bf16 v[28:31], a[64:67], a[28:31], v[28:31]
  buffer_load_dwordx4 v139, s[8:11], s60 offen offset:0 lds
  ds_read_b64_tr_b16 a[50:51], v135 offset:6144
  v_mfma_f32_16x16x32_bf16 v[32:35], a[64:67], a[32:35], v[32:35]
  s_lshl2_add_u32 s85, s56, s44
  s_lshl_b32 s85, s85, 17
  v_mfma_f32_16x16x32_bf16 v[116:119], a[64:67], a[36:39], v[116:119]
  ds_read_b64_tr_b16 a[52:53], v136 offset:0
  s_add_u32 s85, s85, 36700160
  v_mfma_f32_16x16x32_bf16 v[48:51], a[68:71], a[32:35], v[48:51]
  buffer_load_dwordx4 v140, s[8:11], s60 offen offset:1024 lds
  s_cmp_ge_u32 s44, 2
  v_mfma_f32_16x16x32_bf16 v[44:47], a[68:71], a[28:31], v[44:47]
  ds_read_b64_tr_b16 a[54:55], v136 offset:6144
  s_cselect_b64 s[16:17], s[20:21], s[16:17]
  v_mfma_f32_16x16x32_bf16 v[40:43], a[68:71], a[24:27], v[40:43]
  v_lshrrev_b32 v12, 2, v10
  v_mul_u32_u24 v12, 224, v12
  v_mfma_f32_16x16x32_bf16 v[36:39], a[68:71], a[20:23], v[36:39]
  ds_read_b64_tr_b16 a[56:57], v135 offset:22528
  s_waitcnt lgkmcnt(5)
  v_mfma_f32_16x16x32_bf16 v[52:55], a[20:23], a[40:43], v[52:55]
  buffer_load_dwordx4 v141, s[8:11], s60 offen offset:2048 lds
  ds_read_b128 a[0:3], v145 offset:33792
  v_mfma_f32_16x16x32_bf16 v[56:59], a[24:27], a[40:43], v[56:59]
  ds_read_b64_tr_b16 a[58:59], v135 offset:28672
  v_and_b32 v13, 3, v10
  v_mfma_f32_16x16x32_bf16 v[60:63], a[28:31], a[40:43], v[60:63]
  s_lshl_b32 s61, s68, 11
  s_add_u32 m0, s63, 55296
  v_mfma_f32_16x16x32_bf16 v[64:67], a[32:35], a[40:43], v[64:67]
  ds_read_b128 a[4:7], v145 offset:34816
  v_lshl_add_u32 v1, v13, 3, v12
  v_mfma_f32_16x16x32_bf16 v[120:123], a[36:39], a[40:43], v[120:123]
  ds_read_b64_tr_b16 a[60:61], v136 offset:22528
  ds_read_b128 a[8:11], v145 offset:35840
  v_mfma_f32_16x16x32_bf16 v[80:83], a[32:35], a[44:47], v[80:83]
  buffer_load_dwordx4 v142, s[36:39], s61 offen offset:0 sc1 lds
  v_add_u32 v2, 57344, v1
  v_mfma_f32_16x16x32_bf16 v[76:79], a[28:31], a[44:47], v[76:79]
  ds_read_b64_tr_b16 a[62:63], v136 offset:28672
  ds_read_b128 a[12:15], v145 offset:36864
  v_mfma_f32_16x16x32_bf16 v[72:75], a[24:27], a[44:47], v[72:75]
  s_mul_i32 s48, s59, 224
  s_and_b32 s49, s44, 1
  v_mfma_f32_16x16x32_bf16 v[68:71], a[20:23], a[44:47], v[68:71]
  ds_read_b128 a[16:19], v148 offset:41984
  s_waitcnt lgkmcnt(9)
  v_mfma_f32_16x16x32_bf16 v[84:87], a[48:51], a[20:23], v[84:87]
  ds_read_b64_tr_b16 a[64:65], v135 offset:23552
  buffer_load_dwordx4 v142, s[36:39], s61 offen offset:1024 sc1 lds
  v_mfma_f32_16x16x32_bf16 v[88:91], a[48:51], a[24:27], v[88:91]
  s_add_u32 m0, s64, 63488
  ds_read_b64_tr_b16 a[66:67], v135 offset:29696
  v_mfma_f32_16x16x32_bf16 v[92:95], a[48:51], a[28:31], v[92:95]
  s_mul_i32 s49, s49, 229376
  s_add_u32 s48, s48, s49
  v_mfma_f32_16x16x32_bf16 v[96:99], a[48:51], a[32:35], v[96:99]
  s_and_b32 s49, s59, 1
  s_lshl_b32 s49, s49, 1
  v_mfma_f32_16x16x32_bf16 v[112:115], a[52:55], a[32:35], v[112:115]
  buffer_load_dword v143, s[36:39], s61 offen sc1 lds
  ds_read_b64_tr_b16 a[68:69], v136 offset:23552
  v_mfma_f32_16x16x32_bf16 v[108:111], a[52:55], a[28:31], v[108:111]
  v_add_u32 v12, 0, v10
  v_mul_u32_u24 v13, 4682, v12
  v_mfma_f32_16x16x32_bf16 v[104:107], a[52:55], a[24:27], v[104:107]
  s_cmp_eq_u32 s57, 2
  s_cselect_b32 s69, 4, 28
  v_mfma_f32_16x16x32_bf16 v[100:103], a[52:55], a[20:23], v[100:103]
  s_waitcnt vmcnt(24) lgkmcnt(3)
  s_barrier
  v_mfma_f32_16x16x32_bf16 v[20:23], a[56:59], a[0:3], v[20:23]
  s_mul_i32 s60, s69, 196608
  s_add_u32 m0, s62, 64512
  v_mfma_f32_16x16x32_bf16 v[24:27], a[56:59], a[4:7], v[24:27]
  ds_read_b64_tr_b16 a[70:71], v136 offset:29696
  ds_read_b64_tr_b16 a[40:41], v135 offset:21504
  v_mfma_f32_16x16x32_bf16 v[28:31], a[56:59], a[8:11], v[28:31]
  buffer_load_dwordx4 v139, s[8:11], s60 offen offset:0 lds
  ds_read_b64_tr_b16 a[42:43], v135 offset:27648
  v_mfma_f32_16x16x32_bf16 v[32:35], a[56:59], a[12:15], v[32:35]
  v_lshrrev_b32 v13, 16, v13
  v_mul_i32_i24 v14, -14, v13
  v_mfma_f32_16x16x32_bf16 v[116:119], a[56:59], a[16:19], v[116:119]
  ds_read_b64_tr_b16 a[44:45], v136 offset:21504
  v_add3_u32 v12, v12, v14, s49
  v_mfma_f32_16x16x32_bf16 v[48:51], a[60:63], a[12:15], v[48:51]
  buffer_load_dwordx4 v140, s[8:11], s60 offen offset:1024 lds
  v_add_u32 v14, -14, v12
  v_mfma_f32_16x16x32_bf16 v[44:47], a[60:63], a[8:11], v[44:47]
  ds_read_b64_tr_b16 a[46:47], v136 offset:27648
  v_min_u32 v12, v12, v14
  v_mfma_f32_16x16x32_bf16 v[40:43], a[60:63], a[4:7], v[40:43]
  v_mul_u32_u24 v13, 7168, v13
  v_lshl_add_u32 v12, v12, 4, v13
  v_mfma_f32_16x16x32_bf16 v[36:39], a[60:63], a[0:3], v[36:39]
  ds_read_b64_tr_b16 a[48:49], v135 offset:44032
  s_waitcnt lgkmcnt(5)
  v_mfma_f32_16x16x32_bf16 v[52:55], a[0:3], a[64:67], v[52:55]
CT4:
  s_add_u32 s94, s92, CT4-k3_main_kernel+3072
  s_addc_u32 s95, s93, 0
  v_mfma_f32_16x16x32_bf16 v[56:59], a[4:7], a[64:67], v[56:59]
  global_load_dword a252, v0, s[94:95]
  ds_read_b128 a[20:23], v145 offset:55296
  v_mfma_f32_16x16x32_bf16 v[60:63], a[8:11], a[64:67], v[60:63]
  ds_read_b64_tr_b16 a[50:51], v135 offset:50176
  ds_read_b128 a[24:27], v145 offset:56320
  v_mfma_f32_16x16x32_bf16 v[64:67], a[12:15], a[64:67], v[64:67]
  v_add_u32 v3, s48, v12
  s_sub_u32 s48, s48, 1024
  v_mfma_f32_16x16x32_bf16 v[120:123], a[16:19], a[64:67], v[120:123]
  buffer_load_dwordx4 v141, s[8:11], s60 offen offset:2048 lds
  s_lshl_b32 s61, s69, 11
  v_mfma_f32_16x16x32_bf16 v[80:83], a[12:15], a[68:71], v[80:83]
  s_add_u32 m0, s63, 76800
  ds_read_b64_tr_b16 a[52:53], v136 offset:44032
  v_mfma_f32_16x16x32_bf16 v[76:79], a[8:11], a[68:71], v[76:79]
  ds_read_b128 a[28:31], v145 offset:57344
  ds_read_b64_tr_b16 a[54:55], v136 offset:50176
  v_mfma_f32_16x16x32_bf16 v[72:75], a[4:7], a[68:71], v[72:75]
  buffer_load_dwordx4 v142, s[36:39], s61 offen offset:0 sc1 lds
  ds_read_b128 a[32:35], v145 offset:58368
  v_mfma_f32_16x16x32_bf16 v[68:71], a[0:3], a[68:71], v[68:71]
  ds_read_b128 a[36:39], v148 offset:63488
  s_waitcnt lgkmcnt(9)
  v_mfma_f32_16x16x32_bf16 v[84:87], a[40:43], a[0:3], v[84:87]
  ds_read_b64_tr_b16 a[56:57], v135 offset:45056
  v_add_u32 v12, 64, v10
  v_mfma_f32_16x16x32_bf16 v[88:91], a[40:43], a[4:7], v[88:91]
  buffer_load_dwordx4 v142, s[36:39], s61 offen offset:1024 sc1 lds
  s_add_u32 m0, s64, 84992
  v_mfma_f32_16x16x32_bf16 v[92:95], a[40:43], a[8:11], v[92:95]
  ds_read_b64_tr_b16 a[58:59], v135 offset:51200
  v_mul_u32_u24 v13, 4682, v12
  v_mfma_f32_16x16x32_bf16 v[96:99], a[40:43], a[12:15], v[96:99]
  v_lshrrev_b32 v13, 16, v13
  v_mul_i32_i24 v14, -14, v13
  v_mfma_f32_16x16x32_bf16 v[112:115], a[44:47], a[12:15], v[112:115]
  buffer_load_dword v143, s[36:39], s61 offen sc1 lds
  ds_read_b64_tr_b16 a[60:61], v136 offset:45056
  v_mfma_f32_16x16x32_bf16 v[108:111], a[44:47], a[8:11], v[108:111]
  v_add3_u32 v12, v12, v14, s49
  v_add_u32 v14, -14, v12
  v_mfma_f32_16x16x32_bf16 v[104:107], a[44:47], a[4:7], v[104:107]
  s_cmp_eq_u32 s57, 2
  s_cselect_b32 s70, 5, 29
  v_mfma_f32_16x16x32_bf16 v[100:103], a[44:47], a[0:3], v[100:103]
  s_waitcnt vmcnt(25) lgkmcnt(3)
  s_barrier
  v_mfma_f32_16x16x32_bf16 v[20:23], a[48:51], a[20:23], v[20:23]
  s_mul_i32 s60, s70, 196608
  s_add_u32 m0, s62, 86016
  v_mfma_f32_16x16x32_bf16 v[24:27], a[48:51], a[24:27], v[24:27]
  ds_read_b64_tr_b16 a[62:63], v136 offset:51200
  ds_read_b64_tr_b16 a[64:65], v135 offset:43008
  v_mfma_f32_16x16x32_bf16 v[28:31], a[48:51], a[28:31], v[28:31]
  buffer_load_dwordx4 v139, s[8:11], s60 offen offset:0 lds
  ds_read_b64_tr_b16 a[66:67], v135 offset:49152
  v_mfma_f32_16x16x32_bf16 v[32:35], a[48:51], a[32:35], v[32:35]
  v_min_u32 v12, v12, v14
  v_mul_u32_u24 v13, 7168, v13
  v_mfma_f32_16x16x32_bf16 v[116:119], a[48:51], a[36:39], v[116:119]
  ds_read_b64_tr_b16 a[68:69], v136 offset:43008
  v_lshl_add_u32 v12, v12, 4, v13
  v_mfma_f32_16x16x32_bf16 v[48:51], a[52:55], a[32:35], v[48:51]
  buffer_load_dwordx4 v140, s[8:11], s60 offen offset:1024 lds
  v_add_u32 v4, s48, v12
  v_mfma_f32_16x16x32_bf16 v[44:47], a[52:55], a[28:31], v[44:47]
  ds_read_b64_tr_b16 a[70:71], v136 offset:49152
  s_sub_u32 s48, s48, 1024
  v_mfma_f32_16x16x32_bf16 v[40:43], a[52:55], a[24:27], v[40:43]
  v_add_u32 v12, 128, v10
  v_mul_u32_u24 v13, 4682, v12
  v_mfma_f32_16x16x32_bf16 v[36:39], a[52:55], a[20:23], v[36:39]
  ds_read_b64_tr_b16 a[40:41], v137 offset:1024
  s_waitcnt lgkmcnt(5)
  v_mfma_f32_16x16x32_bf16 v[52:55], a[20:23], a[56:59], v[52:55]
  buffer_load_dwordx4 v141, s[8:11], s60 offen offset:2048 lds
  ds_read_b128 a[0:3], v146 offset:12288
  v_mfma_f32_16x16x32_bf16 v[56:59], a[24:27], a[56:59], v[56:59]
  ds_read_b64_tr_b16 a[42:43], v137 offset:7168
  v_lshrrev_b32 v13, 16, v13
  v_mfma_f32_16x16x32_bf16 v[60:63], a[28:31], a[56:59], v[60:63]
  s_lshl_b32 s61, s70, 11
  s_add_u32 m0, s63, 98304
  v_mfma_f32_16x16x32_bf16 v[64:67], a[32:35], a[56:59], v[64:67]
  ds_read_b128 a[4:7], v146 offset:13312
  v_mul_i32_i24 v14, -14, v13
  v_mfma_f32_16x16x32_bf16 v[120:123], a[36:39], a[56:59], v[120:123]
  ds_read_b64_tr_b16 a[44:45], v138 offset:1024
  ds_read_b128 a[8:11], v146 offset:14336
  v_mfma_f32_16x16x32_bf16 v[80:83], a[32:35], a[60:63], v[80:83]
  buffer_load_dwordx4 v142, s[36:39], s61 offen offset:0 sc1 lds
  v_add3_u32 v12, v12, v14, s49
  v_mfma_f32_16x16x32_bf16 v[76:79], a[28:31], a[60:63], v[76:79]
  ds_read_b64_tr_b16 a[46:47], v138 offset:7168
  ds_read_b128 a[12:15], v146 offset:15360
  v_mfma_f32_16x16x32_bf16 v[72:75], a[24:27], a[60:63], v[72:75]
  v_add_u32 v14, -14, v12
  v_min_u32 v12, v12, v14
  v_mfma_f32_16x16x32_bf16 v[68:71], a[20:23], a[60:63], v[68:71]
  ds_read_b128 a[16:19], v149 offset:20480
  s_waitcnt lgkmcnt(9)
  v_mfma_f32_16x16x32_bf16 v[84:87], a[64:67], a[20:23], v[84:87]
  ds_read_b64_tr_b16 a[48:49], v137 offset:2048
  buffer_load_dwordx4 v142, s[36:39], s61 offen offset:1024 sc1 lds
  v_mfma_f32_16x16x32_bf16 v[88:91], a[64:67], a[24:27], v[88:91]
  s_add_u32 m0, s64, 106496
  ds_read_b64_tr_b16 a[50:51], v137 offset:8192
  v_mfma_f32_16x16x32_bf16 v[92:95], a[64:67], a[28:31], v[92:95]
  v_mul_u32_u24 v13, 7168, v13
  v_lshl_add_u32 v12, v12, 4, v13
  v_mfma_f32_16x16x32_bf16 v[96:99], a[64:67], a[32:35], v[96:99]
  v_add_u32 v5, s48, v12
  s_sub_u32 s48, s48, 1024
  v_mfma_f32_16x16x32_bf16 v[112:115], a[68:71], a[32:35], v[112:115]
  buffer_load_dword v143, s[36:39], s61 offen sc1 lds
  ds_read_b64_tr_b16 a[52:53], v138 offset:2048
  v_mfma_f32_16x16x32_bf16 v[108:111], a[68:71], a[28:31], v[108:111]
  v_add_u32 v12, 192, v10
  v_mul_u32_u24 v13, 4682, v12
  v_mfma_f32_16x16x32_bf16 v[104:107], a[68:71], a[24:27], v[104:107]
  s_cmp_eq_u32 s57, 3
  s_cselect_b32 s65, 6, 30
  v_mfma_f32_16x16x32_bf16 v[100:103], a[68:71], a[20:23], v[100:103]
  s_waitcnt vmcnt(25) lgkmcnt(3)
  s_barrier
  v_mfma_f32_16x16x32_bf16 v[20:23], a[40:43], a[0:3], v[20:23]
  s_mul_i32 s60, s65, 196608
  s_add_u32 m0, s62, 107520
  v_mfma_f32_16x16x32_bf16 v[24:27], a[40:43], a[4:7], v[24:27]
  ds_read_b64_tr_b16 a[54:55], v138 offset:8192
  ds_read_b64_tr_b16 a[56:57], v137 offset:0
  v_mfma_f32_16x16x32_bf16 v[28:31], a[40:43], a[8:11], v[28:31]
  buffer_load_dwordx4 v139, s[8:11], s60 offen offset:0 lds
  ds_read_b64_tr_b16 a[58:59], v137 offset:6144
  v_mfma_f32_16x16x32_bf16 v[32:35], a[40:43], a[12:15], v[32:35]
  v_lshrrev_b32 v13, 16, v13
  v_mul_i32_i24 v14, -14, v13
  v_mfma_f32_16x16x32_bf16 v[116:119], a[40:43], a[16:19], v[116:119]
  ds_read_b64_tr_b16 a[60:61], v138 offset:0
  v_add3_u32 v12, v12, v14, s49
  v_mfma_f32_16x16x32_bf16 v[48:51], a[44:47], a[12:15], v[48:51]
  buffer_load_dwordx4 v140, s[8:11], s60 offen offset:1024 lds
  v_add_u32 v14, -14, v12
  v_mfma_f32_16x16x32_bf16 v[44:47], a[44:47], a[8:11], v[44:47]
  ds_read_b64_tr_b16 a[62:63], v138 offset:6144
  v_min_u32 v12, v12, v14
  v_mfma_f32_16x16x32_bf16 v[40:43], a[44:47], a[4:7], v[40:43]
  v_mul_u32_u24 v13, 7168, v13
  v_lshl_add_u32 v12, v12, 4, v13
  v_mfma_f32_16x16x32_bf16 v[36:39], a[44:47], a[0:3], v[36:39]
  ds_read_b64_tr_b16 a[64:65], v133 offset:1024
  s_waitcnt lgkmcnt(5)
  v_mfma_f32_16x16x32_bf16 v[52:55], a[0:3], a[48:51], v[52:55]
  buffer_load_dwordx4 v141, s[8:11], s60 offen offset:2048 lds
  ds_read_b128 a[20:23], v144 offset:12288
  v_mfma_f32_16x16x32_bf16 v[56:59], a[4:7], a[48:51], v[56:59]
  ds_read_b64_tr_b16 a[66:67], v133 offset:7168
  v_add_u32 v6, s48, v12
  v_mfma_f32_16x16x32_bf16 v[60:63], a[8:11], a[48:51], v[60:63]
  s_lshl_b32 s61, s65, 11
  s_add_u32 m0, s63, 119808
  v_mfma_f32_16x16x32_bf16 v[64:67], a[12:15], a[48:51], v[64:67]
  ds_read_b128 a[24:27], v144 offset:13312
  s_sub_u32 s48, s48, -3072
  v_mfma_f32_16x16x32_bf16 v[120:123], a[16:19], a[48:51], v[120:123]
  ds_read_b64_tr_b16 a[68:69], v134 offset:1024
  ds_read_b128 a[28:31], v144 offset:14336
  v_mfma_f32_16x16x32_bf16 v[80:83], a[12:15], a[52:55], v[80:83]
  buffer_load_dwordx4 v142, s[36:39], s61 offen offset:0 sc1 lds
  v_add_u32 v12, 256, v10
  v_mfma_f32_16x16x32_bf16 v[76:79], a[8:11], a[52:55], v[76:79]
  ds_read_b64_tr_b16 a[70:71], v134 offset:7168
  ds_read_b128 a[32:35], v144 offset:15360
  v_mfma_f32_16x16x32_bf16 v[72:75], a[4:7], a[52:55], v[72:75]
  v_mul_u32_u24 v13, 4682, v12
  v_lshrrev_b32 v13, 16, v13
  v_mfma_f32_16x16x32_bf16 v[68:71], a[0:3], a[52:55], v[68:71]
  ds_read_b128 a[36:39], v147 offset:20480
  s_waitcnt lgkmcnt(9)
  v_mfma_f32_16x16x32_bf16 v[84:87], a[56:59], a[0:3], v[84:87]
  ds_read_b64_tr_b16 a[40:41], v133 offset:2048
  buffer_load_dwordx4 v142, s[36:39], s61 offen offset:1024 sc1 lds
  v_mfma_f32_16x16x32_bf16 v[88:91], a[56:59], a[4:7], v[88:91]
  s_add_u32 m0, s64, 128000
  ds_read_b64_tr_b16 a[42:43], v133 offset:8192
  v_mfma_f32_16x16x32_bf16 v[92:95], a[56:59], a[8:11], v[92:95]
  v_mul_i32_i24 v14, -14, v13
  v_add3_u32 v12, v12, v14, s49
  v_mfma_f32_16x16x32_bf16 v[96:99], a[56:59], a[12:15], v[96:99]
  v_add_u32 v14, -14, v12
  v_min_u32 v12, v12, v14
  v_mfma_f32_16x16x32_bf16 v[112:115], a[60:63], a[12:15], v[112:115]
  buffer_load_dword v143, s[36:39], s61 offen sc1 lds
  ds_read_b64_tr_b16 a[44:45], v134 offset:2048
  v_mfma_f32_16x16x32_bf16 v[108:111], a[60:63], a[8:11], v[108:111]
  v_mul_u32_u24 v13, 7168, v13
  v_lshl_add_u32 v12, v12, 4, v13
  v_mfma_f32_16x16x32_bf16 v[104:107], a[60:63], a[4:7], v[104:107]
  s_cmp_eq_u32 s57, 3
  s_cselect_b32 s66, 7, 31
  v_mfma_f32_16x16x32_bf16 v[100:103], a[60:63], a[0:3], v[100:103]
  s_waitcnt vmcnt(25) lgkmcnt(3)
  s_barrier
  v_mfma_f32_16x16x32_bf16 v[20:23], a[64:67], a[20:23], v[20:23]
  s_mul_i32 s60, s66, 196608
  s_add_u32 m0, s62, 129024
  v_mfma_f32_16x16x32_bf16 v[24:27], a[64:67], a[24:27], v[24:27]
  ds_read_b64_tr_b16 a[46:47], v134 offset:8192
  ds_read_b64_tr_b16 a[48:49], v133 offset:0
  v_mfma_f32_16x16x32_bf16 v[28:31], a[64:67], a[28:31], v[28:31]
  buffer_load_dwordx4 v139, s[8:11], s60 offen offset:0 lds
  ds_read_b64_tr_b16 a[50:51], v133 offset:6144
  v_mfma_f32_16x16x32_bf16 v[32:35], a[64:67], a[32:35], v[32:35]
  v_add_u32 v7, s48, v12
  s_sub_u32 s48, s48, 1024
  v_mfma_f32_16x16x32_bf16 v[116:119], a[64:67], a[36:39], v[116:119]
  ds_read_b64_tr_b16 a[52:53], v134 offset:0
  v_add_u32 v12, 320, v10
  v_mfma_f32_16x16x32_bf16 v[48:51], a[68:71], a[32:35], v[48:51]
  buffer_load_dwordx4 v140, s[8:11], s60 offen offset:1024 lds
  v_mul_u32_u24 v13, 4682, v12
  v_mfma_f32_16x16x32_bf16 v[44:47], a[68:71], a[28:31], v[44:47]
  ds_read_b64_tr_b16 a[54:55], v134 offset:6144
  v_lshrrev_b32 v13, 16, v13
  v_mfma_f32_16x16x32_bf16 v[40:43], a[68:71], a[24:27], v[40:43]
  v_mul_i32_i24 v14, -14, v13
  v_add3_u32 v12, v12, v14, s49
  v_mfma_f32_16x16x32_bf16 v[36:39], a[68:71], a[20:23], v[36:39]
  ds_read_b64_tr_b16 a[56:57], v133 offset:22528
  s_waitcnt lgkmcnt(5)
  v_mfma_f32_16x16x32_bf16 v[52:55], a[20:23], a[40:43], v[52:55]
  buffer_load_dwordx4 v141, s[8:11], s60 offen offset:2048 lds
  ds_read_b128 a[0:3], v144 offset:33792
  v_mfma_f32_16x16x32_bf16 v[56:59], a[24:27], a[40:43], v[56:59]
  ds_read_b64_tr_b16 a[58:59], v133 offset:28672
  v_add_u32 v14, -14, v12
  v_mfma_f32_16x16x32_bf16 v[60:63], a[28:31], a[40:43], v[60:63]
  s_lshl_b32 s61, s66, 11
  s_add_u32 m0, s63, 141312
  v_mfma_f32_16x16x32_bf16 v[64:67], a[32:35], a[40:43], v[64:67]
  ds_read_b128 a[4:7], v144 offset:34816
  v_min_u32 v12, v12, v14
  v_mfma_f32_16x16x32_bf16 v[120:123], a[36:39], a[40:43], v[120:123]
  ds_read_b64_tr_b16 a[60:61], v134 offset:22528
  ds_read_b128 a[8:11], v144 offset:35840
  v_mfma_f32_16x16x32_bf16 v[80:83], a[32:35], a[44:47], v[80:83]
  buffer_load_dwordx4 v142, s[36:39], s61 offen offset:0 sc1 lds
  v_mul_u32_u24 v13, 7168, v13
  v_mfma_f32_16x16x32_bf16 v[76:79], a[28:31], a[44:47], v[76:79]
  ds_read_b64_tr_b16 a[62:63], v134 offset:28672
  ds_read_b128 a[12:15], v144 offset:36864
  v_mfma_f32_16x16x32_bf16 v[72:75], a[24:27], a[44:47], v[72:75]
  v_lshl_add_u32 v12, v12, 4, v13
  v_add_u32 v8, s48, v12
  v_mfma_f32_16x16x32_bf16 v[68:71], a[20:23], a[44:47], v[68:71]
  ds_read_b128 a[16:19], v147 offset:41984
  s_waitcnt lgkmcnt(9)
  v_mfma_f32_16x16x32_bf16 v[84:87], a[48:51], a[20:23], v[84:87]
  ds_read_b64_tr_b16 a[64:65], v133 offset:23552
  buffer_load_dwordx4 v142, s[36:39], s61 offen offset:1024 sc1 lds
  v_mfma_f32_16x16x32_bf16 v[88:91], a[48:51], a[24:27], v[88:91]
  s_add_u32 m0, s64, 149504
  ds_read_b64_tr_b16 a[66:67], v133 offset:29696
  v_mfma_f32_16x16x32_bf16 v[92:95], a[48:51], a[28:31], v[92:95]
  s_sub_u32 s48, s48, 1024
  v_add_u32 v12, 384, v10
  v_mfma_f32_16x16x32_bf16 v[96:99], a[48:51], a[32:35], v[96:99]
  v_mul_u32_u24 v13, 4682, v12
  v_lshrrev_b32 v13, 16, v13
  v_mfma_f32_16x16x32_bf16 v[112:115], a[52:55], a[32:35], v[112:115]
  buffer_load_dword v143, s[36:39], s61 offen sc1 lds
  ds_read_b64_tr_b16 a[68:69], v134 offset:23552
  v_mfma_f32_16x16x32_bf16 v[108:111], a[52:55], a[28:31], v[108:111]
  s_add_u32 s50, s72, 0
  s_and_b32 s50, s50, 7
  v_mfma_f32_16x16x32_bf16 v[104:107], a[52:55], a[24:27], v[104:107]
  s_lshl_b32 s50, s50, 18
  s_add_u32 m0, s74, 0
  v_mfma_f32_16x16x32_bf16 v[100:103], a[52:55], a[20:23], v[100:103]
  s_waitcnt vmcnt(25) lgkmcnt(3)
  s_barrier
  v_mfma_f32_16x16x32_bf16 v[20:23], a[56:59], a[0:3], v[20:23]
  ds_read_b64_tr_b16 a[70:71], v134 offset:29696
  ds_read_b64_tr_b16 a[40:41], v133 offset:21504
  v_mfma_f32_16x16x32_bf16 v[24:27], a[56:59], a[4:7], v[24:27]
  buffer_load_dwordx4 v216, s[12:15], s50 offen offset:0 lds
  v_mul_i32_i24 v14, -14, v13
  v_mfma_f32_16x16x32_bf16 v[28:31], a[56:59], a[8:11], v[28:31]
  ds_read_b64_tr_b16 a[42:43], v133 offset:27648
  v_add3_u32 v12, v12, v14, s49
  v_mfma_f32_16x16x32_bf16 v[32:35], a[56:59], a[12:15], v[32:35]
  v_add_u32 v14, -14, v12
  v_min_u32 v12, v12, v14
  v_mfma_f32_16x16x32_bf16 v[116:119], a[56:59], a[16:19], v[116:119]
  ds_read_b64_tr_b16 a[44:45], v134 offset:21504
  v_mul_u32_u24 v13, 7168, v13
  v_mfma_f32_16x16x32_bf16 v[48:51], a[60:63], a[12:15], v[48:51]
  buffer_load_dwordx4 v217, s[12:15], s50 offen offset:1024 lds
  v_lshl_add_u32 v12, v12, 4, v13
  v_mfma_f32_16x16x32_bf16 v[44:47], a[60:63], a[8:11], v[44:47]
  ds_read_b64_tr_b16 a[46:47], v134 offset:27648
  v_add_u32 v9, s48, v12
  v_mfma_f32_16x16x32_bf16 v[40:43], a[60:63], a[4:7], v[40:43]
  s_sub_u32 s48, s48, 1024
  s_and_b32 s48, s56, 1
  v_mfma_f32_16x16x32_bf16 v[36:39], a[60:63], a[0:3], v[36:39]
  ds_read_b64_tr_b16 a[48:49], v133 offset:44032
  s_waitcnt lgkmcnt(5)
  v_mfma_f32_16x16x32_bf16 v[52:55], a[0:3], a[64:67], v[52:55]
  buffer_load_dwordx4 v218, s[12:15], s50 offen offset:2048 lds
  ds_read_b128 a[20:23], v144 offset:55296
  v_mfma_f32_16x16x32_bf16 v[56:59], a[4:7], a[64:67], v[56:59]
  ds_read_b64_tr_b16 a[50:51], v133 offset:50176
  s_lshl_b32 s48, s48, 7
  v_mfma_f32_16x16x32_bf16 v[60:63], a[8:11], a[64:67], v[60:63]
  ds_read_b128 a[24:27], v144 offset:56320
  s_and_b32 s49, s56, 6
  v_mfma_f32_16x16x32_bf16 v[64:67], a[12:15], a[64:67], v[64:67]
  s_add_u32 s48, s48, s49
  v_bfe_u32 v12, v10, 1, 4
  v_mfma_f32_16x16x32_bf16 v[120:123], a[16:19], a[64:67], v[120:123]
  buffer_load_dwordx4 v219, s[12:15], s50 offen offset:3072 lds
  ds_read_b64_tr_b16 a[52:53], v134 offset:44032
  v_mfma_f32_16x16x32_bf16 v[80:83], a[12:15], a[68:71], v[80:83]
  ds_read_b128 a[28:31], v144 offset:57344
  v_and_b32 v13, 1, v10
  v_mfma_f32_16x16x32_bf16 v[76:79], a[8:11], a[68:71], v[76:79]
  ds_read_b64_tr_b16 a[54:55], v134 offset:50176
  ds_read_b128 a[32:35], v144 offset:58368
  v_mfma_f32_16x16x32_bf16 v[72:75], a[4:7], a[68:71], v[72:75]
  v_lshl_add_u32 v12, v12, 3, v13
  v_add_lshl_u32 v250, v12, s48, 7
  v_mfma_f32_16x16x32_bf16 v[68:71], a[0:3], a[68:71], v[68:71]
  buffer_load_dwordx4 v[156:159], v196, s[28:31], s52 offen nt
  s_waitcnt lgkmcnt(8)
  v_mfma_f32_16x16x32_bf16 v[84:87], a[40:43], a[0:3], v[84:87]
  s_add_u32 s52, s52, 12288
  ds_read_b128 a[36:39], v147 offset:63488
  v_mfma_f32_16x16x32_bf16 v[88:91], a[40:43], a[4:7], v[88:91]
  ds_read_b64_tr_b16 a[56:57], v133 offset:45056
  ds_read_b64_tr_b16 a[58:59], v133 offset:51200
  v_mfma_f32_16x16x32_bf16 v[92:95], a[40:43], a[8:11], v[92:95]
  v_mfma_f32_16x16x32_bf16 v[96:99], a[40:43], a[12:15], v[96:99]
  buffer_load_dwordx4 v[160:163], v196, s[28:31], s52 offen nt
  s_add_u32 s52, s52, 12288
  v_mfma_f32_16x16x32_bf16 v[112:115], a[44:47], a[12:15], v[112:115]
  ds_read_b64_tr_b16 a[60:61], v134 offset:45056
  v_mfma_f32_16x16x32_bf16 v[108:111], a[44:47], a[8:11], v[108:111]
  v_mfma_f32_16x16x32_bf16 v[104:107], a[44:47], a[4:7], v[104:107]
  ds_read_b64_tr_b16 a[62:63], v134 offset:51200
  v_mfma_f32_16x16x32_bf16 v[100:103], a[44:47], a[0:3], v[100:103]
  s_waitcnt vmcnt(24) lgkmcnt(4)
  s_barrier
  v_mfma_f32_16x16x32_bf16 v[20:23], a[48:51], a[20:23], v[20:23]
  buffer_load_dwordx4 v[164:167], v196, s[28:31], s52 offen nt
  s_add_u32 s52, s52, 12288
  v_mfma_f32_16x16x32_bf16 v[24:27], a[48:51], a[24:27], v[24:27]
  ds_read_b64_tr_b16 a[64:65], v133 offset:43008
  v_mfma_f32_16x16x32_bf16 v[28:31], a[48:51], a[28:31], v[28:31]
  ds_read_b64_tr_b16 a[66:67], v133 offset:49152
  v_mfma_f32_16x16x32_bf16 v[32:35], a[48:51], a[32:35], v[32:35]
  buffer_load_dwordx4 v[168:171], v196, s[28:31], s52 offen nt
  s_add_u32 s52, s52, 12288
  v_mfma_f32_16x16x32_bf16 v[116:119], a[48:51], a[36:39], v[116:119]
  ds_read_b64_tr_b16 a[68:69], v134 offset:43008
  v_mfma_f32_16x16x32_bf16 v[48:51], a[52:55], a[32:35], v[48:51]
  v_mfma_f32_16x16x32_bf16 v[44:47], a[52:55], a[28:31], v[44:47]
  ds_read_b64_tr_b16 a[70:71], v134 offset:49152
  v_mfma_f32_16x16x32_bf16 v[40:43], a[52:55], a[24:27], v[40:43]
  buffer_load_dwordx4 v[172:175], v196, s[28:31], s52 offen nt
  s_add_u32 s52, s52, 12288
  v_mfma_f32_16x16x32_bf16 v[36:39], a[52:55], a[20:23], v[36:39]
  ds_read_b64_tr_b16 a[40:41], v135 offset:1024
  s_waitcnt lgkmcnt(5)
  v_mfma_f32_16x16x32_bf16 v[52:55], a[20:23], a[56:59], v[52:55]
  ds_read_b128 a[0:3], v145 offset:12288
  v_mfma_f32_16x16x32_bf16 v[56:59], a[24:27], a[56:59], v[56:59]
  ds_read_b64_tr_b16 a[42:43], v135 offset:7168
  v_mfma_f32_16x16x32_bf16 v[60:63], a[28:31], a[56:59], v[60:63]
  buffer_load_dwordx4 v[176:179], v196, s[28:31], s52 offen nt
  s_add_u32 s52, s52, 12288
  v_mfma_f32_16x16x32_bf16 v[64:67], a[32:35], a[56:59], v[64:67]
  ds_read_b128 a[4:7], v145 offset:13312
  v_mfma_f32_16x16x32_bf16 v[120:123], a[36:39], a[56:59], v[120:123]
  ds_read_b64_tr_b16 a[44:45], v136 offset:1024
  ds_read_b128 a[8:11], v145 offset:14336
  v_mfma_f32_16x16x32_bf16 v[80:83], a[32:35], a[60:63], v[80:83]
  v_mfma_f32_16x16x32_bf16 v[76:79], a[28:31], a[60:63], v[76:79]
  buffer_load_dwordx4 v[180:183], v196, s[28:31], s52 offen nt
  s_add_u32 s52, s52, 12288
  v_mfma_f32_16x16x32_bf16 v[72:75], a[24:27], a[60:63], v[72:75]
  ds_read_b64_tr_b16 a[46:47], v136 offset:7168
  ds_read_b128 a[12:15], v145 offset:15360
  v_mfma_f32_16x16x32_bf16 v[68:71], a[20:23], a[60:63], v[68:71]
  ds_read_b128 a[16:19], v148 offset:20480
  s_waitcnt lgkmcnt(9)
  v_mfma_f32_16x16x32_bf16 v[84:87], a[64:67], a[20:23], v[84:87]
  ds_read_b64_tr_b16 a[48:49], v135 offset:2048
  v_mfma_f32_16x16x32_bf16 v[88:91], a[64:67], a[24:27], v[88:91]
  buffer_load_dwordx4 v[184:187], v196, s[28:31], s52 offen nt
  ds_read_b64_tr_b16 a[50:51], v135 offset:8192
  v_mfma_f32_16x16x32_bf16 v[92:95], a[64:67], a[28:31], v[92:95]
  v_mfma_f32_16x16x32_bf16 v[96:99], a[64:67], a[32:35], v[96:99]
  v_mfma_f32_16x16x32_bf16 v[112:115], a[68:71], a[32:35], v[112:115]
  ds_read_b64_tr_b16 a[52:53], v136 offset:2048
  v_mfma_f32_16x16x32_bf16 v[108:111], a[68:71], a[28:31], v[108:111]
  v_mfma_f32_16x16x32_bf16 v[104:107], a[68:71], a[24:27], v[104:107]
  ds_read_b64_tr_b16 a[54:55], v136 offset:8192
  v_mfma_f32_16x16x32_bf16 v[100:103], a[68:71], a[20:23], v[100:103]
  s_waitcnt vmcnt(24) lgkmcnt(4)
  s_barrier
  v_mfma_f32_16x16x32_bf16 v[20:23], a[40:43], a[0:3], v[20:23]
  ds_read_b64_tr_b16 a[56:57], v135 offset:0
  v_mfma_f32_16x16x32_bf16 v[24:27], a[40:43], a[4:7], v[24:27]
  v_mfma_f32_16x16x32_bf16 v[28:31], a[40:43], a[8:11], v[28:31]
  ds_read_b64_tr_b16 a[58:59], v135 offset:6144
  v_mfma_f32_16x16x32_bf16 v[32:35], a[40:43], a[12:15], v[32:35]
  v_mfma_f32_16x16x32_bf16 v[116:119], a[40:43], a[16:19], v[116:119]
  ds_read_b64_tr_b16 a[60:61], v136 offset:0
  v_mfma_f32_16x16x32_bf16 v[48:51], a[44:47], a[12:15], v[48:51]
  v_mfma_f32_16x16x32_bf16 v[44:47], a[44:47], a[8:11], v[44:47]
  ds_read_b64_tr_b16 a[62:63], v136 offset:6144
  v_mfma_f32_16x16x32_bf16 v[40:43], a[44:47], a[4:7], v[40:43]
  v_mfma_f32_16x16x32_bf16 v[36:39], a[44:47], a[0:3], v[36:39]
  ds_read_b64_tr_b16 a[64:65], v135 offset:22528
  s_waitcnt lgkmcnt(5)
  v_mfma_f32_16x16x32_bf16 v[52:55], a[0:3], a[48:51], v[52:55]
  ds_read_b128 a[20:23], v145 offset:33792
  v_mfma_f32_16x16x32_bf16 v[56:59], a[4:7], a[48:51], v[56:59]
  ds_read_b64_tr_b16 a[66:67], v135 offset:28672
  v_mfma_f32_16x16x32_bf16 v[60:63], a[8:11], a[48:51], v[60:63]
  ds_read_b128 a[24:27], v145 offset:34816
  v_mfma_f32_16x16x32_bf16 v[64:67], a[12:15], a[48:51], v[64:67]
  v_mfma_f32_16x16x32_bf16 v[120:123], a[16:19], a[48:51], v[120:123]
  ds_read_b64_tr_b16 a[68:69], v136 offset:22528
  ds_read_b128 a[28:31], v145 offset:35840
  v_mfma_f32_16x16x32_bf16 v[80:83], a[12:15], a[52:55], v[80:83]
  v_mfma_f32_16x16x32_bf16 v[76:79], a[8:11], a[52:55], v[76:79]
  ds_read_b64_tr_b16 a[70:71], v136 offset:28672
  ds_read_b128 a[32:35], v145 offset:36864
  v_mfma_f32_16x16x32_bf16 v[72:75], a[4:7], a[52:55], v[72:75]
  v_mfma_f32_16x16x32_bf16 v[68:71], a[0:3], a[52:55], v[68:71]
  ds_read_b128 a[36:39], v148 offset:41984
  s_waitcnt lgkmcnt(9)
  v_mfma_f32_16x16x32_bf16 v[84:87], a[56:59], a[0:3], v[84:87]
  ds_read_b64_tr_b16 a[40:41], v135 offset:23552
  v_mfma_f32_16x16x32_bf16 v[88:91], a[56:59], a[4:7], v[88:91]
  ds_read_b64_tr_b16 a[42:43], v135 offset:29696
  v_mfma_f32_16x16x32_bf16 v[92:95], a[56:59], a[8:11], v[92:95]
  v_mfma_f32_16x16x32_bf16 v[96:99], a[56:59], a[12:15], v[96:99]
  v_mfma_f32_16x16x32_bf16 v[112:115], a[60:63], a[12:15], v[112:115]
  ds_read_b64_tr_b16 a[44:45], v136 offset:23552
  v_mfma_f32_16x16x32_bf16 v[108:111], a[60:63], a[8:11], v[108:111]
  v_mfma_f32_16x16x32_bf16 v[104:107], a[60:63], a[4:7], v[104:107]
  ds_read_b64_tr_b16 a[46:47], v136 offset:29696
  v_mfma_f32_16x16x32_bf16 v[100:103], a[60:63], a[0:3], v[100:103]
  s_waitcnt vmcnt(18) lgkmcnt(4)
  s_barrier
  v_mfma_f32_16x16x32_bf16 v[20:23], a[64:67], a[20:23], v[20:23]
  ds_read_b64_tr_b16 a[48:49], v135 offset:21504
  v_mfma_f32_16x16x32_bf16 v[24:27], a[64:67], a[24:27], v[24:27]
  v_mfma_f32_16x16x32_bf16 v[28:31], a[64:67], a[28:31], v[28:31]
  ds_read_b64_tr_b16 a[50:51], v135 offset:27648
  v_mfma_f32_16x16x32_bf16 v[32:35], a[64:67], a[32:35], v[32:35]
  v_mfma_f32_16x16x32_bf16 v[116:119], a[64:67], a[36:39], v[116:119]
  ds_read_b64_tr_b16 a[52:53], v136 offset:21504
  v_mfma_f32_16x16x32_bf16 v[48:51], a[68:71], a[32:35], v[48:51]
  v_mfma_f32_16x16x32_bf16 v[44:47], a[68:71], a[28:31], v[44:47]
  ds_read_b64_tr_b16 a[54:55], v136 offset:27648
  v_mfma_f32_16x16x32_bf16 v[40:43], a[68:71], a[24:27], v[40:43]
  v_mfma_f32_16x16x32_bf16 v[36:39], a[68:71], a[20:23], v[36:39]
  ds_read_b64_tr_b16 a[56:57], v135 offset:44032
  s_waitcnt lgkmcnt(5)
  v_mfma_f32_16x16x32_bf16 v[52:55], a[20:23], a[40:43], v[52:55]
  ds_read_b128 a[0:3], v145 offset:55296
  v_mfma_f32_16x16x32_bf16 v[56:59], a[24:27], a[40:43], v[56:59]
  ds_read_b64_tr_b16 a[58:59], v135 offset:50176
  v_mfma_f32_16x16x32_bf16 v[60:63], a[28:31], a[40:43], v[60:63]
  ds_read_b128 a[4:7], v145 offset:56320
  v_mfma_f32_16x16x32_bf16 v[64:67], a[32:35], a[40:43], v[64:67]
  v_mfma_f32_16x16x32_bf16 v[120:123], a[36:39], a[40:43], v[120:123]
  ds_read_b64_tr_b16 a[60:61], v136 offset:44032
  ds_read_b128 a[8:11], v145 offset:57344
  v_mfma_f32_16x16x32_bf16 v[80:83], a[32:35], a[44:47], v[80:83]
  v_mfma_f32_16x16x32_bf16 v[76:79], a[28:31], a[44:47], v[76:79]
  ds_read_b64_tr_b16 a[62:63], v136 offset:50176
  ds_read_b128 a[12:15], v145 offset:58368
  v_mfma_f32_16x16x32_bf16 v[72:75], a[24:27], a[44:47], v[72:75]
  v_mfma_f32_16x16x32_bf16 v[68:71], a[20:23], a[44:47], v[68:71]
  ds_read_b128 a[16:19], v148 offset:63488
  s_waitcnt lgkmcnt(9)
  v_mfma_f32_16x16x32_bf16 v[84:87], a[48:51], a[20:23], v[84:87]
  ds_read_b64_tr_b16 a[64:65], v135 offset:45056
  v_mfma_f32_16x16x32_bf16 v[88:91], a[48:51], a[24:27], v[88:91]
  ds_read_b64_tr_b16 a[66:67], v135 offset:51200
  v_mfma_f32_16x16x32_bf16 v[92:95], a[48:51], a[28:31], v[92:95]
  v_mfma_f32_16x16x32_bf16 v[96:99], a[48:51], a[32:35], v[96:99]
  v_mfma_f32_16x16x32_bf16 v[112:115], a[52:55], a[32:35], v[112:115]
  ds_read_b64_tr_b16 a[68:69], v136 offset:45056
  v_mfma_f32_16x16x32_bf16 v[108:111], a[52:55], a[28:31], v[108:111]
  v_mfma_f32_16x16x32_bf16 v[104:107], a[52:55], a[24:27], v[104:107]
  ds_read_b64_tr_b16 a[70:71], v136 offset:51200
  v_mfma_f32_16x16x32_bf16 v[100:103], a[52:55], a[20:23], v[100:103]
  s_waitcnt vmcnt(12) lgkmcnt(4)
  s_barrier
  v_mfma_f32_16x16x32_bf16 v[20:23], a[56:59], a[0:3], v[20:23]
  ds_read_b64_tr_b16 a[40:41], v135 offset:43008
  v_mfma_f32_16x16x32_bf16 v[24:27], a[56:59], a[4:7], v[24:27]
  s_add_u32 s50, s72, 1
  s_and_b32 s50, s50, 7
  v_mfma_f32_16x16x32_bf16 v[28:31], a[56:59], a[8:11], v[28:31]
  s_lshl_b32 s50, s50, 18
  s_add_u32 m0, s74, 16384
  v_mfma_f32_16x16x32_bf16 v[32:35], a[56:59], a[12:15], v[32:35]
  ds_read_b64_tr_b16 a[42:43], v135 offset:49152
  v_mfma_f32_16x16x32_bf16 v[116:119], a[56:59], a[16:19], v[116:119]
  ds_read_b64_tr_b16 a[44:45], v136 offset:43008
  v_mfma_f32_16x16x32_bf16 v[48:51], a[60:63], a[12:15], v[48:51]
  buffer_load_dwordx4 v216, s[12:15], s50 offen offset:0 lds
  v_mfma_f32_16x16x32_bf16 v[44:47], a[60:63], a[8:11], v[44:47]
  ds_read_b64_tr_b16 a[46:47], v136 offset:49152
  v_mfma_f32_16x16x32_bf16 v[40:43], a[60:63], a[4:7], v[40:43]
  v_mfma_f32_16x16x32_bf16 v[36:39], a[60:63], a[0:3], v[36:39]
  ds_read_b64_tr_b16 a[48:49], v137 offset:1024
  s_waitcnt lgkmcnt(5)
  v_mfma_f32_16x16x32_bf16 v[52:55], a[0:3], a[64:67], v[52:55]
  buffer_load_dwordx4 v217, s[12:15], s50 offen offset:1024 lds
  ds_read_b128 a[20:23], v146 offset:12288
  v_mfma_f32_16x16x32_bf16 v[56:59], a[4:7], a[64:67], v[56:59]
  ds_read_b64_tr_b16 a[50:51], v137 offset:7168
  v_mfma_f32_16x16x32_bf16 v[60:63], a[8:11], a[64:67], v[60:63]
  ds_read_b128 a[24:27], v146 offset:13312
  v_mfma_f32_16x16x32_bf16 v[64:67], a[12:15], a[64:67], v[64:67]
  v_mfma_f32_16x16x32_bf16 v[120:123], a[16:19], a[64:67], v[120:123]
  buffer_load_dwordx4 v218, s[12:15], s50 offen offset:2048 lds
  ds_read_b64_tr_b16 a[52:53], v138 offset:1024
  v_mfma_f32_16x16x32_bf16 v[80:83], a[12:15], a[68:71], v[80:83]
  ds_read_b128 a[28:31], v146 offset:14336
  v_mfma_f32_16x16x32_bf16 v[76:79], a[8:11], a[68:71], v[76:79]
  ds_read_b64_tr_b16 a[54:55], v138 offset:7168
  ds_read_b128 a[32:35], v146 offset:15360
  v_mfma_f32_16x16x32_bf16 v[72:75], a[4:7], a[68:71], v[72:75]
  v_mfma_f32_16x16x32_bf16 v[68:71], a[0:3], a[68:71], v[68:71]
  buffer_load_dwordx4 v219, s[12:15], s50 offen offset:3072 lds
  s_waitcnt lgkmcnt(8)
  v_mfma_f32_16x16x32_bf16 v[84:87], a[40:43], a[0:3], v[84:87]
  s_add_u32 s50, s72, 2
  s_and_b32 s50, s50, 7
  v_mfma_f32_16x16x32_bf16 v[88:91], a[40:43], a[4:7], v[88:91]
  s_lshl_b32 s50, s50, 18
  s_add_u32 m0, s74, 32768
  v_mfma_f32_16x16x32_bf16 v[92:95], a[40:43], a[8:11], v[92:95]
  ds_read_b128 a[36:39], v149 offset:20480
  ds_read_b64_tr_b16 a[56:57], v137 offset:2048
  v_mfma_f32_16x16x32_bf16 v[96:99], a[40:43], a[12:15], v[96:99]
  ds_read_b64_tr_b16 a[58:59], v137 offset:8192
  buffer_load_dwordx4 v216, s[12:15], s50 offen offset:0 lds
  v_mfma_f32_16x16x32_bf16 v[112:115], a[44:47], a[12:15], v[112:115]
  ds_read_b64_tr_b16 a[60:61], v138 offset:2048
  v_mfma_f32_16x16x32_bf16 v[108:111], a[44:47], a[8:11], v[108:111]
  v_mfma_f32_16x16x32_bf16 v[104:107], a[44:47], a[4:7], v[104:107]
  ds_read_b64_tr_b16 a[62:63], v138 offset:8192
  v_mfma_f32_16x16x32_bf16 v[100:103], a[44:47], a[0:3], v[100:103]
  buffer_load_dwordx4 v217, s[12:15], s50 offen offset:1024 lds
  s_waitcnt lgkmcnt(4)
  v_mfma_f32_16x16x32_bf16 v[20:23], a[48:51], a[20:23], v[20:23]
  ds_read_b64_tr_b16 a[64:65], v137 offset:0
  v_mfma_f32_16x16x32_bf16 v[24:27], a[48:51], a[24:27], v[24:27]
  v_mfma_f32_16x16x32_bf16 v[28:31], a[48:51], a[28:31], v[28:31]
  ds_read_b64_tr_b16 a[66:67], v137 offset:6144
  v_mfma_f32_16x16x32_bf16 v[32:35], a[48:51], a[32:35], v[32:35]
  buffer_load_dwordx4 v218, s[12:15], s50 offen offset:2048 lds
  v_mfma_f32_16x16x32_bf16 v[116:119], a[48:51], a[36:39], v[116:119]
  ds_read_b64_tr_b16 a[68:69], v138 offset:0
  v_mfma_f32_16x16x32_bf16 v[48:51], a[52:55], a[32:35], v[48:51]
  v_mfma_f32_16x16x32_bf16 v[44:47], a[52:55], a[28:31], v[44:47]
  ds_read_b64_tr_b16 a[70:71], v138 offset:6144
  v_mfma_f32_16x16x32_bf16 v[40:43], a[52:55], a[24:27], v[40:43]
  buffer_load_dwordx4 v219, s[12:15], s50 offen offset:3072 lds
  v_mfma_f32_16x16x32_bf16 v[36:39], a[52:55], a[20:23], v[36:39]
  s_waitcnt lgkmcnt(4)
  v_mfma_f32_16x16x32_bf16 v[52:55], a[20:23], a[56:59], v[52:55]
  v_cvt_pk_bf16_f32 v116, v116, v117
  v_cvt_pk_bf16_f32 v117, v118, v119
  v_mfma_f32_16x16x32_bf16 v[56:59], a[24:27], a[56:59], v[56:59]
  v_cvt_pk_bf16_f32 v32, v32, v33
  v_cvt_pk_bf16_f32 v33, v34, v35
  v_mfma_f32_16x16x32_bf16 v[60:63], a[28:31], a[56:59], v[60:63]
  v_cvt_pk_bf16_f32 v34, v48, v49
  v_cvt_pk_bf16_f32 v35, v50, v51
  v_mfma_f32_16x16x32_bf16 v[64:67], a[32:35], a[56:59], v[64:67]
  ds_write_b64 v224, v[116:117]
  ds_write_b64 v222, v[32:33]
  v_mfma_f32_16x16x32_bf16 v[120:123], a[36:39], a[56:59], v[120:123]
  ds_write_b64 v223, v[34:35]
  v_mfma_f32_16x16x32_bf16 v[80:83], a[32:35], a[60:63], v[80:83]
  v_mfma_f32_16x16x32_bf16 v[76:79], a[28:31], a[60:63], v[76:79]
  v_cvt_pk_bf16_f32 v55, v54, v55
  v_cvt_pk_bf16_f32 v54, v52, v53
  v_mfma_f32_16x16x32_bf16 v[72:75], a[24:27], a[60:63], v[72:75]
  v_cvt_pk_bf16_f32 v56, v56, v57
  v_cvt_pk_bf16_f32 v57, v58, v59
  v_mfma_f32_16x16x32_bf16 v[68:71], a[20:23], a[60:63], v[68:71]
  v_cvt_pk_bf16_f32 v58, v60, v61
  s_waitcnt lgkmcnt(3)
  v_mfma_f32_16x16x32_bf16 v[84:87], a[64:67], a[20:23], v[84:87]
  v_cvt_pk_bf16_f32 v59, v62, v63
  v_cvt_pk_bf16_f32 v60, v64, v65
  v_mfma_f32_16x16x32_bf16 v[88:91], a[64:67], a[24:27], v[88:91]
  v_cvt_pk_bf16_f32 v61, v66, v67
  v_cvt_pk_bf16_f32 v120, v120, v121
  v_mfma_f32_16x16x32_bf16 v[92:95], a[64:67], a[28:31], v[92:95]
  v_cvt_pk_bf16_f32 v121, v122, v123
  ds_write_b64 v222, v[60:61] offset:1024
  v_mfma_f32_16x16x32_bf16 v[96:99], a[64:67], a[32:35], v[96:99]
  ds_write_b64 v224, v[120:121] offset:1024
  v_cvt_pk_bf16_f32 v71, v70, v71
  v_mfma_f32_16x16x32_bf16 v[112:115], a[68:71], a[32:35], v[112:115]
  v_cvt_pk_bf16_f32 v70, v68, v69
  v_cvt_pk_bf16_f32 v72, v72, v73
  v_mfma_f32_16x16x32_bf16 v[108:111], a[68:71], a[28:31], v[108:111]
  v_cvt_pk_bf16_f32 v73, v74, v75
  v_cvt_pk_bf16_f32 v74, v76, v77
  v_mfma_f32_16x16x32_bf16 v[104:107], a[68:71], a[24:27], v[104:107]
  v_cvt_pk_bf16_f32 v75, v78, v79
  v_cvt_pk_bf16_f32 v76, v80, v81
  v_mfma_f32_16x16x32_bf16 v[100:103], a[68:71], a[20:23], v[100:103]
  v_cvt_pk_bf16_f32 v77, v82, v83
  ds_write_b64 v223, v[76:77] offset:1024
  v_cvt_pk_bf16_f32 v28, v28, v29
  v_cvt_pk_bf16_f32 v29, v30, v31
  v_cvt_pk_bf16_f32 v30, v44, v45
  v_cvt_pk_bf16_f32 v31, v46, v47
  v_cvt_pk_bf16_f32 v24, v24, v25
  v_cvt_pk_bf16_f32 v25, v26, v27
  v_cvt_pk_bf16_f32 v26, v40, v41
  v_cvt_pk_bf16_f32 v27, v42, v43
  v_cvt_pk_bf16_f32 v20, v20, v21
  v_cvt_pk_bf16_f32 v21, v22, v23
  v_cvt_pk_bf16_f32 v22, v36, v37
  v_cvt_pk_bf16_f32 v23, v38, v39
  s_waitcnt lgkmcnt(0)
  s_barrier
  ds_read_b64 v[124:125], v225
  ds_read_b64 v[126:127], v226
  ds_read_b64 v[52:53], v225 offset:1024
  ds_read_b64 v[68:69], v226 offset:1024
  s_cmp_eq_u32 s51, 0
  s_cselect_b64 s[66:67], s[42:43], 0
  s_cselect_b64 s[68:69], s[80:81], 0
  v_cvt_pk_bf16_f32 v96, v96, v97
  v_cvt_pk_bf16_f32 v97, v98, v99
  v_cvt_pk_bf16_f32 v98, v112, v113
  v_cvt_pk_bf16_f32 v99, v114, v115
  v_cvt_pk_bf16_f32 v92, v92, v93
  v_cvt_pk_bf16_f32 v93, v94, v95
  v_cvt_pk_bf16_f32 v94, v108, v109
  s_add_u32 s50, s72, 3
  s_and_b32 s50, s50, 7
  s_lshl_b32 s50, s50, 18
  s_add_u32 m0, s74, 49152
  s_nop 0
  buffer_load_dwordx4 v216, s[12:15], s50 offen offset:0 lds
  v_cvt_pk_bf16_f32 v95, v110, v111
  v_cvt_pk_bf16_f32 v88, v88, v89
  v_cvt_pk_bf16_f32 v89, v90, v91
  v_cvt_pk_bf16_f32 v90, v104, v105
  v_cvt_pk_bf16_f32 v91, v106, v107
  v_cvt_pk_bf16_f32 v84, v84, v85
  v_cvt_pk_bf16_f32 v85, v86, v87
  v_cvt_pk_bf16_f32 v86, v100, v101
  v_cvt_pk_bf16_f32 v87, v102, v103
  v_mov_b32 v12, 0xce6e6b28
  buffer_load_dwordx4 v217, s[12:15], s50 offen offset:1024 lds
  v_mfma_f32_16x16x32_bf16 v[112:115], v[32:35], v[96:99], 0
  v_mfma_f32_16x16x32_bf16 v[48:51], v[28:31], v[96:99], 0
  v_mfma_f32_16x16x32_bf16 v[108:111], v[28:31], v[92:95], 0
  v_mfma_f32_16x16x32_bf16 v[44:47], v[24:27], v[92:95], 0
  v_mfma_f32_16x16x32_bf16 v[104:107], v[24:27], v[88:91], 0
  v_mfma_f32_16x16x32_bf16 v[40:43], v[20:23], v[88:91], 0
  s_waitcnt lgkmcnt(2)
  v_mfma_f32_16x16x32_bf16 v[100:103], v[20:23], v[84:87], 0
  v_mfma_f32_16x16x32_bf16 v[36:39], v[124:127], v[84:87], 0
  s_nop 1
  v_cndmask_b32 v214, v112, v113, s[40:41]
  buffer_load_dwordx4 v218, s[12:15], s50 offen offset:2048 lds
  v_cndmask_b32 v215, v114, v115, s[40:41]
  v_cndmask_b32 v212, v48, v49, s[40:41]
  v_cndmask_b32 v213, v50, v51, s[40:41]
  v_cndmask_b32 v210, v108, v109, s[40:41]
  v_cndmask_b32 v211, v110, v111, s[40:41]
  v_cndmask_b32 v208, v44, v45, s[40:41]
  v_cndmask_b32 v209, v46, v47, s[40:41]
  v_cndmask_b32 v206, v104, v105, s[40:41]
  v_cndmask_b32 v207, v106, v107, s[40:41]
  v_cndmask_b32 v204, v40, v41, s[40:41]
  buffer_load_dwordx4 v219, s[12:15], s50 offen offset:3072 lds
  v_cndmask_b32 v205, v42, v43, s[40:41]
  v_cndmask_b32 v202, v100, v101, s[40:41]
  v_cndmask_b32 v203, v102, v103, s[40:41]
  v_cndmask_b32 v200, v36, v37, s[40:41]
  v_cndmask_b32 v201, v38, v39, s[40:41]
  v_cndmask_b32 v212, v214, v212, s[42:43]
  v_cndmask_b32 v213, v215, v213, s[80:81]
  v_cndmask_b32 v208, v210, v208, s[42:43]
  v_cndmask_b32 v209, v211, v209, s[80:81]
  v_cndmask_b32 v204, v206, v204, s[42:43]
  s_add_u32 s50, s72, 4
  s_and_b32 s50, s50, 7
  s_lshl_b32 s50, s50, 18
  s_add_u32 m0, s74, 65536
  s_nop 0
  buffer_load_dwordx4 v216, s[12:15], s50 offen offset:0 lds
  v_cndmask_b32 v205, v207, v205, s[80:81]
  v_cndmask_b32 v200, v202, v200, s[42:43]
  v_cndmask_b32 v201, v203, v201, s[80:81]
  v_mul_f32 v212, 0x3e8293ee, v212
  v_mul_f32 v213, 0x3e8293ee, v213
  v_mul_f32 v208, 0x3e8293ee, v208
  v_mul_f32 v209, 0x3e8293ee, v209
  v_mul_f32 v204, 0x3e8293ee, v204
  v_mul_f32 v205, 0x3e8293ee, v205
  v_mul_f32 v200, 0x3e8293ee, v200
  buffer_load_dwordx4 v217, s[12:15], s50 offen offset:1024 lds
  v_mul_f32 v201, 0x3e8293ee, v201
  v_cndmask_b32 v200, v200, v12, s[66:67]
  v_cndmask_b32 v201, v201, v12, s[68:69]
  v_max_f32 v214, v212, v213
  v_max_f32 v210, v208, v209
  v_max_f32 v206, v204, v205
  v_max_f32 v202, v200, v201
  v_mov_b32 v215, v214
  v_mov_b32 v211, v210
  v_mov_b32 v207, v206
  buffer_load_dwordx4 v218, s[12:15], s50 offen offset:2048 lds
  v_mov_b32 v203, v202
  v_permlane16_swap_b32 v214, v215
  v_permlane16_swap_b32 v210, v211
  v_permlane16_swap_b32 v206, v207
  v_permlane16_swap_b32 v202, v203
  v_max_f32 v214, v214, v215
  v_max_f32 v210, v210, v211
  v_max_f32 v206, v206, v207
  v_max_f32 v202, v202, v203
  v_mov_b32 v215, v214
  buffer_load_dwordx4 v219, s[12:15], s50 offen offset:3072 lds
  v_mov_b32 v211, v210
  v_mov_b32 v207, v206
  v_mov_b32 v203, v202
  v_permlane32_swap_b32 v214, v215
  v_permlane32_swap_b32 v210, v211
  v_permlane32_swap_b32 v206, v207
  v_permlane32_swap_b32 v202, v203
  v_max_f32 v214, v214, v215
  v_max_f32 v210, v210, v211
  v_max_f32 v206, v206, v207
  s_add_u32 s50, s72, 5
  s_and_b32 s50, s50, 7
  s_lshl_b32 s50, s50, 18
  s_add_u32 m0, s74, 81920
  s_nop 0
  buffer_load_dwordx4 v216, s[12:15], s50 offen offset:0 lds
  v_max_f32 v202, v202, v203
  v_sub_f32 v212, v212, v214
  v_sub_f32 v213, v213, v214
  v_sub_f32 v208, v208, v210
  v_sub_f32 v209, v209, v210
  v_sub_f32 v204, v204, v206
  v_sub_f32 v205, v205, v206
  v_sub_f32 v200, v200, v202
  v_sub_f32 v201, v201, v202
  v_exp_f32 v212, v212
  buffer_load_dwordx4 v217, s[12:15], s50 offen offset:1024 lds
  v_exp_f32 v213, v213
  v_exp_f32 v208, v208
  v_exp_f32 v209, v209
  v_exp_f32 v204, v204
  v_exp_f32 v205, v205
  v_exp_f32 v200, v200
  v_exp_f32 v201, v201
  v_add_f32 v214, v212, v213
  v_add_f32 v210, v208, v209
  v_add_f32 v206, v204, v205
  buffer_load_dwordx4 v218, s[12:15], s50 offen offset:2048 lds
  v_add_f32 v202, v200, v201
  v_mov_b32 v215, v214
  v_mov_b32 v211, v210
  v_mov_b32 v207, v206
  v_mov_b32 v203, v202
  v_permlane16_swap_b32 v214, v215
  v_permlane16_swap_b32 v210, v211
  v_permlane16_swap_b32 v206, v207
  v_permlane16_swap_b32 v202, v203
  v_add_f32 v214, v214, v215
  buffer_load_dwordx4 v219, s[12:15], s50 offen offset:3072 lds
  v_add_f32 v210, v210, v211
  v_add_f32 v206, v206, v207
  v_add_f32 v202, v202, v203
  v_mov_b32 v215, v214
  v_mov_b32 v211, v210
  v_mov_b32 v207, v206
  v_mov_b32 v203, v202
  v_permlane32_swap_b32 v214, v215
  v_permlane32_swap_b32 v210, v211
  v_permlane32_swap_b32 v206, v207
  s_add_u32 s50, s72, 6
  s_and_b32 s50, s50, 7
  s_lshl_b32 s50, s50, 18
  s_add_u32 m0, s74, 98304
  s_nop 0
  buffer_load_dwordx4 v216, s[12:15], s50 offen offset:0 lds
  v_permlane32_swap_b32 v202, v203
  v_add_f32 v214, v214, v215
  v_add_f32 v210, v210, v211
  v_add_f32 v206, v206, v207
  v_add_f32 v202, v202, v203
  v_rcp_f32 v214, v214
  v_rcp_f32 v210, v210
  v_rcp_f32 v206, v206
  v_rcp_f32 v202, v202
  v_mul_f32 v212, v212, v214
  buffer_load_dwordx4 v217, s[12:15], s50 offen offset:1024 lds
  v_mul_f32 v213, v213, v214
  v_mul_f32 v208, v208, v210
  v_mul_f32 v209, v209, v210
  v_mul_f32 v204, v204, v206
  v_mul_f32 v205, v205, v206
  v_mul_f32 v200, v200, v202
  v_mul_f32 v201, v201, v202
  v_cvt_pk_bf16_f32 v212, v212, v212
  v_cvt_pk_bf16_f32 v213, v213, v213
  v_cvt_pk_bf16_f32 v208, v208, v208
  buffer_load_dwordx4 v218, s[12:15], s50 offen offset:2048 lds
  v_cvt_pk_bf16_f32 v209, v209, v209
  v_cvt_pk_bf16_f32 v204, v204, v204
  v_cvt_pk_bf16_f32 v205, v205, v205
  v_cvt_pk_bf16_f32 v200, v200, v200
  v_cvt_pk_bf16_f32 v201, v201, v201
  v_and_b32 v48, v227, v212
  v_and_b32 v49, v228, v213
  v_and_b32 v50, v229, v212
  v_and_b32 v51, v230, v213
  v_and_b32 v44, v227, v208
  buffer_load_dwordx4 v219, s[12:15], s50 offen offset:3072 lds
  v_and_b32 v45, v228, v209
  v_and_b32 v46, v229, v208
  v_and_b32 v47, v230, v209
  v_and_b32 v40, v227, v204
  v_and_b32 v41, v228, v205
  v_and_b32 v42, v229, v204
  v_and_b32 v43, v230, v205
  v_and_b32 v36, v227, v200
  v_and_b32 v37, v228, v201
  v_and_b32 v38, v229, v200
  v_and_b32 v39, v230, v201
  s_waitcnt lgkmcnt(0)
  v_mfma_f32_16x16x32_bf16 v[32:35], v[58:61], v[48:51], 0
  v_mfma_f32_16x16x32_bf16 v[96:99], v[74:77], v[48:51], 0
  v_mfma_f32_16x16x32_bf16 v[28:31], v[56:59], v[44:47], 0
  v_mfma_f32_16x16x32_bf16 v[92:95], v[72:75], v[44:47], 0
  v_mfma_f32_16x16x32_bf16 v[24:27], v[54:57], v[40:43], 0
  v_mfma_f32_16x16x32_bf16 v[88:91], v[70:73], v[40:43], 0
  v_mfma_f32_16x16x32_bf16 v[20:23], v[52:55], v[36:39], 0
  v_mfma_f32_16x16x32_bf16 v[84:87], v[68:71], v[36:39], 0
  s_cmp_eq_u32 s58, 1
  s_cselect_b64 vcc, -1, 0
  v_cvt_pk_bf16_f32 v112, v32, v33
  v_cvt_pk_bf16_f32 v113, v34, v35
  v_cvt_pk_bf16_f32 v114, v96, v97
  v_cvt_pk_bf16_f32 v115, v98, v99
  v_cndmask_b32 v212, v112, v114, vcc
  v_cndmask_b32 v213, v113, v115, vcc
  v_cndmask_b32 v214, v114, v112, vcc
  v_cndmask_b32 v215, v115, v113, vcc
  buffer_store_dwordx4 v[212:215], v0, s[36:39], s76 offen offset:1024 sc1
  v_cvt_pk_bf16_f32 v108, v28, v29
  v_cvt_pk_bf16_f32 v109, v30, v31
  v_cvt_pk_bf16_f32 v110, v92, v93
  v_cvt_pk_bf16_f32 v111, v94, v95
  v_cndmask_b32 v208, v108, v110, vcc
  v_cndmask_b32 v209, v109, v111, vcc
  v_cndmask_b32 v210, v110, v108, vcc
  v_cndmask_b32 v211, v111, v109, vcc
  buffer_store_dwordx4 v[208:211], v0, s[36:39], s76 offen offset:0 sc1
  v_cvt_pk_bf16_f32 v104, v24, v25
  v_cvt_pk_bf16_f32 v105, v26, v27
  v_cvt_pk_bf16_f32 v106, v88, v89
  v_cvt_pk_bf16_f32 v107, v90, v91
  v_cndmask_b32 v204, v104, v106, vcc
  v_cndmask_b32 v205, v105, v107, vcc
  v_cndmask_b32 v206, v106, v104, vcc
  v_cndmask_b32 v207, v107, v105, vcc
  buffer_store_dwordx4 v[204:207], v0, s[36:39], s75 offen offset:1024 sc1
  v_cvt_pk_bf16_f32 v100, v20, v21
  v_cvt_pk_bf16_f32 v101, v22, v23
  v_cvt_pk_bf16_f32 v102, v84, v85
  v_cvt_pk_bf16_f32 v103, v86, v87
  v_cndmask_b32 v200, v100, v102, vcc
  v_cndmask_b32 v201, v101, v103, vcc
  v_cndmask_b32 v202, v102, v100, vcc
  v_cndmask_b32 v203, v103, v101, vcc
  buffer_store_dwordx4 v[200:203], v0, s[36:39], s75 offen offset:0 sc1
  v_mov_b32 v12, 1
  s_waitcnt vmcnt(0) lgkmcnt(0)
  s_barrier
  s_mov_b64 exec, 1
  buffer_store_dword v12, v0, s[36:39], s45 offen sc1
  s_mov_b64 exec, -1
  v_lshlrev_b32 v28, 16, v156
  s_add_u32 s50, s72, 7
  s_and_b32 s50, s50, 7
  s_lshl_b32 s50, s50, 18
  s_add_u32 m0, s74, 114688
  s_nop 0
  buffer_load_dwordx4 v216, s[12:15], s50 offen offset:0 lds
  v_and_b32 v29, 0xffff0000, v156
  v_lshlrev_b32 v30, 16, v157
  v_and_b32 v31, 0xffff0000, v157
  v_mul_f32 v20, v188, v28
  v_mul_f32 v21, v188, v29
  v_mul_f32 v22, v188, v30
  buffer_load_dwordx4 v217, s[12:15], s50 offen offset:1024 lds
  v_mul_f32 v23, v188, v31
  v_lshlrev_b32 v28, 16, v158
  v_and_b32 v29, 0xffff0000, v158
  v_lshlrev_b32 v30, 16, v159
  v_and_b32 v31, 0xffff0000, v159
  v_mul_f32 v24, v188, v28
  buffer_load_dwordx4 v218, s[12:15], s50 offen offset:2048 lds
  v_mul_f32 v25, v188, v29
  v_mul_f32 v26, v188, v30
  v_mul_f32 v27, v188, v31
  v_lshlrev_b32 v28, 16, v160
  v_and_b32 v29, 0xffff0000, v160
  v_lshlrev_b32 v30, 16, v161
  buffer_load_dwordx4 v219, s[12:15], s50 offen offset:3072 lds
  v_and_b32 v31, 0xffff0000, v161
  v_fmac_f32 v20, v189, v28
  v_fmac_f32 v21, v189, v29
  v_fmac_f32 v22, v189, v30
  v_fmac_f32 v23, v189, v31
  v_lshlrev_b32 v28, 16, v162
  s_add_u32 m0, s74, 131072
  s_nop 0
  buffer_load_dwordx4 v220, s[4:7], s73 offen offset:0 lds
  v_and_b32 v29, 0xffff0000, v162
  v_lshlrev_b32 v30, 16, v163
  v_and_b32 v31, 0xffff0000, v163
  v_fmac_f32 v24, v189, v28
  v_fmac_f32 v25, v189, v29
  v_fmac_f32 v26, v189, v30
  buffer_load_dwordx4 v221, s[4:7], s73 offen offset:1024 lds
  v_fmac_f32 v27, v189, v31
  v_lshlrev_b32 v28, 16, v164
  v_and_b32 v29, 0xffff0000, v164
  v_lshlrev_b32 v30, 16, v165
  v_and_b32 v31, 0xffff0000, v165
  v_fmac_f32 v20, v190, v28
  s_add_u32 m0, s74, 133120
  s_add_u32 s48, s73, 32768
  buffer_load_dwordx4 v220, s[4:7], s48 offen offset:0 lds
  v_fmac_f32 v21, v190, v29
  v_fmac_f32 v22, v190, v30
  v_fmac_f32 v23, v190, v31
  v_lshlrev_b32 v28, 16, v166
  v_and_b32 v29, 0xffff0000, v166
  v_lshlrev_b32 v30, 16, v167
  buffer_load_dwordx4 v221, s[4:7], s48 offen offset:1024 lds
  v_and_b32 v31, 0xffff0000, v167
  v_fmac_f32 v24, v190, v28
  v_fmac_f32 v25, v190, v29
  v_fmac_f32 v26, v190, v30
  v_fmac_f32 v27, v190, v31
  v_lshlrev_b32 v28, 16, v168
  v_and_b32 v29, 0xffff0000, v168
  v_lshlrev_b32 v30, 16, v169
  v_and_b32 v31, 0xffff0000, v169
  v_fmac_f32 v20, v191, v28
  v_fmac_f32 v21, v191, v29
  v_fmac_f32 v22, v191, v30
  v_fmac_f32 v23, v191, v31
  v_lshlrev_b32 v28, 16, v170
  v_and_b32 v29, 0xffff0000, v170
  v_lshlrev_b32 v30, 16, v171
  v_and_b32 v31, 0xffff0000, v171
  v_fmac_f32 v24, v191, v28
  v_fmac_f32 v25, v191, v29
  v_fmac_f32 v26, v191, v30
  v_fmac_f32 v27, v191, v31
  v_lshlrev_b32 v28, 16, v172
  v_and_b32 v29, 0xffff0000, v172
  v_lshlrev_b32 v30, 16, v173
  v_and_b32 v31, 0xffff0000, v173
  v_fmac_f32 v20, v192, v28
  v_fmac_f32 v21, v192, v29
  v_fmac_f32 v22, v192, v30
  v_fmac_f32 v23, v192, v31
  v_lshlrev_b32 v28, 16, v174
  v_and_b32 v29, 0xffff0000, v174
  v_lshlrev_b32 v30, 16, v175
  v_and_b32 v31, 0xffff0000, v175
  v_fmac_f32 v24, v192, v28
  v_fmac_f32 v25, v192, v29
  v_fmac_f32 v26, v192, v30
  v_fmac_f32 v27, v192, v31
  v_lshlrev_b32 v28, 16, v176
  v_and_b32 v29, 0xffff0000, v176
  v_lshlrev_b32 v30, 16, v177
  v_and_b32 v31, 0xffff0000, v177
  v_fmac_f32 v20, v193, v28
  v_fmac_f32 v21, v193, v29
  v_fmac_f32 v22, v193, v30
  v_fmac_f32 v23, v193, v31
  v_lshlrev_b32 v28, 16, v178
  v_and_b32 v29, 0xffff0000, v178
  v_lshlrev_b32 v30, 16, v179
  v_and_b32 v31, 0xffff0000, v179
  v_fmac_f32 v24, v193, v28
  v_fmac_f32 v25, v193, v29
  v_fmac_f32 v26, v193, v30
  v_fmac_f32 v27, v193, v31
  v_lshlrev_b32 v28, 16, v180
  v_and_b32 v29, 0xffff0000, v180
  v_lshlrev_b32 v30, 16, v181
  v_and_b32 v31, 0xffff0000, v181
  v_fmac_f32 v20, v194, v28
  v_fmac_f32 v21, v194, v29
  v_fmac_f32 v22, v194, v30
  v_fmac_f32 v23, v194, v31
  v_lshlrev_b32 v28, 16, v182
  v_and_b32 v29, 0xffff0000, v182
  v_lshlrev_b32 v30, 16, v183
  v_and_b32 v31, 0xffff0000, v183
  v_fmac_f32 v24, v194, v28
  v_fmac_f32 v25, v194, v29
  v_fmac_f32 v26, v194, v30
  v_fmac_f32 v27, v194, v31
  v_lshlrev_b32 v28, 16, v184
  v_and_b32 v29, 0xffff0000, v184
  v_lshlrev_b32 v30, 16, v185
  v_and_b32 v31, 0xffff0000, v185
  v_fmac_f32 v20, v195, v28
  v_fmac_f32 v21, v195, v29
  v_fmac_f32 v22, v195, v30
  v_fmac_f32 v23, v195, v31
  v_lshlrev_b32 v28, 16, v186
  v_and_b32 v29, 0xffff0000, v186
  v_lshlrev_b32 v30, 16, v187
  v_and_b32 v31, 0xffff0000, v187
  v_fmac_f32 v24, v195, v28
  v_fmac_f32 v25, v195, v29
  v_fmac_f32 v26, v195, v30
  v_fmac_f32 v27, v195, v31
  s_nop 0
  v_permlane32_swap_b32 v20, v24
  v_permlane32_swap_b32 v21, v25
  v_permlane32_swap_b32 v22, v26
  v_permlane32_swap_b32 v23, v27
  v_add_f32 v20, v20, v24
  v_add_f32 v21, v21, v25
  v_add_f32 v22, v22, v26
  v_add_f32 v23, v23, v27
  s_nop 0
  v_permlane16_swap_b32 v20, v22
  v_permlane16_swap_b32 v21, v23
  v_add_f32 v20, v20, v22
  v_add_f32 v21, v21, v23
  v_add_u32 v196, 162816, v198
  v_add_f32_dpp v20, v20, v20 row_ror:8 row_mask:0xf bank_mask:0xf
  v_add_f32_dpp v21, v21, v21 row_ror:8 row_mask:0xf bank_mask:0xf
  ds_write_b64 v197, v[20:21]
  s_lshl_b32 s45, s2, 7
  s_add_u32 s45, s45, 5341184
  s_cmp_eq_u32 s44, 0
  s_cselect_b32 s45, s45, 1073741824
  s_waitcnt lgkmcnt(0)
  s_barrier
  s_cmp_lg_u32 s44, 1
  s_cbranch_scc1 F_job
  ds_read_b32 v20, v196 offset:0
  ds_read_b32 v21, v196 offset:256
  ds_read_b32 v22, v196 offset:512
  ds_read_b32 v23, v196 offset:768
  s_waitcnt lgkmcnt(0)
  v_add_f32 v20, v20, v21
  v_add_f32 v22, v22, v23
  v_add_f32 v20, v20, v22
  buffer_store_dword v20, v198, s[36:39], s53 offen sc1
  s_mov_b64 exec, 1
  s_waitcnt vmcnt(0)
  buffer_store_dword v12, v0, s[36:39], s54 offen sc1
  s_mov_b64 exec, -1
  s_branch J_job
F_job:
  s_cmp_lg_u32 s44, 0
  s_cbranch_scc1 SM5x
  s_mov_b32 s46, 60000
  s_mov_b32 s47, 5275648
SM5:
  buffer_load_dword v13, v249, s[36:39], s47 offen sc1
  s_sub_u32 s46, s46, 1
  s_cmp_eq_u32 s46, 0
  s_waitcnt vmcnt(0)
  s_cbranch_scc1 SM5x
  v_cmp_ne_u32 vcc, 1, v13
  s_nop 4
  s_cbranch_vccnz SM5
SM5x:
  s_waitcnt vmcnt(0)
J_job:
  s_barrier
  s_lshl_b32 s8, s72, 13
  buffer_load_dwordx4 a[0:3], v243, s[36:39], s8 offen offset:0 sc1
  buffer_load_dwordx4 a[8:11], v243, s[36:39], s8 offen offset:2048 sc1
  buffer_load_dwordx4 a[4:7], v243, s[36:39], s8 offen offset:1024 sc1
  buffer_load_dwordx4 a[12:15], v243, s[36:39], s8 offen offset:3072 sc1
  s_add_u32 s8, s8, 4096
  s_and_b32 s8, s8, 0xffff
  buffer_load_dwordx4 a[16:19], v243, s[36:39], s8 offen offset:0 sc1
  buffer_load_dwordx4 a[20:23], v243, s[36:39], s8 offen offset:1024 sc1
  buffer_load_dwordx4 a[24:27], v243, s[36:39], s8 offen offset:2048 sc1
  buffer_load_dwordx4 a[28:31], v243, s[36:39], s8 offen offset:3072 sc1
  ds_read_b64_tr_b16 a[80:81], v231 offset:0
  ds_read_b64_tr_b16 a[82:83], v231 offset:2048
  ds_read_b64_tr_b16 a[84:85], v231 offset:4096
  ds_read_b64_tr_b16 a[86:87], v231 offset:6144
  ds_read_b64 v[116:117], v239 offset:0
  ds_read_b64 v[118:119], v240 offset:0
  ds_read_b64 v[120:121], v241 offset:0
  ds_read_b64 v[122:123], v242 offset:0
  ds_read_b64 v[124:125], v239 offset:2048
  ds_read_b64 v[126:127], v240 offset:2048
  ds_read_b64 v[128:129], v241 offset:2048
  ds_read_b64 v[130:131], v242 offset:2048
  v_lshrrev_b32 v13, 4, v10
  v_cmp_eq_u32 vcc, 2, v13
  s_add_u32 s9, s77, 4096
  s_mov_b32 s48, 5308416
  v_cndmask_b32 v13, 0, 1.0, vcc
  s_waitcnt lgkmcnt(0)
  v_lshlrev_b32 v52, 16, v116
  v_and_b32 v53, 0xffff0000, v116
  v_lshlrev_b32 v54, 16, v117
  v_and_b32 v55, 0xffff0000, v117
  v_lshlrev_b32 v56, 16, v118
  v_and_b32 v57, 0xffff0000, v118
  v_lshlrev_b32 v58, 16, v119
  v_and_b32 v59, 0xffff0000, v119
  v_lshlrev_b32 v60, 16, v120
  v_and_b32 v61, 0xffff0000, v120
  v_lshlrev_b32 v62, 16, v121
  v_and_b32 v63, 0xffff0000, v121
  v_lshlrev_b32 v64, 16, v122
  v_and_b32 v65, 0xffff0000, v122
  v_lshlrev_b32 v66, 16, v123
  v_and_b32 v67, 0xffff0000, v123
  v_lshlrev_b32 v68, 16, v124
  v_and_b32 v69, 0xffff0000, v124
  v_lshlrev_b32 v70, 16, v125
  v_and_b32 v71, 0xffff0000, v125
  v_lshlrev_b32 v72, 16, v126
  v_and_b32 v73, 0xffff0000, v126
  v_lshlrev_b32 v74, 16, v127
  v_and_b32 v75, 0xffff0000, v127
  v_lshlrev_b32 v76, 16, v128
  v_and_b32 v77, 0xffff0000, v128
  v_lshlrev_b32 v78, 16, v129
  v_and_b32 v79, 0xffff0000, v129
  v_lshlrev_b32 v80, 16, v130
  v_and_b32 v81, 0xffff0000, v130
  v_lshlrev_b32 v82, 16, v131
  v_and_b32 v83, 0xffff0000, v131
  s_waitcnt vmcnt(7) lgkmcnt(8)
  v_mfma_f32_16x16x32_bf16 v[20:23], a[80:83], a[0:3], 0
  s_add_u32 s8, s8, 4096
  s_waitcnt vmcnt(6)
  v_mfma_f32_16x16x32_bf16 v[20:23], a[84:87], a[8:11], v[20:23]
  s_and_b32 s8, s8, 0xffff
  s_waitcnt vmcnt(4)
  v_mfma_f32_16x16x32_bf16 v[24:27], a[84:87], a[12:15], 0
  ds_read_b64_tr_b16 a[88:89], v232 offset:0
  s_waitcnt vmcnt(5)
  v_mfma_f32_16x16x32_bf16 v[24:27], a[80:83], a[4:7], v[24:27]
  ds_read_b64_tr_b16 a[90:91], v232 offset:2048
  ds_read_b64_tr_b16 a[92:93], v232 offset:4096
  ds_read_b64_tr_b16 a[94:95], v232 offset:6144
  s_waitcnt lgkmcnt(0)
  v_mfma_f32_16x16x32_bf16 v[32:35], a[88:91], a[4:7], 0
  ds_read_b64_tr_b16 a[96:97], v233 offset:0
  ds_read_b64_tr_b16 a[98:99], v233 offset:2048
  v_mfma_f32_16x16x32_bf16 v[32:35], a[92:95], a[12:15], v[32:35]
  ds_read_b64_tr_b16 a[100:101], v233 offset:4096
  ds_read_b64_tr_b16 a[102:103], v233 offset:6144
  v_mfma_f32_16x16x32_bf16 v[28:31], a[92:95], a[8:11], 0
  ds_read_b64_tr_b16 a[104:105], v234 offset:0
  ds_read_b64_tr_b16 a[106:107], v234 offset:2048
  v_mfma_f32_16x16x32_bf16 v[28:31], a[88:91], a[0:3], v[28:31]
  ds_read_b64_tr_b16 a[108:109], v234 offset:4096
  s_waitcnt lgkmcnt(3)
  v_mfma_f32_16x16x32_bf16 v[36:39], a[96:99], a[0:3], 0
  ds_read_b64_tr_b16 a[110:111], v234 offset:6144
  buffer_load_dwordx4 a[32:35], v243, s[36:39], s8 offen offset:0 sc1
  v_mfma_f32_16x16x32_bf16 v[36:39], a[100:103], a[8:11], v[36:39]
  ds_read_b64_tr_b16 a[112:113], v231 offset:8192
  ds_read_b64_tr_b16 a[114:115], v231 offset:10240
  v_mfma_f32_16x16x32_bf16 v[40:43], a[100:103], a[12:15], 0
  buffer_load_dwordx4 a[36:39], v243, s[36:39], s8 offen offset:1024 sc1
  ds_read_b64_tr_b16 a[116:117], v231 offset:12288
  v_mfma_f32_16x16x32_bf16 v[40:43], a[96:99], a[4:7], v[40:43]
  ds_read_b64_tr_b16 a[118:119], v231 offset:14336
  s_waitcnt lgkmcnt(4)
  v_mfma_f32_16x16x32_bf16 v[48:51], a[104:107], a[4:7], 0
  buffer_load_dwordx4 a[40:43], v243, s[36:39], s8 offen offset:2048 sc1
  ds_read_b64_tr_b16 a[80:81], v232 offset:8192
  v_mfma_f32_16x16x32_bf16 v[48:51], a[108:111], a[12:15], v[48:51]
  ds_read_b64_tr_b16 a[82:83], v232 offset:10240
  buffer_load_dwordx4 a[44:47], v243, s[36:39], s8 offen offset:3072 sc1
  v_mfma_f32_16x16x32_bf16 v[44:47], a[108:111], a[8:11], 0
  ds_read_b64_tr_b16 a[84:85], v232 offset:12288
  s_add_u32 s8, s8, 4096
  v_mfma_f32_16x16x32_bf16 v[44:47], a[104:107], a[0:3], v[44:47]
  s_and_b32 s8, s8, 0xffff
  s_waitcnt vmcnt(4) lgkmcnt(3)
  v_mfma_f32_16x16x32_bf16 v[20:23], a[112:115], a[16:19], v[20:23]
  ds_read_b64_tr_b16 a[86:87], v232 offset:14336
  buffer_load_dwordx4 a[48:51], v243, s[36:39], s8 offen offset:0 sc1
  v_mfma_f32_16x16x32_bf16 v[20:23], a[116:119], a[24:27], v[20:23]
  ds_read_b64_tr_b16 a[88:89], v233 offset:8192
CT6:
  s_add_u32 s94, s92, CT6-k3_main_kernel+3072
  s_addc_u32 s95, s93, 0
  v_mfma_f32_16x16x32_bf16 v[24:27], a[116:119], a[28:31], v[24:27]
  global_load_dword a252, v0, s[94:95]
  ds_read_b64_tr_b16 a[90:91], v233 offset:10240
  v_mfma_f32_16x16x32_bf16 v[24:27], a[112:115], a[20:23], v[24:27]
  buffer_load_dwordx4 a[52:55], v243, s[36:39], s8 offen offset:1024 sc1
  s_waitcnt lgkmcnt(2)
  v_mfma_f32_16x16x32_bf16 v[32:35], a[80:83], a[20:23], v[32:35]
  ds_read_b64_tr_b16 a[92:93], v233 offset:12288
  ds_read_b64_tr_b16 a[94:95], v233 offset:14336
  v_mfma_f32_16x16x32_bf16 v[32:35], a[84:87], a[28:31], v[32:35]
  buffer_load_dwordx4 a[56:59], v243, s[36:39], s8 offen offset:2048 sc1
  ds_read_b64_tr_b16 a[96:97], v234 offset:8192
  v_mfma_f32_16x16x32_bf16 v[28:31], a[84:87], a[24:27], v[28:31]
  ds_read_b64_tr_b16 a[98:99], v234 offset:10240
  buffer_load_dwordx4 a[60:63], v243, s[36:39], s8 offen offset:3072 sc1
  v_mfma_f32_16x16x32_bf16 v[28:31], a[80:83], a[16:19], v[28:31]
  ds_read_b64_tr_b16 a[100:101], v234 offset:12288
  s_waitcnt lgkmcnt(3)
  v_mfma_f32_16x16x32_bf16 v[36:39], a[88:91], a[16:19], v[36:39]
  s_add_u32 s8, s8, 4096
  s_and_b32 s8, s8, 0xffff
  v_mfma_f32_16x16x32_bf16 v[36:39], a[92:95], a[24:27], v[36:39]
  ds_read_b64_tr_b16 a[102:103], v234 offset:14336
  buffer_load_dwordx4 a[64:67], v243, s[36:39], s8 offen offset:0 sc1
  v_mfma_f32_16x16x32_bf16 v[40:43], a[92:95], a[28:31], v[40:43]
  ds_read_b64_tr_b16 a[104:105], v231 offset:16384
  ds_read_b64_tr_b16 a[106:107], v231 offset:18432
  v_mfma_f32_16x16x32_bf16 v[40:43], a[88:91], a[20:23], v[40:43]
  buffer_load_dwordx4 a[68:71], v243, s[36:39], s8 offen offset:1024 sc1
  s_waitcnt lgkmcnt(2)
  v_mfma_f32_16x16x32_bf16 v[48:51], a[96:99], a[20:23], v[48:51]
  ds_read_b64_tr_b16 a[108:109], v231 offset:20480
  ds_read_b64_tr_b16 a[110:111], v231 offset:22528
  v_mfma_f32_16x16x32_bf16 v[48:51], a[100:103], a[28:31], v[48:51]
  buffer_load_dwordx4 a[72:75], v243, s[36:39], s8 offen offset:2048 sc1
  ds_read_b64_tr_b16 a[112:113], v232 offset:16384
  v_mfma_f32_16x16x32_bf16 v[44:47], a[100:103], a[24:27], v[44:47]
  s_and_b32 s40, s44, 1
  s_lshl1_add_u32 s40, s2, s40
  v_mfma_f32_16x16x32_bf16 v[44:47], a[96:99], a[16:19], v[44:47]
  s_mul_i32 s31, s40, 0
  s_waitcnt vmcnt(8) lgkmcnt(1)
  v_mfma_f32_16x16x32_bf16 v[20:23], a[104:107], a[32:35], v[20:23]
  s_add_u32 s31, s31, 1835008
  v_min_u32 v14, 0, v10
  v_mfma_f32_16x16x32_bf16 v[20:23], a[108:111], a[40:43], v[20:23]
  v_lshlrev_b32 v14, 7, v14
  ds_read_b64_tr_b16 a[114:115], v232 offset:18432
  v_mfma_f32_16x16x32_bf16 v[24:27], a[108:111], a[44:47], v[24:27]
  buffer_load_dwordx4 a[76:79], v243, s[36:39], s8 offen offset:3072 sc1
  ds_read_b64_tr_b16 a[116:117], v232 offset:20480
  v_mfma_f32_16x16x32_bf16 v[24:27], a[104:107], a[36:39], v[24:27]
  ds_read_b64_tr_b16 a[118:119], v232 offset:22528
  s_waitcnt lgkmcnt(0)
  v_mfma_f32_16x16x32_bf16 v[32:35], a[112:115], a[36:39], v[32:35]
  s_add_u32 s8, s8, 4096
  s_and_b32 s8, s8, 0xffff
  v_mfma_f32_16x16x32_bf16 v[32:35], a[116:119], a[44:47], v[32:35]
  buffer_load_dwordx4 a[0:3], v243, s[36:39], s8 offen offset:0 sc1
  ds_read_b64_tr_b16 a[80:81], v233 offset:16384
  v_mfma_f32_16x16x32_bf16 v[28:31], a[116:119], a[40:43], v[28:31]
  ds_read_b64_tr_b16 a[82:83], v233 offset:18432
  buffer_load_dwordx4 a[4:7], v243, s[36:39], s8 offen offset:1024 sc1
  v_mfma_f32_16x16x32_bf16 v[28:31], a[112:115], a[32:35], v[28:31]
  ds_read_b64_tr_b16 a[84:85], v233 offset:20480
  ds_read_b64_tr_b16 a[86:87], v233 offset:22528
  s_waitcnt lgkmcnt(0)
  v_mfma_f32_16x16x32_bf16 v[36:39], a[80:83], a[32:35], v[36:39]
  buffer_load_dwordx4 a[8:11], v243, s[36:39], s8 offen offset:2048 sc1
  ds_read_b64_tr_b16 a[88:89], v234 offset:16384
  v_mfma_f32_16x16x32_bf16 v[36:39], a[84:87], a[40:43], v[36:39]
  ds_read_b64_tr_b16 a[90:91], v234 offset:18432
  buffer_load_dwordx4 a[12:15], v243, s[36:39], s8 offen offset:3072 sc1
  v_mfma_f32_16x16x32_bf16 v[40:43], a[84:87], a[44:47], v[40:43]
  ds_read_b64_tr_b16 a[92:93], v234 offset:20480
  ds_read_b64_tr_b16 a[94:95], v234 offset:22528
  v_mfma_f32_16x16x32_bf16 v[40:43], a[80:83], a[36:39], v[40:43]
  s_add_u32 s8, s8, 4096
  s_waitcnt lgkmcnt(0)
  v_mfma_f32_16x16x32_bf16 v[48:51], a[88:91], a[36:39], v[48:51]
  s_and_b32 s8, s8, 0xffff
  ds_read_b64_tr_b16 a[96:97], v231 offset:24576
  v_mfma_f32_16x16x32_bf16 v[48:51], a[92:95], a[44:47], v[48:51]
  buffer_load_dwordx4 a[16:19], v243, s[36:39], s8 offen offset:0 sc1
  ds_read_b64_tr_b16 a[98:99], v231 offset:26624
  v_mfma_f32_16x16x32_bf16 v[44:47], a[92:95], a[40:43], v[44:47]
  ds_read_b64_tr_b16 a[100:101], v231 offset:28672
  ds_read_b64_tr_b16 a[102:103], v231 offset:30720
  v_mfma_f32_16x16x32_bf16 v[44:47], a[88:91], a[32:35], v[44:47]
  ds_read_b64_tr_b16 a[104:105], v232 offset:24576
  s_waitcnt vmcnt(9) lgkmcnt(1)
  v_mfma_f32_16x16x32_bf16 v[20:23], a[96:99], a[48:51], v[20:23]
  buffer_load_dwordx4 a[20:23], v243, s[36:39], s8 offen offset:1024 sc1
  ds_read_b64_tr_b16 a[106:107], v232 offset:26624
  v_mfma_f32_16x16x32_bf16 v[20:23], a[100:103], a[56:59], v[20:23]
  ds_read_b64_tr_b16 a[108:109], v232 offset:28672
  ds_read_b64_tr_b16 a[110:111], v232 offset:30720
  v_mfma_f32_16x16x32_bf16 v[24:27], a[100:103], a[60:63], v[24:27]
  ds_read_b64_tr_b16 a[112:113], v233 offset:24576
  buffer_load_dwordx4 v[156:159], v247, s[36:39], s48 offen sc1
  v_mfma_f32_16x16x32_bf16 v[24:27], a[96:99], a[52:55], v[24:27]
  buffer_load_dwordx4 a[24:27], v243, s[36:39], s8 offen offset:2048 sc1
  s_waitcnt lgkmcnt(1)
  v_mfma_f32_16x16x32_bf16 v[32:35], a[104:107], a[52:55], v[32:35]
  ds_read_b64_tr_b16 a[114:115], v233 offset:26624
  ds_read_b64_tr_b16 a[116:117], v233 offset:28672
  v_mfma_f32_16x16x32_bf16 v[32:35], a[108:111], a[60:63], v[32:35]
  ds_read_b64_tr_b16 a[118:119], v233 offset:30720
  ds_read_b64_tr_b16 a[80:81], v234 offset:24576
  v_mfma_f32_16x16x32_bf16 v[28:31], a[108:111], a[56:59], v[28:31]
  buffer_load_dwordx4 a[28:31], v243, s[36:39], s8 offen offset:3072 sc1
  ds_read_b64_tr_b16 a[82:83], v234 offset:26624
  v_mfma_f32_16x16x32_bf16 v[28:31], a[104:107], a[48:51], v[28:31]
  ds_read_b64_tr_b16 a[84:85], v234 offset:28672
  s_waitcnt lgkmcnt(3)
  v_mfma_f32_16x16x32_bf16 v[36:39], a[112:115], a[48:51], v[36:39]
  ds_read_b64_tr_b16 a[86:87], v234 offset:30720
  s_add_u32 s8, s8, 4096
  v_mfma_f32_16x16x32_bf16 v[36:39], a[116:119], a[56:59], v[36:39]
  s_and_b32 s8, s8, 0xffff
  ds_read_b64_tr_b16 a[88:89], v231 offset:32768
  v_mfma_f32_16x16x32_bf16 v[40:43], a[116:119], a[60:63], v[40:43]
  buffer_load_dwordx4 a[32:35], v243, s[36:39], s8 offen offset:0 sc1
  ds_read_b64_tr_b16 a[90:91], v231 offset:34816
  v_mfma_f32_16x16x32_bf16 v[40:43], a[112:115], a[52:55], v[40:43]
  ds_read_b64_tr_b16 a[92:93], v231 offset:36864
  s_waitcnt lgkmcnt(3)
  v_mfma_f32_16x16x32_bf16 v[48:51], a[80:83], a[52:55], v[48:51]
  ds_read_b64_tr_b16 a[94:95], v231 offset:38912
  ds_read_b64_tr_b16 a[96:97], v232 offset:32768
  v_mfma_f32_16x16x32_bf16 v[48:51], a[84:87], a[60:63], v[48:51]
  buffer_load_dwordx4 a[36:39], v243, s[36:39], s8 offen offset:1024 sc1
  ds_read_b64_tr_b16 a[98:99], v232 offset:34816
  v_mfma_f32_16x16x32_bf16 v[44:47], a[84:87], a[56:59], v[44:47]
  ds_read_b64_tr_b16 a[100:101], v232 offset:36864
  ds_read_b64_tr_b16 a[102:103], v232 offset:38912
  v_mfma_f32_16x16x32_bf16 v[44:47], a[80:83], a[48:51], v[44:47]
  ds_read_b64_tr_b16 a[104:105], v233 offset:32768
  s_waitcnt vmcnt(11) lgkmcnt(5)
  v_mfma_f32_16x16x32_bf16 v[20:23], a[88:91], a[64:67], v[20:23]
  buffer_load_dwordx4 a[40:43], v243, s[36:39], s8 offen offset:2048 sc1
  ds_read_b64_tr_b16 a[106:107], v233 offset:34816
  v_mfma_f32_16x16x32_bf16 v[20:23], a[92:95], a[72:75], v[20:23]
  ds_read_b64_tr_b16 a[108:109], v233 offset:36864
  ds_read_b64_tr_b16 a[110:111], v233 offset:38912
  v_mfma_f32_16x16x32_bf16 v[24:27], a[92:95], a[76:79], v[24:27]
  ds_read_b64_tr_b16 a[112:113], v234 offset:32768
  buffer_load_dwordx4 a[44:47], v243, s[36:39], s8 offen offset:3072 sc1
  v_mfma_f32_16x16x32_bf16 v[24:27], a[88:91], a[68:71], v[24:27]
  ds_read_b64_tr_b16 a[114:115], v234 offset:34816
  s_waitcnt lgkmcnt(6)
  v_mfma_f32_16x16x32_bf16 v[32:35], a[96:99], a[68:71], v[32:35]
  ds_read_b64_tr_b16 a[116:117], v234 offset:36864
  ds_read_b64_tr_b16 a[118:119], v234 offset:38912
  v_mfma_f32_16x16x32_bf16 v[32:35], a[100:103], a[76:79], v[32:35]
  s_add_u32 s8, s8, 4096
  s_and_b32 s8, s8, 0xffff
  v_mfma_f32_16x16x32_bf16 v[28:31], a[100:103], a[72:75], v[28:31]
  ds_read_b64_tr_b16 a[80:81], v231 offset:40960
  buffer_load_dwordx4 a[48:51], v243, s[36:39], s8 offen offset:0 sc1
  v_mfma_f32_16x16x32_bf16 v[28:31], a[96:99], a[64:67], v[28:31]
  ds_read_b64_tr_b16 a[82:83], v231 offset:43008
  s_waitcnt lgkmcnt(6)
  v_mfma_f32_16x16x32_bf16 v[36:39], a[104:107], a[64:67], v[36:39]
  ds_read_b64_tr_b16 a[84:85], v231 offset:45056
  ds_read_b64_tr_b16 a[86:87], v231 offset:47104
  v_mfma_f32_16x16x32_bf16 v[36:39], a[108:111], a[72:75], v[36:39]
  ds_read_b64_tr_b16 a[88:89], v232 offset:40960
  buffer_load_dwordx4 a[52:55], v243, s[36:39], s8 offen offset:1024 sc1
  v_mfma_f32_16x16x32_bf16 v[40:43], a[108:111], a[76:79], v[40:43]
  ds_read_b64_tr_b16 a[90:91], v232 offset:43008
  ds_read_b64_tr_b16 a[92:93], v232 offset:45056
  v_mfma_f32_16x16x32_bf16 v[40:43], a[104:107], a[68:71], v[40:43]
  ds_read_b64_tr_b16 a[94:95], v232 offset:47104
  s_waitcnt lgkmcnt(8)
  v_mfma_f32_16x16x32_bf16 v[48:51], a[112:115], a[68:71], v[48:51]
  ds_read_b64_tr_b16 a[96:97], v233 offset:40960
  buffer_load_dwordx4 a[56:59], v243, s[36:39], s8 offen offset:2048 sc1
  v_mfma_f32_16x16x32_bf16 v[48:51], a[116:119], a[76:79], v[48:51]
  ds_read_b64_tr_b16 a[98:99], v233 offset:43008
  ds_read_b64_tr_b16 a[100:101], v233 offset:45056
  v_mfma_f32_16x16x32_bf16 v[44:47], a[116:119], a[72:75], v[44:47]
  ds_read_b64_tr_b16 a[102:103], v233 offset:47104
  ds_read_b64_tr_b16 a[104:105], v234 offset:40960
  v_mfma_f32_16x16x32_bf16 v[44:47], a[112:115], a[64:67], v[44:47]
  buffer_load_dwordx4 a[60:63], v243, s[36:39], s8 offen offset:3072 sc1
  s_waitcnt vmcnt(13) lgkmcnt(9)
  v_mfma_f32_16x16x32_bf16 v[20:23], a[80:83], a[0:3], v[20:23]
  ds_read_b64_tr_b16 a[106:107], v234 offset:43008
  ds_read_b64_tr_b16 a[108:109], v234 offset:45056
  v_mfma_f32_16x16x32_bf16 v[20:23], a[84:87], a[8:11], v[20:23]
  ds_read_b64_tr_b16 a[110:111], v234 offset:47104
  s_add_u32 s8, s8, 4096
  v_mfma_f32_16x16x32_bf16 v[24:27], a[84:87], a[12:15], v[24:27]
  s_and_b32 s8, s8, 0xffff
  ds_read_b64_tr_b16 a[112:113], v231 offset:49152
  v_mfma_f32_16x16x32_bf16 v[24:27], a[80:83], a[4:7], v[24:27]
  buffer_load_dwordx4 a[64:67], v243, s[36:39], s8 offen offset:0 sc1
  s_waitcnt lgkmcnt(9)
  v_mfma_f32_16x16x32_bf16 v[32:35], a[88:91], a[4:7], v[32:35]
  ds_read_b64_tr_b16 a[114:115], v231 offset:51200
  ds_read_b64_tr_b16 a[116:117], v231 offset:53248
  v_mfma_f32_16x16x32_bf16 v[32:35], a[92:95], a[12:15], v[32:35]
  ds_read_b64_tr_b16 a[118:119], v231 offset:55296
  ds_read_b64_tr_b16 a[80:81], v232 offset:49152
  v_mfma_f32_16x16x32_bf16 v[28:31], a[92:95], a[8:11], v[28:31]
  buffer_load_dwordx4 a[68:71], v243, s[36:39], s8 offen offset:1024 sc1
  ds_read_b64_tr_b16 a[82:83], v232 offset:51200
  v_mfma_f32_16x16x32_bf16 v[28:31], a[88:91], a[0:3], v[28:31]
  ds_read_b64_tr_b16 a[84:85], v232 offset:53248
  s_waitcnt lgkmcnt(11)
  v_mfma_f32_16x16x32_bf16 v[36:39], a[96:99], a[0:3], v[36:39]
  ds_read_b64_tr_b16 a[86:87], v232 offset:55296
  ds_read_b64_tr_b16 a[88:89], v233 offset:49152
  v_mfma_f32_16x16x32_bf16 v[36:39], a[100:103], a[8:11], v[36:39]
  buffer_load_dwordx4 a[72:75], v243, s[36:39], s8 offen offset:2048 sc1
  ds_read_b64_tr_b16 a[90:91], v233 offset:51200
  v_mfma_f32_16x16x32_bf16 v[40:43], a[100:103], a[12:15], v[40:43]
  ds_read_b64_tr_b16 a[92:93], v233 offset:53248
  s_waitcnt vmcnt(13)
  v_and_b32 v156, v156, v157
  v_and_b32 v158, v158, v159
  v_and_b32 v156, v156, v158
  v_cmp_ne_u32 vcc, 1, v156
  s_nop 4
  s_cbranch_vccnz CK7s
CK7x:
  v_mfma_f32_16x16x32_bf16 v[40:43], a[96:99], a[4:7], v[40:43]
  s_mov_b32 s49, 0
  s_waitcnt lgkmcnt(11)
  v_mfma_f32_16x16x32_bf16 v[48:51], a[104:107], a[4:7], v[48:51]
  buffer_load_dwordx4 v[156:159], v248, s[36:39], s49 offen sc1
  s_mov_b32 s49, 24576
  v_mfma_f32_16x16x32_bf16 v[48:51], a[108:111], a[12:15], v[48:51]
  buffer_load_dwordx4 v[160:163], v248, s[36:39], s49 offen sc1
  s_mov_b32 s49, 49152
  v_mfma_f32_16x16x32_bf16 v[44:47], a[108:111], a[8:11], v[44:47]
  buffer_load_dwordx4 v[164:167], v248, s[36:39], s49 offen sc1
  s_mov_b32 s49, 73728
  v_mfma_f32_16x16x32_bf16 v[44:47], a[104:107], a[0:3], v[44:47]
  buffer_load_dwordx4 v[168:171], v248, s[36:39], s49 offen sc1
  s_waitcnt vmcnt(15) lgkmcnt(7)
  v_mfma_f32_16x16x32_bf16 v[20:23], a[112:115], a[16:19], v[20:23]
  ds_read_b64_tr_b16 a[94:95], v233 offset:55296
  ds_read_b64_tr_b16 a[96:97], v234 offset:49152
  v_mfma_f32_16x16x32_bf16 v[20:23], a[116:119], a[24:27], v[20:23]
  buffer_load_dwordx4 a[76:79], v243, s[36:39], s8 offen offset:3072 sc1
  ds_read_b64_tr_b16 a[98:99], v234 offset:51200
  v_mfma_f32_16x16x32_bf16 v[24:27], a[116:119], a[28:31], v[24:27]
  ds_read_b64_tr_b16 a[100:101], v234 offset:53248
  ds_read_b64_tr_b16 a[102:103], v234 offset:55296
  v_mfma_f32_16x16x32_bf16 v[24:27], a[112:115], a[20:23], v[24:27]
  s_add_u32 s8, s8, 4096
  s_waitcnt lgkmcnt(8)
  v_mfma_f32_16x16x32_bf16 v[32:35], a[80:83], a[20:23], v[32:35]
  s_and_b32 s8, s8, 0xffff
  ds_read_b64_tr_b16 a[104:105], v231 offset:57344
  buffer_load_dwordx4 a[0:3], v243, s[36:39], s8 offen offset:0 sc1
  v_mfma_f32_16x16x32_bf16 v[32:35], a[84:87], a[28:31], v[32:35]
  ds_read_b64_tr_b16 a[106:107], v231 offset:59392
  ds_read_b64_tr_b16 a[108:109], v231 offset:61440
  ds_read_b64_tr_b16 a[110:111], v231 offset:63488
  v_mfma_f32_16x16x32_bf16 v[28:31], a[84:87], a[24:27], v[28:31]
  ds_read_b64_tr_b16 a[112:113], v232 offset:57344
  buffer_load_dwordx4 a[4:7], v243, s[36:39], s8 offen offset:1024 sc1
  ds_read_b64_tr_b16 a[114:115], v232 offset:59392
  v_mfma_f32_16x16x32_bf16 v[28:31], a[80:83], a[16:19], v[28:31]
  ds_read_b64_tr_b16 a[116:117], v232 offset:61440
  ds_read_b64_tr_b16 a[118:119], v232 offset:63488
  s_waitcnt lgkmcnt(12)
  v_mfma_f32_16x16x32_bf16 v[36:39], a[88:91], a[16:19], v[36:39]
  ds_read_b64_tr_b16 a[80:81], v233 offset:57344
  v_mfma_f32_16x16x32_bf16 v[36:39], a[92:95], a[24:27], v[36:39]
  buffer_load_dwordx4 a[8:11], v243, s[36:39], s8 offen offset:2048 sc1
  ds_read_b64_tr_b16 a[82:83], v233 offset:59392
  v_mfma_f32_16x16x32_bf16 v[40:43], a[92:95], a[28:31], v[40:43]
  ds_read_b64_tr_b16 a[84:85], v233 offset:61440
  v_mfma_f32_16x16x32_bf16 v[40:43], a[88:91], a[20:23], v[40:43]
  ds_read_b64_tr_b16 a[86:87], v233 offset:63488
  s_waitcnt lgkmcnt(12)
  v_mfma_f32_16x16x32_bf16 v[48:51], a[96:99], a[20:23], v[48:51]
  ds_read_b64_tr_b16 a[88:89], v234 offset:57344
  v_mfma_f32_16x16x32_bf16 v[48:51], a[100:103], a[28:31], v[48:51]
  buffer_load_dwordx4 a[12:15], v243, s[36:39], s8 offen offset:3072 sc1
  ds_read_b64_tr_b16 a[90:91], v234 offset:59392
  v_mfma_f32_16x16x32_bf16 v[44:47], a[100:103], a[24:27], v[44:47]
  ds_read_b64_tr_b16 a[92:93], v234 offset:61440
  v_mfma_f32_16x16x32_bf16 v[44:47], a[96:99], a[16:19], v[44:47]
  ds_read_b64_tr_b16 a[94:95], v234 offset:63488
  s_waitcnt vmcnt(16) lgkmcnt(12)
  v_mfma_f32_16x16x32_bf16 v[20:23], a[104:107], a[32:35], v[20:23]
  s_add_u32 s8, s8, 4096
  s_and_b32 s8, s8, 0xffff
  ds_read_b64_tr_b16 a[96:97], v235 offset:0
  v_mfma_f32_16x16x32_bf16 v[20:23], a[108:111], a[40:43], v[20:23]
  buffer_load_dwordx4 a[16:19], v243, s[36:39], s8 offen offset:0 sc1
  ds_read_b64_tr_b16 a[98:99], v235 offset:2048
  v_mfma_f32_16x16x32_bf16 v[24:27], a[108:111], a[44:47], v[24:27]
  ds_read_b64_tr_b16 a[100:101], v235 offset:4096
  v_mfma_f32_16x16x32_bf16 v[24:27], a[104:107], a[36:39], v[24:27]
  ds_read_b64_tr_b16 a[102:103], v235 offset:6144
  s_waitcnt lgkmcnt(12)
  v_mfma_f32_16x16x32_bf16 v[32:35], a[112:115], a[36:39], v[32:35]
  ds_read_b64_tr_b16 a[104:105], v236 offset:0
  v_mfma_f32_16x16x32_bf16 v[32:35], a[116:119], a[44:47], v[32:35]
  buffer_load_dwordx4 a[20:23], v243, s[36:39], s8 offen offset:1024 sc1
  ds_read_b64_tr_b16 a[106:107], v236 offset:2048
  v_mfma_f32_16x16x32_bf16 v[28:31], a[116:119], a[40:43], v[28:31]
  ds_read_b64_tr_b16 a[108:109], v236 offset:4096
  v_mfma_f32_16x16x32_bf16 v[28:31], a[112:115], a[32:35], v[28:31]
  ds_read_b64_tr_b16 a[110:111], v236 offset:6144
  s_waitcnt lgkmcnt(12)
  v_mfma_f32_16x16x32_bf16 v[36:39], a[80:83], a[32:35], v[36:39]
  ds_read_b64_tr_b16 a[112:113], v237 offset:0
  v_mfma_f32_16x16x32_bf16 v[36:39], a[84:87], a[40:43], v[36:39]
  buffer_load_dwordx4 a[24:27], v243, s[36:39], s8 offen offset:2048 sc1
  ds_read_b64_tr_b16 a[114:115], v237 offset:2048
  v_mfma_f32_16x16x32_bf16 v[40:43], a[84:87], a[44:47], v[40:43]
  ds_read_b64_tr_b16 a[116:117], v237 offset:4096
  v_mfma_f32_16x16x32_bf16 v[40:43], a[80:83], a[36:39], v[40:43]
  ds_read_b64_tr_b16 a[118:119], v237 offset:6144
  s_waitcnt lgkmcnt(12)
  v_mfma_f32_16x16x32_bf16 v[48:51], a[88:91], a[36:39], v[48:51]
  ds_read_b64_tr_b16 a[80:81], v238 offset:0
  v_mfma_f32_16x16x32_bf16 v[48:51], a[92:95], a[44:47], v[48:51]
  buffer_load_dwordx4 a[28:31], v243, s[36:39], s8 offen offset:3072 sc1
  ds_read_b64_tr_b16 a[82:83], v238 offset:2048
  v_mfma_f32_16x16x32_bf16 v[44:47], a[92:95], a[40:43], v[44:47]
  ds_read_b64_tr_b16 a[84:85], v238 offset:4096
  v_mfma_f32_16x16x32_bf16 v[44:47], a[88:91], a[32:35], v[44:47]
  ds_read_b64_tr_b16 a[86:87], v238 offset:6144
  s_waitcnt vmcnt(16) lgkmcnt(12)
  v_mfma_f32_16x16x32_bf16 v[20:23], a[96:99], a[48:51], v[20:23]
  s_add_u32 s8, s8, 4096
  s_and_b32 s8, s8, 0xffff
  ds_read_b64_tr_b16 a[88:89], v235 offset:8192
  v_mfma_f32_16x16x32_bf16 v[20:23], a[100:103], a[56:59], v[20:23]
  buffer_load_dwordx4 a[32:35], v243, s[36:39], s8 offen offset:0 sc1
  ds_read_b64_tr_b16 a[90:91], v235 offset:10240
  v_mfma_f32_16x16x32_bf16 v[24:27], a[100:103], a[60:63], v[24:27]
  ds_read_b64_tr_b16 a[92:93], v235 offset:12288
  v_mfma_f32_16x16x32_bf16 v[24:27], a[96:99], a[52:55], v[24:27]
  ds_read_b64_tr_b16 a[94:95], v235 offset:14336
  s_waitcnt lgkmcnt(12)
  v_mfma_f32_16x16x32_bf16 v[32:35], a[104:107], a[52:55], v[32:35]
  ds_read_b64_tr_b16 a[96:97], v236 offset:8192
  v_mfma_f32_16x16x32_bf16 v[32:35], a[108:111], a[60:63], v[32:35]
  buffer_load_dwordx4 a[36:39], v243, s[36:39], s8 offen offset:1024 sc1
  ds_read_b64_tr_b16 a[98:99], v236 offset:10240
  v_mfma_f32_16x16x32_bf16 v[28:31], a[108:111], a[56:59], v[28:31]
  ds_read_b64_tr_b16 a[100:101], v236 offset:12288
  v_mfma_f32_16x16x32_bf16 v[28:31], a[104:107], a[48:51], v[28:31]
  ds_read_b64_tr_b16 a[102:103], v236 offset:14336
  s_waitcnt lgkmcnt(12)
  v_mfma_f32_16x16x32_bf16 v[36:39], a[112:115], a[48:51], v[36:39]
  ds_read_b64_tr_b16 a[104:105], v237 offset:8192
  v_mfma_f32_16x16x32_bf16 v[36:39], a[116:119], a[56:59], v[36:39]
  buffer_load_dwordx4 a[40:43], v243, s[36:39], s8 offen offset:2048 sc1
  ds_read_b64_tr_b16 a[106:107], v237 offset:10240
  v_mfma_f32_16x16x32_bf16 v[40:43], a[116:119], a[60:63], v[40:43]
  ds_read_b64_tr_b16 a[108:109], v237 offset:12288
  v_mfma_f32_16x16x32_bf16 v[40:43], a[112:115], a[52:55], v[40:43]
  ds_read_b64_tr_b16 a[110:111], v237 offset:14336
  s_waitcnt lgkmcnt(12)
  v_mfma_f32_16x16x32_bf16 v[48:51], a[80:83], a[52:55], v[48:51]
  ds_read_b64_tr_b16 a[112:113], v238 offset:8192
  v_mfma_f32_16x16x32_bf16 v[48:51], a[84:87], a[60:63], v[48:51]
  buffer_load_dwordx4 a[44:47], v243, s[36:39], s8 offen offset:3072 sc1
  ds_read_b64_tr_b16 a[114:115], v238 offset:10240
  v_mfma_f32_16x16x32_bf16 v[44:47], a[84:87], a[56:59], v[44:47]
  ds_read_b64_tr_b16 a[116:117], v238 offset:12288
  v_mfma_f32_16x16x32_bf16 v[44:47], a[80:83], a[48:51], v[44:47]
  ds_read_b64_tr_b16 a[118:119], v238 offset:14336
  s_waitcnt vmcnt(12) lgkmcnt(12)
  v_mfma_f32_16x16x32_bf16 v[20:23], a[88:91], a[64:67], v[20:23]
  s_add_u32 s8, s8, 4096
  s_and_b32 s8, s8, 0xffff
  ds_read_b64_tr_b16 a[80:81], v235 offset:16384
  v_mfma_f32_16x16x32_bf16 v[20:23], a[92:95], a[72:75], v[20:23]
  buffer_load_dwordx4 a[48:51], v243, s[36:39], s8 offen offset:0 sc1
  ds_read_b64_tr_b16 a[82:83], v235 offset:18432
  v_mfma_f32_16x16x32_bf16 v[24:27], a[92:95], a[76:79], v[24:27]
  ds_read_b64_tr_b16 a[84:85], v235 offset:20480
  v_mfma_f32_16x16x32_bf16 v[24:27], a[88:91], a[68:71], v[24:27]
  ds_read_b64_tr_b16 a[86:87], v235 offset:22528
  s_waitcnt lgkmcnt(12)
  v_mfma_f32_16x16x32_bf16 v[32:35], a[96:99], a[68:71], v[32:35]
  ds_read_b64_tr_b16 a[88:89], v236 offset:16384
  v_mfma_f32_16x16x32_bf16 v[32:35], a[100:103], a[76:79], v[32:35]
  buffer_load_dwordx4 a[52:55], v243, s[36:39], s8 offen offset:1024 sc1
  ds_read_b64_tr_b16 a[90:91], v236 offset:18432
  v_mfma_f32_16x16x32_bf16 v[28:31], a[100:103], a[72:75], v[28:31]
  ds_read_b64_tr_b16 a[92:93], v236 offset:20480
  s_waitcnt vmcnt(15)
  v_add_f32 v156, v156, v164
  v_mfma_f32_16x16x32_bf16 v[28:31], a[96:99], a[64:67], v[28:31]
  v_add_f32 v157, v157, v165
  v_add_f32 v158, v158, v166
  s_waitcnt lgkmcnt(11)
  v_mfma_f32_16x16x32_bf16 v[36:39], a[104:107], a[64:67], v[36:39]
  v_add_f32 v159, v159, v167
  v_add_f32 v160, v160, v168
  v_add_f32 v161, v161, v169
  v_mfma_f32_16x16x32_bf16 v[36:39], a[108:111], a[72:75], v[36:39]
  v_add_f32 v162, v162, v170
  v_add_f32 v163, v163, v171
  v_add_f32 v156, v156, v160
  v_mfma_f32_16x16x32_bf16 v[40:43], a[108:111], a[76:79], v[40:43]
  v_add_f32 v157, v157, v161
  v_add_f32 v158, v158, v162
  v_add_f32 v159, v159, v163
  v_mfma_f32_16x16x32_bf16 v[40:43], a[104:107], a[68:71], v[40:43]
  v_cvt_pk_bf16_f32 v160, v156, v157
  v_lshlrev_b32 v156, 16, v160
  s_waitcnt lgkmcnt(7)
  v_mfma_f32_16x16x32_bf16 v[48:51], a[112:115], a[68:71], v[48:51]
  v_and_b32 v157, 0xffff0000, v160
  v_cvt_pk_bf16_f32 v161, v158, v159
  v_lshlrev_b32 v158, 16, v161
  v_mfma_f32_16x16x32_bf16 v[48:51], a[116:119], a[76:79], v[48:51]
  v_and_b32 v159, 0xffff0000, v161
  v_add_f32 v156, v13, v156
  v_add_f32 v157, v13, v157
  v_mfma_f32_16x16x32_bf16 v[44:47], a[116:119], a[72:75], v[44:47]
  v_add_f32 v158, v13, v158
  v_add_f32 v159, v13, v159
  v_cvt_pk_bf16_f32 v160, v156, v157
  v_mfma_f32_16x16x32_bf16 v[44:47], a[112:115], a[64:67], v[44:47]
  v_lshlrev_b32 v156, 16, v160
  v_and_b32 v157, 0xffff0000, v160
  s_waitcnt vmcnt(10) lgkmcnt(3)
  v_mfma_f32_16x16x32_bf16 v[20:23], a[80:83], a[0:3], v[20:23]
  v_cvt_pk_bf16_f32 v161, v158, v159
  v_lshlrev_b32 v158, 16, v161
  v_and_b32 v159, 0xffff0000, v161
  v_mfma_f32_16x16x32_bf16 v[20:23], a[84:87], a[8:11], v[20:23]
  ds_write_b128 v246, v[156:159]
  ds_read_b128 v[84:87], v244 offset:0
  ds_read_b128 v[100:103], v244 offset:512
  v_mfma_f32_16x16x32_bf16 v[24:27], a[84:87], a[12:15], v[24:27]
  ds_read_b128 v[88:91], v244 offset:64
  ds_read_b128 v[104:107], v244 offset:576
  ds_read_b128 v[92:95], v244 offset:128
  v_mfma_f32_16x16x32_bf16 v[24:27], a[80:83], a[4:7], v[24:27]
  ds_read_b64_tr_b16 a[94:95], v236 offset:22528
  ds_read_b128 v[108:111], v244 offset:640
  s_waitcnt lgkmcnt(1)
  v_mfma_f32_16x16x32_bf16 v[32:35], a[88:91], a[4:7], v[32:35]
  ds_read_b128 v[96:99], v244 offset:192
  ds_read_b128 v[112:115], v244 offset:704
  ds_read_b128 v[116:119], v245 offset:512
  v_mfma_f32_16x16x32_bf16 v[32:35], a[92:95], a[12:15], v[32:35]
  ds_read_b128 v[120:123], v245 offset:576
  ds_read_b128 v[124:127], v245 offset:640
  ds_read_b128 v[128:131], v245 offset:704
  v_mfma_f32_16x16x32_bf16 v[28:31], a[92:95], a[8:11], v[28:31]
  v_accvgpr_write_b32 a248, v156
  v_accvgpr_write_b32 a249, v157
  v_accvgpr_write_b32 a250, v158
  v_mfma_f32_16x16x32_bf16 v[28:31], a[88:91], a[0:3], v[28:31]
  ds_read_b64_tr_b16 a[96:97], v237 offset:16384
  ds_read_b64_tr_b16 a[98:99], v237 offset:18432
  ds_read_b64_tr_b16 a[100:101], v237 offset:20480
  ds_read_b64_tr_b16 a[102:103], v237 offset:22528
  s_waitcnt lgkmcnt(0)
  v_mfma_f32_16x16x32_bf16 v[36:39], a[96:99], a[0:3], v[36:39]
  v_accvgpr_write_b32 a251, v159
  s_waitcnt lgkmcnt(4)
  v_cvt_pk_bf16_f32 v148, v116, v117
  v_mfma_f32_16x16x32_bf16 v[36:39], a[100:103], a[8:11], v[36:39]
  v_cvt_pk_bf16_f32 v149, v118, v119
  v_cvt_pk_bf16_f32 v150, v120, v121
  v_cvt_pk_bf16_f32 v151, v122, v123
  v_mfma_f32_16x16x32_bf16 v[40:43], a[100:103], a[12:15], v[40:43]
  v_cvt_pk_bf16_f32 v152, v124, v125
  v_cvt_pk_bf16_f32 v153, v126, v127
  v_cvt_pk_bf16_f32 v154, v128, v129
  v_mfma_f32_16x16x32_bf16 v[40:43], a[96:99], a[4:7], v[40:43]
  ds_read_b64_tr_b16 a[104:105], v238 offset:16384
  ds_read_b64_tr_b16 a[106:107], v238 offset:18432
  ds_read_b64_tr_b16 a[108:109], v238 offset:20480
  ds_read_b64_tr_b16 a[110:111], v238 offset:22528
  s_waitcnt lgkmcnt(0)
  v_mfma_f32_16x16x32_bf16 v[48:51], a[104:107], a[4:7], v[48:51]
  v_cvt_pk_bf16_f32 v155, v130, v131
  buffer_store_dwordx4 v[148:151], v0, s[36:39], s79 offen offset:0 sc1
  buffer_store_dwordx4 v[152:155], v0, s[36:39], s79 offen offset:1024 sc1
  v_mfma_f32_16x16x32_bf16 v[48:51], a[108:111], a[12:15], v[48:51]
  buffer_load_dwordx4 a[56:59], v243, s[36:39], s8 offen offset:2048 sc1
  buffer_load_dwordx4 a[60:63], v243, s[36:39], s8 offen offset:3072 sc1
  s_add_u32 s8, s8, 4096
  v_mfma_f32_16x16x32_bf16 v[44:47], a[108:111], a[8:11], v[44:47]
  s_and_b32 s8, s8, 0xffff
  ds_read_b64_tr_b16 a[112:113], v235 offset:24576
  buffer_load_dwordx4 a[64:67], v243, s[36:39], s8 offen offset:0 sc1
  v_mfma_f32_16x16x32_bf16 v[44:47], a[104:107], a[0:3], v[44:47]
  ds_read_b64_tr_b16 a[114:115], v235 offset:26624
  ds_read_b64_tr_b16 a[116:117], v235 offset:28672
  ds_read_b64_tr_b16 a[118:119], v235 offset:30720
  s_waitcnt vmcnt(11) lgkmcnt(0)
  v_mfma_f32_16x16x32_bf16 v[20:23], a[112:115], a[16:19], v[20:23]
  ds_read_b64_tr_b16 a[80:81], v236 offset:24576
  buffer_load_dwordx4 a[68:71], v243, s[36:39], s8 offen offset:1024 sc1
  ds_read_b64_tr_b16 a[82:83], v236 offset:26624
  v_mfma_f32_16x16x32_bf16 v[20:23], a[116:119], a[24:27], v[20:23]
  ds_read_b64_tr_b16 a[84:85], v236 offset:28672
  ds_read_b64_tr_b16 a[86:87], v236 offset:30720
  ds_read_b64_tr_b16 a[88:89], v237 offset:24576
  v_mfma_f32_16x16x32_bf16 v[24:27], a[116:119], a[28:31], v[24:27]
  buffer_load_dwordx4 a[72:75], v243, s[36:39], s8 offen offset:2048 sc1
  ds_read_b64_tr_b16 a[90:91], v237 offset:26624
  ds_read_b64_tr_b16 a[92:93], v237 offset:28672
  v_mfma_f32_16x16x32_bf16 v[24:27], a[112:115], a[20:23], v[24:27]
  ds_read_b64_tr_b16 a[94:95], v237 offset:30720
  ds_read_b64_tr_b16 a[96:97], v238 offset:24576
  s_waitcnt lgkmcnt(5)
  v_mfma_f32_16x16x32_bf16 v[32:35], a[80:83], a[20:23], v[32:35]
  buffer_load_dwordx4 a[76:79], v243, s[36:39], s8 offen offset:3072 sc1
  ds_read_b64_tr_b16 a[98:99], v238 offset:26624
  ds_read_b64_tr_b16 a[100:101], v238 offset:28672
  v_mfma_f32_16x16x32_bf16 v[32:35], a[84:87], a[28:31], v[32:35]
  ds_read_b64_tr_b16 a[102:103], v238 offset:30720
  s_add_u32 s8, s8, 4096
  s_and_b32 s8, s8, 0xffff
  v_mfma_f32_16x16x32_bf16 v[28:31], a[84:87], a[24:27], v[28:31]
  ds_read_b64_tr_b16 a[104:105], v235 offset:32768
  buffer_load_dwordx4 a[0:3], v243, s[36:39], s8 offen offset:0 sc1
  ds_read_b64_tr_b16 a[106:107], v235 offset:34816
  v_mfma_f32_16x16x32_bf16 v[28:31], a[80:83], a[16:19], v[28:31]
  ds_read_b64_tr_b16 a[108:109], v235 offset:36864
CT8:
  s_add_u32 s94, s92, CT8-k3_main_kernel+3072
  s_addc_u32 s95, s93, 0
  s_waitcnt lgkmcnt(7)
  v_mfma_f32_16x16x32_bf16 v[36:39], a[88:91], a[16:19], v[36:39]
  global_load_dword a252, v0, s[94:95]
  ds_read_b64_tr_b16 a[110:111], v235 offset:38912
  ds_read_b64_tr_b16 a[112:113], v236 offset:32768
  v_mfma_f32_16x16x32_bf16 v[36:39], a[92:95], a[24:27], v[36:39]
  buffer_load_dwordx4 a[4:7], v243, s[36:39], s8 offen offset:1024 sc1
  ds_read_b64_tr_b16 a[114:115], v236 offset:34816
  ds_read_b64_tr_b16 a[116:117], v236 offset:36864
  v_mfma_f32_16x16x32_bf16 v[40:43], a[92:95], a[28:31], v[40:43]
  ds_read_b64_tr_b16 a[118:119], v236 offset:38912
  ds_read_b64_tr_b16 a[80:81], v237 offset:32768
  buffer_load_dwordx4 a[8:11], v243, s[36:39], s8 offen offset:2048 sc1
  v_mfma_f32_16x16x32_bf16 v[40:43], a[88:91], a[20:23], v[40:43]
  ds_read_b64_tr_b16 a[82:83], v237 offset:34816
  ds_read_b64_tr_b16 a[84:85], v237 offset:36864
  s_waitcnt lgkmcnt(11)
  v_mfma_f32_16x16x32_bf16 v[48:51], a[96:99], a[20:23], v[48:51]
  ds_read_b64_tr_b16 a[86:87], v237 offset:38912
  ds_read_b64_tr_b16 a[88:89], v238 offset:32768
  v_mfma_f32_16x16x32_bf16 v[48:51], a[100:103], a[28:31], v[48:51]
  buffer_load_dwordx4 a[12:15], v243, s[36:39], s8 offen offset:3072 sc1
  ds_read_b64_tr_b16 a[90:91], v238 offset:34816
  v_mfma_f32_16x16x32_bf16 v[44:47], a[100:103], a[24:27], v[44:47]
  ds_read_b64_tr_b16 a[92:93], v238 offset:36864
  v_mfma_f32_16x16x32_bf16 v[44:47], a[96:99], a[16:19], v[44:47]
  ds_read_b64_tr_b16 a[94:95], v238 offset:38912
  s_waitcnt vmcnt(15) lgkmcnt(12)
  v_mfma_f32_16x16x32_bf16 v[20:23], a[104:107], a[32:35], v[20:23]
  ds_read_b64_tr_b16 a[96:97], v235 offset:40960
  v_mfma_f32_16x16x32_bf16 v[20:23], a[108:111], a[40:43], v[20:23]
  ds_read_b64_tr_b16 a[98:99], v235 offset:43008
  v_mfma_f32_16x16x32_bf16 v[24:27], a[108:111], a[44:47], v[24:27]
  ds_read_b64_tr_b16 a[100:101], v235 offset:45056
  v_mfma_f32_16x16x32_bf16 v[24:27], a[104:107], a[36:39], v[24:27]
  ds_read_b64_tr_b16 a[102:103], v235 offset:47104
  s_waitcnt lgkmcnt(12)
  v_mfma_f32_16x16x32_bf16 v[32:35], a[112:115], a[36:39], v[32:35]
  ds_read_b64_tr_b16 a[104:105], v236 offset:40960
  v_mfma_f32_16x16x32_bf16 v[32:35], a[116:119], a[44:47], v[32:35]
  ds_read_b64_tr_b16 a[106:107], v236 offset:43008
  v_mfma_f32_16x16x32_bf16 v[28:31], a[116:119], a[40:43], v[28:31]
  ds_read_b64_tr_b16 a[108:109], v236 offset:45056
  v_mfma_f32_16x16x32_bf16 v[28:31], a[112:115], a[32:35], v[28:31]
  ds_read_b64_tr_b16 a[110:111], v236 offset:47104
  s_waitcnt lgkmcnt(12)
  v_mfma_f32_16x16x32_bf16 v[36:39], a[80:83], a[32:35], v[36:39]
  ds_read_b64_tr_b16 a[112:113], v237 offset:40960
  v_mfma_f32_16x16x32_bf16 v[36:39], a[84:87], a[40:43], v[36:39]
  ds_read_b64_tr_b16 a[114:115], v237 offset:43008
  v_mfma_f32_16x16x32_bf16 v[40:43], a[84:87], a[44:47], v[40:43]
  ds_read_b64_tr_b16 a[116:117], v237 offset:45056
  v_mfma_f32_16x16x32_bf16 v[40:43], a[80:83], a[36:39], v[40:43]
  ds_read_b64_tr_b16 a[118:119], v237 offset:47104
  s_waitcnt lgkmcnt(12)
  v_mfma_f32_16x16x32_bf16 v[48:51], a[88:91], a[36:39], v[48:51]
  ds_read_b64_tr_b16 a[80:81], v238 offset:40960
  v_mfma_f32_16x16x32_bf16 v[48:51], a[92:95], a[44:47], v[48:51]
  ds_read_b64_tr_b16 a[82:83], v238 offset:43008
  v_mfma_f32_16x16x32_bf16 v[44:47], a[92:95], a[40:43], v[44:47]
  ds_read_b64_tr_b16 a[84:85], v238 offset:45056
  v_mfma_f32_16x16x32_bf16 v[44:47], a[88:91], a[32:35], v[44:47]
  ds_read_b64_tr_b16 a[86:87], v238 offset:47104
  s_waitcnt vmcnt(9) lgkmcnt(12)
  v_mfma_f32_16x16x32_bf16 v[20:23], a[96:99], a[48:51], v[20:23]
  ds_read_b64_tr_b16 a[88:89], v235 offset:49152
  v_mfma_f32_16x16x32_bf16 v[20:23], a[100:103], a[56:59], v[20:23]
  ds_read_b64_tr_b16 a[90:91], v235 offset:51200
  v_mfma_f32_16x16x32_bf16 v[24:27], a[100:103], a[60:63], v[24:27]
  ds_read_b64_tr_b16 a[92:93], v235 offset:53248
  v_mfma_f32_16x16x32_bf16 v[24:27], a[96:99], a[52:55], v[24:27]
  ds_read_b64_tr_b16 a[94:95], v235 offset:55296
  s_waitcnt lgkmcnt(12)
  v_mfma_f32_16x16x32_bf16 v[32:35], a[104:107], a[52:55], v[32:35]
  ds_read_b64_tr_b16 a[96:97], v236 offset:49152
  v_mfma_f32_16x16x32_bf16 v[32:35], a[108:111], a[60:63], v[32:35]
  ds_read_b64_tr_b16 a[98:99], v236 offset:51200
  v_mfma_f32_16x16x32_bf16 v[28:31], a[108:111], a[56:59], v[28:31]
  ds_read_b64_tr_b16 a[100:101], v236 offset:53248
  v_mfma_f32_16x16x32_bf16 v[28:31], a[104:107], a[48:51], v[28:31]
  ds_read_b64_tr_b16 a[102:103], v236 offset:55296
  s_waitcnt lgkmcnt(12)
  v_mfma_f32_16x16x32_bf16 v[36:39], a[112:115], a[48:51], v[36:39]
  ds_read_b64_tr_b16 a[104:105], v237 offset:49152
  v_mfma_f32_16x16x32_bf16 v[36:39], a[116:119], a[56:59], v[36:39]
  ds_read_b64_tr_b16 a[106:107], v237 offset:51200
  v_mfma_f32_16x16x32_bf16 v[40:43], a[116:119], a[60:63], v[40:43]
  ds_read_b64_tr_b16 a[108:109], v237 offset:53248
  v_mfma_f32_16x16x32_bf16 v[40:43], a[112:115], a[52:55], v[40:43]
  ds_read_b64_tr_b16 a[110:111], v237 offset:55296
  s_waitcnt lgkmcnt(12)
  v_mfma_f32_16x16x32_bf16 v[48:51], a[80:83], a[52:55], v[48:51]
  ds_read_b64_tr_b16 a[112:113], v238 offset:49152
  v_mfma_f32_16x16x32_bf16 v[48:51], a[84:87], a[60:63], v[48:51]
  ds_read_b64_tr_b16 a[114:115], v238 offset:51200
  v_mfma_f32_16x16x32_bf16 v[44:47], a[84:87], a[56:59], v[44:47]
  ds_read_b64_tr_b16 a[116:117], v238 offset:53248
  v_mfma_f32_16x16x32_bf16 v[44:47], a[80:83], a[48:51], v[44:47]
  ds_read_b64_tr_b16 a[118:119], v238 offset:55296
  s_waitcnt vmcnt(5) lgkmcnt(12)
  v_mfma_f32_16x16x32_bf16 v[20:23], a[88:91], a[64:67], v[20:23]
  ds_read_b64_tr_b16 a[80:81], v235 offset:57344
  v_mfma_f32_16x16x32_bf16 v[20:23], a[92:95], a[72:75], v[20:23]
  ds_read_b64_tr_b16 a[82:83], v235 offset:59392
  v_mfma_f32_16x16x32_bf16 v[24:27], a[92:95], a[76:79], v[24:27]
  ds_read_b64_tr_b16 a[84:85], v235 offset:61440
  v_mfma_f32_16x16x32_bf16 v[24:27], a[88:91], a[68:71], v[24:27]
  ds_read_b64_tr_b16 a[86:87], v235 offset:63488
  s_waitcnt lgkmcnt(12)
  v_mfma_f32_16x16x32_bf16 v[32:35], a[96:99], a[68:71], v[32:35]
  ds_read_b64_tr_b16 a[88:89], v236 offset:57344
  v_mfma_f32_16x16x32_bf16 v[32:35], a[100:103], a[76:79], v[32:35]
  ds_read_b64_tr_b16 a[90:91], v236 offset:59392
  v_mfma_f32_16x16x32_bf16 v[28:31], a[100:103], a[72:75], v[28:31]
  ds_read_b64_tr_b16 a[92:93], v236 offset:61440
  v_mfma_f32_16x16x32_bf16 v[28:31], a[96:99], a[64:67], v[28:31]
  ds_read_b64_tr_b16 a[94:95], v236 offset:63488
  s_waitcnt lgkmcnt(12)
  v_mfma_f32_16x16x32_bf16 v[36:39], a[104:107], a[64:67], v[36:39]
  ds_read_b64_tr_b16 a[96:97], v237 offset:57344
  v_mfma_f32_16x16x32_bf16 v[36:39], a[108:111], a[72:75], v[36:39]
  ds_read_b64_tr_b16 a[98:99], v237 offset:59392
  v_mfma_f32_16x16x32_bf16 v[40:43], a[108:111], a[76:79], v[40:43]
  ds_read_b64_tr_b16 a[100:101], v237 offset:61440
  v_mfma_f32_16x16x32_bf16 v[40:43], a[104:107], a[68:71], v[40:43]
  ds_read_b64_tr_b16 a[102:103], v237 offset:63488
  s_waitcnt lgkmcnt(12)
  v_mfma_f32_16x16x32_bf16 v[48:51], a[112:115], a[68:71], v[48:51]
  ds_read_b64_tr_b16 a[104:105], v238 offset:57344
  v_mfma_f32_16x16x32_bf16 v[48:51], a[116:119], a[76:79], v[48:51]
  ds_read_b64_tr_b16 a[106:107], v238 offset:59392
  v_mfma_f32_16x16x32_bf16 v[44:47], a[116:119], a[72:75], v[44:47]
  ds_read_b64_tr_b16 a[108:109], v238 offset:61440
  v_mfma_f32_16x16x32_bf16 v[44:47], a[112:115], a[64:67], v[44:47]
  ds_read_b64_tr_b16 a[110:111], v238 offset:63488
  s_waitcnt vmcnt(0) lgkmcnt(12)
  v_mfma_f32_16x16x32_bf16 v[20:23], a[80:83], a[0:3], v[20:23]
  v_mfma_f32_16x16x32_bf16 v[20:23], a[84:87], a[8:11], v[20:23]
  v_mfma_f32_16x16x32_bf16 v[24:27], a[84:87], a[12:15], v[24:27]
  v_mfma_f32_16x16x32_bf16 v[24:27], a[80:83], a[4:7], v[24:27]
  s_waitcnt lgkmcnt(8)
  v_mfma_f32_16x16x32_bf16 v[32:35], a[88:91], a[4:7], v[32:35]
  v_mfma_f32_16x16x32_bf16 v[32:35], a[92:95], a[12:15], v[32:35]
  v_mfma_f32_16x16x32_bf16 v[28:31], a[92:95], a[8:11], v[28:31]
  v_mfma_f32_16x16x32_bf16 v[28:31], a[88:91], a[0:3], v[28:31]
  s_waitcnt lgkmcnt(4)
  v_mfma_f32_16x16x32_bf16 v[36:39], a[96:99], a[0:3], v[36:39]
  v_mfma_f32_16x16x32_bf16 v[36:39], a[100:103], a[8:11], v[36:39]
  v_mfma_f32_16x16x32_bf16 v[40:43], a[100:103], a[12:15], v[40:43]
  v_mfma_f32_16x16x32_bf16 v[40:43], a[96:99], a[4:7], v[40:43]
  s_waitcnt lgkmcnt(0)
  v_mfma_f32_16x16x32_bf16 v[48:51], a[104:107], a[4:7], v[48:51]
  v_mfma_f32_16x16x32_bf16 v[48:51], a[108:111], a[12:15], v[48:51]
  v_mfma_f32_16x16x32_bf16 v[44:47], a[108:111], a[8:11], v[44:47]
  v_mfma_f32_16x16x32_bf16 v[44:47], a[104:107], a[0:3], v[44:47]
  s_waitcnt lgkmcnt(0)
  s_nop 2
  v_fmac_f32 v52, v84, v20
  v_fmac_f32 v53, v85, v21
  v_fmac_f32 v54, v86, v22
  v_fmac_f32 v55, v87, v23
  v_mul_f32 v20, v52, v100
  v_mul_f32 v21, v53, v101
  v_mul_f32 v22, v54, v102
  v_mul_f32 v23, v55, v103
  v_cvt_pk_bf16_f32 v132, v20, v21
  v_cvt_pk_bf16_f32 v133, v22, v23
  v_fmac_f32 v56, v88, v28
  v_fmac_f32 v57, v89, v29
  v_fmac_f32 v58, v90, v30
  v_fmac_f32 v59, v91, v31
  v_mul_f32 v28, v56, v104
  v_mul_f32 v29, v57, v105
  v_mul_f32 v30, v58, v106
  v_mul_f32 v31, v59, v107
  v_cvt_pk_bf16_f32 v134, v28, v29
  v_cvt_pk_bf16_f32 v135, v30, v31
  buffer_store_dwordx4 v[132:135], v0, s[36:39], s77 offen offset:0 sc1
  v_fmac_f32 v60, v92, v36
  v_fmac_f32 v61, v93, v37
  v_fmac_f32 v62, v94, v38
  v_fmac_f32 v63, v95, v39
  v_mul_f32 v36, v60, v108
  v_mul_f32 v37, v61, v109
  v_mul_f32 v38, v62, v110
  v_mul_f32 v39, v63, v111
  v_cvt_pk_bf16_f32 v136, v36, v37
  v_cvt_pk_bf16_f32 v137, v38, v39
  v_fmac_f32 v64, v96, v44
  v_fmac_f32 v65, v97, v45
  v_fmac_f32 v66, v98, v46
  v_fmac_f32 v67, v99, v47
  v_mul_f32 v44, v64, v112
  v_mul_f32 v45, v65, v113
  v_mul_f32 v46, v66, v114
  v_mul_f32 v47, v67, v115
  v_cvt_pk_bf16_f32 v138, v44, v45
  v_cvt_pk_bf16_f32 v139, v46, v47
  buffer_store_dwordx4 v[136:139], v0, s[36:39], s9 offen offset:0 sc1
  v_fmac_f32 v68, v84, v24
  v_fmac_f32 v69, v85, v25
  v_fmac_f32 v70, v86, v26
  v_fmac_f32 v71, v87, v27
  v_mul_f32 v24, v68, v100
  v_mul_f32 v25, v69, v101
  v_mul_f32 v26, v70, v102
  v_mul_f32 v27, v71, v103
  v_cvt_pk_bf16_f32 v140, v24, v25
  v_cvt_pk_bf16_f32 v141, v26, v27
  v_fmac_f32 v72, v88, v32
  v_fmac_f32 v73, v89, v33
  v_fmac_f32 v74, v90, v34
  v_fmac_f32 v75, v91, v35
  v_mul_f32 v32, v72, v104
  v_mul_f32 v33, v73, v105
  v_mul_f32 v34, v74, v106
  v_mul_f32 v35, v75, v107
  v_cvt_pk_bf16_f32 v142, v32, v33
  v_cvt_pk_bf16_f32 v143, v34, v35
  buffer_store_dwordx4 v[140:143], v0, s[36:39], s77 offen offset:1024 sc1
  v_fmac_f32 v76, v92, v40
  v_fmac_f32 v77, v93, v41
  v_fmac_f32 v78, v94, v42
  v_fmac_f32 v79, v95, v43
  v_mul_f32 v40, v76, v108
  v_mul_f32 v41, v77, v109
  v_mul_f32 v42, v78, v110
  v_mul_f32 v43, v79, v111
  v_cvt_pk_bf16_f32 v144, v40, v41
  v_cvt_pk_bf16_f32 v145, v42, v43
  v_fmac_f32 v80, v96, v48
  v_fmac_f32 v81, v97, v49
  v_fmac_f32 v82, v98, v50
  v_fmac_f32 v83, v99, v51
  v_mul_f32 v48, v80, v112
  v_mul_f32 v49, v81, v113
  v_mul_f32 v50, v82, v114
  v_mul_f32 v51, v83, v115
  v_cvt_pk_bf16_f32 v146, v48, v49
  v_cvt_pk_bf16_f32 v147, v50, v51
  buffer_store_dwordx4 v[144:147], v0, s[36:39], s9 offen offset:1024 sc1
  v_add_f32 v20, v52, v53
  v_mul_f32 v21, v52, v52
  v_add_f32 v24, v54, v55
  v_mul_f32 v25, v53, v53
  v_fmac_f32 v21, v54, v54
  v_fmac_f32 v25, v55, v55
  v_fmac_f32 v21, v56, v56
  v_add_f32 v20, v20, v56
  v_fmac_f32 v25, v57, v57
  v_add_f32 v24, v24, v57
  v_fmac_f32 v21, v58, v58
  v_add_f32 v20, v20, v58
  v_fmac_f32 v25, v59, v59
  v_add_f32 v24, v24, v59
  v_fmac_f32 v21, v60, v60
  v_add_f32 v20, v20, v60
  v_fmac_f32 v25, v61, v61
  v_add_f32 v24, v24, v61
  v_fmac_f32 v21, v62, v62
  v_add_f32 v20, v20, v62
  v_fmac_f32 v25, v63, v63
  v_add_f32 v24, v24, v63
  v_fmac_f32 v21, v64, v64
  v_add_f32 v20, v20, v64
  v_fmac_f32 v25, v65, v65
  v_add_f32 v24, v24, v65
  v_fmac_f32 v21, v66, v66
  v_add_f32 v20, v20, v66
  v_fmac_f32 v25, v67, v67
  v_add_f32 v24, v24, v67
  v_add_f32 v22, v68, v69
  v_mul_f32 v23, v68, v68
  v_add_f32 v26, v70, v71
  v_mul_f32 v27, v69, v69
  v_fmac_f32 v23, v70, v70
  v_fmac_f32 v27, v71, v71
  v_fmac_f32 v23, v72, v72
  v_add_f32 v22, v22, v72
  v_fmac_f32 v27, v73, v73
  v_add_f32 v26, v26, v73
  v_fmac_f32 v23, v74, v74
  v_add_f32 v22, v22, v74
  v_fmac_f32 v27, v75, v75
  v_add_f32 v26, v26, v75
  v_fmac_f32 v23, v76, v76
  v_add_f32 v22, v22, v76
  v_fmac_f32 v27, v77, v77
  v_add_f32 v26, v26, v77
  v_fmac_f32 v23, v78, v78
  v_add_f32 v22, v22, v78
  v_fmac_f32 v27, v79, v79
  v_add_f32 v26, v26, v79
  v_fmac_f32 v23, v80, v80
  v_add_f32 v22, v22, v80
  v_fmac_f32 v27, v81, v81
  v_add_f32 v26, v26, v81
  v_fmac_f32 v23, v82, v82
  v_add_f32 v22, v22, v82
  v_fmac_f32 v27, v83, v83
  v_add_f32 v26, v26, v83
  v_add_f32 v20, v20, v24
  v_add_f32 v21, v21, v25
  v_add_f32 v22, v22, v26
  v_add_f32 v23, v23, v27
  v_mov_b32 v24, v20
  v_mov_b32 v25, v21
  v_mov_b32 v26, v22
  v_mov_b32 v27, v23
  v_permlane16_swap_b32 v20, v24
  v_permlane16_swap_b32 v21, v25
  v_permlane16_swap_b32 v22, v26
  v_permlane16_swap_b32 v23, v27
  v_add_f32 v20, v20, v24
  v_add_f32 v21, v21, v25
  v_add_f32 v22, v22, v26
  v_add_f32 v23, v23, v27
  v_mov_b32 v24, v20
  v_mov_b32 v25, v21
  v_mov_b32 v26, v22
  v_mov_b32 v27, v23
  v_permlane32_swap_b32 v20, v24
  v_permlane32_swap_b32 v21, v25
  v_permlane32_swap_b32 v22, v26
  v_permlane32_swap_b32 v23, v27
  v_add_f32 v20, v20, v24
  v_add_f32 v21, v21, v25
  v_add_f32 v22, v22, v26
  v_add_f32 v23, v23, v27
  s_mov_b64 exec, 0xffff
  buffer_store_dwordx4 v[20:23], v0, s[36:39], s78 offen sc1
  s_mov_b64 exec, -1
  v_cvt_pk_bf16_f32 v116, v52, v53
  v_cvt_pk_bf16_f32 v117, v54, v55
  v_cvt_pk_bf16_f32 v118, v56, v57
  v_cvt_pk_bf16_f32 v119, v58, v59
  v_cvt_pk_bf16_f32 v120, v60, v61
  v_cvt_pk_bf16_f32 v121, v62, v63
  v_cvt_pk_bf16_f32 v122, v64, v65
  v_cvt_pk_bf16_f32 v123, v66, v67
  v_cvt_pk_bf16_f32 v124, v68, v69
  v_cvt_pk_bf16_f32 v125, v70, v71
  v_cvt_pk_bf16_f32 v126, v72, v73
  v_cvt_pk_bf16_f32 v127, v74, v75
  v_cvt_pk_bf16_f32 v128, v76, v77
  v_cvt_pk_bf16_f32 v129, v78, v79
  v_cvt_pk_bf16_f32 v130, v80, v81
  v_cvt_pk_bf16_f32 v131, v82, v83
  v_accvgpr_write_b32 a232, v116
  v_accvgpr_write_b32 a233, v117
  v_accvgpr_write_b32 a234, v118
  v_accvgpr_write_b32 a235, v119
  v_accvgpr_write_b32 a236, v120
  v_accvgpr_write_b32 a237, v121
  v_accvgpr_write_b32 a238, v122
  v_accvgpr_write_b32 a239, v123
  v_accvgpr_write_b32 a240, v124
  v_accvgpr_write_b32 a241, v125
  v_accvgpr_write_b32 a242, v126
  v_accvgpr_write_b32 a243, v127
  v_accvgpr_write_b32 a244, v128
  v_accvgpr_write_b32 a245, v129
  v_accvgpr_write_b32 a246, v130
  v_accvgpr_write_b32 a247, v131
  v_mov_b32 v12, 1
  s_waitcnt vmcnt(0) lgkmcnt(0)
  s_barrier
  s_mov_b64 exec, 1
  buffer_store_dword v12, v0, s[36:39], s45 offen sc1
  s_mov_b64 exec, -1
  s_bfe_u32 s10, s82, 0x40000
  s_mul_i32 s10, s10, 458752
  s_add_u32 m0, s84, 0
  s_nop 0
  buffer_load_dwordx4 v3, s[16:19], s10 offen offset:0 lds
  buffer_load_dwordx4 v4, s[16:19], s10 offen offset:1024 lds
  buffer_load_dwordx4 v5, s[16:19], s10 offen offset:2048 lds
  buffer_load_dwordx4 v6, s[16:19], s10 offen offset:3072 lds
  s_add_u32 m0, s84, 4096
  s_nop 0
  buffer_load_dwordx4 v7, s[16:19], s10 offen offset:0 lds
  buffer_load_dwordx4 v8, s[16:19], s10 offen offset:1024 lds
  buffer_load_dwordx4 v9, s[16:19], s10 offen offset:2048 lds
  s_bfe_u32 s10, s82, 0x40004
  s_mul_i32 s10, s10, 458752
  s_add_u32 m0, s84, 28672
  s_nop 0
  buffer_load_dwordx4 v3, s[16:19], s10 offen offset:0 lds
  buffer_load_dwordx4 v4, s[16:19], s10 offen offset:1024 lds
  buffer_load_dwordx4 v5, s[16:19], s10 offen offset:2048 lds
  buffer_load_dwordx4 v6, s[16:19], s10 offen offset:3072 lds
  s_add_u32 m0, s84, 32768
  s_nop 0
  buffer_load_dwordx4 v7, s[16:19], s10 offen offset:0 lds
  buffer_load_dwordx4 v8, s[16:19], s10 offen offset:1024 lds
  buffer_load_dwordx4 v9, s[16:19], s10 offen offset:2048 lds
  s_bfe_u32 s11, s82, 0x40000
  s_lshl_b32 s11, s11, 13
  s_add_u32 s11, s11, s85
  s_cmp_lg_u32 s44, 0
  s_cbranch_scc1 SM9x
  s_mov_b32 s46, 60000
  s_mov_b32 s47, 5341184
SM9:
  buffer_load_dword v13, v250, s[36:39], s47 offen sc1
  s_sub_u32 s46, s46, 1
  s_cmp_eq_u32 s46, 0
  s_waitcnt vmcnt(0)
  s_cbranch_scc1 SM9x
  v_cmp_ne_u32 vcc, 1, v13
  s_nop 4
  s_cbranch_vccnz SM9
SM9x:
  s_waitcnt vmcnt(7)
  s_barrier
  buffer_load_dwordx4 a[0:3], v0, s[36:39], s11 offen offset:0 sc1
  buffer_load_dwordx4 a[4:7], v0, s[36:39], s11 offen offset:1024 sc1
  buffer_load_dwordx4 a[8:11], v0, s[36:39], s11 offen offset:2048 sc1
  buffer_load_dwordx4 a[12:15], v0, s[36:39], s11 offen offset:3072 sc1
  s_add_u32 s11, s11, 4096
  buffer_load_dwordx4 a[16:19], v0, s[36:39], s11 offen offset:0 sc1
  buffer_load_dwordx4 a[20:23], v0, s[36:39], s11 offen offset:1024 sc1
  buffer_load_dwordx4 a[24:27], v0, s[36:39], s11 offen offset:2048 sc1
  buffer_load_dwordx4 a[28:31], v0, s[36:39], s11 offen offset:3072 sc1
  ds_read_b64_tr_b16 a[128:129], v1 offset:0
  ds_read_b64_tr_b16 a[130:131], v1 offset:3584
  ds_read_b64_tr_b16 a[132:133], v1 offset:7168
  ds_read_b64_tr_b16 a[134:135], v1 offset:10752
  ds_read_b64_tr_b16 a[136:137], v1 offset:32
  ds_read_b64_tr_b16 a[138:139], v1 offset:3616
  ds_read_b64_tr_b16 a[140:141], v1 offset:7200
  ds_read_b64_tr_b16 a[142:143], v1 offset:10784
  s_waitcnt vmcnt(7) lgkmcnt(0)
  v_mfma_f32_16x16x32_bf16 v[32:35], a[128:131], a[0:3], 0
  ds_read_b64_tr_b16 a[144:145], v1 offset:64
  s_waitcnt vmcnt(3)
  v_mfma_f32_16x16x32_bf16 v[32:35], a[132:135], a[16:19], v[32:35]
  ds_read_b64_tr_b16 a[146:147], v1 offset:3648
  s_waitcnt vmcnt(2)
  v_mfma_f32_16x16x32_bf16 v[36:39], a[132:135], a[20:23], 0
  ds_read_b64_tr_b16 a[148:149], v1 offset:7232
  s_waitcnt vmcnt(6)
  v_mfma_f32_16x16x32_bf16 v[36:39], a[128:131], a[4:7], v[36:39]
  ds_read_b64_tr_b16 a[150:151], v1 offset:10816
  s_waitcnt vmcnt(5)
  v_mfma_f32_16x16x32_bf16 v[40:43], a[128:131], a[8:11], 0
  ds_read_b64_tr_b16 a[152:153], v1 offset:96
  s_waitcnt vmcnt(1)
  v_mfma_f32_16x16x32_bf16 v[40:43], a[132:135], a[24:27], v[40:43]
  ds_read_b64_tr_b16 a[154:155], v1 offset:3680
  s_waitcnt vmcnt(0)
  v_mfma_f32_16x16x32_bf16 v[44:47], a[132:135], a[28:31], 0
  ds_read_b64_tr_b16 a[156:157], v1 offset:7264
  s_waitcnt vmcnt(4)
  v_mfma_f32_16x16x32_bf16 v[44:47], a[128:131], a[12:15], v[44:47]
  ds_read_b64_tr_b16 a[158:159], v1 offset:10848
  s_bfe_u32 s11, s82, 0x40004
  v_mfma_f32_16x16x32_bf16 v[60:63], a[136:139], a[12:15], 0
  s_lshl_b32 s11, s11, 13
  s_add_u32 s11, s11, s85
  v_mfma_f32_16x16x32_bf16 v[60:63], a[140:143], a[28:31], v[60:63]
  buffer_load_dwordx4 a[32:35], v0, s[36:39], s11 offen offset:0 sc1
  ds_read_b64_tr_b16 a[160:161], v1 offset:128
  v_mfma_f32_16x16x32_bf16 v[56:59], a[140:143], a[24:27], 0
  ds_read_b64_tr_b16 a[162:163], v1 offset:3712
  ds_read_b64_tr_b16 a[164:165], v1 offset:7296
  v_mfma_f32_16x16x32_bf16 v[56:59], a[136:139], a[8:11], v[56:59]
  ds_read_b64_tr_b16 a[166:167], v1 offset:10880
  ds_read_b64_tr_b16 a[168:169], v1 offset:160
  v_mfma_f32_16x16x32_bf16 v[52:55], a[136:139], a[4:7], 0
  ds_read_b64_tr_b16 a[170:171], v1 offset:3744
  s_lshl_b32 s31, s40, 10
  v_mfma_f32_16x16x32_bf16 v[52:55], a[140:143], a[20:23], v[52:55]
  s_add_u32 s31, s31, 1835008
  ds_read_b64_tr_b16 a[172:173], v1 offset:7328
  v_mfma_f32_16x16x32_bf16 v[48:51], a[140:143], a[16:19], 0
  buffer_load_dwordx4 a[36:39], v0, s[36:39], s11 offen offset:1024 sc1
  ds_read_b64_tr_b16 a[174:175], v1 offset:10912
  v_mfma_f32_16x16x32_bf16 v[48:51], a[136:139], a[0:3], v[48:51]
  s_waitcnt lgkmcnt(8)
  v_mfma_f32_16x16x32_bf16 v[64:67], a[144:147], a[0:3], 0
  ds_read_b64_tr_b16 a[128:129], v1 offset:192
  v_mfma_f32_16x16x32_bf16 v[64:67], a[148:151], a[16:19], v[64:67]
  v_mfma_f32_16x16x32_bf16 v[68:71], a[148:151], a[20:23], 0
  ds_read_b64_tr_b16 a[130:131], v1 offset:3776
  v_mfma_f32_16x16x32_bf16 v[68:71], a[144:147], a[4:7], v[68:71]
  buffer_load_dwordx4 a[40:43], v0, s[36:39], s11 offen offset:2048 sc1
  v_mfma_f32_16x16x32_bf16 v[72:75], a[144:147], a[8:11], 0
  ds_read_b64_tr_b16 a[132:133], v1 offset:7360
CT10:
  s_add_u32 s94, s92, CT10-k3_main_kernel+3072
  s_addc_u32 s95, s93, 0
  v_mfma_f32_16x16x32_bf16 v[72:75], a[148:151], a[24:27], v[72:75]
  v_mfma_f32_16x16x32_bf16 v[76:79], a[148:151], a[28:31], 0
  ds_read_b64_tr_b16 a[134:135], v1 offset:10944
  v_mfma_f32_16x16x32_bf16 v[76:79], a[144:147], a[12:15], v[76:79]
  v_mfma_f32_16x16x32_bf16 v[92:95], a[152:155], a[12:15], 0
  buffer_load_dwordx4 a[44:47], v0, s[36:39], s11 offen offset:3072 sc1
  s_bfe_u32 s10, s82, 0x40008
  v_mfma_f32_16x16x32_bf16 v[92:95], a[156:159], a[28:31], v[92:95]
  s_mul_i32 s10, s10, 458752
  s_add_u32 m0, s84, 57344
  v_mfma_f32_16x16x32_bf16 v[88:91], a[156:159], a[24:27], 0
  ds_read_b64_tr_b16 a[136:137], v1 offset:14336
  ds_read_b64_tr_b16 a[138:139], v1 offset:17920
  v_mfma_f32_16x16x32_bf16 v[88:91], a[152:155], a[8:11], v[88:91]
  v_mfma_f32_16x16x32_bf16 v[84:87], a[152:155], a[4:7], 0
  ds_read_b64_tr_b16 a[140:141], v1 offset:21504
  v_mfma_f32_16x16x32_bf16 v[84:87], a[156:159], a[20:23], v[84:87]
  buffer_load_dwordx4 v3, s[16:19], s10 offen offset:0 lds
  s_add_u32 s11, s11, 4096
  v_mfma_f32_16x16x32_bf16 v[80:83], a[156:159], a[16:19], 0
  ds_read_b64_tr_b16 a[142:143], v1 offset:25088
  v_mfma_f32_16x16x32_bf16 v[80:83], a[152:155], a[0:3], v[80:83]
  s_waitcnt lgkmcnt(8)
  v_mfma_f32_16x16x32_bf16 v[96:99], a[160:163], a[0:3], 0
  ds_read_b64_tr_b16 a[144:145], v1 offset:14368
  v_mfma_f32_16x16x32_bf16 v[96:99], a[164:167], a[16:19], v[96:99]
  v_mfma_f32_16x16x32_bf16 v[100:103], a[164:167], a[20:23], 0
  buffer_load_dwordx4 a[48:51], v0, s[36:39], s11 offen offset:0 sc1
  ds_read_b64_tr_b16 a[146:147], v1 offset:17952
  v_mfma_f32_16x16x32_bf16 v[100:103], a[160:163], a[4:7], v[100:103]
  v_mfma_f32_16x16x32_bf16 v[104:107], a[160:163], a[8:11], 0
  ds_read_b64_tr_b16 a[148:149], v1 offset:21536
  v_mfma_f32_16x16x32_bf16 v[104:107], a[164:167], a[24:27], v[104:107]
  v_mfma_f32_16x16x32_bf16 v[108:111], a[164:167], a[28:31], 0
  ds_read_b64_tr_b16 a[150:151], v1 offset:25120
  v_mfma_f32_16x16x32_bf16 v[108:111], a[160:163], a[12:15], v[108:111]
  buffer_load_dwordx4 v4, s[16:19], s10 offen offset:1024 lds
  v_mfma_f32_16x16x32_bf16 v[124:127], a[168:171], a[12:15], 0
  s_bfe_u32 s20, s82, 0x40018
  s_lshl4_add_u32 s20, s56, s20
  v_mfma_f32_16x16x32_bf16 v[124:127], a[172:175], a[28:31], v[124:127]
  s_lshl_b32 s20, s20, 11
  s_add_u32 s20, s20, 5767168
  v_mfma_f32_16x16x32_bf16 v[120:123], a[172:175], a[24:27], 0
  ds_read_b64_tr_b16 a[152:153], v1 offset:14400
  ds_read_b64_tr_b16 a[154:155], v1 offset:17984
  v_mfma_f32_16x16x32_bf16 v[120:123], a[168:171], a[8:11], v[120:123]
  s_lshr_b32 s28, s44, 1
  s_mul_i32 s28, s28, 14336
  v_mfma_f32_16x16x32_bf16 v[116:119], a[168:171], a[4:7], 0
  buffer_load_dword a252, v0, s[16:19], s31 offen
  ds_read_b64_tr_b16 a[156:157], v1 offset:21568
  v_mfma_f32_16x16x32_bf16 v[116:119], a[172:175], a[20:23], v[116:119]
  s_and_b32 s29, s44, 1
  s_lshl_b32 s29, s29, 7
  v_mfma_f32_16x16x32_bf16 v[112:115], a[172:175], a[16:19], 0
  ds_read_b64_tr_b16 a[158:159], v1 offset:25152
  s_add_u32 s28, s28, s29
  v_mfma_f32_16x16x32_bf16 v[112:115], a[168:171], a[0:3], v[112:115]
  v_add_u32 v31, s28, v1
  s_waitcnt lgkmcnt(8)
  v_mfma_f32_16x16x32_bf16 v[128:131], a[128:131], a[0:3], 0
  ds_read_b64_tr_b16 a[160:161], v1 offset:14432
  v_mfma_f32_16x16x32_bf16 v[128:131], a[132:135], a[16:19], v[128:131]
  buffer_load_dwordx4 a[52:55], v0, s[36:39], s11 offen offset:1024 sc1
  v_mfma_f32_16x16x32_bf16 v[132:135], a[132:135], a[20:23], 0
  ds_read_b64_tr_b16 a[162:163], v1 offset:18016
  v_mfma_f32_16x16x32_bf16 v[132:135], a[128:131], a[4:7], v[132:135]
  v_mfma_f32_16x16x32_bf16 v[136:139], a[128:131], a[8:11], 0
  ds_read_b64_tr_b16 a[164:165], v1 offset:21600
  v_mfma_f32_16x16x32_bf16 v[136:139], a[132:135], a[24:27], v[136:139]
  v_mfma_f32_16x16x32_bf16 v[140:143], a[132:135], a[28:31], 0
  global_load_dword a252, v0, s[94:95]
  ds_read_b64_tr_b16 a[166:167], v1 offset:25184
  v_mfma_f32_16x16x32_bf16 v[140:143], a[128:131], a[12:15], v[140:143]
  v_mfma_f32_16x16x32_bf16 v[156:159], a[136:139], a[12:15], 0
  ds_read_b64_tr_b16 a[168:169], v1 offset:14464
  v_mfma_f32_16x16x32_bf16 v[156:159], a[140:143], a[28:31], v[156:159]
  v_mfma_f32_16x16x32_bf16 v[152:155], a[140:143], a[24:27], 0
  ds_read_b64_tr_b16 a[170:171], v1 offset:18048
  v_mfma_f32_16x16x32_bf16 v[152:155], a[136:139], a[8:11], v[152:155]
  buffer_load_dwordx4 v5, s[16:19], s10 offen offset:2048 lds
  v_mfma_f32_16x16x32_bf16 v[148:151], a[136:139], a[4:7], 0
  ds_read_b64_tr_b16 a[172:173], v1 offset:21632
  v_mfma_f32_16x16x32_bf16 v[148:151], a[140:143], a[20:23], v[148:151]
  v_mfma_f32_16x16x32_bf16 v[144:147], a[140:143], a[16:19], 0
  ds_read_b64_tr_b16 a[174:175], v1 offset:25216
  v_mfma_f32_16x16x32_bf16 v[144:147], a[136:139], a[0:3], v[144:147]
  s_waitcnt lgkmcnt(8)
  v_mfma_f32_16x16x32_bf16 v[160:163], a[144:147], a[0:3], 0
  buffer_load_dwordx4 a[56:59], v0, s[36:39], s11 offen offset:2048 sc1
  ds_read_b64_tr_b16 a[128:129], v1 offset:14496
  v_mfma_f32_16x16x32_bf16 v[160:163], a[148:151], a[16:19], v[160:163]
  v_mfma_f32_16x16x32_bf16 v[164:167], a[148:151], a[20:23], 0
  ds_read_b64_tr_b16 a[130:131], v1 offset:18080
  v_mfma_f32_16x16x32_bf16 v[164:167], a[144:147], a[4:7], v[164:167]
  v_mfma_f32_16x16x32_bf16 v[168:171], a[144:147], a[8:11], 0
  ds_read_b64_tr_b16 a[132:133], v1 offset:21664
  v_mfma_f32_16x16x32_bf16 v[168:171], a[148:151], a[24:27], v[168:171]
  buffer_load_dwordx4 v6, s[16:19], s10 offen offset:3072 lds
  v_mfma_f32_16x16x32_bf16 v[172:175], a[148:151], a[28:31], 0
  ds_read_b64_tr_b16 a[134:135], v1 offset:25248
  v_mfma_f32_16x16x32_bf16 v[172:175], a[144:147], a[12:15], v[172:175]
  s_waitcnt vmcnt(21)
  s_barrier
  v_mfma_f32_16x16x32_bf16 v[188:191], a[152:155], a[12:15], 0
  ds_read_b64_tr_b16 a[136:137], v1 offset:14528
  v_mfma_f32_16x16x32_bf16 v[188:191], a[156:159], a[28:31], v[188:191]
  v_mfma_f32_16x16x32_bf16 v[184:187], a[156:159], a[24:27], 0
  buffer_load_dwordx4 a[60:63], v0, s[36:39], s11 offen offset:3072 sc1
  s_add_u32 m0, s84, 61440
  v_mfma_f32_16x16x32_bf16 v[184:187], a[152:155], a[8:11], v[184:187]
  ds_read_b64_tr_b16 a[138:139], v1 offset:18112
  s_add_u32 s31, s31, 524288
  v_mfma_f32_16x16x32_bf16 v[180:183], a[152:155], a[4:7], 0
  ds_read_b64_tr_b16 a[140:141], v1 offset:21696
  v_mfma_f32_16x16x32_bf16 v[180:183], a[156:159], a[20:23], v[180:183]
  v_mfma_f32_16x16x32_bf16 v[176:179], a[156:159], a[16:19], 0
  ds_read_b64_tr_b16 a[142:143], v1 offset:25280
  v_mfma_f32_16x16x32_bf16 v[176:179], a[152:155], a[0:3], v[176:179]
  buffer_load_dwordx4 v7, s[16:19], s10 offen offset:0 lds
  s_waitcnt lgkmcnt(8)
  v_mfma_f32_16x16x32_bf16 v[192:195], a[160:163], a[0:3], 0
  s_bfe_u32 s11, s82, 0x40008
  s_lshl_b32 s11, s11, 13
  v_mfma_f32_16x16x32_bf16 v[192:195], a[164:167], a[16:19], v[192:195]
  s_add_u32 s11, s11, s85
  ds_read_b64_tr_b16 a[144:145], v1 offset:28672
  v_mfma_f32_16x16x32_bf16 v[196:199], a[164:167], a[20:23], 0
  ds_read_b64_tr_b16 a[146:147], v1 offset:32256
  v_mfma_f32_16x16x32_bf16 v[196:199], a[160:163], a[4:7], v[196:199]
  v_mfma_f32_16x16x32_bf16 v[200:203], a[160:163], a[8:11], 0
  buffer_load_dwordx4 a[64:67], v0, s[36:39], s11 offen offset:0 sc1
  ds_read_b64_tr_b16 a[148:149], v1 offset:35840
  v_mfma_f32_16x16x32_bf16 v[200:203], a[164:167], a[24:27], v[200:203]
  v_mfma_f32_16x16x32_bf16 v[204:207], a[164:167], a[28:31], 0
  ds_read_b64_tr_b16 a[150:151], v1 offset:39424
  v_mfma_f32_16x16x32_bf16 v[204:207], a[160:163], a[12:15], v[204:207]
  v_mfma_f32_16x16x32_bf16 v[220:223], a[168:171], a[12:15], 0
  ds_read_b64_tr_b16 a[152:153], v1 offset:28704
  v_mfma_f32_16x16x32_bf16 v[220:223], a[172:175], a[28:31], v[220:223]
  buffer_load_dwordx4 v8, s[16:19], s10 offen offset:1024 lds
  v_mfma_f32_16x16x32_bf16 v[216:219], a[172:175], a[24:27], 0
  ds_read_b64_tr_b16 a[154:155], v1 offset:32288
  v_mfma_f32_16x16x32_bf16 v[216:219], a[168:171], a[8:11], v[216:219]
  v_mfma_f32_16x16x32_bf16 v[212:215], a[168:171], a[4:7], 0
  ds_read_b64_tr_b16 a[156:157], v1 offset:35872
  v_mfma_f32_16x16x32_bf16 v[212:215], a[172:175], a[20:23], v[212:215]
  v_mfma_f32_16x16x32_bf16 v[208:211], a[172:175], a[16:19], 0
  buffer_load_dwordx4 a[68:71], v0, s[36:39], s11 offen offset:1024 sc1
  ds_read_b64_tr_b16 a[158:159], v1 offset:39456
  v_mfma_f32_16x16x32_bf16 v[208:211], a[168:171], a[0:3], v[208:211]
  s_waitcnt lgkmcnt(8)
  v_mfma_f32_16x16x32_bf16 v[224:227], a[128:131], a[0:3], 0
  ds_read_b64_tr_b16 a[160:161], v1 offset:28736
  v_mfma_f32_16x16x32_bf16 v[224:227], a[132:135], a[16:19], v[224:227]
  v_mfma_f32_16x16x32_bf16 v[228:231], a[132:135], a[20:23], 0
  ds_read_b64_tr_b16 a[162:163], v1 offset:32320
  v_mfma_f32_16x16x32_bf16 v[228:231], a[128:131], a[4:7], v[228:231]
  buffer_load_dword a252, v0, s[16:19], s31 offen
  v_mfma_f32_16x16x32_bf16 v[232:235], a[128:131], a[8:11], 0
  ds_read_b64_tr_b16 a[164:165], v1 offset:35904
  v_mfma_f32_16x16x32_bf16 v[232:235], a[132:135], a[24:27], v[232:235]
  v_mfma_f32_16x16x32_bf16 v[236:239], a[132:135], a[28:31], 0
  ds_read_b64_tr_b16 a[166:167], v1 offset:39488
  v_mfma_f32_16x16x32_bf16 v[236:239], a[128:131], a[12:15], v[236:239]
  v_mfma_f32_16x16x32_bf16 v[252:255], a[136:139], a[12:15], 0
  buffer_load_dwordx4 v9, s[16:19], s10 offen offset:2048 lds
  ds_read_b64_tr_b16 a[168:169], v1 offset:28768
  v_mfma_f32_16x16x32_bf16 v[252:255], a[140:143], a[28:31], v[252:255]
  v_mfma_f32_16x16x32_bf16 v[248:251], a[140:143], a[24:27], 0
  ds_read_b64_tr_b16 a[170:171], v1 offset:32352
  v_mfma_f32_16x16x32_bf16 v[248:251], a[136:139], a[8:11], v[248:251]
  v_mfma_f32_16x16x32_bf16 v[244:247], a[136:139], a[4:7], 0
  ds_read_b64_tr_b16 a[172:173], v1 offset:35936
  v_mfma_f32_16x16x32_bf16 v[244:247], a[140:143], a[20:23], v[244:247]
  buffer_load_dwordx4 a[72:75], v0, s[36:39], s11 offen offset:2048 sc1
  v_mfma_f32_16x16x32_bf16 v[240:243], a[140:143], a[16:19], 0
  ds_read_b64_tr_b16 a[174:175], v1 offset:39520
  v_mfma_f32_16x16x32_bf16 v[240:243], a[136:139], a[0:3], v[240:243]
  s_waitcnt vmcnt(7) lgkmcnt(8)
  v_mfma_f32_16x16x32_bf16 v[32:35], a[144:147], a[32:35], v[32:35]
  ds_read_b64_tr_b16 a[128:129], v1 offset:28800
  v_mfma_f32_16x16x32_bf16 v[32:35], a[148:151], a[48:51], v[32:35]
  s_barrier
  v_mfma_f32_16x16x32_bf16 v[36:39], a[148:151], a[52:55], v[36:39]
  buffer_load_dwordx4 a[76:79], v0, s[36:39], s11 offen offset:3072 sc1
  s_bfe_u32 s10, s82, 0x4000c
  v_mfma_f32_16x16x32_bf16 v[36:39], a[144:147], a[36:39], v[36:39]
  s_mul_i32 s10, s10, 458752
  s_add_u32 m0, s84, 86016
  v_mfma_f32_16x16x32_bf16 v[40:43], a[144:147], a[40:43], v[40:43]
  ds_read_b64_tr_b16 a[130:131], v1 offset:32384
  ds_read_b64_tr_b16 a[132:133], v1 offset:35968
  v_mfma_f32_16x16x32_bf16 v[40:43], a[148:151], a[56:59], v[40:43]
  v_mfma_f32_16x16x32_bf16 v[44:47], a[148:151], a[60:63], v[44:47]
  ds_read_b64_tr_b16 a[134:135], v1 offset:39552
  v_mfma_f32_16x16x32_bf16 v[44:47], a[144:147], a[44:47], v[44:47]
  buffer_load_dwordx4 v3, s[16:19], s10 offen offset:0 lds
  s_add_u32 s11, s11, 4096
  v_mfma_f32_16x16x32_bf16 v[60:63], a[152:155], a[44:47], v[60:63]
  ds_read_b64_tr_b16 a[136:137], v1 offset:28832
  v_mfma_f32_16x16x32_bf16 v[60:63], a[156:159], a[60:63], v[60:63]
  v_mfma_f32_16x16x32_bf16 v[56:59], a[156:159], a[56:59], v[56:59]
  ds_read_b64_tr_b16 a[138:139], v1 offset:32416
  v_mfma_f32_16x16x32_bf16 v[56:59], a[152:155], a[40:43], v[56:59]
  v_mfma_f32_16x16x32_bf16 v[52:55], a[152:155], a[36:39], v[52:55]
  buffer_load_dwordx4 a[80:83], v0, s[36:39], s11 offen offset:0 sc1
  ds_read_b64_tr_b16 a[140:141], v1 offset:36000
  v_mfma_f32_16x16x32_bf16 v[52:55], a[156:159], a[52:55], v[52:55]
  v_mfma_f32_16x16x32_bf16 v[48:51], a[156:159], a[48:51], v[48:51]
  ds_read_b64_tr_b16 a[142:143], v1 offset:39584
  v_mfma_f32_16x16x32_bf16 v[48:51], a[152:155], a[32:35], v[48:51]
  s_waitcnt lgkmcnt(8)
  v_mfma_f32_16x16x32_bf16 v[64:67], a[160:163], a[32:35], v[64:67]
  ds_read_b64_tr_b16 a[144:145], v1 offset:28864
  v_mfma_f32_16x16x32_bf16 v[64:67], a[164:167], a[48:51], v[64:67]
  buffer_load_dwordx4 v4, s[16:19], s10 offen offset:1024 lds
  v_mfma_f32_16x16x32_bf16 v[68:71], a[164:167], a[52:55], v[68:71]
  ds_read_b64_tr_b16 a[146:147], v1 offset:32448
  v_mfma_f32_16x16x32_bf16 v[68:71], a[160:163], a[36:39], v[68:71]
  v_mfma_f32_16x16x32_bf16 v[72:75], a[160:163], a[40:43], v[72:75]
  ds_read_b64_tr_b16 a[148:149], v1 offset:36032
  v_mfma_f32_16x16x32_bf16 v[72:75], a[164:167], a[56:59], v[72:75]
  v_mfma_f32_16x16x32_bf16 v[76:79], a[164:167], a[60:63], v[76:79]
  buffer_load_dwordx4 a[84:87], v0, s[36:39], s11 offen offset:1024 sc1
  ds_read_b64_tr_b16 a[150:151], v1 offset:39616
  v_mfma_f32_16x16x32_bf16 v[76:79], a[160:163], a[44:47], v[76:79]
  v_mfma_f32_16x16x32_bf16 v[92:95], a[168:171], a[44:47], v[92:95]
  ds_read_b64_tr_b16 a[152:153], v1 offset:43008
  s_add_u32 s31, s31, 524288
  v_mfma_f32_16x16x32_bf16 v[92:95], a[172:175], a[60:63], v[92:95]
  v_mfma_f32_16x16x32_bf16 v[88:91], a[172:175], a[56:59], v[88:91]
  ds_read_b64_tr_b16 a[154:155], v1 offset:46592
  v_mfma_f32_16x16x32_bf16 v[88:91], a[168:171], a[40:43], v[88:91]
  buffer_load_dwordx4 v5, s[16:19], s10 offen offset:2048 lds
  v_mfma_f32_16x16x32_bf16 v[84:87], a[168:171], a[36:39], v[84:87]
  ds_read_b64_tr_b16 a[156:157], v1 offset:50176
  v_mfma_f32_16x16x32_bf16 v[84:87], a[172:175], a[52:55], v[84:87]
  v_mfma_f32_16x16x32_bf16 v[80:83], a[172:175], a[48:51], v[80:83]
  ds_read_b64_tr_b16 a[158:159], v1 offset:53760
  v_mfma_f32_16x16x32_bf16 v[80:83], a[168:171], a[32:35], v[80:83]
  s_waitcnt lgkmcnt(8)
  v_mfma_f32_16x16x32_bf16 v[96:99], a[128:131], a[32:35], v[96:99]
  buffer_load_dword a252, v0, s[16:19], s31 offen
  ds_read_b64_tr_b16 a[160:161], v1 offset:43040
  v_mfma_f32_16x16x32_bf16 v[96:99], a[132:135], a[48:51], v[96:99]
  v_mfma_f32_16x16x32_bf16 v[100:103], a[132:135], a[52:55], v[100:103]
  ds_read_b64_tr_b16 a[162:163], v1 offset:46624
  v_mfma_f32_16x16x32_bf16 v[100:103], a[128:131], a[36:39], v[100:103]
  v_mfma_f32_16x16x32_bf16 v[104:107], a[128:131], a[40:43], v[104:107]
  ds_read_b64_tr_b16 a[164:165], v1 offset:50208
  v_mfma_f32_16x16x32_bf16 v[104:107], a[132:135], a[56:59], v[104:107]
  buffer_load_dwordx4 a[88:91], v0, s[36:39], s11 offen offset:2048 sc1
  v_mfma_f32_16x16x32_bf16 v[108:111], a[132:135], a[60:63], v[108:111]
  ds_read_b64_tr_b16 a[166:167], v1 offset:53792
  v_mfma_f32_16x16x32_bf16 v[108:111], a[128:131], a[44:47], v[108:111]
  v_mfma_f32_16x16x32_bf16 v[124:127], a[136:139], a[44:47], v[124:127]
  ds_read_b64_tr_b16 a[168:169], v1 offset:43072
  v_mfma_f32_16x16x32_bf16 v[124:127], a[140:143], a[60:63], v[124:127]
  v_mfma_f32_16x16x32_bf16 v[120:123], a[140:143], a[56:59], v[120:123]
  buffer_load_dwordx4 v6, s[16:19], s10 offen offset:3072 lds
  ds_read_b64_tr_b16 a[170:171], v1 offset:46656
  v_mfma_f32_16x16x32_bf16 v[120:123], a[136:139], a[40:43], v[120:123]
  v_mfma_f32_16x16x32_bf16 v[116:119], a[136:139], a[36:39], v[116:119]
  ds_read_b64_tr_b16 a[172:173], v1 offset:50240
  v_mfma_f32_16x16x32_bf16 v[116:119], a[140:143], a[52:55], v[116:119]
  v_mfma_f32_16x16x32_bf16 v[112:115], a[140:143], a[48:51], v[112:115]
  ds_read_b64_tr_b16 a[174:175], v1 offset:53824
  v_mfma_f32_16x16x32_bf16 v[112:115], a[136:139], a[32:35], v[112:115]
  s_waitcnt lgkmcnt(8)
  v_mfma_f32_16x16x32_bf16 v[128:131], a[144:147], a[32:35], v[128:131]
  ds_read_b64_tr_b16 a[128:129], v1 offset:43104
  v_mfma_f32_16x16x32_bf16 v[128:131], a[148:151], a[48:51], v[128:131]
  buffer_load_dwordx4 a[92:95], v0, s[36:39], s11 offen offset:3072 sc1
  v_mfma_f32_16x16x32_bf16 v[132:135], a[148:151], a[52:55], v[132:135]
  ds_read_b64_tr_b16 a[130:131], v1 offset:46688
  v_mfma_f32_16x16x32_bf16 v[132:135], a[144:147], a[36:39], v[132:135]
  v_mfma_f32_16x16x32_bf16 v[136:139], a[144:147], a[40:43], v[136:139]
  s_add_u32 m0, s84, 90112
  ds_read_b64_tr_b16 a[132:133], v1 offset:50272
  v_mfma_f32_16x16x32_bf16 v[136:139], a[148:151], a[56:59], v[136:139]
  v_mfma_f32_16x16x32_bf16 v[140:143], a[148:151], a[60:63], v[140:143]
  ds_read_b64_tr_b16 a[134:135], v1 offset:53856
  v_mfma_f32_16x16x32_bf16 v[140:143], a[144:147], a[44:47], v[140:143]
  v_mfma_f32_16x16x32_bf16 v[156:159], a[152:155], a[44:47], v[156:159]
  buffer_load_dwordx4 v7, s[16:19], s10 offen offset:0 lds
  s_bfe_u32 s11, s82, 0x4000c
  v_mfma_f32_16x16x32_bf16 v[156:159], a[156:159], a[60:63], v[156:159]
  s_lshl_b32 s11, s11, 13
  s_add_u32 s11, s11, s85
  v_mfma_f32_16x16x32_bf16 v[152:155], a[156:159], a[56:59], v[152:155]
  ds_read_b64_tr_b16 a[136:137], v1 offset:43136
  ds_read_b64_tr_b16 a[138:139], v1 offset:46720
  v_mfma_f32_16x16x32_bf16 v[152:155], a[152:155], a[40:43], v[152:155]
  v_mfma_f32_16x16x32_bf16 v[148:151], a[152:155], a[36:39], v[148:151]
  ds_read_b64_tr_b16 a[140:141], v1 offset:50304
  v_mfma_f32_16x16x32_bf16 v[148:151], a[156:159], a[52:55], v[148:151]
  buffer_load_dwordx4 a[96:99], v0, s[36:39], s11 offen offset:0 sc1
  v_mfma_f32_16x16x32_bf16 v[144:147], a[156:159], a[48:51], v[144:147]
  ds_read_b64_tr_b16 a[142:143], v1 offset:53888
  v_mfma_f32_16x16x32_bf16 v[144:147], a[152:155], a[32:35], v[144:147]
  s_waitcnt lgkmcnt(8)
  v_mfma_f32_16x16x32_bf16 v[160:163], a[160:163], a[32:35], v[160:163]
  ds_read_b64_tr_b16 a[144:145], v1 offset:43168
  v_mfma_f32_16x16x32_bf16 v[160:163], a[164:167], a[48:51], v[160:163]
  v_mfma_f32_16x16x32_bf16 v[164:167], a[164:167], a[52:55], v[164:167]
  ds_read_b64_tr_b16 a[146:147], v1 offset:46752
  v_mfma_f32_16x16x32_bf16 v[164:167], a[160:163], a[36:39], v[164:167]
  v_mfma_f32_16x16x32_bf16 v[168:171], a[160:163], a[40:43], v[168:171]
  ds_read_b64_tr_b16 a[148:149], v1 offset:50336
  v_mfma_f32_16x16x32_bf16 v[168:171], a[164:167], a[56:59], v[168:171]
  v_mfma_f32_16x16x32_bf16 v[172:175], a[164:167], a[60:63], v[172:175]
  ds_read_b64_tr_b16 a[150:151], v1 offset:53920
  v_mfma_f32_16x16x32_bf16 v[172:175], a[160:163], a[44:47], v[172:175]
  buffer_load_dwordx4 v8, s[16:19], s10 offen offset:1024 lds
  s_waitcnt vmcnt(14)
  s_barrier
  v_mfma_f32_16x16x32_bf16 v[188:191], a[168:171], a[44:47], v[188:191]
  ds_read_b64_tr_b16 a[152:153], v1 offset:43200
  v_mfma_f32_16x16x32_bf16 v[188:191], a[172:175], a[60:63], v[188:191]
  v_mfma_f32_16x16x32_bf16 v[184:187], a[172:175], a[56:59], v[184:187]
  ds_read_b64_tr_b16 a[154:155], v1 offset:46784
  v_mfma_f32_16x16x32_bf16 v[184:187], a[168:171], a[40:43], v[184:187]
  v_mfma_f32_16x16x32_bf16 v[180:183], a[168:171], a[36:39], v[180:183]
  buffer_load_dwordx4 a[100:103], v0, s[36:39], s11 offen offset:1024 sc1
  ds_read_b64_tr_b16 a[156:157], v1 offset:50368
  v_mfma_f32_16x16x32_bf16 v[180:183], a[172:175], a[52:55], v[180:183]
  v_mfma_f32_16x16x32_bf16 v[176:179], a[172:175], a[48:51], v[176:179]
  ds_read_b64_tr_b16 a[158:159], v1 offset:53952
  v_mfma_f32_16x16x32_bf16 v[176:179], a[168:171], a[32:35], v[176:179]
  s_waitcnt lgkmcnt(8)
  v_mfma_f32_16x16x32_bf16 v[192:195], a[128:131], a[32:35], v[192:195]
  ds_read_b64_tr_b16 a[160:161], v2 offset:0
  v_mfma_f32_16x16x32_bf16 v[192:195], a[132:135], a[48:51], v[192:195]
  v_mfma_f32_16x16x32_bf16 v[196:199], a[132:135], a[52:55], v[196:199]
  ds_read_b64_tr_b16 a[162:163], v2 offset:3584
  v_mfma_f32_16x16x32_bf16 v[196:199], a[128:131], a[36:39], v[196:199]
  v_mfma_f32_16x16x32_bf16 v[200:203], a[128:131], a[40:43], v[200:203]
  ds_read_b64_tr_b16 a[164:165], v2 offset:7168
  v_mfma_f32_16x16x32_bf16 v[200:203], a[132:135], a[56:59], v[200:203]
  s_add_u32 s31, s31, 524288
  v_mfma_f32_16x16x32_bf16 v[204:207], a[132:135], a[60:63], v[204:207]
  buffer_load_dwordx4 v9, s[16:19], s10 offen offset:2048 lds
  ds_read_b64_tr_b16 a[166:167], v2 offset:10752
  v_mfma_f32_16x16x32_bf16 v[204:207], a[128:131], a[44:47], v[204:207]
  v_mfma_f32_16x16x32_bf16 v[220:223], a[136:139], a[44:47], v[220:223]
  ds_read_b64_tr_b16 a[168:169], v2 offset:32
  v_mfma_f32_16x16x32_bf16 v[220:223], a[140:143], a[60:63], v[220:223]
  v_mfma_f32_16x16x32_bf16 v[216:219], a[140:143], a[56:59], v[216:219]
  ds_read_b64_tr_b16 a[170:171], v2 offset:3616
  v_mfma_f32_16x16x32_bf16 v[216:219], a[136:139], a[40:43], v[216:219]
  buffer_load_dwordx4 a[104:107], v0, s[36:39], s11 offen offset:2048 sc1
  v_mfma_f32_16x16x32_bf16 v[212:215], a[136:139], a[36:39], v[212:215]
  ds_read_b64_tr_b16 a[172:173], v2 offset:7200
  v_mfma_f32_16x16x32_bf16 v[212:215], a[140:143], a[52:55], v[212:215]
  v_mfma_f32_16x16x32_bf16 v[208:211], a[140:143], a[48:51], v[208:211]
  ds_read_b64_tr_b16 a[174:175], v2 offset:10784
  v_mfma_f32_16x16x32_bf16 v[208:211], a[136:139], a[32:35], v[208:211]
  s_waitcnt lgkmcnt(8)
  v_mfma_f32_16x16x32_bf16 v[224:227], a[144:147], a[32:35], v[224:227]
  buffer_load_dword a252, v0, s[16:19], s31 offen
  ds_read_b64_tr_b16 a[128:129], v2 offset:64
  v_mfma_f32_16x16x32_bf16 v[224:227], a[148:151], a[48:51], v[224:227]
  v_mfma_f32_16x16x32_bf16 v[228:231], a[148:151], a[52:55], v[228:231]
  ds_read_b64_tr_b16 a[130:131], v2 offset:3648
  v_mfma_f32_16x16x32_bf16 v[228:231], a[144:147], a[36:39], v[228:231]
  v_mfma_f32_16x16x32_bf16 v[232:235], a[144:147], a[40:43], v[232:235]
  ds_read_b64_tr_b16 a[132:133], v2 offset:7232
  v_mfma_f32_16x16x32_bf16 v[232:235], a[148:151], a[56:59], v[232:235]
  buffer_load_dwordx4 a[108:111], v0, s[36:39], s11 offen offset:3072 sc1
  v_mfma_f32_16x16x32_bf16 v[236:239], a[148:151], a[60:63], v[236:239]
  ds_read_b64_tr_b16 a[134:135], v2 offset:10816
  v_mfma_f32_16x16x32_bf16 v[236:239], a[144:147], a[44:47], v[236:239]
  v_mfma_f32_16x16x32_bf16 v[252:255], a[152:155], a[44:47], v[252:255]
  ds_read_b64_tr_b16 a[136:137], v2 offset:96
  v_mfma_f32_16x16x32_bf16 v[252:255], a[156:159], a[60:63], v[252:255]
  s_bfe_u32 s10, s82, 0x40010
  s_mul_i32 s10, s10, 458752
  v_mfma_f32_16x16x32_bf16 v[248:251], a[156:159], a[56:59], v[248:251]
  s_add_u32 m0, s84, 0
  ds_read_b64_tr_b16 a[138:139], v2 offset:3680
  v_mfma_f32_16x16x32_bf16 v[248:251], a[152:155], a[40:43], v[248:251]
  v_mfma_f32_16x16x32_bf16 v[244:247], a[152:155], a[36:39], v[244:247]
  ds_read_b64_tr_b16 a[140:141], v2 offset:7264
  v_mfma_f32_16x16x32_bf16 v[244:247], a[156:159], a[52:55], v[244:247]
  buffer_load_dwordx4 v3, s[16:19], s10 offen offset:0 lds
  v_mfma_f32_16x16x32_bf16 v[240:243], a[156:159], a[48:51], v[240:243]
  ds_read_b64_tr_b16 a[142:143], v2 offset:10848
  v_mfma_f32_16x16x32_bf16 v[240:243], a[152:155], a[32:35], v[240:243]
  s_waitcnt vmcnt(9) lgkmcnt(8)
  v_mfma_f32_16x16x32_bf16 v[32:35], a[160:163], a[64:67], v[32:35]
  s_add_u32 s11, s11, 4096
  ds_read_b64_tr_b16 a[144:145], v2 offset:128
  v_mfma_f32_16x16x32_bf16 v[32:35], a[164:167], a[80:83], v[32:35]
  s_barrier
  v_mfma_f32_16x16x32_bf16 v[36:39], a[164:167], a[84:87], v[36:39]
  ds_read_b64_tr_b16 a[146:147], v2 offset:3712
  v_mfma_f32_16x16x32_bf16 v[36:39], a[160:163], a[68:71], v[36:39]
  v_mfma_f32_16x16x32_bf16 v[40:43], a[160:163], a[72:75], v[40:43]
  buffer_load_dwordx4 a[112:115], v0, s[36:39], s11 offen offset:0 sc1
  ds_read_b64_tr_b16 a[148:149], v2 offset:7296
  v_mfma_f32_16x16x32_bf16 v[40:43], a[164:167], a[88:91], v[40:43]
  v_mfma_f32_16x16x32_bf16 v[44:47], a[164:167], a[92:95], v[44:47]
  ds_read_b64_tr_b16 a[150:151], v2 offset:10880
  v_mfma_f32_16x16x32_bf16 v[44:47], a[160:163], a[76:79], v[44:47]
  v_mfma_f32_16x16x32_bf16 v[60:63], a[168:171], a[76:79], v[60:63]
  ds_read_b64_tr_b16 a[152:153], v2 offset:160
  v_mfma_f32_16x16x32_bf16 v[60:63], a[172:175], a[92:95], v[60:63]
  v_mfma_f32_16x16x32_bf16 v[56:59], a[172:175], a[88:91], v[56:59]
  ds_read_b64_tr_b16 a[154:155], v2 offset:3744
  v_mfma_f32_16x16x32_bf16 v[56:59], a[168:171], a[72:75], v[56:59]
  buffer_load_dwordx4 v4, s[16:19], s10 offen offset:1024 lds
  v_mfma_f32_16x16x32_bf16 v[52:55], a[168:171], a[68:71], v[52:55]
  ds_read_b64_tr_b16 a[156:157], v2 offset:7328
  v_mfma_f32_16x16x32_bf16 v[52:55], a[172:175], a[84:87], v[52:55]
  v_mfma_f32_16x16x32_bf16 v[48:51], a[172:175], a[80:83], v[48:51]
  ds_read_b64_tr_b16 a[158:159], v2 offset:10912
  v_mfma_f32_16x16x32_bf16 v[48:51], a[168:171], a[64:67], v[48:51]
  s_waitcnt lgkmcnt(8)
  v_mfma_f32_16x16x32_bf16 v[64:67], a[128:131], a[64:67], v[64:67]
  ds_read_b64_tr_b16 a[160:161], v2 offset:192
  v_mfma_f32_16x16x32_bf16 v[64:67], a[132:135], a[80:83], v[64:67]
  v_mfma_f32_16x16x32_bf16 v[68:71], a[132:135], a[84:87], v[68:71]
  ds_read_b64_tr_b16 a[162:163], v2 offset:3776
  v_mfma_f32_16x16x32_bf16 v[68:71], a[128:131], a[68:71], v[68:71]
  buffer_load_dwordx4 a[116:119], v0, s[36:39], s11 offen offset:1024 sc1
  v_mfma_f32_16x16x32_bf16 v[72:75], a[128:131], a[72:75], v[72:75]
  ds_read_b64_tr_b16 a[164:165], v2 offset:7360
  v_mfma_f32_16x16x32_bf16 v[72:75], a[132:135], a[88:91], v[72:75]
  v_mfma_f32_16x16x32_bf16 v[76:79], a[132:135], a[92:95], v[76:79]
  ds_read_b64_tr_b16 a[166:167], v2 offset:10944
  s_lshl2_add_u32 s28, s56, s44
  v_mfma_f32_16x16x32_bf16 v[76:79], a[128:131], a[76:79], v[76:79]
  s_lshl_b32 s28, s28, 13
  s_add_u32 s28, s28, 262144
  v_mfma_f32_16x16x32_bf16 v[92:95], a[136:139], a[76:79], v[92:95]
  ds_read_b64_tr_b16 a[168:169], v2 offset:14336
  s_add_u32 s29, s28, 4096
  v_mfma_f32_16x16x32_bf16 v[92:95], a[140:143], a[92:95], v[92:95]
  buffer_load_dwordx4 a[176:179], v0, s[36:39], s28 offen offset:0 sc1
  v_mfma_f32_16x16x32_bf16 v[88:91], a[140:143], a[88:91], v[88:91]
  ds_read_b64_tr_b16 a[170:171], v2 offset:17920
  v_mfma_f32_16x16x32_bf16 v[88:91], a[136:139], a[72:75], v[88:91]
  v_mfma_f32_16x16x32_bf16 v[84:87], a[136:139], a[68:71], v[84:87]
  ds_read_b64_tr_b16 a[172:173], v2 offset:21504
  v_mfma_f32_16x16x32_bf16 v[84:87], a[140:143], a[84:87], v[84:87]
  v_mfma_f32_16x16x32_bf16 v[80:83], a[140:143], a[80:83], v[80:83]
  buffer_load_dwordx4 v5, s[16:19], s10 offen offset:2048 lds
  ds_read_b64_tr_b16 a[174:175], v2 offset:25088
  v_mfma_f32_16x16x32_bf16 v[80:83], a[136:139], a[64:67], v[80:83]
  s_waitcnt lgkmcnt(8)
  v_mfma_f32_16x16x32_bf16 v[96:99], a[144:147], a[64:67], v[96:99]
  ds_read_b64_tr_b16 a[128:129], v2 offset:14368
  v_mfma_f32_16x16x32_bf16 v[96:99], a[148:151], a[80:83], v[96:99]
  v_mfma_f32_16x16x32_bf16 v[100:103], a[148:151], a[84:87], v[100:103]
  ds_read_b64_tr_b16 a[130:131], v2 offset:17952
  s_add_u32 s31, s31, 524288
  v_mfma_f32_16x16x32_bf16 v[100:103], a[144:147], a[68:71], v[100:103]
  buffer_load_dwordx4 a[120:123], v0, s[36:39], s11 offen offset:2048 sc1
  v_mfma_f32_16x16x32_bf16 v[104:107], a[144:147], a[72:75], v[104:107]
  ds_read_b64_tr_b16 a[132:133], v2 offset:21536
  v_mfma_f32_16x16x32_bf16 v[104:107], a[148:151], a[88:91], v[104:107]
  v_mfma_f32_16x16x32_bf16 v[108:111], a[148:151], a[92:95], v[108:111]
  ds_read_b64_tr_b16 a[134:135], v2 offset:25120
  v_mfma_f32_16x16x32_bf16 v[108:111], a[144:147], a[76:79], v[108:111]
  v_mfma_f32_16x16x32_bf16 v[124:127], a[152:155], a[76:79], v[124:127]
  buffer_load_dword a252, v0, s[16:19], s31 offen
  ds_read_b64_tr_b16 a[136:137], v2 offset:14400
  v_mfma_f32_16x16x32_bf16 v[124:127], a[156:159], a[92:95], v[124:127]
  v_mfma_f32_16x16x32_bf16 v[120:123], a[156:159], a[88:91], v[120:123]
  ds_read_b64_tr_b16 a[138:139], v2 offset:17984
  v_mfma_f32_16x16x32_bf16 v[120:123], a[152:155], a[72:75], v[120:123]
  v_mfma_f32_16x16x32_bf16 v[116:119], a[152:155], a[68:71], v[116:119]
  ds_read_b64_tr_b16 a[140:141], v2 offset:21568
  v_mfma_f32_16x16x32_bf16 v[116:119], a[156:159], a[84:87], v[116:119]
  buffer_load_dwordx4 v6, s[16:19], s10 offen offset:3072 lds
  v_mfma_f32_16x16x32_bf16 v[112:115], a[156:159], a[80:83], v[112:115]
  ds_read_b64_tr_b16 a[142:143], v2 offset:25152
CT11:
  s_add_u32 s94, s92, CT11-k3_main_kernel+3072
  s_addc_u32 s95, s93, 0
  v_mfma_f32_16x16x32_bf16 v[112:115], a[152:155], a[64:67], v[112:115]
  s_waitcnt lgkmcnt(8)
  v_mfma_f32_16x16x32_bf16 v[128:131], a[160:163], a[64:67], v[128:131]
  ds_read_b64_tr_b16 a[144:145], v2 offset:14432
  v_mfma_f32_16x16x32_bf16 v[128:131], a[164:167], a[80:83], v[128:131]
  v_mfma_f32_16x16x32_bf16 v[132:135], a[164:167], a[84:87], v[132:135]
  global_load_dword a252, v0, s[94:95]
  ds_read_b64_tr_b16 a[146:147], v2 offset:18016
  v_mfma_f32_16x16x32_bf16 v[132:135], a[160:163], a[68:71], v[132:135]
  v_mfma_f32_16x16x32_bf16 v[136:139], a[160:163], a[72:75], v[136:139]
  ds_read_b64_tr_b16 a[148:149], v2 offset:21600
  v_mfma_f32_16x16x32_bf16 v[136:139], a[164:167], a[88:91], v[136:139]
  v_mfma_f32_16x16x32_bf16 v[140:143], a[164:167], a[92:95], v[140:143]
  ds_read_b64_tr_b16 a[150:151], v2 offset:25184
  v_mfma_f32_16x16x32_bf16 v[140:143], a[160:163], a[76:79], v[140:143]
  buffer_load_dwordx4 a[124:127], v0, s[36:39], s11 offen offset:3072 sc1
  s_add_u32 m0, s84, 4096
  v_mfma_f32_16x16x32_bf16 v[156:159], a[168:171], a[76:79], v[156:159]
  ds_read_b64_tr_b16 a[152:153], v2 offset:14464
  v_mfma_f32_16x16x32_bf16 v[156:159], a[172:175], a[92:95], v[156:159]
  v_mfma_f32_16x16x32_bf16 v[152:155], a[172:175], a[88:91], v[152:155]
  ds_read_b64_tr_b16 a[154:155], v2 offset:18048
  v_mfma_f32_16x16x32_bf16 v[152:155], a[168:171], a[72:75], v[152:155]
  v_mfma_f32_16x16x32_bf16 v[148:151], a[168:171], a[68:71], v[148:151]
  buffer_load_dwordx4 v7, s[16:19], s10 offen offset:0 lds
  s_bfe_u32 s11, s82, 0x40010
  v_mfma_f32_16x16x32_bf16 v[148:151], a[172:175], a[84:87], v[148:151]
  s_lshl_b32 s11, s11, 13
  s_add_u32 s11, s11, s85
  v_mfma_f32_16x16x32_bf16 v[144:147], a[172:175], a[80:83], v[144:147]
  ds_read_b64_tr_b16 a[156:157], v2 offset:21632
  ds_read_b64_tr_b16 a[158:159], v2 offset:25216
  v_mfma_f32_16x16x32_bf16 v[144:147], a[168:171], a[64:67], v[144:147]
  s_waitcnt lgkmcnt(8)
  v_mfma_f32_16x16x32_bf16 v[160:163], a[128:131], a[64:67], v[160:163]
  ds_read_b64_tr_b16 a[160:161], v2 offset:14496
  v_mfma_f32_16x16x32_bf16 v[160:163], a[132:135], a[80:83], v[160:163]
  buffer_load_dwordx4 a[180:183], v0, s[36:39], s28 offen offset:1024 sc1
  v_mfma_f32_16x16x32_bf16 v[164:167], a[132:135], a[84:87], v[164:167]
  ds_read_b64_tr_b16 a[162:163], v2 offset:18080
  v_mfma_f32_16x16x32_bf16 v[164:167], a[128:131], a[68:71], v[164:167]
  v_mfma_f32_16x16x32_bf16 v[168:171], a[128:131], a[72:75], v[168:171]
  ds_read_b64_tr_b16 a[164:165], v2 offset:21664
  v_mfma_f32_16x16x32_bf16 v[168:171], a[132:135], a[88:91], v[168:171]
  v_mfma_f32_16x16x32_bf16 v[172:175], a[132:135], a[92:95], v[172:175]
  buffer_load_dwordx4 a[0:3], v0, s[36:39], s11 offen offset:0 sc1
  ds_read_b64_tr_b16 a[166:167], v2 offset:25248
  v_mfma_f32_16x16x32_bf16 v[172:175], a[128:131], a[76:79], v[172:175]
  s_waitcnt vmcnt(17)
  s_barrier
  v_mfma_f32_16x16x32_bf16 v[188:191], a[136:139], a[76:79], v[188:191]
  ds_read_b64_tr_b16 a[168:169], v2 offset:14528
  v_mfma_f32_16x16x32_bf16 v[188:191], a[140:143], a[92:95], v[188:191]
  v_mfma_f32_16x16x32_bf16 v[184:187], a[140:143], a[88:91], v[184:187]
  ds_read_b64_tr_b16 a[170:171], v2 offset:18112
  v_mfma_f32_16x16x32_bf16 v[184:187], a[136:139], a[72:75], v[184:187]
  buffer_load_dwordx4 v8, s[16:19], s10 offen offset:1024 lds
  v_mfma_f32_16x16x32_bf16 v[180:183], a[136:139], a[68:71], v[180:183]
  ds_read_b64_tr_b16 a[172:173], v2 offset:21696
  v_mfma_f32_16x16x32_bf16 v[180:183], a[140:143], a[84:87], v[180:183]
  v_mfma_f32_16x16x32_bf16 v[176:179], a[140:143], a[80:83], v[176:179]
  ds_read_b64_tr_b16 a[174:175], v2 offset:25280
  v_mfma_f32_16x16x32_bf16 v[176:179], a[136:139], a[64:67], v[176:179]
  buffer_load_dwordx4 a[184:187], v0, s[36:39], s28 offen offset:2048 sc1
  s_waitcnt lgkmcnt(8)
  v_mfma_f32_16x16x32_bf16 v[192:195], a[144:147], a[64:67], v[192:195]
  ds_read_b64_tr_b16 a[128:129], v2 offset:28672
  v_mfma_f32_16x16x32_bf16 v[192:195], a[148:151], a[80:83], v[192:195]
  v_mfma_f32_16x16x32_bf16 v[196:199], a[148:151], a[84:87], v[196:199]
  ds_read_b64_tr_b16 a[130:131], v2 offset:32256
  v_mfma_f32_16x16x32_bf16 v[196:199], a[144:147], a[68:71], v[196:199]
  v_mfma_f32_16x16x32_bf16 v[200:203], a[144:147], a[72:75], v[200:203]
  buffer_load_dwordx4 a[4:7], v0, s[36:39], s11 offen offset:1024 sc1
  ds_read_b64_tr_b16 a[132:133], v2 offset:35840
  v_mfma_f32_16x16x32_bf16 v[200:203], a[148:151], a[88:91], v[200:203]
  v_mfma_f32_16x16x32_bf16 v[204:207], a[148:151], a[92:95], v[204:207]
  ds_read_b64_tr_b16 a[134:135], v2 offset:39424
  v_mfma_f32_16x16x32_bf16 v[204:207], a[144:147], a[76:79], v[204:207]
  v_mfma_f32_16x16x32_bf16 v[220:223], a[152:155], a[76:79], v[220:223]
  ds_read_b64_tr_b16 a[136:137], v2 offset:28704
  v_mfma_f32_16x16x32_bf16 v[220:223], a[156:159], a[92:95], v[220:223]
  buffer_load_dwordx4 v9, s[16:19], s10 offen offset:2048 lds
  v_mfma_f32_16x16x32_bf16 v[216:219], a[156:159], a[88:91], v[216:219]
  ds_read_b64_tr_b16 a[138:139], v2 offset:32288
  v_mfma_f32_16x16x32_bf16 v[216:219], a[152:155], a[72:75], v[216:219]
  v_mfma_f32_16x16x32_bf16 v[212:215], a[152:155], a[68:71], v[212:215]
  ds_read_b64_tr_b16 a[140:141], v2 offset:35872
  v_mfma_f32_16x16x32_bf16 v[212:215], a[156:159], a[84:87], v[212:215]
  buffer_load_dwordx4 a[188:191], v0, s[36:39], s28 offen offset:3072 sc1
  v_mfma_f32_16x16x32_bf16 v[208:211], a[156:159], a[80:83], v[208:211]
  ds_read_b64_tr_b16 a[142:143], v2 offset:39456
  v_mfma_f32_16x16x32_bf16 v[208:211], a[152:155], a[64:67], v[208:211]
  s_add_u32 s31, s31, 524288
  s_waitcnt lgkmcnt(8)
  v_mfma_f32_16x16x32_bf16 v[224:227], a[160:163], a[64:67], v[224:227]
  ds_read_b64_tr_b16 a[144:145], v2 offset:28736
  v_mfma_f32_16x16x32_bf16 v[224:227], a[164:167], a[80:83], v[224:227]
  v_mfma_f32_16x16x32_bf16 v[228:231], a[164:167], a[84:87], v[228:231]
  buffer_load_dwordx4 a[8:11], v0, s[36:39], s11 offen offset:2048 sc1
  ds_read_b64_tr_b16 a[146:147], v2 offset:32320
  v_mfma_f32_16x16x32_bf16 v[228:231], a[160:163], a[68:71], v[228:231]
  v_mfma_f32_16x16x32_bf16 v[232:235], a[160:163], a[72:75], v[232:235]
  ds_read_b64_tr_b16 a[148:149], v2 offset:35904
  v_mfma_f32_16x16x32_bf16 v[232:235], a[164:167], a[88:91], v[232:235]
  v_mfma_f32_16x16x32_bf16 v[236:239], a[164:167], a[92:95], v[236:239]
  ds_read_b64_tr_b16 a[150:151], v2 offset:39488
  v_mfma_f32_16x16x32_bf16 v[236:239], a[160:163], a[76:79], v[236:239]
  buffer_load_dword a252, v0, s[16:19], s31 offen
  v_mfma_f32_16x16x32_bf16 v[252:255], a[168:171], a[76:79], v[252:255]
  ds_read_b64_tr_b16 a[152:153], v2 offset:28768
  v_mfma_f32_16x16x32_bf16 v[252:255], a[172:175], a[92:95], v[252:255]
  v_mfma_f32_16x16x32_bf16 v[248:251], a[172:175], a[88:91], v[248:251]
  ds_read_b64_tr_b16 a[154:155], v2 offset:32352
  v_mfma_f32_16x16x32_bf16 v[248:251], a[168:171], a[72:75], v[248:251]
  buffer_load_dwordx4 a[192:195], v0, s[36:39], s29 offen offset:0 sc1
  v_mfma_f32_16x16x32_bf16 v[244:247], a[168:171], a[68:71], v[244:247]
  ds_read_b64_tr_b16 a[156:157], v2 offset:35936
  v_mfma_f32_16x16x32_bf16 v[244:247], a[172:175], a[84:87], v[244:247]
  v_mfma_f32_16x16x32_bf16 v[240:243], a[172:175], a[80:83], v[240:243]
  ds_read_b64_tr_b16 a[158:159], v2 offset:39520
  v_mfma_f32_16x16x32_bf16 v[240:243], a[168:171], a[64:67], v[240:243]
  s_waitcnt vmcnt(11) lgkmcnt(8)
  v_mfma_f32_16x16x32_bf16 v[32:35], a[128:131], a[96:99], v[32:35]
  buffer_load_dwordx4 a[12:15], v0, s[36:39], s11 offen offset:3072 sc1
  s_bfe_u32 s10, s82, 0x40014
  v_mfma_f32_16x16x32_bf16 v[32:35], a[132:135], a[112:115], v[32:35]
  s_mul_i32 s10, s10, 458752
  s_barrier
  v_mfma_f32_16x16x32_bf16 v[36:39], a[132:135], a[116:119], v[36:39]
  s_add_u32 m0, s84, 28672
  ds_read_b64_tr_b16 a[160:161], v2 offset:28800
  v_mfma_f32_16x16x32_bf16 v[36:39], a[128:131], a[100:103], v[36:39]
  ds_read_b64_tr_b16 a[162:163], v2 offset:32384
  v_mfma_f32_16x16x32_bf16 v[40:43], a[128:131], a[104:107], v[40:43]
  ds_read_b64_tr_b16 a[164:165], v2 offset:35968
  v_mfma_f32_16x16x32_bf16 v[40:43], a[132:135], a[120:123], v[40:43]
  buffer_load_dwordx4 v3, s[16:19], s10 offen offset:0 lds
  s_add_u32 s11, s11, 4096
  v_mfma_f32_16x16x32_bf16 v[44:47], a[132:135], a[124:127], v[44:47]
  ds_read_b64_tr_b16 a[166:167], v2 offset:39552
  v_mfma_f32_16x16x32_bf16 v[44:47], a[128:131], a[108:111], v[44:47]
  v_mfma_f32_16x16x32_bf16 v[60:63], a[136:139], a[108:111], v[60:63]
  ds_read_b64_tr_b16 a[168:169], v2 offset:28832
  v_mfma_f32_16x16x32_bf16 v[60:63], a[140:143], a[124:127], v[60:63]
  buffer_load_dwordx4 a[196:199], v0, s[36:39], s29 offen offset:1024 sc1
  v_mfma_f32_16x16x32_bf16 v[56:59], a[140:143], a[120:123], v[56:59]
  ds_read_b64_tr_b16 a[170:171], v2 offset:32416
  v_mfma_f32_16x16x32_bf16 v[56:59], a[136:139], a[104:107], v[56:59]
  v_mfma_f32_16x16x32_bf16 v[52:55], a[136:139], a[100:103], v[52:55]
  ds_read_b64_tr_b16 a[172:173], v2 offset:36000
  v_mfma_f32_16x16x32_bf16 v[52:55], a[140:143], a[116:119], v[52:55]
  v_mfma_f32_16x16x32_bf16 v[48:51], a[140:143], a[112:115], v[48:51]
  buffer_load_dwordx4 a[16:19], v0, s[36:39], s11 offen offset:0 sc1
  ds_read_b64_tr_b16 a[174:175], v2 offset:39584
  v_mfma_f32_16x16x32_bf16 v[48:51], a[136:139], a[96:99], v[48:51]
  s_waitcnt lgkmcnt(8)
  v_mfma_f32_16x16x32_bf16 v[64:67], a[144:147], a[96:99], v[64:67]
  ds_read_b64_tr_b16 a[128:129], v2 offset:28864
  v_mfma_f32_16x16x32_bf16 v[64:67], a[148:151], a[112:115], v[64:67]
  v_mfma_f32_16x16x32_bf16 v[68:71], a[148:151], a[116:119], v[68:71]
  ds_read_b64_tr_b16 a[130:131], v2 offset:32448
  v_mfma_f32_16x16x32_bf16 v[68:71], a[144:147], a[100:103], v[68:71]
  buffer_load_dwordx4 v4, s[16:19], s10 offen offset:1024 lds
  v_mfma_f32_16x16x32_bf16 v[72:75], a[144:147], a[104:107], v[72:75]
  ds_read_b64_tr_b16 a[132:133], v2 offset:36032
  v_mfma_f32_16x16x32_bf16 v[72:75], a[148:151], a[120:123], v[72:75]
  v_mfma_f32_16x16x32_bf16 v[76:79], a[148:151], a[124:127], v[76:79]
  ds_read_b64_tr_b16 a[134:135], v2 offset:39616
  v_mfma_f32_16x16x32_bf16 v[76:79], a[144:147], a[108:111], v[76:79]
  buffer_load_dwordx4 a[200:203], v0, s[36:39], s29 offen offset:2048 sc1
  v_mfma_f32_16x16x32_bf16 v[92:95], a[152:155], a[108:111], v[92:95]
  ds_read_b64_tr_b16 a[136:137], v2 offset:43008
  v_mfma_f32_16x16x32_bf16 v[92:95], a[156:159], a[124:127], v[92:95]
  v_mfma_f32_16x16x32_bf16 v[88:91], a[156:159], a[120:123], v[88:91]
  ds_read_b64_tr_b16 a[138:139], v2 offset:46592
  v_mfma_f32_16x16x32_bf16 v[88:91], a[152:155], a[104:107], v[88:91]
  v_mfma_f32_16x16x32_bf16 v[84:87], a[152:155], a[100:103], v[84:87]
  buffer_load_dwordx4 a[20:23], v0, s[36:39], s11 offen offset:1024 sc1
  ds_read_b64_tr_b16 a[140:141], v2 offset:50176
  v_mfma_f32_16x16x32_bf16 v[84:87], a[156:159], a[116:119], v[84:87]
  v_mfma_f32_16x16x32_bf16 v[80:83], a[156:159], a[112:115], v[80:83]
  ds_read_b64_tr_b16 a[142:143], v2 offset:53760
  v_mfma_f32_16x16x32_bf16 v[80:83], a[152:155], a[96:99], v[80:83]
  s_waitcnt lgkmcnt(8)
  v_mfma_f32_16x16x32_bf16 v[96:99], a[160:163], a[96:99], v[96:99]
  ds_read_b64_tr_b16 a[144:145], v2 offset:43040
  v_mfma_f32_16x16x32_bf16 v[96:99], a[164:167], a[112:115], v[96:99]
  buffer_load_dwordx4 v5, s[16:19], s10 offen offset:2048 lds
  v_mfma_f32_16x16x32_bf16 v[100:103], a[164:167], a[116:119], v[100:103]
  ds_read_b64_tr_b16 a[146:147], v2 offset:46624
  v_mfma_f32_16x16x32_bf16 v[100:103], a[160:163], a[100:103], v[100:103]
  v_mfma_f32_16x16x32_bf16 v[104:107], a[160:163], a[104:107], v[104:107]
  ds_read_b64_tr_b16 a[148:149], v2 offset:50208
  v_mfma_f32_16x16x32_bf16 v[104:107], a[164:167], a[120:123], v[104:107]
  buffer_load_dwordx4 a[204:207], v0, s[36:39], s29 offen offset:3072 sc1
  v_mfma_f32_16x16x32_bf16 v[108:111], a[164:167], a[124:127], v[108:111]
  ds_read_b64_tr_b16 a[150:151], v2 offset:53792
  v_mfma_f32_16x16x32_bf16 v[108:111], a[160:163], a[108:111], v[108:111]
  v_mfma_f32_16x16x32_bf16 v[124:127], a[168:171], a[108:111], v[124:127]
  ds_read_b64_tr_b16 a[152:153], v2 offset:43072
  v_mfma_f32_16x16x32_bf16 v[124:127], a[172:175], a[124:127], v[124:127]
  v_mfma_f32_16x16x32_bf16 v[120:123], a[172:175], a[120:123], v[120:123]
  buffer_load_dwordx4 a[24:27], v0, s[36:39], s11 offen offset:2048 sc1
  ds_read_b64_tr_b16 a[154:155], v2 offset:46656
  v_mfma_f32_16x16x32_bf16 v[120:123], a[168:171], a[104:107], v[120:123]
  v_mfma_f32_16x16x32_bf16 v[116:119], a[168:171], a[100:103], v[116:119]
  ds_read_b64_tr_b16 a[156:157], v2 offset:50240
  v_mfma_f32_16x16x32_bf16 v[116:119], a[172:175], a[116:119], v[116:119]
  s_add_u32 s31, s31, 524288
  v_mfma_f32_16x16x32_bf16 v[112:115], a[172:175], a[112:115], v[112:115]
  ds_read_b64_tr_b16 a[158:159], v2 offset:53824
  v_mfma_f32_16x16x32_bf16 v[112:115], a[168:171], a[96:99], v[112:115]
  buffer_load_dwordx4 v6, s[16:19], s10 offen offset:3072 lds
  s_waitcnt lgkmcnt(8)
  v_mfma_f32_16x16x32_bf16 v[128:131], a[128:131], a[96:99], v[128:131]
  ds_read_b64_tr_b16 a[160:161], v2 offset:43104
  v_mfma_f32_16x16x32_bf16 v[128:131], a[132:135], a[112:115], v[128:131]
  v_mfma_f32_16x16x32_bf16 v[132:135], a[132:135], a[116:119], v[132:135]
  ds_read_b64_tr_b16 a[162:163], v2 offset:46688
  v_mfma_f32_16x16x32_bf16 v[132:135], a[128:131], a[100:103], v[132:135]
  v_mfma_f32_16x16x32_bf16 v[136:139], a[128:131], a[104:107], v[136:139]
  buffer_load_dword a252, v0, s[16:19], s31 offen
  ds_read_b64_tr_b16 a[164:165], v2 offset:50272
  v_mfma_f32_16x16x32_bf16 v[136:139], a[132:135], a[120:123], v[136:139]
  v_mfma_f32_16x16x32_bf16 v[140:143], a[132:135], a[124:127], v[140:143]
  ds_read_b64_tr_b16 a[166:167], v2 offset:53856
  v_mfma_f32_16x16x32_bf16 v[140:143], a[128:131], a[108:111], v[140:143]
  v_mfma_f32_16x16x32_bf16 v[156:159], a[136:139], a[108:111], v[156:159]
  ds_read_b64_tr_b16 a[168:169], v2 offset:43136
  v_mfma_f32_16x16x32_bf16 v[156:159], a[140:143], a[124:127], v[156:159]
  buffer_load_dwordx4 a[28:31], v0, s[36:39], s11 offen offset:3072 sc1
  s_add_u32 m0, s84, 32768
  v_mfma_f32_16x16x32_bf16 v[152:155], a[140:143], a[120:123], v[152:155]
  ds_read_b64_tr_b16 a[170:171], v2 offset:46720
  v_mfma_f32_16x16x32_bf16 v[152:155], a[136:139], a[104:107], v[152:155]
  v_mfma_f32_16x16x32_bf16 v[148:151], a[136:139], a[100:103], v[148:151]
  ds_read_b64_tr_b16 a[172:173], v2 offset:50304
  v_mfma_f32_16x16x32_bf16 v[148:151], a[140:143], a[116:119], v[148:151]
  v_mfma_f32_16x16x32_bf16 v[144:147], a[140:143], a[112:115], v[144:147]
  buffer_load_dwordx4 v7, s[16:19], s10 offen offset:0 lds
  s_bfe_u32 s11, s82, 0x40014
  v_mfma_f32_16x16x32_bf16 v[144:147], a[136:139], a[96:99], v[144:147]
  s_lshl_b32 s11, s11, 13
  s_waitcnt lgkmcnt(7)
  v_mfma_f32_16x16x32_bf16 v[160:163], a[144:147], a[96:99], v[160:163]
  s_add_u32 s11, s11, s85
  ds_read_b64_tr_b16 a[174:175], v2 offset:53888
  v_mfma_f32_16x16x32_bf16 v[160:163], a[148:151], a[112:115], v[160:163]
  ds_read_b64_tr_b16 a[128:129], v2 offset:43168
  v_mfma_f32_16x16x32_bf16 v[164:167], a[148:151], a[116:119], v[164:167]
  ds_read_b64_tr_b16 a[130:131], v2 offset:46752
  v_mfma_f32_16x16x32_bf16 v[164:167], a[144:147], a[100:103], v[164:167]
  buffer_load_dwordx4 a[32:35], v0, s[36:39], s11 offen offset:0 sc1
  v_mfma_f32_16x16x32_bf16 v[168:171], a[144:147], a[104:107], v[168:171]
  ds_read_b64_tr_b16 a[132:133], v2 offset:50336
  v_mfma_f32_16x16x32_bf16 v[168:171], a[148:151], a[120:123], v[168:171]
  v_mfma_f32_16x16x32_bf16 v[172:175], a[148:151], a[124:127], v[172:175]
  ds_read_b64_tr_b16 a[134:135], v2 offset:53920
  v_mfma_f32_16x16x32_bf16 v[172:175], a[144:147], a[108:111], v[172:175]
  s_waitcnt vmcnt(19)
  s_barrier
  v_mfma_f32_16x16x32_bf16 v[188:191], a[152:155], a[108:111], v[188:191]
  buffer_load_dwordx4 v8, s[16:19], s10 offen offset:1024 lds
  ds_read_b64_tr_b16 a[136:137], v2 offset:43200
  v_mfma_f32_16x16x32_bf16 v[188:191], a[156:159], a[124:127], v[188:191]
  v_mfma_f32_16x16x32_bf16 v[184:187], a[156:159], a[120:123], v[184:187]
  ds_read_b64_tr_b16 a[138:139], v2 offset:46784
  v_mfma_f32_16x16x32_bf16 v[184:187], a[152:155], a[104:107], v[184:187]
  v_mfma_f32_16x16x32_bf16 v[180:183], a[152:155], a[100:103], v[180:183]
  ds_read_b64_tr_b16 a[140:141], v2 offset:50368
  v_mfma_f32_16x16x32_bf16 v[180:183], a[156:159], a[116:119], v[180:183]
  buffer_load_dwordx4 a[36:39], v0, s[36:39], s11 offen offset:1024 sc1
  v_mfma_f32_16x16x32_bf16 v[176:179], a[156:159], a[112:115], v[176:179]
  ds_read_b64_tr_b16 a[142:143], v2 offset:53952
  v_mfma_f32_16x16x32_bf16 v[176:179], a[152:155], a[96:99], v[176:179]
  s_waitcnt lgkmcnt(8)
  v_mfma_f32_16x16x32_bf16 v[192:195], a[160:163], a[96:99], v[192:195]
  ds_read_b64_tr_b16 a[144:145], v1 offset:0
  v_mfma_f32_16x16x32_bf16 v[192:195], a[164:167], a[112:115], v[192:195]
  v_mfma_f32_16x16x32_bf16 v[196:199], a[164:167], a[116:119], v[196:199]
  ds_read_b64_tr_b16 a[146:147], v1 offset:3584
  v_mfma_f32_16x16x32_bf16 v[196:199], a[160:163], a[100:103], v[196:199]
  v_mfma_f32_16x16x32_bf16 v[200:203], a[160:163], a[104:107], v[200:203]
  ds_read_b64_tr_b16 a[148:149], v1 offset:7168
  v_mfma_f32_16x16x32_bf16 v[200:203], a[164:167], a[120:123], v[200:203]
  v_mfma_f32_16x16x32_bf16 v[204:207], a[164:167], a[124:127], v[204:207]
  buffer_load_dwordx4 v9, s[16:19], s10 offen offset:2048 lds
  ds_read_b64_tr_b16 a[150:151], v1 offset:10752
  v_mfma_f32_16x16x32_bf16 v[204:207], a[160:163], a[108:111], v[204:207]
  v_mfma_f32_16x16x32_bf16 v[220:223], a[168:171], a[108:111], v[220:223]
  ds_read_b64_tr_b16 a[152:153], v1 offset:32
  v_mfma_f32_16x16x32_bf16 v[220:223], a[172:175], a[124:127], v[220:223]
  v_mfma_f32_16x16x32_bf16 v[216:219], a[172:175], a[120:123], v[216:219]
  ds_read_b64_tr_b16 a[154:155], v1 offset:3616
  v_mfma_f32_16x16x32_bf16 v[216:219], a[168:171], a[104:107], v[216:219]
  buffer_load_dwordx4 a[40:43], v0, s[36:39], s11 offen offset:2048 sc1
  v_mfma_f32_16x16x32_bf16 v[212:215], a[168:171], a[100:103], v[212:215]
  ds_read_b64_tr_b16 a[156:157], v1 offset:7200
  v_mfma_f32_16x16x32_bf16 v[212:215], a[172:175], a[116:119], v[212:215]
  v_mfma_f32_16x16x32_bf16 v[208:211], a[172:175], a[112:115], v[208:211]
  ds_read_b64_tr_b16 a[158:159], v1 offset:10784
  v_mfma_f32_16x16x32_bf16 v[208:211], a[168:171], a[96:99], v[208:211]
  s_waitcnt lgkmcnt(8)
  v_mfma_f32_16x16x32_bf16 v[224:227], a[128:131], a[96:99], v[224:227]
  ds_read_b64_tr_b16 a[160:161], v1 offset:64
  v_mfma_f32_16x16x32_bf16 v[224:227], a[132:135], a[112:115], v[224:227]
  v_mfma_f32_16x16x32_bf16 v[228:231], a[132:135], a[116:119], v[228:231]
  ds_read_b64_tr_b16 a[162:163], v1 offset:3648
  v_mfma_f32_16x16x32_bf16 v[228:231], a[128:131], a[100:103], v[228:231]
  v_mfma_f32_16x16x32_bf16 v[232:235], a[128:131], a[104:107], v[232:235]
  ds_read_b64_tr_b16 a[164:165], v1 offset:7232
  v_mfma_f32_16x16x32_bf16 v[232:235], a[132:135], a[120:123], v[232:235]
  buffer_load_dwordx4 a[44:47], v0, s[36:39], s11 offen offset:3072 sc1
  v_mfma_f32_16x16x32_bf16 v[236:239], a[132:135], a[124:127], v[236:239]
  ds_read_b64_tr_b16 a[166:167], v1 offset:10816
  s_waitcnt vmcnt(11)
  v_mfma_f32_16x16x32_bf16 v[236:239], a[128:131], a[108:111], v[236:239]
  v_accvgpr_read_b32 v22, a176
  v_accvgpr_read_b32 v23, a177
  v_mfma_f32_16x16x32_bf16 v[252:255], a[136:139], a[108:111], v[252:255]
  ds_read_b64_tr_b16 a[168:169], v1 offset:96
  v_accvgpr_read_b32 v24, a178
  v_mfma_f32_16x16x32_bf16 v[252:255], a[140:143], a[124:127], v[252:255]
  s_bfe_u32 s10, s82, 0x40018
  s_mul_i32 s10, s10, 458752
  v_mfma_f32_16x16x32_bf16 v[248:251], a[140:143], a[120:123], v[248:251]
  s_add_u32 m0, s84, 57344
  ds_read_b64_tr_b16 a[170:171], v1 offset:3680
  v_mfma_f32_16x16x32_bf16 v[248:251], a[136:139], a[104:107], v[248:251]
  s_add_u32 s31, s31, 524288
  v_accvgpr_read_b32 v25, a179
  v_mfma_f32_16x16x32_bf16 v[244:247], a[136:139], a[100:103], v[244:247]
  ds_read_b64_tr_b16 a[172:173], v1 offset:7264
  buffer_load_dword a252, v0, s[16:19], s31 offen
  v_mfma_f32_16x16x32_bf16 v[244:247], a[140:143], a[116:119], v[244:247]
  v_accvgpr_read_b32 v26, a180
  v_accvgpr_read_b32 v27, a181
  v_mfma_f32_16x16x32_bf16 v[240:243], a[140:143], a[112:115], v[240:243]
  ds_read_b64_tr_b16 a[174:175], v1 offset:10848
  v_accvgpr_read_b32 v28, a182
  v_mfma_f32_16x16x32_bf16 v[240:243], a[136:139], a[96:99], v[240:243]
  v_accvgpr_read_b32 v29, a183
  s_waitcnt vmcnt(8) lgkmcnt(8)
  v_mfma_f32_16x16x32_bf16 v[32:35], a[144:147], a[0:3], v[32:35]
  ds_read_b64_tr_b16 a[128:129], v1 offset:128
  v_add_f32 v22, v22, v26
  v_mfma_f32_16x16x32_bf16 v[32:35], a[148:151], a[16:19], v[32:35]
  buffer_load_dwordx4 v3, s[16:19], s10 offen offset:0 lds
  s_barrier
  v_mfma_f32_16x16x32_bf16 v[36:39], a[148:151], a[20:23], v[36:39]
  s_add_u32 s11, s11, 4096
  ds_read_b64_tr_b16 a[130:131], v1 offset:3712
  v_mfma_f32_16x16x32_bf16 v[36:39], a[144:147], a[4:7], v[36:39]
  v_add_f32 v23, v23, v27
  v_add_f32 v24, v24, v28
  v_mfma_f32_16x16x32_bf16 v[40:43], a[144:147], a[8:11], v[40:43]
  ds_read_b64_tr_b16 a[132:133], v1 offset:7296
  v_add_f32 v25, v25, v29
  v_mfma_f32_16x16x32_bf16 v[40:43], a[148:151], a[24:27], v[40:43]
  v_accvgpr_read_b32 v26, a184
  v_accvgpr_read_b32 v27, a185
  v_mfma_f32_16x16x32_bf16 v[44:47], a[148:151], a[28:31], v[44:47]
  buffer_load_dwordx4 a[48:51], v0, s[36:39], s11 offen offset:0 sc1
  ds_read_b64_tr_b16 a[134:135], v1 offset:10880
  v_mfma_f32_16x16x32_bf16 v[44:47], a[144:147], a[12:15], v[44:47]
  v_accvgpr_read_b32 v28, a186
  v_accvgpr_read_b32 v29, a187
  v_mfma_f32_16x16x32_bf16 v[60:63], a[152:155], a[12:15], v[60:63]
  ds_read_b64_tr_b16 a[136:137], v1 offset:160
  v_add_f32 v22, v22, v26
  v_mfma_f32_16x16x32_bf16 v[60:63], a[156:159], a[28:31], v[60:63]
  v_add_f32 v23, v23, v27
  v_add_f32 v24, v24, v28
  v_mfma_f32_16x16x32_bf16 v[56:59], a[156:159], a[24:27], v[56:59]
  ds_read_b64_tr_b16 a[138:139], v1 offset:3744
  v_add_f32 v25, v25, v29
  v_mfma_f32_16x16x32_bf16 v[56:59], a[152:155], a[8:11], v[56:59]
  buffer_load_dwordx4 v4, s[16:19], s10 offen offset:1024 lds
  v_accvgpr_read_b32 v26, a188
  v_mfma_f32_16x16x32_bf16 v[52:55], a[152:155], a[4:7], v[52:55]
  ds_read_b64_tr_b16 a[140:141], v1 offset:7328
  v_accvgpr_read_b32 v27, a189
  v_mfma_f32_16x16x32_bf16 v[52:55], a[156:159], a[20:23], v[52:55]
  v_accvgpr_read_b32 v28, a190
  v_accvgpr_read_b32 v29, a191
  v_mfma_f32_16x16x32_bf16 v[48:51], a[156:159], a[16:19], v[48:51]
  ds_read_b64_tr_b16 a[142:143], v1 offset:10912
  v_add_f32 v22, v22, v26
  v_mfma_f32_16x16x32_bf16 v[48:51], a[152:155], a[0:3], v[48:51]
  v_add_f32 v23, v23, v27
  s_waitcnt lgkmcnt(8)
  v_mfma_f32_16x16x32_bf16 v[64:67], a[160:163], a[0:3], v[64:67]
  ds_read_b64_tr_b16 a[144:145], v1 offset:192
  v_add_f32 v24, v24, v28
  v_mfma_f32_16x16x32_bf16 v[64:67], a[164:167], a[16:19], v[64:67]
  v_add_f32 v25, v25, v29
  v_mov_b32 v26, v22
  v_mfma_f32_16x16x32_bf16 v[68:71], a[164:167], a[20:23], v[68:71]
  ds_read_b64_tr_b16 a[146:147], v1 offset:3776
  v_mov_b32 v27, v23
  v_mfma_f32_16x16x32_bf16 v[68:71], a[160:163], a[4:7], v[68:71]
  buffer_load_dwordx4 a[52:55], v0, s[36:39], s11 offen offset:1024 sc1
  v_mov_b32 v28, v24
  v_mfma_f32_16x16x32_bf16 v[72:75], a[160:163], a[8:11], v[72:75]
  ds_read_b64_tr_b16 a[148:149], v1 offset:7360
  v_mov_b32 v29, v25
  v_mfma_f32_16x16x32_bf16 v[72:75], a[164:167], a[24:27], v[72:75]
  v_permlane16_swap_b32 v22, v26
  v_permlane16_swap_b32 v23, v27
  v_mfma_f32_16x16x32_bf16 v[76:79], a[164:167], a[28:31], v[76:79]
  ds_read_b64_tr_b16 a[150:151], v1 offset:10944
  v_permlane16_swap_b32 v24, v28
  v_mfma_f32_16x16x32_bf16 v[76:79], a[160:163], a[12:15], v[76:79]
  v_permlane16_swap_b32 v25, v29
  v_add_f32 v22, v22, v26
  v_mfma_f32_16x16x32_bf16 v[92:95], a[168:171], a[12:15], v[92:95]
  ds_read_b64_tr_b16 a[152:153], v1 offset:14336
  v_add_f32 v23, v23, v27
  v_mfma_f32_16x16x32_bf16 v[92:95], a[172:175], a[28:31], v[92:95]
  v_add_f32 v24, v24, v28
  v_add_f32 v25, v25, v29
  v_mfma_f32_16x16x32_bf16 v[88:91], a[172:175], a[24:27], v[88:91]
  buffer_load_dwordx4 v5, s[16:19], s10 offen offset:2048 lds
  ds_read_b64_tr_b16 a[154:155], v1 offset:17920
  v_mfma_f32_16x16x32_bf16 v[88:91], a[168:171], a[8:11], v[88:91]
  v_mov_b32 v26, v22
  v_mov_b32 v27, v23
  v_mfma_f32_16x16x32_bf16 v[84:87], a[168:171], a[4:7], v[84:87]
  ds_read_b64_tr_b16 a[156:157], v1 offset:21504
  v_mov_b32 v28, v24
  v_mfma_f32_16x16x32_bf16 v[84:87], a[172:175], a[20:23], v[84:87]
  v_mov_b32 v29, v25
  v_permlane32_swap_b32 v22, v26
  v_mfma_f32_16x16x32_bf16 v[80:83], a[172:175], a[16:19], v[80:83]
  ds_read_b64_tr_b16 a[158:159], v1 offset:25088
  v_permlane32_swap_b32 v23, v27
  v_mfma_f32_16x16x32_bf16 v[80:83], a[168:171], a[0:3], v[80:83]
  v_permlane32_swap_b32 v24, v28
  s_waitcnt lgkmcnt(8)
  v_mfma_f32_16x16x32_bf16 v[96:99], a[128:131], a[0:3], v[96:99]
  ds_read_b64_tr_b16 a[160:161], v1 offset:14368
  v_permlane32_swap_b32 v25, v29
  v_mfma_f32_16x16x32_bf16 v[96:99], a[132:135], a[16:19], v[96:99]
  v_add_f32 v22, v22, v26
  v_add_f32 v23, v23, v27
  v_mfma_f32_16x16x32_bf16 v[100:103], a[132:135], a[20:23], v[100:103]
  buffer_load_dwordx4 a[56:59], v0, s[36:39], s11 offen offset:2048 sc1
  ds_read_b64_tr_b16 a[162:163], v1 offset:17952
  v_mfma_f32_16x16x32_bf16 v[100:103], a[128:131], a[4:7], v[100:103]
  v_add_f32 v24, v24, v28
  v_add_f32 v25, v25, v29
  v_mfma_f32_16x16x32_bf16 v[104:107], a[128:131], a[8:11], v[104:107]
  ds_read_b64_tr_b16 a[164:165], v1 offset:21536
  v_mul_f32 v22, 0x3a800000, v22
  v_mfma_f32_16x16x32_bf16 v[104:107], a[132:135], a[24:27], v[104:107]
  v_mul_f32 v23, 0x3a800000, v23
  v_fma_f32 v23, -v22, v22, v23
  v_mfma_f32_16x16x32_bf16 v[108:111], a[132:135], a[28:31], v[108:111]
  ds_read_b64_tr_b16 a[166:167], v1 offset:25120
  v_max_f32 v23, 0, v23
  v_mfma_f32_16x16x32_bf16 v[108:111], a[128:131], a[12:15], v[108:111]
  v_cvt_pk_bf16_f32 v23, v23, v23
  v_lshlrev_b32 v23, 16, v23
  v_mfma_f32_16x16x32_bf16 v[124:127], a[136:139], a[12:15], v[124:127]
  ds_read_b64_tr_b16 a[168:169], v1 offset:14400
  v_add_f32 v23, 0x3727c5ac, v23
  v_mfma_f32_16x16x32_bf16 v[124:127], a[140:143], a[28:31], v[124:127]
  buffer_load_dwordx4 v6, s[16:19], s10 offen offset:3072 lds
  v_cvt_pk_bf16_f32 v23, v23, v23
  v_mfma_f32_16x16x32_bf16 v[120:123], a[140:143], a[24:27], v[120:123]
  ds_read_b64_tr_b16 a[170:171], v1 offset:17984
  v_lshlrev_b32 v23, 16, v23
  v_mfma_f32_16x16x32_bf16 v[120:123], a[136:139], a[8:11], v[120:123]
  v_sqrt_f32 v23, v23
  v_mfma_f32_16x16x32_bf16 v[116:119], a[136:139], a[4:7], v[116:119]
  ds_read_b64_tr_b16 a[172:173], v1 offset:21568
  v_cvt_pk_bf16_f32 v22, v22, v22
  v_mfma_f32_16x16x32_bf16 v[116:119], a[140:143], a[20:23], v[116:119]
  v_lshlrev_b32 v22, 16, v22
  v_cvt_pk_bf16_f32 v23, v23, v23
  v_mfma_f32_16x16x32_bf16 v[112:115], a[140:143], a[16:19], v[112:115]
  ds_read_b64_tr_b16 a[174:175], v1 offset:25152
  v_lshlrev_b32 v23, 16, v23
  v_mfma_f32_16x16x32_bf16 v[112:115], a[136:139], a[0:3], v[112:115]
  v_rcp_f32 v23, v23
  s_waitcnt lgkmcnt(8)
  v_mfma_f32_16x16x32_bf16 v[128:131], a[144:147], a[0:3], v[128:131]
  ds_read_b64_tr_b16 a[128:129], v1 offset:14432
  s_nop 0
  v_mfma_f32_16x16x32_bf16 v[128:131], a[148:151], a[16:19], v[128:131]
  buffer_load_dwordx4 a[60:63], v0, s[36:39], s11 offen offset:3072 sc1
  v_mul_f32 v10, 0xbfb8aa3b, v23
  v_mfma_f32_16x16x32_bf16 v[132:135], a[148:151], a[20:23], v[132:135]
  ds_read_b64_tr_b16 a[130:131], v1 offset:18016
  v_mul_f32 v11, 0xbf317218, v23
  v_mfma_f32_16x16x32_bf16 v[132:135], a[144:147], a[4:7], v[132:135]
  v_mul_f32 v12, -v22, v23
  v_mul_f32 v24, 0x3a800000, v24
  v_mfma_f32_16x16x32_bf16 v[136:139], a[144:147], a[8:11], v[136:139]
  s_add_u32 m0, s84, 61440
  ds_read_b64_tr_b16 a[132:133], v1 offset:21600
  v_mfma_f32_16x16x32_bf16 v[136:139], a[148:151], a[24:27], v[136:139]
  v_mul_f32 v25, 0x3a800000, v25
  v_fma_f32 v25, -v24, v24, v25
  v_mfma_f32_16x16x32_bf16 v[140:143], a[148:151], a[28:31], v[140:143]
  ds_read_b64_tr_b16 a[134:135], v1 offset:25184
  v_max_f32 v25, 0, v25
  v_mfma_f32_16x16x32_bf16 v[140:143], a[144:147], a[12:15], v[140:143]
  s_add_u32 s31, s31, 524288
  v_cvt_pk_bf16_f32 v25, v25, v25
  v_mfma_f32_16x16x32_bf16 v[156:159], a[152:155], a[12:15], v[156:159]
  buffer_load_dwordx4 v7, s[16:19], s10 offen offset:0 lds
  s_bfe_u32 s11, s82, 0x40018
  v_mfma_f32_16x16x32_bf16 v[156:159], a[156:159], a[28:31], v[156:159]
  s_lshl_b32 s11, s11, 13
  s_add_u32 s11, s11, s85
  v_mfma_f32_16x16x32_bf16 v[152:155], a[156:159], a[24:27], v[152:155]
  ds_read_b64_tr_b16 a[136:137], v1 offset:14464
  ds_read_b64_tr_b16 a[138:139], v1 offset:18048
  v_mfma_f32_16x16x32_bf16 v[152:155], a[152:155], a[8:11], v[152:155]
  v_lshlrev_b32 v25, 16, v25
  v_add_f32 v25, 0x3727c5ac, v25
  v_mfma_f32_16x16x32_bf16 v[148:151], a[152:155], a[4:7], v[148:151]
  ds_read_b64_tr_b16 a[140:141], v1 offset:21632
  v_cvt_pk_bf16_f32 v25, v25, v25
  v_mfma_f32_16x16x32_bf16 v[148:151], a[156:159], a[20:23], v[148:151]
  buffer_load_dwordx4 a[64:67], v0, s[36:39], s11 offen offset:0 sc1
  v_lshlrev_b32 v25, 16, v25
  v_mfma_f32_16x16x32_bf16 v[144:147], a[156:159], a[16:19], v[144:147]
  ds_read_b64_tr_b16 a[142:143], v1 offset:25216
  v_sqrt_f32 v25, v25
  v_mfma_f32_16x16x32_bf16 v[144:147], a[152:155], a[0:3], v[144:147]
  v_cvt_pk_bf16_f32 v24, v24, v24
  s_waitcnt lgkmcnt(8)
  v_mfma_f32_16x16x32_bf16 v[160:163], a[160:163], a[0:3], v[160:163]
  ds_read_b64_tr_b16 a[144:145], v1 offset:14496
  v_lshlrev_b32 v24, 16, v24
  v_mfma_f32_16x16x32_bf16 v[160:163], a[164:167], a[16:19], v[160:163]
  v_cvt_pk_bf16_f32 v25, v25, v25
  v_lshlrev_b32 v25, 16, v25
  v_mfma_f32_16x16x32_bf16 v[164:167], a[164:167], a[20:23], v[164:167]
  buffer_load_dword a252, v0, s[16:19], s31 offen
  ds_read_b64_tr_b16 a[146:147], v1 offset:18080
  v_mfma_f32_16x16x32_bf16 v[164:167], a[160:163], a[4:7], v[164:167]
  v_rcp_f32 v25, v25
  v_mfma_f32_16x16x32_bf16 v[168:171], a[160:163], a[8:11], v[168:171]
  ds_read_b64_tr_b16 a[148:149], v1 offset:21664
  s_nop 0
  v_mfma_f32_16x16x32_bf16 v[168:171], a[164:167], a[24:27], v[168:171]
  v_mul_f32 v13, 0xbfb8aa3b, v25
  v_mul_f32 v14, 0xbf317218, v25
  v_mfma_f32_16x16x32_bf16 v[172:175], a[164:167], a[28:31], v[172:175]
  ds_read_b64_tr_b16 a[150:151], v1 offset:25248
  v_mul_f32 v15, -v24, v25
  v_mfma_f32_16x16x32_bf16 v[172:175], a[160:163], a[12:15], v[172:175]
  buffer_load_dwordx4 v8, s[16:19], s10 offen offset:1024 lds
  s_waitcnt vmcnt(15)
  s_barrier
  v_mfma_f32_16x16x32_bf16 v[188:191], a[168:171], a[12:15], v[188:191]
  ds_read_b64_tr_b16 a[152:153], v1 offset:14528
CT12:
  s_add_u32 s94, s92, CT12-k3_main_kernel+3072
  s_addc_u32 s95, s93, 0
  v_mfma_f32_16x16x32_bf16 v[188:191], a[172:175], a[28:31], v[188:191]
  v_accvgpr_read_b32 v22, a192
  v_accvgpr_read_b32 v23, a193
  v_mfma_f32_16x16x32_bf16 v[184:187], a[172:175], a[24:27], v[184:187]
  ds_read_b64_tr_b16 a[154:155], v1 offset:18112
  v_accvgpr_read_b32 v24, a194
  v_mfma_f32_16x16x32_bf16 v[184:187], a[168:171], a[8:11], v[184:187]
  v_accvgpr_read_b32 v25, a195
  v_accvgpr_read_b32 v26, a196
  v_mfma_f32_16x16x32_bf16 v[180:183], a[168:171], a[4:7], v[180:183]
  buffer_load_dwordx4 a[68:71], v0, s[36:39], s11 offen offset:1024 sc1
  ds_read_b64_tr_b16 a[156:157], v1 offset:21696
  v_mfma_f32_16x16x32_bf16 v[180:183], a[172:175], a[20:23], v[180:183]
  v_accvgpr_read_b32 v27, a197
  v_accvgpr_read_b32 v28, a198
  v_mfma_f32_16x16x32_bf16 v[176:179], a[172:175], a[16:19], v[176:179]
  ds_read_b64_tr_b16 a[158:159], v1 offset:25280
  v_accvgpr_read_b32 v29, a199
  v_mfma_f32_16x16x32_bf16 v[176:179], a[168:171], a[0:3], v[176:179]
  v_add_f32 v22, v22, v26
  s_waitcnt lgkmcnt(8)
  v_mfma_f32_16x16x32_bf16 v[192:195], a[128:131], a[0:3], v[192:195]
  ds_read_b64_tr_b16 a[160:161], v1 offset:28672
  v_add_f32 v23, v23, v27
  v_mfma_f32_16x16x32_bf16 v[192:195], a[132:135], a[16:19], v[192:195]
  global_load_dword a252, v0, s[94:95]
  v_add_f32 v24, v24, v28
  v_mfma_f32_16x16x32_bf16 v[196:199], a[132:135], a[20:23], v[196:199]
  ds_read_b64_tr_b16 a[162:163], v1 offset:32256
  v_add_f32 v25, v25, v29
  v_mfma_f32_16x16x32_bf16 v[196:199], a[128:131], a[4:7], v[196:199]
  v_accvgpr_read_b32 v26, a200
  v_accvgpr_read_b32 v27, a201
  v_mfma_f32_16x16x32_bf16 v[200:203], a[128:131], a[8:11], v[200:203]
  ds_read_b64_tr_b16 a[164:165], v1 offset:35840
  v_accvgpr_read_b32 v28, a202
  v_mfma_f32_16x16x32_bf16 v[200:203], a[132:135], a[24:27], v[200:203]
  v_accvgpr_read_b32 v29, a203
  v_add_f32 v22, v22, v26
  v_mfma_f32_16x16x32_bf16 v[204:207], a[132:135], a[28:31], v[204:207]
  buffer_load_dwordx4 v9, s[16:19], s10 offen offset:2048 lds
  ds_read_b64_tr_b16 a[166:167], v1 offset:39424
  v_mfma_f32_16x16x32_bf16 v[204:207], a[128:131], a[12:15], v[204:207]
  v_add_f32 v23, v23, v27
  v_add_f32 v24, v24, v28
  v_mfma_f32_16x16x32_bf16 v[220:223], a[136:139], a[12:15], v[220:223]
  ds_read_b64_tr_b16 a[168:169], v1 offset:28704
  v_add_f32 v25, v25, v29
  v_mfma_f32_16x16x32_bf16 v[220:223], a[140:143], a[28:31], v[220:223]
  v_accvgpr_read_b32 v26, a204
  v_accvgpr_read_b32 v27, a205
  v_mfma_f32_16x16x32_bf16 v[216:219], a[140:143], a[24:27], v[216:219]
  ds_read_b64_tr_b16 a[170:171], v1 offset:32288
  v_accvgpr_read_b32 v28, a206
  v_mfma_f32_16x16x32_bf16 v[216:219], a[136:139], a[8:11], v[216:219]
  buffer_load_dwordx4 a[72:75], v0, s[36:39], s11 offen offset:2048 sc1
  v_accvgpr_read_b32 v29, a207
  v_mfma_f32_16x16x32_bf16 v[212:215], a[136:139], a[4:7], v[212:215]
  ds_read_b64_tr_b16 a[172:173], v1 offset:35872
  v_add_f32 v22, v22, v26
  v_mfma_f32_16x16x32_bf16 v[212:215], a[140:143], a[20:23], v[212:215]
  v_add_f32 v23, v23, v27
  v_add_f32 v24, v24, v28
  v_mfma_f32_16x16x32_bf16 v[208:211], a[140:143], a[16:19], v[208:211]
  ds_read_b64_tr_b16 a[174:175], v1 offset:39456
  v_add_f32 v25, v25, v29
  v_mfma_f32_16x16x32_bf16 v[208:211], a[136:139], a[0:3], v[208:211]
  v_mov_b32 v26, v22
  s_waitcnt lgkmcnt(8)
  v_mfma_f32_16x16x32_bf16 v[224:227], a[144:147], a[0:3], v[224:227]
  ds_read_b64_tr_b16 a[128:129], v1 offset:28736
  v_mov_b32 v27, v23
  v_mfma_f32_16x16x32_bf16 v[224:227], a[148:151], a[16:19], v[224:227]
  v_mov_b32 v28, v24
  v_mov_b32 v29, v25
  v_mfma_f32_16x16x32_bf16 v[228:231], a[148:151], a[20:23], v[228:231]
  ds_read_b64_tr_b16 a[130:131], v1 offset:32320
  v_permlane16_swap_b32 v22, v26
  v_mfma_f32_16x16x32_bf16 v[228:231], a[144:147], a[4:7], v[228:231]
  v_permlane16_swap_b32 v23, v27
  v_permlane16_swap_b32 v24, v28
  v_mfma_f32_16x16x32_bf16 v[232:235], a[144:147], a[8:11], v[232:235]
  ds_read_b64_tr_b16 a[132:133], v1 offset:35904
  v_permlane16_swap_b32 v25, v29
  v_mfma_f32_16x16x32_bf16 v[232:235], a[148:151], a[24:27], v[232:235]
  buffer_load_dwordx4 a[76:79], v0, s[36:39], s11 offen offset:3072 sc1
  v_add_f32 v22, v22, v26
  v_mfma_f32_16x16x32_bf16 v[236:239], a[148:151], a[28:31], v[236:239]
  ds_read_b64_tr_b16 a[134:135], v1 offset:39488
  v_add_f32 v23, v23, v27
  v_mfma_f32_16x16x32_bf16 v[236:239], a[144:147], a[12:15], v[236:239]
  v_add_f32 v24, v24, v28
  v_add_f32 v25, v25, v29
  v_mfma_f32_16x16x32_bf16 v[252:255], a[152:155], a[12:15], v[252:255]
  ds_read_b64_tr_b16 a[136:137], v1 offset:28768
  v_mov_b32 v26, v22
  v_mfma_f32_16x16x32_bf16 v[252:255], a[156:159], a[28:31], v[252:255]
  s_bfe_u32 s10, s82, 0x4001c
  s_mul_i32 s10, s10, 458752
  v_mfma_f32_16x16x32_bf16 v[248:251], a[156:159], a[24:27], v[248:251]
  s_add_u32 m0, s84, 86016
  buffer_load_dwordx4 a[208:211], v0, s[36:39], s20 offen offset:0 sc1
  v_mfma_f32_16x16x32_bf16 v[248:251], a[152:155], a[8:11], v[248:251]
  ds_read_b64_tr_b16 a[138:139], v1 offset:32352
  v_mov_b32 v27, v23
  v_mfma_f32_16x16x32_bf16 v[244:247], a[152:155], a[4:7], v[244:247]
  ds_read_b64_tr_b16 a[140:141], v1 offset:35936
  v_mov_b32 v28, v24
  v_mfma_f32_16x16x32_bf16 v[244:247], a[156:159], a[20:23], v[244:247]
  v_mov_b32 v29, v25
  v_permlane32_swap_b32 v22, v26
  v_mfma_f32_16x16x32_bf16 v[240:243], a[156:159], a[16:19], v[240:243]
  ds_read_b64_tr_b16 a[142:143], v1 offset:39520
  v_permlane32_swap_b32 v23, v27
  v_mfma_f32_16x16x32_bf16 v[240:243], a[152:155], a[0:3], v[240:243]
  buffer_load_dwordx4 a[212:215], v0, s[36:39], s20 offen offset:1024 sc1
  s_waitcnt vmcnt(11) lgkmcnt(8)
  v_mfma_f32_16x16x32_bf16 v[32:35], a[160:163], a[32:35], v[32:35]
  ds_read_b64_tr_b16 a[144:145], v1 offset:28800
  v_permlane32_swap_b32 v24, v28
  v_mfma_f32_16x16x32_bf16 v[32:35], a[164:167], a[48:51], v[32:35]
  v_permlane32_swap_b32 v25, v29
  s_barrier
  v_mfma_f32_16x16x32_bf16 v[36:39], a[164:167], a[52:55], v[36:39]
  ds_read_b64_tr_b16 a[146:147], v1 offset:32384
  v_add_f32 v22, v22, v26
  v_mfma_f32_16x16x32_bf16 v[36:39], a[160:163], a[36:39], v[36:39]
  v_add_f32 v23, v23, v27
  v_add_f32 v24, v24, v28
  v_mfma_f32_16x16x32_bf16 v[40:43], a[160:163], a[40:43], v[40:43]
  buffer_load_dwordx4 v3, s[16:19], s10 offen offset:0 lds
  s_add_u32 s11, s11, 4096
  v_mfma_f32_16x16x32_bf16 v[40:43], a[164:167], a[56:59], v[40:43]
  ds_read_b64_tr_b16 a[148:149], v1 offset:35968
  s_add_u32 s31, s31, 524288
  v_mfma_f32_16x16x32_bf16 v[44:47], a[164:167], a[60:63], v[44:47]
  ds_read_b64_tr_b16 a[150:151], v1 offset:39552
  v_add_f32 v25, v25, v29
  v_mfma_f32_16x16x32_bf16 v[44:47], a[160:163], a[44:47], v[44:47]
  v_mul_f32 v22, 0x3a800000, v22
  v_mul_f32 v23, 0x3a800000, v23
  v_mfma_f32_16x16x32_bf16 v[60:63], a[168:171], a[44:47], v[60:63]
  ds_read_b64_tr_b16 a[152:153], v1 offset:28832
  v_fma_f32 v23, -v22, v22, v23
  v_mfma_f32_16x16x32_bf16 v[60:63], a[172:175], a[60:63], v[60:63]
  buffer_load_dwordx4 a[80:83], v0, s[36:39], s11 offen offset:0 sc1
  v_max_f32 v23, 0, v23
  v_mfma_f32_16x16x32_bf16 v[56:59], a[172:175], a[56:59], v[56:59]
  ds_read_b64_tr_b16 a[154:155], v1 offset:32416
  v_cvt_pk_bf16_f32 v23, v23, v23
  v_mfma_f32_16x16x32_bf16 v[56:59], a[168:171], a[40:43], v[56:59]
  v_lshlrev_b32 v23, 16, v23
  v_add_f32 v23, 0x3727c5ac, v23
  v_mfma_f32_16x16x32_bf16 v[52:55], a[168:171], a[36:39], v[52:55]
  ds_read_b64_tr_b16 a[156:157], v1 offset:36000
  v_cvt_pk_bf16_f32 v23, v23, v23
  v_mfma_f32_16x16x32_bf16 v[52:55], a[172:175], a[52:55], v[52:55]
  v_lshlrev_b32 v23, 16, v23
  v_sqrt_f32 v23, v23
  v_mfma_f32_16x16x32_bf16 v[48:51], a[172:175], a[48:51], v[48:51]
  buffer_load_dword a252, v0, s[16:19], s31 offen
  ds_read_b64_tr_b16 a[158:159], v1 offset:39584
  v_mfma_f32_16x16x32_bf16 v[48:51], a[168:171], a[32:35], v[48:51]
  v_cvt_pk_bf16_f32 v22, v22, v22
  s_waitcnt lgkmcnt(8)
  v_mfma_f32_16x16x32_bf16 v[64:67], a[128:131], a[32:35], v[64:67]
  ds_read_b64_tr_b16 a[160:161], v1 offset:28864
  v_lshlrev_b32 v22, 16, v22
  v_mfma_f32_16x16x32_bf16 v[64:67], a[132:135], a[48:51], v[64:67]
  v_cvt_pk_bf16_f32 v23, v23, v23
  v_lshlrev_b32 v23, 16, v23
  v_mfma_f32_16x16x32_bf16 v[68:71], a[132:135], a[52:55], v[68:71]
  ds_read_b64_tr_b16 a[162:163], v1 offset:32448
  v_rcp_f32 v23, v23
  v_mfma_f32_16x16x32_bf16 v[68:71], a[128:131], a[36:39], v[68:71]
  buffer_load_dwordx4 v4, s[16:19], s10 offen offset:1024 lds
  s_nop 0
  v_mfma_f32_16x16x32_bf16 v[72:75], a[128:131], a[40:43], v[72:75]
  ds_read_b64_tr_b16 a[164:165], v1 offset:36032
  v_mul_f32 v16, 0xbfb8aa3b, v23
  v_mfma_f32_16x16x32_bf16 v[72:75], a[132:135], a[56:59], v[72:75]
  v_mul_f32 v17, 0xbf317218, v23
  v_mul_f32 v18, -v22, v23
  v_mfma_f32_16x16x32_bf16 v[76:79], a[132:135], a[60:63], v[76:79]
  ds_read_b64_tr_b16 a[166:167], v1 offset:39616
  v_mul_f32 v24, 0x3a800000, v24
  v_mfma_f32_16x16x32_bf16 v[76:79], a[128:131], a[44:47], v[76:79]
  v_mul_f32 v25, 0x3a800000, v25
  v_fma_f32 v25, -v24, v24, v25
  v_mfma_f32_16x16x32_bf16 v[92:95], a[136:139], a[44:47], v[92:95]
  buffer_load_dwordx4 a[84:87], v0, s[36:39], s11 offen offset:1024 sc1
  ds_read_b64_tr_b16 a[168:169], v1 offset:43008
  v_mfma_f32_16x16x32_bf16 v[92:95], a[140:143], a[60:63], v[92:95]
  v_max_f32 v25, 0, v25
  v_cvt_pk_bf16_f32 v25, v25, v25
  v_mfma_f32_16x16x32_bf16 v[88:91], a[140:143], a[56:59], v[88:91]
  ds_read_b64_tr_b16 a[170:171], v1 offset:46592
  v_lshlrev_b32 v25, 16, v25
  v_mfma_f32_16x16x32_bf16 v[88:91], a[136:139], a[40:43], v[88:91]
  v_add_f32 v25, 0x3727c5ac, v25
  v_cvt_pk_bf16_f32 v25, v25, v25
  v_mfma_f32_16x16x32_bf16 v[84:87], a[136:139], a[36:39], v[84:87]
  ds_read_b64_tr_b16 a[172:173], v1 offset:50176
  v_lshlrev_b32 v25, 16, v25
  v_mfma_f32_16x16x32_bf16 v[84:87], a[140:143], a[52:55], v[84:87]
  buffer_load_dwordx4 v5, s[16:19], s10 offen offset:2048 lds
  v_sqrt_f32 v25, v25
  v_mfma_f32_16x16x32_bf16 v[80:83], a[140:143], a[48:51], v[80:83]
  ds_read_b64_tr_b16 a[174:175], v1 offset:53760
  v_cvt_pk_bf16_f32 v24, v24, v24
  v_mfma_f32_16x16x32_bf16 v[80:83], a[136:139], a[32:35], v[80:83]
  v_lshlrev_b32 v24, 16, v24
  s_waitcnt lgkmcnt(8)
  v_mfma_f32_16x16x32_bf16 v[96:99], a[144:147], a[32:35], v[96:99]
  ds_read_b64_tr_b16 a[128:129], v1 offset:43040
  v_cvt_pk_bf16_f32 v25, v25, v25
  v_mfma_f32_16x16x32_bf16 v[96:99], a[148:151], a[48:51], v[96:99]
  v_lshlrev_b32 v25, 16, v25
  v_rcp_f32 v25, v25
  v_mfma_f32_16x16x32_bf16 v[100:103], a[148:151], a[52:55], v[100:103]
  buffer_load_dwordx4 a[88:91], v0, s[36:39], s11 offen offset:2048 sc1
  ds_read_b64_tr_b16 a[130:131], v1 offset:46624
  v_mfma_f32_16x16x32_bf16 v[100:103], a[144:147], a[36:39], v[100:103]
  s_nop 0
  v_mul_f32 v19, 0xbfb8aa3b, v25
  v_mfma_f32_16x16x32_bf16 v[104:107], a[144:147], a[40:43], v[104:107]
  ds_read_b64_tr_b16 a[132:133], v1 offset:50208
  v_mul_f32 v20, 0xbf317218, v25
  v_mfma_f32_16x16x32_bf16 v[104:107], a[148:151], a[56:59], v[104:107]
  v_mul_f32 v21, -v24, v25
  v_add_u32 v31, 57344, v31
  v_mfma_f32_16x16x32_bf16 v[108:111], a[148:151], a[60:63], v[108:111]
  ds_read_b64_tr_b16 a[134:135], v1 offset:53792
  v_mfma_f32_16x16x32_bf16 v[108:111], a[144:147], a[44:47], v[108:111]
  v_mfma_f32_16x16x32_bf16 v[124:127], a[152:155], a[44:47], v[124:127]
  ds_read_b64_tr_b16 a[136:137], v1 offset:43072
  v_mfma_f32_16x16x32_bf16 v[124:127], a[156:159], a[60:63], v[124:127]
  buffer_load_dwordx4 v6, s[16:19], s10 offen offset:3072 lds
  v_mfma_f32_16x16x32_bf16 v[120:123], a[156:159], a[56:59], v[120:123]
  ds_read_b64_tr_b16 a[138:139], v1 offset:46656
  v_mfma_f32_16x16x32_bf16 v[120:123], a[152:155], a[40:43], v[120:123]
  v_mfma_f32_16x16x32_bf16 v[116:119], a[152:155], a[36:39], v[116:119]
  ds_read_b64_tr_b16 a[140:141], v1 offset:50240
  v_mfma_f32_16x16x32_bf16 v[116:119], a[156:159], a[52:55], v[116:119]
  v_mfma_f32_16x16x32_bf16 v[112:115], a[156:159], a[48:51], v[112:115]
  ds_read_b64_tr_b16 a[142:143], v1 offset:53824
  v_mfma_f32_16x16x32_bf16 v[112:115], a[152:155], a[32:35], v[112:115]
  s_waitcnt lgkmcnt(8)
  v_mfma_f32_16x16x32_bf16 v[128:131], a[160:163], a[32:35], v[128:131]
  ds_read_b64_tr_b16 a[144:145], v1 offset:43104
  v_mfma_f32_16x16x32_bf16 v[128:131], a[164:167], a[48:51], v[128:131]
  buffer_load_dwordx4 a[92:95], v0, s[36:39], s11 offen offset:3072 sc1
  v_mfma_f32_16x16x32_bf16 v[132:135], a[164:167], a[52:55], v[132:135]
  ds_read_b64_tr_b16 a[146:147], v1 offset:46688
  v_mfma_f32_16x16x32_bf16 v[132:135], a[160:163], a[36:39], v[132:135]
  v_mfma_f32_16x16x32_bf16 v[136:139], a[160:163], a[40:43], v[136:139]
  s_add_u32 m0, s84, 90112
  ds_read_b64_tr_b16 a[148:149], v1 offset:50272
  v_mfma_f32_16x16x32_bf16 v[136:139], a[164:167], a[56:59], v[136:139]
  v_mfma_f32_16x16x32_bf16 v[140:143], a[164:167], a[60:63], v[140:143]
  ds_read_b64_tr_b16 a[150:151], v1 offset:53856
  v_mfma_f32_16x16x32_bf16 v[140:143], a[160:163], a[44:47], v[140:143]
  v_mfma_f32_16x16x32_bf16 v[156:159], a[168:171], a[44:47], v[156:159]
  buffer_load_dwordx4 v7, s[16:19], s10 offen offset:0 lds
  s_bfe_u32 s11, s82, 0x4001c
  v_mfma_f32_16x16x32_bf16 v[156:159], a[172:175], a[60:63], v[156:159]
  s_lshl_b32 s11, s11, 13
  s_add_u32 s11, s11, s85
  v_mfma_f32_16x16x32_bf16 v[152:155], a[172:175], a[56:59], v[152:155]
  ds_read_b64_tr_b16 a[152:153], v1 offset:43136
  ds_read_b64_tr_b16 a[154:155], v1 offset:46720
  v_mfma_f32_16x16x32_bf16 v[152:155], a[168:171], a[40:43], v[152:155]
  v_mfma_f32_16x16x32_bf16 v[148:151], a[168:171], a[36:39], v[148:151]
  ds_read_b64_tr_b16 a[156:157], v1 offset:50304
  v_mfma_f32_16x16x32_bf16 v[148:151], a[172:175], a[52:55], v[148:151]
  buffer_load_dwordx4 a[96:99], v0, s[36:39], s11 offen offset:0 sc1
  v_mfma_f32_16x16x32_bf16 v[144:147], a[172:175], a[48:51], v[144:147]
  ds_read_b64_tr_b16 a[158:159], v1 offset:53888
  v_mfma_f32_16x16x32_bf16 v[144:147], a[168:171], a[32:35], v[144:147]
  s_waitcnt lgkmcnt(8)
  v_mfma_f32_16x16x32_bf16 v[160:163], a[128:131], a[32:35], v[160:163]
  ds_read_b64_tr_b16 a[160:161], v1 offset:43168
  v_mfma_f32_16x16x32_bf16 v[160:163], a[132:135], a[48:51], v[160:163]
  s_add_u32 s31, s31, 524288
  v_mfma_f32_16x16x32_bf16 v[164:167], a[132:135], a[52:55], v[164:167]
  ds_read_b64_tr_b16 a[162:163], v1 offset:46752
  v_mfma_f32_16x16x32_bf16 v[164:167], a[128:131], a[36:39], v[164:167]
  buffer_load_dword a252, v0, s[16:19], s31 offen
  v_mfma_f32_16x16x32_bf16 v[168:171], a[128:131], a[40:43], v[168:171]
  ds_read_b64_tr_b16 a[164:165], v1 offset:50336
  v_mfma_f32_16x16x32_bf16 v[168:171], a[132:135], a[56:59], v[168:171]
  v_mfma_f32_16x16x32_bf16 v[172:175], a[132:135], a[60:63], v[172:175]
  ds_read_b64_tr_b16 a[166:167], v1 offset:53920
  v_mfma_f32_16x16x32_bf16 v[172:175], a[128:131], a[44:47], v[172:175]
  s_waitcnt vmcnt(16)
  s_barrier
  v_mfma_f32_16x16x32_bf16 v[188:191], a[136:139], a[44:47], v[188:191]
  buffer_load_dwordx4 v8, s[16:19], s10 offen offset:1024 lds
  ds_read_b64_tr_b16 a[168:169], v1 offset:43200
  v_mfma_f32_16x16x32_bf16 v[188:191], a[140:143], a[60:63], v[188:191]
  v_mfma_f32_16x16x32_bf16 v[184:187], a[140:143], a[56:59], v[184:187]
  ds_read_b64_tr_b16 a[170:171], v1 offset:46784
  v_mfma_f32_16x16x32_bf16 v[184:187], a[136:139], a[40:43], v[184:187]
  v_mfma_f32_16x16x32_bf16 v[180:183], a[136:139], a[36:39], v[180:183]
  ds_read_b64_tr_b16 a[172:173], v1 offset:50368
  v_mfma_f32_16x16x32_bf16 v[180:183], a[140:143], a[52:55], v[180:183]
  buffer_load_dwordx4 a[100:103], v0, s[36:39], s11 offen offset:1024 sc1
  v_mfma_f32_16x16x32_bf16 v[176:179], a[140:143], a[48:51], v[176:179]
  ds_read_b64_tr_b16 a[174:175], v1 offset:53952
  v_mfma_f32_16x16x32_bf16 v[176:179], a[136:139], a[32:35], v[176:179]
  s_waitcnt lgkmcnt(8)
  v_mfma_f32_16x16x32_bf16 v[192:195], a[144:147], a[32:35], v[192:195]
  ds_read_b64_tr_b16 a[128:129], v2 offset:0
  v_mfma_f32_16x16x32_bf16 v[192:195], a[148:151], a[48:51], v[192:195]
  v_mfma_f32_16x16x32_bf16 v[196:199], a[148:151], a[52:55], v[196:199]
  ds_read_b64_tr_b16 a[130:131], v2 offset:3584
  v_mfma_f32_16x16x32_bf16 v[196:199], a[144:147], a[36:39], v[196:199]
  v_mfma_f32_16x16x32_bf16 v[200:203], a[144:147], a[40:43], v[200:203]
  ds_read_b64_tr_b16 a[132:133], v2 offset:7168
  ds_read_b64_tr_b16 a[176:177], v31 offset:0
  v_mfma_f32_16x16x32_bf16 v[200:203], a[148:151], a[56:59], v[200:203]
  v_mfma_f32_16x16x32_bf16 v[204:207], a[148:151], a[60:63], v[204:207]
  buffer_load_dwordx4 v9, s[16:19], s10 offen offset:2048 lds
  ds_read_b64_tr_b16 a[134:135], v2 offset:10752
  v_mfma_f32_16x16x32_bf16 v[204:207], a[144:147], a[44:47], v[204:207]
  ds_read_b64_tr_b16 a[178:179], v31 offset:3584
  v_mfma_f32_16x16x32_bf16 v[220:223], a[152:155], a[44:47], v[220:223]
  ds_read_b64_tr_b16 a[136:137], v2 offset:32
  ds_read_b64_tr_b16 a[180:181], v31 offset:7168
  v_mfma_f32_16x16x32_bf16 v[220:223], a[156:159], a[60:63], v[220:223]
  v_mfma_f32_16x16x32_bf16 v[216:219], a[156:159], a[56:59], v[216:219]
  ds_read_b64_tr_b16 a[138:139], v2 offset:3616
  ds_read_b64_tr_b16 a[182:183], v31 offset:10752
  v_mfma_f32_16x16x32_bf16 v[216:219], a[152:155], a[40:43], v[216:219]
  buffer_load_dwordx4 a[104:107], v0, s[36:39], s11 offen offset:2048 sc1
  v_mfma_f32_16x16x32_bf16 v[212:215], a[152:155], a[36:39], v[212:215]
  ds_read_b64_tr_b16 a[140:141], v2 offset:7200
  ds_read_b64_tr_b16 a[184:185], v31 offset:32
  v_mfma_f32_16x16x32_bf16 v[212:215], a[156:159], a[52:55], v[212:215]
  v_mfma_f32_16x16x32_bf16 v[208:211], a[156:159], a[48:51], v[208:211]
  ds_read_b64_tr_b16 a[142:143], v2 offset:10784
  ds_read_b64_tr_b16 a[186:187], v31 offset:3616
  v_mfma_f32_16x16x32_bf16 v[208:211], a[152:155], a[32:35], v[208:211]
  s_waitcnt lgkmcnt(14)
  v_mfma_f32_16x16x32_bf16 v[224:227], a[160:163], a[32:35], v[224:227]
  ds_read_b64_tr_b16 a[144:145], v2 offset:64
  ds_read_b64_tr_b16 a[188:189], v31 offset:7200
  v_mfma_f32_16x16x32_bf16 v[224:227], a[164:167], a[48:51], v[224:227]
  v_mfma_f32_16x16x32_bf16 v[228:231], a[164:167], a[52:55], v[228:231]
  ds_read_b64_tr_b16 a[146:147], v2 offset:3648
  ds_read_b64_tr_b16 a[190:191], v31 offset:10784
  v_mfma_f32_16x16x32_bf16 v[228:231], a[160:163], a[36:39], v[228:231]
  v_mfma_f32_16x16x32_bf16 v[232:235], a[160:163], a[40:43], v[232:235]
  ds_read_b64_tr_b16 a[148:149], v2 offset:7232
  ds_read_b64_tr_b16 a[192:193], v31 offset:64
  v_mfma_f32_16x16x32_bf16 v[232:235], a[164:167], a[56:59], v[232:235]
  buffer_load_dwordx4 a[108:111], v0, s[36:39], s11 offen offset:3072 sc1
  v_mfma_f32_16x16x32_bf16 v[236:239], a[164:167], a[60:63], v[236:239]
  ds_read_b64_tr_b16 a[150:151], v2 offset:10816
  ds_read_b64_tr_b16 a[194:195], v31 offset:3648
  v_mfma_f32_16x16x32_bf16 v[236:239], a[160:163], a[44:47], v[236:239]
  v_mfma_f32_16x16x32_bf16 v[252:255], a[168:171], a[44:47], v[252:255]
  ds_read_b64_tr_b16 a[152:153], v2 offset:96
  ds_read_b64_tr_b16 a[196:197], v31 offset:7232
  v_mfma_f32_16x16x32_bf16 v[252:255], a[172:175], a[60:63], v[252:255]
  s_bfe_u32 s10, s83, 0x40000
  s_mul_i32 s10, s10, 458752
  v_mfma_f32_16x16x32_bf16 v[248:251], a[172:175], a[56:59], v[248:251]
  s_add_u32 m0, s84, 0
  ds_read_b64_tr_b16 a[154:155], v2 offset:3680
  v_mfma_f32_16x16x32_bf16 v[248:251], a[168:171], a[40:43], v[248:251]
  ds_read_b64_tr_b16 a[198:199], v31 offset:10816
  v_mfma_f32_16x16x32_bf16 v[244:247], a[168:171], a[36:39], v[244:247]
  ds_read_b64_tr_b16 a[156:157], v2 offset:7264
  ds_read_b64_tr_b16 a[200:201], v31 offset:96
  v_mfma_f32_16x16x32_bf16 v[244:247], a[172:175], a[52:55], v[244:247]
  buffer_load_dwordx4 v3, s[16:19], s10 offen offset:0 lds
  v_mfma_f32_16x16x32_bf16 v[240:243], a[172:175], a[48:51], v[240:243]
  ds_read_b64_tr_b16 a[158:159], v2 offset:10848
  ds_read_b64_tr_b16 a[202:203], v31 offset:3680
  v_mfma_f32_16x16x32_bf16 v[240:243], a[168:171], a[32:35], v[240:243]
  s_waitcnt vmcnt(9) lgkmcnt(15)
  v_mfma_f32_16x16x32_bf16 v[32:35], a[128:131], a[64:67], v[32:35]
  s_add_u32 s11, s11, 4096
  ds_read_b64_tr_b16 a[204:205], v31 offset:7264
  v_mfma_f32_16x16x32_bf16 v[32:35], a[132:135], a[80:83], v[32:35]
  s_barrier
  v_mfma_f32_16x16x32_bf16 v[36:39], a[132:135], a[84:87], v[36:39]
  ds_read_b64_tr_b16 a[206:207], v31 offset:10848
  v_mfma_f32_16x16x32_bf16 v[36:39], a[128:131], a[68:71], v[36:39]
  v_mfma_f32_16x16x32_bf16 v[40:43], a[128:131], a[72:75], v[40:43]
  buffer_load_dwordx4 a[112:115], v0, s[36:39], s11 offen offset:0 sc1
  v_mfma_f32_16x16x32_bf16 v[40:43], a[132:135], a[88:91], v[40:43]
  v_mfma_f32_16x16x32_bf16 v[44:47], a[132:135], a[92:95], v[44:47]
  v_mfma_f32_16x16x32_bf16 v[44:47], a[128:131], a[76:79], v[44:47]
  v_mfma_f32_16x16x32_bf16 v[60:63], a[136:139], a[76:79], v[60:63]
  ds_read_b64_tr_b16 a[160:161], v2 offset:128
  v_mfma_f32_16x16x32_bf16 v[60:63], a[140:143], a[92:95], v[60:63]
  v_mfma_f32_16x16x32_bf16 v[56:59], a[140:143], a[88:91], v[56:59]
  ds_read_b64_tr_b16 a[162:163], v2 offset:3712
  v_mfma_f32_16x16x32_bf16 v[56:59], a[136:139], a[72:75], v[56:59]
  buffer_load_dwordx4 v4, s[16:19], s10 offen offset:1024 lds
  v_mfma_f32_16x16x32_bf16 v[52:55], a[136:139], a[68:71], v[52:55]
  ds_read_b64_tr_b16 a[164:165], v2 offset:7296
  v_mfma_f32_16x16x32_bf16 v[52:55], a[140:143], a[84:87], v[52:55]
  v_mfma_f32_16x16x32_bf16 v[48:51], a[140:143], a[80:83], v[48:51]
  ds_read_b64_tr_b16 a[166:167], v2 offset:10880
  v_mfma_f32_16x16x32_bf16 v[48:51], a[136:139], a[64:67], v[48:51]
  s_waitcnt lgkmcnt(7)
  v_mfma_f32_16x16x32_bf16 v[64:67], a[144:147], a[64:67], v[64:67]
  ds_read_b64_tr_b16 a[168:169], v2 offset:160
  v_mfma_f32_16x16x32_bf16 v[64:67], a[148:151], a[80:83], v[64:67]
  v_mfma_f32_16x16x32_bf16 v[68:71], a[148:151], a[84:87], v[68:71]
  ds_read_b64_tr_b16 a[170:171], v2 offset:3744
  v_mfma_f32_16x16x32_bf16 v[68:71], a[144:147], a[68:71], v[68:71]
  buffer_load_dwordx4 a[116:119], v0, s[36:39], s11 offen offset:1024 sc1
  v_mfma_f32_16x16x32_bf16 v[72:75], a[144:147], a[72:75], v[72:75]
  ds_read_b64_tr_b16 a[172:173], v2 offset:7328
  v_mfma_f32_16x16x32_bf16 v[72:75], a[148:151], a[88:91], v[72:75]
  v_mfma_f32_16x16x32_bf16 v[76:79], a[148:151], a[92:95], v[76:79]
  ds_read_b64_tr_b16 a[174:175], v2 offset:10912
  v_mfma_f32_16x16x32_bf16 v[76:79], a[144:147], a[76:79], v[76:79]
  v_mfma_f32_16x16x32_bf16 v[92:95], a[152:155], a[76:79], v[92:95]
  ds_read_b64_tr_b16 a[128:129], v2 offset:192
  v_mfma_f32_16x16x32_bf16 v[92:95], a[156:159], a[92:95], v[92:95]
  v_mfma_f32_16x16x32_bf16 v[88:91], a[156:159], a[88:91], v[88:91]
  buffer_load_dwordx4 v5, s[16:19], s10 offen offset:2048 lds
  ds_read_b64_tr_b16 a[130:131], v2 offset:3776
  v_mfma_f32_16x16x32_bf16 v[88:91], a[152:155], a[72:75], v[88:91]
  v_mfma_f32_16x16x32_bf16 v[84:87], a[152:155], a[68:71], v[84:87]
  ds_read_b64_tr_b16 a[132:133], v2 offset:7360
  v_mfma_f32_16x16x32_bf16 v[84:87], a[156:159], a[84:87], v[84:87]
  v_mfma_f32_16x16x32_bf16 v[80:83], a[156:159], a[80:83], v[80:83]
  ds_read_b64_tr_b16 a[134:135], v2 offset:10944
  v_mfma_f32_16x16x32_bf16 v[80:83], a[152:155], a[64:67], v[80:83]
  s_waitcnt vmcnt(22) lgkmcnt(12)
  v_mfma_f32_16x16x32_bf16 a[216:219], a[176:179], a[208:211], 0
  ds_read_b64_tr_b16 a[136:137], v2 offset:14336
  v_mfma_f32_16x16x32_bf16 a[216:219], a[180:183], a[212:215], a[216:219]
  v_mfma_f32_16x16x32_bf16 a[220:223], a[184:187], a[208:211], 0
  buffer_load_dwordx4 a[120:123], v0, s[36:39], s11 offen offset:2048 sc1
  ds_read_b64_tr_b16 a[138:139], v2 offset:17920
  v_mfma_f32_16x16x32_bf16 a[220:223], a[188:191], a[212:215], a[220:223]
  v_mfma_f32_16x16x32_bf16 a[224:227], a[192:195], a[208:211], 0
  ds_read_b64_tr_b16 a[140:141], v2 offset:21504
  v_mfma_f32_16x16x32_bf16 a[224:227], a[196:199], a[212:215], a[224:227]
  v_mfma_f32_16x16x32_bf16 a[228:231], a[200:203], a[208:211], 0
  ds_read_b64_tr_b16 a[142:143], v2 offset:25088
  v_mfma_f32_16x16x32_bf16 a[228:231], a[204:207], a[212:215], a[228:231]
  s_waitcnt lgkmcnt(8)
  v_mfma_f32_16x16x32_bf16 v[96:99], a[160:163], a[64:67], v[96:99]
  ds_read_b64_tr_b16 a[144:145], v2 offset:14368
  v_mfma_f32_16x16x32_bf16 v[96:99], a[164:167], a[80:83], v[96:99]
  buffer_load_dwordx4 v6, s[16:19], s10 offen offset:3072 lds
  v_mfma_f32_16x16x32_bf16 v[100:103], a[164:167], a[84:87], v[100:103]
  ds_read_b64_tr_b16 a[146:147], v2 offset:17952
  v_mfma_f32_16x16x32_bf16 v[100:103], a[160:163], a[68:71], v[100:103]
  v_mfma_f32_16x16x32_bf16 v[104:107], a[160:163], a[72:75], v[104:107]
  ds_read_b64_tr_b16 a[148:149], v2 offset:21536
  v_mfma_f32_16x16x32_bf16 v[104:107], a[164:167], a[88:91], v[104:107]
  v_mfma_f32_16x16x32_bf16 v[108:111], a[164:167], a[92:95], v[108:111]
  ds_read_b64_tr_b16 a[150:151], v2 offset:25120
  v_mfma_f32_16x16x32_bf16 v[108:111], a[160:163], a[76:79], v[108:111]
  v_mfma_f32_16x16x32_bf16 v[124:127], a[168:171], a[76:79], v[124:127]
  ds_read_b64_tr_b16 a[152:153], v2 offset:14400
  v_mfma_f32_16x16x32_bf16 v[124:127], a[172:175], a[92:95], v[124:127]
  buffer_load_dwordx4 a[124:127], v0, s[36:39], s11 offen offset:3072 sc1
  v_mfma_f32_16x16x32_bf16 v[120:123], a[172:175], a[88:91], v[120:123]
  ds_read_b64_tr_b16 a[154:155], v2 offset:17984
  v_mfma_f32_16x16x32_bf16 v[120:123], a[168:171], a[72:75], v[120:123]
  v_mfma_f32_16x16x32_bf16 v[116:119], a[168:171], a[68:71], v[116:119]
  s_add_u32 m0, s84, 4096
  ds_read_b64_tr_b16 a[156:157], v2 offset:21568
  v_mfma_f32_16x16x32_bf16 v[116:119], a[172:175], a[84:87], v[116:119]
  v_mfma_f32_16x16x32_bf16 v[112:115], a[172:175], a[80:83], v[112:115]
  ds_read_b64_tr_b16 a[158:159], v2 offset:25152
  v_mfma_f32_16x16x32_bf16 v[112:115], a[168:171], a[64:67], v[112:115]
  s_waitcnt lgkmcnt(8)
  v_mfma_f32_16x16x32_bf16 v[128:131], a[128:131], a[64:67], v[128:131]
  buffer_load_dwordx4 v7, s[16:19], s10 offen offset:0 lds
  s_bfe_u32 s11, s83, 0x40000
  v_mfma_f32_16x16x32_bf16 v[128:131], a[132:135], a[80:83], v[128:131]
  s_lshl_b32 s11, s11, 13
  s_add_u32 s11, s11, s85
  v_mfma_f32_16x16x32_bf16 v[132:135], a[132:135], a[84:87], v[132:135]
  ds_read_b64_tr_b16 a[160:161], v2 offset:14432
  ds_read_b64_tr_b16 a[162:163], v2 offset:18016
  v_mfma_f32_16x16x32_bf16 v[132:135], a[128:131], a[68:71], v[132:135]
  v_mfma_f32_16x16x32_bf16 v[136:139], a[128:131], a[72:75], v[136:139]
  ds_read_b64_tr_b16 a[164:165], v2 offset:21600
  v_mfma_f32_16x16x32_bf16 v[136:139], a[132:135], a[88:91], v[136:139]
  buffer_load_dwordx4 a[0:3], v0, s[36:39], s11 offen offset:0 sc1
  v_mfma_f32_16x16x32_bf16 v[140:143], a[132:135], a[92:95], v[140:143]
  ds_read_b64_tr_b16 a[166:167], v2 offset:25184
  v_mfma_f32_16x16x32_bf16 v[140:143], a[128:131], a[76:79], v[140:143]
  v_mfma_f32_16x16x32_bf16 v[156:159], a[136:139], a[76:79], v[156:159]
  ds_read_b64_tr_b16 a[168:169], v2 offset:14464
  v_mfma_f32_16x16x32_bf16 v[156:159], a[140:143], a[92:95], v[156:159]
  v_mfma_f32_16x16x32_bf16 v[152:155], a[140:143], a[88:91], v[152:155]
  ds_read_b64_tr_b16 a[170:171], v2 offset:18048
  v_mfma_f32_16x16x32_bf16 v[152:155], a[136:139], a[72:75], v[152:155]
  v_mfma_f32_16x16x32_bf16 v[148:151], a[136:139], a[68:71], v[148:151]
  ds_read_b64_tr_b16 a[172:173], v2 offset:21632
  v_mfma_f32_16x16x32_bf16 v[148:151], a[140:143], a[84:87], v[148:151]
  v_mfma_f32_16x16x32_bf16 v[144:147], a[140:143], a[80:83], v[144:147]
  ds_read_b64_tr_b16 a[174:175], v2 offset:25216
  v_mfma_f32_16x16x32_bf16 v[144:147], a[136:139], a[64:67], v[144:147]
  buffer_load_dwordx4 v8, s[16:19], s10 offen offset:1024 lds
  s_waitcnt lgkmcnt(8)
  v_mfma_f32_16x16x32_bf16 v[160:163], a[144:147], a[64:67], v[160:163]
  ds_read_b64_tr_b16 a[128:129], v2 offset:14496
  v_mfma_f32_16x16x32_bf16 v[160:163], a[148:151], a[80:83], v[160:163]
  v_mfma_f32_16x16x32_bf16 v[164:167], a[148:151], a[84:87], v[164:167]
  ds_read_b64_tr_b16 a[130:131], v2 offset:18080
  v_mfma_f32_16x16x32_bf16 v[164:167], a[144:147], a[68:71], v[164:167]
  v_mfma_f32_16x16x32_bf16 v[168:171], a[144:147], a[72:75], v[168:171]
  buffer_load_dwordx4 a[4:7], v0, s[36:39], s11 offen offset:1024 sc1
  ds_read_b64_tr_b16 a[132:133], v2 offset:21664
  v_mfma_f32_16x16x32_bf16 v[168:171], a[148:151], a[88:91], v[168:171]
  v_mfma_f32_16x16x32_bf16 v[172:175], a[148:151], a[92:95], v[172:175]
  ds_read_b64_tr_b16 a[134:135], v2 offset:25248
  v_mfma_f32_16x16x32_bf16 v[172:175], a[144:147], a[76:79], v[172:175]
  s_waitcnt vmcnt(14)
  s_barrier
  v_mfma_f32_16x16x32_bf16 v[188:191], a[152:155], a[76:79], v[188:191]
  ds_read_b64_tr_b16 a[136:137], v2 offset:14528
  v_mfma_f32_16x16x32_bf16 v[188:191], a[156:159], a[92:95], v[188:191]
  v_mfma_f32_16x16x32_bf16 v[184:187], a[156:159], a[88:91], v[184:187]
  ds_read_b64_tr_b16 a[138:139], v2 offset:18112
  v_mfma_f32_16x16x32_bf16 v[184:187], a[152:155], a[72:75], v[184:187]
  v_mfma_f32_16x16x32_bf16 v[180:183], a[152:155], a[68:71], v[180:183]
  ds_read_b64_tr_b16 a[140:141], v2 offset:21696
  v_mfma_f32_16x16x32_bf16 v[180:183], a[156:159], a[84:87], v[180:183]
  v_mfma_f32_16x16x32_bf16 v[176:179], a[156:159], a[80:83], v[176:179]
  buffer_load_dwordx4 v9, s[16:19], s10 offen offset:2048 lds
  ds_read_b64_tr_b16 a[142:143], v2 offset:25280
  v_mfma_f32_16x16x32_bf16 v[176:179], a[152:155], a[64:67], v[176:179]
  s_waitcnt lgkmcnt(8)
  v_mfma_f32_16x16x32_bf16 v[192:195], a[160:163], a[64:67], v[192:195]
  ds_read_b64_tr_b16 a[144:145], v2 offset:28672
  v_mfma_f32_16x16x32_bf16 v[192:195], a[164:167], a[80:83], v[192:195]
  v_mfma_f32_16x16x32_bf16 v[196:199], a[164:167], a[84:87], v[196:199]
  ds_read_b64_tr_b16 a[146:147], v2 offset:32256
  v_mfma_f32_16x16x32_bf16 v[196:199], a[160:163], a[68:71], v[196:199]
  buffer_load_dwordx4 a[8:11], v0, s[36:39], s11 offen offset:2048 sc1
  v_mfma_f32_16x16x32_bf16 v[200:203], a[160:163], a[72:75], v[200:203]
  ds_read_b64_tr_b16 a[148:149], v2 offset:35840
  v_mfma_f32_16x16x32_bf16 v[200:203], a[164:167], a[88:91], v[200:203]
  v_mfma_f32_16x16x32_bf16 v[204:207], a[164:167], a[92:95], v[204:207]
  ds_read_b64_tr_b16 a[150:151], v2 offset:39424
  v_mfma_f32_16x16x32_bf16 v[204:207], a[160:163], a[76:79], v[204:207]
  v_mfma_f32_16x16x32_bf16 v[220:223], a[168:171], a[76:79], v[220:223]
  ds_read_b64_tr_b16 a[152:153], v2 offset:28704
  v_mfma_f32_16x16x32_bf16 v[220:223], a[172:175], a[92:95], v[220:223]
  v_mfma_f32_16x16x32_bf16 v[216:219], a[172:175], a[88:91], v[216:219]
  ds_read_b64_tr_b16 a[154:155], v2 offset:32288
CT13:
  s_add_u32 s94, s92, CT13-k3_main_kernel+3072
  s_addc_u32 s95, s93, 0
  v_mfma_f32_16x16x32_bf16 v[216:219], a[168:171], a[72:75], v[216:219]
  global_load_dword a252, v0, s[94:95]
  v_mfma_f32_16x16x32_bf16 v[212:215], a[168:171], a[68:71], v[212:215]
  ds_read_b64_tr_b16 a[156:157], v2 offset:35872
  v_mfma_f32_16x16x32_bf16 v[212:215], a[172:175], a[84:87], v[212:215]
  v_mfma_f32_16x16x32_bf16 v[208:211], a[172:175], a[80:83], v[208:211]
  ds_read_b64_tr_b16 a[158:159], v2 offset:39456
  v_mfma_f32_16x16x32_bf16 v[208:211], a[168:171], a[64:67], v[208:211]
  s_waitcnt lgkmcnt(8)
  v_mfma_f32_16x16x32_bf16 v[224:227], a[128:131], a[64:67], v[224:227]
  buffer_load_dwordx4 a[12:15], v0, s[36:39], s11 offen offset:3072 sc1
  s_bfe_u32 s10, s83, 0x40004
  v_mfma_f32_16x16x32_bf16 v[224:227], a[132:135], a[80:83], v[224:227]
  s_mul_i32 s10, s10, 458752
  s_add_u32 m0, s84, 28672
  v_mfma_f32_16x16x32_bf16 v[228:231], a[132:135], a[84:87], v[228:231]
  ds_read_b64_tr_b16 a[160:161], v2 offset:28736
  ds_read_b64_tr_b16 a[162:163], v2 offset:32320
  v_mfma_f32_16x16x32_bf16 v[228:231], a[128:131], a[68:71], v[228:231]
  v_mfma_f32_16x16x32_bf16 v[232:235], a[128:131], a[72:75], v[232:235]
  ds_read_b64_tr_b16 a[164:165], v2 offset:35904
  v_mfma_f32_16x16x32_bf16 v[232:235], a[132:135], a[88:91], v[232:235]
  buffer_load_dwordx4 v3, s[16:19], s10 offen offset:0 lds
  v_mfma_f32_16x16x32_bf16 v[236:239], a[132:135], a[92:95], v[236:239]
  ds_read_b64_tr_b16 a[166:167], v2 offset:39488
  v_mfma_f32_16x16x32_bf16 v[236:239], a[128:131], a[76:79], v[236:239]
  v_mfma_f32_16x16x32_bf16 v[252:255], a[136:139], a[76:79], v[252:255]
  ds_read_b64_tr_b16 a[168:169], v2 offset:28768
  v_mfma_f32_16x16x32_bf16 v[252:255], a[140:143], a[92:95], v[252:255]
  v_mfma_f32_16x16x32_bf16 v[248:251], a[140:143], a[88:91], v[248:251]
  ds_read_b64_tr_b16 a[170:171], v2 offset:32352
  v_mfma_f32_16x16x32_bf16 v[248:251], a[136:139], a[72:75], v[248:251]
  v_mfma_f32_16x16x32_bf16 v[244:247], a[136:139], a[68:71], v[244:247]
  ds_read_b64_tr_b16 a[172:173], v2 offset:35936
  v_mfma_f32_16x16x32_bf16 v[244:247], a[140:143], a[84:87], v[244:247]
  v_mfma_f32_16x16x32_bf16 v[240:243], a[140:143], a[80:83], v[240:243]
  ds_read_b64_tr_b16 a[174:175], v2 offset:39520
  v_mfma_f32_16x16x32_bf16 v[240:243], a[136:139], a[64:67], v[240:243]
  s_waitcnt vmcnt(9) lgkmcnt(8)
  v_mfma_f32_16x16x32_bf16 v[32:35], a[144:147], a[96:99], v[32:35]
  s_add_u32 s11, s11, 4096
  ds_read_b64_tr_b16 a[128:129], v2 offset:28800
  v_mfma_f32_16x16x32_bf16 v[32:35], a[148:151], a[112:115], v[32:35]
  s_barrier
  v_mfma_f32_16x16x32_bf16 v[36:39], a[148:151], a[116:119], v[36:39]
  ds_read_b64_tr_b16 a[130:131], v2 offset:32384
  v_mfma_f32_16x16x32_bf16 v[36:39], a[144:147], a[100:103], v[36:39]
  v_mfma_f32_16x16x32_bf16 v[40:43], a[144:147], a[104:107], v[40:43]
  buffer_load_dwordx4 a[16:19], v0, s[36:39], s11 offen offset:0 sc1
  ds_read_b64_tr_b16 a[132:133], v2 offset:35968
  v_mfma_f32_16x16x32_bf16 v[40:43], a[148:151], a[120:123], v[40:43]
  v_mfma_f32_16x16x32_bf16 v[44:47], a[148:151], a[124:127], v[44:47]
  ds_read_b64_tr_b16 a[134:135], v2 offset:39552
  v_mfma_f32_16x16x32_bf16 v[44:47], a[144:147], a[108:111], v[44:47]
  v_mfma_f32_16x16x32_bf16 v[60:63], a[152:155], a[108:111], v[60:63]
  ds_read_b64_tr_b16 a[136:137], v2 offset:28832
  v_mfma_f32_16x16x32_bf16 v[60:63], a[156:159], a[124:127], v[60:63]
  buffer_load_dwordx4 v4, s[16:19], s10 offen offset:1024 lds
  v_mfma_f32_16x16x32_bf16 v[56:59], a[156:159], a[120:123], v[56:59]
  ds_read_b64_tr_b16 a[138:139], v2 offset:32416
  v_mfma_f32_16x16x32_bf16 v[56:59], a[152:155], a[104:107], v[56:59]
  v_mfma_f32_16x16x32_bf16 v[52:55], a[152:155], a[100:103], v[52:55]
  ds_read_b64_tr_b16 a[140:141], v2 offset:36000
  v_mfma_f32_16x16x32_bf16 v[52:55], a[156:159], a[116:119], v[52:55]
  v_mfma_f32_16x16x32_bf16 v[48:51], a[156:159], a[112:115], v[48:51]
  ds_read_b64_tr_b16 a[142:143], v2 offset:39584
  v_mfma_f32_16x16x32_bf16 v[48:51], a[152:155], a[96:99], v[48:51]
  s_waitcnt lgkmcnt(8)
  v_mfma_f32_16x16x32_bf16 v[64:67], a[160:163], a[96:99], v[64:67]
  ds_read_b64_tr_b16 a[144:145], v2 offset:28864
  v_mfma_f32_16x16x32_bf16 v[64:67], a[164:167], a[112:115], v[64:67]
  v_mfma_f32_16x16x32_bf16 v[68:71], a[164:167], a[116:119], v[68:71]
  ds_read_b64_tr_b16 a[146:147], v2 offset:32448
  v_mfma_f32_16x16x32_bf16 v[68:71], a[160:163], a[100:103], v[68:71]
  buffer_load_dwordx4 a[20:23], v0, s[36:39], s11 offen offset:1024 sc1
  v_mfma_f32_16x16x32_bf16 v[72:75], a[160:163], a[104:107], v[72:75]
  ds_read_b64_tr_b16 a[148:149], v2 offset:36032
  v_mfma_f32_16x16x32_bf16 v[72:75], a[164:167], a[120:123], v[72:75]
  v_mfma_f32_16x16x32_bf16 v[76:79], a[164:167], a[124:127], v[76:79]
  ds_read_b64_tr_b16 a[150:151], v2 offset:39616
  v_mfma_f32_16x16x32_bf16 v[76:79], a[160:163], a[108:111], v[76:79]
  v_mfma_f32_16x16x32_bf16 v[92:95], a[168:171], a[108:111], v[92:95]
  buffer_load_dwordx4 v5, s[16:19], s10 offen offset:2048 lds
  ds_read_b64_tr_b16 a[152:153], v2 offset:43008
  v_mfma_f32_16x16x32_bf16 v[92:95], a[172:175], a[124:127], v[92:95]
  v_mfma_f32_16x16x32_bf16 v[88:91], a[172:175], a[120:123], v[88:91]
  ds_read_b64_tr_b16 a[154:155], v2 offset:46592
  v_mfma_f32_16x16x32_bf16 v[88:91], a[168:171], a[104:107], v[88:91]
  v_mfma_f32_16x16x32_bf16 v[84:87], a[168:171], a[100:103], v[84:87]
  ds_read_b64_tr_b16 a[156:157], v2 offset:50176
  v_mfma_f32_16x16x32_bf16 v[84:87], a[172:175], a[116:119], v[84:87]
  v_mfma_f32_16x16x32_bf16 v[80:83], a[172:175], a[112:115], v[80:83]
  ds_read_b64_tr_b16 a[158:159], v2 offset:53760
  v_mfma_f32_16x16x32_bf16 v[80:83], a[168:171], a[96:99], v[80:83]
  s_waitcnt lgkmcnt(8)
  v_mfma_f32_16x16x32_bf16 v[96:99], a[128:131], a[96:99], v[96:99]
  buffer_load_dwordx4 v6, s[16:19], s10 offen offset:3072 lds
  ds_read_b64_tr_b16 a[160:161], v2 offset:43040
  v_mfma_f32_16x16x32_bf16 v[96:99], a[132:135], a[112:115], v[96:99]
  v_mfma_f32_16x16x32_bf16 v[100:103], a[132:135], a[116:119], v[100:103]
  ds_read_b64_tr_b16 a[162:163], v2 offset:46624
  v_mfma_f32_16x16x32_bf16 v[100:103], a[128:131], a[100:103], v[100:103]
  v_mfma_f32_16x16x32_bf16 v[104:107], a[128:131], a[104:107], v[104:107]
  ds_read_b64_tr_b16 a[164:165], v2 offset:50208
  v_mfma_f32_16x16x32_bf16 v[104:107], a[132:135], a[120:123], v[104:107]
  buffer_load_dwordx4 a[24:27], v0, s[36:39], s11 offen offset:2048 sc1
  v_mfma_f32_16x16x32_bf16 v[108:111], a[132:135], a[124:127], v[108:111]
  ds_read_b64_tr_b16 a[166:167], v2 offset:53792
  v_mfma_f32_16x16x32_bf16 v[108:111], a[128:131], a[108:111], v[108:111]
  v_mfma_f32_16x16x32_bf16 v[124:127], a[136:139], a[108:111], v[124:127]
  s_add_u32 m0, s84, 32768
  ds_read_b64_tr_b16 a[168:169], v2 offset:43072
  v_mfma_f32_16x16x32_bf16 v[124:127], a[140:143], a[124:127], v[124:127]
  v_mfma_f32_16x16x32_bf16 v[120:123], a[140:143], a[120:123], v[120:123]
  ds_read_b64_tr_b16 a[170:171], v2 offset:46656
  v_mfma_f32_16x16x32_bf16 v[120:123], a[136:139], a[104:107], v[120:123]
  v_mfma_f32_16x16x32_bf16 v[116:119], a[136:139], a[100:103], v[116:119]
  buffer_load_dwordx4 v7, s[16:19], s10 offen offset:0 lds
  ds_read_b64_tr_b16 a[172:173], v2 offset:50240
  v_mfma_f32_16x16x32_bf16 v[116:119], a[140:143], a[116:119], v[116:119]
  v_mfma_f32_16x16x32_bf16 v[112:115], a[140:143], a[112:115], v[112:115]
  ds_read_b64_tr_b16 a[174:175], v2 offset:53824
  v_mfma_f32_16x16x32_bf16 v[112:115], a[136:139], a[96:99], v[112:115]
  s_waitcnt lgkmcnt(8)
  v_mfma_f32_16x16x32_bf16 v[128:131], a[144:147], a[96:99], v[128:131]
  ds_read_b64_tr_b16 a[128:129], v2 offset:43104
  v_mfma_f32_16x16x32_bf16 v[128:131], a[148:151], a[112:115], v[128:131]
  buffer_load_dwordx4 a[28:31], v0, s[36:39], s11 offen offset:3072 sc1
  v_mfma_f32_16x16x32_bf16 v[132:135], a[148:151], a[116:119], v[132:135]
  ds_read_b64_tr_b16 a[130:131], v2 offset:46688
  v_mfma_f32_16x16x32_bf16 v[132:135], a[144:147], a[100:103], v[132:135]
  v_mfma_f32_16x16x32_bf16 v[136:139], a[144:147], a[104:107], v[136:139]
  ds_read_b64_tr_b16 a[132:133], v2 offset:50272
  v_mfma_f32_16x16x32_bf16 v[136:139], a[148:151], a[120:123], v[136:139]
  v_mfma_f32_16x16x32_bf16 v[140:143], a[148:151], a[124:127], v[140:143]
  ds_read_b64_tr_b16 a[134:135], v2 offset:53856
  v_mfma_f32_16x16x32_bf16 v[140:143], a[144:147], a[108:111], v[140:143]
  v_mfma_f32_16x16x32_bf16 v[156:159], a[152:155], a[108:111], v[156:159]
  buffer_load_dwordx4 v8, s[16:19], s10 offen offset:1024 lds
  s_bfe_u32 s11, s83, 0x40004
  v_mfma_f32_16x16x32_bf16 v[156:159], a[156:159], a[124:127], v[156:159]
  s_lshl_b32 s11, s11, 13
  s_add_u32 s11, s11, s85
  v_mfma_f32_16x16x32_bf16 v[152:155], a[156:159], a[120:123], v[152:155]
  ds_read_b64_tr_b16 a[136:137], v2 offset:43136
  ds_read_b64_tr_b16 a[138:139], v2 offset:46720
  v_mfma_f32_16x16x32_bf16 v[152:155], a[152:155], a[104:107], v[152:155]
  v_mfma_f32_16x16x32_bf16 v[148:151], a[152:155], a[100:103], v[148:151]
  ds_read_b64_tr_b16 a[140:141], v2 offset:50304
  v_mfma_f32_16x16x32_bf16 v[148:151], a[156:159], a[116:119], v[148:151]
  buffer_load_dwordx4 a[32:35], v0, s[36:39], s11 offen offset:0 sc1
  v_mfma_f32_16x16x32_bf16 v[144:147], a[156:159], a[112:115], v[144:147]
  ds_read_b64_tr_b16 a[142:143], v2 offset:53888
  v_mfma_f32_16x16x32_bf16 v[144:147], a[152:155], a[96:99], v[144:147]
  s_waitcnt lgkmcnt(8)
  v_mfma_f32_16x16x32_bf16 v[160:163], a[160:163], a[96:99], v[160:163]
  ds_read_b64_tr_b16 a[144:145], v2 offset:43168
  v_mfma_f32_16x16x32_bf16 v[160:163], a[164:167], a[112:115], v[160:163]
  v_mfma_f32_16x16x32_bf16 v[164:167], a[164:167], a[116:119], v[164:167]
  buffer_load_dwordx4 a[36:39], v0, s[36:39], s11 offen offset:1024 sc1
  ds_read_b64_tr_b16 a[146:147], v2 offset:46752
  v_mfma_f32_16x16x32_bf16 v[164:167], a[160:163], a[100:103], v[164:167]
  v_mfma_f32_16x16x32_bf16 v[168:171], a[160:163], a[104:107], v[168:171]
  ds_read_b64_tr_b16 a[148:149], v2 offset:50336
  v_mfma_f32_16x16x32_bf16 v[168:171], a[164:167], a[120:123], v[168:171]
  v_mfma_f32_16x16x32_bf16 v[172:175], a[164:167], a[124:127], v[172:175]
  ds_read_b64_tr_b16 a[150:151], v2 offset:53920
  v_mfma_f32_16x16x32_bf16 v[172:175], a[160:163], a[108:111], v[172:175]
  buffer_load_dwordx4 v9, s[16:19], s10 offen offset:2048 lds
  s_waitcnt vmcnt(16)
  s_barrier
  v_mfma_f32_16x16x32_bf16 v[188:191], a[168:171], a[108:111], v[188:191]
  ds_read_b64_tr_b16 a[152:153], v2 offset:43200
  v_mfma_f32_16x16x32_bf16 v[188:191], a[172:175], a[124:127], v[188:191]
  v_mfma_f32_16x16x32_bf16 v[184:187], a[172:175], a[120:123], v[184:187]
  ds_read_b64_tr_b16 a[154:155], v2 offset:46784
  v_mfma_f32_16x16x32_bf16 v[184:187], a[168:171], a[104:107], v[184:187]
  v_mfma_f32_16x16x32_bf16 v[180:183], a[168:171], a[100:103], v[180:183]
  ds_read_b64_tr_b16 a[156:157], v2 offset:50368
  v_mfma_f32_16x16x32_bf16 v[180:183], a[172:175], a[116:119], v[180:183]
  buffer_load_dwordx4 a[40:43], v0, s[36:39], s11 offen offset:2048 sc1
  v_mfma_f32_16x16x32_bf16 v[176:179], a[172:175], a[112:115], v[176:179]
  ds_read_b64_tr_b16 a[158:159], v2 offset:53952
  v_mfma_f32_16x16x32_bf16 v[176:179], a[168:171], a[96:99], v[176:179]
  s_waitcnt lgkmcnt(8)
  v_mfma_f32_16x16x32_bf16 v[192:195], a[128:131], a[96:99], v[192:195]
  ds_read_b64_tr_b16 a[160:161], v1 offset:0
  v_mfma_f32_16x16x32_bf16 v[192:195], a[132:135], a[112:115], v[192:195]
  v_mfma_f32_16x16x32_bf16 v[196:199], a[132:135], a[116:119], v[196:199]
  ds_read_b64_tr_b16 a[162:163], v1 offset:3584
  v_mfma_f32_16x16x32_bf16 v[196:199], a[128:131], a[100:103], v[196:199]
  v_mfma_f32_16x16x32_bf16 v[200:203], a[128:131], a[104:107], v[200:203]
  ds_read_b64_tr_b16 a[164:165], v1 offset:7168
  v_mfma_f32_16x16x32_bf16 v[200:203], a[132:135], a[120:123], v[200:203]
  v_mfma_f32_16x16x32_bf16 v[204:207], a[132:135], a[124:127], v[204:207]
  ds_read_b64_tr_b16 a[166:167], v1 offset:10752
  v_mfma_f32_16x16x32_bf16 v[204:207], a[128:131], a[108:111], v[204:207]
  buffer_load_dwordx4 a[44:47], v0, s[36:39], s11 offen offset:3072 sc1
  s_bfe_u32 s10, s83, 0x40008
  v_mfma_f32_16x16x32_bf16 v[220:223], a[136:139], a[108:111], v[220:223]
  s_mul_i32 s10, s10, 458752
  s_add_u32 m0, s84, 57344
  v_mfma_f32_16x16x32_bf16 v[220:223], a[140:143], a[124:127], v[220:223]
  ds_read_b64_tr_b16 a[168:169], v1 offset:32
  v_mfma_f32_16x16x32_bf16 v[216:219], a[140:143], a[120:123], v[216:219]
  s_add_u32 s20, s20, 16384
  ds_read_b64_tr_b16 a[170:171], v1 offset:3616
  v_mfma_f32_16x16x32_bf16 v[216:219], a[136:139], a[104:107], v[216:219]
  v_add_u32 v31, -28672, v31
  v_mfma_f32_16x16x32_bf16 v[212:215], a[136:139], a[100:103], v[212:215]
  buffer_load_dwordx4 v3, s[16:19], s10 offen offset:0 lds
  ds_read_b64_tr_b16 a[172:173], v1 offset:7200
  v_mfma_f32_16x16x32_bf16 v[212:215], a[140:143], a[116:119], v[212:215]
  v_mfma_f32_16x16x32_bf16 v[208:211], a[140:143], a[112:115], v[208:211]
  s_add_u32 s11, s11, 4096
  ds_read_b64_tr_b16 a[174:175], v1 offset:10784
  v_mfma_f32_16x16x32_bf16 v[208:211], a[136:139], a[96:99], v[208:211]
  s_waitcnt lgkmcnt(8)
  v_mfma_f32_16x16x32_bf16 v[224:227], a[144:147], a[96:99], v[224:227]
  ds_read_b64_tr_b16 a[128:129], v1 offset:64
  v_mfma_f32_16x16x32_bf16 v[224:227], a[148:151], a[112:115], v[224:227]
  buffer_load_dwordx4 a[208:211], v0, s[36:39], s20 offen offset:0 sc1
  v_mfma_f32_16x16x32_bf16 v[228:231], a[148:151], a[116:119], v[228:231]
  ds_read_b64_tr_b16 a[130:131], v1 offset:3648
  v_mfma_f32_16x16x32_bf16 v[228:231], a[144:147], a[100:103], v[228:231]
  v_mfma_f32_16x16x32_bf16 v[232:235], a[144:147], a[104:107], v[232:235]
  ds_read_b64_tr_b16 a[132:133], v1 offset:7232
  v_mfma_f32_16x16x32_bf16 v[232:235], a[148:151], a[120:123], v[232:235]
  v_mfma_f32_16x16x32_bf16 v[236:239], a[148:151], a[124:127], v[236:239]
  buffer_load_dwordx4 a[212:215], v0, s[36:39], s20 offen offset:1024 sc1
  ds_read_b64_tr_b16 a[134:135], v1 offset:10816
  v_mfma_f32_16x16x32_bf16 v[236:239], a[144:147], a[108:111], v[236:239]
  v_mfma_f32_16x16x32_bf16 v[252:255], a[152:155], a[108:111], v[252:255]
  ds_read_b64_tr_b16 a[136:137], v1 offset:96
  v_mfma_f32_16x16x32_bf16 v[252:255], a[156:159], a[124:127], v[252:255]
  v_mfma_f32_16x16x32_bf16 v[248:251], a[156:159], a[120:123], v[248:251]
  ds_read_b64_tr_b16 a[138:139], v1 offset:3680
  v_mfma_f32_16x16x32_bf16 v[248:251], a[152:155], a[104:107], v[248:251]
  buffer_load_dwordx4 a[48:51], v0, s[36:39], s11 offen offset:0 sc1
  v_mfma_f32_16x16x32_bf16 v[244:247], a[152:155], a[100:103], v[244:247]
  ds_read_b64_tr_b16 a[140:141], v1 offset:7264
  v_mfma_f32_16x16x32_bf16 v[244:247], a[156:159], a[116:119], v[244:247]
  v_mfma_f32_16x16x32_bf16 v[240:243], a[156:159], a[112:115], v[240:243]
  ds_read_b64_tr_b16 a[142:143], v1 offset:10848
  v_mfma_f32_16x16x32_bf16 v[240:243], a[152:155], a[96:99], v[240:243]
  s_waitcnt vmcnt(10) lgkmcnt(8)
  v_mfma_f32_16x16x32_bf16 v[32:35], a[160:163], a[0:3], v[32:35]
  buffer_load_dwordx4 v4, s[16:19], s10 offen offset:1024 lds
  ds_read_b64_tr_b16 a[144:145], v1 offset:128
  v_mfma_f32_16x16x32_bf16 v[32:35], a[164:167], a[16:19], v[32:35]
  s_barrier
  v_mfma_f32_16x16x32_bf16 v[36:39], a[164:167], a[20:23], v[36:39]
  ds_read_b64_tr_b16 a[146:147], v1 offset:3712
  v_mfma_f32_16x16x32_bf16 v[36:39], a[160:163], a[4:7], v[36:39]
  v_mfma_f32_16x16x32_bf16 v[40:43], a[160:163], a[8:11], v[40:43]
  ds_read_b64_tr_b16 a[148:149], v1 offset:7296
  v_mfma_f32_16x16x32_bf16 v[40:43], a[164:167], a[24:27], v[40:43]
  buffer_load_dwordx4 a[52:55], v0, s[36:39], s11 offen offset:1024 sc1
  v_mfma_f32_16x16x32_bf16 v[44:47], a[164:167], a[28:31], v[44:47]
  ds_read_b64_tr_b16 a[150:151], v1 offset:10880
  v_mfma_f32_16x16x32_bf16 v[44:47], a[160:163], a[12:15], v[44:47]
  v_mfma_f32_16x16x32_bf16 v[60:63], a[168:171], a[12:15], v[60:63]
  ds_read_b64_tr_b16 a[152:153], v1 offset:160
  v_mfma_f32_16x16x32_bf16 v[60:63], a[172:175], a[28:31], v[60:63]
  v_mfma_f32_16x16x32_bf16 v[56:59], a[172:175], a[24:27], v[56:59]
  buffer_load_dwordx4 v5, s[16:19], s10 offen offset:2048 lds
  ds_read_b64_tr_b16 a[154:155], v1 offset:3744
  v_mfma_f32_16x16x32_bf16 v[56:59], a[168:171], a[8:11], v[56:59]
  v_mfma_f32_16x16x32_bf16 v[52:55], a[168:171], a[4:7], v[52:55]
  ds_read_b64_tr_b16 a[156:157], v1 offset:7328
  v_mfma_f32_16x16x32_bf16 v[52:55], a[172:175], a[20:23], v[52:55]
  v_mfma_f32_16x16x32_bf16 v[48:51], a[172:175], a[16:19], v[48:51]
  ds_read_b64_tr_b16 a[158:159], v1 offset:10912
  v_mfma_f32_16x16x32_bf16 v[48:51], a[168:171], a[0:3], v[48:51]
  buffer_load_dwordx4 a[56:59], v0, s[36:39], s11 offen offset:2048 sc1
  s_waitcnt lgkmcnt(8)
  v_mfma_f32_16x16x32_bf16 v[64:67], a[128:131], a[0:3], v[64:67]
  ds_read_b64_tr_b16 a[160:161], v1 offset:192
  v_mfma_f32_16x16x32_bf16 v[64:67], a[132:135], a[16:19], v[64:67]
  v_mfma_f32_16x16x32_bf16 v[68:71], a[132:135], a[20:23], v[68:71]
  ds_read_b64_tr_b16 a[162:163], v1 offset:3776
  v_mfma_f32_16x16x32_bf16 v[68:71], a[128:131], a[4:7], v[68:71]
  v_mfma_f32_16x16x32_bf16 v[72:75], a[128:131], a[8:11], v[72:75]
  buffer_load_dwordx4 v6, s[16:19], s10 offen offset:3072 lds
  ds_read_b64_tr_b16 a[164:165], v1 offset:7360
  v_mfma_f32_16x16x32_bf16 v[72:75], a[132:135], a[24:27], v[72:75]
  v_mfma_f32_16x16x32_bf16 v[76:79], a[132:135], a[28:31], v[76:79]
  ds_read_b64_tr_b16 a[166:167], v1 offset:10944
  v_mfma_f32_16x16x32_bf16 v[76:79], a[128:131], a[12:15], v[76:79]
  v_mfma_f32_16x16x32_bf16 v[92:95], a[136:139], a[12:15], v[92:95]
  ds_read_b64_tr_b16 a[168:169], v1 offset:14336
  v_mfma_f32_16x16x32_bf16 v[92:95], a[140:143], a[28:31], v[92:95]
  buffer_load_dwordx4 a[60:63], v0, s[36:39], s11 offen offset:3072 sc1
  s_bfe_u32 s11, s83, 0x40008
  v_mfma_f32_16x16x32_bf16 v[88:91], a[140:143], a[24:27], v[88:91]
  s_lshl_b32 s11, s11, 13
  s_add_u32 s11, s11, s85
  v_mfma_f32_16x16x32_bf16 v[88:91], a[136:139], a[8:11], v[88:91]
  ds_read_b64_tr_b16 a[170:171], v1 offset:17920
  v_mfma_f32_16x16x32_bf16 v[84:87], a[136:139], a[4:7], v[84:87]
  ds_read_b64_tr_b16 a[172:173], v1 offset:21504
  v_mfma_f32_16x16x32_bf16 v[84:87], a[140:143], a[20:23], v[84:87]
  v_mfma_f32_16x16x32_bf16 v[80:83], a[140:143], a[16:19], v[80:83]
  buffer_load_dwordx4 a[64:67], v0, s[36:39], s11 offen offset:0 sc1
  s_add_u32 m0, s84, 61440
  v_mfma_f32_16x16x32_bf16 v[80:83], a[136:139], a[0:3], v[80:83]
  ds_read_b64_tr_b16 a[174:175], v1 offset:25088
  s_waitcnt lgkmcnt(8)
  v_mfma_f32_16x16x32_bf16 v[96:99], a[144:147], a[0:3], v[96:99]
  ds_read_b64_tr_b16 a[128:129], v1 offset:14368
  v_mfma_f32_16x16x32_bf16 v[96:99], a[148:151], a[16:19], v[96:99]
  v_mfma_f32_16x16x32_bf16 v[100:103], a[148:151], a[20:23], v[100:103]
  ds_read_b64_tr_b16 a[130:131], v1 offset:17952
  v_mfma_f32_16x16x32_bf16 v[100:103], a[144:147], a[4:7], v[100:103]
  buffer_load_dwordx4 v7, s[16:19], s10 offen offset:0 lds
  v_mfma_f32_16x16x32_bf16 v[104:107], a[144:147], a[8:11], v[104:107]
  ds_read_b64_tr_b16 a[132:133], v1 offset:21536
  v_mfma_f32_16x16x32_bf16 v[104:107], a[148:151], a[24:27], v[104:107]
  v_mfma_f32_16x16x32_bf16 v[108:111], a[148:151], a[28:31], v[108:111]
  ds_read_b64_tr_b16 a[134:135], v1 offset:25120
  v_mfma_f32_16x16x32_bf16 v[108:111], a[144:147], a[12:15], v[108:111]
  v_mfma_f32_16x16x32_bf16 v[124:127], a[152:155], a[12:15], v[124:127]
  buffer_load_dwordx4 a[68:71], v0, s[36:39], s11 offen offset:1024 sc1
  ds_read_b64_tr_b16 a[136:137], v1 offset:14400
  v_mfma_f32_16x16x32_bf16 v[124:127], a[156:159], a[28:31], v[124:127]
  v_mfma_f32_16x16x32_bf16 v[120:123], a[156:159], a[24:27], v[120:123]
  ds_read_b64_tr_b16 a[138:139], v1 offset:17984
  v_mfma_f32_16x16x32_bf16 v[120:123], a[152:155], a[8:11], v[120:123]
  v_mfma_f32_16x16x32_bf16 v[116:119], a[152:155], a[4:7], v[116:119]
  ds_read_b64_tr_b16 a[140:141], v1 offset:21568
  v_mfma_f32_16x16x32_bf16 v[116:119], a[156:159], a[20:23], v[116:119]
  buffer_load_dwordx4 v8, s[16:19], s10 offen offset:1024 lds
  v_mfma_f32_16x16x32_bf16 v[112:115], a[156:159], a[16:19], v[112:115]
  ds_read_b64_tr_b16 a[142:143], v1 offset:25152
  v_mfma_f32_16x16x32_bf16 v[112:115], a[152:155], a[0:3], v[112:115]
  s_waitcnt lgkmcnt(8)
  v_mfma_f32_16x16x32_bf16 v[128:131], a[160:163], a[0:3], v[128:131]
  ds_read_b64_tr_b16 a[144:145], v1 offset:14432
  v_mfma_f32_16x16x32_bf16 v[128:131], a[164:167], a[16:19], v[128:131]
  v_mfma_f32_16x16x32_bf16 v[132:135], a[164:167], a[20:23], v[132:135]
  buffer_load_dwordx4 a[72:75], v0, s[36:39], s11 offen offset:2048 sc1
  ds_read_b64_tr_b16 a[146:147], v1 offset:18016
  v_mfma_f32_16x16x32_bf16 v[132:135], a[160:163], a[4:7], v[132:135]
  v_mfma_f32_16x16x32_bf16 v[136:139], a[160:163], a[8:11], v[136:139]
  ds_read_b64_tr_b16 a[148:149], v1 offset:21600
  v_mfma_f32_16x16x32_bf16 v[136:139], a[164:167], a[24:27], v[136:139]
  v_mfma_f32_16x16x32_bf16 v[140:143], a[164:167], a[28:31], v[140:143]
  ds_read_b64_tr_b16 a[150:151], v1 offset:25184
  v_mfma_f32_16x16x32_bf16 v[140:143], a[160:163], a[12:15], v[140:143]
  buffer_load_dwordx4 v9, s[16:19], s10 offen offset:2048 lds
  v_mfma_f32_16x16x32_bf16 v[156:159], a[168:171], a[12:15], v[156:159]
  ds_read_b64_tr_b16 a[152:153], v1 offset:14464
  v_mfma_f32_16x16x32_bf16 v[156:159], a[172:175], a[28:31], v[156:159]
  v_mfma_f32_16x16x32_bf16 v[152:155], a[172:175], a[24:27], v[152:155]
  ds_read_b64_tr_b16 a[154:155], v1 offset:18048
  v_mfma_f32_16x16x32_bf16 v[152:155], a[168:171], a[8:11], v[152:155]
  v_mfma_f32_16x16x32_bf16 v[148:151], a[168:171], a[4:7], v[148:151]
  buffer_load_dwordx4 a[76:79], v0, s[36:39], s11 offen offset:3072 sc1
  s_add_u32 s11, s11, 4096
  v_mfma_f32_16x16x32_bf16 v[148:151], a[172:175], a[20:23], v[148:151]
  ds_read_b64_tr_b16 a[156:157], v1 offset:21632
  v_mfma_f32_16x16x32_bf16 v[144:147], a[172:175], a[16:19], v[144:147]
  ds_read_b64_tr_b16 a[158:159], v1 offset:25216
  v_mfma_f32_16x16x32_bf16 v[144:147], a[168:171], a[0:3], v[144:147]
  s_waitcnt lgkmcnt(8)
  v_mfma_f32_16x16x32_bf16 v[160:163], a[128:131], a[0:3], v[160:163]
  ds_read_b64_tr_b16 a[160:161], v1 offset:14496
  v_mfma_f32_16x16x32_bf16 v[160:163], a[132:135], a[16:19], v[160:163]
  buffer_load_dwordx4 a[80:83], v0, s[36:39], s11 offen offset:0 sc1
  s_bfe_u32 s10, s83, 0x4000c
  v_mfma_f32_16x16x32_bf16 v[164:167], a[132:135], a[20:23], v[164:167]
  s_mul_i32 s10, s10, 458752
  s_add_u32 m0, s84, 86016
  v_mfma_f32_16x16x32_bf16 v[164:167], a[128:131], a[4:7], v[164:167]
  ds_read_b64_tr_b16 a[162:163], v1 offset:18080
  v_mfma_f32_16x16x32_bf16 v[168:171], a[128:131], a[8:11], v[168:171]
  ds_read_b64_tr_b16 a[164:165], v1 offset:21664
  v_mfma_f32_16x16x32_bf16 v[168:171], a[132:135], a[24:27], v[168:171]
  v_mfma_f32_16x16x32_bf16 v[172:175], a[132:135], a[28:31], v[172:175]
  buffer_load_dwordx4 v3, s[16:19], s10 offen offset:0 lds
  ds_read_b64_tr_b16 a[166:167], v1 offset:25248
  v_mfma_f32_16x16x32_bf16 v[172:175], a[128:131], a[12:15], v[172:175]
  s_waitcnt vmcnt(21)
  s_barrier
  v_mfma_f32_16x16x32_bf16 v[188:191], a[136:139], a[12:15], v[188:191]
  ds_read_b64_tr_b16 a[168:169], v1 offset:14528
  ds_read_b64_tr_b16 a[176:177], v31 offset:0
  v_mfma_f32_16x16x32_bf16 v[188:191], a[140:143], a[28:31], v[188:191]
  v_mfma_f32_16x16x32_bf16 v[184:187], a[140:143], a[24:27], v[184:187]
  ds_read_b64_tr_b16 a[170:171], v1 offset:18112
  ds_read_b64_tr_b16 a[178:179], v31 offset:3584
  v_mfma_f32_16x16x32_bf16 v[184:187], a[136:139], a[8:11], v[184:187]
  buffer_load_dwordx4 a[84:87], v0, s[36:39], s11 offen offset:1024 sc1
  v_mfma_f32_16x16x32_bf16 v[180:183], a[136:139], a[4:7], v[180:183]
  ds_read_b64_tr_b16 a[172:173], v1 offset:21696
  ds_read_b64_tr_b16 a[180:181], v31 offset:7168
  v_mfma_f32_16x16x32_bf16 v[180:183], a[140:143], a[20:23], v[180:183]
  v_mfma_f32_16x16x32_bf16 v[176:179], a[140:143], a[16:19], v[176:179]
  ds_read_b64_tr_b16 a[174:175], v1 offset:25280
  ds_read_b64_tr_b16 a[182:183], v31 offset:10752
  v_mfma_f32_16x16x32_bf16 v[176:179], a[136:139], a[0:3], v[176:179]
  s_waitcnt lgkmcnt(12)
  v_mfma_f32_16x16x32_bf16 v[192:195], a[144:147], a[0:3], v[192:195]
  buffer_load_dwordx4 v4, s[16:19], s10 offen offset:1024 lds
  ds_read_b64_tr_b16 a[128:129], v1 offset:28672
  v_mfma_f32_16x16x32_bf16 v[192:195], a[148:151], a[16:19], v[192:195]
  ds_read_b64_tr_b16 a[184:185], v31 offset:32
  v_mfma_f32_16x16x32_bf16 v[196:199], a[148:151], a[20:23], v[196:199]
  ds_read_b64_tr_b16 a[130:131], v1 offset:32256
  ds_read_b64_tr_b16 a[186:187], v31 offset:3616
  v_mfma_f32_16x16x32_bf16 v[196:199], a[144:147], a[4:7], v[196:199]
  v_mfma_f32_16x16x32_bf16 v[200:203], a[144:147], a[8:11], v[200:203]
  ds_read_b64_tr_b16 a[132:133], v1 offset:35840
  ds_read_b64_tr_b16 a[188:189], v31 offset:7200
  v_mfma_f32_16x16x32_bf16 v[200:203], a[148:151], a[24:27], v[200:203]
  buffer_load_dwordx4 a[88:91], v0, s[36:39], s11 offen offset:2048 sc1
  v_mfma_f32_16x16x32_bf16 v[204:207], a[148:151], a[28:31], v[204:207]
  ds_read_b64_tr_b16 a[134:135], v1 offset:39424
  ds_read_b64_tr_b16 a[190:191], v31 offset:10784
  v_mfma_f32_16x16x32_bf16 v[204:207], a[144:147], a[12:15], v[204:207]
  v_mfma_f32_16x16x32_bf16 v[220:223], a[152:155], a[12:15], v[220:223]
  ds_read_b64_tr_b16 a[136:137], v1 offset:28704
  ds_read_b64_tr_b16 a[192:193], v31 offset:64
  v_mfma_f32_16x16x32_bf16 v[220:223], a[156:159], a[28:31], v[220:223]
  v_mfma_f32_16x16x32_bf16 v[216:219], a[156:159], a[24:27], v[216:219]
  ds_read_b64_tr_b16 a[138:139], v1 offset:32288
  ds_read_b64_tr_b16 a[194:195], v31 offset:3648
  v_mfma_f32_16x16x32_bf16 v[216:219], a[152:155], a[8:11], v[216:219]
  buffer_load_dwordx4 v5, s[16:19], s10 offen offset:2048 lds
  v_mfma_f32_16x16x32_bf16 v[212:215], a[152:155], a[4:7], v[212:215]
  ds_read_b64_tr_b16 a[140:141], v1 offset:35872
  ds_read_b64_tr_b16 a[196:197], v31 offset:7232
  v_mfma_f32_16x16x32_bf16 v[212:215], a[156:159], a[20:23], v[212:215]
  v_mfma_f32_16x16x32_bf16 v[208:211], a[156:159], a[16:19], v[208:211]
  ds_read_b64_tr_b16 a[142:143], v1 offset:39456
  ds_read_b64_tr_b16 a[198:199], v31 offset:10816
  v_mfma_f32_16x16x32_bf16 v[208:211], a[152:155], a[0:3], v[208:211]
  s_waitcnt lgkmcnt(15)
  v_mfma_f32_16x16x32_bf16 v[224:227], a[160:163], a[0:3], v[224:227]
  buffer_load_dwordx4 a[92:95], v0, s[36:39], s11 offen offset:3072 sc1
  ds_read_b64_tr_b16 a[200:201], v31 offset:96
  v_mfma_f32_16x16x32_bf16 v[224:227], a[164:167], a[16:19], v[224:227]
  s_bfe_u32 s11, s83, 0x4000c
  s_lshl_b32 s11, s11, 13
  v_mfma_f32_16x16x32_bf16 v[228:231], a[164:167], a[20:23], v[228:231]
  s_add_u32 s11, s11, s85
  ds_read_b64_tr_b16 a[202:203], v31 offset:3680
  v_mfma_f32_16x16x32_bf16 v[228:231], a[160:163], a[4:7], v[228:231]
  v_mfma_f32_16x16x32_bf16 v[232:235], a[160:163], a[8:11], v[232:235]
  ds_read_b64_tr_b16 a[204:205], v31 offset:7264
  v_mfma_f32_16x16x32_bf16 v[232:235], a[164:167], a[24:27], v[232:235]
  buffer_load_dwordx4 a[96:99], v0, s[36:39], s11 offen offset:0 sc1
  v_mfma_f32_16x16x32_bf16 v[236:239], a[164:167], a[28:31], v[236:239]
  ds_read_b64_tr_b16 a[206:207], v31 offset:10848
  v_mfma_f32_16x16x32_bf16 v[236:239], a[160:163], a[12:15], v[236:239]
  v_mfma_f32_16x16x32_bf16 v[252:255], a[168:171], a[12:15], v[252:255]
  ds_read_b64_tr_b16 a[144:145], v1 offset:28736
  v_lshrrev_b32 v22, 4, v0
  v_mfma_f32_16x16x32_bf16 v[252:255], a[172:175], a[28:31], v[252:255]
  v_and_b32 v23, 14, v22
  v_lshlrev_b32 v23, 27, v23
  v_mfma_f32_16x16x32_bf16 v[248:251], a[172:175], a[24:27], v[248:251]
  buffer_load_dwordx4 v6, s[16:19], s10 offen offset:3072 lds
  ds_read_b64_tr_b16 a[146:147], v1 offset:32320
  v_mfma_f32_16x16x32_bf16 v[248:251], a[168:171], a[8:11], v[248:251]
  v_and_b32 v24, 1, v22
  v_lshl_add_u32 v23, v24, 9, v23
  v_mfma_f32_16x16x32_bf16 v[244:247], a[168:171], a[4:7], v[244:247]
  ds_read_b64_tr_b16 a[148:149], v1 offset:35904
  v_and_b32 v22, 0x30, v22
  v_mfma_f32_16x16x32_bf16 v[244:247], a[172:175], a[20:23], v[244:247]
  v_add_u32 v22, v22, v23
  v_mov_b32 v23, 1
  v_mfma_f32_16x16x32_bf16 v[240:243], a[172:175], a[16:19], v[240:243]
  ds_read_b64_tr_b16 a[150:151], v1 offset:39488
  s_lshl3_add_u32 s28, s59, s56
  v_mfma_f32_16x16x32_bf16 v[240:243], a[168:171], a[0:3], v[240:243]
  buffer_load_dwordx4 a[100:103], v0, s[36:39], s11 offen offset:1024 sc1
  s_waitcnt vmcnt(17) lgkmcnt(9)
  v_mfma_f32_16x16x32_bf16 v[32:35], a[128:131], a[32:35], v[32:35]
  s_add_u32 m0, s84, 90112
  ds_read_b64_tr_b16 a[152:153], v1 offset:28768
  v_mfma_f32_16x16x32_bf16 v[32:35], a[132:135], a[48:51], v[32:35]
  s_lshr_b32 s29, s44, 1
  s_barrier
  v_mfma_f32_16x16x32_bf16 v[36:39], a[132:135], a[52:55], v[36:39]
  ds_read_b64_tr_b16 a[154:155], v1 offset:32352
  s_lshl1_add_u32 s28, s28, s29
  v_mfma_f32_16x16x32_bf16 v[36:39], a[128:131], a[36:39], v[36:39]
  s_and_b32 s29, s44, 1
  s_lshl2_add_u32 s28, s28, s29
  v_mfma_f32_16x16x32_bf16 v[40:43], a[128:131], a[40:43], v[40:43]
  buffer_load_dwordx4 v7, s[16:19], s10 offen offset:0 lds
  ds_read_b64_tr_b16 a[156:157], v1 offset:35936
  v_mfma_f32_16x16x32_bf16 v[40:43], a[132:135], a[56:59], v[40:43]
CT14:
  s_add_u32 s94, s92, CT14-k3_main_kernel+3072
  s_addc_u32 s95, s93, 0
  v_mfma_f32_16x16x32_bf16 v[44:47], a[132:135], a[60:63], v[44:47]
  ds_read_b64_tr_b16 a[158:159], v1 offset:39520
  s_lshl_b32 s28, s28, 8
  v_mfma_f32_16x16x32_bf16 v[44:47], a[128:131], a[44:47], v[44:47]
  s_add_u32 s28, s28, 524288
  s_lshl_b32 s45, s2, 7
  v_mfma_f32_16x16x32_bf16 v[60:63], a[136:139], a[44:47], v[60:63]
  ds_read_b64_tr_b16 a[160:161], v1 offset:28800
  s_add_u32 s45, s45, 5373952
  v_mfma_f32_16x16x32_bf16 v[60:63], a[140:143], a[60:63], v[60:63]
  global_load_dword a252, v0, s[94:95]
  s_cmp_eq_u32 s44, 0
  v_mfma_f32_16x16x32_bf16 v[56:59], a[140:143], a[56:59], v[56:59]
  ds_read_b64_tr_b16 a[162:163], v1 offset:32384
  s_cselect_b32 s45, s45, 1073741824
  v_mfma_f32_16x16x32_bf16 v[56:59], a[136:139], a[40:43], v[56:59]
  v_mfma_f32_16x16x32_bf16 v[52:55], a[136:139], a[36:39], v[52:55]
  ds_read_b64_tr_b16 a[164:165], v1 offset:35968
  v_mfma_f32_16x16x32_bf16 v[52:55], a[140:143], a[52:55], v[52:55]
  v_mfma_f32_16x16x32_bf16 v[48:51], a[140:143], a[48:51], v[48:51]
  buffer_load_dwordx4 a[104:107], v0, s[36:39], s11 offen offset:2048 sc1
  ds_read_b64_tr_b16 a[166:167], v1 offset:39552
  v_mfma_f32_16x16x32_bf16 v[48:51], a[136:139], a[32:35], v[48:51]
  s_waitcnt vmcnt(27) lgkmcnt(12)
  v_mfma_f32_16x16x32_bf16 a[216:219], a[176:179], a[208:211], a[216:219]
  ds_read_b64_tr_b16 a[168:169], v1 offset:28832
  v_mfma_f32_16x16x32_bf16 a[216:219], a[180:183], a[212:215], a[216:219]
  v_mfma_f32_16x16x32_bf16 a[220:223], a[184:187], a[208:211], a[220:223]
  ds_read_b64_tr_b16 a[170:171], v1 offset:32416
  v_mfma_f32_16x16x32_bf16 a[220:223], a[188:191], a[212:215], a[220:223]
  buffer_load_dwordx4 v8, s[16:19], s10 offen offset:1024 lds
  v_mfma_f32_16x16x32_bf16 a[224:227], a[192:195], a[208:211], a[224:227]
  ds_read_b64_tr_b16 a[172:173], v1 offset:36000
  v_mfma_f32_16x16x32_bf16 a[224:227], a[196:199], a[212:215], a[224:227]
  v_mfma_f32_16x16x32_bf16 a[228:231], a[200:203], a[208:211], a[228:231]
  ds_read_b64_tr_b16 a[174:175], v1 offset:39584
  v_mfma_f32_16x16x32_bf16 a[228:231], a[204:207], a[212:215], a[228:231]
  s_waitcnt lgkmcnt(8)
  v_mfma_f32_16x16x32_bf16 v[64:67], a[144:147], a[32:35], v[64:67]
  buffer_load_dwordx4 a[108:111], v0, s[36:39], s11 offen offset:3072 sc1
  ds_read_b64_tr_b16 a[128:129], v1 offset:28864
  v_mfma_f32_16x16x32_bf16 v[64:67], a[148:151], a[48:51], v[64:67]
  v_mfma_f32_16x16x32_bf16 v[68:71], a[148:151], a[52:55], v[68:71]
  ds_read_b64_tr_b16 a[130:131], v1 offset:32448
  v_mfma_f32_16x16x32_bf16 v[68:71], a[144:147], a[36:39], v[68:71]
  v_mfma_f32_16x16x32_bf16 v[72:75], a[144:147], a[40:43], v[72:75]
  ds_read_b64_tr_b16 a[132:133], v1 offset:36032
  v_mfma_f32_16x16x32_bf16 v[72:75], a[148:151], a[56:59], v[72:75]
  buffer_load_dwordx4 v9, s[16:19], s10 offen offset:2048 lds
  s_add_u32 s11, s11, 4096
  v_mfma_f32_16x16x32_bf16 v[76:79], a[148:151], a[60:63], v[76:79]
  ds_read_b64_tr_b16 a[134:135], v1 offset:39616
  v_mfma_f32_16x16x32_bf16 v[76:79], a[144:147], a[44:47], v[76:79]
  v_mfma_f32_16x16x32_bf16 v[92:95], a[152:155], a[44:47], v[92:95]
  ds_read_b64_tr_b16 a[136:137], v1 offset:43008
  v_mfma_f32_16x16x32_bf16 v[92:95], a[156:159], a[60:63], v[92:95]
  v_mfma_f32_16x16x32_bf16 v[88:91], a[156:159], a[56:59], v[88:91]
  buffer_load_dwordx4 a[112:115], v0, s[36:39], s11 offen offset:0 sc1
  ds_read_b64_tr_b16 a[138:139], v1 offset:46592
  v_mfma_f32_16x16x32_bf16 v[88:91], a[152:155], a[40:43], v[88:91]
  v_mfma_f32_16x16x32_bf16 v[84:87], a[152:155], a[36:39], v[84:87]
  ds_read_b64_tr_b16 a[140:141], v1 offset:50176
  v_mfma_f32_16x16x32_bf16 v[84:87], a[156:159], a[52:55], v[84:87]
  v_mfma_f32_16x16x32_bf16 v[80:83], a[156:159], a[48:51], v[80:83]
  ds_read_b64_tr_b16 a[142:143], v1 offset:53760
  v_mfma_f32_16x16x32_bf16 v[80:83], a[152:155], a[32:35], v[80:83]
  buffer_store_dwordx4 a[216:219], v22, s[36:39], s28 offen offset:0 sc1
  s_waitcnt lgkmcnt(8)
  v_mfma_f32_16x16x32_bf16 v[96:99], a[160:163], a[32:35], v[96:99]
  ds_read_b64_tr_b16 a[144:145], v1 offset:43040
  v_mfma_f32_16x16x32_bf16 v[96:99], a[164:167], a[48:51], v[96:99]
  v_mfma_f32_16x16x32_bf16 v[100:103], a[164:167], a[52:55], v[100:103]
  ds_read_b64_tr_b16 a[146:147], v1 offset:46624
  v_mfma_f32_16x16x32_bf16 v[100:103], a[160:163], a[36:39], v[100:103]
  v_mfma_f32_16x16x32_bf16 v[104:107], a[160:163], a[40:43], v[104:107]
  buffer_load_dwordx4 a[116:119], v0, s[36:39], s11 offen offset:1024 sc1
  s_bfe_u32 s10, s83, 0x40010
  v_mfma_f32_16x16x32_bf16 v[104:107], a[164:167], a[56:59], v[104:107]
  s_mul_i32 s10, s10, 458752
  s_add_u32 m0, s84, 0
  v_mfma_f32_16x16x32_bf16 v[108:111], a[164:167], a[60:63], v[108:111]
  ds_read_b64_tr_b16 a[148:149], v1 offset:50208
  ds_read_b64_tr_b16 a[150:151], v1 offset:53792
  v_mfma_f32_16x16x32_bf16 v[108:111], a[160:163], a[44:47], v[108:111]
  buffer_store_dwordx4 a[220:223], v22, s[36:39], s28 offen offset:64 sc1
  v_mfma_f32_16x16x32_bf16 v[124:127], a[168:171], a[44:47], v[124:127]
  ds_read_b64_tr_b16 a[152:153], v1 offset:43072
  v_mfma_f32_16x16x32_bf16 v[124:127], a[172:175], a[60:63], v[124:127]
  v_mfma_f32_16x16x32_bf16 v[120:123], a[172:175], a[56:59], v[120:123]
  ds_read_b64_tr_b16 a[154:155], v1 offset:46656
  v_mfma_f32_16x16x32_bf16 v[120:123], a[168:171], a[40:43], v[120:123]
  buffer_store_dwordx4 a[224:227], v22, s[36:39], s28 offen offset:128 sc1
  v_mfma_f32_16x16x32_bf16 v[116:119], a[168:171], a[36:39], v[116:119]
  ds_read_b64_tr_b16 a[156:157], v1 offset:50240
  v_mfma_f32_16x16x32_bf16 v[116:119], a[172:175], a[52:55], v[116:119]
  v_mfma_f32_16x16x32_bf16 v[112:115], a[172:175], a[48:51], v[112:115]
  ds_read_b64_tr_b16 a[158:159], v1 offset:53824
  v_mfma_f32_16x16x32_bf16 v[112:115], a[168:171], a[32:35], v[112:115]
  buffer_store_dwordx4 a[228:231], v22, s[36:39], s28 offen offset:192 sc1
  s_waitcnt lgkmcnt(8)
  v_mfma_f32_16x16x32_bf16 v[128:131], a[128:131], a[32:35], v[128:131]
  ds_read_b64_tr_b16 a[160:161], v1 offset:43104
  v_mfma_f32_16x16x32_bf16 v[128:131], a[132:135], a[48:51], v[128:131]
  v_mfma_f32_16x16x32_bf16 v[132:135], a[132:135], a[52:55], v[132:135]
  ds_read_b64_tr_b16 a[162:163], v1 offset:46688
  v_mfma_f32_16x16x32_bf16 v[132:135], a[128:131], a[36:39], v[132:135]
  v_mfma_f32_16x16x32_bf16 v[136:139], a[128:131], a[40:43], v[136:139]
  buffer_load_dwordx4 v3, s[16:19], s10 offen offset:0 lds
  ds_read_b64_tr_b16 a[164:165], v1 offset:50272
  v_mfma_f32_16x16x32_bf16 v[136:139], a[132:135], a[56:59], v[136:139]
  v_mfma_f32_16x16x32_bf16 v[140:143], a[132:135], a[60:63], v[140:143]
  ds_read_b64_tr_b16 a[166:167], v1 offset:53856
  v_mfma_f32_16x16x32_bf16 v[140:143], a[128:131], a[44:47], v[140:143]
  v_mfma_f32_16x16x32_bf16 v[156:159], a[136:139], a[44:47], v[156:159]
  ds_read_b64_tr_b16 a[168:169], v1 offset:43136
  v_mfma_f32_16x16x32_bf16 v[156:159], a[140:143], a[60:63], v[156:159]
  buffer_load_dwordx4 a[120:123], v0, s[36:39], s11 offen offset:2048 sc1
  v_mfma_f32_16x16x32_bf16 v[152:155], a[140:143], a[56:59], v[152:155]
  ds_read_b64_tr_b16 a[170:171], v1 offset:46720
  v_mfma_f32_16x16x32_bf16 v[152:155], a[136:139], a[40:43], v[152:155]
  v_mfma_f32_16x16x32_bf16 v[148:151], a[136:139], a[36:39], v[148:151]
  ds_read_b64_tr_b16 a[172:173], v1 offset:50304
  v_mfma_f32_16x16x32_bf16 v[148:151], a[140:143], a[52:55], v[148:151]
  v_mfma_f32_16x16x32_bf16 v[144:147], a[140:143], a[48:51], v[144:147]
  buffer_load_dwordx4 v4, s[16:19], s10 offen offset:1024 lds
  ds_read_b64_tr_b16 a[174:175], v1 offset:53888
  v_mfma_f32_16x16x32_bf16 v[144:147], a[136:139], a[32:35], v[144:147]
  s_waitcnt lgkmcnt(8)
  v_mfma_f32_16x16x32_bf16 v[160:163], a[144:147], a[32:35], v[160:163]
  ds_read_b64_tr_b16 a[128:129], v1 offset:43168
  v_mfma_f32_16x16x32_bf16 v[160:163], a[148:151], a[48:51], v[160:163]
  v_mfma_f32_16x16x32_bf16 v[164:167], a[148:151], a[52:55], v[164:167]
  ds_read_b64_tr_b16 a[130:131], v1 offset:46752
  v_mfma_f32_16x16x32_bf16 v[164:167], a[144:147], a[36:39], v[164:167]
  buffer_load_dwordx4 a[124:127], v0, s[36:39], s11 offen offset:3072 sc1
  s_bfe_u32 s11, s83, 0x40010
  v_mfma_f32_16x16x32_bf16 v[168:171], a[144:147], a[40:43], v[168:171]
  s_lshl_b32 s11, s11, 13
  s_add_u32 s11, s11, s85
  v_mfma_f32_16x16x32_bf16 v[168:171], a[148:151], a[56:59], v[168:171]
  ds_read_b64_tr_b16 a[132:133], v1 offset:50336
  v_mfma_f32_16x16x32_bf16 v[172:175], a[148:151], a[60:63], v[172:175]
  ds_read_b64_tr_b16 a[134:135], v1 offset:53920
  v_mfma_f32_16x16x32_bf16 v[172:175], a[144:147], a[44:47], v[172:175]
  s_waitcnt vmcnt(27)
  s_barrier
  v_mfma_f32_16x16x32_bf16 v[188:191], a[152:155], a[44:47], v[188:191]
  buffer_load_dwordx4 a[0:3], v0, s[36:39], s11 offen offset:0 sc1
  ds_read_b64_tr_b16 a[136:137], v1 offset:43200
  v_mfma_f32_16x16x32_bf16 v[188:191], a[156:159], a[60:63], v[188:191]
  v_mfma_f32_16x16x32_bf16 v[184:187], a[156:159], a[56:59], v[184:187]
  ds_read_b64_tr_b16 a[138:139], v1 offset:46784
  v_mfma_f32_16x16x32_bf16 v[184:187], a[152:155], a[40:43], v[184:187]
  v_mfma_f32_16x16x32_bf16 v[180:183], a[152:155], a[36:39], v[180:183]
  ds_read_b64_tr_b16 a[140:141], v1 offset:50368
  v_mfma_f32_16x16x32_bf16 v[180:183], a[156:159], a[52:55], v[180:183]
  buffer_load_dwordx4 v5, s[16:19], s10 offen offset:2048 lds
  v_mfma_f32_16x16x32_bf16 v[176:179], a[156:159], a[48:51], v[176:179]
  ds_read_b64_tr_b16 a[142:143], v1 offset:53952
  v_mfma_f32_16x16x32_bf16 v[176:179], a[152:155], a[32:35], v[176:179]
  s_waitcnt lgkmcnt(8)
  v_mfma_f32_16x16x32_bf16 v[192:195], a[160:163], a[32:35], v[192:195]
  ds_read_b64_tr_b16 a[144:145], v2 offset:0
  v_mfma_f32_16x16x32_bf16 v[192:195], a[164:167], a[48:51], v[192:195]
  v_mfma_f32_16x16x32_bf16 v[196:199], a[164:167], a[52:55], v[196:199]
  buffer_load_dwordx4 a[4:7], v0, s[36:39], s11 offen offset:1024 sc1
  ds_read_b64_tr_b16 a[146:147], v2 offset:3584
  v_mfma_f32_16x16x32_bf16 v[196:199], a[160:163], a[36:39], v[196:199]
  v_mfma_f32_16x16x32_bf16 v[200:203], a[160:163], a[40:43], v[200:203]
  ds_read_b64_tr_b16 a[148:149], v2 offset:7168
  v_mfma_f32_16x16x32_bf16 v[200:203], a[164:167], a[56:59], v[200:203]
  v_mfma_f32_16x16x32_bf16 v[204:207], a[164:167], a[60:63], v[204:207]
  ds_read_b64_tr_b16 a[150:151], v2 offset:10752
  v_mfma_f32_16x16x32_bf16 v[204:207], a[160:163], a[44:47], v[204:207]
  buffer_load_dwordx4 v6, s[16:19], s10 offen offset:3072 lds
  v_mfma_f32_16x16x32_bf16 v[220:223], a[168:171], a[44:47], v[220:223]
  ds_read_b64_tr_b16 a[152:153], v2 offset:32
  v_mfma_f32_16x16x32_bf16 v[220:223], a[172:175], a[60:63], v[220:223]
  v_mfma_f32_16x16x32_bf16 v[216:219], a[172:175], a[56:59], v[216:219]
  ds_read_b64_tr_b16 a[154:155], v2 offset:3616
  v_mfma_f32_16x16x32_bf16 v[216:219], a[168:171], a[40:43], v[216:219]
  v_mfma_f32_16x16x32_bf16 v[212:215], a[168:171], a[36:39], v[212:215]
  buffer_load_dwordx4 a[8:11], v0, s[36:39], s11 offen offset:2048 sc1
  s_add_u32 m0, s84, 4096
  v_mfma_f32_16x16x32_bf16 v[212:215], a[172:175], a[52:55], v[212:215]
  ds_read_b64_tr_b16 a[156:157], v2 offset:7200
  v_mfma_f32_16x16x32_bf16 v[208:211], a[172:175], a[48:51], v[208:211]
  ds_read_b64_tr_b16 a[158:159], v2 offset:10784
  v_mfma_f32_16x16x32_bf16 v[208:211], a[168:171], a[32:35], v[208:211]
  s_waitcnt lgkmcnt(8)
  v_mfma_f32_16x16x32_bf16 v[224:227], a[128:131], a[32:35], v[224:227]
  ds_read_b64_tr_b16 a[160:161], v2 offset:64
  v_mfma_f32_16x16x32_bf16 v[224:227], a[132:135], a[48:51], v[224:227]
  buffer_load_dwordx4 v7, s[16:19], s10 offen offset:0 lds
  v_mfma_f32_16x16x32_bf16 v[228:231], a[132:135], a[52:55], v[228:231]
  ds_read_b64_tr_b16 a[162:163], v2 offset:3648
  v_mfma_f32_16x16x32_bf16 v[228:231], a[128:131], a[36:39], v[228:231]
  v_mfma_f32_16x16x32_bf16 v[232:235], a[128:131], a[40:43], v[232:235]
  ds_read_b64_tr_b16 a[164:165], v2 offset:7232
  v_mfma_f32_16x16x32_bf16 v[232:235], a[132:135], a[56:59], v[232:235]
  v_mfma_f32_16x16x32_bf16 v[236:239], a[132:135], a[60:63], v[236:239]
  buffer_load_dwordx4 a[12:15], v0, s[36:39], s11 offen offset:3072 sc1
  ds_read_b64_tr_b16 a[166:167], v2 offset:10816
  v_mfma_f32_16x16x32_bf16 v[236:239], a[128:131], a[44:47], v[236:239]
  v_mfma_f32_16x16x32_bf16 v[252:255], a[136:139], a[44:47], v[252:255]
  ds_read_b64_tr_b16 a[168:169], v2 offset:96
  v_mfma_f32_16x16x32_bf16 v[252:255], a[140:143], a[60:63], v[252:255]
  v_mfma_f32_16x16x32_bf16 v[248:251], a[140:143], a[56:59], v[248:251]
  ds_read_b64_tr_b16 a[170:171], v2 offset:3680
  v_mfma_f32_16x16x32_bf16 v[248:251], a[136:139], a[40:43], v[248:251]
  buffer_load_dwordx4 v8, s[16:19], s10 offen offset:1024 lds
  s_add_u32 s11, s11, 4096
  v_mfma_f32_16x16x32_bf16 v[244:247], a[136:139], a[36:39], v[244:247]
  ds_read_b64_tr_b16 a[172:173], v2 offset:7264
  v_mfma_f32_16x16x32_bf16 v[244:247], a[140:143], a[52:55], v[244:247]
  v_mfma_f32_16x16x32_bf16 v[240:243], a[140:143], a[48:51], v[240:243]
  ds_read_b64_tr_b16 a[174:175], v2 offset:10848
  v_mfma_f32_16x16x32_bf16 v[240:243], a[136:139], a[32:35], v[240:243]
  s_waitcnt vmcnt(12) lgkmcnt(8)
  v_mfma_f32_16x16x32_bf16 v[32:35], a[144:147], a[64:67], v[32:35]
  buffer_load_dwordx4 a[16:19], v0, s[36:39], s11 offen offset:0 sc1
  ds_read_b64_tr_b16 a[128:129], v2 offset:128
  v_mfma_f32_16x16x32_bf16 v[32:35], a[148:151], a[80:83], v[32:35]
  s_barrier
  v_mfma_f32_16x16x32_bf16 v[36:39], a[148:151], a[84:87], v[36:39]
  ds_read_b64_tr_b16 a[130:131], v2 offset:3712
  s_mov_b64 exec, 1
  buffer_store_dword v23, v0, s[36:39], s45 offen sc1
  s_mov_b64 exec, -1
  v_mfma_f32_16x16x32_bf16 v[36:39], a[144:147], a[68:71], v[36:39]
  s_and_b32 s28, s2, 31
  s_lshl_b32 s28, s28, 7
  v_mfma_f32_16x16x32_bf16 v[40:43], a[144:147], a[72:75], v[40:43]
  ds_read_b64_tr_b16 a[132:133], v2 offset:7296
  s_add_u32 s28, s28, 5373952
  v_mfma_f32_16x16x32_bf16 v[40:43], a[148:151], a[88:91], v[40:43]
  v_and_b32 v22, 0x70, v0
  v_lshlrev_b32 v22, 8, v22
  v_mfma_f32_16x16x32_bf16 v[44:47], a[148:151], a[92:95], v[44:47]
  ds_read_b64_tr_b16 a[134:135], v2 offset:10880
  s_lshl_b32 s29, s59, 14
  v_mfma_f32_16x16x32_bf16 v[44:47], a[144:147], a[76:79], v[44:47]
  buffer_load_dwordx4 a[20:23], v0, s[36:39], s11 offen offset:1024 sc1
  s_lshl_b32 s30, s44, 9
  v_mfma_f32_16x16x32_bf16 v[60:63], a[152:155], a[76:79], v[60:63]
  ds_read_b64_tr_b16 a[136:137], v2 offset:160
  s_add_u32 s29, s29, s30
  v_mfma_f32_16x16x32_bf16 v[60:63], a[156:159], a[92:95], v[60:63]
  s_add_u32 s29, s29, 524288
  s_add_u32 s30, s30, 161792
  v_mfma_f32_16x16x32_bf16 v[56:59], a[156:159], a[88:91], v[56:59]
  ds_read_b64_tr_b16 a[138:139], v2 offset:3744
  v_and_b32 v24, 0x1f0, v0
  v_mfma_f32_16x16x32_bf16 v[56:59], a[152:155], a[72:75], v[56:59]
  v_and_b32 v25, 0x200, v0
  v_lshl_add_u32 v25, v25, 4, v24
  v_mfma_f32_16x16x32_bf16 v[52:55], a[152:155], a[68:71], v[52:55]
  buffer_load_dwordx4 v9, s[16:19], s10 offen offset:2048 lds
  ds_read_b64_tr_b16 a[140:141], v2 offset:7328
  v_mfma_f32_16x16x32_bf16 v[52:55], a[156:159], a[84:87], v[52:55]
  v_add_u32 v24, s30, v24
  s_lshl2_add_u32 s21, s56, s44
  v_mfma_f32_16x16x32_bf16 v[48:51], a[156:159], a[80:83], v[48:51]
  ds_read_b64_tr_b16 a[142:143], v2 offset:10912
  s_lshl_b32 s21, s21, 19
  v_mfma_f32_16x16x32_bf16 v[48:51], a[152:155], a[64:67], v[48:51]
  s_mul_i32 s22, s59, 7
  s_waitcnt lgkmcnt(8)
  v_mfma_f32_16x16x32_bf16 v[64:67], a[160:163], a[64:67], v[64:67]
  ds_read_b64_tr_b16 a[144:145], v2 offset:192
  s_and_b32 s30, s59, 1
  v_mfma_f32_16x16x32_bf16 v[64:67], a[164:167], a[80:83], v[64:67]
  s_add_u32 s22, s22, s30
  s_lshl_b32 s22, s22, 10
  v_mfma_f32_16x16x32_bf16 v[68:71], a[164:167], a[84:87], v[68:71]
  buffer_load_dwordx4 a[24:27], v0, s[36:39], s11 offen offset:2048 sc1
  ds_read_b64_tr_b16 a[146:147], v2 offset:3776
  v_mfma_f32_16x16x32_bf16 v[68:71], a[160:163], a[68:71], v[68:71]
  s_add_u32 s21, s21, s22
  s_add_u32 s23, s21, 19922944
  v_mfma_f32_16x16x32_bf16 v[72:75], a[160:163], a[72:75], v[72:75]
  ds_read_b64_tr_b16 a[148:149], v2 offset:7360
  s_mul_i32 s30, s30, 8184
  v_mfma_f32_16x16x32_bf16 v[72:75], a[164:167], a[88:91], v[72:75]
  s_sub_u32 s21, s23, s30
  s_add_u32 s21, s21, 6144
  v_mfma_f32_16x16x32_bf16 v[76:79], a[164:167], a[92:95], v[76:79]
  s_bfe_u32 s10, s83, 0x40014
  s_mul_i32 s10, s10, 458752
  v_mfma_f32_16x16x32_bf16 v[76:79], a[160:163], a[76:79], v[76:79]
  s_add_u32 m0, s84, 28672
  ds_read_b64_tr_b16 a[150:151], v2 offset:10944
  v_mfma_f32_16x16x32_bf16 v[92:95], a[168:171], a[76:79], v[92:95]
  ds_read_b64_tr_b16 a[152:153], v2 offset:14336
  s_add_u32 s22, s21, 262144
  v_mfma_f32_16x16x32_bf16 v[92:95], a[172:175], a[92:95], v[92:95]
  s_lshl_b32 s45, s2, 7
  s_add_u32 s45, s45, 5406720
  v_mfma_f32_16x16x32_bf16 v[88:91], a[172:175], a[88:91], v[88:91]
  buffer_load_dwordx4 v3, s[16:19], s10 offen offset:0 lds
  ds_read_b64_tr_b16 a[154:155], v2 offset:17920
  v_mfma_f32_16x16x32_bf16 v[88:91], a[168:171], a[72:75], v[88:91]
  s_cmp_eq_u32 s44, 0
  s_cselect_b32 s45, s45, 1073741824
  v_mfma_f32_16x16x32_bf16 v[84:87], a[168:171], a[68:71], v[84:87]
  ds_read_b64_tr_b16 a[156:157], v2 offset:21504
  v_mfma_f32_16x16x32_bf16 v[84:87], a[172:175], a[84:87], v[84:87]
  v_mfma_f32_16x16x32_bf16 v[80:83], a[172:175], a[80:83], v[80:83]
  ds_read_b64_tr_b16 a[158:159], v2 offset:25088
  v_mfma_f32_16x16x32_bf16 v[80:83], a[168:171], a[64:67], v[80:83]
  buffer_load_dwordx4 a[28:31], v0, s[36:39], s11 offen offset:3072 sc1
  s_waitcnt lgkmcnt(8)
  v_mfma_f32_16x16x32_bf16 v[96:99], a[128:131], a[64:67], v[96:99]
  s_bfe_u32 s11, s83, 0x40014
  s_lshl_b32 s11, s11, 13
  v_mfma_f32_16x16x32_bf16 v[96:99], a[132:135], a[80:83], v[96:99]
  s_add_u32 s11, s11, s85
  ds_read_b64_tr_b16 a[160:161], v2 offset:14368
  v_mfma_f32_16x16x32_bf16 v[100:103], a[132:135], a[84:87], v[100:103]
  ds_read_b64_tr_b16 a[162:163], v2 offset:17952
  v_mfma_f32_16x16x32_bf16 v[100:103], a[128:131], a[68:71], v[100:103]
  v_mfma_f32_16x16x32_bf16 v[104:107], a[128:131], a[72:75], v[104:107]
  buffer_load_dwordx4 a[32:35], v0, s[36:39], s11 offen offset:0 sc1
  ds_read_b64_tr_b16 a[164:165], v2 offset:21536
  v_mfma_f32_16x16x32_bf16 v[104:107], a[132:135], a[88:91], v[104:107]
  v_mfma_f32_16x16x32_bf16 v[108:111], a[132:135], a[92:95], v[108:111]
  ds_read_b64_tr_b16 a[166:167], v2 offset:25120
  v_mfma_f32_16x16x32_bf16 v[108:111], a[128:131], a[76:79], v[108:111]
  v_mfma_f32_16x16x32_bf16 v[124:127], a[136:139], a[76:79], v[124:127]
  ds_read_b64_tr_b16 a[168:169], v2 offset:14400
  v_mfma_f32_16x16x32_bf16 v[124:127], a[140:143], a[92:95], v[124:127]
  buffer_load_dwordx4 v4, s[16:19], s10 offen offset:1024 lds
  v_mfma_f32_16x16x32_bf16 v[120:123], a[140:143], a[88:91], v[120:123]
  ds_read_b64_tr_b16 a[170:171], v2 offset:17984
  v_mfma_f32_16x16x32_bf16 v[120:123], a[136:139], a[72:75], v[120:123]
  v_mfma_f32_16x16x32_bf16 v[116:119], a[136:139], a[68:71], v[116:119]
  ds_read_b64_tr_b16 a[172:173], v2 offset:21568
  v_mfma_f32_16x16x32_bf16 v[116:119], a[140:143], a[84:87], v[116:119]
  v_mfma_f32_16x16x32_bf16 v[112:115], a[140:143], a[80:83], v[112:115]
  buffer_load_dwordx4 a[36:39], v0, s[36:39], s11 offen offset:1024 sc1
  ds_read_b64_tr_b16 a[174:175], v2 offset:25152
  v_mfma_f32_16x16x32_bf16 v[112:115], a[136:139], a[64:67], v[112:115]
  s_waitcnt lgkmcnt(8)
  v_mfma_f32_16x16x32_bf16 v[128:131], a[144:147], a[64:67], v[128:131]
  ds_read_b64_tr_b16 a[128:129], v2 offset:14432
  v_mfma_f32_16x16x32_bf16 v[128:131], a[148:151], a[80:83], v[128:131]
  v_mfma_f32_16x16x32_bf16 v[132:135], a[148:151], a[84:87], v[132:135]
  ds_read_b64_tr_b16 a[130:131], v2 offset:18016
  v_mfma_f32_16x16x32_bf16 v[132:135], a[144:147], a[68:71], v[132:135]
  buffer_load_dwordx4 v5, s[16:19], s10 offen offset:2048 lds
  v_mfma_f32_16x16x32_bf16 v[136:139], a[144:147], a[72:75], v[136:139]
  ds_read_b64_tr_b16 a[132:133], v2 offset:21600
  v_mfma_f32_16x16x32_bf16 v[136:139], a[148:151], a[88:91], v[136:139]
  v_mfma_f32_16x16x32_bf16 v[140:143], a[148:151], a[92:95], v[140:143]
  ds_read_b64_tr_b16 a[134:135], v2 offset:25184
  v_mfma_f32_16x16x32_bf16 v[140:143], a[144:147], a[76:79], v[140:143]
  v_mfma_f32_16x16x32_bf16 v[156:159], a[152:155], a[76:79], v[156:159]
  buffer_load_dwordx4 a[40:43], v0, s[36:39], s11 offen offset:2048 sc1
  ds_read_b64_tr_b16 a[136:137], v2 offset:14464
  v_mfma_f32_16x16x32_bf16 v[156:159], a[156:159], a[92:95], v[156:159]
  v_mfma_f32_16x16x32_bf16 v[152:155], a[156:159], a[88:91], v[152:155]
  ds_read_b64_tr_b16 a[138:139], v2 offset:18048
  v_mfma_f32_16x16x32_bf16 v[152:155], a[152:155], a[72:75], v[152:155]
  v_mfma_f32_16x16x32_bf16 v[148:151], a[152:155], a[68:71], v[148:151]
  ds_read_b64_tr_b16 a[140:141], v2 offset:21632
  v_mfma_f32_16x16x32_bf16 v[148:151], a[156:159], a[84:87], v[148:151]
  v_mfma_f32_16x16x32_bf16 v[144:147], a[156:159], a[80:83], v[144:147]
  ds_read_b64_tr_b16 a[142:143], v2 offset:25216
  v_mfma_f32_16x16x32_bf16 v[144:147], a[152:155], a[64:67], v[144:147]
  buffer_load_dwordx4 v6, s[16:19], s10 offen offset:3072 lds
  s_waitcnt lgkmcnt(8)
  v_mfma_f32_16x16x32_bf16 v[160:163], a[160:163], a[64:67], v[160:163]
  ds_read_b64_tr_b16 a[144:145], v2 offset:14496
  v_mfma_f32_16x16x32_bf16 v[160:163], a[164:167], a[80:83], v[160:163]
  v_mfma_f32_16x16x32_bf16 v[164:167], a[164:167], a[84:87], v[164:167]
  ds_read_b64_tr_b16 a[146:147], v2 offset:18080
  v_mfma_f32_16x16x32_bf16 v[164:167], a[160:163], a[68:71], v[164:167]
  v_mfma_f32_16x16x32_bf16 v[168:171], a[160:163], a[72:75], v[168:171]
  buffer_load_dwordx4 a[44:47], v0, s[36:39], s11 offen offset:3072 sc1
  ds_read_b64_tr_b16 a[148:149], v2 offset:21664
  v_mfma_f32_16x16x32_bf16 v[168:171], a[164:167], a[88:91], v[168:171]
  v_mfma_f32_16x16x32_bf16 v[172:175], a[164:167], a[92:95], v[172:175]
  ds_read_b64_tr_b16 a[150:151], v2 offset:25248
  v_mfma_f32_16x16x32_bf16 v[172:175], a[160:163], a[76:79], v[172:175]
  s_add_u32 m0, s84, 32768
  s_waitcnt vmcnt(32)
  s_barrier
  v_mfma_f32_16x16x32_bf16 v[188:191], a[168:171], a[76:79], v[188:191]
  ds_read_b64_tr_b16 a[152:153], v2 offset:14528
  v_mfma_f32_16x16x32_bf16 v[188:191], a[172:175], a[92:95], v[188:191]
  v_mfma_f32_16x16x32_bf16 v[184:187], a[172:175], a[88:91], v[184:187]
  ds_read_b64_tr_b16 a[154:155], v2 offset:18112
  v_mfma_f32_16x16x32_bf16 v[184:187], a[168:171], a[72:75], v[184:187]
  buffer_load_dwordx4 v7, s[16:19], s10 offen offset:0 lds
  s_add_u32 s11, s11, 4096
  v_mfma_f32_16x16x32_bf16 v[180:183], a[168:171], a[68:71], v[180:183]
  ds_read_b64_tr_b16 a[156:157], v2 offset:21696
  v_mfma_f32_16x16x32_bf16 v[180:183], a[172:175], a[84:87], v[180:183]
  v_mfma_f32_16x16x32_bf16 v[176:179], a[172:175], a[80:83], v[176:179]
  ds_read_b64_tr_b16 a[158:159], v2 offset:25280
  v_mfma_f32_16x16x32_bf16 v[176:179], a[168:171], a[64:67], v[176:179]
  s_waitcnt lgkmcnt(8)
  v_mfma_f32_16x16x32_bf16 v[192:195], a[128:131], a[64:67], v[192:195]
  buffer_load_dwordx4 a[48:51], v0, s[36:39], s11 offen offset:0 sc1
  ds_read_b64_tr_b16 a[160:161], v2 offset:28672
  v_mfma_f32_16x16x32_bf16 v[192:195], a[132:135], a[80:83], v[192:195]
  v_mfma_f32_16x16x32_bf16 v[196:199], a[132:135], a[84:87], v[196:199]
  ds_read_b64_tr_b16 a[162:163], v2 offset:32256
  v_mfma_f32_16x16x32_bf16 v[196:199], a[128:131], a[68:71], v[196:199]
  v_mfma_f32_16x16x32_bf16 v[200:203], a[128:131], a[72:75], v[200:203]
  ds_read_b64_tr_b16 a[164:165], v2 offset:35840
  v_mfma_f32_16x16x32_bf16 v[200:203], a[132:135], a[88:91], v[200:203]
  v_mfma_f32_16x16x32_bf16 v[204:207], a[132:135], a[92:95], v[204:207]
  buffer_load_dwordx4 a[52:55], v0, s[36:39], s11 offen offset:1024 sc1
  ds_read_b64_tr_b16 a[166:167], v2 offset:39424
  v_mfma_f32_16x16x32_bf16 v[204:207], a[128:131], a[76:79], v[204:207]
  v_mfma_f32_16x16x32_bf16 v[220:223], a[136:139], a[76:79], v[220:223]
  ds_read_b64_tr_b16 a[168:169], v2 offset:28704
  v_mfma_f32_16x16x32_bf16 v[220:223], a[140:143], a[92:95], v[220:223]
  v_mfma_f32_16x16x32_bf16 v[216:219], a[140:143], a[88:91], v[216:219]
  ds_read_b64_tr_b16 a[170:171], v2 offset:32288
  v_mfma_f32_16x16x32_bf16 v[216:219], a[136:139], a[72:75], v[216:219]
  buffer_load_dwordx4 v8, s[16:19], s10 offen offset:1024 lds
  v_mfma_f32_16x16x32_bf16 v[212:215], a[136:139], a[68:71], v[212:215]
  ds_read_b64_tr_b16 a[172:173], v2 offset:35872
  v_mfma_f32_16x16x32_bf16 v[212:215], a[140:143], a[84:87], v[212:215]
  v_mfma_f32_16x16x32_bf16 v[208:211], a[140:143], a[80:83], v[208:211]
  ds_read_b64_tr_b16 a[174:175], v2 offset:39456
  v_mfma_f32_16x16x32_bf16 v[208:211], a[136:139], a[64:67], v[208:211]
  s_waitcnt lgkmcnt(8)
  v_mfma_f32_16x16x32_bf16 v[224:227], a[144:147], a[64:67], v[224:227]
  buffer_load_dwordx4 a[56:59], v0, s[36:39], s11 offen offset:2048 sc1
  ds_read_b64_tr_b16 a[128:129], v2 offset:28736
  v_mfma_f32_16x16x32_bf16 v[224:227], a[148:151], a[80:83], v[224:227]
  v_mfma_f32_16x16x32_bf16 v[228:231], a[148:151], a[84:87], v[228:231]
  ds_read_b64_tr_b16 a[130:131], v2 offset:32320
  v_mfma_f32_16x16x32_bf16 v[228:231], a[144:147], a[68:71], v[228:231]
  v_mfma_f32_16x16x32_bf16 v[232:235], a[144:147], a[72:75], v[232:235]
  ds_read_b64_tr_b16 a[132:133], v2 offset:35904
  v_mfma_f32_16x16x32_bf16 v[232:235], a[148:151], a[88:91], v[232:235]
  buffer_load_dwordx4 v9, s[16:19], s10 offen offset:2048 lds
  v_mfma_f32_16x16x32_bf16 v[236:239], a[148:151], a[92:95], v[236:239]
  ds_read_b64_tr_b16 a[134:135], v2 offset:39488
  v_mfma_f32_16x16x32_bf16 v[236:239], a[144:147], a[76:79], v[236:239]
  v_mfma_f32_16x16x32_bf16 v[252:255], a[152:155], a[76:79], v[252:255]
  ds_read_b64_tr_b16 a[136:137], v2 offset:28768
  v_mfma_f32_16x16x32_bf16 v[252:255], a[156:159], a[92:95], v[252:255]
  v_mfma_f32_16x16x32_bf16 v[248:251], a[156:159], a[88:91], v[248:251]
  ds_read_b64_tr_b16 a[138:139], v2 offset:32352
  v_mfma_f32_16x16x32_bf16 v[248:251], a[152:155], a[72:75], v[248:251]
  buffer_load_dwordx4 a[60:63], v0, s[36:39], s11 offen offset:3072 sc1
  v_mfma_f32_16x16x32_bf16 v[244:247], a[152:155], a[68:71], v[244:247]
  s_bfe_u32 s11, s83, 0x40018
  s_lshl_b32 s11, s11, 13
  v_mfma_f32_16x16x32_bf16 v[244:247], a[156:159], a[84:87], v[244:247]
  s_add_u32 s11, s11, s85
  ds_read_b64_tr_b16 a[140:141], v2 offset:35936
  v_mfma_f32_16x16x32_bf16 v[240:243], a[156:159], a[80:83], v[240:243]
  ds_read_b64_tr_b16 a[142:143], v2 offset:39520
  v_mfma_f32_16x16x32_bf16 v[240:243], a[152:155], a[64:67], v[240:243]
  s_waitcnt vmcnt(29) lgkmcnt(8)
  v_mfma_f32_16x16x32_bf16 v[32:35], a[160:163], a[96:99], v[32:35]
  buffer_load_dwordx4 a[64:67], v0, s[36:39], s11 offen offset:0 sc1
  ds_read_b64_tr_b16 a[144:145], v2 offset:28800
  v_mfma_f32_16x16x32_bf16 v[32:35], a[164:167], a[112:115], v[32:35]
  s_barrier
  v_mfma_f32_16x16x32_bf16 v[36:39], a[164:167], a[116:119], v[36:39]
  ds_read_b64_tr_b16 a[146:147], v2 offset:32384
  v_mfma_f32_16x16x32_bf16 v[36:39], a[160:163], a[100:103], v[36:39]
  v_mfma_f32_16x16x32_bf16 v[40:43], a[160:163], a[104:107], v[40:43]
  s_bfe_u32 s10, s83, 0x40018
  s_mul_i32 s10, s10, 458752
  v_mfma_f32_16x16x32_bf16 v[40:43], a[164:167], a[120:123], v[40:43]
  s_add_u32 m0, s84, 57344
  ds_read_b64_tr_b16 a[148:149], v2 offset:35968
  v_mfma_f32_16x16x32_bf16 v[44:47], a[164:167], a[124:127], v[44:47]
  ds_read_b64_tr_b16 a[150:151], v2 offset:39552
  v_mfma_f32_16x16x32_bf16 v[44:47], a[160:163], a[108:111], v[44:47]
  v_mfma_f32_16x16x32_bf16 v[60:63], a[168:171], a[108:111], v[60:63]
  buffer_load_dwordx4 v3, s[16:19], s10 offen offset:0 lds
  ds_read_b64_tr_b16 a[152:153], v2 offset:28832
  v_mfma_f32_16x16x32_bf16 v[60:63], a[172:175], a[124:127], v[60:63]
  v_mfma_f32_16x16x32_bf16 v[56:59], a[172:175], a[120:123], v[56:59]
  ds_read_b64_tr_b16 a[154:155], v2 offset:32416
  v_mfma_f32_16x16x32_bf16 v[56:59], a[168:171], a[104:107], v[56:59]
  v_mfma_f32_16x16x32_bf16 v[52:55], a[168:171], a[100:103], v[52:55]
  ds_read_b64_tr_b16 a[156:157], v2 offset:36000
  v_mfma_f32_16x16x32_bf16 v[52:55], a[172:175], a[116:119], v[52:55]
  buffer_load_dword v23, v22, s[36:39], s28 offen sc1
  v_mfma_f32_16x16x32_bf16 v[48:51], a[172:175], a[112:115], v[48:51]
  ds_read_b64_tr_b16 a[158:159], v2 offset:39584
  v_mfma_f32_16x16x32_bf16 v[48:51], a[168:171], a[96:99], v[48:51]
  s_waitcnt lgkmcnt(8)
  v_mfma_f32_16x16x32_bf16 v[64:67], a[128:131], a[96:99], v[64:67]
  ds_read_b64_tr_b16 a[160:161], v2 offset:28864
  v_mfma_f32_16x16x32_bf16 v[64:67], a[132:135], a[112:115], v[64:67]
  v_mfma_f32_16x16x32_bf16 v[68:71], a[132:135], a[116:119], v[68:71]
  buffer_load_dwordx4 a[68:71], v0, s[36:39], s11 offen offset:1024 sc1
  ds_read_b64_tr_b16 a[162:163], v2 offset:32448
  v_mfma_f32_16x16x32_bf16 v[68:71], a[128:131], a[100:103], v[68:71]
  v_mfma_f32_16x16x32_bf16 v[72:75], a[128:131], a[104:107], v[72:75]
  ds_read_b64_tr_b16 a[164:165], v2 offset:36032
  v_mfma_f32_16x16x32_bf16 v[72:75], a[132:135], a[120:123], v[72:75]
  v_mfma_f32_16x16x32_bf16 v[76:79], a[132:135], a[124:127], v[76:79]
  ds_read_b64_tr_b16 a[166:167], v2 offset:39616
CT15:
  s_add_u32 s94, s92, CT15-k3_main_kernel+3072
  s_addc_u32 s95, s93, 0
  v_mfma_f32_16x16x32_bf16 v[76:79], a[128:131], a[108:111], v[76:79]
  global_load_dword a252, v0, s[94:95]
  v_mfma_f32_16x16x32_bf16 v[92:95], a[136:139], a[108:111], v[92:95]
  ds_read_b64_tr_b16 a[168:169], v2 offset:43008
  v_mfma_f32_16x16x32_bf16 v[92:95], a[140:143], a[124:127], v[92:95]
  v_mfma_f32_16x16x32_bf16 v[88:91], a[140:143], a[120:123], v[88:91]
  ds_read_b64_tr_b16 a[170:171], v2 offset:46592
  v_mfma_f32_16x16x32_bf16 v[88:91], a[136:139], a[104:107], v[88:91]
  v_mfma_f32_16x16x32_bf16 v[84:87], a[136:139], a[100:103], v[84:87]
  buffer_load_dwordx4 v4, s[16:19], s10 offen offset:1024 lds
  ds_read_b64_tr_b16 a[172:173], v2 offset:50176
  v_mfma_f32_16x16x32_bf16 v[84:87], a[140:143], a[116:119], v[84:87]
  v_mfma_f32_16x16x32_bf16 v[80:83], a[140:143], a[112:115], v[80:83]
  ds_read_b64_tr_b16 a[174:175], v2 offset:53760
  v_mfma_f32_16x16x32_bf16 v[80:83], a[136:139], a[96:99], v[80:83]
  s_waitcnt lgkmcnt(8)
  v_mfma_f32_16x16x32_bf16 v[96:99], a[144:147], a[96:99], v[96:99]
  ds_read_b64_tr_b16 a[128:129], v2 offset:43040
  v_mfma_f32_16x16x32_bf16 v[96:99], a[148:151], a[112:115], v[96:99]
  buffer_load_dwordx4 a[72:75], v0, s[36:39], s11 offen offset:2048 sc1
  v_mfma_f32_16x16x32_bf16 v[100:103], a[148:151], a[116:119], v[100:103]
  ds_read_b64_tr_b16 a[130:131], v2 offset:46624
  v_mfma_f32_16x16x32_bf16 v[100:103], a[144:147], a[100:103], v[100:103]
  v_mfma_f32_16x16x32_bf16 v[104:107], a[144:147], a[104:107], v[104:107]
  ds_read_b64_tr_b16 a[132:133], v2 offset:50208
  v_mfma_f32_16x16x32_bf16 v[104:107], a[148:151], a[120:123], v[104:107]
  v_mfma_f32_16x16x32_bf16 v[108:111], a[148:151], a[124:127], v[108:111]
  buffer_load_dwordx4 v5, s[16:19], s10 offen offset:2048 lds
  ds_read_b64_tr_b16 a[134:135], v2 offset:53792
  v_mfma_f32_16x16x32_bf16 v[108:111], a[144:147], a[108:111], v[108:111]
  v_mfma_f32_16x16x32_bf16 v[124:127], a[152:155], a[108:111], v[124:127]
  ds_read_b64_tr_b16 a[136:137], v2 offset:43072
  v_mfma_f32_16x16x32_bf16 v[124:127], a[156:159], a[124:127], v[124:127]
  v_mfma_f32_16x16x32_bf16 v[120:123], a[156:159], a[120:123], v[120:123]
  ds_read_b64_tr_b16 a[138:139], v2 offset:46656
  v_mfma_f32_16x16x32_bf16 v[120:123], a[152:155], a[104:107], v[120:123]
  v_mfma_f32_16x16x32_bf16 v[116:119], a[152:155], a[100:103], v[116:119]
  ds_read_b64_tr_b16 a[140:141], v2 offset:50240
  v_mfma_f32_16x16x32_bf16 v[116:119], a[156:159], a[116:119], v[116:119]
  buffer_load_dwordx4 a[76:79], v0, s[36:39], s11 offen offset:3072 sc1
  v_mfma_f32_16x16x32_bf16 v[112:115], a[156:159], a[112:115], v[112:115]
  ds_read_b64_tr_b16 a[142:143], v2 offset:53824
  v_mfma_f32_16x16x32_bf16 v[112:115], a[152:155], a[96:99], v[112:115]
  s_waitcnt lgkmcnt(8)
  v_mfma_f32_16x16x32_bf16 v[128:131], a[160:163], a[96:99], v[128:131]
  ds_read_b64_tr_b16 a[144:145], v2 offset:43104
  v_mfma_f32_16x16x32_bf16 v[128:131], a[164:167], a[112:115], v[128:131]
  v_mfma_f32_16x16x32_bf16 v[132:135], a[164:167], a[116:119], v[132:135]
  ds_read_b64_tr_b16 a[146:147], v2 offset:46688
  v_mfma_f32_16x16x32_bf16 v[132:135], a[160:163], a[100:103], v[132:135]
  v_mfma_f32_16x16x32_bf16 v[136:139], a[160:163], a[104:107], v[136:139]
  ds_read_b64_tr_b16 a[148:149], v2 offset:50272
  v_mfma_f32_16x16x32_bf16 v[136:139], a[164:167], a[120:123], v[136:139]
  buffer_load_dwordx4 v6, s[16:19], s10 offen offset:3072 lds
  v_mfma_f32_16x16x32_bf16 v[140:143], a[164:167], a[124:127], v[140:143]
  ds_read_b64_tr_b16 a[150:151], v2 offset:53856
  v_mfma_f32_16x16x32_bf16 v[140:143], a[160:163], a[108:111], v[140:143]
  v_mfma_f32_16x16x32_bf16 v[156:159], a[168:171], a[108:111], v[156:159]
  s_add_u32 s11, s11, 4096
  ds_read_b64_tr_b16 a[152:153], v2 offset:43136
  v_mfma_f32_16x16x32_bf16 v[156:159], a[172:175], a[124:127], v[156:159]
  v_mfma_f32_16x16x32_bf16 v[152:155], a[172:175], a[120:123], v[152:155]
  ds_read_b64_tr_b16 a[154:155], v2 offset:46720
  v_mfma_f32_16x16x32_bf16 v[152:155], a[168:171], a[104:107], v[152:155]
  v_mfma_f32_16x16x32_bf16 v[148:151], a[168:171], a[100:103], v[148:151]
  buffer_load_dwordx4 a[80:83], v0, s[36:39], s11 offen offset:0 sc1
  ds_read_b64_tr_b16 a[156:157], v2 offset:50304
  v_mfma_f32_16x16x32_bf16 v[148:151], a[172:175], a[116:119], v[148:151]
  v_mfma_f32_16x16x32_bf16 v[144:147], a[172:175], a[112:115], v[144:147]
  ds_read_b64_tr_b16 a[158:159], v2 offset:53888
  v_mfma_f32_16x16x32_bf16 v[144:147], a[168:171], a[96:99], v[144:147]
  s_add_u32 m0, s84, 61440
  s_waitcnt lgkmcnt(8)
  v_mfma_f32_16x16x32_bf16 v[160:163], a[128:131], a[96:99], v[160:163]
  ds_read_b64_tr_b16 a[160:161], v2 offset:43168
  v_mfma_f32_16x16x32_bf16 v[160:163], a[132:135], a[112:115], v[160:163]
  v_mfma_f32_16x16x32_bf16 v[164:167], a[132:135], a[116:119], v[164:167]
  ds_read_b64_tr_b16 a[162:163], v2 offset:46752
  v_mfma_f32_16x16x32_bf16 v[164:167], a[128:131], a[100:103], v[164:167]
  buffer_load_dwordx4 v7, s[16:19], s10 offen offset:0 lds
  v_mfma_f32_16x16x32_bf16 v[168:171], a[128:131], a[104:107], v[168:171]
  ds_read_b64_tr_b16 a[164:165], v2 offset:50336
  v_mfma_f32_16x16x32_bf16 v[168:171], a[132:135], a[120:123], v[168:171]
  v_mfma_f32_16x16x32_bf16 v[172:175], a[132:135], a[124:127], v[172:175]
  ds_read_b64_tr_b16 a[166:167], v2 offset:53920
  v_mfma_f32_16x16x32_bf16 v[172:175], a[128:131], a[108:111], v[172:175]
  s_waitcnt vmcnt(29)
  s_barrier
  v_mfma_f32_16x16x32_bf16 v[188:191], a[136:139], a[108:111], v[188:191]
  ds_read_b64_tr_b16 a[168:169], v2 offset:43200
  v_mfma_f32_16x16x32_bf16 v[188:191], a[140:143], a[124:127], v[188:191]
  v_mfma_f32_16x16x32_bf16 v[184:187], a[140:143], a[120:123], v[184:187]
  ds_read_b64_tr_b16 a[170:171], v2 offset:46784
  v_mfma_f32_16x16x32_bf16 v[184:187], a[136:139], a[104:107], v[184:187]
  buffer_load_dwordx4 a[84:87], v0, s[36:39], s11 offen offset:1024 sc1
  v_mfma_f32_16x16x32_bf16 v[180:183], a[136:139], a[100:103], v[180:183]
  ds_read_b64_tr_b16 a[172:173], v2 offset:50368
  v_mfma_f32_16x16x32_bf16 v[180:183], a[140:143], a[116:119], v[180:183]
  v_mfma_f32_16x16x32_bf16 v[176:179], a[140:143], a[112:115], v[176:179]
  ds_read_b64_tr_b16 a[174:175], v2 offset:53952
  v_mfma_f32_16x16x32_bf16 v[176:179], a[136:139], a[96:99], v[176:179]
  s_waitcnt lgkmcnt(8)
  v_mfma_f32_16x16x32_bf16 v[192:195], a[144:147], a[96:99], v[192:195]
  ds_read_b64_tr_b16 a[128:129], v1 offset:0
  v_mfma_f32_16x16x32_bf16 v[192:195], a[148:151], a[112:115], v[192:195]
  v_mfma_f32_16x16x32_bf16 v[196:199], a[148:151], a[116:119], v[196:199]
  buffer_load_dwordx4 v8, s[16:19], s10 offen offset:1024 lds
  ds_read_b64_tr_b16 a[130:131], v1 offset:3584
  v_mfma_f32_16x16x32_bf16 v[196:199], a[144:147], a[100:103], v[196:199]
  v_mfma_f32_16x16x32_bf16 v[200:203], a[144:147], a[104:107], v[200:203]
  ds_read_b64_tr_b16 a[132:133], v1 offset:7168
  v_mfma_f32_16x16x32_bf16 v[200:203], a[148:151], a[120:123], v[200:203]
  s_waitcnt vmcnt(11)
  v_cmp_ne_u32 vcc, 1, v23
  s_nop 4
  s_cbranch_vccnz CK16s
CK16x:
  v_mfma_f32_16x16x32_bf16 v[204:207], a[148:151], a[124:127], v[204:207]
  ds_read_b64_tr_b16 a[134:135], v1 offset:10752
  v_mfma_f32_16x16x32_bf16 v[204:207], a[144:147], a[108:111], v[204:207]
  buffer_load_dwordx4 a[176:179], v25, s[36:39], s29 offen offset:0 sc1
  v_mfma_f32_16x16x32_bf16 v[220:223], a[152:155], a[108:111], v[220:223]
  ds_read_b64_tr_b16 a[136:137], v1 offset:32
  v_mfma_f32_16x16x32_bf16 v[220:223], a[156:159], a[124:127], v[220:223]
  v_mfma_f32_16x16x32_bf16 v[216:219], a[156:159], a[120:123], v[216:219]
  ds_read_b64_tr_b16 a[138:139], v1 offset:3616
  v_mfma_f32_16x16x32_bf16 v[216:219], a[152:155], a[104:107], v[216:219]
  v_mfma_f32_16x16x32_bf16 v[212:215], a[152:155], a[100:103], v[212:215]
  buffer_load_dwordx4 a[88:91], v0, s[36:39], s11 offen offset:2048 sc1
  ds_read_b64_tr_b16 a[140:141], v1 offset:7200
  v_mfma_f32_16x16x32_bf16 v[212:215], a[156:159], a[116:119], v[212:215]
  v_mfma_f32_16x16x32_bf16 v[208:211], a[156:159], a[112:115], v[208:211]
  ds_read_b64_tr_b16 a[142:143], v1 offset:10784
  v_mfma_f32_16x16x32_bf16 v[208:211], a[152:155], a[96:99], v[208:211]
  s_waitcnt lgkmcnt(8)
  v_mfma_f32_16x16x32_bf16 v[224:227], a[160:163], a[96:99], v[224:227]
  buffer_load_dwordx4 a[180:183], v25, s[36:39], s29 offen offset:2048 sc1
  ds_read_b64_tr_b16 a[144:145], v1 offset:64
  v_mfma_f32_16x16x32_bf16 v[224:227], a[164:167], a[112:115], v[224:227]
  s_add_u32 s29, s29, 4096
  v_mfma_f32_16x16x32_bf16 v[228:231], a[164:167], a[116:119], v[228:231]
  ds_read_b64_tr_b16 a[146:147], v1 offset:3648
  v_mfma_f32_16x16x32_bf16 v[228:231], a[160:163], a[100:103], v[228:231]
  v_mfma_f32_16x16x32_bf16 v[232:235], a[160:163], a[104:107], v[232:235]
  buffer_load_dwordx4 a[184:187], v25, s[36:39], s29 offen offset:0 sc1
  ds_read_b64_tr_b16 a[148:149], v1 offset:7232
  v_mfma_f32_16x16x32_bf16 v[232:235], a[164:167], a[120:123], v[232:235]
  v_mfma_f32_16x16x32_bf16 v[236:239], a[164:167], a[124:127], v[236:239]
  ds_read_b64_tr_b16 a[150:151], v1 offset:10816
  v_mfma_f32_16x16x32_bf16 v[236:239], a[160:163], a[108:111], v[236:239]
  v_mfma_f32_16x16x32_bf16 v[252:255], a[168:171], a[108:111], v[252:255]
  buffer_load_dwordx4 a[188:191], v25, s[36:39], s29 offen offset:2048 sc1
  ds_read_b64_tr_b16 a[152:153], v1 offset:96
  v_mfma_f32_16x16x32_bf16 v[252:255], a[172:175], a[124:127], v[252:255]
  s_mov_b32 s29, 0xbf317218
  s_cmp_lt_u32 s44, 2
  v_mfma_f32_16x16x32_bf16 v[248:251], a[172:175], a[120:123], v[248:251]
  ds_read_b64_tr_b16 a[154:155], v1 offset:3680
  s_cselect_b32 s28, 0xbfb8aa3b, s29
  v_mfma_f32_16x16x32_bf16 v[248:251], a[168:171], a[104:107], v[248:251]
  v_mfma_f32_16x16x32_bf16 v[244:247], a[168:171], a[100:103], v[244:247]
  ds_read_b64_tr_b16 a[156:157], v1 offset:7264
  v_mfma_f32_16x16x32_bf16 v[244:247], a[172:175], a[116:119], v[244:247]
  buffer_load_dwordx4 v9, s[16:19], s10 offen offset:2048 lds
  v_mfma_f32_16x16x32_bf16 v[240:243], a[172:175], a[112:115], v[240:243]
  ds_read_b64_tr_b16 a[158:159], v1 offset:10848
  v_mfma_f32_16x16x32_bf16 v[240:243], a[168:171], a[96:99], v[240:243]
  s_waitcnt vmcnt(34) lgkmcnt(8)
  v_mfma_f32_16x16x32_bf16 v[32:35], a[128:131], a[0:3], v[32:35]
  ds_read_b64_tr_b16 a[160:161], v1 offset:128
  v_mfma_f32_16x16x32_bf16 v[32:35], a[132:135], a[16:19], v[32:35]
  s_waitcnt vmcnt(21)
  s_barrier
  v_mfma_f32_16x16x32_bf16 v[36:39], a[132:135], a[20:23], v[36:39]
  buffer_load_dwordx4 a[92:95], v0, s[36:39], s11 offen offset:3072 sc1
  s_bfe_u32 s11, s83, 0x4001c
  v_mfma_f32_16x16x32_bf16 v[36:39], a[128:131], a[4:7], v[36:39]
  s_lshl_b32 s11, s11, 13
  s_add_u32 s11, s11, s85
  v_mfma_f32_16x16x32_bf16 v[40:43], a[128:131], a[8:11], v[40:43]
  ds_read_b64_tr_b16 a[162:163], v1 offset:3712
  ds_read_b64_tr_b16 a[164:165], v1 offset:7296
  v_mfma_f32_16x16x32_bf16 v[40:43], a[132:135], a[24:27], v[40:43]
  v_mfma_f32_16x16x32_bf16 v[44:47], a[132:135], a[28:31], v[44:47]
  ds_read_b64_tr_b16 a[166:167], v1 offset:10880
  v_mfma_f32_16x16x32_bf16 v[44:47], a[128:131], a[12:15], v[44:47]
  buffer_load_dwordx4 a[96:99], v0, s[36:39], s11 offen offset:0 sc1
  s_bfe_u32 s10, s83, 0x4001c
  v_mfma_f32_16x16x32_bf16 v[60:63], a[136:139], a[12:15], v[60:63]
  s_mul_i32 s10, s10, 458752
  s_add_u32 m0, s84, 86016
  v_mfma_f32_16x16x32_bf16 v[60:63], a[140:143], a[28:31], v[60:63]
  ds_read_b64_tr_b16 a[168:169], v1 offset:160
  v_mfma_f32_16x16x32_bf16 v[56:59], a[140:143], a[24:27], v[56:59]
  ds_read_b64_tr_b16 a[170:171], v1 offset:3744
  v_mfma_f32_16x16x32_bf16 v[56:59], a[136:139], a[8:11], v[56:59]
  v_mfma_f32_16x16x32_bf16 v[52:55], a[136:139], a[4:7], v[52:55]
  buffer_load_dwordx4 v3, s[16:19], s10 offen offset:0 lds
  ds_read_b64_tr_b16 a[172:173], v1 offset:7328
  v_mfma_f32_16x16x32_bf16 v[52:55], a[140:143], a[20:23], v[52:55]
  v_mfma_f32_16x16x32_bf16 v[48:51], a[140:143], a[16:19], v[48:51]
  ds_read_b64_tr_b16 a[174:175], v1 offset:10912
  v_mfma_f32_16x16x32_bf16 v[48:51], a[136:139], a[0:3], v[48:51]
  s_waitcnt lgkmcnt(8)
  v_mfma_f32_16x16x32_bf16 v[64:67], a[144:147], a[0:3], v[64:67]
  ds_read_b64_tr_b16 a[128:129], v1 offset:192
  v_mfma_f32_16x16x32_bf16 v[64:67], a[148:151], a[16:19], v[64:67]
  buffer_load_dwordx4 a[100:103], v0, s[36:39], s11 offen offset:1024 sc1
  v_mfma_f32_16x16x32_bf16 v[68:71], a[148:151], a[20:23], v[68:71]
  ds_read_b64_tr_b16 a[130:131], v1 offset:3776
  v_mfma_f32_16x16x32_bf16 v[68:71], a[144:147], a[4:7], v[68:71]
  v_mfma_f32_16x16x32_bf16 v[72:75], a[144:147], a[8:11], v[72:75]
  ds_read_b64_tr_b16 a[132:133], v1 offset:7360
  v_mfma_f32_16x16x32_bf16 v[72:75], a[148:151], a[24:27], v[72:75]
  v_mfma_f32_16x16x32_bf16 v[76:79], a[148:151], a[28:31], v[76:79]
  buffer_load_dwordx4 v4, s[16:19], s10 offen offset:1024 lds
  ds_read_b64_tr_b16 a[134:135], v1 offset:10944
  v_mfma_f32_16x16x32_bf16 v[76:79], a[144:147], a[12:15], v[76:79]
  v_mfma_f32_16x16x32_bf16 v[92:95], a[152:155], a[12:15], v[92:95]
  ds_read_b64_tr_b16 a[136:137], v1 offset:14336
  v_mfma_f32_16x16x32_bf16 v[92:95], a[156:159], a[28:31], v[92:95]
  v_mfma_f32_16x16x32_bf16 v[88:91], a[156:159], a[24:27], v[88:91]
  ds_read_b64_tr_b16 a[138:139], v1 offset:17920
  v_mfma_f32_16x16x32_bf16 v[88:91], a[152:155], a[8:11], v[88:91]
  buffer_load_dwordx4 a[104:107], v0, s[36:39], s11 offen offset:2048 sc1
  v_mfma_f32_16x16x32_bf16 v[84:87], a[152:155], a[4:7], v[84:87]
  ds_read_b64_tr_b16 a[140:141], v1 offset:21504
  v_mfma_f32_16x16x32_bf16 v[84:87], a[156:159], a[20:23], v[84:87]
  v_mfma_f32_16x16x32_bf16 v[80:83], a[156:159], a[16:19], v[80:83]
  ds_read_b64_tr_b16 a[142:143], v1 offset:25088
  v_mfma_f32_16x16x32_bf16 v[80:83], a[152:155], a[0:3], v[80:83]
  s_waitcnt lgkmcnt(8)
  v_mfma_f32_16x16x32_bf16 v[96:99], a[160:163], a[0:3], v[96:99]
  buffer_load_dwordx4 v5, s[16:19], s10 offen offset:2048 lds
  ds_read_b64_tr_b16 a[144:145], v1 offset:14368
  v_mfma_f32_16x16x32_bf16 v[96:99], a[164:167], a[16:19], v[96:99]
  v_mfma_f32_16x16x32_bf16 v[100:103], a[164:167], a[20:23], v[100:103]
  ds_read_b64_tr_b16 a[146:147], v1 offset:17952
  v_mfma_f32_16x16x32_bf16 v[100:103], a[160:163], a[4:7], v[100:103]
  v_mfma_f32_16x16x32_bf16 v[104:107], a[160:163], a[8:11], v[104:107]
  ds_read_b64_tr_b16 a[148:149], v1 offset:21536
  v_mfma_f32_16x16x32_bf16 v[104:107], a[164:167], a[24:27], v[104:107]
  buffer_load_dwordx4 a[108:111], v0, s[36:39], s11 offen offset:3072 sc1
  v_mfma_f32_16x16x32_bf16 v[108:111], a[164:167], a[28:31], v[108:111]
  ds_read_b64_tr_b16 a[150:151], v1 offset:25120
  v_mfma_f32_16x16x32_bf16 v[108:111], a[160:163], a[12:15], v[108:111]
  v_mfma_f32_16x16x32_bf16 v[124:127], a[168:171], a[12:15], v[124:127]
  ds_read_b64_tr_b16 a[152:153], v1 offset:14400
  v_mfma_f32_16x16x32_bf16 v[124:127], a[172:175], a[28:31], v[124:127]
  v_mfma_f32_16x16x32_bf16 v[120:123], a[172:175], a[24:27], v[120:123]
  buffer_load_dwordx4 v6, s[16:19], s10 offen offset:3072 lds
  s_add_u32 s11, s11, 4096
  v_mfma_f32_16x16x32_bf16 v[120:123], a[168:171], a[8:11], v[120:123]
  ds_read_b64_tr_b16 a[154:155], v1 offset:17984
  v_mfma_f32_16x16x32_bf16 v[116:119], a[168:171], a[4:7], v[116:119]
  ds_read_b64_tr_b16 a[156:157], v1 offset:21568
  v_mfma_f32_16x16x32_bf16 v[116:119], a[172:175], a[20:23], v[116:119]
  v_mfma_f32_16x16x32_bf16 v[112:115], a[172:175], a[16:19], v[112:115]
  ds_read_b64_tr_b16 a[158:159], v1 offset:25152
  v_mfma_f32_16x16x32_bf16 v[112:115], a[168:171], a[0:3], v[112:115]
  buffer_load_dwordx4 a[112:115], v0, s[36:39], s11 offen offset:0 sc1
  s_waitcnt lgkmcnt(8)
  v_mfma_f32_16x16x32_bf16 v[128:131], a[128:131], a[0:3], v[128:131]
  s_add_u32 m0, s84, 90112
  ds_read_b64_tr_b16 a[160:161], v1 offset:14432
  v_mfma_f32_16x16x32_bf16 v[128:131], a[132:135], a[16:19], v[128:131]
  v_mfma_f32_16x16x32_bf16 v[132:135], a[132:135], a[20:23], v[132:135]
  ds_read_b64_tr_b16 a[162:163], v1 offset:18016
  v_mfma_f32_16x16x32_bf16 v[132:135], a[128:131], a[4:7], v[132:135]
  v_mfma_f32_16x16x32_bf16 v[136:139], a[128:131], a[8:11], v[136:139]
  buffer_load_dwordx4 v7, s[16:19], s10 offen offset:0 lds
  ds_read_b64_tr_b16 a[164:165], v1 offset:21600
  v_mfma_f32_16x16x32_bf16 v[136:139], a[132:135], a[24:27], v[136:139]
  v_mfma_f32_16x16x32_bf16 v[140:143], a[132:135], a[28:31], v[140:143]
  ds_read_b64_tr_b16 a[166:167], v1 offset:25184
  v_mfma_f32_16x16x32_bf16 v[140:143], a[128:131], a[12:15], v[140:143]
  v_mfma_f32_16x16x32_bf16 v[156:159], a[136:139], a[12:15], v[156:159]
  ds_read_b64_tr_b16 a[168:169], v1 offset:14464
  v_mfma_f32_16x16x32_bf16 v[156:159], a[140:143], a[28:31], v[156:159]
  buffer_load_dwordx4 a[116:119], v0, s[36:39], s11 offen offset:1024 sc1
  v_mfma_f32_16x16x32_bf16 v[152:155], a[140:143], a[24:27], v[152:155]
  ds_read_b64_tr_b16 a[170:171], v1 offset:18048
  v_mfma_f32_16x16x32_bf16 v[152:155], a[136:139], a[8:11], v[152:155]
  v_mfma_f32_16x16x32_bf16 v[148:151], a[136:139], a[4:7], v[148:151]
  ds_read_b64_tr_b16 a[172:173], v1 offset:21632
  v_mfma_f32_16x16x32_bf16 v[148:151], a[140:143], a[20:23], v[148:151]
  v_mfma_f32_16x16x32_bf16 v[144:147], a[140:143], a[16:19], v[144:147]
  buffer_load_dwordx4 v8, s[16:19], s10 offen offset:1024 lds
  ds_read_b64_tr_b16 a[174:175], v1 offset:25216
  v_mfma_f32_16x16x32_bf16 v[144:147], a[136:139], a[0:3], v[144:147]
  s_waitcnt lgkmcnt(8)
  v_mfma_f32_16x16x32_bf16 v[160:163], a[144:147], a[0:3], v[160:163]
  ds_read_b64_tr_b16 a[128:129], v1 offset:14496
  v_mfma_f32_16x16x32_bf16 v[160:163], a[148:151], a[16:19], v[160:163]
  s_lshl_b32 s31, s44, 8
  s_add_u32 s31, s31, s2
  v_mfma_f32_16x16x32_bf16 v[164:167], a[148:151], a[20:23], v[164:167]
  s_mul_i32 s31, s31, 7168
  ds_read_b64_tr_b16 a[130:131], v1 offset:18080
  v_mfma_f32_16x16x32_bf16 v[164:167], a[144:147], a[4:7], v[164:167]
  buffer_load_dwordx4 a[120:123], v0, s[36:39], s11 offen offset:2048 sc1
  v_mfma_f32_16x16x32_bf16 v[168:171], a[144:147], a[8:11], v[168:171]
  ds_read_b64_tr_b16 a[132:133], v1 offset:21664
  s_waitcnt vmcnt(15)
  v_mfma_f32_16x16x32_bf16 v[168:171], a[148:151], a[24:27], v[168:171]
  v_accvgpr_read_b32 v26, a176
  v_accvgpr_read_b32 v27, a177
  v_mfma_f32_16x16x32_bf16 v[172:175], a[148:151], a[28:31], v[172:175]
  ds_read_b64_tr_b16 a[134:135], v1 offset:25248
  v_accvgpr_read_b32 v28, a178
  v_mfma_f32_16x16x32_bf16 v[172:175], a[144:147], a[12:15], v[172:175]
  v_accvgpr_read_b32 v29, a179
  v_accvgpr_read_b32 v22, a180
  v_mfma_f32_16x16x32_bf16 v[188:191], a[152:155], a[12:15], v[188:191]
  buffer_load_dwordx4 v9, s[16:19], s10 offen offset:2048 lds
  ds_read_b64_tr_b16 a[136:137], v1 offset:14528
  v_mfma_f32_16x16x32_bf16 v[188:191], a[156:159], a[28:31], v[188:191]
  v_accvgpr_read_b32 v23, a181
  v_accvgpr_read_b32 v25, a182
  v_mfma_f32_16x16x32_bf16 v[184:187], a[156:159], a[24:27], v[184:187]
  ds_read_b64_tr_b16 a[138:139], v1 offset:18112
  v_accvgpr_read_b32 v30, a183
  v_mfma_f32_16x16x32_bf16 v[184:187], a[152:155], a[8:11], v[184:187]
  v_add_f32 v26, v26, v22
  v_add_f32 v27, v27, v23
  v_mfma_f32_16x16x32_bf16 v[180:183], a[152:155], a[4:7], v[180:183]
  ds_read_b64_tr_b16 a[140:141], v1 offset:21696
  v_add_f32 v28, v28, v25
  v_mfma_f32_16x16x32_bf16 v[180:183], a[156:159], a[20:23], v[180:183]
  buffer_load_dwordx4 a[124:127], v0, s[36:39], s11 offen offset:3072 sc1
  v_add_f32 v29, v29, v30
  v_mfma_f32_16x16x32_bf16 v[176:179], a[156:159], a[16:19], v[176:179]
  ds_read_b64_tr_b16 a[142:143], v1 offset:25280
  v_accvgpr_read_b32 v22, a184
  v_mfma_f32_16x16x32_bf16 v[176:179], a[152:155], a[0:3], v[176:179]
  v_accvgpr_read_b32 v23, a185
  s_waitcnt lgkmcnt(8)
  v_mfma_f32_16x16x32_bf16 v[192:195], a[160:163], a[0:3], v[192:195]
  ds_read_b64_tr_b16 a[144:145], v1 offset:28864
  v_accvgpr_read_b32 v25, a186
  v_mfma_f32_16x16x32_bf16 v[192:195], a[164:167], a[16:19], v[192:195]
  v_accvgpr_read_b32 v30, a187
  v_add_f32 v26, v26, v22
  v_mfma_f32_16x16x32_bf16 v[196:199], a[164:167], a[20:23], v[196:199]
  ds_read_b64_tr_b16 a[146:147], v1 offset:32448
  v_add_f32 v27, v27, v23
  v_mfma_f32_16x16x32_bf16 v[196:199], a[160:163], a[4:7], v[196:199]
  v_add_f32 v28, v28, v25
  v_add_f32 v29, v29, v30
  v_mfma_f32_16x16x32_bf16 v[200:203], a[160:163], a[8:11], v[200:203]
  ds_read_b64_tr_b16 a[148:149], v1 offset:36032
  v_accvgpr_read_b32 v22, a188
  v_mfma_f32_16x16x32_bf16 v[200:203], a[164:167], a[24:27], v[200:203]
  v_accvgpr_read_b32 v23, a189
  v_accvgpr_read_b32 v25, a190
  v_mfma_f32_16x16x32_bf16 v[204:207], a[164:167], a[28:31], v[204:207]
  ds_read_b64_tr_b16 a[150:151], v1 offset:39616
  v_accvgpr_read_b32 v30, a191
  v_mfma_f32_16x16x32_bf16 v[204:207], a[160:163], a[12:15], v[204:207]
  v_add_f32 v26, v26, v22
  s_waitcnt vmcnt(16)
  s_barrier
  v_mfma_f32_16x16x32_bf16 v[220:223], a[168:171], a[12:15], v[220:223]
  ds_read_b64_tr_b16 a[152:153], v1 offset:43200
  v_add_f32 v27, v27, v23
  v_mfma_f32_16x16x32_bf16 v[220:223], a[172:175], a[28:31], v[220:223]
  v_add_f32 v28, v28, v25
  v_add_f32 v29, v29, v30
  v_mfma_f32_16x16x32_bf16 v[216:219], a[172:175], a[24:27], v[216:219]
  ds_read_b64_tr_b16 a[154:155], v1 offset:46784
  v_mov_b32 v22, v26
  v_mfma_f32_16x16x32_bf16 v[216:219], a[168:171], a[8:11], v[216:219]
  v_mov_b32 v23, v27
  v_mov_b32 v25, v28
  v_mfma_f32_16x16x32_bf16 v[212:215], a[168:171], a[4:7], v[212:215]
  ds_read_b64_tr_b16 a[156:157], v1 offset:50368
  v_mov_b32 v30, v29
  v_mfma_f32_16x16x32_bf16 v[212:215], a[172:175], a[20:23], v[212:215]
  v_permlane32_swap_b32 v26, v22
  v_permlane32_swap_b32 v27, v23
  v_mfma_f32_16x16x32_bf16 v[208:211], a[172:175], a[16:19], v[208:211]
  ds_read_b64_tr_b16 a[158:159], v1 offset:53952
  v_permlane32_swap_b32 v28, v25
  v_mfma_f32_16x16x32_bf16 v[208:211], a[168:171], a[0:3], v[208:211]
  v_permlane32_swap_b32 v29, v30
  s_waitcnt lgkmcnt(8)
  v_mfma_f32_16x16x32_bf16 v[224:227], a[128:131], a[0:3], v[224:227]
  ds_read_b64_tr_b16 a[160:161], v2 offset:192
  v_add_f32 v26, v26, v22
  v_mfma_f32_16x16x32_bf16 v[224:227], a[132:135], a[16:19], v[224:227]
  v_add_f32 v27, v27, v23
  v_add_f32 v28, v28, v25
  v_mfma_f32_16x16x32_bf16 v[228:231], a[132:135], a[20:23], v[228:231]
  ds_read_b64_tr_b16 a[162:163], v2 offset:3776
  v_add_f32 v29, v29, v30
  v_mfma_f32_16x16x32_bf16 v[228:231], a[128:131], a[4:7], v[228:231]
  v_mul_f32 v26, s28, v26
  v_mul_f32 v27, s28, v27
  v_mfma_f32_16x16x32_bf16 v[232:235], a[128:131], a[8:11], v[232:235]
  ds_read_b64_tr_b16 a[164:165], v2 offset:7360
  v_mul_f32 v28, s28, v28
  v_mfma_f32_16x16x32_bf16 v[232:235], a[132:135], a[24:27], v[232:235]
  v_mul_f32 v29, s28, v29
  ds_write_b128 v24, v[26:29]
  v_mfma_f32_16x16x32_bf16 v[236:239], a[132:135], a[28:31], v[236:239]
  ds_read_b64_tr_b16 a[166:167], v2 offset:10944
  s_waitcnt lgkmcnt(1)
  v_mfma_f32_16x16x32_bf16 v[236:239], a[128:131], a[12:15], v[236:239]
  s_waitcnt vmcnt(1)
  s_barrier
  v_mfma_f32_16x16x32_bf16 v[252:255], a[136:139], a[12:15], v[252:255]
  ds_read_b64_tr_b16 a[168:169], v2 offset:14528
  v_mfma_f32_16x16x32_bf16 v[252:255], a[140:143], a[28:31], v[252:255]
  v_mfma_f32_16x16x32_bf16 v[248:251], a[140:143], a[24:27], v[248:251]
  ds_read_b64_tr_b16 a[170:171], v2 offset:18112
  v_mfma_f32_16x16x32_bf16 v[248:251], a[136:139], a[8:11], v[248:251]
  v_mfma_f32_16x16x32_bf16 v[244:247], a[136:139], a[4:7], v[244:247]
  ds_read_b64_tr_b16 a[172:173], v2 offset:21696
  v_mfma_f32_16x16x32_bf16 v[244:247], a[140:143], a[20:23], v[244:247]
  v_mfma_f32_16x16x32_bf16 v[240:243], a[140:143], a[16:19], v[240:243]
  ds_read_b64_tr_b16 a[174:175], v2 offset:25280
  v_mfma_f32_16x16x32_bf16 v[240:243], a[136:139], a[0:3], v[240:243]
  s_waitcnt vmcnt(36) lgkmcnt(9)
  v_mfma_f32_16x16x32_bf16 v[128:131], a[144:147], a[32:35], v[128:131]
  ds_read_b64_tr_b16 a[128:129], v2 offset:28864
CT17:
  s_add_u32 s94, s92, CT17-k3_main_kernel+3072
  s_addc_u32 s95, s93, 0
  v_mfma_f32_16x16x32_bf16 v[128:131], a[148:151], a[48:51], v[128:131]
  global_load_dword a252, v0, s[94:95]
  s_barrier
  v_mfma_f32_16x16x32_bf16 v[132:135], a[148:151], a[52:55], v[132:135]
  ds_read_b64_tr_b16 a[130:131], v2 offset:32448
  v_lshrrev_b32 v31, 4, v0
  v_mfma_f32_16x16x32_bf16 v[132:135], a[144:147], a[36:39], v[132:135]
  v_min_u32 v3, 880, v0
  v_lshlrev_b32 v3, 3, v3
  v_mfma_f32_16x16x32_bf16 v[136:139], a[144:147], a[40:43], v[136:139]
  buffer_load_dword a252, v3, s[24:27], s31 offen
  ds_read_b64_tr_b16 a[132:133], v2 offset:36032
  v_mfma_f32_16x16x32_bf16 v[136:139], a[148:151], a[56:59], v[136:139]
  v_and_b32 v31, 0x30, v31
  v_add_u32 v31, 161792, v31
  v_mfma_f32_16x16x32_bf16 v[140:143], a[148:151], a[60:63], v[140:143]
  ds_read_b64_tr_b16 a[134:135], v2 offset:39616
  ds_read_b128 v[22:25], v31 offset:384
  v_mfma_f32_16x16x32_bf16 v[140:143], a[144:147], a[44:47], v[140:143]
  ds_read_b128 v[26:29], v31 offset:896
  v_mfma_f32_16x16x32_bf16 v[252:255], a[152:155], a[44:47], v[252:255]
  ds_read_b64_tr_b16 a[136:137], v2 offset:43200
  v_mfma_f32_16x16x32_bf16 v[252:255], a[156:159], a[60:63], v[252:255]
  v_mfma_f32_16x16x32_bf16 v[248:251], a[156:159], a[56:59], v[248:251]
  ds_read_b64_tr_b16 a[138:139], v2 offset:46784
  v_mfma_f32_16x16x32_bf16 v[248:251], a[152:155], a[40:43], v[248:251]
  v_mfma_f32_16x16x32_bf16 v[244:247], a[152:155], a[36:39], v[244:247]
  ds_read_b64_tr_b16 a[140:141], v2 offset:50368
  v_mfma_f32_16x16x32_bf16 v[244:247], a[156:159], a[52:55], v[244:247]
  v_mfma_f32_16x16x32_bf16 v[240:243], a[156:159], a[48:51], v[240:243]
  ds_read_b64_tr_b16 a[142:143], v2 offset:53952
  v_mfma_f32_16x16x32_bf16 v[240:243], a[152:155], a[32:35], v[240:243]
  s_waitcnt vmcnt(17) lgkmcnt(10)
  v_mfma_f32_16x16x32_bf16 v[128:131], a[160:163], a[64:67], v[128:131]
  ds_read_b64_tr_b16 a[144:145], v1 offset:28672
  v_mfma_f32_16x16x32_bf16 v[128:131], a[164:167], a[80:83], v[128:131]
  v_mfma_f32_16x16x32_bf16 v[132:135], a[164:167], a[84:87], v[132:135]
  ds_read_b64_tr_b16 a[146:147], v1 offset:32256
  v_mfma_f32_16x16x32_bf16 v[132:135], a[160:163], a[68:71], v[132:135]
  v_mfma_f32_16x16x32_bf16 v[136:139], a[160:163], a[72:75], v[136:139]
  ds_read_b64_tr_b16 a[148:149], v1 offset:35840
  v_mfma_f32_16x16x32_bf16 v[136:139], a[164:167], a[88:91], v[136:139]
  v_mfma_f32_16x16x32_bf16 v[140:143], a[164:167], a[92:95], v[140:143]
  ds_read_b64_tr_b16 a[150:151], v1 offset:39424
  v_mfma_f32_16x16x32_bf16 v[140:143], a[160:163], a[76:79], v[140:143]
  v_mfma_f32_16x16x32_bf16 v[252:255], a[168:171], a[76:79], v[252:255]
  ds_read_b64_tr_b16 a[152:153], v1 offset:43008
  v_mfma_f32_16x16x32_bf16 v[252:255], a[172:175], a[92:95], v[252:255]
  v_mfma_f32_16x16x32_bf16 v[248:251], a[172:175], a[88:91], v[248:251]
  ds_read_b64_tr_b16 a[154:155], v1 offset:46592
  v_mfma_f32_16x16x32_bf16 v[248:251], a[168:171], a[72:75], v[248:251]
  v_mfma_f32_16x16x32_bf16 v[244:247], a[168:171], a[68:71], v[244:247]
  ds_read_b64_tr_b16 a[156:157], v1 offset:50176
  v_mfma_f32_16x16x32_bf16 v[244:247], a[172:175], a[84:87], v[244:247]
  v_mfma_f32_16x16x32_bf16 v[240:243], a[172:175], a[80:83], v[240:243]
  ds_read_b64_tr_b16 a[158:159], v1 offset:53760
  v_mfma_f32_16x16x32_bf16 v[240:243], a[168:171], a[64:67], v[240:243]
  s_waitcnt vmcnt(2) lgkmcnt(8)
  v_mfma_f32_16x16x32_bf16 v[128:131], a[128:131], a[96:99], v[128:131]
  ds_read_b64_tr_b16 a[160:161], v2 offset:0
  v_mfma_f32_16x16x32_bf16 v[128:131], a[132:135], a[112:115], v[128:131]
  v_mfma_f32_16x16x32_bf16 v[132:135], a[132:135], a[116:119], v[132:135]
  ds_read_b64_tr_b16 a[162:163], v2 offset:3584
  v_mfma_f32_16x16x32_bf16 v[132:135], a[128:131], a[100:103], v[132:135]
  v_mfma_f32_16x16x32_bf16 v[136:139], a[128:131], a[104:107], v[136:139]
  ds_read_b64_tr_b16 a[164:165], v2 offset:7168
  v_mfma_f32_16x16x32_bf16 v[136:139], a[132:135], a[120:123], v[136:139]
  v_mfma_f32_16x16x32_bf16 v[140:143], a[132:135], a[124:127], v[140:143]
  ds_read_b64_tr_b16 a[166:167], v2 offset:10752
  v_mfma_f32_16x16x32_bf16 v[140:143], a[128:131], a[108:111], v[140:143]
  v_mfma_f32_16x16x32_bf16 v[252:255], a[136:139], a[108:111], v[252:255]
  ds_read_b64_tr_b16 a[168:169], v2 offset:14336
  v_mfma_f32_16x16x32_bf16 v[252:255], a[140:143], a[124:127], v[252:255]
  v_mfma_f32_16x16x32_bf16 v[248:251], a[140:143], a[120:123], v[248:251]
  ds_read_b64_tr_b16 a[170:171], v2 offset:17920
  s_waitcnt lgkmcnt(15)
  v_mfma_f32_16x16x32_bf16 v[248:251], a[136:139], a[104:107], v[248:251]
  v_fma_f32 v3, v12, v22, v26
  v_fma_f32 v4, v12, v23, v27
  v_mfma_f32_16x16x32_bf16 v[244:247], a[136:139], a[100:103], v[244:247]
  ds_read_b64_tr_b16 a[172:173], v2 offset:21504
  v_fma_f32 v5, v12, v24, v28
  v_mfma_f32_16x16x32_bf16 v[244:247], a[140:143], a[116:119], v[244:247]
  v_fma_f32 v6, v12, v25, v29
  v_fma_f32 v128, v128, v10, v3
  v_mfma_f32_16x16x32_bf16 v[240:243], a[140:143], a[112:115], v[240:243]
  ds_read_b64_tr_b16 a[174:175], v2 offset:25088
  v_fma_f32 v129, v129, v10, v4
  v_mfma_f32_16x16x32_bf16 v[240:243], a[136:139], a[96:99], v[240:243]
  v_fma_f32 v130, v130, v10, v5
  s_waitcnt lgkmcnt(8)
  v_mfma_f32_16x16x32_bf16 v[32:35], a[144:147], a[32:35], v[32:35]
  ds_read_b64_tr_b16 a[128:129], v2 offset:28672
  v_fma_f32 v131, v131, v10, v6
  v_fma_f32 v7, v15, v22, v26
  v_fma_f32 v8, v15, v23, v27
  v_fma_f32 v9, v15, v24, v28
  v_mfma_f32_16x16x32_bf16 v[32:35], a[148:151], a[48:51], v[32:35]
  v_fma_f32 v30, v15, v25, v29
  v_fma_f32 v132, v132, v13, v7
  v_fma_f32 v133, v133, v13, v8
  v_fma_f32 v134, v134, v13, v9
  v_fma_f32 v135, v135, v13, v30
  v_mfma_f32_16x16x32_bf16 v[36:39], a[148:151], a[52:55], v[36:39]
  ds_read_b64_tr_b16 a[130:131], v2 offset:32256
  v_fma_f32 v3, v18, v22, v26
  v_fma_f32 v4, v18, v23, v27
  v_fma_f32 v5, v18, v24, v28
  v_fma_f32 v6, v18, v25, v29
  v_mfma_f32_16x16x32_bf16 v[36:39], a[144:147], a[36:39], v[36:39]
  v_fma_f32 v136, v136, v16, v3
  v_fma_f32 v137, v137, v16, v4
  v_fma_f32 v138, v138, v16, v5
  v_fma_f32 v139, v139, v16, v6
  v_fma_f32 v7, v21, v22, v26
  v_mfma_f32_16x16x32_bf16 v[40:43], a[144:147], a[40:43], v[40:43]
  ds_read_b64_tr_b16 a[132:133], v2 offset:35840
  v_fma_f32 v8, v21, v23, v27
  v_fma_f32 v9, v21, v24, v28
  v_fma_f32 v30, v21, v25, v29
  ds_read_b128 v[22:25], v31 offset:1408
  v_mfma_f32_16x16x32_bf16 v[40:43], a[148:151], a[56:59], v[40:43]
  ds_read_b128 v[26:29], v31 offset:1920
  v_fma_f32 v140, v140, v19, v7
  v_fma_f32 v141, v141, v19, v8
  v_fma_f32 v142, v142, v19, v9
  v_fma_f32 v143, v143, v19, v30
  v_mfma_f32_16x16x32_bf16 v[44:47], a[148:151], a[60:63], v[44:47]
  ds_read_b64_tr_b16 a[134:135], v2 offset:39424
  s_waitcnt lgkmcnt(1)
  v_fma_f32 v7, v21, v22, v26
  v_fma_f32 v8, v21, v23, v27
  v_fma_f32 v9, v21, v24, v28
  v_mfma_f32_16x16x32_bf16 v[44:47], a[144:147], a[44:47], v[44:47]
  v_fma_f32 v30, v21, v25, v29
  v_fma_f32 v252, v252, v20, v7
  v_fma_f32 v253, v253, v20, v8
  v_fma_f32 v254, v254, v20, v9
  v_fma_f32 v255, v255, v20, v30
  v_mfma_f32_16x16x32_bf16 v[156:159], a[152:155], a[44:47], v[156:159]
  ds_read_b64_tr_b16 a[136:137], v2 offset:43008
  v_fma_f32 v3, v18, v22, v26
  v_fma_f32 v4, v18, v23, v27
  v_fma_f32 v5, v18, v24, v28
  v_fma_f32 v6, v18, v25, v29
  v_mfma_f32_16x16x32_bf16 v[156:159], a[156:159], a[60:63], v[156:159]
  v_fma_f32 v248, v248, v17, v3
  v_fma_f32 v249, v249, v17, v4
  v_fma_f32 v250, v250, v17, v5
  v_fma_f32 v251, v251, v17, v6
  v_fma_f32 v7, v15, v22, v26
  v_mfma_f32_16x16x32_bf16 v[152:155], a[156:159], a[56:59], v[152:155]
  ds_read_b64_tr_b16 a[138:139], v2 offset:46592
  v_fma_f32 v8, v15, v23, v27
  v_fma_f32 v9, v15, v24, v28
  v_fma_f32 v30, v15, v25, v29
  v_fma_f32 v244, v244, v14, v7
  v_mfma_f32_16x16x32_bf16 v[152:155], a[152:155], a[40:43], v[152:155]
  v_fma_f32 v245, v245, v14, v8
  v_fma_f32 v246, v246, v14, v9
  v_fma_f32 v247, v247, v14, v30
  v_fma_f32 v3, v12, v22, v26
  v_fma_f32 v4, v12, v23, v27
  v_mfma_f32_16x16x32_bf16 v[148:151], a[152:155], a[36:39], v[148:151]
  ds_read_b64_tr_b16 a[140:141], v2 offset:50176
  v_fma_f32 v5, v12, v24, v28
  v_fma_f32 v6, v12, v25, v29
  ds_read_b128 v[22:25], v31 offset:0
  ds_read_b128 v[26:29], v31 offset:512
  v_mfma_f32_16x16x32_bf16 v[148:151], a[156:159], a[52:55], v[148:151]
  v_fma_f32 v240, v240, v11, v3
  v_fma_f32 v241, v241, v11, v4
  v_fma_f32 v242, v242, v11, v5
  v_fma_f32 v243, v243, v11, v6
  v_exp_f32 v3, v128
  v_mfma_f32_16x16x32_bf16 v[144:147], a[156:159], a[48:51], v[144:147]
  ds_read_b64_tr_b16 a[142:143], v2 offset:53760
  v_exp_f32 v4, v129
  v_exp_f32 v5, v130
  v_mfma_f32_16x16x32_bf16 v[144:147], a[152:155], a[32:35], v[144:147]
  v_exp_f32 v6, v131
  v_exp_f32 v7, v132
  s_waitcnt lgkmcnt(12)
  v_mfma_f32_16x16x32_bf16 v[32:35], a[160:163], a[64:67], v[32:35]
  ds_read_b64_tr_b16 a[144:145], v1 offset:28704
  v_exp_f32 v8, v133
  v_exp_f32 v9, v134
  v_mfma_f32_16x16x32_bf16 v[32:35], a[164:167], a[80:83], v[32:35]
  v_exp_f32 v30, v135
  v_mul_f32 v240, v128, v240
  v_add_f32 v3, 1.0, v3
  v_mul_f32 v241, v129, v241
  v_mfma_f32_16x16x32_bf16 v[36:39], a[164:167], a[84:87], v[36:39]
  ds_read_b64_tr_b16 a[146:147], v1 offset:32288
  v_add_f32 v4, 1.0, v4
  v_mul_f32 v242, v130, v242
  v_add_f32 v5, 1.0, v5
  v_mul_f32 v243, v131, v243
  v_mfma_f32_16x16x32_bf16 v[36:39], a[160:163], a[68:71], v[36:39]
  v_add_f32 v6, 1.0, v6
  v_mul_f32 v244, v132, v244
  v_add_f32 v7, 1.0, v7
  v_mul_f32 v245, v133, v245
  v_add_f32 v8, 1.0, v8
  v_mfma_f32_16x16x32_bf16 v[40:43], a[160:163], a[72:75], v[40:43]
  ds_read_b64_tr_b16 a[148:149], v1 offset:35872
  v_mul_f32 v246, v134, v246
  v_add_f32 v9, 1.0, v9
  v_mul_f32 v247, v135, v247
  v_add_f32 v30, 1.0, v30
  v_mfma_f32_16x16x32_bf16 v[40:43], a[164:167], a[88:91], v[40:43]
  v_rcp_f32 v3, v3
  v_rcp_f32 v4, v4
  v_rcp_f32 v5, v5
  v_mfma_f32_16x16x32_bf16 v[44:47], a[164:167], a[92:95], v[44:47]
  ds_read_b64_tr_b16 a[150:151], v1 offset:39456
  v_rcp_f32 v6, v6
  v_rcp_f32 v7, v7
  v_mfma_f32_16x16x32_bf16 v[44:47], a[160:163], a[76:79], v[44:47]
  v_rcp_f32 v8, v8
  v_rcp_f32 v9, v9
  v_rcp_f32 v30, v30
  v_mfma_f32_16x16x32_bf16 v[156:159], a[168:171], a[76:79], v[156:159]
  ds_read_b64_tr_b16 a[152:153], v1 offset:43040
  v_mul_f32 v240, v240, v3
  v_mul_f32 v241, v241, v4
  v_mul_f32 v242, v242, v5
  v_mul_f32 v243, v243, v6
  v_mfma_f32_16x16x32_bf16 v[156:159], a[172:175], a[92:95], v[156:159]
  v_mul_f32 v244, v244, v7
  v_mul_f32 v245, v245, v8
  v_mul_f32 v246, v246, v9
  v_mul_f32 v247, v247, v30
  v_cvt_pk_bf16_f32 v128, v240, v241
  v_mfma_f32_16x16x32_bf16 v[152:155], a[172:175], a[88:91], v[152:155]
  ds_read_b64_tr_b16 a[154:155], v1 offset:46624
  v_cvt_pk_bf16_f32 v129, v242, v243
  buffer_store_dwordx2 v[128:129], v0, s[36:39], s21 offen offset:0 sc1
  v_cvt_pk_bf16_f32 v132, v244, v245
  v_cvt_pk_bf16_f32 v133, v246, v247
  v_mfma_f32_16x16x32_bf16 v[152:155], a[168:171], a[72:75], v[152:155]
  v_mfma_f32_16x16x32_bf16 v[148:151], a[168:171], a[68:71], v[148:151]
  ds_read_b64_tr_b16 a[156:157], v1 offset:50208
  buffer_store_dwordx2 v[132:133], v0, s[36:39], s21 offen offset:1024 sc1
  v_exp_f32 v3, v136
  v_exp_f32 v4, v137
  v_mfma_f32_16x16x32_bf16 v[148:151], a[172:175], a[84:87], v[148:151]
  v_exp_f32 v5, v138
  v_exp_f32 v6, v139
  v_exp_f32 v7, v140
  v_mfma_f32_16x16x32_bf16 v[144:147], a[172:175], a[80:83], v[144:147]
  ds_read_b64_tr_b16 a[158:159], v1 offset:53792
  v_exp_f32 v8, v141
  v_exp_f32 v9, v142
  v_mfma_f32_16x16x32_bf16 v[144:147], a[168:171], a[64:67], v[144:147]
  v_exp_f32 v30, v143
  v_mul_f32 v248, v136, v248
  v_add_f32 v3, 1.0, v3
  s_waitcnt lgkmcnt(8)
  v_mfma_f32_16x16x32_bf16 v[32:35], a[128:131], a[96:99], v[32:35]
  ds_read_b64_tr_b16 a[160:161], v2 offset:32
CT18:
  s_add_u32 s94, s92, CT18-k3_main_kernel+3072
  s_addc_u32 s95, s93, 0
  global_load_dword a252, v0, s[94:95]
  v_mul_f32 v249, v137, v249
  v_mfma_f32_16x16x32_bf16 v[32:35], a[132:135], a[112:115], v[32:35]
  v_add_f32 v4, 1.0, v4
  v_mul_f32 v250, v138, v250
  v_add_f32 v5, 1.0, v5
  v_mul_f32 v251, v139, v251
  v_add_f32 v6, 1.0, v6
  v_mfma_f32_16x16x32_bf16 v[36:39], a[132:135], a[116:119], v[36:39]
  ds_read_b64_tr_b16 a[162:163], v2 offset:3616
  v_mul_f32 v252, v140, v252
  v_add_f32 v7, 1.0, v7
  v_mul_f32 v253, v141, v253
  v_add_f32 v8, 1.0, v8
  v_mfma_f32_16x16x32_bf16 v[36:39], a[128:131], a[100:103], v[36:39]
  v_mul_f32 v254, v142, v254
  v_add_f32 v9, 1.0, v9
  v_mul_f32 v255, v143, v255
  v_add_f32 v30, 1.0, v30
  v_rcp_f32 v3, v3
  v_mfma_f32_16x16x32_bf16 v[40:43], a[128:131], a[104:107], v[40:43]
  ds_read_b64_tr_b16 a[164:165], v2 offset:7200
  v_rcp_f32 v4, v4
  v_rcp_f32 v5, v5
  v_mfma_f32_16x16x32_bf16 v[40:43], a[132:135], a[120:123], v[40:43]
  v_rcp_f32 v6, v6
  v_rcp_f32 v7, v7
  v_rcp_f32 v8, v8
  v_mfma_f32_16x16x32_bf16 v[44:47], a[132:135], a[124:127], v[44:47]
  ds_read_b64_tr_b16 a[166:167], v2 offset:10784
  v_rcp_f32 v9, v9
  v_rcp_f32 v30, v30
  v_mfma_f32_16x16x32_bf16 v[44:47], a[128:131], a[108:111], v[44:47]
  v_mul_f32 v248, v248, v3
  v_mul_f32 v249, v249, v4
  v_mul_f32 v250, v250, v5
  v_mul_f32 v251, v251, v6
  v_mul_f32 v252, v252, v7
  v_mfma_f32_16x16x32_bf16 v[156:159], a[136:139], a[108:111], v[156:159]
  ds_read_b64_tr_b16 a[168:169], v2 offset:14368
  v_mul_f32 v253, v253, v8
  v_mul_f32 v254, v254, v9
  v_mul_f32 v255, v255, v30
  v_cvt_pk_bf16_f32 v136, v248, v249
  v_mfma_f32_16x16x32_bf16 v[156:159], a[140:143], a[124:127], v[156:159]
  v_cvt_pk_bf16_f32 v137, v250, v251
  buffer_store_dwordx2 v[136:137], v0, s[36:39], s22 offen offset:0 sc1
  v_cvt_pk_bf16_f32 v140, v252, v253
  v_cvt_pk_bf16_f32 v141, v254, v255
  v_mfma_f32_16x16x32_bf16 v[152:155], a[140:143], a[120:123], v[152:155]
  ds_read_b64_tr_b16 a[170:171], v2 offset:17952
  v_mfma_f32_16x16x32_bf16 v[152:155], a[136:139], a[104:107], v[152:155]
  buffer_store_dwordx2 v[140:141], v0, s[36:39], s22 offen offset:1024 sc1
  s_mov_b32 s21, s23
  s_add_u32 s22, s23, 262144
  s_waitcnt lgkmcnt(15)
  v_fma_f32 v3, v12, v22, v26
  v_mfma_f32_16x16x32_bf16 v[148:151], a[136:139], a[100:103], v[148:151]
  v_lshrrev_b32 v128, 4, v0
  s_add_u32 s41, s55, s72
  s_and_b32 s41, s41, 3
  s_and_b32 s54, s2, 1
  s_lshl_b32 s43, s71, 7
  v_mfma_f32_16x16x32_bf16 v[148:151], a[140:143], a[116:119], v[148:151]
  s_lshl3_add_u32 s43, s74, s43
  s_mul_i32 s42, s54, 3670016
  s_add_u32 s43, s43, s42
  s_lshr_b32 s42, s44, 1
  s_mul_i32 s42, s42, 393216
  v_mfma_f32_16x16x32_bf16 v[144:147], a[140:143], a[112:115], v[144:147]
  v_bfe_u32 v129, v128, 4, 2
  v_bfe_u32 v130, v128, 1, 2
  v_xor_b32 v129, v129, v130
  v_lshlrev_b32 v129, 5, v129
  v_and_b32 v130, 1, v128
  v_mfma_f32_16x16x32_bf16 v[144:147], a[136:139], a[96:99], v[144:147]
  v_lshl_add_u32 v129, v130, 4, v129
  v_lshrrev_b32 v130, 3, v128
  v_lshlrev_b32 v130, 11, v130
  s_sub_u32 s24, s24, 2048
  s_waitcnt lgkmcnt(6)
  v_mfma_f32_16x16x32_bf16 v[48:51], a[144:147], a[32:35], v[48:51]
  s_subb_u32 s25, s25, 0
  s_mov_b32 s26, 7342080
  v_add3_u32 v129, v129, v130, s43
  v_add_u32 v133, 2048, v129
  v_add_u32 v134, 17408, v129
  v_mfma_f32_16x16x32_bf16 v[48:51], a[148:151], a[48:51], v[48:51]
  v_xor_b32 v135, 128, v129
  v_add_u32 v136, 15360, v135
  v_and_b32 v129, 7, v128
  v_lshrrev_b32 v131, 4, v128
  v_xor_b32 v129, v129, v131
  v_mfma_f32_16x16x32_bf16 v[52:55], a[148:151], a[52:55], v[52:55]
  v_lshl_add_u32 v252, v129, 4, v130
  v_xor_b32 v253, 64, v252
  v_add_u32 v253, 16384, v253
  s_lshl2_add_u32 s43, s55, s44
  s_lshl_b32 s43, s43, 18
  v_mfma_f32_16x16x32_bf16 v[52:55], a[144:147], a[36:39], v[52:55]
  s_mul_i32 s57, s54, 114688
  s_add_u32 s43, s43, s57
  s_add_u32 s43, s43, 19922944
  v_add_u32 v137, s43, v0
  v_bfe_u32 v129, v128, 3, 2
  v_mfma_f32_16x16x32_bf16 v[56:59], a[144:147], a[40:43], v[56:59]
  v_lshlrev_b32 v129, 5, v129
  v_and_b32 v130, 3, v128
  v_lshl_add_u32 v129, v130, 3, v129
  v_lshrrev_b32 v130, 2, v128
  v_lshl_add_u32 v240, v130, 7, v129
  v_mfma_f32_16x16x32_bf16 v[56:59], a[148:151], a[56:59], v[56:59]
  v_xor_b32 v241, 32, v240
  v_xor_b32 v242, 64, v240
  v_xor_b32 v243, 96, v240
  v_xor_b32 v244, 65536, v240
  v_xor_b32 v245, 65568, v240
  v_mfma_f32_16x16x32_bf16 v[60:63], a[148:151], a[60:63], v[60:63]
  v_xor_b32 v246, 65600, v240
  v_xor_b32 v247, 65632, v240
  v_xor_b32 v248, 131072, v240
  v_xor_b32 v249, 131104, v240
  v_xor_b32 v250, 131136, v240
  v_mfma_f32_16x16x32_bf16 v[60:63], a[144:147], a[44:47], v[60:63]
  v_xor_b32 v251, 131168, v240
  s_lshr_b32 s43, s55, 1
  s_lshl_b32 s43, s43, 5
  s_lshl2_add_u32 s43, s54, s43
  v_and_b32 v129, 3, v128
  v_mfma_f32_16x16x32_bf16 v[172:175], a[152:155], a[44:47], v[172:175]
  v_bfe_u32 v130, v128, 2, 2
  v_lshl_add_u32 v129, v129, 3, v130
  v_add_lshl_u32 v138, v129, s43, 7
  v_mov_b32 v254, 1
  s_mov_b32 s57, 5406720
  v_mfma_f32_16x16x32_bf16 v[172:175], a[156:159], a[60:63], v[172:175]
  ds_read_b64_tr_b16 a[172:173], v2 offset:21536
  ds_read_b64_tr_b16 a[174:175], v2 offset:25120
  ds_read_b64_tr_b16 a[128:129], v2 offset:28704
  ds_read_b64_tr_b16 a[130:131], v2 offset:32288
  ds_read_b64_tr_b16 a[132:133], v2 offset:35872
  v_mfma_f32_16x16x32_bf16 v[168:171], a[156:159], a[56:59], v[168:171]
  ds_read_b64_tr_b16 a[134:135], v2 offset:39456
  ds_read_b64_tr_b16 a[136:137], v2 offset:43040
  ds_read_b64_tr_b16 a[138:139], v2 offset:46624
  v_fma_f32 v4, v12, v23, v27
  v_fma_f32 v5, v12, v24, v28
  v_mfma_f32_16x16x32_bf16 v[168:171], a[152:155], a[40:43], v[168:171]
  v_fma_f32 v6, v12, v25, v29
  v_fma_f32 v32, v32, v10, v3
  v_fma_f32 v33, v33, v10, v4
  v_fma_f32 v34, v34, v10, v5
  v_fma_f32 v35, v35, v10, v6
  v_mfma_f32_16x16x32_bf16 v[164:167], a[152:155], a[36:39], v[164:167]
  ds_read_b64_tr_b16 a[140:141], v2 offset:50208
  v_fma_f32 v7, v15, v22, v26
  v_fma_f32 v8, v15, v23, v27
  v_fma_f32 v9, v15, v24, v28
  v_fma_f32 v30, v15, v25, v29
  v_mfma_f32_16x16x32_bf16 v[164:167], a[156:159], a[52:55], v[164:167]
  v_fma_f32 v36, v36, v13, v7
  v_fma_f32 v37, v37, v13, v8
  v_fma_f32 v38, v38, v13, v9
  v_fma_f32 v39, v39, v13, v30
  v_fma_f32 v3, v18, v22, v26
  v_mfma_f32_16x16x32_bf16 v[160:163], a[156:159], a[48:51], v[160:163]
  ds_read_b64_tr_b16 a[142:143], v2 offset:53792
  v_fma_f32 v4, v18, v23, v27
  v_fma_f32 v5, v18, v24, v28
  v_fma_f32 v6, v18, v25, v29
  v_fma_f32 v40, v40, v16, v3
  v_mfma_f32_16x16x32_bf16 v[160:163], a[152:155], a[32:35], v[160:163]
  v_fma_f32 v41, v41, v16, v4
  v_fma_f32 v42, v42, v16, v5
  v_fma_f32 v43, v43, v16, v6
  v_fma_f32 v7, v21, v22, v26
  s_waitcnt lgkmcnt(8)
  v_mfma_f32_16x16x32_bf16 v[48:51], a[160:163], a[64:67], v[48:51]
  ds_read_b64_tr_b16 a[144:145], v1 offset:28736
  v_fma_f32 v8, v21, v23, v27
  v_fma_f32 v9, v21, v24, v28
  v_fma_f32 v30, v21, v25, v29
  ds_read_b128 v[22:25], v31 offset:1024
  v_mfma_f32_16x16x32_bf16 v[48:51], a[164:167], a[80:83], v[48:51]
  ds_read_b128 v[26:29], v31 offset:1536
  v_fma_f32 v44, v44, v19, v7
  v_fma_f32 v45, v45, v19, v8
  v_fma_f32 v46, v46, v19, v9
  v_fma_f32 v47, v47, v19, v30
  v_mfma_f32_16x16x32_bf16 v[52:55], a[164:167], a[84:87], v[52:55]
  ds_read_b64_tr_b16 a[146:147], v1 offset:32320
  s_waitcnt lgkmcnt(1)
  v_fma_f32 v7, v21, v22, v26
  v_fma_f32 v8, v21, v23, v27
  v_fma_f32 v9, v21, v24, v28
  v_mfma_f32_16x16x32_bf16 v[52:55], a[160:163], a[68:71], v[52:55]
  v_fma_f32 v30, v21, v25, v29
  v_fma_f32 v156, v156, v20, v7
  v_fma_f32 v157, v157, v20, v8
  v_fma_f32 v158, v158, v20, v9
  v_fma_f32 v159, v159, v20, v30
  v_mfma_f32_16x16x32_bf16 v[56:59], a[160:163], a[72:75], v[56:59]
  ds_read_b64_tr_b16 a[148:149], v1 offset:35904
  v_fma_f32 v3, v18, v22, v26
  v_fma_f32 v4, v18, v23, v27
  v_fma_f32 v5, v18, v24, v28
  v_fma_f32 v6, v18, v25, v29
  v_mfma_f32_16x16x32_bf16 v[56:59], a[164:167], a[88:91], v[56:59]
  v_fma_f32 v152, v152, v17, v3
  v_fma_f32 v153, v153, v17, v4
  v_fma_f32 v154, v154, v17, v5
  v_fma_f32 v155, v155, v17, v6
  v_fma_f32 v7, v15, v22, v26
  v_mfma_f32_16x16x32_bf16 v[60:63], a[164:167], a[92:95], v[60:63]
  ds_read_b64_tr_b16 a[150:151], v1 offset:39488
  v_fma_f32 v8, v15, v23, v27
  v_fma_f32 v9, v15, v24, v28
  v_fma_f32 v30, v15, v25, v29
  v_fma_f32 v148, v148, v14, v7
  v_mfma_f32_16x16x32_bf16 v[60:63], a[160:163], a[76:79], v[60:63]
  v_fma_f32 v149, v149, v14, v8
  v_fma_f32 v150, v150, v14, v9
  v_fma_f32 v151, v151, v14, v30
  v_fma_f32 v3, v12, v22, v26
  v_fma_f32 v4, v12, v23, v27
  v_mfma_f32_16x16x32_bf16 v[172:175], a[168:171], a[76:79], v[172:175]
  ds_read_b64_tr_b16 a[152:153], v1 offset:43072
  v_fma_f32 v5, v12, v24, v28
  v_fma_f32 v6, v12, v25, v29
  ds_read_b128 v[22:25], v31 offset:64
  ds_read_b128 v[26:29], v31 offset:576
  v_mfma_f32_16x16x32_bf16 v[172:175], a[172:175], a[92:95], v[172:175]
  v_fma_f32 v144, v144, v11, v3
  v_fma_f32 v145, v145, v11, v4
  v_fma_f32 v146, v146, v11, v5
  v_fma_f32 v147, v147, v11, v6
  v_exp_f32 v3, v32
  v_mfma_f32_16x16x32_bf16 v[168:171], a[172:175], a[88:91], v[168:171]
  s_mov_b32 s6, 3
  s_lshl_b32 s4, s6, 16
  s_add_u32 m0, s74, 114688
  ds_read_b64_tr_b16 a[154:155], v1 offset:46656
  v_exp_f32 v4, v33
  v_mfma_f32_16x16x32_bf16 v[168:171], a[168:171], a[72:75], v[168:171]
  v_exp_f32 v5, v34
  v_exp_f32 v6, v35
  v_exp_f32 v7, v36
  v_mfma_f32_16x16x32_bf16 v[164:167], a[168:171], a[68:71], v[164:167]
  ds_read_b64_tr_b16 a[156:157], v1 offset:50240
  v_exp_f32 v8, v37
  v_exp_f32 v9, v38
  v_mfma_f32_16x16x32_bf16 v[164:167], a[172:175], a[84:87], v[164:167]
  v_exp_f32 v30, v39
  v_mul_f32 v144, v32, v144
  v_add_f32 v3, 1.0, v3
  v_mul_f32 v145, v33, v145
  v_mfma_f32_16x16x32_bf16 v[160:163], a[172:175], a[80:83], v[160:163]
  buffer_load_dwordx4 v133, s[24:27], s4 offen offset:0 lds
  ds_read_b64_tr_b16 a[158:159], v1 offset:53824
  v_add_f32 v4, 1.0, v4
  v_mul_f32 v146, v34, v146
  v_add_f32 v5, 1.0, v5
  v_mfma_f32_16x16x32_bf16 v[160:163], a[168:171], a[64:67], v[160:163]
  v_mul_f32 v147, v35, v147
  v_add_f32 v6, 1.0, v6
  v_mul_f32 v148, v36, v148
  v_add_f32 v7, 1.0, v7
  s_waitcnt lgkmcnt(12)
  v_mfma_f32_16x16x32_bf16 v[48:51], a[128:131], a[96:99], v[48:51]
  ds_read_b64_tr_b16 a[160:161], v2 offset:64
  v_mul_f32 v149, v37, v149
  v_add_f32 v8, 1.0, v8
  v_mul_f32 v150, v38, v150
  v_add_f32 v9, 1.0, v9
  v_mfma_f32_16x16x32_bf16 v[48:51], a[132:135], a[112:115], v[48:51]
  v_mul_f32 v151, v39, v151
  v_add_f32 v30, 1.0, v30
  v_rcp_f32 v3, v3
  v_rcp_f32 v4, v4
  v_mfma_f32_16x16x32_bf16 v[52:55], a[132:135], a[116:119], v[52:55]
  ds_read_b64_tr_b16 a[162:163], v2 offset:3648
  v_rcp_f32 v5, v5
  v_rcp_f32 v6, v6
  v_mfma_f32_16x16x32_bf16 v[52:55], a[128:131], a[100:103], v[52:55]
  buffer_load_dwordx4 v134, s[24:27], s4 offen offset:1024 lds
  v_rcp_f32 v7, v7
  v_rcp_f32 v8, v8
  v_mfma_f32_16x16x32_bf16 v[56:59], a[128:131], a[104:107], v[56:59]
  ds_read_b64_tr_b16 a[164:165], v2 offset:7232
  v_rcp_f32 v9, v9
  v_rcp_f32 v30, v30
  v_mfma_f32_16x16x32_bf16 v[56:59], a[132:135], a[120:123], v[56:59]
  v_mul_f32 v144, v144, v3
  v_mul_f32 v145, v145, v4
  v_mul_f32 v146, v146, v5
  v_mul_f32 v147, v147, v6
  v_mul_f32 v148, v148, v7
  v_mfma_f32_16x16x32_bf16 v[60:63], a[132:135], a[124:127], v[60:63]
  ds_read_b64_tr_b16 a[166:167], v2 offset:10816
  v_mul_f32 v149, v149, v8
  v_mul_f32 v150, v150, v9
  v_mul_f32 v151, v151, v30
  v_cvt_pk_bf16_f32 v32, v144, v145
  v_mfma_f32_16x16x32_bf16 v[60:63], a[128:131], a[108:111], v[60:63]
  v_cvt_pk_bf16_f32 v33, v146, v147
  v_cvt_pk_bf16_f32 v36, v148, v149
  v_cvt_pk_bf16_f32 v37, v150, v151
  v_exp_f32 v3, v40
  v_mfma_f32_16x16x32_bf16 v[172:175], a[136:139], a[108:111], v[172:175]
  buffer_load_dwordx4 v135, s[24:27], s4 offen offset:2048 lds
  ds_read_b64_tr_b16 a[168:169], v2 offset:14400
  v_exp_f32 v4, v41
  v_exp_f32 v5, v42
  v_mfma_f32_16x16x32_bf16 v[172:175], a[140:143], a[124:127], v[172:175]
  v_exp_f32 v6, v43
  v_exp_f32 v7, v44
  v_exp_f32 v8, v45
  v_mfma_f32_16x16x32_bf16 v[168:171], a[140:143], a[120:123], v[168:171]
  ds_read_b64_tr_b16 a[170:171], v2 offset:17984
  v_exp_f32 v9, v46
  v_exp_f32 v30, v47
  v_mfma_f32_16x16x32_bf16 v[168:171], a[136:139], a[104:107], v[168:171]
  v_mul_f32 v152, v40, v152
  v_add_f32 v3, 1.0, v3
  v_mul_f32 v153, v41, v153
  v_add_f32 v4, 1.0, v4
  v_mul_f32 v154, v42, v154
  v_mfma_f32_16x16x32_bf16 v[164:167], a[136:139], a[100:103], v[164:167]
  ds_read_b64_tr_b16 a[172:173], v2 offset:21568
  v_add_f32 v5, 1.0, v5
  v_mul_f32 v155, v43, v155
  v_add_f32 v6, 1.0, v6
  v_mul_f32 v156, v44, v156
  v_mfma_f32_16x16x32_bf16 v[164:167], a[140:143], a[116:119], v[164:167]
  buffer_load_dwordx4 v136, s[24:27], s4 offen offset:3072 lds
  v_add_f32 v7, 1.0, v7
  v_mul_f32 v157, v45, v157
  v_add_f32 v8, 1.0, v8
  v_mul_f32 v158, v46, v158
  v_mfma_f32_16x16x32_bf16 v[160:163], a[140:143], a[112:115], v[160:163]
  s_cmp_eq_u32 s41, 1
  s_cselect_b32 s7, 38, 10
  s_lshl_b32 s4, s7, 16
  s_add_u32 m0, s74, 131072
  ds_read_b64_tr_b16 a[174:175], v2 offset:25152
  v_mfma_f32_16x16x32_bf16 v[160:163], a[136:139], a[96:99], v[160:163]
  v_add_f32 v9, 1.0, v9
  v_mul_f32 v159, v47, v159
  v_add_f32 v30, 1.0, v30
  v_rcp_f32 v3, v3
  s_waitcnt lgkmcnt(8)
  v_mfma_f32_16x16x32_bf16 v[64:67], a[144:147], a[32:35], v[64:67]
  ds_read_b64_tr_b16 a[128:129], v2 offset:28736
  v_rcp_f32 v4, v4
  v_rcp_f32 v5, v5
  v_mfma_f32_16x16x32_bf16 v[64:67], a[148:151], a[48:51], v[64:67]
  v_rcp_f32 v6, v6
  v_rcp_f32 v7, v7
  v_rcp_f32 v8, v8
  v_mfma_f32_16x16x32_bf16 v[68:71], a[148:151], a[52:55], v[68:71]
  buffer_load_dwordx4 v133, s[24:27], s4 offen offset:0 lds
  ds_read_b64_tr_b16 a[130:131], v2 offset:32320
  v_rcp_f32 v9, v9
  v_rcp_f32 v30, v30
  v_mfma_f32_16x16x32_bf16 v[68:71], a[144:147], a[36:39], v[68:71]
  v_mul_f32 v152, v152, v3
  v_mul_f32 v153, v153, v4
  v_mul_f32 v154, v154, v5
  v_mul_f32 v155, v155, v6
  v_mul_f32 v156, v156, v7
  v_mfma_f32_16x16x32_bf16 v[72:75], a[144:147], a[40:43], v[72:75]
  ds_read_b64_tr_b16 a[132:133], v2 offset:35904
  v_mul_f32 v157, v157, v8
  v_mul_f32 v158, v158, v9
  v_mul_f32 v159, v159, v30
  v_cvt_pk_bf16_f32 v40, v152, v153
  v_mfma_f32_16x16x32_bf16 v[72:75], a[148:151], a[56:59], v[72:75]
  v_cvt_pk_bf16_f32 v41, v154, v155
  v_cvt_pk_bf16_f32 v44, v156, v157
  v_cvt_pk_bf16_f32 v45, v158, v159
  s_waitcnt lgkmcnt(14)
  v_fma_f32 v3, v12, v22, v26
  v_mfma_f32_16x16x32_bf16 v[76:79], a[148:151], a[60:63], v[76:79]
  ds_read_b64_tr_b16 a[134:135], v2 offset:39488
  v_fma_f32 v4, v12, v23, v27
  v_fma_f32 v5, v12, v24, v28
  v_fma_f32 v6, v12, v25, v29
  v_fma_f32 v48, v48, v10, v3
  v_mfma_f32_16x16x32_bf16 v[76:79], a[144:147], a[44:47], v[76:79]
  buffer_load_dwordx4 v134, s[24:27], s4 offen offset:1024 lds
  v_fma_f32 v49, v49, v10, v4
  v_fma_f32 v50, v50, v10, v5
  v_fma_f32 v51, v51, v10, v6
  v_fma_f32 v7, v15, v22, v26
  v_mfma_f32_16x16x32_bf16 v[188:191], a[152:155], a[44:47], v[188:191]
  ds_read_b64_tr_b16 a[136:137], v2 offset:43072
  v_fma_f32 v8, v15, v23, v27
  v_fma_f32 v9, v15, v24, v28
  v_fma_f32 v30, v15, v25, v29
  v_fma_f32 v52, v52, v13, v7
  v_mfma_f32_16x16x32_bf16 v[188:191], a[156:159], a[60:63], v[188:191]
  v_fma_f32 v53, v53, v13, v8
  v_fma_f32 v54, v54, v13, v9
  v_fma_f32 v55, v55, v13, v30
  v_fma_f32 v3, v18, v22, v26
  v_fma_f32 v4, v18, v23, v27
  v_mfma_f32_16x16x32_bf16 v[184:187], a[156:159], a[56:59], v[184:187]
  ds_read_b64_tr_b16 a[138:139], v2 offset:46656
  v_fma_f32 v5, v18, v24, v28
  v_fma_f32 v6, v18, v25, v29
  v_fma_f32 v56, v56, v16, v3
  v_fma_f32 v57, v57, v16, v4
  v_mfma_f32_16x16x32_bf16 v[184:187], a[152:155], a[40:43], v[184:187]
  v_fma_f32 v58, v58, v16, v5
  v_fma_f32 v59, v59, v16, v6
  v_fma_f32 v7, v21, v22, v26
  v_fma_f32 v8, v21, v23, v27
  v_fma_f32 v9, v21, v24, v28
  v_mfma_f32_16x16x32_bf16 v[180:183], a[152:155], a[36:39], v[180:183]
  buffer_load_dwordx4 v135, s[24:27], s4 offen offset:2048 lds
  ds_read_b64_tr_b16 a[140:141], v2 offset:50240
  v_fma_f32 v30, v21, v25, v29
  ds_read_b128 v[22:25], v31 offset:1088
  ds_read_b128 v[26:29], v31 offset:1600
  v_mfma_f32_16x16x32_bf16 v[180:183], a[156:159], a[52:55], v[180:183]
  v_fma_f32 v60, v60, v19, v7
  v_fma_f32 v61, v61, v19, v8
  v_fma_f32 v62, v62, v19, v9
  v_fma_f32 v63, v63, v19, v30
  s_waitcnt lgkmcnt(0)
  v_mfma_f32_16x16x32_bf16 v[176:179], a[156:159], a[48:51], v[176:179]
  ds_read_b64_tr_b16 a[142:143], v2 offset:53824
  v_fma_f32 v7, v21, v22, v26
  v_fma_f32 v8, v21, v23, v27
  v_fma_f32 v9, v21, v24, v28
  v_fma_f32 v30, v21, v25, v29
  v_mfma_f32_16x16x32_bf16 v[176:179], a[152:155], a[32:35], v[176:179]
  v_fma_f32 v172, v172, v20, v7
  v_fma_f32 v173, v173, v20, v8
  v_fma_f32 v174, v174, v20, v9
  v_fma_f32 v175, v175, v20, v30
  s_waitcnt lgkmcnt(10)
  v_mfma_f32_16x16x32_bf16 v[64:67], a[160:163], a[64:67], v[64:67]
  ds_read_b64_tr_b16 a[144:145], v1 offset:28768
CT19:
  s_add_u32 s94, s92, CT19-k3_main_kernel+3072
  s_addc_u32 s95, s93, 0
  global_load_dword a252, v0, s[94:95]
  v_fma_f32 v3, v18, v22, v26
  v_mfma_f32_16x16x32_bf16 v[64:67], a[164:167], a[80:83], v[64:67]
  v_fma_f32 v4, v18, v23, v27
  v_fma_f32 v5, v18, v24, v28
  v_fma_f32 v6, v18, v25, v29
  v_fma_f32 v168, v168, v17, v3
  v_fma_f32 v169, v169, v17, v4
  v_mfma_f32_16x16x32_bf16 v[68:71], a[164:167], a[84:87], v[68:71]
  buffer_load_dwordx4 v136, s[24:27], s4 offen offset:3072 lds
  s_cmp_eq_u32 s41, 2
  s_cselect_b32 s8, 45, 17
  s_lshl_b32 s4, s8, 16
  s_add_u32 m0, s74, 0
  v_mfma_f32_16x16x32_bf16 v[68:71], a[160:163], a[68:71], v[68:71]
  ds_read_b64_tr_b16 a[146:147], v1 offset:32352
  v_fma_f32 v170, v170, v17, v5
  v_fma_f32 v171, v171, v17, v6
  v_fma_f32 v7, v15, v22, v26
  v_fma_f32 v8, v15, v23, v27
  v_mfma_f32_16x16x32_bf16 v[72:75], a[160:163], a[72:75], v[72:75]
  ds_read_b64_tr_b16 a[148:149], v1 offset:35936
  v_fma_f32 v9, v15, v24, v28
  v_fma_f32 v30, v15, v25, v29
  v_fma_f32 v164, v164, v14, v7
  v_fma_f32 v165, v165, v14, v8
  v_mfma_f32_16x16x32_bf16 v[72:75], a[164:167], a[88:91], v[72:75]
  v_fma_f32 v166, v166, v14, v9
  v_fma_f32 v167, v167, v14, v30
  v_fma_f32 v3, v12, v22, v26
  v_fma_f32 v4, v12, v23, v27
  v_fma_f32 v5, v12, v24, v28
  v_mfma_f32_16x16x32_bf16 v[76:79], a[164:167], a[92:95], v[76:79]
  buffer_load_dwordx4 v133, s[24:27], s4 offen offset:0 lds
  ds_read_b64_tr_b16 a[150:151], v1 offset:39520
  v_fma_f32 v6, v12, v25, v29
  ds_read_b128 v[22:25], v31 offset:128
  ds_read_b128 v[26:29], v31 offset:640
  v_mfma_f32_16x16x32_bf16 v[76:79], a[160:163], a[76:79], v[76:79]
  v_fma_f32 v160, v160, v11, v3
  v_fma_f32 v161, v161, v11, v4
  v_fma_f32 v162, v162, v11, v5
  v_fma_f32 v163, v163, v11, v6
  v_exp_f32 v3, v48
  v_mfma_f32_16x16x32_bf16 v[188:191], a[168:171], a[76:79], v[188:191]
  ds_read_b64_tr_b16 a[152:153], v1 offset:43104
  v_exp_f32 v4, v49
  v_exp_f32 v5, v50
  v_mfma_f32_16x16x32_bf16 v[188:191], a[172:175], a[92:95], v[188:191]
  v_exp_f32 v6, v51
  v_exp_f32 v7, v52
  v_exp_f32 v8, v53
  v_mfma_f32_16x16x32_bf16 v[184:187], a[172:175], a[88:91], v[184:187]
  ds_read_b64_tr_b16 a[154:155], v1 offset:46688
  v_exp_f32 v9, v54
  v_exp_f32 v30, v55
  v_mfma_f32_16x16x32_bf16 v[184:187], a[168:171], a[72:75], v[184:187]
  buffer_load_dwordx4 v134, s[24:27], s4 offen offset:1024 lds
  v_mul_f32 v160, v48, v160
  v_add_f32 v3, 1.0, v3
  v_mul_f32 v161, v49, v161
  v_add_f32 v4, 1.0, v4
  v_mfma_f32_16x16x32_bf16 v[180:183], a[168:171], a[68:71], v[180:183]
  ds_read_b64_tr_b16 a[156:157], v1 offset:50272
  v_mul_f32 v162, v50, v162
  v_add_f32 v5, 1.0, v5
  v_mul_f32 v163, v51, v163
  v_add_f32 v6, 1.0, v6
  v_mfma_f32_16x16x32_bf16 v[180:183], a[172:175], a[84:87], v[180:183]
  v_mul_f32 v164, v52, v164
  v_add_f32 v7, 1.0, v7
  v_mul_f32 v165, v53, v165
  v_add_f32 v8, 1.0, v8
  v_mul_f32 v166, v54, v166
  v_mfma_f32_16x16x32_bf16 v[176:179], a[172:175], a[80:83], v[176:179]
  ds_read_b64_tr_b16 a[158:159], v1 offset:53856
  v_add_f32 v9, 1.0, v9
  v_mul_f32 v167, v55, v167
  v_add_f32 v30, 1.0, v30
  v_rcp_f32 v3, v3
  v_mfma_f32_16x16x32_bf16 v[176:179], a[168:171], a[64:67], v[176:179]
  v_rcp_f32 v4, v4
  v_rcp_f32 v5, v5
  s_waitcnt lgkmcnt(10)
  v_mfma_f32_16x16x32_bf16 v[64:67], a[128:131], a[96:99], v[64:67]
  buffer_load_dwordx4 v135, s[24:27], s4 offen offset:2048 lds
  ds_read_b64_tr_b16 a[160:161], v2 offset:96
  v_rcp_f32 v6, v6
  v_rcp_f32 v7, v7
  v_mfma_f32_16x16x32_bf16 v[64:67], a[132:135], a[112:115], v[64:67]
  v_rcp_f32 v8, v8
  v_rcp_f32 v9, v9
  v_rcp_f32 v30, v30
  v_mfma_f32_16x16x32_bf16 v[68:71], a[132:135], a[116:119], v[68:71]
  ds_read_b64_tr_b16 a[162:163], v2 offset:3680
  v_mul_f32 v160, v160, v3
  v_mul_f32 v161, v161, v4
  v_mul_f32 v162, v162, v5
  v_mul_f32 v163, v163, v6
  v_mfma_f32_16x16x32_bf16 v[68:71], a[128:131], a[100:103], v[68:71]
  v_mul_f32 v164, v164, v7
  v_mul_f32 v165, v165, v8
  v_mul_f32 v166, v166, v9
  v_mul_f32 v167, v167, v30
  v_cvt_pk_bf16_f32 v34, v160, v161
  v_mfma_f32_16x16x32_bf16 v[72:75], a[128:131], a[104:107], v[72:75]
  ds_read_b64_tr_b16 a[164:165], v2 offset:7264
  v_cvt_pk_bf16_f32 v35, v162, v163
  buffer_store_dwordx4 v[32:35], v0, s[36:39], s21 offen offset:0 sc1
  v_cvt_pk_bf16_f32 v38, v164, v165
  v_cvt_pk_bf16_f32 v39, v166, v167
  v_mfma_f32_16x16x32_bf16 v[72:75], a[132:135], a[120:123], v[72:75]
  v_mfma_f32_16x16x32_bf16 v[76:79], a[132:135], a[124:127], v[76:79]
  buffer_load_dwordx4 v136, s[24:27], s4 offen offset:3072 lds
  ds_read_b64_tr_b16 a[166:167], v2 offset:10848
  v_mfma_f32_16x16x32_bf16 v[76:79], a[128:131], a[108:111], v[76:79]
  v_mfma_f32_16x16x32_bf16 v[188:191], a[136:139], a[108:111], v[188:191]
  ds_read_b64_tr_b16 a[168:169], v2 offset:14432
  buffer_store_dwordx4 v[36:39], v0, s[36:39], s21 offen offset:1024 sc1
  v_exp_f32 v3, v56
  v_exp_f32 v4, v57
  v_mfma_f32_16x16x32_bf16 v[188:191], a[140:143], a[124:127], v[188:191]
  v_exp_f32 v5, v58
  v_exp_f32 v6, v59
  v_exp_f32 v7, v60
  v_mfma_f32_16x16x32_bf16 v[184:187], a[140:143], a[120:123], v[184:187]
  ds_read_b64_tr_b16 a[170:171], v2 offset:18016
  v_exp_f32 v8, v61
  v_exp_f32 v9, v62
  v_mfma_f32_16x16x32_bf16 v[184:187], a[136:139], a[104:107], v[184:187]
  v_exp_f32 v30, v63
  v_mul_f32 v168, v56, v168
  v_add_f32 v3, 1.0, v3
  v_mul_f32 v169, v57, v169
  v_mfma_f32_16x16x32_bf16 v[180:183], a[136:139], a[100:103], v[180:183]
  ds_read_b64_tr_b16 a[172:173], v2 offset:21600
  v_add_f32 v4, 1.0, v4
  v_mul_f32 v170, v58, v170
  v_add_f32 v5, 1.0, v5
  v_mul_f32 v171, v59, v171
  v_mfma_f32_16x16x32_bf16 v[180:183], a[140:143], a[116:119], v[180:183]
  v_add_f32 v6, 1.0, v6
  v_mul_f32 v172, v60, v172
  v_add_f32 v7, 1.0, v7
  v_mul_f32 v173, v61, v173
  v_add_f32 v8, 1.0, v8
  v_mfma_f32_16x16x32_bf16 v[176:179], a[140:143], a[112:115], v[176:179]
  ds_read_b64_tr_b16 a[174:175], v2 offset:25184
  v_mul_f32 v174, v62, v174
  v_add_f32 v9, 1.0, v9
  v_mul_f32 v175, v63, v175
  v_add_f32 v30, 1.0, v30
  v_mfma_f32_16x16x32_bf16 v[176:179], a[136:139], a[96:99], v[176:179]
  v_rcp_f32 v3, v3
  v_rcp_f32 v4, v4
  s_waitcnt lgkmcnt(8)
  v_mfma_f32_16x16x32_bf16 v[80:83], a[144:147], a[32:35], v[80:83]
  ds_read_b64_tr_b16 a[128:129], v2 offset:28768
  v_rcp_f32 v5, v5
  v_rcp_f32 v6, v6
  v_mfma_f32_16x16x32_bf16 v[80:83], a[148:151], a[48:51], v[80:83]
  v_rcp_f32 v7, v7
  v_rcp_f32 v8, v8
  v_rcp_f32 v9, v9
  v_mfma_f32_16x16x32_bf16 v[84:87], a[148:151], a[52:55], v[84:87]
  ds_read_b64_tr_b16 a[130:131], v2 offset:32352
  v_rcp_f32 v30, v30
  v_mul_f32 v168, v168, v3
  v_mul_f32 v169, v169, v4
  v_mfma_f32_16x16x32_bf16 v[84:87], a[144:147], a[36:39], v[84:87]
  v_mul_f32 v170, v170, v5
  v_mul_f32 v171, v171, v6
  v_mul_f32 v172, v172, v7
  v_mul_f32 v173, v173, v8
  v_mul_f32 v174, v174, v9
  v_mfma_f32_16x16x32_bf16 v[88:91], a[144:147], a[40:43], v[88:91]
  ds_read_b64_tr_b16 a[132:133], v2 offset:35936
  v_mul_f32 v175, v175, v30
  v_cvt_pk_bf16_f32 v42, v168, v169
  v_cvt_pk_bf16_f32 v43, v170, v171
  buffer_store_dwordx4 v[40:43], v0, s[36:39], s22 offen offset:0 sc1
  v_mfma_f32_16x16x32_bf16 v[88:91], a[148:151], a[56:59], v[88:91]
  v_cvt_pk_bf16_f32 v46, v172, v173
  v_cvt_pk_bf16_f32 v47, v174, v175
  v_mfma_f32_16x16x32_bf16 v[92:95], a[148:151], a[60:63], v[92:95]
  ds_read_b64_tr_b16 a[134:135], v2 offset:39520
  buffer_store_dwordx4 v[44:47], v0, s[36:39], s22 offen offset:1024 sc1
  s_add_u32 s21, s21, 2048
  s_add_u32 s22, s22, 2048
  s_waitcnt lgkmcnt(15)
  v_mfma_f32_16x16x32_bf16 v[92:95], a[144:147], a[44:47], v[92:95]
  v_fma_f32 v3, v12, v22, v26
  v_fma_f32 v4, v12, v23, v27
  v_fma_f32 v5, v12, v24, v28
  v_fma_f32 v6, v12, v25, v29
  v_fma_f32 v64, v64, v10, v3
  v_mfma_f32_16x16x32_bf16 v[204:207], a[152:155], a[44:47], v[204:207]
  ds_read_b64_tr_b16 a[136:137], v2 offset:43104
  v_fma_f32 v65, v65, v10, v4
  v_fma_f32 v66, v66, v10, v5
  v_fma_f32 v67, v67, v10, v6
  v_fma_f32 v7, v15, v22, v26
  v_mfma_f32_16x16x32_bf16 v[204:207], a[156:159], a[60:63], v[204:207]
  v_fma_f32 v8, v15, v23, v27
  v_fma_f32 v9, v15, v24, v28
  v_fma_f32 v30, v15, v25, v29
  v_fma_f32 v68, v68, v13, v7
  v_fma_f32 v69, v69, v13, v8
  v_mfma_f32_16x16x32_bf16 v[200:203], a[156:159], a[56:59], v[200:203]
  ds_read_b64_tr_b16 a[138:139], v2 offset:46688
  v_fma_f32 v70, v70, v13, v9
  v_fma_f32 v71, v71, v13, v30
  v_fma_f32 v3, v18, v22, v26
  v_fma_f32 v4, v18, v23, v27
  v_mfma_f32_16x16x32_bf16 v[200:203], a[152:155], a[40:43], v[200:203]
  v_fma_f32 v5, v18, v24, v28
  v_fma_f32 v6, v18, v25, v29
  v_fma_f32 v72, v72, v16, v3
  v_fma_f32 v73, v73, v16, v4
  v_fma_f32 v74, v74, v16, v5
  v_mfma_f32_16x16x32_bf16 v[196:199], a[152:155], a[36:39], v[196:199]
  ds_read_b64_tr_b16 a[140:141], v2 offset:50272
  v_fma_f32 v75, v75, v16, v6
  v_fma_f32 v7, v21, v22, v26
  v_fma_f32 v8, v21, v23, v27
  v_fma_f32 v9, v21, v24, v28
  v_mfma_f32_16x16x32_bf16 v[196:199], a[156:159], a[52:55], v[196:199]
  v_fma_f32 v30, v21, v25, v29
  ds_read_b128 v[22:25], v31 offset:1152
  ds_read_b128 v[26:29], v31 offset:1664
  v_fma_f32 v76, v76, v19, v7
  v_fma_f32 v77, v77, v19, v8
  v_mfma_f32_16x16x32_bf16 v[192:195], a[156:159], a[48:51], v[192:195]
  ds_read_b64_tr_b16 a[142:143], v2 offset:53856
  v_fma_f32 v78, v78, v19, v9
  v_fma_f32 v79, v79, v19, v30
  s_waitcnt lgkmcnt(1)
  v_fma_f32 v7, v21, v22, v26
  v_mfma_f32_16x16x32_bf16 v[192:195], a[152:155], a[32:35], v[192:195]
  v_fma_f32 v8, v21, v23, v27
  v_fma_f32 v9, v21, v24, v28
  v_fma_f32 v30, v21, v25, v29
  v_fma_f32 v188, v188, v20, v7
  s_waitcnt lgkmcnt(10)
  v_mfma_f32_16x16x32_bf16 v[80:83], a[160:163], a[64:67], v[80:83]
  ds_read_b64_tr_b16 a[144:145], v1 offset:28800
  v_fma_f32 v189, v189, v20, v8
  v_fma_f32 v190, v190, v20, v9
  v_fma_f32 v191, v191, v20, v30
  v_fma_f32 v3, v18, v22, v26
  v_mfma_f32_16x16x32_bf16 v[80:83], a[164:167], a[80:83], v[80:83]
  v_fma_f32 v4, v18, v23, v27
  v_fma_f32 v5, v18, v24, v28
  v_fma_f32 v6, v18, v25, v29
  v_fma_f32 v184, v184, v17, v3
  v_fma_f32 v185, v185, v17, v4
  v_mfma_f32_16x16x32_bf16 v[84:87], a[164:167], a[84:87], v[84:87]
  ds_read_b64_tr_b16 a[146:147], v1 offset:32384
  v_fma_f32 v186, v186, v17, v5
  v_fma_f32 v187, v187, v17, v6
  v_fma_f32 v7, v15, v22, v26
  v_fma_f32 v8, v15, v23, v27
  v_mfma_f32_16x16x32_bf16 v[84:87], a[160:163], a[68:71], v[84:87]
  v_fma_f32 v9, v15, v24, v28
  v_fma_f32 v30, v15, v25, v29
  v_fma_f32 v180, v180, v14, v7
  v_fma_f32 v181, v181, v14, v8
  v_fma_f32 v182, v182, v14, v9
  v_mfma_f32_16x16x32_bf16 v[88:91], a[160:163], a[72:75], v[88:91]
  ds_read_b64_tr_b16 a[148:149], v1 offset:35968
  v_fma_f32 v183, v183, v14, v30
  v_fma_f32 v3, v12, v22, v26
  v_fma_f32 v4, v12, v23, v27
  v_fma_f32 v5, v12, v24, v28
  v_mfma_f32_16x16x32_bf16 v[88:91], a[164:167], a[88:91], v[88:91]
  v_fma_f32 v6, v12, v25, v29
  ds_read_b128 v[22:25], v31 offset:192
  ds_read_b128 v[26:29], v31 offset:704
  v_fma_f32 v176, v176, v11, v3
  v_fma_f32 v177, v177, v11, v4
  v_mfma_f32_16x16x32_bf16 v[92:95], a[164:167], a[92:95], v[92:95]
  ds_read_b64_tr_b16 a[150:151], v1 offset:39552
  v_fma_f32 v178, v178, v11, v5
  v_fma_f32 v179, v179, v11, v6
  v_exp_f32 v3, v64
  v_mfma_f32_16x16x32_bf16 v[92:95], a[160:163], a[76:79], v[92:95]
  v_exp_f32 v4, v65
  v_exp_f32 v5, v66
  v_exp_f32 v6, v67
  v_mfma_f32_16x16x32_bf16 v[204:207], a[168:171], a[76:79], v[204:207]
  ds_read_b64_tr_b16 a[152:153], v1 offset:43136
  v_exp_f32 v7, v68
  v_exp_f32 v8, v69
  v_mfma_f32_16x16x32_bf16 v[204:207], a[172:175], a[92:95], v[204:207]
  v_exp_f32 v9, v70
  v_exp_f32 v30, v71
  v_mul_f32 v176, v64, v176
  v_mfma_f32_16x16x32_bf16 v[200:203], a[172:175], a[88:91], v[200:203]
  ds_read_b64_tr_b16 a[154:155], v1 offset:46720
  v_add_f32 v3, 1.0, v3
  v_mul_f32 v177, v65, v177
  v_add_f32 v4, 1.0, v4
  v_mul_f32 v178, v66, v178
  v_mfma_f32_16x16x32_bf16 v[200:203], a[168:171], a[72:75], v[200:203]
  v_add_f32 v5, 1.0, v5
  v_mul_f32 v179, v67, v179
  v_add_f32 v6, 1.0, v6
  v_mul_f32 v180, v68, v180
  v_add_f32 v7, 1.0, v7
  v_mfma_f32_16x16x32_bf16 v[196:199], a[168:171], a[68:71], v[196:199]
  ds_read_b64_tr_b16 a[156:157], v1 offset:50304
  v_mul_f32 v181, v69, v181
  v_add_f32 v8, 1.0, v8
  v_mul_f32 v182, v70, v182
  v_add_f32 v9, 1.0, v9
  v_mfma_f32_16x16x32_bf16 v[196:199], a[172:175], a[84:87], v[196:199]
  v_mul_f32 v183, v71, v183
  v_add_f32 v30, 1.0, v30
  v_rcp_f32 v3, v3
  v_rcp_f32 v4, v4
  v_mfma_f32_16x16x32_bf16 v[192:195], a[172:175], a[80:83], v[192:195]
  ds_read_b64_tr_b16 a[158:159], v1 offset:53888
  v_rcp_f32 v5, v5
  v_rcp_f32 v6, v6
  v_mfma_f32_16x16x32_bf16 v[192:195], a[168:171], a[64:67], v[192:195]
  v_rcp_f32 v7, v7
  s_waitcnt vmcnt(0) lgkmcnt(10)
  s_barrier
  v_mfma_f32_16x16x32_bf16 v[80:83], a[128:131], a[96:99], v[80:83]
  s_mov_b64 exec, 1
  buffer_store_dword v254, v0, s[36:39], s45 offen sc1
  s_mov_b64 exec, -1
  s_lshl_b32 s45, s2, 7
  s_add_u32 s45, s45, 5439488
  v_mfma_f32_16x16x32_bf16 v[80:83], a[132:135], a[112:115], v[80:83]
  s_cmp_eq_u32 s44, 0
  s_cselect_b32 s45, s45, 1073741824
  ds_read_b64_tr_b16 a[160:161], v2 offset:128
  v_rcp_f32 v8, v8
  v_mfma_f32_16x16x32_bf16 v[84:87], a[132:135], a[116:119], v[84:87]
  ds_read_b64_tr_b16 a[162:163], v2 offset:3712
  v_rcp_f32 v9, v9
  v_rcp_f32 v30, v30
  v_mfma_f32_16x16x32_bf16 v[84:87], a[128:131], a[100:103], v[84:87]
  v_mul_f32 v176, v176, v3
  v_mul_f32 v177, v177, v4
  v_mul_f32 v178, v178, v5
  v_mul_f32 v179, v179, v6
  v_mul_f32 v180, v180, v7
  v_mfma_f32_16x16x32_bf16 v[88:91], a[128:131], a[104:107], v[88:91]
  ds_read_b64_tr_b16 a[164:165], v2 offset:7296
  v_mul_f32 v181, v181, v8
  v_mul_f32 v182, v182, v9
  v_mul_f32 v183, v183, v30
  v_cvt_pk_bf16_f32 v64, v176, v177
  v_mfma_f32_16x16x32_bf16 v[88:91], a[132:135], a[120:123], v[88:91]
  v_cvt_pk_bf16_f32 v65, v178, v179
  v_cvt_pk_bf16_f32 v68, v180, v181
  v_cvt_pk_bf16_f32 v69, v182, v183
  v_exp_f32 v3, v72
  v_mfma_f32_16x16x32_bf16 v[92:95], a[132:135], a[124:127], v[92:95]
  ds_read_b64_tr_b16 a[166:167], v2 offset:10880
  v_exp_f32 v4, v73
  v_exp_f32 v5, v74
  v_mfma_f32_16x16x32_bf16 v[92:95], a[128:131], a[108:111], v[92:95]
  v_exp_f32 v6, v75
  v_exp_f32 v7, v76
  v_exp_f32 v8, v77
  v_mfma_f32_16x16x32_bf16 v[204:207], a[136:139], a[108:111], v[204:207]
  ds_read_b64_tr_b16 a[168:169], v2 offset:14464
  v_exp_f32 v9, v78
  v_exp_f32 v30, v79
  v_mfma_f32_16x16x32_bf16 v[204:207], a[140:143], a[124:127], v[204:207]
  v_mul_f32 v184, v72, v184
  v_add_f32 v3, 1.0, v3
  v_mul_f32 v185, v73, v185
  v_add_f32 v4, 1.0, v4
  v_mul_f32 v186, v74, v186
  v_mfma_f32_16x16x32_bf16 v[200:203], a[140:143], a[120:123], v[200:203]
  ds_read_b64_tr_b16 a[170:171], v2 offset:18048
  v_add_f32 v5, 1.0, v5
  v_mul_f32 v187, v75, v187
  v_add_f32 v6, 1.0, v6
  v_mul_f32 v188, v76, v188
  v_mfma_f32_16x16x32_bf16 v[200:203], a[136:139], a[104:107], v[200:203]
  v_add_f32 v7, 1.0, v7
  v_mul_f32 v189, v77, v189
  v_add_f32 v8, 1.0, v8
  v_mul_f32 v190, v78, v190
  v_add_f32 v9, 1.0, v9
  v_mfma_f32_16x16x32_bf16 v[196:199], a[136:139], a[100:103], v[196:199]
  ds_read_b64_tr_b16 a[172:173], v2 offset:21632
  v_mul_f32 v191, v79, v191
  v_add_f32 v30, 1.0, v30
  v_rcp_f32 v3, v3
  v_mfma_f32_16x16x32_bf16 v[196:199], a[140:143], a[116:119], v[196:199]
  v_rcp_f32 v4, v4
  v_rcp_f32 v5, v5
  v_rcp_f32 v6, v6
  v_mfma_f32_16x16x32_bf16 v[192:195], a[140:143], a[112:115], v[192:195]
  ds_read_b64_tr_b16 a[174:175], v2 offset:25216
  v_rcp_f32 v7, v7
  v_rcp_f32 v8, v8
  v_mfma_f32_16x16x32_bf16 v[192:195], a[136:139], a[96:99], v[192:195]
  v_rcp_f32 v9, v9
  v_rcp_f32 v30, v30
  s_waitcnt lgkmcnt(8)
  v_mfma_f32_16x16x32_bf16 v[96:99], a[144:147], a[32:35], v[96:99]
  ds_read_b64_tr_b16 a[128:129], v2 offset:28800
CT20:
  s_add_u32 s94, s92, CT20-k3_main_kernel+3072
  s_addc_u32 s95, s93, 0
  global_load_dword a252, v0, s[94:95]
  v_mul_f32 v184, v184, v3
  v_mfma_f32_16x16x32_bf16 v[96:99], a[148:151], a[48:51], v[96:99]
  v_mul_f32 v185, v185, v4
  v_mul_f32 v186, v186, v5
  v_mul_f32 v187, v187, v6
  v_mul_f32 v188, v188, v7
  v_mul_f32 v189, v189, v8
  v_mfma_f32_16x16x32_bf16 v[100:103], a[148:151], a[52:55], v[100:103]
  ds_read_b64_tr_b16 a[130:131], v2 offset:32384
  v_mul_f32 v190, v190, v9
  v_mul_f32 v191, v191, v30
  v_cvt_pk_bf16_f32 v72, v184, v185
  v_cvt_pk_bf16_f32 v73, v186, v187
  v_mfma_f32_16x16x32_bf16 v[100:103], a[144:147], a[36:39], v[100:103]
  v_cvt_pk_bf16_f32 v76, v188, v189
  v_cvt_pk_bf16_f32 v77, v190, v191
  s_waitcnt lgkmcnt(15)
  v_fma_f32 v3, v12, v22, v26
  v_fma_f32 v4, v12, v23, v27
  v_mfma_f32_16x16x32_bf16 v[104:107], a[144:147], a[40:43], v[104:107]
  ds_read_b64_tr_b16 a[132:133], v2 offset:35968
  v_fma_f32 v5, v12, v24, v28
  v_fma_f32 v6, v12, v25, v29
  v_fma_f32 v80, v80, v10, v3
  v_fma_f32 v81, v81, v10, v4
  v_mfma_f32_16x16x32_bf16 v[104:107], a[148:151], a[56:59], v[104:107]
  v_fma_f32 v82, v82, v10, v5
  v_fma_f32 v83, v83, v10, v6
  v_fma_f32 v7, v15, v22, v26
  v_fma_f32 v8, v15, v23, v27
  v_fma_f32 v9, v15, v24, v28
  v_mfma_f32_16x16x32_bf16 v[108:111], a[148:151], a[60:63], v[108:111]
  ds_read_b64_tr_b16 a[134:135], v2 offset:39552
  v_fma_f32 v30, v15, v25, v29
  v_fma_f32 v84, v84, v13, v7
  v_fma_f32 v85, v85, v13, v8
  v_fma_f32 v86, v86, v13, v9
  v_mfma_f32_16x16x32_bf16 v[108:111], a[144:147], a[44:47], v[108:111]
  v_fma_f32 v87, v87, v13, v30
  v_fma_f32 v3, v18, v22, v26
  v_fma_f32 v4, v18, v23, v27
  v_fma_f32 v5, v18, v24, v28
  v_fma_f32 v6, v18, v25, v29
  v_mfma_f32_16x16x32_bf16 v[220:223], a[152:155], a[44:47], v[220:223]
  ds_read_b64_tr_b16 a[136:137], v2 offset:43136
  v_fma_f32 v88, v88, v16, v3
  v_fma_f32 v89, v89, v16, v4
  v_fma_f32 v90, v90, v16, v5
  v_fma_f32 v91, v91, v16, v6
  v_mfma_f32_16x16x32_bf16 v[220:223], a[156:159], a[60:63], v[220:223]
  v_fma_f32 v7, v21, v22, v26
  v_fma_f32 v8, v21, v23, v27
  v_fma_f32 v9, v21, v24, v28
  v_fma_f32 v30, v21, v25, v29
  ds_read_b128 v[22:25], v31 offset:1216
  v_mfma_f32_16x16x32_bf16 v[216:219], a[156:159], a[56:59], v[216:219]
  ds_read_b64_tr_b16 a[138:139], v2 offset:46720
  ds_read_b128 v[26:29], v31 offset:1728
  v_fma_f32 v92, v92, v19, v7
  v_fma_f32 v93, v93, v19, v8
  v_fma_f32 v94, v94, v19, v9
  v_mfma_f32_16x16x32_bf16 v[216:219], a[152:155], a[40:43], v[216:219]
  v_fma_f32 v95, v95, v19, v30
  s_waitcnt lgkmcnt(0)
  v_fma_f32 v7, v21, v22, v26
  v_fma_f32 v8, v21, v23, v27
  v_fma_f32 v9, v21, v24, v28
  v_mfma_f32_16x16x32_bf16 v[212:215], a[152:155], a[36:39], v[212:215]
  ds_read_b64_tr_b16 a[140:141], v2 offset:50304
  v_fma_f32 v30, v21, v25, v29
  v_fma_f32 v204, v204, v20, v7
  v_fma_f32 v205, v205, v20, v8
  v_fma_f32 v206, v206, v20, v9
  v_mfma_f32_16x16x32_bf16 v[212:215], a[156:159], a[52:55], v[212:215]
  v_fma_f32 v207, v207, v20, v30
  v_fma_f32 v3, v18, v22, v26
  v_fma_f32 v4, v18, v23, v27
  v_fma_f32 v5, v18, v24, v28
  v_fma_f32 v6, v18, v25, v29
  v_mfma_f32_16x16x32_bf16 v[208:211], a[156:159], a[48:51], v[208:211]
  ds_read_b64_tr_b16 a[142:143], v2 offset:53888
  v_fma_f32 v200, v200, v17, v3
  v_fma_f32 v201, v201, v17, v4
  v_fma_f32 v202, v202, v17, v5
  v_fma_f32 v203, v203, v17, v6
  v_mfma_f32_16x16x32_bf16 v[208:211], a[152:155], a[32:35], v[208:211]
  v_fma_f32 v7, v15, v22, v26
  v_fma_f32 v8, v15, v23, v27
  v_fma_f32 v9, v15, v24, v28
  v_fma_f32 v30, v15, v25, v29
  s_waitcnt lgkmcnt(10)
  v_mfma_f32_16x16x32_bf16 v[96:99], a[160:163], a[64:67], v[96:99]
  ds_read_b64_tr_b16 a[144:145], v1 offset:28832
  v_fma_f32 v196, v196, v14, v7
  v_fma_f32 v197, v197, v14, v8
  v_fma_f32 v198, v198, v14, v9
  v_fma_f32 v199, v199, v14, v30
  v_mfma_f32_16x16x32_bf16 v[96:99], a[164:167], a[80:83], v[96:99]
  v_fma_f32 v3, v12, v22, v26
  v_fma_f32 v4, v12, v23, v27
  v_fma_f32 v5, v12, v24, v28
  v_fma_f32 v6, v12, v25, v29
  ds_read_b128 v[22:25], v31 offset:256
  v_mfma_f32_16x16x32_bf16 v[100:103], a[164:167], a[84:87], v[100:103]
  ds_read_b64_tr_b16 a[146:147], v1 offset:32416
  ds_read_b128 v[26:29], v31 offset:768
  v_fma_f32 v192, v192, v11, v3
  v_fma_f32 v193, v193, v11, v4
  v_fma_f32 v194, v194, v11, v5
  v_mfma_f32_16x16x32_bf16 v[100:103], a[160:163], a[68:71], v[100:103]
  v_fma_f32 v195, v195, v11, v6
  v_exp_f32 v3, v80
  v_exp_f32 v4, v81
  v_mfma_f32_16x16x32_bf16 v[104:107], a[160:163], a[72:75], v[104:107]
  ds_read_b64_tr_b16 a[148:149], v1 offset:36000
  v_exp_f32 v5, v82
  v_exp_f32 v6, v83
  v_mfma_f32_16x16x32_bf16 v[104:107], a[164:167], a[88:91], v[104:107]
  v_exp_f32 v7, v84
  v_exp_f32 v8, v85
  v_exp_f32 v9, v86
  v_mfma_f32_16x16x32_bf16 v[108:111], a[164:167], a[92:95], v[108:111]
  ds_read_b64_tr_b16 a[150:151], v1 offset:39584
  v_exp_f32 v30, v87
  v_mul_f32 v192, v80, v192
  v_add_f32 v3, 1.0, v3
  v_mfma_f32_16x16x32_bf16 v[108:111], a[160:163], a[76:79], v[108:111]
  v_mul_f32 v193, v81, v193
  v_add_f32 v4, 1.0, v4
  v_mul_f32 v194, v82, v194
  v_add_f32 v5, 1.0, v5
  v_mul_f32 v195, v83, v195
  v_mfma_f32_16x16x32_bf16 v[220:223], a[168:171], a[76:79], v[220:223]
  ds_read_b64_tr_b16 a[152:153], v1 offset:43168
  v_add_f32 v6, 1.0, v6
  v_mul_f32 v196, v84, v196
  v_add_f32 v7, 1.0, v7
  v_mul_f32 v197, v85, v197
  v_mfma_f32_16x16x32_bf16 v[220:223], a[172:175], a[92:95], v[220:223]
  v_add_f32 v8, 1.0, v8
  v_mul_f32 v198, v86, v198
  v_add_f32 v9, 1.0, v9
  v_mul_f32 v199, v87, v199
  v_add_f32 v30, 1.0, v30
  v_mfma_f32_16x16x32_bf16 v[216:219], a[172:175], a[88:91], v[216:219]
  ds_read_b64_tr_b16 a[154:155], v1 offset:46752
  v_rcp_f32 v3, v3
  v_rcp_f32 v4, v4
  v_mfma_f32_16x16x32_bf16 v[216:219], a[168:171], a[72:75], v[216:219]
  v_rcp_f32 v5, v5
  v_rcp_f32 v6, v6
  v_rcp_f32 v7, v7
  v_mfma_f32_16x16x32_bf16 v[212:215], a[168:171], a[68:71], v[212:215]
  ds_read_b64_tr_b16 a[156:157], v1 offset:50336
  v_rcp_f32 v8, v8
  v_rcp_f32 v9, v9
  v_mfma_f32_16x16x32_bf16 v[212:215], a[172:175], a[84:87], v[212:215]
  v_rcp_f32 v30, v30
  v_mul_f32 v192, v192, v3
  v_mul_f32 v193, v193, v4
  v_mul_f32 v194, v194, v5
  v_mfma_f32_16x16x32_bf16 v[208:211], a[172:175], a[80:83], v[208:211]
  ds_read_b64_tr_b16 a[158:159], v1 offset:53920
  v_mul_f32 v195, v195, v6
  v_mul_f32 v196, v196, v7
  v_mul_f32 v197, v197, v8
  v_mul_f32 v198, v198, v9
  v_mfma_f32_16x16x32_bf16 v[208:211], a[168:171], a[64:67], v[208:211]
  v_mul_f32 v199, v199, v30
  v_cvt_pk_bf16_f32 v66, v192, v193
  v_cvt_pk_bf16_f32 v67, v194, v195
  buffer_store_dwordx4 v[64:67], v0, s[36:39], s21 offen offset:0 sc1
  s_waitcnt lgkmcnt(10)
  v_mfma_f32_16x16x32_bf16 v[96:99], a[128:131], a[96:99], v[96:99]
  ds_read_b64_tr_b16 a[160:161], v2 offset:160
  v_cvt_pk_bf16_f32 v70, v196, v197
  v_cvt_pk_bf16_f32 v71, v198, v199
  v_mfma_f32_16x16x32_bf16 v[96:99], a[132:135], a[112:115], v[96:99]
  buffer_store_dwordx4 v[68:71], v0, s[36:39], s21 offen offset:1024 sc1
  v_exp_f32 v3, v88
  v_exp_f32 v4, v89
  v_mfma_f32_16x16x32_bf16 v[100:103], a[132:135], a[116:119], v[100:103]
  ds_read_b64_tr_b16 a[162:163], v2 offset:3744
  v_exp_f32 v5, v90
  v_exp_f32 v6, v91
  v_mfma_f32_16x16x32_bf16 v[100:103], a[128:131], a[100:103], v[100:103]
  buffer_load_dword v139, v138, s[36:39], s57 offen sc1
  v_exp_f32 v7, v92
  v_exp_f32 v8, v93
  v_mfma_f32_16x16x32_bf16 v[104:107], a[128:131], a[104:107], v[104:107]
  ds_read_b64_tr_b16 a[164:165], v2 offset:7328
  v_exp_f32 v9, v94
  v_exp_f32 v30, v95
  v_mfma_f32_16x16x32_bf16 v[104:107], a[132:135], a[120:123], v[104:107]
  v_mul_f32 v200, v88, v200
  v_add_f32 v3, 1.0, v3
  v_mul_f32 v201, v89, v201
  v_add_f32 v4, 1.0, v4
  v_mul_f32 v202, v90, v202
  v_mfma_f32_16x16x32_bf16 v[108:111], a[132:135], a[124:127], v[108:111]
  ds_read_b64_tr_b16 a[166:167], v2 offset:10912
  v_add_f32 v5, 1.0, v5
  v_mul_f32 v203, v91, v203
  v_add_f32 v6, 1.0, v6
  v_mul_f32 v204, v92, v204
  v_mfma_f32_16x16x32_bf16 v[108:111], a[128:131], a[108:111], v[108:111]
  v_add_f32 v7, 1.0, v7
  v_mul_f32 v205, v93, v205
  v_add_f32 v8, 1.0, v8
  v_mul_f32 v206, v94, v206
  v_add_f32 v9, 1.0, v9
  v_mfma_f32_16x16x32_bf16 v[220:223], a[136:139], a[108:111], v[220:223]
  ds_read_b64_tr_b16 a[168:169], v2 offset:14496
  v_mul_f32 v207, v95, v207
  v_add_f32 v30, 1.0, v30
  v_rcp_f32 v3, v3
  v_mfma_f32_16x16x32_bf16 v[220:223], a[140:143], a[124:127], v[220:223]
  v_rcp_f32 v4, v4
  v_rcp_f32 v5, v5
  v_rcp_f32 v6, v6
  v_mfma_f32_16x16x32_bf16 v[216:219], a[140:143], a[120:123], v[216:219]
  ds_read_b64_tr_b16 a[170:171], v2 offset:18080
  v_rcp_f32 v7, v7
  v_rcp_f32 v8, v8
  v_mfma_f32_16x16x32_bf16 v[216:219], a[136:139], a[104:107], v[216:219]
  v_rcp_f32 v9, v9
  v_rcp_f32 v30, v30
  v_mul_f32 v200, v200, v3
  v_mfma_f32_16x16x32_bf16 v[212:215], a[136:139], a[100:103], v[212:215]
  ds_read_b64_tr_b16 a[172:173], v2 offset:21664
  v_mul_f32 v201, v201, v4
  v_mul_f32 v202, v202, v5
  v_mul_f32 v203, v203, v6
  v_mul_f32 v204, v204, v7
  v_mfma_f32_16x16x32_bf16 v[212:215], a[140:143], a[116:119], v[212:215]
  v_mul_f32 v205, v205, v8
  v_mul_f32 v206, v206, v9
  v_mul_f32 v207, v207, v30
  v_cvt_pk_bf16_f32 v74, v200, v201
  v_cvt_pk_bf16_f32 v75, v202, v203
  v_mfma_f32_16x16x32_bf16 v[208:211], a[140:143], a[112:115], v[208:211]
  ds_read_b64_tr_b16 a[174:175], v2 offset:25248
  buffer_store_dwordx4 v[72:75], v0, s[36:39], s22 offen offset:0 sc1
  v_cvt_pk_bf16_f32 v78, v204, v205
  v_cvt_pk_bf16_f32 v79, v206, v207
  v_mfma_f32_16x16x32_bf16 v[208:211], a[136:139], a[96:99], v[208:211]
  s_waitcnt lgkmcnt(8)
  v_mfma_f32_16x16x32_bf16 v[112:115], a[144:147], a[32:35], v[112:115]
  ds_read_b64_tr_b16 a[128:129], v2 offset:28832
  buffer_store_dwordx4 v[76:79], v0, s[36:39], s22 offen offset:1024 sc1
  s_add_u32 s21, s21, 2048
  s_add_u32 s22, s22, 2048
  s_waitcnt lgkmcnt(15)
  v_mfma_f32_16x16x32_bf16 v[112:115], a[148:151], a[48:51], v[112:115]
  v_fma_f32 v3, v12, v22, v26
  v_fma_f32 v4, v12, v23, v27
  v_fma_f32 v5, v12, v24, v28
  v_fma_f32 v6, v12, v25, v29
  v_fma_f32 v96, v96, v10, v3
  v_mfma_f32_16x16x32_bf16 v[116:119], a[148:151], a[52:55], v[116:119]
  ds_read_b64_tr_b16 a[130:131], v2 offset:32416
  v_fma_f32 v97, v97, v10, v4
  v_fma_f32 v98, v98, v10, v5
  v_fma_f32 v99, v99, v10, v6
  v_fma_f32 v7, v15, v22, v26
  v_mfma_f32_16x16x32_bf16 v[116:119], a[144:147], a[36:39], v[116:119]
  v_fma_f32 v8, v15, v23, v27
  v_fma_f32 v9, v15, v24, v28
  v_fma_f32 v30, v15, v25, v29
  v_fma_f32 v100, v100, v13, v7
  v_fma_f32 v101, v101, v13, v8
  v_mfma_f32_16x16x32_bf16 v[120:123], a[144:147], a[40:43], v[120:123]
  ds_read_b64_tr_b16 a[132:133], v2 offset:36000
  v_fma_f32 v102, v102, v13, v9
  v_fma_f32 v103, v103, v13, v30
  v_fma_f32 v3, v18, v22, v26
  v_fma_f32 v4, v18, v23, v27
  v_mfma_f32_16x16x32_bf16 v[120:123], a[148:151], a[56:59], v[120:123]
  v_fma_f32 v5, v18, v24, v28
  v_fma_f32 v6, v18, v25, v29
  v_fma_f32 v104, v104, v16, v3
  v_fma_f32 v105, v105, v16, v4
  v_fma_f32 v106, v106, v16, v5
  v_mfma_f32_16x16x32_bf16 v[124:127], a[148:151], a[60:63], v[124:127]
  ds_read_b64_tr_b16 a[134:135], v2 offset:39584
  v_fma_f32 v107, v107, v16, v6
  v_fma_f32 v7, v21, v22, v26
  v_fma_f32 v8, v21, v23, v27
  v_fma_f32 v9, v21, v24, v28
  v_mfma_f32_16x16x32_bf16 v[124:127], a[144:147], a[44:47], v[124:127]
  v_fma_f32 v30, v21, v25, v29
  ds_read_b128 v[22:25], v31 offset:1280
  ds_read_b128 v[26:29], v31 offset:1792
  v_fma_f32 v108, v108, v19, v7
  v_fma_f32 v109, v109, v19, v8
  v_mfma_f32_16x16x32_bf16 v[236:239], a[152:155], a[44:47], v[236:239]
  ds_read_b64_tr_b16 a[136:137], v2 offset:43168
  v_fma_f32 v110, v110, v19, v9
  v_fma_f32 v111, v111, v19, v30
  s_waitcnt lgkmcnt(1)
  v_fma_f32 v7, v21, v22, v26
  v_mfma_f32_16x16x32_bf16 v[236:239], a[156:159], a[60:63], v[236:239]
  v_fma_f32 v8, v21, v23, v27
  v_fma_f32 v9, v21, v24, v28
  v_fma_f32 v30, v21, v25, v29
  v_fma_f32 v220, v220, v20, v7
  v_fma_f32 v221, v221, v20, v8
  v_mfma_f32_16x16x32_bf16 v[232:235], a[156:159], a[56:59], v[232:235]
  ds_read_b64_tr_b16 a[138:139], v2 offset:46752
  v_fma_f32 v222, v222, v20, v9
  v_fma_f32 v223, v223, v20, v30
  v_fma_f32 v3, v18, v22, v26
  v_fma_f32 v4, v18, v23, v27
  v_mfma_f32_16x16x32_bf16 v[232:235], a[152:155], a[40:43], v[232:235]
  v_fma_f32 v5, v18, v24, v28
  v_fma_f32 v6, v18, v25, v29
  v_fma_f32 v216, v216, v17, v3
  v_fma_f32 v217, v217, v17, v4
  v_fma_f32 v218, v218, v17, v5
  v_mfma_f32_16x16x32_bf16 v[228:231], a[152:155], a[36:39], v[228:231]
  ds_read_b64_tr_b16 a[140:141], v2 offset:50336
  v_fma_f32 v219, v219, v17, v6
  v_fma_f32 v7, v15, v22, v26
  v_fma_f32 v8, v15, v23, v27
  v_fma_f32 v9, v15, v24, v28
  v_mfma_f32_16x16x32_bf16 v[228:231], a[156:159], a[52:55], v[228:231]
  v_fma_f32 v30, v15, v25, v29
  v_fma_f32 v212, v212, v14, v7
  v_fma_f32 v213, v213, v14, v8
  v_fma_f32 v214, v214, v14, v9
  v_fma_f32 v215, v215, v14, v30
  v_mfma_f32_16x16x32_bf16 v[224:227], a[156:159], a[48:51], v[224:227]
  s_waitcnt vmcnt(2)
  v_cmp_ne_u32 vcc, 1, v139
  s_nop 4
  s_cbranch_vccnz CK21s
CK21x:
  s_mov_b32 s57, 5439488
  v_mfma_f32_16x16x32_bf16 v[224:227], a[152:155], a[32:35], v[224:227]
  s_lshl_b32 s5, s6, 11
  ds_read_b64_tr_b16 a[142:143], v2 offset:53920
  buffer_load_dwordx4 a[216:219], v137, s[36:39], s5 offen offset:0 sc1
  v_fma_f32 v3, v12, v22, v26
  s_waitcnt lgkmcnt(10)
  v_mfma_f32_16x16x32_bf16 v[112:115], a[160:163], a[64:67], v[112:115]
  v_fma_f32 v4, v12, v23, v27
  v_fma_f32 v5, v12, v24, v28
  v_fma_f32 v6, v12, v25, v29
  ds_read_b128 v[22:25], v31 offset:320
  ds_read_b128 v[26:29], v31 offset:832
  v_mfma_f32_16x16x32_bf16 v[112:115], a[164:167], a[80:83], v[112:115]
  buffer_load_dwordx4 a[220:223], v137, s[36:39], s5 offen offset:1024 sc1
  v_fma_f32 v208, v208, v11, v3
  v_fma_f32 v209, v209, v11, v4
  v_fma_f32 v210, v210, v11, v5
  v_fma_f32 v211, v211, v11, v6
  v_mfma_f32_16x16x32_bf16 v[116:119], a[164:167], a[84:87], v[116:119]
  v_exp_f32 v3, v96
  v_exp_f32 v4, v97
  v_exp_f32 v5, v98
  v_mfma_f32_16x16x32_bf16 v[116:119], a[160:163], a[68:71], v[116:119]
  buffer_load_dwordx4 a[224:227], v137, s[36:39], s5 offen offset:2048 sc1
  v_exp_f32 v6, v99
  v_exp_f32 v7, v100
  v_mfma_f32_16x16x32_bf16 v[120:123], a[160:163], a[72:75], v[120:123]
  v_exp_f32 v8, v101
  v_exp_f32 v9, v102
  v_exp_f32 v30, v103
  v_mfma_f32_16x16x32_bf16 v[120:123], a[164:167], a[88:91], v[120:123]
  buffer_load_dwordx4 a[228:231], v137, s[36:39], s5 offen offset:3072 sc1
  s_lshl_b32 s5, s7, 11
  v_mul_f32 v208, v96, v208
  v_add_f32 v3, 1.0, v3
  v_mul_f32 v209, v97, v209
  v_mfma_f32_16x16x32_bf16 v[124:127], a[164:167], a[92:95], v[124:127]
  v_add_f32 v4, 1.0, v4
  v_mul_f32 v210, v98, v210
  v_add_f32 v5, 1.0, v5
  v_mul_f32 v211, v99, v211
  v_add_f32 v6, 1.0, v6
  v_mfma_f32_16x16x32_bf16 v[124:127], a[160:163], a[76:79], v[124:127]
  buffer_load_dwordx4 a[0:3], v137, s[36:39], s5 offen offset:0 sc1
  v_mul_f32 v212, v100, v212
  v_add_f32 v7, 1.0, v7
  s_waitcnt vmcnt(25)
  s_barrier
  v_mfma_f32_16x16x32_bf16 v[236:239], a[168:171], a[76:79], v[236:239]
  v_mul_f32 v213, v101, v213
  v_add_f32 v8, 1.0, v8
  v_mul_f32 v214, v102, v214
  v_add_f32 v9, 1.0, v9
  v_mul_f32 v215, v103, v215
  v_mfma_f32_16x16x32_bf16 v[236:239], a[172:175], a[92:95], v[236:239]
  buffer_load_dwordx4 a[4:7], v137, s[36:39], s5 offen offset:1024 sc1
  v_add_f32 v30, 1.0, v30
  v_rcp_f32 v3, v3
  v_rcp_f32 v4, v4
  v_mfma_f32_16x16x32_bf16 v[232:235], a[172:175], a[88:91], v[232:235]
  v_rcp_f32 v5, v5
  v_rcp_f32 v6, v6
  v_rcp_f32 v7, v7
  v_mfma_f32_16x16x32_bf16 v[232:235], a[168:171], a[72:75], v[232:235]
  buffer_load_dwordx4 a[8:11], v137, s[36:39], s5 offen offset:2048 sc1
  v_rcp_f32 v8, v8
  v_rcp_f32 v9, v9
  v_mfma_f32_16x16x32_bf16 v[228:231], a[168:171], a[68:71], v[228:231]
  v_rcp_f32 v30, v30
  v_mul_f32 v208, v208, v3
  v_mul_f32 v209, v209, v4
  v_mul_f32 v210, v210, v5
  v_mfma_f32_16x16x32_bf16 v[228:231], a[172:175], a[84:87], v[228:231]
  buffer_load_dwordx4 a[12:15], v137, s[36:39], s5 offen offset:3072 sc1
  s_lshl_b32 s5, s8, 11
  v_mul_f32 v211, v211, v6
  v_mul_f32 v212, v212, v7
  v_mul_f32 v213, v213, v8
  v_mfma_f32_16x16x32_bf16 v[224:227], a[172:175], a[80:83], v[224:227]
  v_mul_f32 v214, v214, v9
  v_mul_f32 v215, v215, v30
  v_cvt_pk_bf16_f32 v96, v208, v209
  v_cvt_pk_bf16_f32 v97, v210, v211
  v_cvt_pk_bf16_f32 v100, v212, v213
  v_mfma_f32_16x16x32_bf16 v[224:227], a[168:171], a[64:67], v[224:227]
  buffer_load_dwordx4 a[16:19], v137, s[36:39], s5 offen offset:0 sc1
  v_cvt_pk_bf16_f32 v101, v214, v215
  v_exp_f32 v3, v104
  s_waitcnt lgkmcnt(2)
  v_mfma_f32_16x16x32_bf16 v[112:115], a[128:131], a[96:99], v[112:115]
  ds_read_b64_tr_b16 a[176:177], v244 offset:49152
CT22:
  s_add_u32 s94, s92, CT22-k3_main_kernel+3072
  s_addc_u32 s95, s93, 0
  v_exp_f32 v4, v105
  s_barrier
  v_mfma_f32_16x16x32_bf16 v[112:115], a[132:135], a[112:115], v[112:115]
  global_load_dword a252, v0, s[94:95]
  ds_read_b64_tr_b16 a[178:179], v244 offset:53248
  v_exp_f32 v5, v106
  v_exp_f32 v6, v107
  v_mfma_f32_16x16x32_bf16 v[116:119], a[132:135], a[116:119], v[116:119]
  ds_read_b64_tr_b16 a[180:181], v244 offset:57344
  v_exp_f32 v7, v108
  v_exp_f32 v8, v109
  v_mfma_f32_16x16x32_bf16 v[116:119], a[128:131], a[100:103], v[116:119]
  buffer_load_dwordx4 a[20:23], v137, s[36:39], s5 offen offset:1024 sc1
  s_cmp_eq_u32 s41, 3
  s_cselect_b32 s9, 52, 24
  s_lshl_b32 s4, s9, 16
  s_add_u32 m0, s74, 16384
  v_mfma_f32_16x16x32_bf16 v[120:123], a[128:131], a[104:107], v[120:123]
  ds_read_b64_tr_b16 a[182:183], v244 offset:61440
  ds_read_b64_tr_b16 a[184:185], v245 offset:49152
  v_exp_f32 v9, v110
  v_exp_f32 v30, v111
  v_mfma_f32_16x16x32_bf16 v[120:123], a[132:135], a[120:123], v[120:123]
  buffer_load_dwordx4 v133, s[24:27], s4 offen offset:0 lds
  ds_read_b64_tr_b16 a[186:187], v245 offset:53248
  v_mul_f32 v216, v104, v216
  v_add_f32 v3, 1.0, v3
  v_mul_f32 v217, v105, v217
  v_mfma_f32_16x16x32_bf16 v[124:127], a[132:135], a[124:127], v[124:127]
  ds_read_b64_tr_b16 a[188:189], v245 offset:57344
  v_add_f32 v4, 1.0, v4
  v_mul_f32 v218, v106, v218
  v_add_f32 v5, 1.0, v5
  v_mul_f32 v219, v107, v219
  v_mfma_f32_16x16x32_bf16 v[124:127], a[128:131], a[108:111], v[124:127]
  buffer_load_dwordx4 v134, s[24:27], s4 offen offset:1024 lds
  ds_read_b64_tr_b16 a[190:191], v245 offset:61440
  v_add_f32 v6, 1.0, v6
  v_mul_f32 v220, v108, v220
  v_add_f32 v7, 1.0, v7
  v_mfma_f32_16x16x32_bf16 v[236:239], a[136:139], a[108:111], v[236:239]
  ds_read_b64_tr_b16 a[192:193], v246 offset:49152
  v_mul_f32 v221, v109, v221
  v_add_f32 v8, 1.0, v8
  v_mul_f32 v222, v110, v222
  v_add_f32 v9, 1.0, v9
  v_mfma_f32_16x16x32_bf16 v[236:239], a[140:143], a[124:127], v[236:239]
  buffer_load_dwordx4 a[24:27], v137, s[36:39], s5 offen offset:2048 sc1
  ds_read_b64_tr_b16 a[194:195], v246 offset:53248
  v_mul_f32 v223, v111, v223
  v_add_f32 v30, 1.0, v30
  v_rcp_f32 v3, v3
  v_mfma_f32_16x16x32_bf16 v[232:235], a[140:143], a[120:123], v[232:235]
  ds_read_b64_tr_b16 a[196:197], v246 offset:57344
  v_rcp_f32 v4, v4
  v_rcp_f32 v5, v5
  v_mfma_f32_16x16x32_bf16 v[232:235], a[136:139], a[104:107], v[232:235]
  buffer_load_dwordx4 a[28:31], v137, s[36:39], s5 offen offset:3072 sc1
  ds_read_b64_tr_b16 a[198:199], v246 offset:61440
  v_rcp_f32 v6, v6
  v_rcp_f32 v7, v7
  v_mfma_f32_16x16x32_bf16 v[228:231], a[136:139], a[100:103], v[228:231]
  ds_read_b64_tr_b16 a[200:201], v247 offset:49152
  v_rcp_f32 v8, v8
  v_rcp_f32 v9, v9
  v_mfma_f32_16x16x32_bf16 v[228:231], a[140:143], a[116:119], v[228:231]
  buffer_load_dwordx4 v135, s[24:27], s4 offen offset:2048 lds
  ds_read_b64_tr_b16 a[202:203], v247 offset:53248
  v_rcp_f32 v30, v30
  v_mul_f32 v216, v216, v3
  v_mfma_f32_16x16x32_bf16 v[224:227], a[140:143], a[112:115], v[224:227]
  ds_read_b64_tr_b16 a[204:205], v247 offset:57344
  v_mul_f32 v217, v217, v4
  v_mul_f32 v218, v218, v5
  v_mul_f32 v219, v219, v6
  v_mul_f32 v220, v220, v7
  v_mfma_f32_16x16x32_bf16 v[224:227], a[136:139], a[96:99], v[224:227]
  buffer_load_dwordx4 v136, s[24:27], s4 offen offset:3072 lds
  s_lshl_b32 s5, s9, 11
  ds_read_b64_tr_b16 a[206:207], v247 offset:61440
  v_mul_f32 v221, v221, v8
  s_waitcnt vmcnt(13) lgkmcnt(12)
  v_mfma_f32_16x16x32_bf16 v[32:35], a[176:179], a[216:219], 0
  ds_read_b64_tr_b16 a[208:209], v244 offset:51200
CT23:
  s_add_u32 s94, s92, CT23-k3_main_kernel+3072
  s_addc_u32 s95, s93, 0
  v_mul_f32 v222, v222, v9
  v_mfma_f32_16x16x32_bf16 v[32:35], a[180:183], a[224:227], v[32:35]
  global_load_dword a252, v0, s[94:95]
  ds_read_b64_tr_b16 a[210:211], v244 offset:55296
  v_mul_f32 v223, v223, v30
  v_cvt_pk_bf16_f32 v104, v216, v217
  v_mfma_f32_16x16x32_bf16 v[36:39], a[180:183], a[228:231], 0
  ds_read_b64_tr_b16 a[212:213], v244 offset:59392
  v_cvt_pk_bf16_f32 v105, v218, v219
  v_cvt_pk_bf16_f32 v108, v220, v221
  v_cvt_pk_bf16_f32 v109, v222, v223
  v_mfma_f32_16x16x32_bf16 v[36:39], a[176:179], a[220:223], v[36:39]
  buffer_load_dwordx4 a[32:35], v137, s[36:39], s5 offen offset:0 sc1
  ds_read_b64_tr_b16 a[214:215], v244 offset:63488
  s_waitcnt lgkmcnt(12)
  v_mfma_f32_16x16x32_bf16 v[44:47], a[184:187], a[220:223], 0
  ds_read_b64_tr_b16 a[176:177], v245 offset:51200
  v_fma_f32 v3, v12, v22, v26
  v_fma_f32 v4, v12, v23, v27
  v_fma_f32 v5, v12, v24, v28
  v_mfma_f32_16x16x32_bf16 v[44:47], a[188:191], a[228:231], v[44:47]
  buffer_load_dwordx4 a[36:39], v137, s[36:39], s5 offen offset:1024 sc1
  ds_read_b64_tr_b16 a[178:179], v245 offset:55296
  v_fma_f32 v6, v12, v25, v29
  v_fma_f32 v112, v112, v10, v3
  v_mfma_f32_16x16x32_bf16 v[40:43], a[188:191], a[224:227], 0
  ds_read_b64_tr_b16 a[180:181], v245 offset:59392
  v_fma_f32 v113, v113, v10, v4
  v_fma_f32 v114, v114, v10, v5
  v_fma_f32 v115, v115, v10, v6
  v_mfma_f32_16x16x32_bf16 v[40:43], a[184:187], a[216:219], v[40:43]
  buffer_load_dwordx4 a[40:43], v137, s[36:39], s5 offen offset:2048 sc1
  ds_read_b64_tr_b16 a[182:183], v245 offset:63488
  s_waitcnt vmcnt(36) lgkmcnt(12)
  s_barrier
  v_mfma_f32_16x16x32_bf16 v[48:51], a[192:195], a[216:219], 0
  ds_read_b64_tr_b16 a[184:185], v246 offset:51200
  v_fma_f32 v7, v15, v22, v26
  v_fma_f32 v8, v15, v23, v27
  v_fma_f32 v9, v15, v24, v28
  v_mfma_f32_16x16x32_bf16 v[48:51], a[196:199], a[224:227], v[48:51]
  buffer_load_dwordx4 a[44:47], v137, s[36:39], s5 offen offset:3072 sc1
  s_mov_b32 s12, 31
  s_lshl_b32 s5, s12, 11
  ds_read_b64_tr_b16 a[186:187], v246 offset:55296
  v_mfma_f32_16x16x32_bf16 v[52:55], a[196:199], a[228:231], 0
  ds_read_b64_tr_b16 a[188:189], v246 offset:59392
  v_fma_f32 v30, v15, v25, v29
  v_fma_f32 v116, v116, v13, v7
  v_fma_f32 v117, v117, v13, v8
  v_mfma_f32_16x16x32_bf16 v[52:55], a[192:195], a[220:223], v[52:55]
  buffer_load_dwordx4 a[48:51], v137, s[36:39], s5 offen offset:0 sc1
  ds_read_b64_tr_b16 a[190:191], v246 offset:63488
  v_fma_f32 v118, v118, v13, v9
  s_waitcnt lgkmcnt(12)
  v_mfma_f32_16x16x32_bf16 v[60:63], a[200:203], a[220:223], 0
  ds_read_b64_tr_b16 a[192:193], v247 offset:51200
  v_fma_f32 v119, v119, v13, v30
  v_fma_f32 v3, v18, v22, v26
  v_fma_f32 v4, v18, v23, v27
  v_mfma_f32_16x16x32_bf16 v[60:63], a[204:207], a[228:231], v[60:63]
  buffer_load_dwordx4 a[52:55], v137, s[36:39], s5 offen offset:1024 sc1
  ds_read_b64_tr_b16 a[194:195], v247 offset:55296
  v_fma_f32 v5, v18, v24, v28
  v_fma_f32 v6, v18, v25, v29
  v_mfma_f32_16x16x32_bf16 v[56:59], a[204:207], a[224:227], 0
  ds_read_b64_tr_b16 a[196:197], v247 offset:59392
  v_fma_f32 v120, v120, v16, v3
  v_fma_f32 v121, v121, v16, v4
  v_fma_f32 v122, v122, v16, v5
  v_mfma_f32_16x16x32_bf16 v[56:59], a[200:203], a[216:219], v[56:59]
  buffer_load_dwordx4 a[56:59], v137, s[36:39], s5 offen offset:2048 sc1
  ds_read_b64_tr_b16 a[198:199], v247 offset:63488
  v_fma_f32 v123, v123, v16, v6
  s_waitcnt lgkmcnt(12)
  v_mfma_f32_16x16x32_bf16 v[144:147], a[208:211], a[216:219], 0
  ds_read_b64_tr_b16 a[200:201], v248 offset:0
  v_fma_f32 v7, v21, v22, v26
  v_fma_f32 v8, v21, v23, v27
  v_fma_f32 v9, v21, v24, v28
  v_mfma_f32_16x16x32_bf16 v[144:147], a[212:215], a[224:227], v[144:147]
  buffer_load_dwordx4 a[60:63], v137, s[36:39], s5 offen offset:3072 sc1
  s_cmp_eq_u32 s41, 1
  s_cselect_b32 s13, 10, 38
  s_lshl_b32 s5, s13, 11
  v_mfma_f32_16x16x32_bf16 v[148:151], a[212:215], a[228:231], 0
  ds_read_b64_tr_b16 a[202:203], v248 offset:4096
  ds_read_b64_tr_b16 a[204:205], v248 offset:8192
  v_fma_f32 v30, v21, v25, v29
  ds_read_b128 v[22:25], v31 offset:1344
  v_mfma_f32_16x16x32_bf16 v[148:151], a[208:211], a[220:223], v[148:151]
  buffer_load_dwordx4 a[64:67], v137, s[36:39], s5 offen offset:0 sc1
  s_lshl_b32 s4, s12, 16
  s_add_u32 m0, s74, 32768
  s_waitcnt lgkmcnt(12)
  v_mfma_f32_16x16x32_bf16 v[156:159], a[176:179], a[220:223], 0
  ds_read_b64_tr_b16 a[206:207], v248 offset:12288
  ds_read_b64_tr_b16 a[208:209], v249 offset:0
  ds_read_b128 v[26:29], v31 offset:1856
  v_fma_f32 v124, v124, v19, v7
  v_mfma_f32_16x16x32_bf16 v[156:159], a[180:183], a[228:231], v[156:159]
  buffer_load_dwordx4 v133, s[24:27], s4 offen offset:0 lds
  ds_read_b64_tr_b16 a[210:211], v249 offset:4096
  v_fma_f32 v125, v125, v19, v8
  v_fma_f32 v126, v126, v19, v9
  v_mfma_f32_16x16x32_bf16 v[152:155], a[180:183], a[224:227], 0
  ds_read_b64_tr_b16 a[212:213], v249 offset:8192
  v_fma_f32 v127, v127, v19, v30
  s_waitcnt lgkmcnt(2)
  v_fma_f32 v7, v21, v22, v26
  v_mfma_f32_16x16x32_bf16 v[152:155], a[176:179], a[216:219], v[152:155]
  buffer_load_dwordx4 a[68:71], v137, s[36:39], s5 offen offset:1024 sc1
  ds_read_b64_tr_b16 a[214:215], v249 offset:12288
  v_fma_f32 v8, v21, v23, v27
  s_waitcnt lgkmcnt(14)
  v_mfma_f32_16x16x32_bf16 v[160:163], a[184:187], a[216:219], 0
  ds_read_b64_tr_b16 a[176:177], v250 offset:0
  v_fma_f32 v9, v21, v24, v28
  v_fma_f32 v30, v21, v25, v29
  v_fma_f32 v236, v236, v20, v7
  v_mfma_f32_16x16x32_bf16 v[160:163], a[188:191], a[224:227], v[160:163]
  buffer_load_dwordx4 v134, s[24:27], s4 offen offset:1024 lds
  ds_read_b64_tr_b16 a[178:179], v250 offset:4096
  v_fma_f32 v237, v237, v20, v8
  v_fma_f32 v238, v238, v20, v9
  v_mfma_f32_16x16x32_bf16 v[164:167], a[188:191], a[228:231], 0
  ds_read_b64_tr_b16 a[180:181], v250 offset:8192
  v_fma_f32 v239, v239, v20, v30
  v_fma_f32 v3, v18, v22, v26
  v_fma_f32 v4, v18, v23, v27
  v_mfma_f32_16x16x32_bf16 v[164:167], a[184:187], a[220:223], v[164:167]
  buffer_load_dwordx4 a[72:75], v137, s[36:39], s5 offen offset:2048 sc1
  ds_read_b64_tr_b16 a[182:183], v250 offset:12288
  v_fma_f32 v5, v18, v24, v28
  s_waitcnt lgkmcnt(14)
  v_mfma_f32_16x16x32_bf16 v[172:175], a[192:195], a[220:223], 0
  ds_read_b64_tr_b16 a[184:185], v251 offset:0
  v_fma_f32 v6, v18, v25, v29
  v_fma_f32 v232, v232, v17, v3
  v_fma_f32 v233, v233, v17, v4
  v_mfma_f32_16x16x32_bf16 v[172:175], a[196:199], a[228:231], v[172:175]
  buffer_load_dwordx4 v135, s[24:27], s4 offen offset:2048 lds
  ds_read_b64_tr_b16 a[186:187], v251 offset:4096
  v_fma_f32 v234, v234, v17, v5
  v_fma_f32 v235, v235, v17, v6
  v_mfma_f32_16x16x32_bf16 v[168:171], a[196:199], a[224:227], 0
  ds_read_b64_tr_b16 a[188:189], v251 offset:8192
  v_fma_f32 v7, v15, v22, v26
  v_fma_f32 v8, v15, v23, v27
  v_fma_f32 v9, v15, v24, v28
  v_mfma_f32_16x16x32_bf16 v[168:171], a[192:195], a[216:219], v[168:171]
  buffer_load_dwordx4 a[76:79], v137, s[36:39], s5 offen offset:3072 sc1
  ds_read_b64_tr_b16 a[190:191], v251 offset:12288
  v_fma_f32 v30, v15, v25, v29
  s_waitcnt vmcnt(25) lgkmcnt(13)
  v_mfma_f32_16x16x32_bf16 v[32:35], a[200:203], a[0:3], v[32:35]
  ds_read_b64_tr_b16 a[192:193], v248 offset:2048
  v_fma_f32 v228, v228, v14, v7
  v_fma_f32 v229, v229, v14, v8
  v_fma_f32 v230, v230, v14, v9
  v_mfma_f32_16x16x32_bf16 v[32:35], a[204:207], a[8:11], v[32:35]
  buffer_load_dwordx4 v136, s[24:27], s4 offen offset:3072 lds
  s_cmp_eq_u32 s41, 2
  s_cselect_b32 s14, 17, 45
  s_lshl_b32 s5, s14, 11
  v_mfma_f32_16x16x32_bf16 v[36:39], a[204:207], a[12:15], v[36:39]
  ds_read_b64_tr_b16 a[194:195], v248 offset:6144
  ds_read_b64_tr_b16 a[196:197], v248 offset:10240
  v_fma_f32 v231, v231, v14, v30
  v_fma_f32 v3, v12, v22, v26
  v_mfma_f32_16x16x32_bf16 v[36:39], a[200:203], a[4:7], v[36:39]
  buffer_load_dwordx4 a[216:219], v137, s[36:39], s5 offen offset:0 sc1
  s_lshl_b32 s4, s13, 16
  s_add_u32 m0, s74, 49152
  s_waitcnt lgkmcnt(11)
  v_mfma_f32_16x16x32_bf16 v[44:47], a[208:211], a[4:7], v[44:47]
  ds_read_b64_tr_b16 a[198:199], v248 offset:14336
  ds_read_b64_tr_b16 a[200:201], v249 offset:2048
  v_fma_f32 v4, v12, v23, v27
  v_fma_f32 v5, v12, v24, v28
  v_mfma_f32_16x16x32_bf16 v[44:47], a[212:215], a[12:15], v[44:47]
  buffer_load_dwordx4 v133, s[24:27], s4 offen offset:0 lds
  ds_read_b64_tr_b16 a[202:203], v249 offset:6144
  v_fma_f32 v6, v12, v25, v29
  v_fma_f32 v224, v224, v11, v3
  v_mfma_f32_16x16x32_bf16 v[40:43], a[212:215], a[8:11], v[40:43]
  ds_read_b64_tr_b16 a[204:205], v249 offset:10240
  v_fma_f32 v225, v225, v11, v4
  v_fma_f32 v226, v226, v11, v5
  v_fma_f32 v227, v227, v11, v6
  v_mfma_f32_16x16x32_bf16 v[40:43], a[208:211], a[0:3], v[40:43]
  ds_read_b64_tr_b16 a[206:207], v249 offset:14336
  v_exp_f32 v3, v112
  s_waitcnt vmcnt(46) lgkmcnt(12)
  s_barrier
  v_mfma_f32_16x16x32_bf16 v[48:51], a[176:179], a[0:3], v[48:51]
  ds_read_b64_tr_b16 a[208:209], v250 offset:2048
  v_exp_f32 v4, v113
  v_exp_f32 v5, v114
  v_mfma_f32_16x16x32_bf16 v[48:51], a[180:183], a[8:11], v[48:51]
  buffer_load_dwordx4 a[220:223], v137, s[36:39], s5 offen offset:1024 sc1
  ds_read_b64_tr_b16 a[210:211], v250 offset:6144
  v_exp_f32 v6, v115
  v_mfma_f32_16x16x32_bf16 v[52:55], a[180:183], a[12:15], v[52:55]
  ds_read_b64_tr_b16 a[212:213], v250 offset:10240
  v_exp_f32 v7, v116
  v_exp_f32 v8, v117
  v_mfma_f32_16x16x32_bf16 v[52:55], a[176:179], a[4:7], v[52:55]
  ds_read_b64_tr_b16 a[214:215], v250 offset:14336
  v_exp_f32 v9, v118
  s_waitcnt lgkmcnt(12)
  v_mfma_f32_16x16x32_bf16 v[60:63], a[184:187], a[4:7], v[60:63]
  ds_read_b64_tr_b16 a[176:177], v251 offset:2048
  v_exp_f32 v30, v119
  v_mul_f32 v224, v112, v224
  v_mfma_f32_16x16x32_bf16 v[60:63], a[188:191], a[12:15], v[60:63]
  buffer_load_dwordx4 v134, s[24:27], s4 offen offset:1024 lds
  ds_read_b64_tr_b16 a[178:179], v251 offset:6144
  v_add_f32 v3, 1.0, v3
  v_mul_f32 v225, v113, v225
  v_mfma_f32_16x16x32_bf16 v[56:59], a[188:191], a[8:11], v[56:59]
  ds_read_b64_tr_b16 a[180:181], v251 offset:10240
  v_add_f32 v4, 1.0, v4
  v_mul_f32 v226, v114, v226
  v_add_f32 v5, 1.0, v5
  v_mfma_f32_16x16x32_bf16 v[56:59], a[184:187], a[0:3], v[56:59]
  ds_read_b64_tr_b16 a[182:183], v251 offset:14336
  v_mul_f32 v227, v115, v227
  v_add_f32 v6, 1.0, v6
  s_waitcnt lgkmcnt(12)
  v_mfma_f32_16x16x32_bf16 v[144:147], a[192:195], a[0:3], v[144:147]
  ds_read_b64_tr_b16 a[184:185], v240 offset:0
  v_mul_f32 v228, v116, v228
  v_add_f32 v7, 1.0, v7
  v_mul_f32 v229, v117, v229
  v_mfma_f32_16x16x32_bf16 v[144:147], a[196:199], a[8:11], v[144:147]
  buffer_load_dwordx4 a[224:227], v137, s[36:39], s5 offen offset:2048 sc1
  ds_read_b64_tr_b16 a[186:187], v240 offset:4096
  v_add_f32 v8, 1.0, v8
  v_mul_f32 v230, v118, v230
  v_mfma_f32_16x16x32_bf16 v[148:151], a[196:199], a[12:15], v[148:151]
  ds_read_b64_tr_b16 a[188:189], v240 offset:8192
  v_add_f32 v9, 1.0, v9
  v_mul_f32 v231, v119, v231
  v_add_f32 v30, 1.0, v30
  v_mfma_f32_16x16x32_bf16 v[148:151], a[192:195], a[4:7], v[148:151]
  ds_read_b64_tr_b16 a[190:191], v240 offset:12288
  v_rcp_f32 v3, v3
  s_waitcnt lgkmcnt(12)
  v_mfma_f32_16x16x32_bf16 v[156:159], a[200:203], a[4:7], v[156:159]
  ds_read_b64_tr_b16 a[192:193], v241 offset:0
  v_rcp_f32 v4, v4
  v_rcp_f32 v5, v5
  v_mfma_f32_16x16x32_bf16 v[156:159], a[204:207], a[12:15], v[156:159]
  buffer_load_dwordx4 v135, s[24:27], s4 offen offset:2048 lds
  ds_read_b64_tr_b16 a[194:195], v241 offset:4096
  v_rcp_f32 v6, v6
  v_mfma_f32_16x16x32_bf16 v[152:155], a[204:207], a[8:11], v[152:155]
  ds_read_b64_tr_b16 a[196:197], v241 offset:8192
  v_rcp_f32 v7, v7
  v_rcp_f32 v8, v8
  v_mfma_f32_16x16x32_bf16 v[152:155], a[200:203], a[0:3], v[152:155]
  ds_read_b64_tr_b16 a[198:199], v241 offset:12288
  v_rcp_f32 v9, v9
  s_waitcnt lgkmcnt(12)
  v_mfma_f32_16x16x32_bf16 v[160:163], a[208:211], a[0:3], v[160:163]
  ds_read_b64_tr_b16 a[200:201], v242 offset:0
  v_rcp_f32 v30, v30
  v_mul_f32 v224, v224, v3
  v_mfma_f32_16x16x32_bf16 v[160:163], a[212:215], a[8:11], v[160:163]
  buffer_load_dwordx4 a[228:231], v137, s[36:39], s5 offen offset:3072 sc1
  ds_read_b64_tr_b16 a[202:203], v242 offset:4096
  v_mul_f32 v225, v225, v4
  v_mul_f32 v226, v226, v5
  v_mfma_f32_16x16x32_bf16 v[164:167], a[212:215], a[12:15], v[164:167]
  ds_read_b64_tr_b16 a[204:205], v242 offset:8192
  v_mul_f32 v227, v227, v6
  v_mul_f32 v228, v228, v7
  v_mul_f32 v229, v229, v8
  v_mfma_f32_16x16x32_bf16 v[164:167], a[208:211], a[4:7], v[164:167]
  ds_read_b64_tr_b16 a[206:207], v242 offset:12288
  v_mul_f32 v230, v230, v9
  v_mul_f32 v231, v231, v30
  s_waitcnt lgkmcnt(12)
  v_mfma_f32_16x16x32_bf16 v[172:175], a[176:179], a[4:7], v[172:175]
  ds_read_b64_tr_b16 a[208:209], v243 offset:0
  v_cvt_pk_bf16_f32 v98, v224, v225
  v_cvt_pk_bf16_f32 v99, v226, v227
  buffer_store_dwordx4 v[96:99], v0, s[36:39], s21 offen offset:0 sc1
  v_mfma_f32_16x16x32_bf16 v[172:175], a[180:183], a[12:15], v[172:175]
  ds_read_b64_tr_b16 a[210:211], v243 offset:4096
  v_cvt_pk_bf16_f32 v102, v228, v229
  v_cvt_pk_bf16_f32 v103, v230, v231
  v_mfma_f32_16x16x32_bf16 v[168:171], a[180:183], a[8:11], v[168:171]
  ds_read_b64_tr_b16 a[212:213], v243 offset:8192
  v_mfma_f32_16x16x32_bf16 v[168:171], a[176:179], a[0:3], v[168:171]
  buffer_load_dwordx4 v136, s[24:27], s4 offen offset:3072 lds
  s_cmp_eq_u32 s41, 3
  s_cselect_b32 s15, 24, 52
  s_waitcnt vmcnt(28) lgkmcnt(11)
  v_mfma_f32_16x16x32_bf16 v[32:35], a[184:187], a[16:19], v[32:35]
  s_lshl_b32 s5, s15, 11
  ds_read_b64_tr_b16 a[214:215], v243 offset:12288
  ds_read_b64_tr_b16 a[176:177], v240 offset:2048
  v_mfma_f32_16x16x32_bf16 v[32:35], a[188:191], a[24:27], v[32:35]
  ds_read_b64_tr_b16 a[178:179], v240 offset:6144
  v_mfma_f32_16x16x32_bf16 v[36:39], a[188:191], a[28:31], v[36:39]
  buffer_load_dwordx4 a[0:3], v137, s[36:39], s5 offen offset:0 sc1
  s_lshl_b32 s4, s14, 16
  s_add_u32 m0, s74, 65536
  ds_read_b64_tr_b16 a[180:181], v240 offset:10240
  v_mfma_f32_16x16x32_bf16 v[36:39], a[184:187], a[20:23], v[36:39]
  ds_read_b64_tr_b16 a[182:183], v240 offset:14336
  s_waitcnt lgkmcnt(12)
  v_mfma_f32_16x16x32_bf16 v[44:47], a[192:195], a[20:23], v[44:47]
  ds_read_b64_tr_b16 a[184:185], v241 offset:2048
  v_mfma_f32_16x16x32_bf16 v[44:47], a[196:199], a[28:31], v[44:47]
  buffer_store_dwordx4 v[100:103], v0, s[36:39], s21 offen offset:1024 sc1
  v_exp_f32 v3, v120
  v_exp_f32 v4, v121
  v_exp_f32 v5, v122
  v_exp_f32 v6, v123
  v_exp_f32 v7, v124
  v_exp_f32 v8, v125
  v_exp_f32 v9, v126
  v_exp_f32 v30, v127
  v_mul_f32 v232, v120, v232
  v_add_f32 v3, 1.0, v3
  v_mul_f32 v233, v121, v233
  v_add_f32 v4, 1.0, v4
  v_mul_f32 v234, v122, v234
  v_add_f32 v5, 1.0, v5
  v_mul_f32 v235, v123, v235
  v_add_f32 v6, 1.0, v6
  v_mul_f32 v236, v124, v236
  v_add_f32 v7, 1.0, v7
  v_mul_f32 v237, v125, v237
  v_add_f32 v8, 1.0, v8
  v_mul_f32 v238, v126, v238
  v_add_f32 v9, 1.0, v9
  v_mul_f32 v239, v127, v239
  v_add_f32 v30, 1.0, v30
  v_rcp_f32 v3, v3
  v_rcp_f32 v4, v4
  v_rcp_f32 v5, v5
  v_rcp_f32 v6, v6
  v_rcp_f32 v7, v7
  v_rcp_f32 v8, v8
  v_rcp_f32 v9, v9
  v_rcp_f32 v30, v30
  v_mul_f32 v232, v232, v3
  v_mul_f32 v233, v233, v4
  v_mul_f32 v234, v234, v5
  v_mul_f32 v235, v235, v6
  v_mul_f32 v236, v236, v7
  v_mul_f32 v237, v237, v8
  v_mul_f32 v238, v238, v9
  v_mul_f32 v239, v239, v30
  v_cvt_pk_bf16_f32 v106, v232, v233
  v_cvt_pk_bf16_f32 v107, v234, v235
  buffer_store_dwordx4 v[104:107], v0, s[36:39], s22 offen offset:0 sc1
  v_cvt_pk_bf16_f32 v110, v236, v237
  v_cvt_pk_bf16_f32 v111, v238, v239
  buffer_store_dwordx4 v[108:111], v0, s[36:39], s22 offen offset:1024 sc1
  v_mfma_f32_16x16x32_bf16 v[40:43], a[196:199], a[24:27], v[40:43]
  ds_read_b64_tr_b16 a[186:187], v241 offset:6144
  ds_read_b64_tr_b16 a[188:189], v241 offset:10240
  v_mfma_f32_16x16x32_bf16 v[40:43], a[192:195], a[16:19], v[40:43]
  ds_read_b64_tr_b16 a[190:191], v241 offset:14336
  s_waitcnt vmcnt(30) lgkmcnt(12)
  s_barrier
  v_mfma_f32_16x16x32_bf16 v[48:51], a[200:203], a[16:19], v[48:51]
  buffer_load_dwordx4 v133, s[24:27], s4 offen offset:0 lds
  ds_read_b64_tr_b16 a[192:193], v242 offset:2048
  v_mfma_f32_16x16x32_bf16 v[48:51], a[204:207], a[24:27], v[48:51]
  ds_read_b64_tr_b16 a[194:195], v242 offset:6144
  v_mfma_f32_16x16x32_bf16 v[52:55], a[204:207], a[28:31], v[52:55]
  ds_read_b64_tr_b16 a[196:197], v242 offset:10240
  v_mfma_f32_16x16x32_bf16 v[52:55], a[200:203], a[20:23], v[52:55]
  buffer_load_dwordx4 a[4:7], v137, s[36:39], s5 offen offset:1024 sc1
  ds_read_b64_tr_b16 a[198:199], v242 offset:14336
  s_waitcnt lgkmcnt(12)
  v_mfma_f32_16x16x32_bf16 v[60:63], a[208:211], a[20:23], v[60:63]
  ds_read_b64_tr_b16 a[200:201], v243 offset:2048
  v_mfma_f32_16x16x32_bf16 v[60:63], a[212:215], a[28:31], v[60:63]
  ds_read_b64_tr_b16 a[202:203], v243 offset:6144
  v_mfma_f32_16x16x32_bf16 v[56:59], a[212:215], a[24:27], v[56:59]
  buffer_load_dwordx4 v134, s[24:27], s4 offen offset:1024 lds
  ds_read_b64_tr_b16 a[204:205], v243 offset:10240
  v_mfma_f32_16x16x32_bf16 v[56:59], a[208:211], a[16:19], v[56:59]
  ds_read_b64_tr_b16 a[206:207], v243 offset:14336
  s_waitcnt lgkmcnt(12)
  v_mfma_f32_16x16x32_bf16 v[144:147], a[176:179], a[16:19], v[144:147]
  ds_read_b64_tr_b16 a[208:209], v240 offset:16384
  v_mfma_f32_16x16x32_bf16 v[144:147], a[180:183], a[24:27], v[144:147]
  buffer_load_dwordx4 a[8:11], v137, s[36:39], s5 offen offset:2048 sc1
  ds_read_b64_tr_b16 a[210:211], v240 offset:20480
  v_mfma_f32_16x16x32_bf16 v[148:151], a[180:183], a[28:31], v[148:151]
  ds_read_b64_tr_b16 a[212:213], v240 offset:24576
  v_mfma_f32_16x16x32_bf16 v[148:151], a[176:179], a[20:23], v[148:151]
  ds_read_b64_tr_b16 a[214:215], v240 offset:28672
  s_waitcnt lgkmcnt(12)
  v_mfma_f32_16x16x32_bf16 v[156:159], a[184:187], a[20:23], v[156:159]
  ds_read_b64_tr_b16 a[176:177], v241 offset:16384
  v_mfma_f32_16x16x32_bf16 v[156:159], a[188:191], a[28:31], v[156:159]
  buffer_load_dwordx4 v135, s[24:27], s4 offen offset:2048 lds
  ds_read_b64_tr_b16 a[178:179], v241 offset:20480
  v_mfma_f32_16x16x32_bf16 v[152:155], a[188:191], a[24:27], v[152:155]
  ds_read_b64_tr_b16 a[180:181], v241 offset:24576
  v_mfma_f32_16x16x32_bf16 v[152:155], a[184:187], a[16:19], v[152:155]
  ds_read_b64_tr_b16 a[182:183], v241 offset:28672
  s_waitcnt lgkmcnt(12)
  v_mfma_f32_16x16x32_bf16 v[160:163], a[192:195], a[16:19], v[160:163]
  ds_read_b64_tr_b16 a[184:185], v242 offset:16384
  v_mfma_f32_16x16x32_bf16 v[160:163], a[196:199], a[24:27], v[160:163]
  buffer_load_dwordx4 a[12:15], v137, s[36:39], s5 offen offset:3072 sc1
  ds_read_b64_tr_b16 a[186:187], v242 offset:20480
  v_mfma_f32_16x16x32_bf16 v[164:167], a[196:199], a[28:31], v[164:167]
  ds_read_b64_tr_b16 a[188:189], v242 offset:24576
  v_mfma_f32_16x16x32_bf16 v[164:167], a[192:195], a[20:23], v[164:167]
  ds_read_b64_tr_b16 a[190:191], v242 offset:28672
  s_waitcnt lgkmcnt(12)
  v_mfma_f32_16x16x32_bf16 v[172:175], a[200:203], a[20:23], v[172:175]
  ds_read_b64_tr_b16 a[192:193], v243 offset:16384
  v_mfma_f32_16x16x32_bf16 v[172:175], a[204:207], a[28:31], v[172:175]
  buffer_load_dwordx4 v136, s[24:27], s4 offen offset:3072 lds
  s_add_u32 s6, s41, 8
  v_mfma_f32_16x16x32_bf16 v[168:171], a[204:207], a[24:27], v[168:171]
  s_and_b32 s6, s6, 3
  s_mul_i32 s6, s6, 14
  v_mfma_f32_16x16x32_bf16 v[168:171], a[200:203], a[16:19], v[168:171]
  s_lshl_b32 s5, s6, 11
  s_waitcnt vmcnt(32) lgkmcnt(9)
  v_mfma_f32_16x16x32_bf16 v[32:35], a[208:211], a[32:35], v[32:35]
  ds_read_b64_tr_b16 a[194:195], v243 offset:20480
  ds_read_b64_tr_b16 a[196:197], v243 offset:24576
  v_mfma_f32_16x16x32_bf16 v[32:35], a[212:215], a[40:43], v[32:35]
  ds_read_b64_tr_b16 a[198:199], v243 offset:28672
  ds_read_b64_tr_b16 a[200:201], v240 offset:18432
  v_mfma_f32_16x16x32_bf16 v[36:39], a[212:215], a[44:47], v[36:39]
  buffer_load_dwordx4 a[16:19], v137, s[36:39], s5 offen offset:0 sc1
  s_lshl_b32 s4, s15, 16
  v_mfma_f32_16x16x32_bf16 v[36:39], a[208:211], a[36:39], v[36:39]
  s_add_u32 m0, s74, 81920
  s_waitcnt lgkmcnt(9)
  v_mfma_f32_16x16x32_bf16 v[44:47], a[176:179], a[36:39], v[44:47]
  ds_read_b64_tr_b16 a[202:203], v240 offset:22528
  ds_read_b64_tr_b16 a[204:205], v240 offset:26624
  v_mfma_f32_16x16x32_bf16 v[44:47], a[180:183], a[44:47], v[44:47]
  ds_read_b64_tr_b16 a[206:207], v240 offset:30720
  ds_read_b64_tr_b16 a[208:209], v241 offset:18432
  v_mfma_f32_16x16x32_bf16 v[40:43], a[180:183], a[40:43], v[40:43]
  buffer_load_dwordx4 v133, s[24:27], s4 offen offset:0 lds
  ds_read_b64_tr_b16 a[210:211], v241 offset:22528
  v_mfma_f32_16x16x32_bf16 v[40:43], a[176:179], a[32:35], v[40:43]
  s_waitcnt vmcnt(22) lgkmcnt(10)
  s_barrier
  v_mfma_f32_16x16x32_bf16 v[48:51], a[184:187], a[32:35], v[48:51]
  ds_read_b64_tr_b16 a[212:213], v241 offset:26624
  ds_read_b64_tr_b16 a[214:215], v241 offset:30720
  v_mfma_f32_16x16x32_bf16 v[48:51], a[188:191], a[40:43], v[48:51]
  ds_read_b64_tr_b16 a[176:177], v242 offset:18432
  buffer_load_dwordx4 a[20:23], v137, s[36:39], s5 offen offset:1024 sc1
  v_mfma_f32_16x16x32_bf16 v[52:55], a[188:191], a[44:47], v[52:55]
  ds_read_b64_tr_b16 a[178:179], v242 offset:22528
  ds_read_b64_tr_b16 a[180:181], v242 offset:26624
  v_mfma_f32_16x16x32_bf16 v[52:55], a[184:187], a[36:39], v[52:55]
  ds_read_b64_tr_b16 a[182:183], v242 offset:30720
  s_waitcnt lgkmcnt(12)
  v_mfma_f32_16x16x32_bf16 v[60:63], a[192:195], a[36:39], v[60:63]
  ds_read_b64_tr_b16 a[184:185], v243 offset:18432
  v_mfma_f32_16x16x32_bf16 v[60:63], a[196:199], a[44:47], v[60:63]
  buffer_load_dwordx4 v134, s[24:27], s4 offen offset:1024 lds
  s_add_u32 s5, s5, 12288
  v_mfma_f32_16x16x32_bf16 v[56:59], a[196:199], a[40:43], v[56:59]
  ds_read_b64_tr_b16 a[186:187], v243 offset:22528
  ds_read_b64_tr_b16 a[188:189], v243 offset:26624
  v_mfma_f32_16x16x32_bf16 v[56:59], a[192:195], a[32:35], v[56:59]
  ds_read_b64_tr_b16 a[190:191], v243 offset:30720
  s_waitcnt lgkmcnt(12)
  v_mfma_f32_16x16x32_bf16 v[144:147], a[200:203], a[32:35], v[144:147]
  ds_read_b64_tr_b16 a[192:193], v240 offset:32768
  v_mfma_f32_16x16x32_bf16 v[144:147], a[204:207], a[40:43], v[144:147]
  buffer_load_dwordx4 a[24:27], v137, s[36:39], s5 offen offset:2048 sc1
  ds_read_b64_tr_b16 a[194:195], v240 offset:36864
  v_mfma_f32_16x16x32_bf16 v[148:151], a[204:207], a[44:47], v[148:151]
  ds_read_b64_tr_b16 a[196:197], v240 offset:40960
  v_mfma_f32_16x16x32_bf16 v[148:151], a[200:203], a[36:39], v[148:151]
  ds_read_b64_tr_b16 a[198:199], v240 offset:45056
  s_waitcnt lgkmcnt(12)
  v_mfma_f32_16x16x32_bf16 v[156:159], a[208:211], a[36:39], v[156:159]
  ds_read_b64_tr_b16 a[200:201], v241 offset:32768
  v_mfma_f32_16x16x32_bf16 v[156:159], a[212:215], a[44:47], v[156:159]
  buffer_load_dwordx4 v135, s[24:27], s4 offen offset:2048 lds
  ds_read_b64_tr_b16 a[202:203], v241 offset:36864
  v_mfma_f32_16x16x32_bf16 v[152:155], a[212:215], a[40:43], v[152:155]
  ds_read_b64_tr_b16 a[204:205], v241 offset:40960
  v_mfma_f32_16x16x32_bf16 v[152:155], a[208:211], a[32:35], v[152:155]
  ds_read_b64_tr_b16 a[206:207], v241 offset:45056
  s_waitcnt lgkmcnt(12)
  v_mfma_f32_16x16x32_bf16 v[160:163], a[176:179], a[32:35], v[160:163]
  ds_read_b64_tr_b16 a[208:209], v242 offset:32768
  v_mfma_f32_16x16x32_bf16 v[160:163], a[180:183], a[40:43], v[160:163]
  buffer_load_dwordx4 a[28:31], v137, s[36:39], s5 offen offset:3072 sc1
  ds_read_b64_tr_b16 a[210:211], v242 offset:36864
  v_mfma_f32_16x16x32_bf16 v[164:167], a[180:183], a[44:47], v[164:167]
  ds_read_b64_tr_b16 a[212:213], v242 offset:40960
  v_mfma_f32_16x16x32_bf16 v[164:167], a[176:179], a[36:39], v[164:167]
  ds_read_b64_tr_b16 a[214:215], v242 offset:45056
  s_waitcnt lgkmcnt(12)
  v_mfma_f32_16x16x32_bf16 v[172:175], a[184:187], a[36:39], v[172:175]
  ds_read_b64_tr_b16 a[176:177], v243 offset:32768
  v_mfma_f32_16x16x32_bf16 v[172:175], a[188:191], a[44:47], v[172:175]
  buffer_load_dwordx4 v136, s[24:27], s4 offen offset:3072 lds
  s_add_u32 s7, s41, 9
  v_mfma_f32_16x16x32_bf16 v[168:171], a[188:191], a[40:43], v[168:171]
  s_and_b32 s7, s7, 3
  s_mul_i32 s7, s7, 14
  v_mfma_f32_16x16x32_bf16 v[168:171], a[184:187], a[32:35], v[168:171]
  s_lshl_b32 s5, s7, 11
  s_waitcnt vmcnt(36) lgkmcnt(9)
  v_mfma_f32_16x16x32_bf16 v[32:35], a[192:195], a[48:51], v[32:35]
  ds_read_b64_tr_b16 a[178:179], v243 offset:36864
  ds_read_b64_tr_b16 a[180:181], v243 offset:40960
  v_mfma_f32_16x16x32_bf16 v[32:35], a[196:199], a[56:59], v[32:35]
  ds_read_b64_tr_b16 a[182:183], v243 offset:45056
  ds_read_b64_tr_b16 a[184:185], v240 offset:34816
  v_mfma_f32_16x16x32_bf16 v[36:39], a[196:199], a[60:63], v[36:39]
  buffer_load_dwordx4 a[32:35], v137, s[36:39], s5 offen offset:0 sc1
  s_lshl_b32 s4, s6, 16
  v_mfma_f32_16x16x32_bf16 v[36:39], a[192:195], a[52:55], v[36:39]
  s_add_u32 s4, s4, s42
  s_waitcnt lgkmcnt(9)
  v_mfma_f32_16x16x32_bf16 v[44:47], a[200:203], a[52:55], v[44:47]
  s_add_u32 m0, s74, 98304
  ds_read_b64_tr_b16 a[186:187], v240 offset:38912
  v_mfma_f32_16x16x32_bf16 v[44:47], a[204:207], a[60:63], v[44:47]
  ds_read_b64_tr_b16 a[188:189], v240 offset:43008
  ds_read_b64_tr_b16 a[190:191], v240 offset:47104
  v_mfma_f32_16x16x32_bf16 v[40:43], a[204:207], a[56:59], v[40:43]
  ds_read_b64_tr_b16 a[192:193], v241 offset:34816
  buffer_load_dwordx4 v133, s[24:27], s4 offen offset:0 lds
  v_mfma_f32_16x16x32_bf16 v[40:43], a[200:203], a[48:51], v[40:43]
  s_waitcnt vmcnt(17) lgkmcnt(9)
  s_barrier
  v_mfma_f32_16x16x32_bf16 v[48:51], a[208:211], a[48:51], v[48:51]
  ds_read_b64_tr_b16 a[194:195], v241 offset:38912
  ds_read_b64_tr_b16 a[196:197], v241 offset:43008
  v_mfma_f32_16x16x32_bf16 v[48:51], a[212:215], a[56:59], v[48:51]
  ds_read_b64_tr_b16 a[198:199], v241 offset:47104
  s_mov_b64 exec, 1
  buffer_store_dword v254, v0, s[36:39], s45 offen sc1
  s_mov_b64 exec, -1
  v_mfma_f32_16x16x32_bf16 v[52:55], a[212:215], a[60:63], v[52:55]
  s_lshl_b32 s45, s2, 7
  s_add_u32 s45, s45, 5472256
  v_mfma_f32_16x16x32_bf16 v[52:55], a[208:211], a[52:55], v[52:55]
  s_cmp_eq_u32 s44, 0
  s_waitcnt lgkmcnt(8)
  v_mfma_f32_16x16x32_bf16 v[60:63], a[176:179], a[52:55], v[60:63]
  s_cselect_b32 s45, s45, 1073741824
  ds_read_b64_tr_b16 a[200:201], v242 offset:34816
  v_mfma_f32_16x16x32_bf16 v[60:63], a[180:183], a[60:63], v[60:63]
  buffer_load_dwordx4 a[36:39], v137, s[36:39], s5 offen offset:1024 sc1
  ds_read_b64_tr_b16 a[202:203], v242 offset:38912
  v_mfma_f32_16x16x32_bf16 v[56:59], a[180:183], a[56:59], v[56:59]
  ds_read_b64_tr_b16 a[204:205], v242 offset:43008
  ds_read_b64_tr_b16 a[206:207], v242 offset:47104
  v_mfma_f32_16x16x32_bf16 v[56:59], a[176:179], a[48:51], v[56:59]
  ds_read_b64_tr_b16 a[208:209], v243 offset:34816
  s_waitcnt lgkmcnt(9)
  v_mfma_f32_16x16x32_bf16 v[144:147], a[184:187], a[48:51], v[144:147]
  buffer_load_dwordx4 v134, s[24:27], s4 offen offset:1024 lds
  s_add_u32 s5, s5, 12288
  v_mfma_f32_16x16x32_bf16 v[144:147], a[188:191], a[56:59], v[144:147]
  ds_read_b64_tr_b16 a[210:211], v243 offset:38912
  ds_read_b64_tr_b16 a[212:213], v243 offset:43008
  v_mfma_f32_16x16x32_bf16 v[148:151], a[188:191], a[60:63], v[148:151]
  ds_read_b64_tr_b16 a[214:215], v243 offset:47104
  ds_read_b64_tr_b16 a[176:177], v240 offset:49152
  v_mfma_f32_16x16x32_bf16 v[148:151], a[184:187], a[52:55], v[148:151]
  buffer_load_dwordx4 a[40:43], v137, s[36:39], s5 offen offset:2048 sc1
  s_waitcnt lgkmcnt(9)
  v_mfma_f32_16x16x32_bf16 v[156:159], a[192:195], a[52:55], v[156:159]
  ds_read_b64_tr_b16 a[178:179], v240 offset:53248
  ds_read_b64_tr_b16 a[180:181], v240 offset:57344
  v_mfma_f32_16x16x32_bf16 v[156:159], a[196:199], a[60:63], v[156:159]
  ds_read_b64_tr_b16 a[182:183], v240 offset:61440
  ds_read_b64_tr_b16 a[184:185], v241 offset:49152
  v_mfma_f32_16x16x32_bf16 v[152:155], a[196:199], a[56:59], v[152:155]
  buffer_load_dwordx4 v135, s[24:27], s4 offen offset:2048 lds
  ds_read_b64_tr_b16 a[186:187], v241 offset:53248
  v_mfma_f32_16x16x32_bf16 v[152:155], a[192:195], a[48:51], v[152:155]
  ds_read_b64_tr_b16 a[188:189], v241 offset:57344
  s_waitcnt lgkmcnt(11)
  v_mfma_f32_16x16x32_bf16 v[160:163], a[200:203], a[48:51], v[160:163]
  ds_read_b64_tr_b16 a[190:191], v241 offset:61440
  ds_read_b64_tr_b16 a[192:193], v242 offset:49152
  v_mfma_f32_16x16x32_bf16 v[160:163], a[204:207], a[56:59], v[160:163]
  buffer_load_dwordx4 a[44:47], v137, s[36:39], s5 offen offset:3072 sc1
  ds_read_b64_tr_b16 a[194:195], v242 offset:53248
  v_mfma_f32_16x16x32_bf16 v[164:167], a[204:207], a[60:63], v[164:167]
  ds_read_b64_tr_b16 a[196:197], v242 offset:57344
  s_add_u32 s28, s74, 16384
  v_mfma_f32_16x16x32_bf16 v[164:167], a[200:203], a[52:55], v[164:167]
  ds_read_b64_tr_b16 a[198:199], v242 offset:61440
  s_waitcnt lgkmcnt(12)
  v_mfma_f32_16x16x32_bf16 v[172:175], a[208:211], a[52:55], v[172:175]
  ds_read_b64_tr_b16 a[200:201], v243 offset:49152
  v_and_b32 v129, 15, v128
  v_mfma_f32_16x16x32_bf16 v[172:175], a[212:215], a[60:63], v[172:175]
  buffer_load_dwordx4 v136, s[24:27], s4 offen offset:3072 lds
  s_add_u32 s8, s41, 10
  v_mfma_f32_16x16x32_bf16 v[168:171], a[212:215], a[56:59], v[168:171]
  s_and_b32 s8, s8, 3
  s_mul_i32 s8, s8, 14
  v_mfma_f32_16x16x32_bf16 v[168:171], a[208:211], a[48:51], v[168:171]
  s_lshl_b32 s5, s8, 11
  s_waitcnt vmcnt(38) lgkmcnt(9)
  v_mfma_f32_16x16x32_bf16 v[32:35], a[176:179], a[64:67], v[32:35]
  ds_read_b64_tr_b16 a[202:203], v243 offset:53248
  ds_read_b64_tr_b16 a[204:205], v243 offset:57344
  v_mfma_f32_16x16x32_bf16 v[32:35], a[180:183], a[72:75], v[32:35]
  ds_read_b64_tr_b16 a[206:207], v243 offset:61440
  ds_read_b64_tr_b16 a[208:209], v240 offset:51200
  v_mfma_f32_16x16x32_bf16 v[36:39], a[180:183], a[76:79], v[36:39]
  buffer_load_dwordx4 a[48:51], v137, s[36:39], s5 offen offset:0 sc1
  s_lshl_b32 s4, s7, 16
  v_mfma_f32_16x16x32_bf16 v[36:39], a[176:179], a[68:71], v[36:39]
  s_add_u32 s4, s4, s42
  s_waitcnt lgkmcnt(9)
  v_mfma_f32_16x16x32_bf16 v[44:47], a[184:187], a[68:71], v[44:47]
  s_add_u32 m0, s74, 114688
  ds_read_b64_tr_b16 a[210:211], v240 offset:55296
  v_mfma_f32_16x16x32_bf16 v[44:47], a[188:191], a[76:79], v[44:47]
  ds_read_b64_tr_b16 a[212:213], v240 offset:59392
  ds_read_b64_tr_b16 a[214:215], v240 offset:63488
  v_mfma_f32_16x16x32_bf16 v[40:43], a[188:191], a[72:75], v[40:43]
  ds_read_b64_tr_b16 a[176:177], v241 offset:51200
  buffer_load_dwordx4 v133, s[24:27], s4 offen offset:0 lds
  v_mfma_f32_16x16x32_bf16 v[40:43], a[184:187], a[64:67], v[40:43]
  s_waitcnt vmcnt(19) lgkmcnt(9)
  s_barrier
  v_mfma_f32_16x16x32_bf16 v[48:51], a[192:195], a[64:67], v[48:51]
  ds_read_b64_tr_b16 a[178:179], v241 offset:55296
  ds_read_b64_tr_b16 a[180:181], v241 offset:59392
  v_mfma_f32_16x16x32_bf16 v[48:51], a[196:199], a[72:75], v[48:51]
  ds_read_b64_tr_b16 a[182:183], v241 offset:63488
  ds_read_b64_tr_b16 a[184:185], v242 offset:51200
  v_mfma_f32_16x16x32_bf16 v[52:55], a[196:199], a[76:79], v[52:55]
  buffer_load_dwordx4 a[52:55], v137, s[36:39], s5 offen offset:1024 sc1
  ds_read_b64_tr_b16 a[186:187], v242 offset:55296
  v_mfma_f32_16x16x32_bf16 v[52:55], a[192:195], a[68:71], v[52:55]
  ds_read_b64_tr_b16 a[188:189], v242 offset:59392
  s_waitcnt lgkmcnt(11)
  v_mfma_f32_16x16x32_bf16 v[60:63], a[200:203], a[68:71], v[60:63]
  ds_read_b64_tr_b16 a[190:191], v242 offset:63488
  ds_read_b64_tr_b16 a[192:193], v243 offset:51200
  v_mfma_f32_16x16x32_bf16 v[60:63], a[204:207], a[76:79], v[60:63]
  buffer_load_dword v139, v138, s[36:39], s57 offen sc1
  ds_read_b64_tr_b16 a[194:195], v243 offset:55296
  v_mfma_f32_16x16x32_bf16 v[56:59], a[204:207], a[72:75], v[56:59]
  ds_read_b64_tr_b16 a[196:197], v243 offset:59392
  v_lshrrev_b32 v131, 1, v129
  v_mfma_f32_16x16x32_bf16 v[56:59], a[200:203], a[64:67], v[56:59]
  ds_read_b64_tr_b16 a[198:199], v243 offset:63488
  s_waitcnt lgkmcnt(12)
  v_mfma_f32_16x16x32_bf16 v[144:147], a[208:211], a[64:67], v[144:147]
  buffer_load_dwordx4 v134, s[24:27], s4 offen offset:1024 lds
  s_add_u32 s5, s5, 12288
  v_mfma_f32_16x16x32_bf16 v[144:147], a[212:215], a[72:75], v[144:147]
  ds_read_b64_tr_b16 a[200:201], v244 offset:0
  ds_read_b64_tr_b16 a[202:203], v244 offset:4096
  v_mfma_f32_16x16x32_bf16 v[148:151], a[212:215], a[76:79], v[148:151]
  ds_read_b64_tr_b16 a[204:205], v244 offset:8192
  v_lshrrev_b32 v130, 5, v128
  v_mfma_f32_16x16x32_bf16 v[148:151], a[208:211], a[68:71], v[148:151]
  buffer_load_dwordx4 a[56:59], v137, s[36:39], s5 offen offset:2048 sc1
  s_waitcnt lgkmcnt(11)
  v_mfma_f32_16x16x32_bf16 v[156:159], a[176:179], a[68:71], v[156:159]
  ds_read_b64_tr_b16 a[206:207], v244 offset:12288
  ds_read_b64_tr_b16 a[208:209], v245 offset:0
  v_mfma_f32_16x16x32_bf16 v[156:159], a[180:183], a[76:79], v[156:159]
  ds_read_b64_tr_b16 a[210:211], v245 offset:4096
  v_xor_b32 v131, v131, v130
  v_mfma_f32_16x16x32_bf16 v[152:155], a[180:183], a[72:75], v[152:155]
  buffer_load_dwordx4 v135, s[24:27], s4 offen offset:2048 lds
  ds_read_b64_tr_b16 a[212:213], v245 offset:8192
  v_mfma_f32_16x16x32_bf16 v[152:155], a[176:179], a[64:67], v[152:155]
  ds_read_b64_tr_b16 a[214:215], v245 offset:12288
  s_waitcnt lgkmcnt(12)
  v_mfma_f32_16x16x32_bf16 v[160:163], a[184:187], a[64:67], v[160:163]
  ds_read_b64_tr_b16 a[176:177], v246 offset:0
  v_lshlrev_b32 v131, 4, v131
  v_mfma_f32_16x16x32_bf16 v[160:163], a[188:191], a[72:75], v[160:163]
  buffer_load_dwordx4 a[60:63], v137, s[36:39], s5 offen offset:3072 sc1
  ds_read_b64_tr_b16 a[178:179], v246 offset:4096
  v_mfma_f32_16x16x32_bf16 v[164:167], a[188:191], a[76:79], v[164:167]
  ds_read_b64_tr_b16 a[180:181], v246 offset:8192
  v_lshl_add_u32 v131, v129, 7, v131
  v_mfma_f32_16x16x32_bf16 v[164:167], a[184:187], a[68:71], v[164:167]
  ds_read_b64_tr_b16 a[182:183], v246 offset:12288
  s_waitcnt lgkmcnt(12)
  v_mfma_f32_16x16x32_bf16 v[172:175], a[192:195], a[68:71], v[172:175]
  ds_read_b64_tr_b16 a[184:185], v247 offset:0
  v_bfe_u32 v130, v128, 4, 1
  v_mfma_f32_16x16x32_bf16 v[172:175], a[196:199], a[76:79], v[172:175]
  buffer_load_dwordx4 v136, s[24:27], s4 offen offset:3072 lds
  s_add_u32 s9, s41, 11
  v_mfma_f32_16x16x32_bf16 v[168:171], a[196:199], a[72:75], v[168:171]
  s_and_b32 s9, s9, 3
  s_mul_i32 s9, s9, 14
  v_mfma_f32_16x16x32_bf16 v[168:171], a[192:195], a[64:67], v[168:171]
  s_lshl_b32 s5, s9, 11
  s_waitcnt vmcnt(39) lgkmcnt(9)
  v_mfma_f32_16x16x32_bf16 v[32:35], a[200:203], a[216:219], v[32:35]
  ds_read_b64_tr_b16 a[186:187], v247 offset:4096
  ds_read_b64_tr_b16 a[188:189], v247 offset:8192
  v_mfma_f32_16x16x32_bf16 v[32:35], a[204:207], a[224:227], v[32:35]
CT24:
  s_add_u32 s94, s92, CT24-k3_main_kernel+3072
  s_addc_u32 s95, s93, 0
  v_mfma_f32_16x16x32_bf16 v[36:39], a[204:207], a[228:231], v[36:39]
  global_load_dword a252, v0, s[94:95]
  ds_read_b64_tr_b16 a[190:191], v247 offset:12288
  v_mfma_f32_16x16x32_bf16 v[36:39], a[200:203], a[220:223], v[36:39]
  ds_read_b64_tr_b16 a[192:193], v244 offset:2048
  s_waitcnt lgkmcnt(9)
  v_mfma_f32_16x16x32_bf16 v[44:47], a[208:211], a[220:223], v[44:47]
  ds_read_b64_tr_b16 a[194:195], v244 offset:6144
  ds_read_b64_tr_b16 a[196:197], v244 offset:10240
  v_mfma_f32_16x16x32_bf16 v[44:47], a[212:215], a[228:231], v[44:47]
  buffer_load_dwordx4 a[64:67], v137, s[36:39], s5 offen offset:0 sc1
  s_lshl_b32 s4, s8, 16
  v_mfma_f32_16x16x32_bf16 v[40:43], a[212:215], a[224:227], v[40:43]
  s_add_u32 s4, s4, s42
  s_add_u32 m0, s74, 131072
  v_mfma_f32_16x16x32_bf16 v[40:43], a[208:211], a[216:219], v[40:43]
  s_waitcnt vmcnt(20) lgkmcnt(7)
  s_barrier
  v_mfma_f32_16x16x32_bf16 v[48:51], a[176:179], a[216:219], v[48:51]
  ds_read_b64_tr_b16 a[198:199], v244 offset:14336
  ds_read_b64_tr_b16 a[200:201], v245 offset:2048
  v_mfma_f32_16x16x32_bf16 v[48:51], a[180:183], a[224:227], v[48:51]
  buffer_load_dwordx4 v133, s[24:27], s4 offen offset:0 lds
  ds_read_b64_tr_b16 a[202:203], v245 offset:6144
  v_mfma_f32_16x16x32_bf16 v[52:55], a[180:183], a[228:231], v[52:55]
  ds_read_b64_tr_b16 a[204:205], v245 offset:10240
  ds_read_b64_tr_b16 a[206:207], v245 offset:14336
  v_mfma_f32_16x16x32_bf16 v[52:55], a[176:179], a[220:223], v[52:55]
  ds_read_b64_tr_b16 a[208:209], v246 offset:2048
  s_waitcnt lgkmcnt(9)
  v_mfma_f32_16x16x32_bf16 v[60:63], a[184:187], a[220:223], v[60:63]
  buffer_load_dwordx4 a[68:71], v137, s[36:39], s5 offen offset:1024 sc1
  ds_read_b64_tr_b16 a[210:211], v246 offset:6144
  v_mfma_f32_16x16x32_bf16 v[60:63], a[188:191], a[228:231], v[60:63]
  ds_read_b64_tr_b16 a[212:213], v246 offset:10240
  ds_read_b64_tr_b16 a[214:215], v246 offset:14336
  v_mfma_f32_16x16x32_bf16 v[56:59], a[188:191], a[224:227], v[56:59]
  ds_read_b64_tr_b16 a[176:177], v247 offset:2048
  ds_read_b64_tr_b16 a[178:179], v247 offset:6144
  v_mfma_f32_16x16x32_bf16 v[56:59], a[184:187], a[216:219], v[56:59]
  buffer_load_dwordx4 v134, s[24:27], s4 offen offset:1024 lds
  s_waitcnt lgkmcnt(10)
  v_mfma_f32_16x16x32_bf16 v[144:147], a[192:195], a[216:219], v[144:147]
  s_add_u32 s5, s5, 12288
  ds_read_b64_tr_b16 a[180:181], v247 offset:10240
  v_mfma_f32_16x16x32_bf16 v[144:147], a[196:199], a[224:227], v[144:147]
  ds_read_b64_tr_b16 a[182:183], v247 offset:14336
  ds_read_b64_tr_b16 a[184:185], v244 offset:16384
  v_mfma_f32_16x16x32_bf16 v[148:151], a[196:199], a[228:231], v[148:151]
  buffer_load_dwordx4 a[72:75], v137, s[36:39], s5 offen offset:2048 sc1
  ds_read_b64_tr_b16 a[186:187], v244 offset:20480
  v_mfma_f32_16x16x32_bf16 v[148:151], a[192:195], a[220:223], v[148:151]
  ds_read_b64_tr_b16 a[188:189], v244 offset:24576
  s_waitcnt lgkmcnt(11)
  v_mfma_f32_16x16x32_bf16 v[156:159], a[200:203], a[220:223], v[156:159]
  ds_read_b64_tr_b16 a[190:191], v244 offset:28672
  ds_read_b64_tr_b16 a[192:193], v245 offset:16384
  v_mfma_f32_16x16x32_bf16 v[156:159], a[204:207], a[228:231], v[156:159]
  buffer_load_dwordx4 v135, s[24:27], s4 offen offset:2048 lds
  ds_read_b64_tr_b16 a[194:195], v245 offset:20480
  v_mfma_f32_16x16x32_bf16 v[152:155], a[204:207], a[224:227], v[152:155]
  ds_read_b64_tr_b16 a[196:197], v245 offset:24576
  v_lshl_add_u32 v131, v130, 3, v131
  v_mfma_f32_16x16x32_bf16 v[152:155], a[200:203], a[216:219], v[152:155]
  ds_read_b64_tr_b16 a[198:199], v245 offset:28672
  s_waitcnt lgkmcnt(12)
  v_mfma_f32_16x16x32_bf16 v[160:163], a[208:211], a[216:219], v[160:163]
  ds_read_b64_tr_b16 a[200:201], v246 offset:16384
  v_add_u32 v140, s28, v131
  v_mfma_f32_16x16x32_bf16 v[160:163], a[212:215], a[224:227], v[160:163]
  buffer_load_dwordx4 a[76:79], v137, s[36:39], s5 offen offset:3072 sc1
  ds_read_b64_tr_b16 a[202:203], v246 offset:20480
  v_mfma_f32_16x16x32_bf16 v[164:167], a[212:215], a[228:231], v[164:167]
  ds_read_b64_tr_b16 a[204:205], v246 offset:24576
  v_xor_b32 v141, 32, v140
  v_mfma_f32_16x16x32_bf16 v[164:167], a[208:211], a[220:223], v[164:167]
  ds_read_b64_tr_b16 a[206:207], v246 offset:28672
  s_waitcnt lgkmcnt(12)
  v_mfma_f32_16x16x32_bf16 v[172:175], a[176:179], a[220:223], v[172:175]
  ds_read_b64_tr_b16 a[208:209], v247 offset:16384
  v_xor_b32 v142, 64, v140
  v_mfma_f32_16x16x32_bf16 v[172:175], a[180:183], a[228:231], v[172:175]
  buffer_load_dwordx4 v136, s[24:27], s4 offen offset:3072 lds
  s_mov_b32 s12, 1
  v_mfma_f32_16x16x32_bf16 v[168:171], a[180:183], a[224:227], v[168:171]
  ds_read_b64_tr_b16 a[210:211], v247 offset:20480
  s_waitcnt vmcnt(14)
  v_cmp_ne_u32 vcc, 1, v139
  s_nop 4
  s_cbranch_vccnz CK25s
CK25x:
  v_mfma_f32_16x16x32_bf16 v[168:171], a[176:179], a[216:219], v[168:171]
  s_lshl_b32 s5, s12, 11
  s_waitcnt vmcnt(36) lgkmcnt(10)
  v_mfma_f32_16x16x32_bf16 v[32:35], a[184:187], a[0:3], v[32:35]
  ds_read_b64_tr_b16 a[212:213], v247 offset:24576
  ds_read_b64_tr_b16 a[214:215], v247 offset:28672
  v_mfma_f32_16x16x32_bf16 v[32:35], a[188:191], a[8:11], v[32:35]
  ds_read_b64_tr_b16 a[176:177], v244 offset:18432
  buffer_load_dwordx4 a[216:219], v137, s[36:39], s5 offen offset:0 sc1
  v_mfma_f32_16x16x32_bf16 v[36:39], a[188:191], a[12:15], v[36:39]
  s_lshl_b32 s4, s9, 16
  s_add_u32 s4, s4, s42
  v_mfma_f32_16x16x32_bf16 v[36:39], a[184:187], a[4:7], v[36:39]
  s_add_u32 m0, s74, 0
  s_waitcnt lgkmcnt(9)
  v_mfma_f32_16x16x32_bf16 v[44:47], a[192:195], a[4:7], v[44:47]
  ds_read_b64_tr_b16 a[178:179], v244 offset:22528
  ds_read_b64_tr_b16 a[180:181], v244 offset:26624
  v_mfma_f32_16x16x32_bf16 v[44:47], a[196:199], a[12:15], v[44:47]
  ds_read_b64_tr_b16 a[182:183], v244 offset:30720
  ds_read_b64_tr_b16 a[184:185], v245 offset:18432
  v_mfma_f32_16x16x32_bf16 v[40:43], a[196:199], a[8:11], v[40:43]
  buffer_load_dwordx4 v133, s[24:27], s4 offen offset:0 lds
  ds_read_b64_tr_b16 a[186:187], v245 offset:22528
  v_mfma_f32_16x16x32_bf16 v[40:43], a[192:195], a[0:3], v[40:43]
  s_waitcnt vmcnt(20) lgkmcnt(10)
  s_barrier
  v_mfma_f32_16x16x32_bf16 v[48:51], a[200:203], a[0:3], v[48:51]
  ds_read_b64_tr_b16 a[188:189], v245 offset:26624
  ds_read_b64_tr_b16 a[190:191], v245 offset:30720
  v_mfma_f32_16x16x32_bf16 v[48:51], a[204:207], a[8:11], v[48:51]
  ds_read_b64_tr_b16 a[192:193], v246 offset:18432
  buffer_load_dwordx4 a[220:223], v137, s[36:39], s5 offen offset:1024 sc1
  v_mfma_f32_16x16x32_bf16 v[52:55], a[204:207], a[12:15], v[52:55]
  ds_read_b64_tr_b16 a[194:195], v246 offset:22528
  ds_read_b64_tr_b16 a[196:197], v246 offset:26624
  v_mfma_f32_16x16x32_bf16 v[52:55], a[200:203], a[4:7], v[52:55]
  ds_read_b64_tr_b16 a[198:199], v246 offset:30720
  s_waitcnt lgkmcnt(12)
  v_mfma_f32_16x16x32_bf16 v[60:63], a[208:211], a[4:7], v[60:63]
  ds_read_b64_tr_b16 a[200:201], v247 offset:18432
  v_xor_b32 v143, 96, v140
  v_mfma_f32_16x16x32_bf16 v[60:63], a[212:215], a[12:15], v[60:63]
  buffer_load_dwordx4 v134, s[24:27], s4 offen offset:1024 lds
  ds_read_b64_tr_b16 a[202:203], v247 offset:22528
  v_mfma_f32_16x16x32_bf16 v[56:59], a[212:215], a[8:11], v[56:59]
  ds_read_b64_tr_b16 a[204:205], v247 offset:26624
  v_add_u32 v255, s28, v0
  v_mfma_f32_16x16x32_bf16 v[56:59], a[208:211], a[0:3], v[56:59]
  ds_read_b64_tr_b16 a[206:207], v247 offset:30720
  s_waitcnt lgkmcnt(12)
  v_mfma_f32_16x16x32_bf16 v[144:147], a[176:179], a[0:3], v[144:147]
  ds_read_b64_tr_b16 a[208:209], v244 offset:32768
  s_lshl_b32 s28, s44, 10
  v_mfma_f32_16x16x32_bf16 v[144:147], a[180:183], a[8:11], v[144:147]
  buffer_load_dwordx4 a[224:227], v137, s[36:39], s5 offen offset:2048 sc1
  ds_read_b64_tr_b16 a[210:211], v244 offset:36864
  v_mfma_f32_16x16x32_bf16 v[148:151], a[180:183], a[12:15], v[148:151]
  ds_read_b64_tr_b16 a[212:213], v244 offset:40960
  s_add_u32 s28, s28, 151552
  v_mfma_f32_16x16x32_bf16 v[148:151], a[176:179], a[4:7], v[148:151]
  ds_read_b64_tr_b16 a[214:215], v244 offset:45056
  s_waitcnt lgkmcnt(12)
  v_mfma_f32_16x16x32_bf16 v[156:159], a[184:187], a[4:7], v[156:159]
  ds_read_b64_tr_b16 a[176:177], v245 offset:32768
  v_add_u32 v129, s28, v0
  v_mfma_f32_16x16x32_bf16 v[156:159], a[188:191], a[12:15], v[156:159]
  buffer_load_dwordx4 v135, s[24:27], s4 offen offset:2048 lds
  ds_read_b64_tr_b16 a[178:179], v245 offset:36864
  v_mfma_f32_16x16x32_bf16 v[152:155], a[188:191], a[8:11], v[152:155]
  ds_read_b64_tr_b16 a[180:181], v245 offset:40960
  v_lshrrev_b32 v130, 4, v128
  v_mfma_f32_16x16x32_bf16 v[152:155], a[184:187], a[0:3], v[152:155]
  ds_read_b64_tr_b16 a[182:183], v245 offset:45056
  s_waitcnt lgkmcnt(12)
  v_mfma_f32_16x16x32_bf16 v[160:163], a[192:195], a[0:3], v[160:163]
  ds_read_b64_tr_b16 a[184:185], v246 offset:32768
  v_lshl_add_u32 v130, v130, 4, s28
  v_mfma_f32_16x16x32_bf16 v[160:163], a[196:199], a[8:11], v[160:163]
  buffer_load_dwordx4 a[228:231], v137, s[36:39], s5 offen offset:3072 sc1
  ds_read_b64_tr_b16 a[186:187], v246 offset:36864
  v_mfma_f32_16x16x32_bf16 v[164:167], a[196:199], a[12:15], v[164:167]
  ds_read_b64_tr_b16 a[188:189], v246 offset:40960
  ds_write_b128 v129, a[248:251]
  v_mfma_f32_16x16x32_bf16 v[164:167], a[192:195], a[4:7], v[164:167]
  ds_read_b64_tr_b16 a[190:191], v246 offset:45056
  s_waitcnt lgkmcnt(13)
  v_mfma_f32_16x16x32_bf16 v[172:175], a[200:203], a[4:7], v[172:175]
  ds_read_b64_tr_b16 a[192:193], v247 offset:32768
  ds_read_b128 v[176:179], v130 offset:768
  v_mfma_f32_16x16x32_bf16 v[172:175], a[204:207], a[12:15], v[172:175]
  buffer_load_dwordx4 v136, s[24:27], s4 offen offset:3072 lds
  s_cmp_eq_u32 s41, 1
  v_mfma_f32_16x16x32_bf16 v[168:171], a[204:207], a[8:11], v[168:171]
  s_cselect_b32 s13, 19, 5
  s_lshl_b32 s5, s13, 11
  v_mfma_f32_16x16x32_bf16 v[168:171], a[200:203], a[0:3], v[168:171]
  ds_read_b64_tr_b16 a[194:195], v247 offset:36864
  s_waitcnt vmcnt(36) lgkmcnt(12)
  v_mfma_f32_16x16x32_bf16 v[32:35], a[208:211], a[16:19], v[32:35]
  ds_read_b64_tr_b16 a[196:197], v247 offset:40960
  ds_read_b64_tr_b16 a[198:199], v247 offset:45056
  v_mfma_f32_16x16x32_bf16 v[32:35], a[212:215], a[24:27], v[32:35]
  ds_read_b64_tr_b16 a[200:201], v244 offset:34816
  buffer_load_dwordx4 a[0:3], v137, s[36:39], s5 offen offset:0 sc1
  v_mfma_f32_16x16x32_bf16 v[36:39], a[212:215], a[28:31], v[36:39]
  s_lshl_b32 s4, s12, 16
  s_add_u32 m0, s74, 16384
  v_mfma_f32_16x16x32_bf16 v[36:39], a[208:211], a[20:23], v[36:39]
  ds_read_b64_tr_b16 a[202:203], v244 offset:38912
  s_waitcnt lgkmcnt(12)
  v_mfma_f32_16x16x32_bf16 v[44:47], a[176:179], a[20:23], v[44:47]
  ds_read_b64_tr_b16 a[204:205], v244 offset:43008
  ds_read_b64_tr_b16 a[206:207], v244 offset:47104
  v_mfma_f32_16x16x32_bf16 v[44:47], a[180:183], a[28:31], v[44:47]
  ds_read_b64_tr_b16 a[208:209], v245 offset:34816
  buffer_load_dwordx4 v133, s[24:27], s4 offen offset:0 lds
  v_mfma_f32_16x16x32_bf16 v[40:43], a[180:183], a[24:27], v[40:43]
  ds_read_b64_tr_b16 a[210:211], v245 offset:38912
  ds_read_b64_tr_b16 a[212:213], v245 offset:43008
  v_mfma_f32_16x16x32_bf16 v[40:43], a[176:179], a[16:19], v[40:43]
  s_waitcnt vmcnt(19) lgkmcnt(12)
  s_barrier
  v_mfma_f32_16x16x32_bf16 v[48:51], a[184:187], a[16:19], v[48:51]
  ds_read_b64_tr_b16 a[214:215], v245 offset:47104
  ds_read_b64_tr_b16 a[176:177], v246 offset:34816
  v_mfma_f32_16x16x32_bf16 v[48:51], a[188:191], a[24:27], v[48:51]
  buffer_load_dwordx4 a[4:7], v137, s[36:39], s5 offen offset:1024 sc1
  ds_read_b64_tr_b16 a[178:179], v246 offset:38912
  v_mfma_f32_16x16x32_bf16 v[52:55], a[188:191], a[28:31], v[52:55]
  ds_read_b64_tr_b16 a[180:181], v246 offset:43008
  ds_read_b128 v[180:183], v130 offset:832
  v_mfma_f32_16x16x32_bf16 v[52:55], a[184:187], a[20:23], v[52:55]
  ds_read_b64_tr_b16 a[182:183], v246 offset:47104
  s_waitcnt lgkmcnt(13)
  v_mfma_f32_16x16x32_bf16 v[60:63], a[192:195], a[20:23], v[60:63]
  ds_read_b64_tr_b16 a[184:185], v247 offset:34816
  ds_read_b128 v[184:187], v130 offset:896
  v_mfma_f32_16x16x32_bf16 v[60:63], a[196:199], a[28:31], v[60:63]
  buffer_load_dwordx4 v134, s[24:27], s4 offen offset:1024 lds
  ds_read_b64_tr_b16 a[186:187], v247 offset:38912
  v_mfma_f32_16x16x32_bf16 v[56:59], a[196:199], a[24:27], v[56:59]
  ds_read_b64_tr_b16 a[188:189], v247 offset:43008
  ds_read_b128 v[188:191], v130 offset:960
  v_mfma_f32_16x16x32_bf16 v[56:59], a[192:195], a[16:19], v[56:59]
  ds_read_b64_tr_b16 a[190:191], v247 offset:47104
  s_waitcnt lgkmcnt(15)
  v_mfma_f32_16x16x32_bf16 v[144:147], a[200:203], a[16:19], v[144:147]
  ds_read_b64_tr_b16 a[192:193], v244 offset:49152
  v_accvgpr_read_b32 v131, a232
  v_mfma_f32_16x16x32_bf16 v[144:147], a[204:207], a[24:27], v[144:147]
  buffer_load_dwordx4 a[8:11], v137, s[36:39], s5 offen offset:2048 sc1
  ds_read_b64_tr_b16 a[194:195], v244 offset:53248
  v_mfma_f32_16x16x32_bf16 v[148:151], a[204:207], a[28:31], v[148:151]
  ds_read_b64_tr_b16 a[196:197], v244 offset:57344
  v_lshlrev_b32 v64, 16, v131
  v_mfma_f32_16x16x32_bf16 v[148:151], a[200:203], a[20:23], v[148:151]
  ds_read_b64_tr_b16 a[198:199], v244 offset:61440
  s_waitcnt lgkmcnt(15)
  v_mfma_f32_16x16x32_bf16 v[156:159], a[208:211], a[20:23], v[156:159]
  ds_read_b64_tr_b16 a[200:201], v245 offset:49152
  v_and_b32 v65, 0xffff0000, v131
  v_mfma_f32_16x16x32_bf16 v[156:159], a[212:215], a[28:31], v[156:159]
  buffer_load_dwordx4 v135, s[24:27], s4 offen offset:2048 lds
  ds_read_b64_tr_b16 a[202:203], v245 offset:53248
  v_mfma_f32_16x16x32_bf16 v[152:155], a[212:215], a[24:27], v[152:155]
  ds_read_b64_tr_b16 a[204:205], v245 offset:57344
  v_accvgpr_read_b32 v131, a233
  v_mfma_f32_16x16x32_bf16 v[152:155], a[208:211], a[16:19], v[152:155]
  ds_read_b64_tr_b16 a[206:207], v245 offset:61440
  s_waitcnt lgkmcnt(14)
  v_mfma_f32_16x16x32_bf16 v[160:163], a[176:179], a[16:19], v[160:163]
  ds_read_b64_tr_b16 a[208:209], v246 offset:49152
  v_lshlrev_b32 v66, 16, v131
  v_mfma_f32_16x16x32_bf16 v[160:163], a[180:183], a[24:27], v[160:163]
  buffer_load_dwordx4 a[12:15], v137, s[36:39], s5 offen offset:3072 sc1
  ds_read_b64_tr_b16 a[210:211], v246 offset:53248
  v_mfma_f32_16x16x32_bf16 v[164:167], a[180:183], a[28:31], v[164:167]
  ds_read_b64_tr_b16 a[212:213], v246 offset:57344
  v_and_b32 v67, 0xffff0000, v131
  v_mfma_f32_16x16x32_bf16 v[164:167], a[176:179], a[20:23], v[164:167]
  ds_read_b64_tr_b16 a[214:215], v246 offset:61440
  s_waitcnt lgkmcnt(12)
  v_mfma_f32_16x16x32_bf16 v[172:175], a[184:187], a[20:23], v[172:175]
  ds_read_b64_tr_b16 a[176:177], v247 offset:49152
  v_accvgpr_read_b32 v131, a234
  v_mfma_f32_16x16x32_bf16 v[172:175], a[188:191], a[28:31], v[172:175]
  buffer_load_dwordx4 v136, s[24:27], s4 offen offset:3072 lds
  s_cmp_eq_u32 s41, 2
  v_mfma_f32_16x16x32_bf16 v[168:171], a[188:191], a[24:27], v[168:171]
  s_cselect_b32 s14, 22, 8
  s_lshl_b32 s5, s14, 11
  v_mfma_f32_16x16x32_bf16 v[168:171], a[184:187], a[16:19], v[168:171]
  ds_read_b64_tr_b16 a[178:179], v247 offset:53248
  s_waitcnt vmcnt(35) lgkmcnt(10)
  v_mfma_f32_16x16x32_bf16 v[32:35], a[192:195], a[32:35], v[32:35]
  ds_read_b64_tr_b16 a[180:181], v247 offset:57344
  ds_read_b64_tr_b16 a[182:183], v247 offset:61440
  v_mfma_f32_16x16x32_bf16 v[32:35], a[196:199], a[40:43], v[32:35]
  ds_read_b64_tr_b16 a[184:185], v244 offset:51200
  buffer_load_dwordx4 a[16:19], v137, s[36:39], s5 offen offset:0 sc1
  v_mfma_f32_16x16x32_bf16 v[36:39], a[196:199], a[44:47], v[36:39]
  s_lshl_b32 s4, s13, 16
  s_add_u32 m0, s74, 32768
  v_mfma_f32_16x16x32_bf16 v[36:39], a[192:195], a[36:39], v[36:39]
  ds_read_b64_tr_b16 a[186:187], v244 offset:55296
  s_waitcnt lgkmcnt(10)
  v_mfma_f32_16x16x32_bf16 v[44:47], a[200:203], a[36:39], v[44:47]
  ds_read_b64_tr_b16 a[188:189], v244 offset:59392
  ds_read_b64_tr_b16 a[190:191], v244 offset:63488
  v_mfma_f32_16x16x32_bf16 v[44:47], a[204:207], a[44:47], v[44:47]
  ds_read_b64_tr_b16 a[192:193], v245 offset:51200
  buffer_load_dwordx4 v133, s[24:27], s4 offen offset:0 lds
  v_mfma_f32_16x16x32_bf16 v[40:43], a[204:207], a[40:43], v[40:43]
  ds_read_b64_tr_b16 a[194:195], v245 offset:55296
  ds_read_b64_tr_b16 a[196:197], v245 offset:59392
  v_mfma_f32_16x16x32_bf16 v[40:43], a[200:203], a[32:35], v[40:43]
  s_waitcnt vmcnt(18) lgkmcnt(11)
  s_barrier
  v_mfma_f32_16x16x32_bf16 v[48:51], a[208:211], a[32:35], v[48:51]
  ds_read_b64_tr_b16 a[198:199], v245 offset:63488
  ds_read_b64_tr_b16 a[200:201], v246 offset:51200
  v_mfma_f32_16x16x32_bf16 v[48:51], a[212:215], a[40:43], v[48:51]
  buffer_load_dwordx4 a[20:23], v137, s[36:39], s5 offen offset:1024 sc1
  ds_read_b64_tr_b16 a[202:203], v246 offset:55296
  v_mfma_f32_16x16x32_bf16 v[52:55], a[212:215], a[44:47], v[52:55]
  ds_read_b64_tr_b16 a[204:205], v246 offset:59392
  v_lshlrev_b32 v68, 16, v131
  v_mfma_f32_16x16x32_bf16 v[52:55], a[208:211], a[36:39], v[52:55]
  ds_read_b64_tr_b16 a[206:207], v246 offset:63488
  s_waitcnt lgkmcnt(12)
  v_mfma_f32_16x16x32_bf16 v[60:63], a[176:179], a[36:39], v[60:63]
  ds_read_b64_tr_b16 a[208:209], v247 offset:51200
  v_and_b32 v69, 0xffff0000, v131
  v_mfma_f32_16x16x32_bf16 v[60:63], a[180:183], a[44:47], v[60:63]
  buffer_load_dwordx4 v134, s[24:27], s4 offen offset:1024 lds
  ds_read_b64_tr_b16 a[210:211], v247 offset:55296
  v_mfma_f32_16x16x32_bf16 v[56:59], a[180:183], a[40:43], v[56:59]
  ds_read_b64_tr_b16 a[212:213], v247 offset:59392
  v_accvgpr_read_b32 v131, a235
  v_mfma_f32_16x16x32_bf16 v[56:59], a[176:179], a[32:35], v[56:59]
  ds_read_b64_tr_b16 a[214:215], v247 offset:63488
  s_waitcnt lgkmcnt(12)
  v_mfma_f32_16x16x32_bf16 v[144:147], a[184:187], a[32:35], v[144:147]
  ds_read_b64_tr_b16 a[176:177], v248 offset:0
  v_lshlrev_b32 v70, 16, v131
  v_mfma_f32_16x16x32_bf16 v[144:147], a[188:191], a[40:43], v[144:147]
  buffer_load_dwordx4 a[24:27], v137, s[36:39], s5 offen offset:2048 sc1
  ds_read_b64_tr_b16 a[178:179], v248 offset:4096
  v_mfma_f32_16x16x32_bf16 v[148:151], a[188:191], a[44:47], v[148:151]
  ds_read_b64_tr_b16 a[180:181], v248 offset:8192
  v_and_b32 v71, 0xffff0000, v131
  v_mfma_f32_16x16x32_bf16 v[148:151], a[184:187], a[36:39], v[148:151]
  ds_read_b64_tr_b16 a[182:183], v248 offset:12288
  s_waitcnt lgkmcnt(12)
  v_mfma_f32_16x16x32_bf16 v[156:159], a[192:195], a[36:39], v[156:159]
  ds_read_b64_tr_b16 a[184:185], v249 offset:0
  v_accvgpr_read_b32 v131, a236
  v_mfma_f32_16x16x32_bf16 v[156:159], a[196:199], a[44:47], v[156:159]
  buffer_load_dwordx4 v135, s[24:27], s4 offen offset:2048 lds
  ds_read_b64_tr_b16 a[186:187], v249 offset:4096
  v_mfma_f32_16x16x32_bf16 v[152:155], a[196:199], a[40:43], v[152:155]
  ds_read_b64_tr_b16 a[188:189], v249 offset:8192
  v_lshlrev_b32 v72, 16, v131
  v_mfma_f32_16x16x32_bf16 v[152:155], a[192:195], a[32:35], v[152:155]
  ds_read_b64_tr_b16 a[190:191], v249 offset:12288
  s_waitcnt lgkmcnt(12)
  v_mfma_f32_16x16x32_bf16 v[160:163], a[200:203], a[32:35], v[160:163]
  ds_read_b64_tr_b16 a[192:193], v250 offset:0
  v_and_b32 v73, 0xffff0000, v131
  v_mfma_f32_16x16x32_bf16 v[160:163], a[204:207], a[40:43], v[160:163]
  buffer_load_dwordx4 a[28:31], v137, s[36:39], s5 offen offset:3072 sc1
  ds_read_b64_tr_b16 a[194:195], v250 offset:4096
  v_mfma_f32_16x16x32_bf16 v[164:167], a[204:207], a[44:47], v[164:167]
  ds_read_b64_tr_b16 a[196:197], v250 offset:8192
  v_accvgpr_read_b32 v131, a237
  v_mfma_f32_16x16x32_bf16 v[164:167], a[200:203], a[36:39], v[164:167]
  ds_read_b64_tr_b16 a[198:199], v250 offset:12288
  s_waitcnt lgkmcnt(12)
  v_mfma_f32_16x16x32_bf16 v[172:175], a[208:211], a[36:39], v[172:175]
  ds_read_b64_tr_b16 a[200:201], v251 offset:0
  v_lshlrev_b32 v74, 16, v131
  v_mfma_f32_16x16x32_bf16 v[172:175], a[212:215], a[44:47], v[172:175]
  buffer_load_dwordx4 v136, s[24:27], s4 offen offset:3072 lds
  s_cmp_eq_u32 s41, 3
  v_mfma_f32_16x16x32_bf16 v[168:171], a[212:215], a[40:43], v[168:171]
  s_cselect_b32 s15, 26, 12
  s_lshl_b32 s5, s15, 11
  v_mfma_f32_16x16x32_bf16 v[168:171], a[208:211], a[32:35], v[168:171]
  ds_read_b64_tr_b16 a[202:203], v251 offset:4096
  s_waitcnt vmcnt(34) lgkmcnt(10)
  v_mfma_f32_16x16x32_bf16 v[32:35], a[176:179], a[48:51], v[32:35]
  ds_read_b64_tr_b16 a[204:205], v251 offset:8192
  ds_read_b64_tr_b16 a[206:207], v251 offset:12288
  v_mfma_f32_16x16x32_bf16 v[32:35], a[180:183], a[56:59], v[32:35]
  ds_read_b64_tr_b16 a[208:209], v248 offset:2048
  buffer_load_dwordx4 a[32:35], v137, s[36:39], s5 offen offset:0 sc1
  v_mfma_f32_16x16x32_bf16 v[36:39], a[180:183], a[60:63], v[36:39]
  s_lshl_b32 s4, s14, 16
  s_add_u32 m0, s74, 49152
  v_mfma_f32_16x16x32_bf16 v[36:39], a[176:179], a[52:55], v[36:39]
  ds_read_b64_tr_b16 a[210:211], v248 offset:6144
  s_waitcnt lgkmcnt(10)
  v_mfma_f32_16x16x32_bf16 v[44:47], a[184:187], a[52:55], v[44:47]
  ds_read_b64_tr_b16 a[212:213], v248 offset:10240
  ds_read_b64_tr_b16 a[214:215], v248 offset:14336
  v_mfma_f32_16x16x32_bf16 v[44:47], a[188:191], a[60:63], v[44:47]
  ds_read_b64_tr_b16 a[176:177], v249 offset:2048
  buffer_load_dwordx4 v133, s[24:27], s4 offen offset:0 lds
  v_mfma_f32_16x16x32_bf16 v[40:43], a[188:191], a[56:59], v[40:43]
  ds_read_b64_tr_b16 a[178:179], v249 offset:6144
  ds_read_b64_tr_b16 a[180:181], v249 offset:10240
  v_mfma_f32_16x16x32_bf16 v[40:43], a[184:187], a[48:51], v[40:43]
  s_waitcnt vmcnt(18) lgkmcnt(11)
  s_barrier
  v_mfma_f32_16x16x32_bf16 v[48:51], a[192:195], a[48:51], v[48:51]
  ds_read_b64_tr_b16 a[182:183], v249 offset:14336
  ds_read_b64_tr_b16 a[184:185], v250 offset:2048
  v_mfma_f32_16x16x32_bf16 v[48:51], a[196:199], a[56:59], v[48:51]
  buffer_load_dwordx4 a[36:39], v137, s[36:39], s5 offen offset:1024 sc1
  ds_read_b64_tr_b16 a[186:187], v250 offset:6144
  v_mfma_f32_16x16x32_bf16 v[52:55], a[196:199], a[60:63], v[52:55]
  ds_read_b64_tr_b16 a[188:189], v250 offset:10240
  v_and_b32 v75, 0xffff0000, v131
  v_mfma_f32_16x16x32_bf16 v[52:55], a[192:195], a[52:55], v[52:55]
  ds_read_b64_tr_b16 a[190:191], v250 offset:14336
  s_waitcnt lgkmcnt(12)
  v_mfma_f32_16x16x32_bf16 v[60:63], a[200:203], a[52:55], v[60:63]
  ds_read_b64_tr_b16 a[192:193], v251 offset:2048
  v_accvgpr_read_b32 v131, a238
  v_mfma_f32_16x16x32_bf16 v[60:63], a[204:207], a[60:63], v[60:63]
  buffer_load_dwordx4 v134, s[24:27], s4 offen offset:1024 lds
  ds_read_b64_tr_b16 a[194:195], v251 offset:6144
  v_mfma_f32_16x16x32_bf16 v[56:59], a[204:207], a[56:59], v[56:59]
  ds_read_b64_tr_b16 a[196:197], v251 offset:10240
  v_lshlrev_b32 v76, 16, v131
  v_mfma_f32_16x16x32_bf16 v[56:59], a[200:203], a[48:51], v[56:59]
  ds_read_b64_tr_b16 a[198:199], v251 offset:14336
  s_waitcnt lgkmcnt(12)
  v_mfma_f32_16x16x32_bf16 v[144:147], a[208:211], a[48:51], v[144:147]
  ds_read_b64_tr_b16 a[200:201], v240 offset:0
  v_and_b32 v77, 0xffff0000, v131
  v_mfma_f32_16x16x32_bf16 v[144:147], a[212:215], a[56:59], v[144:147]
  buffer_load_dwordx4 a[40:43], v137, s[36:39], s5 offen offset:2048 sc1
  ds_read_b64_tr_b16 a[202:203], v240 offset:4096
  v_mfma_f32_16x16x32_bf16 v[148:151], a[212:215], a[60:63], v[148:151]
  ds_read_b64_tr_b16 a[204:205], v240 offset:8192
  v_accvgpr_read_b32 v131, a239
  v_mfma_f32_16x16x32_bf16 v[148:151], a[208:211], a[52:55], v[148:151]
  ds_read_b64_tr_b16 a[206:207], v240 offset:12288
  s_waitcnt lgkmcnt(12)
  v_mfma_f32_16x16x32_bf16 v[156:159], a[176:179], a[52:55], v[156:159]
  ds_read_b64_tr_b16 a[208:209], v241 offset:0
  v_lshlrev_b32 v78, 16, v131
  v_mfma_f32_16x16x32_bf16 v[156:159], a[180:183], a[60:63], v[156:159]
  buffer_load_dwordx4 v135, s[24:27], s4 offen offset:2048 lds
  ds_read_b64_tr_b16 a[210:211], v241 offset:4096
  v_mfma_f32_16x16x32_bf16 v[152:155], a[180:183], a[56:59], v[152:155]
  ds_read_b64_tr_b16 a[212:213], v241 offset:8192
  v_and_b32 v79, 0xffff0000, v131
  v_mfma_f32_16x16x32_bf16 v[152:155], a[176:179], a[48:51], v[152:155]
  ds_read_b64_tr_b16 a[214:215], v241 offset:12288
  s_waitcnt lgkmcnt(12)
  v_mfma_f32_16x16x32_bf16 v[160:163], a[184:187], a[48:51], v[160:163]
  ds_read_b64_tr_b16 a[176:177], v242 offset:0
  v_accvgpr_read_b32 v131, a240
  v_mfma_f32_16x16x32_bf16 v[160:163], a[188:191], a[56:59], v[160:163]
  buffer_load_dwordx4 a[44:47], v137, s[36:39], s5 offen offset:3072 sc1
  ds_read_b64_tr_b16 a[178:179], v242 offset:4096
  v_mfma_f32_16x16x32_bf16 v[164:167], a[188:191], a[60:63], v[164:167]
  ds_read_b64_tr_b16 a[180:181], v242 offset:8192
  v_lshlrev_b32 v80, 16, v131
  v_mfma_f32_16x16x32_bf16 v[164:167], a[184:187], a[52:55], v[164:167]
  ds_read_b64_tr_b16 a[182:183], v242 offset:12288
  s_waitcnt lgkmcnt(12)
  v_mfma_f32_16x16x32_bf16 v[172:175], a[192:195], a[52:55], v[172:175]
  ds_read_b64_tr_b16 a[184:185], v243 offset:0
  v_and_b32 v81, 0xffff0000, v131
  v_mfma_f32_16x16x32_bf16 v[172:175], a[196:199], a[60:63], v[172:175]
  buffer_load_dwordx4 v136, s[24:27], s4 offen offset:3072 lds
  s_cmp_eq_u32 s41, 0
  v_mfma_f32_16x16x32_bf16 v[168:171], a[196:199], a[56:59], v[168:171]
  s_cselect_b32 s6, 29, 15
  s_lshl_b32 s5, s6, 11
  v_mfma_f32_16x16x32_bf16 v[168:171], a[192:195], a[48:51], v[168:171]
  ds_read_b64_tr_b16 a[186:187], v243 offset:4096
  s_waitcnt vmcnt(33) lgkmcnt(10)
  v_mfma_f32_16x16x32_bf16 v[32:35], a[200:203], a[64:67], v[32:35]
  ds_read_b64_tr_b16 a[188:189], v243 offset:8192
  ds_read_b64_tr_b16 a[190:191], v243 offset:12288
  v_mfma_f32_16x16x32_bf16 v[32:35], a[204:207], a[72:75], v[32:35]
  ds_read_b64_tr_b16 a[192:193], v240 offset:2048
  buffer_load_dwordx4 a[48:51], v137, s[36:39], s5 offen offset:0 sc1
  v_mfma_f32_16x16x32_bf16 v[36:39], a[204:207], a[76:79], v[36:39]
  s_lshl_b32 s4, s15, 16
  s_add_u32 m0, s74, 65536
  v_mfma_f32_16x16x32_bf16 v[36:39], a[200:203], a[68:71], v[36:39]
  ds_read_b64_tr_b16 a[194:195], v240 offset:6144
  s_waitcnt lgkmcnt(10)
  v_mfma_f32_16x16x32_bf16 v[44:47], a[208:211], a[68:71], v[44:47]
  ds_read_b64_tr_b16 a[196:197], v240 offset:10240
  ds_read_b64_tr_b16 a[198:199], v240 offset:14336
  v_mfma_f32_16x16x32_bf16 v[44:47], a[212:215], a[76:79], v[44:47]
  ds_read_b64_tr_b16 a[200:201], v241 offset:2048
  buffer_load_dwordx4 v133, s[24:27], s4 offen offset:0 lds
  v_mfma_f32_16x16x32_bf16 v[40:43], a[212:215], a[72:75], v[40:43]
  ds_read_b64_tr_b16 a[202:203], v241 offset:6144
  ds_read_b64_tr_b16 a[204:205], v241 offset:10240
  v_mfma_f32_16x16x32_bf16 v[40:43], a[208:211], a[64:67], v[40:43]
  s_waitcnt vmcnt(18) lgkmcnt(11)
  s_barrier
  v_mfma_f32_16x16x32_bf16 v[48:51], a[176:179], a[64:67], v[48:51]
  ds_read_b64_tr_b16 a[206:207], v241 offset:14336
  ds_read_b64_tr_b16 a[208:209], v242 offset:2048
  v_mfma_f32_16x16x32_bf16 v[48:51], a[180:183], a[72:75], v[48:51]
  buffer_load_dwordx4 a[52:55], v137, s[36:39], s5 offen offset:1024 sc1
  ds_read_b64_tr_b16 a[210:211], v242 offset:6144
  v_mfma_f32_16x16x32_bf16 v[52:55], a[180:183], a[76:79], v[52:55]
  ds_read_b64_tr_b16 a[212:213], v242 offset:10240
  v_accvgpr_read_b32 v131, a241
  v_mfma_f32_16x16x32_bf16 v[52:55], a[176:179], a[68:71], v[52:55]
  ds_read_b64_tr_b16 a[214:215], v242 offset:14336
  s_waitcnt lgkmcnt(12)
  v_mfma_f32_16x16x32_bf16 v[60:63], a[184:187], a[68:71], v[60:63]
  ds_read_b64_tr_b16 a[176:177], v243 offset:2048
  v_lshlrev_b32 v82, 16, v131
  v_mfma_f32_16x16x32_bf16 v[60:63], a[188:191], a[76:79], v[60:63]
  buffer_load_dwordx4 v134, s[24:27], s4 offen offset:1024 lds
  ds_read_b64_tr_b16 a[178:179], v243 offset:6144
  v_mfma_f32_16x16x32_bf16 v[56:59], a[188:191], a[72:75], v[56:59]
  ds_read_b64_tr_b16 a[180:181], v243 offset:10240
  v_and_b32 v83, 0xffff0000, v131
  v_mfma_f32_16x16x32_bf16 v[56:59], a[184:187], a[64:67], v[56:59]
  ds_read_b64_tr_b16 a[182:183], v243 offset:14336
  s_waitcnt lgkmcnt(12)
  v_mfma_f32_16x16x32_bf16 v[144:147], a[192:195], a[64:67], v[144:147]
  ds_read_b64_tr_b16 a[184:185], v240 offset:16384
  v_accvgpr_read_b32 v131, a242
  v_mfma_f32_16x16x32_bf16 v[144:147], a[196:199], a[72:75], v[144:147]
  buffer_load_dwordx4 a[56:59], v137, s[36:39], s5 offen offset:2048 sc1
  ds_read_b64_tr_b16 a[186:187], v240 offset:20480
  v_mfma_f32_16x16x32_bf16 v[148:151], a[196:199], a[76:79], v[148:151]
  ds_read_b64_tr_b16 a[188:189], v240 offset:24576
  v_lshlrev_b32 v84, 16, v131
  v_mfma_f32_16x16x32_bf16 v[148:151], a[192:195], a[68:71], v[148:151]
  ds_read_b64_tr_b16 a[190:191], v240 offset:28672
  s_waitcnt lgkmcnt(12)
  v_mfma_f32_16x16x32_bf16 v[156:159], a[200:203], a[68:71], v[156:159]
  ds_read_b64_tr_b16 a[192:193], v241 offset:16384
  v_and_b32 v85, 0xffff0000, v131
  v_mfma_f32_16x16x32_bf16 v[156:159], a[204:207], a[76:79], v[156:159]
  buffer_load_dwordx4 v135, s[24:27], s4 offen offset:2048 lds
  ds_read_b64_tr_b16 a[194:195], v241 offset:20480
  v_mfma_f32_16x16x32_bf16 v[152:155], a[204:207], a[72:75], v[152:155]
  ds_read_b64_tr_b16 a[196:197], v241 offset:24576
  v_accvgpr_read_b32 v131, a243
  v_mfma_f32_16x16x32_bf16 v[152:155], a[200:203], a[64:67], v[152:155]
  ds_read_b64_tr_b16 a[198:199], v241 offset:28672
  s_waitcnt lgkmcnt(12)
  v_mfma_f32_16x16x32_bf16 v[160:163], a[208:211], a[64:67], v[160:163]
  ds_read_b64_tr_b16 a[200:201], v242 offset:16384
  v_lshlrev_b32 v86, 16, v131
  v_mfma_f32_16x16x32_bf16 v[160:163], a[212:215], a[72:75], v[160:163]
  buffer_load_dwordx4 a[60:63], v137, s[36:39], s5 offen offset:3072 sc1
  ds_read_b64_tr_b16 a[202:203], v242 offset:20480
  v_mfma_f32_16x16x32_bf16 v[164:167], a[212:215], a[76:79], v[164:167]
  ds_read_b64_tr_b16 a[204:205], v242 offset:24576
  v_and_b32 v87, 0xffff0000, v131
  v_mfma_f32_16x16x32_bf16 v[164:167], a[208:211], a[68:71], v[164:167]
  ds_read_b64_tr_b16 a[206:207], v242 offset:28672
  s_waitcnt lgkmcnt(12)
  v_mfma_f32_16x16x32_bf16 v[172:175], a[176:179], a[68:71], v[172:175]
  ds_read_b64_tr_b16 a[208:209], v243 offset:16384
CT26:
  s_add_u32 s94, s92, CT26-k3_main_kernel+3072
  s_addc_u32 s95, s93, 0
  v_mfma_f32_16x16x32_bf16 v[172:175], a[180:183], a[76:79], v[172:175]
  global_load_dword a252, v0, s[94:95]
  ds_read_b64_tr_b16 a[210:211], v243 offset:20480
  v_mfma_f32_16x16x32_bf16 v[168:171], a[180:183], a[72:75], v[168:171]
  ds_read_b64_tr_b16 a[212:213], v243 offset:24576
  v_accvgpr_read_b32 v131, a244
  v_mfma_f32_16x16x32_bf16 v[168:171], a[176:179], a[64:67], v[168:171]
  ds_read_b64_tr_b16 a[214:215], v243 offset:28672
  s_waitcnt vmcnt(33) lgkmcnt(12)
  v_mfma_f32_16x16x32_bf16 v[32:35], a[184:187], a[216:219], v[32:35]
  buffer_load_dwordx4 v136, s[24:27], s4 offen offset:3072 lds
  s_cmp_eq_u32 s41, 1
  v_mfma_f32_16x16x32_bf16 v[32:35], a[188:191], a[224:227], v[32:35]
  s_cselect_b32 s7, 33, 19
  s_lshl_b32 s5, s7, 11
  v_mfma_f32_16x16x32_bf16 v[36:39], a[188:191], a[228:231], v[36:39]
  ds_read_b64_tr_b16 a[176:177], v240 offset:18432
  ds_read_b64_tr_b16 a[178:179], v240 offset:22528
  v_mfma_f32_16x16x32_bf16 v[36:39], a[184:187], a[220:223], v[36:39]
  buffer_load_dwordx4 a[64:67], v137, s[36:39], s5 offen offset:0 sc1
  s_waitcnt lgkmcnt(10)
  v_mfma_f32_16x16x32_bf16 v[44:47], a[192:195], a[220:223], v[44:47]
  s_lshl_b32 s4, s6, 16
  s_add_u32 m0, s74, 81920
  v_mfma_f32_16x16x32_bf16 v[44:47], a[196:199], a[228:231], v[44:47]
  ds_read_b64_tr_b16 a[180:181], v240 offset:26624
  ds_read_b64_tr_b16 a[182:183], v240 offset:30720
  v_mfma_f32_16x16x32_bf16 v[40:43], a[196:199], a[224:227], v[40:43]
  ds_read_b64_tr_b16 a[184:185], v241 offset:18432
  buffer_load_dwordx4 v133, s[24:27], s4 offen offset:0 lds
  v_mfma_f32_16x16x32_bf16 v[40:43], a[192:195], a[216:219], v[40:43]
  s_waitcnt vmcnt(19) lgkmcnt(9)
  s_barrier
  v_mfma_f32_16x16x32_bf16 v[48:51], a[200:203], a[216:219], v[48:51]
  ds_read_b64_tr_b16 a[186:187], v241 offset:22528
  ds_read_b64_tr_b16 a[188:189], v241 offset:26624
  v_mfma_f32_16x16x32_bf16 v[48:51], a[204:207], a[224:227], v[48:51]
  ds_read_b64_tr_b16 a[190:191], v241 offset:30720
  ds_read_b64_tr_b16 a[192:193], v242 offset:18432
  v_mfma_f32_16x16x32_bf16 v[52:55], a[204:207], a[228:231], v[52:55]
  buffer_load_dwordx4 a[68:71], v137, s[36:39], s5 offen offset:1024 sc1
  ds_read_b64_tr_b16 a[194:195], v242 offset:22528
  v_mfma_f32_16x16x32_bf16 v[52:55], a[200:203], a[220:223], v[52:55]
  ds_read_b64_tr_b16 a[196:197], v242 offset:26624
  s_waitcnt lgkmcnt(11)
  v_mfma_f32_16x16x32_bf16 v[60:63], a[208:211], a[220:223], v[60:63]
  ds_read_b64_tr_b16 a[198:199], v242 offset:30720
  ds_read_b64_tr_b16 a[200:201], v243 offset:18432
  v_mfma_f32_16x16x32_bf16 v[60:63], a[212:215], a[228:231], v[60:63]
  buffer_load_dwordx4 v134, s[24:27], s4 offen offset:1024 lds
  ds_read_b64_tr_b16 a[202:203], v243 offset:22528
  v_mfma_f32_16x16x32_bf16 v[56:59], a[212:215], a[224:227], v[56:59]
  ds_read_b64_tr_b16 a[204:205], v243 offset:26624
  v_lshlrev_b32 v88, 16, v131
  v_mfma_f32_16x16x32_bf16 v[56:59], a[208:211], a[216:219], v[56:59]
  ds_read_b64_tr_b16 a[206:207], v243 offset:30720
  s_waitcnt lgkmcnt(12)
  v_mfma_f32_16x16x32_bf16 v[144:147], a[176:179], a[216:219], v[144:147]
  ds_read_b64_tr_b16 a[208:209], v240 offset:32768
  v_and_b32 v89, 0xffff0000, v131
  v_mfma_f32_16x16x32_bf16 v[144:147], a[180:183], a[224:227], v[144:147]
  buffer_load_dwordx4 a[72:75], v137, s[36:39], s5 offen offset:2048 sc1
  ds_read_b64_tr_b16 a[210:211], v240 offset:36864
  v_mfma_f32_16x16x32_bf16 v[148:151], a[180:183], a[228:231], v[148:151]
  ds_read_b64_tr_b16 a[212:213], v240 offset:40960
  v_accvgpr_read_b32 v131, a245
  v_mfma_f32_16x16x32_bf16 v[148:151], a[176:179], a[220:223], v[148:151]
  ds_read_b64_tr_b16 a[214:215], v240 offset:45056
  s_waitcnt lgkmcnt(12)
  v_mfma_f32_16x16x32_bf16 v[156:159], a[184:187], a[220:223], v[156:159]
  ds_read_b64_tr_b16 a[176:177], v241 offset:32768
  v_lshlrev_b32 v90, 16, v131
  v_mfma_f32_16x16x32_bf16 v[156:159], a[188:191], a[228:231], v[156:159]
  buffer_load_dwordx4 v135, s[24:27], s4 offen offset:2048 lds
  ds_read_b64_tr_b16 a[178:179], v241 offset:36864
  v_mfma_f32_16x16x32_bf16 v[152:155], a[188:191], a[224:227], v[152:155]
  ds_read_b64_tr_b16 a[180:181], v241 offset:40960
  v_and_b32 v91, 0xffff0000, v131
  v_mfma_f32_16x16x32_bf16 v[152:155], a[184:187], a[216:219], v[152:155]
  ds_read_b64_tr_b16 a[182:183], v241 offset:45056
  s_waitcnt lgkmcnt(12)
  v_mfma_f32_16x16x32_bf16 v[160:163], a[192:195], a[216:219], v[160:163]
  ds_read_b64_tr_b16 a[184:185], v242 offset:32768
  v_accvgpr_read_b32 v131, a246
  v_mfma_f32_16x16x32_bf16 v[160:163], a[196:199], a[224:227], v[160:163]
  buffer_load_dwordx4 a[76:79], v137, s[36:39], s5 offen offset:3072 sc1
  ds_read_b64_tr_b16 a[186:187], v242 offset:36864
  v_mfma_f32_16x16x32_bf16 v[164:167], a[196:199], a[228:231], v[164:167]
  ds_read_b64_tr_b16 a[188:189], v242 offset:40960
  v_lshlrev_b32 v92, 16, v131
  v_mfma_f32_16x16x32_bf16 v[164:167], a[192:195], a[220:223], v[164:167]
  ds_read_b64_tr_b16 a[190:191], v242 offset:45056
  s_waitcnt lgkmcnt(12)
  v_mfma_f32_16x16x32_bf16 v[172:175], a[200:203], a[220:223], v[172:175]
  ds_read_b64_tr_b16 a[192:193], v243 offset:32768
  v_and_b32 v93, 0xffff0000, v131
  v_mfma_f32_16x16x32_bf16 v[172:175], a[204:207], a[228:231], v[172:175]
  buffer_load_dwordx4 v136, s[24:27], s4 offen offset:3072 lds
  s_cmp_eq_u32 s41, 2
  v_mfma_f32_16x16x32_bf16 v[168:171], a[204:207], a[224:227], v[168:171]
  s_cselect_b32 s8, 36, 22
  s_lshl_b32 s5, s8, 11
  v_mfma_f32_16x16x32_bf16 v[168:171], a[200:203], a[216:219], v[168:171]
  ds_read_b64_tr_b16 a[194:195], v243 offset:36864
  s_waitcnt vmcnt(34) lgkmcnt(10)
  v_mfma_f32_16x16x32_bf16 v[32:35], a[208:211], a[0:3], v[32:35]
  ds_read_b64_tr_b16 a[196:197], v243 offset:40960
  ds_read_b64_tr_b16 a[198:199], v243 offset:45056
  v_mfma_f32_16x16x32_bf16 v[32:35], a[212:215], a[8:11], v[32:35]
  ds_read_b64_tr_b16 a[200:201], v240 offset:34816
  buffer_load_dwordx4 a[216:219], v137, s[36:39], s5 offen offset:0 sc1
  v_mfma_f32_16x16x32_bf16 v[36:39], a[212:215], a[12:15], v[36:39]
  s_lshl_b32 s4, s7, 16
  s_add_u32 m0, s74, 98304
  v_mfma_f32_16x16x32_bf16 v[36:39], a[208:211], a[4:7], v[36:39]
  ds_read_b64_tr_b16 a[202:203], v240 offset:38912
  s_waitcnt lgkmcnt(10)
  v_mfma_f32_16x16x32_bf16 v[44:47], a[176:179], a[4:7], v[44:47]
  ds_read_b64_tr_b16 a[204:205], v240 offset:43008
  ds_read_b64_tr_b16 a[206:207], v240 offset:47104
  v_mfma_f32_16x16x32_bf16 v[44:47], a[180:183], a[12:15], v[44:47]
  ds_read_b64_tr_b16 a[208:209], v241 offset:34816
  buffer_load_dwordx4 v133, s[24:27], s4 offen offset:0 lds
  v_mfma_f32_16x16x32_bf16 v[40:43], a[180:183], a[8:11], v[40:43]
  ds_read_b64_tr_b16 a[210:211], v241 offset:38912
  ds_read_b64_tr_b16 a[212:213], v241 offset:43008
  v_mfma_f32_16x16x32_bf16 v[40:43], a[176:179], a[0:3], v[40:43]
  s_waitcnt vmcnt(19) lgkmcnt(11)
  s_barrier
  v_mfma_f32_16x16x32_bf16 v[48:51], a[184:187], a[0:3], v[48:51]
  ds_read_b64_tr_b16 a[214:215], v241 offset:47104
  ds_read_b64_tr_b16 a[176:177], v242 offset:34816
  v_mfma_f32_16x16x32_bf16 v[48:51], a[188:191], a[8:11], v[48:51]
  buffer_load_dwordx4 a[220:223], v137, s[36:39], s5 offen offset:1024 sc1
  ds_read_b64_tr_b16 a[178:179], v242 offset:38912
  v_mfma_f32_16x16x32_bf16 v[52:55], a[188:191], a[12:15], v[52:55]
  ds_read_b64_tr_b16 a[180:181], v242 offset:43008
  v_accvgpr_read_b32 v131, a247
  v_mfma_f32_16x16x32_bf16 v[52:55], a[184:187], a[4:7], v[52:55]
  ds_read_b64_tr_b16 a[182:183], v242 offset:47104
  s_waitcnt lgkmcnt(12)
  v_mfma_f32_16x16x32_bf16 v[60:63], a[192:195], a[4:7], v[60:63]
  ds_read_b64_tr_b16 a[184:185], v243 offset:34816
  v_lshlrev_b32 v94, 16, v131
  v_mfma_f32_16x16x32_bf16 v[60:63], a[196:199], a[12:15], v[60:63]
  buffer_load_dwordx4 v134, s[24:27], s4 offen offset:1024 lds
  ds_read_b64_tr_b16 a[186:187], v243 offset:38912
  v_mfma_f32_16x16x32_bf16 v[56:59], a[196:199], a[8:11], v[56:59]
  ds_read_b64_tr_b16 a[188:189], v243 offset:43008
  v_and_b32 v95, 0xffff0000, v131
  v_mfma_f32_16x16x32_bf16 v[56:59], a[192:195], a[0:3], v[56:59]
  ds_read_b64_tr_b16 a[190:191], v243 offset:47104
  s_waitcnt lgkmcnt(12)
  v_mfma_f32_16x16x32_bf16 v[144:147], a[200:203], a[0:3], v[144:147]
  ds_read_b64_tr_b16 a[192:193], v240 offset:49152
  s_lshl_b32 s50, s2, 15
  v_mfma_f32_16x16x32_bf16 v[144:147], a[204:207], a[8:11], v[144:147]
  buffer_load_dwordx4 a[224:227], v137, s[36:39], s5 offen offset:2048 sc1
  ds_read_b64_tr_b16 a[194:195], v240 offset:53248
  v_mfma_f32_16x16x32_bf16 v[148:151], a[204:207], a[12:15], v[148:151]
  ds_read_b64_tr_b16 a[196:197], v240 offset:57344
  s_lshl1_add_u32 s50, s74, s50
  v_mfma_f32_16x16x32_bf16 v[148:151], a[200:203], a[4:7], v[148:151]
  ds_read_b64_tr_b16 a[198:199], v240 offset:61440
  s_waitcnt lgkmcnt(12)
  v_mfma_f32_16x16x32_bf16 v[156:159], a[208:211], a[4:7], v[156:159]
  ds_read_b64_tr_b16 a[200:201], v241 offset:49152
  s_xor_b32 s52, s50, 32768
  v_mfma_f32_16x16x32_bf16 v[156:159], a[212:215], a[12:15], v[156:159]
  buffer_load_dwordx4 v135, s[24:27], s4 offen offset:2048 lds
  ds_read_b64_tr_b16 a[202:203], v241 offset:53248
  v_mfma_f32_16x16x32_bf16 v[152:155], a[212:215], a[8:11], v[152:155]
  ds_read_b64_tr_b16 a[204:205], v241 offset:57344
  s_add_u32 s50, s50, 41943040
  v_mfma_f32_16x16x32_bf16 v[152:155], a[208:211], a[0:3], v[152:155]
  ds_read_b64_tr_b16 a[206:207], v241 offset:61440
  s_waitcnt lgkmcnt(12)
  v_mfma_f32_16x16x32_bf16 v[160:163], a[176:179], a[0:3], v[160:163]
  ds_read_b64_tr_b16 a[208:209], v242 offset:49152
  s_add_u32 s51, s50, 4096
  v_mfma_f32_16x16x32_bf16 v[160:163], a[180:183], a[8:11], v[160:163]
  buffer_load_dwordx4 a[228:231], v137, s[36:39], s5 offen offset:3072 sc1
  ds_read_b64_tr_b16 a[210:211], v242 offset:53248
  v_mfma_f32_16x16x32_bf16 v[164:167], a[180:183], a[12:15], v[164:167]
  ds_read_b64_tr_b16 a[212:213], v242 offset:57344
  s_add_u32 s52, s52, 41943040
  v_mfma_f32_16x16x32_bf16 v[164:167], a[176:179], a[4:7], v[164:167]
  ds_read_b64_tr_b16 a[214:215], v242 offset:61440
  s_waitcnt lgkmcnt(12)
  v_mfma_f32_16x16x32_bf16 v[172:175], a[184:187], a[4:7], v[172:175]
  ds_read_b64_tr_b16 a[176:177], v243 offset:49152
  s_add_u32 s53, s52, 4096
  v_mfma_f32_16x16x32_bf16 v[172:175], a[188:191], a[12:15], v[172:175]
  buffer_load_dwordx4 v136, s[24:27], s4 offen offset:3072 lds
  s_cmp_eq_u32 s41, 3
  v_mfma_f32_16x16x32_bf16 v[168:171], a[188:191], a[8:11], v[168:171]
  s_cselect_b32 s9, 40, 26
  s_lshl_b32 s5, s9, 11
  v_mfma_f32_16x16x32_bf16 v[168:171], a[184:187], a[0:3], v[168:171]
  ds_read_b64_tr_b16 a[178:179], v243 offset:53248
  s_waitcnt vmcnt(34) lgkmcnt(10)
  v_mfma_f32_16x16x32_bf16 v[32:35], a[192:195], a[16:19], v[32:35]
  ds_read_b64_tr_b16 a[180:181], v243 offset:57344
  ds_read_b64_tr_b16 a[182:183], v243 offset:61440
  v_mfma_f32_16x16x32_bf16 v[32:35], a[196:199], a[24:27], v[32:35]
  ds_read_b64_tr_b16 a[184:185], v240 offset:51200
  buffer_load_dwordx4 a[0:3], v137, s[36:39], s5 offen offset:0 sc1
  v_mfma_f32_16x16x32_bf16 v[36:39], a[196:199], a[28:31], v[36:39]
  s_lshl_b32 s4, s8, 16
  s_add_u32 m0, s74, 114688
  v_mfma_f32_16x16x32_bf16 v[36:39], a[192:195], a[20:23], v[36:39]
  ds_read_b64_tr_b16 a[186:187], v240 offset:55296
  s_waitcnt lgkmcnt(10)
  v_mfma_f32_16x16x32_bf16 v[44:47], a[200:203], a[20:23], v[44:47]
  ds_read_b64_tr_b16 a[188:189], v240 offset:59392
  ds_read_b64_tr_b16 a[190:191], v240 offset:63488
  v_mfma_f32_16x16x32_bf16 v[44:47], a[204:207], a[28:31], v[44:47]
  ds_read_b64_tr_b16 a[192:193], v241 offset:51200
  buffer_load_dwordx4 v133, s[24:27], s4 offen offset:0 lds
  v_mfma_f32_16x16x32_bf16 v[40:43], a[204:207], a[24:27], v[40:43]
  ds_read_b64_tr_b16 a[194:195], v241 offset:55296
  ds_read_b64_tr_b16 a[196:197], v241 offset:59392
  v_mfma_f32_16x16x32_bf16 v[40:43], a[200:203], a[16:19], v[40:43]
  s_waitcnt vmcnt(18) lgkmcnt(11)
  s_barrier
  v_mfma_f32_16x16x32_bf16 v[48:51], a[208:211], a[16:19], v[48:51]
  ds_read_b64_tr_b16 a[198:199], v241 offset:63488
  ds_read_b64_tr_b16 a[200:201], v242 offset:51200
  v_mfma_f32_16x16x32_bf16 v[48:51], a[212:215], a[24:27], v[48:51]
  buffer_load_dwordx4 a[4:7], v137, s[36:39], s5 offen offset:1024 sc1
  ds_read_b64_tr_b16 a[202:203], v242 offset:55296
  v_mfma_f32_16x16x32_bf16 v[52:55], a[212:215], a[28:31], v[52:55]
  ds_read_b64_tr_b16 a[204:205], v242 offset:59392
  s_xor_b32 s28, s2, 1
  v_mfma_f32_16x16x32_bf16 v[52:55], a[208:211], a[20:23], v[52:55]
  ds_read_b64_tr_b16 a[206:207], v242 offset:63488
  s_waitcnt lgkmcnt(12)
  v_mfma_f32_16x16x32_bf16 v[60:63], a[176:179], a[20:23], v[60:63]
  ds_read_b64_tr_b16 a[208:209], v243 offset:51200
  s_lshl_b32 s28, s28, 7
  v_mfma_f32_16x16x32_bf16 v[60:63], a[180:183], a[28:31], v[60:63]
  buffer_load_dwordx4 v134, s[24:27], s4 offen offset:1024 lds
  ds_read_b64_tr_b16 a[210:211], v243 offset:55296
  v_mfma_f32_16x16x32_bf16 v[56:59], a[180:183], a[24:27], v[56:59]
  ds_read_b64_tr_b16 a[212:213], v243 offset:59392
  v_mov_b32 v132, s28
  v_mfma_f32_16x16x32_bf16 v[56:59], a[176:179], a[16:19], v[56:59]
  ds_read_b64_tr_b16 a[214:215], v243 offset:63488
  s_waitcnt lgkmcnt(12)
  v_mfma_f32_16x16x32_bf16 v[144:147], a[184:187], a[16:19], v[144:147]
  ds_read_b64_tr_b16 a[176:177], v244 offset:0
  s_add_u32 s49, s73, 32768
  v_mfma_f32_16x16x32_bf16 v[144:147], a[188:191], a[24:27], v[144:147]
  buffer_load_dwordx4 a[8:11], v137, s[36:39], s5 offen offset:2048 sc1
  ds_read_b64_tr_b16 a[178:179], v244 offset:4096
  v_mfma_f32_16x16x32_bf16 v[148:151], a[188:191], a[28:31], v[148:151]
  ds_read_b64_tr_b16 a[180:181], v244 offset:8192
  s_mov_b32 s29, 5472256
  v_mfma_f32_16x16x32_bf16 v[148:151], a[184:187], a[20:23], v[148:151]
  ds_read_b64_tr_b16 a[182:183], v244 offset:12288
  s_waitcnt lgkmcnt(12)
  v_mfma_f32_16x16x32_bf16 v[156:159], a[192:195], a[20:23], v[156:159]
  ds_read_b64_tr_b16 a[184:185], v245 offset:0
  v_mfma_f32_16x16x32_bf16 v[156:159], a[196:199], a[28:31], v[156:159]
  buffer_load_dwordx4 v135, s[24:27], s4 offen offset:2048 lds
  ds_read_b64_tr_b16 a[186:187], v245 offset:4096
  v_mfma_f32_16x16x32_bf16 v[152:155], a[196:199], a[24:27], v[152:155]
  ds_read_b64_tr_b16 a[188:189], v245 offset:8192
  v_mfma_f32_16x16x32_bf16 v[152:155], a[192:195], a[16:19], v[152:155]
  ds_read_b64_tr_b16 a[190:191], v245 offset:12288
  s_waitcnt lgkmcnt(12)
  v_mfma_f32_16x16x32_bf16 v[160:163], a[200:203], a[16:19], v[160:163]
  ds_read_b64_tr_b16 a[192:193], v246 offset:0
  v_mfma_f32_16x16x32_bf16 v[160:163], a[204:207], a[24:27], v[160:163]
  buffer_load_dwordx4 a[12:15], v137, s[36:39], s5 offen offset:3072 sc1
  ds_read_b64_tr_b16 a[194:195], v246 offset:4096
  v_mfma_f32_16x16x32_bf16 v[164:167], a[204:207], a[28:31], v[164:167]
  ds_read_b64_tr_b16 a[196:197], v246 offset:8192
  v_mfma_f32_16x16x32_bf16 v[164:167], a[200:203], a[20:23], v[164:167]
  ds_read_b64_tr_b16 a[198:199], v246 offset:12288
  s_waitcnt lgkmcnt(12)
  v_mfma_f32_16x16x32_bf16 v[172:175], a[208:211], a[20:23], v[172:175]
  ds_read_b64_tr_b16 a[200:201], v247 offset:0
  v_mfma_f32_16x16x32_bf16 v[172:175], a[212:215], a[28:31], v[172:175]
  buffer_load_dwordx4 v136, s[24:27], s4 offen offset:3072 lds
  s_cmp_eq_u32 s41, 0
  v_mfma_f32_16x16x32_bf16 v[168:171], a[212:215], a[24:27], v[168:171]
  s_cselect_b32 s12, 43, 29
  s_lshl_b32 s5, s12, 11
  v_mfma_f32_16x16x32_bf16 v[168:171], a[208:211], a[16:19], v[168:171]
  ds_read_b64_tr_b16 a[202:203], v247 offset:4096
  s_waitcnt vmcnt(34) lgkmcnt(10)
  v_mfma_f32_16x16x32_bf16 v[32:35], a[176:179], a[32:35], v[32:35]
  ds_read_b64_tr_b16 a[204:205], v247 offset:8192
  ds_read_b64_tr_b16 a[206:207], v247 offset:12288
  v_mfma_f32_16x16x32_bf16 v[32:35], a[180:183], a[40:43], v[32:35]
  ds_read_b64_tr_b16 a[208:209], v244 offset:2048
  buffer_load_dwordx4 a[16:19], v137, s[36:39], s5 offen offset:0 sc1
  v_mfma_f32_16x16x32_bf16 v[36:39], a[180:183], a[44:47], v[36:39]
  s_lshl_b32 s4, s9, 16
  s_add_u32 m0, s74, 131072
  v_mfma_f32_16x16x32_bf16 v[36:39], a[176:179], a[36:39], v[36:39]
  ds_read_b64_tr_b16 a[210:211], v244 offset:6144
  s_waitcnt lgkmcnt(10)
  v_mfma_f32_16x16x32_bf16 v[44:47], a[184:187], a[36:39], v[44:47]
  ds_read_b64_tr_b16 a[212:213], v244 offset:10240
  ds_read_b64_tr_b16 a[214:215], v244 offset:14336
  v_mfma_f32_16x16x32_bf16 v[44:47], a[188:191], a[44:47], v[44:47]
  ds_read_b64_tr_b16 a[176:177], v245 offset:2048
  buffer_load_dwordx4 v133, s[24:27], s4 offen offset:0 lds
  v_mfma_f32_16x16x32_bf16 v[40:43], a[188:191], a[40:43], v[40:43]
  ds_read_b64_tr_b16 a[178:179], v245 offset:6144
  ds_read_b64_tr_b16 a[180:181], v245 offset:10240
  v_mfma_f32_16x16x32_bf16 v[40:43], a[184:187], a[32:35], v[40:43]
  s_waitcnt vmcnt(18) lgkmcnt(11)
  s_barrier
  v_mfma_f32_16x16x32_bf16 v[48:51], a[192:195], a[32:35], v[48:51]
  ds_read_b64_tr_b16 a[182:183], v245 offset:14336
  ds_read_b64_tr_b16 a[184:185], v246 offset:2048
  v_mfma_f32_16x16x32_bf16 v[48:51], a[196:199], a[40:43], v[48:51]
  buffer_load_dwordx4 a[20:23], v137, s[36:39], s5 offen offset:1024 sc1
  ds_read_b64_tr_b16 a[186:187], v246 offset:6144
  v_mfma_f32_16x16x32_bf16 v[52:55], a[196:199], a[44:47], v[52:55]
  ds_read_b64_tr_b16 a[188:189], v246 offset:10240
  v_mfma_f32_16x16x32_bf16 v[52:55], a[192:195], a[36:39], v[52:55]
  ds_read_b64_tr_b16 a[190:191], v246 offset:14336
  s_waitcnt lgkmcnt(12)
  v_mfma_f32_16x16x32_bf16 v[60:63], a[200:203], a[36:39], v[60:63]
  ds_read_b64_tr_b16 a[192:193], v247 offset:2048
  v_mfma_f32_16x16x32_bf16 v[60:63], a[204:207], a[44:47], v[60:63]
  buffer_load_dwordx4 v134, s[24:27], s4 offen offset:1024 lds
  ds_read_b64_tr_b16 a[194:195], v247 offset:6144
  v_mfma_f32_16x16x32_bf16 v[56:59], a[204:207], a[40:43], v[56:59]
  ds_read_b64_tr_b16 a[196:197], v247 offset:10240
  v_mfma_f32_16x16x32_bf16 v[56:59], a[200:203], a[32:35], v[56:59]
  ds_read_b64_tr_b16 a[198:199], v247 offset:14336
  s_waitcnt lgkmcnt(12)
  v_mfma_f32_16x16x32_bf16 v[144:147], a[208:211], a[32:35], v[144:147]
  ds_read_b64_tr_b16 a[200:201], v244 offset:16384
  v_mfma_f32_16x16x32_bf16 v[144:147], a[212:215], a[40:43], v[144:147]
  buffer_load_dwordx4 a[24:27], v137, s[36:39], s5 offen offset:2048 sc1
  ds_read_b64_tr_b16 a[202:203], v244 offset:20480
  v_mfma_f32_16x16x32_bf16 v[148:151], a[212:215], a[44:47], v[148:151]
  ds_read_b64_tr_b16 a[204:205], v244 offset:24576
  v_mfma_f32_16x16x32_bf16 v[148:151], a[208:211], a[36:39], v[148:151]
  ds_read_b64_tr_b16 a[206:207], v244 offset:28672
  s_waitcnt lgkmcnt(12)
  v_mfma_f32_16x16x32_bf16 v[156:159], a[176:179], a[36:39], v[156:159]
  ds_read_b64_tr_b16 a[208:209], v245 offset:16384
  v_mfma_f32_16x16x32_bf16 v[156:159], a[180:183], a[44:47], v[156:159]
  buffer_load_dwordx4 v135, s[24:27], s4 offen offset:2048 lds
  ds_read_b64_tr_b16 a[210:211], v245 offset:20480
  v_mfma_f32_16x16x32_bf16 v[152:155], a[180:183], a[40:43], v[152:155]
  ds_read_b64_tr_b16 a[212:213], v245 offset:24576
  v_mfma_f32_16x16x32_bf16 v[152:155], a[176:179], a[32:35], v[152:155]
  ds_read_b64_tr_b16 a[214:215], v245 offset:28672
  s_waitcnt lgkmcnt(12)
  v_mfma_f32_16x16x32_bf16 v[160:163], a[184:187], a[32:35], v[160:163]
  ds_read_b64_tr_b16 a[176:177], v246 offset:16384
  v_mfma_f32_16x16x32_bf16 v[160:163], a[188:191], a[40:43], v[160:163]
  buffer_load_dwordx4 a[28:31], v137, s[36:39], s5 offen offset:3072 sc1
  ds_read_b64_tr_b16 a[178:179], v246 offset:20480
  v_mfma_f32_16x16x32_bf16 v[164:167], a[188:191], a[44:47], v[164:167]
  ds_read_b64_tr_b16 a[180:181], v246 offset:24576
  v_mfma_f32_16x16x32_bf16 v[164:167], a[184:187], a[36:39], v[164:167]
  ds_read_b64_tr_b16 a[182:183], v246 offset:28672
  s_waitcnt lgkmcnt(12)
  v_mfma_f32_16x16x32_bf16 v[172:175], a[192:195], a[36:39], v[172:175]
  ds_read_b64_tr_b16 a[184:185], v247 offset:16384
  v_mfma_f32_16x16x32_bf16 v[172:175], a[196:199], a[44:47], v[172:175]
  buffer_load_dwordx4 v136, s[24:27], s4 offen offset:3072 lds
  s_cmp_eq_u32 s41, 1
  v_mfma_f32_16x16x32_bf16 v[168:171], a[196:199], a[40:43], v[168:171]
  s_cselect_b32 s13, 47, 33
  s_lshl_b32 s5, s13, 11
  v_mfma_f32_16x16x32_bf16 v[168:171], a[192:195], a[32:35], v[168:171]
  ds_read_b64_tr_b16 a[186:187], v247 offset:20480
  s_waitcnt vmcnt(34) lgkmcnt(10)
  v_mfma_f32_16x16x32_bf16 v[32:35], a[200:203], a[48:51], v[32:35]
  ds_read_b64_tr_b16 a[188:189], v247 offset:24576
  ds_read_b64_tr_b16 a[190:191], v247 offset:28672
  v_mfma_f32_16x16x32_bf16 v[32:35], a[204:207], a[56:59], v[32:35]
  ds_read_b64_tr_b16 a[192:193], v244 offset:18432
  buffer_load_dwordx4 a[32:35], v137, s[36:39], s5 offen offset:0 sc1
  v_mfma_f32_16x16x32_bf16 v[36:39], a[204:207], a[60:63], v[36:39]
  s_lshl_b32 s4, s12, 16
  s_add_u32 m0, s74, 0
  v_mfma_f32_16x16x32_bf16 v[36:39], a[200:203], a[52:55], v[36:39]
  ds_read_b64_tr_b16 a[194:195], v244 offset:22528
  s_waitcnt lgkmcnt(10)
  v_mfma_f32_16x16x32_bf16 v[44:47], a[208:211], a[52:55], v[44:47]
  ds_read_b64_tr_b16 a[196:197], v244 offset:26624
  ds_read_b64_tr_b16 a[198:199], v244 offset:30720
  v_mfma_f32_16x16x32_bf16 v[44:47], a[212:215], a[60:63], v[44:47]
  ds_read_b64_tr_b16 a[200:201], v245 offset:18432
  buffer_load_dwordx4 v133, s[24:27], s4 offen offset:0 lds
  v_mfma_f32_16x16x32_bf16 v[40:43], a[212:215], a[56:59], v[40:43]
  ds_read_b64_tr_b16 a[202:203], v245 offset:22528
  ds_read_b64_tr_b16 a[204:205], v245 offset:26624
  v_mfma_f32_16x16x32_bf16 v[40:43], a[208:211], a[48:51], v[40:43]
  s_waitcnt vmcnt(18) lgkmcnt(11)
  s_barrier
  v_mfma_f32_16x16x32_bf16 v[48:51], a[176:179], a[48:51], v[48:51]
  ds_read_b64_tr_b16 a[206:207], v245 offset:30720
  ds_read_b64_tr_b16 a[208:209], v246 offset:18432
  v_mfma_f32_16x16x32_bf16 v[48:51], a[180:183], a[56:59], v[48:51]
  buffer_load_dwordx4 a[36:39], v137, s[36:39], s5 offen offset:1024 sc1
  ds_read_b64_tr_b16 a[210:211], v246 offset:22528
  v_mfma_f32_16x16x32_bf16 v[52:55], a[180:183], a[60:63], v[52:55]
  ds_read_b64_tr_b16 a[212:213], v246 offset:26624
  v_mfma_f32_16x16x32_bf16 v[52:55], a[176:179], a[52:55], v[52:55]
  ds_read_b64_tr_b16 a[214:215], v246 offset:30720
  s_waitcnt lgkmcnt(12)
  v_mfma_f32_16x16x32_bf16 v[60:63], a[184:187], a[52:55], v[60:63]
  ds_read_b64_tr_b16 a[176:177], v247 offset:18432
  v_mfma_f32_16x16x32_bf16 v[60:63], a[188:191], a[60:63], v[60:63]
  buffer_load_dwordx4 v134, s[24:27], s4 offen offset:1024 lds
  ds_read_b64_tr_b16 a[178:179], v247 offset:22528
  v_mfma_f32_16x16x32_bf16 v[56:59], a[188:191], a[56:59], v[56:59]
  ds_read_b64_tr_b16 a[180:181], v247 offset:26624
  v_mfma_f32_16x16x32_bf16 v[56:59], a[184:187], a[48:51], v[56:59]
  ds_read_b64_tr_b16 a[182:183], v247 offset:30720
  s_waitcnt lgkmcnt(12)
  v_mfma_f32_16x16x32_bf16 v[144:147], a[192:195], a[48:51], v[144:147]
  ds_read_b64_tr_b16 a[184:185], v244 offset:32768
  v_mfma_f32_16x16x32_bf16 v[144:147], a[196:199], a[56:59], v[144:147]
  buffer_load_dwordx4 a[40:43], v137, s[36:39], s5 offen offset:2048 sc1
  ds_read_b64_tr_b16 a[186:187], v244 offset:36864
  v_mfma_f32_16x16x32_bf16 v[148:151], a[196:199], a[60:63], v[148:151]
  ds_read_b64_tr_b16 a[188:189], v244 offset:40960
  v_mfma_f32_16x16x32_bf16 v[148:151], a[192:195], a[52:55], v[148:151]
  ds_read_b64_tr_b16 a[190:191], v244 offset:45056
  s_waitcnt lgkmcnt(12)
  v_mfma_f32_16x16x32_bf16 v[156:159], a[200:203], a[52:55], v[156:159]
  ds_read_b64_tr_b16 a[192:193], v245 offset:32768
  v_mfma_f32_16x16x32_bf16 v[156:159], a[204:207], a[60:63], v[156:159]
  buffer_load_dwordx4 v135, s[24:27], s4 offen offset:2048 lds
  ds_read_b64_tr_b16 a[194:195], v245 offset:36864
  v_mfma_f32_16x16x32_bf16 v[152:155], a[204:207], a[56:59], v[152:155]
  ds_read_b64_tr_b16 a[196:197], v245 offset:40960
  v_mfma_f32_16x16x32_bf16 v[152:155], a[200:203], a[48:51], v[152:155]
  ds_read_b64_tr_b16 a[198:199], v245 offset:45056
  s_waitcnt lgkmcnt(12)
  v_mfma_f32_16x16x32_bf16 v[160:163], a[208:211], a[48:51], v[160:163]
  ds_read_b64_tr_b16 a[200:201], v246 offset:32768
  v_mfma_f32_16x16x32_bf16 v[160:163], a[212:215], a[56:59], v[160:163]
  buffer_load_dwordx4 a[44:47], v137, s[36:39], s5 offen offset:3072 sc1
  ds_read_b64_tr_b16 a[202:203], v246 offset:36864
  v_mfma_f32_16x16x32_bf16 v[164:167], a[212:215], a[60:63], v[164:167]
  ds_read_b64_tr_b16 a[204:205], v246 offset:40960
  v_mfma_f32_16x16x32_bf16 v[164:167], a[208:211], a[52:55], v[164:167]
  ds_read_b64_tr_b16 a[206:207], v246 offset:45056
  s_waitcnt lgkmcnt(12)
  v_mfma_f32_16x16x32_bf16 v[172:175], a[176:179], a[52:55], v[172:175]
  ds_read_b64_tr_b16 a[208:209], v247 offset:32768
  v_mfma_f32_16x16x32_bf16 v[172:175], a[180:183], a[60:63], v[172:175]
  buffer_load_dwordx4 v136, s[24:27], s4 offen offset:3072 lds
  s_cmp_eq_u32 s41, 2
  v_mfma_f32_16x16x32_bf16 v[168:171], a[180:183], a[56:59], v[168:171]
  s_cselect_b32 s14, 50, 36
  s_lshl_b32 s5, s14, 11
  v_mfma_f32_16x16x32_bf16 v[168:171], a[176:179], a[48:51], v[168:171]
  ds_read_b64_tr_b16 a[210:211], v247 offset:36864
  s_waitcnt vmcnt(33) lgkmcnt(10)
  v_mfma_f32_16x16x32_bf16 v[32:35], a[184:187], a[64:67], v[32:35]
  ds_read_b64_tr_b16 a[212:213], v247 offset:40960
  ds_read_b64_tr_b16 a[214:215], v247 offset:45056
  v_mfma_f32_16x16x32_bf16 v[32:35], a[188:191], a[72:75], v[32:35]
  ds_read_b64_tr_b16 a[176:177], v244 offset:34816
  buffer_load_dwordx4 a[48:51], v137, s[36:39], s5 offen offset:0 sc1
  v_mfma_f32_16x16x32_bf16 v[36:39], a[188:191], a[76:79], v[36:39]
  s_lshl_b32 s4, s13, 16
  s_add_u32 m0, s74, 16384
  v_mfma_f32_16x16x32_bf16 v[36:39], a[184:187], a[68:71], v[36:39]
  ds_read_b64_tr_b16 a[178:179], v244 offset:38912
  s_waitcnt lgkmcnt(10)
  v_mfma_f32_16x16x32_bf16 v[44:47], a[192:195], a[68:71], v[44:47]
  ds_read_b64_tr_b16 a[180:181], v244 offset:43008
  ds_read_b64_tr_b16 a[182:183], v244 offset:47104
  v_mfma_f32_16x16x32_bf16 v[44:47], a[196:199], a[76:79], v[44:47]
  ds_read_b64_tr_b16 a[184:185], v245 offset:34816
  buffer_load_dwordx4 v133, s[24:27], s4 offen offset:0 lds
  v_mfma_f32_16x16x32_bf16 v[40:43], a[196:199], a[72:75], v[40:43]
  ds_read_b64_tr_b16 a[186:187], v245 offset:38912
  ds_read_b64_tr_b16 a[188:189], v245 offset:43008
  v_mfma_f32_16x16x32_bf16 v[40:43], a[192:195], a[64:67], v[40:43]
  s_waitcnt vmcnt(18) lgkmcnt(11)
  s_barrier
  v_mfma_f32_16x16x32_bf16 v[48:51], a[200:203], a[64:67], v[48:51]
  ds_read_b64_tr_b16 a[190:191], v245 offset:47104
  ds_read_b64_tr_b16 a[192:193], v246 offset:34816
  v_mfma_f32_16x16x32_bf16 v[48:51], a[204:207], a[72:75], v[48:51]
  buffer_load_dwordx4 a[52:55], v137, s[36:39], s5 offen offset:1024 sc1
  ds_read_b64_tr_b16 a[194:195], v246 offset:38912
  v_mfma_f32_16x16x32_bf16 v[52:55], a[204:207], a[76:79], v[52:55]
  ds_read_b64_tr_b16 a[196:197], v246 offset:43008
  v_mfma_f32_16x16x32_bf16 v[52:55], a[200:203], a[68:71], v[52:55]
  ds_read_b64_tr_b16 a[198:199], v246 offset:47104
  s_waitcnt lgkmcnt(12)
  v_mfma_f32_16x16x32_bf16 v[60:63], a[208:211], a[68:71], v[60:63]
  ds_read_b64_tr_b16 a[200:201], v247 offset:34816
  v_mfma_f32_16x16x32_bf16 v[60:63], a[212:215], a[76:79], v[60:63]
  buffer_load_dwordx4 v134, s[24:27], s4 offen offset:1024 lds
  ds_read_b64_tr_b16 a[202:203], v247 offset:38912
  v_mfma_f32_16x16x32_bf16 v[56:59], a[212:215], a[72:75], v[56:59]
  ds_read_b64_tr_b16 a[204:205], v247 offset:43008
  v_mfma_f32_16x16x32_bf16 v[56:59], a[208:211], a[64:67], v[56:59]
  ds_read_b64_tr_b16 a[206:207], v247 offset:47104
  s_waitcnt lgkmcnt(12)
  v_mfma_f32_16x16x32_bf16 v[144:147], a[176:179], a[64:67], v[144:147]
  ds_read_b64_tr_b16 a[208:209], v244 offset:49152
  v_mfma_f32_16x16x32_bf16 v[144:147], a[180:183], a[72:75], v[144:147]
  buffer_load_dwordx4 a[56:59], v137, s[36:39], s5 offen offset:2048 sc1
  ds_read_b64_tr_b16 a[210:211], v244 offset:53248
  v_mfma_f32_16x16x32_bf16 v[148:151], a[180:183], a[76:79], v[148:151]
  ds_read_b64_tr_b16 a[212:213], v244 offset:57344
  v_mfma_f32_16x16x32_bf16 v[148:151], a[176:179], a[68:71], v[148:151]
  ds_read_b64_tr_b16 a[214:215], v244 offset:61440
  s_waitcnt lgkmcnt(12)
  v_mfma_f32_16x16x32_bf16 v[156:159], a[184:187], a[68:71], v[156:159]
  ds_read_b64_tr_b16 a[176:177], v245 offset:49152
  v_mfma_f32_16x16x32_bf16 v[156:159], a[188:191], a[76:79], v[156:159]
  buffer_load_dwordx4 v135, s[24:27], s4 offen offset:2048 lds
  ds_read_b64_tr_b16 a[178:179], v245 offset:53248
  v_mfma_f32_16x16x32_bf16 v[152:155], a[188:191], a[72:75], v[152:155]
  ds_read_b64_tr_b16 a[180:181], v245 offset:57344
  v_mfma_f32_16x16x32_bf16 v[152:155], a[184:187], a[64:67], v[152:155]
  ds_read_b64_tr_b16 a[182:183], v245 offset:61440
  s_waitcnt lgkmcnt(12)
  v_mfma_f32_16x16x32_bf16 v[160:163], a[192:195], a[64:67], v[160:163]
  ds_read_b64_tr_b16 a[184:185], v246 offset:49152
  v_mfma_f32_16x16x32_bf16 v[160:163], a[196:199], a[72:75], v[160:163]
  buffer_load_dwordx4 a[60:63], v137, s[36:39], s5 offen offset:3072 sc1
  ds_read_b64_tr_b16 a[186:187], v246 offset:53248
  v_mfma_f32_16x16x32_bf16 v[164:167], a[196:199], a[76:79], v[164:167]
  ds_read_b64_tr_b16 a[188:189], v246 offset:57344
CT27:
  s_add_u32 s94, s92, CT27-k3_main_kernel+3072
  s_addc_u32 s95, s93, 0
  v_mfma_f32_16x16x32_bf16 v[164:167], a[192:195], a[68:71], v[164:167]
  ds_read_b64_tr_b16 a[190:191], v246 offset:61440
  s_waitcnt lgkmcnt(12)
  v_mfma_f32_16x16x32_bf16 v[172:175], a[200:203], a[68:71], v[172:175]
  global_load_dword a252, v0, s[94:95]
  ds_read_b64_tr_b16 a[192:193], v247 offset:49152
  v_mfma_f32_16x16x32_bf16 v[172:175], a[204:207], a[76:79], v[172:175]
  ds_read_b64_tr_b16 a[194:195], v247 offset:53248
  v_mfma_f32_16x16x32_bf16 v[168:171], a[204:207], a[72:75], v[168:171]
  ds_read_b64_tr_b16 a[196:197], v247 offset:57344
  v_mfma_f32_16x16x32_bf16 v[168:171], a[200:203], a[64:67], v[168:171]
  buffer_load_dwordx4 v136, s[24:27], s4 offen offset:3072 lds
  s_waitcnt vmcnt(34) lgkmcnt(11)
  v_mfma_f32_16x16x32_bf16 v[32:35], a[208:211], a[216:219], v[32:35]
  s_cmp_eq_u32 s41, 3
  s_cselect_b32 s15, 54, 40
  v_mfma_f32_16x16x32_bf16 v[32:35], a[212:215], a[224:227], v[32:35]
  s_lshl_b32 s5, s15, 11
  ds_read_b64_tr_b16 a[198:199], v247 offset:61440
  v_mfma_f32_16x16x32_bf16 v[36:39], a[212:215], a[228:231], v[36:39]
  ds_read_b64_tr_b16 a[200:201], v244 offset:51200
  buffer_load_dwordx4 a[64:67], v137, s[36:39], s5 offen offset:0 sc1
  v_mfma_f32_16x16x32_bf16 v[36:39], a[208:211], a[220:223], v[36:39]
  s_lshl_b32 s4, s14, 16
  s_waitcnt lgkmcnt(9)
  v_mfma_f32_16x16x32_bf16 v[44:47], a[176:179], a[220:223], v[44:47]
  s_add_u32 m0, s74, 32768
  ds_read_b64_tr_b16 a[202:203], v244 offset:55296
  v_mfma_f32_16x16x32_bf16 v[44:47], a[180:183], a[228:231], v[44:47]
  ds_read_b64_tr_b16 a[204:205], v244 offset:59392
  ds_read_b64_tr_b16 a[206:207], v244 offset:63488
  v_mfma_f32_16x16x32_bf16 v[40:43], a[180:183], a[224:227], v[40:43]
  ds_read_b64_tr_b16 a[208:209], v245 offset:51200
  buffer_load_dwordx4 v133, s[24:27], s4 offen offset:0 lds
  v_mfma_f32_16x16x32_bf16 v[40:43], a[176:179], a[216:219], v[40:43]
  s_waitcnt vmcnt(19) lgkmcnt(9)
  s_barrier
  v_mfma_f32_16x16x32_bf16 v[48:51], a[184:187], a[216:219], v[48:51]
  ds_read_b64_tr_b16 a[210:211], v245 offset:55296
  ds_read_b64_tr_b16 a[212:213], v245 offset:59392
  v_mfma_f32_16x16x32_bf16 v[48:51], a[188:191], a[224:227], v[48:51]
  ds_read_b64_tr_b16 a[214:215], v245 offset:63488
  ds_read_b64_tr_b16 a[176:177], v246 offset:51200
  v_mfma_f32_16x16x32_bf16 v[52:55], a[188:191], a[228:231], v[52:55]
  buffer_load_dwordx4 a[68:71], v137, s[36:39], s5 offen offset:1024 sc1
  ds_read_b64_tr_b16 a[178:179], v246 offset:55296
  v_mfma_f32_16x16x32_bf16 v[52:55], a[184:187], a[220:223], v[52:55]
  ds_read_b64_tr_b16 a[180:181], v246 offset:59392
  s_waitcnt lgkmcnt(11)
  v_mfma_f32_16x16x32_bf16 v[60:63], a[192:195], a[220:223], v[60:63]
  ds_read_b64_tr_b16 a[182:183], v246 offset:63488
  ds_read_b64_tr_b16 a[184:185], v247 offset:51200
  v_mfma_f32_16x16x32_bf16 v[60:63], a[196:199], a[228:231], v[60:63]
  buffer_load_dwordx4 v134, s[24:27], s4 offen offset:1024 lds
  ds_read_b64_tr_b16 a[186:187], v247 offset:55296
  v_mfma_f32_16x16x32_bf16 v[56:59], a[196:199], a[224:227], v[56:59]
  ds_read_b64_tr_b16 a[188:189], v247 offset:59392
  v_mfma_f32_16x16x32_bf16 v[56:59], a[192:195], a[216:219], v[56:59]
  ds_read_b64_tr_b16 a[190:191], v247 offset:63488
  s_waitcnt lgkmcnt(12)
  v_mfma_f32_16x16x32_bf16 v[144:147], a[200:203], a[216:219], v[144:147]
  ds_read_b64_tr_b16 a[192:193], v248 offset:0
  v_mfma_f32_16x16x32_bf16 v[144:147], a[204:207], a[224:227], v[144:147]
  buffer_load_dwordx4 a[72:75], v137, s[36:39], s5 offen offset:2048 sc1
  ds_read_b64_tr_b16 a[194:195], v248 offset:4096
  v_mfma_f32_16x16x32_bf16 v[148:151], a[204:207], a[228:231], v[148:151]
  ds_read_b64_tr_b16 a[196:197], v248 offset:8192
  v_mfma_f32_16x16x32_bf16 v[148:151], a[200:203], a[220:223], v[148:151]
  ds_read_b64_tr_b16 a[198:199], v248 offset:12288
  s_waitcnt lgkmcnt(12)
  v_mfma_f32_16x16x32_bf16 v[156:159], a[208:211], a[220:223], v[156:159]
  ds_read_b64_tr_b16 a[200:201], v249 offset:0
  v_mfma_f32_16x16x32_bf16 v[156:159], a[212:215], a[228:231], v[156:159]
  buffer_load_dwordx4 v135, s[24:27], s4 offen offset:2048 lds
  ds_read_b64_tr_b16 a[202:203], v249 offset:4096
  v_mfma_f32_16x16x32_bf16 v[152:155], a[212:215], a[224:227], v[152:155]
  ds_read_b64_tr_b16 a[204:205], v249 offset:8192
  v_mfma_f32_16x16x32_bf16 v[152:155], a[208:211], a[216:219], v[152:155]
  ds_read_b64_tr_b16 a[206:207], v249 offset:12288
  s_waitcnt lgkmcnt(12)
  v_mfma_f32_16x16x32_bf16 v[160:163], a[176:179], a[216:219], v[160:163]
  ds_read_b64_tr_b16 a[208:209], v250 offset:0
  v_mfma_f32_16x16x32_bf16 v[160:163], a[180:183], a[224:227], v[160:163]
  buffer_load_dwordx4 a[76:79], v137, s[36:39], s5 offen offset:3072 sc1
  ds_read_b64_tr_b16 a[210:211], v250 offset:4096
  v_mfma_f32_16x16x32_bf16 v[164:167], a[180:183], a[228:231], v[164:167]
  ds_read_b64_tr_b16 a[212:213], v250 offset:8192
  v_mfma_f32_16x16x32_bf16 v[164:167], a[176:179], a[220:223], v[164:167]
  ds_read_b64_tr_b16 a[214:215], v250 offset:12288
  s_waitcnt lgkmcnt(12)
  v_mfma_f32_16x16x32_bf16 v[172:175], a[184:187], a[220:223], v[172:175]
  ds_read_b64_tr_b16 a[176:177], v251 offset:0
  v_mfma_f32_16x16x32_bf16 v[172:175], a[188:191], a[228:231], v[172:175]
  buffer_load_dwordx4 v136, s[24:27], s4 offen offset:3072 lds
  s_cmp_eq_u32 s41, 0
  v_mfma_f32_16x16x32_bf16 v[168:171], a[188:191], a[224:227], v[168:171]
  s_cselect_b32 s6, 15, 43
  s_lshl_b32 s5, s6, 11
  v_mfma_f32_16x16x32_bf16 v[168:171], a[184:187], a[216:219], v[168:171]
  ds_read_b64_tr_b16 a[178:179], v251 offset:4096
  s_waitcnt vmcnt(34) lgkmcnt(10)
  v_mfma_f32_16x16x32_bf16 v[32:35], a[192:195], a[0:3], v[32:35]
  ds_read_b64_tr_b16 a[180:181], v251 offset:8192
  ds_read_b64_tr_b16 a[182:183], v251 offset:12288
  v_mfma_f32_16x16x32_bf16 v[32:35], a[196:199], a[8:11], v[32:35]
  ds_read_b64_tr_b16 a[184:185], v248 offset:2048
  buffer_load_dwordx4 a[216:219], v137, s[36:39], s5 offen offset:0 sc1
  v_mfma_f32_16x16x32_bf16 v[36:39], a[196:199], a[12:15], v[36:39]
  s_lshl_b32 s4, s15, 16
  s_add_u32 m0, s74, 49152
  v_mfma_f32_16x16x32_bf16 v[36:39], a[192:195], a[4:7], v[36:39]
  ds_read_b64_tr_b16 a[186:187], v248 offset:6144
  s_waitcnt lgkmcnt(10)
  v_mfma_f32_16x16x32_bf16 v[44:47], a[200:203], a[4:7], v[44:47]
  ds_read_b64_tr_b16 a[188:189], v248 offset:10240
  ds_read_b64_tr_b16 a[190:191], v248 offset:14336
  v_mfma_f32_16x16x32_bf16 v[44:47], a[204:207], a[12:15], v[44:47]
  ds_read_b64_tr_b16 a[192:193], v249 offset:2048
  buffer_load_dwordx4 v133, s[24:27], s4 offen offset:0 lds
  v_mfma_f32_16x16x32_bf16 v[40:43], a[204:207], a[8:11], v[40:43]
  ds_read_b64_tr_b16 a[194:195], v249 offset:6144
  ds_read_b64_tr_b16 a[196:197], v249 offset:10240
  v_mfma_f32_16x16x32_bf16 v[40:43], a[200:203], a[0:3], v[40:43]
  s_waitcnt vmcnt(19) lgkmcnt(11)
  s_barrier
  v_mfma_f32_16x16x32_bf16 v[48:51], a[208:211], a[0:3], v[48:51]
  ds_read_b64_tr_b16 a[198:199], v249 offset:14336
  ds_read_b64_tr_b16 a[200:201], v250 offset:2048
  v_mfma_f32_16x16x32_bf16 v[48:51], a[212:215], a[8:11], v[48:51]
  buffer_load_dwordx4 a[220:223], v137, s[36:39], s5 offen offset:1024 sc1
  ds_read_b64_tr_b16 a[202:203], v250 offset:6144
  v_mfma_f32_16x16x32_bf16 v[52:55], a[212:215], a[12:15], v[52:55]
  ds_read_b64_tr_b16 a[204:205], v250 offset:10240
  v_mfma_f32_16x16x32_bf16 v[52:55], a[208:211], a[4:7], v[52:55]
  ds_read_b64_tr_b16 a[206:207], v250 offset:14336
  s_waitcnt lgkmcnt(12)
  v_mfma_f32_16x16x32_bf16 v[60:63], a[176:179], a[4:7], v[60:63]
  ds_read_b64_tr_b16 a[208:209], v251 offset:2048
  v_mfma_f32_16x16x32_bf16 v[60:63], a[180:183], a[12:15], v[60:63]
  buffer_load_dwordx4 v134, s[24:27], s4 offen offset:1024 lds
  ds_read_b64_tr_b16 a[210:211], v251 offset:6144
  v_mfma_f32_16x16x32_bf16 v[56:59], a[180:183], a[8:11], v[56:59]
  ds_read_b64_tr_b16 a[212:213], v251 offset:10240
  v_mfma_f32_16x16x32_bf16 v[56:59], a[176:179], a[0:3], v[56:59]
  ds_read_b64_tr_b16 a[214:215], v251 offset:14336
  s_waitcnt lgkmcnt(12)
  v_mfma_f32_16x16x32_bf16 v[144:147], a[184:187], a[0:3], v[144:147]
  ds_read_b64_tr_b16 a[176:177], v240 offset:0
  v_mfma_f32_16x16x32_bf16 v[144:147], a[188:191], a[8:11], v[144:147]
  buffer_load_dwordx4 a[224:227], v137, s[36:39], s5 offen offset:2048 sc1
  ds_read_b64_tr_b16 a[178:179], v240 offset:4096
  v_mfma_f32_16x16x32_bf16 v[148:151], a[188:191], a[12:15], v[148:151]
  ds_read_b64_tr_b16 a[180:181], v240 offset:8192
  v_mfma_f32_16x16x32_bf16 v[148:151], a[184:187], a[4:7], v[148:151]
  ds_read_b64_tr_b16 a[182:183], v240 offset:12288
  s_waitcnt lgkmcnt(12)
  v_mfma_f32_16x16x32_bf16 v[156:159], a[192:195], a[4:7], v[156:159]
  ds_read_b64_tr_b16 a[184:185], v241 offset:0
  v_mfma_f32_16x16x32_bf16 v[156:159], a[196:199], a[12:15], v[156:159]
  buffer_load_dwordx4 v135, s[24:27], s4 offen offset:2048 lds
  ds_read_b64_tr_b16 a[186:187], v241 offset:4096
  v_mfma_f32_16x16x32_bf16 v[152:155], a[196:199], a[8:11], v[152:155]
  ds_read_b64_tr_b16 a[188:189], v241 offset:8192
  v_mfma_f32_16x16x32_bf16 v[152:155], a[192:195], a[0:3], v[152:155]
  ds_read_b64_tr_b16 a[190:191], v241 offset:12288
  s_waitcnt lgkmcnt(12)
  v_mfma_f32_16x16x32_bf16 v[160:163], a[200:203], a[0:3], v[160:163]
  ds_read_b64_tr_b16 a[192:193], v242 offset:0
  v_mfma_f32_16x16x32_bf16 v[160:163], a[204:207], a[8:11], v[160:163]
  buffer_load_dwordx4 a[228:231], v137, s[36:39], s5 offen offset:3072 sc1
  ds_read_b64_tr_b16 a[194:195], v242 offset:4096
  v_mfma_f32_16x16x32_bf16 v[164:167], a[204:207], a[12:15], v[164:167]
  ds_read_b64_tr_b16 a[196:197], v242 offset:8192
  v_mfma_f32_16x16x32_bf16 v[164:167], a[200:203], a[4:7], v[164:167]
  ds_read_b64_tr_b16 a[198:199], v242 offset:12288
  s_waitcnt lgkmcnt(12)
  v_mfma_f32_16x16x32_bf16 v[172:175], a[208:211], a[4:7], v[172:175]
  ds_read_b64_tr_b16 a[200:201], v243 offset:0
  v_mfma_f32_16x16x32_bf16 v[172:175], a[212:215], a[12:15], v[172:175]
  buffer_load_dwordx4 v136, s[24:27], s4 offen offset:3072 lds
  s_cmp_eq_u32 s41, 1
  v_mfma_f32_16x16x32_bf16 v[168:171], a[212:215], a[8:11], v[168:171]
  s_cselect_b32 s7, 5, 47
  s_lshl_b32 s5, s7, 11
  v_mfma_f32_16x16x32_bf16 v[168:171], a[208:211], a[0:3], v[168:171]
  ds_read_b64_tr_b16 a[202:203], v243 offset:4096
  s_waitcnt vmcnt(34) lgkmcnt(10)
  v_mfma_f32_16x16x32_bf16 v[32:35], a[176:179], a[16:19], v[32:35]
  ds_read_b64_tr_b16 a[204:205], v243 offset:8192
  ds_read_b64_tr_b16 a[206:207], v243 offset:12288
  v_mfma_f32_16x16x32_bf16 v[32:35], a[180:183], a[24:27], v[32:35]
  ds_read_b64_tr_b16 a[208:209], v240 offset:2048
  buffer_load_dwordx4 a[0:3], v137, s[36:39], s5 offen offset:0 sc1
  v_mfma_f32_16x16x32_bf16 v[36:39], a[180:183], a[28:31], v[36:39]
  s_lshl_b32 s4, s6, 16
  s_add_u32 m0, s74, 65536
  v_mfma_f32_16x16x32_bf16 v[36:39], a[176:179], a[20:23], v[36:39]
  ds_read_b64_tr_b16 a[210:211], v240 offset:6144
  s_waitcnt lgkmcnt(10)
  v_mfma_f32_16x16x32_bf16 v[44:47], a[184:187], a[20:23], v[44:47]
  ds_read_b64_tr_b16 a[212:213], v240 offset:10240
  ds_read_b64_tr_b16 a[214:215], v240 offset:14336
  v_mfma_f32_16x16x32_bf16 v[44:47], a[188:191], a[28:31], v[44:47]
  ds_read_b64_tr_b16 a[176:177], v241 offset:2048
  buffer_load_dwordx4 v133, s[24:27], s4 offen offset:0 lds
  v_mfma_f32_16x16x32_bf16 v[40:43], a[188:191], a[24:27], v[40:43]
  ds_read_b64_tr_b16 a[178:179], v241 offset:6144
  ds_read_b64_tr_b16 a[180:181], v241 offset:10240
  v_mfma_f32_16x16x32_bf16 v[40:43], a[184:187], a[16:19], v[40:43]
  s_waitcnt vmcnt(18) lgkmcnt(11)
  s_barrier
  v_mfma_f32_16x16x32_bf16 v[48:51], a[192:195], a[16:19], v[48:51]
  ds_read_b64_tr_b16 a[182:183], v241 offset:14336
  ds_read_b64_tr_b16 a[184:185], v242 offset:2048
  v_mfma_f32_16x16x32_bf16 v[48:51], a[196:199], a[24:27], v[48:51]
  buffer_load_dwordx4 a[4:7], v137, s[36:39], s5 offen offset:1024 sc1
  ds_read_b64_tr_b16 a[186:187], v242 offset:6144
  v_mfma_f32_16x16x32_bf16 v[52:55], a[196:199], a[28:31], v[52:55]
  ds_read_b64_tr_b16 a[188:189], v242 offset:10240
  v_mfma_f32_16x16x32_bf16 v[52:55], a[192:195], a[20:23], v[52:55]
  ds_read_b64_tr_b16 a[190:191], v242 offset:14336
  s_waitcnt lgkmcnt(12)
  v_mfma_f32_16x16x32_bf16 v[60:63], a[200:203], a[20:23], v[60:63]
  ds_read_b64_tr_b16 a[192:193], v243 offset:2048
  v_mfma_f32_16x16x32_bf16 v[60:63], a[204:207], a[28:31], v[60:63]
  buffer_load_dwordx4 v134, s[24:27], s4 offen offset:1024 lds
  ds_read_b64_tr_b16 a[194:195], v243 offset:6144
  v_mfma_f32_16x16x32_bf16 v[56:59], a[204:207], a[24:27], v[56:59]
  ds_read_b64_tr_b16 a[196:197], v243 offset:10240
  v_mfma_f32_16x16x32_bf16 v[56:59], a[200:203], a[16:19], v[56:59]
  ds_read_b64_tr_b16 a[198:199], v243 offset:14336
  s_waitcnt lgkmcnt(12)
  v_mfma_f32_16x16x32_bf16 v[144:147], a[208:211], a[16:19], v[144:147]
  ds_read_b64_tr_b16 a[200:201], v240 offset:16384
  v_mfma_f32_16x16x32_bf16 v[144:147], a[212:215], a[24:27], v[144:147]
  buffer_load_dwordx4 a[8:11], v137, s[36:39], s5 offen offset:2048 sc1
  ds_read_b64_tr_b16 a[202:203], v240 offset:20480
  v_mfma_f32_16x16x32_bf16 v[148:151], a[212:215], a[28:31], v[148:151]
  ds_read_b64_tr_b16 a[204:205], v240 offset:24576
  v_mfma_f32_16x16x32_bf16 v[148:151], a[208:211], a[20:23], v[148:151]
  ds_read_b64_tr_b16 a[206:207], v240 offset:28672
  s_waitcnt lgkmcnt(12)
  v_mfma_f32_16x16x32_bf16 v[156:159], a[176:179], a[20:23], v[156:159]
  ds_read_b64_tr_b16 a[208:209], v241 offset:16384
  v_mfma_f32_16x16x32_bf16 v[156:159], a[180:183], a[28:31], v[156:159]
  buffer_load_dwordx4 v135, s[24:27], s4 offen offset:2048 lds
  ds_read_b64_tr_b16 a[210:211], v241 offset:20480
  v_mfma_f32_16x16x32_bf16 v[152:155], a[180:183], a[24:27], v[152:155]
  ds_read_b64_tr_b16 a[212:213], v241 offset:24576
  v_mfma_f32_16x16x32_bf16 v[152:155], a[176:179], a[16:19], v[152:155]
  ds_read_b64_tr_b16 a[214:215], v241 offset:28672
  s_waitcnt lgkmcnt(12)
  v_mfma_f32_16x16x32_bf16 v[160:163], a[184:187], a[16:19], v[160:163]
  ds_read_b64_tr_b16 a[176:177], v242 offset:16384
  v_mfma_f32_16x16x32_bf16 v[160:163], a[188:191], a[24:27], v[160:163]
  buffer_load_dwordx4 a[12:15], v137, s[36:39], s5 offen offset:3072 sc1
  ds_read_b64_tr_b16 a[178:179], v242 offset:20480
  v_mfma_f32_16x16x32_bf16 v[164:167], a[188:191], a[28:31], v[164:167]
  ds_read_b64_tr_b16 a[180:181], v242 offset:24576
  v_mfma_f32_16x16x32_bf16 v[164:167], a[184:187], a[20:23], v[164:167]
  ds_read_b64_tr_b16 a[182:183], v242 offset:28672
  s_waitcnt lgkmcnt(12)
  v_mfma_f32_16x16x32_bf16 v[172:175], a[192:195], a[20:23], v[172:175]
  ds_read_b64_tr_b16 a[184:185], v243 offset:16384
  v_mfma_f32_16x16x32_bf16 v[172:175], a[196:199], a[28:31], v[172:175]
  buffer_load_dwordx4 v136, s[24:27], s4 offen offset:3072 lds
  s_cmp_eq_u32 s41, 2
  v_mfma_f32_16x16x32_bf16 v[168:171], a[196:199], a[24:27], v[168:171]
  s_cselect_b32 s8, 8, 50
  s_lshl_b32 s5, s8, 11
  v_mfma_f32_16x16x32_bf16 v[168:171], a[192:195], a[16:19], v[168:171]
  ds_read_b64_tr_b16 a[186:187], v243 offset:20480
  s_waitcnt vmcnt(34) lgkmcnt(10)
  v_mfma_f32_16x16x32_bf16 v[32:35], a[200:203], a[32:35], v[32:35]
  ds_read_b64_tr_b16 a[188:189], v243 offset:24576
  ds_read_b64_tr_b16 a[190:191], v243 offset:28672
  v_mfma_f32_16x16x32_bf16 v[32:35], a[204:207], a[40:43], v[32:35]
  ds_read_b64_tr_b16 a[192:193], v240 offset:18432
  buffer_load_dwordx4 a[16:19], v137, s[36:39], s5 offen offset:0 sc1
  v_mfma_f32_16x16x32_bf16 v[36:39], a[204:207], a[44:47], v[36:39]
  s_lshl_b32 s4, s7, 16
  s_add_u32 m0, s74, 81920
  v_mfma_f32_16x16x32_bf16 v[36:39], a[200:203], a[36:39], v[36:39]
  ds_read_b64_tr_b16 a[194:195], v240 offset:22528
  s_waitcnt lgkmcnt(10)
  v_mfma_f32_16x16x32_bf16 v[44:47], a[208:211], a[36:39], v[44:47]
  ds_read_b64_tr_b16 a[196:197], v240 offset:26624
  ds_read_b64_tr_b16 a[198:199], v240 offset:30720
  v_mfma_f32_16x16x32_bf16 v[44:47], a[212:215], a[44:47], v[44:47]
  ds_read_b64_tr_b16 a[200:201], v241 offset:18432
  buffer_load_dwordx4 v133, s[24:27], s4 offen offset:0 lds
  v_mfma_f32_16x16x32_bf16 v[40:43], a[212:215], a[40:43], v[40:43]
  ds_read_b64_tr_b16 a[202:203], v241 offset:22528
  ds_read_b64_tr_b16 a[204:205], v241 offset:26624
  v_mfma_f32_16x16x32_bf16 v[40:43], a[208:211], a[32:35], v[40:43]
  s_waitcnt vmcnt(18) lgkmcnt(11)
  s_barrier
  v_mfma_f32_16x16x32_bf16 v[48:51], a[176:179], a[32:35], v[48:51]
  ds_read_b64_tr_b16 a[206:207], v241 offset:30720
  ds_read_b64_tr_b16 a[208:209], v242 offset:18432
  v_mfma_f32_16x16x32_bf16 v[48:51], a[180:183], a[40:43], v[48:51]
  buffer_load_dwordx4 a[20:23], v137, s[36:39], s5 offen offset:1024 sc1
  ds_read_b64_tr_b16 a[210:211], v242 offset:22528
  v_mfma_f32_16x16x32_bf16 v[52:55], a[180:183], a[44:47], v[52:55]
  ds_read_b64_tr_b16 a[212:213], v242 offset:26624
  v_mfma_f32_16x16x32_bf16 v[52:55], a[176:179], a[36:39], v[52:55]
  ds_read_b64_tr_b16 a[214:215], v242 offset:30720
  s_waitcnt lgkmcnt(12)
  v_mfma_f32_16x16x32_bf16 v[60:63], a[184:187], a[36:39], v[60:63]
  ds_read_b64_tr_b16 a[176:177], v243 offset:18432
  v_mfma_f32_16x16x32_bf16 v[60:63], a[188:191], a[44:47], v[60:63]
  buffer_load_dwordx4 v134, s[24:27], s4 offen offset:1024 lds
  ds_read_b64_tr_b16 a[178:179], v243 offset:22528
  v_mfma_f32_16x16x32_bf16 v[56:59], a[188:191], a[40:43], v[56:59]
  ds_read_b64_tr_b16 a[180:181], v243 offset:26624
  v_mfma_f32_16x16x32_bf16 v[56:59], a[184:187], a[32:35], v[56:59]
  ds_read_b64_tr_b16 a[182:183], v243 offset:30720
  s_waitcnt lgkmcnt(12)
  v_mfma_f32_16x16x32_bf16 v[144:147], a[192:195], a[32:35], v[144:147]
  ds_read_b64_tr_b16 a[184:185], v240 offset:32768
  v_mfma_f32_16x16x32_bf16 v[144:147], a[196:199], a[40:43], v[144:147]
  buffer_load_dwordx4 a[24:27], v137, s[36:39], s5 offen offset:2048 sc1
  ds_read_b64_tr_b16 a[186:187], v240 offset:36864
  v_mfma_f32_16x16x32_bf16 v[148:151], a[196:199], a[44:47], v[148:151]
  ds_read_b64_tr_b16 a[188:189], v240 offset:40960
  v_mfma_f32_16x16x32_bf16 v[148:151], a[192:195], a[36:39], v[148:151]
  ds_read_b64_tr_b16 a[190:191], v240 offset:45056
  s_waitcnt lgkmcnt(12)
  v_mfma_f32_16x16x32_bf16 v[156:159], a[200:203], a[36:39], v[156:159]
  ds_read_b64_tr_b16 a[192:193], v241 offset:32768
  v_mfma_f32_16x16x32_bf16 v[156:159], a[204:207], a[44:47], v[156:159]
  buffer_load_dwordx4 v135, s[24:27], s4 offen offset:2048 lds
  ds_read_b64_tr_b16 a[194:195], v241 offset:36864
  v_mfma_f32_16x16x32_bf16 v[152:155], a[204:207], a[40:43], v[152:155]
  ds_read_b64_tr_b16 a[196:197], v241 offset:40960
  v_mfma_f32_16x16x32_bf16 v[152:155], a[200:203], a[32:35], v[152:155]
  ds_read_b64_tr_b16 a[198:199], v241 offset:45056
  s_waitcnt lgkmcnt(12)
  v_mfma_f32_16x16x32_bf16 v[160:163], a[208:211], a[32:35], v[160:163]
  ds_read_b64_tr_b16 a[200:201], v242 offset:32768
  v_mfma_f32_16x16x32_bf16 v[160:163], a[212:215], a[40:43], v[160:163]
  buffer_load_dwordx4 a[28:31], v137, s[36:39], s5 offen offset:3072 sc1
  ds_read_b64_tr_b16 a[202:203], v242 offset:36864
  v_mfma_f32_16x16x32_bf16 v[164:167], a[212:215], a[44:47], v[164:167]
  ds_read_b64_tr_b16 a[204:205], v242 offset:40960
  v_mfma_f32_16x16x32_bf16 v[164:167], a[208:211], a[36:39], v[164:167]
  ds_read_b64_tr_b16 a[206:207], v242 offset:45056
  s_waitcnt lgkmcnt(12)
  v_mfma_f32_16x16x32_bf16 v[172:175], a[176:179], a[36:39], v[172:175]
  ds_read_b64_tr_b16 a[208:209], v243 offset:32768
  v_mfma_f32_16x16x32_bf16 v[172:175], a[180:183], a[44:47], v[172:175]
  buffer_load_dwordx4 v136, s[24:27], s4 offen offset:3072 lds
  s_cmp_eq_u32 s41, 3
  v_mfma_f32_16x16x32_bf16 v[168:171], a[180:183], a[40:43], v[168:171]
  s_cselect_b32 s9, 12, 54
  s_lshl_b32 s5, s9, 11
  v_mfma_f32_16x16x32_bf16 v[168:171], a[176:179], a[32:35], v[168:171]
  ds_read_b64_tr_b16 a[210:211], v243 offset:36864
  s_waitcnt vmcnt(34) lgkmcnt(10)
  v_mfma_f32_16x16x32_bf16 v[32:35], a[184:187], a[48:51], v[32:35]
  ds_read_b64_tr_b16 a[212:213], v243 offset:40960
  ds_read_b64_tr_b16 a[214:215], v243 offset:45056
  v_mfma_f32_16x16x32_bf16 v[32:35], a[188:191], a[56:59], v[32:35]
  ds_read_b64_tr_b16 a[176:177], v240 offset:34816
  buffer_load_dwordx4 a[32:35], v137, s[36:39], s5 offen offset:0 sc1
  v_mfma_f32_16x16x32_bf16 v[36:39], a[188:191], a[60:63], v[36:39]
  s_lshl_b32 s4, s8, 16
  s_add_u32 m0, s74, 98304
  v_mfma_f32_16x16x32_bf16 v[36:39], a[184:187], a[52:55], v[36:39]
  ds_read_b64_tr_b16 a[178:179], v240 offset:38912
  s_waitcnt lgkmcnt(10)
  v_mfma_f32_16x16x32_bf16 v[44:47], a[192:195], a[52:55], v[44:47]
  ds_read_b64_tr_b16 a[180:181], v240 offset:43008
  ds_read_b64_tr_b16 a[182:183], v240 offset:47104
  v_mfma_f32_16x16x32_bf16 v[44:47], a[196:199], a[60:63], v[44:47]
  ds_read_b64_tr_b16 a[184:185], v241 offset:34816
  buffer_load_dwordx4 v133, s[24:27], s4 offen offset:0 lds
  v_mfma_f32_16x16x32_bf16 v[40:43], a[196:199], a[56:59], v[40:43]
  ds_read_b64_tr_b16 a[186:187], v241 offset:38912
  ds_read_b64_tr_b16 a[188:189], v241 offset:43008
  v_mfma_f32_16x16x32_bf16 v[40:43], a[192:195], a[48:51], v[40:43]
  s_waitcnt vmcnt(18) lgkmcnt(11)
  s_barrier
  v_mfma_f32_16x16x32_bf16 v[48:51], a[200:203], a[48:51], v[48:51]
  ds_read_b64_tr_b16 a[190:191], v241 offset:47104
  ds_read_b64_tr_b16 a[192:193], v242 offset:34816
  v_mfma_f32_16x16x32_bf16 v[48:51], a[204:207], a[56:59], v[48:51]
  buffer_load_dwordx4 a[36:39], v137, s[36:39], s5 offen offset:1024 sc1
  ds_read_b64_tr_b16 a[194:195], v242 offset:38912
  v_mfma_f32_16x16x32_bf16 v[52:55], a[204:207], a[60:63], v[52:55]
  ds_read_b64_tr_b16 a[196:197], v242 offset:43008
  v_mfma_f32_16x16x32_bf16 v[52:55], a[200:203], a[52:55], v[52:55]
  ds_read_b64_tr_b16 a[198:199], v242 offset:47104
  s_waitcnt lgkmcnt(12)
  v_mfma_f32_16x16x32_bf16 v[60:63], a[208:211], a[52:55], v[60:63]
  ds_read_b64_tr_b16 a[200:201], v243 offset:34816
  v_mfma_f32_16x16x32_bf16 v[60:63], a[212:215], a[60:63], v[60:63]
  buffer_load_dwordx4 v134, s[24:27], s4 offen offset:1024 lds
  ds_read_b64_tr_b16 a[202:203], v243 offset:38912
  v_mfma_f32_16x16x32_bf16 v[56:59], a[212:215], a[56:59], v[56:59]
  ds_read_b64_tr_b16 a[204:205], v243 offset:43008
  v_mfma_f32_16x16x32_bf16 v[56:59], a[208:211], a[48:51], v[56:59]
  ds_read_b64_tr_b16 a[206:207], v243 offset:47104
  s_waitcnt lgkmcnt(12)
  v_mfma_f32_16x16x32_bf16 v[144:147], a[176:179], a[48:51], v[144:147]
  ds_read_b64_tr_b16 a[208:209], v240 offset:51200
  v_mfma_f32_16x16x32_bf16 v[144:147], a[180:183], a[56:59], v[144:147]
  buffer_load_dwordx4 a[40:43], v137, s[36:39], s5 offen offset:2048 sc1
  ds_read_b64_tr_b16 a[210:211], v240 offset:55296
  v_mfma_f32_16x16x32_bf16 v[148:151], a[180:183], a[60:63], v[148:151]
  ds_read_b64_tr_b16 a[212:213], v240 offset:59392
  v_mfma_f32_16x16x32_bf16 v[148:151], a[176:179], a[52:55], v[148:151]
  ds_read_b64_tr_b16 a[214:215], v240 offset:63488
  s_waitcnt lgkmcnt(12)
  v_mfma_f32_16x16x32_bf16 v[156:159], a[184:187], a[52:55], v[156:159]
  ds_read_b64_tr_b16 a[176:177], v241 offset:51200
  v_mfma_f32_16x16x32_bf16 v[156:159], a[188:191], a[60:63], v[156:159]
  buffer_load_dwordx4 v135, s[24:27], s4 offen offset:2048 lds
  ds_read_b64_tr_b16 a[178:179], v241 offset:55296
  v_mfma_f32_16x16x32_bf16 v[152:155], a[188:191], a[56:59], v[152:155]
  ds_read_b64_tr_b16 a[180:181], v241 offset:59392
  v_mfma_f32_16x16x32_bf16 v[152:155], a[184:187], a[48:51], v[152:155]
  s_waitcnt vmcnt(14) lgkmcnt(11)
  s_barrier
  v_mfma_f32_16x16x32_bf16 v[160:163], a[192:195], a[48:51], v[160:163]
  ds_read_b64_tr_b16 a[182:183], v241 offset:63488
  ds_read_b64_tr_b16 a[184:185], v242 offset:51200
  v_mfma_f32_16x16x32_bf16 v[160:163], a[196:199], a[56:59], v[160:163]
  buffer_load_dwordx4 a[44:47], v137, s[36:39], s5 offen offset:3072 sc1
  ds_read_b64_tr_b16 a[186:187], v242 offset:55296
  v_mfma_f32_16x16x32_bf16 v[164:167], a[196:199], a[60:63], v[164:167]
  ds_read_b64_tr_b16 a[188:189], v242 offset:59392
  v_mfma_f32_16x16x32_bf16 v[164:167], a[192:195], a[52:55], v[164:167]
  ds_read_b64_tr_b16 a[190:191], v242 offset:63488
  s_waitcnt lgkmcnt(12)
  v_mfma_f32_16x16x32_bf16 v[172:175], a[200:203], a[52:55], v[172:175]
  ds_read_b64_tr_b16 a[192:193], v243 offset:51200
  v_mfma_f32_16x16x32_bf16 v[172:175], a[204:207], a[60:63], v[172:175]
  buffer_load_dwordx4 v136, s[24:27], s4 offen offset:3072 lds
  ds_read_b64_tr_b16 a[194:195], v243 offset:55296
  v_mfma_f32_16x16x32_bf16 v[168:171], a[204:207], a[56:59], v[168:171]
  ds_read_b64_tr_b16 a[196:197], v243 offset:59392
  v_mfma_f32_16x16x32_bf16 v[168:171], a[200:203], a[48:51], v[168:171]
  ds_read_b64_tr_b16 a[198:199], v243 offset:63488
  s_waitcnt vmcnt(33) lgkmcnt(12)
  v_mfma_f32_16x16x32_bf16 v[144:147], a[208:211], a[64:67], v[144:147]
  ds_read_b64_tr_b16 a[200:201], v244 offset:2048
  v_mfma_f32_16x16x32_bf16 v[144:147], a[212:215], a[72:75], v[144:147]
  s_lshl_b32 s4, s9, 16
  s_add_u32 m0, s74, 114688
  v_mfma_f32_16x16x32_bf16 v[148:151], a[212:215], a[76:79], v[148:151]
  ds_read_b64_tr_b16 a[202:203], v244 offset:6144
  ds_read_b64_tr_b16 a[204:205], v244 offset:10240
  v_mfma_f32_16x16x32_bf16 v[148:151], a[208:211], a[68:71], v[148:151]
  ds_read_b64_tr_b16 a[206:207], v244 offset:14336
  s_waitcnt lgkmcnt(12)
  v_mfma_f32_16x16x32_bf16 v[156:159], a[176:179], a[68:71], v[156:159]
  ds_read_b64_tr_b16 a[208:209], v245 offset:2048
  v_mfma_f32_16x16x32_bf16 v[156:159], a[180:183], a[76:79], v[156:159]
  buffer_load_dwordx4 v133, s[24:27], s4 offen offset:0 lds
  ds_read_b64_tr_b16 a[210:211], v245 offset:6144
  v_mfma_f32_16x16x32_bf16 v[152:155], a[180:183], a[72:75], v[152:155]
  ds_read_b64_tr_b16 a[212:213], v245 offset:10240
  v_mfma_f32_16x16x32_bf16 v[152:155], a[176:179], a[64:67], v[152:155]
  s_waitcnt vmcnt(9) lgkmcnt(11)
  s_barrier
  v_mfma_f32_16x16x32_bf16 v[160:163], a[184:187], a[64:67], v[160:163]
  ds_read_b64_tr_b16 a[214:215], v245 offset:14336
  ds_read_b64_tr_b16 a[176:177], v246 offset:2048
  v_mfma_f32_16x16x32_bf16 v[160:163], a[188:191], a[72:75], v[160:163]
  ds_read_b64_tr_b16 a[178:179], v246 offset:6144
  v_mfma_f32_16x16x32_bf16 v[164:167], a[188:191], a[76:79], v[164:167]
  ds_read_b64_tr_b16 a[180:181], v246 offset:10240
  v_mfma_f32_16x16x32_bf16 v[164:167], a[184:187], a[68:71], v[164:167]
  ds_read_b64_tr_b16 a[182:183], v246 offset:14336
  s_waitcnt lgkmcnt(12)
  v_mfma_f32_16x16x32_bf16 v[172:175], a[192:195], a[68:71], v[172:175]
  ds_read_b64_tr_b16 a[184:185], v247 offset:2048
  v_mfma_f32_16x16x32_bf16 v[172:175], a[196:199], a[76:79], v[172:175]
  buffer_load_dwordx4 v134, s[24:27], s4 offen offset:1024 lds
  ds_read_b64_tr_b16 a[186:187], v247 offset:6144
  v_mfma_f32_16x16x32_bf16 v[168:171], a[196:199], a[72:75], v[168:171]
  ds_read_b64_tr_b16 a[188:189], v247 offset:10240
  v_mfma_f32_16x16x32_bf16 v[168:171], a[192:195], a[64:67], v[168:171]
  ds_read_b64_tr_b16 a[190:191], v247 offset:14336
  s_waitcnt vmcnt(27) lgkmcnt(12)
  v_mfma_f32_16x16x32_bf16 v[144:147], a[200:203], a[216:219], v[144:147]
  ds_read_b64_tr_b16 a[192:193], v244 offset:18432
  v_mfma_f32_16x16x32_bf16 v[144:147], a[204:207], a[224:227], v[144:147]
  ds_read_b64_tr_b16 a[194:195], v244 offset:22528
  v_mfma_f32_16x16x32_bf16 v[148:151], a[204:207], a[228:231], v[148:151]
  ds_read_b64_tr_b16 a[196:197], v244 offset:26624
  v_mfma_f32_16x16x32_bf16 v[148:151], a[200:203], a[220:223], v[148:151]
  ds_read_b64_tr_b16 a[198:199], v244 offset:30720
  s_waitcnt lgkmcnt(12)
  v_mfma_f32_16x16x32_bf16 v[156:159], a[208:211], a[220:223], v[156:159]
  ds_read_b64_tr_b16 a[200:201], v245 offset:18432
  v_mfma_f32_16x16x32_bf16 v[156:159], a[212:215], a[228:231], v[156:159]
  buffer_load_dwordx4 v135, s[24:27], s4 offen offset:2048 lds
  ds_read_b64_tr_b16 a[202:203], v245 offset:22528
  v_mfma_f32_16x16x32_bf16 v[152:155], a[212:215], a[224:227], v[152:155]
  ds_read_b64_tr_b16 a[204:205], v245 offset:26624
  v_mfma_f32_16x16x32_bf16 v[152:155], a[208:211], a[216:219], v[152:155]
  s_waitcnt vmcnt(3) lgkmcnt(11)
  s_barrier
  v_mfma_f32_16x16x32_bf16 v[160:163], a[176:179], a[216:219], v[160:163]
  ds_read_b64_tr_b16 a[206:207], v245 offset:30720
  ds_read_b64_tr_b16 a[208:209], v246 offset:18432
  v_mfma_f32_16x16x32_bf16 v[160:163], a[180:183], a[224:227], v[160:163]
  ds_read_b64_tr_b16 a[210:211], v246 offset:22528
  v_mfma_f32_16x16x32_bf16 v[164:167], a[180:183], a[228:231], v[164:167]
  ds_read_b64_tr_b16 a[212:213], v246 offset:26624
  v_mfma_f32_16x16x32_bf16 v[164:167], a[176:179], a[220:223], v[164:167]
  ds_read_b64_tr_b16 a[214:215], v246 offset:30720
  s_waitcnt lgkmcnt(12)
  v_mfma_f32_16x16x32_bf16 v[172:175], a[184:187], a[220:223], v[172:175]
  ds_read_b64_tr_b16 a[176:177], v247 offset:18432
  v_mfma_f32_16x16x32_bf16 v[172:175], a[188:191], a[228:231], v[172:175]
  buffer_load_dwordx4 v136, s[24:27], s4 offen offset:3072 lds
  ds_read_b64_tr_b16 a[178:179], v247 offset:22528
  v_mfma_f32_16x16x32_bf16 v[168:171], a[188:191], a[224:227], v[168:171]
  ds_read_b64_tr_b16 a[180:181], v247 offset:26624
  v_mfma_f32_16x16x32_bf16 v[168:171], a[184:187], a[216:219], v[168:171]
  ds_read_b64_tr_b16 a[182:183], v247 offset:30720
  s_waitcnt vmcnt(21) lgkmcnt(12)
  v_mfma_f32_16x16x32_bf16 v[144:147], a[192:195], a[0:3], v[144:147]
  ds_read_b64_tr_b16 a[184:185], v244 offset:34816
  v_mfma_f32_16x16x32_bf16 v[144:147], a[196:199], a[8:11], v[144:147]
  ds_read_b64_tr_b16 a[186:187], v244 offset:38912
  v_mfma_f32_16x16x32_bf16 v[148:151], a[196:199], a[12:15], v[148:151]
  ds_read_b64_tr_b16 a[188:189], v244 offset:43008
  v_mfma_f32_16x16x32_bf16 v[148:151], a[192:195], a[4:7], v[148:151]
  ds_read_b64_tr_b16 a[190:191], v244 offset:47104
  s_waitcnt lgkmcnt(12)
  v_mfma_f32_16x16x32_bf16 v[156:159], a[200:203], a[4:7], v[156:159]
  ds_read_b64_tr_b16 a[192:193], v245 offset:34816
  v_mfma_f32_16x16x32_bf16 v[156:159], a[204:207], a[12:15], v[156:159]
  ds_read_b64_tr_b16 a[194:195], v245 offset:38912
  v_mfma_f32_16x16x32_bf16 v[152:155], a[204:207], a[8:11], v[152:155]
  ds_read_b64_tr_b16 a[196:197], v245 offset:43008
  v_mfma_f32_16x16x32_bf16 v[152:155], a[200:203], a[0:3], v[152:155]
  s_waitcnt vmcnt(0) lgkmcnt(11)
  s_barrier
  v_mfma_f32_16x16x32_bf16 v[160:163], a[208:211], a[0:3], v[160:163]
  ds_read_b64_tr_b16 a[198:199], v245 offset:47104
  ds_read_b64_tr_b16 a[200:201], v246 offset:34816
  v_mfma_f32_16x16x32_bf16 v[160:163], a[212:215], a[8:11], v[160:163]
  ds_read_b64_tr_b16 a[202:203], v246 offset:38912
  v_mfma_f32_16x16x32_bf16 v[164:167], a[212:215], a[12:15], v[164:167]
  ds_read_b64_tr_b16 a[204:205], v246 offset:43008
  v_mfma_f32_16x16x32_bf16 v[164:167], a[208:211], a[4:7], v[164:167]
  ds_read_b64_tr_b16 a[206:207], v246 offset:47104
  s_waitcnt lgkmcnt(12)
  v_mfma_f32_16x16x32_bf16 v[172:175], a[176:179], a[4:7], v[172:175]
  ds_read_b64_tr_b16 a[208:209], v247 offset:34816
  v_mfma_f32_16x16x32_bf16 v[172:175], a[180:183], a[12:15], v[172:175]
  ds_read_b64_tr_b16 a[210:211], v247 offset:38912
  v_mfma_f32_16x16x32_bf16 v[168:171], a[180:183], a[8:11], v[168:171]
  ds_read_b64_tr_b16 a[212:213], v247 offset:43008
  v_mfma_f32_16x16x32_bf16 v[168:171], a[176:179], a[0:3], v[168:171]
  ds_read_b64_tr_b16 a[214:215], v247 offset:47104
  s_waitcnt vmcnt(13) lgkmcnt(12)
  v_mfma_f32_16x16x32_bf16 v[144:147], a[184:187], a[16:19], v[144:147]
  ds_read_b64_tr_b16 a[176:177], v244 offset:51200
  v_mfma_f32_16x16x32_bf16 v[144:147], a[188:191], a[24:27], v[144:147]
  ds_read_b64_tr_b16 a[178:179], v244 offset:55296
  v_mfma_f32_16x16x32_bf16 v[148:151], a[188:191], a[28:31], v[148:151]
  ds_read_b64_tr_b16 a[180:181], v244 offset:59392
  v_mfma_f32_16x16x32_bf16 v[148:151], a[184:187], a[20:23], v[148:151]
  ds_read_b64_tr_b16 a[182:183], v244 offset:63488
  s_waitcnt lgkmcnt(12)
  v_mfma_f32_16x16x32_bf16 v[156:159], a[192:195], a[20:23], v[156:159]
  ds_read_b64_tr_b16 a[184:185], v245 offset:51200
  v_mfma_f32_16x16x32_bf16 v[156:159], a[196:199], a[28:31], v[156:159]
  ds_read_b64_tr_b16 a[186:187], v245 offset:55296
  v_mfma_f32_16x16x32_bf16 v[152:155], a[196:199], a[24:27], v[152:155]
  ds_read_b64_tr_b16 a[188:189], v245 offset:59392
  v_mfma_f32_16x16x32_bf16 v[152:155], a[192:195], a[16:19], v[152:155]
  ds_read_b64_tr_b16 a[190:191], v245 offset:63488
  s_waitcnt lgkmcnt(12)
  v_mfma_f32_16x16x32_bf16 v[160:163], a[200:203], a[16:19], v[160:163]
  ds_read_b64_tr_b16 a[192:193], v246 offset:51200
  v_mfma_f32_16x16x32_bf16 v[160:163], a[204:207], a[24:27], v[160:163]
  ds_read_b64_tr_b16 a[194:195], v246 offset:55296
  v_mfma_f32_16x16x32_bf16 v[164:167], a[204:207], a[28:31], v[164:167]
  ds_read_b64_tr_b16 a[196:197], v246 offset:59392
  v_mfma_f32_16x16x32_bf16 v[164:167], a[200:203], a[20:23], v[164:167]
  ds_read_b64_tr_b16 a[198:199], v246 offset:63488
  s_waitcnt lgkmcnt(12)
  v_mfma_f32_16x16x32_bf16 v[172:175], a[208:211], a[20:23], v[172:175]
  ds_read_b64_tr_b16 a[200:201], v247 offset:51200
  v_mfma_f32_16x16x32_bf16 v[172:175], a[212:215], a[28:31], v[172:175]
  ds_read_b64_tr_b16 a[202:203], v247 offset:55296
  v_mfma_f32_16x16x32_bf16 v[168:171], a[212:215], a[24:27], v[168:171]
  ds_read_b64_tr_b16 a[204:205], v247 offset:59392
  v_mfma_f32_16x16x32_bf16 v[168:171], a[208:211], a[16:19], v[168:171]
  ds_read_b64_tr_b16 a[206:207], v247 offset:63488
  s_waitcnt vmcnt(5) lgkmcnt(12)
  v_mfma_f32_16x16x32_bf16 v[144:147], a[176:179], a[32:35], v[144:147]
  ds_read_b64_tr_b16 a[208:209], v240 offset:49152
  v_mfma_f32_16x16x32_bf16 v[144:147], a[180:183], a[40:43], v[144:147]
  ds_read_b64_tr_b16 a[210:211], v240 offset:53248
  v_mfma_f32_16x16x32_bf16 v[148:151], a[180:183], a[44:47], v[148:151]
  ds_read_b64_tr_b16 a[212:213], v240 offset:57344
  v_mfma_f32_16x16x32_bf16 v[148:151], a[176:179], a[36:39], v[148:151]
  ds_read_b64_tr_b16 a[214:215], v240 offset:61440
  s_waitcnt lgkmcnt(12)
  v_mfma_f32_16x16x32_bf16 v[156:159], a[184:187], a[36:39], v[156:159]
  ds_read_b64_tr_b16 a[176:177], v241 offset:49152
  v_mfma_f32_16x16x32_bf16 v[156:159], a[188:191], a[44:47], v[156:159]
  ds_read_b64_tr_b16 a[178:179], v241 offset:53248
  v_mfma_f32_16x16x32_bf16 v[152:155], a[188:191], a[40:43], v[152:155]
  ds_read_b64_tr_b16 a[180:181], v241 offset:57344
  v_mfma_f32_16x16x32_bf16 v[152:155], a[184:187], a[32:35], v[152:155]
  ds_read_b64_tr_b16 a[182:183], v241 offset:61440
  s_waitcnt lgkmcnt(12)
  v_mfma_f32_16x16x32_bf16 v[160:163], a[192:195], a[32:35], v[160:163]
  ds_read_b64_tr_b16 a[184:185], v242 offset:49152
  buffer_store_dwordx4 v[144:147], v0, s[36:39], s50 offen offset:0 sc1
  v_mfma_f32_16x16x32_bf16 v[160:163], a[196:199], a[40:43], v[160:163]
  ds_read_b64_tr_b16 a[186:187], v242 offset:53248
  v_mfma_f32_16x16x32_bf16 v[164:167], a[196:199], a[44:47], v[164:167]
  buffer_store_dwordx4 v[148:151], v0, s[36:39], s50 offen offset:1024 sc1
  ds_read_b64_tr_b16 a[188:189], v242 offset:57344
  v_mfma_f32_16x16x32_bf16 v[164:167], a[192:195], a[36:39], v[164:167]
  ds_read_b64_tr_b16 a[190:191], v242 offset:61440
  s_waitcnt lgkmcnt(12)
  v_mfma_f32_16x16x32_bf16 v[172:175], a[200:203], a[36:39], v[172:175]
  ds_read_b64_tr_b16 a[192:193], v243 offset:49152
  v_mfma_f32_16x16x32_bf16 v[172:175], a[204:207], a[44:47], v[172:175]
  ds_read_b64_tr_b16 a[194:195], v243 offset:53248
  buffer_store_dwordx4 v[152:155], v0, s[36:39], s50 offen offset:2048 sc1
  v_mfma_f32_16x16x32_bf16 v[168:171], a[204:207], a[40:43], v[168:171]
  buffer_store_dwordx4 v[156:159], v0, s[36:39], s50 offen offset:3072 sc1
  ds_read_b64_tr_b16 a[196:197], v243 offset:57344
  v_mfma_f32_16x16x32_bf16 v[168:171], a[200:203], a[32:35], v[168:171]
  ds_read_b64_tr_b16 a[198:199], v243 offset:61440
  s_waitcnt lgkmcnt(12)
  v_mfma_f32_16x16x32_bf16 v[32:35], a[208:211], a[64:67], v[32:35]
  ds_read_b64_tr_b16 a[200:201], v244 offset:0
  v_mfma_f32_16x16x32_bf16 v[32:35], a[212:215], a[72:75], v[32:35]
  ds_read_b64_tr_b16 a[202:203], v244 offset:4096
  buffer_store_dwordx4 v[160:163], v0, s[36:39], s51 offen offset:0 sc1
  v_mfma_f32_16x16x32_bf16 v[36:39], a[212:215], a[76:79], v[36:39]
  buffer_store_dwordx4 v[164:167], v0, s[36:39], s51 offen offset:1024 sc1
  ds_read_b64_tr_b16 a[204:205], v244 offset:8192
  v_mfma_f32_16x16x32_bf16 v[36:39], a[208:211], a[68:71], v[36:39]
  ds_read_b64_tr_b16 a[206:207], v244 offset:12288
  s_waitcnt lgkmcnt(12)
  v_mfma_f32_16x16x32_bf16 v[44:47], a[176:179], a[68:71], v[44:47]
  ds_read_b64_tr_b16 a[208:209], v245 offset:0
  v_mfma_f32_16x16x32_bf16 v[44:47], a[180:183], a[76:79], v[44:47]
  ds_read_b64_tr_b16 a[210:211], v245 offset:4096
  buffer_store_dwordx4 v[168:171], v0, s[36:39], s51 offen offset:2048 sc1
  v_mfma_f32_16x16x32_bf16 v[40:43], a[180:183], a[72:75], v[40:43]
  buffer_store_dwordx4 v[172:175], v0, s[36:39], s51 offen offset:3072 sc1
  ds_read_b64_tr_b16 a[212:213], v245 offset:8192
  v_mfma_f32_16x16x32_bf16 v[40:43], a[176:179], a[64:67], v[40:43]
  ds_read_b64_tr_b16 a[214:215], v245 offset:12288
  s_waitcnt lgkmcnt(12)
  v_mfma_f32_16x16x32_bf16 v[48:51], a[184:187], a[64:67], v[48:51]
  ds_read_b64_tr_b16 a[176:177], v246 offset:0
  v_mfma_f32_16x16x32_bf16 v[48:51], a[188:191], a[72:75], v[48:51]
  ds_read_b64_tr_b16 a[178:179], v246 offset:4096
  v_mfma_f32_16x16x32_bf16 v[52:55], a[188:191], a[76:79], v[52:55]
  ds_read_b64_tr_b16 a[180:181], v246 offset:8192
  v_mfma_f32_16x16x32_bf16 v[52:55], a[184:187], a[68:71], v[52:55]
  ds_read_b64_tr_b16 a[182:183], v246 offset:12288
  s_waitcnt lgkmcnt(12)
  v_mfma_f32_16x16x32_bf16 v[60:63], a[192:195], a[68:71], v[60:63]
  ds_read_b64_tr_b16 a[184:185], v247 offset:0
  v_mfma_f32_16x16x32_bf16 v[60:63], a[196:199], a[76:79], v[60:63]
  ds_read_b64_tr_b16 a[186:187], v247 offset:4096
  v_mfma_f32_16x16x32_bf16 v[56:59], a[196:199], a[72:75], v[56:59]
  ds_read_b64_tr_b16 a[188:189], v247 offset:8192
  v_mfma_f32_16x16x32_bf16 v[56:59], a[192:195], a[64:67], v[56:59]
  ds_read_b64_tr_b16 a[190:191], v247 offset:12288
  s_waitcnt lgkmcnt(12)
  v_mfma_f32_16x16x32_bf16 v[32:35], a[200:203], a[216:219], v[32:35]
  ds_read_b64_tr_b16 a[192:193], v244 offset:16384
  v_mfma_f32_16x16x32_bf16 v[32:35], a[204:207], a[224:227], v[32:35]
  ds_read_b64_tr_b16 a[194:195], v244 offset:20480
  v_mfma_f32_16x16x32_bf16 v[36:39], a[204:207], a[228:231], v[36:39]
  ds_read_b64_tr_b16 a[196:197], v244 offset:24576
  v_mfma_f32_16x16x32_bf16 v[36:39], a[200:203], a[220:223], v[36:39]
  ds_read_b64_tr_b16 a[198:199], v244 offset:28672
  s_waitcnt lgkmcnt(12)
  v_mfma_f32_16x16x32_bf16 v[44:47], a[208:211], a[220:223], v[44:47]
  ds_read_b64_tr_b16 a[200:201], v245 offset:16384
  v_mfma_f32_16x16x32_bf16 v[44:47], a[212:215], a[228:231], v[44:47]
  ds_read_b64_tr_b16 a[202:203], v245 offset:20480
  v_mfma_f32_16x16x32_bf16 v[40:43], a[212:215], a[224:227], v[40:43]
  ds_read_b64_tr_b16 a[204:205], v245 offset:24576
  v_mfma_f32_16x16x32_bf16 v[40:43], a[208:211], a[216:219], v[40:43]
  ds_read_b64_tr_b16 a[206:207], v245 offset:28672
  s_waitcnt lgkmcnt(12)
  v_mfma_f32_16x16x32_bf16 v[48:51], a[176:179], a[216:219], v[48:51]
  ds_read_b64_tr_b16 a[208:209], v246 offset:16384
  v_mfma_f32_16x16x32_bf16 v[48:51], a[180:183], a[224:227], v[48:51]
  ds_read_b64_tr_b16 a[210:211], v246 offset:20480
  v_mfma_f32_16x16x32_bf16 v[52:55], a[180:183], a[228:231], v[52:55]
  ds_read_b64_tr_b16 a[212:213], v246 offset:24576
  v_mfma_f32_16x16x32_bf16 v[52:55], a[176:179], a[220:223], v[52:55]
  ds_read_b64_tr_b16 a[214:215], v246 offset:28672
  s_waitcnt lgkmcnt(12)
  v_mfma_f32_16x16x32_bf16 v[60:63], a[184:187], a[220:223], v[60:63]
  ds_read_b64_tr_b16 a[176:177], v247 offset:16384
  v_mfma_f32_16x16x32_bf16 v[60:63], a[188:191], a[228:231], v[60:63]
  ds_read_b64_tr_b16 a[178:179], v247 offset:20480
  v_mfma_f32_16x16x32_bf16 v[56:59], a[188:191], a[224:227], v[56:59]
  ds_read_b64_tr_b16 a[180:181], v247 offset:24576
  v_mfma_f32_16x16x32_bf16 v[56:59], a[184:187], a[216:219], v[56:59]
  ds_read_b64_tr_b16 a[182:183], v247 offset:28672
  s_waitcnt lgkmcnt(12)
  v_mfma_f32_16x16x32_bf16 v[32:35], a[192:195], a[0:3], v[32:35]
  ds_read_b64_tr_b16 a[184:185], v244 offset:32768
  v_mfma_f32_16x16x32_bf16 v[32:35], a[196:199], a[8:11], v[32:35]
  ds_read_b64_tr_b16 a[186:187], v244 offset:36864
  v_mfma_f32_16x16x32_bf16 v[36:39], a[196:199], a[12:15], v[36:39]
  ds_read_b64_tr_b16 a[188:189], v244 offset:40960
  v_mfma_f32_16x16x32_bf16 v[36:39], a[192:195], a[4:7], v[36:39]
  ds_read_b64_tr_b16 a[190:191], v244 offset:45056
  s_waitcnt lgkmcnt(12)
  v_mfma_f32_16x16x32_bf16 v[44:47], a[200:203], a[4:7], v[44:47]
  ds_read_b64_tr_b16 a[192:193], v245 offset:32768
  v_mfma_f32_16x16x32_bf16 v[44:47], a[204:207], a[12:15], v[44:47]
  ds_read_b64_tr_b16 a[194:195], v245 offset:36864
  v_mfma_f32_16x16x32_bf16 v[40:43], a[204:207], a[8:11], v[40:43]
  ds_read_b64_tr_b16 a[196:197], v245 offset:40960
  v_mfma_f32_16x16x32_bf16 v[40:43], a[200:203], a[0:3], v[40:43]
  ds_read_b64_tr_b16 a[198:199], v245 offset:45056
  s_waitcnt lgkmcnt(12)
  v_mfma_f32_16x16x32_bf16 v[48:51], a[208:211], a[0:3], v[48:51]
  ds_read_b64_tr_b16 a[200:201], v246 offset:32768
  v_mfma_f32_16x16x32_bf16 v[48:51], a[212:215], a[8:11], v[48:51]
  ds_read_b64_tr_b16 a[202:203], v246 offset:36864
  v_mfma_f32_16x16x32_bf16 v[52:55], a[212:215], a[12:15], v[52:55]
  ds_read_b64_tr_b16 a[204:205], v246 offset:40960
  v_mfma_f32_16x16x32_bf16 v[52:55], a[208:211], a[4:7], v[52:55]
  ds_read_b64_tr_b16 a[206:207], v246 offset:45056
  s_waitcnt lgkmcnt(12)
  v_mfma_f32_16x16x32_bf16 v[60:63], a[176:179], a[4:7], v[60:63]
  ds_read_b64_tr_b16 a[208:209], v247 offset:32768
  v_mfma_f32_16x16x32_bf16 v[60:63], a[180:183], a[12:15], v[60:63]
  ds_read_b64_tr_b16 a[210:211], v247 offset:36864
  v_mfma_f32_16x16x32_bf16 v[56:59], a[180:183], a[8:11], v[56:59]
  ds_read_b64_tr_b16 a[212:213], v247 offset:40960
  v_mfma_f32_16x16x32_bf16 v[56:59], a[176:179], a[0:3], v[56:59]
  s_waitcnt vmcnt(0) lgkmcnt(11)
  s_barrier
  v_mfma_f32_16x16x32_bf16 v[32:35], a[184:187], a[16:19], v[32:35]
  ds_read_b64_tr_b16 a[214:215], v247 offset:45056
  ds_read_b64_tr_b16 a[176:177], v244 offset:49152
  v_mfma_f32_16x16x32_bf16 v[32:35], a[188:191], a[24:27], v[32:35]
  s_mov_b64 exec, 1
  buffer_store_dword v254, v0, s[36:39], s45 offen sc1
  s_mov_b64 exec, -1
  v_mfma_f32_16x16x32_bf16 v[36:39], a[188:191], a[28:31], v[36:39]
  ds_read_b64_tr_b16 a[178:179], v244 offset:53248
  ds_read_b64_tr_b16 a[180:181], v244 offset:57344
  v_mfma_f32_16x16x32_bf16 v[36:39], a[184:187], a[20:23], v[36:39]
  ds_read_b64_tr_b16 a[182:183], v244 offset:61440
  s_waitcnt lgkmcnt(12)
  v_mfma_f32_16x16x32_bf16 v[44:47], a[192:195], a[20:23], v[44:47]
  ds_read_b64_tr_b16 a[184:185], v245 offset:49152
  v_mfma_f32_16x16x32_bf16 v[44:47], a[196:199], a[28:31], v[44:47]
  ds_read_b64_tr_b16 a[186:187], v245 offset:53248
  v_mfma_f32_16x16x32_bf16 v[40:43], a[196:199], a[24:27], v[40:43]
  ds_read_b64_tr_b16 a[188:189], v245 offset:57344
  v_mfma_f32_16x16x32_bf16 v[40:43], a[192:195], a[16:19], v[40:43]
  ds_read_b64_tr_b16 a[190:191], v245 offset:61440
  s_waitcnt lgkmcnt(12)
  v_mfma_f32_16x16x32_bf16 v[48:51], a[200:203], a[16:19], v[48:51]
  ds_read_b64_tr_b16 a[192:193], v246 offset:49152
  v_mfma_f32_16x16x32_bf16 v[48:51], a[204:207], a[24:27], v[48:51]
  ds_read_b64_tr_b16 a[194:195], v246 offset:53248
  v_mfma_f32_16x16x32_bf16 v[52:55], a[204:207], a[28:31], v[52:55]
  ds_read_b64_tr_b16 a[196:197], v246 offset:57344
  v_mfma_f32_16x16x32_bf16 v[52:55], a[200:203], a[20:23], v[52:55]
  ds_read_b64_tr_b16 a[198:199], v246 offset:61440
  s_waitcnt lgkmcnt(12)
  v_mfma_f32_16x16x32_bf16 v[60:63], a[208:211], a[20:23], v[60:63]
  ds_read_b64_tr_b16 a[200:201], v247 offset:49152
  v_mfma_f32_16x16x32_bf16 v[60:63], a[212:215], a[28:31], v[60:63]
  ds_read_b64_tr_b16 a[202:203], v247 offset:53248
  v_mfma_f32_16x16x32_bf16 v[56:59], a[212:215], a[24:27], v[56:59]
  ds_read_b64_tr_b16 a[204:205], v247 offset:57344
  v_mfma_f32_16x16x32_bf16 v[56:59], a[208:211], a[16:19], v[56:59]
  ds_read_b64_tr_b16 a[206:207], v247 offset:61440
  s_waitcnt lgkmcnt(12)
  v_mfma_f32_16x16x32_bf16 v[32:35], a[176:179], a[32:35], v[32:35]
  v_mfma_f32_16x16x32_bf16 v[32:35], a[180:183], a[40:43], v[32:35]
  v_mfma_f32_16x16x32_bf16 v[36:39], a[180:183], a[44:47], v[36:39]
  v_mfma_f32_16x16x32_bf16 v[36:39], a[176:179], a[36:39], v[36:39]
  s_waitcnt lgkmcnt(8)
  v_mfma_f32_16x16x32_bf16 v[44:47], a[184:187], a[36:39], v[44:47]
  v_mfma_f32_16x16x32_bf16 v[44:47], a[188:191], a[44:47], v[44:47]
  v_mfma_f32_16x16x32_bf16 v[40:43], a[188:191], a[40:43], v[40:43]
  v_mfma_f32_16x16x32_bf16 v[40:43], a[184:187], a[32:35], v[40:43]
  s_waitcnt lgkmcnt(4)
  v_mfma_f32_16x16x32_bf16 v[48:51], a[192:195], a[32:35], v[48:51]
  v_mfma_f32_16x16x32_bf16 v[48:51], a[196:199], a[40:43], v[48:51]
  v_mfma_f32_16x16x32_bf16 v[52:55], a[196:199], a[44:47], v[52:55]
  v_mfma_f32_16x16x32_bf16 v[52:55], a[192:195], a[36:39], v[52:55]
  s_waitcnt lgkmcnt(0)
  v_mfma_f32_16x16x32_bf16 v[60:63], a[200:203], a[36:39], v[60:63]
  v_mfma_f32_16x16x32_bf16 v[60:63], a[204:207], a[44:47], v[60:63]
  v_mfma_f32_16x16x32_bf16 v[56:59], a[204:207], a[40:43], v[56:59]
  v_mfma_f32_16x16x32_bf16 v[56:59], a[200:203], a[32:35], v[56:59]
  buffer_load_dword v139, v132, s[36:39], s29 offen sc1
  v_fmac_f32 v64, v176, v32
  v_fmac_f32 v65, v177, v33
  v_fmac_f32 v66, v178, v34
  v_fmac_f32 v67, v179, v35
  v_fmac_f32 v80, v176, v36
  v_fmac_f32 v81, v177, v37
  v_fmac_f32 v82, v178, v38
  v_fmac_f32 v83, v179, v39
  v_fmac_f32 v68, v180, v40
  v_fmac_f32 v69, v181, v41
  v_fmac_f32 v70, v182, v42
  v_fmac_f32 v71, v183, v43
  v_fmac_f32 v84, v180, v44
  v_fmac_f32 v85, v181, v45
  v_fmac_f32 v86, v182, v46
  v_fmac_f32 v87, v183, v47
  v_fmac_f32 v72, v184, v48
  v_fmac_f32 v73, v185, v49
  v_fmac_f32 v74, v186, v50
  v_fmac_f32 v75, v187, v51
  v_fmac_f32 v88, v184, v52
  v_fmac_f32 v89, v185, v53
  v_fmac_f32 v90, v186, v54
  v_fmac_f32 v91, v187, v55
  v_fmac_f32 v76, v188, v56
  v_fmac_f32 v77, v189, v57
  v_fmac_f32 v78, v190, v58
  v_fmac_f32 v79, v191, v59
  v_fmac_f32 v92, v188, v60
  v_fmac_f32 v93, v189, v61
  v_fmac_f32 v94, v190, v62
  v_fmac_f32 v95, v191, v63
  s_waitcnt vmcnt(0)
  v_cmp_ne_u32 vcc, 1, v139
  s_nop 4
  s_cbranch_vccnz CK28s
CK28x:
  buffer_load_dwordx4 v[96:99], v0, s[36:39], s52 offen offset:0 sc1
  buffer_load_dwordx4 v[100:103], v0, s[36:39], s52 offen offset:1024 sc1
  buffer_load_dwordx4 v[104:107], v0, s[36:39], s52 offen offset:2048 sc1
  buffer_load_dwordx4 v[108:111], v0, s[36:39], s52 offen offset:3072 sc1
  buffer_load_dwordx4 v[112:115], v0, s[36:39], s53 offen offset:0 sc1
  buffer_load_dwordx4 v[116:119], v0, s[36:39], s53 offen offset:1024 sc1
  buffer_load_dwordx4 v[120:123], v0, s[36:39], s53 offen offset:2048 sc1
  buffer_load_dwordx4 v[124:127], v0, s[36:39], s53 offen offset:3072 sc1
  s_waitcnt vmcnt(7)
  v_fmac_f32 v64, v176, v96
  v_fmac_f32 v65, v177, v97
  v_fmac_f32 v66, v178, v98
  v_fmac_f32 v67, v179, v99
  v_cvt_pk_bf16_f32 v192, v64, v65
  v_cvt_pk_bf16_f32 v193, v66, v67
  ds_write_b64 v140, v[192:193] offset:0
  s_waitcnt vmcnt(6)
  v_fmac_f32 v80, v176, v100
  v_fmac_f32 v81, v177, v101
  v_fmac_f32 v82, v178, v102
  v_fmac_f32 v83, v179, v103
  v_cvt_pk_bf16_f32 v200, v80, v81
  v_cvt_pk_bf16_f32 v201, v82, v83
  ds_write_b64 v140, v[200:201] offset:2048
  s_waitcnt vmcnt(5)
  v_fmac_f32 v68, v180, v104
  v_fmac_f32 v69, v181, v105
  v_fmac_f32 v70, v182, v106
  v_fmac_f32 v71, v183, v107
  v_cvt_pk_bf16_f32 v194, v68, v69
  v_cvt_pk_bf16_f32 v195, v70, v71
  ds_write_b64 v141, v[194:195] offset:0
  s_waitcnt vmcnt(4)
  v_fmac_f32 v84, v180, v108
  v_fmac_f32 v85, v181, v109
  v_fmac_f32 v86, v182, v110
  v_fmac_f32 v87, v183, v111
  v_cvt_pk_bf16_f32 v202, v84, v85
  v_cvt_pk_bf16_f32 v203, v86, v87
  ds_write_b64 v141, v[202:203] offset:2048
  s_waitcnt vmcnt(3)
  v_fmac_f32 v72, v184, v112
  v_fmac_f32 v73, v185, v113
  v_fmac_f32 v74, v186, v114
  v_fmac_f32 v75, v187, v115
  v_cvt_pk_bf16_f32 v196, v72, v73
  v_cvt_pk_bf16_f32 v197, v74, v75
  ds_write_b64 v142, v[196:197] offset:0
  s_waitcnt vmcnt(2)
  v_fmac_f32 v88, v184, v116
  v_fmac_f32 v89, v185, v117
  v_fmac_f32 v90, v186, v118
  v_fmac_f32 v91, v187, v119
  v_cvt_pk_bf16_f32 v204, v88, v89
  v_cvt_pk_bf16_f32 v205, v90, v91
  ds_write_b64 v142, v[204:205] offset:2048
  s_waitcnt vmcnt(1)
  v_fmac_f32 v76, v188, v120
  v_fmac_f32 v77, v189, v121
  v_fmac_f32 v78, v190, v122
  v_fmac_f32 v79, v191, v123
  v_cvt_pk_bf16_f32 v198, v76, v77
  v_cvt_pk_bf16_f32 v199, v78, v79
  ds_write_b64 v143, v[198:199] offset:0
  s_waitcnt vmcnt(0)
  v_fmac_f32 v92, v188, v124
  v_fmac_f32 v93, v189, v125
  v_fmac_f32 v94, v190, v126
  v_fmac_f32 v95, v191, v127
  v_cvt_pk_bf16_f32 v206, v92, v93
  v_cvt_pk_bf16_f32 v207, v94, v95
  ds_write_b64 v143, v[206:207] offset:2048
  ds_read_b128 v[64:67], v255 offset:0
  ds_read_b128 v[68:71], v255 offset:1024
  ds_read_b128 v[72:75], v255 offset:2048
  ds_read_b128 v[76:79], v255 offset:3072
  s_waitcnt lgkmcnt(3)
  buffer_store_dwordx4 v[64:67], v252, s[32:35], s73 offen
  s_waitcnt lgkmcnt(2)
  buffer_store_dwordx4 v[68:71], v253, s[32:35], s73 offen
  s_waitcnt lgkmcnt(1)
  buffer_store_dwordx4 v[72:75], v252, s[32:35], s49 offen
  s_waitcnt lgkmcnt(0)
  buffer_store_dwordx4 v[76:79], v253, s[32:35], s49 offen
X_k3_main_kernel:
  s_endpgm
CK7s:
  s_mov_b32 s46, 60000
CK7:
  buffer_load_dwordx4 v[156:159], v247, s[36:39], s48 offen sc1
  s_sub_u32 s46, s46, 1
  s_cmp_eq_u32 s46, 0
  s_waitcnt vmcnt(0)
  s_cbranch_scc1 CK7x
  v_and_b32 v156, v156, v157
  v_and_b32 v158, v158, v159
  v_and_b32 v156, v156, v158
  v_cmp_ne_u32 vcc, 1, v156
  s_nop 4
  s_cbranch_vccnz CK7
  s_branch CK7x
CK16s:
  s_mov_b32 s46, 60000
CK16:
  buffer_load_dword v23, v22, s[36:39], s28 offen sc1
  s_sub_u32 s46, s46, 1
  s_cmp_eq_u32 s46, 0
  s_waitcnt vmcnt(0)
  s_cbranch_scc1 CK16x
  v_cmp_ne_u32 vcc, 1, v23
  s_nop 4
  s_cbranch_vccnz CK16
  s_branch CK16x
CK21s:
  s_mov_b32 s46, 60000
CK21:
  buffer_load_dword v139, v138, s[36:39], s57 offen sc1
  s_sub_u32 s46, s46, 1
  s_cmp_eq_u32 s46, 0
  s_waitcnt vmcnt(0)
  s_cbranch_scc1 CK21x
  v_cmp_ne_u32 vcc, 1, v139
  s_nop 4
  s_cbranch_vccnz CK21
  s_branch CK21x
CK25s:
  s_mov_b32 s46, 60000
CK25:
  buffer_load_dword v139, v138, s[36:39], s57 offen sc1
  s_sub_u32 s46, s46, 1
  s_cmp_eq_u32 s46, 0
  s_waitcnt vmcnt(0)
  s_cbranch_scc1 CK25x
  v_cmp_ne_u32 vcc, 1, v139
  s_nop 4
  s_cbranch_vccnz CK25
  s_branch CK25x
CK28s:
  s_mov_b32 s46, 60000
CK28:
  buffer_load_dword v139, v132, s[36:39], s29 offen sc1
  s_sub_u32 s46, s46, 1
  s_cmp_eq_u32 s46, 0
  s_waitcnt vmcnt(0)
  s_cbranch_scc1 CK28x
  v_cmp_ne_u32 vcc, 1, v139
  s_nop 4
  s_cbranch_vccnz CK28
  s_branch CK28x
code_end:
.fill 2048, 4, 0xBF800000
.section .rodata,"a"
.p2align 6
.amdhsa_kernel k1_mod_kernel
  .amdhsa_next_free_vgpr 77
  .amdhsa_next_free_sgpr 42
  .amdhsa_accum_offset 80
  .amdhsa_group_segment_fixed_size 0
  .amdhsa_kernarg_size 96
  .amdhsa_user_sgpr_count 2
  .amdhsa_user_sgpr_kernarg_segment_ptr 1
  .amdhsa_system_sgpr_workgroup_id_x 1
  .amdhsa_float_denorm_mode_32 3
.end_amdhsa_kernel
.p2align 6
.amdhsa_kernel k3_main_kernel
  .amdhsa_next_free_vgpr 512
  .amdhsa_next_free_sgpr 102
  .amdhsa_accum_offset 256
  .amdhsa_group_segment_fixed_size 0
  .amdhsa_kernarg_size 96
  .amdhsa_user_sgpr_count 2
  .amdhsa_user_sgpr_kernarg_segment_ptr 1
  .amdhsa_system_sgpr_workgroup_id_x 1
  .amdhsa_float_denorm_mode_32 3
.end_amdhsa_kernel
```

```asm
; @launch kernel=k1_mod_kernel grid=(256,1,1) block=(256,1,1) lds=1024
; @launch kernel=k3_main_kernel grid=(256,1,1) block=(256,1,1) lds=163840
.amdgcn_target "amdgcn-amd-amdhsa--gfx950"
.text
.globl k1_mod_kernel
.type k1_mod_kernel,@function
.p2align 8
k1_mod_kernel:
  s_cmp_ge_u32 s2, 256
  s_cbranch_scc1 X_k1_mod_kernel
  s_load_dwordx2 s[4:5], s[0:1], 64
  s_load_dwordx2 s[8:9], s[0:1], 56
  s_load_dwordx2 s[12:13], s[0:1], 88
  s_load_dwordx2 s[16:17], s[0:1], 0
  s_load_dwordx2 s[20:21], s[0:1], 8
  s_load_dwordx2 s[24:25], s[0:1], 88
  s_load_dwordx2 s[32:33], s[0:1], 88
  v_lshrrev_b32 v11, 6, v0
  v_and_b32 v10, 63, v0
  v_readfirstlane_b32 s36, v11
  s_mov_b32 s37, s2
  s_mov_b32 s6, 12582912
  s_mov_b32 s7, 0x20000
  s_mov_b32 s10, 2048
  s_mov_b32 s11, 0x20000
  s_mov_b32 s14, 98304
  s_mov_b32 s15, 0x20000
  s_mov_b32 s18, 4194304
  s_mov_b32 s19, 0x20000
  s_mov_b32 s22, 6291456
  s_mov_b32 s23, 0x20000
  s_mov_b32 s26, 262144
  s_mov_b32 s27, 0x20000
  s_mov_b32 s34, 1048576
  s_mov_b32 s35, 0x20000
  s_waitcnt lgkmcnt(0)
  s_add_u32 s24, s24, 5242880
  s_addc_u32 s25, s25, 0
  s_cmp_lg_u32 s36, 2
  s_cbranch_scc1 F_zk1_mod_kernel
  s_lshl_b32 s28, s2, 7
  s_lshr_b32 s29, s2, 2
  s_lshl_b32 s29, s29, 7
  v_lshrrev_b32 v8, 3, v10
  v_mov_b32 v4, s28
  v_mov_b32 v5, s29
  v_cmp_eq_u32 vcc, 2, v8
  v_and_b32 v9, 7, v10
  v_lshlrev_b32 v8, 15, v8
  v_cndmask_b32 v4, v4, v5, vcc
  v_lshl_add_u32 v8, v9, 4, v8
  v_add_u32 v8, v8, v4
  v_mov_b32 v4, 0
  v_mov_b32 v5, 0
  v_mov_b32 v6, 0
  v_mov_b32 v7, 0
  buffer_store_dwordx4 v[4:7], v8, s[24:27], 0 offen
  s_nop 1
F_zk1_mod_kernel:
  s_cmp_lg_u32 s36, 1
  s_cbranch_scc1 F_sent
  v_mov_b32 v4, -1
  v_mov_b32 v5, -1
  v_mov_b32 v6, -1
  v_mov_b32 v7, -1
  v_lshlrev_b32 v8, 4, v10
  v_lshlrev_b32 v9, 2, v10
  s_lshl_b32 s28, s2, 11
  s_add_u32 s28, s28, 524288
  buffer_store_dwordx4 v[4:7], v8, s[32:35], s28 offen
  buffer_store_dwordx4 v[4:7], v8, s[32:35], s28 offen offset:1024
  s_and_b32 s28, s2, 3
  s_mul_i32 s28, s28, 24576
  s_lshr_b32 s29, s2, 2
  s_lshl_b32 s29, s29, 8
  s_add_u32 s28, s28, s29
  s_add_u32 s28, s28, 8192
  buffer_store_dword v4, v9, s[32:35], s28 offen
  s_nop 1
F_sent:
  s_cmp_ge_u32 s2, 128
  s_cbranch_scc1 T_k1_mod_kernel
  s_lshr_b32 s40, s37, 2
  s_add_u32 s40, s40, 0
  s_and_b32 s41, s37, 3
  s_lshl_b32 s38, s41, 8
  s_lshl_b32 s39, s36, 6
  s_add_u32 s38, s38, s39
  v_and_b32 v12, 0x38, v10
  v_add_u32 v12, s38, v12
  v_lshlrev_b32 v13, 1, v12
  v_mul_u32_u24 v16, 12288, v12
  v_and_b32 v14, 7, v10
  v_lshl_add_u32 v16, v14, 4, v16
  s_lshl_b32 s39, s40, 7
  buffer_load_dwordx4 v[20:23], v13, s[8:11], 0 offen
  buffer_load_dwordx4 v[32:35], v16, s[4:7], s39 offen nt
  s_add_u32 s39, s39, 12288
  buffer_load_dwordx4 v[36:39], v16, s[4:7], s39 offen nt
  s_add_u32 s39, s39, 12288
  buffer_load_dwordx4 v[40:43], v16, s[4:7], s39 offen nt
  s_add_u32 s39, s39, 12288
  buffer_load_dwordx4 v[44:47], v16, s[4:7], s39 offen nt
  s_add_u32 s39, s39, 12288
  buffer_load_dwordx4 v[48:51], v16, s[4:7], s39 offen nt
  s_add_u32 s39, s39, 12288
  buffer_load_dwordx4 v[52:55], v16, s[4:7], s39 offen nt
  s_add_u32 s39, s39, 12288
  buffer_load_dwordx4 v[56:59], v16, s[4:7], s39 offen nt
  s_add_u32 s39, s39, 12288
  buffer_load_dwordx4 v[60:63], v16, s[4:7], s39 offen nt
  s_lshr_b32 s44, s37, 3
  s_lshl_b32 s44, s44, 13
  s_cmp_lg_u32 s36, 3
  s_cbranch_scc1 TC1_k1_mod_kernel
  s_cmp_ge_u32 s44, code_end-k3_main_kernel
  s_cbranch_scc1 TC1_k1_mod_kernel
  s_getpc_b64 s[42:43]
TC1_k1_mod_kernelp:
  s_add_u32 s44, s44, k3_main_kernel-TC1_k1_mod_kernelp
  s_ashr_i32 vcc_hi, s44, 31
  s_add_u32 s42, s42, s44
  s_addc_u32 s43, s43, vcc_hi
  v_lshlrev_b32 v74, 7, v10
  v_mov_b32 v75, s43
  v_add_co_u32 v74, vcc, s42, v74
  s_nop 1
  v_addc_co_u32 v75, vcc, 0, v75, vcc
  global_load_dword v76, v[74:75], off
TC1_k1_mod_kernel:
  v_lshlrev_b32 v74, 7, v10
  s_lshl_b32 s42, s37, 1
  s_add_u32 s42, s42, s36
  s_lshl_b32 s42, s42, 13
  s_cmp_lt_u32 s36, 2
  s_cselect_b32 s42, s42, 0x40000000
  buffer_load_dword v76, v74, s[16:19], s42 offen
  v_lshlrev_b32 v74, 7, v10
  s_mul_i32 s42, s36, 256
  s_add_u32 s42, s42, s37
  s_lshl_b32 s42, s42, 13
  s_add_u32 s43, s42, 0
  s_cmp_lt_u32 s43, 2095104
  s_cselect_b32 s43, s43, 0x40000000
  buffer_load_dword v76, v74, s[20:23], s43 offen
  s_waitcnt vmcnt(10)
  v_lshlrev_b32 v24, 16, v20
  v_and_b32 v25, 0xffff0000, v20
  v_lshlrev_b32 v26, 16, v21
  v_and_b32 v27, 0xffff0000, v21
  v_lshlrev_b32 v28, 16, v22
  v_and_b32 v29, 0xffff0000, v22
  v_lshlrev_b32 v30, 16, v23
  v_and_b32 v31, 0xffff0000, v23
  v_mul_f32 v64, 0xbfb8aa3b, v24
  v_mul_f32 v65, 0xbfb8aa3b, v25
  v_mul_f32 v66, 0xbfb8aa3b, v26
  v_mul_f32 v67, 0xbfb8aa3b, v27
  v_mul_f32 v68, 0xbfb8aa3b, v28
  v_mul_f32 v69, 0xbfb8aa3b, v29
  v_mul_f32 v70, 0xbfb8aa3b, v30
  v_mul_f32 v71, 0xbfb8aa3b, v31
  v_exp_f32 v64, v64
  v_exp_f32 v65, v65
  v_exp_f32 v66, v66
  v_exp_f32 v67, v67
  v_exp_f32 v68, v68
  v_exp_f32 v69, v69
  v_exp_f32 v70, v70
  v_exp_f32 v71, v71
  v_add_f32 v64, 1.0, v64
  v_add_f32 v65, 1.0, v65
  v_add_f32 v66, 1.0, v66
  v_add_f32 v67, 1.0, v67
  v_add_f32 v68, 1.0, v68
  v_add_f32 v69, 1.0, v69
  v_add_f32 v70, 1.0, v70
  v_add_f32 v71, 1.0, v71
  v_rcp_f32 v64, v64
  v_rcp_f32 v65, v65
  v_rcp_f32 v66, v66
  v_rcp_f32 v67, v67
  v_rcp_f32 v68, v68
  v_rcp_f32 v69, v69
  v_rcp_f32 v70, v70
  v_rcp_f32 v71, v71
  v_mul_f32 v24, v24, v64
  v_mul_f32 v25, v25, v65
  v_mul_f32 v26, v26, v66
  v_mul_f32 v27, v27, v67
  v_mul_f32 v28, v28, v68
  v_mul_f32 v29, v29, v69
  v_mul_f32 v30, v30, v70
  v_mul_f32 v31, v31, v71
  v_cvt_pk_bf16_f32 v72, v24, v25
  v_lshlrev_b32 v24, 16, v72
  v_and_b32 v25, 0xffff0000, v72
  v_cvt_pk_bf16_f32 v72, v26, v27
  v_lshlrev_b32 v26, 16, v72
  v_and_b32 v27, 0xffff0000, v72
  v_cvt_pk_bf16_f32 v72, v28, v29
  v_lshlrev_b32 v28, 16, v72
  v_and_b32 v29, 0xffff0000, v72
  v_cvt_pk_bf16_f32 v72, v30, v31
  v_lshlrev_b32 v30, 16, v72
  v_and_b32 v31, 0xffff0000, v72
  v_and_b32 v12, 7, v10
  v_lshlrev_b32 v12, 5, v12
  v_lshrrev_b32 v13, 4, v10
  v_lshl_add_u32 v12, v13, 3, v12
  s_lshl_b32 s38, s36, 8
  v_add_u32 v12, s38, v12
  v_lshlrev_b32 v13, 2, v10
  s_mul_i32 s38, s41, 24576
  s_lshl_b32 s39, s40, 8
  s_add_u32 s38, s38, s39
  s_waitcnt vmcnt(9)
  v_lshlrev_b32 v72, 16, v32
  v_and_b32 v73, 0xffff0000, v32
  v_mul_f32 v64, v24, v72
  v_mul_f32 v65, v24, v73
  v_lshlrev_b32 v72, 16, v33
  v_and_b32 v73, 0xffff0000, v33
  v_mul_f32 v66, v24, v72
  v_mul_f32 v67, v24, v73
  v_lshlrev_b32 v72, 16, v34
  v_and_b32 v73, 0xffff0000, v34
  v_mul_f32 v68, v24, v72
  v_mul_f32 v69, v24, v73
  v_lshlrev_b32 v72, 16, v35
  v_and_b32 v73, 0xffff0000, v35
  v_mul_f32 v70, v24, v72
  v_mul_f32 v71, v24, v73
  s_waitcnt vmcnt(8)
  v_lshlrev_b32 v72, 16, v36
  v_and_b32 v73, 0xffff0000, v36
  v_fmac_f32 v64, v25, v72
  v_fmac_f32 v65, v25, v73
  v_lshlrev_b32 v72, 16, v37
  v_and_b32 v73, 0xffff0000, v37
  v_fmac_f32 v66, v25, v72
  v_fmac_f32 v67, v25, v73
  v_lshlrev_b32 v72, 16, v38
  v_and_b32 v73, 0xffff0000, v38
  v_fmac_f32 v68, v25, v72
  v_fmac_f32 v69, v25, v73
  v_lshlrev_b32 v72, 16, v39
  v_and_b32 v73, 0xffff0000, v39
  v_fmac_f32 v70, v25, v72
  v_fmac_f32 v71, v25, v73
  s_waitcnt vmcnt(7)
  v_lshlrev_b32 v72, 16, v40
  v_and_b32 v73, 0xffff0000, v40
  v_fmac_f32 v64, v26, v72
  v_fmac_f32 v65, v26, v73
  v_lshlrev_b32 v72, 16, v41
  v_and_b32 v73, 0xffff0000, v41
  v_fmac_f32 v66, v26, v72
  v_fmac_f32 v67, v26, v73
  v_lshlrev_b32 v72, 16, v42
  v_and_b32 v73, 0xffff0000, v42
  v_fmac_f32 v68, v26, v72
  v_fmac_f32 v69, v26, v73
  v_lshlrev_b32 v72, 16, v43
  v_and_b32 v73, 0xffff0000, v43
  v_fmac_f32 v70, v26, v72
  v_fmac_f32 v71, v26, v73
  s_waitcnt vmcnt(6)
  v_lshlrev_b32 v72, 16, v44
  v_and_b32 v73, 0xffff0000, v44
  v_fmac_f32 v64, v27, v72
  v_fmac_f32 v65, v27, v73
  v_lshlrev_b32 v72, 16, v45
  v_and_b32 v73, 0xffff0000, v45
  v_fmac_f32 v66, v27, v72
  v_fmac_f32 v67, v27, v73
  v_lshlrev_b32 v72, 16, v46
  v_and_b32 v73, 0xffff0000, v46
  v_fmac_f32 v68, v27, v72
  v_fmac_f32 v69, v27, v73
  v_lshlrev_b32 v72, 16, v47
  v_and_b32 v73, 0xffff0000, v47
  v_fmac_f32 v70, v27, v72
  v_fmac_f32 v71, v27, v73
  s_waitcnt vmcnt(5)
  v_lshlrev_b32 v72, 16, v48
  v_and_b32 v73, 0xffff0000, v48
  v_fmac_f32 v64, v28, v72
  v_fmac_f32 v65, v28, v73
  v_lshlrev_b32 v72, 16, v49
  v_and_b32 v73, 0xffff0000, v49
  v_fmac_f32 v66, v28, v72
  v_fmac_f32 v67, v28, v73
  v_lshlrev_b32 v72, 16, v50
  v_and_b32 v73, 0xffff0000, v50
  v_fmac_f32 v68, v28, v72
  v_fmac_f32 v69, v28, v73
  v_lshlrev_b32 v72, 16, v51
  v_and_b32 v73, 0xffff0000, v51
  v_fmac_f32 v70, v28, v72
  v_fmac_f32 v71, v28, v73
  s_waitcnt vmcnt(4)
  v_lshlrev_b32 v72, 16, v52
  v_and_b32 v73, 0xffff0000, v52
  v_fmac_f32 v64, v29, v72
  v_fmac_f32 v65, v29, v73
  v_lshlrev_b32 v72, 16, v53
  v_and_b32 v73, 0xffff0000, v53
  v_fmac_f32 v66, v29, v72
  v_fmac_f32 v67, v29, v73
  v_lshlrev_b32 v72, 16, v54
  v_and_b32 v73, 0xffff0000, v54
  v_fmac_f32 v68, v29, v72
  v_fmac_f32 v69, v29, v73
  v_lshlrev_b32 v72, 16, v55
  v_and_b32 v73, 0xffff0000, v55
  v_fmac_f32 v70, v29, v72
  v_fmac_f32 v71, v29, v73
  s_waitcnt vmcnt(3)
  v_lshlrev_b32 v72, 16, v56
  v_and_b32 v73, 0xffff0000, v56
  v_fmac_f32 v64, v30, v72
  v_fmac_f32 v65, v30, v73
  v_lshlrev_b32 v72, 16, v57
  v_and_b32 v73, 0xffff0000, v57
  v_fmac_f32 v66, v30, v72
  v_fmac_f32 v67, v30, v73
  v_lshlrev_b32 v72, 16, v58
  v_and_b32 v73, 0xffff0000, v58
  v_fmac_f32 v68, v30, v72
  v_fmac_f32 v69, v30, v73
  v_lshlrev_b32 v72, 16, v59
  v_and_b32 v73, 0xffff0000, v59
  v_fmac_f32 v70, v30, v72
  v_fmac_f32 v71, v30, v73
  s_waitcnt vmcnt(2)
  v_lshlrev_b32 v72, 16, v60
  v_and_b32 v73, 0xffff0000, v60
  v_fmac_f32 v64, v31, v72
  v_fmac_f32 v65, v31, v73
  v_lshlrev_b32 v72, 16, v61
  v_and_b32 v73, 0xffff0000, v61
  v_fmac_f32 v66, v31, v72
  v_fmac_f32 v67, v31, v73
  v_lshlrev_b32 v72, 16, v62
  v_and_b32 v73, 0xffff0000, v62
  v_fmac_f32 v68, v31, v72
  v_fmac_f32 v69, v31, v73
  v_lshlrev_b32 v72, 16, v63
  v_and_b32 v73, 0xffff0000, v63
  v_fmac_f32 v70, v31, v72
  v_fmac_f32 v71, v31, v73
  s_nop 1
  v_permlane32_swap_b32 v64, v68
  v_permlane32_swap_b32 v65, v69
  v_permlane32_swap_b32 v66, v70
  v_permlane32_swap_b32 v67, v71
  s_nop 0
  v_add_f32 v64, v64, v68
  v_add_f32 v65, v65, v69
  v_add_f32 v66, v66, v70
  v_add_f32 v67, v67, v71
  s_nop 1
  v_permlane16_swap_b32 v64, v66
  v_permlane16_swap_b32 v65, v67
  s_nop 0
  v_add_f32 v64, v64, v66
  v_add_f32 v65, v65, v67
  s_nop 1
  v_add_f32_dpp v64, v64, v64 row_ror:8 row_mask:0xf bank_mask:0xf
  v_add_f32_dpp v65, v65, v65 row_ror:8 row_mask:0xf bank_mask:0xf
  ds_write_b64 v12, v[64:65]
  s_waitcnt lgkmcnt(0)
  s_barrier
  s_cmp_lg_u32 s36, 0
  s_cbranch_scc1 E_k1_mod_kernel
  ds_read_b32 v64, v13 offset:0
  ds_read_b32 v65, v13 offset:256
  ds_read_b32 v66, v13 offset:512
  ds_read_b32 v67, v13 offset:768
  s_waitcnt lgkmcnt(0)
  v_add_f32 v64, v64, v65
  v_add_f32 v66, v66, v67
  v_add_f32 v64, v64, v66
  buffer_store_dword v64, v13, s[12:15], s38 offen
  s_branch E_k1_mod_kernel
T_k1_mod_kernel:
  s_lshr_b32 s44, s37, 3
  s_lshl_b32 s44, s44, 13
  s_cmp_lg_u32 s36, 3
  s_cbranch_scc1 TC2_k1_mod_kernel
  s_cmp_ge_u32 s44, code_end-k3_main_kernel
  s_cbranch_scc1 TC2_k1_mod_kernel
  s_getpc_b64 s[42:43]
TC2_k1_mod_kernelp:
  s_add_u32 s44, s44, k3_main_kernel-TC2_k1_mod_kernelp
  s_ashr_i32 vcc_hi, s44, 31
  s_add_u32 s42, s42, s44
  s_addc_u32 s43, s43, vcc_hi
  v_lshlrev_b32 v74, 7, v10
  v_mov_b32 v75, s43
  v_add_co_u32 v74, vcc, s42, v74
  s_nop 1
  v_addc_co_u32 v75, vcc, 0, v75, vcc
  global_load_dword v76, v[74:75], off
TC2_k1_mod_kernel:
  v_lshlrev_b32 v74, 7, v10
  s_lshl_b32 s42, s37, 1
  s_add_u32 s42, s42, s36
  s_lshl_b32 s42, s42, 13
  s_cmp_lt_u32 s36, 2
  s_cselect_b32 s42, s42, 0x40000000
  buffer_load_dword v76, v74, s[16:19], s42 offen
  v_lshlrev_b32 v74, 7, v10
  s_mul_i32 s42, s36, 256
  s_add_u32 s42, s42, s37
  s_lshl_b32 s42, s42, 13
  s_add_u32 s43, s42, 0
  s_cmp_lt_u32 s43, 2095104
  s_cselect_b32 s43, s43, 0x40000000
  buffer_load_dword v76, v74, s[20:23], s43 offen
  s_sub_u32 s37, s37, 128
  s_waitcnt vmcnt(0)
  v_lshlrev_b32 v74, 7, v10
  s_mul_i32 s42, s36, 128
  s_add_u32 s42, s42, s37
  s_lshl_b32 s42, s42, 13
  s_add_u32 s43, s42, 0
  s_cmp_lt_u32 s43, 4196352
  s_cselect_b32 s43, s43, 0x40000000
  s_add_u32 s43, s43, 2095104
  buffer_load_dword v76, v74, s[20:23], s43 offen
  s_add_u32 s43, s42, 4194304
  s_cmp_lt_u32 s43, 4196352
  s_cselect_b32 s43, s43, 0x40000000
  s_add_u32 s43, s43, 2095104
  buffer_load_dword v76, v74, s[20:23], s43 offen
E_k1_mod_kernel:
X_k1_mod_kernel:
  s_endpgm
.globl k3_main_kernel
.type k3_main_kernel,@function
.p2align 8
k3_main_kernel:
  s_cmp_ge_u32 s2, 256
  s_cbranch_scc1 X_k3_main_kernel
  s_load_dwordx2 s[4:5], s[0:1], 0
  s_load_dwordx2 s[36:37], s[0:1], 88
  s_load_dwordx2 s[8:9], s[0:1], 8
  s_load_dwordx2 s[28:29], s[0:1], 64
  s_load_dwordx2 s[40:41], s[0:1], 56
  s_load_dwordx2 s[12:13], s[0:1], 16
  s_load_dwordx2 s[16:17], s[0:1], 32
  s_load_dwordx2 s[20:21], s[0:1], 40
  s_load_dwordx2 s[24:25], s[0:1], 48
  s_load_dwordx2 s[32:33], s[0:1], 72
  v_lshrrev_b32 v1, 6, v0
  v_and_b32 v10, 63, v0
  v_readfirstlane_b32 s44, v1
  v_lshlrev_b32 v0, 4, v10
  s_mov_b32 s6, 4194304
  s_mov_b32 s7, 0x20000
  s_mov_b32 s38, 50331648
  s_mov_b32 s39, 0x20000
  s_mov_b32 s10, 6291456
  s_mov_b32 s11, 0x20000
  s_mov_b32 s30, 12582912
  s_mov_b32 s31, 0x20000
  s_mov_b32 s42, 2048
  s_mov_b32 s43, 0x20000
  s_mov_b32 s14, 2097152
  s_mov_b32 s15, 0x20000
  s_mov_b32 s18, 7340032
  s_mov_b32 s19, 0x20000
  s_mov_b32 s22, 7340032
  s_mov_b32 s23, 0x20000
  s_mov_b32 s26, 7340032
  s_mov_b32 s27, 0x20000
  s_mov_b32 s34, 4194304
  s_mov_b32 s35, 0x20000
  v_and_b32 v12, 7, v10
  v_lshrrev_b32 v13, 3, v10
  v_lshlrev_b32 v132, 11, v12
  v_lshl_add_u32 v132, v13, 4, v132
  s_lshl_b32 s48, s2, 14
  s_lshl_b32 s49, s44, 9
  s_add_u32 s48, s48, s49
  s_lshl_b32 s49, s44, 10
  s_waitcnt lgkmcnt(0)
  buffer_load_dwordx4 v[20:23], v132, s[4:7], s48 offen offset:0
  buffer_load_dwordx4 v[24:27], v132, s[4:7], s48 offen offset:128
  buffer_load_dwordx4 v[28:31], v132, s[4:7], s48 offen offset:256
  buffer_load_dwordx4 v[32:35], v132, s[4:7], s48 offen offset:384
  buffer_load_dwordx4 v[100:103], v0, s[36:39], s49 offen
  s_add_u32 s49, s49, 4096
  buffer_load_dwordx4 v[68:71], v0, s[36:39], s49 offen
  s_add_u32 s49, s49, 20480
  buffer_load_dwordx4 v[104:107], v0, s[36:39], s49 offen
  s_add_u32 s49, s49, 4096
  buffer_load_dwordx4 v[72:75], v0, s[36:39], s49 offen
  s_add_u32 s49, s49, 20480
  buffer_load_dwordx4 v[108:111], v0, s[36:39], s49 offen
  s_add_u32 s49, s49, 4096
  buffer_load_dwordx4 v[76:79], v0, s[36:39], s49 offen
  s_add_u32 s49, s49, 20480
  buffer_load_dwordx4 v[112:115], v0, s[36:39], s49 offen
  s_add_u32 s49, s49, 4096
  buffer_load_dwordx4 v[80:83], v0, s[36:39], s49 offen
  s_mul_i32 s48, s2, 7168
  s_lshl_b32 s49, s2, 13
  s_mov_b32 s55, 0x20000
  s_mov_b32 s54, 1835008
  s_cmp_eq_u32 s44, 1
  s_cselect_b64 s[52:53], s[16:17], s[20:21]
  s_cmp_eq_u32 s44, 0
  s_cselect_b64 s[52:53], s[12:13], s[52:53]
  s_cselect_b32 s54, s14, s54
  s_cselect_b32 s48, s49, s48
  s_add_u32 s49, s49, 6291456
  s_cmp_eq_u32 s44, 3
  s_cselect_b64 s[52:53], s[8:9], s[52:53]
  s_cselect_b32 s54, s10, s54
  s_cselect_b32 s46, s49, s48
  v_lshlrev_b32 v19, 3, v0
  buffer_load_dword a252, v19, s[52:55], s46 offen
  s_getpc_b64 s[92:93]
PC0:
  s_lshl_b32 s48, s44, 10
  s_sub_u32 s48, s48, PC0-k3_main_kernel
  s_ashr_i32 s49, s48, 31
  s_add_u32 s92, s92, s48
  s_addc_u32 s93, s93, s49
  s_and_b32 s48, s2, 7
  s_lshr_b32 s49, s2, 3
  s_and_b32 s56, s48, 3
  s_lshl_b32 s56, s56, 2
  s_and_b32 s51, s49, 3
  s_add_u32 s56, s56, s51
  s_lshr_b32 s51, s48, 2
  s_lshl_b32 s51, s51, 3
  s_lshr_b32 s49, s49, 2
  s_add_u32 s51, s51, s49
  s_add_u32 s57, s51, s56
  s_and_b32 s57, s57, 3
  s_lshr_b32 s58, s44, 1
  s_and_b32 s59, s44, 1
  s_mul_i32 s62, s44, 3072
  s_lshl_b32 s63, s44, 11
  s_lshl_b32 s64, s44, 8
  v_bfe_u32 v14, v10, 4, 2
  v_bfe_u32 v15, v10, 1, 2
  v_xor_b32 v14, v14, v15
  v_lshlrev_b32 v14, 5, v14
  v_and_b32 v15, 1, v10
  v_lshl_add_u32 v150, v15, 4, v14
  s_lshl_b32 s48, s56, 7
  s_mul_i32 s49, s44, 49152
  s_add_u32 s48, s48, s49
  v_mul_u32_u24 v14, 6144, v13
  v_add3_u32 v139, v14, v150, s48
  v_add_u32 v140, 1024, v139
  v_add_u32 v141, 2048, v139
  v_bfe_u32 v14, v10, 3, 2
  v_lshlrev_b32 v14, 5, v14
  v_and_b32 v15, 3, v10
  v_lshl_add_u32 v151, v15, 3, v14
  v_bfe_u32 v14, v10, 2, 3
  v_lshrrev_b32 v15, 5, v10
  v_mul_u32_u24 v15, 24, v15
  v_add_lshl_u32 v14, v14, v15, 7
  s_lshl_b32 s48, s59, 1
  s_add_u32 s48, s48, s58
  s_lshl_b32 s48, s48, 5
  v_xor_b32 v15, s48, v151
  v_add_u32 v133, v14, v15
  v_xor_b32 v134, 32, v133
  v_add_u32 v135, 64512, v133
  v_add_u32 v136, 64512, v134
  v_add_u32 v137, 129024, v133
  v_add_u32 v138, 129024, v134
  s_lshl_b32 s48, s51, 2
  s_add_u32 s49, s48, s44
  s_lshl_b32 s49, s49, 16
  s_add_u32 s49, s49, 1048576
  v_add_u32 v142, s49, v0
  s_max_u32 s48, s48, 1
  s_lshl_b32 s48, s48, 16
  s_add_u32 s48, s48, 984064
  s_add_u32 s48, s48, s64
  v_lshl_add_u32 v143, v10, 2, s48
  s_lshl_b32 s48, s58, 12
  v_add_u32 v147, 0, v0
  v_add_u32 v144, s48, v147
  v_add_u32 v148, 64512, v0
  v_add_u32 v145, s48, v148
  v_add_u32 v149, 129024, v0
  v_add_u32 v146, s48, v149
  s_lshl_b32 s48, s51, 4
  s_sub_u32 s48, s48, 2
  v_min_u32 v152, 17, v10
  v_add_u32 v152, s48, v152
  v_max_i32 v152, 0, v152
  v_lshlrev_b32 v152, 7, v152
  s_add_u32 s48, s63, 150528
  v_add_u32 v14, s48, v0
  v_lshl_add_u32 v15, v13, 5, s48
  v_lshlrev_b32 v17, 5, v12
  v_add_u32 v17, 158720, v17
  s_lshl_b32 s48, s44, 3
  v_add_u32 v16, s48, v17
  v_bfe_u32 v18, v10, 3, 1
  v_lshlrev_b32 v132, 9, v18
  v_bfe_u32 v18, v10, 4, 1
  v_lshl_add_u32 v132, v18, 8, v132
  v_lshrrev_b32 v18, 5, v10
  v_lshl_add_u32 v132, v18, 11, v132
  v_lshl_add_u32 v132, v12, 4, v132
  s_lshr_b32 s50, s2, 2
  s_lshl_b32 s50, s50, 16
  s_bfe_u32 s48, s2, 0x10001
  s_lshl_b32 s48, s48, 10
  s_add_u32 s50, s50, s48
  s_and_b32 s48, s2, 1
  s_lshl_b32 s48, s48, 7
  s_add_u32 s50, s50, s48
  s_lshl_b32 s48, s44, 14
  s_add_u32 s50, s50, s48
  s_add_u32 s50, s50, 1048576
  s_lshl_b32 s45, s2, 7
  s_add_u32 s45, s45, 5242880
  s_cmp_eq_u32 s44, 0
  s_cselect_b32 s45, s45, 1073741824
  s_waitcnt vmcnt(12)
  v_lshlrev_b32 v36, 16, v20
  v_and_b32 v37, 0xffff0000, v20
  v_lshlrev_b32 v38, 16, v21
  v_and_b32 v39, 0xffff0000, v21
  v_lshlrev_b32 v40, 16, v22
  v_and_b32 v41, 0xffff0000, v22
  v_lshlrev_b32 v42, 16, v23
  v_and_b32 v43, 0xffff0000, v23
  s_waitcnt vmcnt(11)
  v_lshlrev_b32 v44, 16, v24
  v_and_b32 v45, 0xffff0000, v24
  v_lshlrev_b32 v46, 16, v25
  v_and_b32 v47, 0xffff0000, v25
  v_lshlrev_b32 v48, 16, v26
  v_and_b32 v49, 0xffff0000, v26
  v_lshlrev_b32 v50, 16, v27
  v_and_b32 v51, 0xffff0000, v27
  s_waitcnt vmcnt(10)
  v_lshlrev_b32 v52, 16, v28
  v_and_b32 v53, 0xffff0000, v28
  v_lshlrev_b32 v54, 16, v29
  v_and_b32 v55, 0xffff0000, v29
  v_lshlrev_b32 v56, 16, v30
  v_and_b32 v57, 0xffff0000, v30
  v_lshlrev_b32 v58, 16, v31
  v_and_b32 v59, 0xffff0000, v31
  s_waitcnt vmcnt(9)
  v_lshlrev_b32 v60, 16, v32
  v_and_b32 v61, 0xffff0000, v32
  v_lshlrev_b32 v62, 16, v33
  v_and_b32 v63, 0xffff0000, v33
  v_lshlrev_b32 v64, 16, v34
  v_and_b32 v65, 0xffff0000, v34
  v_lshlrev_b32 v66, 16, v35
  v_and_b32 v67, 0xffff0000, v35
  v_add_f32 v20, v36, v37
  v_mul_f32 v21, v36, v36
  v_add_f32 v22, v38, v39
  v_mul_f32 v23, v37, v37
  v_fmac_f32 v21, v38, v38
  v_fmac_f32 v23, v39, v39
  v_fmac_f32 v21, v40, v40
  v_add_f32 v20, v20, v40
  v_fmac_f32 v23, v41, v41
  v_add_f32 v22, v22, v41
  v_fmac_f32 v21, v42, v42
  v_add_f32 v20, v20, v42
  v_fmac_f32 v23, v43, v43
  v_add_f32 v22, v22, v43
  v_fmac_f32 v21, v44, v44
  v_add_f32 v20, v20, v44
  v_fmac_f32 v23, v45, v45
  v_add_f32 v22, v22, v45
  v_fmac_f32 v21, v46, v46
  v_add_f32 v20, v20, v46
  v_fmac_f32 v23, v47, v47
  v_add_f32 v22, v22, v47
  v_fmac_f32 v21, v48, v48
  v_add_f32 v20, v20, v48
  v_fmac_f32 v23, v49, v49
  v_add_f32 v22, v22, v49
  v_fmac_f32 v21, v50, v50
  v_add_f32 v20, v20, v50
  v_fmac_f32 v23, v51, v51
  v_add_f32 v22, v22, v51
  v_fmac_f32 v21, v52, v52
  v_add_f32 v20, v20, v52
  v_fmac_f32 v23, v53, v53
  v_add_f32 v22, v22, v53
  v_fmac_f32 v21, v54, v54
  v_add_f32 v20, v20, v54
  v_fmac_f32 v23, v55, v55
  v_add_f32 v22, v22, v55
  v_fmac_f32 v21, v56, v56
  v_add_f32 v20, v20, v56
  v_fmac_f32 v23, v57, v57
  v_add_f32 v22, v22, v57
  v_fmac_f32 v21, v58, v58
  v_add_f32 v20, v20, v58
  v_fmac_f32 v23, v59, v59
  v_add_f32 v22, v22, v59
  v_fmac_f32 v21, v60, v60
  v_add_f32 v20, v20, v60
  v_fmac_f32 v23, v61, v61
  v_add_f32 v22, v22, v61
  v_fmac_f32 v21, v62, v62
  v_add_f32 v20, v20, v62
  v_fmac_f32 v23, v63, v63
  v_add_f32 v22, v22, v63
  v_fmac_f32 v21, v64, v64
  v_add_f32 v20, v20, v64
  v_fmac_f32 v23, v65, v65
  v_add_f32 v22, v22, v65
  v_fmac_f32 v21, v66, v66
  v_add_f32 v20, v20, v66
  v_fmac_f32 v23, v67, v67
  v_add_f32 v22, v22, v67
  v_add_f32 v20, v20, v22
  v_add_f32 v21, v21, v23
  s_nop 0
  v_add_f32_dpp v18, v20, v20 row_ror:8 row_mask:0xf bank_mask:0xf
  v_add_f32_dpp v19, v21, v21 row_ror:8 row_mask:0xf bank_mask:0xf
  v_mov_b32 v20, v18
  v_mov_b32 v21, v19
  s_nop 0
  v_permlane16_swap_b32 v18, v20
  v_permlane16_swap_b32 v19, v21
  v_add_f32 v18, v18, v20
  v_add_f32 v19, v19, v21
  v_mov_b32 v20, v18
  v_mov_b32 v21, v19
  s_nop 0
  v_permlane32_swap_b32 v18, v20
  v_permlane32_swap_b32 v19, v21
  v_add_f32 v18, v18, v20
  v_add_f32 v19, v19, v21
  ds_write_b64 v16, v[18:19]
  s_waitcnt vmcnt(1)
  v_add_f32 v68, v68, v76
  v_add_f32 v100, v100, v108
  v_add_f32 v69, v69, v77
  v_add_f32 v101, v101, v109
  v_add_f32 v70, v70, v78
  v_add_f32 v102, v102, v110
  v_add_f32 v71, v71, v79
  v_add_f32 v103, v103, v111
  v_add_f32 v72, v72, v80
  v_add_f32 v104, v104, v112
  v_add_f32 v73, v73, v81
  v_add_f32 v105, v105, v113
  v_add_f32 v74, v74, v82
  v_add_f32 v106, v106, v114
  v_add_f32 v75, v75, v83
  v_add_f32 v107, v107, v115
  v_add_f32 v68, v68, v72
  v_add_f32 v100, v100, v104
  v_add_f32 v69, v69, v73
  v_add_f32 v101, v101, v105
  v_add_f32 v70, v70, v74
  v_add_f32 v102, v102, v106
  v_add_f32 v71, v71, v75
  v_add_f32 v103, v103, v107
  v_cvt_pk_bf16_f32 v20, v68, v69
  v_lshlrev_b32 v68, 16, v20
  v_and_b32 v69, 0xffff0000, v20
  v_cvt_pk_bf16_f32 v20, v70, v71
  v_lshlrev_b32 v70, 16, v20
  v_and_b32 v71, 0xffff0000, v20
  v_cvt_pk_bf16_f32 v20, v100, v101
  v_lshlrev_b32 v100, 16, v20
  v_and_b32 v101, 0xffff0000, v20
  v_cvt_pk_bf16_f32 v20, v102, v103
  v_lshlrev_b32 v102, 16, v20
  v_and_b32 v103, 0xffff0000, v20
  v_add_f32 v68, 1.0, v68
  v_add_f32 v69, 1.0, v69
  v_add_f32 v70, 1.0, v70
  v_add_f32 v71, 1.0, v71
  v_cvt_pk_bf16_f32 v20, v68, v69
  v_lshlrev_b32 v68, 16, v20
  v_and_b32 v69, 0xffff0000, v20
  v_cvt_pk_bf16_f32 v20, v70, v71
  v_lshlrev_b32 v70, 16, v20
  v_and_b32 v71, 0xffff0000, v20
  ds_write_b128 v14, v[68:71]
  ds_write_b128 v14, v[100:103] offset:1024
  s_waitcnt lgkmcnt(0)
  s_barrier
  ds_read_b128 v[20:23], v17 offset:0
  ds_read_b128 v[24:27], v17 offset:16
  ds_read_b128 v[68:71], v15 offset:0
  ds_read_b128 v[100:103], v15 offset:1024
  ds_read_b128 v[72:75], v15 offset:16
  ds_read_b128 v[104:107], v15 offset:1040
  ds_read_b128 v[76:79], v15 offset:256
  ds_read_b128 v[108:111], v15 offset:1280
  ds_read_b128 v[80:83], v15 offset:272
  ds_read_b128 v[112:115], v15 offset:1296
  ds_read_b128 v[84:87], v15 offset:512
  ds_read_b128 v[116:119], v15 offset:1536
  ds_read_b128 v[88:91], v15 offset:528
  ds_read_b128 v[120:123], v15 offset:1552
  s_waitcnt lgkmcnt(12)
  v_add_f32 v20, v20, v24
  v_add_f32 v21, v21, v25
  v_add_f32 v22, v22, v26
  v_add_f32 v23, v23, v27
  v_add_f32 v20, v20, v22
  v_add_f32 v21, v21, v23
  ds_read_b128 v[92:95], v15 offset:768
  ds_read_b128 v[124:127], v15 offset:1792
  ds_read_b128 v[96:99], v15 offset:784
  ds_read_b128 v[128:131], v15 offset:1808
  v_mul_f32 v18, 0x3a800000, v20
  v_mul_f32 v19, 0x3a800000, v21
  v_fma_f32 v19, -v18, v18, v19
  v_max_f32 v19, 0, v19
  v_cvt_pk_bf16_f32 v19, v19, v19
  v_lshlrev_b32 v19, 16, v19
  v_add_f32 v19, 0x3727c5ac, v19
  v_cvt_pk_bf16_f32 v19, v19, v19
  v_lshlrev_b32 v19, 16, v19
  v_sqrt_f32 v19, v19
  v_cvt_pk_bf16_f32 v18, v18, v18
  v_lshlrev_b32 v18, 16, v18
  v_cvt_pk_bf16_f32 v19, v19, v19
  v_lshlrev_b32 v19, 16, v19
  v_rcp_f32 v19, v19
  s_nop 0
  v_mul_f32 v18, v18, v19
  v_fma_f32 v36, v36, v19, -v18
  v_fma_f32 v37, v37, v19, -v18
  v_fma_f32 v38, v38, v19, -v18
  v_fma_f32 v39, v39, v19, -v18
  v_fma_f32 v40, v40, v19, -v18
  v_fma_f32 v41, v41, v19, -v18
  v_fma_f32 v42, v42, v19, -v18
  v_fma_f32 v43, v43, v19, -v18
  s_waitcnt lgkmcnt(12)
  v_fma_f32 v36, v36, v68, v100
  v_fma_f32 v37, v37, v69, v101
  v_fma_f32 v38, v38, v70, v102
  v_fma_f32 v39, v39, v71, v103
  v_fma_f32 v40, v40, v72, v104
  v_fma_f32 v41, v41, v73, v105
  v_fma_f32 v42, v42, v74, v106
  v_fma_f32 v43, v43, v75, v107
  v_cvt_pk_bf16_f32 v20, v36, v37
  v_cvt_pk_bf16_f32 v21, v38, v39
  v_cvt_pk_bf16_f32 v22, v40, v41
  v_cvt_pk_bf16_f32 v23, v42, v43
  s_nop 1
  v_permlane16_swap_b32 v20, v22
  v_permlane16_swap_b32 v21, v23
  buffer_store_dwordx4 v[20:23], v132, s[36:39], s50 offen sc1
  s_add_u32 s50, s50, 4096
  v_fma_f32 v44, v44, v19, -v18
  v_fma_f32 v45, v45, v19, -v18
  v_fma_f32 v46, v46, v19, -v18
  v_fma_f32 v47, v47, v19, -v18
  v_fma_f32 v48, v48, v19, -v18
  v_fma_f32 v49, v49, v19, -v18
  v_fma_f32 v50, v50, v19, -v18
  v_fma_f32 v51, v51, v19, -v18
  s_waitcnt lgkmcnt(8)
  v_fma_f32 v44, v44, v76, v108
  v_fma_f32 v45, v45, v77, v109
  v_fma_f32 v46, v46, v78, v110
  v_fma_f32 v47, v47, v79, v111
  v_fma_f32 v48, v48, v80, v112
  v_fma_f32 v49, v49, v81, v113
  v_fma_f32 v50, v50, v82, v114
  v_fma_f32 v51, v51, v83, v115
  v_cvt_pk_bf16_f32 v24, v44, v45
  v_cvt_pk_bf16_f32 v25, v46, v47
  v_cvt_pk_bf16_f32 v26, v48, v49
  v_cvt_pk_bf16_f32 v27, v50, v51
  s_nop 1
  v_permlane16_swap_b32 v24, v26
  v_permlane16_swap_b32 v25, v27
  buffer_store_dwordx4 v[24:27], v132, s[36:39], s50 offen sc1
  s_add_u32 s50, s50, 4096
  v_fma_f32 v52, v52, v19, -v18
  v_fma_f32 v53, v53, v19, -v18
  v_fma_f32 v54, v54, v19, -v18
  v_fma_f32 v55, v55, v19, -v18
  v_fma_f32 v56, v56, v19, -v18
  v_fma_f32 v57, v57, v19, -v18
  v_fma_f32 v58, v58, v19, -v18
  v_fma_f32 v59, v59, v19, -v18
  s_waitcnt lgkmcnt(4)
  v_fma_f32 v52, v52, v84, v116
  v_fma_f32 v53, v53, v85, v117
  v_fma_f32 v54, v54, v86, v118
  v_fma_f32 v55, v55, v87, v119
  v_fma_f32 v56, v56, v88, v120
  v_fma_f32 v57, v57, v89, v121
  v_fma_f32 v58, v58, v90, v122
  v_fma_f32 v59, v59, v91, v123
  v_cvt_pk_bf16_f32 v28, v52, v53
  v_cvt_pk_bf16_f32 v29, v54, v55
  v_cvt_pk_bf16_f32 v30, v56, v57
  v_cvt_pk_bf16_f32 v31, v58, v59
  s_nop 1
  v_permlane16_swap_b32 v28, v30
  v_permlane16_swap_b32 v29, v31
  buffer_store_dwordx4 v[28:31], v132, s[36:39], s50 offen sc1
  s_add_u32 s50, s50, 4096
  v_fma_f32 v60, v60, v19, -v18
  v_fma_f32 v61, v61, v19, -v18
  v_fma_f32 v62, v62, v19, -v18
  v_fma_f32 v63, v63, v19, -v18
  v_fma_f32 v64, v64, v19, -v18
  v_fma_f32 v65, v65, v19, -v18
  v_fma_f32 v66, v66, v19, -v18
  v_fma_f32 v67, v67, v19, -v18
  s_waitcnt lgkmcnt(0)
  v_fma_f32 v60, v60, v92, v124
  v_fma_f32 v61, v61, v93, v125
  v_fma_f32 v62, v62, v94, v126
  v_fma_f32 v63, v63, v95, v127
  v_fma_f32 v64, v64, v96, v128
  v_fma_f32 v65, v65, v97, v129
  v_fma_f32 v66, v66, v98, v130
  v_fma_f32 v67, v67, v99, v131
  v_cvt_pk_bf16_f32 v32, v60, v61
  v_cvt_pk_bf16_f32 v33, v62, v63
  v_cvt_pk_bf16_f32 v34, v64, v65
  v_cvt_pk_bf16_f32 v35, v66, v67
  s_nop 1
  v_permlane16_swap_b32 v32, v34
  v_permlane16_swap_b32 v33, v35
  buffer_store_dwordx4 v[32:35], v132, s[36:39], s50 offen sc1
  v_mov_b32 v12, 1
  s_waitcnt vmcnt(0) lgkmcnt(0)
  s_barrier
  s_mov_b64 exec, 1
  buffer_store_dword v12, v0, s[36:39], s45 offen sc1
  s_mov_b64 exec, -1
  s_mov_b32 s65, 0
  s_mul_i32 s60, s65, 196608
  s_add_u32 m0, s62, 64512
  s_nop 0
  buffer_load_dwordx4 v139, s[8:11], s60 offen offset:0 lds
  buffer_load_dwordx4 v140, s[8:11], s60 offen offset:1024 lds
  buffer_load_dwordx4 v141, s[8:11], s60 offen offset:2048 lds
  s_mov_b32 s66, 1
  s_mul_i32 s60, s66, 196608
  s_add_u32 m0, s62, 86016
  s_nop 0
  buffer_load_dwordx4 v139, s[8:11], s60 offen offset:0 lds
  buffer_load_dwordx4 v140, s[8:11], s60 offen offset:1024 lds
  buffer_load_dwordx4 v141, s[8:11], s60 offen offset:2048 lds
  s_cmp_eq_u32 s57, 1
  s_cselect_b32 s67, 10, 2
  s_mul_i32 s60, s67, 196608
  s_add_u32 m0, s62, 107520
  s_nop 0
  buffer_load_dwordx4 v139, s[8:11], s60 offen offset:0 lds
  buffer_load_dwordx4 v140, s[8:11], s60 offen offset:1024 lds
  buffer_load_dwordx4 v141, s[8:11], s60 offen offset:2048 lds
  s_cmp_eq_u32 s57, 1
  s_cselect_b32 s68, 11, 3
  s_mul_i32 s60, s68, 196608
  s_add_u32 m0, s62, 129024
  s_nop 0
  buffer_load_dwordx4 v139, s[8:11], s60 offen offset:0 lds
  buffer_load_dwordx4 v140, s[8:11], s60 offen offset:1024 lds
  buffer_load_dwordx4 v141, s[8:11], s60 offen offset:2048 lds
  s_cmp_eq_u32 s57, 2
  s_cselect_b32 s69, 12, 4
  s_mul_i32 s60, s69, 196608
  s_add_u32 m0, s62, 0
  s_nop 0
  buffer_load_dwordx4 v139, s[8:11], s60 offen offset:0 lds
  buffer_load_dwordx4 v140, s[8:11], s60 offen offset:1024 lds
  buffer_load_dwordx4 v141, s[8:11], s60 offen offset:2048 lds
  s_cmp_lg_u32 s44, 0
  s_cbranch_scc1 SM1x
  s_mov_b32 s46, 60000
  s_mov_b32 s47, 5242880
SM1:
  buffer_load_dword v12, v152, s[36:39], s47 offen sc1
  s_sub_u32 s46, s46, 1
  s_cmp_eq_u32 s46, 0
  s_waitcnt vmcnt(0)
  s_cbranch_scc1 SM1x
  v_cmp_ne_u32 vcc, 1, v12
  s_nop 4
  s_cbranch_vccnz SM1
SM1x:
  s_barrier
  s_lshl_b32 s61, s65, 11
  s_add_u32 m0, s63, 76800
  s_nop 0
  buffer_load_dwordx4 v142, s[36:39], s61 offen offset:0 sc1 lds
  buffer_load_dwordx4 v142, s[36:39], s61 offen offset:1024 sc1 lds
  s_add_u32 m0, s64, 84992
  s_nop 0
  buffer_load_dword v143, s[36:39], s61 offen sc1 lds
  s_lshl_b32 s61, s66, 11
  s_add_u32 m0, s63, 98304
  s_nop 0
  buffer_load_dwordx4 v142, s[36:39], s61 offen offset:0 sc1 lds
  buffer_load_dwordx4 v142, s[36:39], s61 offen offset:1024 sc1 lds
  s_add_u32 m0, s64, 106496
  s_nop 0
  buffer_load_dword v143, s[36:39], s61 offen sc1 lds
  s_lshl_b32 s61, s67, 11
  s_add_u32 m0, s63, 119808
  s_nop 0
  buffer_load_dwordx4 v142, s[36:39], s61 offen offset:0 sc1 lds
  buffer_load_dwordx4 v142, s[36:39], s61 offen offset:1024 sc1 lds
  s_add_u32 m0, s64, 128000
  s_nop 0
  buffer_load_dword v143, s[36:39], s61 offen sc1 lds
  s_lshl_b32 s61, s68, 11
  s_add_u32 m0, s63, 141312
  s_nop 0
  buffer_load_dwordx4 v142, s[36:39], s61 offen offset:0 sc1 lds
  buffer_load_dwordx4 v142, s[36:39], s61 offen offset:1024 sc1 lds
  s_add_u32 m0, s64, 149504
  s_nop 0
  buffer_load_dword v143, s[36:39], s61 offen sc1 lds
  s_waitcnt vmcnt(9)
  s_barrier
  ds_read_b64_tr_b16 a[40:41], v135 offset:1024
  ds_read_b64_tr_b16 a[42:43], v135 offset:7168
  ds_read_b64_tr_b16 a[44:45], v136 offset:1024
  ds_read_b64_tr_b16 a[46:47], v136 offset:7168
  ds_read_b64_tr_b16 a[48:49], v135 offset:2048
  ds_read_b64_tr_b16 a[50:51], v135 offset:8192
  ds_read_b64_tr_b16 a[52:53], v136 offset:2048
  ds_read_b64_tr_b16 a[54:55], v136 offset:8192
  ds_read_b128 a[0:3], v145 offset:12288
  ds_read_b128 a[4:7], v145 offset:13312
  ds_read_b128 a[8:11], v145 offset:14336
  ds_read_b128 a[12:15], v145 offset:15360
  ds_read_b128 a[16:19], v148 offset:20480
  s_waitcnt lgkmcnt(0)
  v_mfma_f32_16x16x32_bf16 v[20:23], a[40:43], a[0:3], 0
  s_waitcnt vmcnt(6)
  s_barrier
  s_lshl_b32 s61, s69, 11
  v_mfma_f32_16x16x32_bf16 v[24:27], a[40:43], a[4:7], 0
  s_add_u32 m0, s63, 12288
  ds_read_b64_tr_b16 a[56:57], v135 offset:0
  buffer_load_dwordx4 v142, s[36:39], s61 offen offset:0 sc1 lds
  v_mfma_f32_16x16x32_bf16 v[28:31], a[40:43], a[8:11], 0
  ds_read_b64_tr_b16 a[58:59], v135 offset:6144
  v_mfma_f32_16x16x32_bf16 v[32:35], a[40:43], a[12:15], 0
  v_mfma_f32_16x16x32_bf16 v[116:119], a[40:43], a[16:19], 0
  ds_read_b64_tr_b16 a[60:61], v136 offset:0
  v_mfma_f32_16x16x32_bf16 v[48:51], a[44:47], a[12:15], 0
  buffer_load_dwordx4 v142, s[36:39], s61 offen offset:1024 sc1 lds
  s_add_u32 m0, s64, 20480
  v_mfma_f32_16x16x32_bf16 v[44:47], a[44:47], a[8:11], 0
  ds_read_b64_tr_b16 a[62:63], v136 offset:6144
  v_mfma_f32_16x16x32_bf16 v[40:43], a[44:47], a[4:7], 0
  v_mfma_f32_16x16x32_bf16 v[36:39], a[44:47], a[0:3], 0
  s_waitcnt lgkmcnt(9)
  ds_read_b64_tr_b16 a[64:65], v135 offset:22528
  v_mfma_f32_16x16x32_bf16 v[52:55], a[0:3], a[48:51], 0
  buffer_load_dword v143, s[36:39], s61 offen sc1 lds
  s_cmp_eq_u32 s57, 2
  v_mfma_f32_16x16x32_bf16 v[56:59], a[4:7], a[48:51], 0
  s_cselect_b32 s70, 13, 5
  s_mul_i32 s60, s70, 196608
  s_add_u32 m0, s62, 21504
  v_mfma_f32_16x16x32_bf16 v[60:63], a[8:11], a[48:51], 0
  ds_read_b128 a[20:23], v145 offset:33792
  ds_read_b64_tr_b16 a[66:67], v135 offset:28672
  v_mfma_f32_16x16x32_bf16 v[64:67], a[12:15], a[48:51], 0
  ds_read_b128 a[24:27], v145 offset:34816
  v_mfma_f32_16x16x32_bf16 v[120:123], a[16:19], a[48:51], 0
  buffer_load_dwordx4 v139, s[8:11], s60 offen offset:0 lds
  ds_read_b64_tr_b16 a[68:69], v136 offset:22528
  v_mfma_f32_16x16x32_bf16 v[80:83], a[12:15], a[52:55], 0
  ds_read_b128 a[28:31], v145 offset:35840
  v_mfma_f32_16x16x32_bf16 v[76:79], a[8:11], a[52:55], 0
  ds_read_b64_tr_b16 a[70:71], v136 offset:28672
  ds_read_b128 a[32:35], v145 offset:36864
  v_mfma_f32_16x16x32_bf16 v[72:75], a[4:7], a[52:55], 0
  v_mfma_f32_16x16x32_bf16 v[68:71], a[0:3], a[52:55], 0
  s_waitcnt lgkmcnt(8)
  buffer_load_dwordx4 v140, s[8:11], s60 offen offset:1024 lds
  ds_read_b128 a[36:39], v148 offset:41984
  v_mfma_f32_16x16x32_bf16 v[84:87], a[56:59], a[0:3], 0
  ds_read_b64_tr_b16 a[40:41], v135 offset:23552
  v_mfma_f32_16x16x32_bf16 v[88:91], a[56:59], a[4:7], 0
  ds_read_b64_tr_b16 a[42:43], v135 offset:29696
  v_mfma_f32_16x16x32_bf16 v[92:95], a[56:59], a[8:11], 0
  v_mfma_f32_16x16x32_bf16 v[96:99], a[56:59], a[12:15], 0
  buffer_load_dwordx4 v141, s[8:11], s60 offen offset:2048 lds
  s_lshl_b32 s61, s70, 11
  v_mfma_f32_16x16x32_bf16 v[112:115], a[60:63], a[12:15], 0
  s_add_u32 m0, s63, 33792
  ds_read_b64_tr_b16 a[44:45], v136 offset:23552
  v_mfma_f32_16x16x32_bf16 v[108:111], a[60:63], a[8:11], 0
  v_mfma_f32_16x16x32_bf16 v[104:107], a[60:63], a[4:7], 0
  ds_read_b64_tr_b16 a[46:47], v136 offset:29696
  v_mfma_f32_16x16x32_bf16 v[100:103], a[60:63], a[0:3], 0
  s_waitcnt vmcnt(9) lgkmcnt(4)
  s_barrier
  buffer_load_dwordx4 v142, s[36:39], s61 offen offset:0 sc1 lds
  v_mfma_f32_16x16x32_bf16 v[20:23], a[64:67], a[20:23], v[20:23]
  ds_read_b64_tr_b16 a[48:49], v135 offset:21504
  v_mfma_f32_16x16x32_bf16 v[24:27], a[64:67], a[24:27], v[24:27]
  v_mfma_f32_16x16x32_bf16 v[28:31], a[64:67], a[28:31], v[28:31]
  ds_read_b64_tr_b16 a[50:51], v135 offset:27648
  v_mfma_f32_16x16x32_bf16 v[32:35], a[64:67], a[32:35], v[32:35]
  buffer_load_dwordx4 v142, s[36:39], s61 offen offset:1024 sc1 lds
  s_add_u32 m0, s64, 41984
  v_mfma_f32_16x16x32_bf16 v[116:119], a[64:67], a[36:39], v[116:119]
  ds_read_b64_tr_b16 a[52:53], v136 offset:21504
  v_mfma_f32_16x16x32_bf16 v[48:51], a[68:71], a[32:35], v[48:51]
  v_mfma_f32_16x16x32_bf16 v[44:47], a[68:71], a[28:31], v[44:47]
  ds_read_b64_tr_b16 a[54:55], v136 offset:27648
  v_mfma_f32_16x16x32_bf16 v[40:43], a[68:71], a[24:27], v[40:43]
  buffer_load_dword v143, s[36:39], s61 offen sc1 lds
  s_cmp_eq_u32 s57, 3
  v_mfma_f32_16x16x32_bf16 v[36:39], a[68:71], a[20:23], v[36:39]
  s_waitcnt lgkmcnt(4)
  s_cselect_b32 s65, 14, 6
  s_mul_i32 s60, s65, 196608
  v_mfma_f32_16x16x32_bf16 v[52:55], a[20:23], a[40:43], v[52:55]
  s_add_u32 m0, s62, 43008
  ds_read_b64_tr_b16 a[56:57], v135 offset:44032
  ds_read_b128 a[0:3], v145 offset:55296
  v_mfma_f32_16x16x32_bf16 v[56:59], a[24:27], a[40:43], v[56:59]
  ds_read_b64_tr_b16 a[58:59], v135 offset:50176
  v_mfma_f32_16x16x32_bf16 v[60:63], a[28:31], a[40:43], v[60:63]
  buffer_load_dwordx4 v139, s[8:11], s60 offen offset:0 lds
  ds_read_b128 a[4:7], v145 offset:56320
  v_mfma_f32_16x16x32_bf16 v[64:67], a[32:35], a[40:43], v[64:67]
  v_mfma_f32_16x16x32_bf16 v[120:123], a[36:39], a[40:43], v[120:123]
  ds_read_b64_tr_b16 a[60:61], v136 offset:44032
  ds_read_b128 a[8:11], v145 offset:57344
  v_mfma_f32_16x16x32_bf16 v[80:83], a[32:35], a[44:47], v[80:83]
CT2:
  s_add_u32 s94, s92, CT2-k3_main_kernel+3072
  s_addc_u32 s95, s93, 0
  v_mfma_f32_16x16x32_bf16 v[76:79], a[28:31], a[44:47], v[76:79]
  buffer_load_dwordx4 v140, s[8:11], s60 offen offset:1024 lds
  ds_read_b64_tr_b16 a[62:63], v136 offset:50176
  v_mfma_f32_16x16x32_bf16 v[72:75], a[24:27], a[44:47], v[72:75]
  ds_read_b128 a[12:15], v145 offset:58368
  v_mfma_f32_16x16x32_bf16 v[68:71], a[20:23], a[44:47], v[68:71]
  s_waitcnt lgkmcnt(8)
  ds_read_b128 a[16:19], v148 offset:63488
  ds_read_b64_tr_b16 a[64:65], v135 offset:45056
  v_mfma_f32_16x16x32_bf16 v[84:87], a[48:51], a[20:23], v[84:87]
  v_mfma_f32_16x16x32_bf16 v[88:91], a[48:51], a[24:27], v[88:91]
  buffer_load_dwordx4 v141, s[8:11], s60 offen offset:2048 lds
  s_lshl_b32 s61, s65, 11
  v_mfma_f32_16x16x32_bf16 v[92:95], a[48:51], a[28:31], v[92:95]
  s_add_u32 m0, s63, 55296
  ds_read_b64_tr_b16 a[66:67], v135 offset:51200
  v_mfma_f32_16x16x32_bf16 v[96:99], a[48:51], a[32:35], v[96:99]
  v_mfma_f32_16x16x32_bf16 v[112:115], a[52:55], a[32:35], v[112:115]
  ds_read_b64_tr_b16 a[68:69], v136 offset:45056
  v_mfma_f32_16x16x32_bf16 v[108:111], a[52:55], a[28:31], v[108:111]
  buffer_load_dwordx4 v142, s[36:39], s61 offen offset:0 sc1 lds
  v_mfma_f32_16x16x32_bf16 v[104:107], a[52:55], a[24:27], v[104:107]
  ds_read_b64_tr_b16 a[70:71], v136 offset:51200
  v_mfma_f32_16x16x32_bf16 v[100:103], a[52:55], a[20:23], v[100:103]
  s_waitcnt vmcnt(13) lgkmcnt(4)
  s_barrier
  v_mfma_f32_16x16x32_bf16 v[20:23], a[56:59], a[0:3], v[20:23]
  ds_read_b64_tr_b16 a[40:41], v135 offset:43008
  v_mfma_f32_16x16x32_bf16 v[24:27], a[56:59], a[4:7], v[24:27]
  buffer_load_dwordx4 v142, s[36:39], s61 offen offset:1024 sc1 lds
  s_add_u32 m0, s64, 63488
  v_mfma_f32_16x16x32_bf16 v[28:31], a[56:59], a[8:11], v[28:31]
  ds_read_b64_tr_b16 a[42:43], v135 offset:49152
  v_mfma_f32_16x16x32_bf16 v[32:35], a[56:59], a[12:15], v[32:35]
  v_mfma_f32_16x16x32_bf16 v[116:119], a[56:59], a[16:19], v[116:119]
  ds_read_b64_tr_b16 a[44:45], v136 offset:43008
  v_mfma_f32_16x16x32_bf16 v[48:51], a[60:63], a[12:15], v[48:51]
  buffer_load_dword v143, s[36:39], s61 offen sc1 lds
  s_cmp_eq_u32 s57, 3
  v_mfma_f32_16x16x32_bf16 v[44:47], a[60:63], a[8:11], v[44:47]
  s_cselect_b32 s66, 15, 7
  s_mul_i32 s60, s66, 196608
  s_add_u32 m0, s62, 64512
  v_mfma_f32_16x16x32_bf16 v[40:43], a[60:63], a[4:7], v[40:43]
  ds_read_b64_tr_b16 a[46:47], v136 offset:49152
  v_mfma_f32_16x16x32_bf16 v[36:39], a[60:63], a[0:3], v[36:39]
  s_waitcnt lgkmcnt(4)
  ds_read_b64_tr_b16 a[48:49], v137 offset:1024
  v_mfma_f32_16x16x32_bf16 v[52:55], a[0:3], a[64:67], v[52:55]
  buffer_load_dwordx4 v139, s[8:11], s60 offen offset:0 lds
  ds_read_b128 a[20:23], v146 offset:12288
  v_mfma_f32_16x16x32_bf16 v[56:59], a[4:7], a[64:67], v[56:59]
  ds_read_b64_tr_b16 a[50:51], v137 offset:7168
  v_mfma_f32_16x16x32_bf16 v[60:63], a[8:11], a[64:67], v[60:63]
  ds_read_b128 a[24:27], v146 offset:13312
  v_mfma_f32_16x16x32_bf16 v[64:67], a[12:15], a[64:67], v[64:67]
  v_mfma_f32_16x16x32_bf16 v[120:123], a[16:19], a[64:67], v[120:123]
  buffer_load_dwordx4 v140, s[8:11], s60 offen offset:1024 lds
  ds_read_b64_tr_b16 a[52:53], v138 offset:1024
  v_mfma_f32_16x16x32_bf16 v[80:83], a[12:15], a[68:71], v[80:83]
  ds_read_b128 a[28:31], v146 offset:14336
  v_mfma_f32_16x16x32_bf16 v[76:79], a[8:11], a[68:71], v[76:79]
  ds_read_b64_tr_b16 a[54:55], v138 offset:7168
  ds_read_b128 a[32:35], v146 offset:15360
  v_mfma_f32_16x16x32_bf16 v[72:75], a[4:7], a[68:71], v[72:75]
  v_mfma_f32_16x16x32_bf16 v[68:71], a[0:3], a[68:71], v[68:71]
  s_waitcnt lgkmcnt(8)
  buffer_load_dwordx4 v141, s[8:11], s60 offen offset:2048 lds
  s_lshl_b32 s61, s66, 11
  v_mfma_f32_16x16x32_bf16 v[84:87], a[40:43], a[0:3], v[84:87]
  s_add_u32 m0, s63, 76800
  ds_read_b128 a[36:39], v149 offset:20480
  ds_read_b64_tr_b16 a[56:57], v137 offset:2048
  v_mfma_f32_16x16x32_bf16 v[88:91], a[40:43], a[4:7], v[88:91]
  ds_read_b64_tr_b16 a[58:59], v137 offset:8192
  v_mfma_f32_16x16x32_bf16 v[92:95], a[40:43], a[8:11], v[92:95]
  v_mfma_f32_16x16x32_bf16 v[96:99], a[40:43], a[12:15], v[96:99]
  buffer_load_dwordx4 v142, s[36:39], s61 offen offset:0 sc1 lds
  v_mfma_f32_16x16x32_bf16 v[112:115], a[44:47], a[12:15], v[112:115]
  ds_read_b64_tr_b16 a[60:61], v138 offset:2048
  v_mfma_f32_16x16x32_bf16 v[108:111], a[44:47], a[8:11], v[108:111]
  v_mfma_f32_16x16x32_bf16 v[104:107], a[44:47], a[4:7], v[104:107]
  ds_read_b64_tr_b16 a[62:63], v138 offset:8192
  v_mfma_f32_16x16x32_bf16 v[100:103], a[44:47], a[0:3], v[100:103]
  s_waitcnt vmcnt(16) lgkmcnt(4)
  s_barrier
  global_load_dword a252, v0, s[94:95]
  v_mfma_f32_16x16x32_bf16 v[20:23], a[48:51], a[20:23], v[20:23]
  ds_read_b64_tr_b16 a[64:65], v137 offset:0
  v_mfma_f32_16x16x32_bf16 v[24:27], a[48:51], a[24:27], v[24:27]
  v_mfma_f32_16x16x32_bf16 v[28:31], a[48:51], a[28:31], v[28:31]
  ds_read_b64_tr_b16 a[66:67], v137 offset:6144
  v_mfma_f32_16x16x32_bf16 v[32:35], a[48:51], a[32:35], v[32:35]
  buffer_load_dwordx4 v142, s[36:39], s61 offen offset:1024 sc1 lds
  s_add_u32 m0, s64, 84992
  v_mfma_f32_16x16x32_bf16 v[116:119], a[48:51], a[36:39], v[116:119]
  ds_read_b64_tr_b16 a[68:69], v138 offset:0
  v_mfma_f32_16x16x32_bf16 v[48:51], a[52:55], a[32:35], v[48:51]
  v_mfma_f32_16x16x32_bf16 v[44:47], a[52:55], a[28:31], v[44:47]
  ds_read_b64_tr_b16 a[70:71], v138 offset:6144
  v_mfma_f32_16x16x32_bf16 v[40:43], a[52:55], a[24:27], v[40:43]
  buffer_load_dword v143, s[36:39], s61 offen sc1 lds
  s_cmp_eq_u32 s57, 0
  v_mfma_f32_16x16x32_bf16 v[36:39], a[52:55], a[20:23], v[36:39]
  s_waitcnt lgkmcnt(4)
  s_cselect_b32 s67, 16, 8
  s_mul_i32 s60, s67, 196608
  v_mfma_f32_16x16x32_bf16 v[52:55], a[20:23], a[56:59], v[52:55]
  s_add_u32 m0, s62, 86016
  ds_read_b64_tr_b16 a[40:41], v133 offset:1024
  ds_read_b128 a[0:3], v144 offset:12288
  v_mfma_f32_16x16x32_bf16 v[56:59], a[24:27], a[56:59], v[56:59]
  ds_read_b64_tr_b16 a[42:43], v133 offset:7168
  v_mfma_f32_16x16x32_bf16 v[60:63], a[28:31], a[56:59], v[60:63]
  buffer_load_dwordx4 v139, s[8:11], s60 offen offset:0 lds
  ds_read_b128 a[4:7], v144 offset:13312
  v_mfma_f32_16x16x32_bf16 v[64:67], a[32:35], a[56:59], v[64:67]
  v_mfma_f32_16x16x32_bf16 v[120:123], a[36:39], a[56:59], v[120:123]
  ds_read_b64_tr_b16 a[44:45], v134 offset:1024
  ds_read_b128 a[8:11], v144 offset:14336
  v_mfma_f32_16x16x32_bf16 v[80:83], a[32:35], a[60:63], v[80:83]
  v_mfma_f32_16x16x32_bf16 v[76:79], a[28:31], a[60:63], v[76:79]
  buffer_load_dwordx4 v140, s[8:11], s60 offen offset:1024 lds
  ds_read_b64_tr_b16 a[46:47], v134 offset:7168
  v_mfma_f32_16x16x32_bf16 v[72:75], a[24:27], a[60:63], v[72:75]
  ds_read_b128 a[12:15], v144 offset:15360
  v_mfma_f32_16x16x32_bf16 v[68:71], a[20:23], a[60:63], v[68:71]
  s_waitcnt lgkmcnt(8)
  ds_read_b128 a[16:19], v147 offset:20480
  ds_read_b64_tr_b16 a[48:49], v133 offset:2048
  v_mfma_f32_16x16x32_bf16 v[84:87], a[64:67], a[20:23], v[84:87]
  v_mfma_f32_16x16x32_bf16 v[88:91], a[64:67], a[24:27], v[88:91]
  buffer_load_dwordx4 v141, s[8:11], s60 offen offset:2048 lds
  s_lshl_b32 s61, s67, 11
  v_mfma_f32_16x16x32_bf16 v[92:95], a[64:67], a[28:31], v[92:95]
  s_add_u32 m0, s63, 98304
  ds_read_b64_tr_b16 a[50:51], v133 offset:8192
  v_mfma_f32_16x16x32_bf16 v[96:99], a[64:67], a[32:35], v[96:99]
  v_mfma_f32_16x16x32_bf16 v[112:115], a[68:71], a[32:35], v[112:115]
  s_and_b32 s48, s2, 3
  ds_read_b64_tr_b16 a[52:53], v134 offset:2048
  s_lshl_b32 s48, s48, 8
  v_mfma_f32_16x16x32_bf16 v[108:111], a[68:71], a[28:31], v[108:111]
  s_lshl_b32 s49, s44, 6
  buffer_load_dwordx4 v142, s[36:39], s61 offen offset:0 sc1 lds
  s_add_u32 s48, s48, s49
  v_mfma_f32_16x16x32_bf16 v[104:107], a[68:71], a[24:27], v[104:107]
  ds_read_b64_tr_b16 a[54:55], v134 offset:8192
  v_mfma_f32_16x16x32_bf16 v[100:103], a[68:71], a[20:23], v[100:103]
  s_waitcnt vmcnt(17) lgkmcnt(4)
  s_barrier
  v_mfma_f32_16x16x32_bf16 v[20:23], a[40:43], a[0:3], v[20:23]
  ds_read_b64_tr_b16 a[56:57], v133 offset:0
  v_mfma_f32_16x16x32_bf16 v[24:27], a[40:43], a[4:7], v[24:27]
  buffer_load_dwordx4 v142, s[36:39], s61 offen offset:1024 sc1 lds
  s_add_u32 m0, s64, 106496
  v_mfma_f32_16x16x32_bf16 v[28:31], a[40:43], a[8:11], v[28:31]
  ds_read_b64_tr_b16 a[58:59], v133 offset:6144
  v_and_b32 v196, 0x38, v10
  v_mfma_f32_16x16x32_bf16 v[32:35], a[40:43], a[12:15], v[32:35]
  v_add_u32 v196, s48, v196
  v_lshlrev_b32 v12, 1, v196
  v_mfma_f32_16x16x32_bf16 v[116:119], a[40:43], a[16:19], v[116:119]
  ds_read_b64_tr_b16 a[60:61], v134 offset:0
  v_mfma_f32_16x16x32_bf16 v[48:51], a[44:47], a[12:15], v[48:51]
  buffer_load_dword v143, s[36:39], s61 offen sc1 lds
  s_cmp_eq_u32 s57, 0
  v_mfma_f32_16x16x32_bf16 v[44:47], a[44:47], a[8:11], v[44:47]
  s_cselect_b32 s68, 17, 9
  s_mul_i32 s60, s68, 196608
  s_add_u32 m0, s62, 107520
  v_mfma_f32_16x16x32_bf16 v[40:43], a[44:47], a[4:7], v[40:43]
  ds_read_b64_tr_b16 a[62:63], v134 offset:6144
  v_mfma_f32_16x16x32_bf16 v[36:39], a[44:47], a[0:3], v[36:39]
  s_waitcnt lgkmcnt(4)
  ds_read_b64_tr_b16 a[64:65], v133 offset:22528
  v_mfma_f32_16x16x32_bf16 v[52:55], a[0:3], a[48:51], v[52:55]
  buffer_load_dwordx4 v139, s[8:11], s60 offen offset:0 lds
  ds_read_b128 a[20:23], v144 offset:33792
  v_mfma_f32_16x16x32_bf16 v[56:59], a[4:7], a[48:51], v[56:59]
  ds_read_b64_tr_b16 a[66:67], v133 offset:28672
  v_mfma_f32_16x16x32_bf16 v[60:63], a[8:11], a[48:51], v[60:63]
  ds_read_b128 a[24:27], v144 offset:34816
  v_mfma_f32_16x16x32_bf16 v[64:67], a[12:15], a[48:51], v[64:67]
  v_mfma_f32_16x16x32_bf16 v[120:123], a[16:19], a[48:51], v[120:123]
  buffer_load_dwordx4 v[208:211], v12, s[40:43], 0 offen
  ds_read_b64_tr_b16 a[68:69], v134 offset:22528
  v_mfma_f32_16x16x32_bf16 v[80:83], a[12:15], a[52:55], v[80:83]
  ds_read_b128 a[28:31], v144 offset:35840
  v_mul_u32_u24 v196, 12288, v196
  v_mfma_f32_16x16x32_bf16 v[76:79], a[8:11], a[52:55], v[76:79]
  ds_read_b64_tr_b16 a[70:71], v134 offset:28672
  ds_read_b128 a[32:35], v144 offset:36864
  v_mfma_f32_16x16x32_bf16 v[72:75], a[4:7], a[52:55], v[72:75]
  v_and_b32 v12, 7, v10
  v_lshl_add_u32 v196, v12, 4, v196
  v_mfma_f32_16x16x32_bf16 v[68:71], a[0:3], a[52:55], v[68:71]
  s_waitcnt lgkmcnt(8)
  buffer_load_dwordx4 v140, s[8:11], s60 offen offset:1024 lds
  ds_read_b128 a[36:39], v147 offset:41984
  v_mfma_f32_16x16x32_bf16 v[84:87], a[56:59], a[0:3], v[84:87]
  ds_read_b64_tr_b16 a[40:41], v133 offset:23552
  v_lshlrev_b32 v12, 5, v12
  v_mfma_f32_16x16x32_bf16 v[88:91], a[56:59], a[4:7], v[88:91]
  ds_read_b64_tr_b16 a[42:43], v133 offset:29696
  v_lshrrev_b32 v13, 4, v10
  v_mfma_f32_16x16x32_bf16 v[92:95], a[56:59], a[8:11], v[92:95]
  v_lshl_add_u32 v12, v13, 3, v12
  s_add_u32 s48, s64, 162816
  v_mfma_f32_16x16x32_bf16 v[96:99], a[56:59], a[12:15], v[96:99]
  buffer_load_dwordx4 v141, s[8:11], s60 offen offset:2048 lds
  s_lshl_b32 s61, s68, 11
  v_mfma_f32_16x16x32_bf16 v[112:115], a[60:63], a[12:15], v[112:115]
  s_add_u32 m0, s63, 119808
  ds_read_b64_tr_b16 a[44:45], v134 offset:23552
  v_add_u32 v197, s48, v12
  v_mfma_f32_16x16x32_bf16 v[108:111], a[60:63], a[8:11], v[108:111]
  v_lshlrev_b32 v198, 2, v10
  s_lshr_b32 s48, s2, 2
  v_mfma_f32_16x16x32_bf16 v[104:107], a[60:63], a[4:7], v[104:107]
  s_and_b32 s49, s2, 3
  ds_read_b64_tr_b16 a[46:47], v134 offset:29696
  s_lshl_b32 s52, s48, 7
  v_mfma_f32_16x16x32_bf16 v[100:103], a[60:63], a[0:3], v[100:103]
  s_waitcnt vmcnt(17) lgkmcnt(4)
  s_barrier
  buffer_load_dwordx4 v142, s[36:39], s61 offen offset:0 sc1 lds
  v_mfma_f32_16x16x32_bf16 v[20:23], a[64:67], a[20:23], v[20:23]
  ds_read_b64_tr_b16 a[48:49], v133 offset:21504
  v_mfma_f32_16x16x32_bf16 v[24:27], a[64:67], a[24:27], v[24:27]
  v_mfma_f32_16x16x32_bf16 v[28:31], a[64:67], a[28:31], v[28:31]
  s_mul_i32 s53, s49, 24576
  ds_read_b64_tr_b16 a[50:51], v133 offset:27648
  s_lshl1_add_u32 s53, s52, s53
  v_mfma_f32_16x16x32_bf16 v[32:35], a[64:67], a[32:35], v[32:35]
  s_add_u32 s53, s53, 8192
  buffer_load_dwordx4 v142, s[36:39], s61 offen offset:1024 sc1 lds
  s_add_u32 m0, s64, 128000
  v_mfma_f32_16x16x32_bf16 v[116:119], a[64:67], a[36:39], v[116:119]
  s_add_u32 s52, s52, 4096
  ds_read_b64_tr_b16 a[52:53], v134 offset:21504
  v_mfma_f32_16x16x32_bf16 v[48:51], a[68:71], a[32:35], v[48:51]
  v_mfma_f32_16x16x32_bf16 v[44:47], a[68:71], a[28:31], v[44:47]
  ds_read_b64_tr_b16 a[54:55], v134 offset:27648
  v_mfma_f32_16x16x32_bf16 v[40:43], a[68:71], a[24:27], v[40:43]
  buffer_load_dword v143, s[36:39], s61 offen sc1 lds
  s_cmp_eq_u32 s57, 1
  v_mfma_f32_16x16x32_bf16 v[36:39], a[68:71], a[20:23], v[36:39]
  s_waitcnt lgkmcnt(4)
  s_cselect_b32 s69, 18, 10
  s_mul_i32 s60, s69, 196608
  v_mfma_f32_16x16x32_bf16 v[52:55], a[20:23], a[40:43], v[52:55]
  s_add_u32 m0, s62, 129024
  ds_read_b64_tr_b16 a[56:57], v133 offset:44032
  ds_read_b128 a[0:3], v144 offset:55296
  v_mfma_f32_16x16x32_bf16 v[56:59], a[24:27], a[40:43], v[56:59]
  s_lshr_b32 s49, s2, 3
  ds_read_b64_tr_b16 a[58:59], v133 offset:50176
  s_and_b32 s71, s49, 7
  v_mfma_f32_16x16x32_bf16 v[60:63], a[28:31], a[40:43], v[60:63]
  s_and_b32 s48, s2, 1
  buffer_load_dwordx4 v139, s[8:11], s60 offen offset:0 lds
  ds_read_b128 a[4:7], v144 offset:56320
  v_mfma_f32_16x16x32_bf16 v[64:67], a[32:35], a[40:43], v[64:67]
  s_lshl1_add_u32 s55, s71, s48
  v_mfma_f32_16x16x32_bf16 v[120:123], a[36:39], a[40:43], v[120:123]
  ds_read_b64_tr_b16 a[60:61], v134 offset:44032
  ds_read_b128 a[8:11], v144 offset:57344
  v_mfma_f32_16x16x32_bf16 v[80:83], a[32:35], a[44:47], v[80:83]
  s_bfe_u32 s54, s2, 0x20001
  s_lshr_b32 s49, s2, 6
  s_lshl2_add_u32 s54, s54, s49
  v_mfma_f32_16x16x32_bf16 v[76:79], a[28:31], a[44:47], v[76:79]
  s_lshl_b32 s73, s44, 12
  buffer_load_dwordx4 v140, s[8:11], s60 offen offset:1024 lds
  ds_read_b64_tr_b16 a[62:63], v134 offset:50176
  v_mfma_f32_16x16x32_bf16 v[72:75], a[24:27], a[44:47], v[72:75]
  ds_read_b128 a[12:15], v144 offset:58368
  v_mfma_f32_16x16x32_bf16 v[68:71], a[20:23], a[44:47], v[68:71]
  s_waitcnt lgkmcnt(8)
  ds_read_b128 a[16:19], v147 offset:63488
  ds_read_b64_tr_b16 a[64:65], v133 offset:45056
  v_mfma_f32_16x16x32_bf16 v[84:87], a[48:51], a[20:23], v[84:87]
  v_mfma_f32_16x16x32_bf16 v[88:91], a[48:51], a[24:27], v[88:91]
  buffer_load_dwordx4 v141, s[8:11], s60 offen offset:2048 lds
  s_lshl_b32 s61, s69, 11
  v_mfma_f32_16x16x32_bf16 v[92:95], a[48:51], a[28:31], v[92:95]
  s_add_u32 m0, s63, 141312
  ds_read_b64_tr_b16 a[66:67], v133 offset:51200
  v_mfma_f32_16x16x32_bf16 v[96:99], a[48:51], a[32:35], v[96:99]
  s_lshl_b32 s48, s55, 7
  s_lshl_b32 s49, s44, 16
  s_add_u32 s48, s48, s49
  v_mfma_f32_16x16x32_bf16 v[112:115], a[52:55], a[32:35], v[112:115]
  ds_read_b64_tr_b16 a[68:69], v134 offset:45056
  v_lshrrev_b32 v12, 3, v10
  v_mfma_f32_16x16x32_bf16 v[108:111], a[52:55], a[28:31], v[108:111]
  buffer_load_dwordx4 v142, s[36:39], s61 offen offset:0 sc1 lds
  v_lshlrev_b32 v12, 11, v12
  v_mfma_f32_16x16x32_bf16 v[104:107], a[52:55], a[24:27], v[104:107]
  ds_read_b64_tr_b16 a[70:71], v134 offset:51200
  v_add3_u32 v216, v12, v150, s48
  v_mfma_f32_16x16x32_bf16 v[100:103], a[52:55], a[20:23], v[100:103]
  s_waitcnt vmcnt(17) lgkmcnt(4)
  s_barrier
  v_mfma_f32_16x16x32_bf16 v[20:23], a[56:59], a[0:3], v[20:23]
  ds_read_b64_tr_b16 a[40:41], v133 offset:43008
  v_mfma_f32_16x16x32_bf16 v[24:27], a[56:59], a[4:7], v[24:27]
  buffer_load_dwordx4 v142, s[36:39], s61 offen offset:1024 sc1 lds
  s_add_u32 m0, s64, 149504
  v_mfma_f32_16x16x32_bf16 v[28:31], a[56:59], a[8:11], v[28:31]
  ds_read_b64_tr_b16 a[42:43], v133 offset:49152
  v_mfma_f32_16x16x32_bf16 v[32:35], a[56:59], a[12:15], v[32:35]
  v_mfma_f32_16x16x32_bf16 v[116:119], a[56:59], a[16:19], v[116:119]
  ds_read_b64_tr_b16 a[44:45], v134 offset:43008
  v_add_u32 v217, 15360, v216
  v_mfma_f32_16x16x32_bf16 v[48:51], a[60:63], a[12:15], v[48:51]
  buffer_load_dword v143, s[36:39], s61 offen sc1 lds
  s_cmp_eq_u32 s57, 1
  v_mfma_f32_16x16x32_bf16 v[44:47], a[60:63], a[8:11], v[44:47]
  s_cselect_b32 s70, 19, 11
  s_mul_i32 s60, s70, 196608
  s_add_u32 m0, s62, 0
  v_mfma_f32_16x16x32_bf16 v[40:43], a[60:63], a[4:7], v[40:43]
  ds_read_b64_tr_b16 a[46:47], v134 offset:49152
  v_add_u32 v218, 30720, v216
  v_mfma_f32_16x16x32_bf16 v[36:39], a[60:63], a[0:3], v[36:39]
  s_waitcnt lgkmcnt(4)
  ds_read_b64_tr_b16 a[48:49], v135 offset:1024
  v_add_u32 v219, 46080, v216
  v_mfma_f32_16x16x32_bf16 v[52:55], a[0:3], a[64:67], v[52:55]
  s_lshl_b32 s72, s54, 18
  buffer_load_dwordx4 v139, s[8:11], s60 offen offset:0 lds
  ds_read_b128 a[20:23], v145 offset:12288
  v_mfma_f32_16x16x32_bf16 v[56:59], a[4:7], a[64:67], v[56:59]
  s_add_u32 s72, s72, s48
  ds_read_b64_tr_b16 a[50:51], v135 offset:7168
  v_mfma_f32_16x16x32_bf16 v[60:63], a[8:11], a[64:67], v[60:63]
  ds_read_b128 a[24:27], v145 offset:13312
  v_mfma_f32_16x16x32_bf16 v[64:67], a[12:15], a[64:67], v[64:67]
  v_and_b32 v13, 7, v10
  v_lshrrev_b32 v14, 4, v10
  v_mfma_f32_16x16x32_bf16 v[120:123], a[16:19], a[64:67], v[120:123]
  buffer_load_dwordx4 v140, s[8:11], s60 offen offset:1024 lds
  ds_read_b64_tr_b16 a[52:53], v136 offset:1024
  v_mfma_f32_16x16x32_bf16 v[80:83], a[12:15], a[68:71], v[80:83]
  ds_read_b128 a[28:31], v145 offset:14336
  v_xor_b32 v13, v13, v14
  v_mfma_f32_16x16x32_bf16 v[76:79], a[8:11], a[68:71], v[76:79]
  ds_read_b64_tr_b16 a[54:55], v136 offset:7168
  ds_read_b128 a[32:35], v145 offset:15360
  v_mfma_f32_16x16x32_bf16 v[72:75], a[4:7], a[68:71], v[72:75]
  v_lshl_add_u32 v220, v13, 4, v12
  v_xor_b32 v221, 64, v220
  v_mfma_f32_16x16x32_bf16 v[68:71], a[0:3], a[68:71], v[68:71]
  s_waitcnt lgkmcnt(8)
  buffer_load_dwordx4 v141, s[8:11], s60 offen offset:2048 lds
  s_lshl_b32 s61, s70, 11
  v_mfma_f32_16x16x32_bf16 v[84:87], a[40:43], a[0:3], v[84:87]
  s_add_u32 m0, s63, 12288
  ds_read_b128 a[36:39], v148 offset:20480
  ds_read_b64_tr_b16 a[56:57], v135 offset:2048
  v_mfma_f32_16x16x32_bf16 v[88:91], a[40:43], a[4:7], v[88:91]
  ds_read_b64_tr_b16 a[58:59], v135 offset:8192
  v_add_u32 v221, 15360, v221
  v_mfma_f32_16x16x32_bf16 v[92:95], a[40:43], a[8:11], v[92:95]
  v_mfma_f32_16x16x32_bf16 v[96:99], a[40:43], a[12:15], v[96:99]
  buffer_load_dwordx4 v142, s[36:39], s61 offen offset:0 sc1 lds
  v_mfma_f32_16x16x32_bf16 v[112:115], a[44:47], a[12:15], v[112:115]
  s_lshl_b32 s48, s44, 10
  ds_read_b64_tr_b16 a[60:61], v136 offset:2048
  s_add_u32 s48, s48, 147456
  v_mfma_f32_16x16x32_bf16 v[108:111], a[44:47], a[8:11], v[108:111]
  v_add_u32 v246, s48, v0
  v_lshl_add_u32 v244, v14, 4, s48
  v_mfma_f32_16x16x32_bf16 v[104:107], a[44:47], a[4:7], v[104:107]
  ds_read_b64_tr_b16 a[62:63], v136 offset:8192
  v_and_b32 v12, 1, v10
  v_mfma_f32_16x16x32_bf16 v[100:103], a[44:47], a[0:3], v[100:103]
  s_waitcnt vmcnt(17) lgkmcnt(4)
  s_barrier
  buffer_load_dwordx4 v142, s[36:39], s61 offen offset:1024 sc1 lds
  v_mfma_f32_16x16x32_bf16 v[20:23], a[48:51], a[20:23], v[20:23]
  s_add_u32 m0, s64, 20480
  ds_read_b64_tr_b16 a[64:65], v135 offset:0
  v_lshlrev_b32 v12, 8, v12
  v_mfma_f32_16x16x32_bf16 v[24:27], a[48:51], a[24:27], v[24:27]
  v_sub_u32 v245, v244, v12
  v_mfma_f32_16x16x32_bf16 v[28:31], a[48:51], a[28:31], v[28:31]
  ds_read_b64_tr_b16 a[66:67], v135 offset:6144
  v_mfma_f32_16x16x32_bf16 v[32:35], a[48:51], a[32:35], v[32:35]
  buffer_load_dword v143, s[36:39], s61 offen sc1 lds
  s_cmp_eq_u32 s57, 2
  v_mfma_f32_16x16x32_bf16 v[116:119], a[48:51], a[36:39], v[116:119]
  s_cselect_b32 s65, 20, 12
  s_mul_i32 s60, s65, 196608
  s_add_u32 m0, s62, 21504
  v_mfma_f32_16x16x32_bf16 v[48:51], a[52:55], a[32:35], v[48:51]
  ds_read_b64_tr_b16 a[68:69], v136 offset:0
  v_mfma_f32_16x16x32_bf16 v[44:47], a[52:55], a[28:31], v[44:47]
  ds_read_b64_tr_b16 a[70:71], v136 offset:6144
  v_mfma_f32_16x16x32_bf16 v[40:43], a[52:55], a[24:27], v[40:43]
  s_lshl_b32 s48, s55, 7
  buffer_load_dwordx4 v139, s[8:11], s60 offen offset:0 lds
  v_and_b32 v13, 0xf0, v0
  v_mfma_f32_16x16x32_bf16 v[36:39], a[52:55], a[20:23], v[36:39]
  s_waitcnt lgkmcnt(4)
  ds_read_b64_tr_b16 a[40:41], v135 offset:22528
  v_lshl_add_u32 v13, v14, 12, v13
  v_mfma_f32_16x16x32_bf16 v[52:55], a[20:23], a[56:59], v[52:55]
  s_lshl1_add_u32 s48, s48, 8192
  ds_read_b128 a[0:3], v145 offset:33792
  v_add_u32 v248, s48, v13
  v_mfma_f32_16x16x32_bf16 v[56:59], a[24:27], a[56:59], v[56:59]
  ds_read_b64_tr_b16 a[42:43], v135 offset:28672
  v_mfma_f32_16x16x32_bf16 v[60:63], a[28:31], a[56:59], v[60:63]
  buffer_load_dwordx4 v140, s[8:11], s60 offen offset:1024 lds
  ds_read_b128 a[4:7], v145 offset:34816
  v_mfma_f32_16x16x32_bf16 v[64:67], a[32:35], a[56:59], v[64:67]
  v_mfma_f32_16x16x32_bf16 v[120:123], a[36:39], a[56:59], v[120:123]
  ds_read_b64_tr_b16 a[44:45], v136 offset:22528
  ds_read_b128 a[8:11], v145 offset:35840
  v_mfma_f32_16x16x32_bf16 v[80:83], a[32:35], a[60:63], v[80:83]
  v_mfma_f32_16x16x32_bf16 v[76:79], a[28:31], a[60:63], v[76:79]
  buffer_load_dwordx4 v141, s[8:11], s60 offen offset:2048 lds
  s_lshl_b32 s61, s65, 11
  v_mfma_f32_16x16x32_bf16 v[72:75], a[24:27], a[60:63], v[72:75]
  s_add_u32 m0, s63, 33792
  ds_read_b64_tr_b16 a[46:47], v136 offset:28672
  ds_read_b128 a[12:15], v145 offset:36864
  v_mfma_f32_16x16x32_bf16 v[68:71], a[20:23], a[60:63], v[68:71]
  s_waitcnt lgkmcnt(8)
  ds_read_b128 a[16:19], v148 offset:41984
  ds_read_b64_tr_b16 a[48:49], v135 offset:23552
  v_mfma_f32_16x16x32_bf16 v[84:87], a[64:67], a[20:23], v[84:87]
  v_lshrrev_b32 v12, 2, v10
  v_lshl_add_u32 v231, v12, 7, v151
  v_mfma_f32_16x16x32_bf16 v[88:91], a[64:67], a[24:27], v[88:91]
  buffer_load_dwordx4 v142, s[36:39], s61 offen offset:0 sc1 lds
  ds_read_b64_tr_b16 a[50:51], v135 offset:29696
  v_mfma_f32_16x16x32_bf16 v[92:95], a[64:67], a[28:31], v[92:95]
  v_xor_b32 v232, 32, v231
  v_xor_b32 v233, 64, v231
  v_mfma_f32_16x16x32_bf16 v[96:99], a[64:67], a[32:35], v[96:99]
  v_xor_b32 v234, 96, v231
  v_mfma_f32_16x16x32_bf16 v[112:115], a[68:71], a[32:35], v[112:115]
  ds_read_b64_tr_b16 a[52:53], v136 offset:23552
  v_mfma_f32_16x16x32_bf16 v[108:111], a[68:71], a[28:31], v[108:111]
  buffer_load_dwordx4 v142, s[36:39], s61 offen offset:1024 sc1 lds
  s_add_u32 m0, s64, 41984
  v_mfma_f32_16x16x32_bf16 v[104:107], a[68:71], a[24:27], v[104:107]
  ds_read_b64_tr_b16 a[54:55], v136 offset:29696
  v_xor_b32 v235, 65536, v231
  v_mfma_f32_16x16x32_bf16 v[100:103], a[68:71], a[20:23], v[100:103]
  s_waitcnt vmcnt(17) lgkmcnt(4)
  s_barrier
  v_xor_b32 v236, 65568, v231
  v_mfma_f32_16x16x32_bf16 v[20:23], a[40:43], a[0:3], v[20:23]
  ds_read_b64_tr_b16 a[56:57], v135 offset:21504
  v_xor_b32 v237, 65600, v231
  v_mfma_f32_16x16x32_bf16 v[24:27], a[40:43], a[4:7], v[24:27]
  buffer_load_dword v143, s[36:39], s61 offen sc1 lds
  s_cmp_eq_u32 s57, 2
  v_mfma_f32_16x16x32_bf16 v[28:31], a[40:43], a[8:11], v[28:31]
  s_cselect_b32 s66, 21, 13
  s_mul_i32 s60, s66, 196608
  s_add_u32 m0, s62, 43008
  v_mfma_f32_16x16x32_bf16 v[32:35], a[40:43], a[12:15], v[32:35]
  ds_read_b64_tr_b16 a[58:59], v135 offset:27648
  v_xor_b32 v238, 65632, v231
  v_mfma_f32_16x16x32_bf16 v[116:119], a[40:43], a[16:19], v[116:119]
  s_add_u32 s48, s73, 131072
  ds_read_b64_tr_b16 a[60:61], v136 offset:21504
  v_and_b32 v12, 15, v10
  v_mfma_f32_16x16x32_bf16 v[48:51], a[44:47], a[12:15], v[48:51]
  buffer_load_dwordx4 v139, s[8:11], s60 offen offset:0 lds
  v_lshrrev_b32 v14, 1, v12
  v_mfma_f32_16x16x32_bf16 v[44:47], a[44:47], a[8:11], v[44:47]
  ds_read_b64_tr_b16 a[62:63], v136 offset:27648
  v_lshrrev_b32 v13, 5, v10
  v_mfma_f32_16x16x32_bf16 v[40:43], a[44:47], a[4:7], v[40:43]
  v_xor_b32 v14, v14, v13
  v_lshlrev_b32 v14, 4, v14
  v_mfma_f32_16x16x32_bf16 v[36:39], a[44:47], a[0:3], v[36:39]
  s_waitcnt lgkmcnt(4)
  ds_read_b64_tr_b16 a[64:65], v135 offset:44032
  v_lshl_add_u32 v14, v12, 7, v14
  v_mfma_f32_16x16x32_bf16 v[52:55], a[0:3], a[48:51], v[52:55]
  buffer_load_dwordx4 v140, s[8:11], s60 offen offset:1024 lds
  ds_read_b128 a[20:23], v145 offset:55296
  v_mfma_f32_16x16x32_bf16 v[56:59], a[4:7], a[48:51], v[56:59]
  ds_read_b64_tr_b16 a[66:67], v135 offset:50176
  v_bfe_u32 v13, v10, 4, 1
  v_mfma_f32_16x16x32_bf16 v[60:63], a[8:11], a[48:51], v[60:63]
  ds_read_b128 a[24:27], v145 offset:56320
  v_lshl_add_u32 v14, v13, 3, v14
  v_mfma_f32_16x16x32_bf16 v[64:67], a[12:15], a[48:51], v[64:67]
  v_add_u32 v239, s48, v14
  v_xor_b32 v240, 32, v239
  v_mfma_f32_16x16x32_bf16 v[120:123], a[16:19], a[48:51], v[120:123]
  buffer_load_dwordx4 v141, s[8:11], s60 offen offset:2048 lds
  s_lshl_b32 s61, s66, 11
  v_mfma_f32_16x16x32_bf16 v[80:83], a[12:15], a[52:55], v[80:83]
  s_add_u32 m0, s63, 55296
  ds_read_b64_tr_b16 a[68:69], v136 offset:44032
  ds_read_b128 a[28:31], v145 offset:57344
  v_mfma_f32_16x16x32_bf16 v[76:79], a[8:11], a[52:55], v[76:79]
  ds_read_b64_tr_b16 a[70:71], v136 offset:50176
  ds_read_b128 a[32:35], v145 offset:58368
  v_mfma_f32_16x16x32_bf16 v[72:75], a[4:7], a[52:55], v[72:75]
  v_xor_b32 v241, 64, v239
  v_xor_b32 v242, 96, v239
  v_mfma_f32_16x16x32_bf16 v[68:71], a[0:3], a[52:55], v[68:71]
  s_waitcnt lgkmcnt(8)
  buffer_load_dwordx4 v142, s[36:39], s61 offen offset:0 sc1 lds
  ds_read_b128 a[36:39], v148 offset:63488
  v_mfma_f32_16x16x32_bf16 v[84:87], a[56:59], a[0:3], v[84:87]
  ds_read_b64_tr_b16 a[40:41], v135 offset:45056
  v_mfma_f32_16x16x32_bf16 v[88:91], a[56:59], a[4:7], v[88:91]
  ds_read_b64_tr_b16 a[42:43], v135 offset:51200
  v_mfma_f32_16x16x32_bf16 v[92:95], a[56:59], a[8:11], v[92:95]
  v_mfma_f32_16x16x32_bf16 v[96:99], a[56:59], a[12:15], v[96:99]
  buffer_load_dwordx4 v142, s[36:39], s61 offen offset:1024 sc1 lds
  s_add_u32 m0, s64, 63488
  v_mfma_f32_16x16x32_bf16 v[112:115], a[60:63], a[12:15], v[112:115]
  ds_read_b64_tr_b16 a[44:45], v136 offset:45056
  v_mfma_f32_16x16x32_bf16 v[108:111], a[60:63], a[8:11], v[108:111]
  v_mfma_f32_16x16x32_bf16 v[104:107], a[60:63], a[4:7], v[104:107]
  s_lshl2_add_u32 s48, s54, s44
  ds_read_b64_tr_b16 a[46:47], v136 offset:51200
  s_lshl_b32 s49, s48, 16
  v_mfma_f32_16x16x32_bf16 v[100:103], a[60:63], a[0:3], v[100:103]
  s_waitcnt vmcnt(17) lgkmcnt(4)
  s_barrier
  buffer_load_dword v143, s[36:39], s61 offen sc1 lds
  v_mfma_f32_16x16x32_bf16 v[20:23], a[64:67], a[20:23], v[20:23]
  s_cmp_eq_u32 s57, 3
  s_cselect_b32 s67, 22, 14
  s_mul_i32 s60, s67, 196608
  v_mfma_f32_16x16x32_bf16 v[24:27], a[64:67], a[24:27], v[24:27]
  s_add_u32 m0, s62, 64512
  ds_read_b64_tr_b16 a[48:49], v135 offset:43008
  s_add_u32 s49, s49, 7340032
  v_mfma_f32_16x16x32_bf16 v[28:31], a[64:67], a[28:31], v[28:31]
  ds_read_b64_tr_b16 a[50:51], v135 offset:49152
  v_add_u32 v243, s49, v0
  v_mfma_f32_16x16x32_bf16 v[32:35], a[64:67], a[32:35], v[32:35]
  buffer_load_dwordx4 v139, s[8:11], s60 offen offset:0 lds
  v_mfma_f32_16x16x32_bf16 v[116:119], a[64:67], a[36:39], v[116:119]
  ds_read_b64_tr_b16 a[52:53], v136 offset:43008
  v_mfma_f32_16x16x32_bf16 v[48:51], a[68:71], a[32:35], v[48:51]
  s_lshl4_add_u32 s77, s48, s55
  s_lshl_b32 s77, s77, 8
  s_add_u32 s77, s77, 262144
  v_mfma_f32_16x16x32_bf16 v[44:47], a[68:71], a[28:31], v[44:47]
  ds_read_b64_tr_b16 a[54:55], v136 offset:49152
  v_mfma_f32_16x16x32_bf16 v[40:43], a[68:71], a[24:27], v[40:43]
  buffer_load_dwordx4 v140, s[8:11], s60 offen offset:1024 lds
  v_mfma_f32_16x16x32_bf16 v[36:39], a[68:71], a[20:23], v[36:39]
  s_waitcnt lgkmcnt(4)
  ds_read_b64_tr_b16 a[56:57], v137 offset:1024
  v_mfma_f32_16x16x32_bf16 v[52:55], a[20:23], a[40:43], v[52:55]
  s_lshr_b32 s76, s48, 1
  ds_read_b128 a[0:3], v146 offset:12288
  s_lshl4_add_u32 s76, s76, s55
  v_mfma_f32_16x16x32_bf16 v[56:59], a[24:27], a[40:43], v[56:59]
  s_and_b32 s49, s48, 1
  ds_read_b64_tr_b16 a[58:59], v137 offset:7168
  s_lshl2_add_u32 s76, s76, s49
  v_mfma_f32_16x16x32_bf16 v[60:63], a[28:31], a[40:43], v[60:63]
  s_lshl_b32 s76, s76, 11
  buffer_load_dwordx4 v141, s[8:11], s60 offen offset:2048 lds
  s_lshl_b32 s61, s67, 11
  v_mfma_f32_16x16x32_bf16 v[64:67], a[32:35], a[40:43], v[64:67]
  s_add_u32 m0, s63, 76800
  ds_read_b128 a[4:7], v146 offset:13312
  s_add_u32 s76, s76, 36700160
  v_mfma_f32_16x16x32_bf16 v[120:123], a[36:39], a[40:43], v[120:123]
  ds_read_b64_tr_b16 a[60:61], v138 offset:1024
  ds_read_b128 a[8:11], v146 offset:14336
  v_mfma_f32_16x16x32_bf16 v[80:83], a[32:35], a[44:47], v[80:83]
  v_mfma_f32_16x16x32_bf16 v[76:79], a[28:31], a[44:47], v[76:79]
  buffer_load_dwordx4 v142, s[36:39], s61 offen offset:0 sc1 lds
  ds_read_b64_tr_b16 a[62:63], v138 offset:7168
  v_mfma_f32_16x16x32_bf16 v[72:75], a[24:27], a[44:47], v[72:75]
  ds_read_b128 a[12:15], v146 offset:15360
  v_mfma_f32_16x16x32_bf16 v[68:71], a[20:23], a[44:47], v[68:71]
  s_waitcnt lgkmcnt(8)
  ds_read_b128 a[16:19], v149 offset:20480
  ds_read_b64_tr_b16 a[64:65], v137 offset:2048
  v_mfma_f32_16x16x32_bf16 v[84:87], a[48:51], a[20:23], v[84:87]
  v_mfma_f32_16x16x32_bf16 v[88:91], a[48:51], a[24:27], v[88:91]
  s_lshl1_add_u32 s78, s48, s55
  buffer_load_dwordx4 v142, s[36:39], s61 offen offset:1024 sc1 lds
  s_add_u32 m0, s64, 84992
  v_mfma_f32_16x16x32_bf16 v[92:95], a[48:51], a[28:31], v[92:95]
  s_lshl_b32 s78, s78, 11
  ds_read_b64_tr_b16 a[66:67], v137 offset:8192
  s_add_u32 s78, s78, 5767168
  v_mfma_f32_16x16x32_bf16 v[96:99], a[48:51], a[32:35], v[96:99]
  s_and_b32 s48, s48, 7
  s_cselect_b32 s78, 1073741824, s78
  v_mfma_f32_16x16x32_bf16 v[112:115], a[52:55], a[32:35], v[112:115]
  ds_read_b64_tr_b16 a[68:69], v138 offset:2048
  v_mfma_f32_16x16x32_bf16 v[108:111], a[52:55], a[28:31], v[108:111]
  buffer_load_dword v143, s[36:39], s61 offen sc1 lds
  s_cmp_eq_u32 s57, 3
  v_mfma_f32_16x16x32_bf16 v[104:107], a[52:55], a[24:27], v[104:107]
  s_cselect_b32 s68, 23, 15
  s_mul_i32 s60, s68, 196608
  s_add_u32 m0, s62, 86016
  v_mfma_f32_16x16x32_bf16 v[100:103], a[52:55], a[20:23], v[100:103]
  s_waitcnt vmcnt(18) lgkmcnt(3)
  s_barrier
  ds_read_b64_tr_b16 a[70:71], v138 offset:8192
  v_mfma_f32_16x16x32_bf16 v[20:23], a[56:59], a[0:3], v[20:23]
  ds_read_b64_tr_b16 a[40:41], v137 offset:0
  v_mfma_f32_16x16x32_bf16 v[24:27], a[56:59], a[4:7], v[24:27]
  s_and_b32 s48, s54, 7
  buffer_load_dwordx4 v139, s[8:11], s60 offen offset:0 lds
  s_lshl_b32 s48, s48, 5
  v_mfma_f32_16x16x32_bf16 v[28:31], a[56:59], a[8:11], v[28:31]
  s_lshr_b32 s49, s54, 3
  ds_read_b64_tr_b16 a[42:43], v137 offset:6144
  s_lshl2_add_u32 s48, s49, s48
  v_mfma_f32_16x16x32_bf16 v[32:35], a[56:59], a[12:15], v[32:35]
  v_mfma_f32_16x16x32_bf16 v[116:119], a[56:59], a[16:19], v[116:119]
  ds_read_b64_tr_b16 a[44:45], v138 offset:0
  v_mfma_f32_16x16x32_bf16 v[48:51], a[60:63], a[12:15], v[48:51]
  buffer_load_dwordx4 v140, s[8:11], s60 offen offset:1024 lds
  v_mfma_f32_16x16x32_bf16 v[44:47], a[60:63], a[8:11], v[44:47]
  ds_read_b64_tr_b16 a[46:47], v138 offset:6144
  v_mfma_f32_16x16x32_bf16 v[40:43], a[60:63], a[4:7], v[40:43]
  v_and_b32 v12, 3, v10
  v_bfe_u32 v13, v10, 2, 2
  v_mfma_f32_16x16x32_bf16 v[36:39], a[60:63], a[0:3], v[36:39]
  s_waitcnt lgkmcnt(4)
  ds_read_b64_tr_b16 a[48:49], v133 offset:1024
  v_lshl_add_u32 v12, v13, 3, v12
  v_mfma_f32_16x16x32_bf16 v[52:55], a[0:3], a[64:67], v[52:55]
  buffer_load_dwordx4 v141, s[8:11], s60 offen offset:2048 lds
  s_lshl_b32 s61, s68, 11
  v_mfma_f32_16x16x32_bf16 v[56:59], a[4:7], a[64:67], v[56:59]
  s_add_u32 m0, s63, 98304
  ds_read_b128 a[20:23], v144 offset:12288
  ds_read_b64_tr_b16 a[50:51], v133 offset:7168
  v_mfma_f32_16x16x32_bf16 v[60:63], a[8:11], a[64:67], v[60:63]
  ds_read_b128 a[24:27], v144 offset:13312
  v_add_lshl_u32 v249, v12, s48, 7
  v_mfma_f32_16x16x32_bf16 v[64:67], a[12:15], a[64:67], v[64:67]
  v_mfma_f32_16x16x32_bf16 v[120:123], a[16:19], a[64:67], v[120:123]
  buffer_load_dwordx4 v142, s[36:39], s61 offen offset:0 sc1 lds
  ds_read_b64_tr_b16 a[52:53], v134 offset:1024
  v_mfma_f32_16x16x32_bf16 v[80:83], a[12:15], a[68:71], v[80:83]
  s_waitcnt vmcnt(39)
  ds_read_b128 a[28:31], v144 offset:14336
  v_mfma_f32_16x16x32_bf16 v[76:79], a[8:11], a[68:71], v[76:79]
  ds_read_b64_tr_b16 a[54:55], v134 offset:7168
  ds_read_b128 a[32:35], v144 offset:15360
  v_mfma_f32_16x16x32_bf16 v[72:75], a[4:7], a[68:71], v[72:75]
  v_lshlrev_b32 v188, 16, v208
  v_mfma_f32_16x16x32_bf16 v[68:71], a[0:3], a[68:71], v[68:71]
  s_waitcnt lgkmcnt(8)
  buffer_load_dwordx4 v142, s[36:39], s61 offen offset:1024 sc1 lds
  s_add_u32 m0, s64, 106496
  v_mfma_f32_16x16x32_bf16 v[84:87], a[40:43], a[0:3], v[84:87]
  ds_read_b128 a[36:39], v147 offset:20480
  ds_read_b64_tr_b16 a[56:57], v133 offset:2048
  v_mfma_f32_16x16x32_bf16 v[88:91], a[40:43], a[4:7], v[88:91]
  ds_read_b64_tr_b16 a[58:59], v133 offset:8192
  v_and_b32 v189, 0xffff0000, v208
  v_mfma_f32_16x16x32_bf16 v[92:95], a[40:43], a[8:11], v[92:95]
  v_lshlrev_b32 v190, 16, v209
  v_and_b32 v191, 0xffff0000, v209
  v_mfma_f32_16x16x32_bf16 v[96:99], a[40:43], a[12:15], v[96:99]
  buffer_load_dword v143, s[36:39], s61 offen sc1 lds
  s_cmp_eq_u32 s57, 0
  v_mfma_f32_16x16x32_bf16 v[112:115], a[44:47], a[12:15], v[112:115]
  s_cselect_b32 s69, 24, 16
  s_mul_i32 s60, s69, 196608
  s_add_u32 m0, s62, 107520
  v_mfma_f32_16x16x32_bf16 v[108:111], a[44:47], a[8:11], v[108:111]
  ds_read_b64_tr_b16 a[60:61], v134 offset:2048
  v_lshlrev_b32 v192, 16, v210
  v_mfma_f32_16x16x32_bf16 v[104:107], a[44:47], a[4:7], v[104:107]
  ds_read_b64_tr_b16 a[62:63], v134 offset:8192
  v_and_b32 v193, 0xffff0000, v210
  v_mfma_f32_16x16x32_bf16 v[100:103], a[44:47], a[0:3], v[100:103]
  s_waitcnt vmcnt(18) lgkmcnt(4)
  s_barrier
  buffer_load_dwordx4 v139, s[8:11], s60 offen offset:0 lds
  v_mfma_f32_16x16x32_bf16 v[20:23], a[48:51], a[20:23], v[20:23]
  ds_read_b64_tr_b16 a[64:65], v133 offset:0
  v_lshlrev_b32 v194, 16, v211
  v_mfma_f32_16x16x32_bf16 v[24:27], a[48:51], a[24:27], v[24:27]
  v_and_b32 v195, 0xffff0000, v211
  v_mfma_f32_16x16x32_bf16 v[28:31], a[48:51], a[28:31], v[28:31]
  ds_read_b64_tr_b16 a[66:67], v133 offset:6144
  v_mul_f32 v200, 0xbfb8aa3b, v188
  v_mfma_f32_16x16x32_bf16 v[32:35], a[48:51], a[32:35], v[32:35]
  buffer_load_dwordx4 v140, s[8:11], s60 offen offset:1024 lds
  v_mfma_f32_16x16x32_bf16 v[116:119], a[48:51], a[36:39], v[116:119]
  ds_read_b64_tr_b16 a[68:69], v134 offset:0
  v_mul_f32 v201, 0xbfb8aa3b, v189
  v_mfma_f32_16x16x32_bf16 v[48:51], a[52:55], a[32:35], v[48:51]
  v_mfma_f32_16x16x32_bf16 v[44:47], a[52:55], a[28:31], v[44:47]
  ds_read_b64_tr_b16 a[70:71], v134 offset:6144
  v_mul_f32 v202, 0xbfb8aa3b, v190
  v_mfma_f32_16x16x32_bf16 v[40:43], a[52:55], a[24:27], v[40:43]
  buffer_load_dwordx4 v141, s[8:11], s60 offen offset:2048 lds
  s_lshl_b32 s61, s69, 11
  v_mfma_f32_16x16x32_bf16 v[36:39], a[52:55], a[20:23], v[36:39]
  s_waitcnt lgkmcnt(4)
  s_add_u32 m0, s63, 119808
  ds_read_b64_tr_b16 a[40:41], v133 offset:22528
  v_mfma_f32_16x16x32_bf16 v[52:55], a[20:23], a[56:59], v[52:55]
  ds_read_b128 a[0:3], v144 offset:33792
  v_mul_f32 v203, 0xbfb8aa3b, v191
  v_mfma_f32_16x16x32_bf16 v[56:59], a[24:27], a[56:59], v[56:59]
  ds_read_b64_tr_b16 a[42:43], v133 offset:28672
  v_mul_f32 v204, 0xbfb8aa3b, v192
  v_mfma_f32_16x16x32_bf16 v[60:63], a[28:31], a[56:59], v[60:63]
  buffer_load_dwordx4 v142, s[36:39], s61 offen offset:0 sc1 lds
  ds_read_b128 a[4:7], v144 offset:34816
  v_mfma_f32_16x16x32_bf16 v[64:67], a[32:35], a[56:59], v[64:67]
  v_mul_f32 v205, 0xbfb8aa3b, v193
  v_mul_f32 v206, 0xbfb8aa3b, v194
  v_mfma_f32_16x16x32_bf16 v[120:123], a[36:39], a[56:59], v[120:123]
  ds_read_b64_tr_b16 a[44:45], v134 offset:22528
  ds_read_b128 a[8:11], v144 offset:35840
  v_mfma_f32_16x16x32_bf16 v[80:83], a[32:35], a[60:63], v[80:83]
  v_mul_f32 v207, 0xbfb8aa3b, v195
  v_mfma_f32_16x16x32_bf16 v[76:79], a[28:31], a[60:63], v[76:79]
  buffer_load_dwordx4 v142, s[36:39], s61 offen offset:1024 sc1 lds
  s_add_u32 m0, s64, 128000
  v_mfma_f32_16x16x32_bf16 v[72:75], a[24:27], a[60:63], v[72:75]
  ds_read_b64_tr_b16 a[46:47], v134 offset:28672
  ds_read_b128 a[12:15], v144 offset:36864
  v_mfma_f32_16x16x32_bf16 v[68:71], a[20:23], a[60:63], v[68:71]
  s_waitcnt lgkmcnt(8)
  ds_read_b128 a[16:19], v147 offset:41984
  ds_read_b64_tr_b16 a[48:49], v133 offset:23552
  v_mfma_f32_16x16x32_bf16 v[84:87], a[64:67], a[20:23], v[84:87]
  v_exp_f32 v200, v200
  v_mfma_f32_16x16x32_bf16 v[88:91], a[64:67], a[24:27], v[88:91]
  buffer_load_dword v143, s[36:39], s61 offen sc1 lds
  s_cmp_eq_u32 s57, 0
  v_mfma_f32_16x16x32_bf16 v[92:95], a[64:67], a[28:31], v[92:95]
  s_cselect_b32 s70, 25, 17
  s_mul_i32 s60, s70, 196608
  s_add_u32 m0, s62, 129024
  v_mfma_f32_16x16x32_bf16 v[96:99], a[64:67], a[32:35], v[96:99]
  ds_read_b64_tr_b16 a[50:51], v133 offset:29696
  v_mfma_f32_16x16x32_bf16 v[112:115], a[68:71], a[32:35], v[112:115]
  ds_read_b64_tr_b16 a[52:53], v134 offset:23552
  v_mfma_f32_16x16x32_bf16 v[108:111], a[68:71], a[28:31], v[108:111]
  buffer_load_dwordx4 v139, s[8:11], s60 offen offset:0 lds
  v_mfma_f32_16x16x32_bf16 v[104:107], a[68:71], a[24:27], v[104:107]
  ds_read_b64_tr_b16 a[54:55], v134 offset:29696
CT3:
  s_add_u32 s94, s92, CT3-k3_main_kernel+3072
  s_addc_u32 s95, s93, 0
  v_mfma_f32_16x16x32_bf16 v[100:103], a[68:71], a[20:23], v[100:103]
  s_waitcnt vmcnt(19) lgkmcnt(4)
  s_barrier
  v_mfma_f32_16x16x32_bf16 v[20:23], a[40:43], a[0:3], v[20:23]
  ds_read_b64_tr_b16 a[56:57], v133 offset:21504
  v_mfma_f32_16x16x32_bf16 v[24:27], a[40:43], a[4:7], v[24:27]
  buffer_load_dwordx4 v140, s[8:11], s60 offen offset:1024 lds
  v_mfma_f32_16x16x32_bf16 v[28:31], a[40:43], a[8:11], v[28:31]
  ds_read_b64_tr_b16 a[58:59], v133 offset:27648
  v_mfma_f32_16x16x32_bf16 v[32:35], a[40:43], a[12:15], v[32:35]
  v_exp_f32 v201, v201
  v_mfma_f32_16x16x32_bf16 v[116:119], a[40:43], a[16:19], v[116:119]
  ds_read_b64_tr_b16 a[60:61], v134 offset:21504
  v_mfma_f32_16x16x32_bf16 v[48:51], a[44:47], a[12:15], v[48:51]
  buffer_load_dwordx4 v141, s[8:11], s60 offen offset:2048 lds
  s_lshl_b32 s61, s70, 11
  v_mfma_f32_16x16x32_bf16 v[44:47], a[44:47], a[8:11], v[44:47]
  s_add_u32 m0, s63, 141312
  ds_read_b64_tr_b16 a[62:63], v134 offset:27648
  v_mfma_f32_16x16x32_bf16 v[40:43], a[44:47], a[4:7], v[40:43]
  v_exp_f32 v202, v202
  v_mfma_f32_16x16x32_bf16 v[36:39], a[44:47], a[0:3], v[36:39]
  s_waitcnt lgkmcnt(4)
  ds_read_b64_tr_b16 a[64:65], v133 offset:44032
  v_mfma_f32_16x16x32_bf16 v[52:55], a[0:3], a[48:51], v[52:55]
  buffer_load_dwordx4 v142, s[36:39], s61 offen offset:0 sc1 lds
  ds_read_b128 a[20:23], v144 offset:55296
  v_mfma_f32_16x16x32_bf16 v[56:59], a[4:7], a[48:51], v[56:59]
  ds_read_b64_tr_b16 a[66:67], v133 offset:50176
  v_mfma_f32_16x16x32_bf16 v[60:63], a[8:11], a[48:51], v[60:63]
  ds_read_b128 a[24:27], v144 offset:56320
  v_mfma_f32_16x16x32_bf16 v[64:67], a[12:15], a[48:51], v[64:67]
  v_exp_f32 v203, v203
  v_mfma_f32_16x16x32_bf16 v[120:123], a[16:19], a[48:51], v[120:123]
  buffer_load_dwordx4 v142, s[36:39], s61 offen offset:1024 sc1 lds
  s_add_u32 m0, s64, 149504
  v_mfma_f32_16x16x32_bf16 v[80:83], a[12:15], a[52:55], v[80:83]
  ds_read_b64_tr_b16 a[68:69], v134 offset:44032
  ds_read_b128 a[28:31], v144 offset:57344
  v_mfma_f32_16x16x32_bf16 v[76:79], a[8:11], a[52:55], v[76:79]
  ds_read_b64_tr_b16 a[70:71], v134 offset:50176
  ds_read_b128 a[32:35], v144 offset:58368
  v_mfma_f32_16x16x32_bf16 v[72:75], a[4:7], a[52:55], v[72:75]
  v_exp_f32 v204, v204
  v_mfma_f32_16x16x32_bf16 v[68:71], a[0:3], a[52:55], v[68:71]
  s_waitcnt lgkmcnt(8)
  buffer_load_dword v143, s[36:39], s61 offen sc1 lds
  s_cmp_eq_u32 s57, 1
  v_mfma_f32_16x16x32_bf16 v[84:87], a[56:59], a[0:3], v[84:87]
  s_cselect_b32 s65, 26, 18
  s_mul_i32 s60, s65, 196608
  s_add_u32 m0, s62, 0
  v_mfma_f32_16x16x32_bf16 v[88:91], a[56:59], a[4:7], v[88:91]
  ds_read_b128 a[36:39], v147 offset:63488
  ds_read_b64_tr_b16 a[40:41], v133 offset:45056
  v_mfma_f32_16x16x32_bf16 v[92:95], a[56:59], a[8:11], v[92:95]
  ds_read_b64_tr_b16 a[42:43], v133 offset:51200
  v_mfma_f32_16x16x32_bf16 v[96:99], a[56:59], a[12:15], v[96:99]
  global_load_dword a252, v0, s[94:95]
  v_mfma_f32_16x16x32_bf16 v[112:115], a[60:63], a[12:15], v[112:115]
  ds_read_b64_tr_b16 a[44:45], v134 offset:45056
  v_mfma_f32_16x16x32_bf16 v[108:111], a[60:63], a[8:11], v[108:111]
  v_exp_f32 v205, v205
  v_mfma_f32_16x16x32_bf16 v[104:107], a[60:63], a[4:7], v[104:107]
  ds_read_b64_tr_b16 a[46:47], v134 offset:51200
  v_mfma_f32_16x16x32_bf16 v[100:103], a[60:63], a[0:3], v[100:103]
  s_waitcnt vmcnt(19) lgkmcnt(4)
  s_barrier
  buffer_load_dwordx4 v139, s[8:11], s60 offen offset:0 lds
  v_mfma_f32_16x16x32_bf16 v[20:23], a[64:67], a[20:23], v[20:23]
  ds_read_b64_tr_b16 a[48:49], v133 offset:43008
  v_mfma_f32_16x16x32_bf16 v[24:27], a[64:67], a[24:27], v[24:27]
  v_exp_f32 v206, v206
  v_mfma_f32_16x16x32_bf16 v[28:31], a[64:67], a[28:31], v[28:31]
  ds_read_b64_tr_b16 a[50:51], v133 offset:49152
  v_mfma_f32_16x16x32_bf16 v[32:35], a[64:67], a[32:35], v[32:35]
  buffer_load_dwordx4 v140, s[8:11], s60 offen offset:1024 lds
  v_mfma_f32_16x16x32_bf16 v[116:119], a[64:67], a[36:39], v[116:119]
  ds_read_b64_tr_b16 a[52:53], v134 offset:43008
  v_mfma_f32_16x16x32_bf16 v[48:51], a[68:71], a[32:35], v[48:51]
  v_exp_f32 v207, v207
  v_mfma_f32_16x16x32_bf16 v[44:47], a[68:71], a[28:31], v[44:47]
  ds_read_b64_tr_b16 a[54:55], v134 offset:49152
  v_add_f32 v200, 1.0, v200
  v_mfma_f32_16x16x32_bf16 v[40:43], a[68:71], a[24:27], v[40:43]
  buffer_load_dwordx4 v141, s[8:11], s60 offen offset:2048 lds
  s_lshl_b32 s61, s65, 11
  v_mfma_f32_16x16x32_bf16 v[36:39], a[68:71], a[20:23], v[36:39]
  s_waitcnt lgkmcnt(4)
  s_add_u32 m0, s63, 12288
  ds_read_b64_tr_b16 a[56:57], v135 offset:1024
  v_mfma_f32_16x16x32_bf16 v[52:55], a[20:23], a[40:43], v[52:55]
  ds_read_b128 a[0:3], v145 offset:12288
  v_add_f32 v201, 1.0, v201
  v_mfma_f32_16x16x32_bf16 v[56:59], a[24:27], a[40:43], v[56:59]
  ds_read_b64_tr_b16 a[58:59], v135 offset:7168
  v_add_f32 v202, 1.0, v202
  v_mfma_f32_16x16x32_bf16 v[60:63], a[28:31], a[40:43], v[60:63]
  buffer_load_dwordx4 v142, s[36:39], s61 offen offset:0 sc1 lds
  ds_read_b128 a[4:7], v145 offset:13312
  v_mfma_f32_16x16x32_bf16 v[64:67], a[32:35], a[40:43], v[64:67]
  v_add_f32 v203, 1.0, v203
  v_add_f32 v204, 1.0, v204
  v_mfma_f32_16x16x32_bf16 v[120:123], a[36:39], a[40:43], v[120:123]
  ds_read_b64_tr_b16 a[60:61], v136 offset:1024
  ds_read_b128 a[8:11], v145 offset:14336
  v_mfma_f32_16x16x32_bf16 v[80:83], a[32:35], a[44:47], v[80:83]
  v_add_f32 v205, 1.0, v205
  v_add_f32 v206, 1.0, v206
  v_mfma_f32_16x16x32_bf16 v[76:79], a[28:31], a[44:47], v[76:79]
  buffer_load_dwordx4 v142, s[36:39], s61 offen offset:1024 sc1 lds
  s_add_u32 m0, s64, 20480
  v_mfma_f32_16x16x32_bf16 v[72:75], a[24:27], a[44:47], v[72:75]
  ds_read_b64_tr_b16 a[62:63], v136 offset:7168
  ds_read_b128 a[12:15], v145 offset:15360
  v_mfma_f32_16x16x32_bf16 v[68:71], a[20:23], a[44:47], v[68:71]
  s_waitcnt lgkmcnt(8)
  ds_read_b128 a[16:19], v148 offset:20480
  ds_read_b64_tr_b16 a[64:65], v135 offset:2048
  v_mfma_f32_16x16x32_bf16 v[84:87], a[48:51], a[20:23], v[84:87]
  v_add_f32 v207, 1.0, v207
  v_mfma_f32_16x16x32_bf16 v[88:91], a[48:51], a[24:27], v[88:91]
  buffer_load_dword v143, s[36:39], s61 offen sc1 lds
  s_cmp_eq_u32 s57, 1
  v_mfma_f32_16x16x32_bf16 v[92:95], a[48:51], a[28:31], v[92:95]
  s_cselect_b32 s66, 27, 19
  s_mul_i32 s60, s66, 196608
  s_add_u32 m0, s62, 21504
  v_mfma_f32_16x16x32_bf16 v[96:99], a[48:51], a[32:35], v[96:99]
  ds_read_b64_tr_b16 a[66:67], v135 offset:8192
  v_mfma_f32_16x16x32_bf16 v[112:115], a[52:55], a[32:35], v[112:115]
  ds_read_b64_tr_b16 a[68:69], v136 offset:2048
  v_mfma_f32_16x16x32_bf16 v[108:111], a[52:55], a[28:31], v[108:111]
  buffer_load_dwordx4 v139, s[8:11], s60 offen offset:0 lds
  v_mfma_f32_16x16x32_bf16 v[104:107], a[52:55], a[24:27], v[104:107]
  ds_read_b64_tr_b16 a[70:71], v136 offset:8192
  v_mfma_f32_16x16x32_bf16 v[100:103], a[52:55], a[20:23], v[100:103]
  s_waitcnt vmcnt(20) lgkmcnt(4)
  s_barrier
  v_mfma_f32_16x16x32_bf16 v[20:23], a[56:59], a[0:3], v[20:23]
  ds_read_b64_tr_b16 a[40:41], v135 offset:0
  v_mfma_f32_16x16x32_bf16 v[24:27], a[56:59], a[4:7], v[24:27]
  buffer_load_dwordx4 v140, s[8:11], s60 offen offset:1024 lds
  v_mfma_f32_16x16x32_bf16 v[28:31], a[56:59], a[8:11], v[28:31]
  ds_read_b64_tr_b16 a[42:43], v135 offset:6144
  v_mfma_f32_16x16x32_bf16 v[32:35], a[56:59], a[12:15], v[32:35]
  v_rcp_f32 v200, v200
  v_mfma_f32_16x16x32_bf16 v[116:119], a[56:59], a[16:19], v[116:119]
  ds_read_b64_tr_b16 a[44:45], v136 offset:0
  v_mfma_f32_16x16x32_bf16 v[48:51], a[60:63], a[12:15], v[48:51]
  buffer_load_dwordx4 v141, s[8:11], s60 offen offset:2048 lds
  s_lshl_b32 s61, s66, 11
  v_mfma_f32_16x16x32_bf16 v[44:47], a[60:63], a[8:11], v[44:47]
  s_add_u32 m0, s63, 33792
  ds_read_b64_tr_b16 a[46:47], v136 offset:6144
  v_mfma_f32_16x16x32_bf16 v[40:43], a[60:63], a[4:7], v[40:43]
  v_rcp_f32 v201, v201
  v_mfma_f32_16x16x32_bf16 v[36:39], a[60:63], a[0:3], v[36:39]
  s_waitcnt lgkmcnt(4)
  ds_read_b64_tr_b16 a[48:49], v135 offset:22528
  v_mfma_f32_16x16x32_bf16 v[52:55], a[0:3], a[64:67], v[52:55]
  buffer_load_dwordx4 v142, s[36:39], s61 offen offset:0 sc1 lds
  ds_read_b128 a[20:23], v145 offset:33792
  v_mfma_f32_16x16x32_bf16 v[56:59], a[4:7], a[64:67], v[56:59]
  ds_read_b64_tr_b16 a[50:51], v135 offset:28672
  v_mfma_f32_16x16x32_bf16 v[60:63], a[8:11], a[64:67], v[60:63]
  ds_read_b128 a[24:27], v145 offset:34816
  v_mfma_f32_16x16x32_bf16 v[64:67], a[12:15], a[64:67], v[64:67]
  v_rcp_f32 v202, v202
  v_mfma_f32_16x16x32_bf16 v[120:123], a[16:19], a[64:67], v[120:123]
  buffer_load_dwordx4 v142, s[36:39], s61 offen offset:1024 sc1 lds
  s_add_u32 m0, s64, 41984
  v_mfma_f32_16x16x32_bf16 v[80:83], a[12:15], a[68:71], v[80:83]
  ds_read_b64_tr_b16 a[52:53], v136 offset:22528
  ds_read_b128 a[28:31], v145 offset:35840
  v_mfma_f32_16x16x32_bf16 v[76:79], a[8:11], a[68:71], v[76:79]
  ds_read_b64_tr_b16 a[54:55], v136 offset:28672
  ds_read_b128 a[32:35], v145 offset:36864
  v_mfma_f32_16x16x32_bf16 v[72:75], a[4:7], a[68:71], v[72:75]
  v_rcp_f32 v203, v203
  v_mfma_f32_16x16x32_bf16 v[68:71], a[0:3], a[68:71], v[68:71]
  s_waitcnt lgkmcnt(8)
  buffer_load_dword v143, s[36:39], s61 offen sc1 lds
  s_cmp_eq_u32 s57, 2
  v_mfma_f32_16x16x32_bf16 v[84:87], a[40:43], a[0:3], v[84:87]
  s_cselect_b32 s67, 28, 20
  s_mul_i32 s60, s67, 196608
  s_add_u32 m0, s62, 43008
  v_mfma_f32_16x16x32_bf16 v[88:91], a[40:43], a[4:7], v[88:91]
  ds_read_b128 a[36:39], v148 offset:41984
  ds_read_b64_tr_b16 a[56:57], v135 offset:23552
  v_mfma_f32_16x16x32_bf16 v[92:95], a[40:43], a[8:11], v[92:95]
  ds_read_b64_tr_b16 a[58:59], v135 offset:29696
  v_mfma_f32_16x16x32_bf16 v[96:99], a[40:43], a[12:15], v[96:99]
  buffer_load_dwordx4 v139, s[8:11], s60 offen offset:0 lds
  v_mfma_f32_16x16x32_bf16 v[112:115], a[44:47], a[12:15], v[112:115]
  ds_read_b64_tr_b16 a[60:61], v136 offset:23552
  v_mfma_f32_16x16x32_bf16 v[108:111], a[44:47], a[8:11], v[108:111]
  v_rcp_f32 v204, v204
  v_mfma_f32_16x16x32_bf16 v[104:107], a[44:47], a[4:7], v[104:107]
  ds_read_b64_tr_b16 a[62:63], v136 offset:29696
  v_mfma_f32_16x16x32_bf16 v[100:103], a[44:47], a[0:3], v[100:103]
  s_waitcnt vmcnt(20) lgkmcnt(4)
  s_barrier
  buffer_load_dwordx4 v140, s[8:11], s60 offen offset:1024 lds
  v_mfma_f32_16x16x32_bf16 v[20:23], a[48:51], a[20:23], v[20:23]
  ds_read_b64_tr_b16 a[64:65], v135 offset:21504
  v_mfma_f32_16x16x32_bf16 v[24:27], a[48:51], a[24:27], v[24:27]
  v_rcp_f32 v205, v205
  v_mfma_f32_16x16x32_bf16 v[28:31], a[48:51], a[28:31], v[28:31]
  ds_read_b64_tr_b16 a[66:67], v135 offset:27648
  v_mfma_f32_16x16x32_bf16 v[32:35], a[48:51], a[32:35], v[32:35]
  buffer_load_dwordx4 v141, s[8:11], s60 offen offset:2048 lds
  s_lshl_b32 s61, s67, 11
  v_mfma_f32_16x16x32_bf16 v[116:119], a[48:51], a[36:39], v[116:119]
  s_add_u32 m0, s63, 55296
  ds_read_b64_tr_b16 a[68:69], v136 offset:21504
  v_mfma_f32_16x16x32_bf16 v[48:51], a[52:55], a[32:35], v[48:51]
  v_rcp_f32 v206, v206
  v_mfma_f32_16x16x32_bf16 v[44:47], a[52:55], a[28:31], v[44:47]
  ds_read_b64_tr_b16 a[70:71], v136 offset:27648
  v_mfma_f32_16x16x32_bf16 v[40:43], a[52:55], a[24:27], v[40:43]
  buffer_load_dwordx4 v142, s[36:39], s61 offen offset:0 sc1 lds
  v_mfma_f32_16x16x32_bf16 v[36:39], a[52:55], a[20:23], v[36:39]
  s_waitcnt lgkmcnt(4)
  ds_read_b64_tr_b16 a[40:41], v135 offset:44032
  v_mfma_f32_16x16x32_bf16 v[52:55], a[20:23], a[56:59], v[52:55]
  ds_read_b128 a[0:3], v145 offset:55296
  v_mfma_f32_16x16x32_bf16 v[56:59], a[24:27], a[56:59], v[56:59]
  ds_read_b64_tr_b16 a[42:43], v135 offset:50176
  v_mfma_f32_16x16x32_bf16 v[60:63], a[28:31], a[56:59], v[60:63]
  buffer_load_dwordx4 v142, s[36:39], s61 offen offset:1024 sc1 lds
  s_add_u32 m0, s64, 63488
  v_mfma_f32_16x16x32_bf16 v[64:67], a[32:35], a[56:59], v[64:67]
  ds_read_b128 a[4:7], v145 offset:56320
  v_mfma_f32_16x16x32_bf16 v[120:123], a[36:39], a[56:59], v[120:123]
  ds_read_b64_tr_b16 a[44:45], v136 offset:44032
  ds_read_b128 a[8:11], v145 offset:57344
  v_mfma_f32_16x16x32_bf16 v[80:83], a[32:35], a[60:63], v[80:83]
  v_rcp_f32 v207, v207
  v_mfma_f32_16x16x32_bf16 v[76:79], a[28:31], a[60:63], v[76:79]
  buffer_load_dword v143, s[36:39], s61 offen sc1 lds
  s_cmp_eq_u32 s57, 2
  v_mfma_f32_16x16x32_bf16 v[72:75], a[24:27], a[60:63], v[72:75]
  s_cselect_b32 s68, 29, 21
  s_mul_i32 s60, s68, 196608
  s_add_u32 m0, s62, 64512
  v_mfma_f32_16x16x32_bf16 v[68:71], a[20:23], a[60:63], v[68:71]
  s_waitcnt lgkmcnt(6)
  ds_read_b64_tr_b16 a[46:47], v136 offset:50176
  ds_read_b128 a[12:15], v145 offset:58368
  v_mfma_f32_16x16x32_bf16 v[84:87], a[64:67], a[20:23], v[84:87]
  ds_read_b128 a[16:19], v148 offset:63488
  ds_read_b64_tr_b16 a[48:49], v135 offset:45056
  v_mfma_f32_16x16x32_bf16 v[88:91], a[64:67], a[24:27], v[88:91]
  buffer_load_dwordx4 v139, s[8:11], s60 offen offset:0 lds
  ds_read_b64_tr_b16 a[50:51], v135 offset:51200
  v_mfma_f32_16x16x32_bf16 v[92:95], a[64:67], a[28:31], v[92:95]
  v_mul_f32 v188, v188, v200
  v_mul_f32 v189, v189, v201
  v_mfma_f32_16x16x32_bf16 v[96:99], a[64:67], a[32:35], v[96:99]
  v_mul_f32 v190, v190, v202
  v_mul_f32 v191, v191, v203
  v_mfma_f32_16x16x32_bf16 v[112:115], a[68:71], a[32:35], v[112:115]
  ds_read_b64_tr_b16 a[52:53], v136 offset:45056
  v_mul_f32 v192, v192, v204
  v_mfma_f32_16x16x32_bf16 v[108:111], a[68:71], a[28:31], v[108:111]
  buffer_load_dwordx4 v140, s[8:11], s60 offen offset:1024 lds
  v_mul_f32 v193, v193, v205
  v_mfma_f32_16x16x32_bf16 v[104:107], a[68:71], a[24:27], v[104:107]
  ds_read_b64_tr_b16 a[54:55], v136 offset:51200
  v_mul_f32 v194, v194, v206
  v_mfma_f32_16x16x32_bf16 v[100:103], a[68:71], a[20:23], v[100:103]
  s_waitcnt vmcnt(21) lgkmcnt(4)
  s_barrier
  v_mul_f32 v195, v195, v207
  v_mfma_f32_16x16x32_bf16 v[20:23], a[40:43], a[0:3], v[20:23]
  ds_read_b64_tr_b16 a[56:57], v135 offset:43008
  v_cvt_pk_bf16_f32 v212, v188, v189
  v_mfma_f32_16x16x32_bf16 v[24:27], a[40:43], a[4:7], v[24:27]
  buffer_load_dwordx4 v141, s[8:11], s60 offen offset:2048 lds
  s_lshl_b32 s61, s68, 11
  v_mfma_f32_16x16x32_bf16 v[28:31], a[40:43], a[8:11], v[28:31]
  s_add_u32 m0, s63, 76800
  ds_read_b64_tr_b16 a[58:59], v135 offset:49152
  v_lshlrev_b32 v188, 16, v212
  v_mfma_f32_16x16x32_bf16 v[32:35], a[40:43], a[12:15], v[32:35]
  v_and_b32 v189, 0xffff0000, v212
  v_cvt_pk_bf16_f32 v212, v190, v191
  v_mfma_f32_16x16x32_bf16 v[116:119], a[40:43], a[16:19], v[116:119]
  ds_read_b64_tr_b16 a[60:61], v136 offset:43008
  v_lshlrev_b32 v190, 16, v212
  v_mfma_f32_16x16x32_bf16 v[48:51], a[44:47], a[12:15], v[48:51]
  buffer_load_dwordx4 v142, s[36:39], s61 offen offset:0 sc1 lds
  v_and_b32 v191, 0xffff0000, v212
  v_mfma_f32_16x16x32_bf16 v[44:47], a[44:47], a[8:11], v[44:47]
  ds_read_b64_tr_b16 a[62:63], v136 offset:49152
  v_cvt_pk_bf16_f32 v212, v192, v193
  v_mfma_f32_16x16x32_bf16 v[40:43], a[44:47], a[4:7], v[40:43]
  v_lshlrev_b32 v192, 16, v212
  v_and_b32 v193, 0xffff0000, v212
  v_mfma_f32_16x16x32_bf16 v[36:39], a[44:47], a[0:3], v[36:39]
  s_waitcnt lgkmcnt(4)
  ds_read_b64_tr_b16 a[64:65], v137 offset:1024
  v_cvt_pk_bf16_f32 v212, v194, v195
  v_mfma_f32_16x16x32_bf16 v[52:55], a[0:3], a[48:51], v[52:55]
  buffer_load_dwordx4 v142, s[36:39], s61 offen offset:1024 sc1 lds
  s_add_u32 m0, s64, 84992
  v_mfma_f32_16x16x32_bf16 v[56:59], a[4:7], a[48:51], v[56:59]
  ds_read_b128 a[20:23], v146 offset:12288
  ds_read_b64_tr_b16 a[66:67], v137 offset:7168
  v_mfma_f32_16x16x32_bf16 v[60:63], a[8:11], a[48:51], v[60:63]
  ds_read_b128 a[24:27], v146 offset:13312
  v_lshlrev_b32 v194, 16, v212
  v_mfma_f32_16x16x32_bf16 v[64:67], a[12:15], a[48:51], v[64:67]
  v_and_b32 v195, 0xffff0000, v212
  s_lshl_b32 s48, s58, 3
  v_mfma_f32_16x16x32_bf16 v[120:123], a[16:19], a[48:51], v[120:123]
  s_add_u32 s48, s48, 150528
  buffer_load_dword v143, s[36:39], s61 offen sc1 lds
  s_cmp_eq_u32 s57, 3
  v_mfma_f32_16x16x32_bf16 v[80:83], a[12:15], a[52:55], v[80:83]
  s_cselect_b32 s69, 30, 22
  s_mul_i32 s60, s69, 196608
  s_add_u32 m0, s62, 86016
  v_mfma_f32_16x16x32_bf16 v[76:79], a[8:11], a[52:55], v[76:79]
  ds_read_b64_tr_b16 a[68:69], v138 offset:1024
  ds_read_b128 a[28:31], v146 offset:14336
  v_mfma_f32_16x16x32_bf16 v[72:75], a[4:7], a[52:55], v[72:75]
  ds_read_b64_tr_b16 a[70:71], v138 offset:7168
  ds_read_b128 a[32:35], v146 offset:15360
  v_mfma_f32_16x16x32_bf16 v[68:71], a[0:3], a[52:55], v[68:71]
  s_waitcnt lgkmcnt(8)
  buffer_load_dwordx4 v139, s[8:11], s60 offen offset:0 lds
  ds_read_b128 a[36:39], v149 offset:20480
  v_mfma_f32_16x16x32_bf16 v[84:87], a[56:59], a[0:3], v[84:87]
  ds_read_b64_tr_b16 a[40:41], v137 offset:2048
  v_add_u32 v12, s48, v0
  v_mfma_f32_16x16x32_bf16 v[88:91], a[56:59], a[4:7], v[88:91]
  ds_read_b64_tr_b16 a[42:43], v137 offset:8192
  v_add_u32 v222, s63, v12
  v_mfma_f32_16x16x32_bf16 v[92:95], a[56:59], a[8:11], v[92:95]
  v_xor_b32 v223, 8, v222
  s_lshl_b32 s48, s59, 11
  v_mfma_f32_16x16x32_bf16 v[96:99], a[56:59], a[12:15], v[96:99]
  s_add_u32 s48, s48, 8192
  buffer_load_dwordx4 v140, s[8:11], s60 offen offset:1024 lds
  v_add_u32 v224, s48, v12
  v_mfma_f32_16x16x32_bf16 v[112:115], a[60:63], a[12:15], v[112:115]
  s_lshl_b32 s48, s58, 13
  ds_read_b64_tr_b16 a[44:45], v138 offset:2048
  v_subrev_u32 v225, s48, v224
  v_mfma_f32_16x16x32_bf16 v[108:111], a[60:63], a[8:11], v[108:111]
  v_xor_b32 v226, 8, v225
  s_mov_b32 s40, 0xaaaaaaaa
  v_mfma_f32_16x16x32_bf16 v[104:107], a[60:63], a[4:7], v[104:107]
  s_mov_b32 s41, 0xaaaaaaaa
  ds_read_b64_tr_b16 a[46:47], v138 offset:8192
  s_mov_b32 s42, 0x000f0000
  v_mfma_f32_16x16x32_bf16 v[100:103], a[60:63], a[0:3], v[100:103]
  s_waitcnt vmcnt(20) lgkmcnt(4)
  s_barrier
  buffer_load_dwordx4 v141, s[8:11], s60 offen offset:2048 lds
  v_mfma_f32_16x16x32_bf16 v[20:23], a[64:67], a[20:23], v[20:23]
  s_lshl_b32 s61, s69, 11
  s_add_u32 m0, s63, 98304
  ds_read_b64_tr_b16 a[48:49], v137 offset:0
  v_mfma_f32_16x16x32_bf16 v[24:27], a[64:67], a[24:27], v[24:27]
  s_mov_b32 s43, 0x0fff00ff
  s_mov_b32 s80, 0x003f0003
  s_mov_b32 s81, 0x3fff03ff
  v_mfma_f32_16x16x32_bf16 v[28:31], a[64:67], a[28:31], v[28:31]
  ds_read_b64_tr_b16 a[50:51], v137 offset:6144
  v_mov_b32 v12, 0xffff
  v_mfma_f32_16x16x32_bf16 v[32:35], a[64:67], a[32:35], v[32:35]
  buffer_load_dwordx4 v142, s[36:39], s61 offen offset:0 sc1 lds
  v_mov_b32 v13, 0xffff0000
  v_mfma_f32_16x16x32_bf16 v[116:119], a[64:67], a[36:39], v[116:119]
  ds_read_b64_tr_b16 a[52:53], v138 offset:0
  v_cndmask_b32 v12, v12, v13, s[40:41]
  v_mfma_f32_16x16x32_bf16 v[48:51], a[68:71], a[32:35], v[48:51]
  v_cndmask_b32 v227, 0, v12, s[42:43]
  v_cndmask_b32 v228, 0, v12, s[80:81]
  v_mfma_f32_16x16x32_bf16 v[44:47], a[68:71], a[28:31], v[44:47]
  ds_read_b64_tr_b16 a[54:55], v138 offset:6144
  v_xor_b32 v229, v227, v12
  v_mfma_f32_16x16x32_bf16 v[40:43], a[68:71], a[24:27], v[40:43]
  buffer_load_dwordx4 v142, s[36:39], s61 offen offset:1024 sc1 lds
  s_add_u32 m0, s64, 106496
  v_mfma_f32_16x16x32_bf16 v[36:39], a[68:71], a[20:23], v[36:39]
  s_waitcnt lgkmcnt(4)
  ds_read_b64_tr_b16 a[56:57], v133 offset:1024
  v_xor_b32 v230, v228, v12
  v_mfma_f32_16x16x32_bf16 v[52:55], a[20:23], a[40:43], v[52:55]
  s_lshl1_add_u32 s48, s51, s58
  ds_read_b128 a[0:3], v144 offset:12288
  s_lshl_b32 s74, s48, 17
  v_mfma_f32_16x16x32_bf16 v[56:59], a[24:27], a[40:43], v[56:59]
  s_lshl1_add_u32 s48, s56, s59
  ds_read_b64_tr_b16 a[58:59], v133 offset:7168
  s_lshl_b32 s48, s48, 11
  v_mfma_f32_16x16x32_bf16 v[60:63], a[28:31], a[40:43], v[60:63]
  s_add_u32 s74, s74, s48
  buffer_load_dword v143, s[36:39], s61 offen sc1 lds
  s_cmp_eq_u32 s57, 3
  v_mfma_f32_16x16x32_bf16 v[64:67], a[32:35], a[40:43], v[64:67]
  s_cselect_b32 s70, 31, 23
  s_mul_i32 s60, s70, 196608
  s_add_u32 m0, s62, 107520
  v_mfma_f32_16x16x32_bf16 v[120:123], a[36:39], a[40:43], v[120:123]
  s_add_u32 s74, s74, 7340032
  ds_read_b128 a[4:7], v144 offset:13312
  ds_read_b64_tr_b16 a[60:61], v134 offset:1024
  v_mfma_f32_16x16x32_bf16 v[80:83], a[32:35], a[44:47], v[80:83]
  s_add_u32 s75, s74, 65536
  ds_read_b128 a[8:11], v144 offset:14336
  s_or_b32 s51, s51, s58
  v_mfma_f32_16x16x32_bf16 v[76:79], a[28:31], a[44:47], v[76:79]
  s_lshl_b32 s45, s2, 7
  buffer_load_dwordx4 v139, s[8:11], s60 offen offset:0 lds
  ds_read_b64_tr_b16 a[62:63], v134 offset:7168
  v_mfma_f32_16x16x32_bf16 v[72:75], a[24:27], a[44:47], v[72:75]
  s_add_u32 s45, s45, 5275648
  ds_read_b128 a[12:15], v144 offset:15360
  s_cmp_eq_u32 s44, 0
  v_mfma_f32_16x16x32_bf16 v[68:71], a[20:23], a[44:47], v[68:71]
  s_waitcnt lgkmcnt(8)
  ds_read_b128 a[16:19], v147 offset:20480
  ds_read_b64_tr_b16 a[64:65], v133 offset:2048
  v_mfma_f32_16x16x32_bf16 v[84:87], a[48:51], a[20:23], v[84:87]
  s_cselect_b32 s45, s45, 1073741824
  s_lshr_b32 s49, s2, 3
  s_and_b32 s59, s49, 3
  v_mfma_f32_16x16x32_bf16 v[88:91], a[48:51], a[24:27], v[88:91]
  s_lshr_b32 s56, s49, 2
  buffer_load_dwordx4 v140, s[8:11], s60 offen offset:1024 lds
  ds_read_b64_tr_b16 a[66:67], v133 offset:8192
  v_mfma_f32_16x16x32_bf16 v[92:95], a[48:51], a[28:31], v[92:95]
  s_lshl1_add_u32 s49, s59, s56
  s_and_b32 s49, s49, 7
  s_and_b32 s48, s2, 7
  v_mfma_f32_16x16x32_bf16 v[96:99], a[48:51], a[32:35], v[96:99]
  s_lshl2_add_u32 s59, s48, s59
  s_mov_b32 s82, 0xc0653421
  s_mov_b32 s83, 0xfedba987
  v_mfma_f32_16x16x32_bf16 v[112:115], a[52:55], a[32:35], v[112:115]
  s_cmp_eq_u32 s49, 1
  ds_read_b64_tr_b16 a[68:69], v134 offset:2048
  s_cselect_b32 s82, 0xd1643520, s82
  v_mfma_f32_16x16x32_bf16 v[108:111], a[52:55], a[28:31], v[108:111]
  s_cselect_b32 s83, 0xfecba897, s83
  buffer_load_dwordx4 v141, s[8:11], s60 offen offset:2048 lds
  s_lshl_b32 s61, s70, 11
  v_mfma_f32_16x16x32_bf16 v[104:107], a[52:55], a[24:27], v[104:107]
  s_add_u32 m0, s63, 119808
  ds_read_b64_tr_b16 a[70:71], v134 offset:8192
  s_cmp_eq_u32 s49, 2
  v_mfma_f32_16x16x32_bf16 v[100:103], a[52:55], a[20:23], v[100:103]
  s_waitcnt vmcnt(21) lgkmcnt(4)
  s_barrier
  s_cselect_b32 s82, 0x72546310, s82
  v_mfma_f32_16x16x32_bf16 v[20:23], a[56:59], a[0:3], v[20:23]
  s_cselect_b32 s83, 0xfdcb98ae, s83
  ds_read_b64_tr_b16 a[40:41], v133 offset:0
  s_cmp_eq_u32 s49, 3
  v_mfma_f32_16x16x32_bf16 v[24:27], a[56:59], a[4:7], v[24:27]
  s_cselect_b32 s82, 0x63547210, s82
  buffer_load_dwordx4 v142, s[36:39], s61 offen offset:0 sc1 lds
  s_cselect_b32 s83, 0xfedca9b8, s83
  v_mfma_f32_16x16x32_bf16 v[28:31], a[56:59], a[8:11], v[28:31]
  s_cmp_eq_u32 s49, 4
  ds_read_b64_tr_b16 a[42:43], v133 offset:6144
  s_cselect_b32 s82, 0x64583210, s82
  v_mfma_f32_16x16x32_bf16 v[32:35], a[56:59], a[12:15], v[32:35]
  s_cselect_b32 s83, 0xfedba9c7, s83
  s_cmp_eq_u32 s49, 5
  s_cselect_b32 s82, 0x65493210, s82
  v_mfma_f32_16x16x32_bf16 v[116:119], a[56:59], a[16:19], v[116:119]
  s_cselect_b32 s83, 0xfecba8d7, s83
  ds_read_b64_tr_b16 a[44:45], v134 offset:0
  s_cmp_eq_u32 s49, 6
  v_mfma_f32_16x16x32_bf16 v[48:51], a[60:63], a[12:15], v[48:51]
  s_cselect_b32 s82, 0x56a43210, s82
  buffer_load_dwordx4 v142, s[36:39], s61 offen offset:1024 sc1 lds
  s_cselect_b32 s83, 0xfdcb98e7, s83
  v_mfma_f32_16x16x32_bf16 v[44:47], a[60:63], a[8:11], v[44:47]
  s_add_u32 m0, s64, 128000
  ds_read_b64_tr_b16 a[46:47], v134 offset:6144
  s_cmp_eq_u32 s49, 7
  v_mfma_f32_16x16x32_bf16 v[40:43], a[60:63], a[4:7], v[40:43]
  s_cselect_b32 s82, 0x57b43210, s82
  s_cselect_b32 s83, 0xedca98f6, s83
  v_mfma_f32_16x16x32_bf16 v[36:39], a[60:63], a[0:3], v[36:39]
  s_waitcnt lgkmcnt(4)
  ds_read_b64_tr_b16 a[48:49], v133 offset:22528
  v_mfma_f32_16x16x32_bf16 v[52:55], a[0:3], a[64:67], v[52:55]
  s_mul_i32 s79, s44, 7168
  buffer_load_dword v143, s[36:39], s61 offen sc1 lds
  s_cmp_eq_u32 s57, 0
  v_mfma_f32_16x16x32_bf16 v[56:59], a[4:7], a[64:67], v[56:59]
  s_cselect_b32 s65, 8, 24
  s_mul_i32 s60, s65, 196608
  s_add_u32 m0, s62, 129024
  v_mfma_f32_16x16x32_bf16 v[60:63], a[8:11], a[64:67], v[60:63]
  s_lshl2_add_u32 s84, s56, s44
  ds_read_b128 a[20:23], v144 offset:33792
  ds_read_b64_tr_b16 a[50:51], v133 offset:28672
  v_mfma_f32_16x16x32_bf16 v[64:67], a[12:15], a[64:67], v[64:67]
  s_lshl_b32 s84, s84, 17
  ds_read_b128 a[24:27], v144 offset:34816
  s_add_u32 s84, s84, 36700160
  v_mfma_f32_16x16x32_bf16 v[120:123], a[16:19], a[64:67], v[120:123]
  buffer_load_dwordx4 v139, s[8:11], s60 offen offset:0 lds
  ds_read_b64_tr_b16 a[52:53], v134 offset:22528
  v_mfma_f32_16x16x32_bf16 v[80:83], a[12:15], a[68:71], v[80:83]
  ds_read_b128 a[28:31], v144 offset:35840
  v_mfma_f32_16x16x32_bf16 v[76:79], a[8:11], a[68:71], v[76:79]
  ds_read_b64_tr_b16 a[54:55], v134 offset:28672
  ds_read_b128 a[32:35], v144 offset:36864
  v_mfma_f32_16x16x32_bf16 v[72:75], a[4:7], a[68:71], v[72:75]
  s_cmp_ge_u32 s44, 2
  s_cselect_b64 s[16:17], s[20:21], s[16:17]
  v_mfma_f32_16x16x32_bf16 v[68:71], a[0:3], a[68:71], v[68:71]
  s_waitcnt lgkmcnt(8)
  buffer_load_dwordx4 v140, s[8:11], s60 offen offset:1024 lds
  ds_read_b128 a[36:39], v147 offset:41984
  v_mfma_f32_16x16x32_bf16 v[84:87], a[40:43], a[0:3], v[84:87]
  ds_read_b64_tr_b16 a[56:57], v133 offset:23552
  v_mfma_f32_16x16x32_bf16 v[88:91], a[40:43], a[4:7], v[88:91]
  ds_read_b64_tr_b16 a[58:59], v133 offset:29696
  v_lshrrev_b32 v12, 2, v10
  v_mfma_f32_16x16x32_bf16 v[92:95], a[40:43], a[8:11], v[92:95]
  v_mul_u32_u24 v12, 224, v12
  v_and_b32 v13, 3, v10
  v_mfma_f32_16x16x32_bf16 v[96:99], a[40:43], a[12:15], v[96:99]
  buffer_load_dwordx4 v141, s[8:11], s60 offen offset:2048 lds
  s_lshl_b32 s61, s65, 11
  v_mfma_f32_16x16x32_bf16 v[112:115], a[44:47], a[12:15], v[112:115]
  s_add_u32 m0, s63, 141312
  ds_read_b64_tr_b16 a[60:61], v134 offset:23552
  v_lshl_add_u32 v1, v13, 3, v12
  v_mfma_f32_16x16x32_bf16 v[108:111], a[44:47], a[8:11], v[108:111]
  v_add_u32 v2, 57344, v1
  v_mfma_f32_16x16x32_bf16 v[104:107], a[44:47], a[4:7], v[104:107]
  ds_read_b64_tr_b16 a[62:63], v134 offset:29696
  v_mfma_f32_16x16x32_bf16 v[100:103], a[44:47], a[0:3], v[100:103]
  s_waitcnt vmcnt(21) lgkmcnt(4)
  s_barrier
  buffer_load_dwordx4 v142, s[36:39], s61 offen offset:0 sc1 lds
  v_mfma_f32_16x16x32_bf16 v[20:23], a[48:51], a[20:23], v[20:23]
  ds_read_b64_tr_b16 a[64:65], v133 offset:21504
  v_mfma_f32_16x16x32_bf16 v[24:27], a[48:51], a[24:27], v[24:27]
  s_mul_i32 s48, s59, 224
  s_and_b32 s49, s44, 1
  s_mul_i32 s49, s49, 229376
  v_mfma_f32_16x16x32_bf16 v[28:31], a[48:51], a[28:31], v[28:31]
  s_add_u32 s48, s48, s49
  ds_read_b64_tr_b16 a[66:67], v133 offset:27648
  s_and_b32 s49, s59, 1
  v_mfma_f32_16x16x32_bf16 v[32:35], a[48:51], a[32:35], v[32:35]
  s_lshl_b32 s49, s49, 1
  buffer_load_dwordx4 v142, s[36:39], s61 offen offset:1024 sc1 lds
  s_add_u32 m0, s64, 149504
  v_mfma_f32_16x16x32_bf16 v[116:119], a[48:51], a[36:39], v[116:119]
  ds_read_b64_tr_b16 a[68:69], v134 offset:21504
  v_mfma_f32_16x16x32_bf16 v[48:51], a[52:55], a[32:35], v[48:51]
  v_mfma_f32_16x16x32_bf16 v[44:47], a[52:55], a[28:31], v[44:47]
  ds_read_b64_tr_b16 a[70:71], v134 offset:27648
  v_mfma_f32_16x16x32_bf16 v[40:43], a[52:55], a[24:27], v[40:43]
  buffer_load_dword v143, s[36:39], s61 offen sc1 lds
  s_cmp_eq_u32 s57, 0
  v_mfma_f32_16x16x32_bf16 v[36:39], a[52:55], a[20:23], v[36:39]
  s_waitcnt lgkmcnt(4)
  s_cselect_b32 s66, 9, 25
  s_mul_i32 s60, s66, 196608
  v_mfma_f32_16x16x32_bf16 v[52:55], a[20:23], a[56:59], v[52:55]
  s_add_u32 m0, s62, 0
  ds_read_b64_tr_b16 a[40:41], v133 offset:44032
  ds_read_b128 a[0:3], v144 offset:55296
  v_mfma_f32_16x16x32_bf16 v[56:59], a[24:27], a[56:59], v[56:59]
  ds_read_b64_tr_b16 a[42:43], v133 offset:50176
  v_add_u32 v12, 0, v10
  v_mfma_f32_16x16x32_bf16 v[60:63], a[28:31], a[56:59], v[60:63]
  buffer_load_dwordx4 v139, s[8:11], s60 offen offset:0 lds
  ds_read_b128 a[4:7], v144 offset:56320
  v_mfma_f32_16x16x32_bf16 v[64:67], a[32:35], a[56:59], v[64:67]
  v_mul_u32_u24 v13, 4682, v12
  v_lshrrev_b32 v13, 16, v13
  v_mfma_f32_16x16x32_bf16 v[120:123], a[36:39], a[56:59], v[120:123]
  ds_read_b64_tr_b16 a[44:45], v134 offset:44032
  ds_read_b128 a[8:11], v144 offset:57344
  v_mfma_f32_16x16x32_bf16 v[80:83], a[32:35], a[60:63], v[80:83]
  v_mul_i32_i24 v14, -14, v13
  v_add3_u32 v12, v12, v14, s49
  v_mfma_f32_16x16x32_bf16 v[76:79], a[28:31], a[60:63], v[76:79]
  buffer_load_dwordx4 v140, s[8:11], s60 offen offset:1024 lds
  ds_read_b64_tr_b16 a[46:47], v134 offset:50176
  v_mfma_f32_16x16x32_bf16 v[72:75], a[24:27], a[60:63], v[72:75]
  ds_read_b128 a[12:15], v144 offset:58368
  v_mfma_f32_16x16x32_bf16 v[68:71], a[20:23], a[60:63], v[68:71]
  s_waitcnt lgkmcnt(8)
  ds_read_b128 a[16:19], v147 offset:63488
  ds_read_b64_tr_b16 a[48:49], v133 offset:45056
  v_mfma_f32_16x16x32_bf16 v[84:87], a[64:67], a[20:23], v[84:87]
  v_add_u32 v14, -14, v12
  v_min_u32 v12, v12, v14
  v_mfma_f32_16x16x32_bf16 v[88:91], a[64:67], a[24:27], v[88:91]
  buffer_load_dwordx4 v141, s[8:11], s60 offen offset:2048 lds
  s_lshl_b32 s61, s66, 11
  v_mfma_f32_16x16x32_bf16 v[92:95], a[64:67], a[28:31], v[92:95]
  s_add_u32 m0, s63, 12288
  ds_read_b64_tr_b16 a[50:51], v133 offset:51200
  v_mul_u32_u24 v13, 7168, v13
  v_mfma_f32_16x16x32_bf16 v[96:99], a[64:67], a[32:35], v[96:99]
  v_lshl_add_u32 v12, v12, 4, v13
  v_add_u32 v3, s48, v12
  v_mfma_f32_16x16x32_bf16 v[112:115], a[68:71], a[32:35], v[112:115]
  ds_read_b64_tr_b16 a[52:53], v134 offset:45056
  v_mfma_f32_16x16x32_bf16 v[108:111], a[68:71], a[28:31], v[108:111]
  buffer_load_dwordx4 v142, s[36:39], s61 offen offset:0 sc1 lds
  v_mfma_f32_16x16x32_bf16 v[104:107], a[68:71], a[24:27], v[104:107]
  ds_read_b64_tr_b16 a[54:55], v134 offset:51200
  v_mfma_f32_16x16x32_bf16 v[100:103], a[68:71], a[20:23], v[100:103]
  s_waitcnt vmcnt(22) lgkmcnt(4)
  s_barrier
  v_mfma_f32_16x16x32_bf16 v[20:23], a[40:43], a[0:3], v[20:23]
  s_sub_u32 s48, s48, 1024
  ds_read_b64_tr_b16 a[56:57], v133 offset:43008
  v_mfma_f32_16x16x32_bf16 v[24:27], a[40:43], a[4:7], v[24:27]
  buffer_load_dwordx4 v142, s[36:39], s61 offen offset:1024 sc1 lds
  s_add_u32 m0, s64, 20480
  v_mfma_f32_16x16x32_bf16 v[28:31], a[40:43], a[8:11], v[28:31]
  ds_read_b64_tr_b16 a[58:59], v133 offset:49152
  v_add_u32 v12, 64, v10
  v_mfma_f32_16x16x32_bf16 v[32:35], a[40:43], a[12:15], v[32:35]
  v_mul_u32_u24 v13, 4682, v12
  v_lshrrev_b32 v13, 16, v13
  v_mfma_f32_16x16x32_bf16 v[116:119], a[40:43], a[16:19], v[116:119]
  ds_read_b64_tr_b16 a[60:61], v134 offset:43008
  v_mul_i32_i24 v14, -14, v13
  v_mfma_f32_16x16x32_bf16 v[48:51], a[44:47], a[12:15], v[48:51]
  buffer_load_dword v143, s[36:39], s61 offen sc1 lds
  s_cmp_eq_u32 s57, 1
  v_mfma_f32_16x16x32_bf16 v[44:47], a[44:47], a[8:11], v[44:47]
  s_cselect_b32 s67, 2, 26
  s_mul_i32 s60, s67, 196608
  s_add_u32 m0, s62, 21504
  v_mfma_f32_16x16x32_bf16 v[40:43], a[44:47], a[4:7], v[40:43]
  ds_read_b64_tr_b16 a[62:63], v134 offset:49152
  v_add3_u32 v12, v12, v14, s49
  v_mfma_f32_16x16x32_bf16 v[36:39], a[44:47], a[0:3], v[36:39]
  s_waitcnt lgkmcnt(4)
  ds_read_b64_tr_b16 a[64:65], v135 offset:1024
  v_mfma_f32_16x16x32_bf16 v[52:55], a[0:3], a[48:51], v[52:55]
  buffer_load_dwordx4 v139, s[8:11], s60 offen offset:0 lds
  ds_read_b128 a[20:23], v145 offset:12288
  v_mfma_f32_16x16x32_bf16 v[56:59], a[4:7], a[48:51], v[56:59]
  ds_read_b64_tr_b16 a[66:67], v135 offset:7168
  v_add_u32 v14, -14, v12
  v_mfma_f32_16x16x32_bf16 v[60:63], a[8:11], a[48:51], v[60:63]
  ds_read_b128 a[24:27], v145 offset:13312
  v_min_u32 v12, v12, v14
  v_mfma_f32_16x16x32_bf16 v[64:67], a[12:15], a[48:51], v[64:67]
  v_mul_u32_u24 v13, 7168, v13
  v_lshl_add_u32 v12, v12, 4, v13
  v_mfma_f32_16x16x32_bf16 v[120:123], a[16:19], a[48:51], v[120:123]
  buffer_load_dwordx4 v140, s[8:11], s60 offen offset:1024 lds
  ds_read_b64_tr_b16 a[68:69], v136 offset:1024
  v_mfma_f32_16x16x32_bf16 v[80:83], a[12:15], a[52:55], v[80:83]
  ds_read_b128 a[28:31], v145 offset:14336
  v_add_u32 v4, s48, v12
  v_mfma_f32_16x16x32_bf16 v[76:79], a[8:11], a[52:55], v[76:79]
  ds_read_b64_tr_b16 a[70:71], v136 offset:7168
  ds_read_b128 a[32:35], v145 offset:15360
  v_mfma_f32_16x16x32_bf16 v[72:75], a[4:7], a[52:55], v[72:75]
  v_mfma_f32_16x16x32_bf16 v[68:71], a[0:3], a[52:55], v[68:71]
  s_waitcnt lgkmcnt(8)
  buffer_load_dwordx4 v141, s[8:11], s60 offen offset:2048 lds
  s_lshl_b32 s61, s67, 11
  v_mfma_f32_16x16x32_bf16 v[84:87], a[56:59], a[0:3], v[84:87]
  s_add_u32 m0, s63, 33792
  ds_read_b128 a[36:39], v148 offset:20480
  ds_read_b64_tr_b16 a[40:41], v135 offset:2048
  v_mfma_f32_16x16x32_bf16 v[88:91], a[56:59], a[4:7], v[88:91]
  s_sub_u32 s48, s48, 1024
  ds_read_b64_tr_b16 a[42:43], v135 offset:8192
  v_mfma_f32_16x16x32_bf16 v[92:95], a[56:59], a[8:11], v[92:95]
  v_add_u32 v12, 128, v10
  v_mul_u32_u24 v13, 4682, v12
  v_mfma_f32_16x16x32_bf16 v[96:99], a[56:59], a[12:15], v[96:99]
  buffer_load_dwordx4 v142, s[36:39], s61 offen offset:0 sc1 lds
  v_lshrrev_b32 v13, 16, v13
  v_mfma_f32_16x16x32_bf16 v[112:115], a[60:63], a[12:15], v[112:115]
  ds_read_b64_tr_b16 a[44:45], v136 offset:2048
  v_mul_i32_i24 v14, -14, v13
  v_mfma_f32_16x16x32_bf16 v[108:111], a[60:63], a[8:11], v[108:111]
  v_add3_u32 v12, v12, v14, s49
  v_mfma_f32_16x16x32_bf16 v[104:107], a[60:63], a[4:7], v[104:107]
  ds_read_b64_tr_b16 a[46:47], v136 offset:8192
  v_mfma_f32_16x16x32_bf16 v[100:103], a[60:63], a[0:3], v[100:103]
  s_waitcnt vmcnt(22) lgkmcnt(4)
  s_barrier
  buffer_load_dwordx4 v142, s[36:39], s61 offen offset:1024 sc1 lds
  v_mfma_f32_16x16x32_bf16 v[20:23], a[64:67], a[20:23], v[20:23]
  s_add_u32 m0, s64, 41984
  ds_read_b64_tr_b16 a[48:49], v135 offset:0
  v_mfma_f32_16x16x32_bf16 v[24:27], a[64:67], a[24:27], v[24:27]
  v_mfma_f32_16x16x32_bf16 v[28:31], a[64:67], a[28:31], v[28:31]
  ds_read_b64_tr_b16 a[50:51], v135 offset:6144
  v_add_u32 v14, -14, v12
  v_mfma_f32_16x16x32_bf16 v[32:35], a[64:67], a[32:35], v[32:35]
  buffer_load_dword v143, s[36:39], s61 offen sc1 lds
  s_cmp_eq_u32 s57, 1
  v_mfma_f32_16x16x32_bf16 v[116:119], a[64:67], a[36:39], v[116:119]
  s_cselect_b32 s68, 3, 27
  s_mul_i32 s60, s68, 196608
  s_add_u32 m0, s62, 43008
  v_mfma_f32_16x16x32_bf16 v[48:51], a[68:71], a[32:35], v[48:51]
  ds_read_b64_tr_b16 a[52:53], v136 offset:0
  v_min_u32 v12, v12, v14
  v_mfma_f32_16x16x32_bf16 v[44:47], a[68:71], a[28:31], v[44:47]
  ds_read_b64_tr_b16 a[54:55], v136 offset:6144
  v_mul_u32_u24 v13, 7168, v13
  v_mfma_f32_16x16x32_bf16 v[40:43], a[68:71], a[24:27], v[40:43]
  buffer_load_dwordx4 v139, s[8:11], s60 offen offset:0 lds
  v_lshl_add_u32 v12, v12, 4, v13
  v_mfma_f32_16x16x32_bf16 v[36:39], a[68:71], a[20:23], v[36:39]
  s_waitcnt lgkmcnt(4)
  ds_read_b64_tr_b16 a[56:57], v135 offset:22528
  v_add_u32 v5, s48, v12
  v_mfma_f32_16x16x32_bf16 v[52:55], a[20:23], a[40:43], v[52:55]
  ds_read_b128 a[0:3], v145 offset:33792
  v_mfma_f32_16x16x32_bf16 v[56:59], a[24:27], a[40:43], v[56:59]
  s_sub_u32 s48, s48, 1024
  ds_read_b64_tr_b16 a[58:59], v135 offset:28672
  v_mfma_f32_16x16x32_bf16 v[60:63], a[28:31], a[40:43], v[60:63]
  buffer_load_dwordx4 v140, s[8:11], s60 offen offset:1024 lds
  ds_read_b128 a[4:7], v145 offset:34816
  v_mfma_f32_16x16x32_bf16 v[64:67], a[32:35], a[40:43], v[64:67]
  v_add_u32 v12, 192, v10
  v_mul_u32_u24 v13, 4682, v12
  v_mfma_f32_16x16x32_bf16 v[120:123], a[36:39], a[40:43], v[120:123]
  ds_read_b64_tr_b16 a[60:61], v136 offset:22528
  ds_read_b128 a[8:11], v145 offset:35840
  v_mfma_f32_16x16x32_bf16 v[80:83], a[32:35], a[44:47], v[80:83]
  v_lshrrev_b32 v13, 16, v13
  v_mul_i32_i24 v14, -14, v13
  v_mfma_f32_16x16x32_bf16 v[76:79], a[28:31], a[44:47], v[76:79]
  buffer_load_dwordx4 v141, s[8:11], s60 offen offset:2048 lds
  s_lshl_b32 s61, s68, 11
  v_mfma_f32_16x16x32_bf16 v[72:75], a[24:27], a[44:47], v[72:75]
  s_add_u32 m0, s63, 55296
  ds_read_b64_tr_b16 a[62:63], v136 offset:28672
  ds_read_b128 a[12:15], v145 offset:36864
  v_mfma_f32_16x16x32_bf16 v[68:71], a[20:23], a[44:47], v[68:71]
  s_waitcnt lgkmcnt(8)
  ds_read_b128 a[16:19], v148 offset:41984
  ds_read_b64_tr_b16 a[64:65], v135 offset:23552
  v_mfma_f32_16x16x32_bf16 v[84:87], a[48:51], a[20:23], v[84:87]
  v_add3_u32 v12, v12, v14, s49
  v_mfma_f32_16x16x32_bf16 v[88:91], a[48:51], a[24:27], v[88:91]
  buffer_load_dwordx4 v142, s[36:39], s61 offen offset:0 sc1 lds
  ds_read_b64_tr_b16 a[66:67], v135 offset:29696
  v_mfma_f32_16x16x32_bf16 v[92:95], a[48:51], a[28:31], v[92:95]
  v_add_u32 v14, -14, v12
  v_min_u32 v12, v12, v14
  v_mfma_f32_16x16x32_bf16 v[96:99], a[48:51], a[32:35], v[96:99]
  v_mul_u32_u24 v13, 7168, v13
  v_lshl_add_u32 v12, v12, 4, v13
  v_mfma_f32_16x16x32_bf16 v[112:115], a[52:55], a[32:35], v[112:115]
  ds_read_b64_tr_b16 a[68:69], v136 offset:23552
  v_add_u32 v6, s48, v12
  v_mfma_f32_16x16x32_bf16 v[108:111], a[52:55], a[28:31], v[108:111]
  buffer_load_dwordx4 v142, s[36:39], s61 offen offset:1024 sc1 lds
  s_add_u32 m0, s64, 63488
  v_mfma_f32_16x16x32_bf16 v[104:107], a[52:55], a[24:27], v[104:107]
  ds_read_b64_tr_b16 a[70:71], v136 offset:29696
  v_mfma_f32_16x16x32_bf16 v[100:103], a[52:55], a[20:23], v[100:103]
  s_waitcnt vmcnt(23) lgkmcnt(4)
  s_barrier
  v_mfma_f32_16x16x32_bf16 v[20:23], a[56:59], a[0:3], v[20:23]
  ds_read_b64_tr_b16 a[40:41], v135 offset:21504
  v_mfma_f32_16x16x32_bf16 v[24:27], a[56:59], a[4:7], v[24:27]
  s_sub_u32 s48, s48, -3072
  buffer_load_dword v143, s[36:39], s61 offen sc1 lds
  s_cmp_eq_u32 s57, 2
  v_mfma_f32_16x16x32_bf16 v[28:31], a[56:59], a[8:11], v[28:31]
  s_cselect_b32 s69, 4, 28
  s_mul_i32 s60, s69, 196608
  s_add_u32 m0, s62, 64512
  v_mfma_f32_16x16x32_bf16 v[32:35], a[56:59], a[12:15], v[32:35]
  ds_read_b64_tr_b16 a[42:43], v135 offset:27648
  v_add_u32 v12, 256, v10
  v_mfma_f32_16x16x32_bf16 v[116:119], a[56:59], a[16:19], v[116:119]
  ds_read_b64_tr_b16 a[44:45], v136 offset:21504
  v_mul_u32_u24 v13, 4682, v12
  v_mfma_f32_16x16x32_bf16 v[48:51], a[60:63], a[12:15], v[48:51]
  buffer_load_dwordx4 v139, s[8:11], s60 offen offset:0 lds
  v_lshrrev_b32 v13, 16, v13
  v_mfma_f32_16x16x32_bf16 v[44:47], a[60:63], a[8:11], v[44:47]
  ds_read_b64_tr_b16 a[46:47], v136 offset:27648
  v_mul_i32_i24 v14, -14, v13
  v_mfma_f32_16x16x32_bf16 v[40:43], a[60:63], a[4:7], v[40:43]
  v_add3_u32 v12, v12, v14, s49
  v_mfma_f32_16x16x32_bf16 v[36:39], a[60:63], a[0:3], v[36:39]
  s_waitcnt lgkmcnt(4)
  ds_read_b64_tr_b16 a[48:49], v135 offset:44032
CT4:
  s_add_u32 s94, s92, CT4-k3_main_kernel+3072
  s_addc_u32 s95, s93, 0
  v_mfma_f32_16x16x32_bf16 v[52:55], a[0:3], a[64:67], v[52:55]
  buffer_load_dwordx4 v140, s[8:11], s60 offen offset:1024 lds
  ds_read_b128 a[20:23], v145 offset:55296
  v_mfma_f32_16x16x32_bf16 v[56:59], a[4:7], a[64:67], v[56:59]
  ds_read_b64_tr_b16 a[50:51], v135 offset:50176
  v_mfma_f32_16x16x32_bf16 v[60:63], a[8:11], a[64:67], v[60:63]
  ds_read_b128 a[24:27], v145 offset:56320
  v_add_u32 v14, -14, v12
  v_mfma_f32_16x16x32_bf16 v[64:67], a[12:15], a[64:67], v[64:67]
  v_min_u32 v12, v12, v14
  v_mul_u32_u24 v13, 7168, v13
  v_mfma_f32_16x16x32_bf16 v[120:123], a[16:19], a[64:67], v[120:123]
  global_load_dword a252, v0, s[94:95]
  ds_read_b64_tr_b16 a[52:53], v136 offset:44032
  v_mfma_f32_16x16x32_bf16 v[80:83], a[12:15], a[68:71], v[80:83]
  ds_read_b128 a[28:31], v145 offset:57344
  v_lshl_add_u32 v12, v12, 4, v13
  v_mfma_f32_16x16x32_bf16 v[76:79], a[8:11], a[68:71], v[76:79]
  ds_read_b64_tr_b16 a[54:55], v136 offset:50176
  ds_read_b128 a[32:35], v145 offset:58368
  v_mfma_f32_16x16x32_bf16 v[72:75], a[4:7], a[68:71], v[72:75]
  v_add_u32 v7, s48, v12
  v_mfma_f32_16x16x32_bf16 v[68:71], a[0:3], a[68:71], v[68:71]
  s_waitcnt lgkmcnt(8)
  buffer_load_dwordx4 v141, s[8:11], s60 offen offset:2048 lds
  s_lshl_b32 s61, s69, 11
  v_mfma_f32_16x16x32_bf16 v[84:87], a[40:43], a[0:3], v[84:87]
  s_add_u32 m0, s63, 76800
  ds_read_b128 a[36:39], v148 offset:63488
  ds_read_b64_tr_b16 a[56:57], v135 offset:45056
  v_mfma_f32_16x16x32_bf16 v[88:91], a[40:43], a[4:7], v[88:91]
  s_sub_u32 s48, s48, 1024
  ds_read_b64_tr_b16 a[58:59], v135 offset:51200
  v_mfma_f32_16x16x32_bf16 v[92:95], a[40:43], a[8:11], v[92:95]
  v_add_u32 v12, 320, v10
  v_mul_u32_u24 v13, 4682, v12
  v_mfma_f32_16x16x32_bf16 v[96:99], a[40:43], a[12:15], v[96:99]
  buffer_load_dwordx4 v142, s[36:39], s61 offen offset:0 sc1 lds
  v_lshrrev_b32 v13, 16, v13
  v_mfma_f32_16x16x32_bf16 v[112:115], a[44:47], a[12:15], v[112:115]
  ds_read_b64_tr_b16 a[60:61], v136 offset:45056
  v_mul_i32_i24 v14, -14, v13
  v_mfma_f32_16x16x32_bf16 v[108:111], a[44:47], a[8:11], v[108:111]
  v_add3_u32 v12, v12, v14, s49
  v_mfma_f32_16x16x32_bf16 v[104:107], a[44:47], a[4:7], v[104:107]
  ds_read_b64_tr_b16 a[62:63], v136 offset:51200
  v_mfma_f32_16x16x32_bf16 v[100:103], a[44:47], a[0:3], v[100:103]
  s_waitcnt vmcnt(23) lgkmcnt(4)
  s_barrier
  buffer_load_dwordx4 v142, s[36:39], s61 offen offset:1024 sc1 lds
  v_mfma_f32_16x16x32_bf16 v[20:23], a[48:51], a[20:23], v[20:23]
  s_add_u32 m0, s64, 84992
  ds_read_b64_tr_b16 a[64:65], v135 offset:43008
  v_mfma_f32_16x16x32_bf16 v[24:27], a[48:51], a[24:27], v[24:27]
  v_mfma_f32_16x16x32_bf16 v[28:31], a[48:51], a[28:31], v[28:31]
  ds_read_b64_tr_b16 a[66:67], v135 offset:49152
  v_add_u32 v14, -14, v12
  v_mfma_f32_16x16x32_bf16 v[32:35], a[48:51], a[32:35], v[32:35]
  buffer_load_dword v143, s[36:39], s61 offen sc1 lds
  s_cmp_eq_u32 s57, 2
  v_mfma_f32_16x16x32_bf16 v[116:119], a[48:51], a[36:39], v[116:119]
  s_cselect_b32 s70, 5, 29
  s_mul_i32 s60, s70, 196608
  s_add_u32 m0, s62, 86016
  v_mfma_f32_16x16x32_bf16 v[48:51], a[52:55], a[32:35], v[48:51]
  ds_read_b64_tr_b16 a[68:69], v136 offset:43008
  v_min_u32 v12, v12, v14
  v_mfma_f32_16x16x32_bf16 v[44:47], a[52:55], a[28:31], v[44:47]
  ds_read_b64_tr_b16 a[70:71], v136 offset:49152
  v_mul_u32_u24 v13, 7168, v13
  v_mfma_f32_16x16x32_bf16 v[40:43], a[52:55], a[24:27], v[40:43]
  buffer_load_dwordx4 v139, s[8:11], s60 offen offset:0 lds
  v_lshl_add_u32 v12, v12, 4, v13
  v_mfma_f32_16x16x32_bf16 v[36:39], a[52:55], a[20:23], v[36:39]
  s_waitcnt lgkmcnt(4)
  ds_read_b64_tr_b16 a[40:41], v137 offset:1024
  v_add_u32 v8, s48, v12
  v_mfma_f32_16x16x32_bf16 v[52:55], a[20:23], a[56:59], v[52:55]
  ds_read_b128 a[0:3], v146 offset:12288
  v_mfma_f32_16x16x32_bf16 v[56:59], a[24:27], a[56:59], v[56:59]
  s_sub_u32 s48, s48, 1024
  ds_read_b64_tr_b16 a[42:43], v137 offset:7168
  v_mfma_f32_16x16x32_bf16 v[60:63], a[28:31], a[56:59], v[60:63]
  buffer_load_dwordx4 v140, s[8:11], s60 offen offset:1024 lds
  ds_read_b128 a[4:7], v146 offset:13312
  v_mfma_f32_16x16x32_bf16 v[64:67], a[32:35], a[56:59], v[64:67]
  v_add_u32 v12, 384, v10
  v_mul_u32_u24 v13, 4682, v12
  v_mfma_f32_16x16x32_bf16 v[120:123], a[36:39], a[56:59], v[120:123]
  ds_read_b64_tr_b16 a[44:45], v138 offset:1024
  ds_read_b128 a[8:11], v146 offset:14336
  v_mfma_f32_16x16x32_bf16 v[80:83], a[32:35], a[60:63], v[80:83]
  v_lshrrev_b32 v13, 16, v13
  v_mul_i32_i24 v14, -14, v13
  v_mfma_f32_16x16x32_bf16 v[76:79], a[28:31], a[60:63], v[76:79]
  buffer_load_dwordx4 v141, s[8:11], s60 offen offset:2048 lds
  s_lshl_b32 s61, s70, 11
  v_mfma_f32_16x16x32_bf16 v[72:75], a[24:27], a[60:63], v[72:75]
  s_add_u32 m0, s63, 98304
  ds_read_b64_tr_b16 a[46:47], v138 offset:7168
  ds_read_b128 a[12:15], v146 offset:15360
  v_mfma_f32_16x16x32_bf16 v[68:71], a[20:23], a[60:63], v[68:71]
  s_waitcnt lgkmcnt(8)
  ds_read_b128 a[16:19], v149 offset:20480
  ds_read_b64_tr_b16 a[48:49], v137 offset:2048
  v_mfma_f32_16x16x32_bf16 v[84:87], a[64:67], a[20:23], v[84:87]
  v_add3_u32 v12, v12, v14, s49
  v_mfma_f32_16x16x32_bf16 v[88:91], a[64:67], a[24:27], v[88:91]
  buffer_load_dwordx4 v142, s[36:39], s61 offen offset:0 sc1 lds
  ds_read_b64_tr_b16 a[50:51], v137 offset:8192
  v_mfma_f32_16x16x32_bf16 v[92:95], a[64:67], a[28:31], v[92:95]
  v_add_u32 v14, -14, v12
  v_min_u32 v12, v12, v14
  v_mfma_f32_16x16x32_bf16 v[96:99], a[64:67], a[32:35], v[96:99]
  v_mul_u32_u24 v13, 7168, v13
  v_lshl_add_u32 v12, v12, 4, v13
  v_mfma_f32_16x16x32_bf16 v[112:115], a[68:71], a[32:35], v[112:115]
  ds_read_b64_tr_b16 a[52:53], v138 offset:2048
  v_add_u32 v9, s48, v12
  v_mfma_f32_16x16x32_bf16 v[108:111], a[68:71], a[28:31], v[108:111]
  buffer_load_dwordx4 v142, s[36:39], s61 offen offset:1024 sc1 lds
  s_add_u32 m0, s64, 106496
  v_mfma_f32_16x16x32_bf16 v[104:107], a[68:71], a[24:27], v[104:107]
  ds_read_b64_tr_b16 a[54:55], v138 offset:8192
  v_mfma_f32_16x16x32_bf16 v[100:103], a[68:71], a[20:23], v[100:103]
  s_waitcnt vmcnt(24) lgkmcnt(4)
  s_barrier
  v_mfma_f32_16x16x32_bf16 v[20:23], a[40:43], a[0:3], v[20:23]
  ds_read_b64_tr_b16 a[56:57], v137 offset:0
  v_mfma_f32_16x16x32_bf16 v[24:27], a[40:43], a[4:7], v[24:27]
  buffer_load_dword v143, s[36:39], s61 offen sc1 lds
  s_cmp_eq_u32 s57, 3
  v_mfma_f32_16x16x32_bf16 v[28:31], a[40:43], a[8:11], v[28:31]
  s_cselect_b32 s65, 6, 30
  s_mul_i32 s60, s65, 196608
  s_add_u32 m0, s62, 107520
  v_mfma_f32_16x16x32_bf16 v[32:35], a[40:43], a[12:15], v[32:35]
  s_sub_u32 s48, s48, 1024
  ds_read_b64_tr_b16 a[58:59], v137 offset:6144
  v_mfma_f32_16x16x32_bf16 v[116:119], a[40:43], a[16:19], v[116:119]
  s_and_b32 s48, s56, 1
  ds_read_b64_tr_b16 a[60:61], v138 offset:0
  s_lshl_b32 s48, s48, 7
  v_mfma_f32_16x16x32_bf16 v[48:51], a[44:47], a[12:15], v[48:51]
  s_and_b32 s49, s56, 6
  buffer_load_dwordx4 v139, s[8:11], s60 offen offset:0 lds
  s_add_u32 s48, s48, s49
  v_mfma_f32_16x16x32_bf16 v[44:47], a[44:47], a[8:11], v[44:47]
  ds_read_b64_tr_b16 a[62:63], v138 offset:6144
  v_mfma_f32_16x16x32_bf16 v[40:43], a[44:47], a[4:7], v[40:43]
  v_mfma_f32_16x16x32_bf16 v[36:39], a[44:47], a[0:3], v[36:39]
  s_waitcnt lgkmcnt(4)
  ds_read_b64_tr_b16 a[64:65], v133 offset:1024
  v_mfma_f32_16x16x32_bf16 v[52:55], a[0:3], a[48:51], v[52:55]
  buffer_load_dwordx4 v140, s[8:11], s60 offen offset:1024 lds
  ds_read_b128 a[20:23], v144 offset:12288
  v_mfma_f32_16x16x32_bf16 v[56:59], a[4:7], a[48:51], v[56:59]
  ds_read_b64_tr_b16 a[66:67], v133 offset:7168
  v_bfe_u32 v12, v10, 1, 4
  v_mfma_f32_16x16x32_bf16 v[60:63], a[8:11], a[48:51], v[60:63]
  ds_read_b128 a[24:27], v144 offset:13312
  v_and_b32 v13, 1, v10
  v_mfma_f32_16x16x32_bf16 v[64:67], a[12:15], a[48:51], v[64:67]
  v_lshl_add_u32 v12, v12, 3, v13
  v_add_lshl_u32 v250, v12, s48, 7
  v_mfma_f32_16x16x32_bf16 v[120:123], a[16:19], a[48:51], v[120:123]
  buffer_load_dwordx4 v141, s[8:11], s60 offen offset:2048 lds
  s_lshl_b32 s61, s65, 11
  v_mfma_f32_16x16x32_bf16 v[80:83], a[12:15], a[52:55], v[80:83]
  s_add_u32 m0, s63, 119808
  ds_read_b64_tr_b16 a[68:69], v134 offset:1024
  ds_read_b128 a[28:31], v144 offset:14336
  v_mfma_f32_16x16x32_bf16 v[76:79], a[8:11], a[52:55], v[76:79]
  ds_read_b64_tr_b16 a[70:71], v134 offset:7168
  ds_read_b128 a[32:35], v144 offset:15360
  v_mfma_f32_16x16x32_bf16 v[72:75], a[4:7], a[52:55], v[72:75]
  v_mfma_f32_16x16x32_bf16 v[68:71], a[0:3], a[52:55], v[68:71]
  s_waitcnt lgkmcnt(8)
  buffer_load_dwordx4 v142, s[36:39], s61 offen offset:0 sc1 lds
  ds_read_b128 a[36:39], v147 offset:20480
  v_mfma_f32_16x16x32_bf16 v[84:87], a[56:59], a[0:3], v[84:87]
  ds_read_b64_tr_b16 a[40:41], v133 offset:2048
  v_mfma_f32_16x16x32_bf16 v[88:91], a[56:59], a[4:7], v[88:91]
  ds_read_b64_tr_b16 a[42:43], v133 offset:8192
  v_mfma_f32_16x16x32_bf16 v[92:95], a[56:59], a[8:11], v[92:95]
  v_mfma_f32_16x16x32_bf16 v[96:99], a[56:59], a[12:15], v[96:99]
  buffer_load_dwordx4 v142, s[36:39], s61 offen offset:1024 sc1 lds
  s_add_u32 m0, s64, 128000
  v_mfma_f32_16x16x32_bf16 v[112:115], a[60:63], a[12:15], v[112:115]
  ds_read_b64_tr_b16 a[44:45], v134 offset:2048
  v_mfma_f32_16x16x32_bf16 v[108:111], a[60:63], a[8:11], v[108:111]
  v_mfma_f32_16x16x32_bf16 v[104:107], a[60:63], a[4:7], v[104:107]
  ds_read_b64_tr_b16 a[46:47], v134 offset:8192
  v_mfma_f32_16x16x32_bf16 v[100:103], a[60:63], a[0:3], v[100:103]
  s_waitcnt vmcnt(24) lgkmcnt(4)
  s_barrier
  buffer_load_dword v143, s[36:39], s61 offen sc1 lds
  v_mfma_f32_16x16x32_bf16 v[20:23], a[64:67], a[20:23], v[20:23]
  s_cmp_eq_u32 s57, 3
  s_cselect_b32 s66, 7, 31
  s_mul_i32 s60, s66, 196608
  v_mfma_f32_16x16x32_bf16 v[24:27], a[64:67], a[24:27], v[24:27]
  s_add_u32 m0, s62, 129024
  ds_read_b64_tr_b16 a[48:49], v133 offset:0
  v_mfma_f32_16x16x32_bf16 v[28:31], a[64:67], a[28:31], v[28:31]
  ds_read_b64_tr_b16 a[50:51], v133 offset:6144
  v_mfma_f32_16x16x32_bf16 v[32:35], a[64:67], a[32:35], v[32:35]
  buffer_load_dwordx4 v139, s[8:11], s60 offen offset:0 lds
  v_mfma_f32_16x16x32_bf16 v[116:119], a[64:67], a[36:39], v[116:119]
  ds_read_b64_tr_b16 a[52:53], v134 offset:0
  v_mfma_f32_16x16x32_bf16 v[48:51], a[68:71], a[32:35], v[48:51]
  v_mfma_f32_16x16x32_bf16 v[44:47], a[68:71], a[28:31], v[44:47]
  ds_read_b64_tr_b16 a[54:55], v134 offset:6144
  v_mfma_f32_16x16x32_bf16 v[40:43], a[68:71], a[24:27], v[40:43]
  buffer_load_dwordx4 v140, s[8:11], s60 offen offset:1024 lds
  v_mfma_f32_16x16x32_bf16 v[36:39], a[68:71], a[20:23], v[36:39]
  s_waitcnt lgkmcnt(4)
  ds_read_b64_tr_b16 a[56:57], v133 offset:22528
  v_mfma_f32_16x16x32_bf16 v[52:55], a[20:23], a[40:43], v[52:55]
  ds_read_b128 a[0:3], v144 offset:33792
  v_mfma_f32_16x16x32_bf16 v[56:59], a[24:27], a[40:43], v[56:59]
  ds_read_b64_tr_b16 a[58:59], v133 offset:28672
  v_mfma_f32_16x16x32_bf16 v[60:63], a[28:31], a[40:43], v[60:63]
  buffer_load_dwordx4 v141, s[8:11], s60 offen offset:2048 lds
  s_lshl_b32 s61, s66, 11
  v_mfma_f32_16x16x32_bf16 v[64:67], a[32:35], a[40:43], v[64:67]
  s_add_u32 m0, s63, 141312
  ds_read_b128 a[4:7], v144 offset:34816
  v_mfma_f32_16x16x32_bf16 v[120:123], a[36:39], a[40:43], v[120:123]
  ds_read_b64_tr_b16 a[60:61], v134 offset:22528
  ds_read_b128 a[8:11], v144 offset:35840
  v_mfma_f32_16x16x32_bf16 v[80:83], a[32:35], a[44:47], v[80:83]
  v_mfma_f32_16x16x32_bf16 v[76:79], a[28:31], a[44:47], v[76:79]
  buffer_load_dwordx4 v142, s[36:39], s61 offen offset:0 sc1 lds
  ds_read_b64_tr_b16 a[62:63], v134 offset:28672
  v_mfma_f32_16x16x32_bf16 v[72:75], a[24:27], a[44:47], v[72:75]
  ds_read_b128 a[12:15], v144 offset:36864
  v_mfma_f32_16x16x32_bf16 v[68:71], a[20:23], a[44:47], v[68:71]
  s_waitcnt lgkmcnt(8)
  ds_read_b128 a[16:19], v147 offset:41984
  ds_read_b64_tr_b16 a[64:65], v133 offset:23552
  v_mfma_f32_16x16x32_bf16 v[84:87], a[48:51], a[20:23], v[84:87]
  v_mfma_f32_16x16x32_bf16 v[88:91], a[48:51], a[24:27], v[88:91]
  buffer_load_dwordx4 v142, s[36:39], s61 offen offset:1024 sc1 lds
  s_add_u32 m0, s64, 149504
  v_mfma_f32_16x16x32_bf16 v[92:95], a[48:51], a[28:31], v[92:95]
  ds_read_b64_tr_b16 a[66:67], v133 offset:29696
  v_mfma_f32_16x16x32_bf16 v[96:99], a[48:51], a[32:35], v[96:99]
  v_mfma_f32_16x16x32_bf16 v[112:115], a[52:55], a[32:35], v[112:115]
  ds_read_b64_tr_b16 a[68:69], v134 offset:23552
  v_mfma_f32_16x16x32_bf16 v[108:111], a[52:55], a[28:31], v[108:111]
  buffer_load_dword v143, s[36:39], s61 offen sc1 lds
  s_nop 0
  v_mfma_f32_16x16x32_bf16 v[104:107], a[52:55], a[24:27], v[104:107]
  s_add_u32 s50, s71, 0
  s_and_b32 s50, s50, 7
  s_lshl_b32 s50, s50, 18
  v_mfma_f32_16x16x32_bf16 v[100:103], a[52:55], a[20:23], v[100:103]
  s_waitcnt vmcnt(25) lgkmcnt(3)
  s_barrier
  s_add_u32 m0, s73, 0
  v_mfma_f32_16x16x32_bf16 v[20:23], a[56:59], a[0:3], v[20:23]
  ds_read_b64_tr_b16 a[70:71], v134 offset:29696
  ds_read_b64_tr_b16 a[40:41], v133 offset:21504
  v_mfma_f32_16x16x32_bf16 v[24:27], a[56:59], a[4:7], v[24:27]
  buffer_load_dwordx4 v216, s[12:15], s50 offen offset:0 lds
  v_mfma_f32_16x16x32_bf16 v[28:31], a[56:59], a[8:11], v[28:31]
  ds_read_b64_tr_b16 a[42:43], v133 offset:27648
  v_mfma_f32_16x16x32_bf16 v[32:35], a[56:59], a[12:15], v[32:35]
  v_mfma_f32_16x16x32_bf16 v[116:119], a[56:59], a[16:19], v[116:119]
  ds_read_b64_tr_b16 a[44:45], v134 offset:21504
  v_mfma_f32_16x16x32_bf16 v[48:51], a[60:63], a[12:15], v[48:51]
  buffer_load_dwordx4 v217, s[12:15], s50 offen offset:1024 lds
  v_mfma_f32_16x16x32_bf16 v[44:47], a[60:63], a[8:11], v[44:47]
  ds_read_b64_tr_b16 a[46:47], v134 offset:27648
  v_mfma_f32_16x16x32_bf16 v[40:43], a[60:63], a[4:7], v[40:43]
  v_mfma_f32_16x16x32_bf16 v[36:39], a[60:63], a[0:3], v[36:39]
  s_waitcnt lgkmcnt(4)
  ds_read_b64_tr_b16 a[48:49], v133 offset:44032
  v_mfma_f32_16x16x32_bf16 v[52:55], a[0:3], a[64:67], v[52:55]
  buffer_load_dwordx4 v218, s[12:15], s50 offen offset:2048 lds
  ds_read_b128 a[20:23], v144 offset:55296
  v_mfma_f32_16x16x32_bf16 v[56:59], a[4:7], a[64:67], v[56:59]
  ds_read_b64_tr_b16 a[50:51], v133 offset:50176
  v_mfma_f32_16x16x32_bf16 v[60:63], a[8:11], a[64:67], v[60:63]
  ds_read_b128 a[24:27], v144 offset:56320
  v_mfma_f32_16x16x32_bf16 v[64:67], a[12:15], a[64:67], v[64:67]
  v_mfma_f32_16x16x32_bf16 v[120:123], a[16:19], a[64:67], v[120:123]
  buffer_load_dwordx4 v219, s[12:15], s50 offen offset:3072 lds
  ds_read_b64_tr_b16 a[52:53], v134 offset:44032
  v_mfma_f32_16x16x32_bf16 v[80:83], a[12:15], a[68:71], v[80:83]
  ds_read_b128 a[28:31], v144 offset:57344
  v_mfma_f32_16x16x32_bf16 v[76:79], a[8:11], a[68:71], v[76:79]
  ds_read_b64_tr_b16 a[54:55], v134 offset:50176
  ds_read_b128 a[32:35], v144 offset:58368
  v_mfma_f32_16x16x32_bf16 v[72:75], a[4:7], a[68:71], v[72:75]
  v_mfma_f32_16x16x32_bf16 v[68:71], a[0:3], a[68:71], v[68:71]
  s_waitcnt lgkmcnt(8)
  buffer_load_dwordx4 v[156:159], v196, s[28:31], s52 offen nt
  s_add_u32 s52, s52, 12288
  v_mfma_f32_16x16x32_bf16 v[84:87], a[40:43], a[0:3], v[84:87]
  ds_read_b128 a[36:39], v147 offset:63488
  ds_read_b64_tr_b16 a[56:57], v133 offset:45056
  v_mfma_f32_16x16x32_bf16 v[88:91], a[40:43], a[4:7], v[88:91]
  ds_read_b64_tr_b16 a[58:59], v133 offset:51200
  v_mfma_f32_16x16x32_bf16 v[92:95], a[40:43], a[8:11], v[92:95]
  v_mfma_f32_16x16x32_bf16 v[96:99], a[40:43], a[12:15], v[96:99]
  buffer_load_dwordx4 v[160:163], v196, s[28:31], s52 offen nt
  s_add_u32 s52, s52, 12288
  v_mfma_f32_16x16x32_bf16 v[112:115], a[44:47], a[12:15], v[112:115]
  ds_read_b64_tr_b16 a[60:61], v134 offset:45056
  v_mfma_f32_16x16x32_bf16 v[108:111], a[44:47], a[8:11], v[108:111]
  v_mfma_f32_16x16x32_bf16 v[104:107], a[44:47], a[4:7], v[104:107]
  ds_read_b64_tr_b16 a[62:63], v134 offset:51200
  v_mfma_f32_16x16x32_bf16 v[100:103], a[44:47], a[0:3], v[100:103]
  s_waitcnt vmcnt(24) lgkmcnt(4)
  s_barrier
  buffer_load_dwordx4 v[164:167], v196, s[28:31], s52 offen nt
  v_mfma_f32_16x16x32_bf16 v[20:23], a[48:51], a[20:23], v[20:23]
  s_add_u32 s52, s52, 12288
  ds_read_b64_tr_b16 a[64:65], v133 offset:43008
  v_mfma_f32_16x16x32_bf16 v[24:27], a[48:51], a[24:27], v[24:27]
  v_mfma_f32_16x16x32_bf16 v[28:31], a[48:51], a[28:31], v[28:31]
  ds_read_b64_tr_b16 a[66:67], v133 offset:49152
  v_mfma_f32_16x16x32_bf16 v[32:35], a[48:51], a[32:35], v[32:35]
  buffer_load_dwordx4 v[168:171], v196, s[28:31], s52 offen nt
  s_add_u32 s52, s52, 12288
  v_mfma_f32_16x16x32_bf16 v[116:119], a[48:51], a[36:39], v[116:119]
  ds_read_b64_tr_b16 a[68:69], v134 offset:43008
  v_mfma_f32_16x16x32_bf16 v[48:51], a[52:55], a[32:35], v[48:51]
  v_mfma_f32_16x16x32_bf16 v[44:47], a[52:55], a[28:31], v[44:47]
  ds_read_b64_tr_b16 a[70:71], v134 offset:49152
  v_mfma_f32_16x16x32_bf16 v[40:43], a[52:55], a[24:27], v[40:43]
  buffer_load_dwordx4 v[172:175], v196, s[28:31], s52 offen nt
  s_add_u32 s52, s52, 12288
  v_mfma_f32_16x16x32_bf16 v[36:39], a[52:55], a[20:23], v[36:39]
  s_waitcnt lgkmcnt(4)
  ds_read_b64_tr_b16 a[40:41], v135 offset:1024
  v_mfma_f32_16x16x32_bf16 v[52:55], a[20:23], a[56:59], v[52:55]
  ds_read_b128 a[0:3], v145 offset:12288
  v_mfma_f32_16x16x32_bf16 v[56:59], a[24:27], a[56:59], v[56:59]
  ds_read_b64_tr_b16 a[42:43], v135 offset:7168
  v_mfma_f32_16x16x32_bf16 v[60:63], a[28:31], a[56:59], v[60:63]
  buffer_load_dwordx4 v[176:179], v196, s[28:31], s52 offen nt
  s_add_u32 s52, s52, 12288
  v_mfma_f32_16x16x32_bf16 v[64:67], a[32:35], a[56:59], v[64:67]
  ds_read_b128 a[4:7], v145 offset:13312
  v_mfma_f32_16x16x32_bf16 v[120:123], a[36:39], a[56:59], v[120:123]
  ds_read_b64_tr_b16 a[44:45], v136 offset:1024
  ds_read_b128 a[8:11], v145 offset:14336
  v_mfma_f32_16x16x32_bf16 v[80:83], a[32:35], a[60:63], v[80:83]
  v_mfma_f32_16x16x32_bf16 v[76:79], a[28:31], a[60:63], v[76:79]
  buffer_load_dwordx4 v[180:183], v196, s[28:31], s52 offen nt
  s_add_u32 s52, s52, 12288
  v_mfma_f32_16x16x32_bf16 v[72:75], a[24:27], a[60:63], v[72:75]
  ds_read_b64_tr_b16 a[46:47], v136 offset:7168
  ds_read_b128 a[12:15], v145 offset:15360
  v_mfma_f32_16x16x32_bf16 v[68:71], a[20:23], a[60:63], v[68:71]
  s_waitcnt lgkmcnt(8)
  ds_read_b128 a[16:19], v148 offset:20480
  ds_read_b64_tr_b16 a[48:49], v135 offset:2048
  v_mfma_f32_16x16x32_bf16 v[84:87], a[64:67], a[20:23], v[84:87]
  v_mfma_f32_16x16x32_bf16 v[88:91], a[64:67], a[24:27], v[88:91]
  buffer_load_dwordx4 v[184:187], v196, s[28:31], s52 offen nt
  ds_read_b64_tr_b16 a[50:51], v135 offset:8192
  v_mfma_f32_16x16x32_bf16 v[92:95], a[64:67], a[28:31], v[92:95]
  v_mfma_f32_16x16x32_bf16 v[96:99], a[64:67], a[32:35], v[96:99]
  v_mfma_f32_16x16x32_bf16 v[112:115], a[68:71], a[32:35], v[112:115]
  ds_read_b64_tr_b16 a[52:53], v136 offset:2048
  v_mfma_f32_16x16x32_bf16 v[108:111], a[68:71], a[28:31], v[108:111]
  v_mfma_f32_16x16x32_bf16 v[104:107], a[68:71], a[24:27], v[104:107]
  ds_read_b64_tr_b16 a[54:55], v136 offset:8192
  v_mfma_f32_16x16x32_bf16 v[100:103], a[68:71], a[20:23], v[100:103]
  s_waitcnt vmcnt(24) lgkmcnt(4)
  s_barrier
  v_mfma_f32_16x16x32_bf16 v[20:23], a[40:43], a[0:3], v[20:23]
  ds_read_b64_tr_b16 a[56:57], v135 offset:0
  v_mfma_f32_16x16x32_bf16 v[24:27], a[40:43], a[4:7], v[24:27]
  v_mfma_f32_16x16x32_bf16 v[28:31], a[40:43], a[8:11], v[28:31]
  ds_read_b64_tr_b16 a[58:59], v135 offset:6144
  v_mfma_f32_16x16x32_bf16 v[32:35], a[40:43], a[12:15], v[32:35]
  v_mfma_f32_16x16x32_bf16 v[116:119], a[40:43], a[16:19], v[116:119]
  ds_read_b64_tr_b16 a[60:61], v136 offset:0
  v_mfma_f32_16x16x32_bf16 v[48:51], a[44:47], a[12:15], v[48:51]
  v_mfma_f32_16x16x32_bf16 v[44:47], a[44:47], a[8:11], v[44:47]
  ds_read_b64_tr_b16 a[62:63], v136 offset:6144
  v_mfma_f32_16x16x32_bf16 v[40:43], a[44:47], a[4:7], v[40:43]
  v_mfma_f32_16x16x32_bf16 v[36:39], a[44:47], a[0:3], v[36:39]
  s_waitcnt lgkmcnt(4)
  ds_read_b64_tr_b16 a[64:65], v135 offset:22528
  v_mfma_f32_16x16x32_bf16 v[52:55], a[0:3], a[48:51], v[52:55]
  ds_read_b128 a[20:23], v145 offset:33792
  v_mfma_f32_16x16x32_bf16 v[56:59], a[4:7], a[48:51], v[56:59]
  ds_read_b64_tr_b16 a[66:67], v135 offset:28672
  v_mfma_f32_16x16x32_bf16 v[60:63], a[8:11], a[48:51], v[60:63]
  ds_read_b128 a[24:27], v145 offset:34816
  v_mfma_f32_16x16x32_bf16 v[64:67], a[12:15], a[48:51], v[64:67]
  v_mfma_f32_16x16x32_bf16 v[120:123], a[16:19], a[48:51], v[120:123]
  ds_read_b64_tr_b16 a[68:69], v136 offset:22528
  ds_read_b128 a[28:31], v145 offset:35840
  v_mfma_f32_16x16x32_bf16 v[80:83], a[12:15], a[52:55], v[80:83]
  v_mfma_f32_16x16x32_bf16 v[76:79], a[8:11], a[52:55], v[76:79]
  ds_read_b64_tr_b16 a[70:71], v136 offset:28672
  ds_read_b128 a[32:35], v145 offset:36864
  v_mfma_f32_16x16x32_bf16 v[72:75], a[4:7], a[52:55], v[72:75]
  v_mfma_f32_16x16x32_bf16 v[68:71], a[0:3], a[52:55], v[68:71]
  s_waitcnt lgkmcnt(8)
  ds_read_b128 a[36:39], v148 offset:41984
  ds_read_b64_tr_b16 a[40:41], v135 offset:23552
  v_mfma_f32_16x16x32_bf16 v[84:87], a[56:59], a[0:3], v[84:87]
  v_mfma_f32_16x16x32_bf16 v[88:91], a[56:59], a[4:7], v[88:91]
  ds_read_b64_tr_b16 a[42:43], v135 offset:29696
  v_mfma_f32_16x16x32_bf16 v[92:95], a[56:59], a[8:11], v[92:95]
  v_mfma_f32_16x16x32_bf16 v[96:99], a[56:59], a[12:15], v[96:99]
  v_mfma_f32_16x16x32_bf16 v[112:115], a[60:63], a[12:15], v[112:115]
  ds_read_b64_tr_b16 a[44:45], v136 offset:23552
  v_mfma_f32_16x16x32_bf16 v[108:111], a[60:63], a[8:11], v[108:111]
  v_mfma_f32_16x16x32_bf16 v[104:107], a[60:63], a[4:7], v[104:107]
  ds_read_b64_tr_b16 a[46:47], v136 offset:29696
  v_mfma_f32_16x16x32_bf16 v[100:103], a[60:63], a[0:3], v[100:103]
  s_waitcnt vmcnt(18) lgkmcnt(4)
  s_barrier
  v_mfma_f32_16x16x32_bf16 v[20:23], a[64:67], a[20:23], v[20:23]
  ds_read_b64_tr_b16 a[48:49], v135 offset:21504
  v_mfma_f32_16x16x32_bf16 v[24:27], a[64:67], a[24:27], v[24:27]
  v_mfma_f32_16x16x32_bf16 v[28:31], a[64:67], a[28:31], v[28:31]
  ds_read_b64_tr_b16 a[50:51], v135 offset:27648
  v_mfma_f32_16x16x32_bf16 v[32:35], a[64:67], a[32:35], v[32:35]
  v_mfma_f32_16x16x32_bf16 v[116:119], a[64:67], a[36:39], v[116:119]
  ds_read_b64_tr_b16 a[52:53], v136 offset:21504
  v_mfma_f32_16x16x32_bf16 v[48:51], a[68:71], a[32:35], v[48:51]
  v_mfma_f32_16x16x32_bf16 v[44:47], a[68:71], a[28:31], v[44:47]
  ds_read_b64_tr_b16 a[54:55], v136 offset:27648
  v_mfma_f32_16x16x32_bf16 v[40:43], a[68:71], a[24:27], v[40:43]
  v_mfma_f32_16x16x32_bf16 v[36:39], a[68:71], a[20:23], v[36:39]
  s_waitcnt lgkmcnt(4)
  ds_read_b64_tr_b16 a[56:57], v135 offset:44032
  v_mfma_f32_16x16x32_bf16 v[52:55], a[20:23], a[40:43], v[52:55]
  ds_read_b128 a[0:3], v145 offset:55296
  v_mfma_f32_16x16x32_bf16 v[56:59], a[24:27], a[40:43], v[56:59]
  ds_read_b64_tr_b16 a[58:59], v135 offset:50176
  v_mfma_f32_16x16x32_bf16 v[60:63], a[28:31], a[40:43], v[60:63]
  ds_read_b128 a[4:7], v145 offset:56320
  v_mfma_f32_16x16x32_bf16 v[64:67], a[32:35], a[40:43], v[64:67]
  v_mfma_f32_16x16x32_bf16 v[120:123], a[36:39], a[40:43], v[120:123]
  ds_read_b64_tr_b16 a[60:61], v136 offset:44032
  ds_read_b128 a[8:11], v145 offset:57344
  v_mfma_f32_16x16x32_bf16 v[80:83], a[32:35], a[44:47], v[80:83]
  v_mfma_f32_16x16x32_bf16 v[76:79], a[28:31], a[44:47], v[76:79]
  ds_read_b64_tr_b16 a[62:63], v136 offset:50176
  ds_read_b128 a[12:15], v145 offset:58368
  v_mfma_f32_16x16x32_bf16 v[72:75], a[24:27], a[44:47], v[72:75]
  v_mfma_f32_16x16x32_bf16 v[68:71], a[20:23], a[44:47], v[68:71]
  s_waitcnt lgkmcnt(8)
  ds_read_b128 a[16:19], v148 offset:63488
  ds_read_b64_tr_b16 a[64:65], v135 offset:45056
  v_mfma_f32_16x16x32_bf16 v[84:87], a[48:51], a[20:23], v[84:87]
  v_mfma_f32_16x16x32_bf16 v[88:91], a[48:51], a[24:27], v[88:91]
  ds_read_b64_tr_b16 a[66:67], v135 offset:51200
  v_mfma_f32_16x16x32_bf16 v[92:95], a[48:51], a[28:31], v[92:95]
  v_mfma_f32_16x16x32_bf16 v[96:99], a[48:51], a[32:35], v[96:99]
  v_mfma_f32_16x16x32_bf16 v[112:115], a[52:55], a[32:35], v[112:115]
  ds_read_b64_tr_b16 a[68:69], v136 offset:45056
  v_mfma_f32_16x16x32_bf16 v[108:111], a[52:55], a[28:31], v[108:111]
  v_mfma_f32_16x16x32_bf16 v[104:107], a[52:55], a[24:27], v[104:107]
  ds_read_b64_tr_b16 a[70:71], v136 offset:51200
  v_mfma_f32_16x16x32_bf16 v[100:103], a[52:55], a[20:23], v[100:103]
  s_waitcnt vmcnt(12) lgkmcnt(4)
  s_barrier
  v_mfma_f32_16x16x32_bf16 v[20:23], a[56:59], a[0:3], v[20:23]
  ds_read_b64_tr_b16 a[40:41], v135 offset:43008
  v_mfma_f32_16x16x32_bf16 v[24:27], a[56:59], a[4:7], v[24:27]
  s_add_u32 s50, s71, 1
  s_and_b32 s50, s50, 7
  s_lshl_b32 s50, s50, 18
  v_mfma_f32_16x16x32_bf16 v[28:31], a[56:59], a[8:11], v[28:31]
  s_add_u32 m0, s73, 16384
  ds_read_b64_tr_b16 a[42:43], v135 offset:49152
  v_mfma_f32_16x16x32_bf16 v[32:35], a[56:59], a[12:15], v[32:35]
  v_mfma_f32_16x16x32_bf16 v[116:119], a[56:59], a[16:19], v[116:119]
  ds_read_b64_tr_b16 a[44:45], v136 offset:43008
  v_mfma_f32_16x16x32_bf16 v[48:51], a[60:63], a[12:15], v[48:51]
  buffer_load_dwordx4 v216, s[12:15], s50 offen offset:0 lds
  v_mfma_f32_16x16x32_bf16 v[44:47], a[60:63], a[8:11], v[44:47]
  ds_read_b64_tr_b16 a[46:47], v136 offset:49152
  v_mfma_f32_16x16x32_bf16 v[40:43], a[60:63], a[4:7], v[40:43]
  v_mfma_f32_16x16x32_bf16 v[36:39], a[60:63], a[0:3], v[36:39]
  s_waitcnt lgkmcnt(4)
  ds_read_b64_tr_b16 a[48:49], v137 offset:1024
  v_mfma_f32_16x16x32_bf16 v[52:55], a[0:3], a[64:67], v[52:55]
  buffer_load_dwordx4 v217, s[12:15], s50 offen offset:1024 lds
  ds_read_b128 a[20:23], v146 offset:12288
  v_mfma_f32_16x16x32_bf16 v[56:59], a[4:7], a[64:67], v[56:59]
  ds_read_b64_tr_b16 a[50:51], v137 offset:7168
  v_mfma_f32_16x16x32_bf16 v[60:63], a[8:11], a[64:67], v[60:63]
  ds_read_b128 a[24:27], v146 offset:13312
  v_mfma_f32_16x16x32_bf16 v[64:67], a[12:15], a[64:67], v[64:67]
  v_mfma_f32_16x16x32_bf16 v[120:123], a[16:19], a[64:67], v[120:123]
  buffer_load_dwordx4 v218, s[12:15], s50 offen offset:2048 lds
  ds_read_b64_tr_b16 a[52:53], v138 offset:1024
  v_mfma_f32_16x16x32_bf16 v[80:83], a[12:15], a[68:71], v[80:83]
  ds_read_b128 a[28:31], v146 offset:14336
  v_mfma_f32_16x16x32_bf16 v[76:79], a[8:11], a[68:71], v[76:79]
  ds_read_b64_tr_b16 a[54:55], v138 offset:7168
  ds_read_b128 a[32:35], v146 offset:15360
  v_mfma_f32_16x16x32_bf16 v[72:75], a[4:7], a[68:71], v[72:75]
  v_mfma_f32_16x16x32_bf16 v[68:71], a[0:3], a[68:71], v[68:71]
  s_waitcnt lgkmcnt(8)
  buffer_load_dwordx4 v219, s[12:15], s50 offen offset:3072 lds
  s_add_u32 s50, s71, 2
  v_mfma_f32_16x16x32_bf16 v[84:87], a[40:43], a[0:3], v[84:87]
  s_and_b32 s50, s50, 7
  s_lshl_b32 s50, s50, 18
  s_add_u32 m0, s73, 32768
  v_mfma_f32_16x16x32_bf16 v[88:91], a[40:43], a[4:7], v[88:91]
  ds_read_b128 a[36:39], v149 offset:20480
  ds_read_b64_tr_b16 a[56:57], v137 offset:2048
  v_mfma_f32_16x16x32_bf16 v[92:95], a[40:43], a[8:11], v[92:95]
  ds_read_b64_tr_b16 a[58:59], v137 offset:8192
  v_mfma_f32_16x16x32_bf16 v[96:99], a[40:43], a[12:15], v[96:99]
  buffer_load_dwordx4 v216, s[12:15], s50 offen offset:0 lds
  v_mfma_f32_16x16x32_bf16 v[112:115], a[44:47], a[12:15], v[112:115]
  ds_read_b64_tr_b16 a[60:61], v138 offset:2048
  v_mfma_f32_16x16x32_bf16 v[108:111], a[44:47], a[8:11], v[108:111]
  v_mfma_f32_16x16x32_bf16 v[104:107], a[44:47], a[4:7], v[104:107]
  ds_read_b64_tr_b16 a[62:63], v138 offset:8192
  v_mfma_f32_16x16x32_bf16 v[100:103], a[44:47], a[0:3], v[100:103]
  s_waitcnt lgkmcnt(4)
  buffer_load_dwordx4 v217, s[12:15], s50 offen offset:1024 lds
  v_mfma_f32_16x16x32_bf16 v[20:23], a[48:51], a[20:23], v[20:23]
  ds_read_b64_tr_b16 a[64:65], v137 offset:0
  v_mfma_f32_16x16x32_bf16 v[24:27], a[48:51], a[24:27], v[24:27]
  v_mfma_f32_16x16x32_bf16 v[28:31], a[48:51], a[28:31], v[28:31]
  ds_read_b64_tr_b16 a[66:67], v137 offset:6144
  v_mfma_f32_16x16x32_bf16 v[32:35], a[48:51], a[32:35], v[32:35]
  buffer_load_dwordx4 v218, s[12:15], s50 offen offset:2048 lds
  v_mfma_f32_16x16x32_bf16 v[116:119], a[48:51], a[36:39], v[116:119]
  ds_read_b64_tr_b16 a[68:69], v138 offset:0
  v_mfma_f32_16x16x32_bf16 v[48:51], a[52:55], a[32:35], v[48:51]
  v_mfma_f32_16x16x32_bf16 v[44:47], a[52:55], a[28:31], v[44:47]
  ds_read_b64_tr_b16 a[70:71], v138 offset:6144
  v_mfma_f32_16x16x32_bf16 v[40:43], a[52:55], a[24:27], v[40:43]
  buffer_load_dwordx4 v219, s[12:15], s50 offen offset:3072 lds
  v_mfma_f32_16x16x32_bf16 v[36:39], a[52:55], a[20:23], v[36:39]
  s_waitcnt lgkmcnt(4)
  v_mfma_f32_16x16x32_bf16 v[52:55], a[20:23], a[56:59], v[52:55]
  v_cvt_pk_bf16_f32 v116, v116, v117
  v_cvt_pk_bf16_f32 v117, v118, v119
  v_mfma_f32_16x16x32_bf16 v[56:59], a[24:27], a[56:59], v[56:59]
  v_cvt_pk_bf16_f32 v32, v32, v33
  v_cvt_pk_bf16_f32 v33, v34, v35
  v_mfma_f32_16x16x32_bf16 v[60:63], a[28:31], a[56:59], v[60:63]
  v_cvt_pk_bf16_f32 v34, v48, v49
  v_cvt_pk_bf16_f32 v35, v50, v51
  v_mfma_f32_16x16x32_bf16 v[64:67], a[32:35], a[56:59], v[64:67]
  ds_write_b64 v224, v[116:117]
  ds_write_b64 v222, v[32:33]
  v_mfma_f32_16x16x32_bf16 v[120:123], a[36:39], a[56:59], v[120:123]
  ds_write_b64 v223, v[34:35]
  v_mfma_f32_16x16x32_bf16 v[80:83], a[32:35], a[60:63], v[80:83]
  v_mfma_f32_16x16x32_bf16 v[76:79], a[28:31], a[60:63], v[76:79]
  v_cvt_pk_bf16_f32 v55, v54, v55
  v_cvt_pk_bf16_f32 v54, v52, v53
  v_mfma_f32_16x16x32_bf16 v[72:75], a[24:27], a[60:63], v[72:75]
  v_cvt_pk_bf16_f32 v56, v56, v57
  v_cvt_pk_bf16_f32 v57, v58, v59
  v_mfma_f32_16x16x32_bf16 v[68:71], a[20:23], a[60:63], v[68:71]
  s_waitcnt lgkmcnt(3)
  v_cvt_pk_bf16_f32 v58, v60, v61
  v_cvt_pk_bf16_f32 v59, v62, v63
  v_mfma_f32_16x16x32_bf16 v[84:87], a[64:67], a[20:23], v[84:87]
  v_cvt_pk_bf16_f32 v60, v64, v65
  v_cvt_pk_bf16_f32 v61, v66, v67
  v_mfma_f32_16x16x32_bf16 v[88:91], a[64:67], a[24:27], v[88:91]
  v_cvt_pk_bf16_f32 v120, v120, v121
  v_cvt_pk_bf16_f32 v121, v122, v123
  v_mfma_f32_16x16x32_bf16 v[92:95], a[64:67], a[28:31], v[92:95]
  ds_write_b64 v222, v[60:61] offset:1024
  ds_write_b64 v224, v[120:121] offset:1024
  v_mfma_f32_16x16x32_bf16 v[96:99], a[64:67], a[32:35], v[96:99]
  v_cvt_pk_bf16_f32 v71, v70, v71
  v_cvt_pk_bf16_f32 v70, v68, v69
  v_mfma_f32_16x16x32_bf16 v[112:115], a[68:71], a[32:35], v[112:115]
  v_cvt_pk_bf16_f32 v72, v72, v73
  v_cvt_pk_bf16_f32 v73, v74, v75
  v_mfma_f32_16x16x32_bf16 v[108:111], a[68:71], a[28:31], v[108:111]
  v_cvt_pk_bf16_f32 v74, v76, v77
  v_cvt_pk_bf16_f32 v75, v78, v79
  v_mfma_f32_16x16x32_bf16 v[104:107], a[68:71], a[24:27], v[104:107]
  v_cvt_pk_bf16_f32 v76, v80, v81
  v_cvt_pk_bf16_f32 v77, v82, v83
  v_mfma_f32_16x16x32_bf16 v[100:103], a[68:71], a[20:23], v[100:103]
  ds_write_b64 v223, v[76:77] offset:1024
  v_cvt_pk_bf16_f32 v28, v28, v29
  v_cvt_pk_bf16_f32 v29, v30, v31
  v_cvt_pk_bf16_f32 v30, v44, v45
  v_cvt_pk_bf16_f32 v31, v46, v47
  v_cvt_pk_bf16_f32 v24, v24, v25
  v_cvt_pk_bf16_f32 v25, v26, v27
  v_cvt_pk_bf16_f32 v26, v40, v41
  v_cvt_pk_bf16_f32 v27, v42, v43
  v_cvt_pk_bf16_f32 v20, v20, v21
  v_cvt_pk_bf16_f32 v21, v22, v23
  v_cvt_pk_bf16_f32 v22, v36, v37
  v_cvt_pk_bf16_f32 v23, v38, v39
  s_waitcnt lgkmcnt(0)
  s_barrier
  ds_read_b64 v[124:125], v225
  ds_read_b64 v[126:127], v226
  ds_read_b64 v[52:53], v225 offset:1024
  ds_read_b64 v[68:69], v226 offset:1024
  s_cmp_eq_u32 s51, 0
  s_cselect_b64 s[66:67], s[42:43], 0
  s_cselect_b64 s[68:69], s[80:81], 0
  v_cvt_pk_bf16_f32 v96, v96, v97
  v_cvt_pk_bf16_f32 v97, v98, v99
  v_cvt_pk_bf16_f32 v98, v112, v113
  v_cvt_pk_bf16_f32 v99, v114, v115
  v_cvt_pk_bf16_f32 v92, v92, v93
  v_cvt_pk_bf16_f32 v93, v94, v95
  v_cvt_pk_bf16_f32 v94, v108, v109
  s_add_u32 s50, s71, 3
  s_and_b32 s50, s50, 7
  s_lshl_b32 s50, s50, 18
  s_add_u32 m0, s73, 49152
  s_nop 0
  buffer_load_dwordx4 v216, s[12:15], s50 offen offset:0 lds
  v_cvt_pk_bf16_f32 v95, v110, v111
  v_cvt_pk_bf16_f32 v88, v88, v89
  v_cvt_pk_bf16_f32 v89, v90, v91
  v_cvt_pk_bf16_f32 v90, v104, v105
  v_cvt_pk_bf16_f32 v91, v106, v107
  v_cvt_pk_bf16_f32 v84, v84, v85
  v_cvt_pk_bf16_f32 v85, v86, v87
  v_cvt_pk_bf16_f32 v86, v100, v101
  v_cvt_pk_bf16_f32 v87, v102, v103
  v_mov_b32 v12, 0xce6e6b28
  buffer_load_dwordx4 v217, s[12:15], s50 offen offset:1024 lds
  v_mfma_f32_16x16x32_bf16 v[112:115], v[32:35], v[96:99], 0
  v_mfma_f32_16x16x32_bf16 v[48:51], v[28:31], v[96:99], 0
  v_mfma_f32_16x16x32_bf16 v[108:111], v[28:31], v[92:95], 0
  v_mfma_f32_16x16x32_bf16 v[44:47], v[24:27], v[92:95], 0
  v_mfma_f32_16x16x32_bf16 v[104:107], v[24:27], v[88:91], 0
  v_mfma_f32_16x16x32_bf16 v[40:43], v[20:23], v[88:91], 0
  s_waitcnt lgkmcnt(2)
  v_mfma_f32_16x16x32_bf16 v[100:103], v[20:23], v[84:87], 0
  v_mfma_f32_16x16x32_bf16 v[36:39], v[124:127], v[84:87], 0
  s_nop 1
  v_cndmask_b32 v214, v112, v113, s[40:41]
  buffer_load_dwordx4 v218, s[12:15], s50 offen offset:2048 lds
  v_cndmask_b32 v215, v114, v115, s[40:41]
  v_cndmask_b32 v212, v48, v49, s[40:41]
  v_cndmask_b32 v213, v50, v51, s[40:41]
  v_cndmask_b32 v210, v108, v109, s[40:41]
  v_cndmask_b32 v211, v110, v111, s[40:41]
  v_cndmask_b32 v208, v44, v45, s[40:41]
  v_cndmask_b32 v209, v46, v47, s[40:41]
  v_cndmask_b32 v206, v104, v105, s[40:41]
  v_cndmask_b32 v207, v106, v107, s[40:41]
  v_cndmask_b32 v204, v40, v41, s[40:41]
  buffer_load_dwordx4 v219, s[12:15], s50 offen offset:3072 lds
  v_cndmask_b32 v205, v42, v43, s[40:41]
  v_cndmask_b32 v202, v100, v101, s[40:41]
  v_cndmask_b32 v203, v102, v103, s[40:41]
  v_cndmask_b32 v200, v36, v37, s[40:41]
  v_cndmask_b32 v201, v38, v39, s[40:41]
  v_cndmask_b32 v212, v214, v212, s[42:43]
  v_cndmask_b32 v213, v215, v213, s[80:81]
  v_cndmask_b32 v208, v210, v208, s[42:43]
  v_cndmask_b32 v209, v211, v209, s[80:81]
  v_cndmask_b32 v204, v206, v204, s[42:43]
  s_add_u32 s50, s71, 4
  s_and_b32 s50, s50, 7
  s_lshl_b32 s50, s50, 18
  s_add_u32 m0, s73, 65536
  s_nop 0
  buffer_load_dwordx4 v216, s[12:15], s50 offen offset:0 lds
  v_cndmask_b32 v205, v207, v205, s[80:81]
  v_cndmask_b32 v200, v202, v200, s[42:43]
  v_cndmask_b32 v201, v203, v201, s[80:81]
  v_mul_f32 v212, 0x3e8293ee, v212
  v_mul_f32 v213, 0x3e8293ee, v213
  v_mul_f32 v208, 0x3e8293ee, v208
  v_mul_f32 v209, 0x3e8293ee, v209
  v_mul_f32 v204, 0x3e8293ee, v204
  v_mul_f32 v205, 0x3e8293ee, v205
  v_mul_f32 v200, 0x3e8293ee, v200
  buffer_load_dwordx4 v217, s[12:15], s50 offen offset:1024 lds
  v_mul_f32 v201, 0x3e8293ee, v201
  v_cndmask_b32 v200, v200, v12, s[66:67]
  v_cndmask_b32 v201, v201, v12, s[68:69]
  v_max_f32 v214, v212, v213
  v_max_f32 v210, v208, v209
  v_max_f32 v206, v204, v205
  v_max_f32 v202, v200, v201
  v_mov_b32 v215, v214
  v_mov_b32 v211, v210
  v_mov_b32 v207, v206
  buffer_load_dwordx4 v218, s[12:15], s50 offen offset:2048 lds
  v_mov_b32 v203, v202
  v_permlane16_swap_b32 v214, v215
  v_permlane16_swap_b32 v210, v211
  v_permlane16_swap_b32 v206, v207
  v_permlane16_swap_b32 v202, v203
  v_max_f32 v214, v214, v215
  v_max_f32 v210, v210, v211
  v_max_f32 v206, v206, v207
  v_max_f32 v202, v202, v203
  v_mov_b32 v215, v214
  buffer_load_dwordx4 v219, s[12:15], s50 offen offset:3072 lds
  v_mov_b32 v211, v210
  v_mov_b32 v207, v206
  v_mov_b32 v203, v202
  v_permlane32_swap_b32 v214, v215
  v_permlane32_swap_b32 v210, v211
  v_permlane32_swap_b32 v206, v207
  v_permlane32_swap_b32 v202, v203
  v_max_f32 v214, v214, v215
  v_max_f32 v210, v210, v211
  v_max_f32 v206, v206, v207
  v_max_f32 v202, v202, v203
  v_sub_f32 v212, v212, v214
  v_sub_f32 v213, v213, v214
  v_sub_f32 v208, v208, v210
  v_sub_f32 v209, v209, v210
  v_sub_f32 v204, v204, v206
  v_sub_f32 v205, v205, v206
  v_sub_f32 v200, v200, v202
  v_sub_f32 v201, v201, v202
  v_exp_f32 v212, v212
  v_exp_f32 v213, v213
  v_exp_f32 v208, v208
  v_exp_f32 v209, v209
  v_exp_f32 v204, v204
  v_exp_f32 v205, v205
  v_exp_f32 v200, v200
  v_exp_f32 v201, v201
  v_add_f32 v214, v212, v213
  v_add_f32 v210, v208, v209
  v_add_f32 v206, v204, v205
  v_add_f32 v202, v200, v201
  v_mov_b32 v215, v214
  v_mov_b32 v211, v210
  v_mov_b32 v207, v206
  v_mov_b32 v203, v202
  v_permlane16_swap_b32 v214, v215
  v_permlane16_swap_b32 v210, v211
  v_permlane16_swap_b32 v206, v207
  v_permlane16_swap_b32 v202, v203
  v_add_f32 v214, v214, v215
  v_add_f32 v210, v210, v211
  v_add_f32 v206, v206, v207
  v_add_f32 v202, v202, v203
  v_mov_b32 v215, v214
  v_mov_b32 v211, v210
  v_mov_b32 v207, v206
  v_mov_b32 v203, v202
  v_permlane32_swap_b32 v214, v215
  v_permlane32_swap_b32 v210, v211
  v_permlane32_swap_b32 v206, v207
  v_permlane32_swap_b32 v202, v203
  v_add_f32 v214, v214, v215
  v_add_f32 v210, v210, v211
  v_add_f32 v206, v206, v207
  v_add_f32 v202, v202, v203
  v_rcp_f32 v214, v214
  v_rcp_f32 v210, v210
  v_rcp_f32 v206, v206
  v_rcp_f32 v202, v202
  v_mul_f32 v212, v212, v214
  v_mul_f32 v213, v213, v214
  v_mul_f32 v208, v208, v210
  v_mul_f32 v209, v209, v210
  v_mul_f32 v204, v204, v206
  v_mul_f32 v205, v205, v206
  v_mul_f32 v200, v200, v202
  v_mul_f32 v201, v201, v202
  v_cvt_pk_bf16_f32 v212, v212, v212
  v_cvt_pk_bf16_f32 v213, v213, v213
  v_cvt_pk_bf16_f32 v208, v208, v208
  v_cvt_pk_bf16_f32 v209, v209, v209
  v_cvt_pk_bf16_f32 v204, v204, v204
  v_cvt_pk_bf16_f32 v205, v205, v205
  v_cvt_pk_bf16_f32 v200, v200, v200
  v_cvt_pk_bf16_f32 v201, v201, v201
  v_and_b32 v48, v227, v212
  v_and_b32 v49, v228, v213
  v_and_b32 v50, v229, v212
  v_and_b32 v51, v230, v213
  v_and_b32 v44, v227, v208
  v_and_b32 v45, v228, v209
  v_and_b32 v46, v229, v208
  v_and_b32 v47, v230, v209
  v_and_b32 v40, v227, v204
  v_and_b32 v41, v228, v205
  v_and_b32 v42, v229, v204
  v_and_b32 v43, v230, v205
  v_and_b32 v36, v227, v200
  v_and_b32 v37, v228, v201
  v_and_b32 v38, v229, v200
  v_and_b32 v39, v230, v201
  s_waitcnt lgkmcnt(0)
  v_mfma_f32_16x16x32_bf16 v[32:35], v[58:61], v[48:51], 0
  v_mfma_f32_16x16x32_bf16 v[96:99], v[74:77], v[48:51], 0
  v_mfma_f32_16x16x32_bf16 v[28:31], v[56:59], v[44:47], 0
  v_mfma_f32_16x16x32_bf16 v[92:95], v[72:75], v[44:47], 0
  v_mfma_f32_16x16x32_bf16 v[24:27], v[54:57], v[40:43], 0
  v_mfma_f32_16x16x32_bf16 v[88:91], v[70:73], v[40:43], 0
  v_mfma_f32_16x16x32_bf16 v[20:23], v[52:55], v[36:39], 0
  v_mfma_f32_16x16x32_bf16 v[84:87], v[68:71], v[36:39], 0
  s_cmp_eq_u32 s58, 1
  s_cselect_b64 vcc, -1, 0
  v_cvt_pk_bf16_f32 v112, v32, v33
  v_cvt_pk_bf16_f32 v113, v34, v35
  v_cvt_pk_bf16_f32 v114, v96, v97
  v_cvt_pk_bf16_f32 v115, v98, v99
  v_cndmask_b32 v212, v112, v114, vcc
  v_cndmask_b32 v213, v113, v115, vcc
  v_cndmask_b32 v214, v114, v112, vcc
  v_cndmask_b32 v215, v115, v113, vcc
  buffer_store_dwordx4 v[212:215], v0, s[36:39], s75 offen offset:1024 sc1
  v_cvt_pk_bf16_f32 v108, v28, v29
  v_cvt_pk_bf16_f32 v109, v30, v31
  v_cvt_pk_bf16_f32 v110, v92, v93
  v_cvt_pk_bf16_f32 v111, v94, v95
  v_cndmask_b32 v208, v108, v110, vcc
  v_cndmask_b32 v209, v109, v111, vcc
  v_cndmask_b32 v210, v110, v108, vcc
  v_cndmask_b32 v211, v111, v109, vcc
  buffer_store_dwordx4 v[208:211], v0, s[36:39], s75 offen offset:0 sc1
  v_cvt_pk_bf16_f32 v104, v24, v25
  v_cvt_pk_bf16_f32 v105, v26, v27
  v_cvt_pk_bf16_f32 v106, v88, v89
  v_cvt_pk_bf16_f32 v107, v90, v91
  v_cndmask_b32 v204, v104, v106, vcc
  v_cndmask_b32 v205, v105, v107, vcc
  v_cndmask_b32 v206, v106, v104, vcc
  v_cndmask_b32 v207, v107, v105, vcc
  buffer_store_dwordx4 v[204:207], v0, s[36:39], s74 offen offset:1024 sc1
  v_cvt_pk_bf16_f32 v100, v20, v21
  v_cvt_pk_bf16_f32 v101, v22, v23
  v_cvt_pk_bf16_f32 v102, v84, v85
  v_cvt_pk_bf16_f32 v103, v86, v87
  v_cndmask_b32 v200, v100, v102, vcc
  v_cndmask_b32 v201, v101, v103, vcc
  v_cndmask_b32 v202, v102, v100, vcc
  v_cndmask_b32 v203, v103, v101, vcc
  buffer_store_dwordx4 v[200:203], v0, s[36:39], s74 offen offset:0 sc1
  v_mov_b32 v12, 1
  s_waitcnt vmcnt(0) lgkmcnt(0)
  s_barrier
  s_mov_b64 exec, 1
  buffer_store_dword v12, v0, s[36:39], s45 offen sc1
  s_mov_b64 exec, -1
CT5:
  v_lshlrev_b32 v28, 16, v156
  s_add_u32 s94, s92, CT5-k3_main_kernel+1536
  s_addc_u32 s95, s93, 0
  global_load_dword a252, v0, s[94:95]
  v_and_b32 v29, 0xffff0000, v156
  v_lshlrev_b32 v30, 16, v157
  v_and_b32 v31, 0xffff0000, v157
  v_mul_f32 v20, v188, v28
  v_mul_f32 v21, v188, v29
  v_mul_f32 v22, v188, v30
  s_add_u32 s94, s92, CT5-k3_main_kernel+5632
  s_addc_u32 s95, s93, 0
  global_load_dword a252, v0, s[94:95]
  v_mul_f32 v23, v188, v31
  v_lshlrev_b32 v28, 16, v158
  v_and_b32 v29, 0xffff0000, v158
  v_lshlrev_b32 v30, 16, v159
  v_and_b32 v31, 0xffff0000, v159
  v_mul_f32 v24, v188, v28
  s_add_u32 s94, s92, CT5-k3_main_kernel+9728
  s_addc_u32 s95, s93, 0
  global_load_dword a252, v0, s[94:95]
  v_mul_f32 v25, v188, v29
  v_mul_f32 v26, v188, v30
  v_mul_f32 v27, v188, v31
  v_lshlrev_b32 v28, 16, v160
  v_and_b32 v29, 0xffff0000, v160
  v_lshlrev_b32 v30, 16, v161
  s_add_u32 s50, s71, 5
  s_and_b32 s50, s50, 7
  s_lshl_b32 s50, s50, 18
  s_add_u32 m0, s73, 81920
  s_nop 0
  buffer_load_dwordx4 v216, s[12:15], s50 offen offset:0 lds
  v_and_b32 v31, 0xffff0000, v161
  v_fmac_f32 v20, v189, v28
  v_fmac_f32 v21, v189, v29
  v_fmac_f32 v22, v189, v30
  v_fmac_f32 v23, v189, v31
  v_lshlrev_b32 v28, 16, v162
  buffer_load_dwordx4 v217, s[12:15], s50 offen offset:1024 lds
  v_and_b32 v29, 0xffff0000, v162
  v_lshlrev_b32 v30, 16, v163
  v_and_b32 v31, 0xffff0000, v163
  v_fmac_f32 v24, v189, v28
  v_fmac_f32 v25, v189, v29
  v_fmac_f32 v26, v189, v30
  buffer_load_dwordx4 v218, s[12:15], s50 offen offset:2048 lds
  v_fmac_f32 v27, v189, v31
  v_lshlrev_b32 v28, 16, v164
  v_and_b32 v29, 0xffff0000, v164
  v_lshlrev_b32 v30, 16, v165
  v_and_b32 v31, 0xffff0000, v165
  v_fmac_f32 v20, v190, v28
  buffer_load_dwordx4 v219, s[12:15], s50 offen offset:3072 lds
  v_fmac_f32 v21, v190, v29
  v_fmac_f32 v22, v190, v30
  v_fmac_f32 v23, v190, v31
  v_lshlrev_b32 v28, 16, v166
  v_and_b32 v29, 0xffff0000, v166
  v_lshlrev_b32 v30, 16, v167
  s_add_u32 s50, s71, 6
  s_and_b32 s50, s50, 7
  s_lshl_b32 s50, s50, 18
  s_add_u32 m0, s73, 98304
  s_nop 0
  buffer_load_dwordx4 v216, s[12:15], s50 offen offset:0 lds
  v_and_b32 v31, 0xffff0000, v167
  v_fmac_f32 v24, v190, v28
  v_fmac_f32 v25, v190, v29
  v_fmac_f32 v26, v190, v30
  v_fmac_f32 v27, v190, v31
  v_lshlrev_b32 v28, 16, v168
  buffer_load_dwordx4 v217, s[12:15], s50 offen offset:1024 lds
  v_and_b32 v29, 0xffff0000, v168
  v_lshlrev_b32 v30, 16, v169
  v_and_b32 v31, 0xffff0000, v169
  v_fmac_f32 v20, v191, v28
  v_fmac_f32 v21, v191, v29
  v_fmac_f32 v22, v191, v30
  buffer_load_dwordx4 v218, s[12:15], s50 offen offset:2048 lds
  v_fmac_f32 v23, v191, v31
  v_lshlrev_b32 v28, 16, v170
  v_and_b32 v29, 0xffff0000, v170
  v_lshlrev_b32 v30, 16, v171
  v_and_b32 v31, 0xffff0000, v171
  v_fmac_f32 v24, v191, v28
  buffer_load_dwordx4 v219, s[12:15], s50 offen offset:3072 lds
  v_fmac_f32 v25, v191, v29
  v_fmac_f32 v26, v191, v30
  v_fmac_f32 v27, v191, v31
  v_lshlrev_b32 v28, 16, v172
  v_and_b32 v29, 0xffff0000, v172
  v_lshlrev_b32 v30, 16, v173
  s_add_u32 s50, s71, 7
  s_and_b32 s50, s50, 7
  s_lshl_b32 s50, s50, 18
  s_add_u32 m0, s73, 114688
  s_nop 0
  buffer_load_dwordx4 v216, s[12:15], s50 offen offset:0 lds
  v_and_b32 v31, 0xffff0000, v173
  v_fmac_f32 v20, v192, v28
  v_fmac_f32 v21, v192, v29
  v_fmac_f32 v22, v192, v30
  v_fmac_f32 v23, v192, v31
  v_lshlrev_b32 v28, 16, v174
  buffer_load_dwordx4 v217, s[12:15], s50 offen offset:1024 lds
  v_and_b32 v29, 0xffff0000, v174
  v_lshlrev_b32 v30, 16, v175
  v_and_b32 v31, 0xffff0000, v175
  v_fmac_f32 v24, v192, v28
  v_fmac_f32 v25, v192, v29
  v_fmac_f32 v26, v192, v30
  buffer_load_dwordx4 v218, s[12:15], s50 offen offset:2048 lds
  v_fmac_f32 v27, v192, v31
  v_lshlrev_b32 v28, 16, v176
  v_and_b32 v29, 0xffff0000, v176
  v_lshlrev_b32 v30, 16, v177
  v_and_b32 v31, 0xffff0000, v177
  v_fmac_f32 v20, v193, v28
  buffer_load_dwordx4 v219, s[12:15], s50 offen offset:3072 lds
  v_fmac_f32 v21, v193, v29
  v_fmac_f32 v22, v193, v30
  v_fmac_f32 v23, v193, v31
  v_lshlrev_b32 v28, 16, v178
  v_and_b32 v29, 0xffff0000, v178
  v_lshlrev_b32 v30, 16, v179
  s_add_u32 m0, s73, 131072
  s_nop 0
  buffer_load_dwordx4 v220, s[4:7], s72 offen offset:0 lds
  v_and_b32 v31, 0xffff0000, v179
  v_fmac_f32 v24, v193, v28
  v_fmac_f32 v25, v193, v29
  v_fmac_f32 v26, v193, v30
  v_fmac_f32 v27, v193, v31
  v_lshlrev_b32 v28, 16, v180
  buffer_load_dwordx4 v221, s[4:7], s72 offen offset:1024 lds
  v_and_b32 v29, 0xffff0000, v180
  v_lshlrev_b32 v30, 16, v181
  v_and_b32 v31, 0xffff0000, v181
  v_fmac_f32 v20, v194, v28
  v_fmac_f32 v21, v194, v29
  v_fmac_f32 v22, v194, v30
  s_add_u32 m0, s73, 133120
  s_add_u32 s48, s72, 32768
  buffer_load_dwordx4 v220, s[4:7], s48 offen offset:0 lds
  v_fmac_f32 v23, v194, v31
  v_lshlrev_b32 v28, 16, v182
  v_and_b32 v29, 0xffff0000, v182
  v_lshlrev_b32 v30, 16, v183
  v_and_b32 v31, 0xffff0000, v183
  v_fmac_f32 v24, v194, v28
  buffer_load_dwordx4 v221, s[4:7], s48 offen offset:1024 lds
  v_fmac_f32 v25, v194, v29
  v_fmac_f32 v26, v194, v30
  v_fmac_f32 v27, v194, v31
  v_lshlrev_b32 v28, 16, v184
  v_and_b32 v29, 0xffff0000, v184
  v_lshlrev_b32 v30, 16, v185
  v_and_b32 v31, 0xffff0000, v185
  v_fmac_f32 v20, v195, v28
  v_fmac_f32 v21, v195, v29
  v_fmac_f32 v22, v195, v30
  v_fmac_f32 v23, v195, v31
  v_lshlrev_b32 v28, 16, v186
  v_and_b32 v29, 0xffff0000, v186
  v_lshlrev_b32 v30, 16, v187
  v_and_b32 v31, 0xffff0000, v187
  v_fmac_f32 v24, v195, v28
  v_fmac_f32 v25, v195, v29
  v_fmac_f32 v26, v195, v30
  v_fmac_f32 v27, v195, v31
  s_nop 0
  v_permlane32_swap_b32 v20, v24
  v_permlane32_swap_b32 v21, v25
  v_permlane32_swap_b32 v22, v26
  v_permlane32_swap_b32 v23, v27
  v_add_f32 v20, v20, v24
  v_add_f32 v21, v21, v25
  v_add_f32 v22, v22, v26
  v_add_f32 v23, v23, v27
  s_nop 0
  v_permlane16_swap_b32 v20, v22
  v_permlane16_swap_b32 v21, v23
  v_add_f32 v20, v20, v22
  v_add_f32 v21, v21, v23
  v_add_u32 v196, 162816, v198
  v_add_f32_dpp v20, v20, v20 row_ror:8 row_mask:0xf bank_mask:0xf
  v_add_f32_dpp v21, v21, v21 row_ror:8 row_mask:0xf bank_mask:0xf
  ds_write_b64 v197, v[20:21]
  s_lshl_b32 s45, s2, 7
  s_add_u32 s45, s45, 5341184
  s_cmp_eq_u32 s44, 0
  s_cselect_b32 s45, s45, 1073741824
  s_waitcnt lgkmcnt(0)
  s_barrier
  ds_read_b32 v200, v196 offset:0
  ds_read_b32 v201, v196 offset:256
  ds_read_b32 v202, v196 offset:512
  ds_read_b32 v203, v196 offset:768
  s_cmp_eq_u32 s44, 1
  s_cselect_b32 s48, s53, 1073741824
  s_waitcnt lgkmcnt(0)
  v_add_f32 v200, v200, v201
  v_add_f32 v202, v202, v203
  v_add_f32 v200, v200, v202
  buffer_store_dword v200, v198, s[36:39], s48 offen sc1
  ds_read_b64_tr_b16 a[80:81], v231 offset:0
  ds_read_b64_tr_b16 a[82:83], v231 offset:2048
  ds_read_b64_tr_b16 a[84:85], v231 offset:4096
  ds_read_b64_tr_b16 a[86:87], v231 offset:6144
  ds_read_b64_tr_b16 a[88:89], v232 offset:0
  ds_read_b64_tr_b16 a[90:91], v232 offset:2048
  ds_read_b64_tr_b16 a[92:93], v232 offset:4096
  ds_read_b64_tr_b16 a[94:95], v232 offset:6144
  ds_read_b64_tr_b16 a[96:97], v233 offset:0
  ds_read_b64_tr_b16 a[98:99], v233 offset:2048
  ds_read_b64_tr_b16 a[100:101], v233 offset:4096
  ds_read_b64_tr_b16 a[102:103], v233 offset:6144
  ds_read_b64_tr_b16 a[104:105], v234 offset:0
  ds_read_b64_tr_b16 a[106:107], v234 offset:2048
  ds_read_b64_tr_b16 a[108:109], v234 offset:4096
  ds_read_b64_tr_b16 a[110:111], v234 offset:6144
  ds_read_b64_tr_b16 a[112:113], v231 offset:8192
  ds_read_b64_tr_b16 a[114:115], v231 offset:10240
  ds_read_b64_tr_b16 a[116:117], v231 offset:12288
  ds_read_b64_tr_b16 a[118:119], v231 offset:14336
  ds_read_b64_tr_b16 a[120:121], v232 offset:8192
  ds_read_b64_tr_b16 a[122:123], v232 offset:10240
  ds_read_b64_tr_b16 a[124:125], v232 offset:12288
  ds_read_b64_tr_b16 a[126:127], v232 offset:14336
  ds_read_b64_tr_b16 a[128:129], v233 offset:8192
  ds_read_b64_tr_b16 a[130:131], v233 offset:10240
  ds_read_b64_tr_b16 a[132:133], v233 offset:12288
  ds_read_b64_tr_b16 a[134:135], v233 offset:14336
  ds_read_b64_tr_b16 a[136:137], v234 offset:8192
  ds_read_b64_tr_b16 a[138:139], v234 offset:10240
  ds_read_b64_tr_b16 a[140:141], v234 offset:12288
  ds_read_b64_tr_b16 a[142:143], v234 offset:14336
  s_cmp_lg_u32 s44, 0
  s_cbranch_scc1 SM6x
  s_mov_b32 s46, 60000
  s_mov_b32 s47, 5275648
SM6:
  buffer_load_dword v13, v249, s[36:39], s47 offen sc1
  s_sub_u32 s46, s46, 1
  s_cmp_eq_u32 s46, 0
  s_waitcnt vmcnt(0)
  s_cbranch_scc1 SM6x
  v_cmp_ne_u32 vcc, 1, v13
  s_nop 4
  s_cbranch_vccnz SM6
SM6x:
  s_waitcnt vmcnt(1)
  s_barrier
  s_lshl_b32 s8, s71, 13
  buffer_load_dwordx4 a[0:3], v243, s[36:39], s8 offen offset:0 sc1
  buffer_load_dwordx4 a[8:11], v243, s[36:39], s8 offen offset:2048 sc1
  buffer_load_dwordx4 a[4:7], v243, s[36:39], s8 offen offset:1024 sc1
  buffer_load_dwordx4 a[12:15], v243, s[36:39], s8 offen offset:3072 sc1
  s_add_u32 s8, s8, 4096
  s_and_b32 s8, s8, 0xffff
  buffer_load_dwordx4 a[16:19], v243, s[36:39], s8 offen offset:0 sc1
  buffer_load_dwordx4 a[20:23], v243, s[36:39], s8 offen offset:1024 sc1
  buffer_load_dwordx4 a[24:27], v243, s[36:39], s8 offen offset:2048 sc1
  buffer_load_dwordx4 a[28:31], v243, s[36:39], s8 offen offset:3072 sc1
  ds_read_b64_tr_b16 a[144:145], v231 offset:16384
  ds_read_b64_tr_b16 a[146:147], v231 offset:18432
  ds_read_b64_tr_b16 a[148:149], v231 offset:20480
  ds_read_b64_tr_b16 a[150:151], v231 offset:22528
  ds_read_b64_tr_b16 a[152:153], v232 offset:16384
  ds_read_b64_tr_b16 a[154:155], v232 offset:18432
  ds_read_b64_tr_b16 a[156:157], v232 offset:20480
  ds_read_b64_tr_b16 a[158:159], v232 offset:22528
  ds_read_b64_tr_b16 a[160:161], v233 offset:16384
  ds_read_b64_tr_b16 a[162:163], v233 offset:18432
  ds_read_b64_tr_b16 a[164:165], v233 offset:20480
  ds_read_b64_tr_b16 a[166:167], v233 offset:22528
  ds_read_b64_tr_b16 a[168:169], v234 offset:16384
  ds_read_b64_tr_b16 a[170:171], v234 offset:18432
  ds_read_b64_tr_b16 a[172:173], v234 offset:20480
  ds_read_b64_tr_b16 a[174:175], v234 offset:22528
  ds_read_b64_tr_b16 a[176:177], v231 offset:24576
  ds_read_b64_tr_b16 a[178:179], v231 offset:26624
  ds_read_b64_tr_b16 a[180:181], v231 offset:28672
  ds_read_b64_tr_b16 a[182:183], v231 offset:30720
  ds_read_b64_tr_b16 a[184:185], v232 offset:24576
  ds_read_b64_tr_b16 a[186:187], v232 offset:26624
  ds_read_b64_tr_b16 a[188:189], v232 offset:28672
  ds_read_b64_tr_b16 a[190:191], v232 offset:30720
  ds_read_b64_tr_b16 a[192:193], v233 offset:24576
  ds_read_b64_tr_b16 a[194:195], v233 offset:26624
  ds_read_b64_tr_b16 a[196:197], v233 offset:28672
  ds_read_b64_tr_b16 a[198:199], v233 offset:30720
  ds_read_b64_tr_b16 a[200:201], v234 offset:24576
  ds_read_b64_tr_b16 a[202:203], v234 offset:26624
  ds_read_b64_tr_b16 a[204:205], v234 offset:28672
  ds_read_b64_tr_b16 a[206:207], v234 offset:30720
  ds_read_b64_tr_b16 a[208:209], v231 offset:32768
  ds_read_b64_tr_b16 a[210:211], v231 offset:34816
  ds_read_b64_tr_b16 a[212:213], v231 offset:36864
  ds_read_b64_tr_b16 a[214:215], v231 offset:38912
  ds_read_b64_tr_b16 a[216:217], v232 offset:32768
  ds_read_b64_tr_b16 a[218:219], v232 offset:34816
  ds_read_b64_tr_b16 a[220:221], v232 offset:36864
  ds_read_b64_tr_b16 a[222:223], v232 offset:38912
  ds_read_b64 v[116:117], v239 offset:0
  ds_read_b64 v[118:119], v240 offset:0
  ds_read_b64 v[120:121], v241 offset:0
  ds_read_b64 v[122:123], v242 offset:0
  ds_read_b64 v[124:125], v239 offset:2048
  ds_read_b64 v[126:127], v240 offset:2048
  ds_read_b64 v[128:129], v241 offset:2048
  ds_read_b64 v[130:131], v242 offset:2048
  v_lshrrev_b32 v13, 4, v10
  v_cmp_eq_u32 vcc, 2, v13
  s_add_u32 s9, s76, 4096
  s_nop 0
  v_cndmask_b32 v13, 0, 1.0, vcc
  s_waitcnt lgkmcnt(0)
  v_lshlrev_b32 v52, 16, v116
  v_and_b32 v53, 0xffff0000, v116
  v_lshlrev_b32 v54, 16, v117
  v_and_b32 v55, 0xffff0000, v117
  v_lshlrev_b32 v56, 16, v118
  v_and_b32 v57, 0xffff0000, v118
  v_lshlrev_b32 v58, 16, v119
  v_and_b32 v59, 0xffff0000, v119
  v_lshlrev_b32 v60, 16, v120
  v_and_b32 v61, 0xffff0000, v120
  v_lshlrev_b32 v62, 16, v121
  v_and_b32 v63, 0xffff0000, v121
  v_lshlrev_b32 v64, 16, v122
  v_and_b32 v65, 0xffff0000, v122
  v_lshlrev_b32 v66, 16, v123
  v_and_b32 v67, 0xffff0000, v123
  v_lshlrev_b32 v68, 16, v124
  v_and_b32 v69, 0xffff0000, v124
  v_lshlrev_b32 v70, 16, v125
  v_and_b32 v71, 0xffff0000, v125
  v_lshlrev_b32 v72, 16, v126
  v_and_b32 v73, 0xffff0000, v126
  v_lshlrev_b32 v74, 16, v127
  v_and_b32 v75, 0xffff0000, v127
  v_lshlrev_b32 v76, 16, v128
  v_and_b32 v77, 0xffff0000, v128
  v_lshlrev_b32 v78, 16, v129
  v_and_b32 v79, 0xffff0000, v129
  v_lshlrev_b32 v80, 16, v130
  v_and_b32 v81, 0xffff0000, v130
  v_lshlrev_b32 v82, 16, v131
  v_and_b32 v83, 0xffff0000, v131
  s_waitcnt vmcnt(7) lgkmcnt(15)
  v_mfma_f32_16x16x32_bf16 v[20:23], a[80:83], a[0:3], 0
  s_waitcnt vmcnt(6)
  s_add_u32 s8, s8, 4096
  s_and_b32 s8, s8, 0xffff
  v_mfma_f32_16x16x32_bf16 v[20:23], a[84:87], a[8:11], v[20:23]
  s_waitcnt vmcnt(4)
  buffer_load_dwordx4 a[32:35], v243, s[36:39], s8 offen offset:0 sc1
  v_mfma_f32_16x16x32_bf16 v[24:27], a[84:87], a[12:15], 0
  s_waitcnt vmcnt(6)
  buffer_load_dwordx4 a[36:39], v243, s[36:39], s8 offen offset:1024 sc1
  v_mfma_f32_16x16x32_bf16 v[24:27], a[80:83], a[4:7], v[24:27]
  s_waitcnt lgkmcnt(15)
  ds_read_b64_tr_b16 a[80:81], v233 offset:32768
  ds_read_b64_tr_b16 a[82:83], v233 offset:34816
  v_mfma_f32_16x16x32_bf16 v[32:35], a[88:91], a[4:7], 0
  ds_read_b64_tr_b16 a[84:85], v233 offset:36864
  ds_read_b64_tr_b16 a[86:87], v233 offset:38912
  v_mfma_f32_16x16x32_bf16 v[32:35], a[92:95], a[12:15], v[32:35]
  buffer_load_dwordx4 a[40:43], v243, s[36:39], s8 offen offset:2048 sc1
  v_mfma_f32_16x16x32_bf16 v[28:31], a[92:95], a[8:11], 0
  buffer_load_dwordx4 a[44:47], v243, s[36:39], s8 offen offset:3072 sc1
  v_mfma_f32_16x16x32_bf16 v[28:31], a[88:91], a[0:3], v[28:31]
  s_waitcnt lgkmcnt(15)
  s_add_u32 s8, s8, 4096
  s_and_b32 s8, s8, 0xffff
  v_mfma_f32_16x16x32_bf16 v[36:39], a[96:99], a[0:3], 0
  ds_read_b64_tr_b16 a[88:89], v234 offset:32768
  ds_read_b64_tr_b16 a[90:91], v234 offset:34816
  v_mfma_f32_16x16x32_bf16 v[36:39], a[100:103], a[8:11], v[36:39]
  ds_read_b64_tr_b16 a[92:93], v234 offset:36864
  buffer_load_dwordx4 a[48:51], v243, s[36:39], s8 offen offset:0 sc1
  v_mfma_f32_16x16x32_bf16 v[40:43], a[100:103], a[12:15], 0
  ds_read_b64_tr_b16 a[94:95], v234 offset:38912
  buffer_load_dwordx4 a[52:55], v243, s[36:39], s8 offen offset:1024 sc1
  v_mfma_f32_16x16x32_bf16 v[40:43], a[96:99], a[4:7], v[40:43]
  s_waitcnt lgkmcnt(15)
  ds_read_b64_tr_b16 a[96:97], v231 offset:40960
  ds_read_b64_tr_b16 a[98:99], v231 offset:43008
  v_mfma_f32_16x16x32_bf16 v[48:51], a[104:107], a[4:7], 0
  s_mov_b32 s49, 0
  buffer_load_dwordx4 a[56:59], v243, s[36:39], s8 offen offset:2048 sc1
  ds_read_b64_tr_b16 a[100:101], v231 offset:45056
  v_mfma_f32_16x16x32_bf16 v[48:51], a[108:111], a[12:15], v[48:51]
  buffer_load_dwordx4 v[156:159], v248, s[36:39], s49 offen sc1
  s_mov_b32 s49, 24576
  v_mfma_f32_16x16x32_bf16 v[44:47], a[108:111], a[8:11], 0
  buffer_load_dwordx4 v[160:163], v248, s[36:39], s49 offen sc1
  s_mov_b32 s49, 49152
  v_mfma_f32_16x16x32_bf16 v[44:47], a[104:107], a[0:3], v[44:47]
  s_waitcnt vmcnt(9) lgkmcnt(15)
  buffer_load_dwordx4 v[164:167], v248, s[36:39], s49 offen sc1
  s_mov_b32 s49, 73728
  v_mfma_f32_16x16x32_bf16 v[20:23], a[112:115], a[16:19], v[20:23]
  buffer_load_dwordx4 v[168:171], v248, s[36:39], s49 offen sc1
  buffer_load_dwordx4 a[60:63], v243, s[36:39], s8 offen offset:3072 sc1
  v_mfma_f32_16x16x32_bf16 v[20:23], a[116:119], a[24:27], v[20:23]
  s_add_u32 s8, s8, 4096
  ds_read_b64_tr_b16 a[102:103], v231 offset:47104
  s_and_b32 s8, s8, 0xffff
  v_mfma_f32_16x16x32_bf16 v[24:27], a[116:119], a[28:31], v[24:27]
  ds_read_b64_tr_b16 a[104:105], v232 offset:40960
  buffer_load_dwordx4 a[64:67], v243, s[36:39], s8 offen offset:0 sc1
  v_mfma_f32_16x16x32_bf16 v[24:27], a[112:115], a[20:23], v[24:27]
  s_waitcnt lgkmcnt(15)
  ds_read_b64_tr_b16 a[106:107], v232 offset:43008
  ds_read_b64_tr_b16 a[108:109], v232 offset:45056
  v_mfma_f32_16x16x32_bf16 v[32:35], a[120:123], a[20:23], v[32:35]
  buffer_load_dwordx4 a[68:71], v243, s[36:39], s8 offen offset:1024 sc1
  ds_read_b64_tr_b16 a[110:111], v232 offset:47104
  v_mfma_f32_16x16x32_bf16 v[32:35], a[124:127], a[28:31], v[32:35]
  buffer_load_dwordx4 a[72:75], v243, s[36:39], s8 offen offset:2048 sc1
  ds_read_b64_tr_b16 a[112:113], v233 offset:40960
  v_mfma_f32_16x16x32_bf16 v[28:31], a[124:127], a[24:27], v[28:31]
  ds_read_b64_tr_b16 a[114:115], v233 offset:43008
  buffer_load_dwordx4 a[76:79], v243, s[36:39], s8 offen offset:3072 sc1
  v_mfma_f32_16x16x32_bf16 v[28:31], a[120:123], a[16:19], v[28:31]
  s_waitcnt lgkmcnt(15)
  s_add_u32 s8, s8, 4096
  s_and_b32 s8, s8, 0xffff
  v_mfma_f32_16x16x32_bf16 v[36:39], a[128:131], a[16:19], v[36:39]
  ds_read_b64_tr_b16 a[116:117], v233 offset:45056
  buffer_load_dwordx4 a[0:3], v243, s[36:39], s8 offen offset:0 sc1
  v_mfma_f32_16x16x32_bf16 v[36:39], a[132:135], a[24:27], v[36:39]
  ds_read_b64_tr_b16 a[118:119], v233 offset:47104
  ds_read_b64_tr_b16 a[120:121], v234 offset:40960
  v_mfma_f32_16x16x32_bf16 v[40:43], a[132:135], a[28:31], v[40:43]
  buffer_load_dwordx4 a[4:7], v243, s[36:39], s8 offen offset:1024 sc1
  ds_read_b64_tr_b16 a[122:123], v234 offset:43008
  v_mfma_f32_16x16x32_bf16 v[40:43], a[128:131], a[20:23], v[40:43]
  s_waitcnt lgkmcnt(15)
  v_mfma_f32_16x16x32_bf16 v[48:51], a[136:139], a[20:23], v[48:51]
  buffer_load_dwordx4 a[8:11], v243, s[36:39], s8 offen offset:2048 sc1
  ds_read_b64_tr_b16 a[124:125], v234 offset:45056
  v_mfma_f32_16x16x32_bf16 v[48:51], a[140:143], a[28:31], v[48:51]
  ds_read_b64_tr_b16 a[126:127], v234 offset:47104
  v_mfma_f32_16x16x32_bf16 v[44:47], a[140:143], a[24:27], v[44:47]
  buffer_load_dwordx4 a[12:15], v243, s[36:39], s8 offen offset:3072 sc1
  ds_read_b64_tr_b16 a[128:129], v231 offset:49152
  v_mfma_f32_16x16x32_bf16 v[44:47], a[136:139], a[16:19], v[44:47]
  s_waitcnt vmcnt(16) lgkmcnt(15)
  v_mfma_f32_16x16x32_bf16 v[20:23], a[144:147], a[32:35], v[20:23]
  s_add_u32 s8, s8, 4096
  s_and_b32 s8, s8, 0xffff
  ds_read_b64_tr_b16 a[130:131], v231 offset:51200
  v_mfma_f32_16x16x32_bf16 v[20:23], a[148:151], a[40:43], v[20:23]
  buffer_load_dwordx4 a[16:19], v243, s[36:39], s8 offen offset:0 sc1
  ds_read_b64_tr_b16 a[132:133], v231 offset:53248
  v_mfma_f32_16x16x32_bf16 v[24:27], a[148:151], a[44:47], v[24:27]
  ds_read_b64_tr_b16 a[134:135], v231 offset:55296
  v_mfma_f32_16x16x32_bf16 v[24:27], a[144:147], a[36:39], v[24:27]
  s_waitcnt lgkmcnt(15)
  ds_read_b64_tr_b16 a[136:137], v232 offset:49152
  v_mfma_f32_16x16x32_bf16 v[32:35], a[152:155], a[36:39], v[32:35]
  v_mfma_f32_16x16x32_bf16 v[32:35], a[156:159], a[44:47], v[32:35]
  buffer_load_dwordx4 a[20:23], v243, s[36:39], s8 offen offset:1024 sc1
  ds_read_b64_tr_b16 a[138:139], v232 offset:51200
  v_mfma_f32_16x16x32_bf16 v[28:31], a[156:159], a[40:43], v[28:31]
  ds_read_b64_tr_b16 a[140:141], v232 offset:53248
  v_mfma_f32_16x16x32_bf16 v[28:31], a[152:155], a[32:35], v[28:31]
  s_waitcnt lgkmcnt(15)
  ds_read_b64_tr_b16 a[142:143], v232 offset:55296
  v_mfma_f32_16x16x32_bf16 v[36:39], a[160:163], a[32:35], v[36:39]
  v_mfma_f32_16x16x32_bf16 v[36:39], a[164:167], a[40:43], v[36:39]
  buffer_load_dwordx4 a[24:27], v243, s[36:39], s8 offen offset:2048 sc1
  ds_read_b64_tr_b16 a[144:145], v233 offset:49152
  v_mfma_f32_16x16x32_bf16 v[40:43], a[164:167], a[44:47], v[40:43]
  ds_read_b64_tr_b16 a[146:147], v233 offset:51200
  v_mfma_f32_16x16x32_bf16 v[40:43], a[160:163], a[36:39], v[40:43]
  s_waitcnt lgkmcnt(15)
  ds_read_b64_tr_b16 a[148:149], v233 offset:53248
  v_mfma_f32_16x16x32_bf16 v[48:51], a[168:171], a[36:39], v[48:51]
  ds_read_b64_tr_b16 a[150:151], v233 offset:55296
  v_mfma_f32_16x16x32_bf16 v[48:51], a[172:175], a[44:47], v[48:51]
  buffer_load_dwordx4 a[28:31], v243, s[36:39], s8 offen offset:3072 sc1
  v_mfma_f32_16x16x32_bf16 v[44:47], a[172:175], a[40:43], v[44:47]
  ds_read_b64_tr_b16 a[152:153], v234 offset:49152
  v_mfma_f32_16x16x32_bf16 v[44:47], a[168:171], a[32:35], v[44:47]
  s_waitcnt vmcnt(12) lgkmcnt(15)
  ds_read_b64_tr_b16 a[154:155], v234 offset:51200
  v_mfma_f32_16x16x32_bf16 v[20:23], a[176:179], a[48:51], v[20:23]
  s_add_u32 s8, s8, 4096
  s_and_b32 s8, s8, 0xffff
  ds_read_b64_tr_b16 a[156:157], v234 offset:53248
  v_mfma_f32_16x16x32_bf16 v[20:23], a[180:183], a[56:59], v[20:23]
  buffer_load_dwordx4 a[32:35], v243, s[36:39], s8 offen offset:0 sc1
  v_mfma_f32_16x16x32_bf16 v[24:27], a[180:183], a[60:63], v[24:27]
  ds_read_b64_tr_b16 a[158:159], v234 offset:55296
  v_mfma_f32_16x16x32_bf16 v[24:27], a[176:179], a[52:55], v[24:27]
  s_waitcnt lgkmcnt(15)
  ds_read_b64_tr_b16 a[160:161], v231 offset:57344
  v_mfma_f32_16x16x32_bf16 v[32:35], a[184:187], a[52:55], v[32:35]
  ds_read_b64_tr_b16 a[162:163], v231 offset:59392
  v_mfma_f32_16x16x32_bf16 v[32:35], a[188:191], a[60:63], v[32:35]
  buffer_load_dwordx4 a[36:39], v243, s[36:39], s8 offen offset:1024 sc1
  ds_read_b64_tr_b16 a[164:165], v231 offset:61440
  v_mfma_f32_16x16x32_bf16 v[28:31], a[188:191], a[56:59], v[28:31]
  v_mfma_f32_16x16x32_bf16 v[28:31], a[184:187], a[48:51], v[28:31]
  s_waitcnt lgkmcnt(15)
  ds_read_b64_tr_b16 a[166:167], v231 offset:63488
  v_mfma_f32_16x16x32_bf16 v[36:39], a[192:195], a[48:51], v[36:39]
  ds_read_b64_tr_b16 a[168:169], v232 offset:57344
  v_mfma_f32_16x16x32_bf16 v[36:39], a[196:199], a[56:59], v[36:39]
  buffer_load_dwordx4 a[40:43], v243, s[36:39], s8 offen offset:2048 sc1
  ds_read_b64_tr_b16 a[170:171], v232 offset:59392
  v_mfma_f32_16x16x32_bf16 v[40:43], a[196:199], a[60:63], v[40:43]
  v_mfma_f32_16x16x32_bf16 v[40:43], a[192:195], a[52:55], v[40:43]
  s_waitcnt lgkmcnt(15)
  ds_read_b64_tr_b16 a[172:173], v232 offset:61440
  v_mfma_f32_16x16x32_bf16 v[48:51], a[200:203], a[52:55], v[48:51]
  ds_read_b64_tr_b16 a[174:175], v232 offset:63488
  v_mfma_f32_16x16x32_bf16 v[48:51], a[204:207], a[60:63], v[48:51]
  buffer_load_dwordx4 a[44:47], v243, s[36:39], s8 offen offset:3072 sc1
  ds_read_b64_tr_b16 a[176:177], v233 offset:57344
  v_mfma_f32_16x16x32_bf16 v[44:47], a[204:207], a[56:59], v[44:47]
  ds_read_b64_tr_b16 a[178:179], v233 offset:59392
  v_mfma_f32_16x16x32_bf16 v[44:47], a[200:203], a[48:51], v[44:47]
  s_waitcnt vmcnt(12) lgkmcnt(15)
  v_mfma_f32_16x16x32_bf16 v[20:23], a[208:211], a[64:67], v[20:23]
  s_add_u32 s8, s8, 4096
  s_and_b32 s8, s8, 0xffff
  ds_read_b64_tr_b16 a[180:181], v233 offset:61440
  v_mfma_f32_16x16x32_bf16 v[20:23], a[212:215], a[72:75], v[20:23]
  buffer_load_dwordx4 a[48:51], v243, s[36:39], s8 offen offset:0 sc1
  ds_read_b64_tr_b16 a[182:183], v233 offset:63488
  v_mfma_f32_16x16x32_bf16 v[24:27], a[212:215], a[76:79], v[24:27]
  ds_read_b64_tr_b16 a[184:185], v234 offset:57344
  v_mfma_f32_16x16x32_bf16 v[24:27], a[208:211], a[68:71], v[24:27]
  s_waitcnt lgkmcnt(15)
  ds_read_b64_tr_b16 a[186:187], v234 offset:59392
  v_mfma_f32_16x16x32_bf16 v[32:35], a[216:219], a[68:71], v[32:35]
  v_mfma_f32_16x16x32_bf16 v[32:35], a[220:223], a[76:79], v[32:35]
  buffer_load_dwordx4 a[52:55], v243, s[36:39], s8 offen offset:1024 sc1
  ds_read_b64_tr_b16 a[188:189], v234 offset:61440
  v_mfma_f32_16x16x32_bf16 v[28:31], a[220:223], a[72:75], v[28:31]
  ds_read_b64_tr_b16 a[190:191], v234 offset:63488
  v_mfma_f32_16x16x32_bf16 v[28:31], a[216:219], a[64:67], v[28:31]
  s_waitcnt lgkmcnt(15)
  ds_read_b64_tr_b16 a[192:193], v235 offset:0
  v_mfma_f32_16x16x32_bf16 v[36:39], a[80:83], a[64:67], v[36:39]
  v_mfma_f32_16x16x32_bf16 v[36:39], a[84:87], a[72:75], v[36:39]
  buffer_load_dwordx4 a[56:59], v243, s[36:39], s8 offen offset:2048 sc1
  ds_read_b64_tr_b16 a[194:195], v235 offset:2048
  v_mfma_f32_16x16x32_bf16 v[40:43], a[84:87], a[76:79], v[40:43]
  ds_read_b64_tr_b16 a[196:197], v235 offset:4096
  v_mfma_f32_16x16x32_bf16 v[40:43], a[80:83], a[68:71], v[40:43]
  s_waitcnt lgkmcnt(15)
  ds_read_b64_tr_b16 a[198:199], v235 offset:6144
  v_mfma_f32_16x16x32_bf16 v[48:51], a[88:91], a[68:71], v[48:51]
  ds_read_b64_tr_b16 a[200:201], v236 offset:0
  v_mfma_f32_16x16x32_bf16 v[48:51], a[92:95], a[76:79], v[48:51]
  buffer_load_dwordx4 a[60:63], v243, s[36:39], s8 offen offset:3072 sc1
  v_mfma_f32_16x16x32_bf16 v[44:47], a[92:95], a[72:75], v[44:47]
  ds_read_b64_tr_b16 a[202:203], v236 offset:2048
  v_mfma_f32_16x16x32_bf16 v[44:47], a[88:91], a[64:67], v[44:47]
  s_waitcnt vmcnt(12) lgkmcnt(15)
  ds_read_b64_tr_b16 a[204:205], v236 offset:4096
  v_mfma_f32_16x16x32_bf16 v[20:23], a[96:99], a[0:3], v[20:23]
  s_add_u32 s8, s8, 4096
  s_and_b32 s8, s8, 0xffff
  ds_read_b64_tr_b16 a[206:207], v236 offset:6144
  v_mfma_f32_16x16x32_bf16 v[20:23], a[100:103], a[8:11], v[20:23]
  buffer_load_dwordx4 a[64:67], v243, s[36:39], s8 offen offset:0 sc1
  v_mfma_f32_16x16x32_bf16 v[24:27], a[100:103], a[12:15], v[24:27]
  ds_read_b64_tr_b16 a[208:209], v237 offset:0
  v_mfma_f32_16x16x32_bf16 v[24:27], a[96:99], a[4:7], v[24:27]
  s_waitcnt lgkmcnt(15)
  ds_read_b64_tr_b16 a[210:211], v237 offset:2048
  v_mfma_f32_16x16x32_bf16 v[32:35], a[104:107], a[4:7], v[32:35]
  ds_read_b64_tr_b16 a[212:213], v237 offset:4096
  v_mfma_f32_16x16x32_bf16 v[32:35], a[108:111], a[12:15], v[32:35]
  buffer_load_dwordx4 a[68:71], v243, s[36:39], s8 offen offset:1024 sc1
  ds_read_b64_tr_b16 a[214:215], v237 offset:6144
  v_mfma_f32_16x16x32_bf16 v[28:31], a[108:111], a[8:11], v[28:31]
  v_mfma_f32_16x16x32_bf16 v[28:31], a[104:107], a[0:3], v[28:31]
  s_waitcnt lgkmcnt(15)
  ds_read_b64_tr_b16 a[216:217], v238 offset:0
  v_mfma_f32_16x16x32_bf16 v[36:39], a[112:115], a[0:3], v[36:39]
  s_waitcnt vmcnt(23)
  ds_read_b64_tr_b16 a[218:219], v238 offset:2048
  v_max_u32 v15, v156, v157
  v_mfma_f32_16x16x32_bf16 v[36:39], a[116:119], a[8:11], v[36:39]
  buffer_load_dwordx4 a[72:75], v243, s[36:39], s8 offen offset:2048 sc1
  ds_read_b64_tr_b16 a[220:221], v238 offset:4096
  v_mfma_f32_16x16x32_bf16 v[40:43], a[116:119], a[12:15], v[40:43]
  v_max3_u32 v15, v15, v158, v159
  v_max3_u32 v15, v15, v160, v161
  v_mfma_f32_16x16x32_bf16 v[40:43], a[112:115], a[4:7], v[40:43]
  s_waitcnt lgkmcnt(15)
  ds_read_b64_tr_b16 a[222:223], v238 offset:6144
  v_max3_u32 v15, v15, v162, v163
  v_mfma_f32_16x16x32_bf16 v[48:51], a[120:123], a[4:7], v[48:51]
  ds_read_b64_tr_b16 a[80:81], v235 offset:8192
  v_max3_u32 v15, v15, v164, v165
  v_mfma_f32_16x16x32_bf16 v[48:51], a[124:127], a[12:15], v[48:51]
  buffer_load_dwordx4 a[76:79], v243, s[36:39], s8 offen offset:3072 sc1
  ds_read_b64_tr_b16 a[82:83], v235 offset:10240
  v_mfma_f32_16x16x32_bf16 v[44:47], a[124:127], a[8:11], v[44:47]
  ds_read_b64_tr_b16 a[84:85], v235 offset:12288
  v_max3_u32 v15, v15, v166, v167
  v_mfma_f32_16x16x32_bf16 v[44:47], a[120:123], a[0:3], v[44:47]
  s_waitcnt vmcnt(12) lgkmcnt(15)
  v_max3_u32 v15, v15, v168, v169
  v_max3_u32 v15, v15, v170, v171
  v_mfma_f32_16x16x32_bf16 v[20:23], a[128:131], a[16:19], v[20:23]
  s_add_u32 s8, s8, 4096
  s_and_b32 s8, s8, 0xffff
  ds_read_b64_tr_b16 a[86:87], v235 offset:14336
  v_mfma_f32_16x16x32_bf16 v[20:23], a[132:135], a[24:27], v[20:23]
  buffer_load_dwordx4 a[0:3], v243, s[36:39], s8 offen offset:0 sc1
  ds_read_b64_tr_b16 a[88:89], v236 offset:8192
  v_mfma_f32_16x16x32_bf16 v[24:27], a[132:135], a[28:31], v[24:27]
  ds_read_b64_tr_b16 a[90:91], v236 offset:10240
  v_mfma_f32_16x16x32_bf16 v[24:27], a[128:131], a[20:23], v[24:27]
  s_waitcnt lgkmcnt(15)
  v_cmp_eq_u32 vcc, -1, v15
  s_nop 4
  s_cbranch_vccnz CK7s
CK7x:
  v_mfma_f32_16x16x32_bf16 v[32:35], a[136:139], a[20:23], v[32:35]
  ds_read_b64_tr_b16 a[92:93], v236 offset:12288
  v_add_f32 v156, v156, v164
  v_mfma_f32_16x16x32_bf16 v[32:35], a[140:143], a[28:31], v[32:35]
  buffer_load_dwordx4 a[4:7], v243, s[36:39], s8 offen offset:1024 sc1
  ds_read_b64_tr_b16 a[94:95], v236 offset:14336
  v_mfma_f32_16x16x32_bf16 v[28:31], a[140:143], a[24:27], v[28:31]
  ds_read_b64_tr_b16 a[96:97], v237 offset:8192
  v_add_f32 v157, v157, v165
  v_mfma_f32_16x16x32_bf16 v[28:31], a[136:139], a[16:19], v[28:31]
  s_waitcnt lgkmcnt(15)
  ds_read_b64_tr_b16 a[98:99], v237 offset:10240
  v_add_f32 v158, v158, v166
  v_mfma_f32_16x16x32_bf16 v[36:39], a[144:147], a[16:19], v[36:39]
  v_add_f32 v159, v159, v167
  v_add_f32 v160, v160, v168
  v_mfma_f32_16x16x32_bf16 v[36:39], a[148:151], a[24:27], v[36:39]
  buffer_load_dwordx4 a[8:11], v243, s[36:39], s8 offen offset:2048 sc1
  ds_read_b64_tr_b16 a[100:101], v237 offset:12288
  v_mfma_f32_16x16x32_bf16 v[40:43], a[148:151], a[28:31], v[40:43]
  ds_read_b64_tr_b16 a[102:103], v237 offset:14336
  v_add_f32 v161, v161, v169
  v_mfma_f32_16x16x32_bf16 v[40:43], a[144:147], a[20:23], v[40:43]
  s_waitcnt lgkmcnt(15)
  ds_read_b64_tr_b16 a[104:105], v238 offset:8192
  v_add_f32 v162, v162, v170
  v_mfma_f32_16x16x32_bf16 v[48:51], a[152:155], a[20:23], v[48:51]
  v_add_f32 v163, v163, v171
  v_add_f32 v156, v156, v160
  v_mfma_f32_16x16x32_bf16 v[48:51], a[156:159], a[28:31], v[48:51]
  buffer_load_dwordx4 a[12:15], v243, s[36:39], s8 offen offset:3072 sc1
  ds_read_b64_tr_b16 a[106:107], v238 offset:10240
  v_mfma_f32_16x16x32_bf16 v[44:47], a[156:159], a[24:27], v[44:47]
  ds_read_b64_tr_b16 a[108:109], v238 offset:12288
  v_add_f32 v157, v157, v161
  v_mfma_f32_16x16x32_bf16 v[44:47], a[152:155], a[16:19], v[44:47]
  s_waitcnt vmcnt(12) lgkmcnt(15)
  ds_read_b64_tr_b16 a[110:111], v238 offset:14336
  v_add_f32 v158, v158, v162
  v_mfma_f32_16x16x32_bf16 v[20:23], a[160:163], a[32:35], v[20:23]
  s_add_u32 s8, s8, 4096
  s_and_b32 s8, s8, 0xffff
  ds_read_b64_tr_b16 a[112:113], v235 offset:16384
  v_mfma_f32_16x16x32_bf16 v[20:23], a[164:167], a[40:43], v[20:23]
  buffer_load_dwordx4 a[16:19], v243, s[36:39], s8 offen offset:0 sc1
  v_add_f32 v159, v159, v163
  v_mfma_f32_16x16x32_bf16 v[24:27], a[164:167], a[44:47], v[24:27]
  ds_read_b64_tr_b16 a[114:115], v235 offset:18432
  v_cvt_pk_bf16_f32 v160, v156, v157
  v_mfma_f32_16x16x32_bf16 v[24:27], a[160:163], a[36:39], v[24:27]
  s_waitcnt lgkmcnt(15)
  ds_read_b64_tr_b16 a[116:117], v235 offset:20480
  v_lshlrev_b32 v156, 16, v160
  v_mfma_f32_16x16x32_bf16 v[32:35], a[168:171], a[36:39], v[32:35]
  ds_read_b64_tr_b16 a[118:119], v235 offset:22528
  v_and_b32 v157, 0xffff0000, v160
  v_mfma_f32_16x16x32_bf16 v[32:35], a[172:175], a[44:47], v[32:35]
  buffer_load_dwordx4 a[20:23], v243, s[36:39], s8 offen offset:1024 sc1
  v_cvt_pk_bf16_f32 v161, v158, v159
  v_mfma_f32_16x16x32_bf16 v[28:31], a[172:175], a[40:43], v[28:31]
  ds_read_b64_tr_b16 a[120:121], v236 offset:16384
  v_lshlrev_b32 v158, 16, v161
  v_mfma_f32_16x16x32_bf16 v[28:31], a[168:171], a[32:35], v[28:31]
  s_waitcnt lgkmcnt(15)
  ds_read_b64_tr_b16 a[122:123], v236 offset:18432
  v_and_b32 v159, 0xffff0000, v161
  v_mfma_f32_16x16x32_bf16 v[36:39], a[176:179], a[32:35], v[36:39]
  ds_read_b64_tr_b16 a[124:125], v236 offset:20480
  v_add_f32 v156, v13, v156
  v_mfma_f32_16x16x32_bf16 v[36:39], a[180:183], a[40:43], v[36:39]
  buffer_load_dwordx4 a[24:27], v243, s[36:39], s8 offen offset:2048 sc1
  ds_read_b64_tr_b16 a[126:127], v236 offset:22528
  v_mfma_f32_16x16x32_bf16 v[40:43], a[180:183], a[44:47], v[40:43]
  v_add_f32 v157, v13, v157
  v_add_f32 v158, v13, v158
  v_mfma_f32_16x16x32_bf16 v[40:43], a[176:179], a[36:39], v[40:43]
  s_waitcnt lgkmcnt(15)
  ds_read_b64_tr_b16 a[128:129], v237 offset:16384
  v_add_f32 v159, v13, v159
  v_mfma_f32_16x16x32_bf16 v[48:51], a[184:187], a[36:39], v[48:51]
  ds_read_b64_tr_b16 a[130:131], v237 offset:18432
  v_cvt_pk_bf16_f32 v160, v156, v157
  v_mfma_f32_16x16x32_bf16 v[48:51], a[188:191], a[44:47], v[48:51]
  buffer_load_dwordx4 a[28:31], v243, s[36:39], s8 offen offset:3072 sc1
  ds_read_b64_tr_b16 a[132:133], v237 offset:20480
  v_mfma_f32_16x16x32_bf16 v[44:47], a[188:191], a[40:43], v[44:47]
  ds_read_b64_tr_b16 a[134:135], v237 offset:22528
  v_lshlrev_b32 v156, 16, v160
  v_mfma_f32_16x16x32_bf16 v[44:47], a[184:187], a[32:35], v[44:47]
  s_waitcnt vmcnt(12) lgkmcnt(15)
  v_and_b32 v157, 0xffff0000, v160
  v_cvt_pk_bf16_f32 v161, v158, v159
  v_mfma_f32_16x16x32_bf16 v[20:23], a[192:195], a[48:51], v[20:23]
  s_add_u32 s8, s8, 4096
  s_and_b32 s8, s8, 0xffff
  ds_read_b64_tr_b16 a[136:137], v238 offset:16384
  v_mfma_f32_16x16x32_bf16 v[20:23], a[196:199], a[56:59], v[20:23]
  buffer_load_dwordx4 a[32:35], v243, s[36:39], s8 offen offset:0 sc1
  ds_read_b64_tr_b16 a[138:139], v238 offset:18432
  v_mfma_f32_16x16x32_bf16 v[24:27], a[196:199], a[60:63], v[24:27]
  ds_read_b64_tr_b16 a[140:141], v238 offset:20480
  v_lshlrev_b32 v158, 16, v161
  v_mfma_f32_16x16x32_bf16 v[24:27], a[192:195], a[52:55], v[24:27]
  s_waitcnt lgkmcnt(15)
  v_and_b32 v159, 0xffff0000, v161
  v_mfma_f32_16x16x32_bf16 v[32:35], a[200:203], a[52:55], v[32:35]
  ds_write_b128 v246, v[156:159]
  ds_read_b128 v[84:87], v244 offset:0
  v_mfma_f32_16x16x32_bf16 v[32:35], a[204:207], a[60:63], v[32:35]
  ds_read_b128 v[100:103], v244 offset:512
  ds_read_b128 v[88:91], v244 offset:64
  v_mfma_f32_16x16x32_bf16 v[28:31], a[204:207], a[56:59], v[28:31]
  ds_read_b128 v[104:107], v244 offset:576
  ds_read_b128 v[92:95], v244 offset:128
  v_mfma_f32_16x16x32_bf16 v[28:31], a[200:203], a[48:51], v[28:31]
  s_waitcnt lgkmcnt(15)
  ds_read_b128 v[108:111], v244 offset:640
  ds_read_b128 v[96:99], v244 offset:192
  v_mfma_f32_16x16x32_bf16 v[36:39], a[208:211], a[48:51], v[36:39]
  ds_read_b128 v[112:115], v244 offset:704
  ds_read_b128 v[116:119], v245 offset:512
  v_mfma_f32_16x16x32_bf16 v[36:39], a[212:215], a[56:59], v[36:39]
  ds_read_b128 v[120:123], v245 offset:576
  ds_read_b128 v[124:127], v245 offset:640
  v_mfma_f32_16x16x32_bf16 v[40:43], a[212:215], a[60:63], v[40:43]
  ds_read_b128 v[128:131], v245 offset:704
  ds_read_b64_tr_b16 a[142:143], v238 offset:22528
  v_mfma_f32_16x16x32_bf16 v[40:43], a[208:211], a[52:55], v[40:43]
  s_waitcnt lgkmcnt(15)
  buffer_load_dwordx4 a[36:39], v243, s[36:39], s8 offen offset:1024 sc1
  ds_read_b64_tr_b16 a[144:145], v235 offset:24576
  v_mfma_f32_16x16x32_bf16 v[48:51], a[216:219], a[52:55], v[48:51]
  ds_read_b64_tr_b16 a[146:147], v235 offset:26624
  ds_read_b64_tr_b16 a[148:149], v235 offset:28672
  v_mfma_f32_16x16x32_bf16 v[48:51], a[220:223], a[60:63], v[48:51]
  buffer_load_dwordx4 a[40:43], v243, s[36:39], s8 offen offset:2048 sc1
  ds_read_b64_tr_b16 a[150:151], v235 offset:30720
  v_mfma_f32_16x16x32_bf16 v[44:47], a[220:223], a[56:59], v[44:47]
  ds_read_b64_tr_b16 a[152:153], v236 offset:24576
  ds_read_b64_tr_b16 a[154:155], v236 offset:26624
  v_mfma_f32_16x16x32_bf16 v[44:47], a[216:219], a[48:51], v[44:47]
  s_waitcnt vmcnt(11) lgkmcnt(15)
  buffer_load_dwordx4 a[44:47], v243, s[36:39], s8 offen offset:3072 sc1
  ds_read_b64_tr_b16 a[156:157], v236 offset:28672
  v_mfma_f32_16x16x32_bf16 v[20:23], a[80:83], a[64:67], v[20:23]
  s_add_u32 s8, s8, 4096
  ds_read_b64_tr_b16 a[158:159], v236 offset:30720
  ds_read_b64_tr_b16 a[160:161], v237 offset:24576
  v_mfma_f32_16x16x32_bf16 v[20:23], a[84:87], a[72:75], v[20:23]
  s_and_b32 s8, s8, 0xffff
  ds_read_b64_tr_b16 a[162:163], v237 offset:26624
  buffer_load_dwordx4 a[48:51], v243, s[36:39], s8 offen offset:0 sc1
  v_mfma_f32_16x16x32_bf16 v[24:27], a[84:87], a[76:79], v[24:27]
  ds_read_b64_tr_b16 a[164:165], v237 offset:28672
  v_accvgpr_write_b32 a248, v156
  v_mfma_f32_16x16x32_bf16 v[24:27], a[80:83], a[68:71], v[24:27]
  s_waitcnt lgkmcnt(15)
  ds_read_b64_tr_b16 a[166:167], v237 offset:30720
  v_accvgpr_write_b32 a249, v157
  v_mfma_f32_16x16x32_bf16 v[32:35], a[88:91], a[68:71], v[32:35]
  ds_read_b64_tr_b16 a[168:169], v238 offset:24576
  v_accvgpr_write_b32 a250, v158
  v_mfma_f32_16x16x32_bf16 v[32:35], a[92:95], a[76:79], v[32:35]
  buffer_load_dwordx4 a[52:55], v243, s[36:39], s8 offen offset:1024 sc1
  v_accvgpr_write_b32 a251, v159
  v_mfma_f32_16x16x32_bf16 v[28:31], a[92:95], a[72:75], v[28:31]
  s_waitcnt lgkmcnt(14)
  ds_read_b64_tr_b16 a[170:171], v238 offset:26624
  v_cvt_pk_bf16_f32 v148, v116, v117
  v_mfma_f32_16x16x32_bf16 v[28:31], a[88:91], a[64:67], v[28:31]
  s_waitcnt lgkmcnt(15)
  ds_read_b64_tr_b16 a[172:173], v238 offset:28672
  v_cvt_pk_bf16_f32 v149, v118, v119
  v_mfma_f32_16x16x32_bf16 v[36:39], a[96:99], a[64:67], v[36:39]
  ds_read_b64_tr_b16 a[174:175], v238 offset:30720
  v_cvt_pk_bf16_f32 v150, v120, v121
  v_mfma_f32_16x16x32_bf16 v[36:39], a[100:103], a[72:75], v[36:39]
  buffer_load_dwordx4 a[56:59], v243, s[36:39], s8 offen offset:2048 sc1
  ds_read_b64_tr_b16 a[176:177], v235 offset:32768
  v_mfma_f32_16x16x32_bf16 v[40:43], a[100:103], a[76:79], v[40:43]
  v_cvt_pk_bf16_f32 v151, v122, v123
  v_cvt_pk_bf16_f32 v152, v124, v125
  v_mfma_f32_16x16x32_bf16 v[40:43], a[96:99], a[68:71], v[40:43]
  s_waitcnt lgkmcnt(15)
  ds_read_b64_tr_b16 a[178:179], v235 offset:34816
  v_cvt_pk_bf16_f32 v153, v126, v127
  v_mfma_f32_16x16x32_bf16 v[48:51], a[104:107], a[68:71], v[48:51]
  ds_read_b64_tr_b16 a[180:181], v235 offset:36864
  v_cvt_pk_bf16_f32 v154, v128, v129
  v_mfma_f32_16x16x32_bf16 v[48:51], a[108:111], a[76:79], v[48:51]
  buffer_load_dwordx4 a[60:63], v243, s[36:39], s8 offen offset:3072 sc1
  ds_read_b64_tr_b16 a[182:183], v235 offset:38912
  v_mfma_f32_16x16x32_bf16 v[44:47], a[108:111], a[72:75], v[44:47]
  v_cvt_pk_bf16_f32 v155, v130, v131
  v_mfma_f32_16x16x32_bf16 v[44:47], a[104:107], a[64:67], v[44:47]
  s_waitcnt vmcnt(12) lgkmcnt(15)
  buffer_store_dwordx4 v[148:151], v0, s[36:39], s78 offen offset:0 sc1
  buffer_store_dwordx4 v[152:155], v0, s[36:39], s78 offen offset:1024 sc1
  v_mfma_f32_16x16x32_bf16 v[20:23], a[112:115], a[0:3], v[20:23]
  s_add_u32 s8, s8, 4096
  ds_read_b64_tr_b16 a[184:185], v236 offset:32768
  s_and_b32 s8, s8, 0xffff
  v_mfma_f32_16x16x32_bf16 v[20:23], a[116:119], a[8:11], v[20:23]
  ds_read_b64_tr_b16 a[186:187], v236 offset:34816
  buffer_load_dwordx4 a[64:67], v243, s[36:39], s8 offen offset:0 sc1
  v_mfma_f32_16x16x32_bf16 v[24:27], a[116:119], a[12:15], v[24:27]
  ds_read_b64_tr_b16 a[188:189], v236 offset:36864
  ds_read_b64_tr_b16 a[190:191], v236 offset:38912
  v_mfma_f32_16x16x32_bf16 v[24:27], a[112:115], a[4:7], v[24:27]
  s_waitcnt lgkmcnt(15)
  v_mfma_f32_16x16x32_bf16 v[32:35], a[120:123], a[4:7], v[32:35]
  ds_read_b64_tr_b16 a[192:193], v237 offset:32768
  v_mfma_f32_16x16x32_bf16 v[32:35], a[124:127], a[12:15], v[32:35]
  buffer_load_dwordx4 a[68:71], v243, s[36:39], s8 offen offset:1024 sc1
  ds_read_b64_tr_b16 a[194:195], v237 offset:34816
  v_mfma_f32_16x16x32_bf16 v[28:31], a[124:127], a[8:11], v[28:31]
  ds_read_b64_tr_b16 a[196:197], v237 offset:36864
  v_mfma_f32_16x16x32_bf16 v[28:31], a[120:123], a[0:3], v[28:31]
  s_waitcnt lgkmcnt(15)
  v_mfma_f32_16x16x32_bf16 v[36:39], a[128:131], a[0:3], v[36:39]
  ds_read_b64_tr_b16 a[198:199], v237 offset:38912
  v_mfma_f32_16x16x32_bf16 v[36:39], a[132:135], a[8:11], v[36:39]
  buffer_load_dwordx4 a[72:75], v243, s[36:39], s8 offen offset:2048 sc1
  ds_read_b64_tr_b16 a[200:201], v238 offset:32768
  v_mfma_f32_16x16x32_bf16 v[40:43], a[132:135], a[12:15], v[40:43]
  ds_read_b64_tr_b16 a[202:203], v238 offset:34816
  v_mfma_f32_16x16x32_bf16 v[40:43], a[128:131], a[4:7], v[40:43]
  s_waitcnt lgkmcnt(15)
  ds_read_b64_tr_b16 a[204:205], v238 offset:36864
  v_mfma_f32_16x16x32_bf16 v[48:51], a[136:139], a[4:7], v[48:51]
  v_mfma_f32_16x16x32_bf16 v[48:51], a[140:143], a[12:15], v[48:51]
  buffer_load_dwordx4 a[76:79], v243, s[36:39], s8 offen offset:3072 sc1
  ds_read_b64_tr_b16 a[206:207], v238 offset:38912
  v_mfma_f32_16x16x32_bf16 v[44:47], a[140:143], a[8:11], v[44:47]
  ds_read_b64_tr_b16 a[208:209], v235 offset:40960
  v_mfma_f32_16x16x32_bf16 v[44:47], a[136:139], a[0:3], v[44:47]
  s_waitcnt vmcnt(14) lgkmcnt(15)
  ds_read_b64_tr_b16 a[210:211], v235 offset:43008
  v_mfma_f32_16x16x32_bf16 v[20:23], a[144:147], a[16:19], v[20:23]
  s_add_u32 s8, s8, 4096
  s_and_b32 s8, s8, 0xffff
  v_mfma_f32_16x16x32_bf16 v[20:23], a[148:151], a[24:27], v[20:23]
  buffer_load_dwordx4 a[0:3], v243, s[36:39], s8 offen offset:0 sc1
  ds_read_b64_tr_b16 a[212:213], v235 offset:45056
  v_mfma_f32_16x16x32_bf16 v[24:27], a[148:151], a[28:31], v[24:27]
  ds_read_b64_tr_b16 a[214:215], v235 offset:47104
  v_mfma_f32_16x16x32_bf16 v[24:27], a[144:147], a[20:23], v[24:27]
  s_waitcnt lgkmcnt(15)
  ds_read_b64_tr_b16 a[216:217], v236 offset:40960
  v_mfma_f32_16x16x32_bf16 v[32:35], a[152:155], a[20:23], v[32:35]
  ds_read_b64_tr_b16 a[218:219], v236 offset:43008
  v_mfma_f32_16x16x32_bf16 v[32:35], a[156:159], a[28:31], v[32:35]
  buffer_load_dwordx4 a[4:7], v243, s[36:39], s8 offen offset:1024 sc1
  v_mfma_f32_16x16x32_bf16 v[28:31], a[156:159], a[24:27], v[28:31]
  ds_read_b64_tr_b16 a[220:221], v236 offset:45056
  v_mfma_f32_16x16x32_bf16 v[28:31], a[152:155], a[16:19], v[28:31]
  s_waitcnt lgkmcnt(15)
  ds_read_b64_tr_b16 a[222:223], v236 offset:47104
  v_mfma_f32_16x16x32_bf16 v[36:39], a[160:163], a[16:19], v[36:39]
  ds_read_b64_tr_b16 a[80:81], v237 offset:40960
  v_mfma_f32_16x16x32_bf16 v[36:39], a[164:167], a[24:27], v[36:39]
  buffer_load_dwordx4 a[8:11], v243, s[36:39], s8 offen offset:2048 sc1
  ds_read_b64_tr_b16 a[82:83], v237 offset:43008
  v_mfma_f32_16x16x32_bf16 v[40:43], a[164:167], a[28:31], v[40:43]
  v_mfma_f32_16x16x32_bf16 v[40:43], a[160:163], a[20:23], v[40:43]
  s_waitcnt lgkmcnt(15)
  ds_read_b64_tr_b16 a[84:85], v237 offset:45056
  v_mfma_f32_16x16x32_bf16 v[48:51], a[168:171], a[20:23], v[48:51]
  ds_read_b64_tr_b16 a[86:87], v237 offset:47104
  v_mfma_f32_16x16x32_bf16 v[48:51], a[172:175], a[28:31], v[48:51]
  buffer_load_dwordx4 a[12:15], v243, s[36:39], s8 offen offset:3072 sc1
  ds_read_b64_tr_b16 a[88:89], v238 offset:40960
  v_mfma_f32_16x16x32_bf16 v[44:47], a[172:175], a[24:27], v[44:47]
  v_mfma_f32_16x16x32_bf16 v[44:47], a[168:171], a[16:19], v[44:47]
  s_waitcnt vmcnt(14) lgkmcnt(15)
  ds_read_b64_tr_b16 a[90:91], v238 offset:43008
  v_mfma_f32_16x16x32_bf16 v[20:23], a[176:179], a[32:35], v[20:23]
  ds_read_b64_tr_b16 a[92:93], v238 offset:45056
  v_mfma_f32_16x16x32_bf16 v[20:23], a[180:183], a[40:43], v[20:23]
  ds_read_b64_tr_b16 a[94:95], v238 offset:47104
  v_mfma_f32_16x16x32_bf16 v[24:27], a[180:183], a[44:47], v[24:27]
  ds_read_b64_tr_b16 a[96:97], v235 offset:49152
  v_mfma_f32_16x16x32_bf16 v[24:27], a[176:179], a[36:39], v[24:27]
  s_waitcnt lgkmcnt(15)
  v_mfma_f32_16x16x32_bf16 v[32:35], a[184:187], a[36:39], v[32:35]
  ds_read_b64_tr_b16 a[98:99], v235 offset:51200
  v_mfma_f32_16x16x32_bf16 v[32:35], a[188:191], a[44:47], v[32:35]
  ds_read_b64_tr_b16 a[100:101], v235 offset:53248
  v_mfma_f32_16x16x32_bf16 v[28:31], a[188:191], a[40:43], v[28:31]
  ds_read_b64_tr_b16 a[102:103], v235 offset:55296
  v_mfma_f32_16x16x32_bf16 v[28:31], a[184:187], a[32:35], v[28:31]
  s_waitcnt lgkmcnt(15)
  v_mfma_f32_16x16x32_bf16 v[36:39], a[192:195], a[32:35], v[36:39]
  ds_read_b64_tr_b16 a[104:105], v236 offset:49152
  v_mfma_f32_16x16x32_bf16 v[36:39], a[196:199], a[40:43], v[36:39]
  ds_read_b64_tr_b16 a[106:107], v236 offset:51200
  v_mfma_f32_16x16x32_bf16 v[40:43], a[196:199], a[44:47], v[40:43]
  ds_read_b64_tr_b16 a[108:109], v236 offset:53248
  v_mfma_f32_16x16x32_bf16 v[40:43], a[192:195], a[36:39], v[40:43]
  s_waitcnt lgkmcnt(15)
  ds_read_b64_tr_b16 a[110:111], v236 offset:55296
  v_mfma_f32_16x16x32_bf16 v[48:51], a[200:203], a[36:39], v[48:51]
  v_mfma_f32_16x16x32_bf16 v[48:51], a[204:207], a[44:47], v[48:51]
  ds_read_b64_tr_b16 a[112:113], v237 offset:49152
  v_mfma_f32_16x16x32_bf16 v[44:47], a[204:207], a[40:43], v[44:47]
  ds_read_b64_tr_b16 a[114:115], v237 offset:51200
  v_mfma_f32_16x16x32_bf16 v[44:47], a[200:203], a[32:35], v[44:47]
  s_waitcnt vmcnt(10) lgkmcnt(15)
  ds_read_b64_tr_b16 a[116:117], v237 offset:53248
  v_mfma_f32_16x16x32_bf16 v[20:23], a[208:211], a[48:51], v[20:23]
  v_mfma_f32_16x16x32_bf16 v[20:23], a[212:215], a[56:59], v[20:23]
  ds_read_b64_tr_b16 a[118:119], v237 offset:55296
  v_mfma_f32_16x16x32_bf16 v[24:27], a[212:215], a[60:63], v[24:27]
  ds_read_b64_tr_b16 a[120:121], v238 offset:49152
  v_mfma_f32_16x16x32_bf16 v[24:27], a[208:211], a[52:55], v[24:27]
  s_waitcnt lgkmcnt(15)
  ds_read_b64_tr_b16 a[122:123], v238 offset:51200
  v_mfma_f32_16x16x32_bf16 v[32:35], a[216:219], a[52:55], v[32:35]
  ds_read_b64_tr_b16 a[124:125], v238 offset:53248
  v_mfma_f32_16x16x32_bf16 v[32:35], a[220:223], a[60:63], v[32:35]
  v_mfma_f32_16x16x32_bf16 v[28:31], a[220:223], a[56:59], v[28:31]
  ds_read_b64_tr_b16 a[126:127], v238 offset:55296
  v_mfma_f32_16x16x32_bf16 v[28:31], a[216:219], a[48:51], v[28:31]
  s_waitcnt lgkmcnt(15)
  ds_read_b64_tr_b16 a[128:129], v235 offset:57344
  v_mfma_f32_16x16x32_bf16 v[36:39], a[80:83], a[48:51], v[36:39]
  ds_read_b64_tr_b16 a[130:131], v235 offset:59392
  v_mfma_f32_16x16x32_bf16 v[36:39], a[84:87], a[56:59], v[36:39]
  v_mfma_f32_16x16x32_bf16 v[40:43], a[84:87], a[60:63], v[40:43]
  ds_read_b64_tr_b16 a[132:133], v235 offset:61440
  v_mfma_f32_16x16x32_bf16 v[40:43], a[80:83], a[52:55], v[40:43]
  s_waitcnt lgkmcnt(15)
  ds_read_b64_tr_b16 a[134:135], v235 offset:63488
  v_mfma_f32_16x16x32_bf16 v[48:51], a[88:91], a[52:55], v[48:51]
  ds_read_b64_tr_b16 a[136:137], v236 offset:57344
  v_mfma_f32_16x16x32_bf16 v[48:51], a[92:95], a[60:63], v[48:51]
  ds_read_b64_tr_b16 a[138:139], v236 offset:59392
  v_mfma_f32_16x16x32_bf16 v[44:47], a[92:95], a[56:59], v[44:47]
  v_mfma_f32_16x16x32_bf16 v[44:47], a[88:91], a[48:51], v[44:47]
  s_waitcnt vmcnt(4) lgkmcnt(15)
  ds_read_b64_tr_b16 a[140:141], v236 offset:61440
  v_mfma_f32_16x16x32_bf16 v[20:23], a[96:99], a[64:67], v[20:23]
  ds_read_b64_tr_b16 a[142:143], v236 offset:63488
  v_mfma_f32_16x16x32_bf16 v[20:23], a[100:103], a[72:75], v[20:23]
  ds_read_b64_tr_b16 a[144:145], v237 offset:57344
  v_mfma_f32_16x16x32_bf16 v[24:27], a[100:103], a[76:79], v[24:27]
  v_mfma_f32_16x16x32_bf16 v[24:27], a[96:99], a[68:71], v[24:27]
  s_waitcnt lgkmcnt(15)
  ds_read_b64_tr_b16 a[146:147], v237 offset:59392
  v_mfma_f32_16x16x32_bf16 v[32:35], a[104:107], a[68:71], v[32:35]
  ds_read_b64_tr_b16 a[148:149], v237 offset:61440
  v_mfma_f32_16x16x32_bf16 v[32:35], a[108:111], a[76:79], v[32:35]
  ds_read_b64_tr_b16 a[150:151], v237 offset:63488
  v_mfma_f32_16x16x32_bf16 v[28:31], a[108:111], a[72:75], v[28:31]
  ds_read_b64_tr_b16 a[152:153], v238 offset:57344
  v_mfma_f32_16x16x32_bf16 v[28:31], a[104:107], a[64:67], v[28:31]
  s_waitcnt lgkmcnt(15)
  v_mfma_f32_16x16x32_bf16 v[36:39], a[112:115], a[64:67], v[36:39]
  ds_read_b64_tr_b16 a[154:155], v238 offset:59392
  v_mfma_f32_16x16x32_bf16 v[36:39], a[116:119], a[72:75], v[36:39]
  ds_read_b64_tr_b16 a[156:157], v238 offset:61440
  v_mfma_f32_16x16x32_bf16 v[40:43], a[116:119], a[76:79], v[40:43]
  ds_read_b64_tr_b16 a[158:159], v238 offset:63488
  v_mfma_f32_16x16x32_bf16 v[40:43], a[112:115], a[68:71], v[40:43]
  s_waitcnt lgkmcnt(15)
  v_mfma_f32_16x16x32_bf16 v[48:51], a[120:123], a[68:71], v[48:51]
  v_mfma_f32_16x16x32_bf16 v[48:51], a[124:127], a[76:79], v[48:51]
  v_mfma_f32_16x16x32_bf16 v[44:47], a[124:127], a[72:75], v[44:47]
  v_mfma_f32_16x16x32_bf16 v[44:47], a[120:123], a[64:67], v[44:47]
  s_waitcnt vmcnt(0) lgkmcnt(12)
  v_mfma_f32_16x16x32_bf16 v[20:23], a[128:131], a[0:3], v[20:23]
  v_mfma_f32_16x16x32_bf16 v[20:23], a[132:135], a[8:11], v[20:23]
  v_mfma_f32_16x16x32_bf16 v[24:27], a[132:135], a[12:15], v[24:27]
  v_mfma_f32_16x16x32_bf16 v[24:27], a[128:131], a[4:7], v[24:27]
  s_waitcnt lgkmcnt(8)
  v_mfma_f32_16x16x32_bf16 v[32:35], a[136:139], a[4:7], v[32:35]
  v_mfma_f32_16x16x32_bf16 v[32:35], a[140:143], a[12:15], v[32:35]
  v_mfma_f32_16x16x32_bf16 v[28:31], a[140:143], a[8:11], v[28:31]
  v_mfma_f32_16x16x32_bf16 v[28:31], a[136:139], a[0:3], v[28:31]
  s_waitcnt lgkmcnt(4)
  v_mfma_f32_16x16x32_bf16 v[36:39], a[144:147], a[0:3], v[36:39]
  v_mfma_f32_16x16x32_bf16 v[36:39], a[148:151], a[8:11], v[36:39]
  v_mfma_f32_16x16x32_bf16 v[40:43], a[148:151], a[12:15], v[40:43]
  v_mfma_f32_16x16x32_bf16 v[40:43], a[144:147], a[4:7], v[40:43]
  s_waitcnt lgkmcnt(0)
  v_mfma_f32_16x16x32_bf16 v[48:51], a[152:155], a[4:7], v[48:51]
  v_mfma_f32_16x16x32_bf16 v[48:51], a[156:159], a[12:15], v[48:51]
  v_mfma_f32_16x16x32_bf16 v[44:47], a[156:159], a[8:11], v[44:47]
  v_mfma_f32_16x16x32_bf16 v[44:47], a[152:155], a[0:3], v[44:47]
  s_waitcnt lgkmcnt(0)
  s_nop 2
  v_fmac_f32 v52, v84, v20
  v_fmac_f32 v53, v85, v21
  v_fmac_f32 v54, v86, v22
  v_fmac_f32 v55, v87, v23
  v_mul_f32 v20, v52, v100
  v_mul_f32 v21, v53, v101
  v_mul_f32 v22, v54, v102
  v_mul_f32 v23, v55, v103
  v_cvt_pk_bf16_f32 v132, v20, v21
  v_cvt_pk_bf16_f32 v133, v22, v23
  v_fmac_f32 v56, v88, v28
  v_fmac_f32 v57, v89, v29
  v_fmac_f32 v58, v90, v30
  v_fmac_f32 v59, v91, v31
  v_mul_f32 v28, v56, v104
  v_mul_f32 v29, v57, v105
  v_mul_f32 v30, v58, v106
  v_mul_f32 v31, v59, v107
  v_cvt_pk_bf16_f32 v134, v28, v29
  v_cvt_pk_bf16_f32 v135, v30, v31
  buffer_store_dwordx4 v[132:135], v0, s[36:39], s76 offen offset:0 sc1
  v_fmac_f32 v60, v92, v36
  v_fmac_f32 v61, v93, v37
  v_fmac_f32 v62, v94, v38
  v_fmac_f32 v63, v95, v39
  v_mul_f32 v36, v60, v108
  v_mul_f32 v37, v61, v109
  v_mul_f32 v38, v62, v110
  v_mul_f32 v39, v63, v111
  v_cvt_pk_bf16_f32 v136, v36, v37
  v_cvt_pk_bf16_f32 v137, v38, v39
  v_fmac_f32 v64, v96, v44
  v_fmac_f32 v65, v97, v45
  v_fmac_f32 v66, v98, v46
  v_fmac_f32 v67, v99, v47
  v_mul_f32 v44, v64, v112
  v_mul_f32 v45, v65, v113
  v_mul_f32 v46, v66, v114
  v_mul_f32 v47, v67, v115
  v_cvt_pk_bf16_f32 v138, v44, v45
  v_cvt_pk_bf16_f32 v139, v46, v47
  buffer_store_dwordx4 v[136:139], v0, s[36:39], s9 offen offset:0 sc1
  v_fmac_f32 v68, v84, v24
  v_fmac_f32 v69, v85, v25
  v_fmac_f32 v70, v86, v26
  v_fmac_f32 v71, v87, v27
  v_mul_f32 v24, v68, v100
  v_mul_f32 v25, v69, v101
  v_mul_f32 v26, v70, v102
  v_mul_f32 v27, v71, v103
  v_cvt_pk_bf16_f32 v140, v24, v25
  v_cvt_pk_bf16_f32 v141, v26, v27
  v_fmac_f32 v72, v88, v32
  v_fmac_f32 v73, v89, v33
  v_fmac_f32 v74, v90, v34
  v_fmac_f32 v75, v91, v35
  v_mul_f32 v32, v72, v104
  v_mul_f32 v33, v73, v105
  v_mul_f32 v34, v74, v106
  v_mul_f32 v35, v75, v107
  v_cvt_pk_bf16_f32 v142, v32, v33
  v_cvt_pk_bf16_f32 v143, v34, v35
  buffer_store_dwordx4 v[140:143], v0, s[36:39], s76 offen offset:1024 sc1
  v_fmac_f32 v76, v92, v40
  v_fmac_f32 v77, v93, v41
  v_fmac_f32 v78, v94, v42
  v_fmac_f32 v79, v95, v43
  v_mul_f32 v40, v76, v108
  v_mul_f32 v41, v77, v109
  v_mul_f32 v42, v78, v110
  v_mul_f32 v43, v79, v111
  v_cvt_pk_bf16_f32 v144, v40, v41
  v_cvt_pk_bf16_f32 v145, v42, v43
  v_fmac_f32 v80, v96, v48
  v_fmac_f32 v81, v97, v49
  v_fmac_f32 v82, v98, v50
  v_fmac_f32 v83, v99, v51
  v_mul_f32 v48, v80, v112
  v_mul_f32 v49, v81, v113
  v_mul_f32 v50, v82, v114
  v_mul_f32 v51, v83, v115
  v_cvt_pk_bf16_f32 v146, v48, v49
  v_cvt_pk_bf16_f32 v147, v50, v51
  buffer_store_dwordx4 v[144:147], v0, s[36:39], s9 offen offset:1024 sc1
  v_add_f32 v20, v52, v53
  v_mul_f32 v21, v52, v52
  v_add_f32 v24, v54, v55
  v_mul_f32 v25, v53, v53
  v_fmac_f32 v21, v54, v54
  v_fmac_f32 v25, v55, v55
  v_fmac_f32 v21, v56, v56
  v_add_f32 v20, v20, v56
  v_fmac_f32 v25, v57, v57
  v_add_f32 v24, v24, v57
  v_fmac_f32 v21, v58, v58
  v_add_f32 v20, v20, v58
  v_fmac_f32 v25, v59, v59
  v_add_f32 v24, v24, v59
  v_fmac_f32 v21, v60, v60
  v_add_f32 v20, v20, v60
  v_fmac_f32 v25, v61, v61
  v_add_f32 v24, v24, v61
  v_fmac_f32 v21, v62, v62
  v_add_f32 v20, v20, v62
  v_fmac_f32 v25, v63, v63
  v_add_f32 v24, v24, v63
  v_fmac_f32 v21, v64, v64
  v_add_f32 v20, v20, v64
  v_fmac_f32 v25, v65, v65
  v_add_f32 v24, v24, v65
  v_fmac_f32 v21, v66, v66
  v_add_f32 v20, v20, v66
  v_fmac_f32 v25, v67, v67
  v_add_f32 v24, v24, v67
  v_add_f32 v22, v68, v69
  v_mul_f32 v23, v68, v68
  v_add_f32 v26, v70, v71
  v_mul_f32 v27, v69, v69
  v_fmac_f32 v23, v70, v70
  v_fmac_f32 v27, v71, v71
  v_fmac_f32 v23, v72, v72
  v_add_f32 v22, v22, v72
  v_fmac_f32 v27, v73, v73
  v_add_f32 v26, v26, v73
  v_fmac_f32 v23, v74, v74
  v_add_f32 v22, v22, v74
  v_fmac_f32 v27, v75, v75
  v_add_f32 v26, v26, v75
  v_fmac_f32 v23, v76, v76
  v_add_f32 v22, v22, v76
  v_fmac_f32 v27, v77, v77
  v_add_f32 v26, v26, v77
  v_fmac_f32 v23, v78, v78
  v_add_f32 v22, v22, v78
  v_fmac_f32 v27, v79, v79
  v_add_f32 v26, v26, v79
  v_fmac_f32 v23, v80, v80
  v_add_f32 v22, v22, v80
  v_fmac_f32 v27, v81, v81
  v_add_f32 v26, v26, v81
  v_fmac_f32 v23, v82, v82
  v_add_f32 v22, v22, v82
  v_fmac_f32 v27, v83, v83
  v_add_f32 v26, v26, v83
  v_add_f32 v20, v20, v24
  v_add_f32 v21, v21, v25
  v_add_f32 v22, v22, v26
  v_add_f32 v23, v23, v27
  v_mov_b32 v24, v20
  v_mov_b32 v25, v21
  v_mov_b32 v26, v22
  v_mov_b32 v27, v23
  v_permlane16_swap_b32 v20, v24
  v_permlane16_swap_b32 v21, v25
  v_permlane16_swap_b32 v22, v26
  v_permlane16_swap_b32 v23, v27
  v_add_f32 v20, v20, v24
  v_add_f32 v21, v21, v25
  v_add_f32 v22, v22, v26
  v_add_f32 v23, v23, v27
  v_mov_b32 v24, v20
  v_mov_b32 v25, v21
  v_mov_b32 v26, v22
  v_mov_b32 v27, v23
  v_permlane32_swap_b32 v20, v24
  v_permlane32_swap_b32 v21, v25
  v_permlane32_swap_b32 v22, v26
  v_permlane32_swap_b32 v23, v27
  v_add_f32 v20, v20, v24
  v_add_f32 v21, v21, v25
  v_add_f32 v22, v22, v26
  v_add_f32 v23, v23, v27
  s_mov_b64 exec, 0xffff
  buffer_store_dwordx4 v[20:23], v0, s[36:39], s77 offen sc1
  s_mov_b64 exec, -1
  v_cvt_pk_bf16_f32 v116, v52, v53
  v_cvt_pk_bf16_f32 v117, v54, v55
  v_cvt_pk_bf16_f32 v118, v56, v57
  v_cvt_pk_bf16_f32 v119, v58, v59
  v_cvt_pk_bf16_f32 v120, v60, v61
  v_cvt_pk_bf16_f32 v121, v62, v63
  v_cvt_pk_bf16_f32 v122, v64, v65
  v_cvt_pk_bf16_f32 v123, v66, v67
  v_cvt_pk_bf16_f32 v124, v68, v69
  v_cvt_pk_bf16_f32 v125, v70, v71
  v_cvt_pk_bf16_f32 v126, v72, v73
  v_cvt_pk_bf16_f32 v127, v74, v75
  v_cvt_pk_bf16_f32 v128, v76, v77
  v_cvt_pk_bf16_f32 v129, v78, v79
  v_cvt_pk_bf16_f32 v130, v80, v81
  v_cvt_pk_bf16_f32 v131, v82, v83
  v_accvgpr_write_b32 a232, v116
  v_accvgpr_write_b32 a233, v117
  v_accvgpr_write_b32 a234, v118
  v_accvgpr_write_b32 a235, v119
  v_accvgpr_write_b32 a236, v120
  v_accvgpr_write_b32 a237, v121
  v_accvgpr_write_b32 a238, v122
  v_accvgpr_write_b32 a239, v123
  v_accvgpr_write_b32 a240, v124
  v_accvgpr_write_b32 a241, v125
  v_accvgpr_write_b32 a242, v126
  v_accvgpr_write_b32 a243, v127
  v_accvgpr_write_b32 a244, v128
  v_accvgpr_write_b32 a245, v129
  v_accvgpr_write_b32 a246, v130
  v_accvgpr_write_b32 a247, v131
  v_mov_b32 v12, 1
  s_waitcnt vmcnt(0) lgkmcnt(0)
  s_barrier
  s_mov_b64 exec, 1
  buffer_store_dword v12, v0, s[36:39], s45 offen sc1
  s_mov_b64 exec, -1
  s_bfe_u32 s10, s82, 0x40000
  s_mul_i32 s10, s10, 458752
  s_add_u32 m0, s79, 0
  s_nop 0
  buffer_load_dwordx4 v3, s[16:19], s10 offen offset:0 lds
  buffer_load_dwordx4 v4, s[16:19], s10 offen offset:1024 lds
  buffer_load_dwordx4 v5, s[16:19], s10 offen offset:2048 lds
  buffer_load_dwordx4 v6, s[16:19], s10 offen offset:3072 lds
  s_add_u32 m0, s79, 4096
  s_nop 0
  buffer_load_dwordx4 v7, s[16:19], s10 offen offset:0 lds
  buffer_load_dwordx4 v8, s[16:19], s10 offen offset:1024 lds
  buffer_load_dwordx4 v9, s[16:19], s10 offen offset:2048 lds
  s_bfe_u32 s10, s82, 0x40004
  s_mul_i32 s10, s10, 458752
  s_add_u32 m0, s79, 28672
  s_nop 0
  buffer_load_dwordx4 v3, s[16:19], s10 offen offset:0 lds
  buffer_load_dwordx4 v4, s[16:19], s10 offen offset:1024 lds
  buffer_load_dwordx4 v5, s[16:19], s10 offen offset:2048 lds
  buffer_load_dwordx4 v6, s[16:19], s10 offen offset:3072 lds
  s_add_u32 m0, s79, 32768
  s_nop 0
  buffer_load_dwordx4 v7, s[16:19], s10 offen offset:0 lds
  buffer_load_dwordx4 v8, s[16:19], s10 offen offset:1024 lds
  buffer_load_dwordx4 v9, s[16:19], s10 offen offset:2048 lds
  s_bfe_u32 s11, s82, 0x40000
  s_lshl_b32 s11, s11, 13
  s_add_u32 s11, s11, s84
  s_cmp_lg_u32 s44, 0
  s_cbranch_scc1 SM8x
  s_mov_b32 s46, 60000
  s_mov_b32 s47, 5341184
SM8:
  buffer_load_dword v13, v250, s[36:39], s47 offen sc1
  s_sub_u32 s46, s46, 1
  s_cmp_eq_u32 s46, 0
  s_waitcnt vmcnt(0)
  s_cbranch_scc1 SM8x
  v_cmp_ne_u32 vcc, 1, v13
  s_nop 4
  s_cbranch_vccnz SM8
SM8x:
  s_waitcnt vmcnt(7)
  s_barrier
  buffer_load_dwordx4 a[0:3], v0, s[36:39], s11 offen offset:0 sc1
  buffer_load_dwordx4 a[4:7], v0, s[36:39], s11 offen offset:1024 sc1
  buffer_load_dwordx4 a[8:11], v0, s[36:39], s11 offen offset:2048 sc1
  buffer_load_dwordx4 a[12:15], v0, s[36:39], s11 offen offset:3072 sc1
  s_add_u32 s11, s11, 4096
  buffer_load_dwordx4 a[16:19], v0, s[36:39], s11 offen offset:0 sc1
  buffer_load_dwordx4 a[20:23], v0, s[36:39], s11 offen offset:1024 sc1
  buffer_load_dwordx4 a[24:27], v0, s[36:39], s11 offen offset:2048 sc1
  buffer_load_dwordx4 a[28:31], v0, s[36:39], s11 offen offset:3072 sc1
  ds_read_b64_tr_b16 a[128:129], v1 offset:0
  ds_read_b64_tr_b16 a[130:131], v1 offset:3584
  ds_read_b64_tr_b16 a[132:133], v1 offset:7168
  ds_read_b64_tr_b16 a[134:135], v1 offset:10752
  ds_read_b64_tr_b16 a[136:137], v1 offset:32
  ds_read_b64_tr_b16 a[138:139], v1 offset:3616
  ds_read_b64_tr_b16 a[140:141], v1 offset:7200
  ds_read_b64_tr_b16 a[142:143], v1 offset:10784
  ds_read_b64_tr_b16 a[144:145], v1 offset:64
  ds_read_b64_tr_b16 a[146:147], v1 offset:3648
  ds_read_b64_tr_b16 a[148:149], v1 offset:7232
  ds_read_b64_tr_b16 a[150:151], v1 offset:10816
  ds_read_b64_tr_b16 a[152:153], v1 offset:96
  ds_read_b64_tr_b16 a[154:155], v1 offset:3680
  ds_read_b64_tr_b16 a[156:157], v1 offset:7264
  ds_read_b64_tr_b16 a[158:159], v1 offset:10848
  s_waitcnt vmcnt(7) lgkmcnt(8)
  v_mfma_f32_16x16x32_bf16 v[32:35], a[128:131], a[0:3], 0
  s_waitcnt vmcnt(3)
  s_bfe_u32 s11, s82, 0x40004
  s_lshl_b32 s11, s11, 13
  v_mfma_f32_16x16x32_bf16 v[32:35], a[132:135], a[16:19], v[32:35]
  s_waitcnt vmcnt(2)
  s_add_u32 s11, s11, s84
  buffer_load_dwordx4 a[32:35], v0, s[36:39], s11 offen offset:0 sc1
  v_mfma_f32_16x16x32_bf16 v[36:39], a[132:135], a[20:23], 0
  s_waitcnt vmcnt(7)
  ds_read_b64_tr_b16 a[160:161], v1 offset:128
  ds_read_b64_tr_b16 a[162:163], v1 offset:3712
  v_mfma_f32_16x16x32_bf16 v[36:39], a[128:131], a[4:7], v[36:39]
  s_waitcnt vmcnt(6)
  v_mfma_f32_16x16x32_bf16 v[40:43], a[128:131], a[8:11], 0
  s_waitcnt vmcnt(2)
  ds_read_b64_tr_b16 a[164:165], v1 offset:7296
  v_mfma_f32_16x16x32_bf16 v[40:43], a[132:135], a[24:27], v[40:43]
  s_waitcnt vmcnt(1)
  v_mfma_f32_16x16x32_bf16 v[44:47], a[132:135], a[28:31], 0
  s_waitcnt vmcnt(5)
  buffer_load_dwordx4 a[36:39], v0, s[36:39], s11 offen offset:1024 sc1
  ds_read_b64_tr_b16 a[166:167], v1 offset:10880
  v_mfma_f32_16x16x32_bf16 v[44:47], a[128:131], a[12:15], v[44:47]
  v_mfma_f32_16x16x32_bf16 v[60:63], a[136:139], a[12:15], 0
  ds_read_b64_tr_b16 a[168:169], v1 offset:160
  v_mfma_f32_16x16x32_bf16 v[60:63], a[140:143], a[28:31], v[60:63]
  v_mfma_f32_16x16x32_bf16 v[56:59], a[140:143], a[24:27], 0
  ds_read_b64_tr_b16 a[170:171], v1 offset:3744
  v_mfma_f32_16x16x32_bf16 v[56:59], a[136:139], a[8:11], v[56:59]
  buffer_load_dwordx4 a[40:43], v0, s[36:39], s11 offen offset:2048 sc1
  v_mfma_f32_16x16x32_bf16 v[52:55], a[136:139], a[4:7], 0
  ds_read_b64_tr_b16 a[172:173], v1 offset:7328
  v_mfma_f32_16x16x32_bf16 v[52:55], a[140:143], a[20:23], v[52:55]
  v_mfma_f32_16x16x32_bf16 v[48:51], a[140:143], a[16:19], 0
  ds_read_b64_tr_b16 a[174:175], v1 offset:10912
  v_mfma_f32_16x16x32_bf16 v[48:51], a[136:139], a[0:3], v[48:51]
  s_waitcnt lgkmcnt(8)
  v_mfma_f32_16x16x32_bf16 v[64:67], a[144:147], a[0:3], 0
  buffer_load_dwordx4 a[44:47], v0, s[36:39], s11 offen offset:3072 sc1
  s_bfe_u32 s10, s82, 0x40008
  v_mfma_f32_16x16x32_bf16 v[64:67], a[148:151], a[16:19], v[64:67]
  s_mul_i32 s10, s10, 458752
  s_add_u32 m0, s79, 57344
  ds_read_b64_tr_b16 a[128:129], v1 offset:192
  v_mfma_f32_16x16x32_bf16 v[68:71], a[148:151], a[20:23], 0
  ds_read_b64_tr_b16 a[130:131], v1 offset:3776
  v_mfma_f32_16x16x32_bf16 v[68:71], a[144:147], a[4:7], v[68:71]
  v_mfma_f32_16x16x32_bf16 v[72:75], a[144:147], a[8:11], 0
  ds_read_b64_tr_b16 a[132:133], v1 offset:7360
CT9:
  s_add_u32 s94, s92, CT9-k3_main_kernel+3072
  s_addc_u32 s95, s93, 0
  v_mfma_f32_16x16x32_bf16 v[72:75], a[148:151], a[24:27], v[72:75]
  buffer_load_dwordx4 v3, s[16:19], s10 offen offset:0 lds
  s_add_u32 s11, s11, 4096
  v_mfma_f32_16x16x32_bf16 v[76:79], a[148:151], a[28:31], 0
  ds_read_b64_tr_b16 a[134:135], v1 offset:10944
  v_mfma_f32_16x16x32_bf16 v[76:79], a[144:147], a[12:15], v[76:79]
  v_mfma_f32_16x16x32_bf16 v[92:95], a[152:155], a[12:15], 0
  ds_read_b64_tr_b16 a[136:137], v1 offset:14336
  v_mfma_f32_16x16x32_bf16 v[92:95], a[156:159], a[28:31], v[92:95]
  v_mfma_f32_16x16x32_bf16 v[88:91], a[156:159], a[24:27], 0
  buffer_load_dwordx4 a[48:51], v0, s[36:39], s11 offen offset:0 sc1
  ds_read_b64_tr_b16 a[138:139], v1 offset:17920
  v_mfma_f32_16x16x32_bf16 v[88:91], a[152:155], a[8:11], v[88:91]
  v_mfma_f32_16x16x32_bf16 v[84:87], a[152:155], a[4:7], 0
  ds_read_b64_tr_b16 a[140:141], v1 offset:21504
  v_mfma_f32_16x16x32_bf16 v[84:87], a[156:159], a[20:23], v[84:87]
  v_mfma_f32_16x16x32_bf16 v[80:83], a[156:159], a[16:19], 0
  ds_read_b64_tr_b16 a[142:143], v1 offset:25088
  v_mfma_f32_16x16x32_bf16 v[80:83], a[152:155], a[0:3], v[80:83]
  s_waitcnt lgkmcnt(8)
  buffer_load_dwordx4 v4, s[16:19], s10 offen offset:1024 lds
  v_mfma_f32_16x16x32_bf16 v[96:99], a[160:163], a[0:3], 0
  ds_read_b64_tr_b16 a[144:145], v1 offset:14368
  v_mfma_f32_16x16x32_bf16 v[96:99], a[164:167], a[16:19], v[96:99]
  v_mfma_f32_16x16x32_bf16 v[100:103], a[164:167], a[20:23], 0
  ds_read_b64_tr_b16 a[146:147], v1 offset:17952
  v_mfma_f32_16x16x32_bf16 v[100:103], a[160:163], a[4:7], v[100:103]
  v_mfma_f32_16x16x32_bf16 v[104:107], a[160:163], a[8:11], 0
  buffer_load_dwordx4 a[52:55], v0, s[36:39], s11 offen offset:1024 sc1
  ds_read_b64_tr_b16 a[148:149], v1 offset:21536
  v_mfma_f32_16x16x32_bf16 v[104:107], a[164:167], a[24:27], v[104:107]
  v_mfma_f32_16x16x32_bf16 v[108:111], a[164:167], a[28:31], 0
  ds_read_b64_tr_b16 a[150:151], v1 offset:25120
  v_mfma_f32_16x16x32_bf16 v[108:111], a[160:163], a[12:15], v[108:111]
  v_mfma_f32_16x16x32_bf16 v[124:127], a[168:171], a[12:15], 0
  s_bfe_u32 s20, s82, 0x40018
  s_lshl4_add_u32 s20, s56, s20
  s_lshl_b32 s20, s20, 11
  v_mfma_f32_16x16x32_bf16 v[124:127], a[172:175], a[28:31], v[124:127]
  s_add_u32 s20, s20, 5767168
  global_load_dword a252, v0, s[94:95]
  ds_read_b64_tr_b16 a[152:153], v1 offset:14400
  v_mfma_f32_16x16x32_bf16 v[120:123], a[172:175], a[24:27], 0
  s_lshr_b32 s28, s44, 1
  ds_read_b64_tr_b16 a[154:155], v1 offset:17984
  s_mul_i32 s28, s28, 14336
  v_mfma_f32_16x16x32_bf16 v[120:123], a[168:171], a[8:11], v[120:123]
  s_and_b32 s29, s44, 1
  s_lshl_b32 s29, s29, 7
  s_add_u32 s28, s28, s29
  v_mfma_f32_16x16x32_bf16 v[116:119], a[168:171], a[4:7], 0
  ds_read_b64_tr_b16 a[156:157], v1 offset:21568
  v_add_u32 v31, s28, v1
  v_mfma_f32_16x16x32_bf16 v[116:119], a[172:175], a[20:23], v[116:119]
  s_lshl_b32 s4, s2, 15
  s_lshl1_add_u32 s4, s73, s4
  s_xor_b32 s6, s4, 32768
  v_mfma_f32_16x16x32_bf16 v[112:115], a[172:175], a[16:19], 0
  s_add_u32 s4, s4, 41943040
  buffer_load_dwordx4 v5, s[16:19], s10 offen offset:2048 lds
  ds_read_b64_tr_b16 a[158:159], v1 offset:25152
  v_mfma_f32_16x16x32_bf16 v[112:115], a[168:171], a[0:3], v[112:115]
  s_waitcnt lgkmcnt(8)
  s_add_u32 s5, s4, 4096
  s_add_u32 s6, s6, 41943040
  v_mfma_f32_16x16x32_bf16 v[128:131], a[128:131], a[0:3], 0
  s_add_u32 s7, s6, 4096
  ds_read_b64_tr_b16 a[160:161], v1 offset:14432
  v_mfma_f32_16x16x32_bf16 v[128:131], a[132:135], a[16:19], v[128:131]
  v_mfma_f32_16x16x32_bf16 v[132:135], a[132:135], a[20:23], 0
  ds_read_b64_tr_b16 a[162:163], v1 offset:18016
  v_mfma_f32_16x16x32_bf16 v[132:135], a[128:131], a[4:7], v[132:135]
  buffer_load_dwordx4 a[56:59], v0, s[36:39], s11 offen offset:2048 sc1
  v_mfma_f32_16x16x32_bf16 v[136:139], a[128:131], a[8:11], 0
  ds_read_b64_tr_b16 a[164:165], v1 offset:21600
  v_mfma_f32_16x16x32_bf16 v[136:139], a[132:135], a[24:27], v[136:139]
  v_mfma_f32_16x16x32_bf16 v[140:143], a[132:135], a[28:31], 0
  ds_read_b64_tr_b16 a[166:167], v1 offset:25184
  v_mfma_f32_16x16x32_bf16 v[140:143], a[128:131], a[12:15], v[140:143]
  v_mfma_f32_16x16x32_bf16 v[156:159], a[136:139], a[12:15], 0
  buffer_load_dwordx4 v6, s[16:19], s10 offen offset:3072 lds
  ds_read_b64_tr_b16 a[168:169], v1 offset:14464
  v_mfma_f32_16x16x32_bf16 v[156:159], a[140:143], a[28:31], v[156:159]
  v_mfma_f32_16x16x32_bf16 v[152:155], a[140:143], a[24:27], 0
  ds_read_b64_tr_b16 a[170:171], v1 offset:18048
  v_mfma_f32_16x16x32_bf16 v[152:155], a[136:139], a[8:11], v[152:155]
  v_mfma_f32_16x16x32_bf16 v[148:151], a[136:139], a[4:7], 0
  ds_read_b64_tr_b16 a[172:173], v1 offset:21632
  v_mfma_f32_16x16x32_bf16 v[148:151], a[140:143], a[20:23], v[148:151]
  buffer_load_dwordx4 a[60:63], v0, s[36:39], s11 offen offset:3072 sc1
  s_add_u32 m0, s79, 61440
  v_mfma_f32_16x16x32_bf16 v[144:147], a[140:143], a[16:19], 0
  ds_read_b64_tr_b16 a[174:175], v1 offset:25216
  v_mfma_f32_16x16x32_bf16 v[144:147], a[136:139], a[0:3], v[144:147]
  s_waitcnt lgkmcnt(8)
  v_mfma_f32_16x16x32_bf16 v[160:163], a[144:147], a[0:3], 0
  ds_read_b64_tr_b16 a[128:129], v1 offset:14496
  v_mfma_f32_16x16x32_bf16 v[160:163], a[148:151], a[16:19], v[160:163]
  v_mfma_f32_16x16x32_bf16 v[164:167], a[148:151], a[20:23], 0
  buffer_load_dwordx4 v7, s[16:19], s10 offen offset:0 lds
  s_bfe_u32 s11, s82, 0x40008
  v_mfma_f32_16x16x32_bf16 v[164:167], a[144:147], a[4:7], v[164:167]
  s_lshl_b32 s11, s11, 13
  s_add_u32 s11, s11, s84
  ds_read_b64_tr_b16 a[130:131], v1 offset:18080
  v_mfma_f32_16x16x32_bf16 v[168:171], a[144:147], a[8:11], 0
  ds_read_b64_tr_b16 a[132:133], v1 offset:21664
  v_mfma_f32_16x16x32_bf16 v[168:171], a[148:151], a[24:27], v[168:171]
  v_mfma_f32_16x16x32_bf16 v[172:175], a[148:151], a[28:31], 0
  ds_read_b64_tr_b16 a[134:135], v1 offset:25248
  v_mfma_f32_16x16x32_bf16 v[172:175], a[144:147], a[12:15], v[172:175]
  s_waitcnt vmcnt(22)
  s_barrier
  buffer_load_dwordx4 a[64:67], v0, s[36:39], s11 offen offset:0 sc1
  v_mfma_f32_16x16x32_bf16 v[188:191], a[152:155], a[12:15], 0
  ds_read_b64_tr_b16 a[136:137], v1 offset:14528
  v_mfma_f32_16x16x32_bf16 v[188:191], a[156:159], a[28:31], v[188:191]
  v_mfma_f32_16x16x32_bf16 v[184:187], a[156:159], a[24:27], 0
  ds_read_b64_tr_b16 a[138:139], v1 offset:18112
  v_mfma_f32_16x16x32_bf16 v[184:187], a[152:155], a[8:11], v[184:187]
  v_mfma_f32_16x16x32_bf16 v[180:183], a[152:155], a[4:7], 0
  buffer_load_dwordx4 v8, s[16:19], s10 offen offset:1024 lds
  ds_read_b64_tr_b16 a[140:141], v1 offset:21696
  v_mfma_f32_16x16x32_bf16 v[180:183], a[156:159], a[20:23], v[180:183]
  v_mfma_f32_16x16x32_bf16 v[176:179], a[156:159], a[16:19], 0
  ds_read_b64_tr_b16 a[142:143], v1 offset:25280
  v_mfma_f32_16x16x32_bf16 v[176:179], a[152:155], a[0:3], v[176:179]
  s_waitcnt lgkmcnt(8)
  v_mfma_f32_16x16x32_bf16 v[192:195], a[160:163], a[0:3], 0
  ds_read_b64_tr_b16 a[144:145], v1 offset:28672
  v_mfma_f32_16x16x32_bf16 v[192:195], a[164:167], a[16:19], v[192:195]
  buffer_load_dwordx4 a[68:71], v0, s[36:39], s11 offen offset:1024 sc1
  v_mfma_f32_16x16x32_bf16 v[196:199], a[164:167], a[20:23], 0
  ds_read_b64_tr_b16 a[146:147], v1 offset:32256
  v_mfma_f32_16x16x32_bf16 v[196:199], a[160:163], a[4:7], v[196:199]
  v_mfma_f32_16x16x32_bf16 v[200:203], a[160:163], a[8:11], 0
  ds_read_b64_tr_b16 a[148:149], v1 offset:35840
  v_mfma_f32_16x16x32_bf16 v[200:203], a[164:167], a[24:27], v[200:203]
  v_mfma_f32_16x16x32_bf16 v[204:207], a[164:167], a[28:31], 0
  buffer_load_dwordx4 v9, s[16:19], s10 offen offset:2048 lds
  ds_read_b64_tr_b16 a[150:151], v1 offset:39424
  v_mfma_f32_16x16x32_bf16 v[204:207], a[160:163], a[12:15], v[204:207]
  v_mfma_f32_16x16x32_bf16 v[220:223], a[168:171], a[12:15], 0
  ds_read_b64_tr_b16 a[152:153], v1 offset:28704
  v_mfma_f32_16x16x32_bf16 v[220:223], a[172:175], a[28:31], v[220:223]
  v_mfma_f32_16x16x32_bf16 v[216:219], a[172:175], a[24:27], 0
  ds_read_b64_tr_b16 a[154:155], v1 offset:32288
  v_mfma_f32_16x16x32_bf16 v[216:219], a[168:171], a[8:11], v[216:219]
  buffer_load_dwordx4 a[72:75], v0, s[36:39], s11 offen offset:2048 sc1
  v_mfma_f32_16x16x32_bf16 v[212:215], a[168:171], a[4:7], 0
  ds_read_b64_tr_b16 a[156:157], v1 offset:35872
  v_mfma_f32_16x16x32_bf16 v[212:215], a[172:175], a[20:23], v[212:215]
  v_mfma_f32_16x16x32_bf16 v[208:211], a[172:175], a[16:19], 0
  ds_read_b64_tr_b16 a[158:159], v1 offset:39456
  v_mfma_f32_16x16x32_bf16 v[208:211], a[168:171], a[0:3], v[208:211]
  s_waitcnt lgkmcnt(8)
  v_mfma_f32_16x16x32_bf16 v[224:227], a[128:131], a[0:3], 0
  ds_read_b64_tr_b16 a[160:161], v1 offset:28736
  v_mfma_f32_16x16x32_bf16 v[224:227], a[132:135], a[16:19], v[224:227]
  v_mfma_f32_16x16x32_bf16 v[228:231], a[132:135], a[20:23], 0
  ds_read_b64_tr_b16 a[162:163], v1 offset:32320
  v_mfma_f32_16x16x32_bf16 v[228:231], a[128:131], a[4:7], v[228:231]
  v_mfma_f32_16x16x32_bf16 v[232:235], a[128:131], a[8:11], 0
  ds_read_b64_tr_b16 a[164:165], v1 offset:35904
  v_mfma_f32_16x16x32_bf16 v[232:235], a[132:135], a[24:27], v[232:235]
  buffer_load_dwordx4 a[76:79], v0, s[36:39], s11 offen offset:3072 sc1
  v_mfma_f32_16x16x32_bf16 v[236:239], a[132:135], a[28:31], 0
  ds_read_b64_tr_b16 a[166:167], v1 offset:39488
  v_mfma_f32_16x16x32_bf16 v[236:239], a[128:131], a[12:15], v[236:239]
  v_mfma_f32_16x16x32_bf16 v[252:255], a[136:139], a[12:15], 0
  ds_read_b64_tr_b16 a[168:169], v1 offset:28768
  v_mfma_f32_16x16x32_bf16 v[252:255], a[140:143], a[28:31], v[252:255]
  s_bfe_u32 s10, s82, 0x4000c
  s_mul_i32 s10, s10, 458752
  s_add_u32 m0, s79, 86016
  v_mfma_f32_16x16x32_bf16 v[248:251], a[140:143], a[24:27], 0
  ds_read_b64_tr_b16 a[170:171], v1 offset:32352
  v_mfma_f32_16x16x32_bf16 v[248:251], a[136:139], a[8:11], v[248:251]
  v_mfma_f32_16x16x32_bf16 v[244:247], a[136:139], a[4:7], 0
  ds_read_b64_tr_b16 a[172:173], v1 offset:35936
  v_mfma_f32_16x16x32_bf16 v[244:247], a[140:143], a[20:23], v[244:247]
  buffer_load_dwordx4 v3, s[16:19], s10 offen offset:0 lds
  v_mfma_f32_16x16x32_bf16 v[240:243], a[140:143], a[16:19], 0
  ds_read_b64_tr_b16 a[174:175], v1 offset:39520
  v_mfma_f32_16x16x32_bf16 v[240:243], a[136:139], a[0:3], v[240:243]
  s_waitcnt vmcnt(8) lgkmcnt(8)
  v_mfma_f32_16x16x32_bf16 v[32:35], a[144:147], a[32:35], v[32:35]
  s_add_u32 s11, s11, 4096
  ds_read_b64_tr_b16 a[128:129], v1 offset:28800
  v_mfma_f32_16x16x32_bf16 v[32:35], a[148:151], a[48:51], v[32:35]
  s_barrier
  v_mfma_f32_16x16x32_bf16 v[36:39], a[148:151], a[52:55], v[36:39]
  ds_read_b64_tr_b16 a[130:131], v1 offset:32384
  v_mfma_f32_16x16x32_bf16 v[36:39], a[144:147], a[36:39], v[36:39]
  v_mfma_f32_16x16x32_bf16 v[40:43], a[144:147], a[40:43], v[40:43]
  buffer_load_dwordx4 a[80:83], v0, s[36:39], s11 offen offset:0 sc1
  ds_read_b64_tr_b16 a[132:133], v1 offset:35968
  v_mfma_f32_16x16x32_bf16 v[40:43], a[148:151], a[56:59], v[40:43]
  v_mfma_f32_16x16x32_bf16 v[44:47], a[148:151], a[60:63], v[44:47]
  ds_read_b64_tr_b16 a[134:135], v1 offset:39552
  v_mfma_f32_16x16x32_bf16 v[44:47], a[144:147], a[44:47], v[44:47]
  v_mfma_f32_16x16x32_bf16 v[60:63], a[152:155], a[44:47], v[60:63]
  ds_read_b64_tr_b16 a[136:137], v1 offset:28832
  v_mfma_f32_16x16x32_bf16 v[60:63], a[156:159], a[60:63], v[60:63]
  v_mfma_f32_16x16x32_bf16 v[56:59], a[156:159], a[56:59], v[56:59]
  ds_read_b64_tr_b16 a[138:139], v1 offset:32416
  v_mfma_f32_16x16x32_bf16 v[56:59], a[152:155], a[40:43], v[56:59]
  buffer_load_dwordx4 v4, s[16:19], s10 offen offset:1024 lds
  v_mfma_f32_16x16x32_bf16 v[52:55], a[152:155], a[36:39], v[52:55]
  ds_read_b64_tr_b16 a[140:141], v1 offset:36000
  v_mfma_f32_16x16x32_bf16 v[52:55], a[156:159], a[52:55], v[52:55]
  v_mfma_f32_16x16x32_bf16 v[48:51], a[156:159], a[48:51], v[48:51]
  ds_read_b64_tr_b16 a[142:143], v1 offset:39584
  v_mfma_f32_16x16x32_bf16 v[48:51], a[152:155], a[32:35], v[48:51]
  s_waitcnt lgkmcnt(8)
  v_mfma_f32_16x16x32_bf16 v[64:67], a[160:163], a[32:35], v[64:67]
  ds_read_b64_tr_b16 a[144:145], v1 offset:28864
  v_mfma_f32_16x16x32_bf16 v[64:67], a[164:167], a[48:51], v[64:67]
  v_mfma_f32_16x16x32_bf16 v[68:71], a[164:167], a[52:55], v[68:71]
  ds_read_b64_tr_b16 a[146:147], v1 offset:32448
  v_mfma_f32_16x16x32_bf16 v[68:71], a[160:163], a[36:39], v[68:71]
  buffer_load_dwordx4 a[84:87], v0, s[36:39], s11 offen offset:1024 sc1
  v_mfma_f32_16x16x32_bf16 v[72:75], a[160:163], a[40:43], v[72:75]
  ds_read_b64_tr_b16 a[148:149], v1 offset:36032
  v_mfma_f32_16x16x32_bf16 v[72:75], a[164:167], a[56:59], v[72:75]
  v_mfma_f32_16x16x32_bf16 v[76:79], a[164:167], a[60:63], v[76:79]
  ds_read_b64_tr_b16 a[150:151], v1 offset:39616
  v_mfma_f32_16x16x32_bf16 v[76:79], a[160:163], a[44:47], v[76:79]
  v_mfma_f32_16x16x32_bf16 v[92:95], a[168:171], a[44:47], v[92:95]
  ds_read_b64_tr_b16 a[152:153], v1 offset:43008
  v_mfma_f32_16x16x32_bf16 v[92:95], a[172:175], a[60:63], v[92:95]
  v_mfma_f32_16x16x32_bf16 v[88:91], a[172:175], a[56:59], v[88:91]
  buffer_load_dwordx4 v5, s[16:19], s10 offen offset:2048 lds
  ds_read_b64_tr_b16 a[154:155], v1 offset:46592
  v_mfma_f32_16x16x32_bf16 v[88:91], a[168:171], a[40:43], v[88:91]
  v_mfma_f32_16x16x32_bf16 v[84:87], a[168:171], a[36:39], v[84:87]
  ds_read_b64_tr_b16 a[156:157], v1 offset:50176
  v_mfma_f32_16x16x32_bf16 v[84:87], a[172:175], a[52:55], v[84:87]
  v_mfma_f32_16x16x32_bf16 v[80:83], a[172:175], a[48:51], v[80:83]
  ds_read_b64_tr_b16 a[158:159], v1 offset:53760
  v_mfma_f32_16x16x32_bf16 v[80:83], a[168:171], a[32:35], v[80:83]
  s_waitcnt lgkmcnt(8)
  v_mfma_f32_16x16x32_bf16 v[96:99], a[128:131], a[32:35], v[96:99]
  ds_read_b64_tr_b16 a[160:161], v1 offset:43040
  v_mfma_f32_16x16x32_bf16 v[96:99], a[132:135], a[48:51], v[96:99]
  v_mfma_f32_16x16x32_bf16 v[100:103], a[132:135], a[52:55], v[100:103]
  buffer_load_dwordx4 a[88:91], v0, s[36:39], s11 offen offset:2048 sc1
  ds_read_b64_tr_b16 a[162:163], v1 offset:46624
  v_mfma_f32_16x16x32_bf16 v[100:103], a[128:131], a[36:39], v[100:103]
  v_mfma_f32_16x16x32_bf16 v[104:107], a[128:131], a[40:43], v[104:107]
  ds_read_b64_tr_b16 a[164:165], v1 offset:50208
  v_mfma_f32_16x16x32_bf16 v[104:107], a[132:135], a[56:59], v[104:107]
  v_mfma_f32_16x16x32_bf16 v[108:111], a[132:135], a[60:63], v[108:111]
  ds_read_b64_tr_b16 a[166:167], v1 offset:53792
  v_mfma_f32_16x16x32_bf16 v[108:111], a[128:131], a[44:47], v[108:111]
  v_mfma_f32_16x16x32_bf16 v[124:127], a[136:139], a[44:47], v[124:127]
  ds_read_b64_tr_b16 a[168:169], v1 offset:43072
  v_mfma_f32_16x16x32_bf16 v[124:127], a[140:143], a[60:63], v[124:127]
  buffer_load_dwordx4 v6, s[16:19], s10 offen offset:3072 lds
  v_mfma_f32_16x16x32_bf16 v[120:123], a[140:143], a[56:59], v[120:123]
  ds_read_b64_tr_b16 a[170:171], v1 offset:46656
  v_mfma_f32_16x16x32_bf16 v[120:123], a[136:139], a[40:43], v[120:123]
  v_mfma_f32_16x16x32_bf16 v[116:119], a[136:139], a[36:39], v[116:119]
  ds_read_b64_tr_b16 a[172:173], v1 offset:50240
  v_mfma_f32_16x16x32_bf16 v[116:119], a[140:143], a[52:55], v[116:119]
  v_mfma_f32_16x16x32_bf16 v[112:115], a[140:143], a[48:51], v[112:115]
  ds_read_b64_tr_b16 a[174:175], v1 offset:53824
  v_mfma_f32_16x16x32_bf16 v[112:115], a[136:139], a[32:35], v[112:115]
  s_waitcnt lgkmcnt(8)
  v_mfma_f32_16x16x32_bf16 v[128:131], a[144:147], a[32:35], v[128:131]
  ds_read_b64_tr_b16 a[128:129], v1 offset:43104
  v_mfma_f32_16x16x32_bf16 v[128:131], a[148:151], a[48:51], v[128:131]
  buffer_load_dwordx4 a[92:95], v0, s[36:39], s11 offen offset:3072 sc1
  v_mfma_f32_16x16x32_bf16 v[132:135], a[148:151], a[52:55], v[132:135]
  ds_read_b64_tr_b16 a[130:131], v1 offset:46688
  v_mfma_f32_16x16x32_bf16 v[132:135], a[144:147], a[36:39], v[132:135]
  v_mfma_f32_16x16x32_bf16 v[136:139], a[144:147], a[40:43], v[136:139]
  s_add_u32 m0, s79, 90112
  ds_read_b64_tr_b16 a[132:133], v1 offset:50272
  v_mfma_f32_16x16x32_bf16 v[136:139], a[148:151], a[56:59], v[136:139]
  v_mfma_f32_16x16x32_bf16 v[140:143], a[148:151], a[60:63], v[140:143]
  ds_read_b64_tr_b16 a[134:135], v1 offset:53856
  v_mfma_f32_16x16x32_bf16 v[140:143], a[144:147], a[44:47], v[140:143]
  v_mfma_f32_16x16x32_bf16 v[156:159], a[152:155], a[44:47], v[156:159]
  buffer_load_dwordx4 v7, s[16:19], s10 offen offset:0 lds
  s_bfe_u32 s11, s82, 0x4000c
  v_mfma_f32_16x16x32_bf16 v[156:159], a[156:159], a[60:63], v[156:159]
  s_lshl_b32 s11, s11, 13
  s_add_u32 s11, s11, s84
  ds_read_b64_tr_b16 a[136:137], v1 offset:43136
  v_mfma_f32_16x16x32_bf16 v[152:155], a[156:159], a[56:59], v[152:155]
  ds_read_b64_tr_b16 a[138:139], v1 offset:46720
  v_mfma_f32_16x16x32_bf16 v[152:155], a[152:155], a[40:43], v[152:155]
  v_mfma_f32_16x16x32_bf16 v[148:151], a[152:155], a[36:39], v[148:151]
  ds_read_b64_tr_b16 a[140:141], v1 offset:50304
  v_mfma_f32_16x16x32_bf16 v[148:151], a[156:159], a[52:55], v[148:151]
  buffer_load_dwordx4 a[96:99], v0, s[36:39], s11 offen offset:0 sc1
  v_mfma_f32_16x16x32_bf16 v[144:147], a[156:159], a[48:51], v[144:147]
  ds_read_b64_tr_b16 a[142:143], v1 offset:53888
  v_mfma_f32_16x16x32_bf16 v[144:147], a[152:155], a[32:35], v[144:147]
  s_waitcnt lgkmcnt(8)
  v_mfma_f32_16x16x32_bf16 v[160:163], a[160:163], a[32:35], v[160:163]
  ds_read_b64_tr_b16 a[144:145], v1 offset:43168
  v_mfma_f32_16x16x32_bf16 v[160:163], a[164:167], a[48:51], v[160:163]
  v_mfma_f32_16x16x32_bf16 v[164:167], a[164:167], a[52:55], v[164:167]
  ds_read_b64_tr_b16 a[146:147], v1 offset:46752
  v_mfma_f32_16x16x32_bf16 v[164:167], a[160:163], a[36:39], v[164:167]
  v_mfma_f32_16x16x32_bf16 v[168:171], a[160:163], a[40:43], v[168:171]
  ds_read_b64_tr_b16 a[148:149], v1 offset:50336
  v_mfma_f32_16x16x32_bf16 v[168:171], a[164:167], a[56:59], v[168:171]
  v_mfma_f32_16x16x32_bf16 v[172:175], a[164:167], a[60:63], v[172:175]
  ds_read_b64_tr_b16 a[150:151], v1 offset:53920
  v_mfma_f32_16x16x32_bf16 v[172:175], a[160:163], a[44:47], v[172:175]
  s_waitcnt vmcnt(12)
  s_barrier
  buffer_load_dwordx4 v8, s[16:19], s10 offen offset:1024 lds
  v_mfma_f32_16x16x32_bf16 v[188:191], a[168:171], a[44:47], v[188:191]
  ds_read_b64_tr_b16 a[152:153], v1 offset:43200
  v_mfma_f32_16x16x32_bf16 v[188:191], a[172:175], a[60:63], v[188:191]
  v_mfma_f32_16x16x32_bf16 v[184:187], a[172:175], a[56:59], v[184:187]
  ds_read_b64_tr_b16 a[154:155], v1 offset:46784
  v_mfma_f32_16x16x32_bf16 v[184:187], a[168:171], a[40:43], v[184:187]
  v_mfma_f32_16x16x32_bf16 v[180:183], a[168:171], a[36:39], v[180:183]
  buffer_load_dwordx4 a[100:103], v0, s[36:39], s11 offen offset:1024 sc1
  ds_read_b64_tr_b16 a[156:157], v1 offset:50368
  v_mfma_f32_16x16x32_bf16 v[180:183], a[172:175], a[52:55], v[180:183]
  v_mfma_f32_16x16x32_bf16 v[176:179], a[172:175], a[48:51], v[176:179]
  ds_read_b64_tr_b16 a[158:159], v1 offset:53952
  v_mfma_f32_16x16x32_bf16 v[176:179], a[168:171], a[32:35], v[176:179]
  s_waitcnt lgkmcnt(8)
  v_mfma_f32_16x16x32_bf16 v[192:195], a[128:131], a[32:35], v[192:195]
  ds_read_b64_tr_b16 a[160:161], v2 offset:0
  v_mfma_f32_16x16x32_bf16 v[192:195], a[132:135], a[48:51], v[192:195]
  v_mfma_f32_16x16x32_bf16 v[196:199], a[132:135], a[52:55], v[196:199]
  ds_read_b64_tr_b16 a[162:163], v2 offset:3584
  v_mfma_f32_16x16x32_bf16 v[196:199], a[128:131], a[36:39], v[196:199]
  v_mfma_f32_16x16x32_bf16 v[200:203], a[128:131], a[40:43], v[200:203]
  ds_read_b64_tr_b16 a[164:165], v2 offset:7168
  v_mfma_f32_16x16x32_bf16 v[200:203], a[132:135], a[56:59], v[200:203]
  v_mfma_f32_16x16x32_bf16 v[204:207], a[132:135], a[60:63], v[204:207]
  buffer_load_dwordx4 v9, s[16:19], s10 offen offset:2048 lds
  ds_read_b64_tr_b16 a[166:167], v2 offset:10752
  v_mfma_f32_16x16x32_bf16 v[204:207], a[128:131], a[44:47], v[204:207]
  v_mfma_f32_16x16x32_bf16 v[220:223], a[136:139], a[44:47], v[220:223]
  ds_read_b64_tr_b16 a[168:169], v2 offset:32
  v_mfma_f32_16x16x32_bf16 v[220:223], a[140:143], a[60:63], v[220:223]
  v_mfma_f32_16x16x32_bf16 v[216:219], a[140:143], a[56:59], v[216:219]
  ds_read_b64_tr_b16 a[170:171], v2 offset:3616
  v_mfma_f32_16x16x32_bf16 v[216:219], a[136:139], a[40:43], v[216:219]
  buffer_load_dwordx4 a[104:107], v0, s[36:39], s11 offen offset:2048 sc1
  v_mfma_f32_16x16x32_bf16 v[212:215], a[136:139], a[36:39], v[212:215]
  ds_read_b64_tr_b16 a[172:173], v2 offset:7200
  v_mfma_f32_16x16x32_bf16 v[212:215], a[140:143], a[52:55], v[212:215]
  v_mfma_f32_16x16x32_bf16 v[208:211], a[140:143], a[48:51], v[208:211]
  ds_read_b64_tr_b16 a[174:175], v2 offset:10784
  v_mfma_f32_16x16x32_bf16 v[208:211], a[136:139], a[32:35], v[208:211]
  s_waitcnt lgkmcnt(8)
  v_mfma_f32_16x16x32_bf16 v[224:227], a[144:147], a[32:35], v[224:227]
  ds_read_b64_tr_b16 a[128:129], v2 offset:64
  v_mfma_f32_16x16x32_bf16 v[224:227], a[148:151], a[48:51], v[224:227]
  v_mfma_f32_16x16x32_bf16 v[228:231], a[148:151], a[52:55], v[228:231]
  ds_read_b64_tr_b16 a[130:131], v2 offset:3648
  v_mfma_f32_16x16x32_bf16 v[228:231], a[144:147], a[36:39], v[228:231]
  v_mfma_f32_16x16x32_bf16 v[232:235], a[144:147], a[40:43], v[232:235]
  ds_read_b64_tr_b16 a[132:133], v2 offset:7232
  v_mfma_f32_16x16x32_bf16 v[232:235], a[148:151], a[56:59], v[232:235]
  buffer_load_dwordx4 a[108:111], v0, s[36:39], s11 offen offset:3072 sc1
  v_mfma_f32_16x16x32_bf16 v[236:239], a[148:151], a[60:63], v[236:239]
  ds_read_b64_tr_b16 a[134:135], v2 offset:10816
  v_mfma_f32_16x16x32_bf16 v[236:239], a[144:147], a[44:47], v[236:239]
  v_mfma_f32_16x16x32_bf16 v[252:255], a[152:155], a[44:47], v[252:255]
  ds_read_b64_tr_b16 a[136:137], v2 offset:96
  v_mfma_f32_16x16x32_bf16 v[252:255], a[156:159], a[60:63], v[252:255]
  s_bfe_u32 s10, s82, 0x40010
  s_mul_i32 s10, s10, 458752
  s_add_u32 m0, s79, 0
  v_mfma_f32_16x16x32_bf16 v[248:251], a[156:159], a[56:59], v[248:251]
  ds_read_b64_tr_b16 a[138:139], v2 offset:3680
  v_mfma_f32_16x16x32_bf16 v[248:251], a[152:155], a[40:43], v[248:251]
  v_mfma_f32_16x16x32_bf16 v[244:247], a[152:155], a[36:39], v[244:247]
  ds_read_b64_tr_b16 a[140:141], v2 offset:7264
  v_mfma_f32_16x16x32_bf16 v[244:247], a[156:159], a[52:55], v[244:247]
  buffer_load_dwordx4 v3, s[16:19], s10 offen offset:0 lds
  v_mfma_f32_16x16x32_bf16 v[240:243], a[156:159], a[48:51], v[240:243]
  ds_read_b64_tr_b16 a[142:143], v2 offset:10848
  v_mfma_f32_16x16x32_bf16 v[240:243], a[152:155], a[32:35], v[240:243]
  s_waitcnt vmcnt(8) lgkmcnt(8)
  v_mfma_f32_16x16x32_bf16 v[32:35], a[160:163], a[64:67], v[32:35]
  s_add_u32 s11, s11, 4096
  ds_read_b64_tr_b16 a[144:145], v2 offset:128
  v_mfma_f32_16x16x32_bf16 v[32:35], a[164:167], a[80:83], v[32:35]
  s_barrier
  v_mfma_f32_16x16x32_bf16 v[36:39], a[164:167], a[84:87], v[36:39]
  ds_read_b64_tr_b16 a[146:147], v2 offset:3712
  v_mfma_f32_16x16x32_bf16 v[36:39], a[160:163], a[68:71], v[36:39]
  v_mfma_f32_16x16x32_bf16 v[40:43], a[160:163], a[72:75], v[40:43]
  buffer_load_dwordx4 a[112:115], v0, s[36:39], s11 offen offset:0 sc1
  ds_read_b64_tr_b16 a[148:149], v2 offset:7296
  v_mfma_f32_16x16x32_bf16 v[40:43], a[164:167], a[88:91], v[40:43]
  v_mfma_f32_16x16x32_bf16 v[44:47], a[164:167], a[92:95], v[44:47]
  ds_read_b64_tr_b16 a[150:151], v2 offset:10880
  v_mfma_f32_16x16x32_bf16 v[44:47], a[160:163], a[76:79], v[44:47]
  v_mfma_f32_16x16x32_bf16 v[60:63], a[168:171], a[76:79], v[60:63]
  ds_read_b64_tr_b16 a[152:153], v2 offset:160
  v_mfma_f32_16x16x32_bf16 v[60:63], a[172:175], a[92:95], v[60:63]
  v_mfma_f32_16x16x32_bf16 v[56:59], a[172:175], a[88:91], v[56:59]
  ds_read_b64_tr_b16 a[154:155], v2 offset:3744
  v_mfma_f32_16x16x32_bf16 v[56:59], a[168:171], a[72:75], v[56:59]
  buffer_load_dwordx4 v4, s[16:19], s10 offen offset:1024 lds
  v_mfma_f32_16x16x32_bf16 v[52:55], a[168:171], a[68:71], v[52:55]
  ds_read_b64_tr_b16 a[156:157], v2 offset:7328
  v_mfma_f32_16x16x32_bf16 v[52:55], a[172:175], a[84:87], v[52:55]
  v_mfma_f32_16x16x32_bf16 v[48:51], a[172:175], a[80:83], v[48:51]
  ds_read_b64_tr_b16 a[158:159], v2 offset:10912
  v_mfma_f32_16x16x32_bf16 v[48:51], a[168:171], a[64:67], v[48:51]
  s_waitcnt lgkmcnt(8)
  v_mfma_f32_16x16x32_bf16 v[64:67], a[128:131], a[64:67], v[64:67]
  ds_read_b64_tr_b16 a[160:161], v2 offset:192
  v_mfma_f32_16x16x32_bf16 v[64:67], a[132:135], a[80:83], v[64:67]
  v_mfma_f32_16x16x32_bf16 v[68:71], a[132:135], a[84:87], v[68:71]
  ds_read_b64_tr_b16 a[162:163], v2 offset:3776
  v_mfma_f32_16x16x32_bf16 v[68:71], a[128:131], a[68:71], v[68:71]
  buffer_load_dwordx4 a[116:119], v0, s[36:39], s11 offen offset:1024 sc1
  v_mfma_f32_16x16x32_bf16 v[72:75], a[128:131], a[72:75], v[72:75]
  ds_read_b64_tr_b16 a[164:165], v2 offset:7360
  v_mfma_f32_16x16x32_bf16 v[72:75], a[132:135], a[88:91], v[72:75]
  v_mfma_f32_16x16x32_bf16 v[76:79], a[132:135], a[92:95], v[76:79]
  s_lshl2_add_u32 s28, s56, s44
  ds_read_b64_tr_b16 a[166:167], v2 offset:10944
  s_lshl_b32 s28, s28, 13
  v_mfma_f32_16x16x32_bf16 v[76:79], a[128:131], a[76:79], v[76:79]
  s_add_u32 s28, s28, 262144
  s_add_u32 s29, s28, 4096
  v_mfma_f32_16x16x32_bf16 v[92:95], a[136:139], a[76:79], v[92:95]
  ds_read_b64_tr_b16 a[168:169], v2 offset:14336
  buffer_load_dwordx4 a[176:179], v0, s[36:39], s28 offen offset:0 sc1
  v_mfma_f32_16x16x32_bf16 v[92:95], a[140:143], a[92:95], v[92:95]
  v_mfma_f32_16x16x32_bf16 v[88:91], a[140:143], a[88:91], v[88:91]
  ds_read_b64_tr_b16 a[170:171], v2 offset:17920
  v_mfma_f32_16x16x32_bf16 v[88:91], a[136:139], a[72:75], v[88:91]
  v_mfma_f32_16x16x32_bf16 v[84:87], a[136:139], a[68:71], v[84:87]
  ds_read_b64_tr_b16 a[172:173], v2 offset:21504
  v_mfma_f32_16x16x32_bf16 v[84:87], a[140:143], a[84:87], v[84:87]
  buffer_load_dwordx4 v5, s[16:19], s10 offen offset:2048 lds
  v_mfma_f32_16x16x32_bf16 v[80:83], a[140:143], a[80:83], v[80:83]
  ds_read_b64_tr_b16 a[174:175], v2 offset:25088
  v_mfma_f32_16x16x32_bf16 v[80:83], a[136:139], a[64:67], v[80:83]
  s_waitcnt lgkmcnt(8)
  v_mfma_f32_16x16x32_bf16 v[96:99], a[144:147], a[64:67], v[96:99]
  ds_read_b64_tr_b16 a[128:129], v2 offset:14368
  v_mfma_f32_16x16x32_bf16 v[96:99], a[148:151], a[80:83], v[96:99]
  v_mfma_f32_16x16x32_bf16 v[100:103], a[148:151], a[84:87], v[100:103]
  buffer_load_dwordx4 a[120:123], v0, s[36:39], s11 offen offset:2048 sc1
  ds_read_b64_tr_b16 a[130:131], v2 offset:17952
  v_mfma_f32_16x16x32_bf16 v[100:103], a[144:147], a[68:71], v[100:103]
  v_mfma_f32_16x16x32_bf16 v[104:107], a[144:147], a[72:75], v[104:107]
  ds_read_b64_tr_b16 a[132:133], v2 offset:21536
  v_mfma_f32_16x16x32_bf16 v[104:107], a[148:151], a[88:91], v[104:107]
  v_mfma_f32_16x16x32_bf16 v[108:111], a[148:151], a[92:95], v[108:111]
  ds_read_b64_tr_b16 a[134:135], v2 offset:25120
  v_mfma_f32_16x16x32_bf16 v[108:111], a[144:147], a[76:79], v[108:111]
  buffer_load_dwordx4 a[180:183], v0, s[36:39], s28 offen offset:1024 sc1
  v_mfma_f32_16x16x32_bf16 v[124:127], a[152:155], a[76:79], v[124:127]
  ds_read_b64_tr_b16 a[136:137], v2 offset:14400
  v_mfma_f32_16x16x32_bf16 v[124:127], a[156:159], a[92:95], v[124:127]
  v_mfma_f32_16x16x32_bf16 v[120:123], a[156:159], a[88:91], v[120:123]
  ds_read_b64_tr_b16 a[138:139], v2 offset:17984
  v_mfma_f32_16x16x32_bf16 v[120:123], a[152:155], a[72:75], v[120:123]
  v_mfma_f32_16x16x32_bf16 v[116:119], a[152:155], a[68:71], v[116:119]
  buffer_load_dwordx4 v6, s[16:19], s10 offen offset:3072 lds
  ds_read_b64_tr_b16 a[140:141], v2 offset:21568
  v_mfma_f32_16x16x32_bf16 v[116:119], a[156:159], a[84:87], v[116:119]
  v_mfma_f32_16x16x32_bf16 v[112:115], a[156:159], a[80:83], v[112:115]
  ds_read_b64_tr_b16 a[142:143], v2 offset:25152
CT10:
  s_add_u32 s94, s92, CT10-k3_main_kernel+3072
  s_addc_u32 s95, s93, 0
  v_mfma_f32_16x16x32_bf16 v[112:115], a[152:155], a[64:67], v[112:115]
  s_waitcnt lgkmcnt(8)
  v_mfma_f32_16x16x32_bf16 v[128:131], a[160:163], a[64:67], v[128:131]
  ds_read_b64_tr_b16 a[144:145], v2 offset:14432
  v_mfma_f32_16x16x32_bf16 v[128:131], a[164:167], a[80:83], v[128:131]
  global_load_dword a252, v0, s[94:95]
  v_mfma_f32_16x16x32_bf16 v[132:135], a[164:167], a[84:87], v[132:135]
  ds_read_b64_tr_b16 a[146:147], v2 offset:18016
  v_mfma_f32_16x16x32_bf16 v[132:135], a[160:163], a[68:71], v[132:135]
  v_mfma_f32_16x16x32_bf16 v[136:139], a[160:163], a[72:75], v[136:139]
  ds_read_b64_tr_b16 a[148:149], v2 offset:21600
  v_mfma_f32_16x16x32_bf16 v[136:139], a[164:167], a[88:91], v[136:139]
  v_mfma_f32_16x16x32_bf16 v[140:143], a[164:167], a[92:95], v[140:143]
  buffer_load_dwordx4 a[124:127], v0, s[36:39], s11 offen offset:3072 sc1
  s_add_u32 m0, s79, 4096
  v_mfma_f32_16x16x32_bf16 v[140:143], a[160:163], a[76:79], v[140:143]
  ds_read_b64_tr_b16 a[150:151], v2 offset:25184
  v_mfma_f32_16x16x32_bf16 v[156:159], a[168:171], a[76:79], v[156:159]
  ds_read_b64_tr_b16 a[152:153], v2 offset:14464
  v_mfma_f32_16x16x32_bf16 v[156:159], a[172:175], a[92:95], v[156:159]
  v_mfma_f32_16x16x32_bf16 v[152:155], a[172:175], a[88:91], v[152:155]
  ds_read_b64_tr_b16 a[154:155], v2 offset:18048
  v_mfma_f32_16x16x32_bf16 v[152:155], a[168:171], a[72:75], v[152:155]
  buffer_load_dwordx4 v7, s[16:19], s10 offen offset:0 lds
  s_bfe_u32 s11, s82, 0x40010
  v_mfma_f32_16x16x32_bf16 v[148:151], a[168:171], a[68:71], v[148:151]
  s_lshl_b32 s11, s11, 13
  s_add_u32 s11, s11, s84
  ds_read_b64_tr_b16 a[156:157], v2 offset:21632
  v_mfma_f32_16x16x32_bf16 v[148:151], a[172:175], a[84:87], v[148:151]
  v_mfma_f32_16x16x32_bf16 v[144:147], a[172:175], a[80:83], v[144:147]
  ds_read_b64_tr_b16 a[158:159], v2 offset:25216
  v_mfma_f32_16x16x32_bf16 v[144:147], a[168:171], a[64:67], v[144:147]
  s_waitcnt lgkmcnt(8)
  v_mfma_f32_16x16x32_bf16 v[160:163], a[128:131], a[64:67], v[160:163]
  buffer_load_dwordx4 a[0:3], v0, s[36:39], s11 offen offset:0 sc1
  ds_read_b64_tr_b16 a[160:161], v2 offset:14496
  v_mfma_f32_16x16x32_bf16 v[160:163], a[132:135], a[80:83], v[160:163]
  v_mfma_f32_16x16x32_bf16 v[164:167], a[132:135], a[84:87], v[164:167]
  ds_read_b64_tr_b16 a[162:163], v2 offset:18080
  v_mfma_f32_16x16x32_bf16 v[164:167], a[128:131], a[68:71], v[164:167]
  v_mfma_f32_16x16x32_bf16 v[168:171], a[128:131], a[72:75], v[168:171]
  ds_read_b64_tr_b16 a[164:165], v2 offset:21664
  v_mfma_f32_16x16x32_bf16 v[168:171], a[132:135], a[88:91], v[168:171]
  buffer_load_dwordx4 a[184:187], v0, s[36:39], s28 offen offset:2048 sc1
  v_mfma_f32_16x16x32_bf16 v[172:175], a[132:135], a[92:95], v[172:175]
  ds_read_b64_tr_b16 a[166:167], v2 offset:25248
  v_mfma_f32_16x16x32_bf16 v[172:175], a[128:131], a[76:79], v[172:175]
  s_waitcnt vmcnt(16)
  s_barrier
  v_mfma_f32_16x16x32_bf16 v[188:191], a[136:139], a[76:79], v[188:191]
  ds_read_b64_tr_b16 a[168:169], v2 offset:14528
  v_mfma_f32_16x16x32_bf16 v[188:191], a[140:143], a[92:95], v[188:191]
  v_mfma_f32_16x16x32_bf16 v[184:187], a[140:143], a[88:91], v[184:187]
  buffer_load_dwordx4 v8, s[16:19], s10 offen offset:1024 lds
  ds_read_b64_tr_b16 a[170:171], v2 offset:18112
  v_mfma_f32_16x16x32_bf16 v[184:187], a[136:139], a[72:75], v[184:187]
  v_mfma_f32_16x16x32_bf16 v[180:183], a[136:139], a[68:71], v[180:183]
  ds_read_b64_tr_b16 a[172:173], v2 offset:21696
  v_mfma_f32_16x16x32_bf16 v[180:183], a[140:143], a[84:87], v[180:183]
  v_mfma_f32_16x16x32_bf16 v[176:179], a[140:143], a[80:83], v[176:179]
  ds_read_b64_tr_b16 a[174:175], v2 offset:25280
  v_mfma_f32_16x16x32_bf16 v[176:179], a[136:139], a[64:67], v[176:179]
  s_waitcnt lgkmcnt(8)
  buffer_load_dwordx4 a[4:7], v0, s[36:39], s11 offen offset:1024 sc1
  v_mfma_f32_16x16x32_bf16 v[192:195], a[144:147], a[64:67], v[192:195]
  ds_read_b64_tr_b16 a[128:129], v2 offset:28672
  v_mfma_f32_16x16x32_bf16 v[192:195], a[148:151], a[80:83], v[192:195]
  v_mfma_f32_16x16x32_bf16 v[196:199], a[148:151], a[84:87], v[196:199]
  ds_read_b64_tr_b16 a[130:131], v2 offset:32256
  v_mfma_f32_16x16x32_bf16 v[196:199], a[144:147], a[68:71], v[196:199]
  v_mfma_f32_16x16x32_bf16 v[200:203], a[144:147], a[72:75], v[200:203]
  ds_read_b64_tr_b16 a[132:133], v2 offset:35840
  buffer_load_dwordx4 a[188:191], v0, s[36:39], s28 offen offset:3072 sc1
  v_mfma_f32_16x16x32_bf16 v[200:203], a[148:151], a[88:91], v[200:203]
  v_mfma_f32_16x16x32_bf16 v[204:207], a[148:151], a[92:95], v[204:207]
  ds_read_b64_tr_b16 a[134:135], v2 offset:39424
  v_mfma_f32_16x16x32_bf16 v[204:207], a[144:147], a[76:79], v[204:207]
  v_mfma_f32_16x16x32_bf16 v[220:223], a[152:155], a[76:79], v[220:223]
  ds_read_b64_tr_b16 a[136:137], v2 offset:28704
  v_mfma_f32_16x16x32_bf16 v[220:223], a[156:159], a[92:95], v[220:223]
  buffer_load_dwordx4 v9, s[16:19], s10 offen offset:2048 lds
  v_mfma_f32_16x16x32_bf16 v[216:219], a[156:159], a[88:91], v[216:219]
  ds_read_b64_tr_b16 a[138:139], v2 offset:32288
  v_mfma_f32_16x16x32_bf16 v[216:219], a[152:155], a[72:75], v[216:219]
  v_mfma_f32_16x16x32_bf16 v[212:215], a[152:155], a[68:71], v[212:215]
  ds_read_b64_tr_b16 a[140:141], v2 offset:35872
  v_mfma_f32_16x16x32_bf16 v[212:215], a[156:159], a[84:87], v[212:215]
  v_mfma_f32_16x16x32_bf16 v[208:211], a[156:159], a[80:83], v[208:211]
  buffer_load_dwordx4 a[8:11], v0, s[36:39], s11 offen offset:2048 sc1
  ds_read_b64_tr_b16 a[142:143], v2 offset:39456
  v_mfma_f32_16x16x32_bf16 v[208:211], a[152:155], a[64:67], v[208:211]
  s_waitcnt lgkmcnt(8)
  v_mfma_f32_16x16x32_bf16 v[224:227], a[160:163], a[64:67], v[224:227]
  ds_read_b64_tr_b16 a[144:145], v2 offset:28736
  v_mfma_f32_16x16x32_bf16 v[224:227], a[164:167], a[80:83], v[224:227]
  v_mfma_f32_16x16x32_bf16 v[228:231], a[164:167], a[84:87], v[228:231]
  ds_read_b64_tr_b16 a[146:147], v2 offset:32320
  v_mfma_f32_16x16x32_bf16 v[228:231], a[160:163], a[68:71], v[228:231]
  buffer_load_dwordx4 a[192:195], v0, s[36:39], s29 offen offset:0 sc1
  v_mfma_f32_16x16x32_bf16 v[232:235], a[160:163], a[72:75], v[232:235]
  ds_read_b64_tr_b16 a[148:149], v2 offset:35904
  v_mfma_f32_16x16x32_bf16 v[232:235], a[164:167], a[88:91], v[232:235]
  v_mfma_f32_16x16x32_bf16 v[236:239], a[164:167], a[92:95], v[236:239]
  ds_read_b64_tr_b16 a[150:151], v2 offset:39488
  v_mfma_f32_16x16x32_bf16 v[236:239], a[160:163], a[76:79], v[236:239]
  v_mfma_f32_16x16x32_bf16 v[252:255], a[168:171], a[76:79], v[252:255]
  buffer_load_dwordx4 a[12:15], v0, s[36:39], s11 offen offset:3072 sc1
  ds_read_b64_tr_b16 a[152:153], v2 offset:28768
  v_mfma_f32_16x16x32_bf16 v[252:255], a[172:175], a[92:95], v[252:255]
  s_bfe_u32 s10, s82, 0x40014
  s_mul_i32 s10, s10, 458752
  s_add_u32 m0, s79, 28672
  v_mfma_f32_16x16x32_bf16 v[248:251], a[172:175], a[88:91], v[248:251]
  ds_read_b64_tr_b16 a[154:155], v2 offset:32352
  v_mfma_f32_16x16x32_bf16 v[248:251], a[168:171], a[72:75], v[248:251]
  v_mfma_f32_16x16x32_bf16 v[244:247], a[168:171], a[68:71], v[244:247]
  ds_read_b64_tr_b16 a[156:157], v2 offset:35936
  v_mfma_f32_16x16x32_bf16 v[244:247], a[172:175], a[84:87], v[244:247]
  buffer_load_dwordx4 v3, s[16:19], s10 offen offset:0 lds
  v_mfma_f32_16x16x32_bf16 v[240:243], a[172:175], a[80:83], v[240:243]
  ds_read_b64_tr_b16 a[158:159], v2 offset:39520
  v_mfma_f32_16x16x32_bf16 v[240:243], a[168:171], a[64:67], v[240:243]
  s_waitcnt vmcnt(11) lgkmcnt(8)
  v_mfma_f32_16x16x32_bf16 v[32:35], a[128:131], a[96:99], v[32:35]
  s_add_u32 s11, s11, 4096
  ds_read_b64_tr_b16 a[160:161], v2 offset:28800
  v_mfma_f32_16x16x32_bf16 v[32:35], a[132:135], a[112:115], v[32:35]
  s_barrier
  v_mfma_f32_16x16x32_bf16 v[36:39], a[132:135], a[116:119], v[36:39]
  ds_read_b64_tr_b16 a[162:163], v2 offset:32384
  buffer_load_dwordx4 a[196:199], v0, s[36:39], s29 offen offset:1024 sc1
  v_mfma_f32_16x16x32_bf16 v[36:39], a[128:131], a[100:103], v[36:39]
  v_mfma_f32_16x16x32_bf16 v[40:43], a[128:131], a[104:107], v[40:43]
  ds_read_b64_tr_b16 a[164:165], v2 offset:35968
  v_mfma_f32_16x16x32_bf16 v[40:43], a[132:135], a[120:123], v[40:43]
  v_mfma_f32_16x16x32_bf16 v[44:47], a[132:135], a[124:127], v[44:47]
  ds_read_b64_tr_b16 a[166:167], v2 offset:39552
  v_mfma_f32_16x16x32_bf16 v[44:47], a[128:131], a[108:111], v[44:47]
  buffer_load_dwordx4 a[16:19], v0, s[36:39], s11 offen offset:0 sc1
  v_mfma_f32_16x16x32_bf16 v[60:63], a[136:139], a[108:111], v[60:63]
  ds_read_b64_tr_b16 a[168:169], v2 offset:28832
  v_mfma_f32_16x16x32_bf16 v[60:63], a[140:143], a[124:127], v[60:63]
  v_mfma_f32_16x16x32_bf16 v[56:59], a[140:143], a[120:123], v[56:59]
  ds_read_b64_tr_b16 a[170:171], v2 offset:32416
  v_mfma_f32_16x16x32_bf16 v[56:59], a[136:139], a[104:107], v[56:59]
  v_mfma_f32_16x16x32_bf16 v[52:55], a[136:139], a[100:103], v[52:55]
  buffer_load_dwordx4 v4, s[16:19], s10 offen offset:1024 lds
  ds_read_b64_tr_b16 a[172:173], v2 offset:36000
  v_mfma_f32_16x16x32_bf16 v[52:55], a[140:143], a[116:119], v[52:55]
  v_mfma_f32_16x16x32_bf16 v[48:51], a[140:143], a[112:115], v[48:51]
  ds_read_b64_tr_b16 a[174:175], v2 offset:39584
  v_mfma_f32_16x16x32_bf16 v[48:51], a[136:139], a[96:99], v[48:51]
  s_waitcnt lgkmcnt(8)
  v_mfma_f32_16x16x32_bf16 v[64:67], a[144:147], a[96:99], v[64:67]
  ds_read_b64_tr_b16 a[128:129], v2 offset:28864
  v_mfma_f32_16x16x32_bf16 v[64:67], a[148:151], a[112:115], v[64:67]
  buffer_load_dwordx4 a[200:203], v0, s[36:39], s29 offen offset:2048 sc1
  v_mfma_f32_16x16x32_bf16 v[68:71], a[148:151], a[116:119], v[68:71]
  ds_read_b64_tr_b16 a[130:131], v2 offset:32448
  v_mfma_f32_16x16x32_bf16 v[68:71], a[144:147], a[100:103], v[68:71]
  v_mfma_f32_16x16x32_bf16 v[72:75], a[144:147], a[104:107], v[72:75]
  ds_read_b64_tr_b16 a[132:133], v2 offset:36032
  v_mfma_f32_16x16x32_bf16 v[72:75], a[148:151], a[120:123], v[72:75]
  v_mfma_f32_16x16x32_bf16 v[76:79], a[148:151], a[124:127], v[76:79]
  buffer_load_dwordx4 a[20:23], v0, s[36:39], s11 offen offset:1024 sc1
  ds_read_b64_tr_b16 a[134:135], v2 offset:39616
  v_mfma_f32_16x16x32_bf16 v[76:79], a[144:147], a[108:111], v[76:79]
  v_mfma_f32_16x16x32_bf16 v[92:95], a[152:155], a[108:111], v[92:95]
  ds_read_b64_tr_b16 a[136:137], v2 offset:43008
  v_mfma_f32_16x16x32_bf16 v[92:95], a[156:159], a[124:127], v[92:95]
  v_mfma_f32_16x16x32_bf16 v[88:91], a[156:159], a[120:123], v[88:91]
  ds_read_b64_tr_b16 a[138:139], v2 offset:46592
  v_mfma_f32_16x16x32_bf16 v[88:91], a[152:155], a[104:107], v[88:91]
  buffer_load_dwordx4 v5, s[16:19], s10 offen offset:2048 lds
  v_mfma_f32_16x16x32_bf16 v[84:87], a[152:155], a[100:103], v[84:87]
  ds_read_b64_tr_b16 a[140:141], v2 offset:50176
  v_mfma_f32_16x16x32_bf16 v[84:87], a[156:159], a[116:119], v[84:87]
  v_mfma_f32_16x16x32_bf16 v[80:83], a[156:159], a[112:115], v[80:83]
  ds_read_b64_tr_b16 a[142:143], v2 offset:53760
  v_mfma_f32_16x16x32_bf16 v[80:83], a[152:155], a[96:99], v[80:83]
  s_waitcnt lgkmcnt(8)
  v_mfma_f32_16x16x32_bf16 v[96:99], a[160:163], a[96:99], v[96:99]
  ds_read_b64_tr_b16 a[144:145], v2 offset:43040
  buffer_load_dwordx4 a[204:207], v0, s[36:39], s29 offen offset:3072 sc1
  v_mfma_f32_16x16x32_bf16 v[96:99], a[164:167], a[112:115], v[96:99]
  v_mfma_f32_16x16x32_bf16 v[100:103], a[164:167], a[116:119], v[100:103]
  ds_read_b64_tr_b16 a[146:147], v2 offset:46624
  v_mfma_f32_16x16x32_bf16 v[100:103], a[160:163], a[100:103], v[100:103]
  v_mfma_f32_16x16x32_bf16 v[104:107], a[160:163], a[104:107], v[104:107]
  ds_read_b64_tr_b16 a[148:149], v2 offset:50208
  v_mfma_f32_16x16x32_bf16 v[104:107], a[164:167], a[120:123], v[104:107]
  buffer_load_dwordx4 a[24:27], v0, s[36:39], s11 offen offset:2048 sc1
  v_mfma_f32_16x16x32_bf16 v[108:111], a[164:167], a[124:127], v[108:111]
  ds_read_b64_tr_b16 a[150:151], v2 offset:53792
  v_mfma_f32_16x16x32_bf16 v[108:111], a[160:163], a[108:111], v[108:111]
  v_mfma_f32_16x16x32_bf16 v[124:127], a[168:171], a[108:111], v[124:127]
  ds_read_b64_tr_b16 a[152:153], v2 offset:43072
  v_mfma_f32_16x16x32_bf16 v[124:127], a[172:175], a[124:127], v[124:127]
  v_mfma_f32_16x16x32_bf16 v[120:123], a[172:175], a[120:123], v[120:123]
  buffer_load_dwordx4 v6, s[16:19], s10 offen offset:3072 lds
  ds_read_b64_tr_b16 a[154:155], v2 offset:46656
  v_mfma_f32_16x16x32_bf16 v[120:123], a[168:171], a[104:107], v[120:123]
  v_mfma_f32_16x16x32_bf16 v[116:119], a[168:171], a[100:103], v[116:119]
  ds_read_b64_tr_b16 a[156:157], v2 offset:50240
  v_mfma_f32_16x16x32_bf16 v[116:119], a[172:175], a[116:119], v[116:119]
  v_mfma_f32_16x16x32_bf16 v[112:115], a[172:175], a[112:115], v[112:115]
  ds_read_b64_tr_b16 a[158:159], v2 offset:53824
  v_mfma_f32_16x16x32_bf16 v[112:115], a[168:171], a[96:99], v[112:115]
  s_waitcnt lgkmcnt(8)
  v_mfma_f32_16x16x32_bf16 v[128:131], a[128:131], a[96:99], v[128:131]
  ds_read_b64_tr_b16 a[160:161], v2 offset:43104
  v_mfma_f32_16x16x32_bf16 v[128:131], a[132:135], a[112:115], v[128:131]
  buffer_load_dwordx4 a[28:31], v0, s[36:39], s11 offen offset:3072 sc1
  v_mfma_f32_16x16x32_bf16 v[132:135], a[132:135], a[116:119], v[132:135]
  ds_read_b64_tr_b16 a[162:163], v2 offset:46688
  v_mfma_f32_16x16x32_bf16 v[132:135], a[128:131], a[100:103], v[132:135]
  v_mfma_f32_16x16x32_bf16 v[136:139], a[128:131], a[104:107], v[136:139]
  s_add_u32 m0, s79, 32768
  ds_read_b64_tr_b16 a[164:165], v2 offset:50272
  v_mfma_f32_16x16x32_bf16 v[136:139], a[132:135], a[120:123], v[136:139]
  v_mfma_f32_16x16x32_bf16 v[140:143], a[132:135], a[124:127], v[140:143]
  ds_read_b64_tr_b16 a[166:167], v2 offset:53856
  v_mfma_f32_16x16x32_bf16 v[140:143], a[128:131], a[108:111], v[140:143]
  v_mfma_f32_16x16x32_bf16 v[156:159], a[136:139], a[108:111], v[156:159]
  buffer_load_dwordx4 v7, s[16:19], s10 offen offset:0 lds
  s_bfe_u32 s11, s82, 0x40014
  v_mfma_f32_16x16x32_bf16 v[156:159], a[140:143], a[124:127], v[156:159]
  s_lshl_b32 s11, s11, 13
  s_add_u32 s11, s11, s84
  ds_read_b64_tr_b16 a[168:169], v2 offset:43136
  v_mfma_f32_16x16x32_bf16 v[152:155], a[140:143], a[120:123], v[152:155]
  ds_read_b64_tr_b16 a[170:171], v2 offset:46720
  v_mfma_f32_16x16x32_bf16 v[152:155], a[136:139], a[104:107], v[152:155]
  v_mfma_f32_16x16x32_bf16 v[148:151], a[136:139], a[100:103], v[148:151]
  ds_read_b64_tr_b16 a[172:173], v2 offset:50304
  v_mfma_f32_16x16x32_bf16 v[148:151], a[140:143], a[116:119], v[148:151]
  buffer_load_dwordx4 a[32:35], v0, s[36:39], s11 offen offset:0 sc1
  v_mfma_f32_16x16x32_bf16 v[144:147], a[140:143], a[112:115], v[144:147]
  ds_read_b64_tr_b16 a[174:175], v2 offset:53888
  v_mfma_f32_16x16x32_bf16 v[144:147], a[136:139], a[96:99], v[144:147]
  s_waitcnt lgkmcnt(8)
  v_mfma_f32_16x16x32_bf16 v[160:163], a[144:147], a[96:99], v[160:163]
  ds_read_b64_tr_b16 a[128:129], v2 offset:43168
  v_mfma_f32_16x16x32_bf16 v[160:163], a[148:151], a[112:115], v[160:163]
  v_mfma_f32_16x16x32_bf16 v[164:167], a[148:151], a[116:119], v[164:167]
  ds_read_b64_tr_b16 a[130:131], v2 offset:46752
  v_mfma_f32_16x16x32_bf16 v[164:167], a[144:147], a[100:103], v[164:167]
  v_mfma_f32_16x16x32_bf16 v[168:171], a[144:147], a[104:107], v[168:171]
  ds_read_b64_tr_b16 a[132:133], v2 offset:50336
  v_mfma_f32_16x16x32_bf16 v[168:171], a[148:151], a[120:123], v[168:171]
  v_mfma_f32_16x16x32_bf16 v[172:175], a[148:151], a[124:127], v[172:175]
  ds_read_b64_tr_b16 a[134:135], v2 offset:53920
  v_mfma_f32_16x16x32_bf16 v[172:175], a[144:147], a[108:111], v[172:175]
  s_waitcnt vmcnt(16)
  s_barrier
  buffer_load_dwordx4 v8, s[16:19], s10 offen offset:1024 lds
  v_mfma_f32_16x16x32_bf16 v[188:191], a[152:155], a[108:111], v[188:191]
  ds_read_b64_tr_b16 a[136:137], v2 offset:43200
  v_mfma_f32_16x16x32_bf16 v[188:191], a[156:159], a[124:127], v[188:191]
  v_mfma_f32_16x16x32_bf16 v[184:187], a[156:159], a[120:123], v[184:187]
  ds_read_b64_tr_b16 a[138:139], v2 offset:46784
  v_mfma_f32_16x16x32_bf16 v[184:187], a[152:155], a[104:107], v[184:187]
  v_mfma_f32_16x16x32_bf16 v[180:183], a[152:155], a[100:103], v[180:183]
  buffer_load_dwordx4 a[36:39], v0, s[36:39], s11 offen offset:1024 sc1
  ds_read_b64_tr_b16 a[140:141], v2 offset:50368
  v_mfma_f32_16x16x32_bf16 v[180:183], a[156:159], a[116:119], v[180:183]
  v_mfma_f32_16x16x32_bf16 v[176:179], a[156:159], a[112:115], v[176:179]
  ds_read_b64_tr_b16 a[142:143], v2 offset:53952
  v_mfma_f32_16x16x32_bf16 v[176:179], a[152:155], a[96:99], v[176:179]
  s_waitcnt lgkmcnt(8)
  v_mfma_f32_16x16x32_bf16 v[192:195], a[160:163], a[96:99], v[192:195]
  ds_read_b64_tr_b16 a[144:145], v1 offset:0
  v_mfma_f32_16x16x32_bf16 v[192:195], a[164:167], a[112:115], v[192:195]
  v_mfma_f32_16x16x32_bf16 v[196:199], a[164:167], a[116:119], v[196:199]
  ds_read_b64_tr_b16 a[146:147], v1 offset:3584
  v_mfma_f32_16x16x32_bf16 v[196:199], a[160:163], a[100:103], v[196:199]
  v_mfma_f32_16x16x32_bf16 v[200:203], a[160:163], a[104:107], v[200:203]
  ds_read_b64_tr_b16 a[148:149], v1 offset:7168
  v_mfma_f32_16x16x32_bf16 v[200:203], a[164:167], a[120:123], v[200:203]
  v_mfma_f32_16x16x32_bf16 v[204:207], a[164:167], a[124:127], v[204:207]
  buffer_load_dwordx4 v9, s[16:19], s10 offen offset:2048 lds
  ds_read_b64_tr_b16 a[150:151], v1 offset:10752
  v_mfma_f32_16x16x32_bf16 v[204:207], a[160:163], a[108:111], v[204:207]
  v_mfma_f32_16x16x32_bf16 v[220:223], a[168:171], a[108:111], v[220:223]
  ds_read_b64_tr_b16 a[152:153], v1 offset:32
  v_mfma_f32_16x16x32_bf16 v[220:223], a[172:175], a[124:127], v[220:223]
  v_mfma_f32_16x16x32_bf16 v[216:219], a[172:175], a[120:123], v[216:219]
  ds_read_b64_tr_b16 a[154:155], v1 offset:3616
  v_mfma_f32_16x16x32_bf16 v[216:219], a[168:171], a[104:107], v[216:219]
  buffer_load_dwordx4 a[40:43], v0, s[36:39], s11 offen offset:2048 sc1
  v_mfma_f32_16x16x32_bf16 v[212:215], a[168:171], a[100:103], v[212:215]
  ds_read_b64_tr_b16 a[156:157], v1 offset:7200
  v_mfma_f32_16x16x32_bf16 v[212:215], a[172:175], a[116:119], v[212:215]
  v_mfma_f32_16x16x32_bf16 v[208:211], a[172:175], a[112:115], v[208:211]
  ds_read_b64_tr_b16 a[158:159], v1 offset:10784
  v_mfma_f32_16x16x32_bf16 v[208:211], a[168:171], a[96:99], v[208:211]
  s_waitcnt lgkmcnt(8)
  v_mfma_f32_16x16x32_bf16 v[224:227], a[128:131], a[96:99], v[224:227]
  ds_read_b64_tr_b16 a[160:161], v1 offset:64
  v_mfma_f32_16x16x32_bf16 v[224:227], a[132:135], a[112:115], v[224:227]
  v_mfma_f32_16x16x32_bf16 v[228:231], a[132:135], a[116:119], v[228:231]
  ds_read_b64_tr_b16 a[162:163], v1 offset:3648
  v_mfma_f32_16x16x32_bf16 v[228:231], a[128:131], a[100:103], v[228:231]
  v_mfma_f32_16x16x32_bf16 v[232:235], a[128:131], a[104:107], v[232:235]
  ds_read_b64_tr_b16 a[164:165], v1 offset:7232
  v_mfma_f32_16x16x32_bf16 v[232:235], a[132:135], a[120:123], v[232:235]
  buffer_load_dwordx4 a[44:47], v0, s[36:39], s11 offen offset:3072 sc1
  v_mfma_f32_16x16x32_bf16 v[236:239], a[132:135], a[124:127], v[236:239]
  s_waitcnt vmcnt(10)
  ds_read_b64_tr_b16 a[166:167], v1 offset:10816
  v_accvgpr_read_b32 v22, a176
  v_mfma_f32_16x16x32_bf16 v[236:239], a[128:131], a[108:111], v[236:239]
  v_accvgpr_read_b32 v23, a177
  v_accvgpr_read_b32 v24, a178
  v_mfma_f32_16x16x32_bf16 v[252:255], a[136:139], a[108:111], v[252:255]
  ds_read_b64_tr_b16 a[168:169], v1 offset:96
  v_accvgpr_read_b32 v25, a179
  v_mfma_f32_16x16x32_bf16 v[252:255], a[140:143], a[124:127], v[252:255]
  s_bfe_u32 s10, s82, 0x40018
  s_mul_i32 s10, s10, 458752
  s_add_u32 m0, s79, 57344
  v_mfma_f32_16x16x32_bf16 v[248:251], a[140:143], a[120:123], v[248:251]
  ds_read_b64_tr_b16 a[170:171], v1 offset:3680
  v_accvgpr_read_b32 v26, a180
  v_mfma_f32_16x16x32_bf16 v[248:251], a[136:139], a[104:107], v[248:251]
  v_accvgpr_read_b32 v27, a181
  v_accvgpr_read_b32 v28, a182
  v_mfma_f32_16x16x32_bf16 v[244:247], a[136:139], a[100:103], v[244:247]
  ds_read_b64_tr_b16 a[172:173], v1 offset:7264
  v_accvgpr_read_b32 v29, a183
  v_mfma_f32_16x16x32_bf16 v[244:247], a[140:143], a[116:119], v[244:247]
  buffer_load_dwordx4 v3, s[16:19], s10 offen offset:0 lds
  v_add_f32 v22, v22, v26
  v_mfma_f32_16x16x32_bf16 v[240:243], a[140:143], a[112:115], v[240:243]
  ds_read_b64_tr_b16 a[174:175], v1 offset:10848
  v_add_f32 v23, v23, v27
  v_mfma_f32_16x16x32_bf16 v[240:243], a[136:139], a[96:99], v[240:243]
  s_waitcnt vmcnt(8) lgkmcnt(8)
  v_add_f32 v24, v24, v28
  v_add_f32 v25, v25, v29
  v_mfma_f32_16x16x32_bf16 v[32:35], a[144:147], a[0:3], v[32:35]
  s_add_u32 s11, s11, 4096
  ds_read_b64_tr_b16 a[128:129], v1 offset:128
  v_accvgpr_read_b32 v26, a184
  v_mfma_f32_16x16x32_bf16 v[32:35], a[148:151], a[16:19], v[32:35]
  s_barrier
  v_accvgpr_read_b32 v27, a185
  v_accvgpr_read_b32 v28, a186
  v_mfma_f32_16x16x32_bf16 v[36:39], a[148:151], a[20:23], v[36:39]
  ds_read_b64_tr_b16 a[130:131], v1 offset:3712
  v_accvgpr_read_b32 v29, a187
  v_mfma_f32_16x16x32_bf16 v[36:39], a[144:147], a[4:7], v[36:39]
  v_add_f32 v22, v22, v26
  v_add_f32 v23, v23, v27
  v_mfma_f32_16x16x32_bf16 v[40:43], a[144:147], a[8:11], v[40:43]
  buffer_load_dwordx4 a[48:51], v0, s[36:39], s11 offen offset:0 sc1
  ds_read_b64_tr_b16 a[132:133], v1 offset:7296
  v_mfma_f32_16x16x32_bf16 v[40:43], a[148:151], a[24:27], v[40:43]
  v_add_f32 v24, v24, v28
  v_add_f32 v25, v25, v29
  v_mfma_f32_16x16x32_bf16 v[44:47], a[148:151], a[28:31], v[44:47]
  ds_read_b64_tr_b16 a[134:135], v1 offset:10880
  v_accvgpr_read_b32 v26, a188
  v_mfma_f32_16x16x32_bf16 v[44:47], a[144:147], a[12:15], v[44:47]
  v_accvgpr_read_b32 v27, a189
  v_accvgpr_read_b32 v28, a190
  v_mfma_f32_16x16x32_bf16 v[60:63], a[152:155], a[12:15], v[60:63]
  ds_read_b64_tr_b16 a[136:137], v1 offset:160
  v_accvgpr_read_b32 v29, a191
  v_mfma_f32_16x16x32_bf16 v[60:63], a[156:159], a[28:31], v[60:63]
  v_add_f32 v22, v22, v26
  v_add_f32 v23, v23, v27
  v_mfma_f32_16x16x32_bf16 v[56:59], a[156:159], a[24:27], v[56:59]
  ds_read_b64_tr_b16 a[138:139], v1 offset:3744
  v_add_f32 v24, v24, v28
  v_mfma_f32_16x16x32_bf16 v[56:59], a[152:155], a[8:11], v[56:59]
  buffer_load_dwordx4 v4, s[16:19], s10 offen offset:1024 lds
  v_add_f32 v25, v25, v29
  v_mfma_f32_16x16x32_bf16 v[52:55], a[152:155], a[4:7], v[52:55]
  ds_read_b64_tr_b16 a[140:141], v1 offset:7328
  v_mov_b32 v26, v22
  v_mfma_f32_16x16x32_bf16 v[52:55], a[156:159], a[20:23], v[52:55]
  v_mov_b32 v27, v23
  v_mov_b32 v28, v24
  v_mfma_f32_16x16x32_bf16 v[48:51], a[156:159], a[16:19], v[48:51]
  ds_read_b64_tr_b16 a[142:143], v1 offset:10912
  v_mov_b32 v29, v25
  v_mfma_f32_16x16x32_bf16 v[48:51], a[152:155], a[0:3], v[48:51]
  s_waitcnt lgkmcnt(8)
  v_permlane16_swap_b32 v22, v26
  v_permlane16_swap_b32 v23, v27
  v_mfma_f32_16x16x32_bf16 v[64:67], a[160:163], a[0:3], v[64:67]
  ds_read_b64_tr_b16 a[144:145], v1 offset:192
  v_permlane16_swap_b32 v24, v28
  v_mfma_f32_16x16x32_bf16 v[64:67], a[164:167], a[16:19], v[64:67]
  v_permlane16_swap_b32 v25, v29
  v_add_f32 v22, v22, v26
  v_mfma_f32_16x16x32_bf16 v[68:71], a[164:167], a[20:23], v[68:71]
  ds_read_b64_tr_b16 a[146:147], v1 offset:3776
  v_add_f32 v23, v23, v27
  v_mfma_f32_16x16x32_bf16 v[68:71], a[160:163], a[4:7], v[68:71]
  buffer_load_dwordx4 a[52:55], v0, s[36:39], s11 offen offset:1024 sc1
  v_add_f32 v24, v24, v28
  v_mfma_f32_16x16x32_bf16 v[72:75], a[160:163], a[8:11], v[72:75]
  ds_read_b64_tr_b16 a[148:149], v1 offset:7360
  v_add_f32 v25, v25, v29
  v_mfma_f32_16x16x32_bf16 v[72:75], a[164:167], a[24:27], v[72:75]
  v_mov_b32 v26, v22
  v_mov_b32 v27, v23
  v_mfma_f32_16x16x32_bf16 v[76:79], a[164:167], a[28:31], v[76:79]
  ds_read_b64_tr_b16 a[150:151], v1 offset:10944
  v_mov_b32 v28, v24
  v_mfma_f32_16x16x32_bf16 v[76:79], a[160:163], a[12:15], v[76:79]
  v_mov_b32 v29, v25
  v_permlane32_swap_b32 v22, v26
  v_mfma_f32_16x16x32_bf16 v[92:95], a[168:171], a[12:15], v[92:95]
  ds_read_b64_tr_b16 a[152:153], v1 offset:14336
  v_permlane32_swap_b32 v23, v27
  v_mfma_f32_16x16x32_bf16 v[92:95], a[172:175], a[28:31], v[92:95]
  v_permlane32_swap_b32 v24, v28
  v_permlane32_swap_b32 v25, v29
  v_mfma_f32_16x16x32_bf16 v[88:91], a[172:175], a[24:27], v[88:91]
  buffer_load_dwordx4 v5, s[16:19], s10 offen offset:2048 lds
  ds_read_b64_tr_b16 a[154:155], v1 offset:17920
  v_mfma_f32_16x16x32_bf16 v[88:91], a[168:171], a[8:11], v[88:91]
  v_add_f32 v22, v22, v26
  v_add_f32 v23, v23, v27
  v_mfma_f32_16x16x32_bf16 v[84:87], a[168:171], a[4:7], v[84:87]
  ds_read_b64_tr_b16 a[156:157], v1 offset:21504
  v_add_f32 v24, v24, v28
  v_mfma_f32_16x16x32_bf16 v[84:87], a[172:175], a[20:23], v[84:87]
  v_add_f32 v25, v25, v29
  v_mul_f32 v22, 0x3a800000, v22
  v_mfma_f32_16x16x32_bf16 v[80:83], a[172:175], a[16:19], v[80:83]
  ds_read_b64_tr_b16 a[158:159], v1 offset:25088
  v_mul_f32 v23, 0x3a800000, v23
  v_mfma_f32_16x16x32_bf16 v[80:83], a[168:171], a[0:3], v[80:83]
  s_waitcnt lgkmcnt(8)
  v_fma_f32 v23, -v22, v22, v23
  v_max_f32 v23, 0, v23
  v_mfma_f32_16x16x32_bf16 v[96:99], a[128:131], a[0:3], v[96:99]
  ds_read_b64_tr_b16 a[160:161], v1 offset:14368
  v_cvt_pk_bf16_f32 v23, v23, v23
  v_mfma_f32_16x16x32_bf16 v[96:99], a[132:135], a[16:19], v[96:99]
  v_lshlrev_b32 v23, 16, v23
  v_add_f32 v23, 0x3727c5ac, v23
  v_mfma_f32_16x16x32_bf16 v[100:103], a[132:135], a[20:23], v[100:103]
  buffer_load_dwordx4 a[56:59], v0, s[36:39], s11 offen offset:2048 sc1
  ds_read_b64_tr_b16 a[162:163], v1 offset:17952
  v_mfma_f32_16x16x32_bf16 v[100:103], a[128:131], a[4:7], v[100:103]
  v_cvt_pk_bf16_f32 v23, v23, v23
  v_lshlrev_b32 v23, 16, v23
  v_mfma_f32_16x16x32_bf16 v[104:107], a[128:131], a[8:11], v[104:107]
  ds_read_b64_tr_b16 a[164:165], v1 offset:21536
  v_mfma_f32_16x16x32_bf16 v[104:107], a[132:135], a[24:27], v[104:107]
  v_sqrt_f32 v23, v23
  v_mfma_f32_16x16x32_bf16 v[108:111], a[132:135], a[28:31], v[108:111]
  s_nop 0
  ds_read_b64_tr_b16 a[166:167], v1 offset:25120
  v_cvt_pk_bf16_f32 v12, -v22, v23
  v_mfma_f32_16x16x32_bf16 v[108:111], a[128:131], a[12:15], v[108:111]
  v_and_b32 v23, 0xffff0000, v12
  v_mfma_f32_16x16x32_bf16 v[124:127], a[136:139], a[12:15], v[124:127]
  ds_read_b64_tr_b16 a[168:169], v1 offset:14400
  v_mfma_f32_16x16x32_bf16 v[124:127], a[140:143], a[28:31], v[124:127]
  buffer_load_dwordx4 v6, s[16:19], s10 offen offset:3072 lds
  v_mfma_f32_16x16x32_bf16 v[120:123], a[140:143], a[24:27], v[120:123]
  ds_read_b64_tr_b16 a[170:171], v1 offset:17984
  v_mfma_f32_16x16x32_bf16 v[120:123], a[136:139], a[8:11], v[120:123]
  v_rcp_f32 v10, v23
  v_mfma_f32_16x16x32_bf16 v[116:119], a[136:139], a[4:7], v[116:119]
  ds_read_b64_tr_b16 a[172:173], v1 offset:21568
  v_mul_f32 v11, v23, v23
  v_mfma_f32_16x16x32_bf16 v[116:119], a[140:143], a[20:23], v[116:119]
  v_mul_f32 v10, 0xbfb8aa3b, v10
  v_mul_f32 v24, 0x3a800000, v24
  v_mfma_f32_16x16x32_bf16 v[112:115], a[140:143], a[16:19], v[112:115]
  ds_read_b64_tr_b16 a[174:175], v1 offset:25152
  v_mul_f32 v25, 0x3a800000, v25
  v_mfma_f32_16x16x32_bf16 v[112:115], a[136:139], a[0:3], v[112:115]
  s_waitcnt lgkmcnt(8)
  v_fma_f32 v25, -v24, v24, v25
  v_max_f32 v25, 0, v25
  v_mfma_f32_16x16x32_bf16 v[128:131], a[144:147], a[0:3], v[128:131]
  ds_read_b64_tr_b16 a[128:129], v1 offset:14432
  v_cvt_pk_bf16_f32 v25, v25, v25
  v_mfma_f32_16x16x32_bf16 v[128:131], a[148:151], a[16:19], v[128:131]
  buffer_load_dwordx4 a[60:63], v0, s[36:39], s11 offen offset:3072 sc1
  v_lshlrev_b32 v25, 16, v25
  v_mfma_f32_16x16x32_bf16 v[132:135], a[148:151], a[20:23], v[132:135]
  ds_read_b64_tr_b16 a[130:131], v1 offset:18016
  v_add_f32 v25, 0x3727c5ac, v25
  v_mfma_f32_16x16x32_bf16 v[132:135], a[144:147], a[4:7], v[132:135]
  v_cvt_pk_bf16_f32 v25, v25, v25
  v_lshlrev_b32 v25, 16, v25
  v_mfma_f32_16x16x32_bf16 v[136:139], a[144:147], a[8:11], v[136:139]
  s_add_u32 m0, s79, 61440
  ds_read_b64_tr_b16 a[132:133], v1 offset:21600
  v_mfma_f32_16x16x32_bf16 v[136:139], a[148:151], a[24:27], v[136:139]
  v_sqrt_f32 v25, v25
  v_mfma_f32_16x16x32_bf16 v[140:143], a[148:151], a[28:31], v[140:143]
  s_nop 0
  ds_read_b64_tr_b16 a[134:135], v1 offset:25184
  v_cvt_pk_bf16_f32 v15, -v24, v25
  v_mfma_f32_16x16x32_bf16 v[140:143], a[144:147], a[12:15], v[140:143]
  v_and_b32 v25, 0xffff0000, v15
  v_mfma_f32_16x16x32_bf16 v[156:159], a[152:155], a[12:15], v[156:159]
  buffer_load_dwordx4 v7, s[16:19], s10 offen offset:0 lds
  s_bfe_u32 s11, s82, 0x40018
  v_mfma_f32_16x16x32_bf16 v[156:159], a[156:159], a[28:31], v[156:159]
  s_lshl_b32 s11, s11, 13
  s_add_u32 s11, s11, s84
  ds_read_b64_tr_b16 a[136:137], v1 offset:14464
  v_mfma_f32_16x16x32_bf16 v[152:155], a[156:159], a[24:27], v[152:155]
  ds_read_b64_tr_b16 a[138:139], v1 offset:18048
  v_mfma_f32_16x16x32_bf16 v[152:155], a[152:155], a[8:11], v[152:155]
  v_rcp_f32 v13, v25
  v_mfma_f32_16x16x32_bf16 v[148:151], a[152:155], a[4:7], v[148:151]
  ds_read_b64_tr_b16 a[140:141], v1 offset:21632
  v_mul_f32 v14, v25, v25
  v_mfma_f32_16x16x32_bf16 v[148:151], a[156:159], a[20:23], v[148:151]
  buffer_load_dwordx4 a[64:67], v0, s[36:39], s11 offen offset:0 sc1
  v_mul_f32 v13, 0xbfb8aa3b, v13
  v_mfma_f32_16x16x32_bf16 v[144:147], a[156:159], a[16:19], v[144:147]
  ds_read_b64_tr_b16 a[142:143], v1 offset:25216
  v_accvgpr_read_b32 v22, a192
  v_mfma_f32_16x16x32_bf16 v[144:147], a[152:155], a[0:3], v[144:147]
  s_waitcnt lgkmcnt(8)
  v_accvgpr_read_b32 v23, a193
  v_accvgpr_read_b32 v24, a194
  v_mfma_f32_16x16x32_bf16 v[160:163], a[160:163], a[0:3], v[160:163]
  ds_read_b64_tr_b16 a[144:145], v1 offset:14496
  v_accvgpr_read_b32 v25, a195
  v_mfma_f32_16x16x32_bf16 v[160:163], a[164:167], a[16:19], v[160:163]
  v_accvgpr_read_b32 v26, a196
  v_accvgpr_read_b32 v27, a197
  v_mfma_f32_16x16x32_bf16 v[164:167], a[164:167], a[20:23], v[164:167]
  ds_read_b64_tr_b16 a[146:147], v1 offset:18080
  v_accvgpr_read_b32 v28, a198
  v_mfma_f32_16x16x32_bf16 v[164:167], a[160:163], a[4:7], v[164:167]
  v_accvgpr_read_b32 v29, a199
  v_add_f32 v22, v22, v26
  v_mfma_f32_16x16x32_bf16 v[168:171], a[160:163], a[8:11], v[168:171]
  ds_read_b64_tr_b16 a[148:149], v1 offset:21664
  v_add_f32 v23, v23, v27
  v_mfma_f32_16x16x32_bf16 v[168:171], a[164:167], a[24:27], v[168:171]
  v_add_f32 v24, v24, v28
  v_add_f32 v25, v25, v29
  v_mfma_f32_16x16x32_bf16 v[172:175], a[164:167], a[28:31], v[172:175]
  ds_read_b64_tr_b16 a[150:151], v1 offset:25248
  v_accvgpr_read_b32 v26, a200
  v_mfma_f32_16x16x32_bf16 v[172:175], a[160:163], a[12:15], v[172:175]
  s_waitcnt vmcnt(12)
  s_barrier
  buffer_load_dwordx4 v8, s[16:19], s10 offen offset:1024 lds
  v_accvgpr_read_b32 v27, a201
  v_mfma_f32_16x16x32_bf16 v[188:191], a[168:171], a[12:15], v[188:191]
  ds_read_b64_tr_b16 a[152:153], v1 offset:14528
CT11:
  s_add_u32 s94, s92, CT11-k3_main_kernel+3072
  s_addc_u32 s95, s93, 0
  v_mfma_f32_16x16x32_bf16 v[188:191], a[172:175], a[28:31], v[188:191]
  v_accvgpr_read_b32 v28, a202
  v_accvgpr_read_b32 v29, a203
  v_mfma_f32_16x16x32_bf16 v[184:187], a[172:175], a[24:27], v[184:187]
  ds_read_b64_tr_b16 a[154:155], v1 offset:18112
  v_add_f32 v22, v22, v26
  v_mfma_f32_16x16x32_bf16 v[184:187], a[168:171], a[8:11], v[184:187]
  v_add_f32 v23, v23, v27
  v_add_f32 v24, v24, v28
  v_mfma_f32_16x16x32_bf16 v[180:183], a[168:171], a[4:7], v[180:183]
  buffer_load_dwordx4 a[68:71], v0, s[36:39], s11 offen offset:1024 sc1
  ds_read_b64_tr_b16 a[156:157], v1 offset:21696
  v_mfma_f32_16x16x32_bf16 v[180:183], a[172:175], a[20:23], v[180:183]
  v_add_f32 v25, v25, v29
  v_accvgpr_read_b32 v26, a204
  v_mfma_f32_16x16x32_bf16 v[176:179], a[172:175], a[16:19], v[176:179]
  ds_read_b64_tr_b16 a[158:159], v1 offset:25280
  v_accvgpr_read_b32 v27, a205
  v_mfma_f32_16x16x32_bf16 v[176:179], a[168:171], a[0:3], v[176:179]
  s_waitcnt lgkmcnt(8)
  v_accvgpr_read_b32 v28, a206
  v_accvgpr_read_b32 v29, a207
  v_mfma_f32_16x16x32_bf16 v[192:195], a[128:131], a[0:3], v[192:195]
  ds_read_b64_tr_b16 a[160:161], v1 offset:28672
  v_add_f32 v22, v22, v26
  v_mfma_f32_16x16x32_bf16 v[192:195], a[132:135], a[16:19], v[192:195]
  global_load_dword a252, v0, s[94:95]
  v_add_f32 v23, v23, v27
  v_mfma_f32_16x16x32_bf16 v[196:199], a[132:135], a[20:23], v[196:199]
  ds_read_b64_tr_b16 a[162:163], v1 offset:32256
  v_add_f32 v24, v24, v28
  v_mfma_f32_16x16x32_bf16 v[196:199], a[128:131], a[4:7], v[196:199]
  v_add_f32 v25, v25, v29
  v_mov_b32 v26, v22
  v_mfma_f32_16x16x32_bf16 v[200:203], a[128:131], a[8:11], v[200:203]
  ds_read_b64_tr_b16 a[164:165], v1 offset:35840
  v_mov_b32 v27, v23
  v_mfma_f32_16x16x32_bf16 v[200:203], a[132:135], a[24:27], v[200:203]
  v_mov_b32 v28, v24
  v_mov_b32 v29, v25
  v_mfma_f32_16x16x32_bf16 v[204:207], a[132:135], a[28:31], v[204:207]
  buffer_load_dwordx4 v9, s[16:19], s10 offen offset:2048 lds
  ds_read_b64_tr_b16 a[166:167], v1 offset:39424
  v_mfma_f32_16x16x32_bf16 v[204:207], a[128:131], a[12:15], v[204:207]
  v_permlane16_swap_b32 v22, v26
  v_permlane16_swap_b32 v23, v27
  v_mfma_f32_16x16x32_bf16 v[220:223], a[136:139], a[12:15], v[220:223]
  ds_read_b64_tr_b16 a[168:169], v1 offset:28704
  v_permlane16_swap_b32 v24, v28
  v_mfma_f32_16x16x32_bf16 v[220:223], a[140:143], a[28:31], v[220:223]
  v_permlane16_swap_b32 v25, v29
  v_add_f32 v22, v22, v26
  v_mfma_f32_16x16x32_bf16 v[216:219], a[140:143], a[24:27], v[216:219]
  ds_read_b64_tr_b16 a[170:171], v1 offset:32288
  v_add_f32 v23, v23, v27
  v_mfma_f32_16x16x32_bf16 v[216:219], a[136:139], a[8:11], v[216:219]
  buffer_load_dwordx4 a[72:75], v0, s[36:39], s11 offen offset:2048 sc1
  v_add_f32 v24, v24, v28
  v_mfma_f32_16x16x32_bf16 v[212:215], a[136:139], a[4:7], v[212:215]
  ds_read_b64_tr_b16 a[172:173], v1 offset:35872
  v_add_f32 v25, v25, v29
  v_mfma_f32_16x16x32_bf16 v[212:215], a[140:143], a[20:23], v[212:215]
  v_mov_b32 v26, v22
  v_mov_b32 v27, v23
  v_mfma_f32_16x16x32_bf16 v[208:211], a[140:143], a[16:19], v[208:211]
  ds_read_b64_tr_b16 a[174:175], v1 offset:39456
  v_mov_b32 v28, v24
  v_mfma_f32_16x16x32_bf16 v[208:211], a[136:139], a[0:3], v[208:211]
  s_waitcnt lgkmcnt(8)
  v_mov_b32 v29, v25
  v_permlane32_swap_b32 v22, v26
  v_mfma_f32_16x16x32_bf16 v[224:227], a[144:147], a[0:3], v[224:227]
  ds_read_b64_tr_b16 a[128:129], v1 offset:28736
  v_permlane32_swap_b32 v23, v27
  v_mfma_f32_16x16x32_bf16 v[224:227], a[148:151], a[16:19], v[224:227]
  v_permlane32_swap_b32 v24, v28
  v_permlane32_swap_b32 v25, v29
  v_mfma_f32_16x16x32_bf16 v[228:231], a[148:151], a[20:23], v[228:231]
  ds_read_b64_tr_b16 a[130:131], v1 offset:32320
  v_add_f32 v22, v22, v26
  v_mfma_f32_16x16x32_bf16 v[228:231], a[144:147], a[4:7], v[228:231]
  v_add_f32 v23, v23, v27
  v_add_f32 v24, v24, v28
  v_mfma_f32_16x16x32_bf16 v[232:235], a[144:147], a[8:11], v[232:235]
  ds_read_b64_tr_b16 a[132:133], v1 offset:35904
  v_add_f32 v25, v25, v29
  v_mfma_f32_16x16x32_bf16 v[232:235], a[148:151], a[24:27], v[232:235]
  buffer_load_dwordx4 a[76:79], v0, s[36:39], s11 offen offset:3072 sc1
  v_mul_f32 v22, 0x3a800000, v22
  v_mfma_f32_16x16x32_bf16 v[236:239], a[148:151], a[28:31], v[236:239]
  ds_read_b64_tr_b16 a[134:135], v1 offset:39488
  v_mul_f32 v23, 0x3a800000, v23
  v_mfma_f32_16x16x32_bf16 v[236:239], a[144:147], a[12:15], v[236:239]
  v_fma_f32 v23, -v22, v22, v23
  v_max_f32 v23, 0, v23
  v_mfma_f32_16x16x32_bf16 v[252:255], a[152:155], a[12:15], v[252:255]
  ds_read_b64_tr_b16 a[136:137], v1 offset:28768
  v_cvt_pk_bf16_f32 v23, v23, v23
  v_mfma_f32_16x16x32_bf16 v[252:255], a[156:159], a[28:31], v[252:255]
  s_bfe_u32 s10, s82, 0x4001c
  s_mul_i32 s10, s10, 458752
  s_add_u32 m0, s79, 86016
  v_mfma_f32_16x16x32_bf16 v[248:251], a[156:159], a[24:27], v[248:251]
  buffer_load_dwordx4 a[208:211], v0, s[36:39], s20 offen offset:0 sc1
  ds_read_b64_tr_b16 a[138:139], v1 offset:32352
  v_mfma_f32_16x16x32_bf16 v[248:251], a[152:155], a[8:11], v[248:251]
  v_lshlrev_b32 v23, 16, v23
  v_add_f32 v23, 0x3727c5ac, v23
  v_mfma_f32_16x16x32_bf16 v[244:247], a[152:155], a[4:7], v[244:247]
  ds_read_b64_tr_b16 a[140:141], v1 offset:35936
  v_cvt_pk_bf16_f32 v23, v23, v23
  v_mfma_f32_16x16x32_bf16 v[244:247], a[156:159], a[20:23], v[244:247]
  v_lshlrev_b32 v23, 16, v23
  v_mfma_f32_16x16x32_bf16 v[240:243], a[156:159], a[16:19], v[240:243]
  ds_read_b64_tr_b16 a[142:143], v1 offset:39520
  v_mfma_f32_16x16x32_bf16 v[240:243], a[152:155], a[0:3], v[240:243]
  s_waitcnt vmcnt(9) lgkmcnt(8)
  buffer_load_dwordx4 a[212:215], v0, s[36:39], s20 offen offset:1024 sc1
  v_mfma_f32_16x16x32_bf16 v[32:35], a[160:163], a[32:35], v[32:35]
  ds_read_b64_tr_b16 a[144:145], v1 offset:28800
  v_mfma_f32_16x16x32_bf16 v[32:35], a[164:167], a[48:51], v[32:35]
  s_barrier
  v_sqrt_f32 v23, v23
  v_mfma_f32_16x16x32_bf16 v[36:39], a[164:167], a[52:55], v[36:39]
  s_nop 0
  ds_read_b64_tr_b16 a[146:147], v1 offset:32384
  v_cvt_pk_bf16_f32 v18, -v22, v23
  v_mfma_f32_16x16x32_bf16 v[36:39], a[160:163], a[36:39], v[36:39]
  v_and_b32 v23, 0xffff0000, v18
  v_mfma_f32_16x16x32_bf16 v[40:43], a[160:163], a[40:43], v[40:43]
  buffer_load_dwordx4 v3, s[16:19], s10 offen offset:0 lds
  s_add_u32 s11, s11, 4096
  v_mfma_f32_16x16x32_bf16 v[40:43], a[164:167], a[56:59], v[40:43]
  ds_read_b64_tr_b16 a[148:149], v1 offset:35968
  v_mfma_f32_16x16x32_bf16 v[44:47], a[164:167], a[60:63], v[44:47]
  ds_read_b64_tr_b16 a[150:151], v1 offset:39552
  v_mfma_f32_16x16x32_bf16 v[44:47], a[160:163], a[44:47], v[44:47]
  v_rcp_f32 v16, v23
  v_mfma_f32_16x16x32_bf16 v[60:63], a[168:171], a[44:47], v[60:63]
  ds_read_b64_tr_b16 a[152:153], v1 offset:28832
  v_mul_f32 v17, v23, v23
  v_mfma_f32_16x16x32_bf16 v[60:63], a[172:175], a[60:63], v[60:63]
  buffer_load_dwordx4 a[80:83], v0, s[36:39], s11 offen offset:0 sc1
  v_mul_f32 v16, 0xbfb8aa3b, v16
  v_mfma_f32_16x16x32_bf16 v[56:59], a[172:175], a[56:59], v[56:59]
  ds_read_b64_tr_b16 a[154:155], v1 offset:32416
  v_mul_f32 v24, 0x3a800000, v24
  v_mfma_f32_16x16x32_bf16 v[56:59], a[168:171], a[40:43], v[56:59]
  v_mul_f32 v25, 0x3a800000, v25
  v_fma_f32 v25, -v24, v24, v25
  v_mfma_f32_16x16x32_bf16 v[52:55], a[168:171], a[36:39], v[52:55]
  ds_read_b64_tr_b16 a[156:157], v1 offset:36000
  v_max_f32 v25, 0, v25
  v_mfma_f32_16x16x32_bf16 v[52:55], a[172:175], a[52:55], v[52:55]
  v_cvt_pk_bf16_f32 v25, v25, v25
  v_lshlrev_b32 v25, 16, v25
  v_mfma_f32_16x16x32_bf16 v[48:51], a[172:175], a[48:51], v[48:51]
  buffer_load_dwordx4 v4, s[16:19], s10 offen offset:1024 lds
  ds_read_b64_tr_b16 a[158:159], v1 offset:39584
  v_mfma_f32_16x16x32_bf16 v[48:51], a[168:171], a[32:35], v[48:51]
  s_waitcnt lgkmcnt(8)
  v_add_f32 v25, 0x3727c5ac, v25
  v_cvt_pk_bf16_f32 v25, v25, v25
  v_mfma_f32_16x16x32_bf16 v[64:67], a[128:131], a[32:35], v[64:67]
  ds_read_b64_tr_b16 a[160:161], v1 offset:28864
  v_lshlrev_b32 v25, 16, v25
  v_mfma_f32_16x16x32_bf16 v[64:67], a[132:135], a[48:51], v[64:67]
  v_sqrt_f32 v25, v25
  v_mfma_f32_16x16x32_bf16 v[68:71], a[132:135], a[52:55], v[68:71]
  s_nop 0
  ds_read_b64_tr_b16 a[162:163], v1 offset:32448
  v_cvt_pk_bf16_f32 v21, -v24, v25
  v_mfma_f32_16x16x32_bf16 v[68:71], a[128:131], a[36:39], v[68:71]
  buffer_load_dwordx4 a[84:87], v0, s[36:39], s11 offen offset:1024 sc1
  v_and_b32 v25, 0xffff0000, v21
  v_mfma_f32_16x16x32_bf16 v[72:75], a[128:131], a[40:43], v[72:75]
  ds_read_b64_tr_b16 a[164:165], v1 offset:36032
  v_mfma_f32_16x16x32_bf16 v[72:75], a[132:135], a[56:59], v[72:75]
  v_rcp_f32 v19, v25
  v_mfma_f32_16x16x32_bf16 v[76:79], a[132:135], a[60:63], v[76:79]
  ds_read_b64_tr_b16 a[166:167], v1 offset:39616
  v_mul_f32 v20, v25, v25
  v_mfma_f32_16x16x32_bf16 v[76:79], a[128:131], a[44:47], v[76:79]
  v_mul_f32 v19, 0xbfb8aa3b, v19
  v_add_u32 v31, 57344, v31
  v_mfma_f32_16x16x32_bf16 v[92:95], a[136:139], a[44:47], v[92:95]
  ds_read_b64_tr_b16 a[168:169], v1 offset:43008
  v_mfma_f32_16x16x32_bf16 v[92:95], a[140:143], a[60:63], v[92:95]
  v_mfma_f32_16x16x32_bf16 v[88:91], a[140:143], a[56:59], v[88:91]
  buffer_load_dwordx4 v5, s[16:19], s10 offen offset:2048 lds
  ds_read_b64_tr_b16 a[170:171], v1 offset:46592
  v_mfma_f32_16x16x32_bf16 v[88:91], a[136:139], a[40:43], v[88:91]
  v_mfma_f32_16x16x32_bf16 v[84:87], a[136:139], a[36:39], v[84:87]
  ds_read_b64_tr_b16 a[172:173], v1 offset:50176
  v_mfma_f32_16x16x32_bf16 v[84:87], a[140:143], a[52:55], v[84:87]
  v_mfma_f32_16x16x32_bf16 v[80:83], a[140:143], a[48:51], v[80:83]
  ds_read_b64_tr_b16 a[174:175], v1 offset:53760
  v_mfma_f32_16x16x32_bf16 v[80:83], a[136:139], a[32:35], v[80:83]
  s_waitcnt lgkmcnt(8)
  v_mfma_f32_16x16x32_bf16 v[96:99], a[144:147], a[32:35], v[96:99]
  ds_read_b64_tr_b16 a[128:129], v1 offset:43040
  v_mfma_f32_16x16x32_bf16 v[96:99], a[148:151], a[48:51], v[96:99]
  v_mfma_f32_16x16x32_bf16 v[100:103], a[148:151], a[52:55], v[100:103]
  buffer_load_dwordx4 a[88:91], v0, s[36:39], s11 offen offset:2048 sc1
  ds_read_b64_tr_b16 a[130:131], v1 offset:46624
  v_mfma_f32_16x16x32_bf16 v[100:103], a[144:147], a[36:39], v[100:103]
  v_mfma_f32_16x16x32_bf16 v[104:107], a[144:147], a[40:43], v[104:107]
  ds_read_b64_tr_b16 a[132:133], v1 offset:50208
  v_mfma_f32_16x16x32_bf16 v[104:107], a[148:151], a[56:59], v[104:107]
  v_mfma_f32_16x16x32_bf16 v[108:111], a[148:151], a[60:63], v[108:111]
  ds_read_b64_tr_b16 a[134:135], v1 offset:53792
  v_mfma_f32_16x16x32_bf16 v[108:111], a[144:147], a[44:47], v[108:111]
  v_mfma_f32_16x16x32_bf16 v[124:127], a[152:155], a[44:47], v[124:127]
  ds_read_b64_tr_b16 a[136:137], v1 offset:43072
  v_mfma_f32_16x16x32_bf16 v[124:127], a[156:159], a[60:63], v[124:127]
  buffer_load_dwordx4 v6, s[16:19], s10 offen offset:3072 lds
  v_mfma_f32_16x16x32_bf16 v[120:123], a[156:159], a[56:59], v[120:123]
  ds_read_b64_tr_b16 a[138:139], v1 offset:46656
  v_mfma_f32_16x16x32_bf16 v[120:123], a[152:155], a[40:43], v[120:123]
  v_mfma_f32_16x16x32_bf16 v[116:119], a[152:155], a[36:39], v[116:119]
  ds_read_b64_tr_b16 a[140:141], v1 offset:50240
  v_mfma_f32_16x16x32_bf16 v[116:119], a[156:159], a[52:55], v[116:119]
  v_mfma_f32_16x16x32_bf16 v[112:115], a[156:159], a[48:51], v[112:115]
  ds_read_b64_tr_b16 a[142:143], v1 offset:53824
  v_mfma_f32_16x16x32_bf16 v[112:115], a[152:155], a[32:35], v[112:115]
  s_waitcnt lgkmcnt(8)
  v_mfma_f32_16x16x32_bf16 v[128:131], a[160:163], a[32:35], v[128:131]
  ds_read_b64_tr_b16 a[144:145], v1 offset:43104
  v_mfma_f32_16x16x32_bf16 v[128:131], a[164:167], a[48:51], v[128:131]
  buffer_load_dwordx4 a[92:95], v0, s[36:39], s11 offen offset:3072 sc1
  v_mfma_f32_16x16x32_bf16 v[132:135], a[164:167], a[52:55], v[132:135]
  ds_read_b64_tr_b16 a[146:147], v1 offset:46688
  v_mfma_f32_16x16x32_bf16 v[132:135], a[160:163], a[36:39], v[132:135]
  v_mfma_f32_16x16x32_bf16 v[136:139], a[160:163], a[40:43], v[136:139]
  s_add_u32 m0, s79, 90112
  ds_read_b64_tr_b16 a[148:149], v1 offset:50272
  v_mfma_f32_16x16x32_bf16 v[136:139], a[164:167], a[56:59], v[136:139]
  v_mfma_f32_16x16x32_bf16 v[140:143], a[164:167], a[60:63], v[140:143]
  ds_read_b64_tr_b16 a[150:151], v1 offset:53856
  v_mfma_f32_16x16x32_bf16 v[140:143], a[160:163], a[44:47], v[140:143]
  v_mfma_f32_16x16x32_bf16 v[156:159], a[168:171], a[44:47], v[156:159]
  buffer_load_dwordx4 v7, s[16:19], s10 offen offset:0 lds
  s_bfe_u32 s11, s82, 0x4001c
  v_mfma_f32_16x16x32_bf16 v[156:159], a[172:175], a[60:63], v[156:159]
  s_lshl_b32 s11, s11, 13
  s_add_u32 s11, s11, s84
  ds_read_b64_tr_b16 a[152:153], v1 offset:43136
  v_mfma_f32_16x16x32_bf16 v[152:155], a[172:175], a[56:59], v[152:155]
  ds_read_b64_tr_b16 a[154:155], v1 offset:46720
  v_mfma_f32_16x16x32_bf16 v[152:155], a[168:171], a[40:43], v[152:155]
  v_mfma_f32_16x16x32_bf16 v[148:151], a[168:171], a[36:39], v[148:151]
  ds_read_b64_tr_b16 a[156:157], v1 offset:50304
  v_mfma_f32_16x16x32_bf16 v[148:151], a[172:175], a[52:55], v[148:151]
  buffer_load_dwordx4 a[96:99], v0, s[36:39], s11 offen offset:0 sc1
  v_mfma_f32_16x16x32_bf16 v[144:147], a[172:175], a[48:51], v[144:147]
  ds_read_b64_tr_b16 a[158:159], v1 offset:53888
  v_mfma_f32_16x16x32_bf16 v[144:147], a[168:171], a[32:35], v[144:147]
  s_waitcnt lgkmcnt(8)
  v_mfma_f32_16x16x32_bf16 v[160:163], a[128:131], a[32:35], v[160:163]
  ds_read_b64_tr_b16 a[160:161], v1 offset:43168
  v_mfma_f32_16x16x32_bf16 v[160:163], a[132:135], a[48:51], v[160:163]
  v_mfma_f32_16x16x32_bf16 v[164:167], a[132:135], a[52:55], v[164:167]
  ds_read_b64_tr_b16 a[162:163], v1 offset:46752
  v_mfma_f32_16x16x32_bf16 v[164:167], a[128:131], a[36:39], v[164:167]
  v_mfma_f32_16x16x32_bf16 v[168:171], a[128:131], a[40:43], v[168:171]
  ds_read_b64_tr_b16 a[164:165], v1 offset:50336
  v_mfma_f32_16x16x32_bf16 v[168:171], a[132:135], a[56:59], v[168:171]
  v_mfma_f32_16x16x32_bf16 v[172:175], a[132:135], a[60:63], v[172:175]
  ds_read_b64_tr_b16 a[166:167], v1 offset:53920
  v_mfma_f32_16x16x32_bf16 v[172:175], a[128:131], a[44:47], v[172:175]
  s_waitcnt vmcnt(14)
  s_barrier
  buffer_load_dwordx4 v8, s[16:19], s10 offen offset:1024 lds
  v_mfma_f32_16x16x32_bf16 v[188:191], a[136:139], a[44:47], v[188:191]
  ds_read_b64_tr_b16 a[168:169], v1 offset:43200
  v_mfma_f32_16x16x32_bf16 v[188:191], a[140:143], a[60:63], v[188:191]
  v_mfma_f32_16x16x32_bf16 v[184:187], a[140:143], a[56:59], v[184:187]
  ds_read_b64_tr_b16 a[170:171], v1 offset:46784
  v_mfma_f32_16x16x32_bf16 v[184:187], a[136:139], a[40:43], v[184:187]
  v_mfma_f32_16x16x32_bf16 v[180:183], a[136:139], a[36:39], v[180:183]
  buffer_load_dwordx4 a[100:103], v0, s[36:39], s11 offen offset:1024 sc1
  ds_read_b64_tr_b16 a[172:173], v1 offset:50368
  v_mfma_f32_16x16x32_bf16 v[180:183], a[140:143], a[52:55], v[180:183]
  v_mfma_f32_16x16x32_bf16 v[176:179], a[140:143], a[48:51], v[176:179]
  ds_read_b64_tr_b16 a[174:175], v1 offset:53952
  v_mfma_f32_16x16x32_bf16 v[176:179], a[136:139], a[32:35], v[176:179]
  s_waitcnt lgkmcnt(8)
  v_mfma_f32_16x16x32_bf16 v[192:195], a[144:147], a[32:35], v[192:195]
  ds_read_b64_tr_b16 a[128:129], v2 offset:0
  v_mfma_f32_16x16x32_bf16 v[192:195], a[148:151], a[48:51], v[192:195]
  v_mfma_f32_16x16x32_bf16 v[196:199], a[148:151], a[52:55], v[196:199]
  ds_read_b64_tr_b16 a[130:131], v2 offset:3584
  v_mfma_f32_16x16x32_bf16 v[196:199], a[144:147], a[36:39], v[196:199]
  v_mfma_f32_16x16x32_bf16 v[200:203], a[144:147], a[40:43], v[200:203]
  ds_read_b64_tr_b16 a[132:133], v2 offset:7168
  ds_read_b64_tr_b16 a[176:177], v31 offset:0
  v_mfma_f32_16x16x32_bf16 v[200:203], a[148:151], a[56:59], v[200:203]
  v_mfma_f32_16x16x32_bf16 v[204:207], a[148:151], a[60:63], v[204:207]
  buffer_load_dwordx4 v9, s[16:19], s10 offen offset:2048 lds
  ds_read_b64_tr_b16 a[134:135], v2 offset:10752
  v_mfma_f32_16x16x32_bf16 v[204:207], a[144:147], a[44:47], v[204:207]
  ds_read_b64_tr_b16 a[178:179], v31 offset:3584
  v_mfma_f32_16x16x32_bf16 v[220:223], a[152:155], a[44:47], v[220:223]
  ds_read_b64_tr_b16 a[136:137], v2 offset:32
  ds_read_b64_tr_b16 a[180:181], v31 offset:7168
  v_mfma_f32_16x16x32_bf16 v[220:223], a[156:159], a[60:63], v[220:223]
  v_mfma_f32_16x16x32_bf16 v[216:219], a[156:159], a[56:59], v[216:219]
  ds_read_b64_tr_b16 a[138:139], v2 offset:3616
  ds_read_b64_tr_b16 a[182:183], v31 offset:10752
  v_mfma_f32_16x16x32_bf16 v[216:219], a[152:155], a[40:43], v[216:219]
  buffer_load_dwordx4 a[104:107], v0, s[36:39], s11 offen offset:2048 sc1
  v_mfma_f32_16x16x32_bf16 v[212:215], a[152:155], a[36:39], v[212:215]
  ds_read_b64_tr_b16 a[140:141], v2 offset:7200
  ds_read_b64_tr_b16 a[184:185], v31 offset:32
  v_mfma_f32_16x16x32_bf16 v[212:215], a[156:159], a[52:55], v[212:215]
  v_mfma_f32_16x16x32_bf16 v[208:211], a[156:159], a[48:51], v[208:211]
  ds_read_b64_tr_b16 a[142:143], v2 offset:10784
  ds_read_b64_tr_b16 a[186:187], v31 offset:3616
  v_mfma_f32_16x16x32_bf16 v[208:211], a[152:155], a[32:35], v[208:211]
  s_waitcnt lgkmcnt(14)
  v_mfma_f32_16x16x32_bf16 v[224:227], a[160:163], a[32:35], v[224:227]
  ds_read_b64_tr_b16 a[144:145], v2 offset:64
  ds_read_b64_tr_b16 a[188:189], v31 offset:7200
  v_mfma_f32_16x16x32_bf16 v[224:227], a[164:167], a[48:51], v[224:227]
  v_mfma_f32_16x16x32_bf16 v[228:231], a[164:167], a[52:55], v[228:231]
  ds_read_b64_tr_b16 a[146:147], v2 offset:3648
  ds_read_b64_tr_b16 a[190:191], v31 offset:10784
  v_mfma_f32_16x16x32_bf16 v[228:231], a[160:163], a[36:39], v[228:231]
  v_mfma_f32_16x16x32_bf16 v[232:235], a[160:163], a[40:43], v[232:235]
  ds_read_b64_tr_b16 a[148:149], v2 offset:7232
  ds_read_b64_tr_b16 a[192:193], v31 offset:64
  v_mfma_f32_16x16x32_bf16 v[232:235], a[164:167], a[56:59], v[232:235]
  buffer_load_dwordx4 a[108:111], v0, s[36:39], s11 offen offset:3072 sc1
  v_mfma_f32_16x16x32_bf16 v[236:239], a[164:167], a[60:63], v[236:239]
  ds_read_b64_tr_b16 a[150:151], v2 offset:10816
  ds_read_b64_tr_b16 a[194:195], v31 offset:3648
  v_mfma_f32_16x16x32_bf16 v[236:239], a[160:163], a[44:47], v[236:239]
  v_mfma_f32_16x16x32_bf16 v[252:255], a[168:171], a[44:47], v[252:255]
  ds_read_b64_tr_b16 a[152:153], v2 offset:96
  ds_read_b64_tr_b16 a[196:197], v31 offset:7232
  v_mfma_f32_16x16x32_bf16 v[252:255], a[172:175], a[60:63], v[252:255]
  s_bfe_u32 s10, s83, 0x40000
  s_mul_i32 s10, s10, 458752
  s_add_u32 m0, s79, 0
  v_mfma_f32_16x16x32_bf16 v[248:251], a[172:175], a[56:59], v[248:251]
  ds_read_b64_tr_b16 a[154:155], v2 offset:3680
  ds_read_b64_tr_b16 a[198:199], v31 offset:10816
  v_mfma_f32_16x16x32_bf16 v[248:251], a[168:171], a[40:43], v[248:251]
  v_mfma_f32_16x16x32_bf16 v[244:247], a[168:171], a[36:39], v[244:247]
  ds_read_b64_tr_b16 a[156:157], v2 offset:7264
  ds_read_b64_tr_b16 a[200:201], v31 offset:96
  v_mfma_f32_16x16x32_bf16 v[244:247], a[172:175], a[52:55], v[244:247]
  buffer_load_dwordx4 v3, s[16:19], s10 offen offset:0 lds
  v_mfma_f32_16x16x32_bf16 v[240:243], a[172:175], a[48:51], v[240:243]
  ds_read_b64_tr_b16 a[158:159], v2 offset:10848
  ds_read_b64_tr_b16 a[202:203], v31 offset:3680
  v_mfma_f32_16x16x32_bf16 v[240:243], a[168:171], a[32:35], v[240:243]
  s_waitcnt vmcnt(8) lgkmcnt(15)
  v_mfma_f32_16x16x32_bf16 v[32:35], a[128:131], a[64:67], v[32:35]
  s_add_u32 s11, s11, 4096
  ds_read_b64_tr_b16 a[204:205], v31 offset:7264
  v_mfma_f32_16x16x32_bf16 v[32:35], a[132:135], a[80:83], v[32:35]
  s_barrier
  v_mfma_f32_16x16x32_bf16 v[36:39], a[132:135], a[84:87], v[36:39]
  ds_read_b64_tr_b16 a[206:207], v31 offset:10848
  v_mfma_f32_16x16x32_bf16 v[36:39], a[128:131], a[68:71], v[36:39]
  v_mfma_f32_16x16x32_bf16 v[40:43], a[128:131], a[72:75], v[40:43]
  buffer_load_dwordx4 a[112:115], v0, s[36:39], s11 offen offset:0 sc1
  v_mfma_f32_16x16x32_bf16 v[40:43], a[132:135], a[88:91], v[40:43]
  v_mfma_f32_16x16x32_bf16 v[44:47], a[132:135], a[92:95], v[44:47]
  v_mfma_f32_16x16x32_bf16 v[44:47], a[128:131], a[76:79], v[44:47]
  v_mfma_f32_16x16x32_bf16 v[60:63], a[136:139], a[76:79], v[60:63]
  ds_read_b64_tr_b16 a[160:161], v2 offset:128
  v_mfma_f32_16x16x32_bf16 v[60:63], a[140:143], a[92:95], v[60:63]
  v_mfma_f32_16x16x32_bf16 v[56:59], a[140:143], a[88:91], v[56:59]
  ds_read_b64_tr_b16 a[162:163], v2 offset:3712
  v_mfma_f32_16x16x32_bf16 v[56:59], a[136:139], a[72:75], v[56:59]
  buffer_load_dwordx4 v4, s[16:19], s10 offen offset:1024 lds
  v_mfma_f32_16x16x32_bf16 v[52:55], a[136:139], a[68:71], v[52:55]
  ds_read_b64_tr_b16 a[164:165], v2 offset:7296
  v_mfma_f32_16x16x32_bf16 v[52:55], a[140:143], a[84:87], v[52:55]
  v_mfma_f32_16x16x32_bf16 v[48:51], a[140:143], a[80:83], v[48:51]
  ds_read_b64_tr_b16 a[166:167], v2 offset:10880
  v_mfma_f32_16x16x32_bf16 v[48:51], a[136:139], a[64:67], v[48:51]
  s_waitcnt lgkmcnt(7)
  v_mfma_f32_16x16x32_bf16 v[64:67], a[144:147], a[64:67], v[64:67]
  ds_read_b64_tr_b16 a[168:169], v2 offset:160
  v_mfma_f32_16x16x32_bf16 v[64:67], a[148:151], a[80:83], v[64:67]
  v_mfma_f32_16x16x32_bf16 v[68:71], a[148:151], a[84:87], v[68:71]
  ds_read_b64_tr_b16 a[170:171], v2 offset:3744
  v_mfma_f32_16x16x32_bf16 v[68:71], a[144:147], a[68:71], v[68:71]
  buffer_load_dwordx4 a[116:119], v0, s[36:39], s11 offen offset:1024 sc1
  v_mfma_f32_16x16x32_bf16 v[72:75], a[144:147], a[72:75], v[72:75]
  ds_read_b64_tr_b16 a[172:173], v2 offset:7328
  v_mfma_f32_16x16x32_bf16 v[72:75], a[148:151], a[88:91], v[72:75]
  v_mfma_f32_16x16x32_bf16 v[76:79], a[148:151], a[92:95], v[76:79]
  ds_read_b64_tr_b16 a[174:175], v2 offset:10912
  v_mfma_f32_16x16x32_bf16 v[76:79], a[144:147], a[76:79], v[76:79]
  v_mfma_f32_16x16x32_bf16 v[92:95], a[152:155], a[76:79], v[92:95]
  ds_read_b64_tr_b16 a[128:129], v2 offset:192
  v_mfma_f32_16x16x32_bf16 v[92:95], a[156:159], a[92:95], v[92:95]
  v_mfma_f32_16x16x32_bf16 v[88:91], a[156:159], a[88:91], v[88:91]
  buffer_load_dwordx4 v5, s[16:19], s10 offen offset:2048 lds
  ds_read_b64_tr_b16 a[130:131], v2 offset:3776
  v_mfma_f32_16x16x32_bf16 v[88:91], a[152:155], a[72:75], v[88:91]
  v_mfma_f32_16x16x32_bf16 v[84:87], a[152:155], a[68:71], v[84:87]
  ds_read_b64_tr_b16 a[132:133], v2 offset:7360
  v_mfma_f32_16x16x32_bf16 v[84:87], a[156:159], a[84:87], v[84:87]
  v_mfma_f32_16x16x32_bf16 v[80:83], a[156:159], a[80:83], v[80:83]
  ds_read_b64_tr_b16 a[134:135], v2 offset:10944
  v_mfma_f32_16x16x32_bf16 v[80:83], a[152:155], a[64:67], v[80:83]
  s_waitcnt vmcnt(20) lgkmcnt(12)
  v_mfma_f32_16x16x32_bf16 a[216:219], a[176:179], a[208:211], 0
  ds_read_b64_tr_b16 a[136:137], v2 offset:14336
  v_mfma_f32_16x16x32_bf16 a[216:219], a[180:183], a[212:215], a[216:219]
  v_mfma_f32_16x16x32_bf16 a[220:223], a[184:187], a[208:211], 0
  buffer_load_dwordx4 a[120:123], v0, s[36:39], s11 offen offset:2048 sc1
  ds_read_b64_tr_b16 a[138:139], v2 offset:17920
  v_mfma_f32_16x16x32_bf16 a[220:223], a[188:191], a[212:215], a[220:223]
  v_mfma_f32_16x16x32_bf16 a[224:227], a[192:195], a[208:211], 0
  ds_read_b64_tr_b16 a[140:141], v2 offset:21504
  v_mfma_f32_16x16x32_bf16 a[224:227], a[196:199], a[212:215], a[224:227]
  v_mfma_f32_16x16x32_bf16 a[228:231], a[200:203], a[208:211], 0
  ds_read_b64_tr_b16 a[142:143], v2 offset:25088
  v_mfma_f32_16x16x32_bf16 a[228:231], a[204:207], a[212:215], a[228:231]
  s_waitcnt lgkmcnt(8)
  v_mfma_f32_16x16x32_bf16 v[96:99], a[160:163], a[64:67], v[96:99]
  ds_read_b64_tr_b16 a[144:145], v2 offset:14368
  v_mfma_f32_16x16x32_bf16 v[96:99], a[164:167], a[80:83], v[96:99]
  buffer_load_dwordx4 v6, s[16:19], s10 offen offset:3072 lds
  v_mfma_f32_16x16x32_bf16 v[100:103], a[164:167], a[84:87], v[100:103]
  ds_read_b64_tr_b16 a[146:147], v2 offset:17952
  v_mfma_f32_16x16x32_bf16 v[100:103], a[160:163], a[68:71], v[100:103]
  v_mfma_f32_16x16x32_bf16 v[104:107], a[160:163], a[72:75], v[104:107]
  ds_read_b64_tr_b16 a[148:149], v2 offset:21536
  v_mfma_f32_16x16x32_bf16 v[104:107], a[164:167], a[88:91], v[104:107]
  v_mfma_f32_16x16x32_bf16 v[108:111], a[164:167], a[92:95], v[108:111]
  ds_read_b64_tr_b16 a[150:151], v2 offset:25120
  v_mfma_f32_16x16x32_bf16 v[108:111], a[160:163], a[76:79], v[108:111]
  v_mfma_f32_16x16x32_bf16 v[124:127], a[168:171], a[76:79], v[124:127]
  ds_read_b64_tr_b16 a[152:153], v2 offset:14400
  v_mfma_f32_16x16x32_bf16 v[124:127], a[172:175], a[92:95], v[124:127]
  buffer_load_dwordx4 a[124:127], v0, s[36:39], s11 offen offset:3072 sc1
  v_mfma_f32_16x16x32_bf16 v[120:123], a[172:175], a[88:91], v[120:123]
  ds_read_b64_tr_b16 a[154:155], v2 offset:17984
  v_mfma_f32_16x16x32_bf16 v[120:123], a[168:171], a[72:75], v[120:123]
  v_mfma_f32_16x16x32_bf16 v[116:119], a[168:171], a[68:71], v[116:119]
  s_add_u32 m0, s79, 4096
  ds_read_b64_tr_b16 a[156:157], v2 offset:21568
  v_mfma_f32_16x16x32_bf16 v[116:119], a[172:175], a[84:87], v[116:119]
  v_mfma_f32_16x16x32_bf16 v[112:115], a[172:175], a[80:83], v[112:115]
  ds_read_b64_tr_b16 a[158:159], v2 offset:25152
  v_mfma_f32_16x16x32_bf16 v[112:115], a[168:171], a[64:67], v[112:115]
  s_waitcnt lgkmcnt(8)
  v_mfma_f32_16x16x32_bf16 v[128:131], a[128:131], a[64:67], v[128:131]
  buffer_load_dwordx4 v7, s[16:19], s10 offen offset:0 lds
  s_bfe_u32 s11, s83, 0x40000
  v_mfma_f32_16x16x32_bf16 v[128:131], a[132:135], a[80:83], v[128:131]
  s_lshl_b32 s11, s11, 13
  s_add_u32 s11, s11, s84
  ds_read_b64_tr_b16 a[160:161], v2 offset:14432
  v_mfma_f32_16x16x32_bf16 v[132:135], a[132:135], a[84:87], v[132:135]
  ds_read_b64_tr_b16 a[162:163], v2 offset:18016
  v_mfma_f32_16x16x32_bf16 v[132:135], a[128:131], a[68:71], v[132:135]
  v_mfma_f32_16x16x32_bf16 v[136:139], a[128:131], a[72:75], v[136:139]
  ds_read_b64_tr_b16 a[164:165], v2 offset:21600
  v_mfma_f32_16x16x32_bf16 v[136:139], a[132:135], a[88:91], v[136:139]
  buffer_load_dwordx4 a[0:3], v0, s[36:39], s11 offen offset:0 sc1
  v_mfma_f32_16x16x32_bf16 v[140:143], a[132:135], a[92:95], v[140:143]
  ds_read_b64_tr_b16 a[166:167], v2 offset:25184
  v_mfma_f32_16x16x32_bf16 v[140:143], a[128:131], a[76:79], v[140:143]
  v_mfma_f32_16x16x32_bf16 v[156:159], a[136:139], a[76:79], v[156:159]
  ds_read_b64_tr_b16 a[168:169], v2 offset:14464
  v_mfma_f32_16x16x32_bf16 v[156:159], a[140:143], a[92:95], v[156:159]
  v_mfma_f32_16x16x32_bf16 v[152:155], a[140:143], a[88:91], v[152:155]
  ds_read_b64_tr_b16 a[170:171], v2 offset:18048
  v_mfma_f32_16x16x32_bf16 v[152:155], a[136:139], a[72:75], v[152:155]
  v_mfma_f32_16x16x32_bf16 v[148:151], a[136:139], a[68:71], v[148:151]
  ds_read_b64_tr_b16 a[172:173], v2 offset:21632
  v_mfma_f32_16x16x32_bf16 v[148:151], a[140:143], a[84:87], v[148:151]
  v_mfma_f32_16x16x32_bf16 v[144:147], a[140:143], a[80:83], v[144:147]
  ds_read_b64_tr_b16 a[174:175], v2 offset:25216
  v_mfma_f32_16x16x32_bf16 v[144:147], a[136:139], a[64:67], v[144:147]
  s_waitcnt lgkmcnt(8)
  buffer_load_dwordx4 v8, s[16:19], s10 offen offset:1024 lds
  v_mfma_f32_16x16x32_bf16 v[160:163], a[144:147], a[64:67], v[160:163]
  ds_read_b64_tr_b16 a[128:129], v2 offset:14496
  v_mfma_f32_16x16x32_bf16 v[160:163], a[148:151], a[80:83], v[160:163]
  v_mfma_f32_16x16x32_bf16 v[164:167], a[148:151], a[84:87], v[164:167]
  ds_read_b64_tr_b16 a[130:131], v2 offset:18080
  v_mfma_f32_16x16x32_bf16 v[164:167], a[144:147], a[68:71], v[164:167]
  v_mfma_f32_16x16x32_bf16 v[168:171], a[144:147], a[72:75], v[168:171]
  buffer_load_dwordx4 a[4:7], v0, s[36:39], s11 offen offset:1024 sc1
  ds_read_b64_tr_b16 a[132:133], v2 offset:21664
  v_mfma_f32_16x16x32_bf16 v[168:171], a[148:151], a[88:91], v[168:171]
  v_mfma_f32_16x16x32_bf16 v[172:175], a[148:151], a[92:95], v[172:175]
  ds_read_b64_tr_b16 a[134:135], v2 offset:25248
  v_mfma_f32_16x16x32_bf16 v[172:175], a[144:147], a[76:79], v[172:175]
  s_waitcnt vmcnt(14)
  s_barrier
  v_mfma_f32_16x16x32_bf16 v[188:191], a[152:155], a[76:79], v[188:191]
  ds_read_b64_tr_b16 a[136:137], v2 offset:14528
  v_mfma_f32_16x16x32_bf16 v[188:191], a[156:159], a[92:95], v[188:191]
  v_mfma_f32_16x16x32_bf16 v[184:187], a[156:159], a[88:91], v[184:187]
  ds_read_b64_tr_b16 a[138:139], v2 offset:18112
  v_mfma_f32_16x16x32_bf16 v[184:187], a[152:155], a[72:75], v[184:187]
  v_mfma_f32_16x16x32_bf16 v[180:183], a[152:155], a[68:71], v[180:183]
  ds_read_b64_tr_b16 a[140:141], v2 offset:21696
  v_mfma_f32_16x16x32_bf16 v[180:183], a[156:159], a[84:87], v[180:183]
  v_mfma_f32_16x16x32_bf16 v[176:179], a[156:159], a[80:83], v[176:179]
  buffer_load_dwordx4 v9, s[16:19], s10 offen offset:2048 lds
  ds_read_b64_tr_b16 a[142:143], v2 offset:25280
  v_mfma_f32_16x16x32_bf16 v[176:179], a[152:155], a[64:67], v[176:179]
  s_waitcnt lgkmcnt(8)
  v_mfma_f32_16x16x32_bf16 v[192:195], a[160:163], a[64:67], v[192:195]
  ds_read_b64_tr_b16 a[144:145], v2 offset:28672
  v_mfma_f32_16x16x32_bf16 v[192:195], a[164:167], a[80:83], v[192:195]
  v_mfma_f32_16x16x32_bf16 v[196:199], a[164:167], a[84:87], v[196:199]
  ds_read_b64_tr_b16 a[146:147], v2 offset:32256
  v_mfma_f32_16x16x32_bf16 v[196:199], a[160:163], a[68:71], v[196:199]
  buffer_load_dwordx4 a[8:11], v0, s[36:39], s11 offen offset:2048 sc1
  v_mfma_f32_16x16x32_bf16 v[200:203], a[160:163], a[72:75], v[200:203]
  ds_read_b64_tr_b16 a[148:149], v2 offset:35840
  v_mfma_f32_16x16x32_bf16 v[200:203], a[164:167], a[88:91], v[200:203]
  v_mfma_f32_16x16x32_bf16 v[204:207], a[164:167], a[92:95], v[204:207]
  ds_read_b64_tr_b16 a[150:151], v2 offset:39424
  v_mfma_f32_16x16x32_bf16 v[204:207], a[160:163], a[76:79], v[204:207]
  v_mfma_f32_16x16x32_bf16 v[220:223], a[168:171], a[76:79], v[220:223]
  ds_read_b64_tr_b16 a[152:153], v2 offset:28704
  v_mfma_f32_16x16x32_bf16 v[220:223], a[172:175], a[92:95], v[220:223]
  v_mfma_f32_16x16x32_bf16 v[216:219], a[172:175], a[88:91], v[216:219]
  ds_read_b64_tr_b16 a[154:155], v2 offset:32288
CT12:
  s_add_u32 s94, s92, CT12-k3_main_kernel+3072
  s_addc_u32 s95, s93, 0
  v_mfma_f32_16x16x32_bf16 v[216:219], a[168:171], a[72:75], v[216:219]
  global_load_dword a252, v0, s[94:95]
  v_mfma_f32_16x16x32_bf16 v[212:215], a[168:171], a[68:71], v[212:215]
  ds_read_b64_tr_b16 a[156:157], v2 offset:35872
  v_mfma_f32_16x16x32_bf16 v[212:215], a[172:175], a[84:87], v[212:215]
  v_mfma_f32_16x16x32_bf16 v[208:211], a[172:175], a[80:83], v[208:211]
  ds_read_b64_tr_b16 a[158:159], v2 offset:39456
  v_mfma_f32_16x16x32_bf16 v[208:211], a[168:171], a[64:67], v[208:211]
  s_waitcnt lgkmcnt(8)
  v_mfma_f32_16x16x32_bf16 v[224:227], a[128:131], a[64:67], v[224:227]
  buffer_load_dwordx4 a[12:15], v0, s[36:39], s11 offen offset:3072 sc1
  s_bfe_u32 s10, s83, 0x40004
  v_mfma_f32_16x16x32_bf16 v[224:227], a[132:135], a[80:83], v[224:227]
  s_mul_i32 s10, s10, 458752
  s_add_u32 m0, s79, 28672
  ds_read_b64_tr_b16 a[160:161], v2 offset:28736
  v_mfma_f32_16x16x32_bf16 v[228:231], a[132:135], a[84:87], v[228:231]
  ds_read_b64_tr_b16 a[162:163], v2 offset:32320
  v_mfma_f32_16x16x32_bf16 v[228:231], a[128:131], a[68:71], v[228:231]
  v_mfma_f32_16x16x32_bf16 v[232:235], a[128:131], a[72:75], v[232:235]
  ds_read_b64_tr_b16 a[164:165], v2 offset:35904
  v_mfma_f32_16x16x32_bf16 v[232:235], a[132:135], a[88:91], v[232:235]
  buffer_load_dwordx4 v3, s[16:19], s10 offen offset:0 lds
  v_mfma_f32_16x16x32_bf16 v[236:239], a[132:135], a[92:95], v[236:239]
  ds_read_b64_tr_b16 a[166:167], v2 offset:39488
  v_mfma_f32_16x16x32_bf16 v[236:239], a[128:131], a[76:79], v[236:239]
  v_mfma_f32_16x16x32_bf16 v[252:255], a[136:139], a[76:79], v[252:255]
  ds_read_b64_tr_b16 a[168:169], v2 offset:28768
  v_mfma_f32_16x16x32_bf16 v[252:255], a[140:143], a[92:95], v[252:255]
  v_mfma_f32_16x16x32_bf16 v[248:251], a[140:143], a[88:91], v[248:251]
  ds_read_b64_tr_b16 a[170:171], v2 offset:32352
  v_mfma_f32_16x16x32_bf16 v[248:251], a[136:139], a[72:75], v[248:251]
  v_mfma_f32_16x16x32_bf16 v[244:247], a[136:139], a[68:71], v[244:247]
  ds_read_b64_tr_b16 a[172:173], v2 offset:35936
  v_mfma_f32_16x16x32_bf16 v[244:247], a[140:143], a[84:87], v[244:247]
  v_mfma_f32_16x16x32_bf16 v[240:243], a[140:143], a[80:83], v[240:243]
  ds_read_b64_tr_b16 a[174:175], v2 offset:39520
  v_mfma_f32_16x16x32_bf16 v[240:243], a[136:139], a[64:67], v[240:243]
  s_waitcnt vmcnt(9) lgkmcnt(8)
  v_mfma_f32_16x16x32_bf16 v[32:35], a[144:147], a[96:99], v[32:35]
  s_add_u32 s11, s11, 4096
  ds_read_b64_tr_b16 a[128:129], v2 offset:28800
  v_mfma_f32_16x16x32_bf16 v[32:35], a[148:151], a[112:115], v[32:35]
  s_barrier
  v_mfma_f32_16x16x32_bf16 v[36:39], a[148:151], a[116:119], v[36:39]
  ds_read_b64_tr_b16 a[130:131], v2 offset:32384
  v_mfma_f32_16x16x32_bf16 v[36:39], a[144:147], a[100:103], v[36:39]
  v_mfma_f32_16x16x32_bf16 v[40:43], a[144:147], a[104:107], v[40:43]
  buffer_load_dwordx4 a[16:19], v0, s[36:39], s11 offen offset:0 sc1
  ds_read_b64_tr_b16 a[132:133], v2 offset:35968
  v_mfma_f32_16x16x32_bf16 v[40:43], a[148:151], a[120:123], v[40:43]
  v_mfma_f32_16x16x32_bf16 v[44:47], a[148:151], a[124:127], v[44:47]
  ds_read_b64_tr_b16 a[134:135], v2 offset:39552
  v_mfma_f32_16x16x32_bf16 v[44:47], a[144:147], a[108:111], v[44:47]
  v_mfma_f32_16x16x32_bf16 v[60:63], a[152:155], a[108:111], v[60:63]
  ds_read_b64_tr_b16 a[136:137], v2 offset:28832
  v_mfma_f32_16x16x32_bf16 v[60:63], a[156:159], a[124:127], v[60:63]
  buffer_load_dwordx4 v4, s[16:19], s10 offen offset:1024 lds
  v_mfma_f32_16x16x32_bf16 v[56:59], a[156:159], a[120:123], v[56:59]
  ds_read_b64_tr_b16 a[138:139], v2 offset:32416
  v_mfma_f32_16x16x32_bf16 v[56:59], a[152:155], a[104:107], v[56:59]
  v_mfma_f32_16x16x32_bf16 v[52:55], a[152:155], a[100:103], v[52:55]
  ds_read_b64_tr_b16 a[140:141], v2 offset:36000
  v_mfma_f32_16x16x32_bf16 v[52:55], a[156:159], a[116:119], v[52:55]
  v_mfma_f32_16x16x32_bf16 v[48:51], a[156:159], a[112:115], v[48:51]
  ds_read_b64_tr_b16 a[142:143], v2 offset:39584
  v_mfma_f32_16x16x32_bf16 v[48:51], a[152:155], a[96:99], v[48:51]
  s_waitcnt lgkmcnt(8)
  v_mfma_f32_16x16x32_bf16 v[64:67], a[160:163], a[96:99], v[64:67]
  ds_read_b64_tr_b16 a[144:145], v2 offset:28864
  v_mfma_f32_16x16x32_bf16 v[64:67], a[164:167], a[112:115], v[64:67]
  v_mfma_f32_16x16x32_bf16 v[68:71], a[164:167], a[116:119], v[68:71]
  ds_read_b64_tr_b16 a[146:147], v2 offset:32448
  v_mfma_f32_16x16x32_bf16 v[68:71], a[160:163], a[100:103], v[68:71]
  buffer_load_dwordx4 a[20:23], v0, s[36:39], s11 offen offset:1024 sc1
  v_mfma_f32_16x16x32_bf16 v[72:75], a[160:163], a[104:107], v[72:75]
  ds_read_b64_tr_b16 a[148:149], v2 offset:36032
  v_mfma_f32_16x16x32_bf16 v[72:75], a[164:167], a[120:123], v[72:75]
  v_mfma_f32_16x16x32_bf16 v[76:79], a[164:167], a[124:127], v[76:79]
  ds_read_b64_tr_b16 a[150:151], v2 offset:39616
  v_mfma_f32_16x16x32_bf16 v[76:79], a[160:163], a[108:111], v[76:79]
  v_mfma_f32_16x16x32_bf16 v[92:95], a[168:171], a[108:111], v[92:95]
  buffer_load_dwordx4 v5, s[16:19], s10 offen offset:2048 lds
  ds_read_b64_tr_b16 a[152:153], v2 offset:43008
  v_mfma_f32_16x16x32_bf16 v[92:95], a[172:175], a[124:127], v[92:95]
  v_mfma_f32_16x16x32_bf16 v[88:91], a[172:175], a[120:123], v[88:91]
  ds_read_b64_tr_b16 a[154:155], v2 offset:46592
  v_mfma_f32_16x16x32_bf16 v[88:91], a[168:171], a[104:107], v[88:91]
  v_mfma_f32_16x16x32_bf16 v[84:87], a[168:171], a[100:103], v[84:87]
  ds_read_b64_tr_b16 a[156:157], v2 offset:50176
  v_mfma_f32_16x16x32_bf16 v[84:87], a[172:175], a[116:119], v[84:87]
  v_mfma_f32_16x16x32_bf16 v[80:83], a[172:175], a[112:115], v[80:83]
  ds_read_b64_tr_b16 a[158:159], v2 offset:53760
  v_mfma_f32_16x16x32_bf16 v[80:83], a[168:171], a[96:99], v[80:83]
  s_waitcnt lgkmcnt(8)
  v_mfma_f32_16x16x32_bf16 v[96:99], a[128:131], a[96:99], v[96:99]
  buffer_load_dwordx4 v6, s[16:19], s10 offen offset:3072 lds
  ds_read_b64_tr_b16 a[160:161], v2 offset:43040
  v_mfma_f32_16x16x32_bf16 v[96:99], a[132:135], a[112:115], v[96:99]
  v_mfma_f32_16x16x32_bf16 v[100:103], a[132:135], a[116:119], v[100:103]
  ds_read_b64_tr_b16 a[162:163], v2 offset:46624
  v_mfma_f32_16x16x32_bf16 v[100:103], a[128:131], a[100:103], v[100:103]
  v_mfma_f32_16x16x32_bf16 v[104:107], a[128:131], a[104:107], v[104:107]
  ds_read_b64_tr_b16 a[164:165], v2 offset:50208
  v_mfma_f32_16x16x32_bf16 v[104:107], a[132:135], a[120:123], v[104:107]
  buffer_load_dwordx4 a[24:27], v0, s[36:39], s11 offen offset:2048 sc1
  v_mfma_f32_16x16x32_bf16 v[108:111], a[132:135], a[124:127], v[108:111]
  ds_read_b64_tr_b16 a[166:167], v2 offset:53792
  v_mfma_f32_16x16x32_bf16 v[108:111], a[128:131], a[108:111], v[108:111]
  v_mfma_f32_16x16x32_bf16 v[124:127], a[136:139], a[108:111], v[124:127]
  s_add_u32 m0, s79, 32768
  ds_read_b64_tr_b16 a[168:169], v2 offset:43072
  v_mfma_f32_16x16x32_bf16 v[124:127], a[140:143], a[124:127], v[124:127]
  v_mfma_f32_16x16x32_bf16 v[120:123], a[140:143], a[120:123], v[120:123]
  ds_read_b64_tr_b16 a[170:171], v2 offset:46656
  v_mfma_f32_16x16x32_bf16 v[120:123], a[136:139], a[104:107], v[120:123]
  v_mfma_f32_16x16x32_bf16 v[116:119], a[136:139], a[100:103], v[116:119]
  buffer_load_dwordx4 v7, s[16:19], s10 offen offset:0 lds
  ds_read_b64_tr_b16 a[172:173], v2 offset:50240
  v_mfma_f32_16x16x32_bf16 v[116:119], a[140:143], a[116:119], v[116:119]
  v_mfma_f32_16x16x32_bf16 v[112:115], a[140:143], a[112:115], v[112:115]
  ds_read_b64_tr_b16 a[174:175], v2 offset:53824
  v_mfma_f32_16x16x32_bf16 v[112:115], a[136:139], a[96:99], v[112:115]
  s_waitcnt lgkmcnt(8)
  v_mfma_f32_16x16x32_bf16 v[128:131], a[144:147], a[96:99], v[128:131]
  ds_read_b64_tr_b16 a[128:129], v2 offset:43104
  v_mfma_f32_16x16x32_bf16 v[128:131], a[148:151], a[112:115], v[128:131]
  buffer_load_dwordx4 a[28:31], v0, s[36:39], s11 offen offset:3072 sc1
  v_mfma_f32_16x16x32_bf16 v[132:135], a[148:151], a[116:119], v[132:135]
  ds_read_b64_tr_b16 a[130:131], v2 offset:46688
  v_mfma_f32_16x16x32_bf16 v[132:135], a[144:147], a[100:103], v[132:135]
  v_mfma_f32_16x16x32_bf16 v[136:139], a[144:147], a[104:107], v[136:139]
  ds_read_b64_tr_b16 a[132:133], v2 offset:50272
  v_mfma_f32_16x16x32_bf16 v[136:139], a[148:151], a[120:123], v[136:139]
  v_mfma_f32_16x16x32_bf16 v[140:143], a[148:151], a[124:127], v[140:143]
  ds_read_b64_tr_b16 a[134:135], v2 offset:53856
  v_mfma_f32_16x16x32_bf16 v[140:143], a[144:147], a[108:111], v[140:143]
  v_mfma_f32_16x16x32_bf16 v[156:159], a[152:155], a[108:111], v[156:159]
  buffer_load_dwordx4 v8, s[16:19], s10 offen offset:1024 lds
  s_bfe_u32 s11, s83, 0x40004
  v_mfma_f32_16x16x32_bf16 v[156:159], a[156:159], a[124:127], v[156:159]
  s_lshl_b32 s11, s11, 13
  s_add_u32 s11, s11, s84
  ds_read_b64_tr_b16 a[136:137], v2 offset:43136
  v_mfma_f32_16x16x32_bf16 v[152:155], a[156:159], a[120:123], v[152:155]
  ds_read_b64_tr_b16 a[138:139], v2 offset:46720
  v_mfma_f32_16x16x32_bf16 v[152:155], a[152:155], a[104:107], v[152:155]
  v_mfma_f32_16x16x32_bf16 v[148:151], a[152:155], a[100:103], v[148:151]
  ds_read_b64_tr_b16 a[140:141], v2 offset:50304
  v_mfma_f32_16x16x32_bf16 v[148:151], a[156:159], a[116:119], v[148:151]
  buffer_load_dwordx4 a[32:35], v0, s[36:39], s11 offen offset:0 sc1
  v_mfma_f32_16x16x32_bf16 v[144:147], a[156:159], a[112:115], v[144:147]
  ds_read_b64_tr_b16 a[142:143], v2 offset:53888
  v_mfma_f32_16x16x32_bf16 v[144:147], a[152:155], a[96:99], v[144:147]
  s_waitcnt lgkmcnt(8)
  v_mfma_f32_16x16x32_bf16 v[160:163], a[160:163], a[96:99], v[160:163]
  ds_read_b64_tr_b16 a[144:145], v2 offset:43168
  v_mfma_f32_16x16x32_bf16 v[160:163], a[164:167], a[112:115], v[160:163]
  v_mfma_f32_16x16x32_bf16 v[164:167], a[164:167], a[116:119], v[164:167]
  buffer_load_dwordx4 a[36:39], v0, s[36:39], s11 offen offset:1024 sc1
  ds_read_b64_tr_b16 a[146:147], v2 offset:46752
  v_mfma_f32_16x16x32_bf16 v[164:167], a[160:163], a[100:103], v[164:167]
  v_mfma_f32_16x16x32_bf16 v[168:171], a[160:163], a[104:107], v[168:171]
  ds_read_b64_tr_b16 a[148:149], v2 offset:50336
  v_mfma_f32_16x16x32_bf16 v[168:171], a[164:167], a[120:123], v[168:171]
  v_mfma_f32_16x16x32_bf16 v[172:175], a[164:167], a[124:127], v[172:175]
  ds_read_b64_tr_b16 a[150:151], v2 offset:53920
  v_mfma_f32_16x16x32_bf16 v[172:175], a[160:163], a[108:111], v[172:175]
  s_waitcnt vmcnt(15)
  s_barrier
  buffer_load_dwordx4 v9, s[16:19], s10 offen offset:2048 lds
  v_mfma_f32_16x16x32_bf16 v[188:191], a[168:171], a[108:111], v[188:191]
  ds_read_b64_tr_b16 a[152:153], v2 offset:43200
  v_mfma_f32_16x16x32_bf16 v[188:191], a[172:175], a[124:127], v[188:191]
  v_mfma_f32_16x16x32_bf16 v[184:187], a[172:175], a[120:123], v[184:187]
  ds_read_b64_tr_b16 a[154:155], v2 offset:46784
  v_mfma_f32_16x16x32_bf16 v[184:187], a[168:171], a[104:107], v[184:187]
  v_mfma_f32_16x16x32_bf16 v[180:183], a[168:171], a[100:103], v[180:183]
  ds_read_b64_tr_b16 a[156:157], v2 offset:50368
  v_mfma_f32_16x16x32_bf16 v[180:183], a[172:175], a[116:119], v[180:183]
  buffer_load_dwordx4 a[40:43], v0, s[36:39], s11 offen offset:2048 sc1
  v_mfma_f32_16x16x32_bf16 v[176:179], a[172:175], a[112:115], v[176:179]
  ds_read_b64_tr_b16 a[158:159], v2 offset:53952
  v_mfma_f32_16x16x32_bf16 v[176:179], a[168:171], a[96:99], v[176:179]
  s_waitcnt lgkmcnt(8)
  v_mfma_f32_16x16x32_bf16 v[192:195], a[128:131], a[96:99], v[192:195]
  ds_read_b64_tr_b16 a[160:161], v1 offset:0
  v_mfma_f32_16x16x32_bf16 v[192:195], a[132:135], a[112:115], v[192:195]
  v_mfma_f32_16x16x32_bf16 v[196:199], a[132:135], a[116:119], v[196:199]
  ds_read_b64_tr_b16 a[162:163], v1 offset:3584
  v_mfma_f32_16x16x32_bf16 v[196:199], a[128:131], a[100:103], v[196:199]
  v_mfma_f32_16x16x32_bf16 v[200:203], a[128:131], a[104:107], v[200:203]
  ds_read_b64_tr_b16 a[164:165], v1 offset:7168
  v_mfma_f32_16x16x32_bf16 v[200:203], a[132:135], a[120:123], v[200:203]
  v_mfma_f32_16x16x32_bf16 v[204:207], a[132:135], a[124:127], v[204:207]
  ds_read_b64_tr_b16 a[166:167], v1 offset:10752
  v_mfma_f32_16x16x32_bf16 v[204:207], a[128:131], a[108:111], v[204:207]
  buffer_load_dwordx4 a[44:47], v0, s[36:39], s11 offen offset:3072 sc1
  s_bfe_u32 s10, s83, 0x40008
  v_mfma_f32_16x16x32_bf16 v[220:223], a[136:139], a[108:111], v[220:223]
  s_mul_i32 s10, s10, 458752
  s_add_u32 m0, s79, 57344
  ds_read_b64_tr_b16 a[168:169], v1 offset:32
  v_mfma_f32_16x16x32_bf16 v[220:223], a[140:143], a[124:127], v[220:223]
  v_mfma_f32_16x16x32_bf16 v[216:219], a[140:143], a[120:123], v[216:219]
  s_add_u32 s20, s20, 16384
  ds_read_b64_tr_b16 a[170:171], v1 offset:3616
  v_add_u32 v31, -28672, v31
  v_mfma_f32_16x16x32_bf16 v[216:219], a[136:139], a[104:107], v[216:219]
  v_mfma_f32_16x16x32_bf16 v[212:215], a[136:139], a[100:103], v[212:215]
  buffer_load_dwordx4 v3, s[16:19], s10 offen offset:0 lds
  ds_read_b64_tr_b16 a[172:173], v1 offset:7200
  v_mfma_f32_16x16x32_bf16 v[212:215], a[140:143], a[116:119], v[212:215]
  v_mfma_f32_16x16x32_bf16 v[208:211], a[140:143], a[112:115], v[208:211]
  s_add_u32 s11, s11, 4096
  ds_read_b64_tr_b16 a[174:175], v1 offset:10784
  v_mfma_f32_16x16x32_bf16 v[208:211], a[136:139], a[96:99], v[208:211]
  s_waitcnt lgkmcnt(8)
  v_mfma_f32_16x16x32_bf16 v[224:227], a[144:147], a[96:99], v[224:227]
  ds_read_b64_tr_b16 a[128:129], v1 offset:64
  v_mfma_f32_16x16x32_bf16 v[224:227], a[148:151], a[112:115], v[224:227]
  buffer_load_dwordx4 a[208:211], v0, s[36:39], s20 offen offset:0 sc1
  v_mfma_f32_16x16x32_bf16 v[228:231], a[148:151], a[116:119], v[228:231]
  ds_read_b64_tr_b16 a[130:131], v1 offset:3648
  v_mfma_f32_16x16x32_bf16 v[228:231], a[144:147], a[100:103], v[228:231]
  v_mfma_f32_16x16x32_bf16 v[232:235], a[144:147], a[104:107], v[232:235]
  ds_read_b64_tr_b16 a[132:133], v1 offset:7232
  v_mfma_f32_16x16x32_bf16 v[232:235], a[148:151], a[120:123], v[232:235]
  v_mfma_f32_16x16x32_bf16 v[236:239], a[148:151], a[124:127], v[236:239]
  buffer_load_dwordx4 a[212:215], v0, s[36:39], s20 offen offset:1024 sc1
  ds_read_b64_tr_b16 a[134:135], v1 offset:10816
  v_mfma_f32_16x16x32_bf16 v[236:239], a[144:147], a[108:111], v[236:239]
  v_mfma_f32_16x16x32_bf16 v[252:255], a[152:155], a[108:111], v[252:255]
  ds_read_b64_tr_b16 a[136:137], v1 offset:96
  v_mfma_f32_16x16x32_bf16 v[252:255], a[156:159], a[124:127], v[252:255]
  v_mfma_f32_16x16x32_bf16 v[248:251], a[156:159], a[120:123], v[248:251]
  ds_read_b64_tr_b16 a[138:139], v1 offset:3680
  v_mfma_f32_16x16x32_bf16 v[248:251], a[152:155], a[104:107], v[248:251]
  buffer_load_dwordx4 a[48:51], v0, s[36:39], s11 offen offset:0 sc1
  v_mfma_f32_16x16x32_bf16 v[244:247], a[152:155], a[100:103], v[244:247]
  ds_read_b64_tr_b16 a[140:141], v1 offset:7264
  v_mfma_f32_16x16x32_bf16 v[244:247], a[156:159], a[116:119], v[244:247]
  v_mfma_f32_16x16x32_bf16 v[240:243], a[156:159], a[112:115], v[240:243]
  ds_read_b64_tr_b16 a[142:143], v1 offset:10848
  v_mfma_f32_16x16x32_bf16 v[240:243], a[152:155], a[96:99], v[240:243]
  s_waitcnt vmcnt(10) lgkmcnt(8)
  v_mfma_f32_16x16x32_bf16 v[32:35], a[160:163], a[0:3], v[32:35]
  buffer_load_dwordx4 v4, s[16:19], s10 offen offset:1024 lds
  ds_read_b64_tr_b16 a[144:145], v1 offset:128
  v_mfma_f32_16x16x32_bf16 v[32:35], a[164:167], a[16:19], v[32:35]
  s_barrier
  v_mfma_f32_16x16x32_bf16 v[36:39], a[164:167], a[20:23], v[36:39]
  ds_read_b64_tr_b16 a[146:147], v1 offset:3712
  v_mfma_f32_16x16x32_bf16 v[36:39], a[160:163], a[4:7], v[36:39]
  v_mfma_f32_16x16x32_bf16 v[40:43], a[160:163], a[8:11], v[40:43]
  ds_read_b64_tr_b16 a[148:149], v1 offset:7296
  v_mfma_f32_16x16x32_bf16 v[40:43], a[164:167], a[24:27], v[40:43]
  buffer_load_dwordx4 a[52:55], v0, s[36:39], s11 offen offset:1024 sc1
  v_mfma_f32_16x16x32_bf16 v[44:47], a[164:167], a[28:31], v[44:47]
  ds_read_b64_tr_b16 a[150:151], v1 offset:10880
  v_mfma_f32_16x16x32_bf16 v[44:47], a[160:163], a[12:15], v[44:47]
  v_mfma_f32_16x16x32_bf16 v[60:63], a[168:171], a[12:15], v[60:63]
  ds_read_b64_tr_b16 a[152:153], v1 offset:160
  v_mfma_f32_16x16x32_bf16 v[60:63], a[172:175], a[28:31], v[60:63]
  v_mfma_f32_16x16x32_bf16 v[56:59], a[172:175], a[24:27], v[56:59]
  buffer_load_dwordx4 v5, s[16:19], s10 offen offset:2048 lds
  ds_read_b64_tr_b16 a[154:155], v1 offset:3744
  v_mfma_f32_16x16x32_bf16 v[56:59], a[168:171], a[8:11], v[56:59]
  v_mfma_f32_16x16x32_bf16 v[52:55], a[168:171], a[4:7], v[52:55]
  ds_read_b64_tr_b16 a[156:157], v1 offset:7328
  v_mfma_f32_16x16x32_bf16 v[52:55], a[172:175], a[20:23], v[52:55]
  v_mfma_f32_16x16x32_bf16 v[48:51], a[172:175], a[16:19], v[48:51]
  ds_read_b64_tr_b16 a[158:159], v1 offset:10912
  v_mfma_f32_16x16x32_bf16 v[48:51], a[168:171], a[0:3], v[48:51]
  s_waitcnt lgkmcnt(8)
  buffer_load_dwordx4 a[56:59], v0, s[36:39], s11 offen offset:2048 sc1
  v_mfma_f32_16x16x32_bf16 v[64:67], a[128:131], a[0:3], v[64:67]
  ds_read_b64_tr_b16 a[160:161], v1 offset:192
  v_mfma_f32_16x16x32_bf16 v[64:67], a[132:135], a[16:19], v[64:67]
  v_mfma_f32_16x16x32_bf16 v[68:71], a[132:135], a[20:23], v[68:71]
  ds_read_b64_tr_b16 a[162:163], v1 offset:3776
  v_mfma_f32_16x16x32_bf16 v[68:71], a[128:131], a[4:7], v[68:71]
  v_mfma_f32_16x16x32_bf16 v[72:75], a[128:131], a[8:11], v[72:75]
  buffer_load_dwordx4 v6, s[16:19], s10 offen offset:3072 lds
  ds_read_b64_tr_b16 a[164:165], v1 offset:7360
  v_mfma_f32_16x16x32_bf16 v[72:75], a[132:135], a[24:27], v[72:75]
  v_mfma_f32_16x16x32_bf16 v[76:79], a[132:135], a[28:31], v[76:79]
  ds_read_b64_tr_b16 a[166:167], v1 offset:10944
  v_mfma_f32_16x16x32_bf16 v[76:79], a[128:131], a[12:15], v[76:79]
  v_mfma_f32_16x16x32_bf16 v[92:95], a[136:139], a[12:15], v[92:95]
  ds_read_b64_tr_b16 a[168:169], v1 offset:14336
  v_mfma_f32_16x16x32_bf16 v[92:95], a[140:143], a[28:31], v[92:95]
  buffer_load_dwordx4 a[60:63], v0, s[36:39], s11 offen offset:3072 sc1
  s_bfe_u32 s11, s83, 0x40008
  v_mfma_f32_16x16x32_bf16 v[88:91], a[140:143], a[24:27], v[88:91]
  s_lshl_b32 s11, s11, 13
  s_add_u32 s11, s11, s84
  ds_read_b64_tr_b16 a[170:171], v1 offset:17920
  v_mfma_f32_16x16x32_bf16 v[88:91], a[136:139], a[8:11], v[88:91]
  v_mfma_f32_16x16x32_bf16 v[84:87], a[136:139], a[4:7], v[84:87]
  ds_read_b64_tr_b16 a[172:173], v1 offset:21504
  v_mfma_f32_16x16x32_bf16 v[84:87], a[140:143], a[20:23], v[84:87]
  v_mfma_f32_16x16x32_bf16 v[80:83], a[140:143], a[16:19], v[80:83]
  buffer_load_dwordx4 a[64:67], v0, s[36:39], s11 offen offset:0 sc1
  s_add_u32 m0, s79, 61440
  v_mfma_f32_16x16x32_bf16 v[80:83], a[136:139], a[0:3], v[80:83]
  s_waitcnt lgkmcnt(7)
  ds_read_b64_tr_b16 a[174:175], v1 offset:25088
  v_mfma_f32_16x16x32_bf16 v[96:99], a[144:147], a[0:3], v[96:99]
  ds_read_b64_tr_b16 a[128:129], v1 offset:14368
  v_mfma_f32_16x16x32_bf16 v[96:99], a[148:151], a[16:19], v[96:99]
  v_mfma_f32_16x16x32_bf16 v[100:103], a[148:151], a[20:23], v[100:103]
  ds_read_b64_tr_b16 a[130:131], v1 offset:17952
  v_mfma_f32_16x16x32_bf16 v[100:103], a[144:147], a[4:7], v[100:103]
  buffer_load_dwordx4 v7, s[16:19], s10 offen offset:0 lds
  v_mfma_f32_16x16x32_bf16 v[104:107], a[144:147], a[8:11], v[104:107]
  ds_read_b64_tr_b16 a[132:133], v1 offset:21536
  v_mfma_f32_16x16x32_bf16 v[104:107], a[148:151], a[24:27], v[104:107]
  v_mfma_f32_16x16x32_bf16 v[108:111], a[148:151], a[28:31], v[108:111]
  ds_read_b64_tr_b16 a[134:135], v1 offset:25120
  v_mfma_f32_16x16x32_bf16 v[108:111], a[144:147], a[12:15], v[108:111]
  v_mfma_f32_16x16x32_bf16 v[124:127], a[152:155], a[12:15], v[124:127]
  buffer_load_dwordx4 a[68:71], v0, s[36:39], s11 offen offset:1024 sc1
  ds_read_b64_tr_b16 a[136:137], v1 offset:14400
  v_mfma_f32_16x16x32_bf16 v[124:127], a[156:159], a[28:31], v[124:127]
  v_mfma_f32_16x16x32_bf16 v[120:123], a[156:159], a[24:27], v[120:123]
  ds_read_b64_tr_b16 a[138:139], v1 offset:17984
  v_mfma_f32_16x16x32_bf16 v[120:123], a[152:155], a[8:11], v[120:123]
  v_mfma_f32_16x16x32_bf16 v[116:119], a[152:155], a[4:7], v[116:119]
  ds_read_b64_tr_b16 a[140:141], v1 offset:21568
  v_mfma_f32_16x16x32_bf16 v[116:119], a[156:159], a[20:23], v[116:119]
  buffer_load_dwordx4 v8, s[16:19], s10 offen offset:1024 lds
  v_mfma_f32_16x16x32_bf16 v[112:115], a[156:159], a[16:19], v[112:115]
  ds_read_b64_tr_b16 a[142:143], v1 offset:25152
  v_mfma_f32_16x16x32_bf16 v[112:115], a[152:155], a[0:3], v[112:115]
  s_waitcnt lgkmcnt(8)
  v_mfma_f32_16x16x32_bf16 v[128:131], a[160:163], a[0:3], v[128:131]
  ds_read_b64_tr_b16 a[144:145], v1 offset:14432
  v_mfma_f32_16x16x32_bf16 v[128:131], a[164:167], a[16:19], v[128:131]
  v_mfma_f32_16x16x32_bf16 v[132:135], a[164:167], a[20:23], v[132:135]
  buffer_load_dwordx4 a[72:75], v0, s[36:39], s11 offen offset:2048 sc1
  ds_read_b64_tr_b16 a[146:147], v1 offset:18016
  v_mfma_f32_16x16x32_bf16 v[132:135], a[160:163], a[4:7], v[132:135]
  v_mfma_f32_16x16x32_bf16 v[136:139], a[160:163], a[8:11], v[136:139]
  ds_read_b64_tr_b16 a[148:149], v1 offset:21600
  v_mfma_f32_16x16x32_bf16 v[136:139], a[164:167], a[24:27], v[136:139]
  v_mfma_f32_16x16x32_bf16 v[140:143], a[164:167], a[28:31], v[140:143]
  ds_read_b64_tr_b16 a[150:151], v1 offset:25184
  v_mfma_f32_16x16x32_bf16 v[140:143], a[160:163], a[12:15], v[140:143]
  buffer_load_dwordx4 v9, s[16:19], s10 offen offset:2048 lds
  v_mfma_f32_16x16x32_bf16 v[156:159], a[168:171], a[12:15], v[156:159]
  ds_read_b64_tr_b16 a[152:153], v1 offset:14464
  v_mfma_f32_16x16x32_bf16 v[156:159], a[172:175], a[28:31], v[156:159]
  v_mfma_f32_16x16x32_bf16 v[152:155], a[172:175], a[24:27], v[152:155]
  ds_read_b64_tr_b16 a[154:155], v1 offset:18048
  v_mfma_f32_16x16x32_bf16 v[152:155], a[168:171], a[8:11], v[152:155]
  v_mfma_f32_16x16x32_bf16 v[148:151], a[168:171], a[4:7], v[148:151]
  buffer_load_dwordx4 a[76:79], v0, s[36:39], s11 offen offset:3072 sc1
  s_add_u32 s11, s11, 4096
  v_mfma_f32_16x16x32_bf16 v[148:151], a[172:175], a[20:23], v[148:151]
  ds_read_b64_tr_b16 a[156:157], v1 offset:21632
  v_mfma_f32_16x16x32_bf16 v[144:147], a[172:175], a[16:19], v[144:147]
  ds_read_b64_tr_b16 a[158:159], v1 offset:25216
  v_mfma_f32_16x16x32_bf16 v[144:147], a[168:171], a[0:3], v[144:147]
  s_waitcnt lgkmcnt(8)
  v_mfma_f32_16x16x32_bf16 v[160:163], a[128:131], a[0:3], v[160:163]
  ds_read_b64_tr_b16 a[160:161], v1 offset:14496
  v_mfma_f32_16x16x32_bf16 v[160:163], a[132:135], a[16:19], v[160:163]
  buffer_load_dwordx4 a[80:83], v0, s[36:39], s11 offen offset:0 sc1
  s_bfe_u32 s10, s83, 0x4000c
  v_mfma_f32_16x16x32_bf16 v[164:167], a[132:135], a[20:23], v[164:167]
  s_mul_i32 s10, s10, 458752
  s_add_u32 m0, s79, 86016
  ds_read_b64_tr_b16 a[162:163], v1 offset:18080
  v_mfma_f32_16x16x32_bf16 v[164:167], a[128:131], a[4:7], v[164:167]
  v_mfma_f32_16x16x32_bf16 v[168:171], a[128:131], a[8:11], v[168:171]
  ds_read_b64_tr_b16 a[164:165], v1 offset:21664
  v_mfma_f32_16x16x32_bf16 v[168:171], a[132:135], a[24:27], v[168:171]
  v_mfma_f32_16x16x32_bf16 v[172:175], a[132:135], a[28:31], v[172:175]
  buffer_load_dwordx4 v3, s[16:19], s10 offen offset:0 lds
  ds_read_b64_tr_b16 a[166:167], v1 offset:25248
  v_mfma_f32_16x16x32_bf16 v[172:175], a[128:131], a[12:15], v[172:175]
  s_waitcnt vmcnt(21)
  s_barrier
  v_mfma_f32_16x16x32_bf16 v[188:191], a[136:139], a[12:15], v[188:191]
  ds_read_b64_tr_b16 a[168:169], v1 offset:14528
  ds_read_b64_tr_b16 a[176:177], v31 offset:0
  v_mfma_f32_16x16x32_bf16 v[188:191], a[140:143], a[28:31], v[188:191]
  v_mfma_f32_16x16x32_bf16 v[184:187], a[140:143], a[24:27], v[184:187]
  ds_read_b64_tr_b16 a[170:171], v1 offset:18112
  ds_read_b64_tr_b16 a[178:179], v31 offset:3584
  v_mfma_f32_16x16x32_bf16 v[184:187], a[136:139], a[8:11], v[184:187]
  buffer_load_dwordx4 a[84:87], v0, s[36:39], s11 offen offset:1024 sc1
  v_mfma_f32_16x16x32_bf16 v[180:183], a[136:139], a[4:7], v[180:183]
  ds_read_b64_tr_b16 a[172:173], v1 offset:21696
  ds_read_b64_tr_b16 a[180:181], v31 offset:7168
  v_mfma_f32_16x16x32_bf16 v[180:183], a[140:143], a[20:23], v[180:183]
  v_mfma_f32_16x16x32_bf16 v[176:179], a[140:143], a[16:19], v[176:179]
  ds_read_b64_tr_b16 a[174:175], v1 offset:25280
  ds_read_b64_tr_b16 a[182:183], v31 offset:10752
  v_mfma_f32_16x16x32_bf16 v[176:179], a[136:139], a[0:3], v[176:179]
  s_waitcnt lgkmcnt(12)
  v_mfma_f32_16x16x32_bf16 v[192:195], a[144:147], a[0:3], v[192:195]
  buffer_load_dwordx4 v4, s[16:19], s10 offen offset:1024 lds
  ds_read_b64_tr_b16 a[128:129], v1 offset:28672
  v_mfma_f32_16x16x32_bf16 v[192:195], a[148:151], a[16:19], v[192:195]
  ds_read_b64_tr_b16 a[184:185], v31 offset:32
  v_mfma_f32_16x16x32_bf16 v[196:199], a[148:151], a[20:23], v[196:199]
  ds_read_b64_tr_b16 a[130:131], v1 offset:32256
  ds_read_b64_tr_b16 a[186:187], v31 offset:3616
  v_mfma_f32_16x16x32_bf16 v[196:199], a[144:147], a[4:7], v[196:199]
  v_mfma_f32_16x16x32_bf16 v[200:203], a[144:147], a[8:11], v[200:203]
  ds_read_b64_tr_b16 a[132:133], v1 offset:35840
  ds_read_b64_tr_b16 a[188:189], v31 offset:7200
  v_mfma_f32_16x16x32_bf16 v[200:203], a[148:151], a[24:27], v[200:203]
  buffer_load_dwordx4 a[88:91], v0, s[36:39], s11 offen offset:2048 sc1
  v_mfma_f32_16x16x32_bf16 v[204:207], a[148:151], a[28:31], v[204:207]
  ds_read_b64_tr_b16 a[134:135], v1 offset:39424
  ds_read_b64_tr_b16 a[190:191], v31 offset:10784
  v_mfma_f32_16x16x32_bf16 v[204:207], a[144:147], a[12:15], v[204:207]
  v_mfma_f32_16x16x32_bf16 v[220:223], a[152:155], a[12:15], v[220:223]
  ds_read_b64_tr_b16 a[136:137], v1 offset:28704
  ds_read_b64_tr_b16 a[192:193], v31 offset:64
  v_mfma_f32_16x16x32_bf16 v[220:223], a[156:159], a[28:31], v[220:223]
  v_mfma_f32_16x16x32_bf16 v[216:219], a[156:159], a[24:27], v[216:219]
  ds_read_b64_tr_b16 a[138:139], v1 offset:32288
  ds_read_b64_tr_b16 a[194:195], v31 offset:3648
  v_mfma_f32_16x16x32_bf16 v[216:219], a[152:155], a[8:11], v[216:219]
  buffer_load_dwordx4 v5, s[16:19], s10 offen offset:2048 lds
  v_mfma_f32_16x16x32_bf16 v[212:215], a[152:155], a[4:7], v[212:215]
  ds_read_b64_tr_b16 a[140:141], v1 offset:35872
  ds_read_b64_tr_b16 a[196:197], v31 offset:7232
  v_mfma_f32_16x16x32_bf16 v[212:215], a[156:159], a[20:23], v[212:215]
  v_mfma_f32_16x16x32_bf16 v[208:211], a[156:159], a[16:19], v[208:211]
  ds_read_b64_tr_b16 a[142:143], v1 offset:39456
  ds_read_b64_tr_b16 a[198:199], v31 offset:10816
  v_mfma_f32_16x16x32_bf16 v[208:211], a[152:155], a[0:3], v[208:211]
  s_waitcnt lgkmcnt(15)
  v_mfma_f32_16x16x32_bf16 v[224:227], a[160:163], a[0:3], v[224:227]
  buffer_load_dwordx4 a[92:95], v0, s[36:39], s11 offen offset:3072 sc1
  ds_read_b64_tr_b16 a[200:201], v31 offset:96
  v_mfma_f32_16x16x32_bf16 v[224:227], a[164:167], a[16:19], v[224:227]
  s_bfe_u32 s11, s83, 0x4000c
  s_lshl_b32 s11, s11, 13
  s_add_u32 s11, s11, s84
  v_mfma_f32_16x16x32_bf16 v[228:231], a[164:167], a[20:23], v[228:231]
  ds_read_b64_tr_b16 a[202:203], v31 offset:3680
  v_mfma_f32_16x16x32_bf16 v[228:231], a[160:163], a[4:7], v[228:231]
  v_mfma_f32_16x16x32_bf16 v[232:235], a[160:163], a[8:11], v[232:235]
  ds_read_b64_tr_b16 a[204:205], v31 offset:7264
  v_mfma_f32_16x16x32_bf16 v[232:235], a[164:167], a[24:27], v[232:235]
  buffer_load_dwordx4 a[96:99], v0, s[36:39], s11 offen offset:0 sc1
  v_mfma_f32_16x16x32_bf16 v[236:239], a[164:167], a[28:31], v[236:239]
  ds_read_b64_tr_b16 a[206:207], v31 offset:10848
  v_mfma_f32_16x16x32_bf16 v[236:239], a[160:163], a[12:15], v[236:239]
  v_mfma_f32_16x16x32_bf16 v[252:255], a[168:171], a[12:15], v[252:255]
  ds_read_b64_tr_b16 a[144:145], v1 offset:28736
  v_lshrrev_b32 v22, 4, v0
  v_mfma_f32_16x16x32_bf16 v[252:255], a[172:175], a[28:31], v[252:255]
  v_and_b32 v23, 14, v22
  v_lshlrev_b32 v23, 27, v23
  v_mfma_f32_16x16x32_bf16 v[248:251], a[172:175], a[24:27], v[248:251]
  buffer_load_dwordx4 v6, s[16:19], s10 offen offset:3072 lds
  ds_read_b64_tr_b16 a[146:147], v1 offset:32320
  v_mfma_f32_16x16x32_bf16 v[248:251], a[168:171], a[8:11], v[248:251]
  v_and_b32 v24, 1, v22
  v_lshl_add_u32 v23, v24, 9, v23
  v_mfma_f32_16x16x32_bf16 v[244:247], a[168:171], a[4:7], v[244:247]
  ds_read_b64_tr_b16 a[148:149], v1 offset:35904
  v_and_b32 v22, 0x30, v22
  v_mfma_f32_16x16x32_bf16 v[244:247], a[172:175], a[20:23], v[244:247]
  v_add_u32 v22, v22, v23
  s_lshl3_add_u32 s28, s59, s56
  v_mfma_f32_16x16x32_bf16 v[240:243], a[172:175], a[16:19], v[240:243]
  s_lshr_b32 s29, s44, 1
  ds_read_b64_tr_b16 a[150:151], v1 offset:39488
  s_lshl1_add_u32 s28, s28, s29
  v_mfma_f32_16x16x32_bf16 v[240:243], a[168:171], a[0:3], v[240:243]
  s_waitcnt vmcnt(16) lgkmcnt(9)
  buffer_load_dwordx4 a[100:103], v0, s[36:39], s11 offen offset:1024 sc1
  s_and_b32 s29, s44, 1
  v_mfma_f32_16x16x32_bf16 v[32:35], a[128:131], a[32:35], v[32:35]
  s_add_u32 m0, s79, 90112
  ds_read_b64_tr_b16 a[152:153], v1 offset:28768
  s_lshl2_add_u32 s28, s28, s29
  v_mfma_f32_16x16x32_bf16 v[32:35], a[132:135], a[48:51], v[32:35]
  s_barrier
  s_lshl_b32 s28, s28, 8
  s_add_u32 s28, s28, 524288
  v_mfma_f32_16x16x32_bf16 v[36:39], a[132:135], a[52:55], v[36:39]
  ds_read_b64_tr_b16 a[154:155], v1 offset:32352
  v_mfma_f32_16x16x32_bf16 v[36:39], a[128:131], a[36:39], v[36:39]
  v_mfma_f32_16x16x32_bf16 v[40:43], a[128:131], a[40:43], v[40:43]
  buffer_load_dwordx4 v7, s[16:19], s10 offen offset:0 lds
  ds_read_b64_tr_b16 a[156:157], v1 offset:35936
  v_mfma_f32_16x16x32_bf16 v[40:43], a[132:135], a[56:59], v[40:43]
CT13:
  s_add_u32 s94, s92, CT13-k3_main_kernel+3072
  s_addc_u32 s95, s93, 0
  v_mfma_f32_16x16x32_bf16 v[44:47], a[132:135], a[60:63], v[44:47]
  ds_read_b64_tr_b16 a[158:159], v1 offset:39520
  v_mfma_f32_16x16x32_bf16 v[44:47], a[128:131], a[44:47], v[44:47]
  v_mfma_f32_16x16x32_bf16 v[60:63], a[136:139], a[44:47], v[60:63]
  ds_read_b64_tr_b16 a[160:161], v1 offset:28800
  v_mfma_f32_16x16x32_bf16 v[60:63], a[140:143], a[60:63], v[60:63]
  global_load_dword a252, v0, s[94:95]
  v_mfma_f32_16x16x32_bf16 v[56:59], a[140:143], a[56:59], v[56:59]
  ds_read_b64_tr_b16 a[162:163], v1 offset:32384
  v_mfma_f32_16x16x32_bf16 v[56:59], a[136:139], a[40:43], v[56:59]
  v_mfma_f32_16x16x32_bf16 v[52:55], a[136:139], a[36:39], v[52:55]
  ds_read_b64_tr_b16 a[164:165], v1 offset:35968
  v_mfma_f32_16x16x32_bf16 v[52:55], a[140:143], a[52:55], v[52:55]
  v_mfma_f32_16x16x32_bf16 v[48:51], a[140:143], a[48:51], v[48:51]
  buffer_load_dwordx4 a[104:107], v0, s[36:39], s11 offen offset:2048 sc1
  ds_read_b64_tr_b16 a[166:167], v1 offset:39552
  v_mfma_f32_16x16x32_bf16 v[48:51], a[136:139], a[32:35], v[48:51]
  s_waitcnt vmcnt(27) lgkmcnt(12)
  v_mfma_f32_16x16x32_bf16 a[216:219], a[176:179], a[208:211], a[216:219]
  ds_read_b64_tr_b16 a[168:169], v1 offset:28832
  v_mfma_f32_16x16x32_bf16 a[216:219], a[180:183], a[212:215], a[216:219]
  v_mfma_f32_16x16x32_bf16 a[220:223], a[184:187], a[208:211], a[220:223]
  ds_read_b64_tr_b16 a[170:171], v1 offset:32416
  v_mfma_f32_16x16x32_bf16 a[220:223], a[188:191], a[212:215], a[220:223]
  buffer_load_dwordx4 v8, s[16:19], s10 offen offset:1024 lds
  v_mfma_f32_16x16x32_bf16 a[224:227], a[192:195], a[208:211], a[224:227]
  ds_read_b64_tr_b16 a[172:173], v1 offset:36000
  v_mfma_f32_16x16x32_bf16 a[224:227], a[196:199], a[212:215], a[224:227]
  v_mfma_f32_16x16x32_bf16 a[228:231], a[200:203], a[208:211], a[228:231]
  ds_read_b64_tr_b16 a[174:175], v1 offset:39584
  v_mfma_f32_16x16x32_bf16 a[228:231], a[204:207], a[212:215], a[228:231]
  s_waitcnt lgkmcnt(8)
  v_mfma_f32_16x16x32_bf16 v[64:67], a[144:147], a[32:35], v[64:67]
  buffer_load_dwordx4 a[108:111], v0, s[36:39], s11 offen offset:3072 sc1
  ds_read_b64_tr_b16 a[128:129], v1 offset:28864
  v_mfma_f32_16x16x32_bf16 v[64:67], a[148:151], a[48:51], v[64:67]
  v_mfma_f32_16x16x32_bf16 v[68:71], a[148:151], a[52:55], v[68:71]
  ds_read_b64_tr_b16 a[130:131], v1 offset:32448
  v_mfma_f32_16x16x32_bf16 v[68:71], a[144:147], a[36:39], v[68:71]
  v_mfma_f32_16x16x32_bf16 v[72:75], a[144:147], a[40:43], v[72:75]
  ds_read_b64_tr_b16 a[132:133], v1 offset:36032
  v_mfma_f32_16x16x32_bf16 v[72:75], a[148:151], a[56:59], v[72:75]
  buffer_load_dwordx4 v9, s[16:19], s10 offen offset:2048 lds
  s_add_u32 s11, s11, 4096
  v_mfma_f32_16x16x32_bf16 v[76:79], a[148:151], a[60:63], v[76:79]
  ds_read_b64_tr_b16 a[134:135], v1 offset:39616
  v_mfma_f32_16x16x32_bf16 v[76:79], a[144:147], a[44:47], v[76:79]
  v_mfma_f32_16x16x32_bf16 v[92:95], a[152:155], a[44:47], v[92:95]
  ds_read_b64_tr_b16 a[136:137], v1 offset:43008
  v_mfma_f32_16x16x32_bf16 v[92:95], a[156:159], a[60:63], v[92:95]
  v_mfma_f32_16x16x32_bf16 v[88:91], a[156:159], a[56:59], v[88:91]
  buffer_load_dwordx4 a[112:115], v0, s[36:39], s11 offen offset:0 sc1
  ds_read_b64_tr_b16 a[138:139], v1 offset:46592
  v_mfma_f32_16x16x32_bf16 v[88:91], a[152:155], a[40:43], v[88:91]
  v_mfma_f32_16x16x32_bf16 v[84:87], a[152:155], a[36:39], v[84:87]
  ds_read_b64_tr_b16 a[140:141], v1 offset:50176
  v_mfma_f32_16x16x32_bf16 v[84:87], a[156:159], a[52:55], v[84:87]
  v_mfma_f32_16x16x32_bf16 v[80:83], a[156:159], a[48:51], v[80:83]
  ds_read_b64_tr_b16 a[142:143], v1 offset:53760
  v_mfma_f32_16x16x32_bf16 v[80:83], a[152:155], a[32:35], v[80:83]
  s_waitcnt lgkmcnt(8)
  buffer_store_dwordx4 a[216:219], v22, s[36:39], s28 offen offset:0 sc1
  v_mfma_f32_16x16x32_bf16 v[96:99], a[160:163], a[32:35], v[96:99]
  ds_read_b64_tr_b16 a[144:145], v1 offset:43040
  v_mfma_f32_16x16x32_bf16 v[96:99], a[164:167], a[48:51], v[96:99]
  v_mfma_f32_16x16x32_bf16 v[100:103], a[164:167], a[52:55], v[100:103]
  ds_read_b64_tr_b16 a[146:147], v1 offset:46624
  v_mfma_f32_16x16x32_bf16 v[100:103], a[160:163], a[36:39], v[100:103]
  v_mfma_f32_16x16x32_bf16 v[104:107], a[160:163], a[40:43], v[104:107]
  buffer_load_dwordx4 a[116:119], v0, s[36:39], s11 offen offset:1024 sc1
  s_bfe_u32 s10, s83, 0x40010
  v_mfma_f32_16x16x32_bf16 v[104:107], a[164:167], a[56:59], v[104:107]
  s_mul_i32 s10, s10, 458752
  s_add_u32 m0, s79, 0
  ds_read_b64_tr_b16 a[148:149], v1 offset:50208
  v_mfma_f32_16x16x32_bf16 v[108:111], a[164:167], a[60:63], v[108:111]
  buffer_store_dwordx4 a[220:223], v22, s[36:39], s28 offen offset:64 sc1
  ds_read_b64_tr_b16 a[150:151], v1 offset:53792
  v_mfma_f32_16x16x32_bf16 v[108:111], a[160:163], a[44:47], v[108:111]
  v_mfma_f32_16x16x32_bf16 v[124:127], a[168:171], a[44:47], v[124:127]
  ds_read_b64_tr_b16 a[152:153], v1 offset:43072
  v_mfma_f32_16x16x32_bf16 v[124:127], a[172:175], a[60:63], v[124:127]
  v_mfma_f32_16x16x32_bf16 v[120:123], a[172:175], a[56:59], v[120:123]
  buffer_store_dwordx4 a[224:227], v22, s[36:39], s28 offen offset:128 sc1
  ds_read_b64_tr_b16 a[154:155], v1 offset:46656
  v_mfma_f32_16x16x32_bf16 v[120:123], a[168:171], a[40:43], v[120:123]
  v_mfma_f32_16x16x32_bf16 v[116:119], a[168:171], a[36:39], v[116:119]
  ds_read_b64_tr_b16 a[156:157], v1 offset:50240
  v_mfma_f32_16x16x32_bf16 v[116:119], a[172:175], a[52:55], v[116:119]
  v_mfma_f32_16x16x32_bf16 v[112:115], a[172:175], a[48:51], v[112:115]
  buffer_store_dwordx4 a[228:231], v22, s[36:39], s28 offen offset:192 sc1
  ds_read_b64_tr_b16 a[158:159], v1 offset:53824
  v_mfma_f32_16x16x32_bf16 v[112:115], a[168:171], a[32:35], v[112:115]
  s_waitcnt lgkmcnt(8)
  s_lshl_b32 s29, s59, 14
  s_lshl_b32 s30, s44, 9
  v_mfma_f32_16x16x32_bf16 v[128:131], a[128:131], a[32:35], v[128:131]
  s_add_u32 s29, s29, s30
  ds_read_b64_tr_b16 a[160:161], v1 offset:43104
  s_add_u32 s29, s29, 524288
  v_mfma_f32_16x16x32_bf16 v[128:131], a[132:135], a[48:51], v[128:131]
  s_lshr_b32 s30, s44, 1
  s_lshl_b32 s30, s30, 8
  s_and_b32 s21, s44, 1
  v_mfma_f32_16x16x32_bf16 v[132:135], a[132:135], a[52:55], v[132:135]
  s_add_u32 s30, s30, s21
  ds_read_b64_tr_b16 a[162:163], v1 offset:46688
  s_lshl3_add_u32 s30, s30, 159744
  v_mfma_f32_16x16x32_bf16 v[132:135], a[128:131], a[36:39], v[132:135]
  buffer_load_dwordx4 v3, s[16:19], s10 offen offset:0 lds
  v_and_b32 v24, 0x1f0, v0
  v_mfma_f32_16x16x32_bf16 v[136:139], a[128:131], a[40:43], v[136:139]
  ds_read_b64_tr_b16 a[164:165], v1 offset:50272
  v_min_u32 v24, 432, v24
  v_mfma_f32_16x16x32_bf16 v[136:139], a[132:135], a[56:59], v[136:139]
  v_and_b32 v26, 0x200, v0
  v_lshl_add_u32 v25, v26, 4, v24
  v_mfma_f32_16x16x32_bf16 v[140:143], a[132:135], a[60:63], v[140:143]
  ds_read_b64_tr_b16 a[166:167], v1 offset:53856
  v_lshrrev_b32 v26, 4, v26
  v_mfma_f32_16x16x32_bf16 v[140:143], a[128:131], a[44:47], v[140:143]
  v_lshl_add_u32 v24, v24, 2, v26
  v_add_u32 v24, s30, v24
  v_mfma_f32_16x16x32_bf16 v[156:159], a[136:139], a[44:47], v[156:159]
  s_lshl2_add_u32 s21, s56, s44
  buffer_load_dwordx4 a[120:123], v0, s[36:39], s11 offen offset:2048 sc1
  ds_read_b64_tr_b16 a[168:169], v1 offset:43136
  v_mfma_f32_16x16x32_bf16 v[156:159], a[140:143], a[60:63], v[156:159]
  s_lshl_b32 s21, s21, 19
  s_mul_i32 s22, s59, 7
  s_and_b32 s30, s59, 1
  v_mfma_f32_16x16x32_bf16 v[152:155], a[140:143], a[56:59], v[152:155]
  s_add_u32 s22, s22, s30
  ds_read_b64_tr_b16 a[170:171], v1 offset:46720
  s_lshl_b32 s22, s22, 10
  v_mfma_f32_16x16x32_bf16 v[152:155], a[136:139], a[40:43], v[152:155]
  s_add_u32 s21, s21, s22
  s_add_u32 s23, s21, 19922944
  s_mul_i32 s30, s30, 8184
  v_mfma_f32_16x16x32_bf16 v[148:151], a[136:139], a[36:39], v[148:151]
  s_sub_u32 s21, s23, s30
  ds_read_b64_tr_b16 a[172:173], v1 offset:50304
  s_add_u32 s21, s21, 6144
  v_mfma_f32_16x16x32_bf16 v[148:151], a[140:143], a[52:55], v[148:151]
  s_add_u32 s22, s21, 262144
  buffer_load_dwordx4 v4, s[16:19], s10 offen offset:1024 lds
  s_lshl_b32 s45, s2, 7
  v_mfma_f32_16x16x32_bf16 v[144:147], a[140:143], a[48:51], v[144:147]
  s_add_u32 s45, s45, 5406720
  ds_read_b64_tr_b16 a[174:175], v1 offset:53888
  s_cmp_eq_u32 s44, 0
  v_mfma_f32_16x16x32_bf16 v[144:147], a[136:139], a[32:35], v[144:147]
  s_waitcnt lgkmcnt(8)
  s_cselect_b32 s45, s45, 1073741824
  s_add_u32 s28, s29, 4096
  v_mfma_f32_16x16x32_bf16 v[160:163], a[144:147], a[32:35], v[160:163]
  ds_read_b64_tr_b16 a[128:129], v1 offset:43168
  v_mfma_f32_16x16x32_bf16 v[160:163], a[148:151], a[48:51], v[160:163]
  v_mfma_f32_16x16x32_bf16 v[164:167], a[148:151], a[52:55], v[164:167]
  buffer_load_dwordx4 a[124:127], v0, s[36:39], s11 offen offset:3072 sc1
  s_bfe_u32 s11, s83, 0x40010
  v_mfma_f32_16x16x32_bf16 v[164:167], a[144:147], a[36:39], v[164:167]
  s_lshl_b32 s11, s11, 13
  s_add_u32 s11, s11, s84
  ds_read_b64_tr_b16 a[130:131], v1 offset:46752
  v_mfma_f32_16x16x32_bf16 v[168:171], a[144:147], a[40:43], v[168:171]
  ds_read_b64_tr_b16 a[132:133], v1 offset:50336
  v_mfma_f32_16x16x32_bf16 v[168:171], a[148:151], a[56:59], v[168:171]
  v_mfma_f32_16x16x32_bf16 v[172:175], a[148:151], a[60:63], v[172:175]
  ds_read_b64_tr_b16 a[134:135], v1 offset:53920
  v_mfma_f32_16x16x32_bf16 v[172:175], a[144:147], a[44:47], v[172:175]
  s_waitcnt vmcnt(27)
  s_barrier
  buffer_load_dwordx4 a[0:3], v0, s[36:39], s11 offen offset:0 sc1
  v_mfma_f32_16x16x32_bf16 v[188:191], a[152:155], a[44:47], v[188:191]
  ds_read_b64_tr_b16 a[136:137], v1 offset:43200
  v_mfma_f32_16x16x32_bf16 v[188:191], a[156:159], a[60:63], v[188:191]
  v_mfma_f32_16x16x32_bf16 v[184:187], a[156:159], a[56:59], v[184:187]
  ds_read_b64_tr_b16 a[138:139], v1 offset:46784
  v_mfma_f32_16x16x32_bf16 v[184:187], a[152:155], a[40:43], v[184:187]
  v_mfma_f32_16x16x32_bf16 v[180:183], a[152:155], a[36:39], v[180:183]
  buffer_load_dwordx4 v5, s[16:19], s10 offen offset:2048 lds
  ds_read_b64_tr_b16 a[140:141], v1 offset:50368
  v_mfma_f32_16x16x32_bf16 v[180:183], a[156:159], a[52:55], v[180:183]
  v_mfma_f32_16x16x32_bf16 v[176:179], a[156:159], a[48:51], v[176:179]
  ds_read_b64_tr_b16 a[142:143], v1 offset:53952
  v_mfma_f32_16x16x32_bf16 v[176:179], a[152:155], a[32:35], v[176:179]
  s_waitcnt lgkmcnt(8)
  v_mfma_f32_16x16x32_bf16 v[192:195], a[160:163], a[32:35], v[192:195]
  ds_read_b64_tr_b16 a[144:145], v2 offset:0
  v_mfma_f32_16x16x32_bf16 v[192:195], a[164:167], a[48:51], v[192:195]
  buffer_load_dwordx4 a[4:7], v0, s[36:39], s11 offen offset:1024 sc1
  v_mfma_f32_16x16x32_bf16 v[196:199], a[164:167], a[52:55], v[196:199]
  ds_read_b64_tr_b16 a[146:147], v2 offset:3584
  v_mfma_f32_16x16x32_bf16 v[196:199], a[160:163], a[36:39], v[196:199]
  v_mfma_f32_16x16x32_bf16 v[200:203], a[160:163], a[40:43], v[200:203]
  ds_read_b64_tr_b16 a[148:149], v2 offset:7168
  v_mfma_f32_16x16x32_bf16 v[200:203], a[164:167], a[56:59], v[200:203]
  v_mfma_f32_16x16x32_bf16 v[204:207], a[164:167], a[60:63], v[204:207]
  buffer_load_dwordx4 v6, s[16:19], s10 offen offset:3072 lds
  ds_read_b64_tr_b16 a[150:151], v2 offset:10752
  v_mfma_f32_16x16x32_bf16 v[204:207], a[160:163], a[44:47], v[204:207]
  v_mfma_f32_16x16x32_bf16 v[220:223], a[168:171], a[44:47], v[220:223]
  ds_read_b64_tr_b16 a[152:153], v2 offset:32
  v_mfma_f32_16x16x32_bf16 v[220:223], a[172:175], a[60:63], v[220:223]
  v_mfma_f32_16x16x32_bf16 v[216:219], a[172:175], a[56:59], v[216:219]
  ds_read_b64_tr_b16 a[154:155], v2 offset:3616
  v_mfma_f32_16x16x32_bf16 v[216:219], a[168:171], a[40:43], v[216:219]
  buffer_load_dwordx4 a[8:11], v0, s[36:39], s11 offen offset:2048 sc1
  s_add_u32 m0, s79, 4096
  v_mfma_f32_16x16x32_bf16 v[212:215], a[168:171], a[36:39], v[212:215]
  ds_read_b64_tr_b16 a[156:157], v2 offset:7200
  v_mfma_f32_16x16x32_bf16 v[212:215], a[172:175], a[52:55], v[212:215]
  v_mfma_f32_16x16x32_bf16 v[208:211], a[172:175], a[48:51], v[208:211]
  ds_read_b64_tr_b16 a[158:159], v2 offset:10784
  v_mfma_f32_16x16x32_bf16 v[208:211], a[168:171], a[32:35], v[208:211]
  s_waitcnt lgkmcnt(8)
  v_mfma_f32_16x16x32_bf16 v[224:227], a[128:131], a[32:35], v[224:227]
  buffer_load_dwordx4 v7, s[16:19], s10 offen offset:0 lds
  ds_read_b64_tr_b16 a[160:161], v2 offset:64
  v_mfma_f32_16x16x32_bf16 v[224:227], a[132:135], a[48:51], v[224:227]
  v_mfma_f32_16x16x32_bf16 v[228:231], a[132:135], a[52:55], v[228:231]
  ds_read_b64_tr_b16 a[162:163], v2 offset:3648
  v_mfma_f32_16x16x32_bf16 v[228:231], a[128:131], a[36:39], v[228:231]
  v_mfma_f32_16x16x32_bf16 v[232:235], a[128:131], a[40:43], v[232:235]
  ds_read_b64_tr_b16 a[164:165], v2 offset:7232
  v_mfma_f32_16x16x32_bf16 v[232:235], a[132:135], a[56:59], v[232:235]
  buffer_load_dwordx4 a[12:15], v0, s[36:39], s11 offen offset:3072 sc1
  v_mfma_f32_16x16x32_bf16 v[236:239], a[132:135], a[60:63], v[236:239]
  ds_read_b64_tr_b16 a[166:167], v2 offset:10816
  v_mfma_f32_16x16x32_bf16 v[236:239], a[128:131], a[44:47], v[236:239]
  v_mfma_f32_16x16x32_bf16 v[252:255], a[136:139], a[44:47], v[252:255]
  ds_read_b64_tr_b16 a[168:169], v2 offset:96
  v_mfma_f32_16x16x32_bf16 v[252:255], a[140:143], a[60:63], v[252:255]
  v_mfma_f32_16x16x32_bf16 v[248:251], a[140:143], a[56:59], v[248:251]
  buffer_load_dwordx4 v8, s[16:19], s10 offen offset:1024 lds
  s_add_u32 s11, s11, 4096
  v_mfma_f32_16x16x32_bf16 v[248:251], a[136:139], a[40:43], v[248:251]
  ds_read_b64_tr_b16 a[170:171], v2 offset:3680
  v_mfma_f32_16x16x32_bf16 v[244:247], a[136:139], a[36:39], v[244:247]
  ds_read_b64_tr_b16 a[172:173], v2 offset:7264
  v_mfma_f32_16x16x32_bf16 v[244:247], a[140:143], a[52:55], v[244:247]
  v_mfma_f32_16x16x32_bf16 v[240:243], a[140:143], a[48:51], v[240:243]
  ds_read_b64_tr_b16 a[174:175], v2 offset:10848
  v_mfma_f32_16x16x32_bf16 v[240:243], a[136:139], a[32:35], v[240:243]
  s_waitcnt vmcnt(27) lgkmcnt(8)
  buffer_load_dwordx4 a[16:19], v0, s[36:39], s11 offen offset:0 sc1
  v_mfma_f32_16x16x32_bf16 v[32:35], a[144:147], a[64:67], v[32:35]
  ds_read_b64_tr_b16 a[128:129], v2 offset:128
  v_mfma_f32_16x16x32_bf16 v[32:35], a[148:151], a[80:83], v[32:35]
  s_barrier
  v_mfma_f32_16x16x32_bf16 v[36:39], a[148:151], a[84:87], v[36:39]
  ds_read_b64_tr_b16 a[130:131], v2 offset:3712
  v_mfma_f32_16x16x32_bf16 v[36:39], a[144:147], a[68:71], v[36:39]
  v_mfma_f32_16x16x32_bf16 v[40:43], a[144:147], a[72:75], v[40:43]
  ds_read_b64_tr_b16 a[132:133], v2 offset:7296
  v_mfma_f32_16x16x32_bf16 v[40:43], a[148:151], a[88:91], v[40:43]
  v_mfma_f32_16x16x32_bf16 v[44:47], a[148:151], a[92:95], v[44:47]
  ds_read_b64_tr_b16 a[134:135], v2 offset:10880
  v_mfma_f32_16x16x32_bf16 v[44:47], a[144:147], a[76:79], v[44:47]
  buffer_load_dwordx4 a[20:23], v0, s[36:39], s11 offen offset:1024 sc1
  v_mfma_f32_16x16x32_bf16 v[60:63], a[152:155], a[76:79], v[60:63]
  ds_read_b64_tr_b16 a[136:137], v2 offset:160
  v_mfma_f32_16x16x32_bf16 v[60:63], a[156:159], a[92:95], v[60:63]
  v_mfma_f32_16x16x32_bf16 v[56:59], a[156:159], a[88:91], v[56:59]
  ds_read_b64_tr_b16 a[138:139], v2 offset:3744
  v_mfma_f32_16x16x32_bf16 v[56:59], a[152:155], a[72:75], v[56:59]
  v_mfma_f32_16x16x32_bf16 v[52:55], a[152:155], a[68:71], v[52:55]
  buffer_load_dwordx4 v9, s[16:19], s10 offen offset:2048 lds
  ds_read_b64_tr_b16 a[140:141], v2 offset:7328
  v_mfma_f32_16x16x32_bf16 v[52:55], a[156:159], a[84:87], v[52:55]
  v_mfma_f32_16x16x32_bf16 v[48:51], a[156:159], a[80:83], v[48:51]
  ds_read_b64_tr_b16 a[142:143], v2 offset:10912
  v_mfma_f32_16x16x32_bf16 v[48:51], a[152:155], a[64:67], v[48:51]
  s_waitcnt lgkmcnt(8)
  v_mfma_f32_16x16x32_bf16 v[64:67], a[160:163], a[64:67], v[64:67]
  ds_read_b64_tr_b16 a[144:145], v2 offset:192
  v_mfma_f32_16x16x32_bf16 v[64:67], a[164:167], a[80:83], v[64:67]
  v_mfma_f32_16x16x32_bf16 v[68:71], a[164:167], a[84:87], v[68:71]
  buffer_load_dwordx4 a[24:27], v0, s[36:39], s11 offen offset:2048 sc1
  ds_read_b64_tr_b16 a[146:147], v2 offset:3776
  v_mfma_f32_16x16x32_bf16 v[68:71], a[160:163], a[68:71], v[68:71]
  v_mfma_f32_16x16x32_bf16 v[72:75], a[160:163], a[72:75], v[72:75]
  ds_read_b64_tr_b16 a[148:149], v2 offset:7360
  v_mfma_f32_16x16x32_bf16 v[72:75], a[164:167], a[88:91], v[72:75]
  v_mfma_f32_16x16x32_bf16 v[76:79], a[164:167], a[92:95], v[76:79]
  s_bfe_u32 s10, s83, 0x40014
  s_mul_i32 s10, s10, 458752
  s_add_u32 m0, s79, 28672
  v_mfma_f32_16x16x32_bf16 v[76:79], a[160:163], a[76:79], v[76:79]
  ds_read_b64_tr_b16 a[150:151], v2 offset:10944
  v_mfma_f32_16x16x32_bf16 v[92:95], a[168:171], a[76:79], v[92:95]
  ds_read_b64_tr_b16 a[152:153], v2 offset:14336
  v_mfma_f32_16x16x32_bf16 v[92:95], a[172:175], a[92:95], v[92:95]
  v_mfma_f32_16x16x32_bf16 v[88:91], a[172:175], a[88:91], v[88:91]
  buffer_load_dwordx4 v3, s[16:19], s10 offen offset:0 lds
  ds_read_b64_tr_b16 a[154:155], v2 offset:17920
  v_mfma_f32_16x16x32_bf16 v[88:91], a[168:171], a[72:75], v[88:91]
  v_mfma_f32_16x16x32_bf16 v[84:87], a[168:171], a[68:71], v[84:87]
  ds_read_b64_tr_b16 a[156:157], v2 offset:21504
  v_mfma_f32_16x16x32_bf16 v[84:87], a[172:175], a[84:87], v[84:87]
  v_mfma_f32_16x16x32_bf16 v[80:83], a[172:175], a[80:83], v[80:83]
  ds_read_b64_tr_b16 a[158:159], v2 offset:25088
  v_mfma_f32_16x16x32_bf16 v[80:83], a[168:171], a[64:67], v[80:83]
  s_waitcnt lgkmcnt(8)
  buffer_load_dwordx4 a[28:31], v0, s[36:39], s11 offen offset:3072 sc1
  s_bfe_u32 s11, s83, 0x40014
  v_mfma_f32_16x16x32_bf16 v[96:99], a[128:131], a[64:67], v[96:99]
  s_lshl_b32 s11, s11, 13
  s_add_u32 s11, s11, s84
  ds_read_b64_tr_b16 a[160:161], v2 offset:14368
  v_mfma_f32_16x16x32_bf16 v[96:99], a[132:135], a[80:83], v[96:99]
  v_mfma_f32_16x16x32_bf16 v[100:103], a[132:135], a[84:87], v[100:103]
  ds_read_b64_tr_b16 a[162:163], v2 offset:17952
  v_mfma_f32_16x16x32_bf16 v[100:103], a[128:131], a[68:71], v[100:103]
  v_mfma_f32_16x16x32_bf16 v[104:107], a[128:131], a[72:75], v[104:107]
  buffer_load_dwordx4 a[32:35], v0, s[36:39], s11 offen offset:0 sc1
  ds_read_b64_tr_b16 a[164:165], v2 offset:21536
  v_mfma_f32_16x16x32_bf16 v[104:107], a[132:135], a[88:91], v[104:107]
  v_mfma_f32_16x16x32_bf16 v[108:111], a[132:135], a[92:95], v[108:111]
  ds_read_b64_tr_b16 a[166:167], v2 offset:25120
  v_mfma_f32_16x16x32_bf16 v[108:111], a[128:131], a[76:79], v[108:111]
  v_mfma_f32_16x16x32_bf16 v[124:127], a[136:139], a[76:79], v[124:127]
  ds_read_b64_tr_b16 a[168:169], v2 offset:14400
  v_mfma_f32_16x16x32_bf16 v[124:127], a[140:143], a[92:95], v[124:127]
  buffer_load_dwordx4 v4, s[16:19], s10 offen offset:1024 lds
  v_mfma_f32_16x16x32_bf16 v[120:123], a[140:143], a[88:91], v[120:123]
  ds_read_b64_tr_b16 a[170:171], v2 offset:17984
  v_mfma_f32_16x16x32_bf16 v[120:123], a[136:139], a[72:75], v[120:123]
  v_mfma_f32_16x16x32_bf16 v[116:119], a[136:139], a[68:71], v[116:119]
  ds_read_b64_tr_b16 a[172:173], v2 offset:21568
  v_mfma_f32_16x16x32_bf16 v[116:119], a[140:143], a[84:87], v[116:119]
  v_mfma_f32_16x16x32_bf16 v[112:115], a[140:143], a[80:83], v[112:115]
  buffer_load_dwordx4 a[36:39], v0, s[36:39], s11 offen offset:1024 sc1
  ds_read_b64_tr_b16 a[174:175], v2 offset:25152
  v_mfma_f32_16x16x32_bf16 v[112:115], a[136:139], a[64:67], v[112:115]
  s_waitcnt lgkmcnt(8)
  v_mfma_f32_16x16x32_bf16 v[128:131], a[144:147], a[64:67], v[128:131]
  ds_read_b64_tr_b16 a[128:129], v2 offset:14432
  v_mfma_f32_16x16x32_bf16 v[128:131], a[148:151], a[80:83], v[128:131]
  v_mfma_f32_16x16x32_bf16 v[132:135], a[148:151], a[84:87], v[132:135]
  ds_read_b64_tr_b16 a[130:131], v2 offset:18016
  v_mfma_f32_16x16x32_bf16 v[132:135], a[144:147], a[68:71], v[132:135]
  buffer_load_dwordx4 v5, s[16:19], s10 offen offset:2048 lds
  v_mfma_f32_16x16x32_bf16 v[136:139], a[144:147], a[72:75], v[136:139]
  ds_read_b64_tr_b16 a[132:133], v2 offset:21600
  v_mfma_f32_16x16x32_bf16 v[136:139], a[148:151], a[88:91], v[136:139]
  v_mfma_f32_16x16x32_bf16 v[140:143], a[148:151], a[92:95], v[140:143]
  ds_read_b64_tr_b16 a[134:135], v2 offset:25184
  v_mfma_f32_16x16x32_bf16 v[140:143], a[144:147], a[76:79], v[140:143]
  v_mfma_f32_16x16x32_bf16 v[156:159], a[152:155], a[76:79], v[156:159]
  buffer_load_dwordx4 a[40:43], v0, s[36:39], s11 offen offset:2048 sc1
  ds_read_b64_tr_b16 a[136:137], v2 offset:14464
  v_mfma_f32_16x16x32_bf16 v[156:159], a[156:159], a[92:95], v[156:159]
  v_mfma_f32_16x16x32_bf16 v[152:155], a[156:159], a[88:91], v[152:155]
  ds_read_b64_tr_b16 a[138:139], v2 offset:18048
  v_mfma_f32_16x16x32_bf16 v[152:155], a[152:155], a[72:75], v[152:155]
  v_mfma_f32_16x16x32_bf16 v[148:151], a[152:155], a[68:71], v[148:151]
  ds_read_b64_tr_b16 a[140:141], v2 offset:21632
  v_mfma_f32_16x16x32_bf16 v[148:151], a[156:159], a[84:87], v[148:151]
  v_mfma_f32_16x16x32_bf16 v[144:147], a[156:159], a[80:83], v[144:147]
  ds_read_b64_tr_b16 a[142:143], v2 offset:25216
  v_mfma_f32_16x16x32_bf16 v[144:147], a[152:155], a[64:67], v[144:147]
  s_waitcnt lgkmcnt(8)
  buffer_load_dwordx4 v6, s[16:19], s10 offen offset:3072 lds
  v_mfma_f32_16x16x32_bf16 v[160:163], a[160:163], a[64:67], v[160:163]
  ds_read_b64_tr_b16 a[144:145], v2 offset:14496
  v_mfma_f32_16x16x32_bf16 v[160:163], a[164:167], a[80:83], v[160:163]
  v_mfma_f32_16x16x32_bf16 v[164:167], a[164:167], a[84:87], v[164:167]
  ds_read_b64_tr_b16 a[146:147], v2 offset:18080
  v_mfma_f32_16x16x32_bf16 v[164:167], a[160:163], a[68:71], v[164:167]
  v_mfma_f32_16x16x32_bf16 v[168:171], a[160:163], a[72:75], v[168:171]
  buffer_load_dwordx4 a[44:47], v0, s[36:39], s11 offen offset:3072 sc1
  ds_read_b64_tr_b16 a[148:149], v2 offset:21664
  v_mfma_f32_16x16x32_bf16 v[168:171], a[164:167], a[88:91], v[168:171]
  v_mfma_f32_16x16x32_bf16 v[172:175], a[164:167], a[92:95], v[172:175]
  ds_read_b64_tr_b16 a[150:151], v2 offset:25248
  v_mfma_f32_16x16x32_bf16 v[172:175], a[160:163], a[76:79], v[172:175]
  s_waitcnt vmcnt(31)
  s_barrier
  s_add_u32 m0, s79, 32768
  v_mfma_f32_16x16x32_bf16 v[188:191], a[168:171], a[76:79], v[188:191]
  ds_read_b64_tr_b16 a[152:153], v2 offset:14528
  v_mfma_f32_16x16x32_bf16 v[188:191], a[172:175], a[92:95], v[188:191]
  v_mfma_f32_16x16x32_bf16 v[184:187], a[172:175], a[88:91], v[184:187]
  ds_read_b64_tr_b16 a[154:155], v2 offset:18112
  v_mfma_f32_16x16x32_bf16 v[184:187], a[168:171], a[72:75], v[184:187]
  buffer_load_dwordx4 v7, s[16:19], s10 offen offset:0 lds
  s_add_u32 s11, s11, 4096
  v_mfma_f32_16x16x32_bf16 v[180:183], a[168:171], a[68:71], v[180:183]
  ds_read_b64_tr_b16 a[156:157], v2 offset:21696
  v_mfma_f32_16x16x32_bf16 v[180:183], a[172:175], a[84:87], v[180:183]
  v_mfma_f32_16x16x32_bf16 v[176:179], a[172:175], a[80:83], v[176:179]
  ds_read_b64_tr_b16 a[158:159], v2 offset:25280
  v_mfma_f32_16x16x32_bf16 v[176:179], a[168:171], a[64:67], v[176:179]
  s_waitcnt lgkmcnt(8)
  v_mfma_f32_16x16x32_bf16 v[192:195], a[128:131], a[64:67], v[192:195]
  buffer_load_dwordx4 a[48:51], v0, s[36:39], s11 offen offset:0 sc1
  ds_read_b64_tr_b16 a[160:161], v2 offset:28672
  v_mfma_f32_16x16x32_bf16 v[192:195], a[132:135], a[80:83], v[192:195]
  v_mfma_f32_16x16x32_bf16 v[196:199], a[132:135], a[84:87], v[196:199]
  ds_read_b64_tr_b16 a[162:163], v2 offset:32256
  v_mfma_f32_16x16x32_bf16 v[196:199], a[128:131], a[68:71], v[196:199]
  v_mfma_f32_16x16x32_bf16 v[200:203], a[128:131], a[72:75], v[200:203]
  ds_read_b64_tr_b16 a[164:165], v2 offset:35840
  v_mfma_f32_16x16x32_bf16 v[200:203], a[132:135], a[88:91], v[200:203]
  v_mfma_f32_16x16x32_bf16 v[204:207], a[132:135], a[92:95], v[204:207]
  buffer_load_dwordx4 a[52:55], v0, s[36:39], s11 offen offset:1024 sc1
  ds_read_b64_tr_b16 a[166:167], v2 offset:39424
  v_mfma_f32_16x16x32_bf16 v[204:207], a[128:131], a[76:79], v[204:207]
  v_mfma_f32_16x16x32_bf16 v[220:223], a[136:139], a[76:79], v[220:223]
  ds_read_b64_tr_b16 a[168:169], v2 offset:28704
  v_mfma_f32_16x16x32_bf16 v[220:223], a[140:143], a[92:95], v[220:223]
  v_mfma_f32_16x16x32_bf16 v[216:219], a[140:143], a[88:91], v[216:219]
  ds_read_b64_tr_b16 a[170:171], v2 offset:32288
  v_mfma_f32_16x16x32_bf16 v[216:219], a[136:139], a[72:75], v[216:219]
  buffer_load_dwordx4 v8, s[16:19], s10 offen offset:1024 lds
  v_mfma_f32_16x16x32_bf16 v[212:215], a[136:139], a[68:71], v[212:215]
  ds_read_b64_tr_b16 a[172:173], v2 offset:35872
  v_mfma_f32_16x16x32_bf16 v[212:215], a[140:143], a[84:87], v[212:215]
  v_mfma_f32_16x16x32_bf16 v[208:211], a[140:143], a[80:83], v[208:211]
  ds_read_b64_tr_b16 a[174:175], v2 offset:39456
  v_mfma_f32_16x16x32_bf16 v[208:211], a[136:139], a[64:67], v[208:211]
  s_waitcnt lgkmcnt(8)
  v_mfma_f32_16x16x32_bf16 v[224:227], a[144:147], a[64:67], v[224:227]
  buffer_load_dwordx4 a[56:59], v0, s[36:39], s11 offen offset:2048 sc1
  ds_read_b64_tr_b16 a[128:129], v2 offset:28736
  v_mfma_f32_16x16x32_bf16 v[224:227], a[148:151], a[80:83], v[224:227]
  v_mfma_f32_16x16x32_bf16 v[228:231], a[148:151], a[84:87], v[228:231]
  ds_read_b64_tr_b16 a[130:131], v2 offset:32320
  v_mfma_f32_16x16x32_bf16 v[228:231], a[144:147], a[68:71], v[228:231]
  v_mfma_f32_16x16x32_bf16 v[232:235], a[144:147], a[72:75], v[232:235]
  ds_read_b64_tr_b16 a[132:133], v2 offset:35904
  v_mfma_f32_16x16x32_bf16 v[232:235], a[148:151], a[88:91], v[232:235]
  buffer_load_dwordx4 v9, s[16:19], s10 offen offset:2048 lds
  v_mfma_f32_16x16x32_bf16 v[236:239], a[148:151], a[92:95], v[236:239]
  ds_read_b64_tr_b16 a[134:135], v2 offset:39488
  v_mfma_f32_16x16x32_bf16 v[236:239], a[144:147], a[76:79], v[236:239]
  v_mfma_f32_16x16x32_bf16 v[252:255], a[152:155], a[76:79], v[252:255]
  ds_read_b64_tr_b16 a[136:137], v2 offset:28768
  v_mfma_f32_16x16x32_bf16 v[252:255], a[156:159], a[92:95], v[252:255]
  v_mfma_f32_16x16x32_bf16 v[248:251], a[156:159], a[88:91], v[248:251]
  ds_read_b64_tr_b16 a[138:139], v2 offset:32352
  v_mfma_f32_16x16x32_bf16 v[248:251], a[152:155], a[72:75], v[248:251]
  buffer_load_dwordx4 a[60:63], v0, s[36:39], s11 offen offset:3072 sc1
  v_mfma_f32_16x16x32_bf16 v[244:247], a[152:155], a[68:71], v[244:247]
  s_bfe_u32 s11, s83, 0x40018
  s_lshl_b32 s11, s11, 13
  s_add_u32 s11, s11, s84
  v_mfma_f32_16x16x32_bf16 v[244:247], a[156:159], a[84:87], v[244:247]
  ds_read_b64_tr_b16 a[140:141], v2 offset:35936
  v_mfma_f32_16x16x32_bf16 v[240:243], a[156:159], a[80:83], v[240:243]
  ds_read_b64_tr_b16 a[142:143], v2 offset:39520
  v_mfma_f32_16x16x32_bf16 v[240:243], a[152:155], a[64:67], v[240:243]
  s_waitcnt vmcnt(28) lgkmcnt(8)
  v_mfma_f32_16x16x32_bf16 v[32:35], a[160:163], a[96:99], v[32:35]
  buffer_load_dwordx4 a[64:67], v0, s[36:39], s11 offen offset:0 sc1
  ds_read_b64_tr_b16 a[144:145], v2 offset:28800
  v_mfma_f32_16x16x32_bf16 v[32:35], a[164:167], a[112:115], v[32:35]
  s_barrier
  v_mfma_f32_16x16x32_bf16 v[36:39], a[164:167], a[116:119], v[36:39]
  ds_read_b64_tr_b16 a[146:147], v2 offset:32384
  v_mfma_f32_16x16x32_bf16 v[36:39], a[160:163], a[100:103], v[36:39]
  v_mfma_f32_16x16x32_bf16 v[40:43], a[160:163], a[104:107], v[40:43]
  s_bfe_u32 s10, s83, 0x40018
  s_mul_i32 s10, s10, 458752
  s_add_u32 m0, s79, 57344
  v_mfma_f32_16x16x32_bf16 v[40:43], a[164:167], a[120:123], v[40:43]
  ds_read_b64_tr_b16 a[148:149], v2 offset:35968
  v_mfma_f32_16x16x32_bf16 v[44:47], a[164:167], a[124:127], v[44:47]
  ds_read_b64_tr_b16 a[150:151], v2 offset:39552
  v_mfma_f32_16x16x32_bf16 v[44:47], a[160:163], a[108:111], v[44:47]
  v_mfma_f32_16x16x32_bf16 v[60:63], a[168:171], a[108:111], v[60:63]
  buffer_load_dwordx4 v3, s[16:19], s10 offen offset:0 lds
  ds_read_b64_tr_b16 a[152:153], v2 offset:28832
  v_mfma_f32_16x16x32_bf16 v[60:63], a[172:175], a[124:127], v[60:63]
  v_mfma_f32_16x16x32_bf16 v[56:59], a[172:175], a[120:123], v[56:59]
  ds_read_b64_tr_b16 a[154:155], v2 offset:32416
  v_mfma_f32_16x16x32_bf16 v[56:59], a[168:171], a[104:107], v[56:59]
  v_mfma_f32_16x16x32_bf16 v[52:55], a[168:171], a[100:103], v[52:55]
  ds_read_b64_tr_b16 a[156:157], v2 offset:36000
  v_mfma_f32_16x16x32_bf16 v[52:55], a[172:175], a[116:119], v[52:55]
  v_mfma_f32_16x16x32_bf16 v[48:51], a[172:175], a[112:115], v[48:51]
  ds_read_b64_tr_b16 a[158:159], v2 offset:39584
  v_mfma_f32_16x16x32_bf16 v[48:51], a[168:171], a[96:99], v[48:51]
  s_waitcnt lgkmcnt(8)
  buffer_load_dwordx4 a[68:71], v0, s[36:39], s11 offen offset:1024 sc1
  v_mfma_f32_16x16x32_bf16 v[64:67], a[128:131], a[96:99], v[64:67]
  ds_read_b64_tr_b16 a[160:161], v2 offset:28864
  v_mfma_f32_16x16x32_bf16 v[64:67], a[132:135], a[112:115], v[64:67]
  v_mfma_f32_16x16x32_bf16 v[68:71], a[132:135], a[116:119], v[68:71]
  ds_read_b64_tr_b16 a[162:163], v2 offset:32448
  v_mfma_f32_16x16x32_bf16 v[68:71], a[128:131], a[100:103], v[68:71]
  v_mfma_f32_16x16x32_bf16 v[72:75], a[128:131], a[104:107], v[72:75]
  ds_read_b64_tr_b16 a[164:165], v2 offset:36032
  v_mfma_f32_16x16x32_bf16 v[72:75], a[132:135], a[120:123], v[72:75]
  v_mfma_f32_16x16x32_bf16 v[76:79], a[132:135], a[124:127], v[76:79]
  ds_read_b64_tr_b16 a[166:167], v2 offset:39616
CT14:
  s_add_u32 s94, s92, CT14-k3_main_kernel+3072
  s_addc_u32 s95, s93, 0
  v_mfma_f32_16x16x32_bf16 v[76:79], a[128:131], a[108:111], v[76:79]
  global_load_dword a252, v0, s[94:95]
  v_mfma_f32_16x16x32_bf16 v[92:95], a[136:139], a[108:111], v[92:95]
  ds_read_b64_tr_b16 a[168:169], v2 offset:43008
  v_mfma_f32_16x16x32_bf16 v[92:95], a[140:143], a[124:127], v[92:95]
  v_mfma_f32_16x16x32_bf16 v[88:91], a[140:143], a[120:123], v[88:91]
  ds_read_b64_tr_b16 a[170:171], v2 offset:46592
  v_mfma_f32_16x16x32_bf16 v[88:91], a[136:139], a[104:107], v[88:91]
  v_mfma_f32_16x16x32_bf16 v[84:87], a[136:139], a[100:103], v[84:87]
  buffer_load_dwordx4 v4, s[16:19], s10 offen offset:1024 lds
  ds_read_b64_tr_b16 a[172:173], v2 offset:50176
  v_mfma_f32_16x16x32_bf16 v[84:87], a[140:143], a[116:119], v[84:87]
  v_mfma_f32_16x16x32_bf16 v[80:83], a[140:143], a[112:115], v[80:83]
  ds_read_b64_tr_b16 a[174:175], v2 offset:53760
  v_mfma_f32_16x16x32_bf16 v[80:83], a[136:139], a[96:99], v[80:83]
  s_waitcnt lgkmcnt(8)
  v_mfma_f32_16x16x32_bf16 v[96:99], a[144:147], a[96:99], v[96:99]
  ds_read_b64_tr_b16 a[128:129], v2 offset:43040
  v_mfma_f32_16x16x32_bf16 v[96:99], a[148:151], a[112:115], v[96:99]
  buffer_load_dwordx4 a[72:75], v0, s[36:39], s11 offen offset:2048 sc1
  v_mfma_f32_16x16x32_bf16 v[100:103], a[148:151], a[116:119], v[100:103]
  ds_read_b64_tr_b16 a[130:131], v2 offset:46624
  v_mfma_f32_16x16x32_bf16 v[100:103], a[144:147], a[100:103], v[100:103]
  v_mfma_f32_16x16x32_bf16 v[104:107], a[144:147], a[104:107], v[104:107]
  buffer_load_dwordx4 a[176:179], v25, s[36:39], s29 offen offset:0 sc1
  ds_read_b64_tr_b16 a[132:133], v2 offset:50208
  v_mfma_f32_16x16x32_bf16 v[104:107], a[148:151], a[120:123], v[104:107]
  v_mfma_f32_16x16x32_bf16 v[108:111], a[148:151], a[124:127], v[108:111]
  ds_read_b64_tr_b16 a[134:135], v2 offset:53792
  v_mfma_f32_16x16x32_bf16 v[108:111], a[144:147], a[108:111], v[108:111]
  v_mfma_f32_16x16x32_bf16 v[124:127], a[152:155], a[108:111], v[124:127]
  ds_read_b64_tr_b16 a[136:137], v2 offset:43072
  v_mfma_f32_16x16x32_bf16 v[124:127], a[156:159], a[124:127], v[124:127]
  buffer_load_dwordx4 a[180:183], v25, s[36:39], s29 offen offset:2048 sc1
  v_mfma_f32_16x16x32_bf16 v[120:123], a[156:159], a[120:123], v[120:123]
  ds_read_b64_tr_b16 a[138:139], v2 offset:46656
  v_mfma_f32_16x16x32_bf16 v[120:123], a[152:155], a[104:107], v[120:123]
  v_mfma_f32_16x16x32_bf16 v[116:119], a[152:155], a[100:103], v[116:119]
  ds_read_b64_tr_b16 a[140:141], v2 offset:50240
  v_mfma_f32_16x16x32_bf16 v[116:119], a[156:159], a[116:119], v[116:119]
  v_mfma_f32_16x16x32_bf16 v[112:115], a[156:159], a[112:115], v[112:115]
  buffer_load_dwordx4 a[184:187], v25, s[36:39], s28 offen offset:0 sc1
  ds_read_b64_tr_b16 a[142:143], v2 offset:53824
  v_mfma_f32_16x16x32_bf16 v[112:115], a[152:155], a[96:99], v[112:115]
  s_waitcnt lgkmcnt(8)
  v_mfma_f32_16x16x32_bf16 v[128:131], a[160:163], a[96:99], v[128:131]
  ds_read_b64_tr_b16 a[144:145], v2 offset:43104
  v_mfma_f32_16x16x32_bf16 v[128:131], a[164:167], a[112:115], v[128:131]
  v_mfma_f32_16x16x32_bf16 v[132:135], a[164:167], a[116:119], v[132:135]
  ds_read_b64_tr_b16 a[146:147], v2 offset:46688
  v_mfma_f32_16x16x32_bf16 v[132:135], a[160:163], a[100:103], v[132:135]
  buffer_load_dwordx4 a[188:191], v25, s[36:39], s28 offen offset:2048 sc1
  v_mfma_f32_16x16x32_bf16 v[136:139], a[160:163], a[104:107], v[136:139]
  ds_read_b64_tr_b16 a[148:149], v2 offset:50272
  v_mfma_f32_16x16x32_bf16 v[136:139], a[164:167], a[120:123], v[136:139]
  v_mfma_f32_16x16x32_bf16 v[140:143], a[164:167], a[124:127], v[140:143]
  ds_read_b64_tr_b16 a[150:151], v2 offset:53856
  v_mfma_f32_16x16x32_bf16 v[140:143], a[160:163], a[108:111], v[140:143]
  v_mfma_f32_16x16x32_bf16 v[156:159], a[168:171], a[108:111], v[156:159]
  buffer_load_dwordx4 v5, s[16:19], s10 offen offset:2048 lds
  ds_read_b64_tr_b16 a[152:153], v2 offset:43136
  v_mfma_f32_16x16x32_bf16 v[156:159], a[172:175], a[124:127], v[156:159]
  v_mfma_f32_16x16x32_bf16 v[152:155], a[172:175], a[120:123], v[152:155]
  ds_read_b64_tr_b16 a[154:155], v2 offset:46720
  v_mfma_f32_16x16x32_bf16 v[152:155], a[168:171], a[104:107], v[152:155]
  v_mfma_f32_16x16x32_bf16 v[148:151], a[168:171], a[100:103], v[148:151]
  ds_read_b64_tr_b16 a[156:157], v2 offset:50304
  v_mfma_f32_16x16x32_bf16 v[148:151], a[172:175], a[116:119], v[148:151]
  buffer_load_dwordx4 a[76:79], v0, s[36:39], s11 offen offset:3072 sc1
  v_mfma_f32_16x16x32_bf16 v[144:147], a[172:175], a[112:115], v[144:147]
  ds_read_b64_tr_b16 a[158:159], v2 offset:53888
  v_mfma_f32_16x16x32_bf16 v[144:147], a[168:171], a[96:99], v[144:147]
  s_waitcnt lgkmcnt(8)
  v_mfma_f32_16x16x32_bf16 v[160:163], a[128:131], a[96:99], v[160:163]
  ds_read_b64_tr_b16 a[160:161], v2 offset:43168
  v_mfma_f32_16x16x32_bf16 v[160:163], a[132:135], a[112:115], v[160:163]
  v_mfma_f32_16x16x32_bf16 v[164:167], a[132:135], a[116:119], v[164:167]
  buffer_load_dwordx4 v6, s[16:19], s10 offen offset:3072 lds
  s_add_u32 s11, s11, 4096
  v_mfma_f32_16x16x32_bf16 v[164:167], a[128:131], a[100:103], v[164:167]
  ds_read_b64_tr_b16 a[162:163], v2 offset:46752
  v_mfma_f32_16x16x32_bf16 v[168:171], a[128:131], a[104:107], v[168:171]
  ds_read_b64_tr_b16 a[164:165], v2 offset:50336
  v_mfma_f32_16x16x32_bf16 v[168:171], a[132:135], a[120:123], v[168:171]
  v_mfma_f32_16x16x32_bf16 v[172:175], a[132:135], a[124:127], v[172:175]
  ds_read_b64_tr_b16 a[166:167], v2 offset:53920
  v_mfma_f32_16x16x32_bf16 v[172:175], a[128:131], a[108:111], v[172:175]
  s_waitcnt vmcnt(30)
  s_barrier
  buffer_load_dwordx4 a[80:83], v0, s[36:39], s11 offen offset:0 sc1
  s_add_u32 m0, s79, 61440
  v_mfma_f32_16x16x32_bf16 v[188:191], a[136:139], a[108:111], v[188:191]
  ds_read_b64_tr_b16 a[168:169], v2 offset:43200
  v_mfma_f32_16x16x32_bf16 v[188:191], a[140:143], a[124:127], v[188:191]
  v_mfma_f32_16x16x32_bf16 v[184:187], a[140:143], a[120:123], v[184:187]
  ds_read_b64_tr_b16 a[170:171], v2 offset:46784
  v_mfma_f32_16x16x32_bf16 v[184:187], a[136:139], a[104:107], v[184:187]
  v_mfma_f32_16x16x32_bf16 v[180:183], a[136:139], a[100:103], v[180:183]
  buffer_load_dwordx4 v7, s[16:19], s10 offen offset:0 lds
  ds_read_b64_tr_b16 a[172:173], v2 offset:50368
  v_mfma_f32_16x16x32_bf16 v[180:183], a[140:143], a[116:119], v[180:183]
  v_mfma_f32_16x16x32_bf16 v[176:179], a[140:143], a[112:115], v[176:179]
  ds_read_b64_tr_b16 a[174:175], v2 offset:53952
  v_mfma_f32_16x16x32_bf16 v[176:179], a[136:139], a[96:99], v[176:179]
  s_waitcnt lgkmcnt(8)
  v_mfma_f32_16x16x32_bf16 v[192:195], a[144:147], a[96:99], v[192:195]
  ds_read_b64_tr_b16 a[128:129], v1 offset:0
  v_mfma_f32_16x16x32_bf16 v[192:195], a[148:151], a[112:115], v[192:195]
  buffer_load_dwordx4 a[84:87], v0, s[36:39], s11 offen offset:1024 sc1
  v_mfma_f32_16x16x32_bf16 v[196:199], a[148:151], a[116:119], v[196:199]
  ds_read_b64_tr_b16 a[130:131], v1 offset:3584
  v_mfma_f32_16x16x32_bf16 v[196:199], a[144:147], a[100:103], v[196:199]
  v_mfma_f32_16x16x32_bf16 v[200:203], a[144:147], a[104:107], v[200:203]
  ds_read_b64_tr_b16 a[132:133], v1 offset:7168
  v_mfma_f32_16x16x32_bf16 v[200:203], a[148:151], a[120:123], v[200:203]
  v_mfma_f32_16x16x32_bf16 v[204:207], a[148:151], a[124:127], v[204:207]
  buffer_load_dwordx4 v8, s[16:19], s10 offen offset:1024 lds
  ds_read_b64_tr_b16 a[134:135], v1 offset:10752
  v_mfma_f32_16x16x32_bf16 v[204:207], a[144:147], a[108:111], v[204:207]
  v_mfma_f32_16x16x32_bf16 v[220:223], a[152:155], a[108:111], v[220:223]
  ds_read_b64_tr_b16 a[136:137], v1 offset:32
  v_mfma_f32_16x16x32_bf16 v[220:223], a[156:159], a[124:127], v[220:223]
  v_mfma_f32_16x16x32_bf16 v[216:219], a[156:159], a[120:123], v[216:219]
  ds_read_b64_tr_b16 a[138:139], v1 offset:3616
  v_mfma_f32_16x16x32_bf16 v[216:219], a[152:155], a[104:107], v[216:219]
  buffer_load_dwordx4 a[88:91], v0, s[36:39], s11 offen offset:2048 sc1
  v_mfma_f32_16x16x32_bf16 v[212:215], a[152:155], a[100:103], v[212:215]
  ds_read_b64_tr_b16 a[140:141], v1 offset:7200
  v_mfma_f32_16x16x32_bf16 v[212:215], a[156:159], a[116:119], v[212:215]
  v_mfma_f32_16x16x32_bf16 v[208:211], a[156:159], a[112:115], v[208:211]
  ds_read_b64_tr_b16 a[142:143], v1 offset:10784
  v_mfma_f32_16x16x32_bf16 v[208:211], a[152:155], a[96:99], v[208:211]
  s_waitcnt lgkmcnt(8)
  v_mfma_f32_16x16x32_bf16 v[224:227], a[160:163], a[96:99], v[224:227]
  ds_read_b64_tr_b16 a[144:145], v1 offset:64
  v_mfma_f32_16x16x32_bf16 v[224:227], a[164:167], a[112:115], v[224:227]
  buffer_load_dwordx4 v9, s[16:19], s10 offen offset:2048 lds
  v_mfma_f32_16x16x32_bf16 v[228:231], a[164:167], a[116:119], v[228:231]
  ds_read_b64_tr_b16 a[146:147], v1 offset:3648
  v_mfma_f32_16x16x32_bf16 v[228:231], a[160:163], a[100:103], v[228:231]
  v_mfma_f32_16x16x32_bf16 v[232:235], a[160:163], a[104:107], v[232:235]
  ds_read_b64_tr_b16 a[148:149], v1 offset:7232
  v_mfma_f32_16x16x32_bf16 v[232:235], a[164:167], a[120:123], v[232:235]
  v_mfma_f32_16x16x32_bf16 v[236:239], a[164:167], a[124:127], v[236:239]
  ds_read_b64_tr_b16 a[150:151], v1 offset:10816
  v_mfma_f32_16x16x32_bf16 v[236:239], a[160:163], a[108:111], v[236:239]
  v_mfma_f32_16x16x32_bf16 v[252:255], a[168:171], a[108:111], v[252:255]
  ds_read_b64_tr_b16 a[152:153], v1 offset:96
  v_mfma_f32_16x16x32_bf16 v[252:255], a[172:175], a[124:127], v[252:255]
  buffer_load_dwordx4 a[92:95], v0, s[36:39], s11 offen offset:3072 sc1
  v_mfma_f32_16x16x32_bf16 v[248:251], a[172:175], a[120:123], v[248:251]
  ds_read_b64_tr_b16 a[154:155], v1 offset:3680
  v_mfma_f32_16x16x32_bf16 v[248:251], a[168:171], a[104:107], v[248:251]
  v_mfma_f32_16x16x32_bf16 v[244:247], a[168:171], a[100:103], v[244:247]
  s_bfe_u32 s11, s83, 0x4001c
  s_lshl_b32 s11, s11, 13
  s_add_u32 s11, s11, s84
  v_mfma_f32_16x16x32_bf16 v[244:247], a[172:175], a[116:119], v[244:247]
  ds_read_b64_tr_b16 a[156:157], v1 offset:7264
  v_mfma_f32_16x16x32_bf16 v[240:243], a[172:175], a[112:115], v[240:243]
  ds_read_b64_tr_b16 a[158:159], v1 offset:10848
  v_mfma_f32_16x16x32_bf16 v[240:243], a[168:171], a[96:99], v[240:243]
  s_waitcnt vmcnt(34) lgkmcnt(8)
  v_mfma_f32_16x16x32_bf16 v[32:35], a[128:131], a[0:3], v[32:35]
  buffer_load_dwordx4 a[96:99], v0, s[36:39], s11 offen offset:0 sc1
  ds_read_b64_tr_b16 a[160:161], v1 offset:128
  v_mfma_f32_16x16x32_bf16 v[32:35], a[132:135], a[16:19], v[32:35]
  s_waitcnt vmcnt(22)
  s_barrier
  s_bfe_u32 s10, s83, 0x4001c
  v_mfma_f32_16x16x32_bf16 v[36:39], a[132:135], a[20:23], v[36:39]
  s_mul_i32 s10, s10, 458752
  s_add_u32 m0, s79, 86016
  ds_read_b64_tr_b16 a[162:163], v1 offset:3712
  v_mfma_f32_16x16x32_bf16 v[36:39], a[128:131], a[4:7], v[36:39]
  v_mfma_f32_16x16x32_bf16 v[40:43], a[128:131], a[8:11], v[40:43]
  ds_read_b64_tr_b16 a[164:165], v1 offset:7296
  v_mfma_f32_16x16x32_bf16 v[40:43], a[132:135], a[24:27], v[40:43]
  buffer_load_dwordx4 v3, s[16:19], s10 offen offset:0 lds
  v_mfma_f32_16x16x32_bf16 v[44:47], a[132:135], a[28:31], v[44:47]
  ds_read_b64_tr_b16 a[166:167], v1 offset:10880
  v_mfma_f32_16x16x32_bf16 v[44:47], a[128:131], a[12:15], v[44:47]
  v_mfma_f32_16x16x32_bf16 v[60:63], a[136:139], a[12:15], v[60:63]
  ds_read_b64_tr_b16 a[168:169], v1 offset:160
  v_mfma_f32_16x16x32_bf16 v[60:63], a[140:143], a[28:31], v[60:63]
  v_mfma_f32_16x16x32_bf16 v[56:59], a[140:143], a[24:27], v[56:59]
  buffer_load_dwordx4 a[100:103], v0, s[36:39], s11 offen offset:1024 sc1
  ds_read_b64_tr_b16 a[170:171], v1 offset:3744
  v_mfma_f32_16x16x32_bf16 v[56:59], a[136:139], a[8:11], v[56:59]
  v_mfma_f32_16x16x32_bf16 v[52:55], a[136:139], a[4:7], v[52:55]
  ds_read_b64_tr_b16 a[172:173], v1 offset:7328
  v_mfma_f32_16x16x32_bf16 v[52:55], a[140:143], a[20:23], v[52:55]
  v_mfma_f32_16x16x32_bf16 v[48:51], a[140:143], a[16:19], v[48:51]
  ds_read_b64_tr_b16 a[174:175], v1 offset:10912
  v_mfma_f32_16x16x32_bf16 v[48:51], a[136:139], a[0:3], v[48:51]
  s_waitcnt lgkmcnt(8)
  buffer_load_dwordx4 v4, s[16:19], s10 offen offset:1024 lds
  v_mfma_f32_16x16x32_bf16 v[64:67], a[144:147], a[0:3], v[64:67]
  ds_read_b64_tr_b16 a[128:129], v1 offset:192
  v_mfma_f32_16x16x32_bf16 v[64:67], a[148:151], a[16:19], v[64:67]
  v_mfma_f32_16x16x32_bf16 v[68:71], a[148:151], a[20:23], v[68:71]
  s_waitcnt vmcnt(14)
  ds_read_b64_tr_b16 a[130:131], v1 offset:3776
  v_accvgpr_read_b32 v26, a176
  v_mfma_f32_16x16x32_bf16 v[68:71], a[144:147], a[4:7], v[68:71]
  v_accvgpr_read_b32 v27, a177
  v_accvgpr_read_b32 v28, a178
  v_mfma_f32_16x16x32_bf16 v[72:75], a[144:147], a[8:11], v[72:75]
  buffer_load_dwordx4 a[104:107], v0, s[36:39], s11 offen offset:2048 sc1
  ds_read_b64_tr_b16 a[132:133], v1 offset:7360
  v_mfma_f32_16x16x32_bf16 v[72:75], a[148:151], a[24:27], v[72:75]
  v_accvgpr_read_b32 v29, a179
  v_max_u32 v31, v26, v27
  v_mfma_f32_16x16x32_bf16 v[76:79], a[148:151], a[28:31], v[76:79]
  ds_read_b64_tr_b16 a[134:135], v1 offset:10944
  v_max3_u32 v31, v31, v28, v29
  v_mfma_f32_16x16x32_bf16 v[76:79], a[144:147], a[12:15], v[76:79]
  v_accvgpr_read_b32 v22, a180
  v_accvgpr_read_b32 v23, a181
  v_mfma_f32_16x16x32_bf16 v[92:95], a[152:155], a[12:15], v[92:95]
  ds_read_b64_tr_b16 a[136:137], v1 offset:14336
  v_max3_u32 v31, v31, v22, v23
  v_mfma_f32_16x16x32_bf16 v[92:95], a[156:159], a[28:31], v[92:95]
  buffer_load_dwordx4 v5, s[16:19], s10 offen offset:2048 lds
  v_add_f32 v26, v26, v22
  v_mfma_f32_16x16x32_bf16 v[88:91], a[156:159], a[24:27], v[88:91]
  ds_read_b64_tr_b16 a[138:139], v1 offset:17920
  v_add_f32 v27, v27, v23
  v_mfma_f32_16x16x32_bf16 v[88:91], a[152:155], a[8:11], v[88:91]
  v_accvgpr_read_b32 v22, a182
  v_accvgpr_read_b32 v23, a183
  v_mfma_f32_16x16x32_bf16 v[84:87], a[152:155], a[4:7], v[84:87]
  ds_read_b64_tr_b16 a[140:141], v1 offset:21504
  v_max3_u32 v31, v31, v22, v23
  v_mfma_f32_16x16x32_bf16 v[84:87], a[156:159], a[20:23], v[84:87]
  v_add_f32 v28, v28, v22
  v_add_f32 v29, v29, v23
  v_mfma_f32_16x16x32_bf16 v[80:83], a[156:159], a[16:19], v[80:83]
  buffer_load_dwordx4 a[108:111], v0, s[36:39], s11 offen offset:3072 sc1
  ds_read_b64_tr_b16 a[142:143], v1 offset:25088
  v_mfma_f32_16x16x32_bf16 v[80:83], a[152:155], a[0:3], v[80:83]
  s_waitcnt lgkmcnt(8)
  v_accvgpr_read_b32 v22, a184
  v_accvgpr_read_b32 v23, a185
  v_mfma_f32_16x16x32_bf16 v[96:99], a[160:163], a[0:3], v[96:99]
  ds_read_b64_tr_b16 a[144:145], v1 offset:14368
  v_max3_u32 v31, v31, v22, v23
  v_mfma_f32_16x16x32_bf16 v[96:99], a[164:167], a[16:19], v[96:99]
  v_add_f32 v26, v26, v22
  v_add_f32 v27, v27, v23
  v_mfma_f32_16x16x32_bf16 v[100:103], a[164:167], a[20:23], v[100:103]
  ds_read_b64_tr_b16 a[146:147], v1 offset:17952
  v_accvgpr_read_b32 v22, a186
  v_mfma_f32_16x16x32_bf16 v[100:103], a[160:163], a[4:7], v[100:103]
  buffer_load_dwordx4 v6, s[16:19], s10 offen offset:3072 lds
  s_add_u32 s11, s11, 4096
  v_mfma_f32_16x16x32_bf16 v[104:107], a[160:163], a[8:11], v[104:107]
  ds_read_b64_tr_b16 a[148:149], v1 offset:21536
  v_accvgpr_read_b32 v23, a187
  v_mfma_f32_16x16x32_bf16 v[104:107], a[164:167], a[24:27], v[104:107]
  v_max3_u32 v31, v31, v22, v23
  v_add_f32 v28, v28, v22
  v_mfma_f32_16x16x32_bf16 v[108:111], a[164:167], a[28:31], v[108:111]
  ds_read_b64_tr_b16 a[150:151], v1 offset:25120
  v_add_f32 v29, v29, v23
  v_mfma_f32_16x16x32_bf16 v[108:111], a[160:163], a[12:15], v[108:111]
  v_accvgpr_read_b32 v22, a188
  v_accvgpr_read_b32 v23, a189
  v_mfma_f32_16x16x32_bf16 v[124:127], a[168:171], a[12:15], v[124:127]
  buffer_load_dwordx4 a[112:115], v0, s[36:39], s11 offen offset:0 sc1
  s_add_u32 m0, s79, 90112
  v_mfma_f32_16x16x32_bf16 v[124:127], a[172:175], a[28:31], v[124:127]
  ds_read_b64_tr_b16 a[152:153], v1 offset:14400
  v_max3_u32 v31, v31, v22, v23
  v_mfma_f32_16x16x32_bf16 v[120:123], a[172:175], a[24:27], v[120:123]
  ds_read_b64_tr_b16 a[154:155], v1 offset:17984
  v_add_f32 v26, v26, v22
  v_mfma_f32_16x16x32_bf16 v[120:123], a[168:171], a[8:11], v[120:123]
  v_add_f32 v27, v27, v23
  v_accvgpr_read_b32 v22, a190
  v_mfma_f32_16x16x32_bf16 v[116:119], a[168:171], a[4:7], v[116:119]
  ds_read_b64_tr_b16 a[156:157], v1 offset:21568
  v_accvgpr_read_b32 v23, a191
  v_mfma_f32_16x16x32_bf16 v[116:119], a[172:175], a[20:23], v[116:119]
  buffer_load_dwordx4 v7, s[16:19], s10 offen offset:0 lds
  v_max3_u32 v31, v31, v22, v23
  v_mfma_f32_16x16x32_bf16 v[112:115], a[172:175], a[16:19], v[112:115]
  ds_read_b64_tr_b16 a[158:159], v1 offset:25152
  v_add_f32 v28, v28, v22
  v_mfma_f32_16x16x32_bf16 v[112:115], a[168:171], a[0:3], v[112:115]
  s_waitcnt lgkmcnt(8)
  v_add_f32 v29, v29, v23
  v_mfma_f32_16x16x32_bf16 v[128:131], a[128:131], a[0:3], v[128:131]
  ds_read_b64_tr_b16 a[160:161], v1 offset:14432
  v_mfma_f32_16x16x32_bf16 v[128:131], a[132:135], a[16:19], v[128:131]
  v_cmp_eq_u32 vcc, -1, v31
  s_nop 4
  s_cbranch_vccnz CK15s
CK15x:
  v_mfma_f32_16x16x32_bf16 v[132:135], a[132:135], a[20:23], v[132:135]
  s_nop 0
  buffer_load_dwordx4 a[116:119], v0, s[36:39], s11 offen offset:1024 sc1
  ds_read_b64_tr_b16 a[162:163], v1 offset:18016
  v_mfma_f32_16x16x32_bf16 v[132:135], a[128:131], a[4:7], v[132:135]
  v_permlane32_swap_b32 v26, v28
  v_permlane32_swap_b32 v27, v29
  v_mfma_f32_16x16x32_bf16 v[136:139], a[128:131], a[8:11], v[136:139]
  ds_read_b64_tr_b16 a[164:165], v1 offset:21600
  v_add_f32 v26, v26, v28
  v_mfma_f32_16x16x32_bf16 v[136:139], a[132:135], a[24:27], v[136:139]
  v_add_f32 v27, v27, v29
  v_cvt_pk_bf16_f32 v25, v26, v26
  v_mfma_f32_16x16x32_bf16 v[140:143], a[132:135], a[28:31], v[140:143]
  ds_read_b64_tr_b16 a[166:167], v1 offset:25184
  v_lshlrev_b32 v25, 16, v25
  v_mfma_f32_16x16x32_bf16 v[140:143], a[128:131], a[12:15], v[140:143]
  buffer_load_dwordx4 v8, s[16:19], s10 offen offset:1024 lds
  v_sub_f32 v30, v26, v25
  v_mfma_f32_16x16x32_bf16 v[156:159], a[136:139], a[12:15], v[156:159]
  ds_read_b64_tr_b16 a[168:169], v1 offset:14464
  v_cvt_pk_bf16_f32 v22, v26, v30
  v_mfma_f32_16x16x32_bf16 v[156:159], a[140:143], a[28:31], v[156:159]
  v_and_b32 v25, 0xffff0000, v22
  v_sub_f32 v30, v30, v25
  v_mfma_f32_16x16x32_bf16 v[152:155], a[140:143], a[24:27], v[152:155]
  ds_read_b64_tr_b16 a[170:171], v1 offset:18048
  v_cvt_pk_bf16_f32 v23, v30, 0
  v_mfma_f32_16x16x32_bf16 v[152:155], a[136:139], a[8:11], v[152:155]
  ds_write_b64 v24, v[22:23] offset:0
  v_cvt_pk_bf16_f32 v25, v27, v27
  v_mfma_f32_16x16x32_bf16 v[148:151], a[136:139], a[4:7], v[148:151]
  buffer_load_dwordx4 a[120:123], v0, s[36:39], s11 offen offset:2048 sc1
  ds_read_b64_tr_b16 a[172:173], v1 offset:21632
  v_mfma_f32_16x16x32_bf16 v[148:151], a[140:143], a[20:23], v[148:151]
  v_lshlrev_b32 v25, 16, v25
  v_sub_f32 v30, v27, v25
  v_mfma_f32_16x16x32_bf16 v[144:147], a[140:143], a[16:19], v[144:147]
  ds_read_b64_tr_b16 a[174:175], v1 offset:25216
  v_cvt_pk_bf16_f32 v28, v27, v30
  v_mfma_f32_16x16x32_bf16 v[144:147], a[136:139], a[0:3], v[144:147]
  s_waitcnt lgkmcnt(9)
  v_and_b32 v25, 0xffff0000, v28
  v_sub_f32 v30, v30, v25
  v_mfma_f32_16x16x32_bf16 v[160:163], a[144:147], a[0:3], v[160:163]
  ds_read_b64_tr_b16 a[128:129], v1 offset:14496
  v_cvt_pk_bf16_f32 v29, v30, 0
  v_mfma_f32_16x16x32_bf16 v[160:163], a[148:151], a[16:19], v[160:163]
  s_lshl_b32 s31, s44, 8
  buffer_load_dwordx4 v9, s[16:19], s10 offen offset:2048 lds
  s_add_u32 s31, s31, s2
  v_mfma_f32_16x16x32_bf16 v[164:167], a[148:151], a[20:23], v[164:167]
  s_mul_i32 s31, s31, 7168
  ds_read_b64_tr_b16 a[130:131], v1 offset:18080
  ds_write_b64 v24, v[28:29] offset:16
  v_mfma_f32_16x16x32_bf16 v[164:167], a[144:147], a[4:7], v[164:167]
  s_waitcnt lgkmcnt(0)
  v_mfma_f32_16x16x32_bf16 v[168:171], a[144:147], a[8:11], v[168:171]
  ds_read_b64_tr_b16 a[132:133], v1 offset:21664
  v_mfma_f32_16x16x32_bf16 v[168:171], a[148:151], a[24:27], v[168:171]
  v_mfma_f32_16x16x32_bf16 v[172:175], a[148:151], a[28:31], v[172:175]
  buffer_load_dwordx4 a[124:127], v0, s[36:39], s11 offen offset:3072 sc1
  ds_read_b64_tr_b16 a[134:135], v1 offset:25248
  v_mfma_f32_16x16x32_bf16 v[172:175], a[144:147], a[12:15], v[172:175]
  v_mfma_f32_16x16x32_bf16 v[188:191], a[152:155], a[12:15], v[188:191]
  ds_read_b64_tr_b16 a[136:137], v1 offset:14528
  v_mfma_f32_16x16x32_bf16 v[188:191], a[156:159], a[28:31], v[188:191]
  v_mfma_f32_16x16x32_bf16 v[184:187], a[156:159], a[24:27], v[184:187]
  ds_read_b64_tr_b16 a[138:139], v1 offset:18112
  v_mfma_f32_16x16x32_bf16 v[184:187], a[152:155], a[8:11], v[184:187]
  v_mfma_f32_16x16x32_bf16 v[180:183], a[152:155], a[4:7], v[180:183]
  ds_read_b64_tr_b16 a[140:141], v1 offset:21696
  v_mfma_f32_16x16x32_bf16 v[180:183], a[156:159], a[20:23], v[180:183]
  v_mfma_f32_16x16x32_bf16 v[176:179], a[156:159], a[16:19], v[176:179]
  ds_read_b64_tr_b16 a[142:143], v1 offset:25280
  v_mfma_f32_16x16x32_bf16 v[176:179], a[152:155], a[0:3], v[176:179]
  s_waitcnt lgkmcnt(9)
  v_mfma_f32_16x16x32_bf16 v[192:195], a[160:163], a[0:3], v[192:195]
  ds_read_b64_tr_b16 a[144:145], v1 offset:28864
  v_mfma_f32_16x16x32_bf16 v[192:195], a[164:167], a[16:19], v[192:195]
  v_mfma_f32_16x16x32_bf16 v[196:199], a[164:167], a[20:23], v[196:199]
  ds_read_b64_tr_b16 a[146:147], v1 offset:32448
  v_mfma_f32_16x16x32_bf16 v[196:199], a[160:163], a[4:7], v[196:199]
  v_mfma_f32_16x16x32_bf16 v[200:203], a[160:163], a[8:11], v[200:203]
  ds_read_b64_tr_b16 a[148:149], v1 offset:36032
  v_mfma_f32_16x16x32_bf16 v[200:203], a[164:167], a[24:27], v[200:203]
  v_mfma_f32_16x16x32_bf16 v[204:207], a[164:167], a[28:31], v[204:207]
  ds_read_b64_tr_b16 a[150:151], v1 offset:39616
  v_mfma_f32_16x16x32_bf16 v[204:207], a[160:163], a[12:15], v[204:207]
  s_waitcnt vmcnt(16)
  s_barrier
  v_mfma_f32_16x16x32_bf16 v[220:223], a[168:171], a[12:15], v[220:223]
  ds_read_b64_tr_b16 a[152:153], v1 offset:43200
  v_mfma_f32_16x16x32_bf16 v[220:223], a[172:175], a[28:31], v[220:223]
  v_mfma_f32_16x16x32_bf16 v[216:219], a[172:175], a[24:27], v[216:219]
  ds_read_b64_tr_b16 a[154:155], v1 offset:46784
  v_mfma_f32_16x16x32_bf16 v[216:219], a[168:171], a[8:11], v[216:219]
  v_mfma_f32_16x16x32_bf16 v[212:215], a[168:171], a[4:7], v[212:215]
  ds_read_b64_tr_b16 a[156:157], v1 offset:50368
  v_mfma_f32_16x16x32_bf16 v[212:215], a[172:175], a[20:23], v[212:215]
  v_mfma_f32_16x16x32_bf16 v[208:211], a[172:175], a[16:19], v[208:211]
  ds_read_b64_tr_b16 a[158:159], v1 offset:53952
  v_mfma_f32_16x16x32_bf16 v[208:211], a[168:171], a[0:3], v[208:211]
  s_waitcnt lgkmcnt(8)
  v_mfma_f32_16x16x32_bf16 v[224:227], a[128:131], a[0:3], v[224:227]
  ds_read_b64_tr_b16 a[160:161], v2 offset:192
  v_mfma_f32_16x16x32_bf16 v[224:227], a[132:135], a[16:19], v[224:227]
  v_mfma_f32_16x16x32_bf16 v[228:231], a[132:135], a[20:23], v[228:231]
  ds_read_b64_tr_b16 a[162:163], v2 offset:3776
  v_mfma_f32_16x16x32_bf16 v[228:231], a[128:131], a[4:7], v[228:231]
  v_mfma_f32_16x16x32_bf16 v[232:235], a[128:131], a[8:11], v[232:235]
  ds_read_b64_tr_b16 a[164:165], v2 offset:7360
  v_mfma_f32_16x16x32_bf16 v[232:235], a[132:135], a[24:27], v[232:235]
  v_mfma_f32_16x16x32_bf16 v[236:239], a[132:135], a[28:31], v[236:239]
  ds_read_b64_tr_b16 a[166:167], v2 offset:10944
  v_mfma_f32_16x16x32_bf16 v[236:239], a[128:131], a[12:15], v[236:239]
  v_mfma_f32_16x16x32_bf16 v[252:255], a[136:139], a[12:15], v[252:255]
  ds_read_b64_tr_b16 a[168:169], v2 offset:14528
  v_mfma_f32_16x16x32_bf16 v[252:255], a[140:143], a[28:31], v[252:255]
  v_mfma_f32_16x16x32_bf16 v[248:251], a[140:143], a[24:27], v[248:251]
  ds_read_b64_tr_b16 a[170:171], v2 offset:18112
  v_mfma_f32_16x16x32_bf16 v[248:251], a[136:139], a[8:11], v[248:251]
  v_mfma_f32_16x16x32_bf16 v[244:247], a[136:139], a[4:7], v[244:247]
  ds_read_b64_tr_b16 a[172:173], v2 offset:21696
  v_mfma_f32_16x16x32_bf16 v[244:247], a[140:143], a[20:23], v[244:247]
  v_mfma_f32_16x16x32_bf16 v[240:243], a[140:143], a[16:19], v[240:243]
  ds_read_b64_tr_b16 a[174:175], v2 offset:25280
  v_mfma_f32_16x16x32_bf16 v[240:243], a[136:139], a[0:3], v[240:243]
  s_waitcnt vmcnt(1) lgkmcnt(8)
  s_barrier
  v_mfma_f32_16x16x32_bf16 v[128:131], a[144:147], a[32:35], v[128:131]
CT16:
  s_add_u32 s94, s92, CT16-k3_main_kernel+3072
  s_addc_u32 s95, s93, 0
  v_mfma_f32_16x16x32_bf16 v[128:131], a[148:151], a[48:51], v[128:131]
  s_barrier
  global_load_dword a252, v0, s[94:95]
  v_and_b32 v31, 0xf0, v0
  v_mfma_f32_16x16x32_bf16 v[132:135], a[148:151], a[52:55], v[132:135]
  v_add_u32 v31, 159744, v31
  v_cmp_gt_u32 vcc, 0x100, v0
  v_mfma_f32_16x16x32_bf16 v[132:135], a[144:147], a[36:39], v[132:135]
  s_mov_b32 s28, 0x01000100
  s_mov_b32 s29, 0x03020302
  v_min_u32 v3, 880, v0
  v_mfma_f32_16x16x32_bf16 v[136:139], a[144:147], a[40:43], v[136:139]
  v_lshlrev_b32 v3, 3, v3
  v_cndmask_b32 v12, 0, v12, vcc
  v_mfma_f32_16x16x32_bf16 v[136:139], a[148:151], a[56:59], v[136:139]
  buffer_load_dword a252, v3, s[24:27], s31 offen
  v_perm_b32 v22, v12, v12, s28
  v_mfma_f32_16x16x32_bf16 v[140:143], a[148:151], a[60:63], v[140:143]
  v_and_b32 v23, 0xffff, v12
  v_perm_b32 v24, v12, v12, s29
  v_mfma_f32_16x16x32_bf16 v[140:143], a[144:147], a[44:47], v[140:143]
  v_lshrrev_b32 v25, 16, v12
  v_accvgpr_write_b32 a0, v22
  v_mfma_f32_16x16x32_bf16 v[252:255], a[152:155], a[44:47], v[252:255]
  ds_read_b64_tr_b16 a[128:129], v2 offset:28864
  v_accvgpr_write_b32 a1, v23
  v_mfma_f32_16x16x32_bf16 v[252:255], a[156:159], a[60:63], v[252:255]
  v_accvgpr_write_b32 a2, v24
  v_accvgpr_write_b32 a3, v25
  v_mfma_f32_16x16x32_bf16 v[248:251], a[156:159], a[56:59], v[248:251]
  ds_read_b64_tr_b16 a[130:131], v2 offset:32448
  v_cndmask_b32 v15, 0, v15, vcc
  v_mfma_f32_16x16x32_bf16 v[248:251], a[152:155], a[40:43], v[248:251]
  v_perm_b32 v26, v15, v15, s28
  v_and_b32 v27, 0xffff, v15
  v_mfma_f32_16x16x32_bf16 v[244:247], a[152:155], a[36:39], v[244:247]
  ds_read_b64_tr_b16 a[132:133], v2 offset:36032
  v_perm_b32 v28, v15, v15, s29
  v_mfma_f32_16x16x32_bf16 v[244:247], a[156:159], a[52:55], v[244:247]
  ds_read_b128 a[16:19], v31 offset:1536
  v_lshrrev_b32 v29, 16, v15
  v_mfma_f32_16x16x32_bf16 v[240:243], a[156:159], a[48:51], v[240:243]
  ds_read_b128 a[20:23], v31 offset:3584
  ds_read_b64_tr_b16 a[134:135], v2 offset:39616
  v_mfma_f32_16x16x32_bf16 v[240:243], a[152:155], a[32:35], v[240:243]
  s_waitcnt vmcnt(17) lgkmcnt(6)
  v_accvgpr_write_b32 a4, v26
  v_accvgpr_write_b32 a5, v27
  v_mfma_f32_16x16x32_bf16 v[128:131], a[160:163], a[64:67], v[128:131]
  ds_read_b64_tr_b16 a[136:137], v2 offset:43200
  v_accvgpr_write_b32 a6, v28
  v_mfma_f32_16x16x32_bf16 v[128:131], a[164:167], a[80:83], v[128:131]
  v_accvgpr_write_b32 a7, v29
  v_cndmask_b32 v18, 0, v18, vcc
  v_mfma_f32_16x16x32_bf16 v[132:135], a[164:167], a[84:87], v[132:135]
  ds_read_b64_tr_b16 a[138:139], v2 offset:46784
  v_perm_b32 v22, v18, v18, s28
  v_mfma_f32_16x16x32_bf16 v[132:135], a[160:163], a[68:71], v[132:135]
  v_and_b32 v23, 0xffff, v18
  v_perm_b32 v24, v18, v18, s29
  v_mfma_f32_16x16x32_bf16 v[136:139], a[160:163], a[72:75], v[136:139]
  ds_read_b64_tr_b16 a[140:141], v2 offset:50368
  v_lshrrev_b32 v25, 16, v18
  v_mfma_f32_16x16x32_bf16 v[136:139], a[164:167], a[88:91], v[136:139]
  v_accvgpr_write_b32 a8, v22
  v_accvgpr_write_b32 a9, v23
  v_mfma_f32_16x16x32_bf16 v[140:143], a[164:167], a[92:95], v[140:143]
  ds_read_b64_tr_b16 a[142:143], v2 offset:53952
  v_accvgpr_write_b32 a10, v24
  v_mfma_f32_16x16x32_bf16 v[140:143], a[160:163], a[76:79], v[140:143]
  v_accvgpr_write_b32 a11, v25
  v_cndmask_b32 v21, 0, v21, vcc
  v_mfma_f32_16x16x32_bf16 v[252:255], a[168:171], a[76:79], v[252:255]
  ds_read_b64_tr_b16 a[144:145], v1 offset:28672
  v_perm_b32 v26, v21, v21, s28
  v_mfma_f32_16x16x32_bf16 v[252:255], a[172:175], a[92:95], v[252:255]
  v_and_b32 v27, 0xffff, v21
  v_perm_b32 v28, v21, v21, s29
  v_mfma_f32_16x16x32_bf16 v[248:251], a[172:175], a[88:91], v[248:251]
  ds_read_b64_tr_b16 a[146:147], v1 offset:32256
  v_lshrrev_b32 v29, 16, v21
  v_mfma_f32_16x16x32_bf16 v[248:251], a[168:171], a[72:75], v[248:251]
  v_accvgpr_write_b32 a12, v26
  v_accvgpr_write_b32 a13, v27
  v_mfma_f32_16x16x32_bf16 v[244:247], a[168:171], a[68:71], v[244:247]
  v_accvgpr_write_b32 a14, v28
  v_accvgpr_write_b32 a15, v29
  v_mfma_f32_16x16x32_bf16 v[244:247], a[172:175], a[84:87], v[244:247]
  ds_read_b64_tr_b16 a[148:149], v1 offset:35840
  v_mfma_f32_16x16x32_bf16 v[240:243], a[172:175], a[80:83], v[240:243]
  ds_read_b64_tr_b16 a[150:151], v1 offset:39424
  v_mfma_f32_16x16x32_bf16 v[240:243], a[168:171], a[64:67], v[240:243]
  s_waitcnt lgkmcnt(9)
  v_mfma_f32_16x16x32_bf16 v[128:131], a[16:19], a[0:3], v[128:131]
  v_mfma_f32_16x16x32_bf16 v[132:135], a[16:19], a[4:7], v[132:135]
  v_mfma_f32_16x16x32_bf16 v[136:139], a[16:19], a[8:11], v[136:139]
  v_mfma_f32_16x16x32_bf16 v[140:143], a[16:19], a[12:15], v[140:143]
  v_mfma_f32_16x16x32_bf16 v[240:243], a[20:23], a[0:3], v[240:243]
  v_mfma_f32_16x16x32_bf16 v[244:247], a[20:23], a[4:7], v[244:247]
  v_mfma_f32_16x16x32_bf16 v[248:251], a[20:23], a[8:11], v[248:251]
  v_mfma_f32_16x16x32_bf16 v[252:255], a[20:23], a[12:15], v[252:255]
  s_waitcnt vmcnt(2) lgkmcnt(4)
  v_mfma_f32_16x16x32_bf16 v[128:131], a[128:131], a[96:99], v[128:131]
  ds_read_b128 a[24:27], v31 offset:0
  ds_read_b64_tr_b16 a[152:153], v1 offset:43008
  v_mfma_f32_16x16x32_bf16 v[128:131], a[132:135], a[112:115], v[128:131]
  v_mfma_f32_16x16x32_bf16 v[132:135], a[132:135], a[116:119], v[132:135]
  ds_read_b128 a[28:31], v31 offset:2048
  ds_read_b64_tr_b16 a[154:155], v1 offset:46592
  v_mfma_f32_16x16x32_bf16 v[132:135], a[128:131], a[100:103], v[132:135]
  v_mfma_f32_16x16x32_bf16 v[136:139], a[128:131], a[104:107], v[136:139]
  ds_read_b64_tr_b16 a[156:157], v1 offset:50176
  v_mfma_f32_16x16x32_bf16 v[136:139], a[132:135], a[120:123], v[136:139]
  v_mfma_f32_16x16x32_bf16 v[140:143], a[132:135], a[124:127], v[140:143]
  ds_read_b64_tr_b16 a[158:159], v1 offset:53760
  v_mfma_f32_16x16x32_bf16 v[140:143], a[128:131], a[108:111], v[140:143]
  v_mfma_f32_16x16x32_bf16 v[252:255], a[136:139], a[108:111], v[252:255]
  ds_read_b64_tr_b16 a[160:161], v2 offset:0
  v_mul_f32 v22, v10, v128
  v_mul_f32 v23, v10, v129
  v_mul_f32 v24, v10, v130
  v_mfma_f32_16x16x32_bf16 v[252:255], a[140:143], a[124:127], v[252:255]
  v_mul_f32 v25, v10, v131
  v_exp_f32 v22, v22
  v_mul_f32 v26, v13, v132
  v_mfma_f32_16x16x32_bf16 v[248:251], a[140:143], a[120:123], v[248:251]
  ds_read_b64_tr_b16 a[162:163], v2 offset:3584
  v_exp_f32 v23, v23
  v_mul_f32 v27, v13, v133
  v_mfma_f32_16x16x32_bf16 v[248:251], a[136:139], a[104:107], v[248:251]
  v_exp_f32 v24, v24
  v_mul_f32 v28, v13, v134
  v_mfma_f32_16x16x32_bf16 v[244:247], a[136:139], a[100:103], v[244:247]
  ds_read_b64_tr_b16 a[164:165], v2 offset:7168
  v_exp_f32 v25, v25
  v_mul_f32 v29, v13, v135
  v_mfma_f32_16x16x32_bf16 v[244:247], a[140:143], a[116:119], v[244:247]
  v_exp_f32 v26, v26
  v_fma_f32 v22, v22, v11, v11
  v_mfma_f32_16x16x32_bf16 v[240:243], a[140:143], a[112:115], v[240:243]
  ds_read_b64_tr_b16 a[166:167], v2 offset:10752
  v_exp_f32 v27, v27
  v_fma_f32 v23, v23, v11, v11
  v_mfma_f32_16x16x32_bf16 v[240:243], a[136:139], a[96:99], v[240:243]
  s_waitcnt lgkmcnt(4)
  v_exp_f32 v28, v28
  v_fma_f32 v24, v24, v11, v11
  v_mfma_f32_16x16x32_bf16 v[32:35], a[144:147], a[32:35], v[32:35]
  ds_read_b64_tr_b16 a[168:169], v2 offset:14336
  v_exp_f32 v29, v29
  v_fma_f32 v25, v25, v11, v11
  v_mfma_f32_16x16x32_bf16 v[32:35], a[148:151], a[48:51], v[32:35]
  v_rcp_f32 v22, v22
  v_fma_f32 v26, v26, v14, v14
  v_mfma_f32_16x16x32_bf16 v[36:39], a[148:151], a[52:55], v[36:39]
  ds_read_b64_tr_b16 a[170:171], v2 offset:17920
  v_rcp_f32 v23, v23
  v_fma_f32 v27, v27, v14, v14
  v_mfma_f32_16x16x32_bf16 v[36:39], a[144:147], a[36:39], v[36:39]
  v_rcp_f32 v24, v24
  v_fma_f32 v28, v28, v14, v14
  v_mfma_f32_16x16x32_bf16 v[40:43], a[144:147], a[40:43], v[40:43]
  ds_read_b64_tr_b16 a[172:173], v2 offset:21504
  v_rcp_f32 v25, v25
  v_fma_f32 v29, v29, v14, v14
  v_mfma_f32_16x16x32_bf16 v[40:43], a[148:151], a[56:59], v[40:43]
  v_rcp_f32 v26, v26
  v_mul_f32 v240, v128, v240
  v_mfma_f32_16x16x32_bf16 v[44:47], a[148:151], a[60:63], v[44:47]
  ds_read_b64_tr_b16 a[174:175], v2 offset:25088
  v_rcp_f32 v27, v27
  v_mul_f32 v241, v129, v241
  v_mfma_f32_16x16x32_bf16 v[44:47], a[144:147], a[44:47], v[44:47]
  s_waitcnt lgkmcnt(11)
  v_rcp_f32 v28, v28
  v_mul_f32 v242, v130, v242
  v_mfma_f32_16x16x32_bf16 v[32:35], a[24:27], a[0:3], v[32:35]
  ds_read_b64_tr_b16 a[128:129], v2 offset:28672
  v_rcp_f32 v29, v29
  v_mul_f32 v243, v131, v243
  v_mfma_f32_16x16x32_bf16 v[36:39], a[24:27], a[4:7], v[36:39]
  v_mul_f32 v240, v240, v22
  v_mul_f32 v241, v241, v23
  v_mul_f32 v242, v242, v24
  v_mul_f32 v243, v243, v25
  v_mfma_f32_16x16x32_bf16 v[40:43], a[24:27], a[8:11], v[40:43]
  ds_read_b64_tr_b16 a[130:131], v2 offset:32256
  v_mul_f32 v22, v16, v136
  v_mul_f32 v23, v16, v137
  v_mul_f32 v24, v16, v138
  v_mfma_f32_16x16x32_bf16 v[44:47], a[24:27], a[12:15], v[44:47]
  v_mul_f32 v25, v16, v139
  v_exp_f32 v22, v22
  v_mul_f32 v244, v132, v244
  v_mfma_f32_16x16x32_bf16 v[144:147], a[28:31], a[0:3], v[144:147]
  ds_read_b64_tr_b16 a[132:133], v2 offset:35840
  v_exp_f32 v23, v23
  v_mul_f32 v245, v133, v245
  v_mfma_f32_16x16x32_bf16 v[148:151], a[28:31], a[4:7], v[148:151]
  v_exp_f32 v24, v24
  v_mul_f32 v246, v134, v246
  v_mfma_f32_16x16x32_bf16 v[152:155], a[28:31], a[8:11], v[152:155]
  ds_read_b64_tr_b16 a[134:135], v2 offset:39424
  v_exp_f32 v25, v25
  v_mul_f32 v247, v135, v247
  v_mfma_f32_16x16x32_bf16 v[156:159], a[28:31], a[12:15], v[156:159]
  v_mul_f32 v244, v244, v26
  v_mul_f32 v245, v245, v27
  v_mul_f32 v246, v246, v28
  v_mul_f32 v247, v247, v29
  v_mfma_f32_16x16x32_bf16 v[156:159], a[152:155], a[44:47], v[156:159]
  ds_read_b64_tr_b16 a[136:137], v2 offset:43008
  v_cvt_pk_bf16_f32 v128, v240, v241
  v_cvt_pk_bf16_f32 v129, v242, v243
  v_mfma_f32_16x16x32_bf16 v[156:159], a[156:159], a[60:63], v[156:159]
  buffer_store_dwordx2 v[128:129], v0, s[36:39], s21 offen offset:0 sc1
  v_mul_f32 v26, v19, v140
  v_mul_f32 v27, v19, v141
  v_mul_f32 v28, v19, v142
  v_mfma_f32_16x16x32_bf16 v[152:155], a[156:159], a[56:59], v[152:155]
  ds_read_b64_tr_b16 a[138:139], v2 offset:46592
  v_mul_f32 v29, v19, v143
  v_exp_f32 v26, v26
  v_mfma_f32_16x16x32_bf16 v[152:155], a[152:155], a[40:43], v[152:155]
  v_fma_f32 v22, v22, v17, v17
  v_exp_f32 v27, v27
  v_fma_f32 v23, v23, v17, v17
  v_mfma_f32_16x16x32_bf16 v[148:151], a[152:155], a[36:39], v[148:151]
  ds_read_b64_tr_b16 a[140:141], v2 offset:50176
  v_exp_f32 v28, v28
  v_fma_f32 v24, v24, v17, v17
  v_mfma_f32_16x16x32_bf16 v[148:151], a[156:159], a[52:55], v[148:151]
  v_exp_f32 v29, v29
  v_fma_f32 v25, v25, v17, v17
  v_cvt_pk_bf16_f32 v132, v244, v245
  v_mfma_f32_16x16x32_bf16 v[144:147], a[156:159], a[48:51], v[144:147]
  ds_read_b64_tr_b16 a[142:143], v2 offset:53760
  v_cvt_pk_bf16_f32 v133, v246, v247
  v_mfma_f32_16x16x32_bf16 v[144:147], a[152:155], a[32:35], v[144:147]
  s_waitcnt lgkmcnt(8)
  buffer_store_dwordx2 v[132:133], v0, s[36:39], s21 offen offset:1024 sc1
  v_rcp_f32 v22, v22
  v_fma_f32 v26, v26, v20, v20
  v_mfma_f32_16x16x32_bf16 v[32:35], a[160:163], a[64:67], v[32:35]
  ds_read_b64_tr_b16 a[144:145], v1 offset:28704
CT17:
  s_add_u32 s94, s92, CT17-k3_main_kernel+3072
  s_addc_u32 s95, s93, 0
  v_mfma_f32_16x16x32_bf16 v[32:35], a[164:167], a[80:83], v[32:35]
  global_load_dword a252, v0, s[94:95]
  v_rcp_f32 v23, v23
  v_fma_f32 v27, v27, v20, v20
  v_mfma_f32_16x16x32_bf16 v[36:39], a[164:167], a[84:87], v[36:39]
  ds_read_b64_tr_b16 a[146:147], v1 offset:32288
  v_rcp_f32 v24, v24
  v_fma_f32 v28, v28, v20, v20
  v_mfma_f32_16x16x32_bf16 v[36:39], a[160:163], a[68:71], v[36:39]
  v_rcp_f32 v25, v25
  v_fma_f32 v29, v29, v20, v20
  v_mfma_f32_16x16x32_bf16 v[40:43], a[160:163], a[72:75], v[40:43]
  ds_read_b64_tr_b16 a[148:149], v1 offset:35872
  v_rcp_f32 v26, v26
  v_mul_f32 v248, v136, v248
  v_mfma_f32_16x16x32_bf16 v[40:43], a[164:167], a[88:91], v[40:43]
  v_rcp_f32 v27, v27
  v_mul_f32 v249, v137, v249
  v_mfma_f32_16x16x32_bf16 v[44:47], a[164:167], a[92:95], v[44:47]
  ds_read_b64_tr_b16 a[150:151], v1 offset:39456
  v_rcp_f32 v28, v28
  v_mul_f32 v250, v138, v250
  v_mfma_f32_16x16x32_bf16 v[44:47], a[160:163], a[76:79], v[44:47]
  v_rcp_f32 v29, v29
  v_mul_f32 v251, v139, v251
  v_mul_f32 v248, v248, v22
  v_mfma_f32_16x16x32_bf16 v[156:159], a[168:171], a[76:79], v[156:159]
  v_mul_f32 v249, v249, v23
  v_mul_f32 v250, v250, v24
  v_mul_f32 v251, v251, v25
  v_mul_f32 v252, v140, v252
  v_mfma_f32_16x16x32_bf16 v[156:159], a[172:175], a[92:95], v[156:159]
  v_mul_f32 v253, v141, v253
  v_mul_f32 v254, v142, v254
  v_mul_f32 v255, v143, v255
  v_cvt_pk_bf16_f32 v136, v248, v249
  v_mfma_f32_16x16x32_bf16 v[152:155], a[172:175], a[88:91], v[152:155]
  v_cvt_pk_bf16_f32 v137, v250, v251
  v_mfma_f32_16x16x32_bf16 v[152:155], a[168:171], a[72:75], v[152:155]
  buffer_store_dwordx2 v[136:137], v0, s[36:39], s22 offen offset:0 sc1
  v_mul_f32 v252, v252, v26
  v_mul_f32 v253, v253, v27
  v_mul_f32 v254, v254, v28
  v_mfma_f32_16x16x32_bf16 v[148:151], a[168:171], a[68:71], v[148:151]
  v_mul_f32 v255, v255, v29
  v_cvt_pk_bf16_f32 v140, v252, v253
  v_cvt_pk_bf16_f32 v141, v254, v255
  v_mfma_f32_16x16x32_bf16 v[148:151], a[172:175], a[84:87], v[148:151]
  buffer_store_dwordx2 v[140:141], v0, s[36:39], s22 offen offset:1024 sc1
  s_mov_b32 s21, s23
  s_add_u32 s22, s23, 262144
  v_mfma_f32_16x16x32_bf16 v[144:147], a[172:175], a[80:83], v[144:147]
  v_lshrrev_b32 v128, 4, v0
  s_add_u32 s52, s54, s71
  s_and_b32 s52, s52, 3
  s_and_b32 s58, s2, 1
  v_mfma_f32_16x16x32_bf16 v[144:147], a[168:171], a[64:67], v[144:147]
  s_waitcnt lgkmcnt(4)
  s_lshl_b32 s57, s55, 7
  s_lshl3_add_u32 s57, s73, s57
  s_mul_i32 s53, s58, 3670016
  s_add_u32 s57, s57, s53
  v_mfma_f32_16x16x32_bf16 v[32:35], a[128:131], a[96:99], v[32:35]
  s_lshr_b32 s53, s44, 1
  s_mul_i32 s53, s53, 393216
  ds_read_b128 a[16:19], v31 offset:256
  ds_read_b64_tr_b16 a[152:153], v1 offset:43040
  v_bfe_u32 v129, v128, 4, 2
  v_mfma_f32_16x16x32_bf16 v[32:35], a[132:135], a[112:115], v[32:35]
  v_bfe_u32 v130, v128, 1, 2
  v_xor_b32 v129, v129, v130
  v_lshlrev_b32 v129, 5, v129
  v_and_b32 v130, 1, v128
  v_mfma_f32_16x16x32_bf16 v[36:39], a[132:135], a[116:119], v[36:39]
  ds_read_b128 a[20:23], v31 offset:2304
  ds_read_b64_tr_b16 a[154:155], v1 offset:46624
  v_lshl_add_u32 v129, v130, 4, v129
  v_lshrrev_b32 v130, 3, v128
  v_mfma_f32_16x16x32_bf16 v[36:39], a[128:131], a[100:103], v[36:39]
  v_lshlrev_b32 v130, 11, v130
  s_sub_u32 s24, s24, 2048
  s_subb_u32 s25, s25, 0
  s_mov_b32 s26, 7342080
  v_mfma_f32_16x16x32_bf16 v[40:43], a[128:131], a[104:107], v[40:43]
  ds_read_b64_tr_b16 a[156:157], v1 offset:50208
  v_add3_u32 v129, v129, v130, s57
  v_add_u32 v133, 2048, v129
  v_add_u32 v134, 17408, v129
  v_mfma_f32_16x16x32_bf16 v[40:43], a[132:135], a[120:123], v[40:43]
  v_xor_b32 v135, 128, v129
  v_add_u32 v136, 15360, v135
  v_and_b32 v129, 7, v128
  v_lshrrev_b32 v131, 4, v128
  v_mfma_f32_16x16x32_bf16 v[44:47], a[132:135], a[124:127], v[44:47]
  ds_read_b64_tr_b16 a[158:159], v1 offset:53792
  v_xor_b32 v129, v129, v131
  v_lshl_add_u32 v252, v129, 4, v130
  v_xor_b32 v253, 64, v252
  v_mfma_f32_16x16x32_bf16 v[44:47], a[128:131], a[108:111], v[44:47]
  v_add_u32 v253, 16384, v253
  s_lshl2_add_u32 s57, s54, s44
  s_lshl_b32 s57, s57, 18
  s_mul_i32 s60, s58, 114688
  v_mfma_f32_16x16x32_bf16 v[156:159], a[136:139], a[108:111], v[156:159]
  s_add_u32 s57, s57, s60
  s_add_u32 s57, s57, 19922944
  ds_read_b64_tr_b16 a[160:161], v2 offset:32
  v_add_u32 v137, s57, v0
  v_bfe_u32 v129, v128, 3, 2
  v_mfma_f32_16x16x32_bf16 v[156:159], a[140:143], a[124:127], v[156:159]
  v_lshlrev_b32 v129, 5, v129
  v_and_b32 v130, 3, v128
  v_lshl_add_u32 v129, v130, 3, v129
  v_lshrrev_b32 v130, 2, v128
  v_mfma_f32_16x16x32_bf16 v[152:155], a[140:143], a[120:123], v[152:155]
  ds_read_b64_tr_b16 a[162:163], v2 offset:3616
  v_lshl_add_u32 v240, v130, 7, v129
  v_xor_b32 v241, 32, v240
  v_xor_b32 v242, 64, v240
  v_mfma_f32_16x16x32_bf16 v[152:155], a[136:139], a[104:107], v[152:155]
  v_xor_b32 v243, 96, v240
  v_xor_b32 v244, 65536, v240
  v_xor_b32 v245, 65568, v240
  v_xor_b32 v246, 65600, v240
  v_mfma_f32_16x16x32_bf16 v[148:151], a[136:139], a[100:103], v[148:151]
  ds_read_b64_tr_b16 a[164:165], v2 offset:7200
  v_xor_b32 v247, 65632, v240
  v_xor_b32 v248, 131072, v240
  v_xor_b32 v249, 131104, v240
  v_mfma_f32_16x16x32_bf16 v[148:151], a[140:143], a[116:119], v[148:151]
  v_xor_b32 v250, 131136, v240
  v_xor_b32 v251, 131168, v240
  s_lshr_b32 s57, s54, 1
  s_lshl_b32 s57, s57, 5
  v_mfma_f32_16x16x32_bf16 v[144:147], a[140:143], a[112:115], v[144:147]
  s_lshl2_add_u32 s57, s58, s57
  ds_read_b64_tr_b16 a[166:167], v2 offset:10784
  v_and_b32 v129, 3, v128
  v_bfe_u32 v130, v128, 2, 2
  v_lshl_add_u32 v129, v129, 3, v130
  v_mfma_f32_16x16x32_bf16 v[144:147], a[136:139], a[96:99], v[144:147]
  s_waitcnt lgkmcnt(4)
  v_add_lshl_u32 v138, v129, s57, 7
  v_mov_b32 v254, 1
  s_mov_b32 s60, 5406720
  v_mul_f32 v22, v10, v32
  v_mfma_f32_16x16x32_bf16 v[48:51], a[144:147], a[32:35], v[48:51]
  ds_read_b64_tr_b16 a[168:169], v2 offset:14368
  v_mul_f32 v23, v10, v33
  v_mul_f32 v24, v10, v34
  v_mul_f32 v25, v10, v35
  v_mfma_f32_16x16x32_bf16 v[48:51], a[148:151], a[48:51], v[48:51]
  v_exp_f32 v22, v22
  v_mul_f32 v26, v13, v36
  v_mfma_f32_16x16x32_bf16 v[52:55], a[148:151], a[52:55], v[52:55]
  ds_read_b64_tr_b16 a[170:171], v2 offset:17952
  v_exp_f32 v23, v23
  v_mul_f32 v27, v13, v37
  v_mfma_f32_16x16x32_bf16 v[52:55], a[144:147], a[36:39], v[52:55]
  v_exp_f32 v24, v24
  v_mul_f32 v28, v13, v38
  v_mfma_f32_16x16x32_bf16 v[56:59], a[144:147], a[40:43], v[56:59]
  ds_read_b64_tr_b16 a[172:173], v2 offset:21536
  v_exp_f32 v25, v25
  v_mul_f32 v29, v13, v39
  v_mfma_f32_16x16x32_bf16 v[56:59], a[148:151], a[56:59], v[56:59]
  v_exp_f32 v26, v26
  v_fma_f32 v22, v22, v11, v11
  v_mfma_f32_16x16x32_bf16 v[60:63], a[148:151], a[60:63], v[60:63]
  ds_read_b64_tr_b16 a[174:175], v2 offset:25120
  v_exp_f32 v27, v27
  v_fma_f32 v23, v23, v11, v11
  v_mfma_f32_16x16x32_bf16 v[60:63], a[144:147], a[44:47], v[60:63]
  s_waitcnt lgkmcnt(11)
  v_exp_f32 v28, v28
  v_fma_f32 v24, v24, v11, v11
  v_mfma_f32_16x16x32_bf16 v[48:51], a[16:19], a[0:3], v[48:51]
  ds_read_b64_tr_b16 a[128:129], v2 offset:28704
  v_exp_f32 v29, v29
  v_fma_f32 v25, v25, v11, v11
  v_mfma_f32_16x16x32_bf16 v[52:55], a[16:19], a[4:7], v[52:55]
  v_rcp_f32 v22, v22
  v_fma_f32 v26, v26, v14, v14
  v_mfma_f32_16x16x32_bf16 v[56:59], a[16:19], a[8:11], v[56:59]
  ds_read_b64_tr_b16 a[130:131], v2 offset:32288
  v_rcp_f32 v23, v23
  v_fma_f32 v27, v27, v14, v14
  v_mfma_f32_16x16x32_bf16 v[60:63], a[16:19], a[12:15], v[60:63]
  v_rcp_f32 v24, v24
  v_fma_f32 v28, v28, v14, v14
  v_mfma_f32_16x16x32_bf16 v[160:163], a[20:23], a[0:3], v[160:163]
  ds_read_b64_tr_b16 a[132:133], v2 offset:35872
  v_rcp_f32 v25, v25
  v_fma_f32 v29, v29, v14, v14
  v_mfma_f32_16x16x32_bf16 v[164:167], a[20:23], a[4:7], v[164:167]
  v_rcp_f32 v26, v26
  v_mul_f32 v144, v32, v144
  v_mfma_f32_16x16x32_bf16 v[168:171], a[20:23], a[8:11], v[168:171]
  ds_read_b64_tr_b16 a[134:135], v2 offset:39456
  v_rcp_f32 v27, v27
  v_mul_f32 v145, v33, v145
  v_mfma_f32_16x16x32_bf16 v[172:175], a[20:23], a[12:15], v[172:175]
  v_rcp_f32 v28, v28
  v_mul_f32 v146, v34, v146
  v_mfma_f32_16x16x32_bf16 v[172:175], a[152:155], a[44:47], v[172:175]
  ds_read_b64_tr_b16 a[136:137], v2 offset:43040
  v_rcp_f32 v29, v29
  v_mul_f32 v147, v35, v147
  v_mul_f32 v144, v144, v22
  v_mfma_f32_16x16x32_bf16 v[172:175], a[156:159], a[60:63], v[172:175]
  v_mul_f32 v145, v145, v23
  v_mul_f32 v146, v146, v24
  v_mul_f32 v147, v147, v25
  v_mul_f32 v22, v16, v40
  v_mfma_f32_16x16x32_bf16 v[168:171], a[156:159], a[56:59], v[168:171]
  ds_read_b64_tr_b16 a[138:139], v2 offset:46624
  v_mul_f32 v23, v16, v41
  v_mul_f32 v24, v16, v42
  v_mul_f32 v25, v16, v43
  v_mfma_f32_16x16x32_bf16 v[168:171], a[152:155], a[40:43], v[168:171]
  v_exp_f32 v22, v22
  v_mul_f32 v148, v36, v148
  v_mfma_f32_16x16x32_bf16 v[164:167], a[152:155], a[36:39], v[164:167]
  ds_read_b64_tr_b16 a[140:141], v2 offset:50208
  v_exp_f32 v23, v23
  v_mul_f32 v149, v37, v149
  v_mfma_f32_16x16x32_bf16 v[164:167], a[156:159], a[52:55], v[164:167]
  v_exp_f32 v24, v24
  v_mul_f32 v150, v38, v150
  v_mfma_f32_16x16x32_bf16 v[160:163], a[156:159], a[48:51], v[160:163]
  ds_read_b64_tr_b16 a[142:143], v2 offset:53792
  v_exp_f32 v25, v25
  v_mul_f32 v151, v39, v151
  v_mfma_f32_16x16x32_bf16 v[160:163], a[152:155], a[32:35], v[160:163]
  s_waitcnt lgkmcnt(8)
  v_mul_f32 v148, v148, v26
  v_mul_f32 v149, v149, v27
  v_mul_f32 v150, v150, v28
  v_mul_f32 v151, v151, v29
  v_mfma_f32_16x16x32_bf16 v[48:51], a[160:163], a[64:67], v[48:51]
  ds_read_b64_tr_b16 a[144:145], v1 offset:28736
  v_cvt_pk_bf16_f32 v32, v144, v145
  v_cvt_pk_bf16_f32 v33, v146, v147
  v_mul_f32 v26, v19, v44
  v_mfma_f32_16x16x32_bf16 v[48:51], a[164:167], a[80:83], v[48:51]
  v_mul_f32 v27, v19, v45
  v_mul_f32 v28, v19, v46
  v_mul_f32 v29, v19, v47
  v_mfma_f32_16x16x32_bf16 v[52:55], a[164:167], a[84:87], v[52:55]
  s_mov_b32 s12, 3
  s_lshl_b32 s8, s12, 16
  s_add_u32 m0, s73, 114688
  ds_read_b64_tr_b16 a[146:147], v1 offset:32320
  v_mfma_f32_16x16x32_bf16 v[52:55], a[160:163], a[68:71], v[52:55]
  v_exp_f32 v26, v26
  v_fma_f32 v22, v22, v17, v17
  v_mfma_f32_16x16x32_bf16 v[56:59], a[160:163], a[72:75], v[56:59]
  ds_read_b64_tr_b16 a[148:149], v1 offset:35904
  v_exp_f32 v27, v27
  v_fma_f32 v23, v23, v17, v17
  v_mfma_f32_16x16x32_bf16 v[56:59], a[164:167], a[88:91], v[56:59]
  v_exp_f32 v28, v28
  v_fma_f32 v24, v24, v17, v17
  v_mfma_f32_16x16x32_bf16 v[60:63], a[164:167], a[92:95], v[60:63]
  buffer_load_dwordx4 v133, s[24:27], s8 offen offset:0 lds
  ds_read_b64_tr_b16 a[150:151], v1 offset:39488
  v_exp_f32 v29, v29
  v_mfma_f32_16x16x32_bf16 v[60:63], a[160:163], a[76:79], v[60:63]
  v_fma_f32 v25, v25, v17, v17
  v_cvt_pk_bf16_f32 v36, v148, v149
  v_cvt_pk_bf16_f32 v37, v150, v151
  v_mfma_f32_16x16x32_bf16 v[172:175], a[168:171], a[76:79], v[172:175]
  v_rcp_f32 v22, v22
  v_fma_f32 v26, v26, v20, v20
  v_mfma_f32_16x16x32_bf16 v[172:175], a[172:175], a[92:95], v[172:175]
  v_rcp_f32 v23, v23
  v_fma_f32 v27, v27, v20, v20
  v_mfma_f32_16x16x32_bf16 v[168:171], a[172:175], a[88:91], v[168:171]
  v_rcp_f32 v24, v24
  v_fma_f32 v28, v28, v20, v20
  v_mfma_f32_16x16x32_bf16 v[168:171], a[168:171], a[72:75], v[168:171]
  buffer_load_dwordx4 v134, s[24:27], s8 offen offset:1024 lds
  v_rcp_f32 v25, v25
  v_fma_f32 v29, v29, v20, v20
  v_mfma_f32_16x16x32_bf16 v[164:167], a[168:171], a[68:71], v[164:167]
  v_rcp_f32 v26, v26
  v_mul_f32 v152, v40, v152
  v_mfma_f32_16x16x32_bf16 v[164:167], a[172:175], a[84:87], v[164:167]
  v_rcp_f32 v27, v27
  v_mul_f32 v153, v41, v153
  v_mfma_f32_16x16x32_bf16 v[160:163], a[172:175], a[80:83], v[160:163]
  v_rcp_f32 v28, v28
  v_mul_f32 v154, v42, v154
  v_mfma_f32_16x16x32_bf16 v[160:163], a[168:171], a[64:67], v[160:163]
  s_waitcnt lgkmcnt(4)
  v_rcp_f32 v29, v29
  v_mul_f32 v155, v43, v155
  v_mul_f32 v152, v152, v22
  v_mfma_f32_16x16x32_bf16 v[48:51], a[128:131], a[96:99], v[48:51]
  ds_read_b128 a[24:27], v31 offset:512
  buffer_load_dwordx4 v135, s[24:27], s8 offen offset:2048 lds
  v_mul_f32 v153, v153, v23
  v_mul_f32 v154, v154, v24
  v_mfma_f32_16x16x32_bf16 v[48:51], a[132:135], a[112:115], v[48:51]
  ds_read_b64_tr_b16 a[152:153], v1 offset:43072
  v_mul_f32 v155, v155, v25
  v_mul_f32 v156, v44, v156
  v_mul_f32 v157, v45, v157
  v_mfma_f32_16x16x32_bf16 v[52:55], a[132:135], a[116:119], v[52:55]
  ds_read_b128 a[28:31], v31 offset:2560
  ds_read_b64_tr_b16 a[154:155], v1 offset:46656
  v_mul_f32 v158, v46, v158
  v_mul_f32 v159, v47, v159
  v_mfma_f32_16x16x32_bf16 v[52:55], a[128:131], a[100:103], v[52:55]
  v_cvt_pk_bf16_f32 v40, v152, v153
  v_cvt_pk_bf16_f32 v41, v154, v155
  v_mul_f32 v156, v156, v26
  v_mul_f32 v157, v157, v27
  v_mfma_f32_16x16x32_bf16 v[56:59], a[128:131], a[104:107], v[56:59]
  ds_read_b64_tr_b16 a[156:157], v1 offset:50240
  v_mul_f32 v158, v158, v28
  v_mul_f32 v159, v159, v29
  v_cvt_pk_bf16_f32 v44, v156, v157
  v_mfma_f32_16x16x32_bf16 v[56:59], a[132:135], a[120:123], v[56:59]
  buffer_load_dwordx4 v136, s[24:27], s8 offen offset:3072 lds
  v_cvt_pk_bf16_f32 v45, v158, v159
  v_mfma_f32_16x16x32_bf16 v[60:63], a[132:135], a[124:127], v[60:63]
  s_cmp_eq_u32 s52, 1
  s_cselect_b32 s13, 38, 10
  s_lshl_b32 s8, s13, 16
  s_add_u32 m0, s73, 131072
  ds_read_b64_tr_b16 a[158:159], v1 offset:53824
  v_mfma_f32_16x16x32_bf16 v[60:63], a[128:131], a[108:111], v[60:63]
  v_mfma_f32_16x16x32_bf16 v[172:175], a[136:139], a[108:111], v[172:175]
  ds_read_b64_tr_b16 a[160:161], v2 offset:64
CT18:
  s_add_u32 s94, s92, CT18-k3_main_kernel+3072
  s_addc_u32 s95, s93, 0
  v_mul_f32 v22, v10, v48
  v_mfma_f32_16x16x32_bf16 v[172:175], a[140:143], a[124:127], v[172:175]
  global_load_dword a252, v0, s[94:95]
  v_mul_f32 v23, v10, v49
  v_mul_f32 v24, v10, v50
  v_mul_f32 v25, v10, v51
  v_mfma_f32_16x16x32_bf16 v[168:171], a[140:143], a[120:123], v[168:171]
  ds_read_b64_tr_b16 a[162:163], v2 offset:3648
  v_exp_f32 v22, v22
  v_mul_f32 v26, v13, v52
  v_mfma_f32_16x16x32_bf16 v[168:171], a[136:139], a[104:107], v[168:171]
  buffer_load_dwordx4 v133, s[24:27], s8 offen offset:0 lds
  v_exp_f32 v23, v23
  v_mul_f32 v27, v13, v53
  v_mfma_f32_16x16x32_bf16 v[164:167], a[136:139], a[100:103], v[164:167]
  ds_read_b64_tr_b16 a[164:165], v2 offset:7232
  v_exp_f32 v24, v24
  v_mul_f32 v28, v13, v54
  v_mfma_f32_16x16x32_bf16 v[164:167], a[140:143], a[116:119], v[164:167]
  v_exp_f32 v25, v25
  v_mul_f32 v29, v13, v55
  v_mfma_f32_16x16x32_bf16 v[160:163], a[140:143], a[112:115], v[160:163]
  ds_read_b64_tr_b16 a[166:167], v2 offset:10816
  v_exp_f32 v26, v26
  v_fma_f32 v22, v22, v11, v11
  v_mfma_f32_16x16x32_bf16 v[160:163], a[136:139], a[96:99], v[160:163]
  s_waitcnt lgkmcnt(4)
  buffer_load_dwordx4 v134, s[24:27], s8 offen offset:1024 lds
  v_exp_f32 v27, v27
  v_fma_f32 v23, v23, v11, v11
  v_mfma_f32_16x16x32_bf16 v[64:67], a[144:147], a[32:35], v[64:67]
  ds_read_b64_tr_b16 a[168:169], v2 offset:14400
  v_exp_f32 v28, v28
  v_fma_f32 v24, v24, v11, v11
  v_mfma_f32_16x16x32_bf16 v[64:67], a[148:151], a[48:51], v[64:67]
  v_exp_f32 v29, v29
  v_fma_f32 v25, v25, v11, v11
  v_mfma_f32_16x16x32_bf16 v[68:71], a[148:151], a[52:55], v[68:71]
  ds_read_b64_tr_b16 a[170:171], v2 offset:17984
  v_rcp_f32 v22, v22
  v_fma_f32 v26, v26, v14, v14
  v_mfma_f32_16x16x32_bf16 v[68:71], a[144:147], a[36:39], v[68:71]
  v_rcp_f32 v23, v23
  v_fma_f32 v27, v27, v14, v14
  v_mfma_f32_16x16x32_bf16 v[72:75], a[144:147], a[40:43], v[72:75]
  buffer_load_dwordx4 v135, s[24:27], s8 offen offset:2048 lds
  ds_read_b64_tr_b16 a[172:173], v2 offset:21568
  v_rcp_f32 v24, v24
  v_mfma_f32_16x16x32_bf16 v[72:75], a[148:151], a[56:59], v[72:75]
  v_fma_f32 v28, v28, v14, v14
  v_rcp_f32 v25, v25
  v_fma_f32 v29, v29, v14, v14
  v_mfma_f32_16x16x32_bf16 v[76:79], a[148:151], a[60:63], v[76:79]
  ds_read_b64_tr_b16 a[174:175], v2 offset:25152
  v_rcp_f32 v26, v26
  v_mul_f32 v160, v48, v160
  v_mfma_f32_16x16x32_bf16 v[76:79], a[144:147], a[44:47], v[76:79]
  s_waitcnt lgkmcnt(11)
  v_rcp_f32 v27, v27
  v_mul_f32 v161, v49, v161
  v_mfma_f32_16x16x32_bf16 v[64:67], a[24:27], a[0:3], v[64:67]
  ds_read_b64_tr_b16 a[128:129], v2 offset:28736
  v_rcp_f32 v28, v28
  v_mul_f32 v162, v50, v162
  v_mfma_f32_16x16x32_bf16 v[68:71], a[24:27], a[4:7], v[68:71]
  buffer_load_dwordx4 v136, s[24:27], s8 offen offset:3072 lds
  v_rcp_f32 v29, v29
  v_mul_f32 v163, v51, v163
  v_mfma_f32_16x16x32_bf16 v[72:75], a[24:27], a[8:11], v[72:75]
  s_cmp_eq_u32 s52, 2
  s_cselect_b32 s14, 45, 17
  s_lshl_b32 s8, s14, 16
  s_add_u32 m0, s73, 0
  ds_read_b64_tr_b16 a[130:131], v2 offset:32320
  v_mfma_f32_16x16x32_bf16 v[76:79], a[24:27], a[12:15], v[76:79]
  v_mul_f32 v160, v160, v22
  v_mul_f32 v161, v161, v23
  v_mul_f32 v162, v162, v24
  v_mul_f32 v163, v163, v25
  v_mfma_f32_16x16x32_bf16 v[176:179], a[28:31], a[0:3], v[176:179]
  ds_read_b64_tr_b16 a[132:133], v2 offset:35904
  v_mul_f32 v22, v16, v56
  v_mul_f32 v23, v16, v57
  v_mul_f32 v24, v16, v58
  v_mfma_f32_16x16x32_bf16 v[180:183], a[28:31], a[4:7], v[180:183]
  v_mul_f32 v25, v16, v59
  v_exp_f32 v22, v22
  v_mul_f32 v164, v52, v164
  v_mfma_f32_16x16x32_bf16 v[184:187], a[28:31], a[8:11], v[184:187]
  buffer_load_dwordx4 v133, s[24:27], s8 offen offset:0 lds
  ds_read_b64_tr_b16 a[134:135], v2 offset:39488
  v_exp_f32 v23, v23
  v_mfma_f32_16x16x32_bf16 v[188:191], a[28:31], a[12:15], v[188:191]
  v_mul_f32 v165, v53, v165
  v_exp_f32 v24, v24
  v_mul_f32 v166, v54, v166
  v_mfma_f32_16x16x32_bf16 v[188:191], a[152:155], a[44:47], v[188:191]
  ds_read_b64_tr_b16 a[136:137], v2 offset:43072
  v_exp_f32 v25, v25
  v_mul_f32 v167, v55, v167
  v_mfma_f32_16x16x32_bf16 v[188:191], a[156:159], a[60:63], v[188:191]
  v_mul_f32 v164, v164, v26
  v_mul_f32 v165, v165, v27
  v_mul_f32 v166, v166, v28
  v_mul_f32 v167, v167, v29
  v_mfma_f32_16x16x32_bf16 v[184:187], a[156:159], a[56:59], v[184:187]
  ds_read_b64_tr_b16 a[138:139], v2 offset:46656
  v_cvt_pk_bf16_f32 v34, v160, v161
  v_cvt_pk_bf16_f32 v35, v162, v163
  v_mfma_f32_16x16x32_bf16 v[184:187], a[152:155], a[40:43], v[184:187]
  buffer_load_dwordx4 v134, s[24:27], s8 offen offset:1024 lds
  v_mfma_f32_16x16x32_bf16 v[180:183], a[152:155], a[36:39], v[180:183]
  ds_read_b64_tr_b16 a[140:141], v2 offset:50240
  v_mfma_f32_16x16x32_bf16 v[180:183], a[156:159], a[52:55], v[180:183]
  buffer_store_dwordx4 v[32:35], v0, s[36:39], s21 offen offset:0 sc1
  v_mul_f32 v26, v19, v60
  v_mul_f32 v27, v19, v61
  v_mul_f32 v28, v19, v62
  v_mfma_f32_16x16x32_bf16 v[176:179], a[156:159], a[48:51], v[176:179]
  ds_read_b64_tr_b16 a[142:143], v2 offset:53824
  v_mul_f32 v29, v19, v63
  v_exp_f32 v26, v26
  v_mfma_f32_16x16x32_bf16 v[176:179], a[152:155], a[32:35], v[176:179]
  s_waitcnt lgkmcnt(8)
  v_fma_f32 v22, v22, v17, v17
  v_exp_f32 v27, v27
  v_fma_f32 v23, v23, v17, v17
  v_mfma_f32_16x16x32_bf16 v[64:67], a[160:163], a[64:67], v[64:67]
  buffer_load_dwordx4 v135, s[24:27], s8 offen offset:2048 lds
  ds_read_b64_tr_b16 a[144:145], v1 offset:28768
  v_exp_f32 v28, v28
  v_mfma_f32_16x16x32_bf16 v[64:67], a[164:167], a[80:83], v[64:67]
  v_fma_f32 v24, v24, v17, v17
  v_exp_f32 v29, v29
  v_fma_f32 v25, v25, v17, v17
  v_mfma_f32_16x16x32_bf16 v[68:71], a[164:167], a[84:87], v[68:71]
  ds_read_b64_tr_b16 a[146:147], v1 offset:32352
  v_cvt_pk_bf16_f32 v38, v164, v165
  v_cvt_pk_bf16_f32 v39, v166, v167
  v_mfma_f32_16x16x32_bf16 v[68:71], a[160:163], a[68:71], v[68:71]
  buffer_store_dwordx4 v[36:39], v0, s[36:39], s21 offen offset:1024 sc1
  v_rcp_f32 v22, v22
  v_fma_f32 v26, v26, v20, v20
  v_mfma_f32_16x16x32_bf16 v[72:75], a[160:163], a[72:75], v[72:75]
  ds_read_b64_tr_b16 a[148:149], v1 offset:35936
  v_rcp_f32 v23, v23
  v_fma_f32 v27, v27, v20, v20
  v_mfma_f32_16x16x32_bf16 v[72:75], a[164:167], a[88:91], v[72:75]
  buffer_load_dwordx4 v136, s[24:27], s8 offen offset:3072 lds
  v_rcp_f32 v24, v24
  v_fma_f32 v28, v28, v20, v20
  v_mfma_f32_16x16x32_bf16 v[76:79], a[164:167], a[92:95], v[76:79]
  ds_read_b64_tr_b16 a[150:151], v1 offset:39520
  v_rcp_f32 v25, v25
  v_fma_f32 v29, v29, v20, v20
  v_mfma_f32_16x16x32_bf16 v[76:79], a[160:163], a[76:79], v[76:79]
  v_rcp_f32 v26, v26
  v_mul_f32 v168, v56, v168
  v_mfma_f32_16x16x32_bf16 v[188:191], a[168:171], a[76:79], v[188:191]
  v_rcp_f32 v27, v27
  v_mul_f32 v169, v57, v169
  v_mfma_f32_16x16x32_bf16 v[188:191], a[172:175], a[92:95], v[188:191]
  v_rcp_f32 v28, v28
  v_mul_f32 v170, v58, v170
  v_mfma_f32_16x16x32_bf16 v[184:187], a[172:175], a[88:91], v[184:187]
  v_rcp_f32 v29, v29
  v_mul_f32 v171, v59, v171
  v_mul_f32 v168, v168, v22
  v_mfma_f32_16x16x32_bf16 v[184:187], a[168:171], a[72:75], v[184:187]
  v_mul_f32 v169, v169, v23
  v_mul_f32 v170, v170, v24
  v_mul_f32 v171, v171, v25
  v_mul_f32 v172, v60, v172
  v_mfma_f32_16x16x32_bf16 v[180:183], a[168:171], a[68:71], v[180:183]
  v_mul_f32 v173, v61, v173
  v_mul_f32 v174, v62, v174
  v_mul_f32 v175, v63, v175
  v_cvt_pk_bf16_f32 v42, v168, v169
  v_mfma_f32_16x16x32_bf16 v[180:183], a[172:175], a[84:87], v[180:183]
  v_cvt_pk_bf16_f32 v43, v170, v171
  v_mfma_f32_16x16x32_bf16 v[176:179], a[172:175], a[80:83], v[176:179]
  buffer_store_dwordx4 v[40:43], v0, s[36:39], s22 offen offset:0 sc1
  v_mul_f32 v172, v172, v26
  v_mul_f32 v173, v173, v27
  v_mul_f32 v174, v174, v28
  v_mfma_f32_16x16x32_bf16 v[176:179], a[168:171], a[64:67], v[176:179]
  s_waitcnt lgkmcnt(4)
  v_mul_f32 v175, v175, v29
  v_cvt_pk_bf16_f32 v46, v172, v173
  v_cvt_pk_bf16_f32 v47, v174, v175
  v_mfma_f32_16x16x32_bf16 v[64:67], a[128:131], a[96:99], v[64:67]
  ds_read_b128 a[16:19], v31 offset:768
  ds_read_b64_tr_b16 a[152:153], v1 offset:43104
  v_mfma_f32_16x16x32_bf16 v[64:67], a[132:135], a[112:115], v[64:67]
  buffer_store_dwordx4 v[44:47], v0, s[36:39], s22 offen offset:1024 sc1
  s_add_u32 s21, s21, 2048
  s_add_u32 s22, s22, 2048
  v_mfma_f32_16x16x32_bf16 v[68:71], a[132:135], a[116:119], v[68:71]
  ds_read_b128 a[20:23], v31 offset:2816
  ds_read_b64_tr_b16 a[154:155], v1 offset:46688
  v_mfma_f32_16x16x32_bf16 v[68:71], a[128:131], a[100:103], v[68:71]
  v_mfma_f32_16x16x32_bf16 v[72:75], a[128:131], a[104:107], v[72:75]
  ds_read_b64_tr_b16 a[156:157], v1 offset:50272
  v_mfma_f32_16x16x32_bf16 v[72:75], a[132:135], a[120:123], v[72:75]
  v_mfma_f32_16x16x32_bf16 v[76:79], a[132:135], a[124:127], v[76:79]
  ds_read_b64_tr_b16 a[158:159], v1 offset:53856
  v_mfma_f32_16x16x32_bf16 v[76:79], a[128:131], a[108:111], v[76:79]
  v_mfma_f32_16x16x32_bf16 v[188:191], a[136:139], a[108:111], v[188:191]
  ds_read_b64_tr_b16 a[160:161], v2 offset:96
  v_mul_f32 v22, v10, v64
  v_mul_f32 v23, v10, v65
  v_mul_f32 v24, v10, v66
  v_mfma_f32_16x16x32_bf16 v[188:191], a[140:143], a[124:127], v[188:191]
  v_mul_f32 v25, v10, v67
  v_exp_f32 v22, v22
  v_mul_f32 v26, v13, v68
  v_mfma_f32_16x16x32_bf16 v[184:187], a[140:143], a[120:123], v[184:187]
  ds_read_b64_tr_b16 a[162:163], v2 offset:3680
  v_exp_f32 v23, v23
  v_mul_f32 v27, v13, v69
  v_mfma_f32_16x16x32_bf16 v[184:187], a[136:139], a[104:107], v[184:187]
  v_exp_f32 v24, v24
  v_mul_f32 v28, v13, v70
  v_mfma_f32_16x16x32_bf16 v[180:183], a[136:139], a[100:103], v[180:183]
  ds_read_b64_tr_b16 a[164:165], v2 offset:7264
  v_exp_f32 v25, v25
  v_mul_f32 v29, v13, v71
  v_mfma_f32_16x16x32_bf16 v[180:183], a[140:143], a[116:119], v[180:183]
  v_exp_f32 v26, v26
  v_fma_f32 v22, v22, v11, v11
  v_mfma_f32_16x16x32_bf16 v[176:179], a[140:143], a[112:115], v[176:179]
  ds_read_b64_tr_b16 a[166:167], v2 offset:10848
  v_exp_f32 v27, v27
  v_fma_f32 v23, v23, v11, v11
  v_mfma_f32_16x16x32_bf16 v[176:179], a[136:139], a[96:99], v[176:179]
  s_waitcnt lgkmcnt(4)
  v_exp_f32 v28, v28
  v_fma_f32 v24, v24, v11, v11
  v_mfma_f32_16x16x32_bf16 v[80:83], a[144:147], a[32:35], v[80:83]
  ds_read_b64_tr_b16 a[168:169], v2 offset:14432
  v_exp_f32 v29, v29
  v_fma_f32 v25, v25, v11, v11
  v_mfma_f32_16x16x32_bf16 v[80:83], a[148:151], a[48:51], v[80:83]
  v_rcp_f32 v22, v22
  v_fma_f32 v26, v26, v14, v14
  v_mfma_f32_16x16x32_bf16 v[84:87], a[148:151], a[52:55], v[84:87]
  ds_read_b64_tr_b16 a[170:171], v2 offset:18016
  v_rcp_f32 v23, v23
  v_fma_f32 v27, v27, v14, v14
  v_mfma_f32_16x16x32_bf16 v[84:87], a[144:147], a[36:39], v[84:87]
  v_rcp_f32 v24, v24
  v_fma_f32 v28, v28, v14, v14
  v_mfma_f32_16x16x32_bf16 v[88:91], a[144:147], a[40:43], v[88:91]
  ds_read_b64_tr_b16 a[172:173], v2 offset:21600
  v_rcp_f32 v25, v25
  v_fma_f32 v29, v29, v14, v14
  v_mfma_f32_16x16x32_bf16 v[88:91], a[148:151], a[56:59], v[88:91]
  v_rcp_f32 v26, v26
  v_mul_f32 v176, v64, v176
  v_mfma_f32_16x16x32_bf16 v[92:95], a[148:151], a[60:63], v[92:95]
  ds_read_b64_tr_b16 a[174:175], v2 offset:25184
  v_rcp_f32 v27, v27
  v_mul_f32 v177, v65, v177
  v_mfma_f32_16x16x32_bf16 v[92:95], a[144:147], a[44:47], v[92:95]
  s_waitcnt lgkmcnt(11)
  v_rcp_f32 v28, v28
  v_mul_f32 v178, v66, v178
  v_mfma_f32_16x16x32_bf16 v[80:83], a[16:19], a[0:3], v[80:83]
  ds_read_b64_tr_b16 a[128:129], v2 offset:28768
  v_rcp_f32 v29, v29
  v_mul_f32 v179, v67, v179
  v_mfma_f32_16x16x32_bf16 v[84:87], a[16:19], a[4:7], v[84:87]
  v_mul_f32 v176, v176, v22
  v_mul_f32 v177, v177, v23
  v_mul_f32 v178, v178, v24
  v_mul_f32 v179, v179, v25
  v_mfma_f32_16x16x32_bf16 v[88:91], a[16:19], a[8:11], v[88:91]
  ds_read_b64_tr_b16 a[130:131], v2 offset:32352
  v_mul_f32 v22, v16, v72
  v_mul_f32 v23, v16, v73
  v_mul_f32 v24, v16, v74
  v_mfma_f32_16x16x32_bf16 v[92:95], a[16:19], a[12:15], v[92:95]
  v_mul_f32 v25, v16, v75
  v_exp_f32 v22, v22
  v_mul_f32 v180, v68, v180
  v_mfma_f32_16x16x32_bf16 v[192:195], a[20:23], a[0:3], v[192:195]
  ds_read_b64_tr_b16 a[132:133], v2 offset:35936
  v_exp_f32 v23, v23
  v_mul_f32 v181, v69, v181
  v_mfma_f32_16x16x32_bf16 v[196:199], a[20:23], a[4:7], v[196:199]
  v_exp_f32 v24, v24
  v_mul_f32 v182, v70, v182
  v_mfma_f32_16x16x32_bf16 v[200:203], a[20:23], a[8:11], v[200:203]
  ds_read_b64_tr_b16 a[134:135], v2 offset:39520
  v_exp_f32 v25, v25
  v_mul_f32 v183, v71, v183
  v_mfma_f32_16x16x32_bf16 v[204:207], a[20:23], a[12:15], v[204:207]
  v_mul_f32 v180, v180, v26
  v_mul_f32 v181, v181, v27
  v_mul_f32 v182, v182, v28
  v_mul_f32 v183, v183, v29
  v_mfma_f32_16x16x32_bf16 v[204:207], a[152:155], a[44:47], v[204:207]
  ds_read_b64_tr_b16 a[136:137], v2 offset:43104
CT19:
  s_add_u32 s94, s92, CT19-k3_main_kernel+3072
  s_addc_u32 s95, s93, 0
  v_cvt_pk_bf16_f32 v64, v176, v177
  v_mfma_f32_16x16x32_bf16 v[204:207], a[156:159], a[60:63], v[204:207]
  global_load_dword a252, v0, s[94:95]
  v_cvt_pk_bf16_f32 v65, v178, v179
  v_mul_f32 v26, v19, v76
  v_mul_f32 v27, v19, v77
  v_mfma_f32_16x16x32_bf16 v[200:203], a[156:159], a[56:59], v[200:203]
  ds_read_b64_tr_b16 a[138:139], v2 offset:46688
  v_mul_f32 v28, v19, v78
  v_mul_f32 v29, v19, v79
  v_mfma_f32_16x16x32_bf16 v[200:203], a[152:155], a[40:43], v[200:203]
  v_exp_f32 v26, v26
  v_fma_f32 v22, v22, v17, v17
  v_mfma_f32_16x16x32_bf16 v[196:199], a[152:155], a[36:39], v[196:199]
  ds_read_b64_tr_b16 a[140:141], v2 offset:50272
  v_exp_f32 v27, v27
  v_fma_f32 v23, v23, v17, v17
  v_mfma_f32_16x16x32_bf16 v[196:199], a[156:159], a[52:55], v[196:199]
  v_exp_f32 v28, v28
  v_fma_f32 v24, v24, v17, v17
  v_mfma_f32_16x16x32_bf16 v[192:195], a[156:159], a[48:51], v[192:195]
  ds_read_b64_tr_b16 a[142:143], v2 offset:53856
  v_exp_f32 v29, v29
  v_fma_f32 v25, v25, v17, v17
  v_mfma_f32_16x16x32_bf16 v[192:195], a[152:155], a[32:35], v[192:195]
  s_waitcnt lgkmcnt(8)
  v_cvt_pk_bf16_f32 v68, v180, v181
  v_cvt_pk_bf16_f32 v69, v182, v183
  v_rcp_f32 v22, v22
  v_mfma_f32_16x16x32_bf16 v[80:83], a[160:163], a[64:67], v[80:83]
  ds_read_b64_tr_b16 a[144:145], v1 offset:28800
  v_fma_f32 v26, v26, v20, v20
  v_rcp_f32 v23, v23
  v_mfma_f32_16x16x32_bf16 v[80:83], a[164:167], a[80:83], v[80:83]
  v_fma_f32 v27, v27, v20, v20
  v_rcp_f32 v24, v24
  v_fma_f32 v28, v28, v20, v20
  v_mfma_f32_16x16x32_bf16 v[84:87], a[164:167], a[84:87], v[84:87]
  ds_read_b64_tr_b16 a[146:147], v1 offset:32384
  v_rcp_f32 v25, v25
  v_fma_f32 v29, v29, v20, v20
  v_mfma_f32_16x16x32_bf16 v[84:87], a[160:163], a[68:71], v[84:87]
  v_rcp_f32 v26, v26
  v_mul_f32 v184, v72, v184
  v_mfma_f32_16x16x32_bf16 v[88:91], a[160:163], a[72:75], v[88:91]
  ds_read_b64_tr_b16 a[148:149], v1 offset:35968
  v_rcp_f32 v27, v27
  v_mul_f32 v185, v73, v185
  v_mfma_f32_16x16x32_bf16 v[88:91], a[164:167], a[88:91], v[88:91]
  v_rcp_f32 v28, v28
  v_mul_f32 v186, v74, v186
  v_mfma_f32_16x16x32_bf16 v[92:95], a[164:167], a[92:95], v[92:95]
  ds_read_b64_tr_b16 a[150:151], v1 offset:39552
  v_rcp_f32 v29, v29
  v_mul_f32 v187, v75, v187
  v_mfma_f32_16x16x32_bf16 v[92:95], a[160:163], a[76:79], v[92:95]
  s_waitcnt vmcnt(1)
  s_barrier
  v_mul_f32 v184, v184, v22
  v_mul_f32 v185, v185, v23
  v_mul_f32 v186, v186, v24
  v_mfma_f32_16x16x32_bf16 v[204:207], a[168:171], a[76:79], v[204:207]
  s_mov_b64 exec, 1
  buffer_store_dword v254, v0, s[36:39], s45 offen sc1
  s_mov_b64 exec, -1
  s_lshl_b32 s45, s2, 7
  v_mfma_f32_16x16x32_bf16 v[204:207], a[172:175], a[92:95], v[204:207]
  s_add_u32 s45, s45, 5439488
  s_cmp_eq_u32 s44, 0
  s_cselect_b32 s45, s45, 1073741824
  v_mul_f32 v187, v187, v25
  v_mul_f32 v188, v76, v188
  v_mfma_f32_16x16x32_bf16 v[200:203], a[172:175], a[88:91], v[200:203]
  v_mul_f32 v189, v77, v189
  v_mul_f32 v190, v78, v190
  v_mul_f32 v191, v79, v191
  v_cvt_pk_bf16_f32 v72, v184, v185
  v_mfma_f32_16x16x32_bf16 v[200:203], a[168:171], a[72:75], v[200:203]
  v_cvt_pk_bf16_f32 v73, v186, v187
  v_mul_f32 v188, v188, v26
  v_mul_f32 v189, v189, v27
  v_mul_f32 v190, v190, v28
  v_mfma_f32_16x16x32_bf16 v[196:199], a[168:171], a[68:71], v[196:199]
  v_mul_f32 v191, v191, v29
  v_cvt_pk_bf16_f32 v76, v188, v189
  v_cvt_pk_bf16_f32 v77, v190, v191
  v_mfma_f32_16x16x32_bf16 v[196:199], a[172:175], a[84:87], v[196:199]
  v_mfma_f32_16x16x32_bf16 v[192:195], a[172:175], a[80:83], v[192:195]
  v_mfma_f32_16x16x32_bf16 v[192:195], a[168:171], a[64:67], v[192:195]
  s_waitcnt lgkmcnt(4)
  v_mfma_f32_16x16x32_bf16 v[80:83], a[128:131], a[96:99], v[80:83]
  ds_read_b128 a[24:27], v31 offset:1024
  ds_read_b64_tr_b16 a[152:153], v1 offset:43136
  v_mfma_f32_16x16x32_bf16 v[80:83], a[132:135], a[112:115], v[80:83]
  v_mfma_f32_16x16x32_bf16 v[84:87], a[132:135], a[116:119], v[84:87]
  ds_read_b128 a[28:31], v31 offset:3072
  ds_read_b64_tr_b16 a[154:155], v1 offset:46720
  v_mfma_f32_16x16x32_bf16 v[84:87], a[128:131], a[100:103], v[84:87]
  v_mfma_f32_16x16x32_bf16 v[88:91], a[128:131], a[104:107], v[88:91]
  ds_read_b64_tr_b16 a[156:157], v1 offset:50304
  v_mfma_f32_16x16x32_bf16 v[88:91], a[132:135], a[120:123], v[88:91]
  v_mfma_f32_16x16x32_bf16 v[92:95], a[132:135], a[124:127], v[92:95]
  ds_read_b64_tr_b16 a[158:159], v1 offset:53888
  v_mfma_f32_16x16x32_bf16 v[92:95], a[128:131], a[108:111], v[92:95]
  v_mfma_f32_16x16x32_bf16 v[204:207], a[136:139], a[108:111], v[204:207]
  ds_read_b64_tr_b16 a[160:161], v2 offset:128
  v_mul_f32 v22, v10, v80
  v_mul_f32 v23, v10, v81
  v_mul_f32 v24, v10, v82
  v_mfma_f32_16x16x32_bf16 v[204:207], a[140:143], a[124:127], v[204:207]
  v_mul_f32 v25, v10, v83
  v_exp_f32 v22, v22
  v_mul_f32 v26, v13, v84
  v_mfma_f32_16x16x32_bf16 v[200:203], a[140:143], a[120:123], v[200:203]
  ds_read_b64_tr_b16 a[162:163], v2 offset:3712
  v_exp_f32 v23, v23
  v_mul_f32 v27, v13, v85
  v_mfma_f32_16x16x32_bf16 v[200:203], a[136:139], a[104:107], v[200:203]
  v_exp_f32 v24, v24
  v_mul_f32 v28, v13, v86
  v_mfma_f32_16x16x32_bf16 v[196:199], a[136:139], a[100:103], v[196:199]
  ds_read_b64_tr_b16 a[164:165], v2 offset:7296
  v_exp_f32 v25, v25
  v_mul_f32 v29, v13, v87
  v_mfma_f32_16x16x32_bf16 v[196:199], a[140:143], a[116:119], v[196:199]
  v_exp_f32 v26, v26
  v_fma_f32 v22, v22, v11, v11
  v_mfma_f32_16x16x32_bf16 v[192:195], a[140:143], a[112:115], v[192:195]
  ds_read_b64_tr_b16 a[166:167], v2 offset:10880
  v_exp_f32 v27, v27
  v_fma_f32 v23, v23, v11, v11
  v_mfma_f32_16x16x32_bf16 v[192:195], a[136:139], a[96:99], v[192:195]
  s_waitcnt lgkmcnt(4)
  v_exp_f32 v28, v28
  v_fma_f32 v24, v24, v11, v11
  v_mfma_f32_16x16x32_bf16 v[96:99], a[144:147], a[32:35], v[96:99]
  ds_read_b64_tr_b16 a[168:169], v2 offset:14464
  v_exp_f32 v29, v29
  v_fma_f32 v25, v25, v11, v11
  v_mfma_f32_16x16x32_bf16 v[96:99], a[148:151], a[48:51], v[96:99]
  v_rcp_f32 v22, v22
  v_fma_f32 v26, v26, v14, v14
  v_mfma_f32_16x16x32_bf16 v[100:103], a[148:151], a[52:55], v[100:103]
  ds_read_b64_tr_b16 a[170:171], v2 offset:18048
  v_rcp_f32 v23, v23
  v_fma_f32 v27, v27, v14, v14
  v_mfma_f32_16x16x32_bf16 v[100:103], a[144:147], a[36:39], v[100:103]
  v_rcp_f32 v24, v24
  v_fma_f32 v28, v28, v14, v14
  v_mfma_f32_16x16x32_bf16 v[104:107], a[144:147], a[40:43], v[104:107]
  ds_read_b64_tr_b16 a[172:173], v2 offset:21632
  v_rcp_f32 v25, v25
  v_fma_f32 v29, v29, v14, v14
  v_mfma_f32_16x16x32_bf16 v[104:107], a[148:151], a[56:59], v[104:107]
  v_rcp_f32 v26, v26
  v_mul_f32 v192, v80, v192
  v_mfma_f32_16x16x32_bf16 v[108:111], a[148:151], a[60:63], v[108:111]
  ds_read_b64_tr_b16 a[174:175], v2 offset:25216
  v_rcp_f32 v27, v27
  v_mul_f32 v193, v81, v193
  v_mfma_f32_16x16x32_bf16 v[108:111], a[144:147], a[44:47], v[108:111]
  s_waitcnt lgkmcnt(11)
  v_rcp_f32 v28, v28
  v_mul_f32 v194, v82, v194
  v_mfma_f32_16x16x32_bf16 v[96:99], a[24:27], a[0:3], v[96:99]
  ds_read_b64_tr_b16 a[128:129], v2 offset:28800
  v_rcp_f32 v29, v29
  v_mul_f32 v195, v83, v195
  v_mfma_f32_16x16x32_bf16 v[100:103], a[24:27], a[4:7], v[100:103]
  v_mul_f32 v192, v192, v22
  v_mul_f32 v193, v193, v23
  v_mul_f32 v194, v194, v24
  v_mul_f32 v195, v195, v25
  v_mfma_f32_16x16x32_bf16 v[104:107], a[24:27], a[8:11], v[104:107]
  ds_read_b64_tr_b16 a[130:131], v2 offset:32384
  v_mul_f32 v22, v16, v88
  v_mul_f32 v23, v16, v89
  v_mul_f32 v24, v16, v90
  v_mfma_f32_16x16x32_bf16 v[108:111], a[24:27], a[12:15], v[108:111]
  v_mul_f32 v25, v16, v91
  v_exp_f32 v22, v22
  v_mul_f32 v196, v84, v196
  v_mfma_f32_16x16x32_bf16 v[208:211], a[28:31], a[0:3], v[208:211]
  ds_read_b64_tr_b16 a[132:133], v2 offset:35968
  v_exp_f32 v23, v23
  v_mul_f32 v197, v85, v197
  v_mfma_f32_16x16x32_bf16 v[212:215], a[28:31], a[4:7], v[212:215]
  v_exp_f32 v24, v24
  v_mul_f32 v198, v86, v198
  v_mfma_f32_16x16x32_bf16 v[216:219], a[28:31], a[8:11], v[216:219]
  ds_read_b64_tr_b16 a[134:135], v2 offset:39552
  v_exp_f32 v25, v25
  v_mul_f32 v199, v87, v199
  v_mfma_f32_16x16x32_bf16 v[220:223], a[28:31], a[12:15], v[220:223]
  v_mul_f32 v196, v196, v26
  v_mul_f32 v197, v197, v27
  v_mul_f32 v198, v198, v28
  v_mul_f32 v199, v199, v29
  v_mfma_f32_16x16x32_bf16 v[220:223], a[152:155], a[44:47], v[220:223]
  ds_read_b64_tr_b16 a[136:137], v2 offset:43136
  v_cvt_pk_bf16_f32 v66, v192, v193
  v_cvt_pk_bf16_f32 v67, v194, v195
  v_mfma_f32_16x16x32_bf16 v[220:223], a[156:159], a[60:63], v[220:223]
  buffer_store_dwordx4 v[64:67], v0, s[36:39], s21 offen offset:0 sc1
  v_mul_f32 v26, v19, v92
  v_mul_f32 v27, v19, v93
  v_mul_f32 v28, v19, v94
  v_mfma_f32_16x16x32_bf16 v[216:219], a[156:159], a[56:59], v[216:219]
  ds_read_b64_tr_b16 a[138:139], v2 offset:46720
  v_mul_f32 v29, v19, v95
  v_exp_f32 v26, v26
  v_mfma_f32_16x16x32_bf16 v[216:219], a[152:155], a[40:43], v[216:219]
  v_fma_f32 v22, v22, v17, v17
  v_exp_f32 v27, v27
  v_fma_f32 v23, v23, v17, v17
  v_mfma_f32_16x16x32_bf16 v[212:215], a[152:155], a[36:39], v[212:215]
  ds_read_b64_tr_b16 a[140:141], v2 offset:50304
  v_exp_f32 v28, v28
  v_fma_f32 v24, v24, v17, v17
  v_mfma_f32_16x16x32_bf16 v[212:215], a[156:159], a[52:55], v[212:215]
  v_exp_f32 v29, v29
  v_fma_f32 v25, v25, v17, v17
  v_cvt_pk_bf16_f32 v70, v196, v197
  v_mfma_f32_16x16x32_bf16 v[208:211], a[156:159], a[48:51], v[208:211]
  ds_read_b64_tr_b16 a[142:143], v2 offset:53888
  v_cvt_pk_bf16_f32 v71, v198, v199
  v_mfma_f32_16x16x32_bf16 v[208:211], a[152:155], a[32:35], v[208:211]
  s_waitcnt lgkmcnt(8)
  buffer_store_dwordx4 v[68:71], v0, s[36:39], s21 offen offset:1024 sc1
  v_rcp_f32 v22, v22
  v_fma_f32 v26, v26, v20, v20
  v_mfma_f32_16x16x32_bf16 v[96:99], a[160:163], a[64:67], v[96:99]
  ds_read_b64_tr_b16 a[144:145], v1 offset:28832
  v_rcp_f32 v23, v23
  v_fma_f32 v27, v27, v20, v20
  v_mfma_f32_16x16x32_bf16 v[96:99], a[164:167], a[80:83], v[96:99]
  v_rcp_f32 v24, v24
  v_fma_f32 v28, v28, v20, v20
  v_mfma_f32_16x16x32_bf16 v[100:103], a[164:167], a[84:87], v[100:103]
  ds_read_b64_tr_b16 a[146:147], v1 offset:32416
  v_rcp_f32 v25, v25
  v_fma_f32 v29, v29, v20, v20
  v_mfma_f32_16x16x32_bf16 v[100:103], a[160:163], a[68:71], v[100:103]
  v_rcp_f32 v26, v26
  v_mul_f32 v200, v88, v200
  v_mfma_f32_16x16x32_bf16 v[104:107], a[160:163], a[72:75], v[104:107]
  ds_read_b64_tr_b16 a[148:149], v1 offset:36000
  v_rcp_f32 v27, v27
  v_mul_f32 v201, v89, v201
  v_mfma_f32_16x16x32_bf16 v[104:107], a[164:167], a[88:91], v[104:107]
  v_rcp_f32 v28, v28
  v_mul_f32 v202, v90, v202
  v_mfma_f32_16x16x32_bf16 v[108:111], a[164:167], a[92:95], v[108:111]
  ds_read_b64_tr_b16 a[150:151], v1 offset:39584
  v_rcp_f32 v29, v29
  v_mul_f32 v203, v91, v203
  v_mfma_f32_16x16x32_bf16 v[108:111], a[160:163], a[76:79], v[108:111]
  v_mul_f32 v200, v200, v22
  v_mul_f32 v201, v201, v23
  v_mul_f32 v202, v202, v24
  v_mul_f32 v203, v203, v25
  v_mfma_f32_16x16x32_bf16 v[220:223], a[168:171], a[76:79], v[220:223]
  v_mul_f32 v204, v92, v204
  v_mul_f32 v205, v93, v205
  v_mul_f32 v206, v94, v206
  v_mul_f32 v207, v95, v207
  v_mfma_f32_16x16x32_bf16 v[220:223], a[172:175], a[92:95], v[220:223]
  v_cvt_pk_bf16_f32 v74, v200, v201
  v_cvt_pk_bf16_f32 v75, v202, v203
  v_mfma_f32_16x16x32_bf16 v[216:219], a[172:175], a[88:91], v[216:219]
  buffer_store_dwordx4 v[72:75], v0, s[36:39], s22 offen offset:0 sc1
  v_mul_f32 v204, v204, v26
  v_mul_f32 v205, v205, v27
  v_mul_f32 v206, v206, v28
  v_mfma_f32_16x16x32_bf16 v[216:219], a[168:171], a[72:75], v[216:219]
  v_mul_f32 v207, v207, v29
  v_cvt_pk_bf16_f32 v78, v204, v205
  v_cvt_pk_bf16_f32 v79, v206, v207
  v_mfma_f32_16x16x32_bf16 v[212:215], a[168:171], a[68:71], v[212:215]
  buffer_store_dwordx4 v[76:79], v0, s[36:39], s22 offen offset:1024 sc1
  s_add_u32 s21, s21, 2048
  s_add_u32 s22, s22, 2048
  v_mfma_f32_16x16x32_bf16 v[212:215], a[172:175], a[84:87], v[212:215]
  v_mfma_f32_16x16x32_bf16 v[208:211], a[172:175], a[80:83], v[208:211]
  v_mfma_f32_16x16x32_bf16 v[208:211], a[168:171], a[64:67], v[208:211]
  s_waitcnt lgkmcnt(4)
  v_mfma_f32_16x16x32_bf16 v[96:99], a[128:131], a[96:99], v[96:99]
  ds_read_b128 a[16:19], v31 offset:1280
  ds_read_b64_tr_b16 a[152:153], v1 offset:43168
  v_mfma_f32_16x16x32_bf16 v[96:99], a[132:135], a[112:115], v[96:99]
CT20:
  s_add_u32 s94, s92, CT20-k3_main_kernel+3072
  s_addc_u32 s95, s93, 0
  global_load_dword a252, v0, s[94:95]
  v_mfma_f32_16x16x32_bf16 v[100:103], a[132:135], a[116:119], v[100:103]
  ds_read_b128 a[20:23], v31 offset:3328
  ds_read_b64_tr_b16 a[154:155], v1 offset:46752
  v_mfma_f32_16x16x32_bf16 v[100:103], a[128:131], a[100:103], v[100:103]
  v_mfma_f32_16x16x32_bf16 v[104:107], a[128:131], a[104:107], v[104:107]
  ds_read_b64_tr_b16 a[156:157], v1 offset:50336
  v_mfma_f32_16x16x32_bf16 v[104:107], a[132:135], a[120:123], v[104:107]
  v_mfma_f32_16x16x32_bf16 v[108:111], a[132:135], a[124:127], v[108:111]
  ds_read_b64_tr_b16 a[158:159], v1 offset:53920
  v_mfma_f32_16x16x32_bf16 v[108:111], a[128:131], a[108:111], v[108:111]
  v_mfma_f32_16x16x32_bf16 v[220:223], a[136:139], a[108:111], v[220:223]
  ds_read_b64_tr_b16 a[160:161], v2 offset:160
  v_mul_f32 v22, v10, v96
  v_mul_f32 v23, v10, v97
  v_mul_f32 v24, v10, v98
  v_mul_f32 v25, v10, v99
  v_mfma_f32_16x16x32_bf16 v[220:223], a[140:143], a[124:127], v[220:223]
  v_exp_f32 v22, v22
  v_mul_f32 v26, v13, v100
  v_mfma_f32_16x16x32_bf16 v[216:219], a[140:143], a[120:123], v[216:219]
  buffer_load_dword v139, v138, s[36:39], s60 offen sc1
  ds_read_b64_tr_b16 a[162:163], v2 offset:3744
  v_exp_f32 v23, v23
  v_mfma_f32_16x16x32_bf16 v[216:219], a[136:139], a[104:107], v[216:219]
  v_mul_f32 v27, v13, v101
  v_exp_f32 v24, v24
  v_mul_f32 v28, v13, v102
  v_mfma_f32_16x16x32_bf16 v[212:215], a[136:139], a[100:103], v[212:215]
  ds_read_b64_tr_b16 a[164:165], v2 offset:7328
  v_exp_f32 v25, v25
  v_mul_f32 v29, v13, v103
  v_mfma_f32_16x16x32_bf16 v[212:215], a[140:143], a[116:119], v[212:215]
  v_exp_f32 v26, v26
  v_fma_f32 v22, v22, v11, v11
  v_mfma_f32_16x16x32_bf16 v[208:211], a[140:143], a[112:115], v[208:211]
  ds_read_b64_tr_b16 a[166:167], v2 offset:10912
  v_exp_f32 v27, v27
  v_fma_f32 v23, v23, v11, v11
  v_mfma_f32_16x16x32_bf16 v[208:211], a[136:139], a[96:99], v[208:211]
  s_waitcnt lgkmcnt(4)
  v_exp_f32 v28, v28
  v_fma_f32 v24, v24, v11, v11
  v_mfma_f32_16x16x32_bf16 v[112:115], a[144:147], a[32:35], v[112:115]
  ds_read_b64_tr_b16 a[168:169], v2 offset:14496
  v_exp_f32 v29, v29
  v_fma_f32 v25, v25, v11, v11
  v_mfma_f32_16x16x32_bf16 v[112:115], a[148:151], a[48:51], v[112:115]
  v_rcp_f32 v22, v22
  v_fma_f32 v26, v26, v14, v14
  v_mfma_f32_16x16x32_bf16 v[116:119], a[148:151], a[52:55], v[116:119]
  ds_read_b64_tr_b16 a[170:171], v2 offset:18080
  v_rcp_f32 v23, v23
  v_fma_f32 v27, v27, v14, v14
  v_mfma_f32_16x16x32_bf16 v[116:119], a[144:147], a[36:39], v[116:119]
  v_rcp_f32 v24, v24
  v_fma_f32 v28, v28, v14, v14
  v_mfma_f32_16x16x32_bf16 v[120:123], a[144:147], a[40:43], v[120:123]
  ds_read_b64_tr_b16 a[172:173], v2 offset:21664
  v_rcp_f32 v25, v25
  v_fma_f32 v29, v29, v14, v14
  v_mfma_f32_16x16x32_bf16 v[120:123], a[148:151], a[56:59], v[120:123]
  v_rcp_f32 v26, v26
  v_mul_f32 v208, v96, v208
  v_mfma_f32_16x16x32_bf16 v[124:127], a[148:151], a[60:63], v[124:127]
  ds_read_b64_tr_b16 a[174:175], v2 offset:25248
  v_rcp_f32 v27, v27
  v_mul_f32 v209, v97, v209
  v_mfma_f32_16x16x32_bf16 v[124:127], a[144:147], a[44:47], v[124:127]
  s_waitcnt lgkmcnt(11)
  v_rcp_f32 v28, v28
  v_mul_f32 v210, v98, v210
  v_mfma_f32_16x16x32_bf16 v[112:115], a[16:19], a[0:3], v[112:115]
  ds_read_b64_tr_b16 a[128:129], v2 offset:28832
  v_rcp_f32 v29, v29
  v_mul_f32 v211, v99, v211
  v_mfma_f32_16x16x32_bf16 v[116:119], a[16:19], a[4:7], v[116:119]
  v_mul_f32 v208, v208, v22
  v_mul_f32 v209, v209, v23
  v_mul_f32 v210, v210, v24
  v_mul_f32 v211, v211, v25
  v_mfma_f32_16x16x32_bf16 v[120:123], a[16:19], a[8:11], v[120:123]
  ds_read_b64_tr_b16 a[130:131], v2 offset:32416
  v_mul_f32 v22, v16, v104
  v_mul_f32 v23, v16, v105
  v_mul_f32 v24, v16, v106
  v_mfma_f32_16x16x32_bf16 v[124:127], a[16:19], a[12:15], v[124:127]
  v_mul_f32 v25, v16, v107
  v_exp_f32 v22, v22
  v_mul_f32 v212, v100, v212
  v_mfma_f32_16x16x32_bf16 v[224:227], a[20:23], a[0:3], v[224:227]
  ds_read_b64_tr_b16 a[132:133], v2 offset:36000
  v_exp_f32 v23, v23
  v_mul_f32 v213, v101, v213
  v_mfma_f32_16x16x32_bf16 v[228:231], a[20:23], a[4:7], v[228:231]
  v_exp_f32 v24, v24
  v_mul_f32 v214, v102, v214
  v_mfma_f32_16x16x32_bf16 v[232:235], a[20:23], a[8:11], v[232:235]
  ds_read_b64_tr_b16 a[134:135], v2 offset:39584
  v_exp_f32 v25, v25
  v_mul_f32 v215, v103, v215
  v_mfma_f32_16x16x32_bf16 v[236:239], a[20:23], a[12:15], v[236:239]
  v_mul_f32 v212, v212, v26
  v_mul_f32 v213, v213, v27
  v_mul_f32 v214, v214, v28
  v_mul_f32 v215, v215, v29
  v_mfma_f32_16x16x32_bf16 v[236:239], a[152:155], a[44:47], v[236:239]
  ds_read_b64_tr_b16 a[136:137], v2 offset:43168
  v_cvt_pk_bf16_f32 v96, v208, v209
  v_cvt_pk_bf16_f32 v97, v210, v211
  v_mul_f32 v26, v19, v108
  v_mfma_f32_16x16x32_bf16 v[236:239], a[156:159], a[60:63], v[236:239]
  v_mul_f32 v27, v19, v109
  v_mul_f32 v28, v19, v110
  v_mul_f32 v29, v19, v111
  v_mfma_f32_16x16x32_bf16 v[232:235], a[156:159], a[56:59], v[232:235]
  ds_read_b64_tr_b16 a[138:139], v2 offset:46752
  v_exp_f32 v26, v26
  v_fma_f32 v22, v22, v17, v17
  v_mfma_f32_16x16x32_bf16 v[232:235], a[152:155], a[40:43], v[232:235]
  v_exp_f32 v27, v27
  v_fma_f32 v23, v23, v17, v17
  v_mfma_f32_16x16x32_bf16 v[228:231], a[152:155], a[36:39], v[228:231]
  ds_read_b64_tr_b16 a[140:141], v2 offset:50336
  v_exp_f32 v28, v28
  v_fma_f32 v24, v24, v17, v17
  v_mfma_f32_16x16x32_bf16 v[228:231], a[156:159], a[52:55], v[228:231]
  v_exp_f32 v29, v29
  v_fma_f32 v25, v25, v17, v17
  v_cvt_pk_bf16_f32 v100, v212, v213
  v_mfma_f32_16x16x32_bf16 v[224:227], a[156:159], a[48:51], v[224:227]
  s_waitcnt vmcnt(0)
  v_cmp_ne_u32 vcc, 1, v139
  s_nop 4
  s_cbranch_vccnz CK21s
CK21x:
  v_mfma_f32_16x16x32_bf16 v[224:227], a[152:155], a[32:35], v[224:227]
  s_waitcnt lgkmcnt(7)
  s_lshl_b32 s9, s12, 11
  s_mov_b32 s60, 5439488
  ds_read_b64_tr_b16 a[142:143], v2 offset:53920
  buffer_load_dwordx4 a[216:219], v137, s[36:39], s9 offen offset:0 sc1
  v_mfma_f32_16x16x32_bf16 v[112:115], a[160:163], a[64:67], v[112:115]
  v_cvt_pk_bf16_f32 v101, v214, v215
  v_rcp_f32 v22, v22
  v_fma_f32 v26, v26, v20, v20
  v_mfma_f32_16x16x32_bf16 v[112:115], a[164:167], a[80:83], v[112:115]
  buffer_load_dwordx4 a[220:223], v137, s[36:39], s9 offen offset:1024 sc1
  v_rcp_f32 v23, v23
  v_fma_f32 v27, v27, v20, v20
  v_mfma_f32_16x16x32_bf16 v[116:119], a[164:167], a[84:87], v[116:119]
  v_rcp_f32 v24, v24
  v_fma_f32 v28, v28, v20, v20
  v_mfma_f32_16x16x32_bf16 v[116:119], a[160:163], a[68:71], v[116:119]
  buffer_load_dwordx4 a[224:227], v137, s[36:39], s9 offen offset:2048 sc1
  v_rcp_f32 v25, v25
  v_fma_f32 v29, v29, v20, v20
  v_mfma_f32_16x16x32_bf16 v[120:123], a[160:163], a[72:75], v[120:123]
  v_rcp_f32 v26, v26
  v_mul_f32 v216, v104, v216
  v_mfma_f32_16x16x32_bf16 v[120:123], a[164:167], a[88:91], v[120:123]
  buffer_load_dwordx4 a[228:231], v137, s[36:39], s9 offen offset:3072 sc1
  s_lshl_b32 s9, s13, 11
  v_rcp_f32 v27, v27
  v_mfma_f32_16x16x32_bf16 v[124:127], a[164:167], a[92:95], v[124:127]
  v_mul_f32 v217, v105, v217
  v_rcp_f32 v28, v28
  v_mul_f32 v218, v106, v218
  v_mfma_f32_16x16x32_bf16 v[124:127], a[160:163], a[76:79], v[124:127]
  s_waitcnt vmcnt(25)
  s_barrier
  buffer_load_dwordx4 a[0:3], v137, s[36:39], s9 offen offset:0 sc1
  v_rcp_f32 v29, v29
  v_mfma_f32_16x16x32_bf16 v[236:239], a[168:171], a[76:79], v[236:239]
  v_mul_f32 v219, v107, v219
  v_mul_f32 v216, v216, v22
  v_mul_f32 v217, v217, v23
  v_mul_f32 v218, v218, v24
  v_mfma_f32_16x16x32_bf16 v[236:239], a[172:175], a[92:95], v[236:239]
  buffer_load_dwordx4 a[4:7], v137, s[36:39], s9 offen offset:1024 sc1
  v_mul_f32 v219, v219, v25
  v_mul_f32 v220, v108, v220
  v_mul_f32 v221, v109, v221
  v_mfma_f32_16x16x32_bf16 v[232:235], a[172:175], a[88:91], v[232:235]
  v_mul_f32 v222, v110, v222
  v_mul_f32 v223, v111, v223
  v_cvt_pk_bf16_f32 v104, v216, v217
  v_cvt_pk_bf16_f32 v105, v218, v219
  v_mfma_f32_16x16x32_bf16 v[232:235], a[168:171], a[72:75], v[232:235]
  buffer_load_dwordx4 a[8:11], v137, s[36:39], s9 offen offset:2048 sc1
  v_mul_f32 v220, v220, v26
  v_mul_f32 v221, v221, v27
  v_mul_f32 v222, v222, v28
  v_mfma_f32_16x16x32_bf16 v[228:231], a[168:171], a[68:71], v[228:231]
  v_mul_f32 v223, v223, v29
  v_cvt_pk_bf16_f32 v108, v220, v221
  v_cvt_pk_bf16_f32 v109, v222, v223
  v_mfma_f32_16x16x32_bf16 v[228:231], a[172:175], a[84:87], v[228:231]
  buffer_load_dwordx4 a[12:15], v137, s[36:39], s9 offen offset:3072 sc1
  s_lshl_b32 s9, s14, 11
  v_mfma_f32_16x16x32_bf16 v[224:227], a[172:175], a[80:83], v[224:227]
  v_mfma_f32_16x16x32_bf16 v[224:227], a[168:171], a[64:67], v[224:227]
  s_waitcnt lgkmcnt(0)
  buffer_load_dwordx4 a[16:19], v137, s[36:39], s9 offen offset:0 sc1
  v_mfma_f32_16x16x32_bf16 v[112:115], a[128:131], a[96:99], v[112:115]
  s_barrier
  ds_read_b64_tr_b16 a[176:177], v244 offset:49152
  v_mfma_f32_16x16x32_bf16 v[112:115], a[132:135], a[112:115], v[112:115]
  buffer_load_dwordx4 a[20:23], v137, s[36:39], s9 offen offset:1024 sc1
  ds_read_b64_tr_b16 a[178:179], v244 offset:53248
  v_mfma_f32_16x16x32_bf16 v[116:119], a[132:135], a[116:119], v[116:119]
  ds_read_b64_tr_b16 a[180:181], v244 offset:57344
  v_mfma_f32_16x16x32_bf16 v[116:119], a[128:131], a[100:103], v[116:119]
  buffer_load_dwordx4 a[24:27], v137, s[36:39], s9 offen offset:2048 sc1
  ds_read_b64_tr_b16 a[182:183], v244 offset:61440
  v_mfma_f32_16x16x32_bf16 v[120:123], a[128:131], a[104:107], v[120:123]
  ds_read_b64_tr_b16 a[184:185], v245 offset:49152
  v_mfma_f32_16x16x32_bf16 v[120:123], a[132:135], a[120:123], v[120:123]
  buffer_load_dwordx4 a[28:31], v137, s[36:39], s9 offen offset:3072 sc1
  ds_read_b64_tr_b16 a[186:187], v245 offset:53248
  v_mfma_f32_16x16x32_bf16 v[124:127], a[132:135], a[124:127], v[124:127]
  s_cmp_eq_u32 s52, 3
  s_cselect_b32 s15, 52, 24
  s_lshl_b32 s8, s15, 16
  s_add_u32 m0, s73, 16384
  ds_read_b64_tr_b16 a[188:189], v245 offset:57344
  v_mfma_f32_16x16x32_bf16 v[124:127], a[128:131], a[108:111], v[124:127]
  ds_read_b64_tr_b16 a[190:191], v245 offset:61440
  v_mfma_f32_16x16x32_bf16 v[236:239], a[136:139], a[108:111], v[236:239]
  ds_read_b64_tr_b16 a[192:193], v246 offset:49152
  v_mul_f32 v22, v10, v112
  v_mul_f32 v23, v10, v113
  v_mul_f32 v24, v10, v114
  v_mfma_f32_16x16x32_bf16 v[236:239], a[140:143], a[124:127], v[236:239]
  ds_read_b64_tr_b16 a[194:195], v246 offset:53248
  v_mul_f32 v25, v10, v115
  v_exp_f32 v22, v22
  v_mfma_f32_16x16x32_bf16 v[232:235], a[140:143], a[120:123], v[232:235]
  buffer_load_dwordx4 v133, s[24:27], s8 offen offset:0 lds
  ds_read_b64_tr_b16 a[196:197], v246 offset:57344
  v_mul_f32 v26, v13, v116
  v_mfma_f32_16x16x32_bf16 v[232:235], a[136:139], a[104:107], v[232:235]
  ds_read_b64_tr_b16 a[198:199], v246 offset:61440
  v_exp_f32 v23, v23
  v_mul_f32 v27, v13, v117
  v_mfma_f32_16x16x32_bf16 v[228:231], a[136:139], a[100:103], v[228:231]
  s_lshl_b32 s9, s15, 11
  ds_read_b64_tr_b16 a[200:201], v247 offset:49152
  v_exp_f32 v24, v24
  v_mul_f32 v28, v13, v118
  v_mfma_f32_16x16x32_bf16 v[228:231], a[140:143], a[116:119], v[228:231]
  ds_read_b64_tr_b16 a[202:203], v247 offset:53248
  v_exp_f32 v25, v25
  v_mul_f32 v29, v13, v119
  v_mfma_f32_16x16x32_bf16 v[224:227], a[140:143], a[112:115], v[224:227]
  ds_read_b64_tr_b16 a[204:205], v247 offset:57344
  v_exp_f32 v26, v26
  v_fma_f32 v22, v22, v11, v11
  v_mfma_f32_16x16x32_bf16 v[224:227], a[136:139], a[96:99], v[224:227]
  s_waitcnt vmcnt(9) lgkmcnt(11)
  ds_read_b64_tr_b16 a[206:207], v247 offset:61440
  v_exp_f32 v27, v27
  v_fma_f32 v23, v23, v11, v11
  v_mfma_f32_16x16x32_bf16 v[32:35], a[176:179], a[216:219], 0
  buffer_load_dwordx4 a[32:35], v137, s[36:39], s9 offen offset:0 sc1
  ds_read_b64_tr_b16 a[208:209], v244 offset:51200
  v_exp_f32 v28, v28
  v_mfma_f32_16x16x32_bf16 v[32:35], a[180:183], a[224:227], v[32:35]
CT22:
  s_add_u32 s94, s92, CT22-k3_main_kernel+3072
  s_addc_u32 s95, s93, 0
  ds_read_b64_tr_b16 a[210:211], v244 offset:55296
  v_fma_f32 v24, v24, v11, v11
  v_mfma_f32_16x16x32_bf16 v[36:39], a[180:183], a[228:231], 0
  global_load_dword a252, v0, s[94:95]
  ds_read_b64_tr_b16 a[212:213], v244 offset:59392
  v_exp_f32 v29, v29
  v_mfma_f32_16x16x32_bf16 v[36:39], a[176:179], a[220:223], v[36:39]
  s_waitcnt lgkmcnt(11)
  ds_read_b64_tr_b16 a[214:215], v244 offset:63488
  v_fma_f32 v25, v25, v11, v11
  v_rcp_f32 v22, v22
  v_mfma_f32_16x16x32_bf16 v[44:47], a[184:187], a[220:223], 0
  buffer_load_dwordx4 v134, s[24:27], s8 offen offset:1024 lds
  ds_read_b64_tr_b16 a[176:177], v245 offset:51200
  v_fma_f32 v26, v26, v14, v14
  v_mfma_f32_16x16x32_bf16 v[44:47], a[188:191], a[228:231], v[44:47]
  ds_read_b64_tr_b16 a[178:179], v245 offset:55296
  v_rcp_f32 v23, v23
  v_fma_f32 v27, v27, v14, v14
  v_mfma_f32_16x16x32_bf16 v[40:43], a[188:191], a[224:227], 0
  buffer_load_dwordx4 a[36:39], v137, s[36:39], s9 offen offset:1024 sc1
  ds_read_b64_tr_b16 a[180:181], v245 offset:59392
  v_rcp_f32 v24, v24
  v_mfma_f32_16x16x32_bf16 v[40:43], a[184:187], a[216:219], v[40:43]
  s_waitcnt vmcnt(33) lgkmcnt(11)
  s_barrier
  ds_read_b64_tr_b16 a[182:183], v245 offset:63488
  v_fma_f32 v28, v28, v14, v14
  v_mfma_f32_16x16x32_bf16 v[48:51], a[192:195], a[216:219], 0
  ds_read_b64_tr_b16 a[184:185], v246 offset:51200
  v_rcp_f32 v25, v25
  v_fma_f32 v29, v29, v14, v14
  v_mfma_f32_16x16x32_bf16 v[48:51], a[196:199], a[224:227], v[48:51]
  buffer_load_dwordx4 v135, s[24:27], s8 offen offset:2048 lds
  ds_read_b64_tr_b16 a[186:187], v246 offset:55296
  v_rcp_f32 v26, v26
  v_mfma_f32_16x16x32_bf16 v[52:55], a[196:199], a[228:231], 0
  ds_read_b64_tr_b16 a[188:189], v246 offset:59392
  v_mul_f32 v224, v112, v224
  v_rcp_f32 v27, v27
  v_mfma_f32_16x16x32_bf16 v[52:55], a[192:195], a[220:223], v[52:55]
  s_waitcnt lgkmcnt(11)
  ds_read_b64_tr_b16 a[190:191], v246 offset:63488
  v_mul_f32 v225, v113, v225
  v_rcp_f32 v28, v28
  v_mfma_f32_16x16x32_bf16 v[60:63], a[200:203], a[220:223], 0
  ds_read_b64_tr_b16 a[192:193], v247 offset:51200
  v_mul_f32 v226, v114, v226
  v_rcp_f32 v29, v29
  v_mfma_f32_16x16x32_bf16 v[60:63], a[204:207], a[228:231], v[60:63]
  buffer_load_dwordx4 a[40:43], v137, s[36:39], s9 offen offset:2048 sc1
  ds_read_b64_tr_b16 a[194:195], v247 offset:55296
  v_mul_f32 v227, v115, v227
  v_mul_f32 v224, v224, v22
  v_mfma_f32_16x16x32_bf16 v[56:59], a[204:207], a[224:227], 0
  ds_read_b64_tr_b16 a[196:197], v247 offset:59392
  v_mul_f32 v225, v225, v23
  v_mul_f32 v226, v226, v24
  v_mul_f32 v227, v227, v25
  v_mfma_f32_16x16x32_bf16 v[56:59], a[200:203], a[216:219], v[56:59]
  s_waitcnt lgkmcnt(11)
  ds_read_b64_tr_b16 a[198:199], v247 offset:63488
  v_mul_f32 v22, v16, v120
  v_mul_f32 v23, v16, v121
  v_mul_f32 v24, v16, v122
  v_mfma_f32_16x16x32_bf16 v[144:147], a[208:211], a[216:219], 0
  buffer_load_dwordx4 v136, s[24:27], s8 offen offset:3072 lds
  ds_read_b64_tr_b16 a[200:201], v248 offset:0
  v_mul_f32 v25, v16, v123
  v_mfma_f32_16x16x32_bf16 v[144:147], a[212:215], a[224:227], v[144:147]
  ds_read_b64_tr_b16 a[202:203], v248 offset:4096
  v_exp_f32 v22, v22
  v_mul_f32 v228, v116, v228
  v_mfma_f32_16x16x32_bf16 v[148:151], a[212:215], a[228:231], 0
  ds_read_b64_tr_b16 a[204:205], v248 offset:8192
  v_exp_f32 v23, v23
  v_mul_f32 v229, v117, v229
  v_mfma_f32_16x16x32_bf16 v[148:151], a[208:211], a[220:223], v[148:151]
  s_waitcnt lgkmcnt(11)
  ds_read_b64_tr_b16 a[206:207], v248 offset:12288
  v_exp_f32 v24, v24
  v_mul_f32 v230, v118, v230
  v_mfma_f32_16x16x32_bf16 v[156:159], a[176:179], a[220:223], 0
  buffer_load_dwordx4 a[44:47], v137, s[36:39], s9 offen offset:3072 sc1
  s_mov_b32 s40, 31
  s_lshl_b32 s8, s40, 16
  s_add_u32 m0, s73, 32768
  v_mfma_f32_16x16x32_bf16 v[156:159], a[180:183], a[228:231], v[156:159]
  ds_read_b64_tr_b16 a[208:209], v249 offset:0
  ds_read_b64_tr_b16 a[210:211], v249 offset:4096
  v_exp_f32 v25, v25
  v_mfma_f32_16x16x32_bf16 v[152:155], a[180:183], a[224:227], 0
  ds_read_b64_tr_b16 a[212:213], v249 offset:8192
  v_mul_f32 v231, v119, v231
  v_mul_f32 v228, v228, v26
  v_mul_f32 v229, v229, v27
  v_mfma_f32_16x16x32_bf16 v[152:155], a[176:179], a[216:219], v[152:155]
  s_waitcnt lgkmcnt(11)
  ds_read_b64_tr_b16 a[214:215], v249 offset:12288
  v_mul_f32 v230, v230, v28
  v_mul_f32 v231, v231, v29
  v_cvt_pk_bf16_f32 v98, v224, v225
  v_mfma_f32_16x16x32_bf16 v[160:163], a[184:187], a[216:219], 0
  buffer_load_dwordx4 v133, s[24:27], s8 offen offset:0 lds
  s_lshl_b32 s9, s40, 11
  ds_read_b64_tr_b16 a[176:177], v250 offset:0
  v_cvt_pk_bf16_f32 v99, v226, v227
  v_mfma_f32_16x16x32_bf16 v[160:163], a[188:191], a[224:227], v[160:163]
  ds_read_b64_tr_b16 a[178:179], v250 offset:4096
  v_mfma_f32_16x16x32_bf16 v[164:167], a[188:191], a[228:231], 0
  ds_read_b64_tr_b16 a[180:181], v250 offset:8192
  buffer_store_dwordx4 v[96:99], v0, s[36:39], s21 offen offset:0 sc1
  v_mul_f32 v26, v19, v124
  v_mul_f32 v27, v19, v125
  v_mfma_f32_16x16x32_bf16 v[164:167], a[184:187], a[220:223], v[164:167]
  s_waitcnt lgkmcnt(11)
  ds_read_b64_tr_b16 a[182:183], v250 offset:12288
  v_mul_f32 v28, v19, v126
  v_mul_f32 v29, v19, v127
  v_mfma_f32_16x16x32_bf16 v[172:175], a[192:195], a[220:223], 0
  buffer_load_dwordx4 a[48:51], v137, s[36:39], s9 offen offset:0 sc1
  ds_read_b64_tr_b16 a[184:185], v251 offset:0
  v_exp_f32 v26, v26
  v_mfma_f32_16x16x32_bf16 v[172:175], a[196:199], a[228:231], v[172:175]
  ds_read_b64_tr_b16 a[186:187], v251 offset:4096
  v_fma_f32 v22, v22, v17, v17
  v_exp_f32 v27, v27
  v_mfma_f32_16x16x32_bf16 v[168:171], a[196:199], a[224:227], 0
  ds_read_b64_tr_b16 a[188:189], v251 offset:8192
  v_fma_f32 v23, v23, v17, v17
  v_exp_f32 v28, v28
  v_mfma_f32_16x16x32_bf16 v[168:171], a[192:195], a[216:219], v[168:171]
  s_waitcnt vmcnt(16) lgkmcnt(11)
  ds_read_b64_tr_b16 a[190:191], v251 offset:12288
  v_fma_f32 v24, v24, v17, v17
  v_exp_f32 v29, v29
  v_mfma_f32_16x16x32_bf16 v[32:35], a[200:203], a[0:3], v[32:35]
  buffer_load_dwordx4 v134, s[24:27], s8 offen offset:1024 lds
  ds_read_b64_tr_b16 a[192:193], v248 offset:2048
  v_fma_f32 v25, v25, v17, v17
  v_cvt_pk_bf16_f32 v102, v228, v229
  v_mfma_f32_16x16x32_bf16 v[32:35], a[204:207], a[8:11], v[32:35]
  ds_read_b64_tr_b16 a[194:195], v248 offset:6144
  v_cvt_pk_bf16_f32 v103, v230, v231
  v_mfma_f32_16x16x32_bf16 v[36:39], a[204:207], a[12:15], v[36:39]
  ds_read_b64_tr_b16 a[196:197], v248 offset:10240
  buffer_store_dwordx4 v[100:103], v0, s[36:39], s21 offen offset:1024 sc1
  v_rcp_f32 v22, v22
  v_mfma_f32_16x16x32_bf16 v[36:39], a[200:203], a[4:7], v[36:39]
  s_waitcnt lgkmcnt(11)
  ds_read_b64_tr_b16 a[198:199], v248 offset:14336
  v_fma_f32 v26, v26, v20, v20
  v_rcp_f32 v23, v23
  v_mfma_f32_16x16x32_bf16 v[44:47], a[208:211], a[4:7], v[44:47]
  buffer_load_dwordx4 a[52:55], v137, s[36:39], s9 offen offset:1024 sc1
  ds_read_b64_tr_b16 a[200:201], v249 offset:2048
  v_fma_f32 v27, v27, v20, v20
  v_mfma_f32_16x16x32_bf16 v[44:47], a[212:215], a[12:15], v[44:47]
  ds_read_b64_tr_b16 a[202:203], v249 offset:6144
  v_rcp_f32 v24, v24
  v_fma_f32 v28, v28, v20, v20
  v_mfma_f32_16x16x32_bf16 v[40:43], a[212:215], a[8:11], v[40:43]
  ds_read_b64_tr_b16 a[204:205], v249 offset:10240
  v_rcp_f32 v25, v25
  v_fma_f32 v29, v29, v20, v20
  v_mfma_f32_16x16x32_bf16 v[40:43], a[208:211], a[0:3], v[40:43]
  s_waitcnt vmcnt(37) lgkmcnt(11)
  s_barrier
  buffer_load_dwordx4 v135, s[24:27], s8 offen offset:2048 lds
  ds_read_b64_tr_b16 a[206:207], v249 offset:14336
  v_mfma_f32_16x16x32_bf16 v[48:51], a[176:179], a[0:3], v[48:51]
  ds_read_b64_tr_b16 a[208:209], v250 offset:2048
  v_rcp_f32 v26, v26
  v_mul_f32 v232, v120, v232
  v_mfma_f32_16x16x32_bf16 v[48:51], a[180:183], a[8:11], v[48:51]
  ds_read_b64_tr_b16 a[210:211], v250 offset:6144
  v_rcp_f32 v27, v27
  v_mul_f32 v233, v121, v233
  v_mfma_f32_16x16x32_bf16 v[52:55], a[180:183], a[12:15], v[52:55]
  ds_read_b64_tr_b16 a[212:213], v250 offset:10240
  v_rcp_f32 v28, v28
  v_mul_f32 v234, v122, v234
  v_mfma_f32_16x16x32_bf16 v[52:55], a[176:179], a[4:7], v[52:55]
  s_waitcnt lgkmcnt(11)
  buffer_load_dwordx4 a[56:59], v137, s[36:39], s9 offen offset:2048 sc1
  ds_read_b64_tr_b16 a[214:215], v250 offset:14336
  v_rcp_f32 v29, v29
  v_mfma_f32_16x16x32_bf16 v[60:63], a[184:187], a[4:7], v[60:63]
  ds_read_b64_tr_b16 a[176:177], v251 offset:2048
  v_mul_f32 v235, v123, v235
  v_mul_f32 v232, v232, v22
  v_mul_f32 v233, v233, v23
  v_mfma_f32_16x16x32_bf16 v[60:63], a[188:191], a[12:15], v[60:63]
  ds_read_b64_tr_b16 a[178:179], v251 offset:6144
  v_mul_f32 v234, v234, v24
  v_mul_f32 v235, v235, v25
  v_mul_f32 v236, v124, v236
  v_mfma_f32_16x16x32_bf16 v[56:59], a[188:191], a[8:11], v[56:59]
  ds_read_b64_tr_b16 a[180:181], v251 offset:10240
  v_mul_f32 v237, v125, v237
  v_mul_f32 v238, v126, v238
  v_mul_f32 v239, v127, v239
  v_mfma_f32_16x16x32_bf16 v[56:59], a[184:187], a[0:3], v[56:59]
  s_waitcnt lgkmcnt(11)
  buffer_load_dwordx4 v136, s[24:27], s8 offen offset:3072 lds
  ds_read_b64_tr_b16 a[182:183], v251 offset:14336
  v_cvt_pk_bf16_f32 v106, v232, v233
  v_cvt_pk_bf16_f32 v107, v234, v235
  v_mfma_f32_16x16x32_bf16 v[144:147], a[192:195], a[0:3], v[144:147]
  ds_read_b64_tr_b16 a[184:185], v240 offset:0
  v_mfma_f32_16x16x32_bf16 v[144:147], a[196:199], a[8:11], v[144:147]
  ds_read_b64_tr_b16 a[186:187], v240 offset:4096
  buffer_store_dwordx4 v[104:107], v0, s[36:39], s22 offen offset:0 sc1
  v_mul_f32 v236, v236, v26
  v_mul_f32 v237, v237, v27
  v_mfma_f32_16x16x32_bf16 v[148:151], a[196:199], a[12:15], v[148:151]
  ds_read_b64_tr_b16 a[188:189], v240 offset:8192
  v_mul_f32 v238, v238, v28
  v_mul_f32 v239, v239, v29
  v_cvt_pk_bf16_f32 v110, v236, v237
  v_mfma_f32_16x16x32_bf16 v[148:151], a[192:195], a[4:7], v[148:151]
  s_waitcnt lgkmcnt(11)
  buffer_load_dwordx4 a[60:63], v137, s[36:39], s9 offen offset:3072 sc1
  s_cmp_eq_u32 s52, 1
  s_cselect_b32 s41, 10, 38
  s_lshl_b32 s8, s41, 16
  v_mfma_f32_16x16x32_bf16 v[156:159], a[200:203], a[4:7], v[156:159]
  s_add_u32 m0, s73, 49152
  ds_read_b64_tr_b16 a[190:191], v240 offset:12288
  ds_read_b64_tr_b16 a[192:193], v241 offset:0
  v_cvt_pk_bf16_f32 v111, v238, v239
  v_mfma_f32_16x16x32_bf16 v[156:159], a[204:207], a[12:15], v[156:159]
  ds_read_b64_tr_b16 a[194:195], v241 offset:4096
  buffer_store_dwordx4 v[108:111], v0, s[36:39], s22 offen offset:1024 sc1
  v_mfma_f32_16x16x32_bf16 v[152:155], a[204:207], a[8:11], v[152:155]
  ds_read_b64_tr_b16 a[196:197], v241 offset:8192
  v_mfma_f32_16x16x32_bf16 v[152:155], a[200:203], a[0:3], v[152:155]
  s_waitcnt lgkmcnt(11)
  buffer_load_dwordx4 v133, s[24:27], s8 offen offset:0 lds
  s_lshl_b32 s9, s41, 11
  ds_read_b64_tr_b16 a[198:199], v241 offset:12288
  v_mfma_f32_16x16x32_bf16 v[160:163], a[208:211], a[0:3], v[160:163]
  ds_read_b64_tr_b16 a[200:201], v242 offset:0
  v_mfma_f32_16x16x32_bf16 v[160:163], a[212:215], a[8:11], v[160:163]
  ds_read_b64_tr_b16 a[202:203], v242 offset:4096
  v_mfma_f32_16x16x32_bf16 v[164:167], a[212:215], a[12:15], v[164:167]
  buffer_load_dwordx4 a[64:67], v137, s[36:39], s9 offen offset:0 sc1
  ds_read_b64_tr_b16 a[204:205], v242 offset:8192
  v_mfma_f32_16x16x32_bf16 v[164:167], a[208:211], a[4:7], v[164:167]
  s_waitcnt lgkmcnt(11)
  ds_read_b64_tr_b16 a[206:207], v242 offset:12288
  v_mfma_f32_16x16x32_bf16 v[172:175], a[176:179], a[4:7], v[172:175]
  ds_read_b64_tr_b16 a[208:209], v243 offset:0
  v_mfma_f32_16x16x32_bf16 v[172:175], a[180:183], a[12:15], v[172:175]
  ds_read_b64_tr_b16 a[210:211], v243 offset:4096
  v_mfma_f32_16x16x32_bf16 v[168:171], a[180:183], a[8:11], v[168:171]
  buffer_load_dwordx4 v134, s[24:27], s8 offen offset:1024 lds
  ds_read_b64_tr_b16 a[212:213], v243 offset:8192
  v_mfma_f32_16x16x32_bf16 v[168:171], a[176:179], a[0:3], v[168:171]
  s_waitcnt vmcnt(24) lgkmcnt(11)
  ds_read_b64_tr_b16 a[214:215], v243 offset:12288
  v_mfma_f32_16x16x32_bf16 v[32:35], a[184:187], a[16:19], v[32:35]
  ds_read_b64_tr_b16 a[176:177], v240 offset:2048
  v_mfma_f32_16x16x32_bf16 v[32:35], a[188:191], a[24:27], v[32:35]
  ds_read_b64_tr_b16 a[178:179], v240 offset:6144
  v_mfma_f32_16x16x32_bf16 v[36:39], a[188:191], a[28:31], v[36:39]
  buffer_load_dwordx4 a[68:71], v137, s[36:39], s9 offen offset:1024 sc1
  ds_read_b64_tr_b16 a[180:181], v240 offset:10240
  v_mfma_f32_16x16x32_bf16 v[36:39], a[184:187], a[20:23], v[36:39]
  s_waitcnt lgkmcnt(11)
  ds_read_b64_tr_b16 a[182:183], v240 offset:14336
  v_mfma_f32_16x16x32_bf16 v[44:47], a[192:195], a[20:23], v[44:47]
  ds_read_b64_tr_b16 a[184:185], v241 offset:2048
  v_mfma_f32_16x16x32_bf16 v[44:47], a[196:199], a[28:31], v[44:47]
  ds_read_b64_tr_b16 a[186:187], v241 offset:6144
  v_mfma_f32_16x16x32_bf16 v[40:43], a[196:199], a[24:27], v[40:43]
  buffer_load_dwordx4 v135, s[24:27], s8 offen offset:2048 lds
  ds_read_b64_tr_b16 a[188:189], v241 offset:10240
  v_mfma_f32_16x16x32_bf16 v[40:43], a[192:195], a[16:19], v[40:43]
  s_waitcnt vmcnt(18) lgkmcnt(11)
  s_barrier
  ds_read_b64_tr_b16 a[190:191], v241 offset:14336
  v_mfma_f32_16x16x32_bf16 v[48:51], a[200:203], a[16:19], v[48:51]
  ds_read_b64_tr_b16 a[192:193], v242 offset:2048
  v_mfma_f32_16x16x32_bf16 v[48:51], a[204:207], a[24:27], v[48:51]
  buffer_load_dwordx4 a[72:75], v137, s[36:39], s9 offen offset:2048 sc1
  ds_read_b64_tr_b16 a[194:195], v242 offset:6144
  v_mfma_f32_16x16x32_bf16 v[52:55], a[204:207], a[28:31], v[52:55]
  ds_read_b64_tr_b16 a[196:197], v242 offset:10240
  v_mfma_f32_16x16x32_bf16 v[52:55], a[200:203], a[20:23], v[52:55]
  s_waitcnt lgkmcnt(11)
  ds_read_b64_tr_b16 a[198:199], v242 offset:14336
  v_mfma_f32_16x16x32_bf16 v[60:63], a[208:211], a[20:23], v[60:63]
  ds_read_b64_tr_b16 a[200:201], v243 offset:2048
  v_mfma_f32_16x16x32_bf16 v[60:63], a[212:215], a[28:31], v[60:63]
  buffer_load_dwordx4 v136, s[24:27], s8 offen offset:3072 lds
  ds_read_b64_tr_b16 a[202:203], v243 offset:6144
  v_mfma_f32_16x16x32_bf16 v[56:59], a[212:215], a[24:27], v[56:59]
  ds_read_b64_tr_b16 a[204:205], v243 offset:10240
  v_mfma_f32_16x16x32_bf16 v[56:59], a[208:211], a[16:19], v[56:59]
  s_waitcnt lgkmcnt(11)
  ds_read_b64_tr_b16 a[206:207], v243 offset:14336
  v_mfma_f32_16x16x32_bf16 v[144:147], a[176:179], a[16:19], v[144:147]
  ds_read_b64_tr_b16 a[208:209], v240 offset:16384
  v_mfma_f32_16x16x32_bf16 v[144:147], a[180:183], a[24:27], v[144:147]
  buffer_load_dwordx4 a[76:79], v137, s[36:39], s9 offen offset:3072 sc1
  s_cmp_eq_u32 s52, 2
  v_mfma_f32_16x16x32_bf16 v[148:151], a[180:183], a[28:31], v[148:151]
  s_cselect_b32 s42, 17, 45
  s_lshl_b32 s8, s42, 16
  s_add_u32 m0, s73, 65536
  v_mfma_f32_16x16x32_bf16 v[148:151], a[176:179], a[20:23], v[148:151]
  s_waitcnt lgkmcnt(9)
  ds_read_b64_tr_b16 a[210:211], v240 offset:20480
  ds_read_b64_tr_b16 a[212:213], v240 offset:24576
  v_mfma_f32_16x16x32_bf16 v[156:159], a[184:187], a[20:23], v[156:159]
  ds_read_b64_tr_b16 a[214:215], v240 offset:28672
  ds_read_b64_tr_b16 a[176:177], v241 offset:16384
  v_mfma_f32_16x16x32_bf16 v[156:159], a[188:191], a[28:31], v[156:159]
  buffer_load_dwordx4 v133, s[24:27], s8 offen offset:0 lds
  s_lshl_b32 s9, s42, 11
  v_mfma_f32_16x16x32_bf16 v[152:155], a[188:191], a[24:27], v[152:155]
  ds_read_b64_tr_b16 a[178:179], v241 offset:20480
  ds_read_b64_tr_b16 a[180:181], v241 offset:24576
  v_mfma_f32_16x16x32_bf16 v[152:155], a[184:187], a[16:19], v[152:155]
  s_waitcnt lgkmcnt(11)
  ds_read_b64_tr_b16 a[182:183], v241 offset:28672
  v_mfma_f32_16x16x32_bf16 v[160:163], a[192:195], a[16:19], v[160:163]
  ds_read_b64_tr_b16 a[184:185], v242 offset:16384
  v_mfma_f32_16x16x32_bf16 v[160:163], a[196:199], a[24:27], v[160:163]
  buffer_load_dwordx4 a[80:83], v137, s[36:39], s9 offen offset:0 sc1
  ds_read_b64_tr_b16 a[186:187], v242 offset:20480
  v_mfma_f32_16x16x32_bf16 v[164:167], a[196:199], a[28:31], v[164:167]
  ds_read_b64_tr_b16 a[188:189], v242 offset:24576
  v_mfma_f32_16x16x32_bf16 v[164:167], a[192:195], a[20:23], v[164:167]
  s_waitcnt lgkmcnt(11)
  ds_read_b64_tr_b16 a[190:191], v242 offset:28672
  v_mfma_f32_16x16x32_bf16 v[172:175], a[200:203], a[20:23], v[172:175]
  buffer_load_dwordx4 v134, s[24:27], s8 offen offset:1024 lds
  ds_read_b64_tr_b16 a[192:193], v243 offset:16384
  v_mfma_f32_16x16x32_bf16 v[172:175], a[204:207], a[28:31], v[172:175]
  ds_read_b64_tr_b16 a[194:195], v243 offset:20480
  v_mfma_f32_16x16x32_bf16 v[168:171], a[204:207], a[24:27], v[168:171]
  ds_read_b64_tr_b16 a[196:197], v243 offset:24576
  v_mfma_f32_16x16x32_bf16 v[168:171], a[200:203], a[16:19], v[168:171]
  s_waitcnt vmcnt(23) lgkmcnt(11)
  ds_read_b64_tr_b16 a[198:199], v243 offset:28672
  v_mfma_f32_16x16x32_bf16 v[32:35], a[208:211], a[32:35], v[32:35]
  buffer_load_dwordx4 a[84:87], v137, s[36:39], s9 offen offset:1024 sc1
  ds_read_b64_tr_b16 a[200:201], v240 offset:18432
  v_mfma_f32_16x16x32_bf16 v[32:35], a[212:215], a[40:43], v[32:35]
  ds_read_b64_tr_b16 a[202:203], v240 offset:22528
  v_mfma_f32_16x16x32_bf16 v[36:39], a[212:215], a[44:47], v[36:39]
  ds_read_b64_tr_b16 a[204:205], v240 offset:26624
  v_mfma_f32_16x16x32_bf16 v[36:39], a[208:211], a[36:39], v[36:39]
  s_waitcnt lgkmcnt(11)
  ds_read_b64_tr_b16 a[206:207], v240 offset:30720
  v_mfma_f32_16x16x32_bf16 v[44:47], a[176:179], a[36:39], v[44:47]
  buffer_load_dwordx4 v135, s[24:27], s8 offen offset:2048 lds
  ds_read_b64_tr_b16 a[208:209], v241 offset:18432
  v_mfma_f32_16x16x32_bf16 v[44:47], a[180:183], a[44:47], v[44:47]
  ds_read_b64_tr_b16 a[210:211], v241 offset:22528
  v_mfma_f32_16x16x32_bf16 v[40:43], a[180:183], a[40:43], v[40:43]
  s_waitcnt vmcnt(13)
  ds_read_b64_tr_b16 a[212:213], v241 offset:26624
  v_mfma_f32_16x16x32_bf16 v[40:43], a[176:179], a[32:35], v[40:43]
  s_waitcnt vmcnt(16) lgkmcnt(11)
  s_barrier
  ds_read_b64_tr_b16 a[214:215], v241 offset:30720
  v_mfma_f32_16x16x32_bf16 v[48:51], a[184:187], a[32:35], v[48:51]
  s_mov_b64 exec, 1
  buffer_store_dword v254, v0, s[36:39], s45 offen sc1
  s_mov_b64 exec, -1
  v_mfma_f32_16x16x32_bf16 v[48:51], a[188:191], a[40:43], v[48:51]
  buffer_load_dwordx4 a[88:91], v137, s[36:39], s9 offen offset:2048 sc1
  ds_read_b64_tr_b16 a[176:177], v242 offset:18432
  v_mfma_f32_16x16x32_bf16 v[52:55], a[188:191], a[44:47], v[52:55]
  ds_read_b64_tr_b16 a[178:179], v242 offset:22528
  ds_read_b64_tr_b16 a[180:181], v242 offset:26624
  v_mfma_f32_16x16x32_bf16 v[52:55], a[184:187], a[36:39], v[52:55]
  s_waitcnt lgkmcnt(11)
  ds_read_b64_tr_b16 a[182:183], v242 offset:30720
  v_mfma_f32_16x16x32_bf16 v[60:63], a[192:195], a[36:39], v[60:63]
  buffer_load_dwordx4 v136, s[24:27], s8 offen offset:3072 lds
  ds_read_b64_tr_b16 a[184:185], v243 offset:18432
  v_mfma_f32_16x16x32_bf16 v[60:63], a[196:199], a[44:47], v[60:63]
  ds_read_b64_tr_b16 a[186:187], v243 offset:22528
  v_mfma_f32_16x16x32_bf16 v[56:59], a[196:199], a[40:43], v[56:59]
  ds_read_b64_tr_b16 a[188:189], v243 offset:26624
  v_mfma_f32_16x16x32_bf16 v[56:59], a[192:195], a[32:35], v[56:59]
  s_waitcnt lgkmcnt(11)
  buffer_load_dwordx4 a[92:95], v137, s[36:39], s9 offen offset:3072 sc1
  s_cmp_eq_u32 s52, 3
  v_mfma_f32_16x16x32_bf16 v[144:147], a[200:203], a[32:35], v[144:147]
  s_cselect_b32 s43, 24, 52
  s_lshl_b32 s8, s43, 16
  s_add_u32 m0, s73, 81920
  v_mfma_f32_16x16x32_bf16 v[144:147], a[204:207], a[40:43], v[144:147]
  ds_read_b64_tr_b16 a[190:191], v243 offset:30720
  ds_read_b64_tr_b16 a[192:193], v240 offset:32768
  v_mfma_f32_16x16x32_bf16 v[148:151], a[204:207], a[44:47], v[148:151]
  ds_read_b64_tr_b16 a[194:195], v240 offset:36864
  ds_read_b64_tr_b16 a[196:197], v240 offset:40960
  v_mfma_f32_16x16x32_bf16 v[148:151], a[200:203], a[36:39], v[148:151]
  s_waitcnt lgkmcnt(11)
  buffer_load_dwordx4 v133, s[24:27], s8 offen offset:0 lds
  s_lshl_b32 s9, s43, 11
  v_mfma_f32_16x16x32_bf16 v[156:159], a[208:211], a[36:39], v[156:159]
  ds_read_b64_tr_b16 a[198:199], v240 offset:45056
  ds_read_b64_tr_b16 a[200:201], v241 offset:32768
  v_mfma_f32_16x16x32_bf16 v[156:159], a[212:215], a[44:47], v[156:159]
  ds_read_b64_tr_b16 a[202:203], v241 offset:36864
  v_mfma_f32_16x16x32_bf16 v[152:155], a[212:215], a[40:43], v[152:155]
  ds_read_b64_tr_b16 a[204:205], v241 offset:40960
  v_mfma_f32_16x16x32_bf16 v[152:155], a[208:211], a[32:35], v[152:155]
  s_waitcnt lgkmcnt(11)
  buffer_load_dwordx4 a[96:99], v137, s[36:39], s9 offen offset:0 sc1
  ds_read_b64_tr_b16 a[206:207], v241 offset:45056
  v_mfma_f32_16x16x32_bf16 v[160:163], a[176:179], a[32:35], v[160:163]
  ds_read_b64_tr_b16 a[208:209], v242 offset:32768
  v_mfma_f32_16x16x32_bf16 v[160:163], a[180:183], a[40:43], v[160:163]
  ds_read_b64_tr_b16 a[210:211], v242 offset:36864
  v_mfma_f32_16x16x32_bf16 v[164:167], a[180:183], a[44:47], v[164:167]
  ds_read_b64_tr_b16 a[212:213], v242 offset:40960
  v_mfma_f32_16x16x32_bf16 v[164:167], a[176:179], a[36:39], v[164:167]
  s_waitcnt lgkmcnt(11)
  buffer_load_dwordx4 v134, s[24:27], s8 offen offset:1024 lds
  ds_read_b64_tr_b16 a[214:215], v242 offset:45056
  v_mfma_f32_16x16x32_bf16 v[172:175], a[184:187], a[36:39], v[172:175]
  ds_read_b64_tr_b16 a[176:177], v243 offset:32768
  v_mfma_f32_16x16x32_bf16 v[172:175], a[188:191], a[44:47], v[172:175]
  ds_read_b64_tr_b16 a[178:179], v243 offset:36864
  v_mfma_f32_16x16x32_bf16 v[168:171], a[188:191], a[40:43], v[168:171]
  ds_read_b64_tr_b16 a[180:181], v243 offset:40960
  v_mfma_f32_16x16x32_bf16 v[168:171], a[184:187], a[32:35], v[168:171]
  s_waitcnt vmcnt(21) lgkmcnt(11)
  buffer_load_dwordx4 a[100:103], v137, s[36:39], s9 offen offset:1024 sc1
  ds_read_b64_tr_b16 a[182:183], v243 offset:45056
  v_mfma_f32_16x16x32_bf16 v[32:35], a[192:195], a[48:51], v[32:35]
  ds_read_b64_tr_b16 a[184:185], v240 offset:34816
  v_mfma_f32_16x16x32_bf16 v[32:35], a[196:199], a[56:59], v[32:35]
  ds_read_b64_tr_b16 a[186:187], v240 offset:38912
  v_mfma_f32_16x16x32_bf16 v[36:39], a[196:199], a[60:63], v[36:39]
  buffer_load_dwordx4 v135, s[24:27], s8 offen offset:2048 lds
  ds_read_b64_tr_b16 a[188:189], v240 offset:43008
  v_mfma_f32_16x16x32_bf16 v[36:39], a[192:195], a[52:55], v[36:39]
  s_waitcnt lgkmcnt(11)
  ds_read_b64_tr_b16 a[190:191], v240 offset:47104
  v_mfma_f32_16x16x32_bf16 v[44:47], a[200:203], a[52:55], v[44:47]
  ds_read_b64_tr_b16 a[192:193], v241 offset:34816
  v_mfma_f32_16x16x32_bf16 v[44:47], a[204:207], a[60:63], v[44:47]
  ds_read_b64_tr_b16 a[194:195], v241 offset:38912
  v_mfma_f32_16x16x32_bf16 v[40:43], a[204:207], a[56:59], v[40:43]
  buffer_load_dwordx4 a[104:107], v137, s[36:39], s9 offen offset:2048 sc1
  ds_read_b64_tr_b16 a[196:197], v241 offset:43008
  v_mfma_f32_16x16x32_bf16 v[40:43], a[200:203], a[48:51], v[40:43]
  s_waitcnt vmcnt(16) lgkmcnt(11)
  s_barrier
  ds_read_b64_tr_b16 a[198:199], v241 offset:47104
  v_mfma_f32_16x16x32_bf16 v[48:51], a[208:211], a[48:51], v[48:51]
  ds_read_b64_tr_b16 a[200:201], v242 offset:34816
  v_mfma_f32_16x16x32_bf16 v[48:51], a[212:215], a[56:59], v[48:51]
  ds_read_b64_tr_b16 a[202:203], v242 offset:38912
  v_mfma_f32_16x16x32_bf16 v[52:55], a[212:215], a[60:63], v[52:55]
  buffer_load_dwordx4 v136, s[24:27], s8 offen offset:3072 lds
  ds_read_b64_tr_b16 a[204:205], v242 offset:43008
  v_mfma_f32_16x16x32_bf16 v[52:55], a[208:211], a[52:55], v[52:55]
  s_waitcnt lgkmcnt(11)
  ds_read_b64_tr_b16 a[206:207], v242 offset:47104
  v_mfma_f32_16x16x32_bf16 v[60:63], a[176:179], a[52:55], v[60:63]
  ds_read_b64_tr_b16 a[208:209], v243 offset:34816
  v_mfma_f32_16x16x32_bf16 v[60:63], a[180:183], a[60:63], v[60:63]
  ds_read_b64_tr_b16 a[210:211], v243 offset:38912
  v_mfma_f32_16x16x32_bf16 v[56:59], a[180:183], a[56:59], v[56:59]
  buffer_load_dwordx4 a[108:111], v137, s[36:39], s9 offen offset:3072 sc1
  s_add_u32 s50, s52, 8
  v_mfma_f32_16x16x32_bf16 v[56:59], a[176:179], a[48:51], v[56:59]
  s_waitcnt lgkmcnt(10)
  s_and_b32 s50, s50, 3
  s_mul_i32 s50, s50, 14
  v_mfma_f32_16x16x32_bf16 v[144:147], a[184:187], a[48:51], v[144:147]
  s_lshl_b32 s8, s50, 16
  s_add_u32 s8, s8, s53
  s_add_u32 m0, s73, 98304
  v_mfma_f32_16x16x32_bf16 v[144:147], a[188:191], a[56:59], v[144:147]
  ds_read_b64_tr_b16 a[212:213], v243 offset:43008
  ds_read_b64_tr_b16 a[214:215], v243 offset:47104
  v_mfma_f32_16x16x32_bf16 v[148:151], a[188:191], a[60:63], v[148:151]
  ds_read_b64_tr_b16 a[176:177], v240 offset:49152
  ds_read_b64_tr_b16 a[178:179], v240 offset:53248
  v_mfma_f32_16x16x32_bf16 v[148:151], a[184:187], a[52:55], v[148:151]
  s_waitcnt lgkmcnt(10)
  buffer_load_dwordx4 v133, s[24:27], s8 offen offset:0 lds
  s_lshl_b32 s9, s50, 11
  v_mfma_f32_16x16x32_bf16 v[156:159], a[192:195], a[52:55], v[156:159]
  ds_read_b64_tr_b16 a[180:181], v240 offset:57344
  ds_read_b64_tr_b16 a[182:183], v240 offset:61440
  v_mfma_f32_16x16x32_bf16 v[156:159], a[196:199], a[60:63], v[156:159]
  ds_read_b64_tr_b16 a[184:185], v241 offset:49152
  ds_read_b64_tr_b16 a[186:187], v241 offset:53248
  v_mfma_f32_16x16x32_bf16 v[152:155], a[196:199], a[56:59], v[152:155]
  s_add_u32 s28, s73, 16384
  buffer_load_dwordx4 a[112:115], v137, s[36:39], s9 offen offset:0 sc1
  ds_read_b64_tr_b16 a[188:189], v241 offset:57344
  v_mfma_f32_16x16x32_bf16 v[152:155], a[192:195], a[48:51], v[152:155]
  s_waitcnt lgkmcnt(11)
  ds_read_b64_tr_b16 a[190:191], v241 offset:61440
  v_and_b32 v129, 15, v128
  v_mfma_f32_16x16x32_bf16 v[160:163], a[200:203], a[48:51], v[160:163]
  ds_read_b64_tr_b16 a[192:193], v242 offset:49152
  v_lshrrev_b32 v131, 1, v129
  v_mfma_f32_16x16x32_bf16 v[160:163], a[204:207], a[56:59], v[160:163]
  buffer_load_dwordx4 v134, s[24:27], s8 offen offset:1024 lds
  ds_read_b64_tr_b16 a[194:195], v242 offset:53248
  v_mfma_f32_16x16x32_bf16 v[164:167], a[204:207], a[60:63], v[164:167]
  ds_read_b64_tr_b16 a[196:197], v242 offset:57344
  v_lshrrev_b32 v130, 5, v128
  v_mfma_f32_16x16x32_bf16 v[164:167], a[200:203], a[52:55], v[164:167]
  s_waitcnt lgkmcnt(11)
  ds_read_b64_tr_b16 a[198:199], v242 offset:61440
  v_xor_b32 v131, v131, v130
  v_mfma_f32_16x16x32_bf16 v[172:175], a[208:211], a[52:55], v[172:175]
  ds_read_b64_tr_b16 a[200:201], v243 offset:49152
  v_lshlrev_b32 v131, 4, v131
  v_mfma_f32_16x16x32_bf16 v[172:175], a[212:215], a[60:63], v[172:175]
  buffer_load_dwordx4 a[116:119], v137, s[36:39], s9 offen offset:1024 sc1
  ds_read_b64_tr_b16 a[202:203], v243 offset:53248
  v_mfma_f32_16x16x32_bf16 v[168:171], a[212:215], a[56:59], v[168:171]
  ds_read_b64_tr_b16 a[204:205], v243 offset:57344
  v_lshl_add_u32 v131, v129, 7, v131
  v_mfma_f32_16x16x32_bf16 v[168:171], a[208:211], a[48:51], v[168:171]
  s_waitcnt vmcnt(21) lgkmcnt(11)
  ds_read_b64_tr_b16 a[206:207], v243 offset:61440
  v_bfe_u32 v130, v128, 4, 1
  v_mfma_f32_16x16x32_bf16 v[32:35], a[176:179], a[64:67], v[32:35]
  ds_read_b64_tr_b16 a[208:209], v240 offset:51200
  v_lshl_add_u32 v131, v130, 3, v131
  v_mfma_f32_16x16x32_bf16 v[32:35], a[180:183], a[72:75], v[32:35]
  buffer_load_dwordx4 v135, s[24:27], s8 offen offset:2048 lds
  s_add_u32 s9, s9, 12288
  v_mfma_f32_16x16x32_bf16 v[36:39], a[180:183], a[76:79], v[36:39]
  ds_read_b64_tr_b16 a[210:211], v240 offset:55296
  ds_read_b64_tr_b16 a[212:213], v240 offset:59392
  v_mfma_f32_16x16x32_bf16 v[36:39], a[176:179], a[68:71], v[36:39]
  s_waitcnt lgkmcnt(11)
  ds_read_b64_tr_b16 a[214:215], v240 offset:63488
  v_add_u32 v140, s28, v131
  v_mfma_f32_16x16x32_bf16 v[44:47], a[184:187], a[68:71], v[44:47]
  ds_read_b64_tr_b16 a[176:177], v241 offset:51200
  v_xor_b32 v141, 32, v140
  v_mfma_f32_16x16x32_bf16 v[44:47], a[188:191], a[76:79], v[44:47]
  buffer_load_dwordx4 a[120:123], v137, s[36:39], s9 offen offset:2048 sc1
  ds_read_b64_tr_b16 a[178:179], v241 offset:55296
  v_mfma_f32_16x16x32_bf16 v[40:43], a[188:191], a[72:75], v[40:43]
  ds_read_b64_tr_b16 a[180:181], v241 offset:59392
  v_xor_b32 v142, 64, v140
  v_mfma_f32_16x16x32_bf16 v[40:43], a[184:187], a[64:67], v[40:43]
  s_waitcnt vmcnt(15) lgkmcnt(11)
  s_barrier
  ds_read_b64_tr_b16 a[182:183], v241 offset:63488
  v_mfma_f32_16x16x32_bf16 v[48:51], a[192:195], a[64:67], v[48:51]
  ds_read_b64_tr_b16 a[184:185], v242 offset:51200
  v_xor_b32 v143, 96, v140
  v_mfma_f32_16x16x32_bf16 v[48:51], a[196:199], a[72:75], v[48:51]
  buffer_load_dwordx4 v136, s[24:27], s8 offen offset:3072 lds
  ds_read_b64_tr_b16 a[186:187], v242 offset:55296
  v_mfma_f32_16x16x32_bf16 v[52:55], a[196:199], a[76:79], v[52:55]
  ds_read_b64_tr_b16 a[188:189], v242 offset:59392
  v_add_u32 v255, s28, v0
  v_mfma_f32_16x16x32_bf16 v[52:55], a[192:195], a[68:71], v[52:55]
  s_waitcnt lgkmcnt(11)
  ds_read_b64_tr_b16 a[190:191], v242 offset:63488
  s_lshl_b32 s28, s44, 10
  v_mfma_f32_16x16x32_bf16 v[60:63], a[200:203], a[68:71], v[60:63]
  s_add_u32 s28, s28, 151552
  buffer_load_dwordx4 a[124:127], v137, s[36:39], s9 offen offset:3072 sc1
  s_add_u32 s51, s52, 9
  v_mfma_f32_16x16x32_bf16 v[60:63], a[204:207], a[76:79], v[60:63]
  s_and_b32 s51, s51, 3
  s_mul_i32 s51, s51, 14
  s_lshl_b32 s8, s51, 16
  v_mfma_f32_16x16x32_bf16 v[56:59], a[204:207], a[72:75], v[56:59]
  s_add_u32 s8, s8, s53
  s_add_u32 m0, s73, 114688
  ds_read_b64_tr_b16 a[192:193], v243 offset:51200
  v_mfma_f32_16x16x32_bf16 v[56:59], a[200:203], a[64:67], v[56:59]
  s_waitcnt lgkmcnt(9)
  ds_read_b64_tr_b16 a[194:195], v243 offset:55296
  ds_read_b64_tr_b16 a[196:197], v243 offset:59392
  v_mfma_f32_16x16x32_bf16 v[144:147], a[208:211], a[64:67], v[144:147]
  ds_read_b64_tr_b16 a[198:199], v243 offset:63488
  buffer_load_dwordx4 v133, s[24:27], s8 offen offset:0 lds
  v_mfma_f32_16x16x32_bf16 v[144:147], a[212:215], a[72:75], v[144:147]
  s_lshl_b32 s9, s51, 11
  ds_read_b64_tr_b16 a[200:201], v244 offset:0
  ds_read_b64_tr_b16 a[202:203], v244 offset:4096
  v_mfma_f32_16x16x32_bf16 v[148:151], a[212:215], a[76:79], v[148:151]
  ds_read_b64_tr_b16 a[204:205], v244 offset:8192
  v_add_u32 v129, s28, v0
  v_mfma_f32_16x16x32_bf16 v[148:151], a[208:211], a[68:71], v[148:151]
  s_waitcnt lgkmcnt(11)
  ds_read_b64_tr_b16 a[206:207], v244 offset:12288
  v_lshrrev_b32 v130, 4, v128
  v_mfma_f32_16x16x32_bf16 v[156:159], a[176:179], a[68:71], v[156:159]
  buffer_load_dwordx4 a[216:219], v137, s[36:39], s9 offen offset:0 sc1
  ds_read_b64_tr_b16 a[208:209], v245 offset:0
  v_mfma_f32_16x16x32_bf16 v[156:159], a[180:183], a[76:79], v[156:159]
  ds_read_b64_tr_b16 a[210:211], v245 offset:4096
  v_lshl_add_u32 v130, v130, 4, s28
  v_mfma_f32_16x16x32_bf16 v[152:155], a[180:183], a[72:75], v[152:155]
  ds_read_b64_tr_b16 a[212:213], v245 offset:8192
  ds_write_b128 v129, a[248:251]
  v_mfma_f32_16x16x32_bf16 v[152:155], a[176:179], a[64:67], v[152:155]
  s_waitcnt lgkmcnt(12)
  ds_read_b64_tr_b16 a[214:215], v245 offset:12288
  ds_read_b128 v[176:179], v130 offset:768
  v_mfma_f32_16x16x32_bf16 v[160:163], a[184:187], a[64:67], v[160:163]
  buffer_load_dwordx4 v134, s[24:27], s8 offen offset:1024 lds
  ds_read_b64_tr_b16 a[176:177], v246 offset:0
  v_mfma_f32_16x16x32_bf16 v[160:163], a[188:191], a[72:75], v[160:163]
  ds_read_b64_tr_b16 a[178:179], v246 offset:4096
  ds_read_b128 v[180:183], v130 offset:832
  v_mfma_f32_16x16x32_bf16 v[164:167], a[188:191], a[76:79], v[164:167]
  ds_read_b64_tr_b16 a[180:181], v246 offset:8192
  ds_read_b128 v[184:187], v130 offset:896
  v_mfma_f32_16x16x32_bf16 v[164:167], a[184:187], a[68:71], v[164:167]
  s_waitcnt lgkmcnt(15)
  ds_read_b64_tr_b16 a[182:183], v246 offset:12288
  ds_read_b128 v[188:191], v130 offset:960
  v_mfma_f32_16x16x32_bf16 v[172:175], a[192:195], a[68:71], v[172:175]
  buffer_load_dwordx4 a[220:223], v137, s[36:39], s9 offen offset:1024 sc1
  ds_read_b64_tr_b16 a[184:185], v247 offset:0
  v_mfma_f32_16x16x32_bf16 v[172:175], a[196:199], a[76:79], v[172:175]
  ds_read_b64_tr_b16 a[186:187], v247 offset:4096
  v_accvgpr_read_b32 v131, a232
  v_mfma_f32_16x16x32_bf16 v[168:171], a[196:199], a[72:75], v[168:171]
  ds_read_b64_tr_b16 a[188:189], v247 offset:8192
CT23:
  s_add_u32 s94, s92, CT23-k3_main_kernel+3072
  s_addc_u32 s95, s93, 0
  v_mfma_f32_16x16x32_bf16 v[168:171], a[192:195], a[64:67], v[168:171]
  s_waitcnt vmcnt(20) lgkmcnt(15)
  global_load_dword a252, v0, s[94:95]
  ds_read_b64_tr_b16 a[190:191], v247 offset:12288
  v_mfma_f32_16x16x32_bf16 v[32:35], a[200:203], a[80:83], v[32:35]
  ds_read_b64_tr_b16 a[192:193], v244 offset:2048
  v_lshlrev_b32 v64, 16, v131
  v_mfma_f32_16x16x32_bf16 v[32:35], a[204:207], a[88:91], v[32:35]
  ds_read_b64_tr_b16 a[194:195], v244 offset:6144
  v_and_b32 v65, 0xffff0000, v131
  v_mfma_f32_16x16x32_bf16 v[36:39], a[204:207], a[92:95], v[36:39]
  buffer_load_dwordx4 v135, s[24:27], s8 offen offset:2048 lds
  s_add_u32 s9, s9, 12288
  v_mfma_f32_16x16x32_bf16 v[36:39], a[200:203], a[84:87], v[36:39]
  s_waitcnt lgkmcnt(14)
  ds_read_b64_tr_b16 a[196:197], v244 offset:10240
  ds_read_b64_tr_b16 a[198:199], v244 offset:14336
  v_mfma_f32_16x16x32_bf16 v[44:47], a[208:211], a[84:87], v[44:47]
  ds_read_b64_tr_b16 a[200:201], v245 offset:2048
  v_accvgpr_read_b32 v131, a233
  v_mfma_f32_16x16x32_bf16 v[44:47], a[212:215], a[92:95], v[44:47]
  buffer_load_dwordx4 a[224:227], v137, s[36:39], s9 offen offset:2048 sc1
  ds_read_b64_tr_b16 a[202:203], v245 offset:6144
  v_mfma_f32_16x16x32_bf16 v[40:43], a[212:215], a[88:91], v[40:43]
  ds_read_b64_tr_b16 a[204:205], v245 offset:10240
  v_lshlrev_b32 v66, 16, v131
  v_mfma_f32_16x16x32_bf16 v[40:43], a[208:211], a[80:83], v[40:43]
  s_waitcnt vmcnt(16) lgkmcnt(12)
  s_barrier
  ds_read_b64_tr_b16 a[206:207], v245 offset:14336
  v_mfma_f32_16x16x32_bf16 v[48:51], a[176:179], a[80:83], v[48:51]
  buffer_load_dwordx4 v136, s[24:27], s8 offen offset:3072 lds
  ds_read_b64_tr_b16 a[208:209], v246 offset:2048
  v_mfma_f32_16x16x32_bf16 v[48:51], a[180:183], a[88:91], v[48:51]
  ds_read_b64_tr_b16 a[210:211], v246 offset:6144
  v_and_b32 v67, 0xffff0000, v131
  v_mfma_f32_16x16x32_bf16 v[52:55], a[180:183], a[92:95], v[52:55]
  ds_read_b64_tr_b16 a[212:213], v246 offset:10240
  v_accvgpr_read_b32 v131, a234
  v_mfma_f32_16x16x32_bf16 v[52:55], a[176:179], a[84:87], v[52:55]
  s_waitcnt lgkmcnt(11)
  buffer_load_dwordx4 a[228:231], v137, s[36:39], s9 offen offset:3072 sc1
  s_add_u32 s12, s52, 10
  v_mfma_f32_16x16x32_bf16 v[60:63], a[184:187], a[84:87], v[60:63]
  s_and_b32 s12, s12, 3
  s_mul_i32 s12, s12, 14
  s_lshl_b32 s8, s12, 16
  v_mfma_f32_16x16x32_bf16 v[60:63], a[188:191], a[92:95], v[60:63]
  s_add_u32 s8, s8, s53
  s_add_u32 m0, s73, 131072
  ds_read_b64_tr_b16 a[214:215], v246 offset:14336
  v_mfma_f32_16x16x32_bf16 v[56:59], a[188:191], a[88:91], v[56:59]
  ds_read_b64_tr_b16 a[176:177], v247 offset:2048
  ds_read_b64_tr_b16 a[178:179], v247 offset:6144
  v_mfma_f32_16x16x32_bf16 v[56:59], a[184:187], a[80:83], v[56:59]
  s_waitcnt lgkmcnt(10)
  ds_read_b64_tr_b16 a[180:181], v247 offset:10240
  buffer_load_dwordx4 v133, s[24:27], s8 offen offset:0 lds
  v_mfma_f32_16x16x32_bf16 v[144:147], a[192:195], a[80:83], v[144:147]
  s_lshl_b32 s9, s12, 11
  ds_read_b64_tr_b16 a[182:183], v247 offset:14336
  ds_read_b64_tr_b16 a[184:185], v244 offset:16384
  v_mfma_f32_16x16x32_bf16 v[144:147], a[196:199], a[88:91], v[144:147]
  ds_read_b64_tr_b16 a[186:187], v244 offset:20480
  v_lshlrev_b32 v68, 16, v131
  v_mfma_f32_16x16x32_bf16 v[148:151], a[196:199], a[92:95], v[148:151]
  buffer_load_dwordx4 a[0:3], v137, s[36:39], s9 offen offset:0 sc1
  ds_read_b64_tr_b16 a[188:189], v244 offset:24576
  v_mfma_f32_16x16x32_bf16 v[148:151], a[192:195], a[84:87], v[148:151]
  s_waitcnt lgkmcnt(11)
  ds_read_b64_tr_b16 a[190:191], v244 offset:28672
  v_and_b32 v69, 0xffff0000, v131
  v_mfma_f32_16x16x32_bf16 v[156:159], a[200:203], a[84:87], v[156:159]
  ds_read_b64_tr_b16 a[192:193], v245 offset:16384
  v_accvgpr_read_b32 v131, a235
  v_mfma_f32_16x16x32_bf16 v[156:159], a[204:207], a[92:95], v[156:159]
  ds_read_b64_tr_b16 a[194:195], v245 offset:20480
  v_lshlrev_b32 v70, 16, v131
  v_mfma_f32_16x16x32_bf16 v[152:155], a[204:207], a[88:91], v[152:155]
  buffer_load_dwordx4 v134, s[24:27], s8 offen offset:1024 lds
  ds_read_b64_tr_b16 a[196:197], v245 offset:24576
  v_mfma_f32_16x16x32_bf16 v[152:155], a[200:203], a[80:83], v[152:155]
  s_waitcnt lgkmcnt(11)
  ds_read_b64_tr_b16 a[198:199], v245 offset:28672
  v_and_b32 v71, 0xffff0000, v131
  v_mfma_f32_16x16x32_bf16 v[160:163], a[208:211], a[80:83], v[160:163]
  ds_read_b64_tr_b16 a[200:201], v246 offset:16384
  v_accvgpr_read_b32 v131, a236
  v_mfma_f32_16x16x32_bf16 v[160:163], a[212:215], a[88:91], v[160:163]
  ds_read_b64_tr_b16 a[202:203], v246 offset:20480
  v_lshlrev_b32 v72, 16, v131
  v_mfma_f32_16x16x32_bf16 v[164:167], a[212:215], a[92:95], v[164:167]
  buffer_load_dword v139, v138, s[36:39], s60 offen sc1
  ds_read_b64_tr_b16 a[204:205], v246 offset:24576
  v_mfma_f32_16x16x32_bf16 v[164:167], a[208:211], a[84:87], v[164:167]
  s_waitcnt lgkmcnt(11)
  ds_read_b64_tr_b16 a[206:207], v246 offset:28672
  v_and_b32 v73, 0xffff0000, v131
  v_mfma_f32_16x16x32_bf16 v[172:175], a[176:179], a[84:87], v[172:175]
  ds_read_b64_tr_b16 a[208:209], v247 offset:16384
  v_accvgpr_read_b32 v131, a237
  v_mfma_f32_16x16x32_bf16 v[172:175], a[180:183], a[92:95], v[172:175]
  buffer_load_dwordx4 a[4:7], v137, s[36:39], s9 offen offset:1024 sc1
  ds_read_b64_tr_b16 a[210:211], v247 offset:20480
  v_mfma_f32_16x16x32_bf16 v[168:171], a[180:183], a[88:91], v[168:171]
  ds_read_b64_tr_b16 a[212:213], v247 offset:24576
  v_lshlrev_b32 v74, 16, v131
  v_mfma_f32_16x16x32_bf16 v[168:171], a[176:179], a[80:83], v[168:171]
  s_waitcnt vmcnt(22) lgkmcnt(11)
  ds_read_b64_tr_b16 a[214:215], v247 offset:28672
  v_and_b32 v75, 0xffff0000, v131
  v_mfma_f32_16x16x32_bf16 v[32:35], a[184:187], a[96:99], v[32:35]
  buffer_load_dwordx4 v135, s[24:27], s8 offen offset:2048 lds
  s_add_u32 s9, s9, 12288
  v_mfma_f32_16x16x32_bf16 v[32:35], a[188:191], a[104:107], v[32:35]
  ds_read_b64_tr_b16 a[176:177], v244 offset:18432
  ds_read_b64_tr_b16 a[178:179], v244 offset:22528
  v_mfma_f32_16x16x32_bf16 v[36:39], a[188:191], a[108:111], v[36:39]
  ds_read_b64_tr_b16 a[180:181], v244 offset:26624
  v_accvgpr_read_b32 v131, a238
  v_mfma_f32_16x16x32_bf16 v[36:39], a[184:187], a[100:103], v[36:39]
  s_waitcnt lgkmcnt(11)
  buffer_load_dwordx4 a[8:11], v137, s[36:39], s9 offen offset:2048 sc1
  ds_read_b64_tr_b16 a[182:183], v244 offset:30720
  v_mfma_f32_16x16x32_bf16 v[44:47], a[192:195], a[100:103], v[44:47]
  ds_read_b64_tr_b16 a[184:185], v245 offset:18432
  v_lshlrev_b32 v76, 16, v131
  v_mfma_f32_16x16x32_bf16 v[44:47], a[196:199], a[108:111], v[44:47]
  ds_read_b64_tr_b16 a[186:187], v245 offset:22528
  v_and_b32 v77, 0xffff0000, v131
  v_mfma_f32_16x16x32_bf16 v[40:43], a[196:199], a[104:107], v[40:43]
  buffer_load_dwordx4 v136, s[24:27], s8 offen offset:3072 lds
  ds_read_b64_tr_b16 a[188:189], v245 offset:26624
  v_mfma_f32_16x16x32_bf16 v[40:43], a[192:195], a[96:99], v[40:43]
  s_waitcnt vmcnt(18) lgkmcnt(11)
  s_barrier
  ds_read_b64_tr_b16 a[190:191], v245 offset:30720
  v_mfma_f32_16x16x32_bf16 v[48:51], a[200:203], a[96:99], v[48:51]
  ds_read_b64_tr_b16 a[192:193], v246 offset:18432
  v_accvgpr_read_b32 v131, a239
  v_mfma_f32_16x16x32_bf16 v[48:51], a[204:207], a[104:107], v[48:51]
  buffer_load_dwordx4 a[12:15], v137, s[36:39], s9 offen offset:3072 sc1
  s_add_u32 s13, s52, 11
  v_mfma_f32_16x16x32_bf16 v[52:55], a[204:207], a[108:111], v[52:55]
  s_and_b32 s13, s13, 3
  s_mul_i32 s13, s13, 14
  s_lshl_b32 s8, s13, 16
  v_mfma_f32_16x16x32_bf16 v[52:55], a[200:203], a[100:103], v[52:55]
  s_waitcnt lgkmcnt(9)
  s_add_u32 s8, s8, s53
  s_add_u32 m0, s73, 0
  v_mfma_f32_16x16x32_bf16 v[60:63], a[208:211], a[100:103], v[60:63]
  ds_read_b64_tr_b16 a[194:195], v246 offset:22528
  ds_read_b64_tr_b16 a[196:197], v246 offset:26624
  v_mfma_f32_16x16x32_bf16 v[60:63], a[212:215], a[108:111], v[60:63]
  ds_read_b64_tr_b16 a[198:199], v246 offset:30720
  ds_read_b64_tr_b16 a[200:201], v247 offset:18432
  v_mfma_f32_16x16x32_bf16 v[56:59], a[212:215], a[104:107], v[56:59]
  buffer_load_dwordx4 v133, s[24:27], s8 offen offset:0 lds
  s_lshl_b32 s9, s13, 11
  v_mfma_f32_16x16x32_bf16 v[56:59], a[208:211], a[96:99], v[56:59]
  s_waitcnt lgkmcnt(9)
  ds_read_b64_tr_b16 a[202:203], v247 offset:22528
  ds_read_b64_tr_b16 a[204:205], v247 offset:26624
  v_mfma_f32_16x16x32_bf16 v[144:147], a[176:179], a[96:99], v[144:147]
  ds_read_b64_tr_b16 a[206:207], v247 offset:30720
  ds_read_b64_tr_b16 a[208:209], v244 offset:32768
  v_mfma_f32_16x16x32_bf16 v[144:147], a[180:183], a[104:107], v[144:147]
  buffer_load_dwordx4 a[16:19], v137, s[36:39], s9 offen offset:0 sc1
  ds_read_b64_tr_b16 a[210:211], v244 offset:36864
  v_mfma_f32_16x16x32_bf16 v[148:151], a[180:183], a[108:111], v[148:151]
  ds_read_b64_tr_b16 a[212:213], v244 offset:40960
  v_lshlrev_b32 v78, 16, v131
  v_mfma_f32_16x16x32_bf16 v[148:151], a[176:179], a[100:103], v[148:151]
  s_waitcnt lgkmcnt(11)
  ds_read_b64_tr_b16 a[214:215], v244 offset:45056
  v_and_b32 v79, 0xffff0000, v131
  v_mfma_f32_16x16x32_bf16 v[156:159], a[184:187], a[100:103], v[156:159]
  ds_read_b64_tr_b16 a[176:177], v245 offset:32768
  v_accvgpr_read_b32 v131, a240
  v_mfma_f32_16x16x32_bf16 v[156:159], a[188:191], a[108:111], v[156:159]
  buffer_load_dwordx4 v134, s[24:27], s8 offen offset:1024 lds
  ds_read_b64_tr_b16 a[178:179], v245 offset:36864
  v_mfma_f32_16x16x32_bf16 v[152:155], a[188:191], a[104:107], v[152:155]
  ds_read_b64_tr_b16 a[180:181], v245 offset:40960
  v_lshlrev_b32 v80, 16, v131
  v_mfma_f32_16x16x32_bf16 v[152:155], a[184:187], a[96:99], v[152:155]
  s_waitcnt lgkmcnt(11)
  ds_read_b64_tr_b16 a[182:183], v245 offset:45056
  v_and_b32 v81, 0xffff0000, v131
  v_mfma_f32_16x16x32_bf16 v[160:163], a[192:195], a[96:99], v[160:163]
  buffer_load_dwordx4 a[20:23], v137, s[36:39], s9 offen offset:1024 sc1
  ds_read_b64_tr_b16 a[184:185], v246 offset:32768
  v_mfma_f32_16x16x32_bf16 v[160:163], a[196:199], a[104:107], v[160:163]
  ds_read_b64_tr_b16 a[186:187], v246 offset:36864
  v_accvgpr_read_b32 v131, a241
  v_mfma_f32_16x16x32_bf16 v[164:167], a[196:199], a[108:111], v[164:167]
  ds_read_b64_tr_b16 a[188:189], v246 offset:40960
  v_lshlrev_b32 v82, 16, v131
  v_mfma_f32_16x16x32_bf16 v[164:167], a[192:195], a[100:103], v[164:167]
  s_waitcnt lgkmcnt(11)
  ds_read_b64_tr_b16 a[190:191], v246 offset:45056
  v_and_b32 v83, 0xffff0000, v131
  v_mfma_f32_16x16x32_bf16 v[172:175], a[200:203], a[100:103], v[172:175]
  buffer_load_dwordx4 v135, s[24:27], s8 offen offset:2048 lds
  s_add_u32 s9, s9, 12288
  v_mfma_f32_16x16x32_bf16 v[172:175], a[204:207], a[108:111], v[172:175]
  ds_read_b64_tr_b16 a[192:193], v247 offset:32768
  ds_read_b64_tr_b16 a[194:195], v247 offset:36864
  v_mfma_f32_16x16x32_bf16 v[168:171], a[204:207], a[104:107], v[168:171]
  ds_read_b64_tr_b16 a[196:197], v247 offset:40960
  v_accvgpr_read_b32 v131, a242
  v_mfma_f32_16x16x32_bf16 v[168:171], a[200:203], a[96:99], v[168:171]
  s_waitcnt vmcnt(23) lgkmcnt(11)
  ds_read_b64_tr_b16 a[198:199], v247 offset:45056
  v_lshlrev_b32 v84, 16, v131
  v_mfma_f32_16x16x32_bf16 v[32:35], a[208:211], a[112:115], v[32:35]
  buffer_load_dwordx4 a[24:27], v137, s[36:39], s9 offen offset:2048 sc1
  ds_read_b64_tr_b16 a[200:201], v244 offset:34816
  v_mfma_f32_16x16x32_bf16 v[32:35], a[212:215], a[120:123], v[32:35]
  ds_read_b64_tr_b16 a[202:203], v244 offset:38912
  v_and_b32 v85, 0xffff0000, v131
  v_mfma_f32_16x16x32_bf16 v[36:39], a[212:215], a[124:127], v[36:39]
  ds_read_b64_tr_b16 a[204:205], v244 offset:43008
  v_accvgpr_read_b32 v131, a243
  v_mfma_f32_16x16x32_bf16 v[36:39], a[208:211], a[116:119], v[36:39]
  s_waitcnt lgkmcnt(11)
  ds_read_b64_tr_b16 a[206:207], v244 offset:47104
  v_lshlrev_b32 v86, 16, v131
  v_mfma_f32_16x16x32_bf16 v[44:47], a[176:179], a[116:119], v[44:47]
  buffer_load_dwordx4 v136, s[24:27], s8 offen offset:3072 lds
  ds_read_b64_tr_b16 a[208:209], v245 offset:34816
  v_mfma_f32_16x16x32_bf16 v[44:47], a[180:183], a[124:127], v[44:47]
  ds_read_b64_tr_b16 a[210:211], v245 offset:38912
  v_and_b32 v87, 0xffff0000, v131
  v_mfma_f32_16x16x32_bf16 v[40:43], a[180:183], a[120:123], v[40:43]
  ds_read_b64_tr_b16 a[212:213], v245 offset:43008
  v_accvgpr_read_b32 v131, a244
  v_mfma_f32_16x16x32_bf16 v[40:43], a[176:179], a[112:115], v[40:43]
  s_waitcnt vmcnt(17) lgkmcnt(11)
  s_barrier
  ds_read_b64_tr_b16 a[214:215], v245 offset:47104
  v_mfma_f32_16x16x32_bf16 v[48:51], a[184:187], a[112:115], v[48:51]
  buffer_load_dwordx4 a[28:31], v137, s[36:39], s9 offen offset:3072 sc1
  s_mov_b32 s14, 1
  v_mfma_f32_16x16x32_bf16 v[48:51], a[188:191], a[120:123], v[48:51]
  s_lshl_b32 s8, s14, 16
  s_add_u32 m0, s73, 16384
  ds_read_b64_tr_b16 a[176:177], v246 offset:34816
  v_mfma_f32_16x16x32_bf16 v[52:55], a[188:191], a[124:127], v[52:55]
  ds_read_b64_tr_b16 a[178:179], v246 offset:38912
  ds_read_b64_tr_b16 a[180:181], v246 offset:43008
  v_mfma_f32_16x16x32_bf16 v[52:55], a[184:187], a[116:119], v[52:55]
  s_waitcnt lgkmcnt(11)
  buffer_load_dwordx4 v133, s[24:27], s8 offen offset:0 lds
  ds_read_b64_tr_b16 a[182:183], v246 offset:47104
  v_mfma_f32_16x16x32_bf16 v[60:63], a[192:195], a[116:119], v[60:63]
  s_waitcnt vmcnt(14)
  v_cmp_ne_u32 vcc, 1, v139
  s_nop 4
  s_cbranch_vccnz CK24s
CK24x:
  v_mfma_f32_16x16x32_bf16 v[60:63], a[196:199], a[124:127], v[60:63]
  s_lshl_b32 s9, s14, 11
  ds_read_b64_tr_b16 a[184:185], v247 offset:34816
  ds_read_b64_tr_b16 a[186:187], v247 offset:38912
  v_mfma_f32_16x16x32_bf16 v[56:59], a[196:199], a[120:123], v[56:59]
  ds_read_b64_tr_b16 a[188:189], v247 offset:43008
  v_lshlrev_b32 v88, 16, v131
  v_mfma_f32_16x16x32_bf16 v[56:59], a[192:195], a[112:115], v[56:59]
  s_waitcnt lgkmcnt(11)
  buffer_load_dwordx4 a[32:35], v137, s[36:39], s9 offen offset:0 sc1
  ds_read_b64_tr_b16 a[190:191], v247 offset:47104
  v_mfma_f32_16x16x32_bf16 v[144:147], a[200:203], a[112:115], v[144:147]
  ds_read_b64_tr_b16 a[192:193], v244 offset:49152
  v_and_b32 v89, 0xffff0000, v131
  v_mfma_f32_16x16x32_bf16 v[144:147], a[204:207], a[120:123], v[144:147]
  ds_read_b64_tr_b16 a[194:195], v244 offset:53248
  v_accvgpr_read_b32 v131, a245
  v_mfma_f32_16x16x32_bf16 v[148:151], a[204:207], a[124:127], v[148:151]
  ds_read_b64_tr_b16 a[196:197], v244 offset:57344
  v_lshlrev_b32 v90, 16, v131
  v_mfma_f32_16x16x32_bf16 v[148:151], a[200:203], a[116:119], v[148:151]
  s_waitcnt lgkmcnt(11)
  buffer_load_dwordx4 v134, s[24:27], s8 offen offset:1024 lds
  ds_read_b64_tr_b16 a[198:199], v244 offset:61440
  v_mfma_f32_16x16x32_bf16 v[156:159], a[208:211], a[116:119], v[156:159]
  ds_read_b64_tr_b16 a[200:201], v245 offset:49152
  v_and_b32 v91, 0xffff0000, v131
  v_mfma_f32_16x16x32_bf16 v[156:159], a[212:215], a[124:127], v[156:159]
  ds_read_b64_tr_b16 a[202:203], v245 offset:53248
  v_accvgpr_read_b32 v131, a246
  v_mfma_f32_16x16x32_bf16 v[152:155], a[212:215], a[120:123], v[152:155]
  ds_read_b64_tr_b16 a[204:205], v245 offset:57344
  v_lshlrev_b32 v92, 16, v131
  v_mfma_f32_16x16x32_bf16 v[152:155], a[208:211], a[112:115], v[152:155]
  s_waitcnt lgkmcnt(11)
  buffer_load_dwordx4 a[36:39], v137, s[36:39], s9 offen offset:1024 sc1
  ds_read_b64_tr_b16 a[206:207], v245 offset:61440
  v_mfma_f32_16x16x32_bf16 v[160:163], a[176:179], a[112:115], v[160:163]
  ds_read_b64_tr_b16 a[208:209], v246 offset:49152
  v_and_b32 v93, 0xffff0000, v131
  v_mfma_f32_16x16x32_bf16 v[160:163], a[180:183], a[120:123], v[160:163]
  ds_read_b64_tr_b16 a[210:211], v246 offset:53248
  v_accvgpr_read_b32 v131, a247
  v_mfma_f32_16x16x32_bf16 v[164:167], a[180:183], a[124:127], v[164:167]
  ds_read_b64_tr_b16 a[212:213], v246 offset:57344
  v_lshlrev_b32 v94, 16, v131
  v_mfma_f32_16x16x32_bf16 v[164:167], a[176:179], a[116:119], v[164:167]
  s_waitcnt lgkmcnt(11)
  buffer_load_dwordx4 v135, s[24:27], s8 offen offset:2048 lds
  ds_read_b64_tr_b16 a[214:215], v246 offset:61440
  v_mfma_f32_16x16x32_bf16 v[172:175], a[184:187], a[116:119], v[172:175]
  ds_read_b64_tr_b16 a[176:177], v247 offset:49152
  v_and_b32 v95, 0xffff0000, v131
  v_mfma_f32_16x16x32_bf16 v[172:175], a[188:191], a[124:127], v[172:175]
  s_add_u32 s49, s72, 32768
  ds_read_b64_tr_b16 a[178:179], v247 offset:53248
  s_lshl_b32 s28, s2, 5
  v_mfma_f32_16x16x32_bf16 v[168:171], a[188:191], a[120:123], v[168:171]
  s_add_u32 s28, s28, s44
  ds_read_b64_tr_b16 a[180:181], v247 offset:57344
  s_lshl2_add_u32 s28, s28, 5472256
  v_mfma_f32_16x16x32_bf16 v[168:171], a[184:187], a[112:115], v[168:171]
  s_waitcnt vmcnt(22) lgkmcnt(11)
  buffer_load_dwordx4 a[40:43], v137, s[36:39], s9 offen offset:2048 sc1
  ds_read_b64_tr_b16 a[182:183], v247 offset:61440
  v_mfma_f32_16x16x32_bf16 v[32:35], a[192:195], a[216:219], v[32:35]
  s_xor_b32 s29, s28, 128
  ds_read_b64_tr_b16 a[184:185], v244 offset:51200
  v_mov_b32 v132, 0
  v_mfma_f32_16x16x32_bf16 v[32:35], a[196:199], a[224:227], v[32:35]
  ds_read_b64_tr_b16 a[186:187], v244 offset:55296
  v_mfma_f32_16x16x32_bf16 v[36:39], a[196:199], a[228:231], v[36:39]
  buffer_load_dwordx4 v136, s[24:27], s8 offen offset:3072 lds
  ds_read_b64_tr_b16 a[188:189], v244 offset:59392
  v_mfma_f32_16x16x32_bf16 v[36:39], a[192:195], a[220:223], v[36:39]
  s_waitcnt lgkmcnt(11)
  ds_read_b64_tr_b16 a[190:191], v244 offset:63488
  v_mfma_f32_16x16x32_bf16 v[44:47], a[200:203], a[220:223], v[44:47]
  ds_read_b64_tr_b16 a[192:193], v245 offset:51200
  v_mfma_f32_16x16x32_bf16 v[44:47], a[204:207], a[228:231], v[44:47]
  ds_read_b64_tr_b16 a[194:195], v245 offset:55296
  v_mfma_f32_16x16x32_bf16 v[40:43], a[204:207], a[224:227], v[40:43]
  buffer_load_dwordx4 a[44:47], v137, s[36:39], s9 offen offset:3072 sc1
  s_cmp_eq_u32 s52, 1
  v_mfma_f32_16x16x32_bf16 v[40:43], a[200:203], a[216:219], v[40:43]
  s_waitcnt vmcnt(17) lgkmcnt(10)
  s_barrier
  s_cselect_b32 s15, 19, 5
  v_mfma_f32_16x16x32_bf16 v[48:51], a[208:211], a[216:219], v[48:51]
  s_lshl_b32 s8, s15, 16
  s_add_u32 m0, s73, 32768
  ds_read_b64_tr_b16 a[196:197], v245 offset:59392
  v_mfma_f32_16x16x32_bf16 v[48:51], a[212:215], a[224:227], v[48:51]
  ds_read_b64_tr_b16 a[198:199], v245 offset:63488
  ds_read_b64_tr_b16 a[200:201], v246 offset:51200
  v_mfma_f32_16x16x32_bf16 v[52:55], a[212:215], a[228:231], v[52:55]
  ds_read_b64_tr_b16 a[202:203], v246 offset:55296
  buffer_load_dwordx4 v133, s[24:27], s8 offen offset:0 lds
  v_mfma_f32_16x16x32_bf16 v[52:55], a[208:211], a[220:223], v[52:55]
  s_waitcnt lgkmcnt(10)
  s_lshl_b32 s9, s15, 11
  ds_read_b64_tr_b16 a[204:205], v246 offset:59392
  v_mfma_f32_16x16x32_bf16 v[60:63], a[176:179], a[220:223], v[60:63]
  ds_read_b64_tr_b16 a[206:207], v246 offset:63488
  ds_read_b64_tr_b16 a[208:209], v247 offset:51200
  v_mfma_f32_16x16x32_bf16 v[60:63], a[180:183], a[228:231], v[60:63]
  ds_read_b64_tr_b16 a[210:211], v247 offset:55296
  v_mfma_f32_16x16x32_bf16 v[56:59], a[180:183], a[224:227], v[56:59]
  buffer_load_dwordx4 a[48:51], v137, s[36:39], s9 offen offset:0 sc1
  ds_read_b64_tr_b16 a[212:213], v247 offset:59392
  v_mfma_f32_16x16x32_bf16 v[56:59], a[176:179], a[216:219], v[56:59]
  s_waitcnt lgkmcnt(11)
  ds_read_b64_tr_b16 a[214:215], v247 offset:63488
  v_mfma_f32_16x16x32_bf16 v[144:147], a[184:187], a[216:219], v[144:147]
  ds_read_b64_tr_b16 a[176:177], v248 offset:0
  v_mfma_f32_16x16x32_bf16 v[144:147], a[188:191], a[224:227], v[144:147]
  ds_read_b64_tr_b16 a[178:179], v248 offset:4096
  v_mfma_f32_16x16x32_bf16 v[148:151], a[188:191], a[228:231], v[148:151]
  buffer_load_dwordx4 v134, s[24:27], s8 offen offset:1024 lds
  ds_read_b64_tr_b16 a[180:181], v248 offset:8192
  v_mfma_f32_16x16x32_bf16 v[148:151], a[184:187], a[220:223], v[148:151]
  s_waitcnt lgkmcnt(11)
  ds_read_b64_tr_b16 a[182:183], v248 offset:12288
  v_mfma_f32_16x16x32_bf16 v[156:159], a[192:195], a[220:223], v[156:159]
  ds_read_b64_tr_b16 a[184:185], v249 offset:0
  v_mfma_f32_16x16x32_bf16 v[156:159], a[196:199], a[228:231], v[156:159]
  buffer_load_dwordx4 a[52:55], v137, s[36:39], s9 offen offset:1024 sc1
  ds_read_b64_tr_b16 a[186:187], v249 offset:4096
  v_mfma_f32_16x16x32_bf16 v[152:155], a[196:199], a[224:227], v[152:155]
  ds_read_b64_tr_b16 a[188:189], v249 offset:8192
  v_mfma_f32_16x16x32_bf16 v[152:155], a[192:195], a[216:219], v[152:155]
  s_waitcnt lgkmcnt(11)
  ds_read_b64_tr_b16 a[190:191], v249 offset:12288
  v_mfma_f32_16x16x32_bf16 v[160:163], a[200:203], a[216:219], v[160:163]
  ds_read_b64_tr_b16 a[192:193], v250 offset:0
  v_mfma_f32_16x16x32_bf16 v[160:163], a[204:207], a[224:227], v[160:163]
  buffer_load_dwordx4 v135, s[24:27], s8 offen offset:2048 lds
  ds_read_b64_tr_b16 a[194:195], v250 offset:4096
  v_mfma_f32_16x16x32_bf16 v[164:167], a[204:207], a[228:231], v[164:167]
  ds_read_b64_tr_b16 a[196:197], v250 offset:8192
  v_mfma_f32_16x16x32_bf16 v[164:167], a[200:203], a[220:223], v[164:167]
  s_waitcnt lgkmcnt(11)
  ds_read_b64_tr_b16 a[198:199], v250 offset:12288
  v_mfma_f32_16x16x32_bf16 v[172:175], a[208:211], a[220:223], v[172:175]
  ds_read_b64_tr_b16 a[200:201], v251 offset:0
  v_mfma_f32_16x16x32_bf16 v[172:175], a[212:215], a[228:231], v[172:175]
  buffer_load_dwordx4 a[56:59], v137, s[36:39], s9 offen offset:2048 sc1
  ds_read_b64_tr_b16 a[202:203], v251 offset:4096
  v_mfma_f32_16x16x32_bf16 v[168:171], a[212:215], a[224:227], v[168:171]
  ds_read_b64_tr_b16 a[204:205], v251 offset:8192
  v_mfma_f32_16x16x32_bf16 v[168:171], a[208:211], a[216:219], v[168:171]
  s_waitcnt vmcnt(22) lgkmcnt(11)
  ds_read_b64_tr_b16 a[206:207], v251 offset:12288
  v_mfma_f32_16x16x32_bf16 v[32:35], a[176:179], a[0:3], v[32:35]
  ds_read_b64_tr_b16 a[208:209], v248 offset:2048
  v_mfma_f32_16x16x32_bf16 v[32:35], a[180:183], a[8:11], v[32:35]
  buffer_load_dwordx4 v136, s[24:27], s8 offen offset:3072 lds
  ds_read_b64_tr_b16 a[210:211], v248 offset:6144
  v_mfma_f32_16x16x32_bf16 v[36:39], a[180:183], a[12:15], v[36:39]
  ds_read_b64_tr_b16 a[212:213], v248 offset:10240
  v_mfma_f32_16x16x32_bf16 v[36:39], a[176:179], a[4:7], v[36:39]
  s_waitcnt lgkmcnt(11)
  ds_read_b64_tr_b16 a[214:215], v248 offset:14336
  v_mfma_f32_16x16x32_bf16 v[44:47], a[184:187], a[4:7], v[44:47]
  ds_read_b64_tr_b16 a[176:177], v249 offset:2048
  v_mfma_f32_16x16x32_bf16 v[44:47], a[188:191], a[12:15], v[44:47]
  buffer_load_dwordx4 a[60:63], v137, s[36:39], s9 offen offset:3072 sc1
  s_cmp_eq_u32 s52, 2
  v_mfma_f32_16x16x32_bf16 v[40:43], a[188:191], a[8:11], v[40:43]
  s_cselect_b32 s40, 22, 8
  s_lshl_b32 s8, s40, 16
  s_add_u32 m0, s73, 49152
  v_mfma_f32_16x16x32_bf16 v[40:43], a[184:187], a[0:3], v[40:43]
  s_waitcnt vmcnt(17) lgkmcnt(9)
  s_barrier
  ds_read_b64_tr_b16 a[178:179], v249 offset:6144
  v_mfma_f32_16x16x32_bf16 v[48:51], a[192:195], a[0:3], v[48:51]
  ds_read_b64_tr_b16 a[180:181], v249 offset:10240
  ds_read_b64_tr_b16 a[182:183], v249 offset:14336
  v_mfma_f32_16x16x32_bf16 v[48:51], a[196:199], a[8:11], v[48:51]
  buffer_load_dwordx4 v133, s[24:27], s8 offen offset:0 lds
  s_lshl_b32 s9, s40, 11
  v_mfma_f32_16x16x32_bf16 v[52:55], a[196:199], a[12:15], v[52:55]
  ds_read_b64_tr_b16 a[184:185], v250 offset:2048
  ds_read_b64_tr_b16 a[186:187], v250 offset:6144
  v_mfma_f32_16x16x32_bf16 v[52:55], a[192:195], a[4:7], v[52:55]
  s_waitcnt lgkmcnt(10)
  ds_read_b64_tr_b16 a[188:189], v250 offset:10240
  ds_read_b64_tr_b16 a[190:191], v250 offset:14336
  v_mfma_f32_16x16x32_bf16 v[60:63], a[200:203], a[4:7], v[60:63]
  buffer_load_dwordx4 a[64:67], v137, s[36:39], s9 offen offset:0 sc1
  ds_read_b64_tr_b16 a[192:193], v251 offset:2048
  v_mfma_f32_16x16x32_bf16 v[60:63], a[204:207], a[12:15], v[60:63]
  ds_read_b64_tr_b16 a[194:195], v251 offset:6144
  v_mfma_f32_16x16x32_bf16 v[56:59], a[204:207], a[8:11], v[56:59]
  ds_read_b64_tr_b16 a[196:197], v251 offset:10240
  v_mfma_f32_16x16x32_bf16 v[56:59], a[200:203], a[0:3], v[56:59]
  s_waitcnt lgkmcnt(11)
  ds_read_b64_tr_b16 a[198:199], v251 offset:14336
  v_mfma_f32_16x16x32_bf16 v[144:147], a[208:211], a[0:3], v[144:147]
  buffer_load_dwordx4 v134, s[24:27], s8 offen offset:1024 lds
  ds_read_b64_tr_b16 a[200:201], v240 offset:0
  v_mfma_f32_16x16x32_bf16 v[144:147], a[212:215], a[8:11], v[144:147]
  ds_read_b64_tr_b16 a[202:203], v240 offset:4096
  v_mfma_f32_16x16x32_bf16 v[148:151], a[212:215], a[12:15], v[148:151]
  ds_read_b64_tr_b16 a[204:205], v240 offset:8192
  v_mfma_f32_16x16x32_bf16 v[148:151], a[208:211], a[4:7], v[148:151]
  s_waitcnt lgkmcnt(11)
  ds_read_b64_tr_b16 a[206:207], v240 offset:12288
  v_mfma_f32_16x16x32_bf16 v[156:159], a[176:179], a[4:7], v[156:159]
  buffer_load_dwordx4 a[68:71], v137, s[36:39], s9 offen offset:1024 sc1
  ds_read_b64_tr_b16 a[208:209], v241 offset:0
  v_mfma_f32_16x16x32_bf16 v[156:159], a[180:183], a[12:15], v[156:159]
  ds_read_b64_tr_b16 a[210:211], v241 offset:4096
  v_mfma_f32_16x16x32_bf16 v[152:155], a[180:183], a[8:11], v[152:155]
  ds_read_b64_tr_b16 a[212:213], v241 offset:8192
  v_mfma_f32_16x16x32_bf16 v[152:155], a[176:179], a[0:3], v[152:155]
  s_waitcnt lgkmcnt(11)
  ds_read_b64_tr_b16 a[214:215], v241 offset:12288
  v_mfma_f32_16x16x32_bf16 v[160:163], a[184:187], a[0:3], v[160:163]
  buffer_load_dwordx4 v135, s[24:27], s8 offen offset:2048 lds
  ds_read_b64_tr_b16 a[176:177], v242 offset:0
  v_mfma_f32_16x16x32_bf16 v[160:163], a[188:191], a[8:11], v[160:163]
  ds_read_b64_tr_b16 a[178:179], v242 offset:4096
  v_mfma_f32_16x16x32_bf16 v[164:167], a[188:191], a[12:15], v[164:167]
  ds_read_b64_tr_b16 a[180:181], v242 offset:8192
  v_mfma_f32_16x16x32_bf16 v[164:167], a[184:187], a[4:7], v[164:167]
  s_waitcnt lgkmcnt(11)
  buffer_load_dwordx4 a[72:75], v137, s[36:39], s9 offen offset:2048 sc1
  ds_read_b64_tr_b16 a[182:183], v242 offset:12288
  v_mfma_f32_16x16x32_bf16 v[172:175], a[192:195], a[4:7], v[172:175]
  ds_read_b64_tr_b16 a[184:185], v243 offset:0
  v_mfma_f32_16x16x32_bf16 v[172:175], a[196:199], a[12:15], v[172:175]
  ds_read_b64_tr_b16 a[186:187], v243 offset:4096
  v_mfma_f32_16x16x32_bf16 v[168:171], a[196:199], a[8:11], v[168:171]
  ds_read_b64_tr_b16 a[188:189], v243 offset:8192
  v_mfma_f32_16x16x32_bf16 v[168:171], a[192:195], a[0:3], v[168:171]
  s_waitcnt vmcnt(22) lgkmcnt(11)
  buffer_load_dwordx4 v136, s[24:27], s8 offen offset:3072 lds
  ds_read_b64_tr_b16 a[190:191], v243 offset:12288
  v_mfma_f32_16x16x32_bf16 v[32:35], a[200:203], a[16:19], v[32:35]
  ds_read_b64_tr_b16 a[192:193], v240 offset:2048
  v_mfma_f32_16x16x32_bf16 v[32:35], a[204:207], a[24:27], v[32:35]
  ds_read_b64_tr_b16 a[194:195], v240 offset:6144
  v_mfma_f32_16x16x32_bf16 v[36:39], a[204:207], a[28:31], v[36:39]
  ds_read_b64_tr_b16 a[196:197], v240 offset:10240
  v_mfma_f32_16x16x32_bf16 v[36:39], a[200:203], a[20:23], v[36:39]
  s_waitcnt lgkmcnt(11)
  buffer_load_dwordx4 a[76:79], v137, s[36:39], s9 offen offset:3072 sc1
  s_cmp_eq_u32 s52, 3
  v_mfma_f32_16x16x32_bf16 v[44:47], a[208:211], a[20:23], v[44:47]
  s_cselect_b32 s41, 26, 12
  s_lshl_b32 s8, s41, 16
  s_add_u32 m0, s73, 65536
  v_mfma_f32_16x16x32_bf16 v[44:47], a[212:215], a[28:31], v[44:47]
  ds_read_b64_tr_b16 a[198:199], v240 offset:14336
  ds_read_b64_tr_b16 a[200:201], v241 offset:2048
  v_mfma_f32_16x16x32_bf16 v[40:43], a[212:215], a[24:27], v[40:43]
  ds_read_b64_tr_b16 a[202:203], v241 offset:6144
  ds_read_b64_tr_b16 a[204:205], v241 offset:10240
  v_mfma_f32_16x16x32_bf16 v[40:43], a[208:211], a[16:19], v[40:43]
  s_waitcnt vmcnt(17) lgkmcnt(11)
  s_barrier
  buffer_load_dwordx4 v133, s[24:27], s8 offen offset:0 lds
  v_mfma_f32_16x16x32_bf16 v[48:51], a[176:179], a[16:19], v[48:51]
  s_lshl_b32 s9, s41, 11
  ds_read_b64_tr_b16 a[206:207], v241 offset:14336
  ds_read_b64_tr_b16 a[208:209], v242 offset:2048
  v_mfma_f32_16x16x32_bf16 v[48:51], a[180:183], a[24:27], v[48:51]
  ds_read_b64_tr_b16 a[210:211], v242 offset:6144
  v_mfma_f32_16x16x32_bf16 v[52:55], a[180:183], a[28:31], v[52:55]
  ds_read_b64_tr_b16 a[212:213], v242 offset:10240
  v_mfma_f32_16x16x32_bf16 v[52:55], a[176:179], a[20:23], v[52:55]
  s_waitcnt lgkmcnt(11)
  buffer_load_dwordx4 a[80:83], v137, s[36:39], s9 offen offset:0 sc1
  ds_read_b64_tr_b16 a[214:215], v242 offset:14336
  v_mfma_f32_16x16x32_bf16 v[60:63], a[184:187], a[20:23], v[60:63]
  ds_read_b64_tr_b16 a[176:177], v243 offset:2048
  v_mfma_f32_16x16x32_bf16 v[60:63], a[188:191], a[28:31], v[60:63]
  ds_read_b64_tr_b16 a[178:179], v243 offset:6144
  v_mfma_f32_16x16x32_bf16 v[56:59], a[188:191], a[24:27], v[56:59]
  buffer_load_dwordx4 v134, s[24:27], s8 offen offset:1024 lds
  ds_read_b64_tr_b16 a[180:181], v243 offset:10240
  v_mfma_f32_16x16x32_bf16 v[56:59], a[184:187], a[16:19], v[56:59]
  s_waitcnt lgkmcnt(11)
  ds_read_b64_tr_b16 a[182:183], v243 offset:14336
  v_mfma_f32_16x16x32_bf16 v[144:147], a[192:195], a[16:19], v[144:147]
  ds_read_b64_tr_b16 a[184:185], v240 offset:16384
  v_mfma_f32_16x16x32_bf16 v[144:147], a[196:199], a[24:27], v[144:147]
  ds_read_b64_tr_b16 a[186:187], v240 offset:20480
  v_mfma_f32_16x16x32_bf16 v[148:151], a[196:199], a[28:31], v[148:151]
  buffer_load_dwordx4 a[84:87], v137, s[36:39], s9 offen offset:1024 sc1
  ds_read_b64_tr_b16 a[188:189], v240 offset:24576
  v_mfma_f32_16x16x32_bf16 v[148:151], a[192:195], a[20:23], v[148:151]
  s_waitcnt lgkmcnt(11)
  ds_read_b64_tr_b16 a[190:191], v240 offset:28672
  v_mfma_f32_16x16x32_bf16 v[156:159], a[200:203], a[20:23], v[156:159]
  ds_read_b64_tr_b16 a[192:193], v241 offset:16384
  v_mfma_f32_16x16x32_bf16 v[156:159], a[204:207], a[28:31], v[156:159]
  ds_read_b64_tr_b16 a[194:195], v241 offset:20480
  v_mfma_f32_16x16x32_bf16 v[152:155], a[204:207], a[24:27], v[152:155]
  buffer_load_dwordx4 v135, s[24:27], s8 offen offset:2048 lds
  ds_read_b64_tr_b16 a[196:197], v241 offset:24576
  v_mfma_f32_16x16x32_bf16 v[152:155], a[200:203], a[16:19], v[152:155]
  s_waitcnt lgkmcnt(11)
  ds_read_b64_tr_b16 a[198:199], v241 offset:28672
  v_mfma_f32_16x16x32_bf16 v[160:163], a[208:211], a[16:19], v[160:163]
  ds_read_b64_tr_b16 a[200:201], v242 offset:16384
  v_mfma_f32_16x16x32_bf16 v[160:163], a[212:215], a[24:27], v[160:163]
  ds_read_b64_tr_b16 a[202:203], v242 offset:20480
  v_mfma_f32_16x16x32_bf16 v[164:167], a[212:215], a[28:31], v[164:167]
  buffer_load_dwordx4 a[88:91], v137, s[36:39], s9 offen offset:2048 sc1
  ds_read_b64_tr_b16 a[204:205], v242 offset:24576
  v_mfma_f32_16x16x32_bf16 v[164:167], a[208:211], a[20:23], v[164:167]
  s_waitcnt lgkmcnt(11)
  ds_read_b64_tr_b16 a[206:207], v242 offset:28672
  v_mfma_f32_16x16x32_bf16 v[172:175], a[176:179], a[20:23], v[172:175]
  ds_read_b64_tr_b16 a[208:209], v243 offset:16384
CT25:
  s_add_u32 s94, s92, CT25-k3_main_kernel+3072
  s_addc_u32 s95, s93, 0
  v_mfma_f32_16x16x32_bf16 v[172:175], a[180:183], a[28:31], v[172:175]
  global_load_dword a252, v0, s[94:95]
  ds_read_b64_tr_b16 a[210:211], v243 offset:20480
  v_mfma_f32_16x16x32_bf16 v[168:171], a[180:183], a[24:27], v[168:171]
  ds_read_b64_tr_b16 a[212:213], v243 offset:24576
  v_mfma_f32_16x16x32_bf16 v[168:171], a[176:179], a[16:19], v[168:171]
  s_waitcnt vmcnt(23) lgkmcnt(11)
  ds_read_b64_tr_b16 a[214:215], v243 offset:28672
  v_mfma_f32_16x16x32_bf16 v[32:35], a[184:187], a[32:35], v[32:35]
  buffer_load_dwordx4 v136, s[24:27], s8 offen offset:3072 lds
  ds_read_b64_tr_b16 a[176:177], v240 offset:18432
  v_mfma_f32_16x16x32_bf16 v[32:35], a[188:191], a[40:43], v[32:35]
  ds_read_b64_tr_b16 a[178:179], v240 offset:22528
  v_mfma_f32_16x16x32_bf16 v[36:39], a[188:191], a[44:47], v[36:39]
  ds_read_b64_tr_b16 a[180:181], v240 offset:26624
  v_mfma_f32_16x16x32_bf16 v[36:39], a[184:187], a[36:39], v[36:39]
  s_waitcnt lgkmcnt(11)
  buffer_load_dwordx4 a[92:95], v137, s[36:39], s9 offen offset:3072 sc1
  s_cmp_eq_u32 s52, 0
  v_mfma_f32_16x16x32_bf16 v[44:47], a[192:195], a[36:39], v[44:47]
  s_cselect_b32 s42, 29, 15
  s_lshl_b32 s8, s42, 16
  s_add_u32 m0, s73, 81920
  v_mfma_f32_16x16x32_bf16 v[44:47], a[196:199], a[44:47], v[44:47]
  ds_read_b64_tr_b16 a[182:183], v240 offset:30720
  ds_read_b64_tr_b16 a[184:185], v241 offset:18432
  v_mfma_f32_16x16x32_bf16 v[40:43], a[196:199], a[40:43], v[40:43]
  buffer_load_dwordx4 v133, s[24:27], s8 offen offset:0 lds
  s_lshl_b32 s9, s42, 11
  v_mfma_f32_16x16x32_bf16 v[40:43], a[192:195], a[32:35], v[40:43]
  s_waitcnt vmcnt(19) lgkmcnt(9)
  s_barrier
  ds_read_b64_tr_b16 a[186:187], v241 offset:22528
  v_mfma_f32_16x16x32_bf16 v[48:51], a[200:203], a[32:35], v[48:51]
  ds_read_b64_tr_b16 a[188:189], v241 offset:26624
  ds_read_b64_tr_b16 a[190:191], v241 offset:30720
  v_mfma_f32_16x16x32_bf16 v[48:51], a[204:207], a[40:43], v[48:51]
  ds_read_b64_tr_b16 a[192:193], v242 offset:18432
  buffer_load_dwordx4 a[96:99], v137, s[36:39], s9 offen offset:0 sc1
  v_mfma_f32_16x16x32_bf16 v[52:55], a[204:207], a[44:47], v[52:55]
  ds_read_b64_tr_b16 a[194:195], v242 offset:22528
  ds_read_b64_tr_b16 a[196:197], v242 offset:26624
  v_mfma_f32_16x16x32_bf16 v[52:55], a[200:203], a[36:39], v[52:55]
  s_waitcnt lgkmcnt(11)
  ds_read_b64_tr_b16 a[198:199], v242 offset:30720
  v_mfma_f32_16x16x32_bf16 v[60:63], a[208:211], a[36:39], v[60:63]
  ds_read_b64_tr_b16 a[200:201], v243 offset:18432
  v_mfma_f32_16x16x32_bf16 v[60:63], a[212:215], a[44:47], v[60:63]
  buffer_load_dwordx4 v134, s[24:27], s8 offen offset:1024 lds
  ds_read_b64_tr_b16 a[202:203], v243 offset:22528
  v_mfma_f32_16x16x32_bf16 v[56:59], a[212:215], a[40:43], v[56:59]
  ds_read_b64_tr_b16 a[204:205], v243 offset:26624
  v_mfma_f32_16x16x32_bf16 v[56:59], a[208:211], a[32:35], v[56:59]
  s_waitcnt lgkmcnt(11)
  ds_read_b64_tr_b16 a[206:207], v243 offset:30720
  v_mfma_f32_16x16x32_bf16 v[144:147], a[176:179], a[32:35], v[144:147]
  ds_read_b64_tr_b16 a[208:209], v240 offset:32768
  v_mfma_f32_16x16x32_bf16 v[144:147], a[180:183], a[40:43], v[144:147]
  buffer_load_dwordx4 a[100:103], v137, s[36:39], s9 offen offset:1024 sc1
  ds_read_b64_tr_b16 a[210:211], v240 offset:36864
  v_mfma_f32_16x16x32_bf16 v[148:151], a[180:183], a[44:47], v[148:151]
  ds_read_b64_tr_b16 a[212:213], v240 offset:40960
  v_mfma_f32_16x16x32_bf16 v[148:151], a[176:179], a[36:39], v[148:151]
  s_waitcnt lgkmcnt(11)
  ds_read_b64_tr_b16 a[214:215], v240 offset:45056
  v_mfma_f32_16x16x32_bf16 v[156:159], a[184:187], a[36:39], v[156:159]
  buffer_load_dwordx4 v135, s[24:27], s8 offen offset:2048 lds
  ds_read_b64_tr_b16 a[176:177], v241 offset:32768
  v_mfma_f32_16x16x32_bf16 v[156:159], a[188:191], a[44:47], v[156:159]
  ds_read_b64_tr_b16 a[178:179], v241 offset:36864
  v_mfma_f32_16x16x32_bf16 v[152:155], a[188:191], a[40:43], v[152:155]
  ds_read_b64_tr_b16 a[180:181], v241 offset:40960
  v_mfma_f32_16x16x32_bf16 v[152:155], a[184:187], a[32:35], v[152:155]
  s_waitcnt lgkmcnt(11)
  ds_read_b64_tr_b16 a[182:183], v241 offset:45056
  v_mfma_f32_16x16x32_bf16 v[160:163], a[192:195], a[32:35], v[160:163]
  buffer_load_dwordx4 a[104:107], v137, s[36:39], s9 offen offset:2048 sc1
  ds_read_b64_tr_b16 a[184:185], v242 offset:32768
  v_mfma_f32_16x16x32_bf16 v[160:163], a[196:199], a[40:43], v[160:163]
  ds_read_b64_tr_b16 a[186:187], v242 offset:36864
  v_mfma_f32_16x16x32_bf16 v[164:167], a[196:199], a[44:47], v[164:167]
  ds_read_b64_tr_b16 a[188:189], v242 offset:40960
  v_mfma_f32_16x16x32_bf16 v[164:167], a[192:195], a[36:39], v[164:167]
  s_waitcnt lgkmcnt(11)
  ds_read_b64_tr_b16 a[190:191], v242 offset:45056
  v_mfma_f32_16x16x32_bf16 v[172:175], a[200:203], a[36:39], v[172:175]
  buffer_load_dwordx4 v136, s[24:27], s8 offen offset:3072 lds
  ds_read_b64_tr_b16 a[192:193], v243 offset:32768
  v_mfma_f32_16x16x32_bf16 v[172:175], a[204:207], a[44:47], v[172:175]
  ds_read_b64_tr_b16 a[194:195], v243 offset:36864
  v_mfma_f32_16x16x32_bf16 v[168:171], a[204:207], a[40:43], v[168:171]
  ds_read_b64_tr_b16 a[196:197], v243 offset:40960
  v_mfma_f32_16x16x32_bf16 v[168:171], a[200:203], a[32:35], v[168:171]
  s_waitcnt vmcnt(24) lgkmcnt(11)
  ds_read_b64_tr_b16 a[198:199], v243 offset:45056
  v_mfma_f32_16x16x32_bf16 v[32:35], a[208:211], a[48:51], v[32:35]
  buffer_load_dwordx4 a[108:111], v137, s[36:39], s9 offen offset:3072 sc1
  s_cmp_eq_u32 s52, 1
  v_mfma_f32_16x16x32_bf16 v[32:35], a[212:215], a[56:59], v[32:35]
  s_cselect_b32 s43, 33, 19
  s_lshl_b32 s8, s43, 16
  s_add_u32 m0, s73, 98304
  v_mfma_f32_16x16x32_bf16 v[36:39], a[212:215], a[60:63], v[36:39]
  ds_read_b64_tr_b16 a[200:201], v240 offset:34816
  ds_read_b64_tr_b16 a[202:203], v240 offset:38912
  v_mfma_f32_16x16x32_bf16 v[36:39], a[208:211], a[52:55], v[36:39]
  s_waitcnt lgkmcnt(10)
  ds_read_b64_tr_b16 a[204:205], v240 offset:43008
  ds_read_b64_tr_b16 a[206:207], v240 offset:47104
  v_mfma_f32_16x16x32_bf16 v[44:47], a[176:179], a[52:55], v[44:47]
  buffer_load_dwordx4 v133, s[24:27], s8 offen offset:0 lds
  s_lshl_b32 s9, s43, 11
  v_mfma_f32_16x16x32_bf16 v[44:47], a[180:183], a[60:63], v[44:47]
  ds_read_b64_tr_b16 a[208:209], v241 offset:34816
  ds_read_b64_tr_b16 a[210:211], v241 offset:38912
  v_mfma_f32_16x16x32_bf16 v[40:43], a[180:183], a[56:59], v[40:43]
  ds_read_b64_tr_b16 a[212:213], v241 offset:43008
  v_mfma_f32_16x16x32_bf16 v[40:43], a[176:179], a[48:51], v[40:43]
  s_waitcnt vmcnt(19) lgkmcnt(11)
  s_barrier
  ds_read_b64_tr_b16 a[214:215], v241 offset:47104
  v_mfma_f32_16x16x32_bf16 v[48:51], a[184:187], a[48:51], v[48:51]
  buffer_load_dwordx4 a[112:115], v137, s[36:39], s9 offen offset:0 sc1
  ds_read_b64_tr_b16 a[176:177], v242 offset:34816
  v_mfma_f32_16x16x32_bf16 v[48:51], a[188:191], a[56:59], v[48:51]
  ds_read_b64_tr_b16 a[178:179], v242 offset:38912
  v_mfma_f32_16x16x32_bf16 v[52:55], a[188:191], a[60:63], v[52:55]
  ds_read_b64_tr_b16 a[180:181], v242 offset:43008
  v_mfma_f32_16x16x32_bf16 v[52:55], a[184:187], a[52:55], v[52:55]
  s_waitcnt lgkmcnt(11)
  buffer_load_dwordx4 v134, s[24:27], s8 offen offset:1024 lds
  ds_read_b64_tr_b16 a[182:183], v242 offset:47104
  v_mfma_f32_16x16x32_bf16 v[60:63], a[192:195], a[52:55], v[60:63]
  ds_read_b64_tr_b16 a[184:185], v243 offset:34816
  v_mfma_f32_16x16x32_bf16 v[60:63], a[196:199], a[60:63], v[60:63]
  ds_read_b64_tr_b16 a[186:187], v243 offset:38912
  v_mfma_f32_16x16x32_bf16 v[56:59], a[196:199], a[56:59], v[56:59]
  ds_read_b64_tr_b16 a[188:189], v243 offset:43008
  v_mfma_f32_16x16x32_bf16 v[56:59], a[192:195], a[48:51], v[56:59]
  s_waitcnt lgkmcnt(11)
  buffer_load_dwordx4 a[116:119], v137, s[36:39], s9 offen offset:1024 sc1
  ds_read_b64_tr_b16 a[190:191], v243 offset:47104
  v_mfma_f32_16x16x32_bf16 v[144:147], a[200:203], a[48:51], v[144:147]
  ds_read_b64_tr_b16 a[192:193], v240 offset:49152
  v_mfma_f32_16x16x32_bf16 v[144:147], a[204:207], a[56:59], v[144:147]
  ds_read_b64_tr_b16 a[194:195], v240 offset:53248
  v_mfma_f32_16x16x32_bf16 v[148:151], a[204:207], a[60:63], v[148:151]
  ds_read_b64_tr_b16 a[196:197], v240 offset:57344
  v_mfma_f32_16x16x32_bf16 v[148:151], a[200:203], a[52:55], v[148:151]
  s_waitcnt lgkmcnt(11)
  buffer_load_dwordx4 v135, s[24:27], s8 offen offset:2048 lds
  ds_read_b64_tr_b16 a[198:199], v240 offset:61440
  v_mfma_f32_16x16x32_bf16 v[156:159], a[208:211], a[52:55], v[156:159]
  ds_read_b64_tr_b16 a[200:201], v241 offset:49152
  v_mfma_f32_16x16x32_bf16 v[156:159], a[212:215], a[60:63], v[156:159]
  ds_read_b64_tr_b16 a[202:203], v241 offset:53248
  v_mfma_f32_16x16x32_bf16 v[152:155], a[212:215], a[56:59], v[152:155]
  ds_read_b64_tr_b16 a[204:205], v241 offset:57344
  v_mfma_f32_16x16x32_bf16 v[152:155], a[208:211], a[48:51], v[152:155]
  s_waitcnt lgkmcnt(11)
  buffer_load_dwordx4 a[120:123], v137, s[36:39], s9 offen offset:2048 sc1
  ds_read_b64_tr_b16 a[206:207], v241 offset:61440
  v_mfma_f32_16x16x32_bf16 v[160:163], a[176:179], a[48:51], v[160:163]
  ds_read_b64_tr_b16 a[208:209], v242 offset:49152
  v_mfma_f32_16x16x32_bf16 v[160:163], a[180:183], a[56:59], v[160:163]
  ds_read_b64_tr_b16 a[210:211], v242 offset:53248
  v_mfma_f32_16x16x32_bf16 v[164:167], a[180:183], a[60:63], v[164:167]
  ds_read_b64_tr_b16 a[212:213], v242 offset:57344
  v_mfma_f32_16x16x32_bf16 v[164:167], a[176:179], a[52:55], v[164:167]
  s_waitcnt lgkmcnt(11)
  buffer_load_dwordx4 v136, s[24:27], s8 offen offset:3072 lds
  ds_read_b64_tr_b16 a[214:215], v242 offset:61440
  v_mfma_f32_16x16x32_bf16 v[172:175], a[184:187], a[52:55], v[172:175]
  ds_read_b64_tr_b16 a[176:177], v243 offset:49152
  v_mfma_f32_16x16x32_bf16 v[172:175], a[188:191], a[60:63], v[172:175]
  ds_read_b64_tr_b16 a[178:179], v243 offset:53248
  v_mfma_f32_16x16x32_bf16 v[168:171], a[188:191], a[56:59], v[168:171]
  buffer_load_dwordx4 a[124:127], v137, s[36:39], s9 offen offset:3072 sc1
  s_cmp_eq_u32 s52, 2
  v_mfma_f32_16x16x32_bf16 v[168:171], a[184:187], a[48:51], v[168:171]
  s_waitcnt vmcnt(25) lgkmcnt(10)
  s_cselect_b32 s50, 36, 22
  s_lshl_b32 s8, s50, 16
  v_mfma_f32_16x16x32_bf16 v[32:35], a[192:195], a[64:67], v[32:35]
  s_add_u32 m0, s73, 114688
  ds_read_b64_tr_b16 a[180:181], v243 offset:57344
  ds_read_b64_tr_b16 a[182:183], v243 offset:61440
  v_mfma_f32_16x16x32_bf16 v[32:35], a[196:199], a[72:75], v[32:35]
  ds_read_b64_tr_b16 a[184:185], v240 offset:51200
  ds_read_b64_tr_b16 a[186:187], v240 offset:55296
  v_mfma_f32_16x16x32_bf16 v[36:39], a[196:199], a[76:79], v[36:39]
  buffer_load_dwordx4 v133, s[24:27], s8 offen offset:0 lds
  s_lshl_b32 s9, s50, 11
  v_mfma_f32_16x16x32_bf16 v[36:39], a[192:195], a[68:71], v[36:39]
  s_waitcnt lgkmcnt(10)
  ds_read_b64_tr_b16 a[188:189], v240 offset:59392
  ds_read_b64_tr_b16 a[190:191], v240 offset:63488
  v_mfma_f32_16x16x32_bf16 v[44:47], a[200:203], a[68:71], v[44:47]
  ds_read_b64_tr_b16 a[192:193], v241 offset:51200
  v_mfma_f32_16x16x32_bf16 v[44:47], a[204:207], a[76:79], v[44:47]
  ds_read_b64_tr_b16 a[194:195], v241 offset:55296
  v_mfma_f32_16x16x32_bf16 v[40:43], a[204:207], a[72:75], v[40:43]
  buffer_load_dwordx4 a[216:219], v137, s[36:39], s9 offen offset:0 sc1
  ds_read_b64_tr_b16 a[196:197], v241 offset:59392
  v_mfma_f32_16x16x32_bf16 v[40:43], a[200:203], a[64:67], v[40:43]
  s_waitcnt vmcnt(19) lgkmcnt(11)
  s_barrier
  ds_read_b64_tr_b16 a[198:199], v241 offset:63488
  v_mfma_f32_16x16x32_bf16 v[48:51], a[208:211], a[64:67], v[48:51]
  ds_read_b64_tr_b16 a[200:201], v242 offset:51200
  v_mfma_f32_16x16x32_bf16 v[48:51], a[212:215], a[72:75], v[48:51]
  ds_read_b64_tr_b16 a[202:203], v242 offset:55296
  v_mfma_f32_16x16x32_bf16 v[52:55], a[212:215], a[76:79], v[52:55]
  buffer_load_dwordx4 v134, s[24:27], s8 offen offset:1024 lds
  ds_read_b64_tr_b16 a[204:205], v242 offset:59392
  v_mfma_f32_16x16x32_bf16 v[52:55], a[208:211], a[68:71], v[52:55]
  s_waitcnt lgkmcnt(11)
  ds_read_b64_tr_b16 a[206:207], v242 offset:63488
  v_mfma_f32_16x16x32_bf16 v[60:63], a[176:179], a[68:71], v[60:63]
  ds_read_b64_tr_b16 a[208:209], v243 offset:51200
  v_mfma_f32_16x16x32_bf16 v[60:63], a[180:183], a[76:79], v[60:63]
  ds_read_b64_tr_b16 a[210:211], v243 offset:55296
  v_mfma_f32_16x16x32_bf16 v[56:59], a[180:183], a[72:75], v[56:59]
  buffer_load_dwordx4 a[220:223], v137, s[36:39], s9 offen offset:1024 sc1
  ds_read_b64_tr_b16 a[212:213], v243 offset:59392
  v_mfma_f32_16x16x32_bf16 v[56:59], a[176:179], a[64:67], v[56:59]
  s_waitcnt lgkmcnt(11)
  ds_read_b64_tr_b16 a[214:215], v243 offset:63488
  v_mfma_f32_16x16x32_bf16 v[144:147], a[184:187], a[64:67], v[144:147]
  ds_read_b64_tr_b16 a[176:177], v244 offset:0
  v_mfma_f32_16x16x32_bf16 v[144:147], a[188:191], a[72:75], v[144:147]
  buffer_load_dwordx4 v135, s[24:27], s8 offen offset:2048 lds
  ds_read_b64_tr_b16 a[178:179], v244 offset:4096
  v_mfma_f32_16x16x32_bf16 v[148:151], a[188:191], a[76:79], v[148:151]
  ds_read_b64_tr_b16 a[180:181], v244 offset:8192
  v_mfma_f32_16x16x32_bf16 v[148:151], a[184:187], a[68:71], v[148:151]
  s_waitcnt lgkmcnt(11)
  ds_read_b64_tr_b16 a[182:183], v244 offset:12288
  v_mfma_f32_16x16x32_bf16 v[156:159], a[192:195], a[68:71], v[156:159]
  ds_read_b64_tr_b16 a[184:185], v245 offset:0
  v_mfma_f32_16x16x32_bf16 v[156:159], a[196:199], a[76:79], v[156:159]
  buffer_load_dwordx4 a[224:227], v137, s[36:39], s9 offen offset:2048 sc1
  ds_read_b64_tr_b16 a[186:187], v245 offset:4096
  v_mfma_f32_16x16x32_bf16 v[152:155], a[196:199], a[72:75], v[152:155]
  ds_read_b64_tr_b16 a[188:189], v245 offset:8192
  v_mfma_f32_16x16x32_bf16 v[152:155], a[192:195], a[64:67], v[152:155]
  s_waitcnt lgkmcnt(11)
  ds_read_b64_tr_b16 a[190:191], v245 offset:12288
  v_mfma_f32_16x16x32_bf16 v[160:163], a[200:203], a[64:67], v[160:163]
  ds_read_b64_tr_b16 a[192:193], v246 offset:0
  v_mfma_f32_16x16x32_bf16 v[160:163], a[204:207], a[72:75], v[160:163]
  buffer_load_dwordx4 v136, s[24:27], s8 offen offset:3072 lds
  ds_read_b64_tr_b16 a[194:195], v246 offset:4096
  v_mfma_f32_16x16x32_bf16 v[164:167], a[204:207], a[76:79], v[164:167]
  ds_read_b64_tr_b16 a[196:197], v246 offset:8192
  v_mfma_f32_16x16x32_bf16 v[164:167], a[200:203], a[68:71], v[164:167]
  s_waitcnt lgkmcnt(11)
  ds_read_b64_tr_b16 a[198:199], v246 offset:12288
  v_mfma_f32_16x16x32_bf16 v[172:175], a[208:211], a[68:71], v[172:175]
  ds_read_b64_tr_b16 a[200:201], v247 offset:0
  v_mfma_f32_16x16x32_bf16 v[172:175], a[212:215], a[76:79], v[172:175]
  buffer_load_dwordx4 a[228:231], v137, s[36:39], s9 offen offset:3072 sc1
  s_cmp_eq_u32 s52, 3
  v_mfma_f32_16x16x32_bf16 v[168:171], a[212:215], a[72:75], v[168:171]
  s_cselect_b32 s51, 40, 26
  s_lshl_b32 s8, s51, 16
  s_add_u32 m0, s73, 131072
  v_mfma_f32_16x16x32_bf16 v[168:171], a[208:211], a[64:67], v[168:171]
  s_waitcnt vmcnt(24) lgkmcnt(9)
  ds_read_b64_tr_b16 a[202:203], v247 offset:4096
  ds_read_b64_tr_b16 a[204:205], v247 offset:8192
  v_mfma_f32_16x16x32_bf16 v[32:35], a[176:179], a[80:83], v[32:35]
  ds_read_b64_tr_b16 a[206:207], v247 offset:12288
  ds_read_b64_tr_b16 a[208:209], v244 offset:2048
  v_mfma_f32_16x16x32_bf16 v[32:35], a[180:183], a[88:91], v[32:35]
  buffer_load_dwordx4 v133, s[24:27], s8 offen offset:0 lds
  s_lshl_b32 s9, s51, 11
  v_mfma_f32_16x16x32_bf16 v[36:39], a[180:183], a[92:95], v[36:39]
  ds_read_b64_tr_b16 a[210:211], v244 offset:6144
  ds_read_b64_tr_b16 a[212:213], v244 offset:10240
  v_mfma_f32_16x16x32_bf16 v[36:39], a[176:179], a[84:87], v[36:39]
  s_waitcnt lgkmcnt(11)
  ds_read_b64_tr_b16 a[214:215], v244 offset:14336
  v_mfma_f32_16x16x32_bf16 v[44:47], a[184:187], a[84:87], v[44:47]
  buffer_load_dwordx4 a[0:3], v137, s[36:39], s9 offen offset:0 sc1
  ds_read_b64_tr_b16 a[176:177], v245 offset:2048
  v_mfma_f32_16x16x32_bf16 v[44:47], a[188:191], a[92:95], v[44:47]
  ds_read_b64_tr_b16 a[178:179], v245 offset:6144
  v_mfma_f32_16x16x32_bf16 v[40:43], a[188:191], a[88:91], v[40:43]
  ds_read_b64_tr_b16 a[180:181], v245 offset:10240
  v_mfma_f32_16x16x32_bf16 v[40:43], a[184:187], a[80:83], v[40:43]
  s_waitcnt vmcnt(19) lgkmcnt(11)
  s_barrier
  ds_read_b64_tr_b16 a[182:183], v245 offset:14336
  v_mfma_f32_16x16x32_bf16 v[48:51], a[192:195], a[80:83], v[48:51]
  buffer_load_dwordx4 v134, s[24:27], s8 offen offset:1024 lds
  ds_read_b64_tr_b16 a[184:185], v246 offset:2048
  v_mfma_f32_16x16x32_bf16 v[48:51], a[196:199], a[88:91], v[48:51]
  ds_read_b64_tr_b16 a[186:187], v246 offset:6144
  v_mfma_f32_16x16x32_bf16 v[52:55], a[196:199], a[92:95], v[52:55]
  ds_read_b64_tr_b16 a[188:189], v246 offset:10240
  v_mfma_f32_16x16x32_bf16 v[52:55], a[192:195], a[84:87], v[52:55]
  s_waitcnt lgkmcnt(11)
  ds_read_b64_tr_b16 a[190:191], v246 offset:14336
  v_mfma_f32_16x16x32_bf16 v[60:63], a[200:203], a[84:87], v[60:63]
  buffer_load_dwordx4 a[4:7], v137, s[36:39], s9 offen offset:1024 sc1
  ds_read_b64_tr_b16 a[192:193], v247 offset:2048
  v_mfma_f32_16x16x32_bf16 v[60:63], a[204:207], a[92:95], v[60:63]
  ds_read_b64_tr_b16 a[194:195], v247 offset:6144
  v_mfma_f32_16x16x32_bf16 v[56:59], a[204:207], a[88:91], v[56:59]
  ds_read_b64_tr_b16 a[196:197], v247 offset:10240
  v_mfma_f32_16x16x32_bf16 v[56:59], a[200:203], a[80:83], v[56:59]
  s_waitcnt lgkmcnt(11)
  ds_read_b64_tr_b16 a[198:199], v247 offset:14336
  v_mfma_f32_16x16x32_bf16 v[144:147], a[208:211], a[80:83], v[144:147]
  buffer_load_dwordx4 v135, s[24:27], s8 offen offset:2048 lds
  ds_read_b64_tr_b16 a[200:201], v244 offset:16384
  v_mfma_f32_16x16x32_bf16 v[144:147], a[212:215], a[88:91], v[144:147]
  ds_read_b64_tr_b16 a[202:203], v244 offset:20480
  v_mfma_f32_16x16x32_bf16 v[148:151], a[212:215], a[92:95], v[148:151]
  ds_read_b64_tr_b16 a[204:205], v244 offset:24576
  v_mfma_f32_16x16x32_bf16 v[148:151], a[208:211], a[84:87], v[148:151]
  s_waitcnt lgkmcnt(11)
  ds_read_b64_tr_b16 a[206:207], v244 offset:28672
  v_mfma_f32_16x16x32_bf16 v[156:159], a[176:179], a[84:87], v[156:159]
  buffer_load_dwordx4 a[8:11], v137, s[36:39], s9 offen offset:2048 sc1
  ds_read_b64_tr_b16 a[208:209], v245 offset:16384
  v_mfma_f32_16x16x32_bf16 v[156:159], a[180:183], a[92:95], v[156:159]
  ds_read_b64_tr_b16 a[210:211], v245 offset:20480
  v_mfma_f32_16x16x32_bf16 v[152:155], a[180:183], a[88:91], v[152:155]
  ds_read_b64_tr_b16 a[212:213], v245 offset:24576
  v_mfma_f32_16x16x32_bf16 v[152:155], a[176:179], a[80:83], v[152:155]
  s_waitcnt lgkmcnt(11)
  buffer_load_dwordx4 v136, s[24:27], s8 offen offset:3072 lds
  ds_read_b64_tr_b16 a[214:215], v245 offset:28672
  v_mfma_f32_16x16x32_bf16 v[160:163], a[184:187], a[80:83], v[160:163]
  ds_read_b64_tr_b16 a[176:177], v246 offset:16384
  v_mfma_f32_16x16x32_bf16 v[160:163], a[188:191], a[88:91], v[160:163]
  ds_read_b64_tr_b16 a[178:179], v246 offset:20480
  v_mfma_f32_16x16x32_bf16 v[164:167], a[188:191], a[92:95], v[164:167]
  ds_read_b64_tr_b16 a[180:181], v246 offset:24576
  v_mfma_f32_16x16x32_bf16 v[164:167], a[184:187], a[84:87], v[164:167]
  s_waitcnt lgkmcnt(11)
  buffer_load_dwordx4 a[12:15], v137, s[36:39], s9 offen offset:3072 sc1
  s_cmp_eq_u32 s52, 0
  v_mfma_f32_16x16x32_bf16 v[172:175], a[192:195], a[84:87], v[172:175]
  s_cselect_b32 s12, 43, 29
  s_lshl_b32 s8, s12, 16
  s_add_u32 m0, s73, 0
  v_mfma_f32_16x16x32_bf16 v[172:175], a[196:199], a[92:95], v[172:175]
  ds_read_b64_tr_b16 a[182:183], v246 offset:28672
  ds_read_b64_tr_b16 a[184:185], v247 offset:16384
  v_mfma_f32_16x16x32_bf16 v[168:171], a[196:199], a[88:91], v[168:171]
  ds_read_b64_tr_b16 a[186:187], v247 offset:20480
  ds_read_b64_tr_b16 a[188:189], v247 offset:24576
  v_mfma_f32_16x16x32_bf16 v[168:171], a[192:195], a[80:83], v[168:171]
  s_waitcnt vmcnt(24) lgkmcnt(11)
  buffer_load_dwordx4 v133, s[24:27], s8 offen offset:0 lds
  s_lshl_b32 s9, s12, 11
  v_mfma_f32_16x16x32_bf16 v[32:35], a[200:203], a[96:99], v[32:35]
  ds_read_b64_tr_b16 a[190:191], v247 offset:28672
  ds_read_b64_tr_b16 a[192:193], v244 offset:18432
  v_mfma_f32_16x16x32_bf16 v[32:35], a[204:207], a[104:107], v[32:35]
  ds_read_b64_tr_b16 a[194:195], v244 offset:22528
  v_mfma_f32_16x16x32_bf16 v[36:39], a[204:207], a[108:111], v[36:39]
  ds_read_b64_tr_b16 a[196:197], v244 offset:26624
  v_mfma_f32_16x16x32_bf16 v[36:39], a[200:203], a[100:103], v[36:39]
  s_waitcnt lgkmcnt(11)
  buffer_load_dwordx4 a[16:19], v137, s[36:39], s9 offen offset:0 sc1
  ds_read_b64_tr_b16 a[198:199], v244 offset:30720
  v_mfma_f32_16x16x32_bf16 v[44:47], a[208:211], a[100:103], v[44:47]
  ds_read_b64_tr_b16 a[200:201], v245 offset:18432
  v_mfma_f32_16x16x32_bf16 v[44:47], a[212:215], a[108:111], v[44:47]
  ds_read_b64_tr_b16 a[202:203], v245 offset:22528
  v_mfma_f32_16x16x32_bf16 v[40:43], a[212:215], a[104:107], v[40:43]
  ds_read_b64_tr_b16 a[204:205], v245 offset:26624
  v_mfma_f32_16x16x32_bf16 v[40:43], a[208:211], a[96:99], v[40:43]
  s_waitcnt vmcnt(19) lgkmcnt(11)
  s_barrier
  buffer_load_dwordx4 v134, s[24:27], s8 offen offset:1024 lds
  v_mfma_f32_16x16x32_bf16 v[48:51], a[176:179], a[96:99], v[48:51]
  ds_read_b64_tr_b16 a[206:207], v245 offset:30720
  ds_read_b64_tr_b16 a[208:209], v246 offset:18432
  v_mfma_f32_16x16x32_bf16 v[48:51], a[180:183], a[104:107], v[48:51]
  ds_read_b64_tr_b16 a[210:211], v246 offset:22528
  v_mfma_f32_16x16x32_bf16 v[52:55], a[180:183], a[108:111], v[52:55]
  buffer_load_dwordx4 a[20:23], v137, s[36:39], s9 offen offset:1024 sc1
  ds_read_b64_tr_b16 a[212:213], v246 offset:26624
  v_mfma_f32_16x16x32_bf16 v[52:55], a[176:179], a[100:103], v[52:55]
  s_waitcnt lgkmcnt(11)
  ds_read_b64_tr_b16 a[214:215], v246 offset:30720
  v_mfma_f32_16x16x32_bf16 v[60:63], a[184:187], a[100:103], v[60:63]
  ds_read_b64_tr_b16 a[176:177], v247 offset:18432
  v_mfma_f32_16x16x32_bf16 v[60:63], a[188:191], a[108:111], v[60:63]
  ds_read_b64_tr_b16 a[178:179], v247 offset:22528
  v_mfma_f32_16x16x32_bf16 v[56:59], a[188:191], a[104:107], v[56:59]
  buffer_load_dwordx4 v135, s[24:27], s8 offen offset:2048 lds
  ds_read_b64_tr_b16 a[180:181], v247 offset:26624
  v_mfma_f32_16x16x32_bf16 v[56:59], a[184:187], a[96:99], v[56:59]
  s_waitcnt lgkmcnt(11)
  ds_read_b64_tr_b16 a[182:183], v247 offset:30720
  v_mfma_f32_16x16x32_bf16 v[144:147], a[192:195], a[96:99], v[144:147]
  ds_read_b64_tr_b16 a[184:185], v244 offset:32768
  v_mfma_f32_16x16x32_bf16 v[144:147], a[196:199], a[104:107], v[144:147]
  ds_read_b64_tr_b16 a[186:187], v244 offset:36864
  v_mfma_f32_16x16x32_bf16 v[148:151], a[196:199], a[108:111], v[148:151]
  buffer_load_dwordx4 a[24:27], v137, s[36:39], s9 offen offset:2048 sc1
  ds_read_b64_tr_b16 a[188:189], v244 offset:40960
  v_mfma_f32_16x16x32_bf16 v[148:151], a[192:195], a[100:103], v[148:151]
  s_waitcnt lgkmcnt(11)
  ds_read_b64_tr_b16 a[190:191], v244 offset:45056
  v_mfma_f32_16x16x32_bf16 v[156:159], a[200:203], a[100:103], v[156:159]
  ds_read_b64_tr_b16 a[192:193], v245 offset:32768
  v_mfma_f32_16x16x32_bf16 v[156:159], a[204:207], a[108:111], v[156:159]
  ds_read_b64_tr_b16 a[194:195], v245 offset:36864
  v_mfma_f32_16x16x32_bf16 v[152:155], a[204:207], a[104:107], v[152:155]
  buffer_load_dwordx4 v136, s[24:27], s8 offen offset:3072 lds
  ds_read_b64_tr_b16 a[196:197], v245 offset:40960
  v_mfma_f32_16x16x32_bf16 v[152:155], a[200:203], a[96:99], v[152:155]
  s_waitcnt lgkmcnt(11)
  ds_read_b64_tr_b16 a[198:199], v245 offset:45056
  v_mfma_f32_16x16x32_bf16 v[160:163], a[208:211], a[96:99], v[160:163]
  ds_read_b64_tr_b16 a[200:201], v246 offset:32768
  v_mfma_f32_16x16x32_bf16 v[160:163], a[212:215], a[104:107], v[160:163]
  ds_read_b64_tr_b16 a[202:203], v246 offset:36864
  v_mfma_f32_16x16x32_bf16 v[164:167], a[212:215], a[108:111], v[164:167]
  buffer_load_dwordx4 a[28:31], v137, s[36:39], s9 offen offset:3072 sc1
  s_cmp_eq_u32 s52, 1
  v_mfma_f32_16x16x32_bf16 v[164:167], a[208:211], a[100:103], v[164:167]
  s_waitcnt lgkmcnt(10)
  s_cselect_b32 s13, 47, 33
  s_lshl_b32 s9, s13, 11
  v_mfma_f32_16x16x32_bf16 v[172:175], a[176:179], a[100:103], v[172:175]
  ds_read_b64_tr_b16 a[204:205], v246 offset:40960
  ds_read_b64_tr_b16 a[206:207], v246 offset:45056
  v_mfma_f32_16x16x32_bf16 v[172:175], a[180:183], a[108:111], v[172:175]
  ds_read_b64_tr_b16 a[208:209], v247 offset:32768
  buffer_load_dwordx4 a[32:35], v137, s[36:39], s9 offen offset:0 sc1
  v_mfma_f32_16x16x32_bf16 v[168:171], a[180:183], a[104:107], v[168:171]
  ds_read_b64_tr_b16 a[210:211], v247 offset:36864
  ds_read_b64_tr_b16 a[212:213], v247 offset:40960
  v_mfma_f32_16x16x32_bf16 v[168:171], a[176:179], a[96:99], v[168:171]
  s_waitcnt vmcnt(25) lgkmcnt(11)
  ds_read_b64_tr_b16 a[214:215], v247 offset:45056
  v_mfma_f32_16x16x32_bf16 v[32:35], a[184:187], a[112:115], v[32:35]
  ds_read_b64_tr_b16 a[176:177], v244 offset:34816
  v_mfma_f32_16x16x32_bf16 v[32:35], a[188:191], a[120:123], v[32:35]
  buffer_load_dwordx4 a[36:39], v137, s[36:39], s9 offen offset:1024 sc1
  s_lshl_b32 s8, s13, 16
  v_mfma_f32_16x16x32_bf16 v[36:39], a[188:191], a[124:127], v[36:39]
  s_add_u32 m0, s73, 16384
  ds_read_b64_tr_b16 a[178:179], v244 offset:38912
  ds_read_b64_tr_b16 a[180:181], v244 offset:43008
  v_mfma_f32_16x16x32_bf16 v[36:39], a[184:187], a[116:119], v[36:39]
  s_waitcnt lgkmcnt(11)
  ds_read_b64_tr_b16 a[182:183], v244 offset:47104
  v_mfma_f32_16x16x32_bf16 v[44:47], a[192:195], a[116:119], v[44:47]
  ds_read_b64_tr_b16 a[184:185], v245 offset:34816
  v_mfma_f32_16x16x32_bf16 v[44:47], a[196:199], a[124:127], v[44:47]
  buffer_load_dwordx4 v135, s[24:27], s8 offen offset:2048 lds
  ds_read_b64_tr_b16 a[186:187], v245 offset:38912
  v_mfma_f32_16x16x32_bf16 v[40:43], a[196:199], a[120:123], v[40:43]
  ds_read_b64_tr_b16 a[188:189], v245 offset:43008
  v_mfma_f32_16x16x32_bf16 v[40:43], a[192:195], a[112:115], v[40:43]
  s_waitcnt vmcnt(20) lgkmcnt(11)
  s_barrier
  ds_read_b64_tr_b16 a[190:191], v245 offset:47104
  v_mfma_f32_16x16x32_bf16 v[48:51], a[200:203], a[112:115], v[48:51]
  ds_read_b64_tr_b16 a[192:193], v246 offset:34816
  v_mfma_f32_16x16x32_bf16 v[48:51], a[204:207], a[120:123], v[48:51]
  buffer_load_dwordx4 a[40:43], v137, s[36:39], s9 offen offset:2048 sc1
  ds_read_b64_tr_b16 a[194:195], v246 offset:38912
  v_mfma_f32_16x16x32_bf16 v[52:55], a[204:207], a[124:127], v[52:55]
  ds_read_b64_tr_b16 a[196:197], v246 offset:43008
  v_mfma_f32_16x16x32_bf16 v[52:55], a[200:203], a[116:119], v[52:55]
  s_waitcnt lgkmcnt(11)
  ds_read_b64_tr_b16 a[198:199], v246 offset:47104
  v_mfma_f32_16x16x32_bf16 v[60:63], a[208:211], a[116:119], v[60:63]
  ds_read_b64_tr_b16 a[200:201], v247 offset:34816
  v_mfma_f32_16x16x32_bf16 v[60:63], a[212:215], a[124:127], v[60:63]
  buffer_load_dwordx4 v136, s[24:27], s8 offen offset:3072 lds
  ds_read_b64_tr_b16 a[202:203], v247 offset:38912
  v_mfma_f32_16x16x32_bf16 v[56:59], a[212:215], a[120:123], v[56:59]
  ds_read_b64_tr_b16 a[204:205], v247 offset:43008
  v_mfma_f32_16x16x32_bf16 v[56:59], a[208:211], a[112:115], v[56:59]
  s_waitcnt lgkmcnt(11)
  ds_read_b64_tr_b16 a[206:207], v247 offset:47104
  v_mfma_f32_16x16x32_bf16 v[144:147], a[176:179], a[112:115], v[144:147]
  ds_read_b64_tr_b16 a[208:209], v244 offset:49152
  v_mfma_f32_16x16x32_bf16 v[144:147], a[180:183], a[120:123], v[144:147]
  buffer_load_dwordx4 a[44:47], v137, s[36:39], s9 offen offset:3072 sc1
  s_cmp_eq_u32 s52, 2
  v_mfma_f32_16x16x32_bf16 v[148:151], a[180:183], a[124:127], v[148:151]
  s_cselect_b32 s14, 50, 36
  s_lshl_b32 s9, s14, 11
  ds_read_b64_tr_b16 a[210:211], v244 offset:53248
  v_mfma_f32_16x16x32_bf16 v[148:151], a[176:179], a[116:119], v[148:151]
  s_waitcnt lgkmcnt(10)
  ds_read_b64_tr_b16 a[212:213], v244 offset:57344
  ds_read_b64_tr_b16 a[214:215], v244 offset:61440
  v_mfma_f32_16x16x32_bf16 v[156:159], a[184:187], a[116:119], v[156:159]
  buffer_load_dwordx4 a[48:51], v137, s[36:39], s9 offen offset:0 sc1
  ds_read_b64_tr_b16 a[176:177], v245 offset:49152
  v_mfma_f32_16x16x32_bf16 v[156:159], a[188:191], a[124:127], v[156:159]
  ds_read_b64_tr_b16 a[178:179], v245 offset:53248
  v_mfma_f32_16x16x32_bf16 v[152:155], a[188:191], a[120:123], v[152:155]
  ds_read_b64_tr_b16 a[180:181], v245 offset:57344
  v_mfma_f32_16x16x32_bf16 v[152:155], a[184:187], a[112:115], v[152:155]
  s_waitcnt lgkmcnt(11)
  ds_read_b64_tr_b16 a[182:183], v245 offset:61440
  v_mfma_f32_16x16x32_bf16 v[160:163], a[192:195], a[112:115], v[160:163]
  buffer_load_dwordx4 a[52:55], v137, s[36:39], s9 offen offset:1024 sc1
  s_lshl_b32 s8, s14, 16
  v_mfma_f32_16x16x32_bf16 v[160:163], a[196:199], a[120:123], v[160:163]
  s_add_u32 m0, s73, 32768
  ds_read_b64_tr_b16 a[184:185], v246 offset:49152
  ds_read_b64_tr_b16 a[186:187], v246 offset:53248
  v_mfma_f32_16x16x32_bf16 v[164:167], a[196:199], a[124:127], v[164:167]
  ds_read_b64_tr_b16 a[188:189], v246 offset:57344
CT26:
  s_add_u32 s94, s92, CT26-k3_main_kernel+3072
  s_addc_u32 s95, s93, 0
  v_mfma_f32_16x16x32_bf16 v[164:167], a[192:195], a[116:119], v[164:167]
  s_waitcnt lgkmcnt(11)
  global_load_dword a252, v0, s[94:95]
  ds_read_b64_tr_b16 a[190:191], v246 offset:61440
  v_mfma_f32_16x16x32_bf16 v[172:175], a[200:203], a[116:119], v[172:175]
  ds_read_b64_tr_b16 a[192:193], v247 offset:49152
  v_mfma_f32_16x16x32_bf16 v[172:175], a[204:207], a[124:127], v[172:175]
  ds_read_b64_tr_b16 a[194:195], v247 offset:53248
  v_mfma_f32_16x16x32_bf16 v[168:171], a[204:207], a[120:123], v[168:171]
  buffer_load_dwordx4 v135, s[24:27], s8 offen offset:2048 lds
  ds_read_b64_tr_b16 a[196:197], v247 offset:57344
  v_mfma_f32_16x16x32_bf16 v[168:171], a[200:203], a[112:115], v[168:171]
  s_waitcnt vmcnt(26) lgkmcnt(11)
  ds_read_b64_tr_b16 a[198:199], v247 offset:61440
  v_mfma_f32_16x16x32_bf16 v[32:35], a[208:211], a[216:219], v[32:35]
  ds_read_b64_tr_b16 a[200:201], v244 offset:51200
  v_mfma_f32_16x16x32_bf16 v[32:35], a[212:215], a[224:227], v[32:35]
  buffer_load_dwordx4 a[56:59], v137, s[36:39], s9 offen offset:2048 sc1
  ds_read_b64_tr_b16 a[202:203], v244 offset:55296
  v_mfma_f32_16x16x32_bf16 v[36:39], a[212:215], a[228:231], v[36:39]
  ds_read_b64_tr_b16 a[204:205], v244 offset:59392
  v_mfma_f32_16x16x32_bf16 v[36:39], a[208:211], a[220:223], v[36:39]
  s_waitcnt lgkmcnt(11)
  ds_read_b64_tr_b16 a[206:207], v244 offset:63488
  v_mfma_f32_16x16x32_bf16 v[44:47], a[176:179], a[220:223], v[44:47]
  buffer_load_dwordx4 v136, s[24:27], s8 offen offset:3072 lds
  ds_read_b64_tr_b16 a[208:209], v245 offset:51200
  v_mfma_f32_16x16x32_bf16 v[44:47], a[180:183], a[228:231], v[44:47]
  ds_read_b64_tr_b16 a[210:211], v245 offset:55296
  v_mfma_f32_16x16x32_bf16 v[40:43], a[180:183], a[224:227], v[40:43]
  ds_read_b64_tr_b16 a[212:213], v245 offset:59392
  v_mfma_f32_16x16x32_bf16 v[40:43], a[176:179], a[216:219], v[40:43]
  s_waitcnt vmcnt(21) lgkmcnt(11)
  s_barrier
  buffer_load_dwordx4 a[60:63], v137, s[36:39], s9 offen offset:3072 sc1
  v_mfma_f32_16x16x32_bf16 v[48:51], a[184:187], a[216:219], v[48:51]
  s_cmp_eq_u32 s52, 3
  s_cselect_b32 s15, 54, 40
  s_lshl_b32 s9, s15, 11
  v_mfma_f32_16x16x32_bf16 v[48:51], a[188:191], a[224:227], v[48:51]
  ds_read_b64_tr_b16 a[214:215], v245 offset:63488
  ds_read_b64_tr_b16 a[176:177], v246 offset:51200
  v_mfma_f32_16x16x32_bf16 v[52:55], a[188:191], a[228:231], v[52:55]
  ds_read_b64_tr_b16 a[178:179], v246 offset:55296
  ds_read_b64_tr_b16 a[180:181], v246 offset:59392
  v_mfma_f32_16x16x32_bf16 v[52:55], a[184:187], a[220:223], v[52:55]
  s_waitcnt lgkmcnt(11)
  buffer_load_dwordx4 a[64:67], v137, s[36:39], s9 offen offset:0 sc1
  ds_read_b64_tr_b16 a[182:183], v246 offset:63488
  v_mfma_f32_16x16x32_bf16 v[60:63], a[192:195], a[220:223], v[60:63]
  ds_read_b64_tr_b16 a[184:185], v247 offset:51200
  v_mfma_f32_16x16x32_bf16 v[60:63], a[196:199], a[228:231], v[60:63]
  ds_read_b64_tr_b16 a[186:187], v247 offset:55296
  v_mfma_f32_16x16x32_bf16 v[56:59], a[196:199], a[224:227], v[56:59]
  ds_read_b64_tr_b16 a[188:189], v247 offset:59392
  v_mfma_f32_16x16x32_bf16 v[56:59], a[192:195], a[216:219], v[56:59]
  s_waitcnt lgkmcnt(11)
  buffer_load_dwordx4 a[68:71], v137, s[36:39], s9 offen offset:1024 sc1
  s_lshl_b32 s8, s15, 16
  v_mfma_f32_16x16x32_bf16 v[144:147], a[200:203], a[216:219], v[144:147]
  s_add_u32 m0, s73, 49152
  ds_read_b64_tr_b16 a[190:191], v247 offset:63488
  ds_read_b64_tr_b16 a[192:193], v248 offset:0
  v_mfma_f32_16x16x32_bf16 v[144:147], a[204:207], a[224:227], v[144:147]
  ds_read_b64_tr_b16 a[194:195], v248 offset:4096
  v_mfma_f32_16x16x32_bf16 v[148:151], a[204:207], a[228:231], v[148:151]
  ds_read_b64_tr_b16 a[196:197], v248 offset:8192
  v_mfma_f32_16x16x32_bf16 v[148:151], a[200:203], a[220:223], v[148:151]
  s_waitcnt lgkmcnt(11)
  buffer_load_dwordx4 v135, s[24:27], s8 offen offset:2048 lds
  ds_read_b64_tr_b16 a[198:199], v248 offset:12288
  v_mfma_f32_16x16x32_bf16 v[156:159], a[208:211], a[220:223], v[156:159]
  ds_read_b64_tr_b16 a[200:201], v249 offset:0
  v_mfma_f32_16x16x32_bf16 v[156:159], a[212:215], a[228:231], v[156:159]
  ds_read_b64_tr_b16 a[202:203], v249 offset:4096
  v_mfma_f32_16x16x32_bf16 v[152:155], a[212:215], a[224:227], v[152:155]
  ds_read_b64_tr_b16 a[204:205], v249 offset:8192
  v_mfma_f32_16x16x32_bf16 v[152:155], a[208:211], a[216:219], v[152:155]
  s_waitcnt lgkmcnt(11)
  buffer_load_dwordx4 a[72:75], v137, s[36:39], s9 offen offset:2048 sc1
  ds_read_b64_tr_b16 a[206:207], v249 offset:12288
  v_mfma_f32_16x16x32_bf16 v[160:163], a[176:179], a[216:219], v[160:163]
  ds_read_b64_tr_b16 a[208:209], v250 offset:0
  v_mfma_f32_16x16x32_bf16 v[160:163], a[180:183], a[224:227], v[160:163]
  ds_read_b64_tr_b16 a[210:211], v250 offset:4096
  v_mfma_f32_16x16x32_bf16 v[164:167], a[180:183], a[228:231], v[164:167]
  buffer_load_dwordx4 v136, s[24:27], s8 offen offset:3072 lds
  ds_read_b64_tr_b16 a[212:213], v250 offset:8192
  v_mfma_f32_16x16x32_bf16 v[164:167], a[176:179], a[220:223], v[164:167]
  s_waitcnt lgkmcnt(11)
  ds_read_b64_tr_b16 a[214:215], v250 offset:12288
  v_mfma_f32_16x16x32_bf16 v[172:175], a[184:187], a[220:223], v[172:175]
  ds_read_b64_tr_b16 a[176:177], v251 offset:0
  v_mfma_f32_16x16x32_bf16 v[172:175], a[188:191], a[228:231], v[172:175]
  ds_read_b64_tr_b16 a[178:179], v251 offset:4096
  v_mfma_f32_16x16x32_bf16 v[168:171], a[188:191], a[224:227], v[168:171]
  buffer_load_dwordx4 a[76:79], v137, s[36:39], s9 offen offset:3072 sc1
  s_cmp_eq_u32 s52, 0
  v_mfma_f32_16x16x32_bf16 v[168:171], a[184:187], a[216:219], v[168:171]
  s_waitcnt vmcnt(27) lgkmcnt(10)
  s_cselect_b32 s40, 15, 43
  s_lshl_b32 s9, s40, 11
  v_mfma_f32_16x16x32_bf16 v[32:35], a[192:195], a[0:3], v[32:35]
  ds_read_b64_tr_b16 a[180:181], v251 offset:8192
  ds_read_b64_tr_b16 a[182:183], v251 offset:12288
  v_mfma_f32_16x16x32_bf16 v[32:35], a[196:199], a[8:11], v[32:35]
  ds_read_b64_tr_b16 a[184:185], v248 offset:2048
  ds_read_b64_tr_b16 a[186:187], v248 offset:6144
  v_mfma_f32_16x16x32_bf16 v[36:39], a[196:199], a[12:15], v[36:39]
  buffer_load_dwordx4 a[80:83], v137, s[36:39], s9 offen offset:0 sc1
  ds_read_b64_tr_b16 a[188:189], v248 offset:10240
  v_mfma_f32_16x16x32_bf16 v[36:39], a[192:195], a[4:7], v[36:39]
  s_waitcnt lgkmcnt(11)
  ds_read_b64_tr_b16 a[190:191], v248 offset:14336
  v_mfma_f32_16x16x32_bf16 v[44:47], a[200:203], a[4:7], v[44:47]
  ds_read_b64_tr_b16 a[192:193], v249 offset:2048
  v_mfma_f32_16x16x32_bf16 v[44:47], a[204:207], a[12:15], v[44:47]
  ds_read_b64_tr_b16 a[194:195], v249 offset:6144
  v_mfma_f32_16x16x32_bf16 v[40:43], a[204:207], a[8:11], v[40:43]
  buffer_load_dwordx4 a[84:87], v137, s[36:39], s9 offen offset:1024 sc1
  s_lshl_b32 s8, s40, 16
  v_mfma_f32_16x16x32_bf16 v[40:43], a[200:203], a[0:3], v[40:43]
  s_waitcnt vmcnt(22) lgkmcnt(10)
  s_barrier
  s_add_u32 m0, s73, 65536
  v_mfma_f32_16x16x32_bf16 v[48:51], a[208:211], a[0:3], v[48:51]
  ds_read_b64_tr_b16 a[196:197], v249 offset:10240
  ds_read_b64_tr_b16 a[198:199], v249 offset:14336
  v_mfma_f32_16x16x32_bf16 v[48:51], a[212:215], a[8:11], v[48:51]
  ds_read_b64_tr_b16 a[200:201], v250 offset:2048
  ds_read_b64_tr_b16 a[202:203], v250 offset:6144
  v_mfma_f32_16x16x32_bf16 v[52:55], a[212:215], a[12:15], v[52:55]
  buffer_load_dwordx4 v135, s[24:27], s8 offen offset:2048 lds
  ds_read_b64_tr_b16 a[204:205], v250 offset:10240
  v_mfma_f32_16x16x32_bf16 v[52:55], a[208:211], a[4:7], v[52:55]
  s_waitcnt lgkmcnt(11)
  ds_read_b64_tr_b16 a[206:207], v250 offset:14336
  v_mfma_f32_16x16x32_bf16 v[60:63], a[176:179], a[4:7], v[60:63]
  ds_read_b64_tr_b16 a[208:209], v251 offset:2048
  v_mfma_f32_16x16x32_bf16 v[60:63], a[180:183], a[12:15], v[60:63]
  buffer_load_dwordx4 a[88:91], v137, s[36:39], s9 offen offset:2048 sc1
  ds_read_b64_tr_b16 a[210:211], v251 offset:6144
  v_mfma_f32_16x16x32_bf16 v[56:59], a[180:183], a[8:11], v[56:59]
  ds_read_b64_tr_b16 a[212:213], v251 offset:10240
  v_mfma_f32_16x16x32_bf16 v[56:59], a[176:179], a[0:3], v[56:59]
  s_waitcnt lgkmcnt(11)
  ds_read_b64_tr_b16 a[214:215], v251 offset:14336
  v_mfma_f32_16x16x32_bf16 v[144:147], a[184:187], a[0:3], v[144:147]
  ds_read_b64_tr_b16 a[176:177], v240 offset:0
  v_mfma_f32_16x16x32_bf16 v[144:147], a[188:191], a[8:11], v[144:147]
  buffer_load_dwordx4 v136, s[24:27], s8 offen offset:3072 lds
  ds_read_b64_tr_b16 a[178:179], v240 offset:4096
  v_mfma_f32_16x16x32_bf16 v[148:151], a[188:191], a[12:15], v[148:151]
  ds_read_b64_tr_b16 a[180:181], v240 offset:8192
  v_mfma_f32_16x16x32_bf16 v[148:151], a[184:187], a[4:7], v[148:151]
  s_waitcnt lgkmcnt(11)
  ds_read_b64_tr_b16 a[182:183], v240 offset:12288
  v_mfma_f32_16x16x32_bf16 v[156:159], a[192:195], a[4:7], v[156:159]
  ds_read_b64_tr_b16 a[184:185], v241 offset:0
  v_mfma_f32_16x16x32_bf16 v[156:159], a[196:199], a[12:15], v[156:159]
  buffer_load_dwordx4 a[92:95], v137, s[36:39], s9 offen offset:3072 sc1
  s_cmp_eq_u32 s52, 1
  v_mfma_f32_16x16x32_bf16 v[152:155], a[196:199], a[8:11], v[152:155]
  s_cselect_b32 s41, 5, 47
  s_lshl_b32 s9, s41, 11
  ds_read_b64_tr_b16 a[186:187], v241 offset:4096
  v_mfma_f32_16x16x32_bf16 v[152:155], a[192:195], a[0:3], v[152:155]
  s_waitcnt lgkmcnt(10)
  ds_read_b64_tr_b16 a[188:189], v241 offset:8192
  ds_read_b64_tr_b16 a[190:191], v241 offset:12288
  v_mfma_f32_16x16x32_bf16 v[160:163], a[200:203], a[0:3], v[160:163]
  ds_read_b64_tr_b16 a[192:193], v242 offset:0
  v_mfma_f32_16x16x32_bf16 v[160:163], a[204:207], a[8:11], v[160:163]
  buffer_load_dwordx4 a[96:99], v137, s[36:39], s9 offen offset:0 sc1
  ds_read_b64_tr_b16 a[194:195], v242 offset:4096
  v_mfma_f32_16x16x32_bf16 v[164:167], a[204:207], a[12:15], v[164:167]
  ds_read_b64_tr_b16 a[196:197], v242 offset:8192
  v_mfma_f32_16x16x32_bf16 v[164:167], a[200:203], a[4:7], v[164:167]
  s_waitcnt lgkmcnt(11)
  ds_read_b64_tr_b16 a[198:199], v242 offset:12288
  v_mfma_f32_16x16x32_bf16 v[172:175], a[208:211], a[4:7], v[172:175]
  ds_read_b64_tr_b16 a[200:201], v243 offset:0
  v_mfma_f32_16x16x32_bf16 v[172:175], a[212:215], a[12:15], v[172:175]
  buffer_load_dwordx4 a[100:103], v137, s[36:39], s9 offen offset:1024 sc1
  s_lshl_b32 s8, s41, 16
  v_mfma_f32_16x16x32_bf16 v[168:171], a[212:215], a[8:11], v[168:171]
  s_add_u32 m0, s73, 81920
  ds_read_b64_tr_b16 a[202:203], v243 offset:4096
  ds_read_b64_tr_b16 a[204:205], v243 offset:8192
  v_mfma_f32_16x16x32_bf16 v[168:171], a[208:211], a[0:3], v[168:171]
  s_waitcnt vmcnt(27) lgkmcnt(11)
  ds_read_b64_tr_b16 a[206:207], v243 offset:12288
  v_mfma_f32_16x16x32_bf16 v[32:35], a[176:179], a[16:19], v[32:35]
  buffer_load_dwordx4 v135, s[24:27], s8 offen offset:2048 lds
  ds_read_b64_tr_b16 a[208:209], v240 offset:2048
  v_mfma_f32_16x16x32_bf16 v[32:35], a[180:183], a[24:27], v[32:35]
  ds_read_b64_tr_b16 a[210:211], v240 offset:6144
  v_mfma_f32_16x16x32_bf16 v[36:39], a[180:183], a[28:31], v[36:39]
  ds_read_b64_tr_b16 a[212:213], v240 offset:10240
  v_mfma_f32_16x16x32_bf16 v[36:39], a[176:179], a[20:23], v[36:39]
  s_waitcnt lgkmcnt(11)
  ds_read_b64_tr_b16 a[214:215], v240 offset:14336
  v_mfma_f32_16x16x32_bf16 v[44:47], a[184:187], a[20:23], v[44:47]
  buffer_load_dwordx4 a[104:107], v137, s[36:39], s9 offen offset:2048 sc1
  ds_read_b64_tr_b16 a[176:177], v241 offset:2048
  v_mfma_f32_16x16x32_bf16 v[44:47], a[188:191], a[28:31], v[44:47]
  ds_read_b64_tr_b16 a[178:179], v241 offset:6144
  v_mfma_f32_16x16x32_bf16 v[40:43], a[188:191], a[24:27], v[40:43]
  ds_read_b64_tr_b16 a[180:181], v241 offset:10240
  v_mfma_f32_16x16x32_bf16 v[40:43], a[184:187], a[16:19], v[40:43]
  s_waitcnt vmcnt(24) lgkmcnt(11)
  s_barrier
  ds_read_b64_tr_b16 a[182:183], v241 offset:14336
  v_mfma_f32_16x16x32_bf16 v[48:51], a[192:195], a[16:19], v[48:51]
  buffer_load_dwordx4 v136, s[24:27], s8 offen offset:3072 lds
  ds_read_b64_tr_b16 a[184:185], v242 offset:2048
  v_mfma_f32_16x16x32_bf16 v[48:51], a[196:199], a[24:27], v[48:51]
  ds_read_b64_tr_b16 a[186:187], v242 offset:6144
  v_mfma_f32_16x16x32_bf16 v[52:55], a[196:199], a[28:31], v[52:55]
  ds_read_b64_tr_b16 a[188:189], v242 offset:10240
  v_mfma_f32_16x16x32_bf16 v[52:55], a[192:195], a[20:23], v[52:55]
  s_waitcnt lgkmcnt(11)
  ds_read_b64_tr_b16 a[190:191], v242 offset:14336
  v_mfma_f32_16x16x32_bf16 v[60:63], a[200:203], a[20:23], v[60:63]
  buffer_load_dwordx4 a[108:111], v137, s[36:39], s9 offen offset:3072 sc1
  s_cmp_eq_u32 s52, 2
  v_mfma_f32_16x16x32_bf16 v[60:63], a[204:207], a[28:31], v[60:63]
  s_cselect_b32 s42, 8, 50
  s_lshl_b32 s9, s42, 11
  ds_read_b64_tr_b16 a[192:193], v243 offset:2048
  v_mfma_f32_16x16x32_bf16 v[56:59], a[204:207], a[24:27], v[56:59]
  ds_read_b64_tr_b16 a[194:195], v243 offset:6144
  ds_read_b64_tr_b16 a[196:197], v243 offset:10240
  v_mfma_f32_16x16x32_bf16 v[56:59], a[200:203], a[16:19], v[56:59]
  s_waitcnt lgkmcnt(11)
  ds_read_b64_tr_b16 a[198:199], v243 offset:14336
  v_mfma_f32_16x16x32_bf16 v[144:147], a[208:211], a[16:19], v[144:147]
  buffer_load_dwordx4 a[112:115], v137, s[36:39], s9 offen offset:0 sc1
  ds_read_b64_tr_b16 a[200:201], v240 offset:18432
  v_mfma_f32_16x16x32_bf16 v[144:147], a[212:215], a[24:27], v[144:147]
  ds_read_b64_tr_b16 a[202:203], v240 offset:22528
  v_mfma_f32_16x16x32_bf16 v[148:151], a[212:215], a[28:31], v[148:151]
  ds_read_b64_tr_b16 a[204:205], v240 offset:26624
  v_mfma_f32_16x16x32_bf16 v[148:151], a[208:211], a[20:23], v[148:151]
  s_waitcnt lgkmcnt(11)
  buffer_load_dwordx4 a[116:119], v137, s[36:39], s9 offen offset:1024 sc1
  s_lshl_b32 s8, s42, 16
  v_mfma_f32_16x16x32_bf16 v[156:159], a[176:179], a[20:23], v[156:159]
  s_add_u32 m0, s73, 98304
  ds_read_b64_tr_b16 a[206:207], v240 offset:30720
  ds_read_b64_tr_b16 a[208:209], v241 offset:18432
  v_mfma_f32_16x16x32_bf16 v[156:159], a[180:183], a[28:31], v[156:159]
  ds_read_b64_tr_b16 a[210:211], v241 offset:22528
  v_mfma_f32_16x16x32_bf16 v[152:155], a[180:183], a[24:27], v[152:155]
  ds_read_b64_tr_b16 a[212:213], v241 offset:26624
  v_mfma_f32_16x16x32_bf16 v[152:155], a[176:179], a[16:19], v[152:155]
  s_waitcnt vmcnt(21) lgkmcnt(11)
  s_barrier
  buffer_load_dwordx4 v135, s[24:27], s8 offen offset:2048 lds
  v_mfma_f32_16x16x32_bf16 v[160:163], a[184:187], a[16:19], v[160:163]
  ds_read_b64_tr_b16 a[214:215], v241 offset:30720
  ds_read_b64_tr_b16 a[176:177], v242 offset:18432
  v_mfma_f32_16x16x32_bf16 v[160:163], a[188:191], a[24:27], v[160:163]
  ds_read_b64_tr_b16 a[178:179], v242 offset:22528
  v_mfma_f32_16x16x32_bf16 v[164:167], a[188:191], a[28:31], v[164:167]
  ds_read_b64_tr_b16 a[180:181], v242 offset:26624
  v_mfma_f32_16x16x32_bf16 v[164:167], a[184:187], a[20:23], v[164:167]
  s_waitcnt lgkmcnt(11)
  buffer_load_dwordx4 a[120:123], v137, s[36:39], s9 offen offset:2048 sc1
  ds_read_b64_tr_b16 a[182:183], v242 offset:30720
  v_mfma_f32_16x16x32_bf16 v[172:175], a[192:195], a[20:23], v[172:175]
  ds_read_b64_tr_b16 a[184:185], v243 offset:18432
  v_mfma_f32_16x16x32_bf16 v[172:175], a[196:199], a[28:31], v[172:175]
  ds_read_b64_tr_b16 a[186:187], v243 offset:22528
  v_mfma_f32_16x16x32_bf16 v[168:171], a[196:199], a[24:27], v[168:171]
  ds_read_b64_tr_b16 a[188:189], v243 offset:26624
  v_mfma_f32_16x16x32_bf16 v[168:171], a[192:195], a[16:19], v[168:171]
  s_waitcnt vmcnt(29) lgkmcnt(11)
  buffer_load_dwordx4 v136, s[24:27], s8 offen offset:3072 lds
  ds_read_b64_tr_b16 a[190:191], v243 offset:30720
  v_mfma_f32_16x16x32_bf16 v[144:147], a[200:203], a[32:35], v[144:147]
  ds_read_b64_tr_b16 a[192:193], v240 offset:34816
  v_mfma_f32_16x16x32_bf16 v[144:147], a[204:207], a[40:43], v[144:147]
  ds_read_b64_tr_b16 a[194:195], v240 offset:38912
  v_mfma_f32_16x16x32_bf16 v[148:151], a[204:207], a[44:47], v[148:151]
  ds_read_b64_tr_b16 a[196:197], v240 offset:43008
  v_mfma_f32_16x16x32_bf16 v[148:151], a[200:203], a[36:39], v[148:151]
  s_waitcnt lgkmcnt(11)
  buffer_load_dwordx4 a[124:127], v137, s[36:39], s9 offen offset:3072 sc1
  s_cmp_eq_u32 s52, 3
  v_mfma_f32_16x16x32_bf16 v[156:159], a[208:211], a[36:39], v[156:159]
  s_cselect_b32 s43, 12, 54
  s_lshl_b32 s9, s43, 11
  ds_read_b64_tr_b16 a[198:199], v240 offset:47104
  v_mfma_f32_16x16x32_bf16 v[156:159], a[212:215], a[44:47], v[156:159]
  ds_read_b64_tr_b16 a[200:201], v241 offset:34816
  ds_read_b64_tr_b16 a[202:203], v241 offset:38912
  v_mfma_f32_16x16x32_bf16 v[152:155], a[212:215], a[40:43], v[152:155]
  buffer_load_dwordx4 a[216:219], v137, s[36:39], s9 offen offset:0 sc1
  ds_read_b64_tr_b16 a[204:205], v241 offset:43008
  v_mfma_f32_16x16x32_bf16 v[152:155], a[208:211], a[32:35], v[152:155]
  s_waitcnt vmcnt(20) lgkmcnt(11)
  s_barrier
  ds_read_b64_tr_b16 a[206:207], v241 offset:47104
  v_mfma_f32_16x16x32_bf16 v[160:163], a[176:179], a[32:35], v[160:163]
  ds_read_b64_tr_b16 a[208:209], v242 offset:34816
  v_mfma_f32_16x16x32_bf16 v[160:163], a[180:183], a[40:43], v[160:163]
  ds_read_b64_tr_b16 a[210:211], v242 offset:38912
  v_mfma_f32_16x16x32_bf16 v[164:167], a[180:183], a[44:47], v[164:167]
  buffer_load_dwordx4 a[220:223], v137, s[36:39], s9 offen offset:1024 sc1
  s_lshl_b32 s8, s43, 16
  v_mfma_f32_16x16x32_bf16 v[164:167], a[176:179], a[36:39], v[164:167]
  s_waitcnt lgkmcnt(10)
  s_add_u32 m0, s73, 114688
  ds_read_b64_tr_b16 a[212:213], v242 offset:43008
  v_mfma_f32_16x16x32_bf16 v[172:175], a[184:187], a[36:39], v[172:175]
  ds_read_b64_tr_b16 a[214:215], v242 offset:47104
  ds_read_b64_tr_b16 a[176:177], v243 offset:34816
  v_mfma_f32_16x16x32_bf16 v[172:175], a[188:191], a[44:47], v[172:175]
  ds_read_b64_tr_b16 a[178:179], v243 offset:38912
  v_mfma_f32_16x16x32_bf16 v[168:171], a[188:191], a[40:43], v[168:171]
  buffer_load_dwordx4 v135, s[24:27], s8 offen offset:2048 lds
  ds_read_b64_tr_b16 a[180:181], v243 offset:43008
  v_mfma_f32_16x16x32_bf16 v[168:171], a[184:187], a[32:35], v[168:171]
  s_waitcnt vmcnt(27) lgkmcnt(11)
  ds_read_b64_tr_b16 a[182:183], v243 offset:47104
  v_mfma_f32_16x16x32_bf16 v[144:147], a[192:195], a[48:51], v[144:147]
  ds_read_b64_tr_b16 a[184:185], v240 offset:51200
  v_mfma_f32_16x16x32_bf16 v[144:147], a[196:199], a[56:59], v[144:147]
  ds_read_b64_tr_b16 a[186:187], v240 offset:55296
  v_mfma_f32_16x16x32_bf16 v[148:151], a[196:199], a[60:63], v[148:151]
  buffer_load_dwordx4 a[224:227], v137, s[36:39], s9 offen offset:2048 sc1
  ds_read_b64_tr_b16 a[188:189], v240 offset:59392
  v_mfma_f32_16x16x32_bf16 v[148:151], a[192:195], a[52:55], v[148:151]
  s_waitcnt lgkmcnt(11)
  ds_read_b64_tr_b16 a[190:191], v240 offset:63488
  v_mfma_f32_16x16x32_bf16 v[156:159], a[200:203], a[52:55], v[156:159]
  ds_read_b64_tr_b16 a[192:193], v241 offset:51200
  v_mfma_f32_16x16x32_bf16 v[156:159], a[204:207], a[60:63], v[156:159]
  ds_read_b64_tr_b16 a[194:195], v241 offset:55296
  v_mfma_f32_16x16x32_bf16 v[152:155], a[204:207], a[56:59], v[152:155]
  buffer_load_dwordx4 v136, s[24:27], s8 offen offset:3072 lds
  ds_read_b64_tr_b16 a[196:197], v241 offset:59392
  v_mfma_f32_16x16x32_bf16 v[152:155], a[200:203], a[48:51], v[152:155]
  s_waitcnt vmcnt(18) lgkmcnt(11)
  s_barrier
  ds_read_b64_tr_b16 a[198:199], v241 offset:63488
  v_mfma_f32_16x16x32_bf16 v[160:163], a[208:211], a[48:51], v[160:163]
  ds_read_b64_tr_b16 a[200:201], v242 offset:51200
  v_mfma_f32_16x16x32_bf16 v[160:163], a[212:215], a[56:59], v[160:163]
  ds_read_b64_tr_b16 a[202:203], v242 offset:55296
  v_mfma_f32_16x16x32_bf16 v[164:167], a[212:215], a[60:63], v[164:167]
  buffer_load_dwordx4 a[228:231], v137, s[36:39], s9 offen offset:3072 sc1
  s_lshl_b32 s8, s13, 16
  v_mfma_f32_16x16x32_bf16 v[164:167], a[208:211], a[52:55], v[164:167]
  s_waitcnt lgkmcnt(10)
  s_add_u32 m0, s73, 16384
  ds_read_b64_tr_b16 a[204:205], v242 offset:59392
  v_mfma_f32_16x16x32_bf16 v[172:175], a[176:179], a[52:55], v[172:175]
  ds_read_b64_tr_b16 a[206:207], v242 offset:63488
  ds_read_b64_tr_b16 a[208:209], v243 offset:51200
  v_mfma_f32_16x16x32_bf16 v[172:175], a[180:183], a[60:63], v[172:175]
  ds_read_b64_tr_b16 a[210:211], v243 offset:55296
  v_mfma_f32_16x16x32_bf16 v[168:171], a[180:183], a[56:59], v[168:171]
  buffer_load_dwordx4 v133, s[24:27], s8 offen offset:0 lds
  ds_read_b64_tr_b16 a[212:213], v243 offset:59392
  v_mfma_f32_16x16x32_bf16 v[168:171], a[176:179], a[48:51], v[168:171]
  s_waitcnt vmcnt(25) lgkmcnt(11)
  ds_read_b64_tr_b16 a[214:215], v243 offset:63488
  v_mfma_f32_16x16x32_bf16 v[144:147], a[184:187], a[64:67], v[144:147]
  ds_read_b64_tr_b16 a[176:177], v244 offset:2048
  v_mfma_f32_16x16x32_bf16 v[144:147], a[188:191], a[72:75], v[144:147]
  ds_read_b64_tr_b16 a[178:179], v244 offset:6144
  v_mfma_f32_16x16x32_bf16 v[148:151], a[188:191], a[76:79], v[148:151]
  buffer_load_dwordx4 v134, s[24:27], s8 offen offset:1024 lds
  s_lshl_b32 s8, s14, 16
  v_mfma_f32_16x16x32_bf16 v[148:151], a[184:187], a[68:71], v[148:151]
  s_waitcnt lgkmcnt(10)
  s_add_u32 m0, s73, 32768
  ds_read_b64_tr_b16 a[180:181], v244 offset:10240
  v_mfma_f32_16x16x32_bf16 v[156:159], a[192:195], a[68:71], v[156:159]
  ds_read_b64_tr_b16 a[182:183], v244 offset:14336
  ds_read_b64_tr_b16 a[184:185], v245 offset:2048
  v_mfma_f32_16x16x32_bf16 v[156:159], a[196:199], a[76:79], v[156:159]
  ds_read_b64_tr_b16 a[186:187], v245 offset:6144
  v_mfma_f32_16x16x32_bf16 v[152:155], a[196:199], a[72:75], v[152:155]
  buffer_load_dwordx4 v133, s[24:27], s8 offen offset:0 lds
  ds_read_b64_tr_b16 a[188:189], v245 offset:10240
  v_mfma_f32_16x16x32_bf16 v[152:155], a[192:195], a[64:67], v[152:155]
  s_waitcnt vmcnt(16) lgkmcnt(11)
  s_barrier
  ds_read_b64_tr_b16 a[190:191], v245 offset:14336
  v_mfma_f32_16x16x32_bf16 v[160:163], a[200:203], a[64:67], v[160:163]
  ds_read_b64_tr_b16 a[192:193], v246 offset:2048
  v_mfma_f32_16x16x32_bf16 v[160:163], a[204:207], a[72:75], v[160:163]
  ds_read_b64_tr_b16 a[194:195], v246 offset:6144
  v_mfma_f32_16x16x32_bf16 v[164:167], a[204:207], a[76:79], v[164:167]
  buffer_load_dwordx4 v134, s[24:27], s8 offen offset:1024 lds
  s_lshl_b32 s8, s15, 16
  v_mfma_f32_16x16x32_bf16 v[164:167], a[200:203], a[68:71], v[164:167]
  s_waitcnt lgkmcnt(10)
  s_add_u32 m0, s73, 49152
  ds_read_b64_tr_b16 a[196:197], v246 offset:10240
  v_mfma_f32_16x16x32_bf16 v[172:175], a[208:211], a[68:71], v[172:175]
  ds_read_b64_tr_b16 a[198:199], v246 offset:14336
  ds_read_b64_tr_b16 a[200:201], v247 offset:2048
  v_mfma_f32_16x16x32_bf16 v[172:175], a[212:215], a[76:79], v[172:175]
  ds_read_b64_tr_b16 a[202:203], v247 offset:6144
  v_mfma_f32_16x16x32_bf16 v[168:171], a[212:215], a[72:75], v[168:171]
  buffer_load_dwordx4 v133, s[24:27], s8 offen offset:0 lds
  ds_read_b64_tr_b16 a[204:205], v247 offset:10240
  v_mfma_f32_16x16x32_bf16 v[168:171], a[208:211], a[64:67], v[168:171]
  s_waitcnt vmcnt(23) lgkmcnt(11)
  ds_read_b64_tr_b16 a[206:207], v247 offset:14336
  v_mfma_f32_16x16x32_bf16 v[144:147], a[176:179], a[80:83], v[144:147]
  ds_read_b64_tr_b16 a[208:209], v244 offset:18432
  v_mfma_f32_16x16x32_bf16 v[144:147], a[180:183], a[88:91], v[144:147]
  ds_read_b64_tr_b16 a[210:211], v244 offset:22528
  v_mfma_f32_16x16x32_bf16 v[148:151], a[180:183], a[92:95], v[148:151]
  buffer_load_dwordx4 v134, s[24:27], s8 offen offset:1024 lds
  s_lshl_b32 s8, s40, 16
  v_mfma_f32_16x16x32_bf16 v[148:151], a[176:179], a[84:87], v[148:151]
  s_waitcnt lgkmcnt(10)
  s_add_u32 m0, s73, 65536
  ds_read_b64_tr_b16 a[212:213], v244 offset:26624
  v_mfma_f32_16x16x32_bf16 v[156:159], a[184:187], a[84:87], v[156:159]
  ds_read_b64_tr_b16 a[214:215], v244 offset:30720
  ds_read_b64_tr_b16 a[176:177], v245 offset:18432
  v_mfma_f32_16x16x32_bf16 v[156:159], a[188:191], a[92:95], v[156:159]
  ds_read_b64_tr_b16 a[178:179], v245 offset:22528
  v_mfma_f32_16x16x32_bf16 v[152:155], a[188:191], a[88:91], v[152:155]
  buffer_load_dwordx4 v133, s[24:27], s8 offen offset:0 lds
  ds_read_b64_tr_b16 a[180:181], v245 offset:26624
  v_mfma_f32_16x16x32_bf16 v[152:155], a[184:187], a[80:83], v[152:155]
  s_waitcnt vmcnt(14) lgkmcnt(11)
  s_barrier
  ds_read_b64_tr_b16 a[182:183], v245 offset:30720
  v_mfma_f32_16x16x32_bf16 v[160:163], a[192:195], a[80:83], v[160:163]
  ds_read_b64_tr_b16 a[184:185], v246 offset:18432
  v_mfma_f32_16x16x32_bf16 v[160:163], a[196:199], a[88:91], v[160:163]
  ds_read_b64_tr_b16 a[186:187], v246 offset:22528
  v_mfma_f32_16x16x32_bf16 v[164:167], a[196:199], a[92:95], v[164:167]
  buffer_load_dwordx4 v134, s[24:27], s8 offen offset:1024 lds
  s_lshl_b32 s8, s41, 16
  v_mfma_f32_16x16x32_bf16 v[164:167], a[192:195], a[84:87], v[164:167]
  s_waitcnt lgkmcnt(10)
  s_add_u32 m0, s73, 81920
  ds_read_b64_tr_b16 a[188:189], v246 offset:26624
  v_mfma_f32_16x16x32_bf16 v[172:175], a[200:203], a[84:87], v[172:175]
  ds_read_b64_tr_b16 a[190:191], v246 offset:30720
  ds_read_b64_tr_b16 a[192:193], v247 offset:18432
  v_mfma_f32_16x16x32_bf16 v[172:175], a[204:207], a[92:95], v[172:175]
  ds_read_b64_tr_b16 a[194:195], v247 offset:22528
  v_mfma_f32_16x16x32_bf16 v[168:171], a[204:207], a[88:91], v[168:171]
  buffer_load_dwordx4 v133, s[24:27], s8 offen offset:0 lds
  ds_read_b64_tr_b16 a[196:197], v247 offset:26624
  v_mfma_f32_16x16x32_bf16 v[168:171], a[200:203], a[80:83], v[168:171]
  s_waitcnt vmcnt(21) lgkmcnt(11)
  ds_read_b64_tr_b16 a[198:199], v247 offset:30720
  v_mfma_f32_16x16x32_bf16 v[144:147], a[208:211], a[96:99], v[144:147]
  ds_read_b64_tr_b16 a[200:201], v244 offset:34816
  v_mfma_f32_16x16x32_bf16 v[144:147], a[212:215], a[104:107], v[144:147]
  ds_read_b64_tr_b16 a[202:203], v244 offset:38912
  v_mfma_f32_16x16x32_bf16 v[148:151], a[212:215], a[108:111], v[148:151]
  buffer_load_dwordx4 v134, s[24:27], s8 offen offset:1024 lds
  s_lshl_b32 s8, s42, 16
  v_mfma_f32_16x16x32_bf16 v[148:151], a[208:211], a[100:103], v[148:151]
  s_waitcnt lgkmcnt(10)
  s_add_u32 m0, s73, 98304
  ds_read_b64_tr_b16 a[204:205], v244 offset:43008
  v_mfma_f32_16x16x32_bf16 v[156:159], a[176:179], a[100:103], v[156:159]
  ds_read_b64_tr_b16 a[206:207], v244 offset:47104
  ds_read_b64_tr_b16 a[208:209], v245 offset:34816
  v_mfma_f32_16x16x32_bf16 v[156:159], a[180:183], a[108:111], v[156:159]
  ds_read_b64_tr_b16 a[210:211], v245 offset:38912
  v_mfma_f32_16x16x32_bf16 v[152:155], a[180:183], a[104:107], v[152:155]
  buffer_load_dwordx4 v133, s[24:27], s8 offen offset:0 lds
  ds_read_b64_tr_b16 a[212:213], v245 offset:43008
  v_mfma_f32_16x16x32_bf16 v[152:155], a[176:179], a[96:99], v[152:155]
  s_waitcnt vmcnt(12) lgkmcnt(11)
  s_barrier
  ds_read_b64_tr_b16 a[214:215], v245 offset:47104
  v_mfma_f32_16x16x32_bf16 v[160:163], a[184:187], a[96:99], v[160:163]
  ds_read_b64_tr_b16 a[176:177], v246 offset:34816
  v_mfma_f32_16x16x32_bf16 v[160:163], a[188:191], a[104:107], v[160:163]
  ds_read_b64_tr_b16 a[178:179], v246 offset:38912
  v_mfma_f32_16x16x32_bf16 v[164:167], a[188:191], a[108:111], v[164:167]
  buffer_load_dwordx4 v134, s[24:27], s8 offen offset:1024 lds
  s_lshl_b32 s8, s43, 16
  v_mfma_f32_16x16x32_bf16 v[164:167], a[184:187], a[100:103], v[164:167]
  s_waitcnt lgkmcnt(10)
  s_add_u32 m0, s73, 114688
  ds_read_b64_tr_b16 a[180:181], v246 offset:43008
  v_mfma_f32_16x16x32_bf16 v[172:175], a[192:195], a[100:103], v[172:175]
  ds_read_b64_tr_b16 a[182:183], v246 offset:47104
  ds_read_b64_tr_b16 a[184:185], v247 offset:34816
  v_mfma_f32_16x16x32_bf16 v[172:175], a[196:199], a[108:111], v[172:175]
  ds_read_b64_tr_b16 a[186:187], v247 offset:38912
  v_mfma_f32_16x16x32_bf16 v[168:171], a[196:199], a[104:107], v[168:171]
  buffer_load_dwordx4 v133, s[24:27], s8 offen offset:0 lds
  ds_read_b64_tr_b16 a[188:189], v247 offset:43008
  v_mfma_f32_16x16x32_bf16 v[168:171], a[192:195], a[96:99], v[168:171]
  s_waitcnt vmcnt(19) lgkmcnt(11)
  ds_read_b64_tr_b16 a[190:191], v247 offset:47104
  v_mfma_f32_16x16x32_bf16 v[144:147], a[200:203], a[112:115], v[144:147]
  ds_read_b64_tr_b16 a[192:193], v244 offset:51200
  v_mfma_f32_16x16x32_bf16 v[144:147], a[204:207], a[120:123], v[144:147]
  ds_read_b64_tr_b16 a[194:195], v244 offset:55296
  v_mfma_f32_16x16x32_bf16 v[148:151], a[204:207], a[124:127], v[148:151]
  buffer_load_dwordx4 v134, s[24:27], s8 offen offset:1024 lds
  ds_read_b64_tr_b16 a[196:197], v244 offset:59392
  v_mfma_f32_16x16x32_bf16 v[148:151], a[200:203], a[116:119], v[148:151]
  s_waitcnt lgkmcnt(11)
  ds_read_b64_tr_b16 a[198:199], v244 offset:63488
  v_mfma_f32_16x16x32_bf16 v[156:159], a[208:211], a[116:119], v[156:159]
  ds_read_b64_tr_b16 a[200:201], v245 offset:51200
  v_mfma_f32_16x16x32_bf16 v[156:159], a[212:215], a[124:127], v[156:159]
  ds_read_b64_tr_b16 a[202:203], v245 offset:55296
  v_mfma_f32_16x16x32_bf16 v[152:155], a[212:215], a[120:123], v[152:155]
  ds_read_b64_tr_b16 a[204:205], v245 offset:59392
  v_mfma_f32_16x16x32_bf16 v[152:155], a[208:211], a[112:115], v[152:155]
  s_waitcnt vmcnt(12) lgkmcnt(11)
  s_barrier
  ds_read_b64_tr_b16 a[206:207], v245 offset:63488
  v_mfma_f32_16x16x32_bf16 v[160:163], a[176:179], a[112:115], v[160:163]
  ds_read_b64_tr_b16 a[208:209], v246 offset:51200
  v_mfma_f32_16x16x32_bf16 v[160:163], a[180:183], a[120:123], v[160:163]
  ds_read_b64_tr_b16 a[210:211], v246 offset:55296
  v_mfma_f32_16x16x32_bf16 v[164:167], a[180:183], a[124:127], v[164:167]
  ds_read_b64_tr_b16 a[212:213], v246 offset:59392
  v_mfma_f32_16x16x32_bf16 v[164:167], a[176:179], a[116:119], v[164:167]
  s_waitcnt lgkmcnt(11)
  ds_read_b64_tr_b16 a[214:215], v246 offset:63488
  v_mfma_f32_16x16x32_bf16 v[172:175], a[184:187], a[116:119], v[172:175]
  ds_read_b64_tr_b16 a[176:177], v247 offset:51200
  v_mfma_f32_16x16x32_bf16 v[172:175], a[188:191], a[124:127], v[172:175]
  ds_read_b64_tr_b16 a[178:179], v247 offset:55296
  v_mfma_f32_16x16x32_bf16 v[168:171], a[188:191], a[120:123], v[168:171]
  ds_read_b64_tr_b16 a[180:181], v247 offset:59392
  v_mfma_f32_16x16x32_bf16 v[168:171], a[184:187], a[112:115], v[168:171]
  s_waitcnt vmcnt(14) lgkmcnt(11)
  ds_read_b64_tr_b16 a[182:183], v247 offset:63488
  v_mfma_f32_16x16x32_bf16 v[144:147], a[192:195], a[216:219], v[144:147]
  ds_read_b64_tr_b16 a[184:185], v240 offset:16384
  v_mfma_f32_16x16x32_bf16 v[144:147], a[196:199], a[224:227], v[144:147]
  ds_read_b64_tr_b16 a[186:187], v240 offset:20480
  v_mfma_f32_16x16x32_bf16 v[148:151], a[196:199], a[228:231], v[148:151]
  ds_read_b64_tr_b16 a[188:189], v240 offset:24576
  v_mfma_f32_16x16x32_bf16 v[148:151], a[192:195], a[220:223], v[148:151]
  s_waitcnt lgkmcnt(11)
  ds_read_b64_tr_b16 a[190:191], v240 offset:28672
  v_mfma_f32_16x16x32_bf16 v[156:159], a[200:203], a[220:223], v[156:159]
  ds_read_b64_tr_b16 a[192:193], v241 offset:16384
  v_mfma_f32_16x16x32_bf16 v[156:159], a[204:207], a[228:231], v[156:159]
  ds_read_b64_tr_b16 a[194:195], v241 offset:20480
  v_mfma_f32_16x16x32_bf16 v[152:155], a[204:207], a[224:227], v[152:155]
  ds_read_b64_tr_b16 a[196:197], v241 offset:24576
  v_mfma_f32_16x16x32_bf16 v[152:155], a[200:203], a[216:219], v[152:155]
  s_waitcnt vmcnt(10) lgkmcnt(11)
  s_barrier
  ds_read_b64_tr_b16 a[198:199], v241 offset:28672
  v_mfma_f32_16x16x32_bf16 v[160:163], a[208:211], a[216:219], v[160:163]
  ds_read_b64_tr_b16 a[200:201], v242 offset:16384
  buffer_store_dwordx4 v[144:147], v0, s[36:39], s4 offen offset:0 sc1
  v_mfma_f32_16x16x32_bf16 v[160:163], a[212:215], a[224:227], v[160:163]
  buffer_store_dwordx4 v[148:151], v0, s[36:39], s4 offen offset:1024 sc1
  ds_read_b64_tr_b16 a[202:203], v242 offset:20480
  v_mfma_f32_16x16x32_bf16 v[164:167], a[212:215], a[228:231], v[164:167]
  ds_read_b64_tr_b16 a[204:205], v242 offset:24576
  v_mfma_f32_16x16x32_bf16 v[164:167], a[208:211], a[220:223], v[164:167]
  s_waitcnt lgkmcnt(11)
  ds_read_b64_tr_b16 a[206:207], v242 offset:28672
  v_mfma_f32_16x16x32_bf16 v[172:175], a[176:179], a[220:223], v[172:175]
  ds_read_b64_tr_b16 a[208:209], v243 offset:16384
  buffer_store_dwordx4 v[152:155], v0, s[36:39], s4 offen offset:2048 sc1
  v_mfma_f32_16x16x32_bf16 v[172:175], a[180:183], a[228:231], v[172:175]
  buffer_store_dwordx4 v[156:159], v0, s[36:39], s4 offen offset:3072 sc1
  ds_read_b64_tr_b16 a[210:211], v243 offset:20480
  v_mfma_f32_16x16x32_bf16 v[168:171], a[180:183], a[224:227], v[168:171]
  ds_read_b64_tr_b16 a[212:213], v243 offset:24576
  v_mfma_f32_16x16x32_bf16 v[168:171], a[176:179], a[216:219], v[168:171]
  s_waitcnt lgkmcnt(11)
  ds_read_b64_tr_b16 a[214:215], v243 offset:28672
  v_mfma_f32_16x16x32_bf16 v[32:35], a[184:187], a[32:35], v[32:35]
  ds_read_b64_tr_b16 a[176:177], v240 offset:32768
  buffer_store_dwordx4 v[160:163], v0, s[36:39], s5 offen offset:0 sc1
  v_mfma_f32_16x16x32_bf16 v[32:35], a[188:191], a[40:43], v[32:35]
  buffer_store_dwordx4 v[164:167], v0, s[36:39], s5 offen offset:1024 sc1
  ds_read_b64_tr_b16 a[178:179], v240 offset:36864
  v_mfma_f32_16x16x32_bf16 v[36:39], a[188:191], a[44:47], v[36:39]
  ds_read_b64_tr_b16 a[180:181], v240 offset:40960
  v_mfma_f32_16x16x32_bf16 v[36:39], a[184:187], a[36:39], v[36:39]
  s_waitcnt lgkmcnt(11)
  ds_read_b64_tr_b16 a[182:183], v240 offset:45056
  v_mfma_f32_16x16x32_bf16 v[44:47], a[192:195], a[36:39], v[44:47]
  ds_read_b64_tr_b16 a[184:185], v241 offset:32768
  buffer_store_dwordx4 v[168:171], v0, s[36:39], s5 offen offset:2048 sc1
  v_mfma_f32_16x16x32_bf16 v[44:47], a[196:199], a[44:47], v[44:47]
  buffer_store_dwordx4 v[172:175], v0, s[36:39], s5 offen offset:3072 sc1
  ds_read_b64_tr_b16 a[186:187], v241 offset:36864
  v_mfma_f32_16x16x32_bf16 v[40:43], a[196:199], a[40:43], v[40:43]
  ds_read_b64_tr_b16 a[188:189], v241 offset:40960
  v_mfma_f32_16x16x32_bf16 v[40:43], a[192:195], a[32:35], v[40:43]
  s_waitcnt vmcnt(16) lgkmcnt(11)
  s_barrier
  ds_read_b64_tr_b16 a[190:191], v241 offset:45056
  v_mfma_f32_16x16x32_bf16 v[48:51], a[200:203], a[32:35], v[48:51]
  ds_read_b64_tr_b16 a[192:193], v242 offset:32768
  v_mfma_f32_16x16x32_bf16 v[48:51], a[204:207], a[40:43], v[48:51]
  ds_read_b64_tr_b16 a[194:195], v242 offset:36864
  v_mfma_f32_16x16x32_bf16 v[52:55], a[204:207], a[44:47], v[52:55]
  ds_read_b64_tr_b16 a[196:197], v242 offset:40960
  v_mfma_f32_16x16x32_bf16 v[52:55], a[200:203], a[36:39], v[52:55]
  s_waitcnt lgkmcnt(11)
  ds_read_b64_tr_b16 a[198:199], v242 offset:45056
  v_mfma_f32_16x16x32_bf16 v[60:63], a[208:211], a[36:39], v[60:63]
  ds_read_b64_tr_b16 a[200:201], v243 offset:32768
  v_mfma_f32_16x16x32_bf16 v[60:63], a[212:215], a[44:47], v[60:63]
  ds_read_b64_tr_b16 a[202:203], v243 offset:36864
  v_mfma_f32_16x16x32_bf16 v[56:59], a[212:215], a[40:43], v[56:59]
  ds_read_b64_tr_b16 a[204:205], v243 offset:40960
  v_mfma_f32_16x16x32_bf16 v[56:59], a[208:211], a[32:35], v[56:59]
  s_waitcnt lgkmcnt(11)
  ds_read_b64_tr_b16 a[206:207], v243 offset:45056
  v_mfma_f32_16x16x32_bf16 v[32:35], a[176:179], a[48:51], v[32:35]
  ds_read_b64_tr_b16 a[208:209], v240 offset:49152
  v_mfma_f32_16x16x32_bf16 v[32:35], a[180:183], a[56:59], v[32:35]
  ds_read_b64_tr_b16 a[210:211], v240 offset:53248
  v_mfma_f32_16x16x32_bf16 v[36:39], a[180:183], a[60:63], v[36:39]
  ds_read_b64_tr_b16 a[212:213], v240 offset:57344
  v_mfma_f32_16x16x32_bf16 v[36:39], a[176:179], a[52:55], v[36:39]
  s_waitcnt lgkmcnt(11)
  ds_read_b64_tr_b16 a[214:215], v240 offset:61440
  v_mfma_f32_16x16x32_bf16 v[44:47], a[184:187], a[52:55], v[44:47]
  ds_read_b64_tr_b16 a[176:177], v241 offset:49152
  v_mfma_f32_16x16x32_bf16 v[44:47], a[188:191], a[60:63], v[44:47]
  ds_read_b64_tr_b16 a[178:179], v241 offset:53248
  v_mfma_f32_16x16x32_bf16 v[40:43], a[188:191], a[56:59], v[40:43]
  ds_read_b64_tr_b16 a[180:181], v241 offset:57344
  v_mfma_f32_16x16x32_bf16 v[40:43], a[184:187], a[48:51], v[40:43]
  s_waitcnt vmcnt(14) lgkmcnt(11)
  s_barrier
  ds_read_b64_tr_b16 a[182:183], v241 offset:61440
  v_mfma_f32_16x16x32_bf16 v[48:51], a[192:195], a[48:51], v[48:51]
  ds_read_b64_tr_b16 a[184:185], v242 offset:49152
  v_mfma_f32_16x16x32_bf16 v[48:51], a[196:199], a[56:59], v[48:51]
  ds_read_b64_tr_b16 a[186:187], v242 offset:53248
  v_mfma_f32_16x16x32_bf16 v[52:55], a[196:199], a[60:63], v[52:55]
  ds_read_b64_tr_b16 a[188:189], v242 offset:57344
  v_mfma_f32_16x16x32_bf16 v[52:55], a[192:195], a[52:55], v[52:55]
  s_waitcnt lgkmcnt(11)
  ds_read_b64_tr_b16 a[190:191], v242 offset:61440
  v_mfma_f32_16x16x32_bf16 v[60:63], a[200:203], a[52:55], v[60:63]
  ds_read_b64_tr_b16 a[192:193], v243 offset:49152
  v_mfma_f32_16x16x32_bf16 v[60:63], a[204:207], a[60:63], v[60:63]
  ds_read_b64_tr_b16 a[194:195], v243 offset:53248
  v_mfma_f32_16x16x32_bf16 v[56:59], a[204:207], a[56:59], v[56:59]
  ds_read_b64_tr_b16 a[196:197], v243 offset:57344
  v_mfma_f32_16x16x32_bf16 v[56:59], a[200:203], a[48:51], v[56:59]
  s_waitcnt lgkmcnt(11)
  ds_read_b64_tr_b16 a[198:199], v243 offset:61440
  v_mfma_f32_16x16x32_bf16 v[32:35], a[208:211], a[64:67], v[32:35]
  ds_read_b64_tr_b16 a[200:201], v244 offset:0
  v_mfma_f32_16x16x32_bf16 v[32:35], a[212:215], a[72:75], v[32:35]
  ds_read_b64_tr_b16 a[202:203], v244 offset:4096
  v_mfma_f32_16x16x32_bf16 v[36:39], a[212:215], a[76:79], v[36:39]
  ds_read_b64_tr_b16 a[204:205], v244 offset:8192
  v_mfma_f32_16x16x32_bf16 v[36:39], a[208:211], a[68:71], v[36:39]
  s_waitcnt lgkmcnt(11)
  ds_read_b64_tr_b16 a[206:207], v244 offset:12288
  v_mfma_f32_16x16x32_bf16 v[44:47], a[176:179], a[68:71], v[44:47]
  ds_read_b64_tr_b16 a[208:209], v245 offset:0
  v_mfma_f32_16x16x32_bf16 v[44:47], a[180:183], a[76:79], v[44:47]
  ds_read_b64_tr_b16 a[210:211], v245 offset:4096
  v_mfma_f32_16x16x32_bf16 v[40:43], a[180:183], a[72:75], v[40:43]
  ds_read_b64_tr_b16 a[212:213], v245 offset:8192
  v_mfma_f32_16x16x32_bf16 v[40:43], a[176:179], a[64:67], v[40:43]
  s_waitcnt vmcnt(12) lgkmcnt(11)
  s_barrier
  ds_read_b64_tr_b16 a[214:215], v245 offset:12288
  v_mfma_f32_16x16x32_bf16 v[48:51], a[184:187], a[64:67], v[48:51]
  ds_read_b64_tr_b16 a[176:177], v246 offset:0
  v_mfma_f32_16x16x32_bf16 v[48:51], a[188:191], a[72:75], v[48:51]
  ds_read_b64_tr_b16 a[178:179], v246 offset:4096
  v_mfma_f32_16x16x32_bf16 v[52:55], a[188:191], a[76:79], v[52:55]
  ds_read_b64_tr_b16 a[180:181], v246 offset:8192
  v_mfma_f32_16x16x32_bf16 v[52:55], a[184:187], a[68:71], v[52:55]
  s_waitcnt lgkmcnt(11)
  ds_read_b64_tr_b16 a[182:183], v246 offset:12288
  v_mfma_f32_16x16x32_bf16 v[60:63], a[192:195], a[68:71], v[60:63]
  ds_read_b64_tr_b16 a[184:185], v247 offset:0
  v_mfma_f32_16x16x32_bf16 v[60:63], a[196:199], a[76:79], v[60:63]
  ds_read_b64_tr_b16 a[186:187], v247 offset:4096
  v_mfma_f32_16x16x32_bf16 v[56:59], a[196:199], a[72:75], v[56:59]
  ds_read_b64_tr_b16 a[188:189], v247 offset:8192
  v_mfma_f32_16x16x32_bf16 v[56:59], a[192:195], a[64:67], v[56:59]
  s_waitcnt lgkmcnt(11)
  ds_read_b64_tr_b16 a[190:191], v247 offset:12288
  v_mfma_f32_16x16x32_bf16 v[32:35], a[200:203], a[80:83], v[32:35]
  s_waitcnt vmcnt(0)
  ds_read_b64_tr_b16 a[192:193], v244 offset:16384
  s_mov_b64 exec, 1
  buffer_store_dword v254, v0, s[36:39], s28 offen sc1
  s_mov_b64 exec, -1
  v_mfma_f32_16x16x32_bf16 v[32:35], a[204:207], a[88:91], v[32:35]
  ds_read_b64_tr_b16 a[194:195], v244 offset:20480
  v_mfma_f32_16x16x32_bf16 v[36:39], a[204:207], a[92:95], v[36:39]
  ds_read_b64_tr_b16 a[196:197], v244 offset:24576
  v_mfma_f32_16x16x32_bf16 v[36:39], a[200:203], a[84:87], v[36:39]
  s_waitcnt lgkmcnt(11)
  ds_read_b64_tr_b16 a[198:199], v244 offset:28672
  v_mfma_f32_16x16x32_bf16 v[44:47], a[208:211], a[84:87], v[44:47]
  ds_read_b64_tr_b16 a[200:201], v245 offset:16384
  buffer_load_dword v139, v132, s[36:39], s29 offen sc1
  v_mfma_f32_16x16x32_bf16 v[44:47], a[212:215], a[92:95], v[44:47]
  ds_read_b64_tr_b16 a[202:203], v245 offset:20480
  v_mfma_f32_16x16x32_bf16 v[40:43], a[212:215], a[88:91], v[40:43]
  ds_read_b64_tr_b16 a[204:205], v245 offset:24576
  v_mfma_f32_16x16x32_bf16 v[40:43], a[208:211], a[80:83], v[40:43]
  s_waitcnt vmcnt(12) lgkmcnt(11)
  s_barrier
  ds_read_b64_tr_b16 a[206:207], v245 offset:28672
  v_mfma_f32_16x16x32_bf16 v[48:51], a[176:179], a[80:83], v[48:51]
  ds_read_b64_tr_b16 a[208:209], v246 offset:16384
  v_mfma_f32_16x16x32_bf16 v[48:51], a[180:183], a[88:91], v[48:51]
  ds_read_b64_tr_b16 a[210:211], v246 offset:20480
  v_mfma_f32_16x16x32_bf16 v[52:55], a[180:183], a[92:95], v[52:55]
  ds_read_b64_tr_b16 a[212:213], v246 offset:24576
  v_mfma_f32_16x16x32_bf16 v[52:55], a[176:179], a[84:87], v[52:55]
  s_waitcnt lgkmcnt(11)
  ds_read_b64_tr_b16 a[214:215], v246 offset:28672
  v_mfma_f32_16x16x32_bf16 v[60:63], a[184:187], a[84:87], v[60:63]
  ds_read_b64_tr_b16 a[176:177], v247 offset:16384
  v_mfma_f32_16x16x32_bf16 v[60:63], a[188:191], a[92:95], v[60:63]
  ds_read_b64_tr_b16 a[178:179], v247 offset:20480
  v_mfma_f32_16x16x32_bf16 v[56:59], a[188:191], a[88:91], v[56:59]
  ds_read_b64_tr_b16 a[180:181], v247 offset:24576
  v_mfma_f32_16x16x32_bf16 v[56:59], a[184:187], a[80:83], v[56:59]
  s_waitcnt lgkmcnt(11)
  ds_read_b64_tr_b16 a[182:183], v247 offset:28672
  v_mfma_f32_16x16x32_bf16 v[32:35], a[192:195], a[96:99], v[32:35]
  ds_read_b64_tr_b16 a[184:185], v244 offset:32768
  v_mfma_f32_16x16x32_bf16 v[32:35], a[196:199], a[104:107], v[32:35]
  ds_read_b64_tr_b16 a[186:187], v244 offset:36864
  v_mfma_f32_16x16x32_bf16 v[36:39], a[196:199], a[108:111], v[36:39]
  ds_read_b64_tr_b16 a[188:189], v244 offset:40960
  v_mfma_f32_16x16x32_bf16 v[36:39], a[192:195], a[100:103], v[36:39]
  s_waitcnt lgkmcnt(11)
  ds_read_b64_tr_b16 a[190:191], v244 offset:45056
  v_mfma_f32_16x16x32_bf16 v[44:47], a[200:203], a[100:103], v[44:47]
  ds_read_b64_tr_b16 a[192:193], v245 offset:32768
  v_mfma_f32_16x16x32_bf16 v[44:47], a[204:207], a[108:111], v[44:47]
  ds_read_b64_tr_b16 a[194:195], v245 offset:36864
  v_mfma_f32_16x16x32_bf16 v[40:43], a[204:207], a[104:107], v[40:43]
  ds_read_b64_tr_b16 a[196:197], v245 offset:40960
  v_mfma_f32_16x16x32_bf16 v[40:43], a[200:203], a[96:99], v[40:43]
  s_waitcnt vmcnt(10) lgkmcnt(11)
  s_barrier
  ds_read_b64_tr_b16 a[198:199], v245 offset:45056
  v_mfma_f32_16x16x32_bf16 v[48:51], a[208:211], a[96:99], v[48:51]
  ds_read_b64_tr_b16 a[200:201], v246 offset:32768
  v_mfma_f32_16x16x32_bf16 v[48:51], a[212:215], a[104:107], v[48:51]
  ds_read_b64_tr_b16 a[202:203], v246 offset:36864
  v_mfma_f32_16x16x32_bf16 v[52:55], a[212:215], a[108:111], v[52:55]
  ds_read_b64_tr_b16 a[204:205], v246 offset:40960
  v_mfma_f32_16x16x32_bf16 v[52:55], a[208:211], a[100:103], v[52:55]
  s_waitcnt lgkmcnt(11)
  ds_read_b64_tr_b16 a[206:207], v246 offset:45056
  v_mfma_f32_16x16x32_bf16 v[60:63], a[176:179], a[100:103], v[60:63]
  ds_read_b64_tr_b16 a[208:209], v247 offset:32768
  v_mfma_f32_16x16x32_bf16 v[60:63], a[180:183], a[108:111], v[60:63]
  ds_read_b64_tr_b16 a[210:211], v247 offset:36864
  v_mfma_f32_16x16x32_bf16 v[56:59], a[180:183], a[104:107], v[56:59]
  s_waitcnt vmcnt(0)
  ds_read_b64_tr_b16 a[212:213], v247 offset:40960
  v_readfirstlane_b32 s30, v139
  v_mfma_f32_16x16x32_bf16 v[56:59], a[176:179], a[96:99], v[56:59]
  s_waitcnt lgkmcnt(11)
  ds_read_b64_tr_b16 a[214:215], v247 offset:45056
  s_nop 0
  v_mfma_f32_16x16x32_bf16 v[32:35], a[184:187], a[112:115], v[32:35]
  s_cmp_eq_u32 s30, 1
  ds_read_b64_tr_b16 a[176:177], v244 offset:49152
  s_cselect_b32 s57, s6, 1073741824
  v_mfma_f32_16x16x32_bf16 v[32:35], a[188:191], a[120:123], v[32:35]
  s_cselect_b32 s58, s7, 1073741824
  ds_read_b64_tr_b16 a[178:179], v244 offset:53248
  buffer_load_dwordx4 v[96:99], v0, s[36:39], s57 offen offset:0 sc1
  v_mfma_f32_16x16x32_bf16 v[36:39], a[188:191], a[124:127], v[36:39]
  ds_read_b64_tr_b16 a[180:181], v244 offset:57344
  v_mfma_f32_16x16x32_bf16 v[36:39], a[184:187], a[116:119], v[36:39]
  s_waitcnt lgkmcnt(11)
  ds_read_b64_tr_b16 a[182:183], v244 offset:61440
  v_mfma_f32_16x16x32_bf16 v[44:47], a[192:195], a[116:119], v[44:47]
  ds_read_b64_tr_b16 a[184:185], v245 offset:49152
  buffer_load_dwordx4 v[100:103], v0, s[36:39], s57 offen offset:1024 sc1
  v_mfma_f32_16x16x32_bf16 v[44:47], a[196:199], a[124:127], v[44:47]
  ds_read_b64_tr_b16 a[186:187], v245 offset:53248
  v_mfma_f32_16x16x32_bf16 v[40:43], a[196:199], a[120:123], v[40:43]
  ds_read_b64_tr_b16 a[188:189], v245 offset:57344
  v_mfma_f32_16x16x32_bf16 v[40:43], a[192:195], a[112:115], v[40:43]
  s_waitcnt lgkmcnt(11)
  buffer_load_dwordx4 v[104:107], v0, s[36:39], s57 offen offset:2048 sc1
  ds_read_b64_tr_b16 a[190:191], v245 offset:61440
  v_mfma_f32_16x16x32_bf16 v[48:51], a[200:203], a[112:115], v[48:51]
  ds_read_b64_tr_b16 a[192:193], v246 offset:49152
  v_mfma_f32_16x16x32_bf16 v[48:51], a[204:207], a[120:123], v[48:51]
  buffer_load_dwordx4 v[108:111], v0, s[36:39], s57 offen offset:3072 sc1
  ds_read_b64_tr_b16 a[194:195], v246 offset:53248
  v_mfma_f32_16x16x32_bf16 v[52:55], a[204:207], a[124:127], v[52:55]
  ds_read_b64_tr_b16 a[196:197], v246 offset:57344
  v_mfma_f32_16x16x32_bf16 v[52:55], a[200:203], a[116:119], v[52:55]
  s_waitcnt lgkmcnt(11)
  buffer_load_dwordx4 v[112:115], v0, s[36:39], s58 offen offset:0 sc1
  ds_read_b64_tr_b16 a[198:199], v246 offset:61440
  v_mfma_f32_16x16x32_bf16 v[60:63], a[208:211], a[116:119], v[60:63]
  ds_read_b64_tr_b16 a[200:201], v247 offset:49152
  v_mfma_f32_16x16x32_bf16 v[60:63], a[212:215], a[124:127], v[60:63]
  buffer_load_dwordx4 v[116:119], v0, s[36:39], s58 offen offset:1024 sc1
  ds_read_b64_tr_b16 a[202:203], v247 offset:53248
  v_mfma_f32_16x16x32_bf16 v[56:59], a[212:215], a[120:123], v[56:59]
  ds_read_b64_tr_b16 a[204:205], v247 offset:57344
  v_mfma_f32_16x16x32_bf16 v[56:59], a[208:211], a[112:115], v[56:59]
  s_waitcnt lgkmcnt(11)
  buffer_load_dwordx4 v[120:123], v0, s[36:39], s58 offen offset:2048 sc1
  ds_read_b64_tr_b16 a[206:207], v247 offset:61440
  v_mfma_f32_16x16x32_bf16 v[32:35], a[176:179], a[216:219], v[32:35]
  v_mfma_f32_16x16x32_bf16 v[32:35], a[180:183], a[224:227], v[32:35]
  buffer_load_dwordx4 v[124:127], v0, s[36:39], s58 offen offset:3072 sc1
  v_mfma_f32_16x16x32_bf16 v[36:39], a[180:183], a[228:231], v[36:39]
  v_mfma_f32_16x16x32_bf16 v[36:39], a[176:179], a[220:223], v[36:39]
  s_waitcnt lgkmcnt(8)
  v_mfma_f32_16x16x32_bf16 v[44:47], a[184:187], a[220:223], v[44:47]
  v_mfma_f32_16x16x32_bf16 v[44:47], a[188:191], a[228:231], v[44:47]
  v_mfma_f32_16x16x32_bf16 v[40:43], a[188:191], a[224:227], v[40:43]
  v_mfma_f32_16x16x32_bf16 v[40:43], a[184:187], a[216:219], v[40:43]
  s_waitcnt lgkmcnt(4)
  v_mfma_f32_16x16x32_bf16 v[48:51], a[192:195], a[216:219], v[48:51]
  v_mfma_f32_16x16x32_bf16 v[48:51], a[196:199], a[224:227], v[48:51]
  v_mfma_f32_16x16x32_bf16 v[52:55], a[196:199], a[228:231], v[52:55]
  v_mfma_f32_16x16x32_bf16 v[52:55], a[192:195], a[220:223], v[52:55]
  s_waitcnt lgkmcnt(0)
  v_mfma_f32_16x16x32_bf16 v[60:63], a[200:203], a[220:223], v[60:63]
  v_mfma_f32_16x16x32_bf16 v[60:63], a[204:207], a[228:231], v[60:63]
  v_mfma_f32_16x16x32_bf16 v[56:59], a[204:207], a[224:227], v[56:59]
  v_mfma_f32_16x16x32_bf16 v[56:59], a[200:203], a[216:219], v[56:59]
  s_cmp_eq_u32 s30, 1
  s_cbranch_scc0 CKXs
CKXx:
  v_pk_fma_f32 v[64:65], v[176:177], v[32:33], v[64:65]
  v_pk_fma_f32 v[66:67], v[178:179], v[34:35], v[66:67]
  v_pk_fma_f32 v[80:81], v[176:177], v[36:37], v[80:81]
  v_pk_fma_f32 v[82:83], v[178:179], v[38:39], v[82:83]
  v_pk_fma_f32 v[68:69], v[180:181], v[40:41], v[68:69]
  v_pk_fma_f32 v[70:71], v[182:183], v[42:43], v[70:71]
  v_pk_fma_f32 v[84:85], v[180:181], v[44:45], v[84:85]
  v_pk_fma_f32 v[86:87], v[182:183], v[46:47], v[86:87]
  v_pk_fma_f32 v[72:73], v[184:185], v[48:49], v[72:73]
  v_pk_fma_f32 v[74:75], v[186:187], v[50:51], v[74:75]
  v_pk_fma_f32 v[88:89], v[184:185], v[52:53], v[88:89]
  v_pk_fma_f32 v[90:91], v[186:187], v[54:55], v[90:91]
  v_pk_fma_f32 v[76:77], v[188:189], v[56:57], v[76:77]
  v_pk_fma_f32 v[78:79], v[190:191], v[58:59], v[78:79]
  v_pk_fma_f32 v[92:93], v[188:189], v[60:61], v[92:93]
  v_pk_fma_f32 v[94:95], v[190:191], v[62:63], v[94:95]
  s_waitcnt vmcnt(7)
  v_pk_fma_f32 v[64:65], v[176:177], v[96:97], v[64:65]
  v_pk_fma_f32 v[66:67], v[178:179], v[98:99], v[66:67]
  v_cvt_pk_bf16_f32 v192, v64, v65
  v_cvt_pk_bf16_f32 v193, v66, v67
  ds_write_b64 v140, v[192:193] offset:0
  s_waitcnt vmcnt(6)
  v_pk_fma_f32 v[80:81], v[176:177], v[100:101], v[80:81]
  v_pk_fma_f32 v[82:83], v[178:179], v[102:103], v[82:83]
  v_cvt_pk_bf16_f32 v200, v80, v81
  v_cvt_pk_bf16_f32 v201, v82, v83
  ds_write_b64 v140, v[200:201] offset:2048
  s_waitcnt vmcnt(5)
  v_pk_fma_f32 v[68:69], v[180:181], v[104:105], v[68:69]
  v_pk_fma_f32 v[70:71], v[182:183], v[106:107], v[70:71]
  v_cvt_pk_bf16_f32 v194, v68, v69
  v_cvt_pk_bf16_f32 v195, v70, v71
  ds_write_b64 v141, v[194:195] offset:0
  s_waitcnt vmcnt(4)
  v_pk_fma_f32 v[84:85], v[180:181], v[108:109], v[84:85]
  v_pk_fma_f32 v[86:87], v[182:183], v[110:111], v[86:87]
  v_cvt_pk_bf16_f32 v202, v84, v85
  v_cvt_pk_bf16_f32 v203, v86, v87
  ds_write_b64 v141, v[202:203] offset:2048
  s_waitcnt vmcnt(3)
  v_pk_fma_f32 v[72:73], v[184:185], v[112:113], v[72:73]
  v_pk_fma_f32 v[74:75], v[186:187], v[114:115], v[74:75]
  v_cvt_pk_bf16_f32 v196, v72, v73
  v_cvt_pk_bf16_f32 v197, v74, v75
  ds_write_b64 v142, v[196:197] offset:0
  s_waitcnt vmcnt(2)
  v_pk_fma_f32 v[88:89], v[184:185], v[116:117], v[88:89]
  v_pk_fma_f32 v[90:91], v[186:187], v[118:119], v[90:91]
  v_cvt_pk_bf16_f32 v204, v88, v89
  v_cvt_pk_bf16_f32 v205, v90, v91
  ds_write_b64 v142, v[204:205] offset:2048
  s_waitcnt vmcnt(1)
  v_pk_fma_f32 v[76:77], v[188:189], v[120:121], v[76:77]
  v_pk_fma_f32 v[78:79], v[190:191], v[122:123], v[78:79]
  v_cvt_pk_bf16_f32 v198, v76, v77
  v_cvt_pk_bf16_f32 v199, v78, v79
  ds_write_b64 v143, v[198:199] offset:0
  s_waitcnt vmcnt(0)
  v_pk_fma_f32 v[92:93], v[188:189], v[124:125], v[92:93]
  v_pk_fma_f32 v[94:95], v[190:191], v[126:127], v[94:95]
  v_cvt_pk_bf16_f32 v206, v92, v93
  v_cvt_pk_bf16_f32 v207, v94, v95
  ds_write_b64 v143, v[206:207] offset:2048
  ds_read_b128 v[64:67], v255 offset:0
  ds_read_b128 v[68:71], v255 offset:1024
  ds_read_b128 v[72:75], v255 offset:2048
  ds_read_b128 v[76:79], v255 offset:3072
  s_waitcnt lgkmcnt(3)
  buffer_store_dwordx4 v[64:67], v252, s[32:35], s72 offen
  s_waitcnt lgkmcnt(2)
  buffer_store_dwordx4 v[68:71], v253, s[32:35], s72 offen
  s_waitcnt lgkmcnt(1)
  buffer_store_dwordx4 v[72:75], v252, s[32:35], s49 offen
  s_waitcnt lgkmcnt(0)
  buffer_store_dwordx4 v[76:79], v253, s[32:35], s49 offen
X_k3_main_kernel:
  s_endpgm
CK7s:
  s_mov_b32 s46, 30000
CK7:
  s_mov_b32 s49, 0
  buffer_load_dwordx4 v[156:159], v248, s[36:39], s49 offen sc1
  s_mov_b32 s49, 24576
  buffer_load_dwordx4 v[160:163], v248, s[36:39], s49 offen sc1
  s_mov_b32 s49, 49152
  buffer_load_dwordx4 v[164:167], v248, s[36:39], s49 offen sc1
  s_mov_b32 s49, 73728
  buffer_load_dwordx4 v[168:171], v248, s[36:39], s49 offen sc1
  s_sub_u32 s46, s46, 1
  s_waitcnt vmcnt(0)
  v_max_u32 v15, v156, v157
  v_max3_u32 v15, v15, v158, v159
  v_max3_u32 v15, v15, v160, v161
  v_max3_u32 v15, v15, v162, v163
  v_max3_u32 v15, v15, v164, v165
  v_max3_u32 v15, v15, v166, v167
  v_max3_u32 v15, v15, v168, v169
  v_max3_u32 v15, v15, v170, v171
  s_cmp_eq_u32 s46, 0
  s_cbranch_scc1 CK7x
  v_cmp_eq_u32 vcc, -1, v15
  s_nop 4
  s_cbranch_vccnz CK7
  s_branch CK7x
CK15s:
  s_mov_b32 s46, 30000
CK15:
  buffer_load_dwordx4 a[176:179], v25, s[36:39], s29 offen offset:0 sc1
  buffer_load_dwordx4 a[180:183], v25, s[36:39], s29 offen offset:2048 sc1
  buffer_load_dwordx4 a[184:187], v25, s[36:39], s28 offen offset:0 sc1
  buffer_load_dwordx4 a[188:191], v25, s[36:39], s28 offen offset:2048 sc1
  s_sub_u32 s46, s46, 1
  s_waitcnt vmcnt(0)
  v_accvgpr_read_b32 v26, a176
  v_accvgpr_read_b32 v27, a177
  v_accvgpr_read_b32 v28, a178
  v_accvgpr_read_b32 v29, a179
  v_max_u32 v31, v26, v27
  v_max3_u32 v31, v31, v28, v29
  v_accvgpr_read_b32 v22, a180
  v_accvgpr_read_b32 v23, a181
  v_max3_u32 v31, v31, v22, v23
  v_add_f32 v26, v26, v22
  v_add_f32 v27, v27, v23
  v_accvgpr_read_b32 v22, a182
  v_accvgpr_read_b32 v23, a183
  v_max3_u32 v31, v31, v22, v23
  v_add_f32 v28, v28, v22
  v_add_f32 v29, v29, v23
  v_accvgpr_read_b32 v22, a184
  v_accvgpr_read_b32 v23, a185
  v_max3_u32 v31, v31, v22, v23
  v_add_f32 v26, v26, v22
  v_add_f32 v27, v27, v23
  v_accvgpr_read_b32 v22, a186
  v_accvgpr_read_b32 v23, a187
  v_max3_u32 v31, v31, v22, v23
  v_add_f32 v28, v28, v22
  v_add_f32 v29, v29, v23
  v_accvgpr_read_b32 v22, a188
  v_accvgpr_read_b32 v23, a189
  v_max3_u32 v31, v31, v22, v23
  v_add_f32 v26, v26, v22
  v_add_f32 v27, v27, v23
  v_accvgpr_read_b32 v22, a190
  v_accvgpr_read_b32 v23, a191
  v_max3_u32 v31, v31, v22, v23
  v_add_f32 v28, v28, v22
  v_add_f32 v29, v29, v23
  s_cmp_eq_u32 s46, 0
  s_cbranch_scc1 CK15x
  v_cmp_eq_u32 vcc, -1, v31
  s_nop 4
  s_cbranch_vccnz CK15
  s_branch CK15x
CK21s:
  s_mov_b32 s46, 60000
CK21:
  buffer_load_dword v139, v138, s[36:39], s60 offen sc1
  s_sub_u32 s46, s46, 1
  s_cmp_eq_u32 s46, 0
  s_waitcnt vmcnt(0)
  s_cbranch_scc1 CK21x
  v_cmp_ne_u32 vcc, 1, v139
  s_nop 4
  s_cbranch_vccnz CK21
  s_branch CK21x
CK24s:
  s_mov_b32 s46, 60000
CK24:
  buffer_load_dword v139, v138, s[36:39], s60 offen sc1
  s_sub_u32 s46, s46, 1
  s_cmp_eq_u32 s46, 0
  s_waitcnt vmcnt(0)
  s_cbranch_scc1 CK24x
  v_cmp_ne_u32 vcc, 1, v139
  s_nop 4
  s_cbranch_vccnz CK24
  s_branch CK24x
CKXs:
  s_mov_b32 s46, 60000
CKX:
  buffer_load_dword v139, v132, s[36:39], s29 offen sc1
  s_sub_u32 s46, s46, 1
  s_cmp_eq_u32 s46, 0
  s_waitcnt vmcnt(0)
  s_cbranch_scc1 CKXy
  v_cmp_ne_u32 vcc, 1, v139
  s_nop 4
  s_cbranch_vccnz CKX
CKXy:
  buffer_load_dwordx4 v[96:99], v0, s[36:39], s6 offen offset:0 sc1
  buffer_load_dwordx4 v[100:103], v0, s[36:39], s6 offen offset:1024 sc1
  buffer_load_dwordx4 v[104:107], v0, s[36:39], s6 offen offset:2048 sc1
  buffer_load_dwordx4 v[108:111], v0, s[36:39], s6 offen offset:3072 sc1
  buffer_load_dwordx4 v[112:115], v0, s[36:39], s7 offen offset:0 sc1
  buffer_load_dwordx4 v[116:119], v0, s[36:39], s7 offen offset:1024 sc1
  buffer_load_dwordx4 v[120:123], v0, s[36:39], s7 offen offset:2048 sc1
  buffer_load_dwordx4 v[124:127], v0, s[36:39], s7 offen offset:3072 sc1
  s_branch CKXx
code_end:
.fill 2048, 4, 0xBF800000
.section .rodata,"a"
.p2align 6
.amdhsa_kernel k1_mod_kernel
  .amdhsa_next_free_vgpr 77
  .amdhsa_next_free_sgpr 48
  .amdhsa_accum_offset 80
  .amdhsa_group_segment_fixed_size 0
  .amdhsa_kernarg_size 96
  .amdhsa_user_sgpr_count 2
  .amdhsa_user_sgpr_kernarg_segment_ptr 1
  .amdhsa_system_sgpr_workgroup_id_x 1
  .amdhsa_float_denorm_mode_32 3
.end_amdhsa_kernel
.p2align 6
.amdhsa_kernel k3_main_kernel
  .amdhsa_next_free_vgpr 512
  .amdhsa_next_free_sgpr 102
  .amdhsa_accum_offset 256
  .amdhsa_group_segment_fixed_size 0
  .amdhsa_kernarg_size 96
  .amdhsa_user_sgpr_count 2
  .amdhsa_user_sgpr_kernarg_segment_ptr 1
  .amdhsa_system_sgpr_workgroup_id_x 1
  .amdhsa_float_denorm_mode_32 3
.end_amdhsa_kernel
```

```asm
; @launch kernel=k1_mod_kernel grid=(256,1,1) block=(256,1,1) lds=1024
; @launch kernel=k3_main_kernel grid=(256,1,1) block=(256,1,1) lds=163840
.amdgcn_target "amdgcn-amd-amdhsa--gfx950"
.text
.globl k1_mod_kernel
.type k1_mod_kernel,@function
.p2align 8
k1_mod_kernel:
  s_cmp_ge_u32 s2, 256
  s_cbranch_scc1 X_k1_mod_kernel
  s_load_dwordx2 s[4:5], s[0:1], 64
  s_load_dwordx2 s[8:9], s[0:1], 56
  s_load_dwordx2 s[12:13], s[0:1], 88
  s_load_dwordx2 s[16:17], s[0:1], 0
  s_load_dwordx2 s[20:21], s[0:1], 8
  s_load_dwordx2 s[24:25], s[0:1], 88
  s_load_dwordx2 s[32:33], s[0:1], 88
  v_lshrrev_b32 v11, 6, v0
  v_and_b32 v10, 63, v0
  v_readfirstlane_b32 s36, v11
  s_mov_b32 s37, s2
  s_mov_b32 s6, 12582912
  s_mov_b32 s7, 0x20000
  s_mov_b32 s10, 2048
  s_mov_b32 s11, 0x20000
  s_mov_b32 s14, 98304
  s_mov_b32 s15, 0x20000
  s_mov_b32 s18, 4194304
  s_mov_b32 s19, 0x20000
  s_mov_b32 s22, 6291456
  s_mov_b32 s23, 0x20000
  s_mov_b32 s26, 262144
  s_mov_b32 s27, 0x20000
  s_mov_b32 s34, 1048576
  s_mov_b32 s35, 0x20000
  s_waitcnt lgkmcnt(0)
  s_add_u32 s24, s24, 5242880
  s_addc_u32 s25, s25, 0
  s_cmp_lg_u32 s36, 2
  s_cbranch_scc1 F_zk1_mod_kernel
  s_lshl_b32 s28, s2, 7
  s_lshr_b32 s29, s2, 2
  s_lshl_b32 s29, s29, 7
  v_lshrrev_b32 v8, 3, v10
  v_mov_b32 v4, s28
  v_mov_b32 v5, s29
  v_cmp_eq_u32 vcc, 2, v8
  v_and_b32 v9, 7, v10
  v_lshlrev_b32 v8, 15, v8
  v_cndmask_b32 v4, v4, v5, vcc
  v_lshl_add_u32 v8, v9, 4, v8
  v_add_u32 v8, v8, v4
  v_mov_b32 v4, 0
  v_mov_b32 v5, 0
  v_mov_b32 v6, 0
  v_mov_b32 v7, 0
  buffer_store_dwordx4 v[4:7], v8, s[24:27], 0 offen
  s_nop 1
F_zk1_mod_kernel:
  s_cmp_lg_u32 s36, 1
  s_cbranch_scc1 F_sent
  v_mov_b32 v4, -1
  v_mov_b32 v5, -1
  v_mov_b32 v6, -1
  v_mov_b32 v7, -1
  v_lshlrev_b32 v8, 4, v10
  v_lshlrev_b32 v9, 2, v10
  s_lshl_b32 s28, s2, 11
  s_add_u32 s28, s28, 524288
  buffer_store_dwordx4 v[4:7], v8, s[32:35], s28 offen
  buffer_store_dwordx4 v[4:7], v8, s[32:35], s28 offen offset:1024
  s_and_b32 s28, s2, 3
  s_mul_i32 s28, s28, 24576
  s_lshr_b32 s29, s2, 2
  s_lshl_b32 s29, s29, 8
  s_add_u32 s28, s28, s29
  s_add_u32 s28, s28, 8192
  buffer_store_dword v4, v9, s[32:35], s28 offen
  s_nop 1
F_sent:
  s_cmp_ge_u32 s2, 128
  s_cbranch_scc1 T_k1_mod_kernel
  s_lshr_b32 s40, s37, 2
  s_add_u32 s40, s40, 0
  s_and_b32 s41, s37, 3
  s_lshl_b32 s38, s41, 8
  s_lshl_b32 s39, s36, 6
  s_add_u32 s38, s38, s39
  v_and_b32 v12, 0x38, v10
  v_add_u32 v12, s38, v12
  v_lshlrev_b32 v13, 1, v12
  v_mul_u32_u24 v16, 12288, v12
  v_and_b32 v14, 7, v10
  v_lshl_add_u32 v16, v14, 4, v16
  s_lshl_b32 s39, s40, 7
  buffer_load_dwordx4 v[20:23], v13, s[8:11], 0 offen
  buffer_load_dwordx4 v[32:35], v16, s[4:7], s39 offen nt
  s_add_u32 s39, s39, 12288
  buffer_load_dwordx4 v[36:39], v16, s[4:7], s39 offen nt
  s_add_u32 s39, s39, 12288
  buffer_load_dwordx4 v[40:43], v16, s[4:7], s39 offen nt
  s_add_u32 s39, s39, 12288
  buffer_load_dwordx4 v[44:47], v16, s[4:7], s39 offen nt
  s_add_u32 s39, s39, 12288
  buffer_load_dwordx4 v[48:51], v16, s[4:7], s39 offen nt
  s_add_u32 s39, s39, 12288
  buffer_load_dwordx4 v[52:55], v16, s[4:7], s39 offen nt
  s_add_u32 s39, s39, 12288
  buffer_load_dwordx4 v[56:59], v16, s[4:7], s39 offen nt
  s_add_u32 s39, s39, 12288
  buffer_load_dwordx4 v[60:63], v16, s[4:7], s39 offen nt
  s_lshr_b32 s44, s37, 3
  s_lshl_b32 s44, s44, 13
  s_cmp_lg_u32 s36, 3
  s_cbranch_scc1 TC1_k1_mod_kernel
  s_cmp_ge_u32 s44, code_end-k3_main_kernel
  s_cbranch_scc1 TC1_k1_mod_kernel
  s_getpc_b64 s[42:43]
TC1_k1_mod_kernelp:
  s_add_u32 s44, s44, k3_main_kernel-TC1_k1_mod_kernelp
  s_ashr_i32 vcc_hi, s44, 31
  s_add_u32 s42, s42, s44
  s_addc_u32 s43, s43, vcc_hi
  v_lshlrev_b32 v74, 7, v10
  v_mov_b32 v75, s43
  v_add_co_u32 v74, vcc, s42, v74
  s_nop 1
  v_addc_co_u32 v75, vcc, 0, v75, vcc
  global_load_dword v76, v[74:75], off
TC1_k1_mod_kernel:
  v_lshlrev_b32 v74, 7, v10
  s_lshl_b32 s42, s37, 1
  s_add_u32 s42, s42, s36
  s_lshl_b32 s42, s42, 13
  s_cmp_lt_u32 s36, 2
  s_cselect_b32 s42, s42, 0x40000000
  buffer_load_dword v76, v74, s[16:19], s42 offen
  v_lshlrev_b32 v74, 7, v10
  s_mul_i32 s42, s36, 256
  s_add_u32 s42, s42, s37
  s_lshl_b32 s42, s42, 13
  s_add_u32 s43, s42, 0
  s_cmp_lt_u32 s43, 2095104
  s_cselect_b32 s43, s43, 0x40000000
  buffer_load_dword v76, v74, s[20:23], s43 offen
  s_waitcnt vmcnt(10)
  v_lshlrev_b32 v24, 16, v20
  v_and_b32 v25, 0xffff0000, v20
  v_lshlrev_b32 v26, 16, v21
  v_and_b32 v27, 0xffff0000, v21
  v_lshlrev_b32 v28, 16, v22
  v_and_b32 v29, 0xffff0000, v22
  v_lshlrev_b32 v30, 16, v23
  v_and_b32 v31, 0xffff0000, v23
  v_mul_f32 v64, 0xbfb8aa3b, v24
  v_mul_f32 v65, 0xbfb8aa3b, v25
  v_mul_f32 v66, 0xbfb8aa3b, v26
  v_mul_f32 v67, 0xbfb8aa3b, v27
  v_mul_f32 v68, 0xbfb8aa3b, v28
  v_mul_f32 v69, 0xbfb8aa3b, v29
  v_mul_f32 v70, 0xbfb8aa3b, v30
  v_mul_f32 v71, 0xbfb8aa3b, v31
  v_exp_f32 v64, v64
  v_exp_f32 v65, v65
  v_exp_f32 v66, v66
  v_exp_f32 v67, v67
  v_exp_f32 v68, v68
  v_exp_f32 v69, v69
  v_exp_f32 v70, v70
  v_exp_f32 v71, v71
  v_add_f32 v64, 1.0, v64
  v_add_f32 v65, 1.0, v65
  v_add_f32 v66, 1.0, v66
  v_add_f32 v67, 1.0, v67
  v_add_f32 v68, 1.0, v68
  v_add_f32 v69, 1.0, v69
  v_add_f32 v70, 1.0, v70
  v_add_f32 v71, 1.0, v71
  v_rcp_f32 v64, v64
  v_rcp_f32 v65, v65
  v_rcp_f32 v66, v66
  v_rcp_f32 v67, v67
  v_rcp_f32 v68, v68
  v_rcp_f32 v69, v69
  v_rcp_f32 v70, v70
  v_rcp_f32 v71, v71
  v_mul_f32 v24, v24, v64
  v_mul_f32 v25, v25, v65
  v_mul_f32 v26, v26, v66
  v_mul_f32 v27, v27, v67
  v_mul_f32 v28, v28, v68
  v_mul_f32 v29, v29, v69
  v_mul_f32 v30, v30, v70
  v_mul_f32 v31, v31, v71
  v_cvt_pk_bf16_f32 v72, v24, v25
  v_lshlrev_b32 v24, 16, v72
  v_and_b32 v25, 0xffff0000, v72
  v_cvt_pk_bf16_f32 v72, v26, v27
  v_lshlrev_b32 v26, 16, v72
  v_and_b32 v27, 0xffff0000, v72
  v_cvt_pk_bf16_f32 v72, v28, v29
  v_lshlrev_b32 v28, 16, v72
  v_and_b32 v29, 0xffff0000, v72
  v_cvt_pk_bf16_f32 v72, v30, v31
  v_lshlrev_b32 v30, 16, v72
  v_and_b32 v31, 0xffff0000, v72
  v_and_b32 v12, 7, v10
  v_lshlrev_b32 v12, 5, v12
  v_lshrrev_b32 v13, 4, v10
  v_lshl_add_u32 v12, v13, 3, v12
  s_lshl_b32 s38, s36, 8
  v_add_u32 v12, s38, v12
  v_lshlrev_b32 v13, 2, v10
  s_mul_i32 s38, s41, 24576
  s_lshl_b32 s39, s40, 8
  s_add_u32 s38, s38, s39
  s_waitcnt vmcnt(9)
  v_lshlrev_b32 v72, 16, v32
  v_and_b32 v73, 0xffff0000, v32
  v_mul_f32 v64, v24, v72
  v_mul_f32 v65, v24, v73
  v_lshlrev_b32 v72, 16, v33
  v_and_b32 v73, 0xffff0000, v33
  v_mul_f32 v66, v24, v72
  v_mul_f32 v67, v24, v73
  v_lshlrev_b32 v72, 16, v34
  v_and_b32 v73, 0xffff0000, v34
  v_mul_f32 v68, v24, v72
  v_mul_f32 v69, v24, v73
  v_lshlrev_b32 v72, 16, v35
  v_and_b32 v73, 0xffff0000, v35
  v_mul_f32 v70, v24, v72
  v_mul_f32 v71, v24, v73
  s_waitcnt vmcnt(8)
  v_lshlrev_b32 v72, 16, v36
  v_and_b32 v73, 0xffff0000, v36
  v_fmac_f32 v64, v25, v72
  v_fmac_f32 v65, v25, v73
  v_lshlrev_b32 v72, 16, v37
  v_and_b32 v73, 0xffff0000, v37
  v_fmac_f32 v66, v25, v72
  v_fmac_f32 v67, v25, v73
  v_lshlrev_b32 v72, 16, v38
  v_and_b32 v73, 0xffff0000, v38
  v_fmac_f32 v68, v25, v72
  v_fmac_f32 v69, v25, v73
  v_lshlrev_b32 v72, 16, v39
  v_and_b32 v73, 0xffff0000, v39
  v_fmac_f32 v70, v25, v72
  v_fmac_f32 v71, v25, v73
  s_waitcnt vmcnt(7)
  v_lshlrev_b32 v72, 16, v40
  v_and_b32 v73, 0xffff0000, v40
  v_fmac_f32 v64, v26, v72
  v_fmac_f32 v65, v26, v73
  v_lshlrev_b32 v72, 16, v41
  v_and_b32 v73, 0xffff0000, v41
  v_fmac_f32 v66, v26, v72
  v_fmac_f32 v67, v26, v73
  v_lshlrev_b32 v72, 16, v42
  v_and_b32 v73, 0xffff0000, v42
  v_fmac_f32 v68, v26, v72
  v_fmac_f32 v69, v26, v73
  v_lshlrev_b32 v72, 16, v43
  v_and_b32 v73, 0xffff0000, v43
  v_fmac_f32 v70, v26, v72
  v_fmac_f32 v71, v26, v73
  s_waitcnt vmcnt(6)
  v_lshlrev_b32 v72, 16, v44
  v_and_b32 v73, 0xffff0000, v44
  v_fmac_f32 v64, v27, v72
  v_fmac_f32 v65, v27, v73
  v_lshlrev_b32 v72, 16, v45
  v_and_b32 v73, 0xffff0000, v45
  v_fmac_f32 v66, v27, v72
  v_fmac_f32 v67, v27, v73
  v_lshlrev_b32 v72, 16, v46
  v_and_b32 v73, 0xffff0000, v46
  v_fmac_f32 v68, v27, v72
  v_fmac_f32 v69, v27, v73
  v_lshlrev_b32 v72, 16, v47
  v_and_b32 v73, 0xffff0000, v47
  v_fmac_f32 v70, v27, v72
  v_fmac_f32 v71, v27, v73
  s_waitcnt vmcnt(5)
  v_lshlrev_b32 v72, 16, v48
  v_and_b32 v73, 0xffff0000, v48
  v_fmac_f32 v64, v28, v72
  v_fmac_f32 v65, v28, v73
  v_lshlrev_b32 v72, 16, v49
  v_and_b32 v73, 0xffff0000, v49
  v_fmac_f32 v66, v28, v72
  v_fmac_f32 v67, v28, v73
  v_lshlrev_b32 v72, 16, v50
  v_and_b32 v73, 0xffff0000, v50
  v_fmac_f32 v68, v28, v72
  v_fmac_f32 v69, v28, v73
  v_lshlrev_b32 v72, 16, v51
  v_and_b32 v73, 0xffff0000, v51
  v_fmac_f32 v70, v28, v72
  v_fmac_f32 v71, v28, v73
  s_waitcnt vmcnt(4)
  v_lshlrev_b32 v72, 16, v52
  v_and_b32 v73, 0xffff0000, v52
  v_fmac_f32 v64, v29, v72
  v_fmac_f32 v65, v29, v73
  v_lshlrev_b32 v72, 16, v53
  v_and_b32 v73, 0xffff0000, v53
  v_fmac_f32 v66, v29, v72
  v_fmac_f32 v67, v29, v73
  v_lshlrev_b32 v72, 16, v54
  v_and_b32 v73, 0xffff0000, v54
  v_fmac_f32 v68, v29, v72
  v_fmac_f32 v69, v29, v73
  v_lshlrev_b32 v72, 16, v55
  v_and_b32 v73, 0xffff0000, v55
  v_fmac_f32 v70, v29, v72
  v_fmac_f32 v71, v29, v73
  s_waitcnt vmcnt(3)
  v_lshlrev_b32 v72, 16, v56
  v_and_b32 v73, 0xffff0000, v56
  v_fmac_f32 v64, v30, v72
  v_fmac_f32 v65, v30, v73
  v_lshlrev_b32 v72, 16, v57
  v_and_b32 v73, 0xffff0000, v57
  v_fmac_f32 v66, v30, v72
  v_fmac_f32 v67, v30, v73
  v_lshlrev_b32 v72, 16, v58
  v_and_b32 v73, 0xffff0000, v58
  v_fmac_f32 v68, v30, v72
  v_fmac_f32 v69, v30, v73
  v_lshlrev_b32 v72, 16, v59
  v_and_b32 v73, 0xffff0000, v59
  v_fmac_f32 v70, v30, v72
  v_fmac_f32 v71, v30, v73
  s_waitcnt vmcnt(2)
  v_lshlrev_b32 v72, 16, v60
  v_and_b32 v73, 0xffff0000, v60
  v_fmac_f32 v64, v31, v72
  v_fmac_f32 v65, v31, v73
  v_lshlrev_b32 v72, 16, v61
  v_and_b32 v73, 0xffff0000, v61
  v_fmac_f32 v66, v31, v72
  v_fmac_f32 v67, v31, v73
  v_lshlrev_b32 v72, 16, v62
  v_and_b32 v73, 0xffff0000, v62
  v_fmac_f32 v68, v31, v72
  v_fmac_f32 v69, v31, v73
  v_lshlrev_b32 v72, 16, v63
  v_and_b32 v73, 0xffff0000, v63
  v_fmac_f32 v70, v31, v72
  v_fmac_f32 v71, v31, v73
  s_nop 1
  v_permlane32_swap_b32 v64, v68
  v_permlane32_swap_b32 v65, v69
  v_permlane32_swap_b32 v66, v70
  v_permlane32_swap_b32 v67, v71
  s_nop 0
  v_add_f32 v64, v64, v68
  v_add_f32 v65, v65, v69
  v_add_f32 v66, v66, v70
  v_add_f32 v67, v67, v71
  s_nop 1
  v_permlane16_swap_b32 v64, v66
  v_permlane16_swap_b32 v65, v67
  s_nop 0
  v_add_f32 v64, v64, v66
  v_add_f32 v65, v65, v67
  s_nop 1
  v_add_f32_dpp v64, v64, v64 row_ror:8 row_mask:0xf bank_mask:0xf
  v_add_f32_dpp v65, v65, v65 row_ror:8 row_mask:0xf bank_mask:0xf
  ds_write_b64 v12, v[64:65]
  s_waitcnt lgkmcnt(0)
  s_barrier
  s_cmp_lg_u32 s36, 0
  s_cbranch_scc1 E_k1_mod_kernel
  ds_read_b32 v64, v13 offset:0
  ds_read_b32 v65, v13 offset:256
  ds_read_b32 v66, v13 offset:512
  ds_read_b32 v67, v13 offset:768
  s_waitcnt lgkmcnt(0)
  v_add_f32 v64, v64, v65
  v_add_f32 v66, v66, v67
  v_add_f32 v64, v64, v66
  buffer_store_dword v64, v13, s[12:15], s38 offen
  s_branch E_k1_mod_kernel
T_k1_mod_kernel:
  s_lshr_b32 s44, s37, 3
  s_lshl_b32 s44, s44, 13
  s_cmp_lg_u32 s36, 3
  s_cbranch_scc1 TC2_k1_mod_kernel
  s_cmp_ge_u32 s44, code_end-k3_main_kernel
  s_cbranch_scc1 TC2_k1_mod_kernel
  s_getpc_b64 s[42:43]
TC2_k1_mod_kernelp:
  s_add_u32 s44, s44, k3_main_kernel-TC2_k1_mod_kernelp
  s_ashr_i32 vcc_hi, s44, 31
  s_add_u32 s42, s42, s44
  s_addc_u32 s43, s43, vcc_hi
  v_lshlrev_b32 v74, 7, v10
  v_mov_b32 v75, s43
  v_add_co_u32 v74, vcc, s42, v74
  s_nop 1
  v_addc_co_u32 v75, vcc, 0, v75, vcc
  global_load_dword v76, v[74:75], off
TC2_k1_mod_kernel:
  v_lshlrev_b32 v74, 7, v10
  s_lshl_b32 s42, s37, 1
  s_add_u32 s42, s42, s36
  s_lshl_b32 s42, s42, 13
  s_cmp_lt_u32 s36, 2
  s_cselect_b32 s42, s42, 0x40000000
  buffer_load_dword v76, v74, s[16:19], s42 offen
  v_lshlrev_b32 v74, 7, v10
  s_mul_i32 s42, s36, 256
  s_add_u32 s42, s42, s37
  s_lshl_b32 s42, s42, 13
  s_add_u32 s43, s42, 0
  s_cmp_lt_u32 s43, 2095104
  s_cselect_b32 s43, s43, 0x40000000
  buffer_load_dword v76, v74, s[20:23], s43 offen
  s_sub_u32 s37, s37, 128
  s_waitcnt vmcnt(0)
  v_lshlrev_b32 v74, 7, v10
  s_mul_i32 s42, s36, 128
  s_add_u32 s42, s42, s37
  s_lshl_b32 s42, s42, 13
  s_add_u32 s43, s42, 0
  s_cmp_lt_u32 s43, 4196352
  s_cselect_b32 s43, s43, 0x40000000
  s_add_u32 s43, s43, 2095104
  buffer_load_dword v76, v74, s[20:23], s43 offen
  s_add_u32 s43, s42, 4194304
  s_cmp_lt_u32 s43, 4196352
  s_cselect_b32 s43, s43, 0x40000000
  s_add_u32 s43, s43, 2095104
  buffer_load_dword v76, v74, s[20:23], s43 offen
E_k1_mod_kernel:
X_k1_mod_kernel:
  s_endpgm
.globl k3_main_kernel
.type k3_main_kernel,@function
.p2align 12
.p2align 8
k3_main_kernel:
  s_cmp_ge_u32 s2, 256
  s_cbranch_scc1 X_k3_main_kernel
  s_load_dwordx2 s[4:5], s[0:1], 0
  s_load_dwordx2 s[36:37], s[0:1], 88
  s_load_dwordx2 s[8:9], s[0:1], 8
  s_load_dwordx2 s[28:29], s[0:1], 64
  s_load_dwordx2 s[40:41], s[0:1], 56
  s_load_dwordx2 s[12:13], s[0:1], 16
  s_load_dwordx2 s[16:17], s[0:1], 32
  s_load_dwordx2 s[20:21], s[0:1], 40
  s_load_dwordx2 s[24:25], s[0:1], 48
  s_load_dwordx2 s[32:33], s[0:1], 72
  v_lshrrev_b32 v1, 6, v0
  v_and_b32 v10, 63, v0
  v_readfirstlane_b32 s44, v1
  v_lshlrev_b32 v0, 4, v10
  s_mov_b32 s6, 4194304
  s_mov_b32 s7, 0x20000
  s_mov_b32 s38, 50331648
  s_mov_b32 s39, 0x20000
  s_mov_b32 s10, 6291456
  s_mov_b32 s11, 0x20000
  s_mov_b32 s30, 12582912
  s_mov_b32 s31, 0x20000
  s_mov_b32 s42, 2048
  s_mov_b32 s43, 0x20000
  s_mov_b32 s14, 2097152
  s_mov_b32 s15, 0x20000
  s_mov_b32 s18, 7340032
  s_mov_b32 s19, 0x20000
  s_mov_b32 s22, 7340032
  s_mov_b32 s23, 0x20000
  s_mov_b32 s26, 7340032
  s_mov_b32 s27, 0x20000
  s_mov_b32 s34, 4194304
  s_mov_b32 s35, 0x20000
  v_and_b32 v12, 7, v10
  v_lshrrev_b32 v13, 3, v10
  v_lshlrev_b32 v132, 11, v12
  v_lshl_add_u32 v132, v13, 4, v132
  s_lshl_b32 s48, s2, 14
  s_lshl_b32 s49, s44, 9
  s_add_u32 s48, s48, s49
  s_lshl_b32 s49, s44, 10
  s_waitcnt lgkmcnt(0)
  buffer_load_dwordx4 v[20:23], v132, s[4:7], s48 offen offset:0
  buffer_load_dwordx4 v[24:27], v132, s[4:7], s48 offen offset:128
  buffer_load_dwordx4 v[28:31], v132, s[4:7], s48 offen offset:256
  buffer_load_dwordx4 v[32:35], v132, s[4:7], s48 offen offset:384
  buffer_load_dwordx4 v[100:103], v0, s[36:39], s49 offen
  s_add_u32 s49, s49, 4096
  buffer_load_dwordx4 v[68:71], v0, s[36:39], s49 offen
  s_add_u32 s49, s49, 20480
  buffer_load_dwordx4 v[104:107], v0, s[36:39], s49 offen
  s_add_u32 s49, s49, 4096
  buffer_load_dwordx4 v[72:75], v0, s[36:39], s49 offen
  s_add_u32 s49, s49, 20480
  buffer_load_dwordx4 v[108:111], v0, s[36:39], s49 offen
  s_add_u32 s49, s49, 4096
  buffer_load_dwordx4 v[76:79], v0, s[36:39], s49 offen
  s_add_u32 s49, s49, 20480
  buffer_load_dwordx4 v[112:115], v0, s[36:39], s49 offen
  s_add_u32 s49, s49, 4096
  buffer_load_dwordx4 v[80:83], v0, s[36:39], s49 offen
  s_mul_i32 s48, s2, 7168
  s_lshl_b32 s49, s2, 13
  s_mov_b32 s55, 0x20000
  s_mov_b32 s54, 1835008
  s_cmp_eq_u32 s44, 1
  s_cselect_b64 s[52:53], s[16:17], s[20:21]
  s_cmp_eq_u32 s44, 0
  s_cselect_b64 s[52:53], s[12:13], s[52:53]
  s_cselect_b32 s54, s14, s54
  s_cselect_b32 s48, s49, s48
  s_lshr_b32 s49, s2, 3
  s_mul_i32 s50, s49, 43
  s_lshr_b32 s50, s50, 7
  s_mul_i32 s50, s50, 387072
  s_lshl_b32 s46, s49, 11
  s_add_u32 s50, s50, s46
  s_and_b32 s46, s2, 2
  s_lshl_b32 s46, s46, 9
  s_add_u32 s50, s50, s46
  s_and_b32 s46, s49, 1
  s_lshl_b32 s46, s46, 10
  s_lshr_b32 s49, s49, 1
  s_lshl_b32 s49, s49, 17
  s_add_u32 s49, s49, s46
  s_bitcmp1_b32 s2, 0
  s_cselect_b32 s49, 1073741824, s50
  s_cselect_b64 vcc, s[12:13], s[8:9]
  s_cselect_b32 s50, s14, s10
  s_cselect_b32 s47, 16, 48
  s_add_u32 s49, s49, 384
  s_cmp_eq_u32 s44, 3
  s_cselect_b64 s[52:53], vcc, s[52:53]
  s_cselect_b32 s54, s50, s54
  s_cselect_b32 s46, s49, s48
  s_cselect_b32 s49, s47, 1
  s_lshl_b32 s49, s49, 3
  v_mul_u32_u24 v19, s49, v0
  buffer_load_dword a252, v19, s[52:55], s46 offen
  s_getpc_b64 s[92:93]
PC0:
  s_lshl_b32 s48, s44, 10
  s_sub_u32 s48, s48, PC0-k3_main_kernel
  s_ashr_i32 s49, s48, 31
  s_add_u32 s92, s92, s48
  s_addc_u32 s93, s93, s49
  s_and_b32 s48, s2, 7
  s_lshr_b32 s49, s2, 3
  s_and_b32 s56, s48, 3
  s_lshl_b32 s56, s56, 2
  s_and_b32 s51, s49, 3
  s_add_u32 s56, s56, s51
  s_lshr_b32 s51, s48, 2
  s_lshl_b32 s51, s51, 3
  s_lshr_b32 s49, s49, 2
  s_add_u32 s51, s51, s49
  s_add_u32 s57, s51, s56
  s_and_b32 s57, s57, 3
  s_lshr_b32 s58, s44, 1
  s_and_b32 s59, s44, 1
  s_mul_i32 s62, s44, 3072
  s_lshl_b32 s63, s44, 11
  s_lshl_b32 s64, s44, 8
  v_bfe_u32 v14, v10, 4, 2
  v_bfe_u32 v15, v10, 1, 2
  v_xor_b32 v14, v14, v15
  v_lshlrev_b32 v14, 5, v14
  v_and_b32 v15, 1, v10
  v_lshl_add_u32 v150, v15, 4, v14
  s_lshl_b32 s48, s56, 7
  s_mul_i32 s49, s44, 49152
  s_add_u32 s48, s48, s49
  v_mul_u32_u24 v14, 6144, v13
  v_add3_u32 v139, v14, v150, s48
  v_add_u32 v140, 1024, v139
  v_add_u32 v141, 2048, v139
  v_bfe_u32 v14, v10, 3, 2
  v_lshlrev_b32 v14, 5, v14
  v_and_b32 v15, 3, v10
  v_lshl_add_u32 v151, v15, 3, v14
  v_bfe_u32 v14, v10, 2, 3
  v_lshrrev_b32 v15, 5, v10
  v_mul_u32_u24 v15, 24, v15
  v_add_lshl_u32 v14, v14, v15, 7
  s_lshl_b32 s48, s59, 1
  s_add_u32 s48, s48, s58
  s_lshl_b32 s48, s48, 5
  v_xor_b32 v15, s48, v151
  v_add_u32 v133, v14, v15
  v_xor_b32 v134, 32, v133
  v_add_u32 v135, 64512, v133
  v_add_u32 v136, 64512, v134
  v_add_u32 v137, 129024, v133
  v_add_u32 v138, 129024, v134
  s_lshl_b32 s48, s51, 2
  s_add_u32 s49, s48, s44
  s_lshl_b32 s49, s49, 16
  s_add_u32 s49, s49, 1048576
  v_add_u32 v142, s49, v0
  s_max_u32 s48, s48, 1
  s_lshl_b32 s48, s48, 16
  s_add_u32 s48, s48, 984064
  s_add_u32 s48, s48, s64
  v_lshl_add_u32 v143, v10, 2, s48
  s_lshl_b32 s48, s58, 12
  v_add_u32 v147, 0, v0
  v_add_u32 v144, s48, v147
  v_add_u32 v148, 64512, v0
  v_add_u32 v145, s48, v148
  v_add_u32 v149, 129024, v0
  v_add_u32 v146, s48, v149
  s_lshl_b32 s48, s51, 4
  s_sub_u32 s48, s48, 2
  v_min_u32 v152, 17, v10
  v_add_u32 v152, s48, v152
  v_max_i32 v152, 0, v152
  v_lshlrev_b32 v152, 7, v152
  s_add_u32 s48, s63, 150528
  v_add_u32 v14, s48, v0
  v_lshl_add_u32 v15, v13, 5, s48
  v_lshlrev_b32 v17, 5, v12
  v_add_u32 v17, 158720, v17
  s_lshl_b32 s48, s44, 3
  v_add_u32 v16, s48, v17
  v_bfe_u32 v18, v10, 3, 1
  v_lshlrev_b32 v132, 9, v18
  v_bfe_u32 v18, v10, 4, 1
  v_lshl_add_u32 v132, v18, 8, v132
  v_lshrrev_b32 v18, 5, v10
  v_lshl_add_u32 v132, v18, 11, v132
  v_lshl_add_u32 v132, v12, 4, v132
  s_lshr_b32 s50, s2, 2
  s_lshl_b32 s50, s50, 16
  s_bfe_u32 s48, s2, 0x10001
  s_lshl_b32 s48, s48, 10
  s_add_u32 s50, s50, s48
  s_and_b32 s48, s2, 1
  s_lshl_b32 s48, s48, 7
  s_add_u32 s50, s50, s48
  s_lshl_b32 s48, s44, 14
  s_add_u32 s50, s50, s48
  s_add_u32 s50, s50, 1048576
  s_lshl_b32 s45, s2, 7
  s_add_u32 s45, s45, 5242880
  s_cmp_eq_u32 s44, 0
  s_cselect_b32 s45, s45, 1073741824
  s_branch AL
.p2align 12
AL:
  s_waitcnt vmcnt(12)
  v_lshlrev_b32 v36, 16, v20
  v_and_b32 v37, 0xffff0000, v20
  v_lshlrev_b32 v38, 16, v21
  v_and_b32 v39, 0xffff0000, v21
  v_lshlrev_b32 v40, 16, v22
  v_and_b32 v41, 0xffff0000, v22
  v_lshlrev_b32 v42, 16, v23
  v_and_b32 v43, 0xffff0000, v23
  s_waitcnt vmcnt(11)
  v_lshlrev_b32 v44, 16, v24
  v_and_b32 v45, 0xffff0000, v24
  v_lshlrev_b32 v46, 16, v25
  v_and_b32 v47, 0xffff0000, v25
  v_lshlrev_b32 v48, 16, v26
  v_and_b32 v49, 0xffff0000, v26
  v_lshlrev_b32 v50, 16, v27
  v_and_b32 v51, 0xffff0000, v27
  s_waitcnt vmcnt(10)
  v_lshlrev_b32 v52, 16, v28
  v_and_b32 v53, 0xffff0000, v28
  v_lshlrev_b32 v54, 16, v29
  v_and_b32 v55, 0xffff0000, v29
  v_lshlrev_b32 v56, 16, v30
  v_and_b32 v57, 0xffff0000, v30
  v_lshlrev_b32 v58, 16, v31
  v_and_b32 v59, 0xffff0000, v31
  s_waitcnt vmcnt(9)
  v_lshlrev_b32 v60, 16, v32
  v_and_b32 v61, 0xffff0000, v32
  v_lshlrev_b32 v62, 16, v33
  v_and_b32 v63, 0xffff0000, v33
  v_lshlrev_b32 v64, 16, v34
  v_and_b32 v65, 0xffff0000, v34
  v_lshlrev_b32 v66, 16, v35
  v_and_b32 v67, 0xffff0000, v35
  v_add_f32 v20, v36, v37
  v_mul_f32 v21, v36, v36
  v_add_f32 v22, v38, v39
  v_mul_f32 v23, v37, v37
  v_fmac_f32 v21, v38, v38
  v_fmac_f32 v23, v39, v39
  v_fmac_f32 v21, v40, v40
  v_add_f32 v20, v20, v40
  v_fmac_f32 v23, v41, v41
  v_add_f32 v22, v22, v41
  v_fmac_f32 v21, v42, v42
  v_add_f32 v20, v20, v42
  v_fmac_f32 v23, v43, v43
  v_add_f32 v22, v22, v43
  v_fmac_f32 v21, v44, v44
  v_add_f32 v20, v20, v44
  v_fmac_f32 v23, v45, v45
  v_add_f32 v22, v22, v45
  v_fmac_f32 v21, v46, v46
  v_add_f32 v20, v20, v46
  v_fmac_f32 v23, v47, v47
  v_add_f32 v22, v22, v47
  v_fmac_f32 v21, v48, v48
  v_add_f32 v20, v20, v48
  v_fmac_f32 v23, v49, v49
  v_add_f32 v22, v22, v49
  v_fmac_f32 v21, v50, v50
  v_add_f32 v20, v20, v50
  v_fmac_f32 v23, v51, v51
  v_add_f32 v22, v22, v51
  v_fmac_f32 v21, v52, v52
  v_add_f32 v20, v20, v52
  v_fmac_f32 v23, v53, v53
  v_add_f32 v22, v22, v53
  v_fmac_f32 v21, v54, v54
  v_add_f32 v20, v20, v54
  v_fmac_f32 v23, v55, v55
  v_add_f32 v22, v22, v55
  v_fmac_f32 v21, v56, v56
  v_add_f32 v20, v20, v56
  v_fmac_f32 v23, v57, v57
  v_add_f32 v22, v22, v57
  v_fmac_f32 v21, v58, v58
  v_add_f32 v20, v20, v58
  v_fmac_f32 v23, v59, v59
  v_add_f32 v22, v22, v59
  v_fmac_f32 v21, v60, v60
  v_add_f32 v20, v20, v60
  v_fmac_f32 v23, v61, v61
  v_add_f32 v22, v22, v61
  v_fmac_f32 v21, v62, v62
  v_add_f32 v20, v20, v62
  v_fmac_f32 v23, v63, v63
  v_add_f32 v22, v22, v63
  v_fmac_f32 v21, v64, v64
  v_add_f32 v20, v20, v64
  v_fmac_f32 v23, v65, v65
  v_add_f32 v22, v22, v65
  v_fmac_f32 v21, v66, v66
  v_add_f32 v20, v20, v66
  v_fmac_f32 v23, v67, v67
  v_add_f32 v22, v22, v67
  v_add_f32 v20, v20, v22
  v_add_f32 v21, v21, v23
  s_nop 0
  v_add_f32_dpp v18, v20, v20 row_ror:8 row_mask:0xf bank_mask:0xf
  v_add_f32_dpp v19, v21, v21 row_ror:8 row_mask:0xf bank_mask:0xf
  v_mov_b32 v20, v18
  v_mov_b32 v21, v19
  s_nop 0
  v_permlane16_swap_b32 v18, v20
  v_permlane16_swap_b32 v19, v21
  v_add_f32 v18, v18, v20
  v_add_f32 v19, v19, v21
  v_mov_b32 v20, v18
  v_mov_b32 v21, v19
  s_nop 0
  v_permlane32_swap_b32 v18, v20
  v_permlane32_swap_b32 v19, v21
  v_add_f32 v18, v18, v20
  v_add_f32 v19, v19, v21
  ds_write_b64 v16, v[18:19]
  s_waitcnt vmcnt(1)
  v_add_f32 v68, v68, v76
  v_add_f32 v100, v100, v108
  v_add_f32 v69, v69, v77
  v_add_f32 v101, v101, v109
  v_add_f32 v70, v70, v78
  v_add_f32 v102, v102, v110
  v_add_f32 v71, v71, v79
  v_add_f32 v103, v103, v111
  v_add_f32 v72, v72, v80
  v_add_f32 v104, v104, v112
  v_add_f32 v73, v73, v81
  v_add_f32 v105, v105, v113
  v_add_f32 v74, v74, v82
  v_add_f32 v106, v106, v114
  v_add_f32 v75, v75, v83
  v_add_f32 v107, v107, v115
  v_add_f32 v68, v68, v72
  v_add_f32 v100, v100, v104
  v_add_f32 v69, v69, v73
  v_add_f32 v101, v101, v105
  v_add_f32 v70, v70, v74
  v_add_f32 v102, v102, v106
  v_add_f32 v71, v71, v75
  v_add_f32 v103, v103, v107
  v_cvt_pk_bf16_f32 v20, v68, v69
  v_lshlrev_b32 v68, 16, v20
  v_and_b32 v69, 0xffff0000, v20
  v_cvt_pk_bf16_f32 v20, v70, v71
  v_lshlrev_b32 v70, 16, v20
  v_and_b32 v71, 0xffff0000, v20
  v_cvt_pk_bf16_f32 v20, v100, v101
  v_lshlrev_b32 v100, 16, v20
  v_and_b32 v101, 0xffff0000, v20
  v_cvt_pk_bf16_f32 v20, v102, v103
  v_lshlrev_b32 v102, 16, v20
  v_and_b32 v103, 0xffff0000, v20
  v_add_f32 v68, 1.0, v68
  v_add_f32 v69, 1.0, v69
  v_add_f32 v70, 1.0, v70
  v_add_f32 v71, 1.0, v71
  v_cvt_pk_bf16_f32 v20, v68, v69
  v_lshlrev_b32 v68, 16, v20
  v_and_b32 v69, 0xffff0000, v20
  v_cvt_pk_bf16_f32 v20, v70, v71
  v_lshlrev_b32 v70, 16, v20
  v_and_b32 v71, 0xffff0000, v20
  ds_write_b128 v14, v[68:71]
  ds_write_b128 v14, v[100:103] offset:1024
  s_waitcnt lgkmcnt(0)
  s_barrier
  ds_read_b128 v[20:23], v17 offset:0
  ds_read_b128 v[24:27], v17 offset:16
  ds_read_b128 v[68:71], v15 offset:0
  ds_read_b128 v[100:103], v15 offset:1024
  ds_read_b128 v[72:75], v15 offset:16
  ds_read_b128 v[104:107], v15 offset:1040
  ds_read_b128 v[76:79], v15 offset:256
  ds_read_b128 v[108:111], v15 offset:1280
  ds_read_b128 v[80:83], v15 offset:272
  ds_read_b128 v[112:115], v15 offset:1296
  ds_read_b128 v[84:87], v15 offset:512
  ds_read_b128 v[116:119], v15 offset:1536
  ds_read_b128 v[88:91], v15 offset:528
  ds_read_b128 v[120:123], v15 offset:1552
  s_waitcnt lgkmcnt(12)
  v_add_f32 v20, v20, v24
  v_add_f32 v21, v21, v25
  v_add_f32 v22, v22, v26
  v_add_f32 v23, v23, v27
  v_add_f32 v20, v20, v22
  v_add_f32 v21, v21, v23
  ds_read_b128 v[92:95], v15 offset:768
  ds_read_b128 v[124:127], v15 offset:1792
  ds_read_b128 v[96:99], v15 offset:784
  ds_read_b128 v[128:131], v15 offset:1808
  v_mul_f32 v18, 0x3a800000, v20
  v_mul_f32 v19, 0x3a800000, v21
  v_fma_f32 v19, -v18, v18, v19
  v_max_f32 v19, 0, v19
  v_cvt_pk_bf16_f32 v19, v19, v19
  v_lshlrev_b32 v19, 16, v19
  v_add_f32 v19, 0x3727c5ac, v19
  v_cvt_pk_bf16_f32 v19, v19, v19
  v_lshlrev_b32 v19, 16, v19
  v_sqrt_f32 v19, v19
  v_cvt_pk_bf16_f32 v18, v18, v18
  v_lshlrev_b32 v18, 16, v18
  v_cvt_pk_bf16_f32 v19, v19, v19
  v_lshlrev_b32 v19, 16, v19
  v_rcp_f32 v19, v19
  s_nop 0
  v_mul_f32 v18, v18, v19
  v_fma_f32 v36, v36, v19, -v18
  v_fma_f32 v37, v37, v19, -v18
  v_fma_f32 v38, v38, v19, -v18
  v_fma_f32 v39, v39, v19, -v18
  v_fma_f32 v40, v40, v19, -v18
  v_fma_f32 v41, v41, v19, -v18
  v_fma_f32 v42, v42, v19, -v18
  v_fma_f32 v43, v43, v19, -v18
  s_waitcnt lgkmcnt(12)
  v_fma_f32 v36, v36, v68, v100
  v_fma_f32 v37, v37, v69, v101
  v_fma_f32 v38, v38, v70, v102
  v_fma_f32 v39, v39, v71, v103
  v_fma_f32 v40, v40, v72, v104
  v_fma_f32 v41, v41, v73, v105
  v_fma_f32 v42, v42, v74, v106
  v_fma_f32 v43, v43, v75, v107
  v_cvt_pk_bf16_f32 v20, v36, v37
  v_cvt_pk_bf16_f32 v21, v38, v39
  v_cvt_pk_bf16_f32 v22, v40, v41
  v_cvt_pk_bf16_f32 v23, v42, v43
  s_nop 1
  v_permlane16_swap_b32 v20, v22
  v_permlane16_swap_b32 v21, v23
  buffer_store_dwordx4 v[20:23], v132, s[36:39], s50 offen sc1
  s_add_u32 s50, s50, 4096
  v_fma_f32 v44, v44, v19, -v18
  v_fma_f32 v45, v45, v19, -v18
  v_fma_f32 v46, v46, v19, -v18
  v_fma_f32 v47, v47, v19, -v18
  v_fma_f32 v48, v48, v19, -v18
  v_fma_f32 v49, v49, v19, -v18
  v_fma_f32 v50, v50, v19, -v18
  v_fma_f32 v51, v51, v19, -v18
  s_waitcnt lgkmcnt(8)
  v_fma_f32 v44, v44, v76, v108
  v_fma_f32 v45, v45, v77, v109
  v_fma_f32 v46, v46, v78, v110
  v_fma_f32 v47, v47, v79, v111
  v_fma_f32 v48, v48, v80, v112
  v_fma_f32 v49, v49, v81, v113
  v_fma_f32 v50, v50, v82, v114
  v_fma_f32 v51, v51, v83, v115
  v_cvt_pk_bf16_f32 v24, v44, v45
  v_cvt_pk_bf16_f32 v25, v46, v47
  v_cvt_pk_bf16_f32 v26, v48, v49
  v_cvt_pk_bf16_f32 v27, v50, v51
  s_nop 1
  v_permlane16_swap_b32 v24, v26
  v_permlane16_swap_b32 v25, v27
  buffer_store_dwordx4 v[24:27], v132, s[36:39], s50 offen sc1
  s_add_u32 s50, s50, 4096
  v_fma_f32 v52, v52, v19, -v18
  v_fma_f32 v53, v53, v19, -v18
  v_fma_f32 v54, v54, v19, -v18
  v_fma_f32 v55, v55, v19, -v18
  v_fma_f32 v56, v56, v19, -v18
  v_fma_f32 v57, v57, v19, -v18
  v_fma_f32 v58, v58, v19, -v18
  v_fma_f32 v59, v59, v19, -v18
  s_waitcnt lgkmcnt(4)
  v_fma_f32 v52, v52, v84, v116
  v_fma_f32 v53, v53, v85, v117
  v_fma_f32 v54, v54, v86, v118
  v_fma_f32 v55, v55, v87, v119
  v_fma_f32 v56, v56, v88, v120
  v_fma_f32 v57, v57, v89, v121
  v_fma_f32 v58, v58, v90, v122
  v_fma_f32 v59, v59, v91, v123
  v_cvt_pk_bf16_f32 v28, v52, v53
  v_cvt_pk_bf16_f32 v29, v54, v55
  v_cvt_pk_bf16_f32 v30, v56, v57
  v_cvt_pk_bf16_f32 v31, v58, v59
  s_nop 1
  v_permlane16_swap_b32 v28, v30
  v_permlane16_swap_b32 v29, v31
  buffer_store_dwordx4 v[28:31], v132, s[36:39], s50 offen sc1
  s_add_u32 s50, s50, 4096
  v_fma_f32 v60, v60, v19, -v18
  v_fma_f32 v61, v61, v19, -v18
  v_fma_f32 v62, v62, v19, -v18
  v_fma_f32 v63, v63, v19, -v18
  v_fma_f32 v64, v64, v19, -v18
  v_fma_f32 v65, v65, v19, -v18
  v_fma_f32 v66, v66, v19, -v18
  v_fma_f32 v67, v67, v19, -v18
  s_waitcnt lgkmcnt(0)
  v_fma_f32 v60, v60, v92, v124
  v_fma_f32 v61, v61, v93, v125
  v_fma_f32 v62, v62, v94, v126
  v_fma_f32 v63, v63, v95, v127
  v_fma_f32 v64, v64, v96, v128
  v_fma_f32 v65, v65, v97, v129
  v_fma_f32 v66, v66, v98, v130
  v_fma_f32 v67, v67, v99, v131
  v_cvt_pk_bf16_f32 v32, v60, v61
  v_cvt_pk_bf16_f32 v33, v62, v63
  v_cvt_pk_bf16_f32 v34, v64, v65
  v_cvt_pk_bf16_f32 v35, v66, v67
  s_nop 1
  v_permlane16_swap_b32 v32, v34
  v_permlane16_swap_b32 v33, v35
  buffer_store_dwordx4 v[32:35], v132, s[36:39], s50 offen sc1
  v_mov_b32 v12, 1
  s_waitcnt vmcnt(0) lgkmcnt(0)
  s_barrier
  s_mov_b64 exec, 1
  buffer_store_dword v12, v0, s[36:39], s45 offen sc1
  s_mov_b64 exec, -1
  s_mov_b32 s65, 0
  s_mul_i32 s60, s65, 196608
  s_add_u32 m0, s62, 64512
  s_nop 0
  buffer_load_dwordx4 v139, s[8:11], s60 offen offset:0 lds
  buffer_load_dwordx4 v140, s[8:11], s60 offen offset:1024 lds
  buffer_load_dwordx4 v141, s[8:11], s60 offen offset:2048 lds
  s_mov_b32 s66, 1
  s_mul_i32 s60, s66, 196608
  s_add_u32 m0, s62, 86016
  s_nop 0
  buffer_load_dwordx4 v139, s[8:11], s60 offen offset:0 lds
  buffer_load_dwordx4 v140, s[8:11], s60 offen offset:1024 lds
  buffer_load_dwordx4 v141, s[8:11], s60 offen offset:2048 lds
  s_mov_b32 s67, 2
  s_mul_i32 s60, s67, 196608
  s_add_u32 m0, s62, 107520
  s_nop 0
  buffer_load_dwordx4 v139, s[8:11], s60 offen offset:0 lds
  buffer_load_dwordx4 v140, s[8:11], s60 offen offset:1024 lds
  buffer_load_dwordx4 v141, s[8:11], s60 offen offset:2048 lds
  s_mov_b32 s68, 3
  s_mul_i32 s60, s68, 196608
  s_add_u32 m0, s62, 129024
  s_nop 0
  buffer_load_dwordx4 v139, s[8:11], s60 offen offset:0 lds
  buffer_load_dwordx4 v140, s[8:11], s60 offen offset:1024 lds
  buffer_load_dwordx4 v141, s[8:11], s60 offen offset:2048 lds
  s_mov_b32 s69, 4
  s_mul_i32 s60, s69, 196608
  s_add_u32 m0, s62, 0
  s_nop 0
  buffer_load_dwordx4 v139, s[8:11], s60 offen offset:0 lds
  buffer_load_dwordx4 v140, s[8:11], s60 offen offset:1024 lds
  buffer_load_dwordx4 v141, s[8:11], s60 offen offset:2048 lds
  s_mov_b64 exec, 0
  s_cmp_eq_u32 s44, 1
  s_cbranch_scc1 Ha0
  s_cmp_eq_u32 s44, 2
  s_cbranch_scc1 Ha1
  s_cmp_eq_u32 s44, 3
  s_cbranch_scc1 Ha2
Ra:
  s_mov_b64 exec, -1
  s_cmp_lg_u32 s44, 0
  s_cbranch_scc1 SM1x
  s_mov_b32 s46, 60000
  s_mov_b32 s47, 5242880
SM1:
  buffer_load_dword v12, v152, s[36:39], s47 offen sc1
  s_sub_u32 s46, s46, 1
  s_cmp_eq_u32 s46, 0
  s_waitcnt vmcnt(0)
  s_cbranch_scc1 SM1x
  v_cmp_ne_u32 vcc, 1, v12
  s_nop 4
  s_cbranch_vccnz SM1
SM1x:
  s_barrier
  s_lshl_b32 s61, s65, 11
  s_add_u32 m0, s63, 76800
  s_nop 0
  buffer_load_dwordx4 v142, s[36:39], s61 offen offset:0 sc1 lds
  buffer_load_dwordx4 v142, s[36:39], s61 offen offset:1024 sc1 lds
  s_add_u32 m0, s64, 84992
  s_nop 0
  buffer_load_dword v143, s[36:39], s61 offen sc1 lds
  s_lshl_b32 s61, s66, 11
  s_add_u32 m0, s63, 98304
  s_nop 0
  buffer_load_dwordx4 v142, s[36:39], s61 offen offset:0 sc1 lds
  buffer_load_dwordx4 v142, s[36:39], s61 offen offset:1024 sc1 lds
  s_add_u32 m0, s64, 106496
  s_nop 0
  buffer_load_dword v143, s[36:39], s61 offen sc1 lds
  s_lshl_b32 s61, s67, 11
  s_add_u32 m0, s63, 119808
  s_nop 0
  buffer_load_dwordx4 v142, s[36:39], s61 offen offset:0 sc1 lds
  buffer_load_dwordx4 v142, s[36:39], s61 offen offset:1024 sc1 lds
  s_add_u32 m0, s64, 128000
  s_nop 0
  buffer_load_dword v143, s[36:39], s61 offen sc1 lds
  s_lshl_b32 s61, s68, 11
  s_add_u32 m0, s63, 141312
  s_nop 0
  buffer_load_dwordx4 v142, s[36:39], s61 offen offset:0 sc1 lds
  buffer_load_dwordx4 v142, s[36:39], s61 offen offset:1024 sc1 lds
  s_add_u32 m0, s64, 149504
  s_nop 0
  buffer_load_dword v143, s[36:39], s61 offen sc1 lds
  s_waitcnt vmcnt(9)
  s_barrier
  ds_read_b64_tr_b16 a[40:41], v135 offset:1024
  ds_read_b64_tr_b16 a[42:43], v135 offset:7168
  ds_read_b64_tr_b16 a[44:45], v136 offset:1024
  ds_read_b64_tr_b16 a[46:47], v136 offset:7168
  ds_read_b64_tr_b16 a[48:49], v135 offset:2048
  ds_read_b64_tr_b16 a[50:51], v135 offset:8192
  ds_read_b64_tr_b16 a[52:53], v136 offset:2048
  ds_read_b64_tr_b16 a[54:55], v136 offset:8192
  ds_read_b128 a[0:3], v145 offset:12288
  ds_read_b128 a[4:7], v145 offset:13312
  ds_read_b128 a[8:11], v145 offset:14336
  ds_read_b128 a[12:15], v145 offset:15360
  ds_read_b128 a[16:19], v148 offset:20480
  s_waitcnt lgkmcnt(0)
  v_mfma_f32_16x16x32_bf16 v[20:23], a[40:43], a[0:3], 0
  s_waitcnt vmcnt(6)
  s_barrier
  s_lshl_b32 s61, s69, 11
  v_mfma_f32_16x16x32_bf16 v[24:27], a[40:43], a[4:7], 0
  s_add_u32 m0, s63, 12288
  ds_read_b64_tr_b16 a[56:57], v135 offset:0
  v_mfma_f32_16x16x32_bf16 v[28:31], a[40:43], a[8:11], 0
  buffer_load_dwordx4 v142, s[36:39], s61 offen offset:0 sc1 lds
  v_mfma_f32_16x16x32_bf16 v[32:35], a[40:43], a[12:15], 0
  ds_read_b64_tr_b16 a[58:59], v135 offset:6144
  v_mfma_f32_16x16x32_bf16 v[116:119], a[40:43], a[16:19], 0
  ds_read_b64_tr_b16 a[60:61], v136 offset:0
  v_mfma_f32_16x16x32_bf16 v[48:51], a[44:47], a[12:15], 0
  v_mfma_f32_16x16x32_bf16 v[44:47], a[44:47], a[8:11], 0
  buffer_load_dwordx4 v142, s[36:39], s61 offen offset:1024 sc1 lds
  s_add_u32 m0, s64, 20480
  v_mfma_f32_16x16x32_bf16 v[40:43], a[44:47], a[4:7], 0
  ds_read_b64_tr_b16 a[62:63], v136 offset:6144
  v_mfma_f32_16x16x32_bf16 v[36:39], a[44:47], a[0:3], 0
  s_waitcnt lgkmcnt(9)
  ds_read_b64_tr_b16 a[64:65], v135 offset:22528
  v_mfma_f32_16x16x32_bf16 v[52:55], a[0:3], a[48:51], 0
  ds_read_b128 a[20:23], v145 offset:33792
  v_mfma_f32_16x16x32_bf16 v[56:59], a[4:7], a[48:51], 0
  buffer_load_dword v143, s[36:39], s61 offen sc1 lds
  s_mov_b32 s70, 5
  v_mfma_f32_16x16x32_bf16 v[60:63], a[8:11], a[48:51], 0
  s_mul_i32 s60, s70, 196608
  s_add_u32 m0, s62, 21504
  ds_read_b64_tr_b16 a[66:67], v135 offset:28672
  v_mfma_f32_16x16x32_bf16 v[64:67], a[12:15], a[48:51], 0
  ds_read_b128 a[24:27], v145 offset:34816
  v_mfma_f32_16x16x32_bf16 v[120:123], a[16:19], a[48:51], 0
  ds_read_b64_tr_b16 a[68:69], v136 offset:22528
  v_mfma_f32_16x16x32_bf16 v[80:83], a[12:15], a[52:55], 0
  buffer_load_dwordx4 v139, s[8:11], s60 offen offset:0 lds
  v_mfma_f32_16x16x32_bf16 v[76:79], a[8:11], a[52:55], 0
  ds_read_b128 a[28:31], v145 offset:35840
  v_mfma_f32_16x16x32_bf16 v[72:75], a[4:7], a[52:55], 0
  ds_read_b64_tr_b16 a[70:71], v136 offset:28672
  v_mfma_f32_16x16x32_bf16 v[68:71], a[0:3], a[52:55], 0
  s_waitcnt lgkmcnt(7)
  ds_read_b128 a[32:35], v145 offset:36864
  v_mfma_f32_16x16x32_bf16 v[84:87], a[56:59], a[0:3], 0
  buffer_load_dwordx4 v140, s[8:11], s60 offen offset:1024 lds
  v_mfma_f32_16x16x32_bf16 v[88:91], a[56:59], a[4:7], 0
  ds_read_b128 a[36:39], v148 offset:41984
  v_mfma_f32_16x16x32_bf16 v[92:95], a[56:59], a[8:11], 0
  ds_read_b64_tr_b16 a[40:41], v135 offset:23552
  v_mfma_f32_16x16x32_bf16 v[96:99], a[56:59], a[12:15], 0
  ds_read_b64_tr_b16 a[42:43], v135 offset:29696
  v_mfma_f32_16x16x32_bf16 v[112:115], a[60:63], a[12:15], 0
  buffer_load_dwordx4 v141, s[8:11], s60 offen offset:2048 lds
  s_lshl_b32 s61, s70, 11
  v_mfma_f32_16x16x32_bf16 v[108:111], a[60:63], a[8:11], 0
  s_add_u32 m0, s63, 33792
  ds_read_b64_tr_b16 a[44:45], v136 offset:23552
  v_mfma_f32_16x16x32_bf16 v[104:107], a[60:63], a[4:7], 0
  ds_read_b64_tr_b16 a[46:47], v136 offset:29696
  v_mfma_f32_16x16x32_bf16 v[100:103], a[60:63], a[0:3], 0
  s_waitcnt vmcnt(9) lgkmcnt(4)
  s_barrier
  v_mfma_f32_16x16x32_bf16 v[20:23], a[64:67], a[20:23], v[20:23]
  buffer_load_dwordx4 v142, s[36:39], s61 offen offset:0 sc1 lds
  v_mfma_f32_16x16x32_bf16 v[24:27], a[64:67], a[24:27], v[24:27]
  ds_read_b64_tr_b16 a[48:49], v135 offset:21504
  v_mfma_f32_16x16x32_bf16 v[28:31], a[64:67], a[28:31], v[28:31]
  ds_read_b64_tr_b16 a[50:51], v135 offset:27648
  v_mfma_f32_16x16x32_bf16 v[32:35], a[64:67], a[32:35], v[32:35]
  v_mfma_f32_16x16x32_bf16 v[116:119], a[64:67], a[36:39], v[116:119]
  buffer_load_dwordx4 v142, s[36:39], s61 offen offset:1024 sc1 lds
  s_add_u32 m0, s64, 41984
  v_mfma_f32_16x16x32_bf16 v[48:51], a[68:71], a[32:35], v[48:51]
  ds_read_b64_tr_b16 a[52:53], v136 offset:21504
  v_mfma_f32_16x16x32_bf16 v[44:47], a[68:71], a[28:31], v[44:47]
  ds_read_b64_tr_b16 a[54:55], v136 offset:27648
  v_mfma_f32_16x16x32_bf16 v[40:43], a[68:71], a[24:27], v[40:43]
  v_mfma_f32_16x16x32_bf16 v[36:39], a[68:71], a[20:23], v[36:39]
  s_waitcnt lgkmcnt(4)
  buffer_load_dword v143, s[36:39], s61 offen sc1 lds
  s_mov_b32 s65, 6
  v_mfma_f32_16x16x32_bf16 v[52:55], a[20:23], a[40:43], v[52:55]
  s_mul_i32 s60, s65, 196608
  s_add_u32 m0, s62, 43008
  ds_read_b64_tr_b16 a[56:57], v135 offset:44032
  v_mfma_f32_16x16x32_bf16 v[56:59], a[24:27], a[40:43], v[56:59]
  ds_read_b128 a[0:3], v145 offset:55296
  v_mfma_f32_16x16x32_bf16 v[60:63], a[28:31], a[40:43], v[60:63]
  ds_read_b64_tr_b16 a[58:59], v135 offset:50176
  v_mfma_f32_16x16x32_bf16 v[64:67], a[32:35], a[40:43], v[64:67]
  buffer_load_dwordx4 v139, s[8:11], s60 offen offset:0 lds
  v_mfma_f32_16x16x32_bf16 v[120:123], a[36:39], a[40:43], v[120:123]
  ds_read_b128 a[4:7], v145 offset:56320
  v_mfma_f32_16x16x32_bf16 v[80:83], a[32:35], a[44:47], v[80:83]
  ds_read_b64_tr_b16 a[60:61], v136 offset:44032
  v_mfma_f32_16x16x32_bf16 v[76:79], a[28:31], a[44:47], v[76:79]
  ds_read_b128 a[8:11], v145 offset:57344
  v_mfma_f32_16x16x32_bf16 v[72:75], a[24:27], a[44:47], v[72:75]
  buffer_load_dwordx4 v140, s[8:11], s60 offen offset:1024 lds
  v_mfma_f32_16x16x32_bf16 v[68:71], a[20:23], a[44:47], v[68:71]
  s_waitcnt lgkmcnt(6)
  ds_read_b64_tr_b16 a[62:63], v136 offset:50176
  v_mfma_f32_16x16x32_bf16 v[84:87], a[48:51], a[20:23], v[84:87]
  ds_read_b128 a[12:15], v145 offset:58368
  v_mfma_f32_16x16x32_bf16 v[88:91], a[48:51], a[24:27], v[88:91]
  ds_read_b128 a[16:19], v148 offset:63488
  v_mfma_f32_16x16x32_bf16 v[92:95], a[48:51], a[28:31], v[92:95]
  buffer_load_dwordx4 v141, s[8:11], s60 offen offset:2048 lds
  s_lshl_b32 s61, s65, 11
  v_mfma_f32_16x16x32_bf16 v[96:99], a[48:51], a[32:35], v[96:99]
  s_add_u32 m0, s63, 55296
  ds_read_b64_tr_b16 a[64:65], v135 offset:45056
  v_mfma_f32_16x16x32_bf16 v[112:115], a[52:55], a[32:35], v[112:115]
  ds_read_b64_tr_b16 a[66:67], v135 offset:51200
  v_mfma_f32_16x16x32_bf16 v[108:111], a[52:55], a[28:31], v[108:111]
  ds_read_b64_tr_b16 a[68:69], v136 offset:45056
  v_mfma_f32_16x16x32_bf16 v[104:107], a[52:55], a[24:27], v[104:107]
  buffer_load_dwordx4 v142, s[36:39], s61 offen offset:0 sc1 lds
  v_mfma_f32_16x16x32_bf16 v[100:103], a[52:55], a[20:23], v[100:103]
  s_waitcnt vmcnt(13) lgkmcnt(3)
  s_barrier
  ds_read_b64_tr_b16 a[70:71], v136 offset:51200
  v_mfma_f32_16x16x32_bf16 v[20:23], a[56:59], a[0:3], v[20:23]
  ds_read_b64_tr_b16 a[40:41], v135 offset:43008
  v_mfma_f32_16x16x32_bf16 v[24:27], a[56:59], a[4:7], v[24:27]
  v_mfma_f32_16x16x32_bf16 v[28:31], a[56:59], a[8:11], v[28:31]
  buffer_load_dwordx4 v142, s[36:39], s61 offen offset:1024 sc1 lds
  s_add_u32 m0, s64, 63488
  v_mfma_f32_16x16x32_bf16 v[32:35], a[56:59], a[12:15], v[32:35]
  ds_read_b64_tr_b16 a[42:43], v135 offset:49152
  v_mfma_f32_16x16x32_bf16 v[116:119], a[56:59], a[16:19], v[116:119]
  ds_read_b64_tr_b16 a[44:45], v136 offset:43008
  v_mfma_f32_16x16x32_bf16 v[48:51], a[60:63], a[12:15], v[48:51]
  v_mfma_f32_16x16x32_bf16 v[44:47], a[60:63], a[8:11], v[44:47]
  buffer_load_dword v143, s[36:39], s61 offen sc1 lds
  s_mov_b32 s66, 7
  v_mfma_f32_16x16x32_bf16 v[40:43], a[60:63], a[4:7], v[40:43]
  s_mul_i32 s60, s66, 196608
  s_add_u32 m0, s62, 64512
  ds_read_b64_tr_b16 a[46:47], v136 offset:49152
  v_mfma_f32_16x16x32_bf16 v[36:39], a[60:63], a[0:3], v[36:39]
  s_waitcnt lgkmcnt(4)
  ds_read_b64_tr_b16 a[48:49], v137 offset:1024
  v_mfma_f32_16x16x32_bf16 v[52:55], a[0:3], a[64:67], v[52:55]
  ds_read_b128 a[20:23], v146 offset:12288
  v_mfma_f32_16x16x32_bf16 v[56:59], a[4:7], a[64:67], v[56:59]
  buffer_load_dwordx4 v139, s[8:11], s60 offen offset:0 lds
  v_mfma_f32_16x16x32_bf16 v[60:63], a[8:11], a[64:67], v[60:63]
  ds_read_b64_tr_b16 a[50:51], v137 offset:7168
  v_mfma_f32_16x16x32_bf16 v[64:67], a[12:15], a[64:67], v[64:67]
  ds_read_b128 a[24:27], v146 offset:13312
  v_mfma_f32_16x16x32_bf16 v[120:123], a[16:19], a[64:67], v[120:123]
  ds_read_b64_tr_b16 a[52:53], v138 offset:1024
  v_mfma_f32_16x16x32_bf16 v[80:83], a[12:15], a[68:71], v[80:83]
  buffer_load_dwordx4 v140, s[8:11], s60 offen offset:1024 lds
  v_mfma_f32_16x16x32_bf16 v[76:79], a[8:11], a[68:71], v[76:79]
  ds_read_b128 a[28:31], v146 offset:14336
  v_mfma_f32_16x16x32_bf16 v[72:75], a[4:7], a[68:71], v[72:75]
  ds_read_b64_tr_b16 a[54:55], v138 offset:7168
  v_mfma_f32_16x16x32_bf16 v[68:71], a[0:3], a[68:71], v[68:71]
  s_waitcnt lgkmcnt(7)
  ds_read_b128 a[32:35], v146 offset:15360
  v_mfma_f32_16x16x32_bf16 v[84:87], a[40:43], a[0:3], v[84:87]
  buffer_load_dwordx4 v141, s[8:11], s60 offen offset:2048 lds
  s_lshl_b32 s61, s66, 11
  v_mfma_f32_16x16x32_bf16 v[88:91], a[40:43], a[4:7], v[88:91]
  s_add_u32 m0, s63, 76800
  ds_read_b128 a[36:39], v149 offset:20480
  v_mfma_f32_16x16x32_bf16 v[92:95], a[40:43], a[8:11], v[92:95]
  ds_read_b64_tr_b16 a[56:57], v137 offset:2048
  v_mfma_f32_16x16x32_bf16 v[96:99], a[40:43], a[12:15], v[96:99]
  ds_read_b64_tr_b16 a[58:59], v137 offset:8192
  v_mfma_f32_16x16x32_bf16 v[112:115], a[44:47], a[12:15], v[112:115]
  buffer_load_dwordx4 v142, s[36:39], s61 offen offset:0 sc1 lds
  v_mfma_f32_16x16x32_bf16 v[108:111], a[44:47], a[8:11], v[108:111]
  ds_read_b64_tr_b16 a[60:61], v138 offset:2048
  v_mfma_f32_16x16x32_bf16 v[104:107], a[44:47], a[4:7], v[104:107]
  ds_read_b64_tr_b16 a[62:63], v138 offset:8192
  v_mfma_f32_16x16x32_bf16 v[100:103], a[44:47], a[0:3], v[100:103]
  s_waitcnt vmcnt(16) lgkmcnt(4)
  s_barrier
  v_mfma_f32_16x16x32_bf16 v[20:23], a[48:51], a[20:23], v[20:23]
  buffer_load_dwordx4 v142, s[36:39], s61 offen offset:1024 sc1 lds
  s_add_u32 m0, s64, 84992
  v_mfma_f32_16x16x32_bf16 v[24:27], a[48:51], a[24:27], v[24:27]
  ds_read_b64_tr_b16 a[64:65], v137 offset:0
  v_mfma_f32_16x16x32_bf16 v[28:31], a[48:51], a[28:31], v[28:31]
  ds_read_b64_tr_b16 a[66:67], v137 offset:6144
  v_mfma_f32_16x16x32_bf16 v[32:35], a[48:51], a[32:35], v[32:35]
  v_mfma_f32_16x16x32_bf16 v[116:119], a[48:51], a[36:39], v[116:119]
  buffer_load_dword v143, s[36:39], s61 offen sc1 lds
  s_mov_b32 s67, 8
  v_mfma_f32_16x16x32_bf16 v[48:51], a[52:55], a[32:35], v[48:51]
  s_mul_i32 s60, s67, 196608
  s_add_u32 m0, s62, 86016
  ds_read_b64_tr_b16 a[68:69], v138 offset:0
  v_mfma_f32_16x16x32_bf16 v[44:47], a[52:55], a[28:31], v[44:47]
  ds_read_b64_tr_b16 a[70:71], v138 offset:6144
  v_mfma_f32_16x16x32_bf16 v[40:43], a[52:55], a[24:27], v[40:43]
  v_mfma_f32_16x16x32_bf16 v[36:39], a[52:55], a[20:23], v[36:39]
  s_waitcnt lgkmcnt(4)
  buffer_load_dwordx4 v139, s[8:11], s60 offen offset:0 lds
  v_mfma_f32_16x16x32_bf16 v[52:55], a[20:23], a[56:59], v[52:55]
  ds_read_b64_tr_b16 a[40:41], v133 offset:1024
  v_mfma_f32_16x16x32_bf16 v[56:59], a[24:27], a[56:59], v[56:59]
  ds_read_b128 a[0:3], v144 offset:12288
  v_mfma_f32_16x16x32_bf16 v[60:63], a[28:31], a[56:59], v[60:63]
Ha0:
  s_cbranch_execz Ha0_1
  ds_read_b64_tr_b16 a[42:43], v133 offset:7168
  v_mfma_f32_16x16x32_bf16 v[64:67], a[32:35], a[56:59], v[64:67]
  buffer_load_dwordx4 v140, s[8:11], s60 offen offset:1024 lds
  v_mfma_f32_16x16x32_bf16 v[120:123], a[36:39], a[56:59], v[120:123]
  ds_read_b128 a[4:7], v144 offset:13312
  v_mfma_f32_16x16x32_bf16 v[80:83], a[32:35], a[60:63], v[80:83]
  ds_read_b64_tr_b16 a[44:45], v134 offset:1024
  v_mfma_f32_16x16x32_bf16 v[76:79], a[28:31], a[60:63], v[76:79]
  ds_read_b128 a[8:11], v144 offset:14336
  v_mfma_f32_16x16x32_bf16 v[72:75], a[24:27], a[60:63], v[72:75]
  buffer_load_dwordx4 v141, s[8:11], s60 offen offset:2048 lds
  s_lshl_b32 s61, s67, 11
  v_mfma_f32_16x16x32_bf16 v[68:71], a[20:23], a[60:63], v[68:71]
  s_waitcnt lgkmcnt(6)
  s_add_u32 m0, s63, 98304
  ds_read_b64_tr_b16 a[46:47], v134 offset:7168
  v_mfma_f32_16x16x32_bf16 v[84:87], a[64:67], a[20:23], v[84:87]
  ds_read_b128 a[12:15], v144 offset:15360
  v_mfma_f32_16x16x32_bf16 v[88:91], a[64:67], a[24:27], v[88:91]
  ds_read_b128 a[16:19], v147 offset:20480
  v_mfma_f32_16x16x32_bf16 v[92:95], a[64:67], a[28:31], v[92:95]
  buffer_load_dwordx4 v142, s[36:39], s61 offen offset:0 sc1 lds
  v_mfma_f32_16x16x32_bf16 v[96:99], a[64:67], a[32:35], v[96:99]
  ds_read_b64_tr_b16 a[48:49], v133 offset:2048
  v_mfma_f32_16x16x32_bf16 v[112:115], a[68:71], a[32:35], v[112:115]
  s_and_b32 s48, s2, 3
  ds_read_b64_tr_b16 a[50:51], v133 offset:8192
  s_lshl_b32 s48, s48, 8
  v_mfma_f32_16x16x32_bf16 v[108:111], a[68:71], a[28:31], v[108:111]
  s_lshl_b32 s49, s44, 6
  ds_read_b64_tr_b16 a[52:53], v134 offset:2048
  s_add_u32 s48, s48, s49
  v_mfma_f32_16x16x32_bf16 v[104:107], a[68:71], a[24:27], v[104:107]
  buffer_load_dwordx4 v142, s[36:39], s61 offen offset:1024 sc1 lds
  s_add_u32 m0, s64, 106496
  v_mfma_f32_16x16x32_bf16 v[100:103], a[68:71], a[20:23], v[100:103]
  s_waitcnt vmcnt(17) lgkmcnt(3)
  s_barrier
  ds_read_b64_tr_b16 a[54:55], v134 offset:8192
  v_mfma_f32_16x16x32_bf16 v[20:23], a[40:43], a[0:3], v[20:23]
  ds_read_b64_tr_b16 a[56:57], v133 offset:0
  v_mfma_f32_16x16x32_bf16 v[24:27], a[40:43], a[4:7], v[24:27]
  v_mfma_f32_16x16x32_bf16 v[28:31], a[40:43], a[8:11], v[28:31]
  buffer_load_dword v143, s[36:39], s61 offen sc1 lds
  s_mov_b32 s68, 9
  v_mfma_f32_16x16x32_bf16 v[32:35], a[40:43], a[12:15], v[32:35]
  s_mul_i32 s60, s68, 196608
  s_add_u32 m0, s62, 107520
  ds_read_b64_tr_b16 a[58:59], v133 offset:6144
  v_mfma_f32_16x16x32_bf16 v[116:119], a[40:43], a[16:19], v[116:119]
  ds_read_b64_tr_b16 a[60:61], v134 offset:0
  v_and_b32 v196, 0x38, v10
  v_mfma_f32_16x16x32_bf16 v[48:51], a[44:47], a[12:15], v[48:51]
  v_add_u32 v196, s48, v196
  v_lshlrev_b32 v12, 1, v196
  v_mfma_f32_16x16x32_bf16 v[44:47], a[44:47], a[8:11], v[44:47]
  buffer_load_dwordx4 v139, s[8:11], s60 offen offset:0 lds
  v_mfma_f32_16x16x32_bf16 v[40:43], a[44:47], a[4:7], v[40:43]
  ds_read_b64_tr_b16 a[62:63], v134 offset:6144
  v_mfma_f32_16x16x32_bf16 v[36:39], a[44:47], a[0:3], v[36:39]
  s_waitcnt lgkmcnt(4)
  ds_read_b64_tr_b16 a[64:65], v133 offset:22528
  v_mfma_f32_16x16x32_bf16 v[52:55], a[0:3], a[48:51], v[52:55]
  ds_read_b128 a[20:23], v144 offset:33792
  v_mfma_f32_16x16x32_bf16 v[56:59], a[4:7], a[48:51], v[56:59]
  buffer_load_dwordx4 v140, s[8:11], s60 offen offset:1024 lds
  v_mfma_f32_16x16x32_bf16 v[60:63], a[8:11], a[48:51], v[60:63]
  ds_read_b64_tr_b16 a[66:67], v133 offset:28672
  v_mfma_f32_16x16x32_bf16 v[64:67], a[12:15], a[48:51], v[64:67]
  ds_read_b128 a[24:27], v144 offset:34816
  v_mfma_f32_16x16x32_bf16 v[120:123], a[16:19], a[48:51], v[120:123]
  buffer_load_dwordx4 v[208:211], v12, s[40:43], 0 offen
  v_mul_u32_u24 v196, 12288, v196
  v_mfma_f32_16x16x32_bf16 v[80:83], a[12:15], a[52:55], v[80:83]
  ds_read_b64_tr_b16 a[68:69], v134 offset:22528
  v_and_b32 v12, 7, v10
  v_mfma_f32_16x16x32_bf16 v[76:79], a[8:11], a[52:55], v[76:79]
  ds_read_b128 a[28:31], v144 offset:35840
  v_lshl_add_u32 v196, v12, 4, v196
  v_mfma_f32_16x16x32_bf16 v[72:75], a[4:7], a[52:55], v[72:75]
  ds_read_b64_tr_b16 a[70:71], v134 offset:28672
  v_lshlrev_b32 v12, 5, v12
  v_mfma_f32_16x16x32_bf16 v[68:71], a[0:3], a[52:55], v[68:71]
  s_waitcnt lgkmcnt(7)
  buffer_load_dwordx4 v141, s[8:11], s60 offen offset:2048 lds
  s_lshl_b32 s61, s68, 11
  v_mfma_f32_16x16x32_bf16 v[84:87], a[56:59], a[0:3], v[84:87]
  s_add_u32 m0, s63, 119808
  ds_read_b128 a[32:35], v144 offset:36864
  v_lshrrev_b32 v13, 4, v10
  v_mfma_f32_16x16x32_bf16 v[88:91], a[56:59], a[4:7], v[88:91]
  ds_read_b128 a[36:39], v147 offset:41984
  v_lshl_add_u32 v12, v13, 3, v12
  v_mfma_f32_16x16x32_bf16 v[92:95], a[56:59], a[8:11], v[92:95]
  s_add_u32 s48, s64, 162816
  ds_read_b64_tr_b16 a[40:41], v133 offset:23552
  v_add_u32 v197, s48, v12
  v_mfma_f32_16x16x32_bf16 v[96:99], a[56:59], a[12:15], v[96:99]
  buffer_load_dwordx4 v142, s[36:39], s61 offen offset:0 sc1 lds
  v_lshlrev_b32 v198, 2, v10
  v_mfma_f32_16x16x32_bf16 v[112:115], a[60:63], a[12:15], v[112:115]
  ds_read_b64_tr_b16 a[42:43], v133 offset:29696
  v_mfma_f32_16x16x32_bf16 v[108:111], a[60:63], a[8:11], v[108:111]
  s_lshr_b32 s48, s2, 2
  ds_read_b64_tr_b16 a[44:45], v134 offset:23552
  s_and_b32 s49, s2, 3
  v_mfma_f32_16x16x32_bf16 v[104:107], a[60:63], a[4:7], v[104:107]
  s_lshl_b32 s52, s48, 7
  ds_read_b64_tr_b16 a[46:47], v134 offset:29696
  v_mfma_f32_16x16x32_bf16 v[100:103], a[60:63], a[0:3], v[100:103]
  s_waitcnt vmcnt(17) lgkmcnt(4)
  s_barrier
  buffer_load_dwordx4 v142, s[36:39], s61 offen offset:1024 sc1 lds
  v_mfma_f32_16x16x32_bf16 v[20:23], a[64:67], a[20:23], v[20:23]
  s_add_u32 m0, s64, 128000
  ds_read_b64_tr_b16 a[48:49], v133 offset:21504
  v_mfma_f32_16x16x32_bf16 v[24:27], a[64:67], a[24:27], v[24:27]
  v_mfma_f32_16x16x32_bf16 v[28:31], a[64:67], a[28:31], v[28:31]
  s_mul_i32 s53, s49, 24576
  ds_read_b64_tr_b16 a[50:51], v133 offset:27648
  s_lshl1_add_u32 s53, s52, s53
  v_mfma_f32_16x16x32_bf16 v[32:35], a[64:67], a[32:35], v[32:35]
  s_add_u32 s53, s53, 8192
  buffer_load_dword v143, s[36:39], s61 offen sc1 lds
  s_mov_b32 s69, 10
  v_mfma_f32_16x16x32_bf16 v[116:119], a[64:67], a[36:39], v[116:119]
  s_mul_i32 s60, s69, 196608
  s_add_u32 m0, s62, 129024
  ds_read_b64_tr_b16 a[52:53], v134 offset:21504
  v_mfma_f32_16x16x32_bf16 v[48:51], a[68:71], a[32:35], v[48:51]
  s_add_u32 s52, s52, 4096
  v_mfma_f32_16x16x32_bf16 v[44:47], a[68:71], a[28:31], v[44:47]
  ds_read_b64_tr_b16 a[54:55], v134 offset:27648
  v_mfma_f32_16x16x32_bf16 v[40:43], a[68:71], a[24:27], v[40:43]
  buffer_load_dwordx4 v139, s[8:11], s60 offen offset:0 lds
  v_mfma_f32_16x16x32_bf16 v[36:39], a[68:71], a[20:23], v[36:39]
  s_waitcnt lgkmcnt(4)
  ds_read_b64_tr_b16 a[56:57], v133 offset:44032
  s_lshr_b32 s49, s2, 3
  v_mfma_f32_16x16x32_bf16 v[52:55], a[20:23], a[40:43], v[52:55]
  s_and_b32 s71, s49, 7
  ds_read_b128 a[0:3], v144 offset:55296
  s_and_b32 s48, s2, 1
  v_mfma_f32_16x16x32_bf16 v[56:59], a[24:27], a[40:43], v[56:59]
  s_lshl1_add_u32 s55, s71, s48
  ds_read_b64_tr_b16 a[58:59], v133 offset:50176
  v_mfma_f32_16x16x32_bf16 v[60:63], a[28:31], a[40:43], v[60:63]
  buffer_load_dwordx4 v140, s[8:11], s60 offen offset:1024 lds
  v_mfma_f32_16x16x32_bf16 v[64:67], a[32:35], a[40:43], v[64:67]
  ds_read_b128 a[4:7], v144 offset:56320
  v_mfma_f32_16x16x32_bf16 v[120:123], a[36:39], a[40:43], v[120:123]
  ds_read_b64_tr_b16 a[60:61], v134 offset:44032
  v_mfma_f32_16x16x32_bf16 v[80:83], a[32:35], a[44:47], v[80:83]
  s_and_b32 s79, s71, 0
  ds_read_b128 a[8:11], v144 offset:57344
  s_lshl_b32 s79, s79, 3
  v_mfma_f32_16x16x32_bf16 v[76:79], a[28:31], a[44:47], v[76:79]
  buffer_load_dwordx4 v141, s[8:11], s60 offen offset:2048 lds
  s_lshl_b32 s61, s69, 11
  v_mfma_f32_16x16x32_bf16 v[72:75], a[24:27], a[44:47], v[72:75]
  s_add_u32 m0, s63, 141312
  ds_read_b64_tr_b16 a[62:63], v134 offset:50176
  v_mfma_f32_16x16x32_bf16 v[68:71], a[20:23], a[44:47], v[68:71]
  s_waitcnt lgkmcnt(7)
  ds_read_b128 a[12:15], v144 offset:58368
  v_mfma_f32_16x16x32_bf16 v[84:87], a[48:51], a[20:23], v[84:87]
  s_bfe_u32 s54, s2, 0x20001
  ds_read_b128 a[16:19], v147 offset:63488
  s_lshr_b32 s49, s2, 6
  v_mfma_f32_16x16x32_bf16 v[88:91], a[48:51], a[24:27], v[88:91]
  s_lshl2_add_u32 s54, s54, s49
  buffer_load_dwordx4 v142, s[36:39], s61 offen offset:0 sc1 lds
  s_lshl_b32 s73, s44, 12
  v_mfma_f32_16x16x32_bf16 v[92:95], a[48:51], a[28:31], v[92:95]
  ds_read_b64_tr_b16 a[64:65], v133 offset:45056
  v_mfma_f32_16x16x32_bf16 v[96:99], a[48:51], a[32:35], v[96:99]
  ds_read_b64_tr_b16 a[66:67], v133 offset:51200
  v_mfma_f32_16x16x32_bf16 v[112:115], a[52:55], a[32:35], v[112:115]
  ds_read_b64_tr_b16 a[68:69], v134 offset:45056
  v_mfma_f32_16x16x32_bf16 v[108:111], a[52:55], a[28:31], v[108:111]
  buffer_load_dwordx4 v142, s[36:39], s61 offen offset:1024 sc1 lds
  s_add_u32 m0, s64, 149504
  v_mfma_f32_16x16x32_bf16 v[104:107], a[52:55], a[24:27], v[104:107]
  s_lshl_b32 s48, s55, 7
  ds_read_b64_tr_b16 a[70:71], v134 offset:51200
  s_lshl_b32 s49, s44, 16
  v_mfma_f32_16x16x32_bf16 v[100:103], a[52:55], a[20:23], v[100:103]
  s_waitcnt vmcnt(18) lgkmcnt(4)
  s_barrier
  s_add_u32 s48, s48, s49
  v_mfma_f32_16x16x32_bf16 v[20:23], a[56:59], a[0:3], v[20:23]
  ds_read_b64_tr_b16 a[40:41], v133 offset:43008
  v_lshrrev_b32 v12, 3, v10
  v_mfma_f32_16x16x32_bf16 v[24:27], a[56:59], a[4:7], v[24:27]
  buffer_load_dword v143, s[36:39], s61 offen sc1 lds
  s_mov_b32 s70, 11
  v_mfma_f32_16x16x32_bf16 v[28:31], a[56:59], a[8:11], v[28:31]
  s_mul_i32 s60, s70, 196608
  s_add_u32 m0, s62, 0
  ds_read_b64_tr_b16 a[42:43], v133 offset:49152
  v_mfma_f32_16x16x32_bf16 v[32:35], a[56:59], a[12:15], v[32:35]
  v_lshlrev_b32 v12, 11, v12
  v_add3_u32 v216, v12, v150, s48
  v_mfma_f32_16x16x32_bf16 v[116:119], a[56:59], a[16:19], v[116:119]
  ds_read_b64_tr_b16 a[44:45], v134 offset:43008
  v_mfma_f32_16x16x32_bf16 v[48:51], a[60:63], a[12:15], v[48:51]
  buffer_load_dwordx4 v139, s[8:11], s60 offen offset:0 lds
  v_mfma_f32_16x16x32_bf16 v[44:47], a[60:63], a[8:11], v[44:47]
  ds_read_b64_tr_b16 a[46:47], v134 offset:49152
  v_mfma_f32_16x16x32_bf16 v[40:43], a[60:63], a[4:7], v[40:43]
  v_mfma_f32_16x16x32_bf16 v[36:39], a[60:63], a[0:3], v[36:39]
  s_waitcnt lgkmcnt(4)
  ds_read_b64_tr_b16 a[48:49], v135 offset:1024
  v_add_u32 v217, 15360, v216
  v_mfma_f32_16x16x32_bf16 v[52:55], a[0:3], a[64:67], v[52:55]
  buffer_load_dwordx4 v140, s[8:11], s60 offen offset:1024 lds
  v_add_u32 v218, 30720, v216
  v_mfma_f32_16x16x32_bf16 v[56:59], a[4:7], a[64:67], v[56:59]
  ds_read_b128 a[20:23], v145 offset:12288
  v_mfma_f32_16x16x32_bf16 v[60:63], a[8:11], a[64:67], v[60:63]
  ds_read_b64_tr_b16 a[50:51], v135 offset:7168
  v_add_u32 v219, 46080, v216
  v_mfma_f32_16x16x32_bf16 v[64:67], a[12:15], a[64:67], v[64:67]
  s_lshl_b32 s72, s54, 18
  ds_read_b128 a[24:27], v145 offset:13312
  s_add_u32 s72, s72, s48
  v_mfma_f32_16x16x32_bf16 v[120:123], a[16:19], a[64:67], v[120:123]
  buffer_load_dwordx4 v141, s[8:11], s60 offen offset:2048 lds
  s_lshl_b32 s61, s70, 11
  v_mfma_f32_16x16x32_bf16 v[80:83], a[12:15], a[68:71], v[80:83]
  s_add_u32 m0, s63, 12288
  ds_read_b64_tr_b16 a[52:53], v136 offset:1024
  v_mfma_f32_16x16x32_bf16 v[76:79], a[8:11], a[68:71], v[76:79]
  ds_read_b128 a[28:31], v145 offset:14336
  v_and_b32 v13, 7, v10
  v_mfma_f32_16x16x32_bf16 v[72:75], a[4:7], a[68:71], v[72:75]
  ds_read_b64_tr_b16 a[54:55], v136 offset:7168
  v_lshrrev_b32 v14, 4, v10
  v_mfma_f32_16x16x32_bf16 v[68:71], a[0:3], a[68:71], v[68:71]
  s_waitcnt lgkmcnt(7)
  buffer_load_dwordx4 v142, s[36:39], s61 offen offset:0 sc1 lds
  v_xor_b32 v13, v13, v14
  v_mfma_f32_16x16x32_bf16 v[84:87], a[40:43], a[0:3], v[84:87]
  ds_read_b128 a[32:35], v145 offset:15360
  v_lshl_add_u32 v220, v13, 4, v12
  v_mfma_f32_16x16x32_bf16 v[88:91], a[40:43], a[4:7], v[88:91]
  ds_read_b128 a[36:39], v148 offset:20480
  v_xor_b32 v221, 64, v220
  v_mfma_f32_16x16x32_bf16 v[92:95], a[40:43], a[8:11], v[92:95]
  ds_read_b64_tr_b16 a[56:57], v135 offset:2048
  v_add_u32 v221, 15360, v221
  v_mfma_f32_16x16x32_bf16 v[96:99], a[40:43], a[12:15], v[96:99]
  buffer_load_dwordx4 v142, s[36:39], s61 offen offset:1024 sc1 lds
  s_add_u32 m0, s64, 20480
  v_mfma_f32_16x16x32_bf16 v[112:115], a[44:47], a[12:15], v[112:115]
  ds_read_b64_tr_b16 a[58:59], v135 offset:8192
  v_mfma_f32_16x16x32_bf16 v[108:111], a[44:47], a[8:11], v[108:111]
  ds_read_b64_tr_b16 a[60:61], v136 offset:2048
  v_mfma_f32_16x16x32_bf16 v[104:107], a[44:47], a[4:7], v[104:107]
  ds_read_b64_tr_b16 a[62:63], v136 offset:8192
  v_mfma_f32_16x16x32_bf16 v[100:103], a[44:47], a[0:3], v[100:103]
  s_waitcnt vmcnt(18) lgkmcnt(4)
  s_barrier
  buffer_load_dword v143, s[36:39], s61 offen sc1 lds
  v_mfma_f32_16x16x32_bf16 v[20:23], a[48:51], a[20:23], v[20:23]
  s_mov_b32 s65, 12
  s_mul_i32 s60, s65, 196608
  s_add_u32 m0, s62, 21504
  v_mfma_f32_16x16x32_bf16 v[24:27], a[48:51], a[24:27], v[24:27]
  s_lshl_b32 s48, s44, 10
  ds_read_b64_tr_b16 a[64:65], v135 offset:0
  s_add_u32 s48, s48, 147456
  v_mfma_f32_16x16x32_bf16 v[28:31], a[48:51], a[28:31], v[28:31]
  ds_read_b64_tr_b16 a[66:67], v135 offset:6144
  v_add_u32 v246, s48, v0
  v_mfma_f32_16x16x32_bf16 v[32:35], a[48:51], a[32:35], v[32:35]
  buffer_load_dwordx4 v139, s[8:11], s60 offen offset:0 lds
  v_lshl_add_u32 v244, v14, 4, s48
  v_mfma_f32_16x16x32_bf16 v[116:119], a[48:51], a[36:39], v[116:119]
  ds_read_b64_tr_b16 a[68:69], v136 offset:0
  v_and_b32 v12, 1, v10
  v_mfma_f32_16x16x32_bf16 v[48:51], a[52:55], a[32:35], v[48:51]
  v_lshlrev_b32 v12, 8, v12
  v_sub_u32 v245, v244, v12
  v_mfma_f32_16x16x32_bf16 v[44:47], a[52:55], a[28:31], v[44:47]
  ds_read_b64_tr_b16 a[70:71], v136 offset:6144
  v_mfma_f32_16x16x32_bf16 v[40:43], a[52:55], a[24:27], v[40:43]
  buffer_load_dwordx4 v140, s[8:11], s60 offen offset:1024 lds
  v_mfma_f32_16x16x32_bf16 v[36:39], a[52:55], a[20:23], v[36:39]
  s_waitcnt lgkmcnt(4)
  ds_read_b64_tr_b16 a[40:41], v135 offset:22528
  v_mfma_f32_16x16x32_bf16 v[52:55], a[20:23], a[56:59], v[52:55]
  ds_read_b128 a[0:3], v145 offset:33792
  v_mfma_f32_16x16x32_bf16 v[56:59], a[24:27], a[56:59], v[56:59]
  s_lshl_b32 s48, s55, 7
  ds_read_b64_tr_b16 a[42:43], v135 offset:28672
  v_and_b32 v13, 0xf0, v0
  v_mfma_f32_16x16x32_bf16 v[60:63], a[28:31], a[56:59], v[60:63]
  buffer_load_dwordx4 v141, s[8:11], s60 offen offset:2048 lds
  s_lshl_b32 s61, s65, 11
  v_mfma_f32_16x16x32_bf16 v[64:67], a[32:35], a[56:59], v[64:67]
  s_add_u32 m0, s63, 33792
  ds_read_b128 a[4:7], v145 offset:34816
  v_lshl_add_u32 v13, v14, 12, v13
  v_mfma_f32_16x16x32_bf16 v[120:123], a[36:39], a[56:59], v[120:123]
  s_lshl1_add_u32 s48, s48, 8192
  ds_read_b64_tr_b16 a[44:45], v136 offset:22528
  v_add_u32 v248, s48, v13
  v_mfma_f32_16x16x32_bf16 v[80:83], a[32:35], a[60:63], v[80:83]
  ds_read_b128 a[8:11], v145 offset:35840
  v_mfma_f32_16x16x32_bf16 v[76:79], a[28:31], a[60:63], v[76:79]
  buffer_load_dwordx4 v142, s[36:39], s61 offen offset:0 sc1 lds
  v_mfma_f32_16x16x32_bf16 v[72:75], a[24:27], a[60:63], v[72:75]
  ds_read_b64_tr_b16 a[46:47], v136 offset:28672
  v_mfma_f32_16x16x32_bf16 v[68:71], a[20:23], a[60:63], v[68:71]
  s_waitcnt lgkmcnt(7)
  ds_read_b128 a[12:15], v145 offset:36864
  v_mfma_f32_16x16x32_bf16 v[84:87], a[64:67], a[20:23], v[84:87]
  ds_read_b128 a[16:19], v148 offset:41984
  v_lshrrev_b32 v12, 2, v10
  v_mfma_f32_16x16x32_bf16 v[88:91], a[64:67], a[24:27], v[88:91]
  buffer_load_dwordx4 v142, s[36:39], s61 offen offset:1024 sc1 lds
  s_add_u32 m0, s64, 41984
  v_mfma_f32_16x16x32_bf16 v[92:95], a[64:67], a[28:31], v[92:95]
  ds_read_b64_tr_b16 a[48:49], v135 offset:23552
  v_lshl_add_u32 v231, v12, 7, v151
  v_mfma_f32_16x16x32_bf16 v[96:99], a[64:67], a[32:35], v[96:99]
  ds_read_b64_tr_b16 a[50:51], v135 offset:29696
  v_xor_b32 v232, 32, v231
  v_mfma_f32_16x16x32_bf16 v[112:115], a[68:71], a[32:35], v[112:115]
  ds_read_b64_tr_b16 a[52:53], v136 offset:23552
  v_mfma_f32_16x16x32_bf16 v[108:111], a[68:71], a[28:31], v[108:111]
  buffer_load_dword v143, s[36:39], s61 offen sc1 lds
  s_mov_b32 s66, 13
  v_mfma_f32_16x16x32_bf16 v[104:107], a[68:71], a[24:27], v[104:107]
  s_mul_i32 s60, s66, 196608
  s_add_u32 m0, s62, 43008
  ds_read_b64_tr_b16 a[54:55], v136 offset:29696
  v_mfma_f32_16x16x32_bf16 v[100:103], a[68:71], a[20:23], v[100:103]
  s_waitcnt vmcnt(18) lgkmcnt(4)
  s_barrier
  v_xor_b32 v233, 64, v231
  v_mfma_f32_16x16x32_bf16 v[20:23], a[40:43], a[0:3], v[20:23]
  ds_read_b64_tr_b16 a[56:57], v135 offset:21504
  v_xor_b32 v234, 96, v231
  v_mfma_f32_16x16x32_bf16 v[24:27], a[40:43], a[4:7], v[24:27]
  buffer_load_dwordx4 v139, s[8:11], s60 offen offset:0 lds
  v_xor_b32 v235, 65536, v231
  v_mfma_f32_16x16x32_bf16 v[28:31], a[40:43], a[8:11], v[28:31]
  ds_read_b64_tr_b16 a[58:59], v135 offset:27648
  v_xor_b32 v236, 65568, v231
  v_mfma_f32_16x16x32_bf16 v[32:35], a[40:43], a[12:15], v[32:35]
  v_xor_b32 v237, 65600, v231
  v_mfma_f32_16x16x32_bf16 v[116:119], a[40:43], a[16:19], v[116:119]
  ds_read_b64_tr_b16 a[60:61], v136 offset:21504
  v_mfma_f32_16x16x32_bf16 v[48:51], a[44:47], a[12:15], v[48:51]
  buffer_load_dwordx4 v140, s[8:11], s60 offen offset:1024 lds
  v_xor_b32 v238, 65632, v231
  v_mfma_f32_16x16x32_bf16 v[44:47], a[44:47], a[8:11], v[44:47]
  ds_read_b64_tr_b16 a[62:63], v136 offset:27648
  v_mfma_f32_16x16x32_bf16 v[40:43], a[44:47], a[4:7], v[40:43]
  s_add_u32 s48, s73, 131072
  v_and_b32 v12, 15, v10
  v_lshrrev_b32 v14, 1, v12
  v_mfma_f32_16x16x32_bf16 v[36:39], a[44:47], a[0:3], v[36:39]
  s_waitcnt lgkmcnt(4)
  ds_read_b64_tr_b16 a[64:65], v135 offset:44032
  v_lshrrev_b32 v13, 5, v10
  v_mfma_f32_16x16x32_bf16 v[52:55], a[0:3], a[48:51], v[52:55]
  buffer_load_dwordx4 v141, s[8:11], s60 offen offset:2048 lds
  s_lshl_b32 s61, s66, 11
  v_mfma_f32_16x16x32_bf16 v[56:59], a[4:7], a[48:51], v[56:59]
  s_add_u32 m0, s63, 55296
  ds_read_b128 a[20:23], v145 offset:55296
  v_xor_b32 v14, v14, v13
  v_mfma_f32_16x16x32_bf16 v[60:63], a[8:11], a[48:51], v[60:63]
  ds_read_b64_tr_b16 a[66:67], v135 offset:50176
  v_lshlrev_b32 v14, 4, v14
  v_mfma_f32_16x16x32_bf16 v[64:67], a[12:15], a[48:51], v[64:67]
  ds_read_b128 a[24:27], v145 offset:56320
  v_lshl_add_u32 v14, v12, 7, v14
  v_mfma_f32_16x16x32_bf16 v[120:123], a[16:19], a[48:51], v[120:123]
  buffer_load_dwordx4 v142, s[36:39], s61 offen offset:0 sc1 lds
  v_bfe_u32 v13, v10, 4, 1
  v_mfma_f32_16x16x32_bf16 v[80:83], a[12:15], a[52:55], v[80:83]
  ds_read_b64_tr_b16 a[68:69], v136 offset:44032
  v_lshl_add_u32 v14, v13, 3, v14
  v_mfma_f32_16x16x32_bf16 v[76:79], a[8:11], a[52:55], v[76:79]
  ds_read_b128 a[28:31], v145 offset:57344
  v_add_u32 v239, s48, v14
  v_mfma_f32_16x16x32_bf16 v[72:75], a[4:7], a[52:55], v[72:75]
  ds_read_b64_tr_b16 a[70:71], v136 offset:50176
  v_xor_b32 v240, 32, v239
  v_mfma_f32_16x16x32_bf16 v[68:71], a[0:3], a[52:55], v[68:71]
  s_waitcnt lgkmcnt(7)
  buffer_load_dwordx4 v142, s[36:39], s61 offen offset:1024 sc1 lds
  s_add_u32 m0, s64, 63488
  v_mfma_f32_16x16x32_bf16 v[84:87], a[56:59], a[0:3], v[84:87]
  ds_read_b128 a[32:35], v145 offset:58368
  v_xor_b32 v241, 64, v239
  v_mfma_f32_16x16x32_bf16 v[88:91], a[56:59], a[4:7], v[88:91]
  ds_read_b128 a[36:39], v148 offset:63488
  v_xor_b32 v242, 96, v239
  v_mfma_f32_16x16x32_bf16 v[92:95], a[56:59], a[8:11], v[92:95]
  ds_read_b64_tr_b16 a[40:41], v135 offset:45056
  v_mfma_f32_16x16x32_bf16 v[96:99], a[56:59], a[12:15], v[96:99]
  buffer_load_dword v143, s[36:39], s61 offen sc1 lds
  s_mov_b32 s67, 14
  v_mfma_f32_16x16x32_bf16 v[112:115], a[60:63], a[12:15], v[112:115]
  s_mul_i32 s60, s67, 196608
  s_add_u32 m0, s62, 64512
  ds_read_b64_tr_b16 a[42:43], v135 offset:51200
  v_mfma_f32_16x16x32_bf16 v[108:111], a[60:63], a[8:11], v[108:111]
  ds_read_b64_tr_b16 a[44:45], v136 offset:45056
  v_mfma_f32_16x16x32_bf16 v[104:107], a[60:63], a[4:7], v[104:107]
  ds_read_b64_tr_b16 a[46:47], v136 offset:51200
  v_mfma_f32_16x16x32_bf16 v[100:103], a[60:63], a[0:3], v[100:103]
  s_waitcnt vmcnt(18) lgkmcnt(4)
  s_barrier
  buffer_load_dwordx4 v139, s[8:11], s60 offen offset:0 lds
  v_mfma_f32_16x16x32_bf16 v[20:23], a[64:67], a[20:23], v[20:23]
  ds_read_b64_tr_b16 a[48:49], v135 offset:43008
  v_mfma_f32_16x16x32_bf16 v[24:27], a[64:67], a[24:27], v[24:27]
  s_lshl2_add_u32 s48, s54, s44
  s_lshl_b32 s49, s48, 16
  s_add_u32 s49, s49, 7340032
  v_mfma_f32_16x16x32_bf16 v[28:31], a[64:67], a[28:31], v[28:31]
  ds_read_b64_tr_b16 a[50:51], v135 offset:49152
  v_add_u32 v243, s49, v0
  v_mfma_f32_16x16x32_bf16 v[32:35], a[64:67], a[32:35], v[32:35]
  buffer_load_dwordx4 v140, s[8:11], s60 offen offset:1024 lds
  v_mfma_f32_16x16x32_bf16 v[116:119], a[64:67], a[36:39], v[116:119]
  ds_read_b64_tr_b16 a[52:53], v136 offset:43008
  v_mfma_f32_16x16x32_bf16 v[48:51], a[68:71], a[32:35], v[48:51]
  v_mfma_f32_16x16x32_bf16 v[44:47], a[68:71], a[28:31], v[44:47]
  ds_read_b64_tr_b16 a[54:55], v136 offset:49152
  v_mfma_f32_16x16x32_bf16 v[40:43], a[68:71], a[24:27], v[40:43]
  buffer_load_dwordx4 v141, s[8:11], s60 offen offset:2048 lds
  s_lshl_b32 s61, s67, 11
  v_mfma_f32_16x16x32_bf16 v[36:39], a[68:71], a[20:23], v[36:39]
  s_waitcnt lgkmcnt(4)
  s_add_u32 m0, s63, 76800
  ds_read_b64_tr_b16 a[56:57], v137 offset:1024
  v_mfma_f32_16x16x32_bf16 v[52:55], a[20:23], a[40:43], v[52:55]
  s_lshl4_add_u32 s77, s48, s55
  ds_read_b128 a[0:3], v146 offset:12288
  s_lshl_b32 s77, s77, 8
  v_mfma_f32_16x16x32_bf16 v[56:59], a[24:27], a[40:43], v[56:59]
  s_add_u32 s77, s77, 262144
  ds_read_b64_tr_b16 a[58:59], v137 offset:7168
  v_mfma_f32_16x16x32_bf16 v[60:63], a[28:31], a[40:43], v[60:63]
  buffer_load_dwordx4 v142, s[36:39], s61 offen offset:0 sc1 lds
  v_mfma_f32_16x16x32_bf16 v[64:67], a[32:35], a[40:43], v[64:67]
  ds_read_b128 a[4:7], v146 offset:13312
  v_mfma_f32_16x16x32_bf16 v[120:123], a[36:39], a[40:43], v[120:123]
  s_lshr_b32 s76, s48, 1
  ds_read_b64_tr_b16 a[60:61], v138 offset:1024
  s_lshl4_add_u32 s76, s76, s55
  v_mfma_f32_16x16x32_bf16 v[80:83], a[32:35], a[44:47], v[80:83]
  s_and_b32 s49, s48, 1
  ds_read_b128 a[8:11], v146 offset:14336
  s_lshl2_add_u32 s76, s76, s49
  v_mfma_f32_16x16x32_bf16 v[76:79], a[28:31], a[44:47], v[76:79]
  s_lshl_b32 s76, s76, 11
  buffer_load_dwordx4 v142, s[36:39], s61 offen offset:1024 sc1 lds
  s_add_u32 m0, s64, 84992
  v_mfma_f32_16x16x32_bf16 v[72:75], a[24:27], a[44:47], v[72:75]
  s_add_u32 s76, s76, 36700160
  ds_read_b64_tr_b16 a[62:63], v138 offset:7168
  v_mfma_f32_16x16x32_bf16 v[68:71], a[20:23], a[44:47], v[68:71]
  s_waitcnt lgkmcnt(7)
  ds_read_b128 a[12:15], v146 offset:15360
  v_mfma_f32_16x16x32_bf16 v[84:87], a[48:51], a[20:23], v[84:87]
  ds_read_b128 a[16:19], v149 offset:20480
  v_mfma_f32_16x16x32_bf16 v[88:91], a[48:51], a[24:27], v[88:91]
  buffer_load_dword v143, s[36:39], s61 offen sc1 lds
  s_mov_b32 s68, 15
  v_mfma_f32_16x16x32_bf16 v[92:95], a[48:51], a[28:31], v[92:95]
  s_mul_i32 s60, s68, 196608
  s_add_u32 m0, s62, 86016
  ds_read_b64_tr_b16 a[64:65], v137 offset:2048
  v_mfma_f32_16x16x32_bf16 v[96:99], a[48:51], a[32:35], v[96:99]
  ds_read_b64_tr_b16 a[66:67], v137 offset:8192
  v_mfma_f32_16x16x32_bf16 v[112:115], a[52:55], a[32:35], v[112:115]
  s_lshl1_add_u32 s78, s48, s55
  ds_read_b64_tr_b16 a[68:69], v138 offset:2048
  s_lshl_b32 s78, s78, 11
  v_mfma_f32_16x16x32_bf16 v[108:111], a[52:55], a[28:31], v[108:111]
  s_add_u32 s78, s78, 5767168
  buffer_load_dwordx4 v139, s[8:11], s60 offen offset:0 lds
  s_and_b32 s48, s48, 7
  v_mfma_f32_16x16x32_bf16 v[104:107], a[52:55], a[24:27], v[104:107]
  s_cselect_b32 s78, 1073741824, s78
  ds_read_b64_tr_b16 a[70:71], v138 offset:8192
  v_mfma_f32_16x16x32_bf16 v[100:103], a[52:55], a[20:23], v[100:103]
  s_waitcnt vmcnt(19) lgkmcnt(4)
  s_barrier
  v_mfma_f32_16x16x32_bf16 v[20:23], a[56:59], a[0:3], v[20:23]
  ds_read_b64_tr_b16 a[40:41], v137 offset:0
  v_mfma_f32_16x16x32_bf16 v[24:27], a[56:59], a[4:7], v[24:27]
  buffer_load_dwordx4 v140, s[8:11], s60 offen offset:1024 lds
  v_mfma_f32_16x16x32_bf16 v[28:31], a[56:59], a[8:11], v[28:31]
  ds_read_b64_tr_b16 a[42:43], v137 offset:6144
  v_mfma_f32_16x16x32_bf16 v[32:35], a[56:59], a[12:15], v[32:35]
  v_mfma_f32_16x16x32_bf16 v[116:119], a[56:59], a[16:19], v[116:119]
  s_and_b32 s48, s54, 7
  ds_read_b64_tr_b16 a[44:45], v138 offset:0
  s_lshl_b32 s48, s48, 5
  v_mfma_f32_16x16x32_bf16 v[48:51], a[60:63], a[12:15], v[48:51]
  s_lshr_b32 s49, s54, 3
  buffer_load_dwordx4 v141, s[8:11], s60 offen offset:2048 lds
  s_lshl_b32 s61, s68, 11
  v_mfma_f32_16x16x32_bf16 v[44:47], a[60:63], a[8:11], v[44:47]
  s_add_u32 m0, s63, 98304
  ds_read_b64_tr_b16 a[46:47], v138 offset:6144
  s_lshl2_add_u32 s48, s49, s48
  v_mfma_f32_16x16x32_bf16 v[40:43], a[60:63], a[4:7], v[40:43]
  v_mfma_f32_16x16x32_bf16 v[36:39], a[60:63], a[0:3], v[36:39]
  s_waitcnt lgkmcnt(4)
  ds_read_b64_tr_b16 a[48:49], v133 offset:1024
  v_mfma_f32_16x16x32_bf16 v[52:55], a[0:3], a[64:67], v[52:55]
  buffer_load_dwordx4 v142, s[36:39], s61 offen offset:0 sc1 lds
  v_mfma_f32_16x16x32_bf16 v[56:59], a[4:7], a[64:67], v[56:59]
  ds_read_b128 a[20:23], v144 offset:12288
  v_mfma_f32_16x16x32_bf16 v[60:63], a[8:11], a[64:67], v[60:63]
  ds_read_b64_tr_b16 a[50:51], v133 offset:7168
  v_and_b32 v12, 3, v10
  v_mfma_f32_16x16x32_bf16 v[64:67], a[12:15], a[64:67], v[64:67]
  ds_read_b128 a[24:27], v144 offset:13312
  v_bfe_u32 v13, v10, 2, 2
  v_mfma_f32_16x16x32_bf16 v[120:123], a[16:19], a[64:67], v[120:123]
  buffer_load_dwordx4 v142, s[36:39], s61 offen offset:1024 sc1 lds
  s_add_u32 m0, s64, 106496
  v_mfma_f32_16x16x32_bf16 v[80:83], a[12:15], a[68:71], v[80:83]
  ds_read_b64_tr_b16 a[52:53], v134 offset:1024
  v_lshl_add_u32 v12, v13, 3, v12
  v_mfma_f32_16x16x32_bf16 v[76:79], a[8:11], a[68:71], v[76:79]
  ds_read_b128 a[28:31], v144 offset:14336
  v_add_lshl_u32 v249, v12, s48, 7
  v_mfma_f32_16x16x32_bf16 v[72:75], a[4:7], a[68:71], v[72:75]
  ds_read_b64_tr_b16 a[54:55], v134 offset:7168
  v_mfma_f32_16x16x32_bf16 v[68:71], a[0:3], a[68:71], v[68:71]
  s_waitcnt lgkmcnt(7)
  buffer_load_dword v143, s[36:39], s61 offen sc1 lds
  s_mov_b32 s69, 16
  v_mfma_f32_16x16x32_bf16 v[84:87], a[40:43], a[0:3], v[84:87]
  s_mul_i32 s60, s69, 196608
  s_add_u32 m0, s62, 107520
  ds_read_b128 a[32:35], v144 offset:15360
  v_mfma_f32_16x16x32_bf16 v[88:91], a[40:43], a[4:7], v[88:91]
  s_waitcnt vmcnt(40)
  ds_read_b128 a[36:39], v147 offset:20480
  v_lshlrev_b32 v188, 16, v208
  v_mfma_f32_16x16x32_bf16 v[92:95], a[40:43], a[8:11], v[92:95]
  ds_read_b64_tr_b16 a[56:57], v133 offset:2048
  v_and_b32 v189, 0xffff0000, v208
  v_mfma_f32_16x16x32_bf16 v[96:99], a[40:43], a[12:15], v[96:99]
  buffer_load_dwordx4 v139, s[8:11], s60 offen offset:0 lds
  v_mfma_f32_16x16x32_bf16 v[112:115], a[44:47], a[12:15], v[112:115]
  ds_read_b64_tr_b16 a[58:59], v133 offset:8192
  v_lshlrev_b32 v190, 16, v209
  v_mfma_f32_16x16x32_bf16 v[108:111], a[44:47], a[8:11], v[108:111]
  ds_read_b64_tr_b16 a[60:61], v134 offset:2048
  v_mfma_f32_16x16x32_bf16 v[104:107], a[44:47], a[4:7], v[104:107]
  ds_read_b64_tr_b16 a[62:63], v134 offset:8192
  v_and_b32 v191, 0xffff0000, v209
  v_mfma_f32_16x16x32_bf16 v[100:103], a[44:47], a[0:3], v[100:103]
  s_waitcnt vmcnt(19) lgkmcnt(4)
  s_barrier
  buffer_load_dwordx4 v140, s[8:11], s60 offen offset:1024 lds
  v_mfma_f32_16x16x32_bf16 v[20:23], a[48:51], a[20:23], v[20:23]
  ds_read_b64_tr_b16 a[64:65], v133 offset:0
  v_lshlrev_b32 v192, 16, v210
  v_mfma_f32_16x16x32_bf16 v[24:27], a[48:51], a[24:27], v[24:27]
Ha1:
  s_cbranch_execz Ha1_1
  v_and_b32 v193, 0xffff0000, v210
  v_mfma_f32_16x16x32_bf16 v[28:31], a[48:51], a[28:31], v[28:31]
  ds_read_b64_tr_b16 a[66:67], v133 offset:6144
  v_lshlrev_b32 v194, 16, v211
  v_mfma_f32_16x16x32_bf16 v[32:35], a[48:51], a[32:35], v[32:35]
  buffer_load_dwordx4 v141, s[8:11], s60 offen offset:2048 lds
  s_lshl_b32 s61, s69, 11
  v_mfma_f32_16x16x32_bf16 v[116:119], a[48:51], a[36:39], v[116:119]
  s_add_u32 m0, s63, 119808
  ds_read_b64_tr_b16 a[68:69], v134 offset:0
  v_and_b32 v195, 0xffff0000, v211
  v_mfma_f32_16x16x32_bf16 v[48:51], a[52:55], a[32:35], v[48:51]
  v_mfma_f32_16x16x32_bf16 v[44:47], a[52:55], a[28:31], v[44:47]
  ds_read_b64_tr_b16 a[70:71], v134 offset:6144
  v_mul_f32 v200, 0xbfb8aa3b, v188
  v_mfma_f32_16x16x32_bf16 v[40:43], a[52:55], a[24:27], v[40:43]
  buffer_load_dwordx4 v142, s[36:39], s61 offen offset:0 sc1 lds
  v_mul_f32 v201, 0xbfb8aa3b, v189
  v_mfma_f32_16x16x32_bf16 v[36:39], a[52:55], a[20:23], v[36:39]
  s_waitcnt lgkmcnt(4)
  ds_read_b64_tr_b16 a[40:41], v133 offset:22528
  v_mfma_f32_16x16x32_bf16 v[52:55], a[20:23], a[56:59], v[52:55]
  ds_read_b128 a[0:3], v144 offset:33792
  v_mul_f32 v202, 0xbfb8aa3b, v190
  v_mfma_f32_16x16x32_bf16 v[56:59], a[24:27], a[56:59], v[56:59]
  ds_read_b64_tr_b16 a[42:43], v133 offset:28672
  v_mul_f32 v203, 0xbfb8aa3b, v191
  v_mfma_f32_16x16x32_bf16 v[60:63], a[28:31], a[56:59], v[60:63]
  buffer_load_dwordx4 v142, s[36:39], s61 offen offset:1024 sc1 lds
  s_add_u32 m0, s64, 128000
  v_mfma_f32_16x16x32_bf16 v[64:67], a[32:35], a[56:59], v[64:67]
  ds_read_b128 a[4:7], v144 offset:34816
  v_mul_f32 v204, 0xbfb8aa3b, v192
  v_mfma_f32_16x16x32_bf16 v[120:123], a[36:39], a[56:59], v[120:123]
  ds_read_b64_tr_b16 a[44:45], v134 offset:22528
  v_mfma_f32_16x16x32_bf16 v[80:83], a[32:35], a[60:63], v[80:83]
  ds_read_b128 a[8:11], v144 offset:35840
  v_mul_f32 v205, 0xbfb8aa3b, v193
  v_mfma_f32_16x16x32_bf16 v[76:79], a[28:31], a[60:63], v[76:79]
  buffer_load_dword v143, s[36:39], s61 offen sc1 lds
  s_mov_b32 s70, 17
  v_mfma_f32_16x16x32_bf16 v[72:75], a[24:27], a[60:63], v[72:75]
  s_mul_i32 s60, s70, 196608
  s_add_u32 m0, s62, 129024
  ds_read_b64_tr_b16 a[46:47], v134 offset:28672
  v_mfma_f32_16x16x32_bf16 v[68:71], a[20:23], a[60:63], v[68:71]
  s_waitcnt lgkmcnt(7)
  ds_read_b128 a[12:15], v144 offset:36864
  v_mul_f32 v206, 0xbfb8aa3b, v194
  v_mfma_f32_16x16x32_bf16 v[84:87], a[64:67], a[20:23], v[84:87]
  ds_read_b128 a[16:19], v147 offset:41984
  v_mul_f32 v207, 0xbfb8aa3b, v195
  v_mfma_f32_16x16x32_bf16 v[88:91], a[64:67], a[24:27], v[88:91]
  buffer_load_dwordx4 v139, s[8:11], s60 offen offset:0 lds
  v_mfma_f32_16x16x32_bf16 v[92:95], a[64:67], a[28:31], v[92:95]
  ds_read_b64_tr_b16 a[48:49], v133 offset:23552
  v_mfma_f32_16x16x32_bf16 v[96:99], a[64:67], a[32:35], v[96:99]
  ds_read_b64_tr_b16 a[50:51], v133 offset:29696
  v_mfma_f32_16x16x32_bf16 v[112:115], a[68:71], a[32:35], v[112:115]
  ds_read_b64_tr_b16 a[52:53], v134 offset:23552
  v_mfma_f32_16x16x32_bf16 v[108:111], a[68:71], a[28:31], v[108:111]
  buffer_load_dwordx4 v140, s[8:11], s60 offen offset:1024 lds
  v_mfma_f32_16x16x32_bf16 v[104:107], a[68:71], a[24:27], v[104:107]
  ds_read_b64_tr_b16 a[54:55], v134 offset:29696
  v_mfma_f32_16x16x32_bf16 v[100:103], a[68:71], a[20:23], v[100:103]
  s_waitcnt vmcnt(20) lgkmcnt(4)
  s_barrier
  v_mfma_f32_16x16x32_bf16 v[20:23], a[40:43], a[0:3], v[20:23]
  ds_read_b64_tr_b16 a[56:57], v133 offset:21504
  v_mfma_f32_16x16x32_bf16 v[24:27], a[40:43], a[4:7], v[24:27]
  buffer_load_dwordx4 v141, s[8:11], s60 offen offset:2048 lds
  s_lshl_b32 s61, s70, 11
  v_mfma_f32_16x16x32_bf16 v[28:31], a[40:43], a[8:11], v[28:31]
  s_add_u32 m0, s63, 141312
  ds_read_b64_tr_b16 a[58:59], v133 offset:27648
  v_mfma_f32_16x16x32_bf16 v[32:35], a[40:43], a[12:15], v[32:35]
  v_exp_f32 v200, v200
  v_mfma_f32_16x16x32_bf16 v[116:119], a[40:43], a[16:19], v[116:119]
  ds_read_b64_tr_b16 a[60:61], v134 offset:21504
  v_mfma_f32_16x16x32_bf16 v[48:51], a[44:47], a[12:15], v[48:51]
  buffer_load_dwordx4 v142, s[36:39], s61 offen offset:0 sc1 lds
  v_mfma_f32_16x16x32_bf16 v[44:47], a[44:47], a[8:11], v[44:47]
  ds_read_b64_tr_b16 a[62:63], v134 offset:27648
  v_mfma_f32_16x16x32_bf16 v[40:43], a[44:47], a[4:7], v[40:43]
  v_exp_f32 v201, v201
  v_mfma_f32_16x16x32_bf16 v[36:39], a[44:47], a[0:3], v[36:39]
  s_waitcnt lgkmcnt(4)
  ds_read_b64_tr_b16 a[64:65], v133 offset:44032
  v_mfma_f32_16x16x32_bf16 v[52:55], a[0:3], a[48:51], v[52:55]
  buffer_load_dwordx4 v142, s[36:39], s61 offen offset:1024 sc1 lds
  s_add_u32 m0, s64, 149504
  v_mfma_f32_16x16x32_bf16 v[56:59], a[4:7], a[48:51], v[56:59]
  ds_read_b128 a[20:23], v144 offset:55296
  v_mfma_f32_16x16x32_bf16 v[60:63], a[8:11], a[48:51], v[60:63]
  ds_read_b64_tr_b16 a[66:67], v133 offset:50176
  v_mfma_f32_16x16x32_bf16 v[64:67], a[12:15], a[48:51], v[64:67]
  ds_read_b128 a[24:27], v144 offset:56320
  v_mfma_f32_16x16x32_bf16 v[120:123], a[16:19], a[48:51], v[120:123]
  buffer_load_dword v143, s[36:39], s61 offen sc1 lds
  s_mov_b32 s65, 18
  v_mfma_f32_16x16x32_bf16 v[80:83], a[12:15], a[52:55], v[80:83]
  s_mul_i32 s60, s65, 196608
  s_add_u32 m0, s62, 0
  ds_read_b64_tr_b16 a[68:69], v134 offset:44032
  v_mfma_f32_16x16x32_bf16 v[76:79], a[8:11], a[52:55], v[76:79]
  ds_read_b128 a[28:31], v144 offset:57344
  v_mfma_f32_16x16x32_bf16 v[72:75], a[4:7], a[52:55], v[72:75]
  ds_read_b64_tr_b16 a[70:71], v134 offset:50176
  v_mfma_f32_16x16x32_bf16 v[68:71], a[0:3], a[52:55], v[68:71]
  s_waitcnt lgkmcnt(7)
  buffer_load_dwordx4 v139, s[8:11], s60 offen offset:0 lds
  v_mfma_f32_16x16x32_bf16 v[84:87], a[56:59], a[0:3], v[84:87]
  ds_read_b128 a[32:35], v144 offset:58368
  v_mfma_f32_16x16x32_bf16 v[88:91], a[56:59], a[4:7], v[88:91]
  ds_read_b128 a[36:39], v147 offset:63488
  v_mfma_f32_16x16x32_bf16 v[92:95], a[56:59], a[8:11], v[92:95]
  ds_read_b64_tr_b16 a[40:41], v133 offset:45056
  v_mfma_f32_16x16x32_bf16 v[96:99], a[56:59], a[12:15], v[96:99]
  buffer_load_dwordx4 v140, s[8:11], s60 offen offset:1024 lds
  v_mfma_f32_16x16x32_bf16 v[112:115], a[60:63], a[12:15], v[112:115]
  ds_read_b64_tr_b16 a[42:43], v133 offset:51200
  v_mfma_f32_16x16x32_bf16 v[108:111], a[60:63], a[8:11], v[108:111]
  ds_read_b64_tr_b16 a[44:45], v134 offset:45056
  v_mfma_f32_16x16x32_bf16 v[104:107], a[60:63], a[4:7], v[104:107]
  ds_read_b64_tr_b16 a[46:47], v134 offset:51200
  v_mfma_f32_16x16x32_bf16 v[100:103], a[60:63], a[0:3], v[100:103]
  s_waitcnt vmcnt(20) lgkmcnt(4)
  s_barrier
  buffer_load_dwordx4 v141, s[8:11], s60 offen offset:2048 lds
  v_mfma_f32_16x16x32_bf16 v[20:23], a[64:67], a[20:23], v[20:23]
  s_lshl_b32 s61, s65, 11
  s_add_u32 m0, s63, 12288
  ds_read_b64_tr_b16 a[48:49], v133 offset:43008
  v_mfma_f32_16x16x32_bf16 v[24:27], a[64:67], a[24:27], v[24:27]
  v_exp_f32 v202, v202
  v_mfma_f32_16x16x32_bf16 v[28:31], a[64:67], a[28:31], v[28:31]
  ds_read_b64_tr_b16 a[50:51], v133 offset:49152
  v_mfma_f32_16x16x32_bf16 v[32:35], a[64:67], a[32:35], v[32:35]
  buffer_load_dwordx4 v142, s[36:39], s61 offen offset:0 sc1 lds
  v_mfma_f32_16x16x32_bf16 v[116:119], a[64:67], a[36:39], v[116:119]
  ds_read_b64_tr_b16 a[52:53], v134 offset:43008
  v_mfma_f32_16x16x32_bf16 v[48:51], a[68:71], a[32:35], v[48:51]
  v_exp_f32 v203, v203
  v_mfma_f32_16x16x32_bf16 v[44:47], a[68:71], a[28:31], v[44:47]
  ds_read_b64_tr_b16 a[54:55], v134 offset:49152
  v_mfma_f32_16x16x32_bf16 v[40:43], a[68:71], a[24:27], v[40:43]
  buffer_load_dwordx4 v142, s[36:39], s61 offen offset:1024 sc1 lds
  s_add_u32 m0, s64, 20480
  v_mfma_f32_16x16x32_bf16 v[36:39], a[68:71], a[20:23], v[36:39]
  s_waitcnt lgkmcnt(4)
  ds_read_b64_tr_b16 a[56:57], v135 offset:1024
  v_mfma_f32_16x16x32_bf16 v[52:55], a[20:23], a[40:43], v[52:55]
  ds_read_b128 a[0:3], v145 offset:12288
  v_mfma_f32_16x16x32_bf16 v[56:59], a[24:27], a[40:43], v[56:59]
  ds_read_b64_tr_b16 a[58:59], v135 offset:7168
  v_mfma_f32_16x16x32_bf16 v[60:63], a[28:31], a[40:43], v[60:63]
  buffer_load_dword v143, s[36:39], s61 offen sc1 lds
  s_mov_b32 s66, 19
  v_mfma_f32_16x16x32_bf16 v[64:67], a[32:35], a[40:43], v[64:67]
  s_mul_i32 s60, s66, 196608
  s_add_u32 m0, s62, 21504
  ds_read_b128 a[4:7], v145 offset:13312
  v_mfma_f32_16x16x32_bf16 v[120:123], a[36:39], a[40:43], v[120:123]
  ds_read_b64_tr_b16 a[60:61], v136 offset:1024
  v_mfma_f32_16x16x32_bf16 v[80:83], a[32:35], a[44:47], v[80:83]
  ds_read_b128 a[8:11], v145 offset:14336
  v_mfma_f32_16x16x32_bf16 v[76:79], a[28:31], a[44:47], v[76:79]
  buffer_load_dwordx4 v139, s[8:11], s60 offen offset:0 lds
  v_mfma_f32_16x16x32_bf16 v[72:75], a[24:27], a[44:47], v[72:75]
  ds_read_b64_tr_b16 a[62:63], v136 offset:7168
  v_mfma_f32_16x16x32_bf16 v[68:71], a[20:23], a[44:47], v[68:71]
  s_waitcnt lgkmcnt(7)
  ds_read_b128 a[12:15], v145 offset:15360
  v_mfma_f32_16x16x32_bf16 v[84:87], a[48:51], a[20:23], v[84:87]
  ds_read_b128 a[16:19], v148 offset:20480
  v_mfma_f32_16x16x32_bf16 v[88:91], a[48:51], a[24:27], v[88:91]
  buffer_load_dwordx4 v140, s[8:11], s60 offen offset:1024 lds
  v_mfma_f32_16x16x32_bf16 v[92:95], a[48:51], a[28:31], v[92:95]
  ds_read_b64_tr_b16 a[64:65], v135 offset:2048
  v_mfma_f32_16x16x32_bf16 v[96:99], a[48:51], a[32:35], v[96:99]
  ds_read_b64_tr_b16 a[66:67], v135 offset:8192
  v_mfma_f32_16x16x32_bf16 v[112:115], a[52:55], a[32:35], v[112:115]
  ds_read_b64_tr_b16 a[68:69], v136 offset:2048
  v_mfma_f32_16x16x32_bf16 v[108:111], a[52:55], a[28:31], v[108:111]
  buffer_load_dwordx4 v141, s[8:11], s60 offen offset:2048 lds
  s_lshl_b32 s61, s66, 11
  v_mfma_f32_16x16x32_bf16 v[104:107], a[52:55], a[24:27], v[104:107]
  s_add_u32 m0, s63, 33792
  ds_read_b64_tr_b16 a[70:71], v136 offset:8192
  v_mfma_f32_16x16x32_bf16 v[100:103], a[52:55], a[20:23], v[100:103]
  s_waitcnt vmcnt(21) lgkmcnt(4)
  s_barrier
  v_mfma_f32_16x16x32_bf16 v[20:23], a[56:59], a[0:3], v[20:23]
  ds_read_b64_tr_b16 a[40:41], v135 offset:0
  v_mfma_f32_16x16x32_bf16 v[24:27], a[56:59], a[4:7], v[24:27]
  buffer_load_dwordx4 v142, s[36:39], s61 offen offset:0 sc1 lds
  v_mfma_f32_16x16x32_bf16 v[28:31], a[56:59], a[8:11], v[28:31]
  ds_read_b64_tr_b16 a[42:43], v135 offset:6144
  v_mfma_f32_16x16x32_bf16 v[32:35], a[56:59], a[12:15], v[32:35]
  v_exp_f32 v204, v204
  v_mfma_f32_16x16x32_bf16 v[116:119], a[56:59], a[16:19], v[116:119]
  ds_read_b64_tr_b16 a[44:45], v136 offset:0
  v_mfma_f32_16x16x32_bf16 v[48:51], a[60:63], a[12:15], v[48:51]
  buffer_load_dwordx4 v142, s[36:39], s61 offen offset:1024 sc1 lds
  s_add_u32 m0, s64, 41984
  v_mfma_f32_16x16x32_bf16 v[44:47], a[60:63], a[8:11], v[44:47]
  ds_read_b64_tr_b16 a[46:47], v136 offset:6144
  v_mfma_f32_16x16x32_bf16 v[40:43], a[60:63], a[4:7], v[40:43]
  v_exp_f32 v205, v205
  v_mfma_f32_16x16x32_bf16 v[36:39], a[60:63], a[0:3], v[36:39]
  s_waitcnt lgkmcnt(4)
  ds_read_b64_tr_b16 a[48:49], v135 offset:22528
  v_mfma_f32_16x16x32_bf16 v[52:55], a[0:3], a[64:67], v[52:55]
  buffer_load_dword v143, s[36:39], s61 offen sc1 lds
  s_mov_b32 s67, 20
  v_mfma_f32_16x16x32_bf16 v[56:59], a[4:7], a[64:67], v[56:59]
  s_mul_i32 s60, s67, 196608
  s_add_u32 m0, s62, 43008
  ds_read_b128 a[20:23], v145 offset:33792
  v_mfma_f32_16x16x32_bf16 v[60:63], a[8:11], a[64:67], v[60:63]
  ds_read_b64_tr_b16 a[50:51], v135 offset:28672
  v_mfma_f32_16x16x32_bf16 v[64:67], a[12:15], a[64:67], v[64:67]
  ds_read_b128 a[24:27], v145 offset:34816
  v_mfma_f32_16x16x32_bf16 v[120:123], a[16:19], a[64:67], v[120:123]
  buffer_load_dwordx4 v139, s[8:11], s60 offen offset:0 lds
  v_mfma_f32_16x16x32_bf16 v[80:83], a[12:15], a[68:71], v[80:83]
  ds_read_b64_tr_b16 a[52:53], v136 offset:22528
  v_mfma_f32_16x16x32_bf16 v[76:79], a[8:11], a[68:71], v[76:79]
  ds_read_b128 a[28:31], v145 offset:35840
  v_mfma_f32_16x16x32_bf16 v[72:75], a[4:7], a[68:71], v[72:75]
  ds_read_b64_tr_b16 a[54:55], v136 offset:28672
  v_mfma_f32_16x16x32_bf16 v[68:71], a[0:3], a[68:71], v[68:71]
  s_waitcnt lgkmcnt(7)
  buffer_load_dwordx4 v140, s[8:11], s60 offen offset:1024 lds
  v_mfma_f32_16x16x32_bf16 v[84:87], a[40:43], a[0:3], v[84:87]
  ds_read_b128 a[32:35], v145 offset:36864
  v_mfma_f32_16x16x32_bf16 v[88:91], a[40:43], a[4:7], v[88:91]
  ds_read_b128 a[36:39], v148 offset:41984
  v_mfma_f32_16x16x32_bf16 v[92:95], a[40:43], a[8:11], v[92:95]
  ds_read_b64_tr_b16 a[56:57], v135 offset:23552
  v_mfma_f32_16x16x32_bf16 v[96:99], a[40:43], a[12:15], v[96:99]
  buffer_load_dwordx4 v141, s[8:11], s60 offen offset:2048 lds
  s_lshl_b32 s61, s67, 11
  v_mfma_f32_16x16x32_bf16 v[112:115], a[44:47], a[12:15], v[112:115]
  s_add_u32 m0, s63, 55296
  ds_read_b64_tr_b16 a[58:59], v135 offset:29696
  v_mfma_f32_16x16x32_bf16 v[108:111], a[44:47], a[8:11], v[108:111]
  ds_read_b64_tr_b16 a[60:61], v136 offset:23552
  v_mfma_f32_16x16x32_bf16 v[104:107], a[44:47], a[4:7], v[104:107]
  ds_read_b64_tr_b16 a[62:63], v136 offset:29696
  v_mfma_f32_16x16x32_bf16 v[100:103], a[44:47], a[0:3], v[100:103]
  s_waitcnt vmcnt(21) lgkmcnt(4)
  s_barrier
  buffer_load_dwordx4 v142, s[36:39], s61 offen offset:0 sc1 lds
  v_mfma_f32_16x16x32_bf16 v[20:23], a[48:51], a[20:23], v[20:23]
  ds_read_b64_tr_b16 a[64:65], v135 offset:21504
  v_mfma_f32_16x16x32_bf16 v[24:27], a[48:51], a[24:27], v[24:27]
  v_exp_f32 v206, v206
  v_mfma_f32_16x16x32_bf16 v[28:31], a[48:51], a[28:31], v[28:31]
  ds_read_b64_tr_b16 a[66:67], v135 offset:27648
  v_mfma_f32_16x16x32_bf16 v[32:35], a[48:51], a[32:35], v[32:35]
  buffer_load_dwordx4 v142, s[36:39], s61 offen offset:1024 sc1 lds
  s_add_u32 m0, s64, 63488
  v_mfma_f32_16x16x32_bf16 v[116:119], a[48:51], a[36:39], v[116:119]
  ds_read_b64_tr_b16 a[68:69], v136 offset:21504
  v_mfma_f32_16x16x32_bf16 v[48:51], a[52:55], a[32:35], v[48:51]
  v_exp_f32 v207, v207
  v_mfma_f32_16x16x32_bf16 v[44:47], a[52:55], a[28:31], v[44:47]
  ds_read_b64_tr_b16 a[70:71], v136 offset:27648
  v_add_f32 v200, 1.0, v200
  v_mfma_f32_16x16x32_bf16 v[40:43], a[52:55], a[24:27], v[40:43]
  buffer_load_dword v143, s[36:39], s61 offen sc1 lds
  s_mov_b32 s68, 21
  v_mfma_f32_16x16x32_bf16 v[36:39], a[52:55], a[20:23], v[36:39]
  s_waitcnt lgkmcnt(4)
  s_mul_i32 s60, s68, 196608
  s_add_u32 m0, s62, 64512
  v_mfma_f32_16x16x32_bf16 v[52:55], a[20:23], a[56:59], v[52:55]
  ds_read_b64_tr_b16 a[40:41], v135 offset:44032
  v_add_f32 v201, 1.0, v201
  v_mfma_f32_16x16x32_bf16 v[56:59], a[24:27], a[56:59], v[56:59]
  ds_read_b128 a[0:3], v145 offset:55296
  v_add_f32 v202, 1.0, v202
  v_mfma_f32_16x16x32_bf16 v[60:63], a[28:31], a[56:59], v[60:63]
  buffer_load_dwordx4 v139, s[8:11], s60 offen offset:0 lds
  v_add_f32 v203, 1.0, v203
  v_mfma_f32_16x16x32_bf16 v[64:67], a[32:35], a[56:59], v[64:67]
  ds_read_b64_tr_b16 a[42:43], v135 offset:50176
  v_add_f32 v204, 1.0, v204
  v_mfma_f32_16x16x32_bf16 v[120:123], a[36:39], a[56:59], v[120:123]
  ds_read_b128 a[4:7], v145 offset:56320
  v_add_f32 v205, 1.0, v205
  v_mfma_f32_16x16x32_bf16 v[80:83], a[32:35], a[60:63], v[80:83]
  ds_read_b64_tr_b16 a[44:45], v136 offset:44032
  v_add_f32 v206, 1.0, v206
  v_mfma_f32_16x16x32_bf16 v[76:79], a[28:31], a[60:63], v[76:79]
  buffer_load_dwordx4 v140, s[8:11], s60 offen offset:1024 lds
  v_add_f32 v207, 1.0, v207
  v_mfma_f32_16x16x32_bf16 v[72:75], a[24:27], a[60:63], v[72:75]
  ds_read_b128 a[8:11], v145 offset:57344
  v_mfma_f32_16x16x32_bf16 v[68:71], a[20:23], a[60:63], v[68:71]
  s_waitcnt lgkmcnt(6)
  ds_read_b64_tr_b16 a[46:47], v136 offset:50176
  v_mfma_f32_16x16x32_bf16 v[84:87], a[64:67], a[20:23], v[84:87]
  ds_read_b128 a[12:15], v145 offset:58368
  v_mfma_f32_16x16x32_bf16 v[88:91], a[64:67], a[24:27], v[88:91]
  buffer_load_dwordx4 v141, s[8:11], s60 offen offset:2048 lds
  s_lshl_b32 s61, s68, 11
  v_mfma_f32_16x16x32_bf16 v[92:95], a[64:67], a[28:31], v[92:95]
  s_add_u32 m0, s63, 76800
  ds_read_b128 a[16:19], v148 offset:63488
  v_mfma_f32_16x16x32_bf16 v[96:99], a[64:67], a[32:35], v[96:99]
  ds_read_b64_tr_b16 a[48:49], v135 offset:45056
  v_mfma_f32_16x16x32_bf16 v[112:115], a[68:71], a[32:35], v[112:115]
  ds_read_b64_tr_b16 a[50:51], v135 offset:51200
  v_mfma_f32_16x16x32_bf16 v[108:111], a[68:71], a[28:31], v[108:111]
  buffer_load_dwordx4 v142, s[36:39], s61 offen offset:0 sc1 lds
  v_mfma_f32_16x16x32_bf16 v[104:107], a[68:71], a[24:27], v[104:107]
  ds_read_b64_tr_b16 a[52:53], v136 offset:45056
  v_mfma_f32_16x16x32_bf16 v[100:103], a[68:71], a[20:23], v[100:103]
  s_waitcnt vmcnt(22) lgkmcnt(3)
  s_barrier
  ds_read_b64_tr_b16 a[54:55], v136 offset:51200
  v_mfma_f32_16x16x32_bf16 v[20:23], a[40:43], a[0:3], v[20:23]
  ds_read_b64_tr_b16 a[56:57], v135 offset:43008
  v_mfma_f32_16x16x32_bf16 v[24:27], a[40:43], a[4:7], v[24:27]
  buffer_load_dwordx4 v142, s[36:39], s61 offen offset:1024 sc1 lds
  s_add_u32 m0, s64, 84992
  v_mfma_f32_16x16x32_bf16 v[28:31], a[40:43], a[8:11], v[28:31]
  ds_read_b64_tr_b16 a[58:59], v135 offset:49152
  v_mfma_f32_16x16x32_bf16 v[32:35], a[40:43], a[12:15], v[32:35]
  v_rcp_f32 v200, v200
  v_mfma_f32_16x16x32_bf16 v[116:119], a[40:43], a[16:19], v[116:119]
  ds_read_b64_tr_b16 a[60:61], v136 offset:43008
  v_mfma_f32_16x16x32_bf16 v[48:51], a[44:47], a[12:15], v[48:51]
  buffer_load_dword v143, s[36:39], s61 offen sc1 lds
  s_mov_b32 s69, 22
  v_mfma_f32_16x16x32_bf16 v[44:47], a[44:47], a[8:11], v[44:47]
  s_mul_i32 s60, s69, 196608
  s_add_u32 m0, s62, 86016
  ds_read_b64_tr_b16 a[62:63], v136 offset:49152
  v_mfma_f32_16x16x32_bf16 v[40:43], a[44:47], a[4:7], v[40:43]
  v_rcp_f32 v201, v201
  v_mfma_f32_16x16x32_bf16 v[36:39], a[44:47], a[0:3], v[36:39]
  s_waitcnt lgkmcnt(4)
  ds_read_b64_tr_b16 a[64:65], v137 offset:1024
  v_mfma_f32_16x16x32_bf16 v[52:55], a[0:3], a[48:51], v[52:55]
  buffer_load_dwordx4 v139, s[8:11], s60 offen offset:0 lds
  v_mfma_f32_16x16x32_bf16 v[56:59], a[4:7], a[48:51], v[56:59]
  ds_read_b128 a[20:23], v146 offset:12288
  v_mfma_f32_16x16x32_bf16 v[60:63], a[8:11], a[48:51], v[60:63]
  ds_read_b64_tr_b16 a[66:67], v137 offset:7168
  v_mfma_f32_16x16x32_bf16 v[64:67], a[12:15], a[48:51], v[64:67]
  ds_read_b128 a[24:27], v146 offset:13312
  v_mfma_f32_16x16x32_bf16 v[120:123], a[16:19], a[48:51], v[120:123]
  buffer_load_dwordx4 v140, s[8:11], s60 offen offset:1024 lds
  v_mfma_f32_16x16x32_bf16 v[80:83], a[12:15], a[52:55], v[80:83]
  ds_read_b64_tr_b16 a[68:69], v138 offset:1024
  v_mfma_f32_16x16x32_bf16 v[76:79], a[8:11], a[52:55], v[76:79]
  ds_read_b128 a[28:31], v146 offset:14336
  v_mfma_f32_16x16x32_bf16 v[72:75], a[4:7], a[52:55], v[72:75]
  ds_read_b64_tr_b16 a[70:71], v138 offset:7168
  v_mfma_f32_16x16x32_bf16 v[68:71], a[0:3], a[52:55], v[68:71]
  s_waitcnt lgkmcnt(7)
  buffer_load_dwordx4 v141, s[8:11], s60 offen offset:2048 lds
  s_lshl_b32 s61, s69, 11
  v_mfma_f32_16x16x32_bf16 v[84:87], a[56:59], a[0:3], v[84:87]
  s_add_u32 m0, s63, 98304
  ds_read_b128 a[32:35], v146 offset:15360
  v_mfma_f32_16x16x32_bf16 v[88:91], a[56:59], a[4:7], v[88:91]
  ds_read_b128 a[36:39], v149 offset:20480
  v_mfma_f32_16x16x32_bf16 v[92:95], a[56:59], a[8:11], v[92:95]
  ds_read_b64_tr_b16 a[40:41], v137 offset:2048
  v_mfma_f32_16x16x32_bf16 v[96:99], a[56:59], a[12:15], v[96:99]
  buffer_load_dwordx4 v142, s[36:39], s61 offen offset:0 sc1 lds
  v_mfma_f32_16x16x32_bf16 v[112:115], a[60:63], a[12:15], v[112:115]
  ds_read_b64_tr_b16 a[42:43], v137 offset:8192
  v_mfma_f32_16x16x32_bf16 v[108:111], a[60:63], a[8:11], v[108:111]
  ds_read_b64_tr_b16 a[44:45], v138 offset:2048
  v_mfma_f32_16x16x32_bf16 v[104:107], a[60:63], a[4:7], v[104:107]
  ds_read_b64_tr_b16 a[46:47], v138 offset:8192
  v_mfma_f32_16x16x32_bf16 v[100:103], a[60:63], a[0:3], v[100:103]
  s_waitcnt vmcnt(22) lgkmcnt(4)
  s_barrier
  buffer_load_dwordx4 v142, s[36:39], s61 offen offset:1024 sc1 lds
  v_mfma_f32_16x16x32_bf16 v[20:23], a[64:67], a[20:23], v[20:23]
  s_add_u32 m0, s64, 106496
  ds_read_b64_tr_b16 a[48:49], v137 offset:0
  v_mfma_f32_16x16x32_bf16 v[24:27], a[64:67], a[24:27], v[24:27]
  v_rcp_f32 v202, v202
  v_mfma_f32_16x16x32_bf16 v[28:31], a[64:67], a[28:31], v[28:31]
  ds_read_b64_tr_b16 a[50:51], v137 offset:6144
  v_mfma_f32_16x16x32_bf16 v[32:35], a[64:67], a[32:35], v[32:35]
  buffer_load_dword v143, s[36:39], s61 offen sc1 lds
  s_mov_b32 s70, 23
  v_mfma_f32_16x16x32_bf16 v[116:119], a[64:67], a[36:39], v[116:119]
  s_mul_i32 s60, s70, 196608
  s_add_u32 m0, s62, 107520
  ds_read_b64_tr_b16 a[52:53], v138 offset:0
  v_mfma_f32_16x16x32_bf16 v[48:51], a[68:71], a[32:35], v[48:51]
  v_rcp_f32 v203, v203
  v_mfma_f32_16x16x32_bf16 v[44:47], a[68:71], a[28:31], v[44:47]
  ds_read_b64_tr_b16 a[54:55], v138 offset:6144
  v_mfma_f32_16x16x32_bf16 v[40:43], a[68:71], a[24:27], v[40:43]
  buffer_load_dwordx4 v139, s[8:11], s60 offen offset:0 lds
  v_mfma_f32_16x16x32_bf16 v[36:39], a[68:71], a[20:23], v[36:39]
  s_waitcnt lgkmcnt(4)
  ds_read_b64_tr_b16 a[56:57], v133 offset:1024
  v_mfma_f32_16x16x32_bf16 v[52:55], a[20:23], a[40:43], v[52:55]
  ds_read_b128 a[0:3], v144 offset:12288
  v_mfma_f32_16x16x32_bf16 v[56:59], a[24:27], a[40:43], v[56:59]
  ds_read_b64_tr_b16 a[58:59], v133 offset:7168
  v_mfma_f32_16x16x32_bf16 v[60:63], a[28:31], a[40:43], v[60:63]
  buffer_load_dwordx4 v140, s[8:11], s60 offen offset:1024 lds
  v_mfma_f32_16x16x32_bf16 v[64:67], a[32:35], a[40:43], v[64:67]
  ds_read_b128 a[4:7], v144 offset:13312
  v_mfma_f32_16x16x32_bf16 v[120:123], a[36:39], a[40:43], v[120:123]
  ds_read_b64_tr_b16 a[60:61], v134 offset:1024
  v_mfma_f32_16x16x32_bf16 v[80:83], a[32:35], a[44:47], v[80:83]
  ds_read_b128 a[8:11], v144 offset:14336
  v_mfma_f32_16x16x32_bf16 v[76:79], a[28:31], a[44:47], v[76:79]
  buffer_load_dwordx4 v141, s[8:11], s60 offen offset:2048 lds
  s_lshl_b32 s61, s70, 11
  v_mfma_f32_16x16x32_bf16 v[72:75], a[24:27], a[44:47], v[72:75]
  s_add_u32 m0, s63, 119808
  ds_read_b64_tr_b16 a[62:63], v134 offset:7168
  v_mfma_f32_16x16x32_bf16 v[68:71], a[20:23], a[44:47], v[68:71]
  s_waitcnt lgkmcnt(7)
  ds_read_b128 a[12:15], v144 offset:15360
  v_mfma_f32_16x16x32_bf16 v[84:87], a[48:51], a[20:23], v[84:87]
  ds_read_b128 a[16:19], v147 offset:20480
  v_mfma_f32_16x16x32_bf16 v[88:91], a[48:51], a[24:27], v[88:91]
  buffer_load_dwordx4 v142, s[36:39], s61 offen offset:0 sc1 lds
  v_mfma_f32_16x16x32_bf16 v[92:95], a[48:51], a[28:31], v[92:95]
  ds_read_b64_tr_b16 a[64:65], v133 offset:2048
  v_mfma_f32_16x16x32_bf16 v[96:99], a[48:51], a[32:35], v[96:99]
  ds_read_b64_tr_b16 a[66:67], v133 offset:8192
  v_mfma_f32_16x16x32_bf16 v[112:115], a[52:55], a[32:35], v[112:115]
  ds_read_b64_tr_b16 a[68:69], v134 offset:2048
  v_mfma_f32_16x16x32_bf16 v[108:111], a[52:55], a[28:31], v[108:111]
  buffer_load_dwordx4 v142, s[36:39], s61 offen offset:1024 sc1 lds
  s_add_u32 m0, s64, 128000
  v_mfma_f32_16x16x32_bf16 v[104:107], a[52:55], a[24:27], v[104:107]
  ds_read_b64_tr_b16 a[70:71], v134 offset:8192
  v_mfma_f32_16x16x32_bf16 v[100:103], a[52:55], a[20:23], v[100:103]
  s_waitcnt vmcnt(23) lgkmcnt(4)
  s_barrier
  v_mfma_f32_16x16x32_bf16 v[20:23], a[56:59], a[0:3], v[20:23]
  ds_read_b64_tr_b16 a[40:41], v133 offset:0
  v_mfma_f32_16x16x32_bf16 v[24:27], a[56:59], a[4:7], v[24:27]
  buffer_load_dword v143, s[36:39], s61 offen sc1 lds
  s_mov_b32 s65, 24
  v_mfma_f32_16x16x32_bf16 v[28:31], a[56:59], a[8:11], v[28:31]
  s_mul_i32 s60, s65, 196608
  s_add_u32 m0, s62, 129024
  ds_read_b64_tr_b16 a[42:43], v133 offset:6144
  v_mfma_f32_16x16x32_bf16 v[32:35], a[56:59], a[12:15], v[32:35]
  v_rcp_f32 v204, v204
  v_mfma_f32_16x16x32_bf16 v[116:119], a[56:59], a[16:19], v[116:119]
  ds_read_b64_tr_b16 a[44:45], v134 offset:0
  v_mfma_f32_16x16x32_bf16 v[48:51], a[60:63], a[12:15], v[48:51]
  buffer_load_dwordx4 v139, s[8:11], s60 offen offset:0 lds
  v_mfma_f32_16x16x32_bf16 v[44:47], a[60:63], a[8:11], v[44:47]
  ds_read_b64_tr_b16 a[46:47], v134 offset:6144
  v_mfma_f32_16x16x32_bf16 v[40:43], a[60:63], a[4:7], v[40:43]
  v_rcp_f32 v205, v205
  v_mfma_f32_16x16x32_bf16 v[36:39], a[60:63], a[0:3], v[36:39]
  s_waitcnt lgkmcnt(4)
  ds_read_b64_tr_b16 a[48:49], v133 offset:22528
  v_mfma_f32_16x16x32_bf16 v[52:55], a[0:3], a[64:67], v[52:55]
  buffer_load_dwordx4 v140, s[8:11], s60 offen offset:1024 lds
  v_mfma_f32_16x16x32_bf16 v[56:59], a[4:7], a[64:67], v[56:59]
  ds_read_b128 a[20:23], v144 offset:33792
  v_mfma_f32_16x16x32_bf16 v[60:63], a[8:11], a[64:67], v[60:63]
  ds_read_b64_tr_b16 a[50:51], v133 offset:28672
  v_mfma_f32_16x16x32_bf16 v[64:67], a[12:15], a[64:67], v[64:67]
  ds_read_b128 a[24:27], v144 offset:34816
  v_mfma_f32_16x16x32_bf16 v[120:123], a[16:19], a[64:67], v[120:123]
  buffer_load_dwordx4 v141, s[8:11], s60 offen offset:2048 lds
  s_lshl_b32 s61, s65, 11
  v_mfma_f32_16x16x32_bf16 v[80:83], a[12:15], a[68:71], v[80:83]
  s_add_u32 m0, s63, 141312
  ds_read_b64_tr_b16 a[52:53], v134 offset:22528
  v_mfma_f32_16x16x32_bf16 v[76:79], a[8:11], a[68:71], v[76:79]
  ds_read_b128 a[28:31], v144 offset:35840
  v_mfma_f32_16x16x32_bf16 v[72:75], a[4:7], a[68:71], v[72:75]
  ds_read_b64_tr_b16 a[54:55], v134 offset:28672
  v_mfma_f32_16x16x32_bf16 v[68:71], a[0:3], a[68:71], v[68:71]
  s_waitcnt lgkmcnt(7)
  buffer_load_dwordx4 v142, s[36:39], s61 offen offset:0 sc1 lds
  v_mfma_f32_16x16x32_bf16 v[84:87], a[40:43], a[0:3], v[84:87]
  ds_read_b128 a[32:35], v144 offset:36864
  v_mfma_f32_16x16x32_bf16 v[88:91], a[40:43], a[4:7], v[88:91]
  ds_read_b128 a[36:39], v147 offset:41984
  v_mfma_f32_16x16x32_bf16 v[92:95], a[40:43], a[8:11], v[92:95]
  ds_read_b64_tr_b16 a[56:57], v133 offset:23552
  v_mfma_f32_16x16x32_bf16 v[96:99], a[40:43], a[12:15], v[96:99]
  buffer_load_dwordx4 v142, s[36:39], s61 offen offset:1024 sc1 lds
  s_add_u32 m0, s64, 149504
  v_mfma_f32_16x16x32_bf16 v[112:115], a[44:47], a[12:15], v[112:115]
  ds_read_b64_tr_b16 a[58:59], v133 offset:29696
  v_mfma_f32_16x16x32_bf16 v[108:111], a[44:47], a[8:11], v[108:111]
  ds_read_b64_tr_b16 a[60:61], v134 offset:23552
  v_mfma_f32_16x16x32_bf16 v[104:107], a[44:47], a[4:7], v[104:107]
  ds_read_b64_tr_b16 a[62:63], v134 offset:29696
  v_mfma_f32_16x16x32_bf16 v[100:103], a[44:47], a[0:3], v[100:103]
  s_waitcnt vmcnt(23) lgkmcnt(4)
  s_barrier
  buffer_load_dword v143, s[36:39], s61 offen sc1 lds
  v_mfma_f32_16x16x32_bf16 v[20:23], a[48:51], a[20:23], v[20:23]
  s_mov_b32 s66, 25
  s_mul_i32 s60, s66, 196608
  s_add_u32 m0, s62, 0
  v_mfma_f32_16x16x32_bf16 v[24:27], a[48:51], a[24:27], v[24:27]
  ds_read_b64_tr_b16 a[64:65], v133 offset:21504
  v_mfma_f32_16x16x32_bf16 v[28:31], a[48:51], a[28:31], v[28:31]
  ds_read_b64_tr_b16 a[66:67], v133 offset:27648
  v_mfma_f32_16x16x32_bf16 v[32:35], a[48:51], a[32:35], v[32:35]
  buffer_load_dwordx4 v139, s[8:11], s60 offen offset:0 lds
  v_mfma_f32_16x16x32_bf16 v[116:119], a[48:51], a[36:39], v[116:119]
  ds_read_b64_tr_b16 a[68:69], v134 offset:21504
  v_mfma_f32_16x16x32_bf16 v[48:51], a[52:55], a[32:35], v[48:51]
  v_rcp_f32 v206, v206
  v_mfma_f32_16x16x32_bf16 v[44:47], a[52:55], a[28:31], v[44:47]
  ds_read_b64_tr_b16 a[70:71], v134 offset:27648
  v_mfma_f32_16x16x32_bf16 v[40:43], a[52:55], a[24:27], v[40:43]
  buffer_load_dwordx4 v140, s[8:11], s60 offen offset:1024 lds
  v_mfma_f32_16x16x32_bf16 v[36:39], a[52:55], a[20:23], v[36:39]
  s_waitcnt lgkmcnt(4)
  ds_read_b64_tr_b16 a[40:41], v133 offset:44032
  v_mfma_f32_16x16x32_bf16 v[52:55], a[20:23], a[56:59], v[52:55]
  ds_read_b128 a[0:3], v144 offset:55296
  v_mfma_f32_16x16x32_bf16 v[56:59], a[24:27], a[56:59], v[56:59]
  ds_read_b64_tr_b16 a[42:43], v133 offset:50176
  v_mfma_f32_16x16x32_bf16 v[60:63], a[28:31], a[56:59], v[60:63]
  buffer_load_dwordx4 v141, s[8:11], s60 offen offset:2048 lds
  s_lshl_b32 s61, s66, 11
  v_mfma_f32_16x16x32_bf16 v[64:67], a[32:35], a[56:59], v[64:67]
  s_add_u32 m0, s63, 12288
  ds_read_b128 a[4:7], v144 offset:56320
  v_mfma_f32_16x16x32_bf16 v[120:123], a[36:39], a[56:59], v[120:123]
  ds_read_b64_tr_b16 a[44:45], v134 offset:44032
  v_mfma_f32_16x16x32_bf16 v[80:83], a[32:35], a[60:63], v[80:83]
  ds_read_b128 a[8:11], v144 offset:57344
  v_mfma_f32_16x16x32_bf16 v[76:79], a[28:31], a[60:63], v[76:79]
  buffer_load_dwordx4 v142, s[36:39], s61 offen offset:0 sc1 lds
  v_mfma_f32_16x16x32_bf16 v[72:75], a[24:27], a[60:63], v[72:75]
  ds_read_b64_tr_b16 a[46:47], v134 offset:50176
  v_mfma_f32_16x16x32_bf16 v[68:71], a[20:23], a[60:63], v[68:71]
  s_waitcnt lgkmcnt(7)
  ds_read_b128 a[12:15], v144 offset:58368
  v_mfma_f32_16x16x32_bf16 v[84:87], a[64:67], a[20:23], v[84:87]
Ha2:
  s_cbranch_execz Ha2_1
  ds_read_b128 a[16:19], v147 offset:63488
  v_mfma_f32_16x16x32_bf16 v[88:91], a[64:67], a[24:27], v[88:91]
  ds_read_b64_tr_b16 a[48:49], v133 offset:45056
  v_mfma_f32_16x16x32_bf16 v[92:95], a[64:67], a[28:31], v[92:95]
  buffer_load_dwordx4 v142, s[36:39], s61 offen offset:1024 sc1 lds
  s_add_u32 m0, s64, 20480
  v_mfma_f32_16x16x32_bf16 v[96:99], a[64:67], a[32:35], v[96:99]
  ds_read_b64_tr_b16 a[50:51], v133 offset:51200
  v_mfma_f32_16x16x32_bf16 v[112:115], a[68:71], a[32:35], v[112:115]
  ds_read_b64_tr_b16 a[52:53], v134 offset:45056
  v_mfma_f32_16x16x32_bf16 v[108:111], a[68:71], a[28:31], v[108:111]
  v_rcp_f32 v207, v207
  v_mfma_f32_16x16x32_bf16 v[104:107], a[68:71], a[24:27], v[104:107]
  buffer_load_dword v143, s[36:39], s61 offen sc1 lds
  s_mov_b32 s67, 26
  v_mfma_f32_16x16x32_bf16 v[100:103], a[68:71], a[20:23], v[100:103]
  s_waitcnt vmcnt(24) lgkmcnt(3)
  s_barrier
  s_mul_i32 s60, s67, 196608
  v_mfma_f32_16x16x32_bf16 v[20:23], a[40:43], a[0:3], v[20:23]
  s_add_u32 m0, s62, 21504
  ds_read_b64_tr_b16 a[54:55], v134 offset:51200
  v_mul_f32 v188, v188, v200
  v_mfma_f32_16x16x32_bf16 v[24:27], a[40:43], a[4:7], v[24:27]
  ds_read_b64_tr_b16 a[56:57], v133 offset:43008
  v_mul_f32 v189, v189, v201
  v_mfma_f32_16x16x32_bf16 v[28:31], a[40:43], a[8:11], v[28:31]
  buffer_load_dwordx4 v139, s[8:11], s60 offen offset:0 lds
  v_mul_f32 v190, v190, v202
  v_mfma_f32_16x16x32_bf16 v[32:35], a[40:43], a[12:15], v[32:35]
  ds_read_b64_tr_b16 a[58:59], v133 offset:49152
  v_mul_f32 v191, v191, v203
  v_mfma_f32_16x16x32_bf16 v[116:119], a[40:43], a[16:19], v[116:119]
  ds_read_b64_tr_b16 a[60:61], v134 offset:43008
  v_mul_f32 v192, v192, v204
  v_mfma_f32_16x16x32_bf16 v[48:51], a[44:47], a[12:15], v[48:51]
  v_mul_f32 v193, v193, v205
  v_mul_f32 v194, v194, v206
  v_mfma_f32_16x16x32_bf16 v[44:47], a[44:47], a[8:11], v[44:47]
  buffer_load_dwordx4 v140, s[8:11], s60 offen offset:1024 lds
  v_mul_f32 v195, v195, v207
  v_mfma_f32_16x16x32_bf16 v[40:43], a[44:47], a[4:7], v[40:43]
  ds_read_b64_tr_b16 a[62:63], v134 offset:49152
  v_cvt_pk_bf16_f32 v212, v188, v189
  v_mfma_f32_16x16x32_bf16 v[36:39], a[44:47], a[0:3], v[36:39]
  s_waitcnt lgkmcnt(4)
  ds_read_b64_tr_b16 a[64:65], v135 offset:1024
  v_lshlrev_b32 v188, 16, v212
  v_mfma_f32_16x16x32_bf16 v[52:55], a[0:3], a[48:51], v[52:55]
  ds_read_b128 a[20:23], v145 offset:12288
  v_and_b32 v189, 0xffff0000, v212
  v_mfma_f32_16x16x32_bf16 v[56:59], a[4:7], a[48:51], v[56:59]
  buffer_load_dwordx4 v141, s[8:11], s60 offen offset:2048 lds
  v_cvt_pk_bf16_f32 v212, v190, v191
  v_mfma_f32_16x16x32_bf16 v[60:63], a[8:11], a[48:51], v[60:63]
  s_lshl_b32 s61, s67, 11
  ds_read_b64_tr_b16 a[66:67], v135 offset:7168
  s_add_u32 m0, s63, 33792
  v_mfma_f32_16x16x32_bf16 v[64:67], a[12:15], a[48:51], v[64:67]
  ds_read_b128 a[24:27], v145 offset:13312
  v_lshlrev_b32 v190, 16, v212
  v_mfma_f32_16x16x32_bf16 v[120:123], a[16:19], a[48:51], v[120:123]
  ds_read_b64_tr_b16 a[68:69], v136 offset:1024
  v_and_b32 v191, 0xffff0000, v212
  v_mfma_f32_16x16x32_bf16 v[80:83], a[12:15], a[52:55], v[80:83]
  ds_read_b128 a[28:31], v145 offset:14336
  v_cvt_pk_bf16_f32 v212, v192, v193
  v_mfma_f32_16x16x32_bf16 v[76:79], a[8:11], a[52:55], v[76:79]
  buffer_load_dwordx4 v142, s[36:39], s61 offen offset:0 sc1 lds
  v_lshlrev_b32 v192, 16, v212
  v_mfma_f32_16x16x32_bf16 v[72:75], a[4:7], a[52:55], v[72:75]
  ds_read_b64_tr_b16 a[70:71], v136 offset:7168
  v_and_b32 v193, 0xffff0000, v212
  v_mfma_f32_16x16x32_bf16 v[68:71], a[0:3], a[52:55], v[68:71]
  s_waitcnt lgkmcnt(7)
  ds_read_b128 a[32:35], v145 offset:15360
  v_cvt_pk_bf16_f32 v212, v194, v195
  v_mfma_f32_16x16x32_bf16 v[84:87], a[56:59], a[0:3], v[84:87]
  ds_read_b128 a[36:39], v148 offset:20480
  v_lshlrev_b32 v194, 16, v212
  v_mfma_f32_16x16x32_bf16 v[88:91], a[56:59], a[4:7], v[88:91]
  ds_read_b64_tr_b16 a[40:41], v135 offset:2048
  v_and_b32 v195, 0xffff0000, v212
  v_mfma_f32_16x16x32_bf16 v[92:95], a[56:59], a[8:11], v[92:95]
  s_lshl_b32 s48, s58, 3
  buffer_load_dwordx4 v142, s[36:39], s61 offen offset:1024 sc1 lds
  s_add_u32 m0, s64, 41984
  v_mfma_f32_16x16x32_bf16 v[96:99], a[56:59], a[12:15], v[96:99]
  s_add_u32 s48, s48, 150528
  ds_read_b64_tr_b16 a[42:43], v135 offset:8192
  v_add_u32 v12, s48, v0
  v_mfma_f32_16x16x32_bf16 v[112:115], a[60:63], a[12:15], v[112:115]
  ds_read_b64_tr_b16 a[44:45], v136 offset:2048
  v_add_u32 v222, s63, v12
  v_mfma_f32_16x16x32_bf16 v[108:111], a[60:63], a[8:11], v[108:111]
  v_xor_b32 v223, 8, v222
  s_lshl_b32 s48, s59, 11
  v_mfma_f32_16x16x32_bf16 v[104:107], a[60:63], a[4:7], v[104:107]
  s_add_u32 s48, s48, 8192
  buffer_load_dword v143, s[36:39], s61 offen sc1 lds
  s_mov_b32 s68, 27
  v_mfma_f32_16x16x32_bf16 v[100:103], a[60:63], a[0:3], v[100:103]
  s_waitcnt vmcnt(24) lgkmcnt(3)
  s_barrier
  s_mul_i32 s60, s68, 196608
  v_mfma_f32_16x16x32_bf16 v[20:23], a[64:67], a[20:23], v[20:23]
  s_add_u32 m0, s62, 43008
  ds_read_b64_tr_b16 a[46:47], v136 offset:8192
  v_add_u32 v224, s48, v12
  v_mfma_f32_16x16x32_bf16 v[24:27], a[64:67], a[24:27], v[24:27]
  s_lshl_b32 s48, s58, 13
  ds_read_b64_tr_b16 a[48:49], v135 offset:0
  v_subrev_u32 v225, s48, v224
  v_mfma_f32_16x16x32_bf16 v[28:31], a[64:67], a[28:31], v[28:31]
  buffer_load_dwordx4 v139, s[8:11], s60 offen offset:0 lds
  v_xor_b32 v226, 8, v225
  v_mfma_f32_16x16x32_bf16 v[32:35], a[64:67], a[32:35], v[32:35]
  s_mov_b32 s40, 0xaaaaaaaa
  ds_read_b64_tr_b16 a[50:51], v135 offset:6144
  s_mov_b32 s41, 0xaaaaaaaa
  v_mfma_f32_16x16x32_bf16 v[116:119], a[64:67], a[36:39], v[116:119]
  s_mov_b32 s42, 0x000f0000
  ds_read_b64_tr_b16 a[52:53], v136 offset:0
  s_mov_b32 s43, 0x0fff00ff
  v_mfma_f32_16x16x32_bf16 v[48:51], a[68:71], a[32:35], v[48:51]
  s_mov_b32 s80, 0x003f0003
  s_mov_b32 s81, 0x3fff03ff
  v_mov_b32 v12, 0xffff
  v_mfma_f32_16x16x32_bf16 v[44:47], a[68:71], a[28:31], v[44:47]
  buffer_load_dwordx4 v140, s[8:11], s60 offen offset:1024 lds
  v_mov_b32 v13, 0xffff0000
  v_mfma_f32_16x16x32_bf16 v[40:43], a[68:71], a[24:27], v[40:43]
  ds_read_b64_tr_b16 a[54:55], v136 offset:6144
  v_cndmask_b32 v12, v12, v13, s[40:41]
  v_mfma_f32_16x16x32_bf16 v[36:39], a[68:71], a[20:23], v[36:39]
  s_waitcnt lgkmcnt(4)
  ds_read_b64_tr_b16 a[56:57], v135 offset:22528
  v_cndmask_b32 v227, 0, v12, s[42:43]
  v_mfma_f32_16x16x32_bf16 v[52:55], a[20:23], a[40:43], v[52:55]
  ds_read_b128 a[0:3], v145 offset:33792
  v_cndmask_b32 v228, 0, v12, s[80:81]
  v_mfma_f32_16x16x32_bf16 v[56:59], a[24:27], a[40:43], v[56:59]
  buffer_load_dwordx4 v141, s[8:11], s60 offen offset:2048 lds
  v_xor_b32 v229, v227, v12
  v_mfma_f32_16x16x32_bf16 v[60:63], a[28:31], a[40:43], v[60:63]
  s_lshl_b32 s61, s68, 11
  ds_read_b64_tr_b16 a[58:59], v135 offset:28672
  s_add_u32 m0, s63, 55296
  v_mfma_f32_16x16x32_bf16 v[64:67], a[32:35], a[40:43], v[64:67]
  ds_read_b128 a[4:7], v145 offset:34816
  v_xor_b32 v230, v228, v12
  v_mfma_f32_16x16x32_bf16 v[120:123], a[36:39], a[40:43], v[120:123]
  s_lshl1_add_u32 s48, s51, s58
  ds_read_b64_tr_b16 a[60:61], v136 offset:22528
  s_lshl_b32 s74, s48, 17
  v_mfma_f32_16x16x32_bf16 v[80:83], a[32:35], a[44:47], v[80:83]
  s_lshl1_add_u32 s48, s56, s59
  ds_read_b128 a[8:11], v145 offset:35840
  s_lshl_b32 s48, s48, 11
  v_mfma_f32_16x16x32_bf16 v[76:79], a[28:31], a[44:47], v[76:79]
  s_add_u32 s74, s74, s48
  buffer_load_dwordx4 v142, s[36:39], s61 offen offset:0 sc1 lds
  s_add_u32 s74, s74, 7340032
  v_mfma_f32_16x16x32_bf16 v[72:75], a[24:27], a[44:47], v[72:75]
  s_add_u32 s75, s74, 65536
  ds_read_b64_tr_b16 a[62:63], v136 offset:28672
  s_or_b32 s51, s51, s58
  v_mfma_f32_16x16x32_bf16 v[68:71], a[20:23], a[44:47], v[68:71]
  s_waitcnt lgkmcnt(7)
  ds_read_b128 a[12:15], v145 offset:36864
  s_lshl_b32 s45, s2, 7
  v_mfma_f32_16x16x32_bf16 v[84:87], a[48:51], a[20:23], v[84:87]
  s_add_u32 s45, s45, 5275648
  ds_read_b128 a[16:19], v148 offset:41984
  s_cmp_eq_u32 s44, 0
  v_mfma_f32_16x16x32_bf16 v[88:91], a[48:51], a[24:27], v[88:91]
  s_cselect_b32 s45, s45, 1073741824
  ds_read_b64_tr_b16 a[64:65], v135 offset:23552
  s_lshr_b32 s49, s2, 3
  v_mfma_f32_16x16x32_bf16 v[92:95], a[48:51], a[28:31], v[92:95]
  s_and_b32 s59, s49, 3
  buffer_load_dwordx4 v142, s[36:39], s61 offen offset:1024 sc1 lds
  s_add_u32 m0, s64, 63488
  v_mfma_f32_16x16x32_bf16 v[96:99], a[48:51], a[32:35], v[96:99]
  s_lshr_b32 s56, s49, 2
  ds_read_b64_tr_b16 a[66:67], v135 offset:29696
  s_lshl1_add_u32 s49, s59, s56
  v_mfma_f32_16x16x32_bf16 v[112:115], a[52:55], a[32:35], v[112:115]
  s_and_b32 s49, s49, 7
  ds_read_b64_tr_b16 a[68:69], v136 offset:23552
  s_and_b32 s48, s2, 7
  v_mfma_f32_16x16x32_bf16 v[108:111], a[52:55], a[28:31], v[108:111]
  s_lshl2_add_u32 s59, s48, s59
  s_mov_b32 s82, 0xc0653421
  s_mov_b32 s83, 0xfedba987
  v_mfma_f32_16x16x32_bf16 v[104:107], a[52:55], a[24:27], v[104:107]
  s_cmp_eq_u32 s49, 1
  buffer_load_dword v143, s[36:39], s61 offen sc1 lds
  s_mov_b32 s69, 28
  v_mfma_f32_16x16x32_bf16 v[100:103], a[52:55], a[20:23], v[100:103]
  s_waitcnt vmcnt(24) lgkmcnt(3)
  s_barrier
  s_mul_i32 s60, s69, 196608
  v_mfma_f32_16x16x32_bf16 v[20:23], a[56:59], a[0:3], v[20:23]
  s_cselect_b32 s82, 0xd1643520, s82
  ds_read_b64_tr_b16 a[70:71], v136 offset:29696
  s_cselect_b32 s83, 0xfecba897, s83
  v_mfma_f32_16x16x32_bf16 v[24:27], a[56:59], a[4:7], v[24:27]
  s_add_u32 m0, s62, 64512
  ds_read_b64_tr_b16 a[40:41], v135 offset:21504
  s_cmp_eq_u32 s49, 2
  v_mfma_f32_16x16x32_bf16 v[28:31], a[56:59], a[8:11], v[28:31]
  s_cselect_b32 s82, 0x72546310, s82
  buffer_load_dwordx4 v139, s[8:11], s60 offen offset:0 lds
  s_cselect_b32 s83, 0xfdcb98ae, s83
  v_mfma_f32_16x16x32_bf16 v[32:35], a[56:59], a[12:15], v[32:35]
  s_cmp_eq_u32 s49, 3
  ds_read_b64_tr_b16 a[42:43], v135 offset:27648
  s_cselect_b32 s82, 0x63547210, s82
  v_mfma_f32_16x16x32_bf16 v[116:119], a[56:59], a[16:19], v[116:119]
  s_cselect_b32 s83, 0xfedca9b8, s83
  ds_read_b64_tr_b16 a[44:45], v136 offset:21504
  s_cmp_eq_u32 s49, 4
  v_mfma_f32_16x16x32_bf16 v[48:51], a[60:63], a[12:15], v[48:51]
  s_cselect_b32 s82, 0x64583210, s82
  s_cselect_b32 s83, 0xfedba9c7, s83
  s_cmp_eq_u32 s49, 5
  v_mfma_f32_16x16x32_bf16 v[44:47], a[60:63], a[8:11], v[44:47]
  s_cselect_b32 s82, 0x65493210, s82
  buffer_load_dwordx4 v140, s[8:11], s60 offen offset:1024 lds
  s_cselect_b32 s83, 0xfecba8d7, s83
  v_mfma_f32_16x16x32_bf16 v[40:43], a[60:63], a[4:7], v[40:43]
  s_cmp_eq_u32 s49, 6
  ds_read_b64_tr_b16 a[46:47], v136 offset:27648
  s_cselect_b32 s82, 0x56a43210, s82
  v_mfma_f32_16x16x32_bf16 v[36:39], a[60:63], a[0:3], v[36:39]
  s_waitcnt lgkmcnt(4)
  ds_read_b64_tr_b16 a[48:49], v135 offset:44032
  s_cselect_b32 s83, 0xfdcb98e7, s83
  v_mfma_f32_16x16x32_bf16 v[52:55], a[0:3], a[64:67], v[52:55]
  s_cmp_eq_u32 s49, 7
  ds_read_b128 a[20:23], v145 offset:55296
  s_cselect_b32 s82, 0x57b43210, s82
  v_mfma_f32_16x16x32_bf16 v[56:59], a[4:7], a[64:67], v[56:59]
  s_cselect_b32 s83, 0xedca98f6, s83
  buffer_load_dwordx4 v141, s[8:11], s60 offen offset:2048 lds
  s_mul_i32 s84, s44, 7168
  v_mfma_f32_16x16x32_bf16 v[60:63], a[8:11], a[64:67], v[60:63]
  s_lshl_b32 s61, s69, 11
  ds_read_b64_tr_b16 a[50:51], v135 offset:50176
  s_add_u32 m0, s63, 76800
  v_mfma_f32_16x16x32_bf16 v[64:67], a[12:15], a[64:67], v[64:67]
  s_lshl2_add_u32 s85, s56, s44
  ds_read_b128 a[24:27], v145 offset:56320
  s_lshl_b32 s85, s85, 17
  v_mfma_f32_16x16x32_bf16 v[120:123], a[16:19], a[64:67], v[120:123]
  s_add_u32 s85, s85, 36700160
  ds_read_b64_tr_b16 a[52:53], v136 offset:44032
  s_cmp_ge_u32 s44, 2
  v_mfma_f32_16x16x32_bf16 v[80:83], a[12:15], a[68:71], v[80:83]
  s_cselect_b64 s[16:17], s[20:21], s[16:17]
  ds_read_b128 a[28:31], v145 offset:57344
  v_lshrrev_b32 v12, 2, v10
  v_mfma_f32_16x16x32_bf16 v[76:79], a[8:11], a[68:71], v[76:79]
  buffer_load_dwordx4 v142, s[36:39], s61 offen offset:0 sc1 lds
  v_mul_u32_u24 v12, 224, v12
  v_mfma_f32_16x16x32_bf16 v[72:75], a[4:7], a[68:71], v[72:75]
  ds_read_b64_tr_b16 a[54:55], v136 offset:50176
  v_and_b32 v13, 3, v10
  v_mfma_f32_16x16x32_bf16 v[68:71], a[0:3], a[68:71], v[68:71]
  s_waitcnt lgkmcnt(7)
  ds_read_b128 a[32:35], v145 offset:58368
  v_lshl_add_u32 v1, v13, 3, v12
  v_mfma_f32_16x16x32_bf16 v[84:87], a[40:43], a[0:3], v[84:87]
  ds_read_b128 a[36:39], v148 offset:63488
  v_add_u32 v2, 57344, v1
  v_mfma_f32_16x16x32_bf16 v[88:91], a[40:43], a[4:7], v[88:91]
  s_mul_i32 s48, s59, 224
  ds_read_b64_tr_b16 a[56:57], v135 offset:45056
  s_and_b32 s49, s44, 1
  v_mfma_f32_16x16x32_bf16 v[92:95], a[40:43], a[8:11], v[92:95]
  s_mul_i32 s49, s49, 229376
  buffer_load_dwordx4 v142, s[36:39], s61 offen offset:1024 sc1 lds
  s_add_u32 m0, s64, 84992
  v_mfma_f32_16x16x32_bf16 v[96:99], a[40:43], a[12:15], v[96:99]
  s_add_u32 s48, s48, s49
  ds_read_b64_tr_b16 a[58:59], v135 offset:51200
  s_and_b32 s49, s59, 1
  v_mfma_f32_16x16x32_bf16 v[112:115], a[44:47], a[12:15], v[112:115]
  s_lshl_b32 s49, s49, 1
  ds_read_b64_tr_b16 a[60:61], v136 offset:45056
  v_add_u32 v12, 0, v10
  v_mfma_f32_16x16x32_bf16 v[108:111], a[44:47], a[8:11], v[108:111]
  v_mul_u32_u24 v13, 4682, v12
  v_lshrrev_b32 v13, 16, v13
  v_mfma_f32_16x16x32_bf16 v[104:107], a[44:47], a[4:7], v[104:107]
  buffer_load_dword v143, s[36:39], s61 offen sc1 lds
  s_mov_b32 s70, 29
  v_mfma_f32_16x16x32_bf16 v[100:103], a[44:47], a[0:3], v[100:103]
  s_waitcnt vmcnt(24) lgkmcnt(3)
  s_barrier
  s_mul_i32 s60, s70, 196608
  v_mfma_f32_16x16x32_bf16 v[20:23], a[48:51], a[20:23], v[20:23]
  s_add_u32 m0, s62, 86016
  ds_read_b64_tr_b16 a[62:63], v136 offset:51200
  v_mul_i32_i24 v14, -14, v13
  v_mfma_f32_16x16x32_bf16 v[24:27], a[48:51], a[24:27], v[24:27]
  ds_read_b64_tr_b16 a[64:65], v135 offset:43008
  v_add3_u32 v12, v12, v14, s49
  v_mfma_f32_16x16x32_bf16 v[28:31], a[48:51], a[28:31], v[28:31]
  buffer_load_dwordx4 v139, s[8:11], s60 offen offset:0 lds
  v_add_u32 v14, -14, v12
  v_mfma_f32_16x16x32_bf16 v[32:35], a[48:51], a[32:35], v[32:35]
  ds_read_b64_tr_b16 a[66:67], v135 offset:49152
  v_min_u32 v12, v12, v14
  v_mfma_f32_16x16x32_bf16 v[116:119], a[48:51], a[36:39], v[116:119]
  ds_read_b64_tr_b16 a[68:69], v136 offset:43008
  v_mul_u32_u24 v13, 7168, v13
  v_mfma_f32_16x16x32_bf16 v[48:51], a[52:55], a[32:35], v[48:51]
  v_lshl_add_u32 v12, v12, 4, v13
  v_add_u32 v3, s48, v12
  v_mfma_f32_16x16x32_bf16 v[44:47], a[52:55], a[28:31], v[44:47]
  s_sub_u32 s48, s48, 1024
  buffer_load_dwordx4 v140, s[8:11], s60 offen offset:1024 lds
  v_add_u32 v12, 64, v10
  v_mfma_f32_16x16x32_bf16 v[40:43], a[52:55], a[24:27], v[40:43]
  ds_read_b64_tr_b16 a[70:71], v136 offset:49152
  v_mul_u32_u24 v13, 4682, v12
  v_mfma_f32_16x16x32_bf16 v[36:39], a[52:55], a[20:23], v[36:39]
  s_waitcnt lgkmcnt(4)
  ds_read_b64_tr_b16 a[40:41], v137 offset:1024
  v_lshrrev_b32 v13, 16, v13
  v_mfma_f32_16x16x32_bf16 v[52:55], a[20:23], a[56:59], v[52:55]
  ds_read_b128 a[0:3], v146 offset:12288
  v_mul_i32_i24 v14, -14, v13
  v_mfma_f32_16x16x32_bf16 v[56:59], a[24:27], a[56:59], v[56:59]
  buffer_load_dwordx4 v141, s[8:11], s60 offen offset:2048 lds
  v_add3_u32 v12, v12, v14, s49
  v_mfma_f32_16x16x32_bf16 v[60:63], a[28:31], a[56:59], v[60:63]
  s_lshl_b32 s61, s70, 11
  ds_read_b64_tr_b16 a[42:43], v137 offset:7168
  s_add_u32 m0, s63, 98304
  v_mfma_f32_16x16x32_bf16 v[64:67], a[32:35], a[56:59], v[64:67]
  ds_read_b128 a[4:7], v146 offset:13312
  v_add_u32 v14, -14, v12
  v_mfma_f32_16x16x32_bf16 v[120:123], a[36:39], a[56:59], v[120:123]
  ds_read_b64_tr_b16 a[44:45], v138 offset:1024
  v_min_u32 v12, v12, v14
  v_mfma_f32_16x16x32_bf16 v[80:83], a[32:35], a[60:63], v[80:83]
  ds_read_b128 a[8:11], v146 offset:14336
  v_mul_u32_u24 v13, 7168, v13
  v_mfma_f32_16x16x32_bf16 v[76:79], a[28:31], a[60:63], v[76:79]
  buffer_load_dwordx4 v142, s[36:39], s61 offen offset:0 sc1 lds
  v_lshl_add_u32 v12, v12, 4, v13
  v_mfma_f32_16x16x32_bf16 v[72:75], a[24:27], a[60:63], v[72:75]
  ds_read_b64_tr_b16 a[46:47], v138 offset:7168
  v_add_u32 v4, s48, v12
  v_mfma_f32_16x16x32_bf16 v[68:71], a[20:23], a[60:63], v[68:71]
  s_waitcnt lgkmcnt(7)
  ds_read_b128 a[12:15], v146 offset:15360
  s_sub_u32 s48, s48, 1024
  v_mfma_f32_16x16x32_bf16 v[84:87], a[64:67], a[20:23], v[84:87]
  ds_read_b128 a[16:19], v149 offset:20480
  v_add_u32 v12, 128, v10
  v_mfma_f32_16x16x32_bf16 v[88:91], a[64:67], a[24:27], v[88:91]
  ds_read_b64_tr_b16 a[48:49], v137 offset:2048
  v_mul_u32_u24 v13, 4682, v12
  v_mfma_f32_16x16x32_bf16 v[92:95], a[64:67], a[28:31], v[92:95]
  buffer_load_dwordx4 v142, s[36:39], s61 offen offset:1024 sc1 lds
  s_add_u32 m0, s64, 106496
  v_mfma_f32_16x16x32_bf16 v[96:99], a[64:67], a[32:35], v[96:99]
  ds_read_b64_tr_b16 a[50:51], v137 offset:8192
  v_lshrrev_b32 v13, 16, v13
  v_mfma_f32_16x16x32_bf16 v[112:115], a[68:71], a[32:35], v[112:115]
  ds_read_b64_tr_b16 a[52:53], v138 offset:2048
  v_mul_i32_i24 v14, -14, v13
  v_mfma_f32_16x16x32_bf16 v[108:111], a[68:71], a[28:31], v[108:111]
  v_add3_u32 v12, v12, v14, s49
  v_add_u32 v14, -14, v12
  v_mfma_f32_16x16x32_bf16 v[104:107], a[68:71], a[24:27], v[104:107]
  buffer_load_dword v143, s[36:39], s61 offen sc1 lds
  s_mov_b32 s65, 30
  v_mfma_f32_16x16x32_bf16 v[100:103], a[68:71], a[20:23], v[100:103]
  s_waitcnt vmcnt(24) lgkmcnt(3)
  s_barrier
  s_mul_i32 s60, s65, 196608
  v_mfma_f32_16x16x32_bf16 v[20:23], a[40:43], a[0:3], v[20:23]
  s_add_u32 m0, s62, 107520
  ds_read_b64_tr_b16 a[54:55], v138 offset:8192
  v_min_u32 v12, v12, v14
  v_mfma_f32_16x16x32_bf16 v[24:27], a[40:43], a[4:7], v[24:27]
  ds_read_b64_tr_b16 a[56:57], v137 offset:0
  v_mul_u32_u24 v13, 7168, v13
  v_mfma_f32_16x16x32_bf16 v[28:31], a[40:43], a[8:11], v[28:31]
  buffer_load_dwordx4 v139, s[8:11], s60 offen offset:0 lds
  v_lshl_add_u32 v12, v12, 4, v13
  v_mfma_f32_16x16x32_bf16 v[32:35], a[40:43], a[12:15], v[32:35]
  ds_read_b64_tr_b16 a[58:59], v137 offset:6144
  v_add_u32 v5, s48, v12
  v_mfma_f32_16x16x32_bf16 v[116:119], a[40:43], a[16:19], v[116:119]
  s_sub_u32 s48, s48, 1024
  ds_read_b64_tr_b16 a[60:61], v138 offset:0
  v_add_u32 v12, 192, v10
  v_mfma_f32_16x16x32_bf16 v[48:51], a[44:47], a[12:15], v[48:51]
  v_mul_u32_u24 v13, 4682, v12
  v_lshrrev_b32 v13, 16, v13
  v_mfma_f32_16x16x32_bf16 v[44:47], a[44:47], a[8:11], v[44:47]
  buffer_load_dwordx4 v140, s[8:11], s60 offen offset:1024 lds
  v_mul_i32_i24 v14, -14, v13
  v_mfma_f32_16x16x32_bf16 v[40:43], a[44:47], a[4:7], v[40:43]
  ds_read_b64_tr_b16 a[62:63], v138 offset:6144
  v_add3_u32 v12, v12, v14, s49
  v_mfma_f32_16x16x32_bf16 v[36:39], a[44:47], a[0:3], v[36:39]
  s_waitcnt lgkmcnt(4)
  ds_read_b64_tr_b16 a[64:65], v133 offset:1024
  v_add_u32 v14, -14, v12
  v_mfma_f32_16x16x32_bf16 v[52:55], a[0:3], a[48:51], v[52:55]
  ds_read_b128 a[20:23], v144 offset:12288
  v_min_u32 v12, v12, v14
  v_mfma_f32_16x16x32_bf16 v[56:59], a[4:7], a[48:51], v[56:59]
  buffer_load_dwordx4 v141, s[8:11], s60 offen offset:2048 lds
  v_mul_u32_u24 v13, 7168, v13
  v_mfma_f32_16x16x32_bf16 v[60:63], a[8:11], a[48:51], v[60:63]
  s_lshl_b32 s61, s65, 11
  ds_read_b64_tr_b16 a[66:67], v133 offset:7168
  s_add_u32 m0, s63, 119808
  v_mfma_f32_16x16x32_bf16 v[64:67], a[12:15], a[48:51], v[64:67]
  ds_read_b128 a[24:27], v144 offset:13312
  v_lshl_add_u32 v12, v12, 4, v13
  v_mfma_f32_16x16x32_bf16 v[120:123], a[16:19], a[48:51], v[120:123]
  ds_read_b64_tr_b16 a[68:69], v134 offset:1024
  v_add_u32 v6, s48, v12
  v_mfma_f32_16x16x32_bf16 v[80:83], a[12:15], a[52:55], v[80:83]
  s_sub_u32 s48, s48, -3072
  ds_read_b128 a[28:31], v144 offset:14336
  v_add_u32 v12, 256, v10
  v_mfma_f32_16x16x32_bf16 v[76:79], a[8:11], a[52:55], v[76:79]
  buffer_load_dwordx4 v142, s[36:39], s61 offen offset:0 sc1 lds
  v_mul_u32_u24 v13, 4682, v12
  v_mfma_f32_16x16x32_bf16 v[72:75], a[4:7], a[52:55], v[72:75]
  ds_read_b64_tr_b16 a[70:71], v134 offset:7168
  v_lshrrev_b32 v13, 16, v13
  v_mfma_f32_16x16x32_bf16 v[68:71], a[0:3], a[52:55], v[68:71]
  s_waitcnt lgkmcnt(7)
  ds_read_b128 a[32:35], v144 offset:15360
  v_mul_i32_i24 v14, -14, v13
  v_mfma_f32_16x16x32_bf16 v[84:87], a[56:59], a[0:3], v[84:87]
  ds_read_b128 a[36:39], v147 offset:20480
  v_add3_u32 v12, v12, v14, s49
  v_mfma_f32_16x16x32_bf16 v[88:91], a[56:59], a[4:7], v[88:91]
  ds_read_b64_tr_b16 a[40:41], v133 offset:2048
  v_add_u32 v14, -14, v12
  v_mfma_f32_16x16x32_bf16 v[92:95], a[56:59], a[8:11], v[92:95]
  buffer_load_dwordx4 v142, s[36:39], s61 offen offset:1024 sc1 lds
  s_add_u32 m0, s64, 128000
  v_mfma_f32_16x16x32_bf16 v[96:99], a[56:59], a[12:15], v[96:99]
  ds_read_b64_tr_b16 a[42:43], v133 offset:8192
  v_min_u32 v12, v12, v14
  v_mfma_f32_16x16x32_bf16 v[112:115], a[60:63], a[12:15], v[112:115]
  ds_read_b64_tr_b16 a[44:45], v134 offset:2048
  v_mul_u32_u24 v13, 7168, v13
  v_mfma_f32_16x16x32_bf16 v[108:111], a[60:63], a[8:11], v[108:111]
  v_lshl_add_u32 v12, v12, 4, v13
  v_add_u32 v7, s48, v12
  v_mfma_f32_16x16x32_bf16 v[104:107], a[60:63], a[4:7], v[104:107]
  s_sub_u32 s48, s48, 1024
  buffer_load_dword v143, s[36:39], s61 offen sc1 lds
  s_mov_b32 s66, 31
  v_mfma_f32_16x16x32_bf16 v[100:103], a[60:63], a[0:3], v[100:103]
  s_waitcnt vmcnt(24) lgkmcnt(3)
  s_barrier
  s_mul_i32 s60, s66, 196608
  v_mfma_f32_16x16x32_bf16 v[20:23], a[64:67], a[20:23], v[20:23]
  s_add_u32 m0, s62, 129024
  ds_read_b64_tr_b16 a[46:47], v134 offset:8192
  v_add_u32 v12, 320, v10
  v_mfma_f32_16x16x32_bf16 v[24:27], a[64:67], a[24:27], v[24:27]
  ds_read_b64_tr_b16 a[48:49], v133 offset:0
  v_mul_u32_u24 v13, 4682, v12
  v_mfma_f32_16x16x32_bf16 v[28:31], a[64:67], a[28:31], v[28:31]
  buffer_load_dwordx4 v139, s[8:11], s60 offen offset:0 lds
  v_lshrrev_b32 v13, 16, v13
  v_mfma_f32_16x16x32_bf16 v[32:35], a[64:67], a[32:35], v[32:35]
  ds_read_b64_tr_b16 a[50:51], v133 offset:6144
  v_mul_i32_i24 v14, -14, v13
  v_mfma_f32_16x16x32_bf16 v[116:119], a[64:67], a[36:39], v[116:119]
  ds_read_b64_tr_b16 a[52:53], v134 offset:0
  v_add3_u32 v12, v12, v14, s49
  v_mfma_f32_16x16x32_bf16 v[48:51], a[68:71], a[32:35], v[48:51]
  v_add_u32 v14, -14, v12
  v_min_u32 v12, v12, v14
  v_mfma_f32_16x16x32_bf16 v[44:47], a[68:71], a[28:31], v[44:47]
  buffer_load_dwordx4 v140, s[8:11], s60 offen offset:1024 lds
  v_mul_u32_u24 v13, 7168, v13
  v_mfma_f32_16x16x32_bf16 v[40:43], a[68:71], a[24:27], v[40:43]
  ds_read_b64_tr_b16 a[54:55], v134 offset:6144
  v_lshl_add_u32 v12, v12, 4, v13
  v_mfma_f32_16x16x32_bf16 v[36:39], a[68:71], a[20:23], v[36:39]
  s_waitcnt lgkmcnt(4)
  ds_read_b64_tr_b16 a[56:57], v133 offset:22528
  v_add_u32 v8, s48, v12
  v_mfma_f32_16x16x32_bf16 v[52:55], a[20:23], a[40:43], v[52:55]
  s_sub_u32 s48, s48, 1024
  ds_read_b128 a[0:3], v144 offset:33792
  v_add_u32 v12, 384, v10
  v_mfma_f32_16x16x32_bf16 v[56:59], a[24:27], a[40:43], v[56:59]
  buffer_load_dwordx4 v141, s[8:11], s60 offen offset:2048 lds
  v_mul_u32_u24 v13, 4682, v12
  v_mfma_f32_16x16x32_bf16 v[60:63], a[28:31], a[40:43], v[60:63]
  s_lshl_b32 s61, s66, 11
  ds_read_b64_tr_b16 a[58:59], v133 offset:28672
  s_add_u32 m0, s63, 141312
  v_mfma_f32_16x16x32_bf16 v[64:67], a[32:35], a[40:43], v[64:67]
  ds_read_b128 a[4:7], v144 offset:34816
  v_lshrrev_b32 v13, 16, v13
  v_mfma_f32_16x16x32_bf16 v[120:123], a[36:39], a[40:43], v[120:123]
  ds_read_b64_tr_b16 a[60:61], v134 offset:22528
  v_mul_i32_i24 v14, -14, v13
  v_mfma_f32_16x16x32_bf16 v[80:83], a[32:35], a[44:47], v[80:83]
  ds_read_b128 a[8:11], v144 offset:35840
  v_add3_u32 v12, v12, v14, s49
  v_mfma_f32_16x16x32_bf16 v[76:79], a[28:31], a[44:47], v[76:79]
  buffer_load_dwordx4 v142, s[36:39], s61 offen offset:0 sc1 lds
  v_add_u32 v14, -14, v12
  v_mfma_f32_16x16x32_bf16 v[72:75], a[24:27], a[44:47], v[72:75]
  ds_read_b64_tr_b16 a[62:63], v134 offset:28672
  v_min_u32 v12, v12, v14
  v_mfma_f32_16x16x32_bf16 v[68:71], a[20:23], a[44:47], v[68:71]
  s_waitcnt lgkmcnt(7)
  ds_read_b128 a[12:15], v144 offset:36864
  v_mul_u32_u24 v13, 7168, v13
  v_mfma_f32_16x16x32_bf16 v[84:87], a[48:51], a[20:23], v[84:87]
  ds_read_b128 a[16:19], v147 offset:41984
  v_lshl_add_u32 v12, v12, 4, v13
  v_mfma_f32_16x16x32_bf16 v[88:91], a[48:51], a[24:27], v[88:91]
  ds_read_b64_tr_b16 a[64:65], v133 offset:23552
  v_add_u32 v9, s48, v12
  v_mfma_f32_16x16x32_bf16 v[92:95], a[48:51], a[28:31], v[92:95]
  s_sub_u32 s48, s48, 1024
  buffer_load_dwordx4 v142, s[36:39], s61 offen offset:1024 sc1 lds
  s_add_u32 m0, s64, 149504
  v_mfma_f32_16x16x32_bf16 v[96:99], a[48:51], a[32:35], v[96:99]
  s_and_b32 s48, s56, 1
  ds_read_b64_tr_b16 a[66:67], v133 offset:29696
  s_lshl_b32 s48, s48, 7
  v_mfma_f32_16x16x32_bf16 v[112:115], a[52:55], a[32:35], v[112:115]
  s_and_b32 s49, s56, 6
  ds_read_b64_tr_b16 a[68:69], v134 offset:23552
  s_add_u32 s48, s48, s49
  v_mfma_f32_16x16x32_bf16 v[108:111], a[52:55], a[28:31], v[108:111]
  v_bfe_u32 v12, v10, 1, 4
  v_and_b32 v13, 1, v10
  v_mfma_f32_16x16x32_bf16 v[104:107], a[52:55], a[24:27], v[104:107]
  buffer_load_dword v143, s[36:39], s61 offen sc1 lds
  s_nop 0
  v_mfma_f32_16x16x32_bf16 v[100:103], a[52:55], a[20:23], v[100:103]
  s_waitcnt vmcnt(24) lgkmcnt(3)
  s_barrier
  s_add_u32 s50, s79, 0
  v_mfma_f32_16x16x32_bf16 v[20:23], a[56:59], a[0:3], v[20:23]
  s_and_b32 s50, s50, 7
  s_lshl_b32 s50, s50, 18
  s_add_u32 m0, s73, 0
  v_mfma_f32_16x16x32_bf16 v[24:27], a[56:59], a[4:7], v[24:27]
  ds_read_b64_tr_b16 a[70:71], v134 offset:29696
  v_lshl_add_u32 v12, v12, 3, v13
  v_mfma_f32_16x16x32_bf16 v[28:31], a[56:59], a[8:11], v[28:31]
  ds_read_b64_tr_b16 a[40:41], v133 offset:21504
  v_add_lshl_u32 v250, v12, s48, 7
  v_mfma_f32_16x16x32_bf16 v[32:35], a[56:59], a[12:15], v[32:35]
  buffer_load_dwordx4 v216, s[12:15], s50 offen offset:0 lds
  v_mfma_f32_16x16x32_bf16 v[116:119], a[56:59], a[16:19], v[116:119]
  ds_read_b64_tr_b16 a[42:43], v133 offset:27648
  v_mfma_f32_16x16x32_bf16 v[48:51], a[60:63], a[12:15], v[48:51]
  ds_read_b64_tr_b16 a[44:45], v134 offset:21504
  v_mfma_f32_16x16x32_bf16 v[44:47], a[60:63], a[8:11], v[44:47]
  ds_read_b64_tr_b16 a[46:47], v134 offset:27648
  v_mfma_f32_16x16x32_bf16 v[40:43], a[60:63], a[4:7], v[40:43]
  buffer_load_dwordx4 v217, s[12:15], s50 offen offset:1024 lds
  v_mfma_f32_16x16x32_bf16 v[36:39], a[60:63], a[0:3], v[36:39]
  s_waitcnt lgkmcnt(4)
  ds_read_b64_tr_b16 a[48:49], v133 offset:44032
  v_mfma_f32_16x16x32_bf16 v[52:55], a[0:3], a[64:67], v[52:55]
Ha0_1:
  s_cbranch_execz Ha0_2
  ds_read_b128 a[20:23], v144 offset:55296
  v_mfma_f32_16x16x32_bf16 v[56:59], a[4:7], a[64:67], v[56:59]
  ds_read_b64_tr_b16 a[50:51], v133 offset:50176
  v_mfma_f32_16x16x32_bf16 v[60:63], a[8:11], a[64:67], v[60:63]
  buffer_load_dwordx4 v218, s[12:15], s50 offen offset:2048 lds
  v_mfma_f32_16x16x32_bf16 v[64:67], a[12:15], a[64:67], v[64:67]
  ds_read_b128 a[24:27], v144 offset:56320
  v_mfma_f32_16x16x32_bf16 v[120:123], a[16:19], a[64:67], v[120:123]
  ds_read_b64_tr_b16 a[52:53], v134 offset:44032
  v_mfma_f32_16x16x32_bf16 v[80:83], a[12:15], a[68:71], v[80:83]
  ds_read_b128 a[28:31], v144 offset:57344
  v_mfma_f32_16x16x32_bf16 v[76:79], a[8:11], a[68:71], v[76:79]
  buffer_load_dwordx4 v219, s[12:15], s50 offen offset:3072 lds
  v_mfma_f32_16x16x32_bf16 v[72:75], a[4:7], a[68:71], v[72:75]
  ds_read_b64_tr_b16 a[54:55], v134 offset:50176
  v_mfma_f32_16x16x32_bf16 v[68:71], a[0:3], a[68:71], v[68:71]
  s_waitcnt lgkmcnt(7)
  ds_read_b128 a[32:35], v144 offset:58368
  v_mfma_f32_16x16x32_bf16 v[84:87], a[40:43], a[0:3], v[84:87]
  ds_read_b128 a[36:39], v147 offset:63488
  v_mfma_f32_16x16x32_bf16 v[88:91], a[40:43], a[4:7], v[88:91]
  buffer_load_dwordx4 v[156:159], v196, s[28:31], s52 offen nt
  s_add_u32 s52, s52, 12288
  v_mfma_f32_16x16x32_bf16 v[92:95], a[40:43], a[8:11], v[92:95]
  ds_read_b64_tr_b16 a[56:57], v133 offset:45056
  v_mfma_f32_16x16x32_bf16 v[96:99], a[40:43], a[12:15], v[96:99]
  ds_read_b64_tr_b16 a[58:59], v133 offset:51200
  v_mfma_f32_16x16x32_bf16 v[112:115], a[44:47], a[12:15], v[112:115]
  ds_read_b64_tr_b16 a[60:61], v134 offset:45056
  v_mfma_f32_16x16x32_bf16 v[108:111], a[44:47], a[8:11], v[108:111]
  buffer_load_dwordx4 v[160:163], v196, s[28:31], s52 offen nt
  s_add_u32 s52, s52, 12288
  v_mfma_f32_16x16x32_bf16 v[104:107], a[44:47], a[4:7], v[104:107]
  ds_read_b64_tr_b16 a[62:63], v134 offset:51200
  v_mfma_f32_16x16x32_bf16 v[100:103], a[44:47], a[0:3], v[100:103]
  s_waitcnt vmcnt(24) lgkmcnt(4)
  s_barrier
  v_mfma_f32_16x16x32_bf16 v[20:23], a[48:51], a[20:23], v[20:23]
  ds_read_b64_tr_b16 a[64:65], v133 offset:43008
  v_mfma_f32_16x16x32_bf16 v[24:27], a[48:51], a[24:27], v[24:27]
  buffer_load_dwordx4 v[164:167], v196, s[28:31], s52 offen nt
  s_add_u32 s52, s52, 12288
  v_mfma_f32_16x16x32_bf16 v[28:31], a[48:51], a[28:31], v[28:31]
  ds_read_b64_tr_b16 a[66:67], v133 offset:49152
  v_mfma_f32_16x16x32_bf16 v[32:35], a[48:51], a[32:35], v[32:35]
  v_mfma_f32_16x16x32_bf16 v[116:119], a[48:51], a[36:39], v[116:119]
  ds_read_b64_tr_b16 a[68:69], v134 offset:43008
  v_mfma_f32_16x16x32_bf16 v[48:51], a[52:55], a[32:35], v[48:51]
  buffer_load_dwordx4 v[168:171], v196, s[28:31], s52 offen nt
  s_add_u32 s52, s52, 12288
  v_mfma_f32_16x16x32_bf16 v[44:47], a[52:55], a[28:31], v[44:47]
  ds_read_b64_tr_b16 a[70:71], v134 offset:49152
  v_mfma_f32_16x16x32_bf16 v[40:43], a[52:55], a[24:27], v[40:43]
  v_mfma_f32_16x16x32_bf16 v[36:39], a[52:55], a[20:23], v[36:39]
  s_waitcnt lgkmcnt(4)
  ds_read_b64_tr_b16 a[40:41], v135 offset:1024
  v_mfma_f32_16x16x32_bf16 v[52:55], a[20:23], a[56:59], v[52:55]
  buffer_load_dwordx4 v[172:175], v196, s[28:31], s52 offen nt
  s_add_u32 s52, s52, 12288
  v_mfma_f32_16x16x32_bf16 v[56:59], a[24:27], a[56:59], v[56:59]
  ds_read_b128 a[0:3], v145 offset:12288
  v_mfma_f32_16x16x32_bf16 v[60:63], a[28:31], a[56:59], v[60:63]
  ds_read_b64_tr_b16 a[42:43], v135 offset:7168
  v_mfma_f32_16x16x32_bf16 v[64:67], a[32:35], a[56:59], v[64:67]
  ds_read_b128 a[4:7], v145 offset:13312
  v_mfma_f32_16x16x32_bf16 v[120:123], a[36:39], a[56:59], v[120:123]
  buffer_load_dwordx4 v[176:179], v196, s[28:31], s52 offen nt
  s_add_u32 s52, s52, 12288
  v_mfma_f32_16x16x32_bf16 v[80:83], a[32:35], a[60:63], v[80:83]
  ds_read_b64_tr_b16 a[44:45], v136 offset:1024
  v_mfma_f32_16x16x32_bf16 v[76:79], a[28:31], a[60:63], v[76:79]
  ds_read_b128 a[8:11], v145 offset:14336
  v_mfma_f32_16x16x32_bf16 v[72:75], a[24:27], a[60:63], v[72:75]
  ds_read_b64_tr_b16 a[46:47], v136 offset:7168
  v_mfma_f32_16x16x32_bf16 v[68:71], a[20:23], a[60:63], v[68:71]
  s_waitcnt lgkmcnt(7)
  buffer_load_dwordx4 v[180:183], v196, s[28:31], s52 offen nt
  s_add_u32 s52, s52, 12288
  v_mfma_f32_16x16x32_bf16 v[84:87], a[64:67], a[20:23], v[84:87]
  ds_read_b128 a[12:15], v145 offset:15360
  v_mfma_f32_16x16x32_bf16 v[88:91], a[64:67], a[24:27], v[88:91]
  ds_read_b128 a[16:19], v148 offset:20480
  v_mfma_f32_16x16x32_bf16 v[92:95], a[64:67], a[28:31], v[92:95]
  ds_read_b64_tr_b16 a[48:49], v135 offset:2048
  v_mfma_f32_16x16x32_bf16 v[96:99], a[64:67], a[32:35], v[96:99]
  buffer_load_dwordx4 v[184:187], v196, s[28:31], s52 offen nt
  v_mfma_f32_16x16x32_bf16 v[112:115], a[68:71], a[32:35], v[112:115]
  ds_read_b64_tr_b16 a[50:51], v135 offset:8192
  v_mfma_f32_16x16x32_bf16 v[108:111], a[68:71], a[28:31], v[108:111]
  ds_read_b64_tr_b16 a[52:53], v136 offset:2048
  v_mfma_f32_16x16x32_bf16 v[104:107], a[68:71], a[24:27], v[104:107]
  ds_read_b64_tr_b16 a[54:55], v136 offset:8192
  v_mfma_f32_16x16x32_bf16 v[100:103], a[68:71], a[20:23], v[100:103]
  s_waitcnt vmcnt(24) lgkmcnt(4)
  s_barrier
  v_mfma_f32_16x16x32_bf16 v[20:23], a[40:43], a[0:3], v[20:23]
  ds_read_b64_tr_b16 a[56:57], v135 offset:0
  v_mfma_f32_16x16x32_bf16 v[24:27], a[40:43], a[4:7], v[24:27]
  v_mfma_f32_16x16x32_bf16 v[28:31], a[40:43], a[8:11], v[28:31]
  ds_read_b64_tr_b16 a[58:59], v135 offset:6144
  v_mfma_f32_16x16x32_bf16 v[32:35], a[40:43], a[12:15], v[32:35]
  v_mfma_f32_16x16x32_bf16 v[116:119], a[40:43], a[16:19], v[116:119]
  ds_read_b64_tr_b16 a[60:61], v136 offset:0
  v_mfma_f32_16x16x32_bf16 v[48:51], a[44:47], a[12:15], v[48:51]
  v_mfma_f32_16x16x32_bf16 v[44:47], a[44:47], a[8:11], v[44:47]
  ds_read_b64_tr_b16 a[62:63], v136 offset:6144
  v_mfma_f32_16x16x32_bf16 v[40:43], a[44:47], a[4:7], v[40:43]
  v_mfma_f32_16x16x32_bf16 v[36:39], a[44:47], a[0:3], v[36:39]
  s_waitcnt lgkmcnt(4)
  ds_read_b64_tr_b16 a[64:65], v135 offset:22528
  v_mfma_f32_16x16x32_bf16 v[52:55], a[0:3], a[48:51], v[52:55]
  ds_read_b128 a[20:23], v145 offset:33792
  v_mfma_f32_16x16x32_bf16 v[56:59], a[4:7], a[48:51], v[56:59]
  ds_read_b64_tr_b16 a[66:67], v135 offset:28672
  v_mfma_f32_16x16x32_bf16 v[60:63], a[8:11], a[48:51], v[60:63]
  ds_read_b128 a[24:27], v145 offset:34816
  v_mfma_f32_16x16x32_bf16 v[64:67], a[12:15], a[48:51], v[64:67]
  v_mfma_f32_16x16x32_bf16 v[120:123], a[16:19], a[48:51], v[120:123]
  ds_read_b64_tr_b16 a[68:69], v136 offset:22528
  v_mfma_f32_16x16x32_bf16 v[80:83], a[12:15], a[52:55], v[80:83]
  ds_read_b128 a[28:31], v145 offset:35840
  v_mfma_f32_16x16x32_bf16 v[76:79], a[8:11], a[52:55], v[76:79]
  ds_read_b64_tr_b16 a[70:71], v136 offset:28672
  v_mfma_f32_16x16x32_bf16 v[72:75], a[4:7], a[52:55], v[72:75]
  ds_read_b128 a[32:35], v145 offset:36864
  v_mfma_f32_16x16x32_bf16 v[68:71], a[0:3], a[52:55], v[68:71]
  s_waitcnt lgkmcnt(8)
  ds_read_b128 a[36:39], v148 offset:41984
  v_mfma_f32_16x16x32_bf16 v[84:87], a[56:59], a[0:3], v[84:87]
  ds_read_b64_tr_b16 a[40:41], v135 offset:23552
  v_mfma_f32_16x16x32_bf16 v[88:91], a[56:59], a[4:7], v[88:91]
  ds_read_b64_tr_b16 a[42:43], v135 offset:29696
  v_mfma_f32_16x16x32_bf16 v[92:95], a[56:59], a[8:11], v[92:95]
  v_mfma_f32_16x16x32_bf16 v[96:99], a[56:59], a[12:15], v[96:99]
  v_mfma_f32_16x16x32_bf16 v[112:115], a[60:63], a[12:15], v[112:115]
  ds_read_b64_tr_b16 a[44:45], v136 offset:23552
  v_mfma_f32_16x16x32_bf16 v[108:111], a[60:63], a[8:11], v[108:111]
  v_mfma_f32_16x16x32_bf16 v[104:107], a[60:63], a[4:7], v[104:107]
  ds_read_b64_tr_b16 a[46:47], v136 offset:29696
  v_mfma_f32_16x16x32_bf16 v[100:103], a[60:63], a[0:3], v[100:103]
  s_waitcnt vmcnt(18) lgkmcnt(4)
  s_barrier
  v_mfma_f32_16x16x32_bf16 v[20:23], a[64:67], a[20:23], v[20:23]
  ds_read_b64_tr_b16 a[48:49], v135 offset:21504
  v_mfma_f32_16x16x32_bf16 v[24:27], a[64:67], a[24:27], v[24:27]
  v_mfma_f32_16x16x32_bf16 v[28:31], a[64:67], a[28:31], v[28:31]
  ds_read_b64_tr_b16 a[50:51], v135 offset:27648
  v_mfma_f32_16x16x32_bf16 v[32:35], a[64:67], a[32:35], v[32:35]
  v_mfma_f32_16x16x32_bf16 v[116:119], a[64:67], a[36:39], v[116:119]
  ds_read_b64_tr_b16 a[52:53], v136 offset:21504
  v_mfma_f32_16x16x32_bf16 v[48:51], a[68:71], a[32:35], v[48:51]
  v_mfma_f32_16x16x32_bf16 v[44:47], a[68:71], a[28:31], v[44:47]
  ds_read_b64_tr_b16 a[54:55], v136 offset:27648
  v_mfma_f32_16x16x32_bf16 v[40:43], a[68:71], a[24:27], v[40:43]
  v_mfma_f32_16x16x32_bf16 v[36:39], a[68:71], a[20:23], v[36:39]
  s_waitcnt lgkmcnt(4)
  ds_read_b64_tr_b16 a[56:57], v135 offset:44032
  v_mfma_f32_16x16x32_bf16 v[52:55], a[20:23], a[40:43], v[52:55]
  ds_read_b128 a[0:3], v145 offset:55296
  v_mfma_f32_16x16x32_bf16 v[56:59], a[24:27], a[40:43], v[56:59]
  ds_read_b64_tr_b16 a[58:59], v135 offset:50176
  v_mfma_f32_16x16x32_bf16 v[60:63], a[28:31], a[40:43], v[60:63]
  ds_read_b128 a[4:7], v145 offset:56320
  v_mfma_f32_16x16x32_bf16 v[64:67], a[32:35], a[40:43], v[64:67]
  v_mfma_f32_16x16x32_bf16 v[120:123], a[36:39], a[40:43], v[120:123]
  ds_read_b64_tr_b16 a[60:61], v136 offset:44032
  v_mfma_f32_16x16x32_bf16 v[80:83], a[32:35], a[44:47], v[80:83]
  ds_read_b128 a[8:11], v145 offset:57344
  v_mfma_f32_16x16x32_bf16 v[76:79], a[28:31], a[44:47], v[76:79]
  ds_read_b64_tr_b16 a[62:63], v136 offset:50176
  v_mfma_f32_16x16x32_bf16 v[72:75], a[24:27], a[44:47], v[72:75]
  ds_read_b128 a[12:15], v145 offset:58368
  v_mfma_f32_16x16x32_bf16 v[68:71], a[20:23], a[44:47], v[68:71]
  s_waitcnt lgkmcnt(8)
  ds_read_b128 a[16:19], v148 offset:63488
  v_mfma_f32_16x16x32_bf16 v[84:87], a[48:51], a[20:23], v[84:87]
  ds_read_b64_tr_b16 a[64:65], v135 offset:45056
  v_mfma_f32_16x16x32_bf16 v[88:91], a[48:51], a[24:27], v[88:91]
  ds_read_b64_tr_b16 a[66:67], v135 offset:51200
  v_mfma_f32_16x16x32_bf16 v[92:95], a[48:51], a[28:31], v[92:95]
  v_mfma_f32_16x16x32_bf16 v[96:99], a[48:51], a[32:35], v[96:99]
  v_mfma_f32_16x16x32_bf16 v[112:115], a[52:55], a[32:35], v[112:115]
  ds_read_b64_tr_b16 a[68:69], v136 offset:45056
  v_mfma_f32_16x16x32_bf16 v[108:111], a[52:55], a[28:31], v[108:111]
  v_mfma_f32_16x16x32_bf16 v[104:107], a[52:55], a[24:27], v[104:107]
  ds_read_b64_tr_b16 a[70:71], v136 offset:51200
  v_mfma_f32_16x16x32_bf16 v[100:103], a[52:55], a[20:23], v[100:103]
  s_waitcnt vmcnt(12) lgkmcnt(4)
  s_barrier
  v_mfma_f32_16x16x32_bf16 v[20:23], a[56:59], a[0:3], v[20:23]
  ds_read_b64_tr_b16 a[40:41], v135 offset:43008
  v_mfma_f32_16x16x32_bf16 v[24:27], a[56:59], a[4:7], v[24:27]
  s_add_u32 s50, s79, 1
  s_and_b32 s50, s50, 7
  s_lshl_b32 s50, s50, 18
  v_mfma_f32_16x16x32_bf16 v[28:31], a[56:59], a[8:11], v[28:31]
  s_add_u32 m0, s73, 16384
  ds_read_b64_tr_b16 a[42:43], v135 offset:49152
  v_mfma_f32_16x16x32_bf16 v[32:35], a[56:59], a[12:15], v[32:35]
  v_mfma_f32_16x16x32_bf16 v[116:119], a[56:59], a[16:19], v[116:119]
  ds_read_b64_tr_b16 a[44:45], v136 offset:43008
  v_mfma_f32_16x16x32_bf16 v[48:51], a[60:63], a[12:15], v[48:51]
  buffer_load_dwordx4 v216, s[12:15], s50 offen offset:0 lds
  v_mfma_f32_16x16x32_bf16 v[44:47], a[60:63], a[8:11], v[44:47]
  ds_read_b64_tr_b16 a[46:47], v136 offset:49152
  v_mfma_f32_16x16x32_bf16 v[40:43], a[60:63], a[4:7], v[40:43]
  v_mfma_f32_16x16x32_bf16 v[36:39], a[60:63], a[0:3], v[36:39]
  s_waitcnt lgkmcnt(4)
  ds_read_b64_tr_b16 a[48:49], v137 offset:1024
  v_mfma_f32_16x16x32_bf16 v[52:55], a[0:3], a[64:67], v[52:55]
  buffer_load_dwordx4 v217, s[12:15], s50 offen offset:1024 lds
  v_mfma_f32_16x16x32_bf16 v[56:59], a[4:7], a[64:67], v[56:59]
  ds_read_b128 a[20:23], v146 offset:12288
  v_mfma_f32_16x16x32_bf16 v[60:63], a[8:11], a[64:67], v[60:63]
  ds_read_b64_tr_b16 a[50:51], v137 offset:7168
  v_mfma_f32_16x16x32_bf16 v[64:67], a[12:15], a[64:67], v[64:67]
  ds_read_b128 a[24:27], v146 offset:13312
  v_mfma_f32_16x16x32_bf16 v[120:123], a[16:19], a[64:67], v[120:123]
  buffer_load_dwordx4 v218, s[12:15], s50 offen offset:2048 lds
  v_mfma_f32_16x16x32_bf16 v[80:83], a[12:15], a[68:71], v[80:83]
  ds_read_b64_tr_b16 a[52:53], v138 offset:1024
  v_mfma_f32_16x16x32_bf16 v[76:79], a[8:11], a[68:71], v[76:79]
  ds_read_b128 a[28:31], v146 offset:14336
  v_mfma_f32_16x16x32_bf16 v[72:75], a[4:7], a[68:71], v[72:75]
  ds_read_b64_tr_b16 a[54:55], v138 offset:7168
  v_mfma_f32_16x16x32_bf16 v[68:71], a[0:3], a[68:71], v[68:71]
  s_waitcnt lgkmcnt(7)
  ds_read_b128 a[32:35], v146 offset:15360
  v_mfma_f32_16x16x32_bf16 v[84:87], a[40:43], a[0:3], v[84:87]
  buffer_load_dwordx4 v219, s[12:15], s50 offen offset:3072 lds
  s_add_u32 s50, s79, 2
  v_mfma_f32_16x16x32_bf16 v[88:91], a[40:43], a[4:7], v[88:91]
  s_and_b32 s50, s50, 7
  s_lshl_b32 s50, s50, 18
  s_add_u32 m0, s73, 32768
  v_mfma_f32_16x16x32_bf16 v[92:95], a[40:43], a[8:11], v[92:95]
  ds_read_b128 a[36:39], v149 offset:20480
  v_mfma_f32_16x16x32_bf16 v[96:99], a[40:43], a[12:15], v[96:99]
  ds_read_b64_tr_b16 a[56:57], v137 offset:2048
  v_mfma_f32_16x16x32_bf16 v[112:115], a[44:47], a[12:15], v[112:115]
  ds_read_b64_tr_b16 a[58:59], v137 offset:8192
  v_mfma_f32_16x16x32_bf16 v[108:111], a[44:47], a[8:11], v[108:111]
  buffer_load_dwordx4 v216, s[12:15], s50 offen offset:0 lds
  v_mfma_f32_16x16x32_bf16 v[104:107], a[44:47], a[4:7], v[104:107]
  ds_read_b64_tr_b16 a[60:61], v138 offset:2048
  v_mfma_f32_16x16x32_bf16 v[100:103], a[44:47], a[0:3], v[100:103]
  s_waitcnt lgkmcnt(3)
  ds_read_b64_tr_b16 a[62:63], v138 offset:8192
  v_mfma_f32_16x16x32_bf16 v[20:23], a[48:51], a[20:23], v[20:23]
  ds_read_b64_tr_b16 a[64:65], v137 offset:0
  v_mfma_f32_16x16x32_bf16 v[24:27], a[48:51], a[24:27], v[24:27]
  buffer_load_dwordx4 v217, s[12:15], s50 offen offset:1024 lds
  v_mfma_f32_16x16x32_bf16 v[28:31], a[48:51], a[28:31], v[28:31]
  ds_read_b64_tr_b16 a[66:67], v137 offset:6144
  v_mfma_f32_16x16x32_bf16 v[32:35], a[48:51], a[32:35], v[32:35]
  v_mfma_f32_16x16x32_bf16 v[116:119], a[48:51], a[36:39], v[116:119]
  ds_read_b64_tr_b16 a[68:69], v138 offset:0
  v_mfma_f32_16x16x32_bf16 v[48:51], a[52:55], a[32:35], v[48:51]
  buffer_load_dwordx4 v218, s[12:15], s50 offen offset:2048 lds
  v_mfma_f32_16x16x32_bf16 v[44:47], a[52:55], a[28:31], v[44:47]
  ds_read_b64_tr_b16 a[70:71], v138 offset:6144
  v_mfma_f32_16x16x32_bf16 v[40:43], a[52:55], a[24:27], v[40:43]
  v_mfma_f32_16x16x32_bf16 v[36:39], a[52:55], a[20:23], v[36:39]
  s_waitcnt lgkmcnt(4)
  v_mfma_f32_16x16x32_bf16 v[52:55], a[20:23], a[56:59], v[52:55]
  buffer_load_dwordx4 v219, s[12:15], s50 offen offset:3072 lds
  v_cvt_pk_bf16_f32 v116, v116, v117
  v_mfma_f32_16x16x32_bf16 v[56:59], a[24:27], a[56:59], v[56:59]
  v_cvt_pk_bf16_f32 v117, v118, v119
  v_cvt_pk_bf16_f32 v32, v32, v33
  v_mfma_f32_16x16x32_bf16 v[60:63], a[28:31], a[56:59], v[60:63]
  v_cvt_pk_bf16_f32 v33, v34, v35
  v_cvt_pk_bf16_f32 v34, v48, v49
  v_mfma_f32_16x16x32_bf16 v[64:67], a[32:35], a[56:59], v[64:67]
  v_cvt_pk_bf16_f32 v35, v50, v51
  v_mfma_f32_16x16x32_bf16 v[120:123], a[36:39], a[56:59], v[120:123]
  ds_write_b64 v224, v[116:117]
  v_mfma_f32_16x16x32_bf16 v[80:83], a[32:35], a[60:63], v[80:83]
  ds_write_b64 v222, v[32:33]
  v_mfma_f32_16x16x32_bf16 v[76:79], a[28:31], a[60:63], v[76:79]
  ds_write_b64 v223, v[34:35]
  v_cvt_pk_bf16_f32 v55, v54, v55
  v_mfma_f32_16x16x32_bf16 v[72:75], a[24:27], a[60:63], v[72:75]
  v_cvt_pk_bf16_f32 v54, v52, v53
  v_cvt_pk_bf16_f32 v56, v56, v57
  v_mfma_f32_16x16x32_bf16 v[68:71], a[20:23], a[60:63], v[68:71]
  s_waitcnt lgkmcnt(3)
  v_cvt_pk_bf16_f32 v57, v58, v59
  v_cvt_pk_bf16_f32 v58, v60, v61
  v_mfma_f32_16x16x32_bf16 v[84:87], a[64:67], a[20:23], v[84:87]
  v_cvt_pk_bf16_f32 v59, v62, v63
  v_cvt_pk_bf16_f32 v60, v64, v65
  v_mfma_f32_16x16x32_bf16 v[88:91], a[64:67], a[24:27], v[88:91]
  v_cvt_pk_bf16_f32 v61, v66, v67
  v_cvt_pk_bf16_f32 v120, v120, v121
  v_mfma_f32_16x16x32_bf16 v[92:95], a[64:67], a[28:31], v[92:95]
  v_cvt_pk_bf16_f32 v121, v122, v123
  v_mfma_f32_16x16x32_bf16 v[96:99], a[64:67], a[32:35], v[96:99]
  ds_write_b64 v222, v[60:61] offset:1024
  v_mfma_f32_16x16x32_bf16 v[112:115], a[68:71], a[32:35], v[112:115]
  ds_write_b64 v224, v[120:121] offset:1024
  v_cvt_pk_bf16_f32 v71, v70, v71
  v_mfma_f32_16x16x32_bf16 v[108:111], a[68:71], a[28:31], v[108:111]
  v_cvt_pk_bf16_f32 v70, v68, v69
  v_cvt_pk_bf16_f32 v72, v72, v73
  v_mfma_f32_16x16x32_bf16 v[104:107], a[68:71], a[24:27], v[104:107]
  v_cvt_pk_bf16_f32 v73, v74, v75
  v_cvt_pk_bf16_f32 v74, v76, v77
  v_mfma_f32_16x16x32_bf16 v[100:103], a[68:71], a[20:23], v[100:103]
  v_cvt_pk_bf16_f32 v75, v78, v79
  v_cvt_pk_bf16_f32 v76, v80, v81
  v_cvt_pk_bf16_f32 v77, v82, v83
  ds_write_b64 v223, v[76:77] offset:1024
  v_cvt_pk_bf16_f32 v28, v28, v29
  v_cvt_pk_bf16_f32 v29, v30, v31
  v_cvt_pk_bf16_f32 v30, v44, v45
  v_cvt_pk_bf16_f32 v31, v46, v47
  v_cvt_pk_bf16_f32 v24, v24, v25
  v_cvt_pk_bf16_f32 v25, v26, v27
  v_cvt_pk_bf16_f32 v26, v40, v41
  v_cvt_pk_bf16_f32 v27, v42, v43
  v_cvt_pk_bf16_f32 v20, v20, v21
  v_cvt_pk_bf16_f32 v21, v22, v23
  v_cvt_pk_bf16_f32 v22, v36, v37
  v_cvt_pk_bf16_f32 v23, v38, v39
  s_waitcnt lgkmcnt(0)
  s_barrier
  ds_read_b64 v[124:125], v225
  ds_read_b64 v[126:127], v226
  ds_read_b64 v[52:53], v225 offset:1024
  ds_read_b64 v[68:69], v226 offset:1024
  s_cmp_eq_u32 s51, 0
  s_cselect_b64 s[66:67], s[42:43], 0
  s_cselect_b64 s[68:69], s[80:81], 0
  v_cvt_pk_bf16_f32 v96, v96, v97
  v_cvt_pk_bf16_f32 v97, v98, v99
  v_cvt_pk_bf16_f32 v98, v112, v113
  v_cvt_pk_bf16_f32 v99, v114, v115
  v_cvt_pk_bf16_f32 v92, v92, v93
  v_cvt_pk_bf16_f32 v93, v94, v95
  v_cvt_pk_bf16_f32 v94, v108, v109
  s_add_u32 s50, s79, 3
  s_and_b32 s50, s50, 7
  s_lshl_b32 s50, s50, 18
  s_add_u32 m0, s73, 49152
  s_nop 0
  buffer_load_dwordx4 v216, s[12:15], s50 offen offset:0 lds
  v_cvt_pk_bf16_f32 v95, v110, v111
  v_cvt_pk_bf16_f32 v88, v88, v89
  v_cvt_pk_bf16_f32 v89, v90, v91
  v_cvt_pk_bf16_f32 v90, v104, v105
  v_cvt_pk_bf16_f32 v91, v106, v107
  v_cvt_pk_bf16_f32 v84, v84, v85
  v_cvt_pk_bf16_f32 v85, v86, v87
  v_cvt_pk_bf16_f32 v86, v100, v101
  v_cvt_pk_bf16_f32 v87, v102, v103
  v_mov_b32 v12, 0xce6e6b28
  buffer_load_dwordx4 v217, s[12:15], s50 offen offset:1024 lds
  v_mfma_f32_16x16x32_bf16 v[112:115], v[32:35], v[96:99], 0
  v_mfma_f32_16x16x32_bf16 v[48:51], v[28:31], v[96:99], 0
  v_mfma_f32_16x16x32_bf16 v[108:111], v[28:31], v[92:95], 0
  v_mfma_f32_16x16x32_bf16 v[44:47], v[24:27], v[92:95], 0
  v_mfma_f32_16x16x32_bf16 v[104:107], v[24:27], v[88:91], 0
  v_mfma_f32_16x16x32_bf16 v[40:43], v[20:23], v[88:91], 0
  s_waitcnt lgkmcnt(2)
  v_mfma_f32_16x16x32_bf16 v[100:103], v[20:23], v[84:87], 0
  v_mfma_f32_16x16x32_bf16 v[36:39], v[124:127], v[84:87], 0
  s_nop 1
  v_cndmask_b32 v214, v112, v113, s[40:41]
  buffer_load_dwordx4 v218, s[12:15], s50 offen offset:2048 lds
  v_cndmask_b32 v215, v114, v115, s[40:41]
  v_cndmask_b32 v212, v48, v49, s[40:41]
  v_cndmask_b32 v213, v50, v51, s[40:41]
  v_cndmask_b32 v210, v108, v109, s[40:41]
  v_cndmask_b32 v211, v110, v111, s[40:41]
  v_cndmask_b32 v208, v44, v45, s[40:41]
  v_cndmask_b32 v209, v46, v47, s[40:41]
  v_cndmask_b32 v206, v104, v105, s[40:41]
  v_cndmask_b32 v207, v106, v107, s[40:41]
  v_cndmask_b32 v204, v40, v41, s[40:41]
  buffer_load_dwordx4 v219, s[12:15], s50 offen offset:3072 lds
  v_cndmask_b32 v205, v42, v43, s[40:41]
  v_cndmask_b32 v202, v100, v101, s[40:41]
  v_cndmask_b32 v203, v102, v103, s[40:41]
  v_cndmask_b32 v200, v36, v37, s[40:41]
  v_cndmask_b32 v201, v38, v39, s[40:41]
  v_cndmask_b32 v212, v214, v212, s[42:43]
  v_cndmask_b32 v213, v215, v213, s[80:81]
  v_cndmask_b32 v208, v210, v208, s[42:43]
  v_cndmask_b32 v209, v211, v209, s[80:81]
  v_cndmask_b32 v204, v206, v204, s[42:43]
  s_add_u32 s50, s79, 4
  s_and_b32 s50, s50, 7
  s_lshl_b32 s50, s50, 18
  s_add_u32 m0, s73, 65536
  s_nop 0
  buffer_load_dwordx4 v216, s[12:15], s50 offen offset:0 lds
  v_cndmask_b32 v205, v207, v205, s[80:81]
  v_cndmask_b32 v200, v202, v200, s[42:43]
  v_cndmask_b32 v201, v203, v201, s[80:81]
  v_mul_f32 v212, 0x3e8293ee, v212
  v_mul_f32 v213, 0x3e8293ee, v213
  v_mul_f32 v208, 0x3e8293ee, v208
  v_mul_f32 v209, 0x3e8293ee, v209
  v_mul_f32 v204, 0x3e8293ee, v204
  v_mul_f32 v205, 0x3e8293ee, v205
  v_mul_f32 v200, 0x3e8293ee, v200
  buffer_load_dwordx4 v217, s[12:15], s50 offen offset:1024 lds
  v_mul_f32 v201, 0x3e8293ee, v201
  v_cndmask_b32 v200, v200, v12, s[66:67]
  v_cndmask_b32 v201, v201, v12, s[68:69]
  v_max_f32 v214, v212, v213
  v_max_f32 v210, v208, v209
  v_max_f32 v206, v204, v205
  v_max_f32 v202, v200, v201
  v_mov_b32 v215, v214
  v_mov_b32 v211, v210
  v_mov_b32 v207, v206
  buffer_load_dwordx4 v218, s[12:15], s50 offen offset:2048 lds
  v_mov_b32 v203, v202
  v_permlane16_swap_b32 v214, v215
  v_permlane16_swap_b32 v210, v211
  v_permlane16_swap_b32 v206, v207
  v_permlane16_swap_b32 v202, v203
  v_max_f32 v214, v214, v215
  v_max_f32 v210, v210, v211
  v_max_f32 v206, v206, v207
  v_max_f32 v202, v202, v203
  v_mov_b32 v215, v214
  buffer_load_dwordx4 v219, s[12:15], s50 offen offset:3072 lds
  v_mov_b32 v211, v210
  v_mov_b32 v207, v206
  v_mov_b32 v203, v202
  v_permlane32_swap_b32 v214, v215
  v_permlane32_swap_b32 v210, v211
  v_permlane32_swap_b32 v206, v207
  v_permlane32_swap_b32 v202, v203
  v_max_f32 v214, v214, v215
  v_max_f32 v210, v210, v211
  v_max_f32 v206, v206, v207
  v_max_f32 v202, v202, v203
  v_sub_f32 v212, v212, v214
  v_sub_f32 v213, v213, v214
  v_sub_f32 v208, v208, v210
  v_sub_f32 v209, v209, v210
  v_sub_f32 v204, v204, v206
  v_sub_f32 v205, v205, v206
  v_sub_f32 v200, v200, v202
  v_sub_f32 v201, v201, v202
  v_exp_f32 v212, v212
  v_exp_f32 v213, v213
  v_exp_f32 v208, v208
  v_exp_f32 v209, v209
  v_exp_f32 v204, v204
  v_exp_f32 v205, v205
  v_exp_f32 v200, v200
  v_exp_f32 v201, v201
  v_add_f32 v214, v212, v213
  v_add_f32 v210, v208, v209
  v_add_f32 v206, v204, v205
  v_add_f32 v202, v200, v201
  v_mov_b32 v215, v214
  v_mov_b32 v211, v210
  v_mov_b32 v207, v206
  v_mov_b32 v203, v202
  v_permlane16_swap_b32 v214, v215
  v_permlane16_swap_b32 v210, v211
  v_permlane16_swap_b32 v206, v207
  v_permlane16_swap_b32 v202, v203
  v_add_f32 v214, v214, v215
  v_add_f32 v210, v210, v211
  v_add_f32 v206, v206, v207
  v_add_f32 v202, v202, v203
  v_mov_b32 v215, v214
  v_mov_b32 v211, v210
  v_mov_b32 v207, v206
  v_mov_b32 v203, v202
  v_permlane32_swap_b32 v214, v215
  v_permlane32_swap_b32 v210, v211
  v_permlane32_swap_b32 v206, v207
  v_permlane32_swap_b32 v202, v203
  v_add_f32 v214, v214, v215
  v_add_f32 v210, v210, v211
  v_add_f32 v206, v206, v207
  v_add_f32 v202, v202, v203
  v_rcp_f32 v214, v214
  v_rcp_f32 v210, v210
  v_rcp_f32 v206, v206
  v_rcp_f32 v202, v202
  v_mul_f32 v212, v212, v214
  v_mul_f32 v213, v213, v214
  v_mul_f32 v208, v208, v210
  v_mul_f32 v209, v209, v210
  v_mul_f32 v204, v204, v206
  v_mul_f32 v205, v205, v206
  v_mul_f32 v200, v200, v202
  v_mul_f32 v201, v201, v202
  v_cvt_pk_bf16_f32 v212, v212, v212
  v_cvt_pk_bf16_f32 v213, v213, v213
  v_cvt_pk_bf16_f32 v208, v208, v208
  v_cvt_pk_bf16_f32 v209, v209, v209
  v_cvt_pk_bf16_f32 v204, v204, v204
  v_cvt_pk_bf16_f32 v205, v205, v205
  v_cvt_pk_bf16_f32 v200, v200, v200
  v_cvt_pk_bf16_f32 v201, v201, v201
  v_and_b32 v48, v227, v212
  v_and_b32 v49, v228, v213
  v_and_b32 v50, v229, v212
  v_and_b32 v51, v230, v213
  v_and_b32 v44, v227, v208
  v_and_b32 v45, v228, v209
  v_and_b32 v46, v229, v208
  v_and_b32 v47, v230, v209
  v_and_b32 v40, v227, v204
  v_and_b32 v41, v228, v205
  v_and_b32 v42, v229, v204
  v_and_b32 v43, v230, v205
  v_and_b32 v36, v227, v200
  v_and_b32 v37, v228, v201
  v_and_b32 v38, v229, v200
  v_and_b32 v39, v230, v201
  s_waitcnt lgkmcnt(0)
  v_mfma_f32_16x16x32_bf16 v[32:35], v[58:61], v[48:51], 0
  v_mfma_f32_16x16x32_bf16 v[96:99], v[74:77], v[48:51], 0
  v_mfma_f32_16x16x32_bf16 v[28:31], v[56:59], v[44:47], 0
  v_mfma_f32_16x16x32_bf16 v[92:95], v[72:75], v[44:47], 0
  v_mfma_f32_16x16x32_bf16 v[24:27], v[54:57], v[40:43], 0
  v_mfma_f32_16x16x32_bf16 v[88:91], v[70:73], v[40:43], 0
  v_mfma_f32_16x16x32_bf16 v[20:23], v[52:55], v[36:39], 0
  v_mfma_f32_16x16x32_bf16 v[84:87], v[68:71], v[36:39], 0
  s_cmp_eq_u32 s58, 1
  s_cselect_b64 vcc, -1, 0
  v_cvt_pk_bf16_f32 v112, v32, v33
  v_cvt_pk_bf16_f32 v113, v34, v35
  v_cvt_pk_bf16_f32 v114, v96, v97
  v_cvt_pk_bf16_f32 v115, v98, v99
  v_cndmask_b32 v212, v112, v114, vcc
  v_cndmask_b32 v213, v113, v115, vcc
  v_cndmask_b32 v214, v114, v112, vcc
  v_cndmask_b32 v215, v115, v113, vcc
  buffer_store_dwordx4 v[212:215], v0, s[36:39], s75 offen offset:1024 sc1
  v_cvt_pk_bf16_f32 v108, v28, v29
  v_cvt_pk_bf16_f32 v109, v30, v31
  v_cvt_pk_bf16_f32 v110, v92, v93
  v_cvt_pk_bf16_f32 v111, v94, v95
  v_cndmask_b32 v208, v108, v110, vcc
  v_cndmask_b32 v209, v109, v111, vcc
  v_cndmask_b32 v210, v110, v108, vcc
  v_cndmask_b32 v211, v111, v109, vcc
  buffer_store_dwordx4 v[208:211], v0, s[36:39], s75 offen offset:0 sc1
  v_cvt_pk_bf16_f32 v104, v24, v25
  v_cvt_pk_bf16_f32 v105, v26, v27
  v_cvt_pk_bf16_f32 v106, v88, v89
  v_cvt_pk_bf16_f32 v107, v90, v91
  v_cndmask_b32 v204, v104, v106, vcc
  v_cndmask_b32 v205, v105, v107, vcc
  v_cndmask_b32 v206, v106, v104, vcc
  v_cndmask_b32 v207, v107, v105, vcc
  buffer_store_dwordx4 v[204:207], v0, s[36:39], s74 offen offset:1024 sc1
  v_cvt_pk_bf16_f32 v100, v20, v21
  v_cvt_pk_bf16_f32 v101, v22, v23
  v_cvt_pk_bf16_f32 v102, v84, v85
  v_cvt_pk_bf16_f32 v103, v86, v87
  v_cndmask_b32 v200, v100, v102, vcc
  v_cndmask_b32 v201, v101, v103, vcc
  v_cndmask_b32 v202, v102, v100, vcc
  v_cndmask_b32 v203, v103, v101, vcc
  buffer_store_dwordx4 v[200:203], v0, s[36:39], s74 offen offset:0 sc1
  v_mov_b32 v12, 1
  s_waitcnt vmcnt(0) lgkmcnt(0)
  s_barrier
  s_mov_b64 exec, 1
  buffer_store_dword v12, v0, s[36:39], s45 offen sc1
  s_mov_b64 exec, -1
  v_lshlrev_b32 v28, 16, v156
  v_lshrrev_b32 v14, 2, v10
  v_min_u32 v14, (X_k3_main_kernel-G3S)/4096, v14
  v_and_b32 v15, 3, v10
  v_lshlrev_b32 v15, 7, v15
  v_lshl_add_u32 v14, v14, 12, v15
  s_lshl_b32 s94, s44, 10
  s_sub_u32 s94, AL-k3_main_kernel+((G3S-AL+4095)/4096)*4096, s94
  s_add_u32 s94, s92, s94
  s_addc_u32 s95, s93, 0
  global_load_dword a252, v14, s[94:95]
  v_and_b32 v29, 0xffff0000, v156
  v_lshlrev_b32 v30, 16, v157
  v_and_b32 v31, 0xffff0000, v157
  v_mul_f32 v20, v188, v28
  v_mul_f32 v21, v188, v29
  v_mul_f32 v22, v188, v30
  s_add_u32 s50, s79, 5
  s_and_b32 s50, s50, 7
  s_lshl_b32 s50, s50, 18
  s_add_u32 m0, s73, 81920
  s_nop 0
  buffer_load_dwordx4 v216, s[12:15], s50 offen offset:0 lds
  v_mul_f32 v23, v188, v31
  v_lshlrev_b32 v28, 16, v158
  v_and_b32 v29, 0xffff0000, v158
  v_lshlrev_b32 v30, 16, v159
  v_and_b32 v31, 0xffff0000, v159
  v_mul_f32 v24, v188, v28
  buffer_load_dwordx4 v217, s[12:15], s50 offen offset:1024 lds
  v_mul_f32 v25, v188, v29
  v_mul_f32 v26, v188, v30
  v_mul_f32 v27, v188, v31
  v_lshlrev_b32 v28, 16, v160
  v_and_b32 v29, 0xffff0000, v160
  v_lshlrev_b32 v30, 16, v161
Ha1_1:
  s_cbranch_execz Ra
  buffer_load_dwordx4 v218, s[12:15], s50 offen offset:2048 lds
  v_and_b32 v31, 0xffff0000, v161
  v_fmac_f32 v20, v189, v28
  v_fmac_f32 v21, v189, v29
  v_fmac_f32 v22, v189, v30
  v_fmac_f32 v23, v189, v31
  v_lshlrev_b32 v28, 16, v162
  buffer_load_dwordx4 v219, s[12:15], s50 offen offset:3072 lds
  v_and_b32 v29, 0xffff0000, v162
  v_lshlrev_b32 v30, 16, v163
  v_and_b32 v31, 0xffff0000, v163
  v_fmac_f32 v24, v189, v28
  v_fmac_f32 v25, v189, v29
  v_fmac_f32 v26, v189, v30
  s_add_u32 s50, s79, 6
  s_and_b32 s50, s50, 7
  s_lshl_b32 s50, s50, 18
  s_add_u32 m0, s73, 98304
  s_nop 0
  buffer_load_dwordx4 v216, s[12:15], s50 offen offset:0 lds
  v_fmac_f32 v27, v189, v31
  v_lshlrev_b32 v28, 16, v164
  v_and_b32 v29, 0xffff0000, v164
  v_lshlrev_b32 v30, 16, v165
  v_and_b32 v31, 0xffff0000, v165
  v_fmac_f32 v20, v190, v28
  buffer_load_dwordx4 v217, s[12:15], s50 offen offset:1024 lds
  v_fmac_f32 v21, v190, v29
  v_fmac_f32 v22, v190, v30
  v_fmac_f32 v23, v190, v31
  v_lshlrev_b32 v28, 16, v166
  v_and_b32 v29, 0xffff0000, v166
  v_lshlrev_b32 v30, 16, v167
  buffer_load_dwordx4 v218, s[12:15], s50 offen offset:2048 lds
  v_and_b32 v31, 0xffff0000, v167
  v_fmac_f32 v24, v190, v28
  v_fmac_f32 v25, v190, v29
  v_fmac_f32 v26, v190, v30
  v_fmac_f32 v27, v190, v31
  v_lshlrev_b32 v28, 16, v168
  buffer_load_dwordx4 v219, s[12:15], s50 offen offset:3072 lds
  v_and_b32 v29, 0xffff0000, v168
  v_lshlrev_b32 v30, 16, v169
  v_and_b32 v31, 0xffff0000, v169
  v_fmac_f32 v20, v191, v28
  v_fmac_f32 v21, v191, v29
  v_fmac_f32 v22, v191, v30
  s_add_u32 s50, s79, 7
  s_and_b32 s50, s50, 7
  s_lshl_b32 s50, s50, 18
  s_add_u32 m0, s73, 114688
  s_nop 0
  buffer_load_dwordx4 v216, s[12:15], s50 offen offset:0 lds
  v_fmac_f32 v23, v191, v31
  v_lshlrev_b32 v28, 16, v170
  v_and_b32 v29, 0xffff0000, v170
  v_lshlrev_b32 v30, 16, v171
  v_and_b32 v31, 0xffff0000, v171
  v_fmac_f32 v24, v191, v28
  buffer_load_dwordx4 v217, s[12:15], s50 offen offset:1024 lds
  v_fmac_f32 v25, v191, v29
  v_fmac_f32 v26, v191, v30
  v_fmac_f32 v27, v191, v31
  v_lshlrev_b32 v28, 16, v172
  v_and_b32 v29, 0xffff0000, v172
  v_lshlrev_b32 v30, 16, v173
  buffer_load_dwordx4 v218, s[12:15], s50 offen offset:2048 lds
  v_and_b32 v31, 0xffff0000, v173
  v_fmac_f32 v20, v192, v28
  v_fmac_f32 v21, v192, v29
  v_fmac_f32 v22, v192, v30
  v_fmac_f32 v23, v192, v31
  v_lshlrev_b32 v28, 16, v174
  buffer_load_dwordx4 v219, s[12:15], s50 offen offset:3072 lds
  v_and_b32 v29, 0xffff0000, v174
  v_lshlrev_b32 v30, 16, v175
  v_and_b32 v31, 0xffff0000, v175
  v_fmac_f32 v24, v192, v28
  v_fmac_f32 v25, v192, v29
  v_fmac_f32 v26, v192, v30
  s_add_u32 m0, s73, 131072
  s_nop 0
  buffer_load_dwordx4 v220, s[4:7], s72 offen offset:0 lds
  v_fmac_f32 v27, v192, v31
  v_lshlrev_b32 v28, 16, v176
  v_and_b32 v29, 0xffff0000, v176
  v_lshlrev_b32 v30, 16, v177
  v_and_b32 v31, 0xffff0000, v177
  v_fmac_f32 v20, v193, v28
  buffer_load_dwordx4 v221, s[4:7], s72 offen offset:1024 lds
  v_fmac_f32 v21, v193, v29
  v_fmac_f32 v22, v193, v30
  v_fmac_f32 v23, v193, v31
  v_lshlrev_b32 v28, 16, v178
  v_and_b32 v29, 0xffff0000, v178
  v_lshlrev_b32 v30, 16, v179
  s_add_u32 m0, s73, 133120
  s_add_u32 s48, s72, 32768
  buffer_load_dwordx4 v220, s[4:7], s48 offen offset:0 lds
  v_and_b32 v31, 0xffff0000, v179
  v_fmac_f32 v24, v193, v28
  v_fmac_f32 v25, v193, v29
  v_fmac_f32 v26, v193, v30
  v_fmac_f32 v27, v193, v31
  v_lshlrev_b32 v28, 16, v180
  buffer_load_dwordx4 v221, s[4:7], s48 offen offset:1024 lds
  v_and_b32 v29, 0xffff0000, v180
  v_lshlrev_b32 v30, 16, v181
  v_and_b32 v31, 0xffff0000, v181
  v_fmac_f32 v20, v194, v28
  v_fmac_f32 v21, v194, v29
  v_fmac_f32 v22, v194, v30
  v_fmac_f32 v23, v194, v31
  v_lshlrev_b32 v28, 16, v182
  v_and_b32 v29, 0xffff0000, v182
  v_lshlrev_b32 v30, 16, v183
  v_and_b32 v31, 0xffff0000, v183
  v_fmac_f32 v24, v194, v28
  v_fmac_f32 v25, v194, v29
  v_fmac_f32 v26, v194, v30
  v_fmac_f32 v27, v194, v31
  v_lshlrev_b32 v28, 16, v184
  v_and_b32 v29, 0xffff0000, v184
  v_lshlrev_b32 v30, 16, v185
  v_and_b32 v31, 0xffff0000, v185
  v_fmac_f32 v20, v195, v28
  v_fmac_f32 v21, v195, v29
  v_fmac_f32 v22, v195, v30
  v_fmac_f32 v23, v195, v31
  v_lshlrev_b32 v28, 16, v186
  v_and_b32 v29, 0xffff0000, v186
  v_lshlrev_b32 v30, 16, v187
  v_and_b32 v31, 0xffff0000, v187
  v_fmac_f32 v24, v195, v28
  v_fmac_f32 v25, v195, v29
  v_fmac_f32 v26, v195, v30
  v_fmac_f32 v27, v195, v31
  s_nop 0
  v_permlane32_swap_b32 v20, v24
  v_permlane32_swap_b32 v21, v25
  v_permlane32_swap_b32 v22, v26
  v_permlane32_swap_b32 v23, v27
  v_add_f32 v20, v20, v24
  v_add_f32 v21, v21, v25
  v_add_f32 v22, v22, v26
  v_add_f32 v23, v23, v27
  s_nop 0
  v_permlane16_swap_b32 v20, v22
  v_permlane16_swap_b32 v21, v23
  v_add_f32 v20, v20, v22
  v_add_f32 v21, v21, v23
  v_add_u32 v196, 162816, v198
  v_add_f32_dpp v20, v20, v20 row_ror:8 row_mask:0xf bank_mask:0xf
  v_add_f32_dpp v21, v21, v21 row_ror:8 row_mask:0xf bank_mask:0xf
  ds_write_b64 v197, v[20:21]
  s_lshl_b32 s45, s2, 7
  s_add_u32 s45, s45, 5341184
  s_cmp_eq_u32 s44, 0
  s_cselect_b32 s45, s45, 1073741824
  s_waitcnt lgkmcnt(0)
  s_barrier
  ds_read_b32 v200, v196 offset:0
  ds_read_b32 v201, v196 offset:256
  ds_read_b32 v202, v196 offset:512
  ds_read_b32 v203, v196 offset:768
  s_cmp_eq_u32 s44, 1
  s_cselect_b32 s48, s53, 1073741824
  s_waitcnt lgkmcnt(0)
  v_add_f32 v200, v200, v201
  v_add_f32 v202, v202, v203
  v_add_f32 v200, v200, v202
  buffer_store_dword v200, v198, s[36:39], s48 offen sc1
  ds_read_b64_tr_b16 a[80:81], v231 offset:0
  ds_read_b64_tr_b16 a[82:83], v231 offset:2048
  ds_read_b64_tr_b16 a[84:85], v231 offset:4096
  ds_read_b64_tr_b16 a[86:87], v231 offset:6144
  ds_read_b64_tr_b16 a[88:89], v232 offset:0
  ds_read_b64_tr_b16 a[90:91], v232 offset:2048
  ds_read_b64_tr_b16 a[92:93], v232 offset:4096
  ds_read_b64_tr_b16 a[94:95], v232 offset:6144
  ds_read_b64_tr_b16 a[96:97], v233 offset:0
  ds_read_b64_tr_b16 a[98:99], v233 offset:2048
  ds_read_b64_tr_b16 a[100:101], v233 offset:4096
  ds_read_b64_tr_b16 a[102:103], v233 offset:6144
  ds_read_b64_tr_b16 a[104:105], v234 offset:0
  ds_read_b64_tr_b16 a[106:107], v234 offset:2048
  ds_read_b64_tr_b16 a[108:109], v234 offset:4096
  ds_read_b64_tr_b16 a[110:111], v234 offset:6144
  ds_read_b64_tr_b16 a[112:113], v231 offset:8192
  ds_read_b64_tr_b16 a[114:115], v231 offset:10240
  ds_read_b64_tr_b16 a[116:117], v231 offset:12288
  ds_read_b64_tr_b16 a[118:119], v231 offset:14336
  ds_read_b64_tr_b16 a[120:121], v232 offset:8192
  ds_read_b64_tr_b16 a[122:123], v232 offset:10240
  ds_read_b64_tr_b16 a[124:125], v232 offset:12288
  ds_read_b64_tr_b16 a[126:127], v232 offset:14336
  ds_read_b64_tr_b16 a[128:129], v233 offset:8192
  ds_read_b64_tr_b16 a[130:131], v233 offset:10240
  ds_read_b64_tr_b16 a[132:133], v233 offset:12288
  ds_read_b64_tr_b16 a[134:135], v233 offset:14336
  ds_read_b64_tr_b16 a[136:137], v234 offset:8192
  ds_read_b64_tr_b16 a[138:139], v234 offset:10240
  ds_read_b64_tr_b16 a[140:141], v234 offset:12288
  ds_read_b64_tr_b16 a[142:143], v234 offset:14336
  s_cmp_lg_u32 s44, 0
  s_cbranch_scc1 SM2x
  s_mov_b32 s46, 60000
  s_mov_b32 s47, 5275648
SM2:
  buffer_load_dword v13, v249, s[36:39], s47 offen sc1
  s_sub_u32 s46, s46, 1
  s_cmp_eq_u32 s46, 0
  s_waitcnt vmcnt(0)
  s_cbranch_scc1 SM2x
  v_cmp_ne_u32 vcc, 1, v13
  s_nop 4
  s_cbranch_vccnz SM2
SM2x:
  s_waitcnt vmcnt(1)
  s_barrier
  s_lshl_b32 s8, s79, 13
  buffer_load_dwordx4 a[0:3], v243, s[36:39], s8 offen offset:0 sc1
  buffer_load_dwordx4 a[8:11], v243, s[36:39], s8 offen offset:2048 sc1
  buffer_load_dwordx4 a[4:7], v243, s[36:39], s8 offen offset:1024 sc1
  buffer_load_dwordx4 a[12:15], v243, s[36:39], s8 offen offset:3072 sc1
  s_add_u32 s8, s8, 4096
  s_and_b32 s8, s8, 0xffff
  buffer_load_dwordx4 a[16:19], v243, s[36:39], s8 offen offset:0 sc1
  buffer_load_dwordx4 a[20:23], v243, s[36:39], s8 offen offset:1024 sc1
  buffer_load_dwordx4 a[24:27], v243, s[36:39], s8 offen offset:2048 sc1
  buffer_load_dwordx4 a[28:31], v243, s[36:39], s8 offen offset:3072 sc1
  ds_read_b64_tr_b16 a[144:145], v231 offset:16384
  ds_read_b64_tr_b16 a[146:147], v231 offset:18432
  ds_read_b64_tr_b16 a[148:149], v231 offset:20480
  ds_read_b64_tr_b16 a[150:151], v231 offset:22528
  ds_read_b64_tr_b16 a[152:153], v232 offset:16384
  ds_read_b64_tr_b16 a[154:155], v232 offset:18432
  ds_read_b64_tr_b16 a[156:157], v232 offset:20480
  ds_read_b64_tr_b16 a[158:159], v232 offset:22528
  ds_read_b64_tr_b16 a[160:161], v233 offset:16384
  ds_read_b64_tr_b16 a[162:163], v233 offset:18432
  ds_read_b64_tr_b16 a[164:165], v233 offset:20480
  ds_read_b64_tr_b16 a[166:167], v233 offset:22528
  ds_read_b64_tr_b16 a[168:169], v234 offset:16384
  ds_read_b64_tr_b16 a[170:171], v234 offset:18432
  ds_read_b64_tr_b16 a[172:173], v234 offset:20480
  ds_read_b64_tr_b16 a[174:175], v234 offset:22528
  ds_read_b64_tr_b16 a[176:177], v231 offset:24576
  ds_read_b64_tr_b16 a[178:179], v231 offset:26624
  ds_read_b64_tr_b16 a[180:181], v231 offset:28672
  ds_read_b64_tr_b16 a[182:183], v231 offset:30720
  ds_read_b64_tr_b16 a[184:185], v232 offset:24576
  ds_read_b64_tr_b16 a[186:187], v232 offset:26624
  ds_read_b64_tr_b16 a[188:189], v232 offset:28672
  ds_read_b64_tr_b16 a[190:191], v232 offset:30720
  ds_read_b64_tr_b16 a[192:193], v233 offset:24576
  ds_read_b64_tr_b16 a[194:195], v233 offset:26624
  ds_read_b64_tr_b16 a[196:197], v233 offset:28672
  ds_read_b64_tr_b16 a[198:199], v233 offset:30720
  ds_read_b64_tr_b16 a[200:201], v234 offset:24576
  ds_read_b64_tr_b16 a[202:203], v234 offset:26624
  ds_read_b64_tr_b16 a[204:205], v234 offset:28672
  ds_read_b64_tr_b16 a[206:207], v234 offset:30720
  ds_read_b64_tr_b16 a[208:209], v231 offset:32768
  ds_read_b64_tr_b16 a[210:211], v231 offset:34816
  ds_read_b64_tr_b16 a[212:213], v231 offset:36864
  ds_read_b64_tr_b16 a[214:215], v231 offset:38912
  ds_read_b64_tr_b16 a[216:217], v232 offset:32768
  ds_read_b64_tr_b16 a[218:219], v232 offset:34816
  ds_read_b64_tr_b16 a[220:221], v232 offset:36864
  ds_read_b64_tr_b16 a[222:223], v232 offset:38912
  ds_read_b64 v[116:117], v239 offset:0
  ds_read_b64 v[118:119], v240 offset:0
  ds_read_b64 v[120:121], v241 offset:0
  ds_read_b64 v[122:123], v242 offset:0
  ds_read_b64 v[124:125], v239 offset:2048
  ds_read_b64 v[126:127], v240 offset:2048
  ds_read_b64 v[128:129], v241 offset:2048
  ds_read_b64 v[130:131], v242 offset:2048
  v_lshrrev_b32 v13, 4, v10
  v_cmp_eq_u32 vcc, 2, v13
  s_add_u32 s9, s76, 4096
  s_nop 0
  v_cndmask_b32 v13, 0, 1.0, vcc
  s_waitcnt lgkmcnt(0)
  v_lshlrev_b32 v52, 16, v116
  v_and_b32 v53, 0xffff0000, v116
  v_lshlrev_b32 v54, 16, v117
  v_and_b32 v55, 0xffff0000, v117
  v_lshlrev_b32 v56, 16, v118
  v_and_b32 v57, 0xffff0000, v118
  v_lshlrev_b32 v58, 16, v119
  v_and_b32 v59, 0xffff0000, v119
  v_lshlrev_b32 v60, 16, v120
  v_and_b32 v61, 0xffff0000, v120
  v_lshlrev_b32 v62, 16, v121
  v_and_b32 v63, 0xffff0000, v121
  v_lshlrev_b32 v64, 16, v122
  v_and_b32 v65, 0xffff0000, v122
  v_lshlrev_b32 v66, 16, v123
  v_and_b32 v67, 0xffff0000, v123
  v_lshlrev_b32 v68, 16, v124
  v_and_b32 v69, 0xffff0000, v124
  v_lshlrev_b32 v70, 16, v125
  v_and_b32 v71, 0xffff0000, v125
  v_lshlrev_b32 v72, 16, v126
  v_and_b32 v73, 0xffff0000, v126
  v_lshlrev_b32 v74, 16, v127
  v_and_b32 v75, 0xffff0000, v127
  v_lshlrev_b32 v76, 16, v128
  v_and_b32 v77, 0xffff0000, v128
  v_lshlrev_b32 v78, 16, v129
  v_and_b32 v79, 0xffff0000, v129
  v_lshlrev_b32 v80, 16, v130
  v_and_b32 v81, 0xffff0000, v130
  v_lshlrev_b32 v82, 16, v131
  v_and_b32 v83, 0xffff0000, v131
  s_waitcnt vmcnt(7) lgkmcnt(15)
  v_mfma_f32_16x16x32_bf16 v[20:23], a[80:83], a[0:3], 0
  s_waitcnt vmcnt(6)
  s_add_u32 s8, s8, 4096
  s_and_b32 s8, s8, 0xffff
  v_mfma_f32_16x16x32_bf16 v[20:23], a[84:87], a[8:11], v[20:23]
  s_waitcnt vmcnt(4)
  buffer_load_dwordx4 a[32:35], v243, s[36:39], s8 offen offset:0 sc1
  v_mfma_f32_16x16x32_bf16 v[24:27], a[84:87], a[12:15], 0
  s_waitcnt vmcnt(6)
  buffer_load_dwordx4 a[36:39], v243, s[36:39], s8 offen offset:1024 sc1
  v_mfma_f32_16x16x32_bf16 v[24:27], a[80:83], a[4:7], v[24:27]
  s_waitcnt lgkmcnt(15)
  ds_read_b64_tr_b16 a[80:81], v233 offset:32768
  ds_read_b64_tr_b16 a[82:83], v233 offset:34816
  v_mfma_f32_16x16x32_bf16 v[32:35], a[88:91], a[4:7], 0
  ds_read_b64_tr_b16 a[84:85], v233 offset:36864
  ds_read_b64_tr_b16 a[86:87], v233 offset:38912
  v_mfma_f32_16x16x32_bf16 v[32:35], a[92:95], a[12:15], v[32:35]
  buffer_load_dwordx4 a[40:43], v243, s[36:39], s8 offen offset:2048 sc1
  v_mfma_f32_16x16x32_bf16 v[28:31], a[92:95], a[8:11], 0
  buffer_load_dwordx4 a[44:47], v243, s[36:39], s8 offen offset:3072 sc1
  v_mfma_f32_16x16x32_bf16 v[28:31], a[88:91], a[0:3], v[28:31]
  s_waitcnt lgkmcnt(15)
  s_add_u32 s8, s8, 4096
  s_and_b32 s8, s8, 0xffff
  v_mfma_f32_16x16x32_bf16 v[36:39], a[96:99], a[0:3], 0
  ds_read_b64_tr_b16 a[88:89], v234 offset:32768
  ds_read_b64_tr_b16 a[90:91], v234 offset:34816
  v_mfma_f32_16x16x32_bf16 v[36:39], a[100:103], a[8:11], v[36:39]
  ds_read_b64_tr_b16 a[92:93], v234 offset:36864
  buffer_load_dwordx4 a[48:51], v243, s[36:39], s8 offen offset:0 sc1
  v_mfma_f32_16x16x32_bf16 v[40:43], a[100:103], a[12:15], 0
  ds_read_b64_tr_b16 a[94:95], v234 offset:38912
  buffer_load_dwordx4 a[52:55], v243, s[36:39], s8 offen offset:1024 sc1
  v_mfma_f32_16x16x32_bf16 v[40:43], a[96:99], a[4:7], v[40:43]
  s_waitcnt lgkmcnt(15)
  ds_read_b64_tr_b16 a[96:97], v231 offset:40960
  ds_read_b64_tr_b16 a[98:99], v231 offset:43008
  v_mfma_f32_16x16x32_bf16 v[48:51], a[104:107], a[4:7], 0
  s_mov_b32 s49, 0
  buffer_load_dwordx4 a[56:59], v243, s[36:39], s8 offen offset:2048 sc1
  ds_read_b64_tr_b16 a[100:101], v231 offset:45056
  v_mfma_f32_16x16x32_bf16 v[48:51], a[108:111], a[12:15], v[48:51]
  buffer_load_dwordx4 v[156:159], v248, s[36:39], s49 offen sc1
  s_mov_b32 s49, 24576
  v_mfma_f32_16x16x32_bf16 v[44:47], a[108:111], a[8:11], 0
  buffer_load_dwordx4 v[160:163], v248, s[36:39], s49 offen sc1
  s_mov_b32 s49, 49152
  v_mfma_f32_16x16x32_bf16 v[44:47], a[104:107], a[0:3], v[44:47]
  s_waitcnt vmcnt(9) lgkmcnt(15)
  buffer_load_dwordx4 v[164:167], v248, s[36:39], s49 offen sc1
  s_mov_b32 s49, 73728
  v_mfma_f32_16x16x32_bf16 v[20:23], a[112:115], a[16:19], v[20:23]
  buffer_load_dwordx4 v[168:171], v248, s[36:39], s49 offen sc1
  buffer_load_dwordx4 a[60:63], v243, s[36:39], s8 offen offset:3072 sc1
  v_mfma_f32_16x16x32_bf16 v[20:23], a[116:119], a[24:27], v[20:23]
  s_add_u32 s8, s8, 4096
  ds_read_b64_tr_b16 a[102:103], v231 offset:47104
  s_and_b32 s8, s8, 0xffff
  v_mfma_f32_16x16x32_bf16 v[24:27], a[116:119], a[28:31], v[24:27]
  ds_read_b64_tr_b16 a[104:105], v232 offset:40960
  buffer_load_dwordx4 a[64:67], v243, s[36:39], s8 offen offset:0 sc1
  v_mfma_f32_16x16x32_bf16 v[24:27], a[112:115], a[20:23], v[24:27]
  s_waitcnt lgkmcnt(15)
  ds_read_b64_tr_b16 a[106:107], v232 offset:43008
  ds_read_b64_tr_b16 a[108:109], v232 offset:45056
  v_mfma_f32_16x16x32_bf16 v[32:35], a[120:123], a[20:23], v[32:35]
  buffer_load_dwordx4 a[68:71], v243, s[36:39], s8 offen offset:1024 sc1
  ds_read_b64_tr_b16 a[110:111], v232 offset:47104
  v_mfma_f32_16x16x32_bf16 v[32:35], a[124:127], a[28:31], v[32:35]
  buffer_load_dwordx4 a[72:75], v243, s[36:39], s8 offen offset:2048 sc1
  ds_read_b64_tr_b16 a[112:113], v233 offset:40960
  v_mfma_f32_16x16x32_bf16 v[28:31], a[124:127], a[24:27], v[28:31]
  ds_read_b64_tr_b16 a[114:115], v233 offset:43008
  buffer_load_dwordx4 a[76:79], v243, s[36:39], s8 offen offset:3072 sc1
  v_mfma_f32_16x16x32_bf16 v[28:31], a[120:123], a[16:19], v[28:31]
  s_waitcnt lgkmcnt(15)
  s_add_u32 s8, s8, 4096
  s_and_b32 s8, s8, 0xffff
  v_mfma_f32_16x16x32_bf16 v[36:39], a[128:131], a[16:19], v[36:39]
  ds_read_b64_tr_b16 a[116:117], v233 offset:45056
  buffer_load_dwordx4 a[0:3], v243, s[36:39], s8 offen offset:0 sc1
  v_mfma_f32_16x16x32_bf16 v[36:39], a[132:135], a[24:27], v[36:39]
  ds_read_b64_tr_b16 a[118:119], v233 offset:47104
  ds_read_b64_tr_b16 a[120:121], v234 offset:40960
  v_mfma_f32_16x16x32_bf16 v[40:43], a[132:135], a[28:31], v[40:43]
  buffer_load_dwordx4 a[4:7], v243, s[36:39], s8 offen offset:1024 sc1
  ds_read_b64_tr_b16 a[122:123], v234 offset:43008
  v_mfma_f32_16x16x32_bf16 v[40:43], a[128:131], a[20:23], v[40:43]
  s_waitcnt lgkmcnt(15)
  v_mfma_f32_16x16x32_bf16 v[48:51], a[136:139], a[20:23], v[48:51]
  buffer_load_dwordx4 a[8:11], v243, s[36:39], s8 offen offset:2048 sc1
  ds_read_b64_tr_b16 a[124:125], v234 offset:45056
  v_mfma_f32_16x16x32_bf16 v[48:51], a[140:143], a[28:31], v[48:51]
  ds_read_b64_tr_b16 a[126:127], v234 offset:47104
  v_mfma_f32_16x16x32_bf16 v[44:47], a[140:143], a[24:27], v[44:47]
  buffer_load_dwordx4 a[12:15], v243, s[36:39], s8 offen offset:3072 sc1
  ds_read_b64_tr_b16 a[128:129], v231 offset:49152
  v_mfma_f32_16x16x32_bf16 v[44:47], a[136:139], a[16:19], v[44:47]
  s_waitcnt vmcnt(16) lgkmcnt(15)
  v_mfma_f32_16x16x32_bf16 v[20:23], a[144:147], a[32:35], v[20:23]
  s_add_u32 s8, s8, 4096
  s_and_b32 s8, s8, 0xffff
  ds_read_b64_tr_b16 a[130:131], v231 offset:51200
  v_mfma_f32_16x16x32_bf16 v[20:23], a[148:151], a[40:43], v[20:23]
  buffer_load_dwordx4 a[16:19], v243, s[36:39], s8 offen offset:0 sc1
  ds_read_b64_tr_b16 a[132:133], v231 offset:53248
  v_mfma_f32_16x16x32_bf16 v[24:27], a[148:151], a[44:47], v[24:27]
  ds_read_b64_tr_b16 a[134:135], v231 offset:55296
  v_mfma_f32_16x16x32_bf16 v[24:27], a[144:147], a[36:39], v[24:27]
  s_waitcnt lgkmcnt(15)
  ds_read_b64_tr_b16 a[136:137], v232 offset:49152
  v_mfma_f32_16x16x32_bf16 v[32:35], a[152:155], a[36:39], v[32:35]
  v_mfma_f32_16x16x32_bf16 v[32:35], a[156:159], a[44:47], v[32:35]
  buffer_load_dwordx4 a[20:23], v243, s[36:39], s8 offen offset:1024 sc1
  ds_read_b64_tr_b16 a[138:139], v232 offset:51200
  v_mfma_f32_16x16x32_bf16 v[28:31], a[156:159], a[40:43], v[28:31]
  ds_read_b64_tr_b16 a[140:141], v232 offset:53248
  v_mfma_f32_16x16x32_bf16 v[28:31], a[152:155], a[32:35], v[28:31]
  s_waitcnt lgkmcnt(15)
  ds_read_b64_tr_b16 a[142:143], v232 offset:55296
  v_mfma_f32_16x16x32_bf16 v[36:39], a[160:163], a[32:35], v[36:39]
  v_mfma_f32_16x16x32_bf16 v[36:39], a[164:167], a[40:43], v[36:39]
  buffer_load_dwordx4 a[24:27], v243, s[36:39], s8 offen offset:2048 sc1
  ds_read_b64_tr_b16 a[144:145], v233 offset:49152
  v_mfma_f32_16x16x32_bf16 v[40:43], a[164:167], a[44:47], v[40:43]
  ds_read_b64_tr_b16 a[146:147], v233 offset:51200
  v_mfma_f32_16x16x32_bf16 v[40:43], a[160:163], a[36:39], v[40:43]
  s_waitcnt lgkmcnt(15)
  ds_read_b64_tr_b16 a[148:149], v233 offset:53248
  v_mfma_f32_16x16x32_bf16 v[48:51], a[168:171], a[36:39], v[48:51]
  ds_read_b64_tr_b16 a[150:151], v233 offset:55296
  v_mfma_f32_16x16x32_bf16 v[48:51], a[172:175], a[44:47], v[48:51]
  buffer_load_dwordx4 a[28:31], v243, s[36:39], s8 offen offset:3072 sc1
  v_mfma_f32_16x16x32_bf16 v[44:47], a[172:175], a[40:43], v[44:47]
  ds_read_b64_tr_b16 a[152:153], v234 offset:49152
  v_mfma_f32_16x16x32_bf16 v[44:47], a[168:171], a[32:35], v[44:47]
  s_waitcnt vmcnt(12) lgkmcnt(15)
  ds_read_b64_tr_b16 a[154:155], v234 offset:51200
  v_mfma_f32_16x16x32_bf16 v[20:23], a[176:179], a[48:51], v[20:23]
  s_add_u32 s8, s8, 4096
  s_and_b32 s8, s8, 0xffff
  ds_read_b64_tr_b16 a[156:157], v234 offset:53248
  v_mfma_f32_16x16x32_bf16 v[20:23], a[180:183], a[56:59], v[20:23]
  buffer_load_dwordx4 a[32:35], v243, s[36:39], s8 offen offset:0 sc1
  v_mfma_f32_16x16x32_bf16 v[24:27], a[180:183], a[60:63], v[24:27]
  ds_read_b64_tr_b16 a[158:159], v234 offset:55296
  v_mfma_f32_16x16x32_bf16 v[24:27], a[176:179], a[52:55], v[24:27]
  s_waitcnt lgkmcnt(15)
  ds_read_b64_tr_b16 a[160:161], v231 offset:57344
  v_mfma_f32_16x16x32_bf16 v[32:35], a[184:187], a[52:55], v[32:35]
  ds_read_b64_tr_b16 a[162:163], v231 offset:59392
  v_mfma_f32_16x16x32_bf16 v[32:35], a[188:191], a[60:63], v[32:35]
  buffer_load_dwordx4 a[36:39], v243, s[36:39], s8 offen offset:1024 sc1
  ds_read_b64_tr_b16 a[164:165], v231 offset:61440
  v_mfma_f32_16x16x32_bf16 v[28:31], a[188:191], a[56:59], v[28:31]
  v_mfma_f32_16x16x32_bf16 v[28:31], a[184:187], a[48:51], v[28:31]
  s_waitcnt lgkmcnt(15)
  ds_read_b64_tr_b16 a[166:167], v231 offset:63488
  v_mfma_f32_16x16x32_bf16 v[36:39], a[192:195], a[48:51], v[36:39]
  ds_read_b64_tr_b16 a[168:169], v232 offset:57344
  v_mfma_f32_16x16x32_bf16 v[36:39], a[196:199], a[56:59], v[36:39]
  buffer_load_dwordx4 a[40:43], v243, s[36:39], s8 offen offset:2048 sc1
  ds_read_b64_tr_b16 a[170:171], v232 offset:59392
  v_mfma_f32_16x16x32_bf16 v[40:43], a[196:199], a[60:63], v[40:43]
  v_mfma_f32_16x16x32_bf16 v[40:43], a[192:195], a[52:55], v[40:43]
  s_waitcnt lgkmcnt(15)
  ds_read_b64_tr_b16 a[172:173], v232 offset:61440
  v_mfma_f32_16x16x32_bf16 v[48:51], a[200:203], a[52:55], v[48:51]
  ds_read_b64_tr_b16 a[174:175], v232 offset:63488
  v_mfma_f32_16x16x32_bf16 v[48:51], a[204:207], a[60:63], v[48:51]
  buffer_load_dwordx4 a[44:47], v243, s[36:39], s8 offen offset:3072 sc1
  ds_read_b64_tr_b16 a[176:177], v233 offset:57344
  v_mfma_f32_16x16x32_bf16 v[44:47], a[204:207], a[56:59], v[44:47]
  ds_read_b64_tr_b16 a[178:179], v233 offset:59392
  v_mfma_f32_16x16x32_bf16 v[44:47], a[200:203], a[48:51], v[44:47]
  s_waitcnt vmcnt(12) lgkmcnt(15)
  v_mfma_f32_16x16x32_bf16 v[20:23], a[208:211], a[64:67], v[20:23]
  s_add_u32 s8, s8, 4096
  s_and_b32 s8, s8, 0xffff
  ds_read_b64_tr_b16 a[180:181], v233 offset:61440
  v_mfma_f32_16x16x32_bf16 v[20:23], a[212:215], a[72:75], v[20:23]
  buffer_load_dwordx4 a[48:51], v243, s[36:39], s8 offen offset:0 sc1
  ds_read_b64_tr_b16 a[182:183], v233 offset:63488
  v_mfma_f32_16x16x32_bf16 v[24:27], a[212:215], a[76:79], v[24:27]
  ds_read_b64_tr_b16 a[184:185], v234 offset:57344
  v_mfma_f32_16x16x32_bf16 v[24:27], a[208:211], a[68:71], v[24:27]
  s_waitcnt lgkmcnt(15)
  ds_read_b64_tr_b16 a[186:187], v234 offset:59392
  v_mfma_f32_16x16x32_bf16 v[32:35], a[216:219], a[68:71], v[32:35]
  v_mfma_f32_16x16x32_bf16 v[32:35], a[220:223], a[76:79], v[32:35]
  buffer_load_dwordx4 a[52:55], v243, s[36:39], s8 offen offset:1024 sc1
  ds_read_b64_tr_b16 a[188:189], v234 offset:61440
  v_mfma_f32_16x16x32_bf16 v[28:31], a[220:223], a[72:75], v[28:31]
  ds_read_b64_tr_b16 a[190:191], v234 offset:63488
  v_mfma_f32_16x16x32_bf16 v[28:31], a[216:219], a[64:67], v[28:31]
  s_waitcnt lgkmcnt(15)
  ds_read_b64_tr_b16 a[192:193], v235 offset:0
  v_mfma_f32_16x16x32_bf16 v[36:39], a[80:83], a[64:67], v[36:39]
  v_mfma_f32_16x16x32_bf16 v[36:39], a[84:87], a[72:75], v[36:39]
  buffer_load_dwordx4 a[56:59], v243, s[36:39], s8 offen offset:2048 sc1
  ds_read_b64_tr_b16 a[194:195], v235 offset:2048
  v_mfma_f32_16x16x32_bf16 v[40:43], a[84:87], a[76:79], v[40:43]
  ds_read_b64_tr_b16 a[196:197], v235 offset:4096
  v_mfma_f32_16x16x32_bf16 v[40:43], a[80:83], a[68:71], v[40:43]
  s_waitcnt lgkmcnt(15)
  ds_read_b64_tr_b16 a[198:199], v235 offset:6144
  v_mfma_f32_16x16x32_bf16 v[48:51], a[88:91], a[68:71], v[48:51]
  ds_read_b64_tr_b16 a[200:201], v236 offset:0
  v_mfma_f32_16x16x32_bf16 v[48:51], a[92:95], a[76:79], v[48:51]
  buffer_load_dwordx4 a[60:63], v243, s[36:39], s8 offen offset:3072 sc1
  v_mfma_f32_16x16x32_bf16 v[44:47], a[92:95], a[72:75], v[44:47]
  ds_read_b64_tr_b16 a[202:203], v236 offset:2048
  v_mfma_f32_16x16x32_bf16 v[44:47], a[88:91], a[64:67], v[44:47]
  s_waitcnt vmcnt(12) lgkmcnt(15)
  ds_read_b64_tr_b16 a[204:205], v236 offset:4096
  v_mfma_f32_16x16x32_bf16 v[20:23], a[96:99], a[0:3], v[20:23]
  s_add_u32 s8, s8, 4096
  s_and_b32 s8, s8, 0xffff
  ds_read_b64_tr_b16 a[206:207], v236 offset:6144
  v_mfma_f32_16x16x32_bf16 v[20:23], a[100:103], a[8:11], v[20:23]
  buffer_load_dwordx4 a[64:67], v243, s[36:39], s8 offen offset:0 sc1
  v_mfma_f32_16x16x32_bf16 v[24:27], a[100:103], a[12:15], v[24:27]
  ds_read_b64_tr_b16 a[208:209], v237 offset:0
  v_mfma_f32_16x16x32_bf16 v[24:27], a[96:99], a[4:7], v[24:27]
  s_waitcnt lgkmcnt(15)
  ds_read_b64_tr_b16 a[210:211], v237 offset:2048
  v_mfma_f32_16x16x32_bf16 v[32:35], a[104:107], a[4:7], v[32:35]
  ds_read_b64_tr_b16 a[212:213], v237 offset:4096
  v_mfma_f32_16x16x32_bf16 v[32:35], a[108:111], a[12:15], v[32:35]
  buffer_load_dwordx4 a[68:71], v243, s[36:39], s8 offen offset:1024 sc1
  ds_read_b64_tr_b16 a[214:215], v237 offset:6144
  v_mfma_f32_16x16x32_bf16 v[28:31], a[108:111], a[8:11], v[28:31]
  v_mfma_f32_16x16x32_bf16 v[28:31], a[104:107], a[0:3], v[28:31]
  s_waitcnt lgkmcnt(15)
  ds_read_b64_tr_b16 a[216:217], v238 offset:0
  v_mfma_f32_16x16x32_bf16 v[36:39], a[112:115], a[0:3], v[36:39]
  s_waitcnt vmcnt(23)
  ds_read_b64_tr_b16 a[218:219], v238 offset:2048
  v_max_u32 v15, v156, v157
  v_mfma_f32_16x16x32_bf16 v[36:39], a[116:119], a[8:11], v[36:39]
  buffer_load_dwordx4 a[72:75], v243, s[36:39], s8 offen offset:2048 sc1
  ds_read_b64_tr_b16 a[220:221], v238 offset:4096
  v_mfma_f32_16x16x32_bf16 v[40:43], a[116:119], a[12:15], v[40:43]
  v_max3_u32 v15, v15, v158, v159
  v_max3_u32 v15, v15, v160, v161
  v_mfma_f32_16x16x32_bf16 v[40:43], a[112:115], a[4:7], v[40:43]
  s_waitcnt lgkmcnt(15)
  ds_read_b64_tr_b16 a[222:223], v238 offset:6144
  v_max3_u32 v15, v15, v162, v163
  v_mfma_f32_16x16x32_bf16 v[48:51], a[120:123], a[4:7], v[48:51]
  ds_read_b64_tr_b16 a[80:81], v235 offset:8192
  v_max3_u32 v15, v15, v164, v165
  v_mfma_f32_16x16x32_bf16 v[48:51], a[124:127], a[12:15], v[48:51]
  buffer_load_dwordx4 a[76:79], v243, s[36:39], s8 offen offset:3072 sc1
  ds_read_b64_tr_b16 a[82:83], v235 offset:10240
  v_mfma_f32_16x16x32_bf16 v[44:47], a[124:127], a[8:11], v[44:47]
  ds_read_b64_tr_b16 a[84:85], v235 offset:12288
  v_max3_u32 v15, v15, v166, v167
  v_mfma_f32_16x16x32_bf16 v[44:47], a[120:123], a[0:3], v[44:47]
  s_waitcnt vmcnt(12) lgkmcnt(15)
  v_max3_u32 v15, v15, v168, v169
  v_max3_u32 v15, v15, v170, v171
  v_mfma_f32_16x16x32_bf16 v[20:23], a[128:131], a[16:19], v[20:23]
  s_add_u32 s8, s8, 4096
  s_and_b32 s8, s8, 0xffff
  ds_read_b64_tr_b16 a[86:87], v235 offset:14336
  v_mfma_f32_16x16x32_bf16 v[20:23], a[132:135], a[24:27], v[20:23]
  buffer_load_dwordx4 a[0:3], v243, s[36:39], s8 offen offset:0 sc1
  ds_read_b64_tr_b16 a[88:89], v236 offset:8192
  v_mfma_f32_16x16x32_bf16 v[24:27], a[132:135], a[28:31], v[24:27]
  ds_read_b64_tr_b16 a[90:91], v236 offset:10240
  v_mfma_f32_16x16x32_bf16 v[24:27], a[128:131], a[20:23], v[24:27]
  s_waitcnt lgkmcnt(15)
  v_cmp_eq_u32 vcc, -1, v15
  s_nop 4
  s_cbranch_vccnz CK3s
CK3x:
  v_mfma_f32_16x16x32_bf16 v[32:35], a[136:139], a[20:23], v[32:35]
  ds_read_b64_tr_b16 a[92:93], v236 offset:12288
  v_add_f32 v156, v156, v164
  v_mfma_f32_16x16x32_bf16 v[32:35], a[140:143], a[28:31], v[32:35]
  buffer_load_dwordx4 a[4:7], v243, s[36:39], s8 offen offset:1024 sc1
  ds_read_b64_tr_b16 a[94:95], v236 offset:14336
  v_mfma_f32_16x16x32_bf16 v[28:31], a[140:143], a[24:27], v[28:31]
Ha2_1:
  s_cbranch_execz Ra
  ds_read_b64_tr_b16 a[96:97], v237 offset:8192
  v_add_f32 v157, v157, v165
  v_mfma_f32_16x16x32_bf16 v[28:31], a[136:139], a[16:19], v[28:31]
  s_waitcnt lgkmcnt(15)
  ds_read_b64_tr_b16 a[98:99], v237 offset:10240
  v_add_f32 v158, v158, v166
  v_mfma_f32_16x16x32_bf16 v[36:39], a[144:147], a[16:19], v[36:39]
  v_add_f32 v159, v159, v167
  v_add_f32 v160, v160, v168
  v_mfma_f32_16x16x32_bf16 v[36:39], a[148:151], a[24:27], v[36:39]
  buffer_load_dwordx4 a[8:11], v243, s[36:39], s8 offen offset:2048 sc1
  ds_read_b64_tr_b16 a[100:101], v237 offset:12288
  v_mfma_f32_16x16x32_bf16 v[40:43], a[148:151], a[28:31], v[40:43]
  ds_read_b64_tr_b16 a[102:103], v237 offset:14336
  v_add_f32 v161, v161, v169
  v_mfma_f32_16x16x32_bf16 v[40:43], a[144:147], a[20:23], v[40:43]
  s_waitcnt lgkmcnt(15)
  ds_read_b64_tr_b16 a[104:105], v238 offset:8192
  v_add_f32 v162, v162, v170
  v_mfma_f32_16x16x32_bf16 v[48:51], a[152:155], a[20:23], v[48:51]
  v_add_f32 v163, v163, v171
  v_add_f32 v156, v156, v160
  v_mfma_f32_16x16x32_bf16 v[48:51], a[156:159], a[28:31], v[48:51]
  buffer_load_dwordx4 a[12:15], v243, s[36:39], s8 offen offset:3072 sc1
  ds_read_b64_tr_b16 a[106:107], v238 offset:10240
  v_mfma_f32_16x16x32_bf16 v[44:47], a[156:159], a[24:27], v[44:47]
  ds_read_b64_tr_b16 a[108:109], v238 offset:12288
  v_add_f32 v157, v157, v161
  v_mfma_f32_16x16x32_bf16 v[44:47], a[152:155], a[16:19], v[44:47]
  s_waitcnt vmcnt(12) lgkmcnt(15)
  ds_read_b64_tr_b16 a[110:111], v238 offset:14336
  v_add_f32 v158, v158, v162
  v_mfma_f32_16x16x32_bf16 v[20:23], a[160:163], a[32:35], v[20:23]
  s_add_u32 s8, s8, 4096
  s_and_b32 s8, s8, 0xffff
  ds_read_b64_tr_b16 a[112:113], v235 offset:16384
  v_mfma_f32_16x16x32_bf16 v[20:23], a[164:167], a[40:43], v[20:23]
  buffer_load_dwordx4 a[16:19], v243, s[36:39], s8 offen offset:0 sc1
  v_add_f32 v159, v159, v163
  v_mfma_f32_16x16x32_bf16 v[24:27], a[164:167], a[44:47], v[24:27]
  ds_read_b64_tr_b16 a[114:115], v235 offset:18432
  v_cvt_pk_bf16_f32 v160, v156, v157
  v_mfma_f32_16x16x32_bf16 v[24:27], a[160:163], a[36:39], v[24:27]
  s_waitcnt lgkmcnt(15)
  ds_read_b64_tr_b16 a[116:117], v235 offset:20480
  v_lshlrev_b32 v156, 16, v160
  v_mfma_f32_16x16x32_bf16 v[32:35], a[168:171], a[36:39], v[32:35]
  ds_read_b64_tr_b16 a[118:119], v235 offset:22528
  v_and_b32 v157, 0xffff0000, v160
  v_mfma_f32_16x16x32_bf16 v[32:35], a[172:175], a[44:47], v[32:35]
  buffer_load_dwordx4 a[20:23], v243, s[36:39], s8 offen offset:1024 sc1
  v_cvt_pk_bf16_f32 v161, v158, v159
  v_mfma_f32_16x16x32_bf16 v[28:31], a[172:175], a[40:43], v[28:31]
  ds_read_b64_tr_b16 a[120:121], v236 offset:16384
  v_lshlrev_b32 v158, 16, v161
  v_mfma_f32_16x16x32_bf16 v[28:31], a[168:171], a[32:35], v[28:31]
  s_waitcnt lgkmcnt(15)
  ds_read_b64_tr_b16 a[122:123], v236 offset:18432
  v_and_b32 v159, 0xffff0000, v161
  v_mfma_f32_16x16x32_bf16 v[36:39], a[176:179], a[32:35], v[36:39]
  ds_read_b64_tr_b16 a[124:125], v236 offset:20480
  v_add_f32 v156, v13, v156
  v_mfma_f32_16x16x32_bf16 v[36:39], a[180:183], a[40:43], v[36:39]
  buffer_load_dwordx4 a[24:27], v243, s[36:39], s8 offen offset:2048 sc1
  ds_read_b64_tr_b16 a[126:127], v236 offset:22528
  v_mfma_f32_16x16x32_bf16 v[40:43], a[180:183], a[44:47], v[40:43]
  v_add_f32 v157, v13, v157
  v_add_f32 v158, v13, v158
  v_mfma_f32_16x16x32_bf16 v[40:43], a[176:179], a[36:39], v[40:43]
  s_waitcnt lgkmcnt(15)
  ds_read_b64_tr_b16 a[128:129], v237 offset:16384
  v_add_f32 v159, v13, v159
  v_mfma_f32_16x16x32_bf16 v[48:51], a[184:187], a[36:39], v[48:51]
  ds_read_b64_tr_b16 a[130:131], v237 offset:18432
  v_cvt_pk_bf16_f32 v160, v156, v157
  v_mfma_f32_16x16x32_bf16 v[48:51], a[188:191], a[44:47], v[48:51]
  buffer_load_dwordx4 a[28:31], v243, s[36:39], s8 offen offset:3072 sc1
  ds_read_b64_tr_b16 a[132:133], v237 offset:20480
  v_mfma_f32_16x16x32_bf16 v[44:47], a[188:191], a[40:43], v[44:47]
  ds_read_b64_tr_b16 a[134:135], v237 offset:22528
  v_lshlrev_b32 v156, 16, v160
  v_mfma_f32_16x16x32_bf16 v[44:47], a[184:187], a[32:35], v[44:47]
  s_waitcnt vmcnt(12) lgkmcnt(15)
  v_and_b32 v157, 0xffff0000, v160
  v_cvt_pk_bf16_f32 v161, v158, v159
  v_mfma_f32_16x16x32_bf16 v[20:23], a[192:195], a[48:51], v[20:23]
  s_add_u32 s8, s8, 4096
  s_and_b32 s8, s8, 0xffff
  ds_read_b64_tr_b16 a[136:137], v238 offset:16384
  v_mfma_f32_16x16x32_bf16 v[20:23], a[196:199], a[56:59], v[20:23]
  buffer_load_dwordx4 a[32:35], v243, s[36:39], s8 offen offset:0 sc1
  ds_read_b64_tr_b16 a[138:139], v238 offset:18432
  v_mfma_f32_16x16x32_bf16 v[24:27], a[196:199], a[60:63], v[24:27]
  ds_read_b64_tr_b16 a[140:141], v238 offset:20480
  v_lshlrev_b32 v158, 16, v161
  v_mfma_f32_16x16x32_bf16 v[24:27], a[192:195], a[52:55], v[24:27]
  s_waitcnt lgkmcnt(15)
  v_and_b32 v159, 0xffff0000, v161
  v_mfma_f32_16x16x32_bf16 v[32:35], a[200:203], a[52:55], v[32:35]
  ds_write_b128 v246, v[156:159]
  ds_read_b128 v[84:87], v244 offset:0
  v_mfma_f32_16x16x32_bf16 v[32:35], a[204:207], a[60:63], v[32:35]
  ds_read_b128 v[100:103], v244 offset:512
  ds_read_b128 v[88:91], v244 offset:64
  v_mfma_f32_16x16x32_bf16 v[28:31], a[204:207], a[56:59], v[28:31]
  ds_read_b128 v[104:107], v244 offset:576
  ds_read_b128 v[92:95], v244 offset:128
  v_mfma_f32_16x16x32_bf16 v[28:31], a[200:203], a[48:51], v[28:31]
  s_waitcnt lgkmcnt(15)
  ds_read_b128 v[108:111], v244 offset:640
  ds_read_b128 v[96:99], v244 offset:192
  v_mfma_f32_16x16x32_bf16 v[36:39], a[208:211], a[48:51], v[36:39]
  ds_read_b128 v[112:115], v244 offset:704
  ds_read_b128 v[116:119], v245 offset:512
  v_mfma_f32_16x16x32_bf16 v[36:39], a[212:215], a[56:59], v[36:39]
  ds_read_b128 v[120:123], v245 offset:576
  ds_read_b128 v[124:127], v245 offset:640
  v_mfma_f32_16x16x32_bf16 v[40:43], a[212:215], a[60:63], v[40:43]
  ds_read_b128 v[128:131], v245 offset:704
  ds_read_b64_tr_b16 a[142:143], v238 offset:22528
  v_mfma_f32_16x16x32_bf16 v[40:43], a[208:211], a[52:55], v[40:43]
  s_waitcnt lgkmcnt(15)
  buffer_load_dwordx4 a[36:39], v243, s[36:39], s8 offen offset:1024 sc1
  ds_read_b64_tr_b16 a[144:145], v235 offset:24576
  v_mfma_f32_16x16x32_bf16 v[48:51], a[216:219], a[52:55], v[48:51]
  ds_read_b64_tr_b16 a[146:147], v235 offset:26624
  ds_read_b64_tr_b16 a[148:149], v235 offset:28672
  v_mfma_f32_16x16x32_bf16 v[48:51], a[220:223], a[60:63], v[48:51]
  buffer_load_dwordx4 a[40:43], v243, s[36:39], s8 offen offset:2048 sc1
  ds_read_b64_tr_b16 a[150:151], v235 offset:30720
  v_mfma_f32_16x16x32_bf16 v[44:47], a[220:223], a[56:59], v[44:47]
  ds_read_b64_tr_b16 a[152:153], v236 offset:24576
  ds_read_b64_tr_b16 a[154:155], v236 offset:26624
  v_mfma_f32_16x16x32_bf16 v[44:47], a[216:219], a[48:51], v[44:47]
  s_waitcnt vmcnt(11) lgkmcnt(15)
  buffer_load_dwordx4 a[44:47], v243, s[36:39], s8 offen offset:3072 sc1
  ds_read_b64_tr_b16 a[156:157], v236 offset:28672
  v_mfma_f32_16x16x32_bf16 v[20:23], a[80:83], a[64:67], v[20:23]
  s_add_u32 s8, s8, 4096
  ds_read_b64_tr_b16 a[158:159], v236 offset:30720
  ds_read_b64_tr_b16 a[160:161], v237 offset:24576
  v_mfma_f32_16x16x32_bf16 v[20:23], a[84:87], a[72:75], v[20:23]
  s_and_b32 s8, s8, 0xffff
  ds_read_b64_tr_b16 a[162:163], v237 offset:26624
  buffer_load_dwordx4 a[48:51], v243, s[36:39], s8 offen offset:0 sc1
  v_mfma_f32_16x16x32_bf16 v[24:27], a[84:87], a[76:79], v[24:27]
  ds_read_b64_tr_b16 a[164:165], v237 offset:28672
  v_accvgpr_write_b32 a248, v156
  v_mfma_f32_16x16x32_bf16 v[24:27], a[80:83], a[68:71], v[24:27]
  s_waitcnt lgkmcnt(15)
  ds_read_b64_tr_b16 a[166:167], v237 offset:30720
  v_accvgpr_write_b32 a249, v157
  v_mfma_f32_16x16x32_bf16 v[32:35], a[88:91], a[68:71], v[32:35]
  ds_read_b64_tr_b16 a[168:169], v238 offset:24576
  v_accvgpr_write_b32 a250, v158
  v_mfma_f32_16x16x32_bf16 v[32:35], a[92:95], a[76:79], v[32:35]
  buffer_load_dwordx4 a[52:55], v243, s[36:39], s8 offen offset:1024 sc1
  v_accvgpr_write_b32 a251, v159
  v_mfma_f32_16x16x32_bf16 v[28:31], a[92:95], a[72:75], v[28:31]
  s_waitcnt lgkmcnt(14)
  ds_read_b64_tr_b16 a[170:171], v238 offset:26624
  v_cvt_pk_bf16_f32 v148, v116, v117
  v_mfma_f32_16x16x32_bf16 v[28:31], a[88:91], a[64:67], v[28:31]
  s_waitcnt lgkmcnt(15)
  ds_read_b64_tr_b16 a[172:173], v238 offset:28672
  v_cvt_pk_bf16_f32 v149, v118, v119
  v_mfma_f32_16x16x32_bf16 v[36:39], a[96:99], a[64:67], v[36:39]
  ds_read_b64_tr_b16 a[174:175], v238 offset:30720
  v_cvt_pk_bf16_f32 v150, v120, v121
  v_mfma_f32_16x16x32_bf16 v[36:39], a[100:103], a[72:75], v[36:39]
  buffer_load_dwordx4 a[56:59], v243, s[36:39], s8 offen offset:2048 sc1
  ds_read_b64_tr_b16 a[176:177], v235 offset:32768
  v_mfma_f32_16x16x32_bf16 v[40:43], a[100:103], a[76:79], v[40:43]
  v_cvt_pk_bf16_f32 v151, v122, v123
  v_cvt_pk_bf16_f32 v152, v124, v125
  v_mfma_f32_16x16x32_bf16 v[40:43], a[96:99], a[68:71], v[40:43]
  s_waitcnt lgkmcnt(15)
  ds_read_b64_tr_b16 a[178:179], v235 offset:34816
  v_cvt_pk_bf16_f32 v153, v126, v127
  v_mfma_f32_16x16x32_bf16 v[48:51], a[104:107], a[68:71], v[48:51]
  ds_read_b64_tr_b16 a[180:181], v235 offset:36864
  v_cvt_pk_bf16_f32 v154, v128, v129
  v_mfma_f32_16x16x32_bf16 v[48:51], a[108:111], a[76:79], v[48:51]
  buffer_load_dwordx4 a[60:63], v243, s[36:39], s8 offen offset:3072 sc1
  ds_read_b64_tr_b16 a[182:183], v235 offset:38912
  v_mfma_f32_16x16x32_bf16 v[44:47], a[108:111], a[72:75], v[44:47]
  v_cvt_pk_bf16_f32 v155, v130, v131
  v_mfma_f32_16x16x32_bf16 v[44:47], a[104:107], a[64:67], v[44:47]
  s_waitcnt vmcnt(12) lgkmcnt(15)
  buffer_store_dwordx4 v[148:151], v0, s[36:39], s78 offen offset:0 sc1
  buffer_store_dwordx4 v[152:155], v0, s[36:39], s78 offen offset:1024 sc1
  v_mfma_f32_16x16x32_bf16 v[20:23], a[112:115], a[0:3], v[20:23]
  s_add_u32 s8, s8, 4096
  ds_read_b64_tr_b16 a[184:185], v236 offset:32768
  s_and_b32 s8, s8, 0xffff
  v_mfma_f32_16x16x32_bf16 v[20:23], a[116:119], a[8:11], v[20:23]
  ds_read_b64_tr_b16 a[186:187], v236 offset:34816
  buffer_load_dwordx4 a[64:67], v243, s[36:39], s8 offen offset:0 sc1
  v_mfma_f32_16x16x32_bf16 v[24:27], a[116:119], a[12:15], v[24:27]
  ds_read_b64_tr_b16 a[188:189], v236 offset:36864
  ds_read_b64_tr_b16 a[190:191], v236 offset:38912
  v_mfma_f32_16x16x32_bf16 v[24:27], a[112:115], a[4:7], v[24:27]
  s_waitcnt lgkmcnt(15)
  v_mfma_f32_16x16x32_bf16 v[32:35], a[120:123], a[4:7], v[32:35]
  ds_read_b64_tr_b16 a[192:193], v237 offset:32768
  v_mfma_f32_16x16x32_bf16 v[32:35], a[124:127], a[12:15], v[32:35]
  buffer_load_dwordx4 a[68:71], v243, s[36:39], s8 offen offset:1024 sc1
  ds_read_b64_tr_b16 a[194:195], v237 offset:34816
  v_mfma_f32_16x16x32_bf16 v[28:31], a[124:127], a[8:11], v[28:31]
  ds_read_b64_tr_b16 a[196:197], v237 offset:36864
  v_mfma_f32_16x16x32_bf16 v[28:31], a[120:123], a[0:3], v[28:31]
  s_waitcnt lgkmcnt(15)
  v_mfma_f32_16x16x32_bf16 v[36:39], a[128:131], a[0:3], v[36:39]
  ds_read_b64_tr_b16 a[198:199], v237 offset:38912
  v_mfma_f32_16x16x32_bf16 v[36:39], a[132:135], a[8:11], v[36:39]
  buffer_load_dwordx4 a[72:75], v243, s[36:39], s8 offen offset:2048 sc1
  ds_read_b64_tr_b16 a[200:201], v238 offset:32768
  v_mfma_f32_16x16x32_bf16 v[40:43], a[132:135], a[12:15], v[40:43]
  ds_read_b64_tr_b16 a[202:203], v238 offset:34816
  v_mfma_f32_16x16x32_bf16 v[40:43], a[128:131], a[4:7], v[40:43]
  s_waitcnt lgkmcnt(15)
  ds_read_b64_tr_b16 a[204:205], v238 offset:36864
  v_mfma_f32_16x16x32_bf16 v[48:51], a[136:139], a[4:7], v[48:51]
  v_mfma_f32_16x16x32_bf16 v[48:51], a[140:143], a[12:15], v[48:51]
  buffer_load_dwordx4 a[76:79], v243, s[36:39], s8 offen offset:3072 sc1
  ds_read_b64_tr_b16 a[206:207], v238 offset:38912
  v_mfma_f32_16x16x32_bf16 v[44:47], a[140:143], a[8:11], v[44:47]
  ds_read_b64_tr_b16 a[208:209], v235 offset:40960
  v_mfma_f32_16x16x32_bf16 v[44:47], a[136:139], a[0:3], v[44:47]
  s_waitcnt vmcnt(14) lgkmcnt(15)
  ds_read_b64_tr_b16 a[210:211], v235 offset:43008
  v_mfma_f32_16x16x32_bf16 v[20:23], a[144:147], a[16:19], v[20:23]
  s_add_u32 s8, s8, 4096
  s_and_b32 s8, s8, 0xffff
  v_mfma_f32_16x16x32_bf16 v[20:23], a[148:151], a[24:27], v[20:23]
  buffer_load_dwordx4 a[0:3], v243, s[36:39], s8 offen offset:0 sc1
  ds_read_b64_tr_b16 a[212:213], v235 offset:45056
  v_mfma_f32_16x16x32_bf16 v[24:27], a[148:151], a[28:31], v[24:27]
  ds_read_b64_tr_b16 a[214:215], v235 offset:47104
  v_mfma_f32_16x16x32_bf16 v[24:27], a[144:147], a[20:23], v[24:27]
  s_waitcnt lgkmcnt(15)
  ds_read_b64_tr_b16 a[216:217], v236 offset:40960
  v_mfma_f32_16x16x32_bf16 v[32:35], a[152:155], a[20:23], v[32:35]
  ds_read_b64_tr_b16 a[218:219], v236 offset:43008
  v_mfma_f32_16x16x32_bf16 v[32:35], a[156:159], a[28:31], v[32:35]
  buffer_load_dwordx4 a[4:7], v243, s[36:39], s8 offen offset:1024 sc1
  v_mfma_f32_16x16x32_bf16 v[28:31], a[156:159], a[24:27], v[28:31]
  ds_read_b64_tr_b16 a[220:221], v236 offset:45056
  v_mfma_f32_16x16x32_bf16 v[28:31], a[152:155], a[16:19], v[28:31]
  s_waitcnt lgkmcnt(15)
  ds_read_b64_tr_b16 a[222:223], v236 offset:47104
  v_mfma_f32_16x16x32_bf16 v[36:39], a[160:163], a[16:19], v[36:39]
  ds_read_b64_tr_b16 a[80:81], v237 offset:40960
  v_mfma_f32_16x16x32_bf16 v[36:39], a[164:167], a[24:27], v[36:39]
  buffer_load_dwordx4 a[8:11], v243, s[36:39], s8 offen offset:2048 sc1
  ds_read_b64_tr_b16 a[82:83], v237 offset:43008
  v_mfma_f32_16x16x32_bf16 v[40:43], a[164:167], a[28:31], v[40:43]
  v_mfma_f32_16x16x32_bf16 v[40:43], a[160:163], a[20:23], v[40:43]
  s_waitcnt lgkmcnt(15)
  ds_read_b64_tr_b16 a[84:85], v237 offset:45056
  v_mfma_f32_16x16x32_bf16 v[48:51], a[168:171], a[20:23], v[48:51]
  ds_read_b64_tr_b16 a[86:87], v237 offset:47104
  v_mfma_f32_16x16x32_bf16 v[48:51], a[172:175], a[28:31], v[48:51]
  buffer_load_dwordx4 a[12:15], v243, s[36:39], s8 offen offset:3072 sc1
  ds_read_b64_tr_b16 a[88:89], v238 offset:40960
  v_mfma_f32_16x16x32_bf16 v[44:47], a[172:175], a[24:27], v[44:47]
  v_mfma_f32_16x16x32_bf16 v[44:47], a[168:171], a[16:19], v[44:47]
  s_waitcnt vmcnt(14) lgkmcnt(15)
  ds_read_b64_tr_b16 a[90:91], v238 offset:43008
  v_mfma_f32_16x16x32_bf16 v[20:23], a[176:179], a[32:35], v[20:23]
  ds_read_b64_tr_b16 a[92:93], v238 offset:45056
  v_mfma_f32_16x16x32_bf16 v[20:23], a[180:183], a[40:43], v[20:23]
  ds_read_b64_tr_b16 a[94:95], v238 offset:47104
  v_mfma_f32_16x16x32_bf16 v[24:27], a[180:183], a[44:47], v[24:27]
  ds_read_b64_tr_b16 a[96:97], v235 offset:49152
  v_mfma_f32_16x16x32_bf16 v[24:27], a[176:179], a[36:39], v[24:27]
  s_waitcnt lgkmcnt(15)
  v_mfma_f32_16x16x32_bf16 v[32:35], a[184:187], a[36:39], v[32:35]
  ds_read_b64_tr_b16 a[98:99], v235 offset:51200
  v_mfma_f32_16x16x32_bf16 v[32:35], a[188:191], a[44:47], v[32:35]
  ds_read_b64_tr_b16 a[100:101], v235 offset:53248
  v_mfma_f32_16x16x32_bf16 v[28:31], a[188:191], a[40:43], v[28:31]
  ds_read_b64_tr_b16 a[102:103], v235 offset:55296
  v_mfma_f32_16x16x32_bf16 v[28:31], a[184:187], a[32:35], v[28:31]
  s_waitcnt lgkmcnt(15)
  v_mfma_f32_16x16x32_bf16 v[36:39], a[192:195], a[32:35], v[36:39]
  ds_read_b64_tr_b16 a[104:105], v236 offset:49152
  v_mfma_f32_16x16x32_bf16 v[36:39], a[196:199], a[40:43], v[36:39]
  ds_read_b64_tr_b16 a[106:107], v236 offset:51200
  v_mfma_f32_16x16x32_bf16 v[40:43], a[196:199], a[44:47], v[40:43]
  ds_read_b64_tr_b16 a[108:109], v236 offset:53248
  v_mfma_f32_16x16x32_bf16 v[40:43], a[192:195], a[36:39], v[40:43]
  s_waitcnt lgkmcnt(15)
  ds_read_b64_tr_b16 a[110:111], v236 offset:55296
  v_mfma_f32_16x16x32_bf16 v[48:51], a[200:203], a[36:39], v[48:51]
  v_mfma_f32_16x16x32_bf16 v[48:51], a[204:207], a[44:47], v[48:51]
  ds_read_b64_tr_b16 a[112:113], v237 offset:49152
  v_mfma_f32_16x16x32_bf16 v[44:47], a[204:207], a[40:43], v[44:47]
  ds_read_b64_tr_b16 a[114:115], v237 offset:51200
  v_mfma_f32_16x16x32_bf16 v[44:47], a[200:203], a[32:35], v[44:47]
  s_waitcnt vmcnt(10) lgkmcnt(15)
  ds_read_b64_tr_b16 a[116:117], v237 offset:53248
  v_mfma_f32_16x16x32_bf16 v[20:23], a[208:211], a[48:51], v[20:23]
  v_mfma_f32_16x16x32_bf16 v[20:23], a[212:215], a[56:59], v[20:23]
  ds_read_b64_tr_b16 a[118:119], v237 offset:55296
  v_mfma_f32_16x16x32_bf16 v[24:27], a[212:215], a[60:63], v[24:27]
  ds_read_b64_tr_b16 a[120:121], v238 offset:49152
  v_mfma_f32_16x16x32_bf16 v[24:27], a[208:211], a[52:55], v[24:27]
  s_waitcnt lgkmcnt(15)
  ds_read_b64_tr_b16 a[122:123], v238 offset:51200
  v_mfma_f32_16x16x32_bf16 v[32:35], a[216:219], a[52:55], v[32:35]
  ds_read_b64_tr_b16 a[124:125], v238 offset:53248
  v_mfma_f32_16x16x32_bf16 v[32:35], a[220:223], a[60:63], v[32:35]
  v_mfma_f32_16x16x32_bf16 v[28:31], a[220:223], a[56:59], v[28:31]
  ds_read_b64_tr_b16 a[126:127], v238 offset:55296
  v_mfma_f32_16x16x32_bf16 v[28:31], a[216:219], a[48:51], v[28:31]
  s_waitcnt lgkmcnt(15)
  ds_read_b64_tr_b16 a[128:129], v235 offset:57344
  v_mfma_f32_16x16x32_bf16 v[36:39], a[80:83], a[48:51], v[36:39]
  ds_read_b64_tr_b16 a[130:131], v235 offset:59392
  v_mfma_f32_16x16x32_bf16 v[36:39], a[84:87], a[56:59], v[36:39]
  v_mfma_f32_16x16x32_bf16 v[40:43], a[84:87], a[60:63], v[40:43]
  ds_read_b64_tr_b16 a[132:133], v235 offset:61440
  v_mfma_f32_16x16x32_bf16 v[40:43], a[80:83], a[52:55], v[40:43]
  s_waitcnt lgkmcnt(15)
  ds_read_b64_tr_b16 a[134:135], v235 offset:63488
  v_mfma_f32_16x16x32_bf16 v[48:51], a[88:91], a[52:55], v[48:51]
  ds_read_b64_tr_b16 a[136:137], v236 offset:57344
  v_mfma_f32_16x16x32_bf16 v[48:51], a[92:95], a[60:63], v[48:51]
  ds_read_b64_tr_b16 a[138:139], v236 offset:59392
  v_mfma_f32_16x16x32_bf16 v[44:47], a[92:95], a[56:59], v[44:47]
  v_mfma_f32_16x16x32_bf16 v[44:47], a[88:91], a[48:51], v[44:47]
  s_waitcnt vmcnt(4) lgkmcnt(15)
  ds_read_b64_tr_b16 a[140:141], v236 offset:61440
  v_mfma_f32_16x16x32_bf16 v[20:23], a[96:99], a[64:67], v[20:23]
  ds_read_b64_tr_b16 a[142:143], v236 offset:63488
  v_mfma_f32_16x16x32_bf16 v[20:23], a[100:103], a[72:75], v[20:23]
  ds_read_b64_tr_b16 a[144:145], v237 offset:57344
  v_mfma_f32_16x16x32_bf16 v[24:27], a[100:103], a[76:79], v[24:27]
  v_mfma_f32_16x16x32_bf16 v[24:27], a[96:99], a[68:71], v[24:27]
  s_waitcnt lgkmcnt(15)
  ds_read_b64_tr_b16 a[146:147], v237 offset:59392
  v_mfma_f32_16x16x32_bf16 v[32:35], a[104:107], a[68:71], v[32:35]
  ds_read_b64_tr_b16 a[148:149], v237 offset:61440
  v_mfma_f32_16x16x32_bf16 v[32:35], a[108:111], a[76:79], v[32:35]
  ds_read_b64_tr_b16 a[150:151], v237 offset:63488
  v_mfma_f32_16x16x32_bf16 v[28:31], a[108:111], a[72:75], v[28:31]
  ds_read_b64_tr_b16 a[152:153], v238 offset:57344
  v_mfma_f32_16x16x32_bf16 v[28:31], a[104:107], a[64:67], v[28:31]
  s_waitcnt lgkmcnt(15)
  v_mfma_f32_16x16x32_bf16 v[36:39], a[112:115], a[64:67], v[36:39]
  ds_read_b64_tr_b16 a[154:155], v238 offset:59392
  v_mfma_f32_16x16x32_bf16 v[36:39], a[116:119], a[72:75], v[36:39]
  ds_read_b64_tr_b16 a[156:157], v238 offset:61440
  v_mfma_f32_16x16x32_bf16 v[40:43], a[116:119], a[76:79], v[40:43]
  ds_read_b64_tr_b16 a[158:159], v238 offset:63488
  v_mfma_f32_16x16x32_bf16 v[40:43], a[112:115], a[68:71], v[40:43]
  s_waitcnt lgkmcnt(15)
  v_mfma_f32_16x16x32_bf16 v[48:51], a[120:123], a[68:71], v[48:51]
  v_mfma_f32_16x16x32_bf16 v[48:51], a[124:127], a[76:79], v[48:51]
  v_mfma_f32_16x16x32_bf16 v[44:47], a[124:127], a[72:75], v[44:47]
  v_mfma_f32_16x16x32_bf16 v[44:47], a[120:123], a[64:67], v[44:47]
  s_waitcnt vmcnt(0) lgkmcnt(12)
  v_mfma_f32_16x16x32_bf16 v[20:23], a[128:131], a[0:3], v[20:23]
  v_mfma_f32_16x16x32_bf16 v[20:23], a[132:135], a[8:11], v[20:23]
  v_mfma_f32_16x16x32_bf16 v[24:27], a[132:135], a[12:15], v[24:27]
  v_mfma_f32_16x16x32_bf16 v[24:27], a[128:131], a[4:7], v[24:27]
  s_waitcnt lgkmcnt(8)
  v_mfma_f32_16x16x32_bf16 v[32:35], a[136:139], a[4:7], v[32:35]
  v_mfma_f32_16x16x32_bf16 v[32:35], a[140:143], a[12:15], v[32:35]
  v_mfma_f32_16x16x32_bf16 v[28:31], a[140:143], a[8:11], v[28:31]
  v_mfma_f32_16x16x32_bf16 v[28:31], a[136:139], a[0:3], v[28:31]
  s_waitcnt lgkmcnt(4)
  v_mfma_f32_16x16x32_bf16 v[36:39], a[144:147], a[0:3], v[36:39]
  v_mfma_f32_16x16x32_bf16 v[36:39], a[148:151], a[8:11], v[36:39]
  v_mfma_f32_16x16x32_bf16 v[40:43], a[148:151], a[12:15], v[40:43]
  v_mfma_f32_16x16x32_bf16 v[40:43], a[144:147], a[4:7], v[40:43]
  s_waitcnt lgkmcnt(0)
  v_mfma_f32_16x16x32_bf16 v[48:51], a[152:155], a[4:7], v[48:51]
  v_mfma_f32_16x16x32_bf16 v[48:51], a[156:159], a[12:15], v[48:51]
  v_mfma_f32_16x16x32_bf16 v[44:47], a[156:159], a[8:11], v[44:47]
  v_mfma_f32_16x16x32_bf16 v[44:47], a[152:155], a[0:3], v[44:47]
  s_waitcnt lgkmcnt(0)
  s_nop 2
  v_fmac_f32 v52, v84, v20
  v_fmac_f32 v53, v85, v21
  v_fmac_f32 v54, v86, v22
  v_fmac_f32 v55, v87, v23
  v_mul_f32 v20, v52, v100
  v_mul_f32 v21, v53, v101
  v_mul_f32 v22, v54, v102
  v_mul_f32 v23, v55, v103
  v_cvt_pk_bf16_f32 v132, v20, v21
  v_cvt_pk_bf16_f32 v133, v22, v23
  v_fmac_f32 v56, v88, v28
  v_fmac_f32 v57, v89, v29
  v_fmac_f32 v58, v90, v30
  v_fmac_f32 v59, v91, v31
  v_mul_f32 v28, v56, v104
  v_mul_f32 v29, v57, v105
  v_mul_f32 v30, v58, v106
  v_mul_f32 v31, v59, v107
  v_cvt_pk_bf16_f32 v134, v28, v29
  v_cvt_pk_bf16_f32 v135, v30, v31
  buffer_store_dwordx4 v[132:135], v0, s[36:39], s76 offen offset:0 sc1
  v_fmac_f32 v60, v92, v36
  v_fmac_f32 v61, v93, v37
  v_fmac_f32 v62, v94, v38
  v_fmac_f32 v63, v95, v39
  v_mul_f32 v36, v60, v108
  v_mul_f32 v37, v61, v109
  v_mul_f32 v38, v62, v110
  v_mul_f32 v39, v63, v111
  v_cvt_pk_bf16_f32 v136, v36, v37
  v_cvt_pk_bf16_f32 v137, v38, v39
  v_fmac_f32 v64, v96, v44
  v_fmac_f32 v65, v97, v45
  v_fmac_f32 v66, v98, v46
  v_fmac_f32 v67, v99, v47
  v_mul_f32 v44, v64, v112
  v_mul_f32 v45, v65, v113
  v_mul_f32 v46, v66, v114
  v_mul_f32 v47, v67, v115
  v_cvt_pk_bf16_f32 v138, v44, v45
  v_cvt_pk_bf16_f32 v139, v46, v47
  buffer_store_dwordx4 v[136:139], v0, s[36:39], s9 offen offset:0 sc1
  v_fmac_f32 v68, v84, v24
  v_fmac_f32 v69, v85, v25
  v_fmac_f32 v70, v86, v26
  v_fmac_f32 v71, v87, v27
  v_mul_f32 v24, v68, v100
  v_mul_f32 v25, v69, v101
  v_mul_f32 v26, v70, v102
  v_mul_f32 v27, v71, v103
  v_cvt_pk_bf16_f32 v140, v24, v25
  v_cvt_pk_bf16_f32 v141, v26, v27
  v_fmac_f32 v72, v88, v32
  v_fmac_f32 v73, v89, v33
  v_fmac_f32 v74, v90, v34
  v_fmac_f32 v75, v91, v35
  v_mul_f32 v32, v72, v104
  v_mul_f32 v33, v73, v105
  v_mul_f32 v34, v74, v106
  v_mul_f32 v35, v75, v107
  v_cvt_pk_bf16_f32 v142, v32, v33
  v_cvt_pk_bf16_f32 v143, v34, v35
  buffer_store_dwordx4 v[140:143], v0, s[36:39], s76 offen offset:1024 sc1
  v_fmac_f32 v76, v92, v40
  v_fmac_f32 v77, v93, v41
  v_fmac_f32 v78, v94, v42
  v_fmac_f32 v79, v95, v43
  v_mul_f32 v40, v76, v108
  v_mul_f32 v41, v77, v109
  v_mul_f32 v42, v78, v110
  v_mul_f32 v43, v79, v111
  v_cvt_pk_bf16_f32 v144, v40, v41
  v_cvt_pk_bf16_f32 v145, v42, v43
  v_fmac_f32 v80, v96, v48
  v_fmac_f32 v81, v97, v49
  v_fmac_f32 v82, v98, v50
  v_fmac_f32 v83, v99, v51
  v_mul_f32 v48, v80, v112
  v_mul_f32 v49, v81, v113
  v_mul_f32 v50, v82, v114
  v_mul_f32 v51, v83, v115
  v_cvt_pk_bf16_f32 v146, v48, v49
  v_cvt_pk_bf16_f32 v147, v50, v51
  buffer_store_dwordx4 v[144:147], v0, s[36:39], s9 offen offset:1024 sc1
  v_add_f32 v20, v52, v53
  v_mul_f32 v21, v52, v52
  v_add_f32 v24, v54, v55
  v_mul_f32 v25, v53, v53
  v_fmac_f32 v21, v54, v54
  v_fmac_f32 v25, v55, v55
  v_fmac_f32 v21, v56, v56
  v_add_f32 v20, v20, v56
  v_fmac_f32 v25, v57, v57
  v_add_f32 v24, v24, v57
  v_fmac_f32 v21, v58, v58
  v_add_f32 v20, v20, v58
  v_fmac_f32 v25, v59, v59
  v_add_f32 v24, v24, v59
  v_fmac_f32 v21, v60, v60
  v_add_f32 v20, v20, v60
  v_fmac_f32 v25, v61, v61
  v_add_f32 v24, v24, v61
  v_fmac_f32 v21, v62, v62
  v_add_f32 v20, v20, v62
  v_fmac_f32 v25, v63, v63
  v_add_f32 v24, v24, v63
  v_fmac_f32 v21, v64, v64
  v_add_f32 v20, v20, v64
  v_fmac_f32 v25, v65, v65
  v_add_f32 v24, v24, v65
  v_fmac_f32 v21, v66, v66
  v_add_f32 v20, v20, v66
  v_fmac_f32 v25, v67, v67
  v_add_f32 v24, v24, v67
  v_add_f32 v22, v68, v69
  v_mul_f32 v23, v68, v68
  v_add_f32 v26, v70, v71
  v_mul_f32 v27, v69, v69
  v_fmac_f32 v23, v70, v70
  v_fmac_f32 v27, v71, v71
  v_fmac_f32 v23, v72, v72
  v_add_f32 v22, v22, v72
  v_fmac_f32 v27, v73, v73
  v_add_f32 v26, v26, v73
  v_fmac_f32 v23, v74, v74
  v_add_f32 v22, v22, v74
  v_fmac_f32 v27, v75, v75
  v_add_f32 v26, v26, v75
  v_fmac_f32 v23, v76, v76
  v_add_f32 v22, v22, v76
  v_fmac_f32 v27, v77, v77
  v_add_f32 v26, v26, v77
  v_fmac_f32 v23, v78, v78
  v_add_f32 v22, v22, v78
  v_fmac_f32 v27, v79, v79
  v_add_f32 v26, v26, v79
  v_fmac_f32 v23, v80, v80
  v_add_f32 v22, v22, v80
  v_fmac_f32 v27, v81, v81
  v_add_f32 v26, v26, v81
  v_fmac_f32 v23, v82, v82
  v_add_f32 v22, v22, v82
  v_fmac_f32 v27, v83, v83
  v_add_f32 v26, v26, v83
  v_add_f32 v20, v20, v24
  v_add_f32 v21, v21, v25
  v_add_f32 v22, v22, v26
  v_add_f32 v23, v23, v27
  v_mov_b32 v24, v20
  v_mov_b32 v25, v21
  v_mov_b32 v26, v22
  v_mov_b32 v27, v23
  v_permlane16_swap_b32 v20, v24
  v_permlane16_swap_b32 v21, v25
  v_permlane16_swap_b32 v22, v26
  v_permlane16_swap_b32 v23, v27
  v_add_f32 v20, v20, v24
  v_add_f32 v21, v21, v25
  v_add_f32 v22, v22, v26
  v_add_f32 v23, v23, v27
  v_mov_b32 v24, v20
  v_mov_b32 v25, v21
  v_mov_b32 v26, v22
  v_mov_b32 v27, v23
  v_permlane32_swap_b32 v20, v24
  v_permlane32_swap_b32 v21, v25
  v_permlane32_swap_b32 v22, v26
  v_permlane32_swap_b32 v23, v27
  v_add_f32 v20, v20, v24
  v_add_f32 v21, v21, v25
  v_add_f32 v22, v22, v26
  v_add_f32 v23, v23, v27
  s_mov_b64 exec, 0xffff
  buffer_store_dwordx4 v[20:23], v0, s[36:39], s77 offen sc1
  s_mov_b64 exec, -1
  v_cvt_pk_bf16_f32 v116, v52, v53
  v_cvt_pk_bf16_f32 v117, v54, v55
  v_cvt_pk_bf16_f32 v118, v56, v57
  v_cvt_pk_bf16_f32 v119, v58, v59
  v_cvt_pk_bf16_f32 v120, v60, v61
  v_cvt_pk_bf16_f32 v121, v62, v63
  v_cvt_pk_bf16_f32 v122, v64, v65
  v_cvt_pk_bf16_f32 v123, v66, v67
  v_cvt_pk_bf16_f32 v124, v68, v69
  v_cvt_pk_bf16_f32 v125, v70, v71
  v_cvt_pk_bf16_f32 v126, v72, v73
  v_cvt_pk_bf16_f32 v127, v74, v75
  v_cvt_pk_bf16_f32 v128, v76, v77
  v_cvt_pk_bf16_f32 v129, v78, v79
  v_cvt_pk_bf16_f32 v130, v80, v81
  v_cvt_pk_bf16_f32 v131, v82, v83
  v_accvgpr_write_b32 a232, v116
  v_accvgpr_write_b32 a233, v117
  v_accvgpr_write_b32 a234, v118
  v_accvgpr_write_b32 a235, v119
  v_accvgpr_write_b32 a236, v120
  v_accvgpr_write_b32 a237, v121
  v_accvgpr_write_b32 a238, v122
  v_accvgpr_write_b32 a239, v123
  v_accvgpr_write_b32 a240, v124
  v_accvgpr_write_b32 a241, v125
  v_accvgpr_write_b32 a242, v126
  v_accvgpr_write_b32 a243, v127
  v_accvgpr_write_b32 a244, v128
  v_accvgpr_write_b32 a245, v129
  v_accvgpr_write_b32 a246, v130
  v_accvgpr_write_b32 a247, v131
  v_mov_b32 v12, 1
  s_waitcnt vmcnt(0) lgkmcnt(0)
  s_barrier
  s_mov_b64 exec, 1
  buffer_store_dword v12, v0, s[36:39], s45 offen sc1
  s_mov_b64 exec, -1
  s_bfe_u32 s10, s82, 0x40000
  s_mul_i32 s10, s10, 458752
  s_add_u32 m0, s84, 0
  s_nop 0
  buffer_load_dwordx4 v3, s[16:19], s10 offen offset:0 lds
  buffer_load_dwordx4 v4, s[16:19], s10 offen offset:1024 lds
  buffer_load_dwordx4 v5, s[16:19], s10 offen offset:2048 lds
  buffer_load_dwordx4 v6, s[16:19], s10 offen offset:3072 lds
  s_add_u32 m0, s84, 4096
  s_nop 0
  buffer_load_dwordx4 v7, s[16:19], s10 offen offset:0 lds
  buffer_load_dwordx4 v8, s[16:19], s10 offen offset:1024 lds
  buffer_load_dwordx4 v9, s[16:19], s10 offen offset:2048 lds
  s_bfe_u32 s10, s82, 0x40004
  s_mul_i32 s10, s10, 458752
  s_add_u32 m0, s84, 28672
  s_nop 0
  buffer_load_dwordx4 v3, s[16:19], s10 offen offset:0 lds
  buffer_load_dwordx4 v4, s[16:19], s10 offen offset:1024 lds
  buffer_load_dwordx4 v5, s[16:19], s10 offen offset:2048 lds
  buffer_load_dwordx4 v6, s[16:19], s10 offen offset:3072 lds
  s_add_u32 m0, s84, 32768
  s_nop 0
  buffer_load_dwordx4 v7, s[16:19], s10 offen offset:0 lds
  buffer_load_dwordx4 v8, s[16:19], s10 offen offset:1024 lds
  buffer_load_dwordx4 v9, s[16:19], s10 offen offset:2048 lds
  s_bfe_u32 s11, s82, 0x40000
  s_lshl_b32 s11, s11, 13
  s_add_u32 s11, s11, s85
  s_mov_b64 exec, 0
  s_cmp_eq_u32 s44, 1
  s_cbranch_scc1 Hb0
  s_cmp_eq_u32 s44, 2
Ha0_2:
  s_cbranch_execz Ra
  s_cbranch_scc1 Hb1
  s_cmp_eq_u32 s44, 3
  s_cbranch_scc1 Hb2
Rb:
  s_mov_b64 exec, -1
G3S:
  s_cmp_lg_u32 s44, 0
  s_cbranch_scc1 SM4x
  s_mov_b32 s46, 60000
  s_mov_b32 s47, 5341184
SM4:
  buffer_load_dword v13, v250, s[36:39], s47 offen sc1
  s_sub_u32 s46, s46, 1
  s_cmp_eq_u32 s46, 0
  s_waitcnt vmcnt(0)
  s_cbranch_scc1 SM4x
  v_cmp_ne_u32 vcc, 1, v13
  s_nop 4
  s_cbranch_vccnz SM4
SM4x:
  s_waitcnt vmcnt(7)
  s_barrier
  buffer_load_dwordx4 a[0:3], v0, s[36:39], s11 offen offset:0 sc1
  buffer_load_dwordx4 a[4:7], v0, s[36:39], s11 offen offset:1024 sc1
  buffer_load_dwordx4 a[8:11], v0, s[36:39], s11 offen offset:2048 sc1
  buffer_load_dwordx4 a[12:15], v0, s[36:39], s11 offen offset:3072 sc1
  s_add_u32 s11, s11, 4096
  buffer_load_dwordx4 a[16:19], v0, s[36:39], s11 offen offset:0 sc1
  buffer_load_dwordx4 a[20:23], v0, s[36:39], s11 offen offset:1024 sc1
  buffer_load_dwordx4 a[24:27], v0, s[36:39], s11 offen offset:2048 sc1
  buffer_load_dwordx4 a[28:31], v0, s[36:39], s11 offen offset:3072 sc1
  ds_read_b64_tr_b16 a[128:129], v1 offset:0
  ds_read_b64_tr_b16 a[130:131], v1 offset:3584
  ds_read_b64_tr_b16 a[132:133], v1 offset:7168
  ds_read_b64_tr_b16 a[134:135], v1 offset:10752
  ds_read_b64_tr_b16 a[136:137], v1 offset:32
  ds_read_b64_tr_b16 a[138:139], v1 offset:3616
  ds_read_b64_tr_b16 a[140:141], v1 offset:7200
  ds_read_b64_tr_b16 a[142:143], v1 offset:10784
  ds_read_b64_tr_b16 a[144:145], v1 offset:64
  ds_read_b64_tr_b16 a[146:147], v1 offset:3648
  ds_read_b64_tr_b16 a[148:149], v1 offset:7232
  ds_read_b64_tr_b16 a[150:151], v1 offset:10816
  ds_read_b64_tr_b16 a[152:153], v1 offset:96
  ds_read_b64_tr_b16 a[154:155], v1 offset:3680
  ds_read_b64_tr_b16 a[156:157], v1 offset:7264
  ds_read_b64_tr_b16 a[158:159], v1 offset:10848
  s_waitcnt vmcnt(7) lgkmcnt(8)
  v_mfma_f32_16x16x32_bf16 v[32:35], a[128:131], a[0:3], 0
  s_waitcnt vmcnt(3)
  s_bfe_u32 s11, s82, 0x40004
  s_lshl_b32 s11, s11, 13
  v_mfma_f32_16x16x32_bf16 v[32:35], a[132:135], a[16:19], v[32:35]
  s_waitcnt vmcnt(2)
  s_add_u32 s11, s11, s85
  buffer_load_dwordx4 a[32:35], v0, s[36:39], s11 offen offset:0 sc1
  v_mfma_f32_16x16x32_bf16 v[36:39], a[132:135], a[20:23], 0
  s_waitcnt vmcnt(7)
  ds_read_b64_tr_b16 a[160:161], v1 offset:128
  v_mfma_f32_16x16x32_bf16 v[36:39], a[128:131], a[4:7], v[36:39]
  s_waitcnt vmcnt(6)
  ds_read_b64_tr_b16 a[162:163], v1 offset:3712
  v_mfma_f32_16x16x32_bf16 v[40:43], a[128:131], a[8:11], 0
  s_waitcnt vmcnt(2)
  ds_read_b64_tr_b16 a[164:165], v1 offset:7296
  v_mfma_f32_16x16x32_bf16 v[40:43], a[132:135], a[24:27], v[40:43]
  s_waitcnt vmcnt(1)
  v_mfma_f32_16x16x32_bf16 v[44:47], a[132:135], a[28:31], 0
  s_waitcnt vmcnt(5)
  buffer_load_dwordx4 a[36:39], v0, s[36:39], s11 offen offset:1024 sc1
  v_mfma_f32_16x16x32_bf16 v[44:47], a[128:131], a[12:15], v[44:47]
  ds_read_b64_tr_b16 a[166:167], v1 offset:10880
  v_mfma_f32_16x16x32_bf16 v[60:63], a[136:139], a[12:15], 0
  ds_read_b64_tr_b16 a[168:169], v1 offset:160
  v_mfma_f32_16x16x32_bf16 v[60:63], a[140:143], a[28:31], v[60:63]
  v_mfma_f32_16x16x32_bf16 v[56:59], a[140:143], a[24:27], 0
  ds_read_b64_tr_b16 a[170:171], v1 offset:3744
  v_mfma_f32_16x16x32_bf16 v[56:59], a[136:139], a[8:11], v[56:59]
  buffer_load_dwordx4 a[40:43], v0, s[36:39], s11 offen offset:2048 sc1
  v_mfma_f32_16x16x32_bf16 v[52:55], a[136:139], a[4:7], 0
  ds_read_b64_tr_b16 a[172:173], v1 offset:7328
  v_mfma_f32_16x16x32_bf16 v[52:55], a[140:143], a[20:23], v[52:55]
  v_mfma_f32_16x16x32_bf16 v[48:51], a[140:143], a[16:19], 0
  ds_read_b64_tr_b16 a[174:175], v1 offset:10912
  v_mfma_f32_16x16x32_bf16 v[48:51], a[136:139], a[0:3], v[48:51]
  s_waitcnt lgkmcnt(8)
  v_mfma_f32_16x16x32_bf16 v[64:67], a[144:147], a[0:3], 0
  buffer_load_dwordx4 a[44:47], v0, s[36:39], s11 offen offset:3072 sc1
  s_bfe_u32 s10, s82, 0x40008
  v_mfma_f32_16x16x32_bf16 v[64:67], a[148:151], a[16:19], v[64:67]
  s_mul_i32 s10, s10, 458752
  s_add_u32 m0, s84, 57344
  ds_read_b64_tr_b16 a[128:129], v1 offset:192
  v_mfma_f32_16x16x32_bf16 v[68:71], a[148:151], a[20:23], 0
  ds_read_b64_tr_b16 a[130:131], v1 offset:3776
  v_mfma_f32_16x16x32_bf16 v[68:71], a[144:147], a[4:7], v[68:71]
  v_mfma_f32_16x16x32_bf16 v[72:75], a[144:147], a[8:11], 0
  ds_read_b64_tr_b16 a[132:133], v1 offset:7360
  v_mfma_f32_16x16x32_bf16 v[72:75], a[148:151], a[24:27], v[72:75]
  buffer_load_dwordx4 v3, s[16:19], s10 offen offset:0 lds
  s_add_u32 s11, s11, 4096
  v_mfma_f32_16x16x32_bf16 v[76:79], a[148:151], a[28:31], 0
  ds_read_b64_tr_b16 a[134:135], v1 offset:10944
  v_mfma_f32_16x16x32_bf16 v[76:79], a[144:147], a[12:15], v[76:79]
  v_mfma_f32_16x16x32_bf16 v[92:95], a[152:155], a[12:15], 0
  ds_read_b64_tr_b16 a[136:137], v1 offset:14336
  v_mfma_f32_16x16x32_bf16 v[92:95], a[156:159], a[28:31], v[92:95]
  v_mfma_f32_16x16x32_bf16 v[88:91], a[156:159], a[24:27], 0
  buffer_load_dwordx4 a[48:51], v0, s[36:39], s11 offen offset:0 sc1
  v_mfma_f32_16x16x32_bf16 v[88:91], a[152:155], a[8:11], v[88:91]
  ds_read_b64_tr_b16 a[138:139], v1 offset:17920
  v_mfma_f32_16x16x32_bf16 v[84:87], a[152:155], a[4:7], 0
  ds_read_b64_tr_b16 a[140:141], v1 offset:21504
  v_mfma_f32_16x16x32_bf16 v[84:87], a[156:159], a[20:23], v[84:87]
  v_mfma_f32_16x16x32_bf16 v[80:83], a[156:159], a[16:19], 0
  ds_read_b64_tr_b16 a[142:143], v1 offset:25088
  v_mfma_f32_16x16x32_bf16 v[80:83], a[152:155], a[0:3], v[80:83]
  s_waitcnt lgkmcnt(8)
  buffer_load_dwordx4 v4, s[16:19], s10 offen offset:1024 lds
  v_mfma_f32_16x16x32_bf16 v[96:99], a[160:163], a[0:3], 0
  ds_read_b64_tr_b16 a[144:145], v1 offset:14368
  v_mfma_f32_16x16x32_bf16 v[96:99], a[164:167], a[16:19], v[96:99]
  v_mfma_f32_16x16x32_bf16 v[100:103], a[164:167], a[20:23], 0
  ds_read_b64_tr_b16 a[146:147], v1 offset:17952
  v_mfma_f32_16x16x32_bf16 v[100:103], a[160:163], a[4:7], v[100:103]
  v_mfma_f32_16x16x32_bf16 v[104:107], a[160:163], a[8:11], 0
  buffer_load_dwordx4 a[52:55], v0, s[36:39], s11 offen offset:1024 sc1
  v_mfma_f32_16x16x32_bf16 v[104:107], a[164:167], a[24:27], v[104:107]
  ds_read_b64_tr_b16 a[148:149], v1 offset:21536
  v_mfma_f32_16x16x32_bf16 v[108:111], a[164:167], a[28:31], 0
  ds_read_b64_tr_b16 a[150:151], v1 offset:25120
  v_mfma_f32_16x16x32_bf16 v[108:111], a[160:163], a[12:15], v[108:111]
  v_mfma_f32_16x16x32_bf16 v[124:127], a[168:171], a[12:15], 0
  s_bfe_u32 s20, s82, 0x40018
  s_lshl4_add_u32 s20, s56, s20
  s_lshl_b32 s20, s20, 11
  v_mfma_f32_16x16x32_bf16 v[124:127], a[172:175], a[28:31], v[124:127]
  s_add_u32 s20, s20, 5767168
  buffer_load_dwordx4 v5, s[16:19], s10 offen offset:2048 lds
  s_lshr_b32 s28, s44, 1
  v_mfma_f32_16x16x32_bf16 v[120:123], a[172:175], a[24:27], 0
  s_mul_i32 s28, s28, 14336
  ds_read_b64_tr_b16 a[152:153], v1 offset:14400
  s_and_b32 s29, s44, 1
  v_mfma_f32_16x16x32_bf16 v[120:123], a[168:171], a[8:11], v[120:123]
  s_lshl_b32 s29, s29, 7
  ds_read_b64_tr_b16 a[154:155], v1 offset:17984
  s_add_u32 s28, s28, s29
  v_mfma_f32_16x16x32_bf16 v[116:119], a[168:171], a[4:7], 0
  ds_read_b64_tr_b16 a[156:157], v1 offset:21568
  v_add_u32 v31, s28, v1
  v_mfma_f32_16x16x32_bf16 v[116:119], a[172:175], a[20:23], v[116:119]
  s_lshl_b32 s4, s2, 15
  s_lshl1_add_u32 s4, s73, s4
  s_xor_b32 s6, s4, 32768
  v_mfma_f32_16x16x32_bf16 v[112:115], a[172:175], a[16:19], 0
  s_add_u32 s4, s4, 41943040
  buffer_load_dwordx4 a[56:59], v0, s[36:39], s11 offen offset:2048 sc1
  s_add_u32 s5, s4, 4096
  v_mfma_f32_16x16x32_bf16 v[112:115], a[168:171], a[0:3], v[112:115]
  s_waitcnt lgkmcnt(7)
  ds_read_b64_tr_b16 a[158:159], v1 offset:25152
  s_add_u32 s6, s6, 41943040
  v_mfma_f32_16x16x32_bf16 v[128:131], a[128:131], a[0:3], 0
  s_add_u32 s7, s6, 4096
  ds_read_b64_tr_b16 a[160:161], v1 offset:14432
  v_mfma_f32_16x16x32_bf16 v[128:131], a[132:135], a[16:19], v[128:131]
  v_mfma_f32_16x16x32_bf16 v[132:135], a[132:135], a[20:23], 0
  ds_read_b64_tr_b16 a[162:163], v1 offset:18016
  v_mfma_f32_16x16x32_bf16 v[132:135], a[128:131], a[4:7], v[132:135]
  buffer_load_dwordx4 v6, s[16:19], s10 offen offset:3072 lds
  v_mfma_f32_16x16x32_bf16 v[136:139], a[128:131], a[8:11], 0
  ds_read_b64_tr_b16 a[164:165], v1 offset:21600
  v_mfma_f32_16x16x32_bf16 v[136:139], a[132:135], a[24:27], v[136:139]
  v_mfma_f32_16x16x32_bf16 v[140:143], a[132:135], a[28:31], 0
  ds_read_b64_tr_b16 a[166:167], v1 offset:25184
  v_mfma_f32_16x16x32_bf16 v[140:143], a[128:131], a[12:15], v[140:143]
  v_mfma_f32_16x16x32_bf16 v[156:159], a[136:139], a[12:15], 0
  buffer_load_dwordx4 a[60:63], v0, s[36:39], s11 offen offset:3072 sc1
  s_add_u32 m0, s84, 61440
  v_mfma_f32_16x16x32_bf16 v[156:159], a[140:143], a[28:31], v[156:159]
  ds_read_b64_tr_b16 a[168:169], v1 offset:14464
  v_mfma_f32_16x16x32_bf16 v[152:155], a[140:143], a[24:27], 0
  ds_read_b64_tr_b16 a[170:171], v1 offset:18048
  v_mfma_f32_16x16x32_bf16 v[152:155], a[136:139], a[8:11], v[152:155]
  v_mfma_f32_16x16x32_bf16 v[148:151], a[136:139], a[4:7], 0
  ds_read_b64_tr_b16 a[172:173], v1 offset:21632
  v_mfma_f32_16x16x32_bf16 v[148:151], a[140:143], a[20:23], v[148:151]
  buffer_load_dwordx4 v7, s[16:19], s10 offen offset:0 lds
  s_bfe_u32 s11, s82, 0x40008
  v_mfma_f32_16x16x32_bf16 v[144:147], a[140:143], a[16:19], 0
  s_lshl_b32 s11, s11, 13
  s_add_u32 s11, s11, s85
  ds_read_b64_tr_b16 a[174:175], v1 offset:25216
  v_mfma_f32_16x16x32_bf16 v[144:147], a[136:139], a[0:3], v[144:147]
  s_waitcnt lgkmcnt(8)
  v_mfma_f32_16x16x32_bf16 v[160:163], a[144:147], a[0:3], 0
  ds_read_b64_tr_b16 a[128:129], v1 offset:14496
  v_mfma_f32_16x16x32_bf16 v[160:163], a[148:151], a[16:19], v[160:163]
  v_mfma_f32_16x16x32_bf16 v[164:167], a[148:151], a[20:23], 0
  buffer_load_dwordx4 a[64:67], v0, s[36:39], s11 offen offset:0 sc1
  v_mfma_f32_16x16x32_bf16 v[164:167], a[144:147], a[4:7], v[164:167]
  ds_read_b64_tr_b16 a[130:131], v1 offset:18080
  v_mfma_f32_16x16x32_bf16 v[168:171], a[144:147], a[8:11], 0
  ds_read_b64_tr_b16 a[132:133], v1 offset:21664
  v_mfma_f32_16x16x32_bf16 v[168:171], a[148:151], a[24:27], v[168:171]
  v_mfma_f32_16x16x32_bf16 v[172:175], a[148:151], a[28:31], 0
  ds_read_b64_tr_b16 a[134:135], v1 offset:25248
  v_mfma_f32_16x16x32_bf16 v[172:175], a[144:147], a[12:15], v[172:175]
  s_waitcnt vmcnt(22)
  s_barrier
  buffer_load_dwordx4 v8, s[16:19], s10 offen offset:1024 lds
  v_mfma_f32_16x16x32_bf16 v[188:191], a[152:155], a[12:15], 0
  ds_read_b64_tr_b16 a[136:137], v1 offset:14528
  v_mfma_f32_16x16x32_bf16 v[188:191], a[156:159], a[28:31], v[188:191]
  v_mfma_f32_16x16x32_bf16 v[184:187], a[156:159], a[24:27], 0
  ds_read_b64_tr_b16 a[138:139], v1 offset:18112
  v_mfma_f32_16x16x32_bf16 v[184:187], a[152:155], a[8:11], v[184:187]
  v_mfma_f32_16x16x32_bf16 v[180:183], a[152:155], a[4:7], 0
  buffer_load_dwordx4 a[68:71], v0, s[36:39], s11 offen offset:1024 sc1
  v_mfma_f32_16x16x32_bf16 v[180:183], a[156:159], a[20:23], v[180:183]
  ds_read_b64_tr_b16 a[140:141], v1 offset:21696
  v_mfma_f32_16x16x32_bf16 v[176:179], a[156:159], a[16:19], 0
  ds_read_b64_tr_b16 a[142:143], v1 offset:25280
  v_mfma_f32_16x16x32_bf16 v[176:179], a[152:155], a[0:3], v[176:179]
  s_waitcnt lgkmcnt(8)
  v_mfma_f32_16x16x32_bf16 v[192:195], a[160:163], a[0:3], 0
  ds_read_b64_tr_b16 a[144:145], v1 offset:28672
  v_mfma_f32_16x16x32_bf16 v[192:195], a[164:167], a[16:19], v[192:195]
  v_mfma_f32_16x16x32_bf16 v[196:199], a[164:167], a[20:23], 0
  ds_read_b64_tr_b16 a[146:147], v1 offset:32256
  v_mfma_f32_16x16x32_bf16 v[196:199], a[160:163], a[4:7], v[196:199]
  v_mfma_f32_16x16x32_bf16 v[200:203], a[160:163], a[8:11], 0
  ds_read_b64_tr_b16 a[148:149], v1 offset:35840
  v_mfma_f32_16x16x32_bf16 v[200:203], a[164:167], a[24:27], v[200:203]
  v_mfma_f32_16x16x32_bf16 v[204:207], a[164:167], a[28:31], 0
  buffer_load_dwordx4 v9, s[16:19], s10 offen offset:2048 lds
  v_mfma_f32_16x16x32_bf16 v[204:207], a[160:163], a[12:15], v[204:207]
  ds_read_b64_tr_b16 a[150:151], v1 offset:39424
  v_mfma_f32_16x16x32_bf16 v[220:223], a[168:171], a[12:15], 0
  ds_read_b64_tr_b16 a[152:153], v1 offset:28704
  v_mfma_f32_16x16x32_bf16 v[220:223], a[172:175], a[28:31], v[220:223]
  v_mfma_f32_16x16x32_bf16 v[216:219], a[172:175], a[24:27], 0
  ds_read_b64_tr_b16 a[154:155], v1 offset:32288
  v_mfma_f32_16x16x32_bf16 v[216:219], a[168:171], a[8:11], v[216:219]
  buffer_load_dwordx4 a[72:75], v0, s[36:39], s11 offen offset:2048 sc1
  v_mfma_f32_16x16x32_bf16 v[212:215], a[168:171], a[4:7], 0
  ds_read_b64_tr_b16 a[156:157], v1 offset:35872
  v_mfma_f32_16x16x32_bf16 v[212:215], a[172:175], a[20:23], v[212:215]
  v_mfma_f32_16x16x32_bf16 v[208:211], a[172:175], a[16:19], 0
  ds_read_b64_tr_b16 a[158:159], v1 offset:39456
  v_mfma_f32_16x16x32_bf16 v[208:211], a[168:171], a[0:3], v[208:211]
  s_waitcnt lgkmcnt(8)
  v_mfma_f32_16x16x32_bf16 v[224:227], a[128:131], a[0:3], 0
  ds_read_b64_tr_b16 a[160:161], v1 offset:28736
  v_mfma_f32_16x16x32_bf16 v[224:227], a[132:135], a[16:19], v[224:227]
  v_mfma_f32_16x16x32_bf16 v[228:231], a[132:135], a[20:23], 0
  ds_read_b64_tr_b16 a[162:163], v1 offset:32320
  v_mfma_f32_16x16x32_bf16 v[228:231], a[128:131], a[4:7], v[228:231]
  v_mfma_f32_16x16x32_bf16 v[232:235], a[128:131], a[8:11], 0
  ds_read_b64_tr_b16 a[164:165], v1 offset:35904
  v_mfma_f32_16x16x32_bf16 v[232:235], a[132:135], a[24:27], v[232:235]
  buffer_load_dwordx4 a[76:79], v0, s[36:39], s11 offen offset:3072 sc1
  v_mfma_f32_16x16x32_bf16 v[236:239], a[132:135], a[28:31], 0
  ds_read_b64_tr_b16 a[166:167], v1 offset:39488
  v_mfma_f32_16x16x32_bf16 v[236:239], a[128:131], a[12:15], v[236:239]
  v_mfma_f32_16x16x32_bf16 v[252:255], a[136:139], a[12:15], 0
  ds_read_b64_tr_b16 a[168:169], v1 offset:28768
  v_mfma_f32_16x16x32_bf16 v[252:255], a[140:143], a[28:31], v[252:255]
  s_bfe_u32 s10, s82, 0x4000c
  s_mul_i32 s10, s10, 458752
  s_add_u32 m0, s84, 86016
  v_mfma_f32_16x16x32_bf16 v[248:251], a[140:143], a[24:27], 0
  ds_read_b64_tr_b16 a[170:171], v1 offset:32352
  v_mfma_f32_16x16x32_bf16 v[248:251], a[136:139], a[8:11], v[248:251]
  v_mfma_f32_16x16x32_bf16 v[244:247], a[136:139], a[4:7], 0
  ds_read_b64_tr_b16 a[172:173], v1 offset:35936
  v_mfma_f32_16x16x32_bf16 v[244:247], a[140:143], a[20:23], v[244:247]
  buffer_load_dwordx4 v3, s[16:19], s10 offen offset:0 lds
  v_mfma_f32_16x16x32_bf16 v[240:243], a[140:143], a[16:19], 0
  ds_read_b64_tr_b16 a[174:175], v1 offset:39520
  v_mfma_f32_16x16x32_bf16 v[240:243], a[136:139], a[0:3], v[240:243]
  s_waitcnt vmcnt(8) lgkmcnt(8)
  v_mfma_f32_16x16x32_bf16 v[32:35], a[144:147], a[32:35], v[32:35]
  s_add_u32 s11, s11, 4096
  ds_read_b64_tr_b16 a[128:129], v1 offset:28800
  v_mfma_f32_16x16x32_bf16 v[32:35], a[148:151], a[48:51], v[32:35]
  v_mfma_f32_16x16x32_bf16 v[36:39], a[148:151], a[52:55], v[36:39]
  ds_read_b64_tr_b16 a[130:131], v1 offset:32384
  v_mfma_f32_16x16x32_bf16 v[36:39], a[144:147], a[36:39], v[36:39]
  v_mfma_f32_16x16x32_bf16 v[40:43], a[144:147], a[40:43], v[40:43]
  buffer_load_dwordx4 a[80:83], v0, s[36:39], s11 offen offset:0 sc1
  v_mfma_f32_16x16x32_bf16 v[40:43], a[148:151], a[56:59], v[40:43]
  ds_read_b64_tr_b16 a[132:133], v1 offset:35968
  v_mfma_f32_16x16x32_bf16 v[44:47], a[148:151], a[60:63], v[44:47]
  ds_read_b64_tr_b16 a[134:135], v1 offset:39552
  v_mfma_f32_16x16x32_bf16 v[44:47], a[144:147], a[44:47], v[44:47]
  v_mfma_f32_16x16x32_bf16 v[60:63], a[152:155], a[44:47], v[60:63]
  ds_read_b64_tr_b16 a[136:137], v1 offset:28832
  v_mfma_f32_16x16x32_bf16 v[60:63], a[156:159], a[60:63], v[60:63]
  v_mfma_f32_16x16x32_bf16 v[56:59], a[156:159], a[56:59], v[56:59]
  ds_read_b64_tr_b16 a[138:139], v1 offset:32416
  v_mfma_f32_16x16x32_bf16 v[56:59], a[152:155], a[40:43], v[56:59]
  buffer_load_dwordx4 v4, s[16:19], s10 offen offset:1024 lds
  v_mfma_f32_16x16x32_bf16 v[52:55], a[152:155], a[36:39], v[52:55]
  ds_read_b64_tr_b16 a[140:141], v1 offset:36000
  v_mfma_f32_16x16x32_bf16 v[52:55], a[156:159], a[52:55], v[52:55]
  v_mfma_f32_16x16x32_bf16 v[48:51], a[156:159], a[48:51], v[48:51]
  ds_read_b64_tr_b16 a[142:143], v1 offset:39584
  v_mfma_f32_16x16x32_bf16 v[48:51], a[152:155], a[32:35], v[48:51]
  s_waitcnt lgkmcnt(8)
  v_mfma_f32_16x16x32_bf16 v[64:67], a[160:163], a[32:35], v[64:67]
  ds_read_b64_tr_b16 a[144:145], v1 offset:28864
  v_mfma_f32_16x16x32_bf16 v[64:67], a[164:167], a[48:51], v[64:67]
  v_mfma_f32_16x16x32_bf16 v[68:71], a[164:167], a[52:55], v[68:71]
  ds_read_b64_tr_b16 a[146:147], v1 offset:32448
  v_mfma_f32_16x16x32_bf16 v[68:71], a[160:163], a[36:39], v[68:71]
  buffer_load_dwordx4 a[84:87], v0, s[36:39], s11 offen offset:1024 sc1
  v_mfma_f32_16x16x32_bf16 v[72:75], a[160:163], a[40:43], v[72:75]
  ds_read_b64_tr_b16 a[148:149], v1 offset:36032
  v_mfma_f32_16x16x32_bf16 v[72:75], a[164:167], a[56:59], v[72:75]
  v_mfma_f32_16x16x32_bf16 v[76:79], a[164:167], a[60:63], v[76:79]
  ds_read_b64_tr_b16 a[150:151], v1 offset:39616
  v_mfma_f32_16x16x32_bf16 v[76:79], a[160:163], a[44:47], v[76:79]
  v_mfma_f32_16x16x32_bf16 v[92:95], a[168:171], a[44:47], v[92:95]
  ds_read_b64_tr_b16 a[152:153], v1 offset:43008
  v_mfma_f32_16x16x32_bf16 v[92:95], a[172:175], a[60:63], v[92:95]
  v_mfma_f32_16x16x32_bf16 v[88:91], a[172:175], a[56:59], v[88:91]
  buffer_load_dwordx4 v5, s[16:19], s10 offen offset:2048 lds
  v_mfma_f32_16x16x32_bf16 v[88:91], a[168:171], a[40:43], v[88:91]
  ds_read_b64_tr_b16 a[154:155], v1 offset:46592
  v_mfma_f32_16x16x32_bf16 v[84:87], a[168:171], a[36:39], v[84:87]
  ds_read_b64_tr_b16 a[156:157], v1 offset:50176
  v_mfma_f32_16x16x32_bf16 v[84:87], a[172:175], a[52:55], v[84:87]
  v_mfma_f32_16x16x32_bf16 v[80:83], a[172:175], a[48:51], v[80:83]
  ds_read_b64_tr_b16 a[158:159], v1 offset:53760
  v_mfma_f32_16x16x32_bf16 v[80:83], a[168:171], a[32:35], v[80:83]
  s_waitcnt lgkmcnt(8)
  v_mfma_f32_16x16x32_bf16 v[96:99], a[128:131], a[32:35], v[96:99]
  ds_read_b64_tr_b16 a[160:161], v1 offset:43040
  v_mfma_f32_16x16x32_bf16 v[96:99], a[132:135], a[48:51], v[96:99]
  v_mfma_f32_16x16x32_bf16 v[100:103], a[132:135], a[52:55], v[100:103]
  buffer_load_dwordx4 a[88:91], v0, s[36:39], s11 offen offset:2048 sc1
  v_mfma_f32_16x16x32_bf16 v[100:103], a[128:131], a[36:39], v[100:103]
  ds_read_b64_tr_b16 a[162:163], v1 offset:46624
  v_mfma_f32_16x16x32_bf16 v[104:107], a[128:131], a[40:43], v[104:107]
  ds_read_b64_tr_b16 a[164:165], v1 offset:50208
  v_mfma_f32_16x16x32_bf16 v[104:107], a[132:135], a[56:59], v[104:107]
  v_mfma_f32_16x16x32_bf16 v[108:111], a[132:135], a[60:63], v[108:111]
  ds_read_b64_tr_b16 a[166:167], v1 offset:53792
  v_mfma_f32_16x16x32_bf16 v[108:111], a[128:131], a[44:47], v[108:111]
  v_mfma_f32_16x16x32_bf16 v[124:127], a[136:139], a[44:47], v[124:127]
  ds_read_b64_tr_b16 a[168:169], v1 offset:43072
  v_mfma_f32_16x16x32_bf16 v[124:127], a[140:143], a[60:63], v[124:127]
  buffer_load_dwordx4 v6, s[16:19], s10 offen offset:3072 lds
  v_mfma_f32_16x16x32_bf16 v[120:123], a[140:143], a[56:59], v[120:123]
  ds_read_b64_tr_b16 a[170:171], v1 offset:46656
  v_mfma_f32_16x16x32_bf16 v[120:123], a[136:139], a[40:43], v[120:123]
  v_mfma_f32_16x16x32_bf16 v[116:119], a[136:139], a[36:39], v[116:119]
  ds_read_b64_tr_b16 a[172:173], v1 offset:50240
  v_mfma_f32_16x16x32_bf16 v[116:119], a[140:143], a[52:55], v[116:119]
  v_mfma_f32_16x16x32_bf16 v[112:115], a[140:143], a[48:51], v[112:115]
  ds_read_b64_tr_b16 a[174:175], v1 offset:53824
  v_mfma_f32_16x16x32_bf16 v[112:115], a[136:139], a[32:35], v[112:115]
  s_waitcnt lgkmcnt(8)
  v_mfma_f32_16x16x32_bf16 v[128:131], a[144:147], a[32:35], v[128:131]
  ds_read_b64_tr_b16 a[128:129], v1 offset:43104
  v_mfma_f32_16x16x32_bf16 v[128:131], a[148:151], a[48:51], v[128:131]
  buffer_load_dwordx4 a[92:95], v0, s[36:39], s11 offen offset:3072 sc1
  v_mfma_f32_16x16x32_bf16 v[132:135], a[148:151], a[52:55], v[132:135]
  ds_read_b64_tr_b16 a[130:131], v1 offset:46688
  v_mfma_f32_16x16x32_bf16 v[132:135], a[144:147], a[36:39], v[132:135]
  v_mfma_f32_16x16x32_bf16 v[136:139], a[144:147], a[40:43], v[136:139]
  s_add_u32 m0, s84, 90112
  ds_read_b64_tr_b16 a[132:133], v1 offset:50272
  v_mfma_f32_16x16x32_bf16 v[136:139], a[148:151], a[56:59], v[136:139]
  v_mfma_f32_16x16x32_bf16 v[140:143], a[148:151], a[60:63], v[140:143]
  ds_read_b64_tr_b16 a[134:135], v1 offset:53856
  v_mfma_f32_16x16x32_bf16 v[140:143], a[144:147], a[44:47], v[140:143]
  v_mfma_f32_16x16x32_bf16 v[156:159], a[152:155], a[44:47], v[156:159]
  buffer_load_dwordx4 v7, s[16:19], s10 offen offset:0 lds
  s_bfe_u32 s11, s82, 0x4000c
  v_mfma_f32_16x16x32_bf16 v[156:159], a[156:159], a[60:63], v[156:159]
  s_lshl_b32 s11, s11, 13
  s_add_u32 s11, s11, s85
  ds_read_b64_tr_b16 a[136:137], v1 offset:43136
  v_mfma_f32_16x16x32_bf16 v[152:155], a[156:159], a[56:59], v[152:155]
  ds_read_b64_tr_b16 a[138:139], v1 offset:46720
  v_mfma_f32_16x16x32_bf16 v[152:155], a[152:155], a[40:43], v[152:155]
  v_mfma_f32_16x16x32_bf16 v[148:151], a[152:155], a[36:39], v[148:151]
  ds_read_b64_tr_b16 a[140:141], v1 offset:50304
  v_mfma_f32_16x16x32_bf16 v[148:151], a[156:159], a[52:55], v[148:151]
  buffer_load_dwordx4 a[96:99], v0, s[36:39], s11 offen offset:0 sc1
  v_mfma_f32_16x16x32_bf16 v[144:147], a[156:159], a[48:51], v[144:147]
  ds_read_b64_tr_b16 a[142:143], v1 offset:53888
  v_mfma_f32_16x16x32_bf16 v[144:147], a[152:155], a[32:35], v[144:147]
  s_waitcnt lgkmcnt(8)
  v_mfma_f32_16x16x32_bf16 v[160:163], a[160:163], a[32:35], v[160:163]
  ds_read_b64_tr_b16 a[144:145], v1 offset:43168
  v_mfma_f32_16x16x32_bf16 v[160:163], a[164:167], a[48:51], v[160:163]
  v_mfma_f32_16x16x32_bf16 v[164:167], a[164:167], a[52:55], v[164:167]
  ds_read_b64_tr_b16 a[146:147], v1 offset:46752
  v_mfma_f32_16x16x32_bf16 v[164:167], a[160:163], a[36:39], v[164:167]
  v_mfma_f32_16x16x32_bf16 v[168:171], a[160:163], a[40:43], v[168:171]
  ds_read_b64_tr_b16 a[148:149], v1 offset:50336
  v_mfma_f32_16x16x32_bf16 v[168:171], a[164:167], a[56:59], v[168:171]
  v_mfma_f32_16x16x32_bf16 v[172:175], a[164:167], a[60:63], v[172:175]
  ds_read_b64_tr_b16 a[150:151], v1 offset:53920
  v_mfma_f32_16x16x32_bf16 v[172:175], a[160:163], a[44:47], v[172:175]
  s_waitcnt vmcnt(12)
  s_barrier
  buffer_load_dwordx4 v8, s[16:19], s10 offen offset:1024 lds
  v_mfma_f32_16x16x32_bf16 v[188:191], a[168:171], a[44:47], v[188:191]
  ds_read_b64_tr_b16 a[152:153], v1 offset:43200
  v_mfma_f32_16x16x32_bf16 v[188:191], a[172:175], a[60:63], v[188:191]
  v_mfma_f32_16x16x32_bf16 v[184:187], a[172:175], a[56:59], v[184:187]
  ds_read_b64_tr_b16 a[154:155], v1 offset:46784
  v_mfma_f32_16x16x32_bf16 v[184:187], a[168:171], a[40:43], v[184:187]
  v_mfma_f32_16x16x32_bf16 v[180:183], a[168:171], a[36:39], v[180:183]
  buffer_load_dwordx4 a[100:103], v0, s[36:39], s11 offen offset:1024 sc1
  v_mfma_f32_16x16x32_bf16 v[180:183], a[172:175], a[52:55], v[180:183]
  ds_read_b64_tr_b16 a[156:157], v1 offset:50368
  v_mfma_f32_16x16x32_bf16 v[176:179], a[172:175], a[48:51], v[176:179]
  ds_read_b64_tr_b16 a[158:159], v1 offset:53952
  v_mfma_f32_16x16x32_bf16 v[176:179], a[168:171], a[32:35], v[176:179]
  s_waitcnt lgkmcnt(8)
  v_mfma_f32_16x16x32_bf16 v[192:195], a[128:131], a[32:35], v[192:195]
  ds_read_b64_tr_b16 a[160:161], v2 offset:0
  v_mfma_f32_16x16x32_bf16 v[192:195], a[132:135], a[48:51], v[192:195]
  v_mfma_f32_16x16x32_bf16 v[196:199], a[132:135], a[52:55], v[196:199]
  ds_read_b64_tr_b16 a[162:163], v2 offset:3584
  v_mfma_f32_16x16x32_bf16 v[196:199], a[128:131], a[36:39], v[196:199]
  v_mfma_f32_16x16x32_bf16 v[200:203], a[128:131], a[40:43], v[200:203]
  ds_read_b64_tr_b16 a[164:165], v2 offset:7168
  v_mfma_f32_16x16x32_bf16 v[200:203], a[132:135], a[56:59], v[200:203]
  v_mfma_f32_16x16x32_bf16 v[204:207], a[132:135], a[60:63], v[204:207]
  buffer_load_dwordx4 v9, s[16:19], s10 offen offset:2048 lds
  v_mfma_f32_16x16x32_bf16 v[204:207], a[128:131], a[44:47], v[204:207]
  ds_read_b64_tr_b16 a[166:167], v2 offset:10752
  v_mfma_f32_16x16x32_bf16 v[220:223], a[136:139], a[44:47], v[220:223]
  ds_read_b64_tr_b16 a[168:169], v2 offset:32
  v_mfma_f32_16x16x32_bf16 v[220:223], a[140:143], a[60:63], v[220:223]
  v_mfma_f32_16x16x32_bf16 v[216:219], a[140:143], a[56:59], v[216:219]
  ds_read_b64_tr_b16 a[170:171], v2 offset:3616
  v_mfma_f32_16x16x32_bf16 v[216:219], a[136:139], a[40:43], v[216:219]
  buffer_load_dwordx4 a[104:107], v0, s[36:39], s11 offen offset:2048 sc1
  v_mfma_f32_16x16x32_bf16 v[212:215], a[136:139], a[36:39], v[212:215]
  ds_read_b64_tr_b16 a[172:173], v2 offset:7200
  v_mfma_f32_16x16x32_bf16 v[212:215], a[140:143], a[52:55], v[212:215]
  v_mfma_f32_16x16x32_bf16 v[208:211], a[140:143], a[48:51], v[208:211]
  ds_read_b64_tr_b16 a[174:175], v2 offset:10784
  v_mfma_f32_16x16x32_bf16 v[208:211], a[136:139], a[32:35], v[208:211]
  s_waitcnt lgkmcnt(8)
  v_mfma_f32_16x16x32_bf16 v[224:227], a[144:147], a[32:35], v[224:227]
  ds_read_b64_tr_b16 a[128:129], v2 offset:64
  v_mfma_f32_16x16x32_bf16 v[224:227], a[148:151], a[48:51], v[224:227]
  v_mfma_f32_16x16x32_bf16 v[228:231], a[148:151], a[52:55], v[228:231]
  ds_read_b64_tr_b16 a[130:131], v2 offset:3648
  v_mfma_f32_16x16x32_bf16 v[228:231], a[144:147], a[36:39], v[228:231]
  v_mfma_f32_16x16x32_bf16 v[232:235], a[144:147], a[40:43], v[232:235]
  ds_read_b64_tr_b16 a[132:133], v2 offset:7232
  v_mfma_f32_16x16x32_bf16 v[232:235], a[148:151], a[56:59], v[232:235]
  buffer_load_dwordx4 a[108:111], v0, s[36:39], s11 offen offset:3072 sc1
  v_mfma_f32_16x16x32_bf16 v[236:239], a[148:151], a[60:63], v[236:239]
  ds_read_b64_tr_b16 a[134:135], v2 offset:10816
  v_mfma_f32_16x16x32_bf16 v[236:239], a[144:147], a[44:47], v[236:239]
  v_mfma_f32_16x16x32_bf16 v[252:255], a[152:155], a[44:47], v[252:255]
  ds_read_b64_tr_b16 a[136:137], v2 offset:96
  v_mfma_f32_16x16x32_bf16 v[252:255], a[156:159], a[60:63], v[252:255]
  s_bfe_u32 s10, s82, 0x40010
  s_mul_i32 s10, s10, 458752
  s_add_u32 m0, s84, 0
  v_mfma_f32_16x16x32_bf16 v[248:251], a[156:159], a[56:59], v[248:251]
  ds_read_b64_tr_b16 a[138:139], v2 offset:3680
  v_mfma_f32_16x16x32_bf16 v[248:251], a[152:155], a[40:43], v[248:251]
  v_mfma_f32_16x16x32_bf16 v[244:247], a[152:155], a[36:39], v[244:247]
  ds_read_b64_tr_b16 a[140:141], v2 offset:7264
  v_mfma_f32_16x16x32_bf16 v[244:247], a[156:159], a[52:55], v[244:247]
  buffer_load_dwordx4 v3, s[16:19], s10 offen offset:0 lds
  v_mfma_f32_16x16x32_bf16 v[240:243], a[156:159], a[48:51], v[240:243]
  ds_read_b64_tr_b16 a[142:143], v2 offset:10848
  v_mfma_f32_16x16x32_bf16 v[240:243], a[152:155], a[32:35], v[240:243]
  s_waitcnt vmcnt(8) lgkmcnt(8)
  v_mfma_f32_16x16x32_bf16 v[32:35], a[160:163], a[64:67], v[32:35]
  s_add_u32 s11, s11, 4096
  ds_read_b64_tr_b16 a[144:145], v2 offset:128
  v_mfma_f32_16x16x32_bf16 v[32:35], a[164:167], a[80:83], v[32:35]
  v_mfma_f32_16x16x32_bf16 v[36:39], a[164:167], a[84:87], v[36:39]
  ds_read_b64_tr_b16 a[146:147], v2 offset:3712
  v_mfma_f32_16x16x32_bf16 v[36:39], a[160:163], a[68:71], v[36:39]
  v_mfma_f32_16x16x32_bf16 v[40:43], a[160:163], a[72:75], v[40:43]
  buffer_load_dwordx4 a[112:115], v0, s[36:39], s11 offen offset:0 sc1
  v_mfma_f32_16x16x32_bf16 v[40:43], a[164:167], a[88:91], v[40:43]
  ds_read_b64_tr_b16 a[148:149], v2 offset:7296
  v_mfma_f32_16x16x32_bf16 v[44:47], a[164:167], a[92:95], v[44:47]
  ds_read_b64_tr_b16 a[150:151], v2 offset:10880
  v_mfma_f32_16x16x32_bf16 v[44:47], a[160:163], a[76:79], v[44:47]
  v_mfma_f32_16x16x32_bf16 v[60:63], a[168:171], a[76:79], v[60:63]
  ds_read_b64_tr_b16 a[152:153], v2 offset:160
  v_mfma_f32_16x16x32_bf16 v[60:63], a[172:175], a[92:95], v[60:63]
  v_mfma_f32_16x16x32_bf16 v[56:59], a[172:175], a[88:91], v[56:59]
  ds_read_b64_tr_b16 a[154:155], v2 offset:3744
  v_mfma_f32_16x16x32_bf16 v[56:59], a[168:171], a[72:75], v[56:59]
  buffer_load_dwordx4 v4, s[16:19], s10 offen offset:1024 lds
  v_mfma_f32_16x16x32_bf16 v[52:55], a[168:171], a[68:71], v[52:55]
  ds_read_b64_tr_b16 a[156:157], v2 offset:7328
  v_mfma_f32_16x16x32_bf16 v[52:55], a[172:175], a[84:87], v[52:55]
  v_mfma_f32_16x16x32_bf16 v[48:51], a[172:175], a[80:83], v[48:51]
  ds_read_b64_tr_b16 a[158:159], v2 offset:10912
  v_mfma_f32_16x16x32_bf16 v[48:51], a[168:171], a[64:67], v[48:51]
  s_waitcnt lgkmcnt(8)
  v_mfma_f32_16x16x32_bf16 v[64:67], a[128:131], a[64:67], v[64:67]
  ds_read_b64_tr_b16 a[160:161], v2 offset:192
  v_mfma_f32_16x16x32_bf16 v[64:67], a[132:135], a[80:83], v[64:67]
  v_mfma_f32_16x16x32_bf16 v[68:71], a[132:135], a[84:87], v[68:71]
  ds_read_b64_tr_b16 a[162:163], v2 offset:3776
  v_mfma_f32_16x16x32_bf16 v[68:71], a[128:131], a[68:71], v[68:71]
  buffer_load_dwordx4 a[116:119], v0, s[36:39], s11 offen offset:1024 sc1
  v_mfma_f32_16x16x32_bf16 v[72:75], a[128:131], a[72:75], v[72:75]
  ds_read_b64_tr_b16 a[164:165], v2 offset:7360
  v_mfma_f32_16x16x32_bf16 v[72:75], a[132:135], a[88:91], v[72:75]
  v_mfma_f32_16x16x32_bf16 v[76:79], a[132:135], a[92:95], v[76:79]
  ds_read_b64_tr_b16 a[166:167], v2 offset:10944
  v_mfma_f32_16x16x32_bf16 v[76:79], a[128:131], a[76:79], v[76:79]
  v_mfma_f32_16x16x32_bf16 v[92:95], a[136:139], a[76:79], v[92:95]
  ds_read_b64_tr_b16 a[168:169], v2 offset:14336
  v_mfma_f32_16x16x32_bf16 v[92:95], a[140:143], a[92:95], v[92:95]
  v_mfma_f32_16x16x32_bf16 v[88:91], a[140:143], a[88:91], v[88:91]
  buffer_load_dwordx4 v5, s[16:19], s10 offen offset:2048 lds
  v_mfma_f32_16x16x32_bf16 v[88:91], a[136:139], a[72:75], v[88:91]
  ds_read_b64_tr_b16 a[170:171], v2 offset:17920
  v_mfma_f32_16x16x32_bf16 v[84:87], a[136:139], a[68:71], v[84:87]
  ds_read_b64_tr_b16 a[172:173], v2 offset:21504
  v_mfma_f32_16x16x32_bf16 v[84:87], a[140:143], a[84:87], v[84:87]
  v_mfma_f32_16x16x32_bf16 v[80:83], a[140:143], a[80:83], v[80:83]
  ds_read_b64_tr_b16 a[174:175], v2 offset:25088
  v_mfma_f32_16x16x32_bf16 v[80:83], a[136:139], a[64:67], v[80:83]
  s_waitcnt lgkmcnt(8)
  v_mfma_f32_16x16x32_bf16 v[96:99], a[144:147], a[64:67], v[96:99]
  ds_read_b64_tr_b16 a[128:129], v2 offset:14368
  v_mfma_f32_16x16x32_bf16 v[96:99], a[148:151], a[80:83], v[96:99]
Hb0:
  s_cbranch_execz Hb0_1
  v_mfma_f32_16x16x32_bf16 v[100:103], a[148:151], a[84:87], v[100:103]
  buffer_load_dwordx4 a[120:123], v0, s[36:39], s11 offen offset:2048 sc1
  v_mfma_f32_16x16x32_bf16 v[100:103], a[144:147], a[68:71], v[100:103]
  ds_read_b64_tr_b16 a[130:131], v2 offset:17952
  v_mfma_f32_16x16x32_bf16 v[104:107], a[144:147], a[72:75], v[104:107]
  ds_read_b64_tr_b16 a[132:133], v2 offset:21536
  v_mfma_f32_16x16x32_bf16 v[104:107], a[148:151], a[88:91], v[104:107]
  v_mfma_f32_16x16x32_bf16 v[108:111], a[148:151], a[92:95], v[108:111]
  ds_read_b64_tr_b16 a[134:135], v2 offset:25120
  v_mfma_f32_16x16x32_bf16 v[108:111], a[144:147], a[76:79], v[108:111]
  v_mfma_f32_16x16x32_bf16 v[124:127], a[152:155], a[76:79], v[124:127]
  ds_read_b64_tr_b16 a[136:137], v2 offset:14400
  v_mfma_f32_16x16x32_bf16 v[124:127], a[156:159], a[92:95], v[124:127]
  buffer_load_dwordx4 v6, s[16:19], s10 offen offset:3072 lds
  v_mfma_f32_16x16x32_bf16 v[120:123], a[156:159], a[88:91], v[120:123]
  ds_read_b64_tr_b16 a[138:139], v2 offset:17984
  v_mfma_f32_16x16x32_bf16 v[120:123], a[152:155], a[72:75], v[120:123]
  v_mfma_f32_16x16x32_bf16 v[116:119], a[152:155], a[68:71], v[116:119]
  ds_read_b64_tr_b16 a[140:141], v2 offset:21568
  v_mfma_f32_16x16x32_bf16 v[116:119], a[156:159], a[84:87], v[116:119]
  v_mfma_f32_16x16x32_bf16 v[112:115], a[156:159], a[80:83], v[112:115]
  ds_read_b64_tr_b16 a[142:143], v2 offset:25152
  v_mfma_f32_16x16x32_bf16 v[112:115], a[152:155], a[64:67], v[112:115]
  s_waitcnt lgkmcnt(8)
  v_mfma_f32_16x16x32_bf16 v[128:131], a[160:163], a[64:67], v[128:131]
  ds_read_b64_tr_b16 a[144:145], v2 offset:14432
  v_mfma_f32_16x16x32_bf16 v[128:131], a[164:167], a[80:83], v[128:131]
  buffer_load_dwordx4 a[124:127], v0, s[36:39], s11 offen offset:3072 sc1
  v_mfma_f32_16x16x32_bf16 v[132:135], a[164:167], a[84:87], v[132:135]
  ds_read_b64_tr_b16 a[146:147], v2 offset:18016
  v_mfma_f32_16x16x32_bf16 v[132:135], a[160:163], a[68:71], v[132:135]
  v_mfma_f32_16x16x32_bf16 v[136:139], a[160:163], a[72:75], v[136:139]
  s_add_u32 m0, s84, 4096
  ds_read_b64_tr_b16 a[148:149], v2 offset:21600
  v_mfma_f32_16x16x32_bf16 v[136:139], a[164:167], a[88:91], v[136:139]
  v_mfma_f32_16x16x32_bf16 v[140:143], a[164:167], a[92:95], v[140:143]
  ds_read_b64_tr_b16 a[150:151], v2 offset:25184
  v_mfma_f32_16x16x32_bf16 v[140:143], a[160:163], a[76:79], v[140:143]
  v_mfma_f32_16x16x32_bf16 v[156:159], a[168:171], a[76:79], v[156:159]
  buffer_load_dwordx4 v7, s[16:19], s10 offen offset:0 lds
  s_bfe_u32 s11, s82, 0x40010
  v_mfma_f32_16x16x32_bf16 v[156:159], a[172:175], a[92:95], v[156:159]
  s_lshl_b32 s11, s11, 13
  s_add_u32 s11, s11, s85
  ds_read_b64_tr_b16 a[152:153], v2 offset:14464
  v_mfma_f32_16x16x32_bf16 v[152:155], a[172:175], a[88:91], v[152:155]
  ds_read_b64_tr_b16 a[154:155], v2 offset:18048
  v_mfma_f32_16x16x32_bf16 v[152:155], a[168:171], a[72:75], v[152:155]
  v_mfma_f32_16x16x32_bf16 v[148:151], a[168:171], a[68:71], v[148:151]
  ds_read_b64_tr_b16 a[156:157], v2 offset:21632
  v_mfma_f32_16x16x32_bf16 v[148:151], a[172:175], a[84:87], v[148:151]
  buffer_load_dwordx4 a[0:3], v0, s[36:39], s11 offen offset:0 sc1
  v_mfma_f32_16x16x32_bf16 v[144:147], a[172:175], a[80:83], v[144:147]
  ds_read_b64_tr_b16 a[158:159], v2 offset:25216
  v_mfma_f32_16x16x32_bf16 v[144:147], a[168:171], a[64:67], v[144:147]
  s_waitcnt lgkmcnt(8)
  v_mfma_f32_16x16x32_bf16 v[160:163], a[128:131], a[64:67], v[160:163]
  ds_read_b64_tr_b16 a[160:161], v2 offset:14496
  v_mfma_f32_16x16x32_bf16 v[160:163], a[132:135], a[80:83], v[160:163]
  v_mfma_f32_16x16x32_bf16 v[164:167], a[132:135], a[84:87], v[164:167]
  ds_read_b64_tr_b16 a[162:163], v2 offset:18080
  v_mfma_f32_16x16x32_bf16 v[164:167], a[128:131], a[68:71], v[164:167]
  v_mfma_f32_16x16x32_bf16 v[168:171], a[128:131], a[72:75], v[168:171]
  ds_read_b64_tr_b16 a[164:165], v2 offset:21664
  v_mfma_f32_16x16x32_bf16 v[168:171], a[132:135], a[88:91], v[168:171]
  v_mfma_f32_16x16x32_bf16 v[172:175], a[132:135], a[92:95], v[172:175]
  ds_read_b64_tr_b16 a[166:167], v2 offset:25248
  v_mfma_f32_16x16x32_bf16 v[172:175], a[128:131], a[76:79], v[172:175]
  s_waitcnt vmcnt(12)
  s_barrier
  buffer_load_dwordx4 v8, s[16:19], s10 offen offset:1024 lds
  v_mfma_f32_16x16x32_bf16 v[188:191], a[136:139], a[76:79], v[188:191]
  ds_read_b64_tr_b16 a[168:169], v2 offset:14528
  v_mfma_f32_16x16x32_bf16 v[188:191], a[140:143], a[92:95], v[188:191]
  v_mfma_f32_16x16x32_bf16 v[184:187], a[140:143], a[88:91], v[184:187]
  ds_read_b64_tr_b16 a[170:171], v2 offset:18112
  v_mfma_f32_16x16x32_bf16 v[184:187], a[136:139], a[72:75], v[184:187]
  v_mfma_f32_16x16x32_bf16 v[180:183], a[136:139], a[68:71], v[180:183]
  buffer_load_dwordx4 a[4:7], v0, s[36:39], s11 offen offset:1024 sc1
  v_mfma_f32_16x16x32_bf16 v[180:183], a[140:143], a[84:87], v[180:183]
  ds_read_b64_tr_b16 a[172:173], v2 offset:21696
  v_mfma_f32_16x16x32_bf16 v[176:179], a[140:143], a[80:83], v[176:179]
  ds_read_b64_tr_b16 a[174:175], v2 offset:25280
  v_mfma_f32_16x16x32_bf16 v[176:179], a[136:139], a[64:67], v[176:179]
  s_waitcnt lgkmcnt(8)
  v_mfma_f32_16x16x32_bf16 v[192:195], a[144:147], a[64:67], v[192:195]
  ds_read_b64_tr_b16 a[128:129], v2 offset:28672
  v_mfma_f32_16x16x32_bf16 v[192:195], a[148:151], a[80:83], v[192:195]
  v_mfma_f32_16x16x32_bf16 v[196:199], a[148:151], a[84:87], v[196:199]
  ds_read_b64_tr_b16 a[130:131], v2 offset:32256
  v_mfma_f32_16x16x32_bf16 v[196:199], a[144:147], a[68:71], v[196:199]
  v_mfma_f32_16x16x32_bf16 v[200:203], a[144:147], a[72:75], v[200:203]
  ds_read_b64_tr_b16 a[132:133], v2 offset:35840
  v_mfma_f32_16x16x32_bf16 v[200:203], a[148:151], a[88:91], v[200:203]
  v_mfma_f32_16x16x32_bf16 v[204:207], a[148:151], a[92:95], v[204:207]
  buffer_load_dwordx4 v9, s[16:19], s10 offen offset:2048 lds
  v_mfma_f32_16x16x32_bf16 v[204:207], a[144:147], a[76:79], v[204:207]
  ds_read_b64_tr_b16 a[134:135], v2 offset:39424
  v_mfma_f32_16x16x32_bf16 v[220:223], a[152:155], a[76:79], v[220:223]
  ds_read_b64_tr_b16 a[136:137], v2 offset:28704
  v_mfma_f32_16x16x32_bf16 v[220:223], a[156:159], a[92:95], v[220:223]
  v_mfma_f32_16x16x32_bf16 v[216:219], a[156:159], a[88:91], v[216:219]
  ds_read_b64_tr_b16 a[138:139], v2 offset:32288
  v_mfma_f32_16x16x32_bf16 v[216:219], a[152:155], a[72:75], v[216:219]
  buffer_load_dwordx4 a[8:11], v0, s[36:39], s11 offen offset:2048 sc1
  v_mfma_f32_16x16x32_bf16 v[212:215], a[152:155], a[68:71], v[212:215]
  ds_read_b64_tr_b16 a[140:141], v2 offset:35872
  v_mfma_f32_16x16x32_bf16 v[212:215], a[156:159], a[84:87], v[212:215]
  v_mfma_f32_16x16x32_bf16 v[208:211], a[156:159], a[80:83], v[208:211]
  ds_read_b64_tr_b16 a[142:143], v2 offset:39456
  v_mfma_f32_16x16x32_bf16 v[208:211], a[152:155], a[64:67], v[208:211]
  s_waitcnt lgkmcnt(8)
  v_mfma_f32_16x16x32_bf16 v[224:227], a[160:163], a[64:67], v[224:227]
  ds_read_b64_tr_b16 a[144:145], v2 offset:28736
  v_mfma_f32_16x16x32_bf16 v[224:227], a[164:167], a[80:83], v[224:227]
  v_mfma_f32_16x16x32_bf16 v[228:231], a[164:167], a[84:87], v[228:231]
  ds_read_b64_tr_b16 a[146:147], v2 offset:32320
  v_mfma_f32_16x16x32_bf16 v[228:231], a[160:163], a[68:71], v[228:231]
  v_mfma_f32_16x16x32_bf16 v[232:235], a[160:163], a[72:75], v[232:235]
  ds_read_b64_tr_b16 a[148:149], v2 offset:35904
  v_mfma_f32_16x16x32_bf16 v[232:235], a[164:167], a[88:91], v[232:235]
  buffer_load_dwordx4 a[12:15], v0, s[36:39], s11 offen offset:3072 sc1
  v_mfma_f32_16x16x32_bf16 v[236:239], a[164:167], a[92:95], v[236:239]
  ds_read_b64_tr_b16 a[150:151], v2 offset:39488
  v_mfma_f32_16x16x32_bf16 v[236:239], a[160:163], a[76:79], v[236:239]
  v_mfma_f32_16x16x32_bf16 v[252:255], a[168:171], a[76:79], v[252:255]
  ds_read_b64_tr_b16 a[152:153], v2 offset:28768
  v_mfma_f32_16x16x32_bf16 v[252:255], a[172:175], a[92:95], v[252:255]
  s_bfe_u32 s10, s82, 0x40014
  s_mul_i32 s10, s10, 458752
  s_add_u32 m0, s84, 28672
  v_mfma_f32_16x16x32_bf16 v[248:251], a[172:175], a[88:91], v[248:251]
  ds_read_b64_tr_b16 a[154:155], v2 offset:32352
  v_mfma_f32_16x16x32_bf16 v[248:251], a[168:171], a[72:75], v[248:251]
  v_mfma_f32_16x16x32_bf16 v[244:247], a[168:171], a[68:71], v[244:247]
  ds_read_b64_tr_b16 a[156:157], v2 offset:35936
  v_mfma_f32_16x16x32_bf16 v[244:247], a[172:175], a[84:87], v[244:247]
  buffer_load_dwordx4 v3, s[16:19], s10 offen offset:0 lds
  v_mfma_f32_16x16x32_bf16 v[240:243], a[172:175], a[80:83], v[240:243]
  ds_read_b64_tr_b16 a[158:159], v2 offset:39520
  v_mfma_f32_16x16x32_bf16 v[240:243], a[168:171], a[64:67], v[240:243]
  s_waitcnt vmcnt(8) lgkmcnt(8)
  v_mfma_f32_16x16x32_bf16 v[32:35], a[128:131], a[96:99], v[32:35]
  s_add_u32 s11, s11, 4096
  ds_read_b64_tr_b16 a[160:161], v2 offset:28800
  v_mfma_f32_16x16x32_bf16 v[32:35], a[132:135], a[112:115], v[32:35]
  v_mfma_f32_16x16x32_bf16 v[36:39], a[132:135], a[116:119], v[36:39]
  ds_read_b64_tr_b16 a[162:163], v2 offset:32384
  v_mfma_f32_16x16x32_bf16 v[36:39], a[128:131], a[100:103], v[36:39]
  v_mfma_f32_16x16x32_bf16 v[40:43], a[128:131], a[104:107], v[40:43]
  buffer_load_dwordx4 a[16:19], v0, s[36:39], s11 offen offset:0 sc1
  v_mfma_f32_16x16x32_bf16 v[40:43], a[132:135], a[120:123], v[40:43]
  ds_read_b64_tr_b16 a[164:165], v2 offset:35968
  v_mfma_f32_16x16x32_bf16 v[44:47], a[132:135], a[124:127], v[44:47]
  ds_read_b64_tr_b16 a[166:167], v2 offset:39552
  v_mfma_f32_16x16x32_bf16 v[44:47], a[128:131], a[108:111], v[44:47]
  v_mfma_f32_16x16x32_bf16 v[60:63], a[136:139], a[108:111], v[60:63]
  ds_read_b64_tr_b16 a[168:169], v2 offset:28832
  v_mfma_f32_16x16x32_bf16 v[60:63], a[140:143], a[124:127], v[60:63]
  v_mfma_f32_16x16x32_bf16 v[56:59], a[140:143], a[120:123], v[56:59]
  ds_read_b64_tr_b16 a[170:171], v2 offset:32416
  v_mfma_f32_16x16x32_bf16 v[56:59], a[136:139], a[104:107], v[56:59]
  buffer_load_dwordx4 v4, s[16:19], s10 offen offset:1024 lds
  v_mfma_f32_16x16x32_bf16 v[52:55], a[136:139], a[100:103], v[52:55]
  ds_read_b64_tr_b16 a[172:173], v2 offset:36000
  v_mfma_f32_16x16x32_bf16 v[52:55], a[140:143], a[116:119], v[52:55]
  v_mfma_f32_16x16x32_bf16 v[48:51], a[140:143], a[112:115], v[48:51]
  ds_read_b64_tr_b16 a[174:175], v2 offset:39584
  v_mfma_f32_16x16x32_bf16 v[48:51], a[136:139], a[96:99], v[48:51]
  s_waitcnt lgkmcnt(8)
  v_mfma_f32_16x16x32_bf16 v[64:67], a[144:147], a[96:99], v[64:67]
  ds_read_b64_tr_b16 a[128:129], v2 offset:28864
  v_mfma_f32_16x16x32_bf16 v[64:67], a[148:151], a[112:115], v[64:67]
  v_mfma_f32_16x16x32_bf16 v[68:71], a[148:151], a[116:119], v[68:71]
  ds_read_b64_tr_b16 a[130:131], v2 offset:32448
  v_mfma_f32_16x16x32_bf16 v[68:71], a[144:147], a[100:103], v[68:71]
  buffer_load_dwordx4 a[20:23], v0, s[36:39], s11 offen offset:1024 sc1
  v_mfma_f32_16x16x32_bf16 v[72:75], a[144:147], a[104:107], v[72:75]
  ds_read_b64_tr_b16 a[132:133], v2 offset:36032
  v_mfma_f32_16x16x32_bf16 v[72:75], a[148:151], a[120:123], v[72:75]
  v_mfma_f32_16x16x32_bf16 v[76:79], a[148:151], a[124:127], v[76:79]
  ds_read_b64_tr_b16 a[134:135], v2 offset:39616
  v_mfma_f32_16x16x32_bf16 v[76:79], a[144:147], a[108:111], v[76:79]
  v_mfma_f32_16x16x32_bf16 v[92:95], a[152:155], a[108:111], v[92:95]
  ds_read_b64_tr_b16 a[136:137], v2 offset:43008
  v_mfma_f32_16x16x32_bf16 v[92:95], a[156:159], a[124:127], v[92:95]
  v_mfma_f32_16x16x32_bf16 v[88:91], a[156:159], a[120:123], v[88:91]
  buffer_load_dwordx4 v5, s[16:19], s10 offen offset:2048 lds
  v_mfma_f32_16x16x32_bf16 v[88:91], a[152:155], a[104:107], v[88:91]
  ds_read_b64_tr_b16 a[138:139], v2 offset:46592
  v_mfma_f32_16x16x32_bf16 v[84:87], a[152:155], a[100:103], v[84:87]
  ds_read_b64_tr_b16 a[140:141], v2 offset:50176
  v_mfma_f32_16x16x32_bf16 v[84:87], a[156:159], a[116:119], v[84:87]
  v_mfma_f32_16x16x32_bf16 v[80:83], a[156:159], a[112:115], v[80:83]
  ds_read_b64_tr_b16 a[142:143], v2 offset:53760
  v_mfma_f32_16x16x32_bf16 v[80:83], a[152:155], a[96:99], v[80:83]
  s_waitcnt lgkmcnt(8)
  v_mfma_f32_16x16x32_bf16 v[96:99], a[160:163], a[96:99], v[96:99]
  ds_read_b64_tr_b16 a[144:145], v2 offset:43040
  v_mfma_f32_16x16x32_bf16 v[96:99], a[164:167], a[112:115], v[96:99]
  v_mfma_f32_16x16x32_bf16 v[100:103], a[164:167], a[116:119], v[100:103]
  buffer_load_dwordx4 a[24:27], v0, s[36:39], s11 offen offset:2048 sc1
  v_mfma_f32_16x16x32_bf16 v[100:103], a[160:163], a[100:103], v[100:103]
  ds_read_b64_tr_b16 a[146:147], v2 offset:46624
  v_mfma_f32_16x16x32_bf16 v[104:107], a[160:163], a[104:107], v[104:107]
  ds_read_b64_tr_b16 a[148:149], v2 offset:50208
  v_mfma_f32_16x16x32_bf16 v[104:107], a[164:167], a[120:123], v[104:107]
  v_mfma_f32_16x16x32_bf16 v[108:111], a[164:167], a[124:127], v[108:111]
  ds_read_b64_tr_b16 a[150:151], v2 offset:53792
  v_mfma_f32_16x16x32_bf16 v[108:111], a[160:163], a[108:111], v[108:111]
  v_mfma_f32_16x16x32_bf16 v[124:127], a[168:171], a[108:111], v[124:127]
  ds_read_b64_tr_b16 a[152:153], v2 offset:43072
  v_mfma_f32_16x16x32_bf16 v[124:127], a[172:175], a[124:127], v[124:127]
  buffer_load_dwordx4 v6, s[16:19], s10 offen offset:3072 lds
  v_mfma_f32_16x16x32_bf16 v[120:123], a[172:175], a[120:123], v[120:123]
  ds_read_b64_tr_b16 a[154:155], v2 offset:46656
  v_mfma_f32_16x16x32_bf16 v[120:123], a[168:171], a[104:107], v[120:123]
  v_mfma_f32_16x16x32_bf16 v[116:119], a[168:171], a[100:103], v[116:119]
  ds_read_b64_tr_b16 a[156:157], v2 offset:50240
  v_mfma_f32_16x16x32_bf16 v[116:119], a[172:175], a[116:119], v[116:119]
  v_mfma_f32_16x16x32_bf16 v[112:115], a[172:175], a[112:115], v[112:115]
  ds_read_b64_tr_b16 a[158:159], v2 offset:53824
  v_mfma_f32_16x16x32_bf16 v[112:115], a[168:171], a[96:99], v[112:115]
  s_waitcnt lgkmcnt(8)
  v_mfma_f32_16x16x32_bf16 v[128:131], a[128:131], a[96:99], v[128:131]
  ds_read_b64_tr_b16 a[160:161], v2 offset:43104
  v_mfma_f32_16x16x32_bf16 v[128:131], a[132:135], a[112:115], v[128:131]
  buffer_load_dwordx4 a[28:31], v0, s[36:39], s11 offen offset:3072 sc1
  v_mfma_f32_16x16x32_bf16 v[132:135], a[132:135], a[116:119], v[132:135]
  ds_read_b64_tr_b16 a[162:163], v2 offset:46688
  v_mfma_f32_16x16x32_bf16 v[132:135], a[128:131], a[100:103], v[132:135]
  v_mfma_f32_16x16x32_bf16 v[136:139], a[128:131], a[104:107], v[136:139]
  s_add_u32 m0, s84, 32768
  ds_read_b64_tr_b16 a[164:165], v2 offset:50272
  v_mfma_f32_16x16x32_bf16 v[136:139], a[132:135], a[120:123], v[136:139]
  v_mfma_f32_16x16x32_bf16 v[140:143], a[132:135], a[124:127], v[140:143]
  ds_read_b64_tr_b16 a[166:167], v2 offset:53856
  v_mfma_f32_16x16x32_bf16 v[140:143], a[128:131], a[108:111], v[140:143]
  v_mfma_f32_16x16x32_bf16 v[156:159], a[136:139], a[108:111], v[156:159]
  buffer_load_dwordx4 v7, s[16:19], s10 offen offset:0 lds
  s_bfe_u32 s11, s82, 0x40014
  v_mfma_f32_16x16x32_bf16 v[156:159], a[140:143], a[124:127], v[156:159]
  s_lshl_b32 s11, s11, 13
  s_add_u32 s11, s11, s85
  ds_read_b64_tr_b16 a[168:169], v2 offset:43136
  v_mfma_f32_16x16x32_bf16 v[152:155], a[140:143], a[120:123], v[152:155]
  ds_read_b64_tr_b16 a[170:171], v2 offset:46720
  v_mfma_f32_16x16x32_bf16 v[152:155], a[136:139], a[104:107], v[152:155]
  v_mfma_f32_16x16x32_bf16 v[148:151], a[136:139], a[100:103], v[148:151]
  ds_read_b64_tr_b16 a[172:173], v2 offset:50304
  v_mfma_f32_16x16x32_bf16 v[148:151], a[140:143], a[116:119], v[148:151]
  buffer_load_dwordx4 a[32:35], v0, s[36:39], s11 offen offset:0 sc1
  v_mfma_f32_16x16x32_bf16 v[144:147], a[140:143], a[112:115], v[144:147]
  ds_read_b64_tr_b16 a[174:175], v2 offset:53888
  v_mfma_f32_16x16x32_bf16 v[144:147], a[136:139], a[96:99], v[144:147]
  s_waitcnt lgkmcnt(8)
  v_mfma_f32_16x16x32_bf16 v[160:163], a[144:147], a[96:99], v[160:163]
  ds_read_b64_tr_b16 a[128:129], v2 offset:43168
  v_mfma_f32_16x16x32_bf16 v[160:163], a[148:151], a[112:115], v[160:163]
  v_mfma_f32_16x16x32_bf16 v[164:167], a[148:151], a[116:119], v[164:167]
  ds_read_b64_tr_b16 a[130:131], v2 offset:46752
  v_mfma_f32_16x16x32_bf16 v[164:167], a[144:147], a[100:103], v[164:167]
  v_mfma_f32_16x16x32_bf16 v[168:171], a[144:147], a[104:107], v[168:171]
  ds_read_b64_tr_b16 a[132:133], v2 offset:50336
  v_mfma_f32_16x16x32_bf16 v[168:171], a[148:151], a[120:123], v[168:171]
  v_mfma_f32_16x16x32_bf16 v[172:175], a[148:151], a[124:127], v[172:175]
  ds_read_b64_tr_b16 a[134:135], v2 offset:53920
  v_mfma_f32_16x16x32_bf16 v[172:175], a[144:147], a[108:111], v[172:175]
  s_waitcnt vmcnt(12)
  s_barrier
  buffer_load_dwordx4 v8, s[16:19], s10 offen offset:1024 lds
  v_mfma_f32_16x16x32_bf16 v[188:191], a[152:155], a[108:111], v[188:191]
  ds_read_b64_tr_b16 a[136:137], v2 offset:43200
  v_mfma_f32_16x16x32_bf16 v[188:191], a[156:159], a[124:127], v[188:191]
  v_mfma_f32_16x16x32_bf16 v[184:187], a[156:159], a[120:123], v[184:187]
  ds_read_b64_tr_b16 a[138:139], v2 offset:46784
  v_mfma_f32_16x16x32_bf16 v[184:187], a[152:155], a[104:107], v[184:187]
  v_mfma_f32_16x16x32_bf16 v[180:183], a[152:155], a[100:103], v[180:183]
  buffer_load_dwordx4 a[36:39], v0, s[36:39], s11 offen offset:1024 sc1
  v_mfma_f32_16x16x32_bf16 v[180:183], a[156:159], a[116:119], v[180:183]
  ds_read_b64_tr_b16 a[140:141], v2 offset:50368
  v_mfma_f32_16x16x32_bf16 v[176:179], a[156:159], a[112:115], v[176:179]
  ds_read_b64_tr_b16 a[142:143], v2 offset:53952
  v_mfma_f32_16x16x32_bf16 v[176:179], a[152:155], a[96:99], v[176:179]
  s_waitcnt lgkmcnt(8)
  v_mfma_f32_16x16x32_bf16 v[192:195], a[160:163], a[96:99], v[192:195]
  ds_read_b64_tr_b16 a[144:145], v1 offset:0
  v_mfma_f32_16x16x32_bf16 v[192:195], a[164:167], a[112:115], v[192:195]
  v_mfma_f32_16x16x32_bf16 v[196:199], a[164:167], a[116:119], v[196:199]
  ds_read_b64_tr_b16 a[146:147], v1 offset:3584
  v_mfma_f32_16x16x32_bf16 v[196:199], a[160:163], a[100:103], v[196:199]
  v_mfma_f32_16x16x32_bf16 v[200:203], a[160:163], a[104:107], v[200:203]
  ds_read_b64_tr_b16 a[148:149], v1 offset:7168
  v_mfma_f32_16x16x32_bf16 v[200:203], a[164:167], a[120:123], v[200:203]
  v_mfma_f32_16x16x32_bf16 v[204:207], a[164:167], a[124:127], v[204:207]
  buffer_load_dwordx4 v9, s[16:19], s10 offen offset:2048 lds
  v_mfma_f32_16x16x32_bf16 v[204:207], a[160:163], a[108:111], v[204:207]
  ds_read_b64_tr_b16 a[150:151], v1 offset:10752
  v_mfma_f32_16x16x32_bf16 v[220:223], a[168:171], a[108:111], v[220:223]
  ds_read_b64_tr_b16 a[152:153], v1 offset:32
  v_mfma_f32_16x16x32_bf16 v[220:223], a[172:175], a[124:127], v[220:223]
  v_mfma_f32_16x16x32_bf16 v[216:219], a[172:175], a[120:123], v[216:219]
  ds_read_b64_tr_b16 a[154:155], v1 offset:3616
  v_mfma_f32_16x16x32_bf16 v[216:219], a[168:171], a[104:107], v[216:219]
  buffer_load_dwordx4 a[40:43], v0, s[36:39], s11 offen offset:2048 sc1
  v_mfma_f32_16x16x32_bf16 v[212:215], a[168:171], a[100:103], v[212:215]
  ds_read_b64_tr_b16 a[156:157], v1 offset:7200
  v_mfma_f32_16x16x32_bf16 v[212:215], a[172:175], a[116:119], v[212:215]
  v_mfma_f32_16x16x32_bf16 v[208:211], a[172:175], a[112:115], v[208:211]
  ds_read_b64_tr_b16 a[158:159], v1 offset:10784
  v_mfma_f32_16x16x32_bf16 v[208:211], a[168:171], a[96:99], v[208:211]
  s_waitcnt lgkmcnt(8)
  v_mfma_f32_16x16x32_bf16 v[224:227], a[128:131], a[96:99], v[224:227]
  ds_read_b64_tr_b16 a[160:161], v1 offset:64
  v_mfma_f32_16x16x32_bf16 v[224:227], a[132:135], a[112:115], v[224:227]
  v_mfma_f32_16x16x32_bf16 v[228:231], a[132:135], a[116:119], v[228:231]
  ds_read_b64_tr_b16 a[162:163], v1 offset:3648
  v_mfma_f32_16x16x32_bf16 v[228:231], a[128:131], a[100:103], v[228:231]
  v_mfma_f32_16x16x32_bf16 v[232:235], a[128:131], a[104:107], v[232:235]
  ds_read_b64_tr_b16 a[164:165], v1 offset:7232
  v_mfma_f32_16x16x32_bf16 v[232:235], a[132:135], a[120:123], v[232:235]
  buffer_load_dwordx4 a[44:47], v0, s[36:39], s11 offen offset:3072 sc1
  v_mfma_f32_16x16x32_bf16 v[236:239], a[132:135], a[124:127], v[236:239]
  ds_read_b64_tr_b16 a[166:167], v1 offset:10816
  v_mfma_f32_16x16x32_bf16 v[236:239], a[128:131], a[108:111], v[236:239]
  v_mfma_f32_16x16x32_bf16 v[252:255], a[136:139], a[108:111], v[252:255]
  ds_read_b64_tr_b16 a[168:169], v1 offset:96
  v_mfma_f32_16x16x32_bf16 v[252:255], a[140:143], a[124:127], v[252:255]
  s_bfe_u32 s10, s82, 0x40018
  s_mul_i32 s10, s10, 458752
  s_add_u32 m0, s84, 57344
  v_mfma_f32_16x16x32_bf16 v[248:251], a[140:143], a[120:123], v[248:251]
  ds_read_b64_tr_b16 a[170:171], v1 offset:3680
  v_mfma_f32_16x16x32_bf16 v[248:251], a[136:139], a[104:107], v[248:251]
  v_mfma_f32_16x16x32_bf16 v[244:247], a[136:139], a[100:103], v[244:247]
  ds_read_b64_tr_b16 a[172:173], v1 offset:7264
  v_mfma_f32_16x16x32_bf16 v[244:247], a[140:143], a[116:119], v[244:247]
  buffer_load_dwordx4 v3, s[16:19], s10 offen offset:0 lds
  v_mfma_f32_16x16x32_bf16 v[240:243], a[140:143], a[112:115], v[240:243]
  ds_read_b64_tr_b16 a[174:175], v1 offset:10848
  v_mfma_f32_16x16x32_bf16 v[240:243], a[136:139], a[96:99], v[240:243]
  s_waitcnt vmcnt(8) lgkmcnt(8)
  v_mfma_f32_16x16x32_bf16 v[32:35], a[144:147], a[0:3], v[32:35]
  s_add_u32 s11, s11, 4096
  ds_read_b64_tr_b16 a[128:129], v1 offset:128
  v_mfma_f32_16x16x32_bf16 v[32:35], a[148:151], a[16:19], v[32:35]
  v_mfma_f32_16x16x32_bf16 v[36:39], a[148:151], a[20:23], v[36:39]
  ds_read_b64_tr_b16 a[130:131], v1 offset:3712
  v_mfma_f32_16x16x32_bf16 v[36:39], a[144:147], a[4:7], v[36:39]
  v_mfma_f32_16x16x32_bf16 v[40:43], a[144:147], a[8:11], v[40:43]
  buffer_load_dwordx4 a[48:51], v0, s[36:39], s11 offen offset:0 sc1
  v_mfma_f32_16x16x32_bf16 v[40:43], a[148:151], a[24:27], v[40:43]
  ds_read_b64_tr_b16 a[132:133], v1 offset:7296
  v_mfma_f32_16x16x32_bf16 v[44:47], a[148:151], a[28:31], v[44:47]
  ds_read_b64_tr_b16 a[134:135], v1 offset:10880
  v_mfma_f32_16x16x32_bf16 v[44:47], a[144:147], a[12:15], v[44:47]
  v_mfma_f32_16x16x32_bf16 v[60:63], a[152:155], a[12:15], v[60:63]
  ds_read_b64_tr_b16 a[136:137], v1 offset:160
  v_mfma_f32_16x16x32_bf16 v[60:63], a[156:159], a[28:31], v[60:63]
  v_mfma_f32_16x16x32_bf16 v[56:59], a[156:159], a[24:27], v[56:59]
  ds_read_b64_tr_b16 a[138:139], v1 offset:3744
  v_mfma_f32_16x16x32_bf16 v[56:59], a[152:155], a[8:11], v[56:59]
  buffer_load_dwordx4 v4, s[16:19], s10 offen offset:1024 lds
  v_mfma_f32_16x16x32_bf16 v[52:55], a[152:155], a[4:7], v[52:55]
  ds_read_b64_tr_b16 a[140:141], v1 offset:7328
  v_mfma_f32_16x16x32_bf16 v[52:55], a[156:159], a[20:23], v[52:55]
  v_mfma_f32_16x16x32_bf16 v[48:51], a[156:159], a[16:19], v[48:51]
  ds_read_b64_tr_b16 a[142:143], v1 offset:10912
  v_mfma_f32_16x16x32_bf16 v[48:51], a[152:155], a[0:3], v[48:51]
  s_waitcnt lgkmcnt(8)
  v_mfma_f32_16x16x32_bf16 v[64:67], a[160:163], a[0:3], v[64:67]
  ds_read_b64_tr_b16 a[144:145], v1 offset:192
  v_mfma_f32_16x16x32_bf16 v[64:67], a[164:167], a[16:19], v[64:67]
  v_mfma_f32_16x16x32_bf16 v[68:71], a[164:167], a[20:23], v[68:71]
  ds_read_b64_tr_b16 a[146:147], v1 offset:3776
  v_mfma_f32_16x16x32_bf16 v[68:71], a[160:163], a[4:7], v[68:71]
  buffer_load_dwordx4 a[52:55], v0, s[36:39], s11 offen offset:1024 sc1
  v_mfma_f32_16x16x32_bf16 v[72:75], a[160:163], a[8:11], v[72:75]
  ds_read_b64_tr_b16 a[148:149], v1 offset:7360
  v_mfma_f32_16x16x32_bf16 v[72:75], a[164:167], a[24:27], v[72:75]
  v_mfma_f32_16x16x32_bf16 v[76:79], a[164:167], a[28:31], v[76:79]
  ds_read_b64_tr_b16 a[150:151], v1 offset:10944
  v_mfma_f32_16x16x32_bf16 v[76:79], a[160:163], a[12:15], v[76:79]
  v_mfma_f32_16x16x32_bf16 v[92:95], a[168:171], a[12:15], v[92:95]
  ds_read_b64_tr_b16 a[152:153], v1 offset:14336
  v_mfma_f32_16x16x32_bf16 v[92:95], a[172:175], a[28:31], v[92:95]
  v_mfma_f32_16x16x32_bf16 v[88:91], a[172:175], a[24:27], v[88:91]
  buffer_load_dwordx4 v5, s[16:19], s10 offen offset:2048 lds
  v_mfma_f32_16x16x32_bf16 v[88:91], a[168:171], a[8:11], v[88:91]
  ds_read_b64_tr_b16 a[154:155], v1 offset:17920
  v_mfma_f32_16x16x32_bf16 v[84:87], a[168:171], a[4:7], v[84:87]
  ds_read_b64_tr_b16 a[156:157], v1 offset:21504
  v_mfma_f32_16x16x32_bf16 v[84:87], a[172:175], a[20:23], v[84:87]
  v_mfma_f32_16x16x32_bf16 v[80:83], a[172:175], a[16:19], v[80:83]
  ds_read_b64_tr_b16 a[158:159], v1 offset:25088
  v_mfma_f32_16x16x32_bf16 v[80:83], a[168:171], a[0:3], v[80:83]
  s_waitcnt lgkmcnt(8)
  v_mfma_f32_16x16x32_bf16 v[96:99], a[128:131], a[0:3], v[96:99]
  ds_read_b64_tr_b16 a[160:161], v1 offset:14368
  v_mfma_f32_16x16x32_bf16 v[96:99], a[132:135], a[16:19], v[96:99]
  v_mfma_f32_16x16x32_bf16 v[100:103], a[132:135], a[20:23], v[100:103]
  buffer_load_dwordx4 a[56:59], v0, s[36:39], s11 offen offset:2048 sc1
  v_mfma_f32_16x16x32_bf16 v[100:103], a[128:131], a[4:7], v[100:103]
  ds_read_b64_tr_b16 a[162:163], v1 offset:17952
  v_mfma_f32_16x16x32_bf16 v[104:107], a[128:131], a[8:11], v[104:107]
  ds_read_b64_tr_b16 a[164:165], v1 offset:21536
  v_mfma_f32_16x16x32_bf16 v[104:107], a[132:135], a[24:27], v[104:107]
  v_mfma_f32_16x16x32_bf16 v[108:111], a[132:135], a[28:31], v[108:111]
  ds_read_b64_tr_b16 a[166:167], v1 offset:25120
  v_mfma_f32_16x16x32_bf16 v[108:111], a[128:131], a[12:15], v[108:111]
  v_mfma_f32_16x16x32_bf16 v[124:127], a[136:139], a[12:15], v[124:127]
  ds_read_b64_tr_b16 a[168:169], v1 offset:14400
  v_mfma_f32_16x16x32_bf16 v[124:127], a[140:143], a[28:31], v[124:127]
  buffer_load_dwordx4 v6, s[16:19], s10 offen offset:3072 lds
  v_mfma_f32_16x16x32_bf16 v[120:123], a[140:143], a[24:27], v[120:123]
  ds_read_b64_tr_b16 a[170:171], v1 offset:17984
  v_mfma_f32_16x16x32_bf16 v[120:123], a[136:139], a[8:11], v[120:123]
  v_mfma_f32_16x16x32_bf16 v[116:119], a[136:139], a[4:7], v[116:119]
  ds_read_b64_tr_b16 a[172:173], v1 offset:21568
  v_mfma_f32_16x16x32_bf16 v[116:119], a[140:143], a[20:23], v[116:119]
  v_mfma_f32_16x16x32_bf16 v[112:115], a[140:143], a[16:19], v[112:115]
  ds_read_b64_tr_b16 a[174:175], v1 offset:25152
  v_mfma_f32_16x16x32_bf16 v[112:115], a[136:139], a[0:3], v[112:115]
  s_waitcnt lgkmcnt(8)
  v_mfma_f32_16x16x32_bf16 v[128:131], a[144:147], a[0:3], v[128:131]
  ds_read_b64_tr_b16 a[128:129], v1 offset:14432
  v_mfma_f32_16x16x32_bf16 v[128:131], a[148:151], a[16:19], v[128:131]
  buffer_load_dwordx4 a[60:63], v0, s[36:39], s11 offen offset:3072 sc1
  v_mfma_f32_16x16x32_bf16 v[132:135], a[148:151], a[20:23], v[132:135]
  ds_read_b64_tr_b16 a[130:131], v1 offset:18016
  v_mfma_f32_16x16x32_bf16 v[132:135], a[144:147], a[4:7], v[132:135]
  v_mfma_f32_16x16x32_bf16 v[136:139], a[144:147], a[8:11], v[136:139]
  s_add_u32 m0, s84, 61440
  ds_read_b64_tr_b16 a[132:133], v1 offset:21600
  v_mfma_f32_16x16x32_bf16 v[136:139], a[148:151], a[24:27], v[136:139]
  v_mfma_f32_16x16x32_bf16 v[140:143], a[148:151], a[28:31], v[140:143]
  ds_read_b64_tr_b16 a[134:135], v1 offset:25184
  v_mfma_f32_16x16x32_bf16 v[140:143], a[144:147], a[12:15], v[140:143]
  v_mfma_f32_16x16x32_bf16 v[156:159], a[152:155], a[12:15], v[156:159]
  buffer_load_dwordx4 v7, s[16:19], s10 offen offset:0 lds
  s_bfe_u32 s11, s82, 0x40018
  v_mfma_f32_16x16x32_bf16 v[156:159], a[156:159], a[28:31], v[156:159]
  s_lshl_b32 s11, s11, 13
  s_add_u32 s11, s11, s85
  ds_read_b64_tr_b16 a[136:137], v1 offset:14464
  v_mfma_f32_16x16x32_bf16 v[152:155], a[156:159], a[24:27], v[152:155]
  ds_read_b64_tr_b16 a[138:139], v1 offset:18048
  v_mfma_f32_16x16x32_bf16 v[152:155], a[152:155], a[8:11], v[152:155]
  v_mfma_f32_16x16x32_bf16 v[148:151], a[152:155], a[4:7], v[148:151]
  ds_read_b64_tr_b16 a[140:141], v1 offset:21632
  v_mfma_f32_16x16x32_bf16 v[148:151], a[156:159], a[20:23], v[148:151]
  buffer_load_dwordx4 a[64:67], v0, s[36:39], s11 offen offset:0 sc1
  v_mfma_f32_16x16x32_bf16 v[144:147], a[156:159], a[16:19], v[144:147]
  ds_read_b64_tr_b16 a[142:143], v1 offset:25216
  v_mfma_f32_16x16x32_bf16 v[144:147], a[152:155], a[0:3], v[144:147]
  s_waitcnt lgkmcnt(8)
  v_mfma_f32_16x16x32_bf16 v[160:163], a[160:163], a[0:3], v[160:163]
  ds_read_b64_tr_b16 a[144:145], v1 offset:14496
  v_mfma_f32_16x16x32_bf16 v[160:163], a[164:167], a[16:19], v[160:163]
  v_mfma_f32_16x16x32_bf16 v[164:167], a[164:167], a[20:23], v[164:167]
  ds_read_b64_tr_b16 a[146:147], v1 offset:18080
  v_mfma_f32_16x16x32_bf16 v[164:167], a[160:163], a[4:7], v[164:167]
  v_mfma_f32_16x16x32_bf16 v[168:171], a[160:163], a[8:11], v[168:171]
  ds_read_b64_tr_b16 a[148:149], v1 offset:21664
  v_mfma_f32_16x16x32_bf16 v[168:171], a[164:167], a[24:27], v[168:171]
  v_mfma_f32_16x16x32_bf16 v[172:175], a[164:167], a[28:31], v[172:175]
  ds_read_b64_tr_b16 a[150:151], v1 offset:25248
  v_mfma_f32_16x16x32_bf16 v[172:175], a[160:163], a[12:15], v[172:175]
  s_waitcnt vmcnt(12)
  s_barrier
  buffer_load_dwordx4 v8, s[16:19], s10 offen offset:1024 lds
  v_mfma_f32_16x16x32_bf16 v[188:191], a[168:171], a[12:15], v[188:191]
  ds_read_b64_tr_b16 a[152:153], v1 offset:14528
  v_mfma_f32_16x16x32_bf16 v[188:191], a[172:175], a[28:31], v[188:191]
  v_mfma_f32_16x16x32_bf16 v[184:187], a[172:175], a[24:27], v[184:187]
  ds_read_b64_tr_b16 a[154:155], v1 offset:18112
  v_mfma_f32_16x16x32_bf16 v[184:187], a[168:171], a[8:11], v[184:187]
  v_mfma_f32_16x16x32_bf16 v[180:183], a[168:171], a[4:7], v[180:183]
  buffer_load_dwordx4 a[68:71], v0, s[36:39], s11 offen offset:1024 sc1
  v_mfma_f32_16x16x32_bf16 v[180:183], a[172:175], a[20:23], v[180:183]
  ds_read_b64_tr_b16 a[156:157], v1 offset:21696
  v_mfma_f32_16x16x32_bf16 v[176:179], a[172:175], a[16:19], v[176:179]
  ds_read_b64_tr_b16 a[158:159], v1 offset:25280
  v_mfma_f32_16x16x32_bf16 v[176:179], a[168:171], a[0:3], v[176:179]
  s_waitcnt lgkmcnt(8)
  v_mfma_f32_16x16x32_bf16 v[192:195], a[128:131], a[0:3], v[192:195]
  ds_read_b64_tr_b16 a[160:161], v1 offset:28672
  v_mfma_f32_16x16x32_bf16 v[192:195], a[132:135], a[16:19], v[192:195]
  v_mfma_f32_16x16x32_bf16 v[196:199], a[132:135], a[20:23], v[196:199]
  ds_read_b64_tr_b16 a[162:163], v1 offset:32256
  v_mfma_f32_16x16x32_bf16 v[196:199], a[128:131], a[4:7], v[196:199]
  v_mfma_f32_16x16x32_bf16 v[200:203], a[128:131], a[8:11], v[200:203]
  ds_read_b64_tr_b16 a[164:165], v1 offset:35840
  v_mfma_f32_16x16x32_bf16 v[200:203], a[132:135], a[24:27], v[200:203]
  v_mfma_f32_16x16x32_bf16 v[204:207], a[132:135], a[28:31], v[204:207]
  buffer_load_dwordx4 v9, s[16:19], s10 offen offset:2048 lds
  v_mfma_f32_16x16x32_bf16 v[204:207], a[128:131], a[12:15], v[204:207]
  ds_read_b64_tr_b16 a[166:167], v1 offset:39424
  v_mfma_f32_16x16x32_bf16 v[220:223], a[136:139], a[12:15], v[220:223]
  ds_read_b64_tr_b16 a[168:169], v1 offset:28704
  v_mfma_f32_16x16x32_bf16 v[220:223], a[140:143], a[28:31], v[220:223]
  v_mfma_f32_16x16x32_bf16 v[216:219], a[140:143], a[24:27], v[216:219]
  ds_read_b64_tr_b16 a[170:171], v1 offset:32288
  v_mfma_f32_16x16x32_bf16 v[216:219], a[136:139], a[8:11], v[216:219]
  buffer_load_dwordx4 a[72:75], v0, s[36:39], s11 offen offset:2048 sc1
  v_mfma_f32_16x16x32_bf16 v[212:215], a[136:139], a[4:7], v[212:215]
  ds_read_b64_tr_b16 a[172:173], v1 offset:35872
  v_mfma_f32_16x16x32_bf16 v[212:215], a[140:143], a[20:23], v[212:215]
  v_mfma_f32_16x16x32_bf16 v[208:211], a[140:143], a[16:19], v[208:211]
  ds_read_b64_tr_b16 a[174:175], v1 offset:39456
  v_mfma_f32_16x16x32_bf16 v[208:211], a[136:139], a[0:3], v[208:211]
  s_waitcnt lgkmcnt(8)
  v_mfma_f32_16x16x32_bf16 v[224:227], a[144:147], a[0:3], v[224:227]
  ds_read_b64_tr_b16 a[128:129], v1 offset:28736
  v_mfma_f32_16x16x32_bf16 v[224:227], a[148:151], a[16:19], v[224:227]
  v_mfma_f32_16x16x32_bf16 v[228:231], a[148:151], a[20:23], v[228:231]
  ds_read_b64_tr_b16 a[130:131], v1 offset:32320
  v_mfma_f32_16x16x32_bf16 v[228:231], a[144:147], a[4:7], v[228:231]
  v_mfma_f32_16x16x32_bf16 v[232:235], a[144:147], a[8:11], v[232:235]
  ds_read_b64_tr_b16 a[132:133], v1 offset:35904
  v_mfma_f32_16x16x32_bf16 v[232:235], a[148:151], a[24:27], v[232:235]
  buffer_load_dwordx4 a[76:79], v0, s[36:39], s11 offen offset:3072 sc1
  v_mfma_f32_16x16x32_bf16 v[236:239], a[148:151], a[28:31], v[236:239]
  ds_read_b64_tr_b16 a[134:135], v1 offset:39488
  v_mfma_f32_16x16x32_bf16 v[236:239], a[144:147], a[12:15], v[236:239]
Hb1:
  s_cbranch_execz Hb1_1
  v_mfma_f32_16x16x32_bf16 v[252:255], a[152:155], a[12:15], v[252:255]
  ds_read_b64_tr_b16 a[136:137], v1 offset:28768
  v_mfma_f32_16x16x32_bf16 v[252:255], a[156:159], a[28:31], v[252:255]
  s_bfe_u32 s10, s82, 0x4001c
  s_mul_i32 s10, s10, 458752
  s_add_u32 m0, s84, 86016
  v_mfma_f32_16x16x32_bf16 v[248:251], a[156:159], a[24:27], v[248:251]
  buffer_load_dwordx4 a[208:211], v0, s[36:39], s20 offen offset:0 sc1
  v_add_u32 v31, 57344, v31
  v_mfma_f32_16x16x32_bf16 v[248:251], a[152:155], a[8:11], v[248:251]
  ds_read_b64_tr_b16 a[138:139], v1 offset:32352
  v_mfma_f32_16x16x32_bf16 v[244:247], a[152:155], a[4:7], v[244:247]
  ds_read_b64_tr_b16 a[140:141], v1 offset:35936
  v_mfma_f32_16x16x32_bf16 v[244:247], a[156:159], a[20:23], v[244:247]
  v_mfma_f32_16x16x32_bf16 v[240:243], a[156:159], a[16:19], v[240:243]
  ds_read_b64_tr_b16 a[142:143], v1 offset:39520
  v_mfma_f32_16x16x32_bf16 v[240:243], a[152:155], a[0:3], v[240:243]
  s_waitcnt vmcnt(8) lgkmcnt(8)
  buffer_load_dwordx4 a[212:215], v0, s[36:39], s20 offen offset:1024 sc1
  v_mfma_f32_16x16x32_bf16 v[32:35], a[160:163], a[32:35], v[32:35]
  ds_read_b64_tr_b16 a[144:145], v1 offset:28800
  v_mfma_f32_16x16x32_bf16 v[32:35], a[164:167], a[48:51], v[32:35]
  v_mfma_f32_16x16x32_bf16 v[36:39], a[164:167], a[52:55], v[36:39]
  ds_read_b64_tr_b16 a[146:147], v1 offset:32384
  v_mfma_f32_16x16x32_bf16 v[36:39], a[160:163], a[36:39], v[36:39]
  v_mfma_f32_16x16x32_bf16 v[40:43], a[160:163], a[40:43], v[40:43]
  buffer_load_dwordx4 v3, s[16:19], s10 offen offset:0 lds
  s_add_u32 s11, s11, 4096
  v_mfma_f32_16x16x32_bf16 v[40:43], a[164:167], a[56:59], v[40:43]
  ds_read_b64_tr_b16 a[148:149], v1 offset:35968
  v_mfma_f32_16x16x32_bf16 v[44:47], a[164:167], a[60:63], v[44:47]
  ds_read_b64_tr_b16 a[150:151], v1 offset:39552
  v_mfma_f32_16x16x32_bf16 v[44:47], a[160:163], a[44:47], v[44:47]
  v_mfma_f32_16x16x32_bf16 v[60:63], a[168:171], a[44:47], v[60:63]
  ds_read_b64_tr_b16 a[152:153], v1 offset:28832
  v_mfma_f32_16x16x32_bf16 v[60:63], a[172:175], a[60:63], v[60:63]
  buffer_load_dwordx4 a[80:83], v0, s[36:39], s11 offen offset:0 sc1
  v_mfma_f32_16x16x32_bf16 v[56:59], a[172:175], a[56:59], v[56:59]
  ds_read_b64_tr_b16 a[154:155], v1 offset:32416
  v_mfma_f32_16x16x32_bf16 v[56:59], a[168:171], a[40:43], v[56:59]
  v_mfma_f32_16x16x32_bf16 v[52:55], a[168:171], a[36:39], v[52:55]
  ds_read_b64_tr_b16 a[156:157], v1 offset:36000
  v_mfma_f32_16x16x32_bf16 v[52:55], a[172:175], a[52:55], v[52:55]
  v_mfma_f32_16x16x32_bf16 v[48:51], a[172:175], a[48:51], v[48:51]
  buffer_load_dwordx4 v4, s[16:19], s10 offen offset:1024 lds
  v_mfma_f32_16x16x32_bf16 v[48:51], a[168:171], a[32:35], v[48:51]
  s_waitcnt lgkmcnt(7)
  ds_read_b64_tr_b16 a[158:159], v1 offset:39584
  v_mfma_f32_16x16x32_bf16 v[64:67], a[128:131], a[32:35], v[64:67]
  ds_read_b64_tr_b16 a[160:161], v1 offset:28864
  v_mfma_f32_16x16x32_bf16 v[64:67], a[132:135], a[48:51], v[64:67]
  v_mfma_f32_16x16x32_bf16 v[68:71], a[132:135], a[52:55], v[68:71]
  ds_read_b64_tr_b16 a[162:163], v1 offset:32448
  v_mfma_f32_16x16x32_bf16 v[68:71], a[128:131], a[36:39], v[68:71]
  buffer_load_dwordx4 a[84:87], v0, s[36:39], s11 offen offset:1024 sc1
  v_mfma_f32_16x16x32_bf16 v[72:75], a[128:131], a[40:43], v[72:75]
  ds_read_b64_tr_b16 a[164:165], v1 offset:36032
  v_mfma_f32_16x16x32_bf16 v[72:75], a[132:135], a[56:59], v[72:75]
  v_mfma_f32_16x16x32_bf16 v[76:79], a[132:135], a[60:63], v[76:79]
  ds_read_b64_tr_b16 a[166:167], v1 offset:39616
  v_mfma_f32_16x16x32_bf16 v[76:79], a[128:131], a[44:47], v[76:79]
  v_mfma_f32_16x16x32_bf16 v[92:95], a[136:139], a[44:47], v[92:95]
  ds_read_b64_tr_b16 a[168:169], v1 offset:43008
  v_mfma_f32_16x16x32_bf16 v[92:95], a[140:143], a[60:63], v[92:95]
  v_mfma_f32_16x16x32_bf16 v[88:91], a[140:143], a[56:59], v[88:91]
  buffer_load_dwordx4 v5, s[16:19], s10 offen offset:2048 lds
  v_mfma_f32_16x16x32_bf16 v[88:91], a[136:139], a[40:43], v[88:91]
  ds_read_b64_tr_b16 a[170:171], v1 offset:46592
  v_mfma_f32_16x16x32_bf16 v[84:87], a[136:139], a[36:39], v[84:87]
  ds_read_b64_tr_b16 a[172:173], v1 offset:50176
  v_mfma_f32_16x16x32_bf16 v[84:87], a[140:143], a[52:55], v[84:87]
  v_mfma_f32_16x16x32_bf16 v[80:83], a[140:143], a[48:51], v[80:83]
  ds_read_b64_tr_b16 a[174:175], v1 offset:53760
  v_mfma_f32_16x16x32_bf16 v[80:83], a[136:139], a[32:35], v[80:83]
  s_waitcnt lgkmcnt(8)
  v_mfma_f32_16x16x32_bf16 v[96:99], a[144:147], a[32:35], v[96:99]
  ds_read_b64_tr_b16 a[128:129], v1 offset:43040
  v_mfma_f32_16x16x32_bf16 v[96:99], a[148:151], a[48:51], v[96:99]
  v_mfma_f32_16x16x32_bf16 v[100:103], a[148:151], a[52:55], v[100:103]
  buffer_load_dwordx4 a[88:91], v0, s[36:39], s11 offen offset:2048 sc1
  v_mfma_f32_16x16x32_bf16 v[100:103], a[144:147], a[36:39], v[100:103]
  ds_read_b64_tr_b16 a[130:131], v1 offset:46624
  v_mfma_f32_16x16x32_bf16 v[104:107], a[144:147], a[40:43], v[104:107]
  ds_read_b64_tr_b16 a[132:133], v1 offset:50208
  v_mfma_f32_16x16x32_bf16 v[104:107], a[148:151], a[56:59], v[104:107]
  v_mfma_f32_16x16x32_bf16 v[108:111], a[148:151], a[60:63], v[108:111]
  ds_read_b64_tr_b16 a[134:135], v1 offset:53792
  v_mfma_f32_16x16x32_bf16 v[108:111], a[144:147], a[44:47], v[108:111]
  v_mfma_f32_16x16x32_bf16 v[124:127], a[152:155], a[44:47], v[124:127]
  ds_read_b64_tr_b16 a[136:137], v1 offset:43072
  v_mfma_f32_16x16x32_bf16 v[124:127], a[156:159], a[60:63], v[124:127]
  buffer_load_dwordx4 v6, s[16:19], s10 offen offset:3072 lds
  v_mfma_f32_16x16x32_bf16 v[120:123], a[156:159], a[56:59], v[120:123]
  ds_read_b64_tr_b16 a[138:139], v1 offset:46656
  v_mfma_f32_16x16x32_bf16 v[120:123], a[152:155], a[40:43], v[120:123]
  v_mfma_f32_16x16x32_bf16 v[116:119], a[152:155], a[36:39], v[116:119]
  ds_read_b64_tr_b16 a[140:141], v1 offset:50240
  v_mfma_f32_16x16x32_bf16 v[116:119], a[156:159], a[52:55], v[116:119]
  v_mfma_f32_16x16x32_bf16 v[112:115], a[156:159], a[48:51], v[112:115]
  ds_read_b64_tr_b16 a[142:143], v1 offset:53824
  v_mfma_f32_16x16x32_bf16 v[112:115], a[152:155], a[32:35], v[112:115]
  s_waitcnt lgkmcnt(8)
  v_mfma_f32_16x16x32_bf16 v[128:131], a[160:163], a[32:35], v[128:131]
  ds_read_b64_tr_b16 a[144:145], v1 offset:43104
  v_mfma_f32_16x16x32_bf16 v[128:131], a[164:167], a[48:51], v[128:131]
  buffer_load_dwordx4 a[92:95], v0, s[36:39], s11 offen offset:3072 sc1
  v_mfma_f32_16x16x32_bf16 v[132:135], a[164:167], a[52:55], v[132:135]
  ds_read_b64_tr_b16 a[146:147], v1 offset:46688
  v_mfma_f32_16x16x32_bf16 v[132:135], a[160:163], a[36:39], v[132:135]
  v_mfma_f32_16x16x32_bf16 v[136:139], a[160:163], a[40:43], v[136:139]
  s_add_u32 m0, s84, 90112
  ds_read_b64_tr_b16 a[148:149], v1 offset:50272
  v_mfma_f32_16x16x32_bf16 v[136:139], a[164:167], a[56:59], v[136:139]
  v_mfma_f32_16x16x32_bf16 v[140:143], a[164:167], a[60:63], v[140:143]
  ds_read_b64_tr_b16 a[150:151], v1 offset:53856
  v_mfma_f32_16x16x32_bf16 v[140:143], a[160:163], a[44:47], v[140:143]
  v_mfma_f32_16x16x32_bf16 v[156:159], a[168:171], a[44:47], v[156:159]
  buffer_load_dwordx4 v7, s[16:19], s10 offen offset:0 lds
  s_bfe_u32 s11, s82, 0x4001c
  v_mfma_f32_16x16x32_bf16 v[156:159], a[172:175], a[60:63], v[156:159]
  s_lshl_b32 s11, s11, 13
  s_add_u32 s11, s11, s85
  ds_read_b64_tr_b16 a[152:153], v1 offset:43136
  v_mfma_f32_16x16x32_bf16 v[152:155], a[172:175], a[56:59], v[152:155]
  ds_read_b64_tr_b16 a[154:155], v1 offset:46720
  v_mfma_f32_16x16x32_bf16 v[152:155], a[168:171], a[40:43], v[152:155]
  v_mfma_f32_16x16x32_bf16 v[148:151], a[168:171], a[36:39], v[148:151]
  ds_read_b64_tr_b16 a[156:157], v1 offset:50304
  v_mfma_f32_16x16x32_bf16 v[148:151], a[172:175], a[52:55], v[148:151]
  buffer_load_dwordx4 a[96:99], v0, s[36:39], s11 offen offset:0 sc1
  v_mfma_f32_16x16x32_bf16 v[144:147], a[172:175], a[48:51], v[144:147]
  ds_read_b64_tr_b16 a[158:159], v1 offset:53888
  v_mfma_f32_16x16x32_bf16 v[144:147], a[168:171], a[32:35], v[144:147]
  s_waitcnt lgkmcnt(8)
  v_mfma_f32_16x16x32_bf16 v[160:163], a[128:131], a[32:35], v[160:163]
  ds_read_b64_tr_b16 a[160:161], v1 offset:43168
  v_mfma_f32_16x16x32_bf16 v[160:163], a[132:135], a[48:51], v[160:163]
  v_mfma_f32_16x16x32_bf16 v[164:167], a[132:135], a[52:55], v[164:167]
  ds_read_b64_tr_b16 a[162:163], v1 offset:46752
  v_mfma_f32_16x16x32_bf16 v[164:167], a[128:131], a[36:39], v[164:167]
  v_mfma_f32_16x16x32_bf16 v[168:171], a[128:131], a[40:43], v[168:171]
  ds_read_b64_tr_b16 a[164:165], v1 offset:50336
  v_mfma_f32_16x16x32_bf16 v[168:171], a[132:135], a[56:59], v[168:171]
  v_mfma_f32_16x16x32_bf16 v[172:175], a[132:135], a[60:63], v[172:175]
  ds_read_b64_tr_b16 a[166:167], v1 offset:53920
  v_mfma_f32_16x16x32_bf16 v[172:175], a[128:131], a[44:47], v[172:175]
  s_waitcnt vmcnt(14)
  s_barrier
  buffer_load_dwordx4 v8, s[16:19], s10 offen offset:1024 lds
  v_mfma_f32_16x16x32_bf16 v[188:191], a[136:139], a[44:47], v[188:191]
  ds_read_b64_tr_b16 a[168:169], v1 offset:43200
  v_mfma_f32_16x16x32_bf16 v[188:191], a[140:143], a[60:63], v[188:191]
  v_mfma_f32_16x16x32_bf16 v[184:187], a[140:143], a[56:59], v[184:187]
  ds_read_b64_tr_b16 a[170:171], v1 offset:46784
  v_mfma_f32_16x16x32_bf16 v[184:187], a[136:139], a[40:43], v[184:187]
  v_mfma_f32_16x16x32_bf16 v[180:183], a[136:139], a[36:39], v[180:183]
  buffer_load_dwordx4 a[100:103], v0, s[36:39], s11 offen offset:1024 sc1
  v_mfma_f32_16x16x32_bf16 v[180:183], a[140:143], a[52:55], v[180:183]
  ds_read_b64_tr_b16 a[172:173], v1 offset:50368
  v_mfma_f32_16x16x32_bf16 v[176:179], a[140:143], a[48:51], v[176:179]
  ds_read_b64_tr_b16 a[174:175], v1 offset:53952
  v_mfma_f32_16x16x32_bf16 v[176:179], a[136:139], a[32:35], v[176:179]
  s_waitcnt lgkmcnt(8)
  v_mfma_f32_16x16x32_bf16 v[192:195], a[144:147], a[32:35], v[192:195]
  ds_read_b64_tr_b16 a[128:129], v2 offset:0
  v_mfma_f32_16x16x32_bf16 v[192:195], a[148:151], a[48:51], v[192:195]
  v_mfma_f32_16x16x32_bf16 v[196:199], a[148:151], a[52:55], v[196:199]
  ds_read_b64_tr_b16 a[130:131], v2 offset:3584
  v_mfma_f32_16x16x32_bf16 v[196:199], a[144:147], a[36:39], v[196:199]
  v_mfma_f32_16x16x32_bf16 v[200:203], a[144:147], a[40:43], v[200:203]
  ds_read_b64_tr_b16 a[132:133], v2 offset:7168
  v_mfma_f32_16x16x32_bf16 v[200:203], a[148:151], a[56:59], v[200:203]
  ds_read_b64_tr_b16 a[176:177], v31 offset:0
  v_mfma_f32_16x16x32_bf16 v[204:207], a[148:151], a[60:63], v[204:207]
  buffer_load_dwordx4 v9, s[16:19], s10 offen offset:2048 lds
  v_mfma_f32_16x16x32_bf16 v[204:207], a[144:147], a[44:47], v[204:207]
  ds_read_b64_tr_b16 a[134:135], v2 offset:10752
  v_mfma_f32_16x16x32_bf16 v[220:223], a[152:155], a[44:47], v[220:223]
  ds_read_b64_tr_b16 a[136:137], v2 offset:32
  v_mfma_f32_16x16x32_bf16 v[220:223], a[156:159], a[60:63], v[220:223]
  ds_read_b64_tr_b16 a[178:179], v31 offset:3584
  v_mfma_f32_16x16x32_bf16 v[216:219], a[156:159], a[56:59], v[216:219]
  ds_read_b64_tr_b16 a[138:139], v2 offset:3616
  v_mfma_f32_16x16x32_bf16 v[216:219], a[152:155], a[40:43], v[216:219]
  buffer_load_dwordx4 a[104:107], v0, s[36:39], s11 offen offset:2048 sc1
  v_mfma_f32_16x16x32_bf16 v[212:215], a[152:155], a[36:39], v[212:215]
  ds_read_b64_tr_b16 a[140:141], v2 offset:7200
  v_mfma_f32_16x16x32_bf16 v[212:215], a[156:159], a[52:55], v[212:215]
  ds_read_b64_tr_b16 a[180:181], v31 offset:7168
  v_mfma_f32_16x16x32_bf16 v[208:211], a[156:159], a[48:51], v[208:211]
  ds_read_b64_tr_b16 a[142:143], v2 offset:10784
  v_mfma_f32_16x16x32_bf16 v[208:211], a[152:155], a[32:35], v[208:211]
  s_waitcnt lgkmcnt(11)
  ds_read_b64_tr_b16 a[182:183], v31 offset:10752
  v_mfma_f32_16x16x32_bf16 v[224:227], a[160:163], a[32:35], v[224:227]
  ds_read_b64_tr_b16 a[144:145], v2 offset:64
  v_mfma_f32_16x16x32_bf16 v[224:227], a[164:167], a[48:51], v[224:227]
  ds_read_b64_tr_b16 a[184:185], v31 offset:32
  v_mfma_f32_16x16x32_bf16 v[228:231], a[164:167], a[52:55], v[228:231]
  ds_read_b64_tr_b16 a[146:147], v2 offset:3648
  v_mfma_f32_16x16x32_bf16 v[228:231], a[160:163], a[36:39], v[228:231]
  ds_read_b64_tr_b16 a[186:187], v31 offset:3616
  v_mfma_f32_16x16x32_bf16 v[232:235], a[160:163], a[40:43], v[232:235]
  ds_read_b64_tr_b16 a[148:149], v2 offset:7232
  v_mfma_f32_16x16x32_bf16 v[232:235], a[164:167], a[56:59], v[232:235]
  buffer_load_dwordx4 a[108:111], v0, s[36:39], s11 offen offset:3072 sc1
  v_mfma_f32_16x16x32_bf16 v[236:239], a[164:167], a[60:63], v[236:239]
  ds_read_b64_tr_b16 a[150:151], v2 offset:10816
  v_mfma_f32_16x16x32_bf16 v[236:239], a[160:163], a[44:47], v[236:239]
  ds_read_b64_tr_b16 a[188:189], v31 offset:7200
  v_mfma_f32_16x16x32_bf16 v[252:255], a[168:171], a[44:47], v[252:255]
  ds_read_b64_tr_b16 a[152:153], v2 offset:96
  v_mfma_f32_16x16x32_bf16 v[252:255], a[172:175], a[60:63], v[252:255]
  s_bfe_u32 s10, s83, 0x40000
  s_mul_i32 s10, s10, 458752
  s_add_u32 m0, s84, 0
  v_mfma_f32_16x16x32_bf16 v[248:251], a[172:175], a[56:59], v[248:251]
  ds_read_b64_tr_b16 a[154:155], v2 offset:3680
  v_mfma_f32_16x16x32_bf16 v[248:251], a[168:171], a[40:43], v[248:251]
  ds_read_b64_tr_b16 a[190:191], v31 offset:10784
  v_mfma_f32_16x16x32_bf16 v[244:247], a[168:171], a[36:39], v[244:247]
  ds_read_b64_tr_b16 a[156:157], v2 offset:7264
  v_mfma_f32_16x16x32_bf16 v[244:247], a[172:175], a[52:55], v[244:247]
  buffer_load_dwordx4 v3, s[16:19], s10 offen offset:0 lds
  v_mfma_f32_16x16x32_bf16 v[240:243], a[172:175], a[48:51], v[240:243]
  ds_read_b64_tr_b16 a[158:159], v2 offset:10848
  v_mfma_f32_16x16x32_bf16 v[240:243], a[168:171], a[32:35], v[240:243]
  s_waitcnt vmcnt(8) lgkmcnt(13)
  ds_read_b64_tr_b16 a[192:193], v31 offset:64
  v_mfma_f32_16x16x32_bf16 v[32:35], a[128:131], a[64:67], v[32:35]
  s_add_u32 s11, s11, 4096
  ds_read_b64_tr_b16 a[194:195], v31 offset:3648
  v_mfma_f32_16x16x32_bf16 v[32:35], a[132:135], a[80:83], v[32:35]
  ds_read_b64_tr_b16 a[196:197], v31 offset:7232
  v_mfma_f32_16x16x32_bf16 v[36:39], a[132:135], a[84:87], v[36:39]
  ds_read_b64_tr_b16 a[198:199], v31 offset:10816
  v_mfma_f32_16x16x32_bf16 v[36:39], a[128:131], a[68:71], v[36:39]
  ds_read_b64_tr_b16 a[200:201], v31 offset:96
  v_mfma_f32_16x16x32_bf16 v[40:43], a[128:131], a[72:75], v[40:43]
  buffer_load_dwordx4 a[112:115], v0, s[36:39], s11 offen offset:0 sc1
  v_mfma_f32_16x16x32_bf16 v[40:43], a[132:135], a[88:91], v[40:43]
  ds_read_b64_tr_b16 a[202:203], v31 offset:3680
  v_mfma_f32_16x16x32_bf16 v[44:47], a[132:135], a[92:95], v[44:47]
  ds_read_b64_tr_b16 a[204:205], v31 offset:7264
  v_mfma_f32_16x16x32_bf16 v[44:47], a[128:131], a[76:79], v[44:47]
  ds_read_b64_tr_b16 a[206:207], v31 offset:10848
  v_mfma_f32_16x16x32_bf16 v[60:63], a[136:139], a[76:79], v[60:63]
  ds_read_b64_tr_b16 a[160:161], v2 offset:128
  v_mfma_f32_16x16x32_bf16 v[60:63], a[140:143], a[92:95], v[60:63]
  v_mfma_f32_16x16x32_bf16 v[56:59], a[140:143], a[88:91], v[56:59]
  ds_read_b64_tr_b16 a[162:163], v2 offset:3712
  v_mfma_f32_16x16x32_bf16 v[56:59], a[136:139], a[72:75], v[56:59]
  buffer_load_dwordx4 v4, s[16:19], s10 offen offset:1024 lds
  v_mfma_f32_16x16x32_bf16 v[52:55], a[136:139], a[68:71], v[52:55]
  ds_read_b64_tr_b16 a[164:165], v2 offset:7296
  v_mfma_f32_16x16x32_bf16 v[52:55], a[140:143], a[84:87], v[52:55]
  v_mfma_f32_16x16x32_bf16 v[48:51], a[140:143], a[80:83], v[48:51]
  ds_read_b64_tr_b16 a[166:167], v2 offset:10880
  v_mfma_f32_16x16x32_bf16 v[48:51], a[136:139], a[64:67], v[48:51]
  s_waitcnt lgkmcnt(12)
  v_mfma_f32_16x16x32_bf16 v[64:67], a[144:147], a[64:67], v[64:67]
  ds_read_b64_tr_b16 a[168:169], v2 offset:160
  v_mfma_f32_16x16x32_bf16 v[64:67], a[148:151], a[80:83], v[64:67]
  v_mfma_f32_16x16x32_bf16 v[68:71], a[148:151], a[84:87], v[68:71]
  ds_read_b64_tr_b16 a[170:171], v2 offset:3744
  v_mfma_f32_16x16x32_bf16 v[68:71], a[144:147], a[68:71], v[68:71]
  buffer_load_dwordx4 a[116:119], v0, s[36:39], s11 offen offset:1024 sc1
  v_mfma_f32_16x16x32_bf16 v[72:75], a[144:147], a[72:75], v[72:75]
  ds_read_b64_tr_b16 a[172:173], v2 offset:7328
  v_mfma_f32_16x16x32_bf16 v[72:75], a[148:151], a[88:91], v[72:75]
  v_mfma_f32_16x16x32_bf16 v[76:79], a[148:151], a[92:95], v[76:79]
  ds_read_b64_tr_b16 a[174:175], v2 offset:10912
  v_mfma_f32_16x16x32_bf16 v[76:79], a[144:147], a[76:79], v[76:79]
  v_mfma_f32_16x16x32_bf16 v[92:95], a[152:155], a[76:79], v[92:95]
  ds_read_b64_tr_b16 a[128:129], v2 offset:192
  v_mfma_f32_16x16x32_bf16 v[92:95], a[156:159], a[92:95], v[92:95]
  v_mfma_f32_16x16x32_bf16 v[88:91], a[156:159], a[88:91], v[88:91]
  buffer_load_dwordx4 v5, s[16:19], s10 offen offset:2048 lds
  v_mfma_f32_16x16x32_bf16 v[88:91], a[152:155], a[72:75], v[88:91]
  ds_read_b64_tr_b16 a[130:131], v2 offset:3776
  v_mfma_f32_16x16x32_bf16 v[84:87], a[152:155], a[68:71], v[84:87]
  ds_read_b64_tr_b16 a[132:133], v2 offset:7360
  v_mfma_f32_16x16x32_bf16 v[84:87], a[156:159], a[84:87], v[84:87]
  v_mfma_f32_16x16x32_bf16 v[80:83], a[156:159], a[80:83], v[80:83]
  ds_read_b64_tr_b16 a[134:135], v2 offset:10944
  v_mfma_f32_16x16x32_bf16 v[80:83], a[152:155], a[64:67], v[80:83]
  s_waitcnt vmcnt(20) lgkmcnt(12)
  v_mfma_f32_16x16x32_bf16 a[216:219], a[176:179], a[208:211], 0
  ds_read_b64_tr_b16 a[136:137], v2 offset:14336
  v_mfma_f32_16x16x32_bf16 a[216:219], a[180:183], a[212:215], a[216:219]
  v_mfma_f32_16x16x32_bf16 a[220:223], a[184:187], a[208:211], 0
  buffer_load_dwordx4 a[120:123], v0, s[36:39], s11 offen offset:2048 sc1
  v_mfma_f32_16x16x32_bf16 a[220:223], a[188:191], a[212:215], a[220:223]
  ds_read_b64_tr_b16 a[138:139], v2 offset:17920
  v_mfma_f32_16x16x32_bf16 a[224:227], a[192:195], a[208:211], 0
  ds_read_b64_tr_b16 a[140:141], v2 offset:21504
  v_mfma_f32_16x16x32_bf16 a[224:227], a[196:199], a[212:215], a[224:227]
  v_mfma_f32_16x16x32_bf16 a[228:231], a[200:203], a[208:211], 0
  ds_read_b64_tr_b16 a[142:143], v2 offset:25088
  v_mfma_f32_16x16x32_bf16 a[228:231], a[204:207], a[212:215], a[228:231]
  s_waitcnt lgkmcnt(8)
  v_mfma_f32_16x16x32_bf16 v[96:99], a[160:163], a[64:67], v[96:99]
  ds_read_b64_tr_b16 a[144:145], v2 offset:14368
  v_mfma_f32_16x16x32_bf16 v[96:99], a[164:167], a[80:83], v[96:99]
  buffer_load_dwordx4 v6, s[16:19], s10 offen offset:3072 lds
  v_mfma_f32_16x16x32_bf16 v[100:103], a[164:167], a[84:87], v[100:103]
  s_lshl2_add_u32 s28, s56, s44
  ds_read_b64_tr_b16 a[146:147], v2 offset:17952
  s_lshl_b32 s28, s28, 13
  v_mfma_f32_16x16x32_bf16 v[100:103], a[160:163], a[68:71], v[100:103]
  s_add_u32 s28, s28, 262144
  s_add_u32 s29, s28, 4096
  v_mfma_f32_16x16x32_bf16 v[104:107], a[160:163], a[72:75], v[104:107]
  ds_read_b64_tr_b16 a[148:149], v2 offset:21536
  v_mfma_f32_16x16x32_bf16 v[104:107], a[164:167], a[88:91], v[104:107]
  v_mfma_f32_16x16x32_bf16 v[108:111], a[164:167], a[92:95], v[108:111]
  ds_read_b64_tr_b16 a[150:151], v2 offset:25120
  v_mfma_f32_16x16x32_bf16 v[108:111], a[160:163], a[76:79], v[108:111]
  buffer_load_dwordx4 a[176:179], v0, s[36:39], s28 offen offset:0 sc1
  v_mfma_f32_16x16x32_bf16 v[124:127], a[168:171], a[76:79], v[124:127]
  ds_read_b64_tr_b16 a[152:153], v2 offset:14400
  v_mfma_f32_16x16x32_bf16 v[124:127], a[172:175], a[92:95], v[124:127]
  v_mfma_f32_16x16x32_bf16 v[120:123], a[172:175], a[88:91], v[120:123]
  ds_read_b64_tr_b16 a[154:155], v2 offset:17984
  v_mfma_f32_16x16x32_bf16 v[120:123], a[168:171], a[72:75], v[120:123]
  v_mfma_f32_16x16x32_bf16 v[116:119], a[168:171], a[68:71], v[116:119]
  buffer_load_dwordx4 a[124:127], v0, s[36:39], s11 offen offset:3072 sc1
  s_add_u32 m0, s84, 4096
  v_mfma_f32_16x16x32_bf16 v[116:119], a[172:175], a[84:87], v[116:119]
  ds_read_b64_tr_b16 a[156:157], v2 offset:21568
  v_mfma_f32_16x16x32_bf16 v[112:115], a[172:175], a[80:83], v[112:115]
  ds_read_b64_tr_b16 a[158:159], v2 offset:25152
  v_mfma_f32_16x16x32_bf16 v[112:115], a[168:171], a[64:67], v[112:115]
  s_waitcnt lgkmcnt(8)
  v_mfma_f32_16x16x32_bf16 v[128:131], a[128:131], a[64:67], v[128:131]
  ds_read_b64_tr_b16 a[160:161], v2 offset:14432
  v_mfma_f32_16x16x32_bf16 v[128:131], a[132:135], a[80:83], v[128:131]
  buffer_load_dwordx4 v7, s[16:19], s10 offen offset:0 lds
  s_bfe_u32 s11, s83, 0x40000
  v_mfma_f32_16x16x32_bf16 v[132:135], a[132:135], a[84:87], v[132:135]
  s_lshl_b32 s11, s11, 13
  s_add_u32 s11, s11, s85
  ds_read_b64_tr_b16 a[162:163], v2 offset:18016
  v_mfma_f32_16x16x32_bf16 v[132:135], a[128:131], a[68:71], v[132:135]
  v_mfma_f32_16x16x32_bf16 v[136:139], a[128:131], a[72:75], v[136:139]
  ds_read_b64_tr_b16 a[164:165], v2 offset:21600
  v_mfma_f32_16x16x32_bf16 v[136:139], a[132:135], a[88:91], v[136:139]
  v_mfma_f32_16x16x32_bf16 v[140:143], a[132:135], a[92:95], v[140:143]
  buffer_load_dwordx4 a[0:3], v0, s[36:39], s11 offen offset:0 sc1
  v_mfma_f32_16x16x32_bf16 v[140:143], a[128:131], a[76:79], v[140:143]
  ds_read_b64_tr_b16 a[166:167], v2 offset:25184
  v_mfma_f32_16x16x32_bf16 v[156:159], a[136:139], a[76:79], v[156:159]
  ds_read_b64_tr_b16 a[168:169], v2 offset:14464
  v_mfma_f32_16x16x32_bf16 v[156:159], a[140:143], a[92:95], v[156:159]
  v_mfma_f32_16x16x32_bf16 v[152:155], a[140:143], a[88:91], v[152:155]
  ds_read_b64_tr_b16 a[170:171], v2 offset:18048
  v_mfma_f32_16x16x32_bf16 v[152:155], a[136:139], a[72:75], v[152:155]
  buffer_load_dwordx4 a[180:183], v0, s[36:39], s28 offen offset:1024 sc1
  v_mfma_f32_16x16x32_bf16 v[148:151], a[136:139], a[68:71], v[148:151]
  ds_read_b64_tr_b16 a[172:173], v2 offset:21632
  v_mfma_f32_16x16x32_bf16 v[148:151], a[140:143], a[84:87], v[148:151]
  v_mfma_f32_16x16x32_bf16 v[144:147], a[140:143], a[80:83], v[144:147]
  ds_read_b64_tr_b16 a[174:175], v2 offset:25216
  v_mfma_f32_16x16x32_bf16 v[144:147], a[136:139], a[64:67], v[144:147]
  s_waitcnt lgkmcnt(8)
  v_mfma_f32_16x16x32_bf16 v[160:163], a[144:147], a[64:67], v[160:163]
  buffer_load_dwordx4 v8, s[16:19], s10 offen offset:1024 lds
  v_mfma_f32_16x16x32_bf16 v[160:163], a[148:151], a[80:83], v[160:163]
  ds_read_b64_tr_b16 a[128:129], v2 offset:14496
  v_mfma_f32_16x16x32_bf16 v[164:167], a[148:151], a[84:87], v[164:167]
  ds_read_b64_tr_b16 a[130:131], v2 offset:18080
  v_mfma_f32_16x16x32_bf16 v[164:167], a[144:147], a[68:71], v[164:167]
  v_mfma_f32_16x16x32_bf16 v[168:171], a[144:147], a[72:75], v[168:171]
  ds_read_b64_tr_b16 a[132:133], v2 offset:21664
  v_mfma_f32_16x16x32_bf16 v[168:171], a[148:151], a[88:91], v[168:171]
  buffer_load_dwordx4 a[4:7], v0, s[36:39], s11 offen offset:1024 sc1
  v_mfma_f32_16x16x32_bf16 v[172:175], a[148:151], a[92:95], v[172:175]
  ds_read_b64_tr_b16 a[134:135], v2 offset:25248
  v_mfma_f32_16x16x32_bf16 v[172:175], a[144:147], a[76:79], v[172:175]
  s_waitcnt vmcnt(16)
  s_barrier
  v_mfma_f32_16x16x32_bf16 v[188:191], a[152:155], a[76:79], v[188:191]
  ds_read_b64_tr_b16 a[136:137], v2 offset:14528
  v_mfma_f32_16x16x32_bf16 v[188:191], a[156:159], a[92:95], v[188:191]
  v_mfma_f32_16x16x32_bf16 v[184:187], a[156:159], a[88:91], v[184:187]
  ds_read_b64_tr_b16 a[138:139], v2 offset:18112
  v_mfma_f32_16x16x32_bf16 v[184:187], a[152:155], a[72:75], v[184:187]
  buffer_load_dwordx4 a[184:187], v0, s[36:39], s28 offen offset:2048 sc1
  v_mfma_f32_16x16x32_bf16 v[180:183], a[152:155], a[68:71], v[180:183]
  ds_read_b64_tr_b16 a[140:141], v2 offset:21696
  v_mfma_f32_16x16x32_bf16 v[180:183], a[156:159], a[84:87], v[180:183]
  v_mfma_f32_16x16x32_bf16 v[176:179], a[156:159], a[80:83], v[176:179]
  ds_read_b64_tr_b16 a[142:143], v2 offset:25280
  v_mfma_f32_16x16x32_bf16 v[176:179], a[152:155], a[64:67], v[176:179]
  s_waitcnt lgkmcnt(8)
  v_mfma_f32_16x16x32_bf16 v[192:195], a[160:163], a[64:67], v[192:195]
  buffer_load_dwordx4 v9, s[16:19], s10 offen offset:2048 lds
  v_mfma_f32_16x16x32_bf16 v[192:195], a[164:167], a[80:83], v[192:195]
  ds_read_b64_tr_b16 a[144:145], v2 offset:28672
  v_mfma_f32_16x16x32_bf16 v[196:199], a[164:167], a[84:87], v[196:199]
  ds_read_b64_tr_b16 a[146:147], v2 offset:32256
  v_mfma_f32_16x16x32_bf16 v[196:199], a[160:163], a[68:71], v[196:199]
  v_mfma_f32_16x16x32_bf16 v[200:203], a[160:163], a[72:75], v[200:203]
  ds_read_b64_tr_b16 a[148:149], v2 offset:35840
  v_mfma_f32_16x16x32_bf16 v[200:203], a[164:167], a[88:91], v[200:203]
  buffer_load_dwordx4 a[8:11], v0, s[36:39], s11 offen offset:2048 sc1
  v_mfma_f32_16x16x32_bf16 v[204:207], a[164:167], a[92:95], v[204:207]
  ds_read_b64_tr_b16 a[150:151], v2 offset:39424
  v_mfma_f32_16x16x32_bf16 v[204:207], a[160:163], a[76:79], v[204:207]
  v_mfma_f32_16x16x32_bf16 v[220:223], a[168:171], a[76:79], v[220:223]
  ds_read_b64_tr_b16 a[152:153], v2 offset:28704
  v_mfma_f32_16x16x32_bf16 v[220:223], a[172:175], a[92:95], v[220:223]
  buffer_load_dwordx4 a[188:191], v0, s[36:39], s28 offen offset:3072 sc1
  v_mfma_f32_16x16x32_bf16 v[216:219], a[172:175], a[88:91], v[216:219]
  ds_read_b64_tr_b16 a[154:155], v2 offset:32288
  v_mfma_f32_16x16x32_bf16 v[216:219], a[168:171], a[72:75], v[216:219]
  v_mfma_f32_16x16x32_bf16 v[212:215], a[168:171], a[68:71], v[212:215]
  ds_read_b64_tr_b16 a[156:157], v2 offset:35872
  v_mfma_f32_16x16x32_bf16 v[212:215], a[172:175], a[84:87], v[212:215]
  v_mfma_f32_16x16x32_bf16 v[208:211], a[172:175], a[80:83], v[208:211]
  buffer_load_dwordx4 a[12:15], v0, s[36:39], s11 offen offset:3072 sc1
  v_mfma_f32_16x16x32_bf16 v[208:211], a[168:171], a[64:67], v[208:211]
  s_waitcnt lgkmcnt(7)
  ds_read_b64_tr_b16 a[158:159], v2 offset:39456
  v_mfma_f32_16x16x32_bf16 v[224:227], a[128:131], a[64:67], v[224:227]
  ds_read_b64_tr_b16 a[160:161], v2 offset:28736
  v_mfma_f32_16x16x32_bf16 v[224:227], a[132:135], a[80:83], v[224:227]
  s_bfe_u32 s10, s83, 0x40004
  s_mul_i32 s10, s10, 458752
  s_add_u32 m0, s84, 28672
  v_mfma_f32_16x16x32_bf16 v[228:231], a[132:135], a[84:87], v[228:231]
  buffer_load_dwordx4 a[192:195], v0, s[36:39], s29 offen offset:0 sc1
  v_mfma_f32_16x16x32_bf16 v[228:231], a[128:131], a[68:71], v[228:231]
  ds_read_b64_tr_b16 a[162:163], v2 offset:32320
  v_mfma_f32_16x16x32_bf16 v[232:235], a[128:131], a[72:75], v[232:235]
  ds_read_b64_tr_b16 a[164:165], v2 offset:35904
  v_mfma_f32_16x16x32_bf16 v[232:235], a[132:135], a[88:91], v[232:235]
  v_mfma_f32_16x16x32_bf16 v[236:239], a[132:135], a[92:95], v[236:239]
  ds_read_b64_tr_b16 a[166:167], v2 offset:39488
  v_mfma_f32_16x16x32_bf16 v[236:239], a[128:131], a[76:79], v[236:239]
  buffer_load_dwordx4 v3, s[16:19], s10 offen offset:0 lds
  v_mfma_f32_16x16x32_bf16 v[252:255], a[136:139], a[76:79], v[252:255]
  ds_read_b64_tr_b16 a[168:169], v2 offset:28768
  v_mfma_f32_16x16x32_bf16 v[252:255], a[140:143], a[92:95], v[252:255]
  v_mfma_f32_16x16x32_bf16 v[248:251], a[140:143], a[88:91], v[248:251]
  ds_read_b64_tr_b16 a[170:171], v2 offset:32352
  v_mfma_f32_16x16x32_bf16 v[248:251], a[136:139], a[72:75], v[248:251]
  buffer_load_dwordx4 a[196:199], v0, s[36:39], s29 offen offset:1024 sc1
  v_mfma_f32_16x16x32_bf16 v[244:247], a[136:139], a[68:71], v[244:247]
  ds_read_b64_tr_b16 a[172:173], v2 offset:35936
  v_mfma_f32_16x16x32_bf16 v[244:247], a[140:143], a[84:87], v[244:247]
  v_mfma_f32_16x16x32_bf16 v[240:243], a[140:143], a[80:83], v[240:243]
  ds_read_b64_tr_b16 a[174:175], v2 offset:39520
  v_mfma_f32_16x16x32_bf16 v[240:243], a[136:139], a[64:67], v[240:243]
  s_waitcnt vmcnt(13) lgkmcnt(8)
  v_mfma_f32_16x16x32_bf16 v[32:35], a[144:147], a[96:99], v[32:35]
  s_add_u32 s11, s11, 4096
  ds_read_b64_tr_b16 a[128:129], v2 offset:28800
  v_mfma_f32_16x16x32_bf16 v[32:35], a[148:151], a[112:115], v[32:35]
  buffer_load_dwordx4 a[200:203], v0, s[36:39], s29 offen offset:2048 sc1
  v_mfma_f32_16x16x32_bf16 v[36:39], a[148:151], a[116:119], v[36:39]
  ds_read_b64_tr_b16 a[130:131], v2 offset:32384
  v_mfma_f32_16x16x32_bf16 v[36:39], a[144:147], a[100:103], v[36:39]
  v_mfma_f32_16x16x32_bf16 v[40:43], a[144:147], a[104:107], v[40:43]
  ds_read_b64_tr_b16 a[132:133], v2 offset:35968
  v_mfma_f32_16x16x32_bf16 v[40:43], a[148:151], a[120:123], v[40:43]
  v_mfma_f32_16x16x32_bf16 v[44:47], a[148:151], a[124:127], v[44:47]
  buffer_load_dwordx4 a[16:19], v0, s[36:39], s11 offen offset:0 sc1
  v_mfma_f32_16x16x32_bf16 v[44:47], a[144:147], a[108:111], v[44:47]
  ds_read_b64_tr_b16 a[134:135], v2 offset:39552
  v_mfma_f32_16x16x32_bf16 v[60:63], a[152:155], a[108:111], v[60:63]
  ds_read_b64_tr_b16 a[136:137], v2 offset:28832
  v_mfma_f32_16x16x32_bf16 v[60:63], a[156:159], a[124:127], v[60:63]
  v_mfma_f32_16x16x32_bf16 v[56:59], a[156:159], a[120:123], v[56:59]
  ds_read_b64_tr_b16 a[138:139], v2 offset:32416
  v_mfma_f32_16x16x32_bf16 v[56:59], a[152:155], a[104:107], v[56:59]
  buffer_load_dwordx4 v4, s[16:19], s10 offen offset:1024 lds
  v_mfma_f32_16x16x32_bf16 v[52:55], a[152:155], a[100:103], v[52:55]
  ds_read_b64_tr_b16 a[140:141], v2 offset:36000
  v_mfma_f32_16x16x32_bf16 v[52:55], a[156:159], a[116:119], v[52:55]
  buffer_load_dwordx4 a[204:207], v0, s[36:39], s29 offen offset:3072 sc1
  v_mfma_f32_16x16x32_bf16 v[48:51], a[156:159], a[112:115], v[48:51]
  ds_read_b64_tr_b16 a[142:143], v2 offset:39584
  v_mfma_f32_16x16x32_bf16 v[48:51], a[152:155], a[96:99], v[48:51]
  s_waitcnt lgkmcnt(8)
  v_mfma_f32_16x16x32_bf16 v[64:67], a[160:163], a[96:99], v[64:67]
  ds_read_b64_tr_b16 a[144:145], v2 offset:28864
  v_mfma_f32_16x16x32_bf16 v[64:67], a[164:167], a[112:115], v[64:67]
  v_mfma_f32_16x16x32_bf16 v[68:71], a[164:167], a[116:119], v[68:71]
  ds_read_b64_tr_b16 a[146:147], v2 offset:32448
  v_mfma_f32_16x16x32_bf16 v[68:71], a[160:163], a[100:103], v[68:71]
  buffer_load_dwordx4 a[20:23], v0, s[36:39], s11 offen offset:1024 sc1
  v_mfma_f32_16x16x32_bf16 v[72:75], a[160:163], a[104:107], v[72:75]
  ds_read_b64_tr_b16 a[148:149], v2 offset:36032
  v_mfma_f32_16x16x32_bf16 v[72:75], a[164:167], a[120:123], v[72:75]
  v_mfma_f32_16x16x32_bf16 v[76:79], a[164:167], a[124:127], v[76:79]
  ds_read_b64_tr_b16 a[150:151], v2 offset:39616
  v_mfma_f32_16x16x32_bf16 v[76:79], a[160:163], a[108:111], v[76:79]
  v_mfma_f32_16x16x32_bf16 v[92:95], a[168:171], a[108:111], v[92:95]
  ds_read_b64_tr_b16 a[152:153], v2 offset:43008
  v_mfma_f32_16x16x32_bf16 v[92:95], a[172:175], a[124:127], v[92:95]
  v_mfma_f32_16x16x32_bf16 v[88:91], a[172:175], a[120:123], v[88:91]
  buffer_load_dwordx4 v5, s[16:19], s10 offen offset:2048 lds
  v_mfma_f32_16x16x32_bf16 v[88:91], a[168:171], a[104:107], v[88:91]
  ds_read_b64_tr_b16 a[154:155], v2 offset:46592
  v_mfma_f32_16x16x32_bf16 v[84:87], a[168:171], a[100:103], v[84:87]
  ds_read_b64_tr_b16 a[156:157], v2 offset:50176
  v_mfma_f32_16x16x32_bf16 v[84:87], a[172:175], a[116:119], v[84:87]
  v_mfma_f32_16x16x32_bf16 v[80:83], a[172:175], a[112:115], v[80:83]
  ds_read_b64_tr_b16 a[158:159], v2 offset:53760
  v_mfma_f32_16x16x32_bf16 v[80:83], a[168:171], a[96:99], v[80:83]
  s_waitcnt lgkmcnt(8)
  v_mfma_f32_16x16x32_bf16 v[96:99], a[128:131], a[96:99], v[96:99]
  ds_read_b64_tr_b16 a[160:161], v2 offset:43040
  v_mfma_f32_16x16x32_bf16 v[96:99], a[132:135], a[112:115], v[96:99]
  v_mfma_f32_16x16x32_bf16 v[100:103], a[132:135], a[116:119], v[100:103]
  buffer_load_dwordx4 a[24:27], v0, s[36:39], s11 offen offset:2048 sc1
  v_mfma_f32_16x16x32_bf16 v[100:103], a[128:131], a[100:103], v[100:103]
  ds_read_b64_tr_b16 a[162:163], v2 offset:46624
  v_mfma_f32_16x16x32_bf16 v[104:107], a[128:131], a[104:107], v[104:107]
  ds_read_b64_tr_b16 a[164:165], v2 offset:50208
  v_mfma_f32_16x16x32_bf16 v[104:107], a[132:135], a[120:123], v[104:107]
  v_mfma_f32_16x16x32_bf16 v[108:111], a[132:135], a[124:127], v[108:111]
  ds_read_b64_tr_b16 a[166:167], v2 offset:53792
  v_mfma_f32_16x16x32_bf16 v[108:111], a[128:131], a[108:111], v[108:111]
  v_mfma_f32_16x16x32_bf16 v[124:127], a[136:139], a[108:111], v[124:127]
Hb2:
  s_cbranch_execz Hb2_1
  ds_read_b64_tr_b16 a[168:169], v2 offset:43072
  v_mfma_f32_16x16x32_bf16 v[124:127], a[140:143], a[124:127], v[124:127]
  buffer_load_dwordx4 v6, s[16:19], s10 offen offset:3072 lds
  v_mfma_f32_16x16x32_bf16 v[120:123], a[140:143], a[120:123], v[120:123]
  ds_read_b64_tr_b16 a[170:171], v2 offset:46656
  v_mfma_f32_16x16x32_bf16 v[120:123], a[136:139], a[104:107], v[120:123]
  v_mfma_f32_16x16x32_bf16 v[116:119], a[136:139], a[100:103], v[116:119]
  ds_read_b64_tr_b16 a[172:173], v2 offset:50240
  v_mfma_f32_16x16x32_bf16 v[116:119], a[140:143], a[116:119], v[116:119]
  v_mfma_f32_16x16x32_bf16 v[112:115], a[140:143], a[112:115], v[112:115]
  ds_read_b64_tr_b16 a[174:175], v2 offset:53824
  v_mfma_f32_16x16x32_bf16 v[112:115], a[136:139], a[96:99], v[112:115]
  s_waitcnt lgkmcnt(8)
  v_mfma_f32_16x16x32_bf16 v[128:131], a[144:147], a[96:99], v[128:131]
  ds_read_b64_tr_b16 a[128:129], v2 offset:43104
  v_mfma_f32_16x16x32_bf16 v[128:131], a[148:151], a[112:115], v[128:131]
  buffer_load_dwordx4 a[28:31], v0, s[36:39], s11 offen offset:3072 sc1
  v_mfma_f32_16x16x32_bf16 v[132:135], a[148:151], a[116:119], v[132:135]
  ds_read_b64_tr_b16 a[130:131], v2 offset:46688
  v_mfma_f32_16x16x32_bf16 v[132:135], a[144:147], a[100:103], v[132:135]
  v_mfma_f32_16x16x32_bf16 v[136:139], a[144:147], a[104:107], v[136:139]
  s_add_u32 m0, s84, 32768
  ds_read_b64_tr_b16 a[132:133], v2 offset:50272
  v_mfma_f32_16x16x32_bf16 v[136:139], a[148:151], a[120:123], v[136:139]
  v_mfma_f32_16x16x32_bf16 v[140:143], a[148:151], a[124:127], v[140:143]
  ds_read_b64_tr_b16 a[134:135], v2 offset:53856
  v_mfma_f32_16x16x32_bf16 v[140:143], a[144:147], a[108:111], v[140:143]
  v_mfma_f32_16x16x32_bf16 v[156:159], a[152:155], a[108:111], v[156:159]
  buffer_load_dwordx4 v7, s[16:19], s10 offen offset:0 lds
  s_bfe_u32 s11, s83, 0x40004
  v_mfma_f32_16x16x32_bf16 v[156:159], a[156:159], a[124:127], v[156:159]
  s_lshl_b32 s11, s11, 13
  s_add_u32 s11, s11, s85
  ds_read_b64_tr_b16 a[136:137], v2 offset:43136
  v_mfma_f32_16x16x32_bf16 v[152:155], a[156:159], a[120:123], v[152:155]
  ds_read_b64_tr_b16 a[138:139], v2 offset:46720
  v_mfma_f32_16x16x32_bf16 v[152:155], a[152:155], a[104:107], v[152:155]
  v_mfma_f32_16x16x32_bf16 v[148:151], a[152:155], a[100:103], v[148:151]
  ds_read_b64_tr_b16 a[140:141], v2 offset:50304
  v_mfma_f32_16x16x32_bf16 v[148:151], a[156:159], a[116:119], v[148:151]
  buffer_load_dwordx4 a[32:35], v0, s[36:39], s11 offen offset:0 sc1
  v_mfma_f32_16x16x32_bf16 v[144:147], a[156:159], a[112:115], v[144:147]
  ds_read_b64_tr_b16 a[142:143], v2 offset:53888
  v_mfma_f32_16x16x32_bf16 v[144:147], a[152:155], a[96:99], v[144:147]
  s_waitcnt lgkmcnt(8)
  v_mfma_f32_16x16x32_bf16 v[160:163], a[160:163], a[96:99], v[160:163]
  s_waitcnt vmcnt(7)
  ds_read_b64_tr_b16 a[144:145], v2 offset:43168
  v_accvgpr_read_b32 v22, a176
  v_mfma_f32_16x16x32_bf16 v[160:163], a[164:167], a[112:115], v[160:163]
  v_accvgpr_read_b32 v23, a177
  v_accvgpr_read_b32 v24, a178
  v_mfma_f32_16x16x32_bf16 v[164:167], a[164:167], a[116:119], v[164:167]
  ds_read_b64_tr_b16 a[146:147], v2 offset:46752
  v_accvgpr_read_b32 v25, a179
  v_mfma_f32_16x16x32_bf16 v[164:167], a[160:163], a[100:103], v[164:167]
  v_accvgpr_read_b32 v26, a180
  v_accvgpr_read_b32 v27, a181
  v_mfma_f32_16x16x32_bf16 v[168:171], a[160:163], a[104:107], v[168:171]
  ds_read_b64_tr_b16 a[148:149], v2 offset:50336
  v_accvgpr_read_b32 v28, a182
  v_mfma_f32_16x16x32_bf16 v[168:171], a[164:167], a[120:123], v[168:171]
  v_accvgpr_read_b32 v29, a183
  v_add_f32 v22, v22, v26
  v_mfma_f32_16x16x32_bf16 v[172:175], a[164:167], a[124:127], v[172:175]
  ds_read_b64_tr_b16 a[150:151], v2 offset:53920
  v_add_f32 v23, v23, v27
  v_mfma_f32_16x16x32_bf16 v[172:175], a[160:163], a[108:111], v[172:175]
  s_waitcnt vmcnt(17)
  s_barrier
  buffer_load_dwordx4 v8, s[16:19], s10 offen offset:1024 lds
  v_add_f32 v24, v24, v28
  v_mfma_f32_16x16x32_bf16 v[188:191], a[168:171], a[108:111], v[188:191]
  ds_read_b64_tr_b16 a[152:153], v2 offset:43200
  v_add_f32 v25, v25, v29
  v_mfma_f32_16x16x32_bf16 v[188:191], a[172:175], a[124:127], v[188:191]
  v_accvgpr_read_b32 v26, a184
  v_accvgpr_read_b32 v27, a185
  v_mfma_f32_16x16x32_bf16 v[184:187], a[172:175], a[120:123], v[184:187]
  ds_read_b64_tr_b16 a[154:155], v2 offset:46784
  v_accvgpr_read_b32 v28, a186
  v_mfma_f32_16x16x32_bf16 v[184:187], a[168:171], a[104:107], v[184:187]
  v_accvgpr_read_b32 v29, a187
  v_add_f32 v22, v22, v26
  v_mfma_f32_16x16x32_bf16 v[180:183], a[168:171], a[100:103], v[180:183]
  buffer_load_dwordx4 a[36:39], v0, s[36:39], s11 offen offset:1024 sc1
  v_add_f32 v23, v23, v27
  v_mfma_f32_16x16x32_bf16 v[180:183], a[172:175], a[116:119], v[180:183]
  ds_read_b64_tr_b16 a[156:157], v2 offset:50368
  v_add_f32 v24, v24, v28
  v_mfma_f32_16x16x32_bf16 v[176:179], a[172:175], a[112:115], v[176:179]
  ds_read_b64_tr_b16 a[158:159], v2 offset:53952
  v_add_f32 v25, v25, v29
  v_mfma_f32_16x16x32_bf16 v[176:179], a[168:171], a[96:99], v[176:179]
  s_waitcnt lgkmcnt(8)
  v_accvgpr_read_b32 v26, a188
  v_accvgpr_read_b32 v27, a189
  v_mfma_f32_16x16x32_bf16 v[192:195], a[128:131], a[96:99], v[192:195]
  ds_read_b64_tr_b16 a[160:161], v1 offset:0
  v_accvgpr_read_b32 v28, a190
  v_mfma_f32_16x16x32_bf16 v[192:195], a[132:135], a[112:115], v[192:195]
  v_accvgpr_read_b32 v29, a191
  v_add_f32 v22, v22, v26
  v_mfma_f32_16x16x32_bf16 v[196:199], a[132:135], a[116:119], v[196:199]
  ds_read_b64_tr_b16 a[162:163], v1 offset:3584
  v_add_f32 v23, v23, v27
  v_mfma_f32_16x16x32_bf16 v[196:199], a[128:131], a[100:103], v[196:199]
  v_add_f32 v24, v24, v28
  v_add_f32 v25, v25, v29
  v_mfma_f32_16x16x32_bf16 v[200:203], a[128:131], a[104:107], v[200:203]
  ds_read_b64_tr_b16 a[164:165], v1 offset:7168
  v_mov_b32 v26, v22
  v_mfma_f32_16x16x32_bf16 v[200:203], a[132:135], a[120:123], v[200:203]
  v_mov_b32 v27, v23
  v_mov_b32 v28, v24
  v_mfma_f32_16x16x32_bf16 v[204:207], a[132:135], a[124:127], v[204:207]
  buffer_load_dwordx4 v9, s[16:19], s10 offen offset:2048 lds
  v_mov_b32 v29, v25
  v_mfma_f32_16x16x32_bf16 v[204:207], a[128:131], a[108:111], v[204:207]
  ds_read_b64_tr_b16 a[166:167], v1 offset:10752
  v_permlane16_swap_b32 v22, v26
  v_mfma_f32_16x16x32_bf16 v[220:223], a[136:139], a[108:111], v[220:223]
  ds_read_b64_tr_b16 a[168:169], v1 offset:32
  v_permlane16_swap_b32 v23, v27
  v_mfma_f32_16x16x32_bf16 v[220:223], a[140:143], a[124:127], v[220:223]
  v_permlane16_swap_b32 v24, v28
  v_permlane16_swap_b32 v25, v29
  v_mfma_f32_16x16x32_bf16 v[216:219], a[140:143], a[120:123], v[216:219]
  s_add_u32 s20, s20, 16384
  ds_read_b64_tr_b16 a[170:171], v1 offset:3616
  v_add_f32 v22, v22, v26
  v_mfma_f32_16x16x32_bf16 v[216:219], a[136:139], a[104:107], v[216:219]
  buffer_load_dwordx4 a[40:43], v0, s[36:39], s11 offen offset:2048 sc1
  v_add_f32 v23, v23, v27
  v_mfma_f32_16x16x32_bf16 v[212:215], a[136:139], a[100:103], v[212:215]
  ds_read_b64_tr_b16 a[172:173], v1 offset:7200
  v_add_f32 v24, v24, v28
  v_mfma_f32_16x16x32_bf16 v[212:215], a[140:143], a[116:119], v[212:215]
  v_add_f32 v25, v25, v29
  v_mov_b32 v26, v22
  v_mfma_f32_16x16x32_bf16 v[208:211], a[140:143], a[112:115], v[208:211]
  ds_read_b64_tr_b16 a[174:175], v1 offset:10784
  v_mov_b32 v27, v23
  v_mfma_f32_16x16x32_bf16 v[208:211], a[136:139], a[96:99], v[208:211]
  s_waitcnt lgkmcnt(8)
  v_mov_b32 v28, v24
  v_mov_b32 v29, v25
  v_mfma_f32_16x16x32_bf16 v[224:227], a[144:147], a[96:99], v[224:227]
  buffer_load_dwordx4 a[208:211], v0, s[36:39], s20 offen offset:0 sc1
  v_permlane32_swap_b32 v22, v26
  v_mfma_f32_16x16x32_bf16 v[224:227], a[148:151], a[112:115], v[224:227]
  ds_read_b64_tr_b16 a[128:129], v1 offset:64
  v_permlane32_swap_b32 v23, v27
  v_mfma_f32_16x16x32_bf16 v[228:231], a[148:151], a[116:119], v[228:231]
  ds_read_b64_tr_b16 a[130:131], v1 offset:3648
  v_permlane32_swap_b32 v24, v28
  v_mfma_f32_16x16x32_bf16 v[228:231], a[144:147], a[100:103], v[228:231]
  v_permlane32_swap_b32 v25, v29
  v_add_f32 v22, v22, v26
  v_mfma_f32_16x16x32_bf16 v[232:235], a[144:147], a[104:107], v[232:235]
  ds_read_b64_tr_b16 a[132:133], v1 offset:7232
  v_add_f32 v23, v23, v27
  v_mfma_f32_16x16x32_bf16 v[232:235], a[148:151], a[120:123], v[232:235]
  buffer_load_dwordx4 a[212:215], v0, s[36:39], s20 offen offset:1024 sc1
  v_add_f32 v24, v24, v28
  v_mfma_f32_16x16x32_bf16 v[236:239], a[148:151], a[124:127], v[236:239]
  ds_read_b64_tr_b16 a[134:135], v1 offset:10816
  v_add_f32 v25, v25, v29
  v_mfma_f32_16x16x32_bf16 v[236:239], a[144:147], a[108:111], v[236:239]
  v_mul_f32 v22, 0x3a800000, v22
  v_mul_f32 v23, 0x3a800000, v23
  v_mfma_f32_16x16x32_bf16 v[252:255], a[152:155], a[108:111], v[252:255]
  ds_read_b64_tr_b16 a[136:137], v1 offset:96
  v_fma_f32 v23, -v22, v22, v23
  v_mfma_f32_16x16x32_bf16 v[252:255], a[156:159], a[124:127], v[252:255]
  v_max_f32 v23, 0, v23
  v_cvt_pk_bf16_f32 v23, v23, v23
  v_mfma_f32_16x16x32_bf16 v[248:251], a[156:159], a[120:123], v[248:251]
  buffer_load_dwordx4 a[44:47], v0, s[36:39], s11 offen offset:3072 sc1
  s_bfe_u32 s10, s83, 0x40008
  v_mfma_f32_16x16x32_bf16 v[248:251], a[152:155], a[104:107], v[248:251]
  s_mul_i32 s10, s10, 458752
  s_add_u32 m0, s84, 57344
  ds_read_b64_tr_b16 a[138:139], v1 offset:3680
  v_mfma_f32_16x16x32_bf16 v[244:247], a[152:155], a[100:103], v[244:247]
  ds_read_b64_tr_b16 a[140:141], v1 offset:7264
  v_lshlrev_b32 v23, 16, v23
  v_mfma_f32_16x16x32_bf16 v[244:247], a[156:159], a[116:119], v[244:247]
  v_add_f32 v23, 0x3727c5ac, v23
  v_cvt_pk_bf16_f32 v23, v23, v23
  v_mfma_f32_16x16x32_bf16 v[240:243], a[156:159], a[112:115], v[240:243]
  ds_read_b64_tr_b16 a[142:143], v1 offset:10848
  v_lshlrev_b32 v23, 16, v23
  v_mfma_f32_16x16x32_bf16 v[240:243], a[152:155], a[96:99], v[240:243]
  s_waitcnt vmcnt(9) lgkmcnt(8)
  buffer_load_dwordx4 v3, s[16:19], s10 offen offset:0 lds
  v_mfma_f32_16x16x32_bf16 v[32:35], a[160:163], a[0:3], v[32:35]
  s_add_u32 s11, s11, 4096
  ds_read_b64_tr_b16 a[144:145], v1 offset:128
  v_mfma_f32_16x16x32_bf16 v[32:35], a[164:167], a[16:19], v[32:35]
  s_barrier
  v_sqrt_f32 v23, v23
  v_mfma_f32_16x16x32_bf16 v[36:39], a[164:167], a[20:23], v[36:39]
  s_nop 0
  ds_read_b64_tr_b16 a[146:147], v1 offset:3712
  v_cvt_pk_bf16_f32 v12, -v22, v23
  v_mfma_f32_16x16x32_bf16 v[36:39], a[160:163], a[4:7], v[36:39]
  v_and_b32 v23, 0xffff0000, v12
  v_mfma_f32_16x16x32_bf16 v[40:43], a[160:163], a[8:11], v[40:43]
  buffer_load_dwordx4 a[48:51], v0, s[36:39], s11 offen offset:0 sc1
  v_mfma_f32_16x16x32_bf16 v[40:43], a[164:167], a[24:27], v[40:43]
  ds_read_b64_tr_b16 a[148:149], v1 offset:7296
  v_mfma_f32_16x16x32_bf16 v[44:47], a[164:167], a[28:31], v[44:47]
  ds_read_b64_tr_b16 a[150:151], v1 offset:10880
  v_mfma_f32_16x16x32_bf16 v[44:47], a[160:163], a[12:15], v[44:47]
  v_rcp_f32 v10, v23
  v_mfma_f32_16x16x32_bf16 v[60:63], a[168:171], a[12:15], v[60:63]
  ds_read_b64_tr_b16 a[152:153], v1 offset:160
  v_mul_f32 v11, v23, v23
  v_mfma_f32_16x16x32_bf16 v[60:63], a[172:175], a[28:31], v[60:63]
  v_mul_f32 v10, 0xbfb8aa3b, v10
  v_mul_f32 v24, 0x3a800000, v24
  v_mfma_f32_16x16x32_bf16 v[56:59], a[172:175], a[24:27], v[56:59]
  ds_read_b64_tr_b16 a[154:155], v1 offset:3744
  v_mul_f32 v25, 0x3a800000, v25
  v_mfma_f32_16x16x32_bf16 v[56:59], a[168:171], a[8:11], v[56:59]
  buffer_load_dwordx4 v4, s[16:19], s10 offen offset:1024 lds
  v_fma_f32 v25, -v24, v24, v25
  v_mfma_f32_16x16x32_bf16 v[52:55], a[168:171], a[4:7], v[52:55]
  ds_read_b64_tr_b16 a[156:157], v1 offset:7328
  v_max_f32 v25, 0, v25
  v_mfma_f32_16x16x32_bf16 v[52:55], a[172:175], a[20:23], v[52:55]
  v_cvt_pk_bf16_f32 v25, v25, v25
  v_lshlrev_b32 v25, 16, v25
  v_mfma_f32_16x16x32_bf16 v[48:51], a[172:175], a[16:19], v[48:51]
  ds_read_b64_tr_b16 a[158:159], v1 offset:10912
  v_add_f32 v25, 0x3727c5ac, v25
  v_mfma_f32_16x16x32_bf16 v[48:51], a[168:171], a[0:3], v[48:51]
  s_waitcnt lgkmcnt(8)
  v_cvt_pk_bf16_f32 v25, v25, v25
  v_lshlrev_b32 v25, 16, v25
  v_mfma_f32_16x16x32_bf16 v[64:67], a[128:131], a[0:3], v[64:67]
  ds_read_b64_tr_b16 a[160:161], v1 offset:192
  v_mfma_f32_16x16x32_bf16 v[64:67], a[132:135], a[16:19], v[64:67]
  v_sqrt_f32 v25, v25
  v_mfma_f32_16x16x32_bf16 v[68:71], a[132:135], a[20:23], v[68:71]
  s_nop 0
  ds_read_b64_tr_b16 a[162:163], v1 offset:3776
  v_cvt_pk_bf16_f32 v15, -v24, v25
  v_mfma_f32_16x16x32_bf16 v[68:71], a[128:131], a[4:7], v[68:71]
  buffer_load_dwordx4 a[52:55], v0, s[36:39], s11 offen offset:1024 sc1
  v_and_b32 v25, 0xffff0000, v15
  v_mfma_f32_16x16x32_bf16 v[72:75], a[128:131], a[8:11], v[72:75]
  ds_read_b64_tr_b16 a[164:165], v1 offset:7360
  v_mfma_f32_16x16x32_bf16 v[72:75], a[132:135], a[24:27], v[72:75]
  v_rcp_f32 v13, v25
  v_mfma_f32_16x16x32_bf16 v[76:79], a[132:135], a[28:31], v[76:79]
  ds_read_b64_tr_b16 a[166:167], v1 offset:10944
  v_mul_f32 v14, v25, v25
  v_mfma_f32_16x16x32_bf16 v[76:79], a[128:131], a[12:15], v[76:79]
  v_mul_f32 v13, 0xbfb8aa3b, v13
  v_accvgpr_read_b32 v22, a192
  v_mfma_f32_16x16x32_bf16 v[92:95], a[136:139], a[12:15], v[92:95]
  ds_read_b64_tr_b16 a[168:169], v1 offset:14336
  v_accvgpr_read_b32 v23, a193
  v_mfma_f32_16x16x32_bf16 v[92:95], a[140:143], a[28:31], v[92:95]
  v_accvgpr_read_b32 v24, a194
  v_accvgpr_read_b32 v25, a195
  v_mfma_f32_16x16x32_bf16 v[88:91], a[140:143], a[24:27], v[88:91]
  buffer_load_dwordx4 v5, s[16:19], s10 offen offset:2048 lds
  v_accvgpr_read_b32 v26, a196
  v_mfma_f32_16x16x32_bf16 v[88:91], a[136:139], a[8:11], v[88:91]
  ds_read_b64_tr_b16 a[170:171], v1 offset:17920
  v_accvgpr_read_b32 v27, a197
  v_mfma_f32_16x16x32_bf16 v[84:87], a[136:139], a[4:7], v[84:87]
  ds_read_b64_tr_b16 a[172:173], v1 offset:21504
  v_accvgpr_read_b32 v28, a198
  v_mfma_f32_16x16x32_bf16 v[84:87], a[140:143], a[20:23], v[84:87]
  v_accvgpr_read_b32 v29, a199
  v_add_f32 v22, v22, v26
  v_mfma_f32_16x16x32_bf16 v[80:83], a[140:143], a[16:19], v[80:83]
  ds_read_b64_tr_b16 a[174:175], v1 offset:25088
  v_add_f32 v23, v23, v27
  v_mfma_f32_16x16x32_bf16 v[80:83], a[136:139], a[0:3], v[80:83]
  s_waitcnt lgkmcnt(8)
  v_add_f32 v24, v24, v28
  v_add_f32 v25, v25, v29
  v_mfma_f32_16x16x32_bf16 v[96:99], a[144:147], a[0:3], v[96:99]
  ds_read_b64_tr_b16 a[128:129], v1 offset:14368
  v_accvgpr_read_b32 v26, a200
  v_mfma_f32_16x16x32_bf16 v[96:99], a[148:151], a[16:19], v[96:99]
  v_accvgpr_read_b32 v27, a201
  v_accvgpr_read_b32 v28, a202
  v_mfma_f32_16x16x32_bf16 v[100:103], a[148:151], a[20:23], v[100:103]
  buffer_load_dwordx4 a[56:59], v0, s[36:39], s11 offen offset:2048 sc1
  v_accvgpr_read_b32 v29, a203
  v_mfma_f32_16x16x32_bf16 v[100:103], a[144:147], a[4:7], v[100:103]
  ds_read_b64_tr_b16 a[130:131], v1 offset:17952
  v_add_f32 v22, v22, v26
  v_mfma_f32_16x16x32_bf16 v[104:107], a[144:147], a[8:11], v[104:107]
  ds_read_b64_tr_b16 a[132:133], v1 offset:21536
  v_add_f32 v23, v23, v27
  v_mfma_f32_16x16x32_bf16 v[104:107], a[148:151], a[24:27], v[104:107]
  v_add_f32 v24, v24, v28
  v_add_f32 v25, v25, v29
  v_mfma_f32_16x16x32_bf16 v[108:111], a[148:151], a[28:31], v[108:111]
  ds_read_b64_tr_b16 a[134:135], v1 offset:25120
  v_accvgpr_read_b32 v26, a204
  v_mfma_f32_16x16x32_bf16 v[108:111], a[144:147], a[12:15], v[108:111]
  v_accvgpr_read_b32 v27, a205
  v_accvgpr_read_b32 v28, a206
  v_mfma_f32_16x16x32_bf16 v[124:127], a[152:155], a[12:15], v[124:127]
  ds_read_b64_tr_b16 a[136:137], v1 offset:14400
  v_accvgpr_read_b32 v29, a207
  v_mfma_f32_16x16x32_bf16 v[124:127], a[156:159], a[28:31], v[124:127]
  buffer_load_dwordx4 v6, s[16:19], s10 offen offset:3072 lds
  v_add_f32 v22, v22, v26
  v_mfma_f32_16x16x32_bf16 v[120:123], a[156:159], a[24:27], v[120:123]
  ds_read_b64_tr_b16 a[138:139], v1 offset:17984
  v_add_f32 v23, v23, v27
  v_mfma_f32_16x16x32_bf16 v[120:123], a[152:155], a[8:11], v[120:123]
  v_add_f32 v24, v24, v28
  v_add_f32 v25, v25, v29
  v_mfma_f32_16x16x32_bf16 v[116:119], a[152:155], a[4:7], v[116:119]
  ds_read_b64_tr_b16 a[140:141], v1 offset:21568
  v_mov_b32 v26, v22
  v_mfma_f32_16x16x32_bf16 v[116:119], a[156:159], a[20:23], v[116:119]
  v_mov_b32 v27, v23
  v_mov_b32 v28, v24
  v_mfma_f32_16x16x32_bf16 v[112:115], a[156:159], a[16:19], v[112:115]
  ds_read_b64_tr_b16 a[142:143], v1 offset:25152
  v_mov_b32 v29, v25
  v_mfma_f32_16x16x32_bf16 v[112:115], a[152:155], a[0:3], v[112:115]
  s_waitcnt lgkmcnt(8)
  v_permlane16_swap_b32 v22, v26
  v_permlane16_swap_b32 v23, v27
  v_mfma_f32_16x16x32_bf16 v[128:131], a[160:163], a[0:3], v[128:131]
  ds_read_b64_tr_b16 a[144:145], v1 offset:14432
  v_permlane16_swap_b32 v24, v28
  v_mfma_f32_16x16x32_bf16 v[128:131], a[164:167], a[16:19], v[128:131]
  buffer_load_dwordx4 a[60:63], v0, s[36:39], s11 offen offset:3072 sc1
  v_permlane16_swap_b32 v25, v29
  v_mfma_f32_16x16x32_bf16 v[132:135], a[164:167], a[20:23], v[132:135]
  s_add_u32 m0, s84, 61440
  ds_read_b64_tr_b16 a[146:147], v1 offset:18016
  v_add_f32 v22, v22, v26
  v_mfma_f32_16x16x32_bf16 v[132:135], a[160:163], a[4:7], v[132:135]
  v_add_f32 v23, v23, v27
  v_add_f32 v24, v24, v28
  v_mfma_f32_16x16x32_bf16 v[136:139], a[160:163], a[8:11], v[136:139]
  ds_read_b64_tr_b16 a[148:149], v1 offset:21600
  v_add_f32 v25, v25, v29
  v_mfma_f32_16x16x32_bf16 v[136:139], a[164:167], a[24:27], v[136:139]
  v_mov_b32 v26, v22
  v_mov_b32 v27, v23
  v_mfma_f32_16x16x32_bf16 v[140:143], a[164:167], a[28:31], v[140:143]
  buffer_load_dwordx4 v7, s[16:19], s10 offen offset:0 lds
  s_bfe_u32 s11, s83, 0x40008
  v_mfma_f32_16x16x32_bf16 v[140:143], a[160:163], a[12:15], v[140:143]
  s_lshl_b32 s11, s11, 13
  s_add_u32 s11, s11, s85
  ds_read_b64_tr_b16 a[150:151], v1 offset:25184
  v_mfma_f32_16x16x32_bf16 v[156:159], a[168:171], a[12:15], v[156:159]
  ds_read_b64_tr_b16 a[152:153], v1 offset:14464
  v_mov_b32 v28, v24
  v_mfma_f32_16x16x32_bf16 v[156:159], a[172:175], a[28:31], v[156:159]
  v_mov_b32 v29, v25
  v_permlane32_swap_b32 v22, v26
  v_mfma_f32_16x16x32_bf16 v[152:155], a[172:175], a[24:27], v[152:155]
  ds_read_b64_tr_b16 a[154:155], v1 offset:18048
  v_permlane32_swap_b32 v23, v27
  v_mfma_f32_16x16x32_bf16 v[152:155], a[168:171], a[8:11], v[152:155]
  buffer_load_dwordx4 a[64:67], v0, s[36:39], s11 offen offset:0 sc1
  v_permlane32_swap_b32 v24, v28
  v_mfma_f32_16x16x32_bf16 v[148:151], a[168:171], a[4:7], v[148:151]
  ds_read_b64_tr_b16 a[156:157], v1 offset:21632
  v_permlane32_swap_b32 v25, v29
  v_mfma_f32_16x16x32_bf16 v[148:151], a[172:175], a[20:23], v[148:151]
  v_add_f32 v22, v22, v26
  v_add_f32 v23, v23, v27
  v_mfma_f32_16x16x32_bf16 v[144:147], a[172:175], a[16:19], v[144:147]
  ds_read_b64_tr_b16 a[158:159], v1 offset:25216
  v_add_f32 v24, v24, v28
  v_mfma_f32_16x16x32_bf16 v[144:147], a[168:171], a[0:3], v[144:147]
  s_waitcnt lgkmcnt(8)
  v_add_f32 v25, v25, v29
  v_mul_f32 v22, 0x3a800000, v22
  v_mfma_f32_16x16x32_bf16 v[160:163], a[128:131], a[0:3], v[160:163]
  ds_read_b64_tr_b16 a[160:161], v1 offset:14496
  v_mul_f32 v23, 0x3a800000, v23
  v_mfma_f32_16x16x32_bf16 v[160:163], a[132:135], a[16:19], v[160:163]
  v_fma_f32 v23, -v22, v22, v23
  v_max_f32 v23, 0, v23
  v_mfma_f32_16x16x32_bf16 v[164:167], a[132:135], a[20:23], v[164:167]
  buffer_load_dwordx4 v8, s[16:19], s10 offen offset:1024 lds
  v_cvt_pk_bf16_f32 v23, v23, v23
  v_mfma_f32_16x16x32_bf16 v[164:167], a[128:131], a[4:7], v[164:167]
  ds_read_b64_tr_b16 a[162:163], v1 offset:18080
  v_lshlrev_b32 v23, 16, v23
  v_mfma_f32_16x16x32_bf16 v[168:171], a[128:131], a[8:11], v[168:171]
  ds_read_b64_tr_b16 a[164:165], v1 offset:21664
  v_add_f32 v23, 0x3727c5ac, v23
  v_mfma_f32_16x16x32_bf16 v[168:171], a[132:135], a[24:27], v[168:171]
  v_cvt_pk_bf16_f32 v23, v23, v23
  v_lshlrev_b32 v23, 16, v23
  v_mfma_f32_16x16x32_bf16 v[172:175], a[132:135], a[28:31], v[172:175]
  ds_read_b64_tr_b16 a[166:167], v1 offset:25248
  v_mfma_f32_16x16x32_bf16 v[172:175], a[128:131], a[12:15], v[172:175]
  s_waitcnt vmcnt(15)
  s_barrier
  buffer_load_dwordx4 a[68:71], v0, s[36:39], s11 offen offset:1024 sc1
  v_mfma_f32_16x16x32_bf16 v[188:191], a[136:139], a[12:15], v[188:191]
  ds_read_b64_tr_b16 a[168:169], v1 offset:14528
  v_mfma_f32_16x16x32_bf16 v[188:191], a[140:143], a[28:31], v[188:191]
  v_sqrt_f32 v23, v23
  v_mfma_f32_16x16x32_bf16 v[184:187], a[140:143], a[24:27], v[184:187]
  s_nop 0
  ds_read_b64_tr_b16 a[170:171], v1 offset:18112
  v_cvt_pk_bf16_f32 v18, -v22, v23
  v_mfma_f32_16x16x32_bf16 v[184:187], a[136:139], a[8:11], v[184:187]
  v_and_b32 v23, 0xffff0000, v18
  v_mfma_f32_16x16x32_bf16 v[180:183], a[136:139], a[4:7], v[180:183]
  ds_read_b64_tr_b16 a[172:173], v1 offset:21696
  v_mfma_f32_16x16x32_bf16 v[180:183], a[140:143], a[20:23], v[180:183]
  v_rcp_f32 v16, v23
  v_mfma_f32_16x16x32_bf16 v[176:179], a[140:143], a[16:19], v[176:179]
  buffer_load_dwordx4 v9, s[16:19], s10 offen offset:2048 lds
  v_mul_f32 v17, v23, v23
  v_mfma_f32_16x16x32_bf16 v[176:179], a[136:139], a[0:3], v[176:179]
  s_waitcnt lgkmcnt(7)
  ds_read_b64_tr_b16 a[174:175], v1 offset:25280
  v_mul_f32 v16, 0xbfb8aa3b, v16
  v_mfma_f32_16x16x32_bf16 v[192:195], a[144:147], a[0:3], v[192:195]
  ds_read_b64_tr_b16 a[128:129], v1 offset:28672
  v_mul_f32 v24, 0x3a800000, v24
  v_mfma_f32_16x16x32_bf16 v[192:195], a[148:151], a[16:19], v[192:195]
  v_mul_f32 v25, 0x3a800000, v25
  v_fma_f32 v25, -v24, v24, v25
  v_mfma_f32_16x16x32_bf16 v[196:199], a[148:151], a[20:23], v[196:199]
  ds_read_b64_tr_b16 a[130:131], v1 offset:32256
  v_max_f32 v25, 0, v25
  v_mfma_f32_16x16x32_bf16 v[196:199], a[144:147], a[4:7], v[196:199]
  v_cvt_pk_bf16_f32 v25, v25, v25
  v_lshlrev_b32 v25, 16, v25
  v_mfma_f32_16x16x32_bf16 v[200:203], a[144:147], a[8:11], v[200:203]
  ds_read_b64_tr_b16 a[132:133], v1 offset:35840
  v_add_f32 v25, 0x3727c5ac, v25
  v_mfma_f32_16x16x32_bf16 v[200:203], a[148:151], a[24:27], v[200:203]
  v_cvt_pk_bf16_f32 v25, v25, v25
  v_lshlrev_b32 v25, 16, v25
  v_mfma_f32_16x16x32_bf16 v[204:207], a[148:151], a[28:31], v[204:207]
  buffer_load_dwordx4 a[72:75], v0, s[36:39], s11 offen offset:2048 sc1
  v_mfma_f32_16x16x32_bf16 v[204:207], a[144:147], a[12:15], v[204:207]
  ds_read_b64_tr_b16 a[134:135], v1 offset:39424
  v_mfma_f32_16x16x32_bf16 v[220:223], a[152:155], a[12:15], v[220:223]
  ds_read_b64_tr_b16 a[136:137], v1 offset:28704
  v_mfma_f32_16x16x32_bf16 v[220:223], a[156:159], a[28:31], v[220:223]
  v_sqrt_f32 v25, v25
  v_mfma_f32_16x16x32_bf16 v[216:219], a[156:159], a[24:27], v[216:219]
  s_nop 0
  ds_read_b64_tr_b16 a[138:139], v1 offset:32288
  v_cvt_pk_bf16_f32 v21, -v24, v25
  v_mfma_f32_16x16x32_bf16 v[216:219], a[152:155], a[8:11], v[216:219]
  v_and_b32 v25, 0xffff0000, v21
  v_mfma_f32_16x16x32_bf16 v[212:215], a[152:155], a[4:7], v[212:215]
  s_bfe_u32 s10, s83, 0x4000c
  s_mul_i32 s10, s10, 458752
  s_add_u32 m0, s84, 86016
  v_mfma_f32_16x16x32_bf16 v[212:215], a[156:159], a[20:23], v[212:215]
  ds_read_b64_tr_b16 a[140:141], v1 offset:35872
  v_mfma_f32_16x16x32_bf16 v[208:211], a[156:159], a[16:19], v[208:211]
  ds_read_b64_tr_b16 a[142:143], v1 offset:39456
  v_mfma_f32_16x16x32_bf16 v[208:211], a[152:155], a[0:3], v[208:211]
  s_waitcnt lgkmcnt(8)
  v_rcp_f32 v19, v25
  v_mfma_f32_16x16x32_bf16 v[224:227], a[160:163], a[0:3], v[224:227]
  buffer_load_dwordx4 v3, s[16:19], s10 offen offset:0 lds
  v_mul_f32 v20, v25, v25
  v_mfma_f32_16x16x32_bf16 v[224:227], a[164:167], a[16:19], v[224:227]
  v_mul_f32 v19, 0xbfb8aa3b, v19
  v_add_u32 v31, -28672, v31
  v_mfma_f32_16x16x32_bf16 v[228:231], a[164:167], a[20:23], v[228:231]
  ds_read_b64_tr_b16 a[176:177], v31 offset:0
  v_mfma_f32_16x16x32_bf16 v[228:231], a[160:163], a[4:7], v[228:231]
  ds_read_b64_tr_b16 a[178:179], v31 offset:3584
  v_mfma_f32_16x16x32_bf16 v[232:235], a[160:163], a[8:11], v[232:235]
  ds_read_b64_tr_b16 a[180:181], v31 offset:7168
  v_mfma_f32_16x16x32_bf16 v[232:235], a[164:167], a[24:27], v[232:235]
  buffer_load_dwordx4 a[76:79], v0, s[36:39], s11 offen offset:3072 sc1
  v_mfma_f32_16x16x32_bf16 v[236:239], a[164:167], a[28:31], v[236:239]
  ds_read_b64_tr_b16 a[182:183], v31 offset:10752
  v_mfma_f32_16x16x32_bf16 v[236:239], a[160:163], a[12:15], v[236:239]
  ds_read_b64_tr_b16 a[184:185], v31 offset:32
  v_mfma_f32_16x16x32_bf16 v[252:255], a[168:171], a[12:15], v[252:255]
  ds_read_b64_tr_b16 a[144:145], v1 offset:28736
  v_mfma_f32_16x16x32_bf16 v[252:255], a[172:175], a[28:31], v[252:255]
  ds_read_b64_tr_b16 a[186:187], v31 offset:3616
  v_mfma_f32_16x16x32_bf16 v[248:251], a[172:175], a[24:27], v[248:251]
  ds_read_b64_tr_b16 a[146:147], v1 offset:32320
  v_mfma_f32_16x16x32_bf16 v[248:251], a[168:171], a[8:11], v[248:251]
  ds_read_b64_tr_b16 a[188:189], v31 offset:7200
  v_mfma_f32_16x16x32_bf16 v[244:247], a[168:171], a[4:7], v[244:247]
  buffer_load_dwordx4 v4, s[16:19], s10 offen offset:1024 lds
  v_mfma_f32_16x16x32_bf16 v[244:247], a[172:175], a[20:23], v[244:247]
  ds_read_b64_tr_b16 a[148:149], v1 offset:35904
  v_mfma_f32_16x16x32_bf16 v[240:243], a[172:175], a[16:19], v[240:243]
  s_add_u32 s11, s11, 4096
  ds_read_b64_tr_b16 a[150:151], v1 offset:39488
  v_mfma_f32_16x16x32_bf16 v[240:243], a[168:171], a[0:3], v[240:243]
  s_waitcnt vmcnt(9) lgkmcnt(11)
  ds_read_b64_tr_b16 a[190:191], v31 offset:10784
  v_mfma_f32_16x16x32_bf16 v[32:35], a[128:131], a[32:35], v[32:35]
  ds_read_b64_tr_b16 a[152:153], v1 offset:28768
  v_mfma_f32_16x16x32_bf16 v[32:35], a[132:135], a[48:51], v[32:35]
  s_barrier
  ds_read_b64_tr_b16 a[192:193], v31 offset:64
  v_mfma_f32_16x16x32_bf16 v[36:39], a[132:135], a[52:55], v[36:39]
  buffer_load_dwordx4 a[80:83], v0, s[36:39], s11 offen offset:0 sc1
  v_mfma_f32_16x16x32_bf16 v[36:39], a[128:131], a[36:39], v[36:39]
  ds_read_b64_tr_b16 a[154:155], v1 offset:32352
  v_mfma_f32_16x16x32_bf16 v[40:43], a[128:131], a[40:43], v[40:43]
  ds_read_b64_tr_b16 a[156:157], v1 offset:35936
  v_mfma_f32_16x16x32_bf16 v[40:43], a[132:135], a[56:59], v[40:43]
  ds_read_b64_tr_b16 a[194:195], v31 offset:3648
  v_mfma_f32_16x16x32_bf16 v[44:47], a[132:135], a[60:63], v[44:47]
  ds_read_b64_tr_b16 a[196:197], v31 offset:7232
  ds_read_b64_tr_b16 a[198:199], v31 offset:10816
  ds_read_b64_tr_b16 a[200:201], v31 offset:96
  ds_read_b64_tr_b16 a[202:203], v31 offset:3680
  ds_read_b64_tr_b16 a[204:205], v31 offset:7264
  ds_read_b64_tr_b16 a[206:207], v31 offset:10848
  v_mfma_f32_16x16x32_bf16 v[44:47], a[128:131], a[44:47], v[44:47]
  ds_read_b64_tr_b16 a[158:159], v1 offset:39520
  v_lshrrev_b32 v22, 4, v0
  v_mfma_f32_16x16x32_bf16 v[60:63], a[136:139], a[44:47], v[60:63]
  buffer_load_dwordx4 v5, s[16:19], s10 offen offset:2048 lds
  v_and_b32 v23, 14, v22
  v_mfma_f32_16x16x32_bf16 v[60:63], a[140:143], a[60:63], v[60:63]
  ds_read_b64_tr_b16 a[160:161], v1 offset:28800
  v_lshlrev_b32 v23, 27, v23
  v_mfma_f32_16x16x32_bf16 v[56:59], a[140:143], a[56:59], v[56:59]
  ds_read_b64_tr_b16 a[162:163], v1 offset:32384
  v_and_b32 v24, 1, v22
  v_mfma_f32_16x16x32_bf16 v[56:59], a[136:139], a[40:43], v[56:59]
  v_lshl_add_u32 v23, v24, 9, v23
  v_and_b32 v22, 0x30, v22
  v_mfma_f32_16x16x32_bf16 v[52:55], a[136:139], a[36:39], v[52:55]
  ds_read_b64_tr_b16 a[164:165], v1 offset:35968
  v_add_u32 v22, v22, v23
  v_mfma_f32_16x16x32_bf16 v[52:55], a[140:143], a[52:55], v[52:55]
  s_lshl3_add_u32 s28, s59, s56
  buffer_load_dwordx4 a[84:87], v0, s[36:39], s11 offen offset:1024 sc1
  s_lshr_b32 s29, s44, 1
  v_mfma_f32_16x16x32_bf16 v[48:51], a[140:143], a[48:51], v[48:51]
  s_lshl1_add_u32 s28, s28, s29
  ds_read_b64_tr_b16 a[166:167], v1 offset:39552
  s_and_b32 s29, s44, 1
  v_mfma_f32_16x16x32_bf16 v[48:51], a[136:139], a[32:35], v[48:51]
  s_waitcnt vmcnt(21) lgkmcnt(5)
  s_lshl2_add_u32 s28, s28, s29
  s_lshl_b32 s28, s28, 8
  v_mfma_f32_16x16x32_bf16 a[216:219], a[176:179], a[208:211], a[216:219]
  s_add_u32 s28, s28, 524288
  ds_read_b64_tr_b16 a[168:169], v1 offset:28832
  v_mfma_f32_16x16x32_bf16 a[216:219], a[180:183], a[212:215], a[216:219]
  v_mfma_f32_16x16x32_bf16 a[220:223], a[184:187], a[208:211], a[220:223]
  ds_read_b64_tr_b16 a[170:171], v1 offset:32416
  v_mfma_f32_16x16x32_bf16 a[220:223], a[188:191], a[212:215], a[220:223]
  v_mfma_f32_16x16x32_bf16 a[224:227], a[192:195], a[208:211], a[224:227]
  buffer_load_dwordx4 v6, s[16:19], s10 offen offset:3072 lds
  v_mfma_f32_16x16x32_bf16 a[224:227], a[196:199], a[212:215], a[224:227]
  ds_read_b64_tr_b16 a[172:173], v1 offset:36000
  v_mfma_f32_16x16x32_bf16 a[228:231], a[200:203], a[208:211], a[228:231]
  ds_read_b64_tr_b16 a[174:175], v1 offset:39584
  v_mfma_f32_16x16x32_bf16 a[228:231], a[204:207], a[212:215], a[228:231]
  s_waitcnt lgkmcnt(8)
  v_mfma_f32_16x16x32_bf16 v[64:67], a[144:147], a[32:35], v[64:67]
  ds_read_b64_tr_b16 a[128:129], v1 offset:28864
  v_mfma_f32_16x16x32_bf16 v[64:67], a[148:151], a[48:51], v[64:67]
  buffer_load_dwordx4 a[88:91], v0, s[36:39], s11 offen offset:2048 sc1
  v_mfma_f32_16x16x32_bf16 v[68:71], a[148:151], a[52:55], v[68:71]
Hb0_1:
  s_cbranch_execz Hb0_2
  ds_read_b64_tr_b16 a[130:131], v1 offset:32448
  v_mfma_f32_16x16x32_bf16 v[68:71], a[144:147], a[36:39], v[68:71]
  s_add_u32 m0, s84, 90112
  v_mfma_f32_16x16x32_bf16 v[72:75], a[144:147], a[40:43], v[72:75]
  ds_read_b64_tr_b16 a[132:133], v1 offset:36032
  v_mfma_f32_16x16x32_bf16 v[72:75], a[148:151], a[56:59], v[72:75]
  v_mfma_f32_16x16x32_bf16 v[76:79], a[148:151], a[60:63], v[76:79]
  ds_read_b64_tr_b16 a[134:135], v1 offset:39616
  v_mfma_f32_16x16x32_bf16 v[76:79], a[144:147], a[44:47], v[76:79]
  buffer_load_dwordx4 v7, s[16:19], s10 offen offset:0 lds
  v_mfma_f32_16x16x32_bf16 v[92:95], a[152:155], a[44:47], v[92:95]
  ds_read_b64_tr_b16 a[136:137], v1 offset:43008
  v_mfma_f32_16x16x32_bf16 v[92:95], a[156:159], a[60:63], v[92:95]
  v_mfma_f32_16x16x32_bf16 v[88:91], a[156:159], a[56:59], v[88:91]
  ds_read_b64_tr_b16 a[138:139], v1 offset:46592
  v_mfma_f32_16x16x32_bf16 v[88:91], a[152:155], a[40:43], v[88:91]
  v_mfma_f32_16x16x32_bf16 v[84:87], a[152:155], a[36:39], v[84:87]
  buffer_load_dwordx4 a[92:95], v0, s[36:39], s11 offen offset:3072 sc1
  s_bfe_u32 s11, s83, 0x4000c
  v_mfma_f32_16x16x32_bf16 v[84:87], a[156:159], a[52:55], v[84:87]
  s_lshl_b32 s11, s11, 13
  s_add_u32 s11, s11, s85
  ds_read_b64_tr_b16 a[140:141], v1 offset:50176
  v_mfma_f32_16x16x32_bf16 v[80:83], a[156:159], a[48:51], v[80:83]
  ds_read_b64_tr_b16 a[142:143], v1 offset:53760
  v_mfma_f32_16x16x32_bf16 v[80:83], a[152:155], a[32:35], v[80:83]
  s_waitcnt lgkmcnt(8)
  v_mfma_f32_16x16x32_bf16 v[96:99], a[160:163], a[32:35], v[96:99]
  ds_read_b64_tr_b16 a[144:145], v1 offset:43040
  v_mfma_f32_16x16x32_bf16 v[96:99], a[164:167], a[48:51], v[96:99]
  buffer_load_dwordx4 a[96:99], v0, s[36:39], s11 offen offset:0 sc1
  v_mfma_f32_16x16x32_bf16 v[100:103], a[164:167], a[52:55], v[100:103]
  buffer_store_dwordx4 a[216:219], v22, s[36:39], s28 offen offset:0 sc1
  v_mfma_f32_16x16x32_bf16 v[100:103], a[160:163], a[36:39], v[100:103]
  ds_read_b64_tr_b16 a[146:147], v1 offset:46624
  v_mfma_f32_16x16x32_bf16 v[104:107], a[160:163], a[40:43], v[104:107]
  ds_read_b64_tr_b16 a[148:149], v1 offset:50208
  v_mfma_f32_16x16x32_bf16 v[104:107], a[164:167], a[56:59], v[104:107]
  v_mfma_f32_16x16x32_bf16 v[108:111], a[164:167], a[60:63], v[108:111]
  buffer_store_dwordx4 a[220:223], v22, s[36:39], s28 offen offset:64 sc1
  v_mfma_f32_16x16x32_bf16 v[108:111], a[160:163], a[44:47], v[108:111]
  ds_read_b64_tr_b16 a[150:151], v1 offset:53792
  v_mfma_f32_16x16x32_bf16 v[124:127], a[168:171], a[44:47], v[124:127]
  ds_read_b64_tr_b16 a[152:153], v1 offset:43072
  v_mfma_f32_16x16x32_bf16 v[124:127], a[172:175], a[60:63], v[124:127]
  v_mfma_f32_16x16x32_bf16 v[120:123], a[172:175], a[56:59], v[120:123]
  buffer_store_dwordx4 a[224:227], v22, s[36:39], s28 offen offset:128 sc1
  v_mfma_f32_16x16x32_bf16 v[120:123], a[168:171], a[40:43], v[120:123]
  ds_read_b64_tr_b16 a[154:155], v1 offset:46656
  v_mfma_f32_16x16x32_bf16 v[116:119], a[168:171], a[36:39], v[116:119]
  ds_read_b64_tr_b16 a[156:157], v1 offset:50240
  v_mfma_f32_16x16x32_bf16 v[116:119], a[172:175], a[52:55], v[116:119]
  v_mfma_f32_16x16x32_bf16 v[112:115], a[172:175], a[48:51], v[112:115]
  buffer_store_dwordx4 a[228:231], v22, s[36:39], s28 offen offset:192 sc1
  s_lshl_b32 s29, s59, 14
  v_mfma_f32_16x16x32_bf16 v[112:115], a[168:171], a[32:35], v[112:115]
  s_waitcnt lgkmcnt(7)
  ds_read_b64_tr_b16 a[158:159], v1 offset:53824
  s_lshl_b32 s30, s44, 9
  v_mfma_f32_16x16x32_bf16 v[128:131], a[128:131], a[32:35], v[128:131]
  s_add_u32 s29, s29, s30
  ds_read_b64_tr_b16 a[160:161], v1 offset:43104
  s_add_u32 s29, s29, 524288
  v_mfma_f32_16x16x32_bf16 v[128:131], a[132:135], a[48:51], v[128:131]
  s_lshr_b32 s30, s44, 1
  s_lshl_b32 s30, s30, 8
  s_and_b32 s21, s44, 1
  v_mfma_f32_16x16x32_bf16 v[132:135], a[132:135], a[52:55], v[132:135]
  s_add_u32 s30, s30, s21
  ds_read_b64_tr_b16 a[162:163], v1 offset:46688
  s_lshl3_add_u32 s30, s30, 159744
  v_mfma_f32_16x16x32_bf16 v[132:135], a[128:131], a[36:39], v[132:135]
  buffer_load_dwordx4 v8, s[16:19], s10 offen offset:1024 lds
  v_and_b32 v24, 0x1f0, v0
  v_mfma_f32_16x16x32_bf16 v[136:139], a[128:131], a[40:43], v[136:139]
  ds_read_b64_tr_b16 a[164:165], v1 offset:50272
  v_min_u32 v24, 432, v24
  v_mfma_f32_16x16x32_bf16 v[136:139], a[132:135], a[56:59], v[136:139]
  v_and_b32 v26, 0x200, v0
  v_lshl_add_u32 v25, v26, 4, v24
  v_mfma_f32_16x16x32_bf16 v[140:143], a[132:135], a[60:63], v[140:143]
  ds_read_b64_tr_b16 a[166:167], v1 offset:53856
  v_lshrrev_b32 v26, 4, v26
  v_mfma_f32_16x16x32_bf16 v[140:143], a[128:131], a[44:47], v[140:143]
  v_lshl_add_u32 v24, v24, 2, v26
  v_add_u32 v24, s30, v24
  v_mfma_f32_16x16x32_bf16 v[156:159], a[136:139], a[44:47], v[156:159]
  s_lshl2_add_u32 s21, s56, s44
  buffer_load_dwordx4 a[100:103], v0, s[36:39], s11 offen offset:1024 sc1
  s_lshl_b32 s21, s21, 19
  v_mfma_f32_16x16x32_bf16 v[156:159], a[140:143], a[60:63], v[156:159]
  s_mul_i32 s22, s59, 7
  ds_read_b64_tr_b16 a[168:169], v1 offset:43136
  s_and_b32 s30, s59, 1
  v_mfma_f32_16x16x32_bf16 v[152:155], a[140:143], a[56:59], v[152:155]
  s_add_u32 s22, s22, s30
  ds_read_b64_tr_b16 a[170:171], v1 offset:46720
  s_lshl_b32 s22, s22, 10
  v_mfma_f32_16x16x32_bf16 v[152:155], a[136:139], a[40:43], v[152:155]
  s_add_u32 s21, s21, s22
  s_add_u32 s23, s21, 19922944
  s_mul_i32 s30, s30, 8184
  v_mfma_f32_16x16x32_bf16 v[148:151], a[136:139], a[36:39], v[148:151]
  s_sub_u32 s21, s23, s30
  ds_read_b64_tr_b16 a[172:173], v1 offset:50304
  s_add_u32 s21, s21, 6144
  v_mfma_f32_16x16x32_bf16 v[148:151], a[140:143], a[52:55], v[148:151]
  s_add_u32 s22, s21, 262144
  buffer_load_dwordx4 v9, s[16:19], s10 offen offset:2048 lds
  s_lshl_b32 s45, s2, 7
  v_mfma_f32_16x16x32_bf16 v[144:147], a[140:143], a[48:51], v[144:147]
  s_add_u32 s45, s45, 5406720
  ds_read_b64_tr_b16 a[174:175], v1 offset:53888
  s_cmp_eq_u32 s44, 0
  v_mfma_f32_16x16x32_bf16 v[144:147], a[136:139], a[32:35], v[144:147]
  s_waitcnt lgkmcnt(8)
  s_cselect_b32 s45, s45, 1073741824
  s_add_u32 s28, s29, 4096
  v_mfma_f32_16x16x32_bf16 v[160:163], a[144:147], a[32:35], v[160:163]
  ds_read_b64_tr_b16 a[128:129], v1 offset:43168
  v_mfma_f32_16x16x32_bf16 v[160:163], a[148:151], a[48:51], v[160:163]
  v_mfma_f32_16x16x32_bf16 v[164:167], a[148:151], a[52:55], v[164:167]
  buffer_load_dwordx4 a[104:107], v0, s[36:39], s11 offen offset:2048 sc1
  v_mfma_f32_16x16x32_bf16 v[164:167], a[144:147], a[36:39], v[164:167]
  ds_read_b64_tr_b16 a[130:131], v1 offset:46752
  v_mfma_f32_16x16x32_bf16 v[168:171], a[144:147], a[40:43], v[168:171]
  ds_read_b64_tr_b16 a[132:133], v1 offset:50336
  v_mfma_f32_16x16x32_bf16 v[168:171], a[148:151], a[56:59], v[168:171]
  v_mfma_f32_16x16x32_bf16 v[172:175], a[148:151], a[60:63], v[172:175]
  ds_read_b64_tr_b16 a[134:135], v1 offset:53920
  v_mfma_f32_16x16x32_bf16 v[172:175], a[144:147], a[44:47], v[172:175]
  s_waitcnt vmcnt(20)
  s_barrier
  buffer_load_dwordx4 a[108:111], v0, s[36:39], s11 offen offset:3072 sc1
  s_bfe_u32 s10, s83, 0x40010
  v_mfma_f32_16x16x32_bf16 v[188:191], a[152:155], a[44:47], v[188:191]
  s_mul_i32 s10, s10, 458752
  s_add_u32 m0, s84, 0
  ds_read_b64_tr_b16 a[136:137], v1 offset:43200
  v_mfma_f32_16x16x32_bf16 v[188:191], a[156:159], a[60:63], v[188:191]
  v_mfma_f32_16x16x32_bf16 v[184:187], a[156:159], a[56:59], v[184:187]
  ds_read_b64_tr_b16 a[138:139], v1 offset:46784
  v_mfma_f32_16x16x32_bf16 v[184:187], a[152:155], a[40:43], v[184:187]
  v_mfma_f32_16x16x32_bf16 v[180:183], a[152:155], a[36:39], v[180:183]
  buffer_load_dwordx4 v3, s[16:19], s10 offen offset:0 lds
  s_add_u32 s11, s11, 4096
  v_mfma_f32_16x16x32_bf16 v[180:183], a[156:159], a[52:55], v[180:183]
  ds_read_b64_tr_b16 a[140:141], v1 offset:50368
  v_mfma_f32_16x16x32_bf16 v[176:179], a[156:159], a[48:51], v[176:179]
  ds_read_b64_tr_b16 a[142:143], v1 offset:53952
  v_mfma_f32_16x16x32_bf16 v[176:179], a[152:155], a[32:35], v[176:179]
  s_waitcnt lgkmcnt(8)
  v_mfma_f32_16x16x32_bf16 v[192:195], a[160:163], a[32:35], v[192:195]
  ds_read_b64_tr_b16 a[144:145], v2 offset:0
  v_mfma_f32_16x16x32_bf16 v[192:195], a[164:167], a[48:51], v[192:195]
  buffer_load_dwordx4 a[112:115], v0, s[36:39], s11 offen offset:0 sc1
  v_mfma_f32_16x16x32_bf16 v[196:199], a[164:167], a[52:55], v[196:199]
  ds_read_b64_tr_b16 a[146:147], v2 offset:3584
  v_mfma_f32_16x16x32_bf16 v[196:199], a[160:163], a[36:39], v[196:199]
  v_mfma_f32_16x16x32_bf16 v[200:203], a[160:163], a[40:43], v[200:203]
  ds_read_b64_tr_b16 a[148:149], v2 offset:7168
  v_mfma_f32_16x16x32_bf16 v[200:203], a[164:167], a[56:59], v[200:203]
  v_mfma_f32_16x16x32_bf16 v[204:207], a[164:167], a[60:63], v[204:207]
  buffer_load_dwordx4 v4, s[16:19], s10 offen offset:1024 lds
  v_mfma_f32_16x16x32_bf16 v[204:207], a[160:163], a[44:47], v[204:207]
  ds_read_b64_tr_b16 a[150:151], v2 offset:10752
  v_mfma_f32_16x16x32_bf16 v[220:223], a[168:171], a[44:47], v[220:223]
  ds_read_b64_tr_b16 a[152:153], v2 offset:32
  v_mfma_f32_16x16x32_bf16 v[220:223], a[172:175], a[60:63], v[220:223]
  v_mfma_f32_16x16x32_bf16 v[216:219], a[172:175], a[56:59], v[216:219]
  ds_read_b64_tr_b16 a[154:155], v2 offset:3616
  v_mfma_f32_16x16x32_bf16 v[216:219], a[168:171], a[40:43], v[216:219]
  buffer_load_dwordx4 a[116:119], v0, s[36:39], s11 offen offset:1024 sc1
  v_mfma_f32_16x16x32_bf16 v[212:215], a[168:171], a[36:39], v[212:215]
  ds_read_b64_tr_b16 a[156:157], v2 offset:7200
  v_mfma_f32_16x16x32_bf16 v[212:215], a[172:175], a[52:55], v[212:215]
  v_mfma_f32_16x16x32_bf16 v[208:211], a[172:175], a[48:51], v[208:211]
  ds_read_b64_tr_b16 a[158:159], v2 offset:10784
  v_mfma_f32_16x16x32_bf16 v[208:211], a[168:171], a[32:35], v[208:211]
  s_waitcnt lgkmcnt(8)
  v_mfma_f32_16x16x32_bf16 v[224:227], a[128:131], a[32:35], v[224:227]
  buffer_load_dwordx4 a[120:123], v0, s[36:39], s11 offen offset:2048 sc1
  v_mfma_f32_16x16x32_bf16 v[224:227], a[132:135], a[48:51], v[224:227]
  ds_read_b64_tr_b16 a[160:161], v2 offset:64
  v_mfma_f32_16x16x32_bf16 v[228:231], a[132:135], a[52:55], v[228:231]
  ds_read_b64_tr_b16 a[162:163], v2 offset:3648
  v_mfma_f32_16x16x32_bf16 v[228:231], a[128:131], a[36:39], v[228:231]
  v_mfma_f32_16x16x32_bf16 v[232:235], a[128:131], a[40:43], v[232:235]
  ds_read_b64_tr_b16 a[164:165], v2 offset:7232
  v_mfma_f32_16x16x32_bf16 v[232:235], a[132:135], a[56:59], v[232:235]
  buffer_load_dwordx4 v5, s[16:19], s10 offen offset:2048 lds
  v_mfma_f32_16x16x32_bf16 v[236:239], a[132:135], a[60:63], v[236:239]
  ds_read_b64_tr_b16 a[166:167], v2 offset:10816
  v_mfma_f32_16x16x32_bf16 v[236:239], a[128:131], a[44:47], v[236:239]
  v_mfma_f32_16x16x32_bf16 v[252:255], a[136:139], a[44:47], v[252:255]
  ds_read_b64_tr_b16 a[168:169], v2 offset:96
  v_mfma_f32_16x16x32_bf16 v[252:255], a[140:143], a[60:63], v[252:255]
  v_mfma_f32_16x16x32_bf16 v[248:251], a[140:143], a[56:59], v[248:251]
  buffer_load_dwordx4 a[124:127], v0, s[36:39], s11 offen offset:3072 sc1
  v_mfma_f32_16x16x32_bf16 v[248:251], a[136:139], a[40:43], v[248:251]
  ds_read_b64_tr_b16 a[170:171], v2 offset:3680
  v_mfma_f32_16x16x32_bf16 v[244:247], a[136:139], a[36:39], v[244:247]
  ds_read_b64_tr_b16 a[172:173], v2 offset:7264
  v_mfma_f32_16x16x32_bf16 v[244:247], a[140:143], a[52:55], v[244:247]
  v_mfma_f32_16x16x32_bf16 v[240:243], a[140:143], a[48:51], v[240:243]
  ds_read_b64_tr_b16 a[174:175], v2 offset:10848
  v_mfma_f32_16x16x32_bf16 v[240:243], a[136:139], a[32:35], v[240:243]
  s_waitcnt vmcnt(17) lgkmcnt(8)
  buffer_load_dwordx4 v6, s[16:19], s10 offen offset:3072 lds
  s_bfe_u32 s11, s83, 0x40010
  v_mfma_f32_16x16x32_bf16 v[32:35], a[144:147], a[64:67], v[32:35]
  s_lshl_b32 s11, s11, 13
  s_add_u32 s11, s11, s85
  ds_read_b64_tr_b16 a[128:129], v2 offset:128
  v_mfma_f32_16x16x32_bf16 v[32:35], a[148:151], a[80:83], v[32:35]
  s_barrier
  v_mfma_f32_16x16x32_bf16 v[36:39], a[148:151], a[84:87], v[36:39]
  ds_read_b64_tr_b16 a[130:131], v2 offset:3712
  v_mfma_f32_16x16x32_bf16 v[36:39], a[144:147], a[68:71], v[36:39]
  v_mfma_f32_16x16x32_bf16 v[40:43], a[144:147], a[72:75], v[40:43]
  buffer_load_dwordx4 a[0:3], v0, s[36:39], s11 offen offset:0 sc1
  v_mfma_f32_16x16x32_bf16 v[40:43], a[148:151], a[88:91], v[40:43]
  s_add_u32 m0, s84, 4096
  ds_read_b64_tr_b16 a[132:133], v2 offset:7296
  v_mfma_f32_16x16x32_bf16 v[44:47], a[148:151], a[92:95], v[44:47]
  ds_read_b64_tr_b16 a[134:135], v2 offset:10880
  v_mfma_f32_16x16x32_bf16 v[44:47], a[144:147], a[76:79], v[44:47]
  v_mfma_f32_16x16x32_bf16 v[60:63], a[152:155], a[76:79], v[60:63]
  ds_read_b64_tr_b16 a[136:137], v2 offset:160
  v_mfma_f32_16x16x32_bf16 v[60:63], a[156:159], a[92:95], v[60:63]
  buffer_load_dwordx4 v7, s[16:19], s10 offen offset:0 lds
  v_mfma_f32_16x16x32_bf16 v[56:59], a[156:159], a[88:91], v[56:59]
  ds_read_b64_tr_b16 a[138:139], v2 offset:3744
  v_mfma_f32_16x16x32_bf16 v[56:59], a[152:155], a[72:75], v[56:59]
  v_mfma_f32_16x16x32_bf16 v[52:55], a[152:155], a[68:71], v[52:55]
  ds_read_b64_tr_b16 a[140:141], v2 offset:7328
  v_mfma_f32_16x16x32_bf16 v[52:55], a[156:159], a[84:87], v[52:55]
  v_mfma_f32_16x16x32_bf16 v[48:51], a[156:159], a[80:83], v[48:51]
  buffer_load_dwordx4 a[4:7], v0, s[36:39], s11 offen offset:1024 sc1
  v_mfma_f32_16x16x32_bf16 v[48:51], a[152:155], a[64:67], v[48:51]
  s_waitcnt lgkmcnt(7)
  ds_read_b64_tr_b16 a[142:143], v2 offset:10912
  v_mfma_f32_16x16x32_bf16 v[64:67], a[160:163], a[64:67], v[64:67]
  ds_read_b64_tr_b16 a[144:145], v2 offset:192
  v_mfma_f32_16x16x32_bf16 v[64:67], a[164:167], a[80:83], v[64:67]
  v_mfma_f32_16x16x32_bf16 v[68:71], a[164:167], a[84:87], v[68:71]
  ds_read_b64_tr_b16 a[146:147], v2 offset:3776
  v_mfma_f32_16x16x32_bf16 v[68:71], a[160:163], a[68:71], v[68:71]
  v_mfma_f32_16x16x32_bf16 v[72:75], a[160:163], a[72:75], v[72:75]
  buffer_load_dwordx4 a[8:11], v0, s[36:39], s11 offen offset:2048 sc1
  v_mfma_f32_16x16x32_bf16 v[72:75], a[164:167], a[88:91], v[72:75]
  ds_read_b64_tr_b16 a[148:149], v2 offset:7360
  v_mfma_f32_16x16x32_bf16 v[76:79], a[164:167], a[92:95], v[76:79]
  ds_read_b64_tr_b16 a[150:151], v2 offset:10944
  v_mfma_f32_16x16x32_bf16 v[76:79], a[160:163], a[76:79], v[76:79]
  v_mfma_f32_16x16x32_bf16 v[92:95], a[168:171], a[76:79], v[92:95]
  ds_read_b64_tr_b16 a[152:153], v2 offset:14336
  v_mfma_f32_16x16x32_bf16 v[92:95], a[172:175], a[92:95], v[92:95]
  buffer_load_dwordx4 v8, s[16:19], s10 offen offset:1024 lds
  v_mfma_f32_16x16x32_bf16 v[88:91], a[172:175], a[88:91], v[88:91]
  ds_read_b64_tr_b16 a[154:155], v2 offset:17920
  v_mfma_f32_16x16x32_bf16 v[88:91], a[168:171], a[72:75], v[88:91]
  v_mfma_f32_16x16x32_bf16 v[84:87], a[168:171], a[68:71], v[84:87]
  ds_read_b64_tr_b16 a[156:157], v2 offset:21504
  v_mfma_f32_16x16x32_bf16 v[84:87], a[172:175], a[84:87], v[84:87]
  v_mfma_f32_16x16x32_bf16 v[80:83], a[172:175], a[80:83], v[80:83]
  buffer_load_dwordx4 a[12:15], v0, s[36:39], s11 offen offset:3072 sc1
  v_mfma_f32_16x16x32_bf16 v[80:83], a[168:171], a[64:67], v[80:83]
  s_waitcnt lgkmcnt(7)
  ds_read_b64_tr_b16 a[158:159], v2 offset:25088
  v_mfma_f32_16x16x32_bf16 v[96:99], a[128:131], a[64:67], v[96:99]
  ds_read_b64_tr_b16 a[160:161], v2 offset:14368
  v_mfma_f32_16x16x32_bf16 v[96:99], a[132:135], a[80:83], v[96:99]
  v_mfma_f32_16x16x32_bf16 v[100:103], a[132:135], a[84:87], v[100:103]
  ds_read_b64_tr_b16 a[162:163], v2 offset:17952
  v_mfma_f32_16x16x32_bf16 v[100:103], a[128:131], a[68:71], v[100:103]
  buffer_load_dwordx4 v9, s[16:19], s10 offen offset:2048 lds
  v_mfma_f32_16x16x32_bf16 v[104:107], a[128:131], a[72:75], v[104:107]
  s_add_u32 s11, s11, 4096
  ds_read_b64_tr_b16 a[164:165], v2 offset:21536
  v_mfma_f32_16x16x32_bf16 v[104:107], a[132:135], a[88:91], v[104:107]
  v_mfma_f32_16x16x32_bf16 v[108:111], a[132:135], a[92:95], v[108:111]
  ds_read_b64_tr_b16 a[166:167], v2 offset:25120
  v_mfma_f32_16x16x32_bf16 v[108:111], a[128:131], a[76:79], v[108:111]
  v_mfma_f32_16x16x32_bf16 v[124:127], a[136:139], a[76:79], v[124:127]
  buffer_load_dwordx4 a[16:19], v0, s[36:39], s11 offen offset:0 sc1
  v_mfma_f32_16x16x32_bf16 v[124:127], a[140:143], a[92:95], v[124:127]
  ds_read_b64_tr_b16 a[168:169], v2 offset:14400
  v_mfma_f32_16x16x32_bf16 v[120:123], a[140:143], a[88:91], v[120:123]
  ds_read_b64_tr_b16 a[170:171], v2 offset:17984
  v_mfma_f32_16x16x32_bf16 v[120:123], a[136:139], a[72:75], v[120:123]
  v_mfma_f32_16x16x32_bf16 v[116:119], a[136:139], a[68:71], v[116:119]
  ds_read_b64_tr_b16 a[172:173], v2 offset:21568
  v_mfma_f32_16x16x32_bf16 v[116:119], a[140:143], a[84:87], v[116:119]
  v_mfma_f32_16x16x32_bf16 v[112:115], a[140:143], a[80:83], v[112:115]
  ds_read_b64_tr_b16 a[174:175], v2 offset:25152
  v_mfma_f32_16x16x32_bf16 v[112:115], a[136:139], a[64:67], v[112:115]
  s_waitcnt lgkmcnt(8)
  v_mfma_f32_16x16x32_bf16 v[128:131], a[144:147], a[64:67], v[128:131]
  ds_read_b64_tr_b16 a[128:129], v2 offset:14432
  v_mfma_f32_16x16x32_bf16 v[128:131], a[148:151], a[80:83], v[128:131]
  v_mfma_f32_16x16x32_bf16 v[132:135], a[148:151], a[84:87], v[132:135]
  buffer_load_dwordx4 a[20:23], v0, s[36:39], s11 offen offset:1024 sc1
  s_bfe_u32 s10, s83, 0x40014
  v_mfma_f32_16x16x32_bf16 v[132:135], a[144:147], a[68:71], v[132:135]
  s_mul_i32 s10, s10, 458752
  s_add_u32 m0, s84, 28672
  ds_read_b64_tr_b16 a[130:131], v2 offset:18016
  v_mfma_f32_16x16x32_bf16 v[136:139], a[144:147], a[72:75], v[136:139]
  ds_read_b64_tr_b16 a[132:133], v2 offset:21600
  v_mfma_f32_16x16x32_bf16 v[136:139], a[148:151], a[88:91], v[136:139]
  v_mfma_f32_16x16x32_bf16 v[140:143], a[148:151], a[92:95], v[140:143]
  ds_read_b64_tr_b16 a[134:135], v2 offset:25184
  v_mfma_f32_16x16x32_bf16 v[140:143], a[144:147], a[76:79], v[140:143]
  buffer_load_dwordx4 v3, s[16:19], s10 offen offset:0 lds
  v_mfma_f32_16x16x32_bf16 v[156:159], a[152:155], a[76:79], v[156:159]
  ds_read_b64_tr_b16 a[136:137], v2 offset:14464
  v_mfma_f32_16x16x32_bf16 v[156:159], a[156:159], a[92:95], v[156:159]
  v_mfma_f32_16x16x32_bf16 v[152:155], a[156:159], a[88:91], v[152:155]
  ds_read_b64_tr_b16 a[138:139], v2 offset:18048
  v_mfma_f32_16x16x32_bf16 v[152:155], a[152:155], a[72:75], v[152:155]
  v_mfma_f32_16x16x32_bf16 v[148:151], a[152:155], a[68:71], v[148:151]
  buffer_load_dwordx4 a[24:27], v0, s[36:39], s11 offen offset:2048 sc1
  v_mfma_f32_16x16x32_bf16 v[148:151], a[156:159], a[84:87], v[148:151]
  ds_read_b64_tr_b16 a[140:141], v2 offset:21632
  v_mfma_f32_16x16x32_bf16 v[144:147], a[156:159], a[80:83], v[144:147]
  ds_read_b64_tr_b16 a[142:143], v2 offset:25216
  v_mfma_f32_16x16x32_bf16 v[144:147], a[152:155], a[64:67], v[144:147]
  s_waitcnt lgkmcnt(8)
  v_mfma_f32_16x16x32_bf16 v[160:163], a[160:163], a[64:67], v[160:163]
  ds_read_b64_tr_b16 a[144:145], v2 offset:14496
  v_mfma_f32_16x16x32_bf16 v[160:163], a[164:167], a[80:83], v[160:163]
  buffer_load_dwordx4 v4, s[16:19], s10 offen offset:1024 lds
  v_mfma_f32_16x16x32_bf16 v[164:167], a[164:167], a[84:87], v[164:167]
  ds_read_b64_tr_b16 a[146:147], v2 offset:18080
  v_mfma_f32_16x16x32_bf16 v[164:167], a[160:163], a[68:71], v[164:167]
  v_mfma_f32_16x16x32_bf16 v[168:171], a[160:163], a[72:75], v[168:171]
  ds_read_b64_tr_b16 a[148:149], v2 offset:21664
  v_mfma_f32_16x16x32_bf16 v[168:171], a[164:167], a[88:91], v[168:171]
  v_mfma_f32_16x16x32_bf16 v[172:175], a[164:167], a[92:95], v[172:175]
  buffer_load_dwordx4 a[28:31], v0, s[36:39], s11 offen offset:3072 sc1
  v_mfma_f32_16x16x32_bf16 v[172:175], a[160:163], a[76:79], v[172:175]
  s_waitcnt vmcnt(23)
  s_barrier
  ds_read_b64_tr_b16 a[150:151], v2 offset:25248
  v_mfma_f32_16x16x32_bf16 v[188:191], a[168:171], a[76:79], v[188:191]
  ds_read_b64_tr_b16 a[152:153], v2 offset:14528
  v_mfma_f32_16x16x32_bf16 v[188:191], a[172:175], a[92:95], v[188:191]
  v_mfma_f32_16x16x32_bf16 v[184:187], a[172:175], a[88:91], v[184:187]
  ds_read_b64_tr_b16 a[154:155], v2 offset:18112
  v_mfma_f32_16x16x32_bf16 v[184:187], a[168:171], a[72:75], v[184:187]
  buffer_load_dwordx4 v5, s[16:19], s10 offen offset:2048 lds
  s_bfe_u32 s11, s83, 0x40014
  v_mfma_f32_16x16x32_bf16 v[180:183], a[168:171], a[68:71], v[180:183]
  s_lshl_b32 s11, s11, 13
  s_add_u32 s11, s11, s85
  ds_read_b64_tr_b16 a[156:157], v2 offset:21696
  v_mfma_f32_16x16x32_bf16 v[180:183], a[172:175], a[84:87], v[180:183]
  v_mfma_f32_16x16x32_bf16 v[176:179], a[172:175], a[80:83], v[176:179]
  ds_read_b64_tr_b16 a[158:159], v2 offset:25280
  v_mfma_f32_16x16x32_bf16 v[176:179], a[168:171], a[64:67], v[176:179]
  s_waitcnt lgkmcnt(8)
  v_mfma_f32_16x16x32_bf16 v[192:195], a[128:131], a[64:67], v[192:195]
  buffer_load_dwordx4 a[32:35], v0, s[36:39], s11 offen offset:0 sc1
  v_mfma_f32_16x16x32_bf16 v[192:195], a[132:135], a[80:83], v[192:195]
  ds_read_b64_tr_b16 a[160:161], v2 offset:28672
  v_mfma_f32_16x16x32_bf16 v[196:199], a[132:135], a[84:87], v[196:199]
  ds_read_b64_tr_b16 a[162:163], v2 offset:32256
  v_mfma_f32_16x16x32_bf16 v[196:199], a[128:131], a[68:71], v[196:199]
  v_mfma_f32_16x16x32_bf16 v[200:203], a[128:131], a[72:75], v[200:203]
  ds_read_b64_tr_b16 a[164:165], v2 offset:35840
  v_mfma_f32_16x16x32_bf16 v[200:203], a[132:135], a[88:91], v[200:203]
  buffer_load_dwordx4 a[36:39], v0, s[36:39], s11 offen offset:1024 sc1
  v_mfma_f32_16x16x32_bf16 v[204:207], a[132:135], a[92:95], v[204:207]
  ds_read_b64_tr_b16 a[166:167], v2 offset:39424
  v_mfma_f32_16x16x32_bf16 v[204:207], a[128:131], a[76:79], v[204:207]
  v_mfma_f32_16x16x32_bf16 v[220:223], a[136:139], a[76:79], v[220:223]
  ds_read_b64_tr_b16 a[168:169], v2 offset:28704
  v_mfma_f32_16x16x32_bf16 v[220:223], a[140:143], a[92:95], v[220:223]
  v_mfma_f32_16x16x32_bf16 v[216:219], a[140:143], a[88:91], v[216:219]
  buffer_load_dwordx4 v6, s[16:19], s10 offen offset:3072 lds
  v_mfma_f32_16x16x32_bf16 v[216:219], a[136:139], a[72:75], v[216:219]
  ds_read_b64_tr_b16 a[170:171], v2 offset:32288
  v_mfma_f32_16x16x32_bf16 v[212:215], a[136:139], a[68:71], v[212:215]
  ds_read_b64_tr_b16 a[172:173], v2 offset:35872
  v_mfma_f32_16x16x32_bf16 v[212:215], a[140:143], a[84:87], v[212:215]
  v_mfma_f32_16x16x32_bf16 v[208:211], a[140:143], a[80:83], v[208:211]
  ds_read_b64_tr_b16 a[174:175], v2 offset:39456
  v_mfma_f32_16x16x32_bf16 v[208:211], a[136:139], a[64:67], v[208:211]
  s_waitcnt lgkmcnt(8)
  buffer_load_dwordx4 a[40:43], v0, s[36:39], s11 offen offset:2048 sc1
  s_add_u32 m0, s84, 32768
  v_mfma_f32_16x16x32_bf16 v[224:227], a[144:147], a[64:67], v[224:227]
  ds_read_b64_tr_b16 a[128:129], v2 offset:28736
  v_mfma_f32_16x16x32_bf16 v[224:227], a[148:151], a[80:83], v[224:227]
  v_mfma_f32_16x16x32_bf16 v[228:231], a[148:151], a[84:87], v[228:231]
  ds_read_b64_tr_b16 a[130:131], v2 offset:32320
  v_mfma_f32_16x16x32_bf16 v[228:231], a[144:147], a[68:71], v[228:231]
  v_mfma_f32_16x16x32_bf16 v[232:235], a[144:147], a[72:75], v[232:235]
  buffer_load_dwordx4 v7, s[16:19], s10 offen offset:0 lds
  v_mfma_f32_16x16x32_bf16 v[232:235], a[148:151], a[88:91], v[232:235]
  ds_read_b64_tr_b16 a[132:133], v2 offset:35904
  v_mfma_f32_16x16x32_bf16 v[236:239], a[148:151], a[92:95], v[236:239]
  ds_read_b64_tr_b16 a[134:135], v2 offset:39488
  v_mfma_f32_16x16x32_bf16 v[236:239], a[144:147], a[76:79], v[236:239]
  v_mfma_f32_16x16x32_bf16 v[252:255], a[152:155], a[76:79], v[252:255]
  ds_read_b64_tr_b16 a[136:137], v2 offset:28768
  v_mfma_f32_16x16x32_bf16 v[252:255], a[156:159], a[92:95], v[252:255]
  buffer_load_dwordx4 a[44:47], v0, s[36:39], s11 offen offset:3072 sc1
  v_mfma_f32_16x16x32_bf16 v[248:251], a[156:159], a[88:91], v[248:251]
  ds_read_b64_tr_b16 a[138:139], v2 offset:32352
  v_mfma_f32_16x16x32_bf16 v[248:251], a[152:155], a[72:75], v[248:251]
  v_mfma_f32_16x16x32_bf16 v[244:247], a[152:155], a[68:71], v[244:247]
  ds_read_b64_tr_b16 a[140:141], v2 offset:35936
  v_mfma_f32_16x16x32_bf16 v[244:247], a[156:159], a[84:87], v[244:247]
  v_mfma_f32_16x16x32_bf16 v[240:243], a[156:159], a[80:83], v[240:243]
  ds_read_b64_tr_b16 a[142:143], v2 offset:39520
  v_mfma_f32_16x16x32_bf16 v[240:243], a[152:155], a[64:67], v[240:243]
  s_waitcnt vmcnt(21) lgkmcnt(8)
  buffer_load_dwordx4 v8, s[16:19], s10 offen offset:1024 lds
  s_add_u32 s11, s11, 4096
  v_mfma_f32_16x16x32_bf16 v[32:35], a[160:163], a[96:99], v[32:35]
  ds_read_b64_tr_b16 a[144:145], v2 offset:28800
  v_mfma_f32_16x16x32_bf16 v[32:35], a[164:167], a[112:115], v[32:35]
  s_barrier
  v_mfma_f32_16x16x32_bf16 v[36:39], a[164:167], a[116:119], v[36:39]
  ds_read_b64_tr_b16 a[146:147], v2 offset:32384
  v_mfma_f32_16x16x32_bf16 v[36:39], a[160:163], a[100:103], v[36:39]
  v_mfma_f32_16x16x32_bf16 v[40:43], a[160:163], a[104:107], v[40:43]
  buffer_load_dwordx4 a[48:51], v0, s[36:39], s11 offen offset:0 sc1
  v_mfma_f32_16x16x32_bf16 v[40:43], a[164:167], a[120:123], v[40:43]
  ds_read_b64_tr_b16 a[148:149], v2 offset:35968
  v_mfma_f32_16x16x32_bf16 v[44:47], a[164:167], a[124:127], v[44:47]
  ds_read_b64_tr_b16 a[150:151], v2 offset:39552
  v_mfma_f32_16x16x32_bf16 v[44:47], a[160:163], a[108:111], v[44:47]
  v_mfma_f32_16x16x32_bf16 v[60:63], a[168:171], a[108:111], v[60:63]
  ds_read_b64_tr_b16 a[152:153], v2 offset:28832
  v_mfma_f32_16x16x32_bf16 v[60:63], a[172:175], a[124:127], v[60:63]
  v_mfma_f32_16x16x32_bf16 v[56:59], a[172:175], a[120:123], v[56:59]
  ds_read_b64_tr_b16 a[154:155], v2 offset:32416
  v_mfma_f32_16x16x32_bf16 v[56:59], a[168:171], a[104:107], v[56:59]
  buffer_load_dwordx4 v9, s[16:19], s10 offen offset:2048 lds
  v_mfma_f32_16x16x32_bf16 v[52:55], a[168:171], a[100:103], v[52:55]
  ds_read_b64_tr_b16 a[156:157], v2 offset:36000
  v_mfma_f32_16x16x32_bf16 v[52:55], a[172:175], a[116:119], v[52:55]
  v_mfma_f32_16x16x32_bf16 v[48:51], a[172:175], a[112:115], v[48:51]
  ds_read_b64_tr_b16 a[158:159], v2 offset:39584
  v_mfma_f32_16x16x32_bf16 v[48:51], a[168:171], a[96:99], v[48:51]
  s_waitcnt lgkmcnt(8)
  v_mfma_f32_16x16x32_bf16 v[64:67], a[128:131], a[96:99], v[64:67]
  buffer_load_dwordx4 a[52:55], v0, s[36:39], s11 offen offset:1024 sc1
  v_mfma_f32_16x16x32_bf16 v[64:67], a[132:135], a[112:115], v[64:67]
  ds_read_b64_tr_b16 a[160:161], v2 offset:28864
  v_mfma_f32_16x16x32_bf16 v[68:71], a[132:135], a[116:119], v[68:71]
  ds_read_b64_tr_b16 a[162:163], v2 offset:32448
  v_mfma_f32_16x16x32_bf16 v[68:71], a[128:131], a[100:103], v[68:71]
  v_mfma_f32_16x16x32_bf16 v[72:75], a[128:131], a[104:107], v[72:75]
  ds_read_b64_tr_b16 a[164:165], v2 offset:36032
  v_mfma_f32_16x16x32_bf16 v[72:75], a[132:135], a[120:123], v[72:75]
  v_mfma_f32_16x16x32_bf16 v[76:79], a[132:135], a[124:127], v[76:79]
  buffer_load_dwordx4 a[56:59], v0, s[36:39], s11 offen offset:2048 sc1
  v_mfma_f32_16x16x32_bf16 v[76:79], a[128:131], a[108:111], v[76:79]
  ds_read_b64_tr_b16 a[166:167], v2 offset:39616
  v_mfma_f32_16x16x32_bf16 v[92:95], a[136:139], a[108:111], v[92:95]
  s_bfe_u32 s10, s83, 0x40018
  s_mul_i32 s10, s10, 458752
  s_add_u32 m0, s84, 57344
  v_mfma_f32_16x16x32_bf16 v[92:95], a[140:143], a[124:127], v[92:95]
  ds_read_b64_tr_b16 a[168:169], v2 offset:43008
  v_mfma_f32_16x16x32_bf16 v[88:91], a[140:143], a[120:123], v[88:91]
  ds_read_b64_tr_b16 a[170:171], v2 offset:46592
  v_mfma_f32_16x16x32_bf16 v[88:91], a[136:139], a[104:107], v[88:91]
  v_mfma_f32_16x16x32_bf16 v[84:87], a[136:139], a[100:103], v[84:87]
  buffer_load_dwordx4 v3, s[16:19], s10 offen offset:0 lds
  v_mfma_f32_16x16x32_bf16 v[84:87], a[140:143], a[116:119], v[84:87]
  ds_read_b64_tr_b16 a[172:173], v2 offset:50176
  v_mfma_f32_16x16x32_bf16 v[80:83], a[140:143], a[112:115], v[80:83]
  ds_read_b64_tr_b16 a[174:175], v2 offset:53760
  v_mfma_f32_16x16x32_bf16 v[80:83], a[136:139], a[96:99], v[80:83]
  s_waitcnt lgkmcnt(8)
  v_mfma_f32_16x16x32_bf16 v[96:99], a[144:147], a[96:99], v[96:99]
  ds_read_b64_tr_b16 a[128:129], v2 offset:43040
  v_mfma_f32_16x16x32_bf16 v[96:99], a[148:151], a[112:115], v[96:99]
  buffer_load_dwordx4 a[60:63], v0, s[36:39], s11 offen offset:3072 sc1
  s_bfe_u32 s11, s83, 0x40018
  v_mfma_f32_16x16x32_bf16 v[100:103], a[148:151], a[116:119], v[100:103]
  s_lshl_b32 s11, s11, 13
  s_add_u32 s11, s11, s85
  ds_read_b64_tr_b16 a[130:131], v2 offset:46624
  v_mfma_f32_16x16x32_bf16 v[100:103], a[144:147], a[100:103], v[100:103]
  v_mfma_f32_16x16x32_bf16 v[104:107], a[144:147], a[104:107], v[104:107]
  buffer_load_dwordx4 a[208:211], v25, s[36:39], s29 offen offset:0 sc1
  v_mfma_f32_16x16x32_bf16 v[104:107], a[148:151], a[120:123], v[104:107]
  ds_read_b64_tr_b16 a[132:133], v2 offset:50208
  v_mfma_f32_16x16x32_bf16 v[108:111], a[148:151], a[124:127], v[108:111]
  ds_read_b64_tr_b16 a[134:135], v2 offset:53792
  v_mfma_f32_16x16x32_bf16 v[108:111], a[144:147], a[108:111], v[108:111]
  v_mfma_f32_16x16x32_bf16 v[124:127], a[152:155], a[108:111], v[124:127]
  ds_read_b64_tr_b16 a[136:137], v2 offset:43072
  v_mfma_f32_16x16x32_bf16 v[124:127], a[156:159], a[124:127], v[124:127]
  buffer_load_dwordx4 a[212:215], v25, s[36:39], s29 offen offset:2048 sc1
  v_mfma_f32_16x16x32_bf16 v[120:123], a[156:159], a[120:123], v[120:123]
  ds_read_b64_tr_b16 a[138:139], v2 offset:46656
  v_mfma_f32_16x16x32_bf16 v[120:123], a[152:155], a[104:107], v[120:123]
  v_mfma_f32_16x16x32_bf16 v[116:119], a[152:155], a[100:103], v[116:119]
  ds_read_b64_tr_b16 a[140:141], v2 offset:50240
  v_mfma_f32_16x16x32_bf16 v[116:119], a[156:159], a[116:119], v[116:119]
  v_mfma_f32_16x16x32_bf16 v[112:115], a[156:159], a[112:115], v[112:115]
  buffer_load_dwordx4 a[216:219], v25, s[36:39], s28 offen offset:0 sc1
  v_mfma_f32_16x16x32_bf16 v[112:115], a[152:155], a[96:99], v[112:115]
  s_waitcnt lgkmcnt(7)
  ds_read_b64_tr_b16 a[142:143], v2 offset:53824
  v_mfma_f32_16x16x32_bf16 v[128:131], a[160:163], a[96:99], v[128:131]
  ds_read_b64_tr_b16 a[144:145], v2 offset:43104
  v_mfma_f32_16x16x32_bf16 v[128:131], a[164:167], a[112:115], v[128:131]
  v_mfma_f32_16x16x32_bf16 v[132:135], a[164:167], a[116:119], v[132:135]
  ds_read_b64_tr_b16 a[146:147], v2 offset:46688
  v_mfma_f32_16x16x32_bf16 v[132:135], a[160:163], a[100:103], v[132:135]
  buffer_load_dwordx4 a[220:223], v25, s[36:39], s28 offen offset:2048 sc1
  v_mfma_f32_16x16x32_bf16 v[136:139], a[160:163], a[104:107], v[136:139]
  ds_read_b64_tr_b16 a[148:149], v2 offset:50272
  v_mfma_f32_16x16x32_bf16 v[136:139], a[164:167], a[120:123], v[136:139]
  v_mfma_f32_16x16x32_bf16 v[140:143], a[164:167], a[124:127], v[140:143]
  ds_read_b64_tr_b16 a[150:151], v2 offset:53856
  v_mfma_f32_16x16x32_bf16 v[140:143], a[160:163], a[108:111], v[140:143]
  v_mfma_f32_16x16x32_bf16 v[156:159], a[168:171], a[108:111], v[156:159]
  buffer_load_dwordx4 a[64:67], v0, s[36:39], s11 offen offset:0 sc1
  v_mfma_f32_16x16x32_bf16 v[156:159], a[172:175], a[124:127], v[156:159]
  ds_read_b64_tr_b16 a[152:153], v2 offset:43136
  v_mfma_f32_16x16x32_bf16 v[152:155], a[172:175], a[120:123], v[152:155]
  ds_read_b64_tr_b16 a[154:155], v2 offset:46720
  v_mfma_f32_16x16x32_bf16 v[152:155], a[168:171], a[104:107], v[152:155]
  v_mfma_f32_16x16x32_bf16 v[148:151], a[168:171], a[100:103], v[148:151]
  ds_read_b64_tr_b16 a[156:157], v2 offset:50304
  v_mfma_f32_16x16x32_bf16 v[148:151], a[172:175], a[116:119], v[148:151]
  buffer_load_dwordx4 v4, s[16:19], s10 offen offset:1024 lds
  v_mfma_f32_16x16x32_bf16 v[144:147], a[172:175], a[112:115], v[144:147]
Hb1_1:
  s_cbranch_execz Hb1_2
  ds_read_b64_tr_b16 a[158:159], v2 offset:53888
  v_mfma_f32_16x16x32_bf16 v[144:147], a[168:171], a[96:99], v[144:147]
  s_waitcnt lgkmcnt(8)
  v_mfma_f32_16x16x32_bf16 v[160:163], a[128:131], a[96:99], v[160:163]
  ds_read_b64_tr_b16 a[160:161], v2 offset:43168
  v_mfma_f32_16x16x32_bf16 v[160:163], a[132:135], a[112:115], v[160:163]
  v_mfma_f32_16x16x32_bf16 v[164:167], a[132:135], a[116:119], v[164:167]
  buffer_load_dwordx4 a[68:71], v0, s[36:39], s11 offen offset:1024 sc1
  v_mfma_f32_16x16x32_bf16 v[164:167], a[128:131], a[100:103], v[164:167]
  ds_read_b64_tr_b16 a[162:163], v2 offset:46752
  v_mfma_f32_16x16x32_bf16 v[168:171], a[128:131], a[104:107], v[168:171]
  ds_read_b64_tr_b16 a[164:165], v2 offset:50336
  v_mfma_f32_16x16x32_bf16 v[168:171], a[132:135], a[120:123], v[168:171]
  v_mfma_f32_16x16x32_bf16 v[172:175], a[132:135], a[124:127], v[172:175]
  ds_read_b64_tr_b16 a[166:167], v2 offset:53920
  v_mfma_f32_16x16x32_bf16 v[172:175], a[128:131], a[108:111], v[172:175]
  s_waitcnt vmcnt(27)
  s_barrier
  buffer_load_dwordx4 v5, s[16:19], s10 offen offset:2048 lds
  v_mfma_f32_16x16x32_bf16 v[188:191], a[136:139], a[108:111], v[188:191]
  ds_read_b64_tr_b16 a[168:169], v2 offset:43200
  v_mfma_f32_16x16x32_bf16 v[188:191], a[140:143], a[124:127], v[188:191]
  v_mfma_f32_16x16x32_bf16 v[184:187], a[140:143], a[120:123], v[184:187]
  ds_read_b64_tr_b16 a[170:171], v2 offset:46784
  v_mfma_f32_16x16x32_bf16 v[184:187], a[136:139], a[104:107], v[184:187]
  v_mfma_f32_16x16x32_bf16 v[180:183], a[136:139], a[100:103], v[180:183]
  buffer_load_dwordx4 a[72:75], v0, s[36:39], s11 offen offset:2048 sc1
  v_mfma_f32_16x16x32_bf16 v[180:183], a[140:143], a[116:119], v[180:183]
  ds_read_b64_tr_b16 a[172:173], v2 offset:50368
  v_mfma_f32_16x16x32_bf16 v[176:179], a[140:143], a[112:115], v[176:179]
  ds_read_b64_tr_b16 a[174:175], v2 offset:53952
  v_mfma_f32_16x16x32_bf16 v[176:179], a[136:139], a[96:99], v[176:179]
  s_waitcnt lgkmcnt(8)
  v_mfma_f32_16x16x32_bf16 v[192:195], a[144:147], a[96:99], v[192:195]
  ds_read_b64_tr_b16 a[128:129], v1 offset:0
  v_mfma_f32_16x16x32_bf16 v[192:195], a[148:151], a[112:115], v[192:195]
  buffer_load_dwordx4 v6, s[16:19], s10 offen offset:3072 lds
  v_mfma_f32_16x16x32_bf16 v[196:199], a[148:151], a[116:119], v[196:199]
  ds_read_b64_tr_b16 a[130:131], v1 offset:3584
  v_mfma_f32_16x16x32_bf16 v[196:199], a[144:147], a[100:103], v[196:199]
  v_mfma_f32_16x16x32_bf16 v[200:203], a[144:147], a[104:107], v[200:203]
  ds_read_b64_tr_b16 a[132:133], v1 offset:7168
  v_mfma_f32_16x16x32_bf16 v[200:203], a[148:151], a[120:123], v[200:203]
  v_mfma_f32_16x16x32_bf16 v[204:207], a[148:151], a[124:127], v[204:207]
  buffer_load_dwordx4 a[76:79], v0, s[36:39], s11 offen offset:3072 sc1
  s_add_u32 m0, s84, 61440
  v_mfma_f32_16x16x32_bf16 v[204:207], a[144:147], a[108:111], v[204:207]
  ds_read_b64_tr_b16 a[134:135], v1 offset:10752
  v_mfma_f32_16x16x32_bf16 v[220:223], a[152:155], a[108:111], v[220:223]
  ds_read_b64_tr_b16 a[136:137], v1 offset:32
  v_mfma_f32_16x16x32_bf16 v[220:223], a[156:159], a[124:127], v[220:223]
  v_mfma_f32_16x16x32_bf16 v[216:219], a[156:159], a[120:123], v[216:219]
  ds_read_b64_tr_b16 a[138:139], v1 offset:3616
  v_mfma_f32_16x16x32_bf16 v[216:219], a[152:155], a[104:107], v[216:219]
  buffer_load_dwordx4 v7, s[16:19], s10 offen offset:0 lds
  s_add_u32 s11, s11, 4096
  v_mfma_f32_16x16x32_bf16 v[212:215], a[152:155], a[100:103], v[212:215]
  ds_read_b64_tr_b16 a[140:141], v1 offset:7200
  v_mfma_f32_16x16x32_bf16 v[212:215], a[156:159], a[116:119], v[212:215]
  v_mfma_f32_16x16x32_bf16 v[208:211], a[156:159], a[112:115], v[208:211]
  ds_read_b64_tr_b16 a[142:143], v1 offset:10784
  v_mfma_f32_16x16x32_bf16 v[208:211], a[152:155], a[96:99], v[208:211]
  s_waitcnt lgkmcnt(8)
  v_mfma_f32_16x16x32_bf16 v[224:227], a[160:163], a[96:99], v[224:227]
  buffer_load_dwordx4 a[80:83], v0, s[36:39], s11 offen offset:0 sc1
  v_mfma_f32_16x16x32_bf16 v[224:227], a[164:167], a[112:115], v[224:227]
  ds_read_b64_tr_b16 a[144:145], v1 offset:64
  v_mfma_f32_16x16x32_bf16 v[228:231], a[164:167], a[116:119], v[228:231]
  ds_read_b64_tr_b16 a[146:147], v1 offset:3648
  v_mfma_f32_16x16x32_bf16 v[228:231], a[160:163], a[100:103], v[228:231]
  v_mfma_f32_16x16x32_bf16 v[232:235], a[160:163], a[104:107], v[232:235]
  ds_read_b64_tr_b16 a[148:149], v1 offset:7232
  v_mfma_f32_16x16x32_bf16 v[232:235], a[164:167], a[120:123], v[232:235]
  buffer_load_dwordx4 a[84:87], v0, s[36:39], s11 offen offset:1024 sc1
  v_mfma_f32_16x16x32_bf16 v[236:239], a[164:167], a[124:127], v[236:239]
  ds_read_b64_tr_b16 a[150:151], v1 offset:10816
  v_mfma_f32_16x16x32_bf16 v[236:239], a[160:163], a[108:111], v[236:239]
  v_mfma_f32_16x16x32_bf16 v[252:255], a[168:171], a[108:111], v[252:255]
  ds_read_b64_tr_b16 a[152:153], v1 offset:96
  v_mfma_f32_16x16x32_bf16 v[252:255], a[172:175], a[124:127], v[252:255]
  v_mfma_f32_16x16x32_bf16 v[248:251], a[172:175], a[120:123], v[248:251]
  buffer_load_dwordx4 v8, s[16:19], s10 offen offset:1024 lds
  v_mfma_f32_16x16x32_bf16 v[248:251], a[168:171], a[104:107], v[248:251]
  ds_read_b64_tr_b16 a[154:155], v1 offset:3680
  v_mfma_f32_16x16x32_bf16 v[244:247], a[168:171], a[100:103], v[244:247]
  ds_read_b64_tr_b16 a[156:157], v1 offset:7264
  v_mfma_f32_16x16x32_bf16 v[244:247], a[172:175], a[116:119], v[244:247]
  v_mfma_f32_16x16x32_bf16 v[240:243], a[172:175], a[112:115], v[240:243]
  ds_read_b64_tr_b16 a[158:159], v1 offset:10848
  v_mfma_f32_16x16x32_bf16 v[240:243], a[168:171], a[96:99], v[240:243]
  s_waitcnt vmcnt(29) lgkmcnt(8)
  buffer_load_dwordx4 a[88:91], v0, s[36:39], s11 offen offset:2048 sc1
  v_mfma_f32_16x16x32_bf16 v[32:35], a[128:131], a[0:3], v[32:35]
  ds_read_b64_tr_b16 a[160:161], v1 offset:128
  v_mfma_f32_16x16x32_bf16 v[32:35], a[132:135], a[16:19], v[32:35]
  s_waitcnt vmcnt(20)
  s_barrier
  v_mfma_f32_16x16x32_bf16 v[36:39], a[132:135], a[20:23], v[36:39]
  ds_read_b64_tr_b16 a[162:163], v1 offset:3712
  v_mfma_f32_16x16x32_bf16 v[36:39], a[128:131], a[4:7], v[36:39]
  v_mfma_f32_16x16x32_bf16 v[40:43], a[128:131], a[8:11], v[40:43]
  buffer_load_dwordx4 v9, s[16:19], s10 offen offset:2048 lds
  v_mfma_f32_16x16x32_bf16 v[40:43], a[132:135], a[24:27], v[40:43]
  ds_read_b64_tr_b16 a[164:165], v1 offset:7296
  v_mfma_f32_16x16x32_bf16 v[44:47], a[132:135], a[28:31], v[44:47]
  ds_read_b64_tr_b16 a[166:167], v1 offset:10880
  v_mfma_f32_16x16x32_bf16 v[44:47], a[128:131], a[12:15], v[44:47]
  v_mfma_f32_16x16x32_bf16 v[60:63], a[136:139], a[12:15], v[60:63]
  ds_read_b64_tr_b16 a[168:169], v1 offset:160
  v_mfma_f32_16x16x32_bf16 v[60:63], a[140:143], a[28:31], v[60:63]
  buffer_load_dwordx4 a[92:95], v0, s[36:39], s11 offen offset:3072 sc1
  s_bfe_u32 s11, s83, 0x4001c
  v_mfma_f32_16x16x32_bf16 v[56:59], a[140:143], a[24:27], v[56:59]
  s_lshl_b32 s11, s11, 13
  s_add_u32 s11, s11, s85
  ds_read_b64_tr_b16 a[170:171], v1 offset:3744
  v_mfma_f32_16x16x32_bf16 v[56:59], a[136:139], a[8:11], v[56:59]
  v_mfma_f32_16x16x32_bf16 v[52:55], a[136:139], a[4:7], v[52:55]
  ds_read_b64_tr_b16 a[172:173], v1 offset:7328
  v_mfma_f32_16x16x32_bf16 v[52:55], a[140:143], a[20:23], v[52:55]
  s_waitcnt vmcnt(14)
  v_accvgpr_read_b32 v26, a208
  v_accvgpr_read_b32 v27, a209
  v_mfma_f32_16x16x32_bf16 v[48:51], a[140:143], a[16:19], v[48:51]
  buffer_load_dwordx4 a[96:99], v0, s[36:39], s11 offen offset:0 sc1
  s_bfe_u32 s10, s83, 0x4001c
  v_mfma_f32_16x16x32_bf16 v[48:51], a[136:139], a[0:3], v[48:51]
  s_waitcnt lgkmcnt(7)
  s_mul_i32 s10, s10, 458752
  s_add_u32 m0, s84, 86016
  v_mfma_f32_16x16x32_bf16 v[64:67], a[144:147], a[0:3], v[64:67]
  ds_read_b64_tr_b16 a[174:175], v1 offset:10912
  v_accvgpr_read_b32 v28, a210
  v_mfma_f32_16x16x32_bf16 v[64:67], a[148:151], a[16:19], v[64:67]
  ds_read_b64_tr_b16 a[128:129], v1 offset:192
  v_accvgpr_read_b32 v29, a211
  v_mfma_f32_16x16x32_bf16 v[68:71], a[148:151], a[20:23], v[68:71]
  ds_read_b64_tr_b16 a[130:131], v1 offset:3776
  v_max_u32 v31, v26, v27
  v_mfma_f32_16x16x32_bf16 v[68:71], a[144:147], a[4:7], v[68:71]
  buffer_load_dwordx4 v3, s[16:19], s10 offen offset:0 lds
  v_max3_u32 v31, v31, v28, v29
  v_mfma_f32_16x16x32_bf16 v[72:75], a[144:147], a[8:11], v[72:75]
  ds_read_b64_tr_b16 a[132:133], v1 offset:7360
  v_accvgpr_read_b32 v22, a212
  v_mfma_f32_16x16x32_bf16 v[72:75], a[148:151], a[24:27], v[72:75]
  v_accvgpr_read_b32 v23, a213
  v_max3_u32 v31, v31, v22, v23
  v_mfma_f32_16x16x32_bf16 v[76:79], a[148:151], a[28:31], v[76:79]
  ds_read_b64_tr_b16 a[134:135], v1 offset:10944
  v_add_f32 v26, v26, v22
  v_mfma_f32_16x16x32_bf16 v[76:79], a[144:147], a[12:15], v[76:79]
  v_add_f32 v27, v27, v23
  v_accvgpr_read_b32 v22, a214
  v_mfma_f32_16x16x32_bf16 v[92:95], a[152:155], a[12:15], v[92:95]
  buffer_load_dwordx4 a[100:103], v0, s[36:39], s11 offen offset:1024 sc1
  v_accvgpr_read_b32 v23, a215
  v_mfma_f32_16x16x32_bf16 v[92:95], a[156:159], a[28:31], v[92:95]
  ds_read_b64_tr_b16 a[136:137], v1 offset:14336
  v_max3_u32 v31, v31, v22, v23
  v_mfma_f32_16x16x32_bf16 v[88:91], a[156:159], a[24:27], v[88:91]
  ds_read_b64_tr_b16 a[138:139], v1 offset:17920
  v_add_f32 v28, v28, v22
  v_mfma_f32_16x16x32_bf16 v[88:91], a[152:155], a[8:11], v[88:91]
  v_add_f32 v29, v29, v23
  v_accvgpr_read_b32 v22, a216
  v_mfma_f32_16x16x32_bf16 v[84:87], a[152:155], a[4:7], v[84:87]
  ds_read_b64_tr_b16 a[140:141], v1 offset:21504
  v_accvgpr_read_b32 v23, a217
  v_mfma_f32_16x16x32_bf16 v[84:87], a[156:159], a[20:23], v[84:87]
  buffer_load_dwordx4 v4, s[16:19], s10 offen offset:1024 lds
  v_max3_u32 v31, v31, v22, v23
  v_mfma_f32_16x16x32_bf16 v[80:83], a[156:159], a[16:19], v[80:83]
  ds_read_b64_tr_b16 a[142:143], v1 offset:25088
  v_add_f32 v26, v26, v22
  v_mfma_f32_16x16x32_bf16 v[80:83], a[152:155], a[0:3], v[80:83]
  s_waitcnt lgkmcnt(8)
  v_add_f32 v27, v27, v23
  v_accvgpr_read_b32 v22, a218
  v_mfma_f32_16x16x32_bf16 v[96:99], a[160:163], a[0:3], v[96:99]
  ds_read_b64_tr_b16 a[144:145], v1 offset:14368
  v_accvgpr_read_b32 v23, a219
  v_mfma_f32_16x16x32_bf16 v[96:99], a[164:167], a[16:19], v[96:99]
  v_max3_u32 v31, v31, v22, v23
  v_add_f32 v28, v28, v22
  v_mfma_f32_16x16x32_bf16 v[100:103], a[164:167], a[20:23], v[100:103]
  buffer_load_dwordx4 a[104:107], v0, s[36:39], s11 offen offset:2048 sc1
  v_add_f32 v29, v29, v23
  v_mfma_f32_16x16x32_bf16 v[100:103], a[160:163], a[4:7], v[100:103]
  ds_read_b64_tr_b16 a[146:147], v1 offset:17952
  v_accvgpr_read_b32 v22, a220
  v_mfma_f32_16x16x32_bf16 v[104:107], a[160:163], a[8:11], v[104:107]
  ds_read_b64_tr_b16 a[148:149], v1 offset:21536
  v_accvgpr_read_b32 v23, a221
  v_mfma_f32_16x16x32_bf16 v[104:107], a[164:167], a[24:27], v[104:107]
  v_max3_u32 v31, v31, v22, v23
  v_add_f32 v26, v26, v22
  v_mfma_f32_16x16x32_bf16 v[108:111], a[164:167], a[28:31], v[108:111]
  ds_read_b64_tr_b16 a[150:151], v1 offset:25120
  v_add_f32 v27, v27, v23
  v_mfma_f32_16x16x32_bf16 v[108:111], a[160:163], a[12:15], v[108:111]
  buffer_load_dwordx4 v5, s[16:19], s10 offen offset:2048 lds
  v_accvgpr_read_b32 v22, a222
  v_mfma_f32_16x16x32_bf16 v[124:127], a[168:171], a[12:15], v[124:127]
  ds_read_b64_tr_b16 a[152:153], v1 offset:14400
  v_accvgpr_read_b32 v23, a223
  v_mfma_f32_16x16x32_bf16 v[124:127], a[172:175], a[28:31], v[124:127]
  v_max3_u32 v31, v31, v22, v23
  v_add_f32 v28, v28, v22
  v_mfma_f32_16x16x32_bf16 v[120:123], a[172:175], a[24:27], v[120:123]
  ds_read_b64_tr_b16 a[154:155], v1 offset:17984
  v_add_f32 v29, v29, v23
  v_mfma_f32_16x16x32_bf16 v[120:123], a[168:171], a[8:11], v[120:123]
  v_cmp_eq_u32 vcc, -1, v31
  s_nop 4
  s_cbranch_vccnz CK5s
CK5x:
  v_mfma_f32_16x16x32_bf16 v[116:119], a[168:171], a[4:7], v[116:119]
  s_nop 0
  buffer_load_dwordx4 a[108:111], v0, s[36:39], s11 offen offset:3072 sc1
  v_permlane32_swap_b32 v26, v28
  v_mfma_f32_16x16x32_bf16 v[116:119], a[172:175], a[20:23], v[116:119]
  ds_read_b64_tr_b16 a[156:157], v1 offset:21568
  v_permlane32_swap_b32 v27, v29
  v_mfma_f32_16x16x32_bf16 v[112:115], a[172:175], a[16:19], v[112:115]
  ds_read_b64_tr_b16 a[158:159], v1 offset:25152
  v_add_f32 v26, v26, v28
  v_mfma_f32_16x16x32_bf16 v[112:115], a[168:171], a[0:3], v[112:115]
  s_waitcnt lgkmcnt(8)
  v_add_f32 v27, v27, v29
  v_cvt_pk_bf16_f32 v25, v26, v26
  v_mfma_f32_16x16x32_bf16 v[128:131], a[128:131], a[0:3], v[128:131]
  ds_read_b64_tr_b16 a[160:161], v1 offset:14432
  v_lshlrev_b32 v25, 16, v25
  v_mfma_f32_16x16x32_bf16 v[128:131], a[132:135], a[16:19], v[128:131]
  buffer_load_dwordx4 v6, s[16:19], s10 offen offset:3072 lds
  s_add_u32 s11, s11, 4096
  v_mfma_f32_16x16x32_bf16 v[132:135], a[132:135], a[20:23], v[132:135]
  ds_read_b64_tr_b16 a[162:163], v1 offset:18016
  v_sub_f32 v30, v26, v25
  v_mfma_f32_16x16x32_bf16 v[132:135], a[128:131], a[4:7], v[132:135]
  v_cvt_pk_bf16_f32 v22, v26, v30
  v_and_b32 v25, 0xffff0000, v22
  v_mfma_f32_16x16x32_bf16 v[136:139], a[128:131], a[8:11], v[136:139]
  ds_read_b64_tr_b16 a[164:165], v1 offset:21600
  v_sub_f32 v30, v30, v25
  v_mfma_f32_16x16x32_bf16 v[136:139], a[132:135], a[24:27], v[136:139]
  v_cvt_pk_bf16_f32 v23, v30, 0
  v_mfma_f32_16x16x32_bf16 v[140:143], a[132:135], a[28:31], v[140:143]
  buffer_load_dwordx4 a[112:115], v0, s[36:39], s11 offen offset:0 sc1
  s_add_u32 m0, s84, 90112
  v_mfma_f32_16x16x32_bf16 v[140:143], a[128:131], a[12:15], v[140:143]
  ds_read_b64_tr_b16 a[166:167], v1 offset:25184
  v_mfma_f32_16x16x32_bf16 v[156:159], a[136:139], a[12:15], v[156:159]
  ds_read_b64_tr_b16 a[168:169], v1 offset:14464
  v_mfma_f32_16x16x32_bf16 v[156:159], a[140:143], a[28:31], v[156:159]
  ds_write_b64 v24, v[22:23] offset:0
  v_cvt_pk_bf16_f32 v25, v27, v27
  v_mfma_f32_16x16x32_bf16 v[152:155], a[140:143], a[24:27], v[152:155]
  ds_read_b64_tr_b16 a[170:171], v1 offset:18048
  v_lshlrev_b32 v25, 16, v25
  v_mfma_f32_16x16x32_bf16 v[152:155], a[136:139], a[8:11], v[152:155]
  buffer_load_dwordx4 v7, s[16:19], s10 offen offset:0 lds
  v_sub_f32 v30, v27, v25
  v_mfma_f32_16x16x32_bf16 v[148:151], a[136:139], a[4:7], v[148:151]
  ds_read_b64_tr_b16 a[172:173], v1 offset:21632
  v_cvt_pk_bf16_f32 v28, v27, v30
  v_mfma_f32_16x16x32_bf16 v[148:151], a[140:143], a[20:23], v[148:151]
  v_and_b32 v25, 0xffff0000, v28
  v_sub_f32 v30, v30, v25
  v_mfma_f32_16x16x32_bf16 v[144:147], a[140:143], a[16:19], v[144:147]
  ds_read_b64_tr_b16 a[174:175], v1 offset:25216
  v_cvt_pk_bf16_f32 v29, v30, 0
  v_mfma_f32_16x16x32_bf16 v[144:147], a[136:139], a[0:3], v[144:147]
  s_waitcnt lgkmcnt(9)
  ds_write_b64 v24, v[28:29] offset:16
  s_waitcnt lgkmcnt(0)
  v_mfma_f32_16x16x32_bf16 v[160:163], a[144:147], a[0:3], v[160:163]
  buffer_load_dwordx4 a[116:119], v0, s[36:39], s11 offen offset:1024 sc1
  v_mfma_f32_16x16x32_bf16 v[160:163], a[148:151], a[16:19], v[160:163]
  s_lshl_b32 s31, s44, 8
  ds_read_b64_tr_b16 a[128:129], v1 offset:14496
  s_add_u32 s31, s31, s2
  v_mfma_f32_16x16x32_bf16 v[164:167], a[148:151], a[20:23], v[164:167]
  s_mul_i32 s31, s31, 7168
  ds_read_b64_tr_b16 a[130:131], v1 offset:18080
  v_mfma_f32_16x16x32_bf16 v[164:167], a[144:147], a[4:7], v[164:167]
  v_mfma_f32_16x16x32_bf16 v[168:171], a[144:147], a[8:11], v[168:171]
  ds_read_b64_tr_b16 a[132:133], v1 offset:21664
  v_mfma_f32_16x16x32_bf16 v[168:171], a[148:151], a[24:27], v[168:171]
  buffer_load_dwordx4 v8, s[16:19], s10 offen offset:1024 lds
  v_mfma_f32_16x16x32_bf16 v[172:175], a[148:151], a[28:31], v[172:175]
  ds_read_b64_tr_b16 a[134:135], v1 offset:25248
  v_mfma_f32_16x16x32_bf16 v[172:175], a[144:147], a[12:15], v[172:175]
  v_mfma_f32_16x16x32_bf16 v[188:191], a[152:155], a[12:15], v[188:191]
  ds_read_b64_tr_b16 a[136:137], v1 offset:14528
  v_mfma_f32_16x16x32_bf16 v[188:191], a[156:159], a[28:31], v[188:191]
  v_mfma_f32_16x16x32_bf16 v[184:187], a[156:159], a[24:27], v[184:187]
  buffer_load_dwordx4 a[120:123], v0, s[36:39], s11 offen offset:2048 sc1
  v_mfma_f32_16x16x32_bf16 v[184:187], a[152:155], a[8:11], v[184:187]
  ds_read_b64_tr_b16 a[138:139], v1 offset:18112
  v_mfma_f32_16x16x32_bf16 v[180:183], a[152:155], a[4:7], v[180:183]
  ds_read_b64_tr_b16 a[140:141], v1 offset:21696
  v_mfma_f32_16x16x32_bf16 v[180:183], a[156:159], a[20:23], v[180:183]
  v_mfma_f32_16x16x32_bf16 v[176:179], a[156:159], a[16:19], v[176:179]
  ds_read_b64_tr_b16 a[142:143], v1 offset:25280
  v_mfma_f32_16x16x32_bf16 v[176:179], a[152:155], a[0:3], v[176:179]
  s_waitcnt lgkmcnt(9)
  buffer_load_dwordx4 v9, s[16:19], s10 offen offset:2048 lds
  v_mfma_f32_16x16x32_bf16 v[192:195], a[160:163], a[0:3], v[192:195]
  ds_read_b64_tr_b16 a[144:145], v1 offset:28864
  v_mfma_f32_16x16x32_bf16 v[192:195], a[164:167], a[16:19], v[192:195]
  v_mfma_f32_16x16x32_bf16 v[196:199], a[164:167], a[20:23], v[196:199]
  ds_read_b64_tr_b16 a[146:147], v1 offset:32448
  v_mfma_f32_16x16x32_bf16 v[196:199], a[160:163], a[4:7], v[196:199]
  v_mfma_f32_16x16x32_bf16 v[200:203], a[160:163], a[8:11], v[200:203]
  buffer_load_dwordx4 a[124:127], v0, s[36:39], s11 offen offset:3072 sc1
  v_mfma_f32_16x16x32_bf16 v[200:203], a[164:167], a[24:27], v[200:203]
  ds_read_b64_tr_b16 a[148:149], v1 offset:36032
  v_mfma_f32_16x16x32_bf16 v[204:207], a[164:167], a[28:31], v[204:207]
  ds_read_b64_tr_b16 a[150:151], v1 offset:39616
  v_mfma_f32_16x16x32_bf16 v[204:207], a[160:163], a[12:15], v[204:207]
  s_waitcnt vmcnt(16)
  s_barrier
  v_mfma_f32_16x16x32_bf16 v[220:223], a[168:171], a[12:15], v[220:223]
  ds_read_b64_tr_b16 a[152:153], v1 offset:43200
  v_mfma_f32_16x16x32_bf16 v[220:223], a[172:175], a[28:31], v[220:223]
  v_mfma_f32_16x16x32_bf16 v[216:219], a[172:175], a[24:27], v[216:219]
  ds_read_b64_tr_b16 a[154:155], v1 offset:46784
  v_mfma_f32_16x16x32_bf16 v[216:219], a[168:171], a[8:11], v[216:219]
  v_mfma_f32_16x16x32_bf16 v[212:215], a[168:171], a[4:7], v[212:215]
  ds_read_b64_tr_b16 a[156:157], v1 offset:50368
  v_mfma_f32_16x16x32_bf16 v[212:215], a[172:175], a[20:23], v[212:215]
  v_mfma_f32_16x16x32_bf16 v[208:211], a[172:175], a[16:19], v[208:211]
  ds_read_b64_tr_b16 a[158:159], v1 offset:53952
  v_mfma_f32_16x16x32_bf16 v[208:211], a[168:171], a[0:3], v[208:211]
  s_waitcnt lgkmcnt(8)
  v_mfma_f32_16x16x32_bf16 v[224:227], a[128:131], a[0:3], v[224:227]
  ds_read_b64_tr_b16 a[160:161], v2 offset:192
  v_mfma_f32_16x16x32_bf16 v[224:227], a[132:135], a[16:19], v[224:227]
  v_mfma_f32_16x16x32_bf16 v[228:231], a[132:135], a[20:23], v[228:231]
  ds_read_b64_tr_b16 a[162:163], v2 offset:3776
  v_mfma_f32_16x16x32_bf16 v[228:231], a[128:131], a[4:7], v[228:231]
  v_mfma_f32_16x16x32_bf16 v[232:235], a[128:131], a[8:11], v[232:235]
  ds_read_b64_tr_b16 a[164:165], v2 offset:7360
  v_mfma_f32_16x16x32_bf16 v[232:235], a[132:135], a[24:27], v[232:235]
  v_mfma_f32_16x16x32_bf16 v[236:239], a[132:135], a[28:31], v[236:239]
  ds_read_b64_tr_b16 a[166:167], v2 offset:10944
  v_mfma_f32_16x16x32_bf16 v[236:239], a[128:131], a[12:15], v[236:239]
  v_mfma_f32_16x16x32_bf16 v[252:255], a[136:139], a[12:15], v[252:255]
  ds_read_b64_tr_b16 a[168:169], v2 offset:14528
  v_mfma_f32_16x16x32_bf16 v[252:255], a[140:143], a[28:31], v[252:255]
  v_mfma_f32_16x16x32_bf16 v[248:251], a[140:143], a[24:27], v[248:251]
  ds_read_b64_tr_b16 a[170:171], v2 offset:18112
  v_mfma_f32_16x16x32_bf16 v[248:251], a[136:139], a[8:11], v[248:251]
  v_mfma_f32_16x16x32_bf16 v[244:247], a[136:139], a[4:7], v[244:247]
  ds_read_b64_tr_b16 a[172:173], v2 offset:21696
  v_mfma_f32_16x16x32_bf16 v[244:247], a[140:143], a[20:23], v[244:247]
  v_mfma_f32_16x16x32_bf16 v[240:243], a[140:143], a[16:19], v[240:243]
  ds_read_b64_tr_b16 a[174:175], v2 offset:25280
  v_mfma_f32_16x16x32_bf16 v[240:243], a[136:139], a[0:3], v[240:243]
  s_waitcnt vmcnt(1) lgkmcnt(8)
  s_barrier
  v_mfma_f32_16x16x32_bf16 v[128:131], a[144:147], a[32:35], v[128:131]
  v_and_b32 v31, 0xf0, v0
  v_add_u32 v31, 159744, v31
  v_mfma_f32_16x16x32_bf16 v[128:131], a[148:151], a[48:51], v[128:131]
  s_barrier
  v_cmp_gt_u32 vcc, 0x100, v0
  s_mov_b32 s28, 0x01000100
  v_mfma_f32_16x16x32_bf16 v[132:135], a[148:151], a[52:55], v[132:135]
  s_mov_b32 s29, 0x03020302
  v_cndmask_b32 v12, 0, v12, vcc
  v_perm_b32 v22, v12, v12, s28
  v_mfma_f32_16x16x32_bf16 v[132:135], a[144:147], a[36:39], v[132:135]
  v_min_u32 v3, 880, v0
  v_lshlrev_b32 v3, 3, v3
  v_mfma_f32_16x16x32_bf16 v[136:139], a[144:147], a[40:43], v[136:139]
  buffer_load_dword a252, v3, s[24:27], s31 offen
  v_and_b32 v23, 0xffff, v12
  v_mfma_f32_16x16x32_bf16 v[136:139], a[148:151], a[56:59], v[136:139]
  v_perm_b32 v24, v12, v12, s29
  v_lshrrev_b32 v25, 16, v12
  v_mfma_f32_16x16x32_bf16 v[140:143], a[148:151], a[60:63], v[140:143]
  v_accvgpr_write_b32 a0, v22
  v_accvgpr_write_b32 a1, v23
  v_mfma_f32_16x16x32_bf16 v[140:143], a[144:147], a[44:47], v[140:143]
  v_accvgpr_write_b32 a2, v24
  v_accvgpr_write_b32 a3, v25
  v_mfma_f32_16x16x32_bf16 v[252:255], a[152:155], a[44:47], v[252:255]
  ds_read_b64_tr_b16 a[128:129], v2 offset:28864
  v_cndmask_b32 v15, 0, v15, vcc
  v_mfma_f32_16x16x32_bf16 v[252:255], a[156:159], a[60:63], v[252:255]
  v_perm_b32 v26, v15, v15, s28
  v_and_b32 v27, 0xffff, v15
  v_mfma_f32_16x16x32_bf16 v[248:251], a[156:159], a[56:59], v[248:251]
  ds_read_b64_tr_b16 a[130:131], v2 offset:32448
  v_perm_b32 v28, v15, v15, s29
  v_mfma_f32_16x16x32_bf16 v[248:251], a[152:155], a[40:43], v[248:251]
  v_lshrrev_b32 v29, 16, v15
  v_accvgpr_write_b32 a4, v26
  v_mfma_f32_16x16x32_bf16 v[244:247], a[152:155], a[36:39], v[244:247]
  ds_read_b64_tr_b16 a[132:133], v2 offset:36032
  v_accvgpr_write_b32 a5, v27
  v_mfma_f32_16x16x32_bf16 v[244:247], a[156:159], a[52:55], v[244:247]
  ds_read_b128 a[16:19], v31 offset:1536
  v_accvgpr_write_b32 a6, v28
  v_mfma_f32_16x16x32_bf16 v[240:243], a[156:159], a[48:51], v[240:243]
  ds_read_b128 a[20:23], v31 offset:3584
  v_accvgpr_write_b32 a7, v29
  v_mfma_f32_16x16x32_bf16 v[240:243], a[152:155], a[32:35], v[240:243]
  s_waitcnt vmcnt(16) lgkmcnt(5)
  ds_read_b64_tr_b16 a[134:135], v2 offset:39616
  v_cndmask_b32 v18, 0, v18, vcc
  v_mfma_f32_16x16x32_bf16 v[128:131], a[160:163], a[64:67], v[128:131]
  ds_read_b64_tr_b16 a[136:137], v2 offset:43200
  v_perm_b32 v22, v18, v18, s28
  v_mfma_f32_16x16x32_bf16 v[128:131], a[164:167], a[80:83], v[128:131]
  v_and_b32 v23, 0xffff, v18
  v_perm_b32 v24, v18, v18, s29
  v_mfma_f32_16x16x32_bf16 v[132:135], a[164:167], a[84:87], v[132:135]
  ds_read_b64_tr_b16 a[138:139], v2 offset:46784
  v_lshrrev_b32 v25, 16, v18
  v_mfma_f32_16x16x32_bf16 v[132:135], a[160:163], a[68:71], v[132:135]
  v_accvgpr_write_b32 a8, v22
  v_accvgpr_write_b32 a9, v23
  v_mfma_f32_16x16x32_bf16 v[136:139], a[160:163], a[72:75], v[136:139]
  ds_read_b64_tr_b16 a[140:141], v2 offset:50368
  v_accvgpr_write_b32 a10, v24
  v_mfma_f32_16x16x32_bf16 v[136:139], a[164:167], a[88:91], v[136:139]
  v_accvgpr_write_b32 a11, v25
  v_cndmask_b32 v21, 0, v21, vcc
  v_mfma_f32_16x16x32_bf16 v[140:143], a[164:167], a[92:95], v[140:143]
  ds_read_b64_tr_b16 a[142:143], v2 offset:53952
  v_perm_b32 v26, v21, v21, s28
  v_mfma_f32_16x16x32_bf16 v[140:143], a[160:163], a[76:79], v[140:143]
  v_and_b32 v27, 0xffff, v21
  v_perm_b32 v28, v21, v21, s29
  v_mfma_f32_16x16x32_bf16 v[252:255], a[168:171], a[76:79], v[252:255]
  ds_read_b64_tr_b16 a[144:145], v1 offset:28672
  v_lshrrev_b32 v29, 16, v21
  v_mfma_f32_16x16x32_bf16 v[252:255], a[172:175], a[92:95], v[252:255]
  v_accvgpr_write_b32 a12, v26
  v_accvgpr_write_b32 a13, v27
  v_mfma_f32_16x16x32_bf16 v[248:251], a[172:175], a[88:91], v[248:251]
  ds_read_b64_tr_b16 a[146:147], v1 offset:32256
  v_accvgpr_write_b32 a14, v28
  v_mfma_f32_16x16x32_bf16 v[248:251], a[168:171], a[72:75], v[248:251]
  v_accvgpr_write_b32 a15, v29
  v_mfma_f32_16x16x32_bf16 v[244:247], a[168:171], a[68:71], v[244:247]
  ds_read_b64_tr_b16 a[148:149], v1 offset:35840
  v_mfma_f32_16x16x32_bf16 v[244:247], a[172:175], a[84:87], v[244:247]
  v_mfma_f32_16x16x32_bf16 v[240:243], a[172:175], a[80:83], v[240:243]
  ds_read_b64_tr_b16 a[150:151], v1 offset:39424
  v_mfma_f32_16x16x32_bf16 v[240:243], a[168:171], a[64:67], v[240:243]
  s_waitcnt lgkmcnt(9)
  v_mfma_f32_16x16x32_bf16 v[128:131], a[16:19], a[0:3], v[128:131]
  v_mfma_f32_16x16x32_bf16 v[132:135], a[16:19], a[4:7], v[132:135]
  v_mfma_f32_16x16x32_bf16 v[136:139], a[16:19], a[8:11], v[136:139]
  v_mfma_f32_16x16x32_bf16 v[140:143], a[16:19], a[12:15], v[140:143]
  v_mfma_f32_16x16x32_bf16 v[240:243], a[20:23], a[0:3], v[240:243]
  v_mfma_f32_16x16x32_bf16 v[244:247], a[20:23], a[4:7], v[244:247]
  v_mfma_f32_16x16x32_bf16 v[248:251], a[20:23], a[8:11], v[248:251]
  v_mfma_f32_16x16x32_bf16 v[252:255], a[20:23], a[12:15], v[252:255]
  s_waitcnt vmcnt(1) lgkmcnt(4)
  v_mfma_f32_16x16x32_bf16 v[128:131], a[128:131], a[96:99], v[128:131]
  ds_read_b128 a[24:27], v31 offset:0
  v_mfma_f32_16x16x32_bf16 v[128:131], a[132:135], a[112:115], v[128:131]
  ds_read_b64_tr_b16 a[152:153], v1 offset:43008
  v_mfma_f32_16x16x32_bf16 v[132:135], a[132:135], a[116:119], v[132:135]
  ds_read_b128 a[28:31], v31 offset:2048
  v_mfma_f32_16x16x32_bf16 v[132:135], a[128:131], a[100:103], v[132:135]
  ds_read_b64_tr_b16 a[154:155], v1 offset:46592
  v_mfma_f32_16x16x32_bf16 v[136:139], a[128:131], a[104:107], v[136:139]
  ds_read_b64_tr_b16 a[156:157], v1 offset:50176
  v_mfma_f32_16x16x32_bf16 v[136:139], a[132:135], a[120:123], v[136:139]
  v_mfma_f32_16x16x32_bf16 v[140:143], a[132:135], a[124:127], v[140:143]
  ds_read_b64_tr_b16 a[158:159], v1 offset:53760
  v_mfma_f32_16x16x32_bf16 v[140:143], a[128:131], a[108:111], v[140:143]
  v_mfma_f32_16x16x32_bf16 v[252:255], a[136:139], a[108:111], v[252:255]
  ds_read_b64_tr_b16 a[160:161], v2 offset:0
  v_mul_f32 v22, v10, v128
  v_mul_f32 v23, v10, v129
  v_mul_f32 v24, v10, v130
  v_mfma_f32_16x16x32_bf16 v[252:255], a[140:143], a[124:127], v[252:255]
  v_mul_f32 v25, v10, v131
  v_exp_f32 v22, v22
  v_mul_f32 v26, v13, v132
  v_mfma_f32_16x16x32_bf16 v[248:251], a[140:143], a[120:123], v[248:251]
  ds_read_b64_tr_b16 a[162:163], v2 offset:3584
  v_exp_f32 v23, v23
  v_mul_f32 v27, v13, v133
  v_mfma_f32_16x16x32_bf16 v[248:251], a[136:139], a[104:107], v[248:251]
  v_exp_f32 v24, v24
  v_mul_f32 v28, v13, v134
  v_mfma_f32_16x16x32_bf16 v[244:247], a[136:139], a[100:103], v[244:247]
  ds_read_b64_tr_b16 a[164:165], v2 offset:7168
  v_exp_f32 v25, v25
  v_mul_f32 v29, v13, v135
  v_mfma_f32_16x16x32_bf16 v[244:247], a[140:143], a[116:119], v[244:247]
  v_exp_f32 v26, v26
  v_fma_f32 v22, v22, v11, v11
  v_mfma_f32_16x16x32_bf16 v[240:243], a[140:143], a[112:115], v[240:243]
  ds_read_b64_tr_b16 a[166:167], v2 offset:10752
  v_exp_f32 v27, v27
  v_fma_f32 v23, v23, v11, v11
  v_mfma_f32_16x16x32_bf16 v[240:243], a[136:139], a[96:99], v[240:243]
  s_waitcnt lgkmcnt(4)
  v_exp_f32 v28, v28
  v_fma_f32 v24, v24, v11, v11
  v_mfma_f32_16x16x32_bf16 v[32:35], a[144:147], a[32:35], v[32:35]
  ds_read_b64_tr_b16 a[168:169], v2 offset:14336
  v_exp_f32 v29, v29
  v_fma_f32 v25, v25, v11, v11
  v_mfma_f32_16x16x32_bf16 v[32:35], a[148:151], a[48:51], v[32:35]
  v_rcp_f32 v22, v22
  v_fma_f32 v26, v26, v14, v14
  v_mfma_f32_16x16x32_bf16 v[36:39], a[148:151], a[52:55], v[36:39]
  ds_read_b64_tr_b16 a[170:171], v2 offset:17920
  v_rcp_f32 v23, v23
  v_fma_f32 v27, v27, v14, v14
  v_mfma_f32_16x16x32_bf16 v[36:39], a[144:147], a[36:39], v[36:39]
  v_rcp_f32 v24, v24
  v_fma_f32 v28, v28, v14, v14
  v_mfma_f32_16x16x32_bf16 v[40:43], a[144:147], a[40:43], v[40:43]
  ds_read_b64_tr_b16 a[172:173], v2 offset:21504
  v_rcp_f32 v25, v25
  v_fma_f32 v29, v29, v14, v14
  v_mfma_f32_16x16x32_bf16 v[40:43], a[148:151], a[56:59], v[40:43]
  v_rcp_f32 v26, v26
  v_mul_f32 v240, v128, v240
  v_mfma_f32_16x16x32_bf16 v[44:47], a[148:151], a[60:63], v[44:47]
  ds_read_b64_tr_b16 a[174:175], v2 offset:25088
  v_rcp_f32 v27, v27
  v_mul_f32 v241, v129, v241
  v_mfma_f32_16x16x32_bf16 v[44:47], a[144:147], a[44:47], v[44:47]
  s_waitcnt lgkmcnt(11)
  v_rcp_f32 v28, v28
  v_mul_f32 v242, v130, v242
  v_mfma_f32_16x16x32_bf16 v[32:35], a[24:27], a[0:3], v[32:35]
  ds_read_b64_tr_b16 a[128:129], v2 offset:28672
  v_rcp_f32 v29, v29
  v_mul_f32 v243, v131, v243
  v_mfma_f32_16x16x32_bf16 v[36:39], a[24:27], a[4:7], v[36:39]
  v_mul_f32 v240, v240, v22
  v_mul_f32 v241, v241, v23
  v_mul_f32 v242, v242, v24
  v_mul_f32 v243, v243, v25
  v_mfma_f32_16x16x32_bf16 v[40:43], a[24:27], a[8:11], v[40:43]
  ds_read_b64_tr_b16 a[130:131], v2 offset:32256
  v_mul_f32 v22, v16, v136
  v_mul_f32 v23, v16, v137
  v_mul_f32 v24, v16, v138
  v_mfma_f32_16x16x32_bf16 v[44:47], a[24:27], a[12:15], v[44:47]
  v_mul_f32 v25, v16, v139
  v_exp_f32 v22, v22
  v_mul_f32 v244, v132, v244
  v_mfma_f32_16x16x32_bf16 v[144:147], a[28:31], a[0:3], v[144:147]
  ds_read_b64_tr_b16 a[132:133], v2 offset:35840
  v_exp_f32 v23, v23
  v_mul_f32 v245, v133, v245
  v_mfma_f32_16x16x32_bf16 v[148:151], a[28:31], a[4:7], v[148:151]
  v_exp_f32 v24, v24
  v_mul_f32 v246, v134, v246
  v_mfma_f32_16x16x32_bf16 v[152:155], a[28:31], a[8:11], v[152:155]
  ds_read_b64_tr_b16 a[134:135], v2 offset:39424
  v_exp_f32 v25, v25
  v_mul_f32 v247, v135, v247
  v_mfma_f32_16x16x32_bf16 v[156:159], a[28:31], a[12:15], v[156:159]
Hb2_1:
  s_cbranch_execz Hb2_2
  v_mul_f32 v244, v244, v26
  v_mul_f32 v245, v245, v27
  v_mul_f32 v246, v246, v28
  v_mul_f32 v247, v247, v29
  v_mfma_f32_16x16x32_bf16 v[156:159], a[152:155], a[44:47], v[156:159]
  ds_read_b64_tr_b16 a[136:137], v2 offset:43008
  v_cvt_pk_bf16_f32 v128, v240, v241
  v_cvt_pk_bf16_f32 v129, v242, v243
  v_mfma_f32_16x16x32_bf16 v[156:159], a[156:159], a[60:63], v[156:159]
  buffer_store_dwordx2 v[128:129], v0, s[36:39], s21 offen offset:0 sc1
  v_mul_f32 v26, v19, v140
  v_mul_f32 v27, v19, v141
  v_mul_f32 v28, v19, v142
  v_mfma_f32_16x16x32_bf16 v[152:155], a[156:159], a[56:59], v[152:155]
  ds_read_b64_tr_b16 a[138:139], v2 offset:46592
  v_mul_f32 v29, v19, v143
  v_exp_f32 v26, v26
  v_mfma_f32_16x16x32_bf16 v[152:155], a[152:155], a[40:43], v[152:155]
  v_fma_f32 v22, v22, v17, v17
  v_exp_f32 v27, v27
  v_fma_f32 v23, v23, v17, v17
  v_mfma_f32_16x16x32_bf16 v[148:151], a[152:155], a[36:39], v[148:151]
  ds_read_b64_tr_b16 a[140:141], v2 offset:50176
  v_exp_f32 v28, v28
  v_fma_f32 v24, v24, v17, v17
  v_mfma_f32_16x16x32_bf16 v[148:151], a[156:159], a[52:55], v[148:151]
  v_exp_f32 v29, v29
  v_fma_f32 v25, v25, v17, v17
  v_cvt_pk_bf16_f32 v132, v244, v245
  v_mfma_f32_16x16x32_bf16 v[144:147], a[156:159], a[48:51], v[144:147]
  ds_read_b64_tr_b16 a[142:143], v2 offset:53760
  v_cvt_pk_bf16_f32 v133, v246, v247
  v_mfma_f32_16x16x32_bf16 v[144:147], a[152:155], a[32:35], v[144:147]
  s_waitcnt lgkmcnt(8)
  buffer_store_dwordx2 v[132:133], v0, s[36:39], s21 offen offset:1024 sc1
  v_rcp_f32 v22, v22
  v_fma_f32 v26, v26, v20, v20
  v_mfma_f32_16x16x32_bf16 v[32:35], a[160:163], a[64:67], v[32:35]
  ds_read_b64_tr_b16 a[144:145], v1 offset:28704
  v_rcp_f32 v23, v23
  v_fma_f32 v27, v27, v20, v20
  v_mfma_f32_16x16x32_bf16 v[32:35], a[164:167], a[80:83], v[32:35]
  v_rcp_f32 v24, v24
  v_fma_f32 v28, v28, v20, v20
  v_mfma_f32_16x16x32_bf16 v[36:39], a[164:167], a[84:87], v[36:39]
  ds_read_b64_tr_b16 a[146:147], v1 offset:32288
  v_rcp_f32 v25, v25
  v_fma_f32 v29, v29, v20, v20
  v_mfma_f32_16x16x32_bf16 v[36:39], a[160:163], a[68:71], v[36:39]
  v_rcp_f32 v26, v26
  v_mul_f32 v248, v136, v248
  v_mfma_f32_16x16x32_bf16 v[40:43], a[160:163], a[72:75], v[40:43]
  ds_read_b64_tr_b16 a[148:149], v1 offset:35872
  v_rcp_f32 v27, v27
  v_mul_f32 v249, v137, v249
  v_mfma_f32_16x16x32_bf16 v[40:43], a[164:167], a[88:91], v[40:43]
  v_rcp_f32 v28, v28
  v_mul_f32 v250, v138, v250
  v_mfma_f32_16x16x32_bf16 v[44:47], a[164:167], a[92:95], v[44:47]
  ds_read_b64_tr_b16 a[150:151], v1 offset:39456
  v_rcp_f32 v29, v29
  v_mul_f32 v251, v139, v251
  v_mfma_f32_16x16x32_bf16 v[44:47], a[160:163], a[76:79], v[44:47]
  v_mul_f32 v248, v248, v22
  v_mul_f32 v249, v249, v23
  v_mul_f32 v250, v250, v24
  v_mul_f32 v251, v251, v25
  v_mfma_f32_16x16x32_bf16 v[156:159], a[168:171], a[76:79], v[156:159]
  v_mul_f32 v252, v140, v252
  v_mul_f32 v253, v141, v253
  v_mul_f32 v254, v142, v254
  v_mul_f32 v255, v143, v255
  v_mfma_f32_16x16x32_bf16 v[156:159], a[172:175], a[92:95], v[156:159]
  v_cvt_pk_bf16_f32 v136, v248, v249
  v_cvt_pk_bf16_f32 v137, v250, v251
  v_mfma_f32_16x16x32_bf16 v[152:155], a[172:175], a[88:91], v[152:155]
  buffer_store_dwordx2 v[136:137], v0, s[36:39], s22 offen offset:0 sc1
  v_mul_f32 v252, v252, v26
  v_mul_f32 v253, v253, v27
  v_mul_f32 v254, v254, v28
  v_mfma_f32_16x16x32_bf16 v[152:155], a[168:171], a[72:75], v[152:155]
  v_mul_f32 v255, v255, v29
  v_cvt_pk_bf16_f32 v140, v252, v253
  v_cvt_pk_bf16_f32 v141, v254, v255
  v_mfma_f32_16x16x32_bf16 v[148:151], a[168:171], a[68:71], v[148:151]
  buffer_store_dwordx2 v[140:141], v0, s[36:39], s22 offen offset:1024 sc1
  s_mov_b32 s21, s23
  s_add_u32 s22, s23, 262144
  v_mfma_f32_16x16x32_bf16 v[148:151], a[172:175], a[84:87], v[148:151]
  v_lshrrev_b32 v128, 4, v0
  s_add_u32 s52, s54, s71
  s_and_b32 s52, s52, 3
  s_and_b32 s58, s2, 1
  v_mfma_f32_16x16x32_bf16 v[144:147], a[172:175], a[80:83], v[144:147]
  s_lshl_b32 s57, s55, 7
  s_lshl3_add_u32 s57, s73, s57
  s_mul_i32 s53, s58, 3670016
  s_add_u32 s57, s57, s53
  s_lshr_b32 s53, s44, 1
  v_mfma_f32_16x16x32_bf16 v[144:147], a[168:171], a[64:67], v[144:147]
  s_waitcnt lgkmcnt(4)
  s_mul_i32 s53, s53, 393216
  v_bfe_u32 v129, v128, 4, 2
  v_bfe_u32 v130, v128, 1, 2
  v_xor_b32 v129, v129, v130
  v_mfma_f32_16x16x32_bf16 v[32:35], a[128:131], a[96:99], v[32:35]
  ds_read_b128 a[16:19], v31 offset:256
  v_lshlrev_b32 v129, 5, v129
  v_and_b32 v130, 1, v128
  v_lshl_add_u32 v129, v130, 4, v129
  v_mfma_f32_16x16x32_bf16 v[32:35], a[132:135], a[112:115], v[32:35]
  ds_read_b64_tr_b16 a[152:153], v1 offset:43040
  v_lshrrev_b32 v130, 3, v128
  v_lshlrev_b32 v130, 11, v130
  s_sub_u32 s24, s24, 2048
  v_mfma_f32_16x16x32_bf16 v[36:39], a[132:135], a[116:119], v[36:39]
  s_subb_u32 s25, s25, 0
  s_mov_b32 s26, 7342080
  ds_read_b128 a[20:23], v31 offset:2304
  v_add3_u32 v129, v129, v130, s57
  v_add_u32 v133, 2048, v129
  v_mfma_f32_16x16x32_bf16 v[36:39], a[128:131], a[100:103], v[36:39]
  ds_read_b64_tr_b16 a[154:155], v1 offset:46624
  v_add_u32 v134, 17408, v129
  v_xor_b32 v135, 128, v129
  v_add_u32 v136, 15360, v135
  v_mfma_f32_16x16x32_bf16 v[40:43], a[128:131], a[104:107], v[40:43]
  ds_read_b64_tr_b16 a[156:157], v1 offset:50208
  v_and_b32 v129, 7, v128
  v_lshrrev_b32 v131, 4, v128
  v_xor_b32 v129, v129, v131
  v_mfma_f32_16x16x32_bf16 v[40:43], a[132:135], a[120:123], v[40:43]
  v_lshl_add_u32 v252, v129, 4, v130
  v_xor_b32 v253, 64, v252
  v_add_u32 v253, 16384, v253
  s_lshl2_add_u32 s57, s54, s44
  v_mfma_f32_16x16x32_bf16 v[44:47], a[132:135], a[124:127], v[44:47]
  s_lshl_b32 s57, s57, 18
  s_mul_i32 s60, s58, 114688
  s_add_u32 s57, s57, s60
  s_add_u32 s57, s57, 19922944
  ds_read_b64_tr_b16 a[158:159], v1 offset:53792
  v_mfma_f32_16x16x32_bf16 v[44:47], a[128:131], a[108:111], v[44:47]
  v_add_u32 v137, s57, v0
  v_bfe_u32 v129, v128, 3, 2
  v_lshlrev_b32 v129, 5, v129
  v_and_b32 v130, 3, v128
  v_mfma_f32_16x16x32_bf16 v[156:159], a[136:139], a[108:111], v[156:159]
  ds_read_b64_tr_b16 a[160:161], v2 offset:32
  v_lshl_add_u32 v129, v130, 3, v129
  v_lshrrev_b32 v130, 2, v128
  v_lshl_add_u32 v240, v130, 7, v129
  v_mfma_f32_16x16x32_bf16 v[156:159], a[140:143], a[124:127], v[156:159]
  v_xor_b32 v241, 32, v240
  v_xor_b32 v242, 64, v240
  v_xor_b32 v243, 96, v240
  v_xor_b32 v244, 65536, v240
  v_mfma_f32_16x16x32_bf16 v[152:155], a[140:143], a[120:123], v[152:155]
  ds_read_b64_tr_b16 a[162:163], v2 offset:3616
  v_xor_b32 v245, 65568, v240
  v_xor_b32 v246, 65600, v240
  v_xor_b32 v247, 65632, v240
  v_mfma_f32_16x16x32_bf16 v[152:155], a[136:139], a[104:107], v[152:155]
  v_xor_b32 v248, 131072, v240
  v_xor_b32 v249, 131104, v240
  v_xor_b32 v250, 131136, v240
  v_xor_b32 v251, 131168, v240
  v_mfma_f32_16x16x32_bf16 v[148:151], a[136:139], a[100:103], v[148:151]
  s_lshr_b32 s57, s54, 1
  s_lshl_b32 s57, s57, 5
  s_lshl2_add_u32 s57, s58, s57
  ds_read_b64_tr_b16 a[164:165], v2 offset:7200
  v_and_b32 v129, 3, v128
  v_mfma_f32_16x16x32_bf16 v[148:151], a[140:143], a[116:119], v[148:151]
  v_bfe_u32 v130, v128, 2, 2
  v_lshl_add_u32 v129, v129, 3, v130
  v_add_lshl_u32 v138, v129, s57, 7
  v_mov_b32 v254, 1
  v_mfma_f32_16x16x32_bf16 v[144:147], a[140:143], a[112:115], v[144:147]
  s_mov_b32 s60, 5406720
  ds_read_b64_tr_b16 a[166:167], v2 offset:10784
  v_mul_f32 v22, v10, v32
  v_mul_f32 v23, v10, v33
  v_mul_f32 v24, v10, v34
  v_mfma_f32_16x16x32_bf16 v[144:147], a[136:139], a[96:99], v[144:147]
  s_waitcnt lgkmcnt(4)
  v_mul_f32 v25, v10, v35
  v_exp_f32 v22, v22
  v_mul_f32 v26, v13, v36
  v_mfma_f32_16x16x32_bf16 v[48:51], a[144:147], a[32:35], v[48:51]
  ds_read_b64_tr_b16 a[168:169], v2 offset:14368
  v_exp_f32 v23, v23
  v_mul_f32 v27, v13, v37
  v_mfma_f32_16x16x32_bf16 v[48:51], a[148:151], a[48:51], v[48:51]
  v_exp_f32 v24, v24
  v_mul_f32 v28, v13, v38
  v_mfma_f32_16x16x32_bf16 v[52:55], a[148:151], a[52:55], v[52:55]
  ds_read_b64_tr_b16 a[170:171], v2 offset:17952
  v_exp_f32 v25, v25
  v_mul_f32 v29, v13, v39
  v_mfma_f32_16x16x32_bf16 v[52:55], a[144:147], a[36:39], v[52:55]
  v_exp_f32 v26, v26
  v_fma_f32 v22, v22, v11, v11
  v_mfma_f32_16x16x32_bf16 v[56:59], a[144:147], a[40:43], v[56:59]
  ds_read_b64_tr_b16 a[172:173], v2 offset:21536
  v_exp_f32 v27, v27
  v_fma_f32 v23, v23, v11, v11
  v_mfma_f32_16x16x32_bf16 v[56:59], a[148:151], a[56:59], v[56:59]
  v_exp_f32 v28, v28
  v_fma_f32 v24, v24, v11, v11
  v_mfma_f32_16x16x32_bf16 v[60:63], a[148:151], a[60:63], v[60:63]
  ds_read_b64_tr_b16 a[174:175], v2 offset:25120
  v_exp_f32 v29, v29
  v_fma_f32 v25, v25, v11, v11
  v_mfma_f32_16x16x32_bf16 v[60:63], a[144:147], a[44:47], v[60:63]
  s_waitcnt lgkmcnt(11)
  v_rcp_f32 v22, v22
  v_fma_f32 v26, v26, v14, v14
  v_mfma_f32_16x16x32_bf16 v[48:51], a[16:19], a[0:3], v[48:51]
  ds_read_b64_tr_b16 a[128:129], v2 offset:28704
  v_rcp_f32 v23, v23
  v_fma_f32 v27, v27, v14, v14
  v_mfma_f32_16x16x32_bf16 v[52:55], a[16:19], a[4:7], v[52:55]
  v_rcp_f32 v24, v24
  v_fma_f32 v28, v28, v14, v14
  v_mfma_f32_16x16x32_bf16 v[56:59], a[16:19], a[8:11], v[56:59]
  ds_read_b64_tr_b16 a[130:131], v2 offset:32288
  v_rcp_f32 v25, v25
  v_fma_f32 v29, v29, v14, v14
  v_mfma_f32_16x16x32_bf16 v[60:63], a[16:19], a[12:15], v[60:63]
  v_rcp_f32 v26, v26
  v_mul_f32 v144, v32, v144
  v_mfma_f32_16x16x32_bf16 v[160:163], a[20:23], a[0:3], v[160:163]
  ds_read_b64_tr_b16 a[132:133], v2 offset:35872
  v_rcp_f32 v27, v27
  v_mul_f32 v145, v33, v145
  v_mfma_f32_16x16x32_bf16 v[164:167], a[20:23], a[4:7], v[164:167]
  v_rcp_f32 v28, v28
  v_mul_f32 v146, v34, v146
  v_mfma_f32_16x16x32_bf16 v[168:171], a[20:23], a[8:11], v[168:171]
  ds_read_b64_tr_b16 a[134:135], v2 offset:39456
  v_rcp_f32 v29, v29
  v_mul_f32 v147, v35, v147
  v_mfma_f32_16x16x32_bf16 v[172:175], a[20:23], a[12:15], v[172:175]
  v_mul_f32 v144, v144, v22
  v_mul_f32 v145, v145, v23
  v_mul_f32 v146, v146, v24
  v_mul_f32 v147, v147, v25
  v_mfma_f32_16x16x32_bf16 v[172:175], a[152:155], a[44:47], v[172:175]
  ds_read_b64_tr_b16 a[136:137], v2 offset:43040
  v_mul_f32 v22, v16, v40
  v_mul_f32 v23, v16, v41
  v_mul_f32 v24, v16, v42
  v_mul_f32 v25, v16, v43
  v_mfma_f32_16x16x32_bf16 v[172:175], a[156:159], a[60:63], v[172:175]
  v_exp_f32 v22, v22
  v_mul_f32 v148, v36, v148
  v_mfma_f32_16x16x32_bf16 v[168:171], a[156:159], a[56:59], v[168:171]
  ds_read_b64_tr_b16 a[138:139], v2 offset:46624
  v_exp_f32 v23, v23
  v_mul_f32 v149, v37, v149
  v_mfma_f32_16x16x32_bf16 v[168:171], a[152:155], a[40:43], v[168:171]
  v_exp_f32 v24, v24
  v_mul_f32 v150, v38, v150
  v_mfma_f32_16x16x32_bf16 v[164:167], a[152:155], a[36:39], v[164:167]
  ds_read_b64_tr_b16 a[140:141], v2 offset:50208
  v_exp_f32 v25, v25
  v_mul_f32 v151, v39, v151
  v_mfma_f32_16x16x32_bf16 v[164:167], a[156:159], a[52:55], v[164:167]
  v_mul_f32 v148, v148, v26
  v_mul_f32 v149, v149, v27
  v_mul_f32 v150, v150, v28
  v_mul_f32 v151, v151, v29
  v_mfma_f32_16x16x32_bf16 v[160:163], a[156:159], a[48:51], v[160:163]
  ds_read_b64_tr_b16 a[142:143], v2 offset:53792
  v_cvt_pk_bf16_f32 v32, v144, v145
  v_cvt_pk_bf16_f32 v33, v146, v147
  v_mul_f32 v26, v19, v44
  v_mfma_f32_16x16x32_bf16 v[160:163], a[152:155], a[32:35], v[160:163]
  s_waitcnt lgkmcnt(8)
  v_mul_f32 v27, v19, v45
  v_mul_f32 v28, v19, v46
  v_mul_f32 v29, v19, v47
  v_mfma_f32_16x16x32_bf16 v[48:51], a[160:163], a[64:67], v[48:51]
  ds_read_b64_tr_b16 a[144:145], v1 offset:28736
  v_exp_f32 v26, v26
  v_fma_f32 v22, v22, v17, v17
  v_mfma_f32_16x16x32_bf16 v[48:51], a[164:167], a[80:83], v[48:51]
  v_exp_f32 v27, v27
  v_fma_f32 v23, v23, v17, v17
  v_mfma_f32_16x16x32_bf16 v[52:55], a[164:167], a[84:87], v[52:55]
  s_mov_b32 s12, 3
  s_lshl_b32 s8, s12, 16
  s_add_u32 m0, s73, 114688
  ds_read_b64_tr_b16 a[146:147], v1 offset:32320
  v_mfma_f32_16x16x32_bf16 v[52:55], a[160:163], a[68:71], v[52:55]
  v_exp_f32 v28, v28
  v_fma_f32 v24, v24, v17, v17
  v_mfma_f32_16x16x32_bf16 v[56:59], a[160:163], a[72:75], v[56:59]
  ds_read_b64_tr_b16 a[148:149], v1 offset:35904
  v_exp_f32 v29, v29
  v_fma_f32 v25, v25, v17, v17
  v_mfma_f32_16x16x32_bf16 v[56:59], a[164:167], a[88:91], v[56:59]
  v_cvt_pk_bf16_f32 v36, v148, v149
  v_cvt_pk_bf16_f32 v37, v150, v151
  v_rcp_f32 v22, v22
  v_mfma_f32_16x16x32_bf16 v[60:63], a[164:167], a[92:95], v[60:63]
  buffer_load_dwordx4 v133, s[24:27], s8 offen offset:0 lds
  v_fma_f32 v26, v26, v20, v20
  v_rcp_f32 v23, v23
  v_mfma_f32_16x16x32_bf16 v[60:63], a[160:163], a[76:79], v[60:63]
  ds_read_b64_tr_b16 a[150:151], v1 offset:39488
  v_fma_f32 v27, v27, v20, v20
  v_rcp_f32 v24, v24
  v_mfma_f32_16x16x32_bf16 v[172:175], a[168:171], a[76:79], v[172:175]
  v_fma_f32 v28, v28, v20, v20
  v_rcp_f32 v25, v25
  v_fma_f32 v29, v29, v20, v20
  v_mfma_f32_16x16x32_bf16 v[172:175], a[172:175], a[92:95], v[172:175]
  v_rcp_f32 v26, v26
  v_mul_f32 v152, v40, v152
  v_mfma_f32_16x16x32_bf16 v[168:171], a[172:175], a[88:91], v[168:171]
  v_rcp_f32 v27, v27
  v_mul_f32 v153, v41, v153
  v_mfma_f32_16x16x32_bf16 v[168:171], a[168:171], a[72:75], v[168:171]
  buffer_load_dwordx4 v134, s[24:27], s8 offen offset:1024 lds
  v_rcp_f32 v28, v28
  v_mul_f32 v154, v42, v154
  v_mfma_f32_16x16x32_bf16 v[164:167], a[168:171], a[68:71], v[164:167]
  v_rcp_f32 v29, v29
  v_mul_f32 v155, v43, v155
  v_mul_f32 v152, v152, v22
  v_mfma_f32_16x16x32_bf16 v[164:167], a[172:175], a[84:87], v[164:167]
  v_mul_f32 v153, v153, v23
  v_mul_f32 v154, v154, v24
  v_mul_f32 v155, v155, v25
  v_mul_f32 v156, v44, v156
  v_mfma_f32_16x16x32_bf16 v[160:163], a[172:175], a[80:83], v[160:163]
  v_mul_f32 v157, v45, v157
  v_mul_f32 v158, v46, v158
  v_mul_f32 v159, v47, v159
  v_cvt_pk_bf16_f32 v40, v152, v153
  v_mfma_f32_16x16x32_bf16 v[160:163], a[168:171], a[64:67], v[160:163]
  s_waitcnt lgkmcnt(4)
  v_cvt_pk_bf16_f32 v41, v154, v155
  v_mul_f32 v156, v156, v26
  v_mul_f32 v157, v157, v27
  v_mul_f32 v158, v158, v28
  v_mfma_f32_16x16x32_bf16 v[48:51], a[128:131], a[96:99], v[48:51]
  ds_read_b128 a[24:27], v31 offset:512
  v_mul_f32 v159, v159, v29
  v_cvt_pk_bf16_f32 v44, v156, v157
  v_cvt_pk_bf16_f32 v45, v158, v159
  v_mfma_f32_16x16x32_bf16 v[48:51], a[132:135], a[112:115], v[48:51]
  buffer_load_dwordx4 v135, s[24:27], s8 offen offset:2048 lds
  v_mfma_f32_16x16x32_bf16 v[52:55], a[132:135], a[116:119], v[52:55]
  ds_read_b64_tr_b16 a[152:153], v1 offset:43072
  v_mfma_f32_16x16x32_bf16 v[52:55], a[128:131], a[100:103], v[52:55]
  ds_read_b128 a[28:31], v31 offset:2560
  v_mfma_f32_16x16x32_bf16 v[56:59], a[128:131], a[104:107], v[56:59]
  ds_read_b64_tr_b16 a[154:155], v1 offset:46656
  v_mfma_f32_16x16x32_bf16 v[56:59], a[132:135], a[120:123], v[56:59]
  ds_read_b64_tr_b16 a[156:157], v1 offset:50240
  v_mfma_f32_16x16x32_bf16 v[60:63], a[132:135], a[124:127], v[60:63]
  buffer_load_dwordx4 v136, s[24:27], s8 offen offset:3072 lds
  s_cmp_eq_u32 s52, 1
  s_cselect_b32 s13, 38, 10
  s_lshl_b32 s8, s13, 16
  v_mfma_f32_16x16x32_bf16 v[60:63], a[128:131], a[108:111], v[60:63]
  s_add_u32 m0, s73, 131072
  ds_read_b64_tr_b16 a[158:159], v1 offset:53824
  v_mfma_f32_16x16x32_bf16 v[172:175], a[136:139], a[108:111], v[172:175]
  ds_read_b64_tr_b16 a[160:161], v2 offset:64
  v_mul_f32 v22, v10, v48
  v_mul_f32 v23, v10, v49
  v_mul_f32 v24, v10, v50
  v_mfma_f32_16x16x32_bf16 v[172:175], a[140:143], a[124:127], v[172:175]
  v_mul_f32 v25, v10, v51
  v_exp_f32 v22, v22
  v_mul_f32 v26, v13, v52
  v_mfma_f32_16x16x32_bf16 v[168:171], a[140:143], a[120:123], v[168:171]
  buffer_load_dwordx4 v133, s[24:27], s8 offen offset:0 lds
  v_exp_f32 v23, v23
  v_mul_f32 v27, v13, v53
  v_mfma_f32_16x16x32_bf16 v[168:171], a[136:139], a[104:107], v[168:171]
  ds_read_b64_tr_b16 a[162:163], v2 offset:3648
  v_exp_f32 v24, v24
  v_mul_f32 v28, v13, v54
  v_mfma_f32_16x16x32_bf16 v[164:167], a[136:139], a[100:103], v[164:167]
  ds_read_b64_tr_b16 a[164:165], v2 offset:7232
  v_exp_f32 v25, v25
  v_mul_f32 v29, v13, v55
  v_mfma_f32_16x16x32_bf16 v[164:167], a[140:143], a[116:119], v[164:167]
  v_exp_f32 v26, v26
  v_fma_f32 v22, v22, v11, v11
  v_mfma_f32_16x16x32_bf16 v[160:163], a[140:143], a[112:115], v[160:163]
  ds_read_b64_tr_b16 a[166:167], v2 offset:10816
  v_exp_f32 v27, v27
  v_fma_f32 v23, v23, v11, v11
  v_mfma_f32_16x16x32_bf16 v[160:163], a[136:139], a[96:99], v[160:163]
  s_waitcnt lgkmcnt(4)
  buffer_load_dwordx4 v134, s[24:27], s8 offen offset:1024 lds
  v_exp_f32 v28, v28
  v_fma_f32 v24, v24, v11, v11
  v_mfma_f32_16x16x32_bf16 v[64:67], a[144:147], a[32:35], v[64:67]
  ds_read_b64_tr_b16 a[168:169], v2 offset:14400
  v_exp_f32 v29, v29
  v_fma_f32 v25, v25, v11, v11
  v_mfma_f32_16x16x32_bf16 v[64:67], a[148:151], a[48:51], v[64:67]
  v_rcp_f32 v22, v22
  v_fma_f32 v26, v26, v14, v14
  v_mfma_f32_16x16x32_bf16 v[68:71], a[148:151], a[52:55], v[68:71]
  ds_read_b64_tr_b16 a[170:171], v2 offset:17984
  v_rcp_f32 v23, v23
  v_fma_f32 v27, v27, v14, v14
  v_mfma_f32_16x16x32_bf16 v[68:71], a[144:147], a[36:39], v[68:71]
  v_rcp_f32 v24, v24
  v_fma_f32 v28, v28, v14, v14
  v_mfma_f32_16x16x32_bf16 v[72:75], a[144:147], a[40:43], v[72:75]
  buffer_load_dwordx4 v135, s[24:27], s8 offen offset:2048 lds
  v_rcp_f32 v25, v25
  v_fma_f32 v29, v29, v14, v14
  v_mfma_f32_16x16x32_bf16 v[72:75], a[148:151], a[56:59], v[72:75]
  ds_read_b64_tr_b16 a[172:173], v2 offset:21568
  v_rcp_f32 v26, v26
  v_mul_f32 v160, v48, v160
  v_mfma_f32_16x16x32_bf16 v[76:79], a[148:151], a[60:63], v[76:79]
  ds_read_b64_tr_b16 a[174:175], v2 offset:25152
  v_rcp_f32 v27, v27
  v_mul_f32 v161, v49, v161
  v_mfma_f32_16x16x32_bf16 v[76:79], a[144:147], a[44:47], v[76:79]
  s_waitcnt lgkmcnt(11)
  v_rcp_f32 v28, v28
  v_mul_f32 v162, v50, v162
  v_mfma_f32_16x16x32_bf16 v[64:67], a[24:27], a[0:3], v[64:67]
  ds_read_b64_tr_b16 a[128:129], v2 offset:28736
  v_rcp_f32 v29, v29
  v_mul_f32 v163, v51, v163
  v_mfma_f32_16x16x32_bf16 v[68:71], a[24:27], a[4:7], v[68:71]
  buffer_load_dwordx4 v136, s[24:27], s8 offen offset:3072 lds
  v_mul_f32 v160, v160, v22
  v_mul_f32 v161, v161, v23
  v_mul_f32 v162, v162, v24
  v_mfma_f32_16x16x32_bf16 v[72:75], a[24:27], a[8:11], v[72:75]
  s_cmp_eq_u32 s52, 2
  s_cselect_b32 s14, 45, 17
  s_lshl_b32 s8, s14, 16
  s_add_u32 m0, s73, 0
  ds_read_b64_tr_b16 a[130:131], v2 offset:32320
  v_mfma_f32_16x16x32_bf16 v[76:79], a[24:27], a[12:15], v[76:79]
  v_mul_f32 v163, v163, v25
  v_mul_f32 v22, v16, v56
  v_mul_f32 v23, v16, v57
  v_mul_f32 v24, v16, v58
  v_mfma_f32_16x16x32_bf16 v[176:179], a[28:31], a[0:3], v[176:179]
  ds_read_b64_tr_b16 a[132:133], v2 offset:35904
  v_mul_f32 v25, v16, v59
  v_exp_f32 v22, v22
  v_mfma_f32_16x16x32_bf16 v[180:183], a[28:31], a[4:7], v[180:183]
  v_mul_f32 v164, v52, v164
  v_exp_f32 v23, v23
  v_mul_f32 v165, v53, v165
  v_mfma_f32_16x16x32_bf16 v[184:187], a[28:31], a[8:11], v[184:187]
  buffer_load_dwordx4 v133, s[24:27], s8 offen offset:0 lds
  v_exp_f32 v24, v24
  v_mul_f32 v166, v54, v166
  v_mfma_f32_16x16x32_bf16 v[188:191], a[28:31], a[12:15], v[188:191]
  ds_read_b64_tr_b16 a[134:135], v2 offset:39488
  v_exp_f32 v25, v25
  v_mul_f32 v167, v55, v167
  v_mfma_f32_16x16x32_bf16 v[188:191], a[152:155], a[44:47], v[188:191]
  ds_read_b64_tr_b16 a[136:137], v2 offset:43072
  v_mul_f32 v164, v164, v26
  v_mul_f32 v165, v165, v27
  v_mul_f32 v166, v166, v28
  v_mfma_f32_16x16x32_bf16 v[188:191], a[156:159], a[60:63], v[188:191]
  v_mul_f32 v167, v167, v29
  v_cvt_pk_bf16_f32 v34, v160, v161
  v_cvt_pk_bf16_f32 v35, v162, v163
  v_mfma_f32_16x16x32_bf16 v[184:187], a[156:159], a[56:59], v[184:187]
  ds_read_b64_tr_b16 a[138:139], v2 offset:46656
  v_mfma_f32_16x16x32_bf16 v[184:187], a[152:155], a[40:43], v[184:187]
  buffer_load_dwordx4 v134, s[24:27], s8 offen offset:1024 lds
  v_mfma_f32_16x16x32_bf16 v[180:183], a[152:155], a[36:39], v[180:183]
  ds_read_b64_tr_b16 a[140:141], v2 offset:50240
  v_mfma_f32_16x16x32_bf16 v[180:183], a[156:159], a[52:55], v[180:183]
  buffer_store_dwordx4 v[32:35], v0, s[36:39], s21 offen offset:0 sc1
  v_mul_f32 v26, v19, v60
  v_mul_f32 v27, v19, v61
  v_mul_f32 v28, v19, v62
  v_mfma_f32_16x16x32_bf16 v[176:179], a[156:159], a[48:51], v[176:179]
  ds_read_b64_tr_b16 a[142:143], v2 offset:53824
  v_mul_f32 v29, v19, v63
  v_exp_f32 v26, v26
  v_mfma_f32_16x16x32_bf16 v[176:179], a[152:155], a[32:35], v[176:179]
  s_waitcnt lgkmcnt(8)
  v_fma_f32 v22, v22, v17, v17
  v_exp_f32 v27, v27
  v_fma_f32 v23, v23, v17, v17
  v_mfma_f32_16x16x32_bf16 v[64:67], a[160:163], a[64:67], v[64:67]
  buffer_load_dwordx4 v135, s[24:27], s8 offen offset:2048 lds
  v_exp_f32 v28, v28
  v_fma_f32 v24, v24, v17, v17
  v_mfma_f32_16x16x32_bf16 v[64:67], a[164:167], a[80:83], v[64:67]
  ds_read_b64_tr_b16 a[144:145], v1 offset:28768
  v_exp_f32 v29, v29
  v_fma_f32 v25, v25, v17, v17
  v_mfma_f32_16x16x32_bf16 v[68:71], a[164:167], a[84:87], v[68:71]
  ds_read_b64_tr_b16 a[146:147], v1 offset:32352
  v_cvt_pk_bf16_f32 v38, v164, v165
  v_cvt_pk_bf16_f32 v39, v166, v167
  v_mfma_f32_16x16x32_bf16 v[68:71], a[160:163], a[68:71], v[68:71]
  buffer_store_dwordx4 v[36:39], v0, s[36:39], s21 offen offset:1024 sc1
  v_rcp_f32 v22, v22
  v_fma_f32 v26, v26, v20, v20
  v_mfma_f32_16x16x32_bf16 v[72:75], a[160:163], a[72:75], v[72:75]
  ds_read_b64_tr_b16 a[148:149], v1 offset:35936
  v_rcp_f32 v23, v23
  v_fma_f32 v27, v27, v20, v20
  v_mfma_f32_16x16x32_bf16 v[72:75], a[164:167], a[88:91], v[72:75]
  buffer_load_dwordx4 v136, s[24:27], s8 offen offset:3072 lds
  v_rcp_f32 v24, v24
  v_fma_f32 v28, v28, v20, v20
  v_mfma_f32_16x16x32_bf16 v[76:79], a[164:167], a[92:95], v[76:79]
  ds_read_b64_tr_b16 a[150:151], v1 offset:39520
  v_rcp_f32 v25, v25
  v_fma_f32 v29, v29, v20, v20
  v_mfma_f32_16x16x32_bf16 v[76:79], a[160:163], a[76:79], v[76:79]
  v_rcp_f32 v26, v26
  v_mul_f32 v168, v56, v168
  v_mfma_f32_16x16x32_bf16 v[188:191], a[168:171], a[76:79], v[188:191]
  v_rcp_f32 v27, v27
  v_mul_f32 v169, v57, v169
  v_mfma_f32_16x16x32_bf16 v[188:191], a[172:175], a[92:95], v[188:191]
  v_rcp_f32 v28, v28
  v_mul_f32 v170, v58, v170
  v_mfma_f32_16x16x32_bf16 v[184:187], a[172:175], a[88:91], v[184:187]
  v_rcp_f32 v29, v29
  v_mul_f32 v171, v59, v171
  v_mul_f32 v168, v168, v22
  v_mfma_f32_16x16x32_bf16 v[184:187], a[168:171], a[72:75], v[184:187]
  v_mul_f32 v169, v169, v23
  v_mul_f32 v170, v170, v24
  v_mul_f32 v171, v171, v25
  v_mul_f32 v172, v60, v172
  v_mfma_f32_16x16x32_bf16 v[180:183], a[168:171], a[68:71], v[180:183]
  v_mul_f32 v173, v61, v173
  v_mul_f32 v174, v62, v174
  v_mul_f32 v175, v63, v175
  v_cvt_pk_bf16_f32 v42, v168, v169
  v_mfma_f32_16x16x32_bf16 v[180:183], a[172:175], a[84:87], v[180:183]
  v_cvt_pk_bf16_f32 v43, v170, v171
  v_mfma_f32_16x16x32_bf16 v[176:179], a[172:175], a[80:83], v[176:179]
  buffer_store_dwordx4 v[40:43], v0, s[36:39], s22 offen offset:0 sc1
  v_mul_f32 v172, v172, v26
  v_mul_f32 v173, v173, v27
  v_mul_f32 v174, v174, v28
  v_mfma_f32_16x16x32_bf16 v[176:179], a[168:171], a[64:67], v[176:179]
  s_waitcnt lgkmcnt(4)
  v_mul_f32 v175, v175, v29
  v_cvt_pk_bf16_f32 v46, v172, v173
  v_cvt_pk_bf16_f32 v47, v174, v175
  v_mfma_f32_16x16x32_bf16 v[64:67], a[128:131], a[96:99], v[64:67]
  ds_read_b128 a[16:19], v31 offset:768
  v_mfma_f32_16x16x32_bf16 v[64:67], a[132:135], a[112:115], v[64:67]
  ds_read_b64_tr_b16 a[152:153], v1 offset:43104
  v_mfma_f32_16x16x32_bf16 v[68:71], a[132:135], a[116:119], v[68:71]
  ds_read_b128 a[20:23], v31 offset:2816
  v_mfma_f32_16x16x32_bf16 v[68:71], a[128:131], a[100:103], v[68:71]
  ds_read_b64_tr_b16 a[154:155], v1 offset:46688
  v_mfma_f32_16x16x32_bf16 v[72:75], a[128:131], a[104:107], v[72:75]
  ds_read_b64_tr_b16 a[156:157], v1 offset:50272
  v_mfma_f32_16x16x32_bf16 v[72:75], a[132:135], a[120:123], v[72:75]
  buffer_store_dwordx4 v[44:47], v0, s[36:39], s22 offen offset:1024 sc1
  s_add_u32 s21, s21, 2048
  s_add_u32 s22, s22, 2048
  v_mfma_f32_16x16x32_bf16 v[76:79], a[132:135], a[124:127], v[76:79]
  ds_read_b64_tr_b16 a[158:159], v1 offset:53856
  v_mfma_f32_16x16x32_bf16 v[76:79], a[128:131], a[108:111], v[76:79]
  v_mfma_f32_16x16x32_bf16 v[188:191], a[136:139], a[108:111], v[188:191]
  ds_read_b64_tr_b16 a[160:161], v2 offset:96
  v_mul_f32 v22, v10, v64
  v_mul_f32 v23, v10, v65
  v_mul_f32 v24, v10, v66
  v_mfma_f32_16x16x32_bf16 v[188:191], a[140:143], a[124:127], v[188:191]
  v_mul_f32 v25, v10, v67
  v_exp_f32 v22, v22
  v_mul_f32 v26, v13, v68
  v_mfma_f32_16x16x32_bf16 v[184:187], a[140:143], a[120:123], v[184:187]
  ds_read_b64_tr_b16 a[162:163], v2 offset:3680
  v_exp_f32 v23, v23
  v_mul_f32 v27, v13, v69
  v_mfma_f32_16x16x32_bf16 v[184:187], a[136:139], a[104:107], v[184:187]
  v_exp_f32 v24, v24
  v_mul_f32 v28, v13, v70
  v_mfma_f32_16x16x32_bf16 v[180:183], a[136:139], a[100:103], v[180:183]
  ds_read_b64_tr_b16 a[164:165], v2 offset:7264
  v_exp_f32 v25, v25
  v_mul_f32 v29, v13, v71
  v_mfma_f32_16x16x32_bf16 v[180:183], a[140:143], a[116:119], v[180:183]
  v_exp_f32 v26, v26
  v_fma_f32 v22, v22, v11, v11
  v_mfma_f32_16x16x32_bf16 v[176:179], a[140:143], a[112:115], v[176:179]
  ds_read_b64_tr_b16 a[166:167], v2 offset:10848
  v_exp_f32 v27, v27
  v_fma_f32 v23, v23, v11, v11
  v_mfma_f32_16x16x32_bf16 v[176:179], a[136:139], a[96:99], v[176:179]
  s_waitcnt lgkmcnt(4)
  v_exp_f32 v28, v28
  v_fma_f32 v24, v24, v11, v11
  v_mfma_f32_16x16x32_bf16 v[80:83], a[144:147], a[32:35], v[80:83]
  ds_read_b64_tr_b16 a[168:169], v2 offset:14432
  v_exp_f32 v29, v29
  v_fma_f32 v25, v25, v11, v11
  v_mfma_f32_16x16x32_bf16 v[80:83], a[148:151], a[48:51], v[80:83]
  v_rcp_f32 v22, v22
  v_fma_f32 v26, v26, v14, v14
  v_mfma_f32_16x16x32_bf16 v[84:87], a[148:151], a[52:55], v[84:87]
  ds_read_b64_tr_b16 a[170:171], v2 offset:18016
  v_rcp_f32 v23, v23
  v_fma_f32 v27, v27, v14, v14
  v_mfma_f32_16x16x32_bf16 v[84:87], a[144:147], a[36:39], v[84:87]
  v_rcp_f32 v24, v24
  v_fma_f32 v28, v28, v14, v14
  v_mfma_f32_16x16x32_bf16 v[88:91], a[144:147], a[40:43], v[88:91]
  ds_read_b64_tr_b16 a[172:173], v2 offset:21600
  v_rcp_f32 v25, v25
  v_fma_f32 v29, v29, v14, v14
  v_mfma_f32_16x16x32_bf16 v[88:91], a[148:151], a[56:59], v[88:91]
  v_rcp_f32 v26, v26
  v_mul_f32 v176, v64, v176
  v_mfma_f32_16x16x32_bf16 v[92:95], a[148:151], a[60:63], v[92:95]
  ds_read_b64_tr_b16 a[174:175], v2 offset:25184
  v_rcp_f32 v27, v27
  v_mul_f32 v177, v65, v177
  v_mfma_f32_16x16x32_bf16 v[92:95], a[144:147], a[44:47], v[92:95]
  s_waitcnt lgkmcnt(11)
  v_rcp_f32 v28, v28
  v_mul_f32 v178, v66, v178
  v_mfma_f32_16x16x32_bf16 v[80:83], a[16:19], a[0:3], v[80:83]
  ds_read_b64_tr_b16 a[128:129], v2 offset:28768
  v_rcp_f32 v29, v29
  v_mul_f32 v179, v67, v179
  v_mfma_f32_16x16x32_bf16 v[84:87], a[16:19], a[4:7], v[84:87]
  v_mul_f32 v176, v176, v22
  v_mul_f32 v177, v177, v23
  v_mul_f32 v178, v178, v24
  v_mul_f32 v179, v179, v25
  v_mfma_f32_16x16x32_bf16 v[88:91], a[16:19], a[8:11], v[88:91]
  ds_read_b64_tr_b16 a[130:131], v2 offset:32352
  v_mul_f32 v22, v16, v72
  v_mul_f32 v23, v16, v73
  v_mul_f32 v24, v16, v74
  v_mfma_f32_16x16x32_bf16 v[92:95], a[16:19], a[12:15], v[92:95]
Hb0_2:
  s_cbranch_execz Hb0_3
  v_mul_f32 v25, v16, v75
  v_exp_f32 v22, v22
  v_mul_f32 v180, v68, v180
  v_mfma_f32_16x16x32_bf16 v[192:195], a[20:23], a[0:3], v[192:195]
  ds_read_b64_tr_b16 a[132:133], v2 offset:35936
  v_exp_f32 v23, v23
  v_mul_f32 v181, v69, v181
  v_mfma_f32_16x16x32_bf16 v[196:199], a[20:23], a[4:7], v[196:199]
  v_exp_f32 v24, v24
  v_mul_f32 v182, v70, v182
  v_mfma_f32_16x16x32_bf16 v[200:203], a[20:23], a[8:11], v[200:203]
  ds_read_b64_tr_b16 a[134:135], v2 offset:39520
  v_exp_f32 v25, v25
  v_mul_f32 v183, v71, v183
  v_mfma_f32_16x16x32_bf16 v[204:207], a[20:23], a[12:15], v[204:207]
  v_mul_f32 v180, v180, v26
  v_mul_f32 v181, v181, v27
  v_mul_f32 v182, v182, v28
  v_mul_f32 v183, v183, v29
  v_mfma_f32_16x16x32_bf16 v[204:207], a[152:155], a[44:47], v[204:207]
  ds_read_b64_tr_b16 a[136:137], v2 offset:43104
  v_cvt_pk_bf16_f32 v64, v176, v177
  v_cvt_pk_bf16_f32 v65, v178, v179
  v_mul_f32 v26, v19, v76
  v_mfma_f32_16x16x32_bf16 v[204:207], a[156:159], a[60:63], v[204:207]
  v_mul_f32 v27, v19, v77
  v_mul_f32 v28, v19, v78
  v_mul_f32 v29, v19, v79
  v_mfma_f32_16x16x32_bf16 v[200:203], a[156:159], a[56:59], v[200:203]
  ds_read_b64_tr_b16 a[138:139], v2 offset:46688
  v_exp_f32 v26, v26
  v_fma_f32 v22, v22, v17, v17
  v_mfma_f32_16x16x32_bf16 v[200:203], a[152:155], a[40:43], v[200:203]
  v_exp_f32 v27, v27
  v_fma_f32 v23, v23, v17, v17
  v_mfma_f32_16x16x32_bf16 v[196:199], a[152:155], a[36:39], v[196:199]
  ds_read_b64_tr_b16 a[140:141], v2 offset:50272
  v_exp_f32 v28, v28
  v_fma_f32 v24, v24, v17, v17
  v_mfma_f32_16x16x32_bf16 v[196:199], a[156:159], a[52:55], v[196:199]
  v_exp_f32 v29, v29
  v_fma_f32 v25, v25, v17, v17
  v_cvt_pk_bf16_f32 v68, v180, v181
  v_mfma_f32_16x16x32_bf16 v[192:195], a[156:159], a[48:51], v[192:195]
  ds_read_b64_tr_b16 a[142:143], v2 offset:53856
  v_cvt_pk_bf16_f32 v69, v182, v183
  v_rcp_f32 v22, v22
  v_mfma_f32_16x16x32_bf16 v[192:195], a[152:155], a[32:35], v[192:195]
  s_waitcnt lgkmcnt(8)
  v_fma_f32 v26, v26, v20, v20
  v_rcp_f32 v23, v23
  v_fma_f32 v27, v27, v20, v20
  v_mfma_f32_16x16x32_bf16 v[80:83], a[160:163], a[64:67], v[80:83]
  ds_read_b64_tr_b16 a[144:145], v1 offset:28800
  v_rcp_f32 v24, v24
  v_fma_f32 v28, v28, v20, v20
  v_mfma_f32_16x16x32_bf16 v[80:83], a[164:167], a[80:83], v[80:83]
  v_rcp_f32 v25, v25
  v_fma_f32 v29, v29, v20, v20
  v_mfma_f32_16x16x32_bf16 v[84:87], a[164:167], a[84:87], v[84:87]
  ds_read_b64_tr_b16 a[146:147], v1 offset:32384
  v_rcp_f32 v26, v26
  v_mul_f32 v184, v72, v184
  v_mfma_f32_16x16x32_bf16 v[84:87], a[160:163], a[68:71], v[84:87]
  v_rcp_f32 v27, v27
  v_mul_f32 v185, v73, v185
  v_mfma_f32_16x16x32_bf16 v[88:91], a[160:163], a[72:75], v[88:91]
  ds_read_b64_tr_b16 a[148:149], v1 offset:35968
  v_rcp_f32 v28, v28
  v_mul_f32 v186, v74, v186
  v_mfma_f32_16x16x32_bf16 v[88:91], a[164:167], a[88:91], v[88:91]
  v_rcp_f32 v29, v29
  v_mul_f32 v187, v75, v187
  v_mul_f32 v184, v184, v22
  v_mfma_f32_16x16x32_bf16 v[92:95], a[164:167], a[92:95], v[92:95]
  ds_read_b64_tr_b16 a[150:151], v1 offset:39552
  v_mul_f32 v185, v185, v23
  v_mul_f32 v186, v186, v24
  v_mul_f32 v187, v187, v25
  v_mfma_f32_16x16x32_bf16 v[92:95], a[160:163], a[76:79], v[92:95]
  s_waitcnt vmcnt(0)
  s_barrier
  v_mul_f32 v188, v76, v188
  v_mul_f32 v189, v77, v189
  v_mul_f32 v190, v78, v190
  v_mfma_f32_16x16x32_bf16 v[204:207], a[168:171], a[76:79], v[204:207]
  s_mov_b64 exec, 1
  buffer_store_dword v254, v0, s[36:39], s45 offen sc1
  s_mov_b64 exec, -1
  s_lshl_b32 s45, s2, 7
  v_mfma_f32_16x16x32_bf16 v[204:207], a[172:175], a[92:95], v[204:207]
  s_add_u32 s45, s45, 5439488
  s_cmp_eq_u32 s44, 0
  s_cselect_b32 s45, s45, 1073741824
  v_mul_f32 v191, v79, v191
  v_cvt_pk_bf16_f32 v72, v184, v185
  v_mfma_f32_16x16x32_bf16 v[200:203], a[172:175], a[88:91], v[200:203]
  v_cvt_pk_bf16_f32 v73, v186, v187
  v_mul_f32 v188, v188, v26
  v_mul_f32 v189, v189, v27
  v_mul_f32 v190, v190, v28
  v_mfma_f32_16x16x32_bf16 v[200:203], a[168:171], a[72:75], v[200:203]
  v_mul_f32 v191, v191, v29
  v_cvt_pk_bf16_f32 v76, v188, v189
  v_cvt_pk_bf16_f32 v77, v190, v191
  v_mfma_f32_16x16x32_bf16 v[196:199], a[168:171], a[68:71], v[196:199]
  v_mfma_f32_16x16x32_bf16 v[196:199], a[172:175], a[84:87], v[196:199]
  v_mfma_f32_16x16x32_bf16 v[192:195], a[172:175], a[80:83], v[192:195]
  v_mfma_f32_16x16x32_bf16 v[192:195], a[168:171], a[64:67], v[192:195]
  s_waitcnt lgkmcnt(4)
  v_mfma_f32_16x16x32_bf16 v[80:83], a[128:131], a[96:99], v[80:83]
  ds_read_b128 a[24:27], v31 offset:1024
  v_mfma_f32_16x16x32_bf16 v[80:83], a[132:135], a[112:115], v[80:83]
  ds_read_b64_tr_b16 a[152:153], v1 offset:43136
  v_mfma_f32_16x16x32_bf16 v[84:87], a[132:135], a[116:119], v[84:87]
  ds_read_b128 a[28:31], v31 offset:3072
  v_mfma_f32_16x16x32_bf16 v[84:87], a[128:131], a[100:103], v[84:87]
  ds_read_b64_tr_b16 a[154:155], v1 offset:46720
  v_mfma_f32_16x16x32_bf16 v[88:91], a[128:131], a[104:107], v[88:91]
  ds_read_b64_tr_b16 a[156:157], v1 offset:50304
  v_mfma_f32_16x16x32_bf16 v[88:91], a[132:135], a[120:123], v[88:91]
  v_mfma_f32_16x16x32_bf16 v[92:95], a[132:135], a[124:127], v[92:95]
  ds_read_b64_tr_b16 a[158:159], v1 offset:53888
  v_mfma_f32_16x16x32_bf16 v[92:95], a[128:131], a[108:111], v[92:95]
  v_mfma_f32_16x16x32_bf16 v[204:207], a[136:139], a[108:111], v[204:207]
  ds_read_b64_tr_b16 a[160:161], v2 offset:128
  v_mul_f32 v22, v10, v80
  v_mul_f32 v23, v10, v81
  v_mul_f32 v24, v10, v82
  v_mfma_f32_16x16x32_bf16 v[204:207], a[140:143], a[124:127], v[204:207]
  v_mul_f32 v25, v10, v83
  v_exp_f32 v22, v22
  v_mul_f32 v26, v13, v84
  v_mfma_f32_16x16x32_bf16 v[200:203], a[140:143], a[120:123], v[200:203]
  ds_read_b64_tr_b16 a[162:163], v2 offset:3712
  v_exp_f32 v23, v23
  v_mul_f32 v27, v13, v85
  v_mfma_f32_16x16x32_bf16 v[200:203], a[136:139], a[104:107], v[200:203]
  v_exp_f32 v24, v24
  v_mul_f32 v28, v13, v86
  v_mfma_f32_16x16x32_bf16 v[196:199], a[136:139], a[100:103], v[196:199]
  ds_read_b64_tr_b16 a[164:165], v2 offset:7296
  v_exp_f32 v25, v25
  v_mul_f32 v29, v13, v87
  v_mfma_f32_16x16x32_bf16 v[196:199], a[140:143], a[116:119], v[196:199]
  v_exp_f32 v26, v26
  v_fma_f32 v22, v22, v11, v11
  v_mfma_f32_16x16x32_bf16 v[192:195], a[140:143], a[112:115], v[192:195]
  ds_read_b64_tr_b16 a[166:167], v2 offset:10880
  v_exp_f32 v27, v27
  v_fma_f32 v23, v23, v11, v11
  v_mfma_f32_16x16x32_bf16 v[192:195], a[136:139], a[96:99], v[192:195]
  s_waitcnt lgkmcnt(4)
  v_exp_f32 v28, v28
  v_fma_f32 v24, v24, v11, v11
  v_mfma_f32_16x16x32_bf16 v[96:99], a[144:147], a[32:35], v[96:99]
  ds_read_b64_tr_b16 a[168:169], v2 offset:14464
  v_exp_f32 v29, v29
  v_fma_f32 v25, v25, v11, v11
  v_mfma_f32_16x16x32_bf16 v[96:99], a[148:151], a[48:51], v[96:99]
  v_rcp_f32 v22, v22
  v_fma_f32 v26, v26, v14, v14
  v_mfma_f32_16x16x32_bf16 v[100:103], a[148:151], a[52:55], v[100:103]
  ds_read_b64_tr_b16 a[170:171], v2 offset:18048
  v_rcp_f32 v23, v23
  v_fma_f32 v27, v27, v14, v14
  v_mfma_f32_16x16x32_bf16 v[100:103], a[144:147], a[36:39], v[100:103]
  v_rcp_f32 v24, v24
  v_fma_f32 v28, v28, v14, v14
  v_mfma_f32_16x16x32_bf16 v[104:107], a[144:147], a[40:43], v[104:107]
  ds_read_b64_tr_b16 a[172:173], v2 offset:21632
  v_rcp_f32 v25, v25
  v_fma_f32 v29, v29, v14, v14
  v_mfma_f32_16x16x32_bf16 v[104:107], a[148:151], a[56:59], v[104:107]
  v_rcp_f32 v26, v26
  v_mul_f32 v192, v80, v192
  v_mfma_f32_16x16x32_bf16 v[108:111], a[148:151], a[60:63], v[108:111]
  ds_read_b64_tr_b16 a[174:175], v2 offset:25216
  v_rcp_f32 v27, v27
  v_mul_f32 v193, v81, v193
  v_mfma_f32_16x16x32_bf16 v[108:111], a[144:147], a[44:47], v[108:111]
  s_waitcnt lgkmcnt(11)
  v_rcp_f32 v28, v28
  v_mul_f32 v194, v82, v194
  v_mfma_f32_16x16x32_bf16 v[96:99], a[24:27], a[0:3], v[96:99]
  ds_read_b64_tr_b16 a[128:129], v2 offset:28800
  v_rcp_f32 v29, v29
  v_mul_f32 v195, v83, v195
  v_mfma_f32_16x16x32_bf16 v[100:103], a[24:27], a[4:7], v[100:103]
  v_mul_f32 v192, v192, v22
  v_mul_f32 v193, v193, v23
  v_mul_f32 v194, v194, v24
  v_mul_f32 v195, v195, v25
  v_mfma_f32_16x16x32_bf16 v[104:107], a[24:27], a[8:11], v[104:107]
  ds_read_b64_tr_b16 a[130:131], v2 offset:32384
  v_mul_f32 v22, v16, v88
  v_mul_f32 v23, v16, v89
  v_mul_f32 v24, v16, v90
  v_mfma_f32_16x16x32_bf16 v[108:111], a[24:27], a[12:15], v[108:111]
  v_mul_f32 v25, v16, v91
  v_exp_f32 v22, v22
  v_mul_f32 v196, v84, v196
  v_mfma_f32_16x16x32_bf16 v[208:211], a[28:31], a[0:3], v[208:211]
  ds_read_b64_tr_b16 a[132:133], v2 offset:35968
  v_exp_f32 v23, v23
  v_mul_f32 v197, v85, v197
  v_mfma_f32_16x16x32_bf16 v[212:215], a[28:31], a[4:7], v[212:215]
  v_exp_f32 v24, v24
  v_mul_f32 v198, v86, v198
  v_mfma_f32_16x16x32_bf16 v[216:219], a[28:31], a[8:11], v[216:219]
  ds_read_b64_tr_b16 a[134:135], v2 offset:39552
  v_exp_f32 v25, v25
  v_mul_f32 v199, v87, v199
  v_mfma_f32_16x16x32_bf16 v[220:223], a[28:31], a[12:15], v[220:223]
  v_mul_f32 v196, v196, v26
  v_mul_f32 v197, v197, v27
  v_mul_f32 v198, v198, v28
  v_mul_f32 v199, v199, v29
  v_mfma_f32_16x16x32_bf16 v[220:223], a[152:155], a[44:47], v[220:223]
  ds_read_b64_tr_b16 a[136:137], v2 offset:43136
  v_cvt_pk_bf16_f32 v66, v192, v193
  v_cvt_pk_bf16_f32 v67, v194, v195
  v_mfma_f32_16x16x32_bf16 v[220:223], a[156:159], a[60:63], v[220:223]
  buffer_store_dwordx4 v[64:67], v0, s[36:39], s21 offen offset:0 sc1
  v_mul_f32 v26, v19, v92
  v_mul_f32 v27, v19, v93
  v_mul_f32 v28, v19, v94
  v_mfma_f32_16x16x32_bf16 v[216:219], a[156:159], a[56:59], v[216:219]
  ds_read_b64_tr_b16 a[138:139], v2 offset:46720
  v_mul_f32 v29, v19, v95
  v_exp_f32 v26, v26
  v_mfma_f32_16x16x32_bf16 v[216:219], a[152:155], a[40:43], v[216:219]
  v_fma_f32 v22, v22, v17, v17
  v_exp_f32 v27, v27
  v_fma_f32 v23, v23, v17, v17
  v_mfma_f32_16x16x32_bf16 v[212:215], a[152:155], a[36:39], v[212:215]
  ds_read_b64_tr_b16 a[140:141], v2 offset:50304
  v_exp_f32 v28, v28
  v_fma_f32 v24, v24, v17, v17
  v_mfma_f32_16x16x32_bf16 v[212:215], a[156:159], a[52:55], v[212:215]
  v_exp_f32 v29, v29
  v_fma_f32 v25, v25, v17, v17
  v_cvt_pk_bf16_f32 v70, v196, v197
  v_mfma_f32_16x16x32_bf16 v[208:211], a[156:159], a[48:51], v[208:211]
  ds_read_b64_tr_b16 a[142:143], v2 offset:53888
  v_cvt_pk_bf16_f32 v71, v198, v199
  v_mfma_f32_16x16x32_bf16 v[208:211], a[152:155], a[32:35], v[208:211]
  s_waitcnt lgkmcnt(8)
  buffer_store_dwordx4 v[68:71], v0, s[36:39], s21 offen offset:1024 sc1
  v_rcp_f32 v22, v22
  v_fma_f32 v26, v26, v20, v20
  v_mfma_f32_16x16x32_bf16 v[96:99], a[160:163], a[64:67], v[96:99]
  ds_read_b64_tr_b16 a[144:145], v1 offset:28832
  v_rcp_f32 v23, v23
  v_fma_f32 v27, v27, v20, v20
  v_mfma_f32_16x16x32_bf16 v[96:99], a[164:167], a[80:83], v[96:99]
  v_rcp_f32 v24, v24
  v_fma_f32 v28, v28, v20, v20
  v_mfma_f32_16x16x32_bf16 v[100:103], a[164:167], a[84:87], v[100:103]
  ds_read_b64_tr_b16 a[146:147], v1 offset:32416
  v_rcp_f32 v25, v25
  v_fma_f32 v29, v29, v20, v20
  v_mfma_f32_16x16x32_bf16 v[100:103], a[160:163], a[68:71], v[100:103]
  v_rcp_f32 v26, v26
  v_mul_f32 v200, v88, v200
  v_mfma_f32_16x16x32_bf16 v[104:107], a[160:163], a[72:75], v[104:107]
  ds_read_b64_tr_b16 a[148:149], v1 offset:36000
  v_rcp_f32 v27, v27
  v_mul_f32 v201, v89, v201
  v_mfma_f32_16x16x32_bf16 v[104:107], a[164:167], a[88:91], v[104:107]
  v_rcp_f32 v28, v28
  v_mul_f32 v202, v90, v202
  v_mfma_f32_16x16x32_bf16 v[108:111], a[164:167], a[92:95], v[108:111]
  ds_read_b64_tr_b16 a[150:151], v1 offset:39584
  v_rcp_f32 v29, v29
  v_mul_f32 v203, v91, v203
  v_mfma_f32_16x16x32_bf16 v[108:111], a[160:163], a[76:79], v[108:111]
  v_mul_f32 v200, v200, v22
  v_mul_f32 v201, v201, v23
  v_mul_f32 v202, v202, v24
  v_mul_f32 v203, v203, v25
  v_mfma_f32_16x16x32_bf16 v[220:223], a[168:171], a[76:79], v[220:223]
  v_mul_f32 v204, v92, v204
  v_mul_f32 v205, v93, v205
  v_mul_f32 v206, v94, v206
  v_mul_f32 v207, v95, v207
  v_mfma_f32_16x16x32_bf16 v[220:223], a[172:175], a[92:95], v[220:223]
  v_cvt_pk_bf16_f32 v74, v200, v201
  v_cvt_pk_bf16_f32 v75, v202, v203
  v_mfma_f32_16x16x32_bf16 v[216:219], a[172:175], a[88:91], v[216:219]
  buffer_store_dwordx4 v[72:75], v0, s[36:39], s22 offen offset:0 sc1
  v_mul_f32 v204, v204, v26
  v_mul_f32 v205, v205, v27
  v_mul_f32 v206, v206, v28
  v_mfma_f32_16x16x32_bf16 v[216:219], a[168:171], a[72:75], v[216:219]
  v_mul_f32 v207, v207, v29
  v_cvt_pk_bf16_f32 v78, v204, v205
  v_cvt_pk_bf16_f32 v79, v206, v207
  v_mfma_f32_16x16x32_bf16 v[212:215], a[168:171], a[68:71], v[212:215]
  buffer_store_dwordx4 v[76:79], v0, s[36:39], s22 offen offset:1024 sc1
  s_add_u32 s21, s21, 2048
  s_add_u32 s22, s22, 2048
  v_mfma_f32_16x16x32_bf16 v[212:215], a[172:175], a[84:87], v[212:215]
  v_mfma_f32_16x16x32_bf16 v[208:211], a[172:175], a[80:83], v[208:211]
  v_mfma_f32_16x16x32_bf16 v[208:211], a[168:171], a[64:67], v[208:211]
  s_waitcnt lgkmcnt(4)
  v_mfma_f32_16x16x32_bf16 v[96:99], a[128:131], a[96:99], v[96:99]
  ds_read_b128 a[16:19], v31 offset:1280
  v_mfma_f32_16x16x32_bf16 v[96:99], a[132:135], a[112:115], v[96:99]
  ds_read_b64_tr_b16 a[152:153], v1 offset:43168
  v_mfma_f32_16x16x32_bf16 v[100:103], a[132:135], a[116:119], v[100:103]
  ds_read_b128 a[20:23], v31 offset:3328
  v_mfma_f32_16x16x32_bf16 v[100:103], a[128:131], a[100:103], v[100:103]
  ds_read_b64_tr_b16 a[154:155], v1 offset:46752
  v_mfma_f32_16x16x32_bf16 v[104:107], a[128:131], a[104:107], v[104:107]
  ds_read_b64_tr_b16 a[156:157], v1 offset:50336
  v_mfma_f32_16x16x32_bf16 v[104:107], a[132:135], a[120:123], v[104:107]
  v_mfma_f32_16x16x32_bf16 v[108:111], a[132:135], a[124:127], v[108:111]
  ds_read_b64_tr_b16 a[158:159], v1 offset:53920
  v_mfma_f32_16x16x32_bf16 v[108:111], a[128:131], a[108:111], v[108:111]
  v_mfma_f32_16x16x32_bf16 v[220:223], a[136:139], a[108:111], v[220:223]
  ds_read_b64_tr_b16 a[160:161], v2 offset:160
  v_mul_f32 v22, v10, v96
  v_mul_f32 v23, v10, v97
  v_mul_f32 v24, v10, v98
  v_mul_f32 v25, v10, v99
  v_mfma_f32_16x16x32_bf16 v[220:223], a[140:143], a[124:127], v[220:223]
  v_exp_f32 v22, v22
  v_mul_f32 v26, v13, v100
  v_mfma_f32_16x16x32_bf16 v[216:219], a[140:143], a[120:123], v[216:219]
  buffer_load_dword v139, v138, s[36:39], s60 offen sc1
  v_exp_f32 v23, v23
  v_mul_f32 v27, v13, v101
  v_mfma_f32_16x16x32_bf16 v[216:219], a[136:139], a[104:107], v[216:219]
  ds_read_b64_tr_b16 a[162:163], v2 offset:3744
  v_exp_f32 v24, v24
  v_mul_f32 v28, v13, v102
  v_mfma_f32_16x16x32_bf16 v[212:215], a[136:139], a[100:103], v[212:215]
  ds_read_b64_tr_b16 a[164:165], v2 offset:7328
  v_exp_f32 v25, v25
  v_mul_f32 v29, v13, v103
  v_mfma_f32_16x16x32_bf16 v[212:215], a[140:143], a[116:119], v[212:215]
  v_exp_f32 v26, v26
  v_fma_f32 v22, v22, v11, v11
  v_mfma_f32_16x16x32_bf16 v[208:211], a[140:143], a[112:115], v[208:211]
  ds_read_b64_tr_b16 a[166:167], v2 offset:10912
  v_exp_f32 v27, v27
  v_fma_f32 v23, v23, v11, v11
  v_mfma_f32_16x16x32_bf16 v[208:211], a[136:139], a[96:99], v[208:211]
  s_waitcnt lgkmcnt(4)
  v_exp_f32 v28, v28
  v_fma_f32 v24, v24, v11, v11
  v_mfma_f32_16x16x32_bf16 v[112:115], a[144:147], a[32:35], v[112:115]
  ds_read_b64_tr_b16 a[168:169], v2 offset:14496
  v_exp_f32 v29, v29
  v_fma_f32 v25, v25, v11, v11
  v_mfma_f32_16x16x32_bf16 v[112:115], a[148:151], a[48:51], v[112:115]
  v_rcp_f32 v22, v22
  v_fma_f32 v26, v26, v14, v14
  v_mfma_f32_16x16x32_bf16 v[116:119], a[148:151], a[52:55], v[116:119]
  ds_read_b64_tr_b16 a[170:171], v2 offset:18080
  v_rcp_f32 v23, v23
  v_fma_f32 v27, v27, v14, v14
  v_mfma_f32_16x16x32_bf16 v[116:119], a[144:147], a[36:39], v[116:119]
  v_rcp_f32 v24, v24
  v_fma_f32 v28, v28, v14, v14
  v_mfma_f32_16x16x32_bf16 v[120:123], a[144:147], a[40:43], v[120:123]
  ds_read_b64_tr_b16 a[172:173], v2 offset:21664
  v_rcp_f32 v25, v25
  v_fma_f32 v29, v29, v14, v14
  v_mfma_f32_16x16x32_bf16 v[120:123], a[148:151], a[56:59], v[120:123]
  v_rcp_f32 v26, v26
  v_mul_f32 v208, v96, v208
  v_mfma_f32_16x16x32_bf16 v[124:127], a[148:151], a[60:63], v[124:127]
  ds_read_b64_tr_b16 a[174:175], v2 offset:25248
  v_rcp_f32 v27, v27
  v_mul_f32 v209, v97, v209
  v_mfma_f32_16x16x32_bf16 v[124:127], a[144:147], a[44:47], v[124:127]
  s_waitcnt lgkmcnt(11)
  v_rcp_f32 v28, v28
  v_mul_f32 v210, v98, v210
  v_mfma_f32_16x16x32_bf16 v[112:115], a[16:19], a[0:3], v[112:115]
  ds_read_b64_tr_b16 a[128:129], v2 offset:28832
  v_rcp_f32 v29, v29
  v_mul_f32 v211, v99, v211
  v_mfma_f32_16x16x32_bf16 v[116:119], a[16:19], a[4:7], v[116:119]
  v_mul_f32 v208, v208, v22
  v_mul_f32 v209, v209, v23
  v_mul_f32 v210, v210, v24
  v_mul_f32 v211, v211, v25
  v_mfma_f32_16x16x32_bf16 v[120:123], a[16:19], a[8:11], v[120:123]
  ds_read_b64_tr_b16 a[130:131], v2 offset:32416
  v_mul_f32 v22, v16, v104
  v_mul_f32 v23, v16, v105
  v_mul_f32 v24, v16, v106
  v_mfma_f32_16x16x32_bf16 v[124:127], a[16:19], a[12:15], v[124:127]
  v_mul_f32 v25, v16, v107
  v_exp_f32 v22, v22
  v_mul_f32 v212, v100, v212
  v_mfma_f32_16x16x32_bf16 v[224:227], a[20:23], a[0:3], v[224:227]
  ds_read_b64_tr_b16 a[132:133], v2 offset:36000
  v_exp_f32 v23, v23
  v_mul_f32 v213, v101, v213
  v_mfma_f32_16x16x32_bf16 v[228:231], a[20:23], a[4:7], v[228:231]
  v_exp_f32 v24, v24
  v_mul_f32 v214, v102, v214
  v_mfma_f32_16x16x32_bf16 v[232:235], a[20:23], a[8:11], v[232:235]
  ds_read_b64_tr_b16 a[134:135], v2 offset:39584
  v_exp_f32 v25, v25
  v_mul_f32 v215, v103, v215
  v_mfma_f32_16x16x32_bf16 v[236:239], a[20:23], a[12:15], v[236:239]
  v_mul_f32 v212, v212, v26
  v_mul_f32 v213, v213, v27
  v_mul_f32 v214, v214, v28
  v_mul_f32 v215, v215, v29
  v_mfma_f32_16x16x32_bf16 v[236:239], a[152:155], a[44:47], v[236:239]
  ds_read_b64_tr_b16 a[136:137], v2 offset:43168
  v_cvt_pk_bf16_f32 v96, v208, v209
  v_cvt_pk_bf16_f32 v97, v210, v211
  v_mul_f32 v26, v19, v108
  v_mfma_f32_16x16x32_bf16 v[236:239], a[156:159], a[60:63], v[236:239]
  v_mul_f32 v27, v19, v109
  v_mul_f32 v28, v19, v110
  v_mul_f32 v29, v19, v111
  v_mfma_f32_16x16x32_bf16 v[232:235], a[156:159], a[56:59], v[232:235]
  ds_read_b64_tr_b16 a[138:139], v2 offset:46752
  v_exp_f32 v26, v26
  v_fma_f32 v22, v22, v17, v17
  v_mfma_f32_16x16x32_bf16 v[232:235], a[152:155], a[40:43], v[232:235]
  v_exp_f32 v27, v27
  v_fma_f32 v23, v23, v17, v17
  v_mfma_f32_16x16x32_bf16 v[228:231], a[152:155], a[36:39], v[228:231]
  ds_read_b64_tr_b16 a[140:141], v2 offset:50336
  v_exp_f32 v28, v28
  v_fma_f32 v24, v24, v17, v17
  v_mfma_f32_16x16x32_bf16 v[228:231], a[156:159], a[52:55], v[228:231]
  v_exp_f32 v29, v29
  v_fma_f32 v25, v25, v17, v17
  v_cvt_pk_bf16_f32 v100, v212, v213
  v_mfma_f32_16x16x32_bf16 v[224:227], a[156:159], a[48:51], v[224:227]
  s_waitcnt vmcnt(0)
  v_cmp_ne_u32 vcc, 1, v139
  s_nop 4
  s_cbranch_vccnz CK6s
CK6x:
  v_mfma_f32_16x16x32_bf16 v[224:227], a[152:155], a[32:35], v[224:227]
  s_waitcnt lgkmcnt(7)
  s_lshl_b32 s9, s12, 11
  s_mov_b32 s60, 5439488
  ds_read_b64_tr_b16 a[142:143], v2 offset:53920
  v_cvt_pk_bf16_f32 v101, v214, v215
  v_mfma_f32_16x16x32_bf16 v[112:115], a[160:163], a[64:67], v[112:115]
  buffer_load_dwordx4 a[216:219], v137, s[36:39], s9 offen offset:0 sc1
  v_rcp_f32 v22, v22
  v_fma_f32 v26, v26, v20, v20
  v_mfma_f32_16x16x32_bf16 v[112:115], a[164:167], a[80:83], v[112:115]
  v_rcp_f32 v23, v23
  v_fma_f32 v27, v27, v20, v20
  v_mfma_f32_16x16x32_bf16 v[116:119], a[164:167], a[84:87], v[116:119]
  buffer_load_dwordx4 a[220:223], v137, s[36:39], s9 offen offset:1024 sc1
  v_rcp_f32 v24, v24
  v_fma_f32 v28, v28, v20, v20
  v_mfma_f32_16x16x32_bf16 v[116:119], a[160:163], a[68:71], v[116:119]
  v_rcp_f32 v25, v25
  v_fma_f32 v29, v29, v20, v20
  v_mfma_f32_16x16x32_bf16 v[120:123], a[160:163], a[72:75], v[120:123]
  buffer_load_dwordx4 a[224:227], v137, s[36:39], s9 offen offset:2048 sc1
  v_rcp_f32 v26, v26
  v_mul_f32 v216, v104, v216
  v_mfma_f32_16x16x32_bf16 v[120:123], a[164:167], a[88:91], v[120:123]
  v_rcp_f32 v27, v27
  v_mul_f32 v217, v105, v217
  v_mfma_f32_16x16x32_bf16 v[124:127], a[164:167], a[92:95], v[124:127]
  buffer_load_dwordx4 a[228:231], v137, s[36:39], s9 offen offset:3072 sc1
  s_lshl_b32 s9, s13, 11
  v_rcp_f32 v28, v28
  v_mfma_f32_16x16x32_bf16 v[124:127], a[160:163], a[76:79], v[124:127]
  s_waitcnt vmcnt(22)
  s_barrier
  v_mul_f32 v218, v106, v218
  v_rcp_f32 v29, v29
  v_mfma_f32_16x16x32_bf16 v[236:239], a[168:171], a[76:79], v[236:239]
  buffer_load_dwordx4 a[0:3], v137, s[36:39], s9 offen offset:0 sc1
  v_mul_f32 v219, v107, v219
  v_mul_f32 v216, v216, v22
  v_mul_f32 v217, v217, v23
  v_mfma_f32_16x16x32_bf16 v[236:239], a[172:175], a[92:95], v[236:239]
  v_mul_f32 v218, v218, v24
  v_mul_f32 v219, v219, v25
  v_mul_f32 v220, v108, v220
  v_mul_f32 v221, v109, v221
  v_mfma_f32_16x16x32_bf16 v[232:235], a[172:175], a[88:91], v[232:235]
  buffer_load_dwordx4 a[4:7], v137, s[36:39], s9 offen offset:1024 sc1
  v_mul_f32 v222, v110, v222
  v_mul_f32 v223, v111, v223
  v_cvt_pk_bf16_f32 v104, v216, v217
  v_mfma_f32_16x16x32_bf16 v[232:235], a[168:171], a[72:75], v[232:235]
  v_cvt_pk_bf16_f32 v105, v218, v219
  v_mul_f32 v220, v220, v26
  v_mul_f32 v221, v221, v27
  v_mul_f32 v222, v222, v28
  v_mfma_f32_16x16x32_bf16 v[228:231], a[168:171], a[68:71], v[228:231]
  buffer_load_dwordx4 a[8:11], v137, s[36:39], s9 offen offset:2048 sc1
  v_mul_f32 v223, v223, v29
  v_cvt_pk_bf16_f32 v108, v220, v221
  v_cvt_pk_bf16_f32 v109, v222, v223
  v_mfma_f32_16x16x32_bf16 v[228:231], a[172:175], a[84:87], v[228:231]
  v_mfma_f32_16x16x32_bf16 v[224:227], a[172:175], a[80:83], v[224:227]
  buffer_load_dwordx4 a[12:15], v137, s[36:39], s9 offen offset:3072 sc1
  s_lshl_b32 s9, s14, 11
  v_mfma_f32_16x16x32_bf16 v[224:227], a[168:171], a[64:67], v[224:227]
  s_waitcnt lgkmcnt(0)
  v_mfma_f32_16x16x32_bf16 v[112:115], a[128:131], a[96:99], v[112:115]
  s_barrier
  buffer_load_dwordx4 a[16:19], v137, s[36:39], s9 offen offset:0 sc1
  ds_read_b64_tr_b16 a[176:177], v244 offset:49152
  v_mfma_f32_16x16x32_bf16 v[112:115], a[132:135], a[112:115], v[112:115]
  ds_read_b64_tr_b16 a[178:179], v244 offset:53248
  v_mfma_f32_16x16x32_bf16 v[116:119], a[132:135], a[116:119], v[116:119]
  buffer_load_dwordx4 a[20:23], v137, s[36:39], s9 offen offset:1024 sc1
  ds_read_b64_tr_b16 a[180:181], v244 offset:57344
  v_mfma_f32_16x16x32_bf16 v[116:119], a[128:131], a[100:103], v[116:119]
  ds_read_b64_tr_b16 a[182:183], v244 offset:61440
  v_mfma_f32_16x16x32_bf16 v[120:123], a[128:131], a[104:107], v[120:123]
  buffer_load_dwordx4 a[24:27], v137, s[36:39], s9 offen offset:2048 sc1
  ds_read_b64_tr_b16 a[184:185], v245 offset:49152
  v_mfma_f32_16x16x32_bf16 v[120:123], a[132:135], a[120:123], v[120:123]
  ds_read_b64_tr_b16 a[186:187], v245 offset:53248
  v_mfma_f32_16x16x32_bf16 v[124:127], a[132:135], a[124:127], v[124:127]
  buffer_load_dwordx4 a[28:31], v137, s[36:39], s9 offen offset:3072 sc1
  s_cmp_eq_u32 s52, 3
  s_cselect_b32 s15, 52, 24
  s_lshl_b32 s8, s15, 16
  v_mfma_f32_16x16x32_bf16 v[124:127], a[128:131], a[108:111], v[124:127]
  s_add_u32 m0, s73, 16384
  ds_read_b64_tr_b16 a[188:189], v245 offset:57344
  ds_read_b64_tr_b16 a[190:191], v245 offset:61440
  v_mfma_f32_16x16x32_bf16 v[236:239], a[136:139], a[108:111], v[236:239]
  ds_read_b64_tr_b16 a[192:193], v246 offset:49152
  v_mul_f32 v22, v10, v112
  v_mul_f32 v23, v10, v113
  v_mul_f32 v24, v10, v114
  v_mfma_f32_16x16x32_bf16 v[236:239], a[140:143], a[124:127], v[236:239]
  ds_read_b64_tr_b16 a[194:195], v246 offset:53248
  v_mul_f32 v25, v10, v115
  v_exp_f32 v22, v22
  v_mfma_f32_16x16x32_bf16 v[232:235], a[140:143], a[120:123], v[232:235]
  buffer_load_dwordx4 v133, s[24:27], s8 offen offset:0 lds
  ds_read_b64_tr_b16 a[196:197], v246 offset:57344
  v_mul_f32 v26, v13, v116
  v_mfma_f32_16x16x32_bf16 v[232:235], a[136:139], a[104:107], v[232:235]
  ds_read_b64_tr_b16 a[198:199], v246 offset:61440
  v_exp_f32 v23, v23
  v_mul_f32 v27, v13, v117
  v_mfma_f32_16x16x32_bf16 v[228:231], a[136:139], a[100:103], v[228:231]
  s_lshl_b32 s9, s15, 11
  ds_read_b64_tr_b16 a[200:201], v247 offset:49152
  v_exp_f32 v24, v24
  v_mul_f32 v28, v13, v118
  v_mfma_f32_16x16x32_bf16 v[228:231], a[140:143], a[116:119], v[228:231]
  ds_read_b64_tr_b16 a[202:203], v247 offset:53248
  v_exp_f32 v25, v25
  v_mul_f32 v29, v13, v119
  v_mfma_f32_16x16x32_bf16 v[224:227], a[140:143], a[112:115], v[224:227]
  ds_read_b64_tr_b16 a[204:205], v247 offset:57344
  v_exp_f32 v26, v26
  v_fma_f32 v22, v22, v11, v11
  v_mfma_f32_16x16x32_bf16 v[224:227], a[136:139], a[96:99], v[224:227]
  s_waitcnt vmcnt(9) lgkmcnt(11)
  ds_read_b64_tr_b16 a[206:207], v247 offset:61440
  v_exp_f32 v27, v27
  v_fma_f32 v23, v23, v11, v11
  v_mfma_f32_16x16x32_bf16 v[32:35], a[176:179], a[216:219], 0
  buffer_load_dwordx4 a[32:35], v137, s[36:39], s9 offen offset:0 sc1
  ds_read_b64_tr_b16 a[208:209], v244 offset:51200
  v_exp_f32 v28, v28
  v_mfma_f32_16x16x32_bf16 v[32:35], a[180:183], a[224:227], v[32:35]
  ds_read_b64_tr_b16 a[210:211], v244 offset:55296
  v_fma_f32 v24, v24, v11, v11
  v_exp_f32 v29, v29
  v_mfma_f32_16x16x32_bf16 v[36:39], a[180:183], a[228:231], 0
  buffer_load_dwordx4 v134, s[24:27], s8 offen offset:1024 lds
  ds_read_b64_tr_b16 a[212:213], v244 offset:59392
  v_fma_f32 v25, v25, v11, v11
  v_mfma_f32_16x16x32_bf16 v[36:39], a[176:179], a[220:223], v[36:39]
  s_waitcnt lgkmcnt(11)
  ds_read_b64_tr_b16 a[214:215], v244 offset:63488
  v_rcp_f32 v22, v22
  v_fma_f32 v26, v26, v14, v14
  v_mfma_f32_16x16x32_bf16 v[44:47], a[184:187], a[220:223], 0
  ds_read_b64_tr_b16 a[176:177], v245 offset:51200
  v_rcp_f32 v23, v23
  v_fma_f32 v27, v27, v14, v14
  v_mfma_f32_16x16x32_bf16 v[44:47], a[188:191], a[228:231], v[44:47]
  buffer_load_dwordx4 a[36:39], v137, s[36:39], s9 offen offset:1024 sc1
  ds_read_b64_tr_b16 a[178:179], v245 offset:55296
  v_rcp_f32 v24, v24
  v_mfma_f32_16x16x32_bf16 v[40:43], a[188:191], a[224:227], 0
  ds_read_b64_tr_b16 a[180:181], v245 offset:59392
  v_fma_f32 v28, v28, v14, v14
  v_rcp_f32 v25, v25
  v_mfma_f32_16x16x32_bf16 v[40:43], a[184:187], a[216:219], v[40:43]
  s_waitcnt vmcnt(30) lgkmcnt(11)
  s_barrier
  ds_read_b64_tr_b16 a[182:183], v245 offset:63488
  v_fma_f32 v29, v29, v14, v14
  v_mfma_f32_16x16x32_bf16 v[48:51], a[192:195], a[216:219], 0
  ds_read_b64_tr_b16 a[184:185], v246 offset:51200
  v_rcp_f32 v26, v26
  v_mul_f32 v224, v112, v224
  v_mfma_f32_16x16x32_bf16 v[48:51], a[196:199], a[224:227], v[48:51]
  buffer_load_dwordx4 v135, s[24:27], s8 offen offset:2048 lds
  ds_read_b64_tr_b16 a[186:187], v246 offset:55296
  v_rcp_f32 v27, v27
  v_mfma_f32_16x16x32_bf16 v[52:55], a[196:199], a[228:231], 0
  ds_read_b64_tr_b16 a[188:189], v246 offset:59392
  v_mul_f32 v225, v113, v225
  v_rcp_f32 v28, v28
  v_mfma_f32_16x16x32_bf16 v[52:55], a[192:195], a[220:223], v[52:55]
  s_waitcnt lgkmcnt(11)
  ds_read_b64_tr_b16 a[190:191], v246 offset:63488
  v_mul_f32 v226, v114, v226
  v_rcp_f32 v29, v29
  v_mfma_f32_16x16x32_bf16 v[60:63], a[200:203], a[220:223], 0
  ds_read_b64_tr_b16 a[192:193], v247 offset:51200
  v_mul_f32 v227, v115, v227
  v_mul_f32 v224, v224, v22
  v_mul_f32 v225, v225, v23
  v_mfma_f32_16x16x32_bf16 v[60:63], a[204:207], a[228:231], v[60:63]
  buffer_load_dwordx4 a[40:43], v137, s[36:39], s9 offen offset:2048 sc1
  ds_read_b64_tr_b16 a[194:195], v247 offset:55296
  v_mul_f32 v226, v226, v24
  v_mul_f32 v227, v227, v25
  v_mfma_f32_16x16x32_bf16 v[56:59], a[204:207], a[224:227], 0
  ds_read_b64_tr_b16 a[196:197], v247 offset:59392
  v_mul_f32 v22, v16, v120
  v_mul_f32 v23, v16, v121
  v_mul_f32 v24, v16, v122
  v_mfma_f32_16x16x32_bf16 v[56:59], a[200:203], a[216:219], v[56:59]
  s_waitcnt lgkmcnt(11)
  ds_read_b64_tr_b16 a[198:199], v247 offset:63488
  v_mul_f32 v25, v16, v123
  v_exp_f32 v22, v22
  v_mfma_f32_16x16x32_bf16 v[144:147], a[208:211], a[216:219], 0
  buffer_load_dwordx4 v136, s[24:27], s8 offen offset:3072 lds
  ds_read_b64_tr_b16 a[200:201], v248 offset:0
  v_mul_f32 v228, v116, v228
  v_mfma_f32_16x16x32_bf16 v[144:147], a[212:215], a[224:227], v[144:147]
  ds_read_b64_tr_b16 a[202:203], v248 offset:4096
  v_exp_f32 v23, v23
  v_mul_f32 v229, v117, v229
  v_mfma_f32_16x16x32_bf16 v[148:151], a[212:215], a[228:231], 0
Hb1_2:
  s_cbranch_execz Hb1_3
  ds_read_b64_tr_b16 a[204:205], v248 offset:8192
  v_exp_f32 v24, v24
  v_mul_f32 v230, v118, v230
  v_mfma_f32_16x16x32_bf16 v[148:151], a[208:211], a[220:223], v[148:151]
  s_waitcnt lgkmcnt(11)
  ds_read_b64_tr_b16 a[206:207], v248 offset:12288
  v_exp_f32 v25, v25
  v_mul_f32 v231, v119, v231
  v_mfma_f32_16x16x32_bf16 v[156:159], a[176:179], a[220:223], 0
  buffer_load_dwordx4 a[44:47], v137, s[36:39], s9 offen offset:3072 sc1
  s_mov_b32 s40, 31
  s_lshl_b32 s8, s40, 16
  s_add_u32 m0, s73, 32768
  v_mfma_f32_16x16x32_bf16 v[156:159], a[180:183], a[228:231], v[156:159]
  ds_read_b64_tr_b16 a[208:209], v249 offset:0
  ds_read_b64_tr_b16 a[210:211], v249 offset:4096
  v_mul_f32 v228, v228, v26
  v_mul_f32 v229, v229, v27
  v_mfma_f32_16x16x32_bf16 v[152:155], a[180:183], a[224:227], 0
  ds_read_b64_tr_b16 a[212:213], v249 offset:8192
  v_mul_f32 v230, v230, v28
  v_mul_f32 v231, v231, v29
  v_cvt_pk_bf16_f32 v98, v224, v225
  v_mfma_f32_16x16x32_bf16 v[152:155], a[176:179], a[216:219], v[152:155]
  s_waitcnt lgkmcnt(11)
  ds_read_b64_tr_b16 a[214:215], v249 offset:12288
  v_cvt_pk_bf16_f32 v99, v226, v227
  v_mfma_f32_16x16x32_bf16 v[160:163], a[184:187], a[216:219], 0
  buffer_load_dwordx4 v133, s[24:27], s8 offen offset:0 lds
  s_lshl_b32 s9, s40, 11
  ds_read_b64_tr_b16 a[176:177], v250 offset:0
  v_mfma_f32_16x16x32_bf16 v[160:163], a[188:191], a[224:227], v[160:163]
  ds_read_b64_tr_b16 a[178:179], v250 offset:4096
  v_mfma_f32_16x16x32_bf16 v[164:167], a[188:191], a[228:231], 0
  ds_read_b64_tr_b16 a[180:181], v250 offset:8192
  buffer_store_dwordx4 v[96:99], v0, s[36:39], s21 offen offset:0 sc1
  v_mul_f32 v26, v19, v124
  v_mul_f32 v27, v19, v125
  v_mfma_f32_16x16x32_bf16 v[164:167], a[184:187], a[220:223], v[164:167]
  s_waitcnt lgkmcnt(11)
  ds_read_b64_tr_b16 a[182:183], v250 offset:12288
  v_mul_f32 v28, v19, v126
  v_mul_f32 v29, v19, v127
  v_mfma_f32_16x16x32_bf16 v[172:175], a[192:195], a[220:223], 0
  buffer_load_dwordx4 a[48:51], v137, s[36:39], s9 offen offset:0 sc1
  ds_read_b64_tr_b16 a[184:185], v251 offset:0
  v_exp_f32 v26, v26
  v_mfma_f32_16x16x32_bf16 v[172:175], a[196:199], a[228:231], v[172:175]
  ds_read_b64_tr_b16 a[186:187], v251 offset:4096
  v_fma_f32 v22, v22, v17, v17
  v_exp_f32 v27, v27
  v_mfma_f32_16x16x32_bf16 v[168:171], a[196:199], a[224:227], 0
  ds_read_b64_tr_b16 a[188:189], v251 offset:8192
  v_fma_f32 v23, v23, v17, v17
  v_exp_f32 v28, v28
  v_mfma_f32_16x16x32_bf16 v[168:171], a[192:195], a[216:219], v[168:171]
  s_waitcnt vmcnt(15) lgkmcnt(11)
  ds_read_b64_tr_b16 a[190:191], v251 offset:12288
  v_fma_f32 v24, v24, v17, v17
  v_exp_f32 v29, v29
  v_mfma_f32_16x16x32_bf16 v[32:35], a[200:203], a[0:3], v[32:35]
  buffer_load_dwordx4 v134, s[24:27], s8 offen offset:1024 lds
  ds_read_b64_tr_b16 a[192:193], v248 offset:2048
  v_fma_f32 v25, v25, v17, v17
  v_cvt_pk_bf16_f32 v102, v228, v229
  v_mfma_f32_16x16x32_bf16 v[32:35], a[204:207], a[8:11], v[32:35]
  ds_read_b64_tr_b16 a[194:195], v248 offset:6144
  v_cvt_pk_bf16_f32 v103, v230, v231
  v_mfma_f32_16x16x32_bf16 v[36:39], a[204:207], a[12:15], v[36:39]
  ds_read_b64_tr_b16 a[196:197], v248 offset:10240
  buffer_store_dwordx4 v[100:103], v0, s[36:39], s21 offen offset:1024 sc1
  v_rcp_f32 v22, v22
  v_mfma_f32_16x16x32_bf16 v[36:39], a[200:203], a[4:7], v[36:39]
  s_waitcnt lgkmcnt(11)
  ds_read_b64_tr_b16 a[198:199], v248 offset:14336
  v_fma_f32 v26, v26, v20, v20
  v_rcp_f32 v23, v23
  v_mfma_f32_16x16x32_bf16 v[44:47], a[208:211], a[4:7], v[44:47]
  buffer_load_dwordx4 a[52:55], v137, s[36:39], s9 offen offset:1024 sc1
  ds_read_b64_tr_b16 a[200:201], v249 offset:2048
  v_fma_f32 v27, v27, v20, v20
  v_mfma_f32_16x16x32_bf16 v[44:47], a[212:215], a[12:15], v[44:47]
  ds_read_b64_tr_b16 a[202:203], v249 offset:6144
  v_rcp_f32 v24, v24
  v_fma_f32 v28, v28, v20, v20
  v_mfma_f32_16x16x32_bf16 v[40:43], a[212:215], a[8:11], v[40:43]
  ds_read_b64_tr_b16 a[204:205], v249 offset:10240
  v_rcp_f32 v25, v25
  v_fma_f32 v29, v29, v20, v20
  v_mfma_f32_16x16x32_bf16 v[40:43], a[208:211], a[0:3], v[40:43]
  s_waitcnt vmcnt(34) lgkmcnt(11)
  s_barrier
  buffer_load_dwordx4 v135, s[24:27], s8 offen offset:2048 lds
  ds_read_b64_tr_b16 a[206:207], v249 offset:14336
  v_mfma_f32_16x16x32_bf16 v[48:51], a[176:179], a[0:3], v[48:51]
  ds_read_b64_tr_b16 a[208:209], v250 offset:2048
  v_rcp_f32 v26, v26
  v_mul_f32 v232, v120, v232
  v_mfma_f32_16x16x32_bf16 v[48:51], a[180:183], a[8:11], v[48:51]
  ds_read_b64_tr_b16 a[210:211], v250 offset:6144
  v_rcp_f32 v27, v27
  v_mul_f32 v233, v121, v233
  v_mfma_f32_16x16x32_bf16 v[52:55], a[180:183], a[12:15], v[52:55]
  ds_read_b64_tr_b16 a[212:213], v250 offset:10240
  v_rcp_f32 v28, v28
  v_mul_f32 v234, v122, v234
  v_mfma_f32_16x16x32_bf16 v[52:55], a[176:179], a[4:7], v[52:55]
  s_waitcnt lgkmcnt(11)
  buffer_load_dwordx4 a[56:59], v137, s[36:39], s9 offen offset:2048 sc1
  ds_read_b64_tr_b16 a[214:215], v250 offset:14336
  v_rcp_f32 v29, v29
  v_mfma_f32_16x16x32_bf16 v[60:63], a[184:187], a[4:7], v[60:63]
  ds_read_b64_tr_b16 a[176:177], v251 offset:2048
  v_mul_f32 v235, v123, v235
  v_mul_f32 v232, v232, v22
  v_mul_f32 v233, v233, v23
  v_mfma_f32_16x16x32_bf16 v[60:63], a[188:191], a[12:15], v[60:63]
  ds_read_b64_tr_b16 a[178:179], v251 offset:6144
  v_mul_f32 v234, v234, v24
  v_mul_f32 v235, v235, v25
  v_mul_f32 v236, v124, v236
  v_mfma_f32_16x16x32_bf16 v[56:59], a[188:191], a[8:11], v[56:59]
  ds_read_b64_tr_b16 a[180:181], v251 offset:10240
  v_mul_f32 v237, v125, v237
  v_mul_f32 v238, v126, v238
  v_mul_f32 v239, v127, v239
  v_mfma_f32_16x16x32_bf16 v[56:59], a[184:187], a[0:3], v[56:59]
  s_waitcnt lgkmcnt(11)
  buffer_load_dwordx4 v136, s[24:27], s8 offen offset:3072 lds
  ds_read_b64_tr_b16 a[182:183], v251 offset:14336
  v_cvt_pk_bf16_f32 v106, v232, v233
  v_cvt_pk_bf16_f32 v107, v234, v235
  v_mfma_f32_16x16x32_bf16 v[144:147], a[192:195], a[0:3], v[144:147]
  ds_read_b64_tr_b16 a[184:185], v240 offset:0
  v_mfma_f32_16x16x32_bf16 v[144:147], a[196:199], a[8:11], v[144:147]
  ds_read_b64_tr_b16 a[186:187], v240 offset:4096
  buffer_store_dwordx4 v[104:107], v0, s[36:39], s22 offen offset:0 sc1
  v_mul_f32 v236, v236, v26
  v_mul_f32 v237, v237, v27
  v_mfma_f32_16x16x32_bf16 v[148:151], a[196:199], a[12:15], v[148:151]
  ds_read_b64_tr_b16 a[188:189], v240 offset:8192
  v_mul_f32 v238, v238, v28
  v_mul_f32 v239, v239, v29
  v_cvt_pk_bf16_f32 v110, v236, v237
  v_mfma_f32_16x16x32_bf16 v[148:151], a[192:195], a[4:7], v[148:151]
  s_waitcnt lgkmcnt(11)
  buffer_load_dwordx4 a[60:63], v137, s[36:39], s9 offen offset:3072 sc1
  s_cmp_eq_u32 s52, 1
  s_cselect_b32 s41, 10, 38
  s_lshl_b32 s8, s41, 16
  v_mfma_f32_16x16x32_bf16 v[156:159], a[200:203], a[4:7], v[156:159]
  s_add_u32 m0, s73, 49152
  ds_read_b64_tr_b16 a[190:191], v240 offset:12288
  ds_read_b64_tr_b16 a[192:193], v241 offset:0
  v_cvt_pk_bf16_f32 v111, v238, v239
  v_mfma_f32_16x16x32_bf16 v[156:159], a[204:207], a[12:15], v[156:159]
  ds_read_b64_tr_b16 a[194:195], v241 offset:4096
  buffer_store_dwordx4 v[108:111], v0, s[36:39], s22 offen offset:1024 sc1
  v_mfma_f32_16x16x32_bf16 v[152:155], a[204:207], a[8:11], v[152:155]
  ds_read_b64_tr_b16 a[196:197], v241 offset:8192
  v_mfma_f32_16x16x32_bf16 v[152:155], a[200:203], a[0:3], v[152:155]
  s_waitcnt lgkmcnt(11)
  buffer_load_dwordx4 v133, s[24:27], s8 offen offset:0 lds
  s_lshl_b32 s9, s41, 11
  ds_read_b64_tr_b16 a[198:199], v241 offset:12288
  v_mfma_f32_16x16x32_bf16 v[160:163], a[208:211], a[0:3], v[160:163]
  ds_read_b64_tr_b16 a[200:201], v242 offset:0
  v_mfma_f32_16x16x32_bf16 v[160:163], a[212:215], a[8:11], v[160:163]
  ds_read_b64_tr_b16 a[202:203], v242 offset:4096
  v_mfma_f32_16x16x32_bf16 v[164:167], a[212:215], a[12:15], v[164:167]
  buffer_load_dwordx4 a[64:67], v137, s[36:39], s9 offen offset:0 sc1
  ds_read_b64_tr_b16 a[204:205], v242 offset:8192
  v_mfma_f32_16x16x32_bf16 v[164:167], a[208:211], a[4:7], v[164:167]
  s_waitcnt lgkmcnt(11)
  ds_read_b64_tr_b16 a[206:207], v242 offset:12288
  v_mfma_f32_16x16x32_bf16 v[172:175], a[176:179], a[4:7], v[172:175]
  ds_read_b64_tr_b16 a[208:209], v243 offset:0
  v_mfma_f32_16x16x32_bf16 v[172:175], a[180:183], a[12:15], v[172:175]
  ds_read_b64_tr_b16 a[210:211], v243 offset:4096
  v_mfma_f32_16x16x32_bf16 v[168:171], a[180:183], a[8:11], v[168:171]
  buffer_load_dwordx4 v134, s[24:27], s8 offen offset:1024 lds
  ds_read_b64_tr_b16 a[212:213], v243 offset:8192
  v_mfma_f32_16x16x32_bf16 v[168:171], a[176:179], a[0:3], v[168:171]
  s_waitcnt vmcnt(23) lgkmcnt(11)
  ds_read_b64_tr_b16 a[214:215], v243 offset:12288
  v_mfma_f32_16x16x32_bf16 v[32:35], a[184:187], a[16:19], v[32:35]
  ds_read_b64_tr_b16 a[176:177], v240 offset:2048
  v_mfma_f32_16x16x32_bf16 v[32:35], a[188:191], a[24:27], v[32:35]
  ds_read_b64_tr_b16 a[178:179], v240 offset:6144
  v_mfma_f32_16x16x32_bf16 v[36:39], a[188:191], a[28:31], v[36:39]
  buffer_load_dwordx4 a[68:71], v137, s[36:39], s9 offen offset:1024 sc1
  ds_read_b64_tr_b16 a[180:181], v240 offset:10240
  v_mfma_f32_16x16x32_bf16 v[36:39], a[184:187], a[20:23], v[36:39]
  s_waitcnt lgkmcnt(11)
  ds_read_b64_tr_b16 a[182:183], v240 offset:14336
  v_mfma_f32_16x16x32_bf16 v[44:47], a[192:195], a[20:23], v[44:47]
  ds_read_b64_tr_b16 a[184:185], v241 offset:2048
  v_mfma_f32_16x16x32_bf16 v[44:47], a[196:199], a[28:31], v[44:47]
  ds_read_b64_tr_b16 a[186:187], v241 offset:6144
  v_mfma_f32_16x16x32_bf16 v[40:43], a[196:199], a[24:27], v[40:43]
  buffer_load_dwordx4 v135, s[24:27], s8 offen offset:2048 lds
  ds_read_b64_tr_b16 a[188:189], v241 offset:10240
  v_mfma_f32_16x16x32_bf16 v[40:43], a[192:195], a[16:19], v[40:43]
  s_waitcnt vmcnt(18) lgkmcnt(11)
  s_barrier
  ds_read_b64_tr_b16 a[190:191], v241 offset:14336
  v_mfma_f32_16x16x32_bf16 v[48:51], a[200:203], a[16:19], v[48:51]
  ds_read_b64_tr_b16 a[192:193], v242 offset:2048
  v_mfma_f32_16x16x32_bf16 v[48:51], a[204:207], a[24:27], v[48:51]
  buffer_load_dwordx4 a[72:75], v137, s[36:39], s9 offen offset:2048 sc1
  ds_read_b64_tr_b16 a[194:195], v242 offset:6144
  v_mfma_f32_16x16x32_bf16 v[52:55], a[204:207], a[28:31], v[52:55]
  ds_read_b64_tr_b16 a[196:197], v242 offset:10240
  v_mfma_f32_16x16x32_bf16 v[52:55], a[200:203], a[20:23], v[52:55]
  s_waitcnt lgkmcnt(11)
  ds_read_b64_tr_b16 a[198:199], v242 offset:14336
  v_mfma_f32_16x16x32_bf16 v[60:63], a[208:211], a[20:23], v[60:63]
  ds_read_b64_tr_b16 a[200:201], v243 offset:2048
  v_mfma_f32_16x16x32_bf16 v[60:63], a[212:215], a[28:31], v[60:63]
  buffer_load_dwordx4 v136, s[24:27], s8 offen offset:3072 lds
  ds_read_b64_tr_b16 a[202:203], v243 offset:6144
  v_mfma_f32_16x16x32_bf16 v[56:59], a[212:215], a[24:27], v[56:59]
  ds_read_b64_tr_b16 a[204:205], v243 offset:10240
  v_mfma_f32_16x16x32_bf16 v[56:59], a[208:211], a[16:19], v[56:59]
  s_waitcnt lgkmcnt(11)
  ds_read_b64_tr_b16 a[206:207], v243 offset:14336
  v_mfma_f32_16x16x32_bf16 v[144:147], a[176:179], a[16:19], v[144:147]
  ds_read_b64_tr_b16 a[208:209], v240 offset:16384
  v_mfma_f32_16x16x32_bf16 v[144:147], a[180:183], a[24:27], v[144:147]
  buffer_load_dwordx4 a[76:79], v137, s[36:39], s9 offen offset:3072 sc1
  s_cmp_eq_u32 s52, 2
  v_mfma_f32_16x16x32_bf16 v[148:151], a[180:183], a[28:31], v[148:151]
  s_cselect_b32 s42, 17, 45
  s_lshl_b32 s8, s42, 16
  s_add_u32 m0, s73, 65536
  v_mfma_f32_16x16x32_bf16 v[148:151], a[176:179], a[20:23], v[148:151]
  s_waitcnt lgkmcnt(9)
  ds_read_b64_tr_b16 a[210:211], v240 offset:20480
  ds_read_b64_tr_b16 a[212:213], v240 offset:24576
  v_mfma_f32_16x16x32_bf16 v[156:159], a[184:187], a[20:23], v[156:159]
  ds_read_b64_tr_b16 a[214:215], v240 offset:28672
  ds_read_b64_tr_b16 a[176:177], v241 offset:16384
  v_mfma_f32_16x16x32_bf16 v[156:159], a[188:191], a[28:31], v[156:159]
  buffer_load_dwordx4 v133, s[24:27], s8 offen offset:0 lds
  s_lshl_b32 s9, s42, 11
  v_mfma_f32_16x16x32_bf16 v[152:155], a[188:191], a[24:27], v[152:155]
  ds_read_b64_tr_b16 a[178:179], v241 offset:20480
  ds_read_b64_tr_b16 a[180:181], v241 offset:24576
  v_mfma_f32_16x16x32_bf16 v[152:155], a[184:187], a[16:19], v[152:155]
  s_waitcnt lgkmcnt(11)
  ds_read_b64_tr_b16 a[182:183], v241 offset:28672
  v_mfma_f32_16x16x32_bf16 v[160:163], a[192:195], a[16:19], v[160:163]
  ds_read_b64_tr_b16 a[184:185], v242 offset:16384
  v_mfma_f32_16x16x32_bf16 v[160:163], a[196:199], a[24:27], v[160:163]
  buffer_load_dwordx4 a[80:83], v137, s[36:39], s9 offen offset:0 sc1
  ds_read_b64_tr_b16 a[186:187], v242 offset:20480
  v_mfma_f32_16x16x32_bf16 v[164:167], a[196:199], a[28:31], v[164:167]
  ds_read_b64_tr_b16 a[188:189], v242 offset:24576
  v_mfma_f32_16x16x32_bf16 v[164:167], a[192:195], a[20:23], v[164:167]
  s_waitcnt lgkmcnt(11)
  ds_read_b64_tr_b16 a[190:191], v242 offset:28672
  v_mfma_f32_16x16x32_bf16 v[172:175], a[200:203], a[20:23], v[172:175]
  buffer_load_dwordx4 v134, s[24:27], s8 offen offset:1024 lds
  ds_read_b64_tr_b16 a[192:193], v243 offset:16384
  v_mfma_f32_16x16x32_bf16 v[172:175], a[204:207], a[28:31], v[172:175]
  ds_read_b64_tr_b16 a[194:195], v243 offset:20480
  v_mfma_f32_16x16x32_bf16 v[168:171], a[204:207], a[24:27], v[168:171]
  ds_read_b64_tr_b16 a[196:197], v243 offset:24576
  v_mfma_f32_16x16x32_bf16 v[168:171], a[200:203], a[16:19], v[168:171]
  s_waitcnt vmcnt(23) lgkmcnt(11)
  ds_read_b64_tr_b16 a[198:199], v243 offset:28672
  v_mfma_f32_16x16x32_bf16 v[32:35], a[208:211], a[32:35], v[32:35]
  buffer_load_dwordx4 a[84:87], v137, s[36:39], s9 offen offset:1024 sc1
  ds_read_b64_tr_b16 a[200:201], v240 offset:18432
  v_mfma_f32_16x16x32_bf16 v[32:35], a[212:215], a[40:43], v[32:35]
  ds_read_b64_tr_b16 a[202:203], v240 offset:22528
  v_mfma_f32_16x16x32_bf16 v[36:39], a[212:215], a[44:47], v[36:39]
  ds_read_b64_tr_b16 a[204:205], v240 offset:26624
  v_mfma_f32_16x16x32_bf16 v[36:39], a[208:211], a[36:39], v[36:39]
  s_waitcnt lgkmcnt(11)
  ds_read_b64_tr_b16 a[206:207], v240 offset:30720
  v_mfma_f32_16x16x32_bf16 v[44:47], a[176:179], a[36:39], v[44:47]
  buffer_load_dwordx4 v135, s[24:27], s8 offen offset:2048 lds
  ds_read_b64_tr_b16 a[208:209], v241 offset:18432
  v_mfma_f32_16x16x32_bf16 v[44:47], a[180:183], a[44:47], v[44:47]
  ds_read_b64_tr_b16 a[210:211], v241 offset:22528
  v_mfma_f32_16x16x32_bf16 v[40:43], a[180:183], a[40:43], v[40:43]
  s_waitcnt vmcnt(13)
  ds_read_b64_tr_b16 a[212:213], v241 offset:26624
  v_mfma_f32_16x16x32_bf16 v[40:43], a[176:179], a[32:35], v[40:43]
  s_waitcnt vmcnt(16) lgkmcnt(11)
  s_barrier
  ds_read_b64_tr_b16 a[214:215], v241 offset:30720
  v_mfma_f32_16x16x32_bf16 v[48:51], a[184:187], a[32:35], v[48:51]
  s_mov_b64 exec, 1
  buffer_store_dword v254, v0, s[36:39], s45 offen sc1
  s_mov_b64 exec, -1
  v_mfma_f32_16x16x32_bf16 v[48:51], a[188:191], a[40:43], v[48:51]
  buffer_load_dwordx4 a[88:91], v137, s[36:39], s9 offen offset:2048 sc1
  ds_read_b64_tr_b16 a[176:177], v242 offset:18432
  v_mfma_f32_16x16x32_bf16 v[52:55], a[188:191], a[44:47], v[52:55]
  ds_read_b64_tr_b16 a[178:179], v242 offset:22528
  ds_read_b64_tr_b16 a[180:181], v242 offset:26624
  v_mfma_f32_16x16x32_bf16 v[52:55], a[184:187], a[36:39], v[52:55]
  s_waitcnt lgkmcnt(11)
  ds_read_b64_tr_b16 a[182:183], v242 offset:30720
  v_mfma_f32_16x16x32_bf16 v[60:63], a[192:195], a[36:39], v[60:63]
  buffer_load_dwordx4 v136, s[24:27], s8 offen offset:3072 lds
  ds_read_b64_tr_b16 a[184:185], v243 offset:18432
  v_mfma_f32_16x16x32_bf16 v[60:63], a[196:199], a[44:47], v[60:63]
  ds_read_b64_tr_b16 a[186:187], v243 offset:22528
  v_mfma_f32_16x16x32_bf16 v[56:59], a[196:199], a[40:43], v[56:59]
  ds_read_b64_tr_b16 a[188:189], v243 offset:26624
  v_mfma_f32_16x16x32_bf16 v[56:59], a[192:195], a[32:35], v[56:59]
  s_waitcnt lgkmcnt(11)
  buffer_load_dwordx4 a[92:95], v137, s[36:39], s9 offen offset:3072 sc1
  s_cmp_eq_u32 s52, 3
  v_mfma_f32_16x16x32_bf16 v[144:147], a[200:203], a[32:35], v[144:147]
  s_cselect_b32 s43, 24, 52
  s_lshl_b32 s8, s43, 16
  s_add_u32 m0, s73, 81920
  v_mfma_f32_16x16x32_bf16 v[144:147], a[204:207], a[40:43], v[144:147]
  ds_read_b64_tr_b16 a[190:191], v243 offset:30720
  ds_read_b64_tr_b16 a[192:193], v240 offset:32768
  v_mfma_f32_16x16x32_bf16 v[148:151], a[204:207], a[44:47], v[148:151]
  ds_read_b64_tr_b16 a[194:195], v240 offset:36864
  ds_read_b64_tr_b16 a[196:197], v240 offset:40960
  v_mfma_f32_16x16x32_bf16 v[148:151], a[200:203], a[36:39], v[148:151]
  s_waitcnt lgkmcnt(11)
  buffer_load_dwordx4 v133, s[24:27], s8 offen offset:0 lds
  s_lshl_b32 s9, s43, 11
  v_mfma_f32_16x16x32_bf16 v[156:159], a[208:211], a[36:39], v[156:159]
  ds_read_b64_tr_b16 a[198:199], v240 offset:45056
  ds_read_b64_tr_b16 a[200:201], v241 offset:32768
  v_mfma_f32_16x16x32_bf16 v[156:159], a[212:215], a[44:47], v[156:159]
  ds_read_b64_tr_b16 a[202:203], v241 offset:36864
  v_mfma_f32_16x16x32_bf16 v[152:155], a[212:215], a[40:43], v[152:155]
  ds_read_b64_tr_b16 a[204:205], v241 offset:40960
  v_mfma_f32_16x16x32_bf16 v[152:155], a[208:211], a[32:35], v[152:155]
  s_waitcnt lgkmcnt(11)
  buffer_load_dwordx4 a[96:99], v137, s[36:39], s9 offen offset:0 sc1
  ds_read_b64_tr_b16 a[206:207], v241 offset:45056
  v_mfma_f32_16x16x32_bf16 v[160:163], a[176:179], a[32:35], v[160:163]
  ds_read_b64_tr_b16 a[208:209], v242 offset:32768
  v_mfma_f32_16x16x32_bf16 v[160:163], a[180:183], a[40:43], v[160:163]
  ds_read_b64_tr_b16 a[210:211], v242 offset:36864
  v_mfma_f32_16x16x32_bf16 v[164:167], a[180:183], a[44:47], v[164:167]
  ds_read_b64_tr_b16 a[212:213], v242 offset:40960
  v_mfma_f32_16x16x32_bf16 v[164:167], a[176:179], a[36:39], v[164:167]
  s_waitcnt lgkmcnt(11)
  buffer_load_dwordx4 v134, s[24:27], s8 offen offset:1024 lds
  ds_read_b64_tr_b16 a[214:215], v242 offset:45056
  v_mfma_f32_16x16x32_bf16 v[172:175], a[184:187], a[36:39], v[172:175]
  ds_read_b64_tr_b16 a[176:177], v243 offset:32768
  v_mfma_f32_16x16x32_bf16 v[172:175], a[188:191], a[44:47], v[172:175]
  ds_read_b64_tr_b16 a[178:179], v243 offset:36864
  v_mfma_f32_16x16x32_bf16 v[168:171], a[188:191], a[40:43], v[168:171]
  ds_read_b64_tr_b16 a[180:181], v243 offset:40960
  v_mfma_f32_16x16x32_bf16 v[168:171], a[184:187], a[32:35], v[168:171]
  s_waitcnt vmcnt(21) lgkmcnt(11)
  buffer_load_dwordx4 a[100:103], v137, s[36:39], s9 offen offset:1024 sc1
  ds_read_b64_tr_b16 a[182:183], v243 offset:45056
  v_mfma_f32_16x16x32_bf16 v[32:35], a[192:195], a[48:51], v[32:35]
  ds_read_b64_tr_b16 a[184:185], v240 offset:34816
  v_mfma_f32_16x16x32_bf16 v[32:35], a[196:199], a[56:59], v[32:35]
  ds_read_b64_tr_b16 a[186:187], v240 offset:38912
  v_mfma_f32_16x16x32_bf16 v[36:39], a[196:199], a[60:63], v[36:39]
  buffer_load_dwordx4 v135, s[24:27], s8 offen offset:2048 lds
  ds_read_b64_tr_b16 a[188:189], v240 offset:43008
  v_mfma_f32_16x16x32_bf16 v[36:39], a[192:195], a[52:55], v[36:39]
  s_waitcnt lgkmcnt(11)
  ds_read_b64_tr_b16 a[190:191], v240 offset:47104
  v_mfma_f32_16x16x32_bf16 v[44:47], a[200:203], a[52:55], v[44:47]
  ds_read_b64_tr_b16 a[192:193], v241 offset:34816
  v_mfma_f32_16x16x32_bf16 v[44:47], a[204:207], a[60:63], v[44:47]
  ds_read_b64_tr_b16 a[194:195], v241 offset:38912
  v_mfma_f32_16x16x32_bf16 v[40:43], a[204:207], a[56:59], v[40:43]
  buffer_load_dwordx4 a[104:107], v137, s[36:39], s9 offen offset:2048 sc1
  ds_read_b64_tr_b16 a[196:197], v241 offset:43008
  v_mfma_f32_16x16x32_bf16 v[40:43], a[200:203], a[48:51], v[40:43]
  s_waitcnt vmcnt(16) lgkmcnt(11)
  s_barrier
  ds_read_b64_tr_b16 a[198:199], v241 offset:47104
  v_mfma_f32_16x16x32_bf16 v[48:51], a[208:211], a[48:51], v[48:51]
  ds_read_b64_tr_b16 a[200:201], v242 offset:34816
  v_mfma_f32_16x16x32_bf16 v[48:51], a[212:215], a[56:59], v[48:51]
  ds_read_b64_tr_b16 a[202:203], v242 offset:38912
  v_mfma_f32_16x16x32_bf16 v[52:55], a[212:215], a[60:63], v[52:55]
  buffer_load_dwordx4 v136, s[24:27], s8 offen offset:3072 lds
  ds_read_b64_tr_b16 a[204:205], v242 offset:43008
  v_mfma_f32_16x16x32_bf16 v[52:55], a[208:211], a[52:55], v[52:55]
  s_waitcnt lgkmcnt(11)
  ds_read_b64_tr_b16 a[206:207], v242 offset:47104
  v_mfma_f32_16x16x32_bf16 v[60:63], a[176:179], a[52:55], v[60:63]
  ds_read_b64_tr_b16 a[208:209], v243 offset:34816
  v_mfma_f32_16x16x32_bf16 v[60:63], a[180:183], a[60:63], v[60:63]
  ds_read_b64_tr_b16 a[210:211], v243 offset:38912
  v_mfma_f32_16x16x32_bf16 v[56:59], a[180:183], a[56:59], v[56:59]
  buffer_load_dwordx4 a[108:111], v137, s[36:39], s9 offen offset:3072 sc1
  s_add_u32 s50, s52, 8
  v_mfma_f32_16x16x32_bf16 v[56:59], a[176:179], a[48:51], v[56:59]
  s_waitcnt lgkmcnt(10)
  s_and_b32 s50, s50, 3
  s_mul_i32 s50, s50, 14
  v_mfma_f32_16x16x32_bf16 v[144:147], a[184:187], a[48:51], v[144:147]
  s_lshl_b32 s8, s50, 16
  s_add_u32 s8, s8, s53
  s_add_u32 m0, s73, 98304
  v_mfma_f32_16x16x32_bf16 v[144:147], a[188:191], a[56:59], v[144:147]
  ds_read_b64_tr_b16 a[212:213], v243 offset:43008
  ds_read_b64_tr_b16 a[214:215], v243 offset:47104
  v_mfma_f32_16x16x32_bf16 v[148:151], a[188:191], a[60:63], v[148:151]
  ds_read_b64_tr_b16 a[176:177], v240 offset:49152
  ds_read_b64_tr_b16 a[178:179], v240 offset:53248
  v_mfma_f32_16x16x32_bf16 v[148:151], a[184:187], a[52:55], v[148:151]
  s_waitcnt lgkmcnt(10)
  buffer_load_dwordx4 v133, s[24:27], s8 offen offset:0 lds
  s_lshl_b32 s9, s50, 11
  v_mfma_f32_16x16x32_bf16 v[156:159], a[192:195], a[52:55], v[156:159]
  ds_read_b64_tr_b16 a[180:181], v240 offset:57344
  ds_read_b64_tr_b16 a[182:183], v240 offset:61440
  v_mfma_f32_16x16x32_bf16 v[156:159], a[196:199], a[60:63], v[156:159]
  ds_read_b64_tr_b16 a[184:185], v241 offset:49152
  ds_read_b64_tr_b16 a[186:187], v241 offset:53248
  v_mfma_f32_16x16x32_bf16 v[152:155], a[196:199], a[56:59], v[152:155]
  s_add_u32 s28, s73, 16384
  buffer_load_dwordx4 a[112:115], v137, s[36:39], s9 offen offset:0 sc1
  ds_read_b64_tr_b16 a[188:189], v241 offset:57344
  v_mfma_f32_16x16x32_bf16 v[152:155], a[192:195], a[48:51], v[152:155]
  s_waitcnt lgkmcnt(11)
  ds_read_b64_tr_b16 a[190:191], v241 offset:61440
  v_and_b32 v129, 15, v128
  v_mfma_f32_16x16x32_bf16 v[160:163], a[200:203], a[48:51], v[160:163]
  ds_read_b64_tr_b16 a[192:193], v242 offset:49152
  v_lshrrev_b32 v131, 1, v129
  v_mfma_f32_16x16x32_bf16 v[160:163], a[204:207], a[56:59], v[160:163]
  buffer_load_dwordx4 v134, s[24:27], s8 offen offset:1024 lds
  ds_read_b64_tr_b16 a[194:195], v242 offset:53248
  v_mfma_f32_16x16x32_bf16 v[164:167], a[204:207], a[60:63], v[164:167]
  ds_read_b64_tr_b16 a[196:197], v242 offset:57344
  v_lshrrev_b32 v130, 5, v128
  v_mfma_f32_16x16x32_bf16 v[164:167], a[200:203], a[52:55], v[164:167]
  s_waitcnt lgkmcnt(11)
  ds_read_b64_tr_b16 a[198:199], v242 offset:61440
  v_xor_b32 v131, v131, v130
  v_mfma_f32_16x16x32_bf16 v[172:175], a[208:211], a[52:55], v[172:175]
  ds_read_b64_tr_b16 a[200:201], v243 offset:49152
  v_lshlrev_b32 v131, 4, v131
  v_mfma_f32_16x16x32_bf16 v[172:175], a[212:215], a[60:63], v[172:175]
  buffer_load_dwordx4 a[116:119], v137, s[36:39], s9 offen offset:1024 sc1
  ds_read_b64_tr_b16 a[202:203], v243 offset:53248
  v_mfma_f32_16x16x32_bf16 v[168:171], a[212:215], a[56:59], v[168:171]
  ds_read_b64_tr_b16 a[204:205], v243 offset:57344
  v_lshl_add_u32 v131, v129, 7, v131
  v_mfma_f32_16x16x32_bf16 v[168:171], a[208:211], a[48:51], v[168:171]
  s_waitcnt vmcnt(21) lgkmcnt(11)
  ds_read_b64_tr_b16 a[206:207], v243 offset:61440
  v_bfe_u32 v130, v128, 4, 1
  v_mfma_f32_16x16x32_bf16 v[32:35], a[176:179], a[64:67], v[32:35]
  ds_read_b64_tr_b16 a[208:209], v240 offset:51200
  v_lshl_add_u32 v131, v130, 3, v131
  v_mfma_f32_16x16x32_bf16 v[32:35], a[180:183], a[72:75], v[32:35]
  buffer_load_dwordx4 v135, s[24:27], s8 offen offset:2048 lds
  s_add_u32 s9, s9, 12288
  v_mfma_f32_16x16x32_bf16 v[36:39], a[180:183], a[76:79], v[36:39]
  ds_read_b64_tr_b16 a[210:211], v240 offset:55296
  ds_read_b64_tr_b16 a[212:213], v240 offset:59392
  v_mfma_f32_16x16x32_bf16 v[36:39], a[176:179], a[68:71], v[36:39]
  s_waitcnt lgkmcnt(11)
  ds_read_b64_tr_b16 a[214:215], v240 offset:63488
  v_add_u32 v140, s28, v131
  v_mfma_f32_16x16x32_bf16 v[44:47], a[184:187], a[68:71], v[44:47]
  ds_read_b64_tr_b16 a[176:177], v241 offset:51200
  v_xor_b32 v141, 32, v140
  v_mfma_f32_16x16x32_bf16 v[44:47], a[188:191], a[76:79], v[44:47]
  buffer_load_dwordx4 a[120:123], v137, s[36:39], s9 offen offset:2048 sc1
  ds_read_b64_tr_b16 a[178:179], v241 offset:55296
  v_mfma_f32_16x16x32_bf16 v[40:43], a[188:191], a[72:75], v[40:43]
  ds_read_b64_tr_b16 a[180:181], v241 offset:59392
  v_xor_b32 v142, 64, v140
  v_mfma_f32_16x16x32_bf16 v[40:43], a[184:187], a[64:67], v[40:43]
  s_waitcnt vmcnt(15) lgkmcnt(11)
  s_barrier
  ds_read_b64_tr_b16 a[182:183], v241 offset:63488
  v_mfma_f32_16x16x32_bf16 v[48:51], a[192:195], a[64:67], v[48:51]
  ds_read_b64_tr_b16 a[184:185], v242 offset:51200
  v_xor_b32 v143, 96, v140
  v_mfma_f32_16x16x32_bf16 v[48:51], a[196:199], a[72:75], v[48:51]
  buffer_load_dwordx4 v136, s[24:27], s8 offen offset:3072 lds
  ds_read_b64_tr_b16 a[186:187], v242 offset:55296
  v_mfma_f32_16x16x32_bf16 v[52:55], a[196:199], a[76:79], v[52:55]
  ds_read_b64_tr_b16 a[188:189], v242 offset:59392
  v_add_u32 v255, s28, v0
  v_mfma_f32_16x16x32_bf16 v[52:55], a[192:195], a[68:71], v[52:55]
  s_waitcnt lgkmcnt(11)
  ds_read_b64_tr_b16 a[190:191], v242 offset:63488
  s_lshl_b32 s28, s44, 10
  v_mfma_f32_16x16x32_bf16 v[60:63], a[200:203], a[68:71], v[60:63]
  s_add_u32 s28, s28, 151552
  buffer_load_dwordx4 a[124:127], v137, s[36:39], s9 offen offset:3072 sc1
  s_add_u32 s51, s52, 9
  v_mfma_f32_16x16x32_bf16 v[60:63], a[204:207], a[76:79], v[60:63]
  s_and_b32 s51, s51, 3
  s_mul_i32 s51, s51, 14
  s_lshl_b32 s8, s51, 16
  v_mfma_f32_16x16x32_bf16 v[56:59], a[204:207], a[72:75], v[56:59]
  s_add_u32 s8, s8, s53
  s_add_u32 m0, s73, 114688
  ds_read_b64_tr_b16 a[192:193], v243 offset:51200
  v_mfma_f32_16x16x32_bf16 v[56:59], a[200:203], a[64:67], v[56:59]
  s_waitcnt lgkmcnt(9)
  ds_read_b64_tr_b16 a[194:195], v243 offset:55296
  ds_read_b64_tr_b16 a[196:197], v243 offset:59392
  v_mfma_f32_16x16x32_bf16 v[144:147], a[208:211], a[64:67], v[144:147]
  ds_read_b64_tr_b16 a[198:199], v243 offset:63488
  buffer_load_dwordx4 v133, s[24:27], s8 offen offset:0 lds
  v_mfma_f32_16x16x32_bf16 v[144:147], a[212:215], a[72:75], v[144:147]
  s_lshl_b32 s9, s51, 11
  ds_read_b64_tr_b16 a[200:201], v244 offset:0
  ds_read_b64_tr_b16 a[202:203], v244 offset:4096
  v_mfma_f32_16x16x32_bf16 v[148:151], a[212:215], a[76:79], v[148:151]
  ds_read_b64_tr_b16 a[204:205], v244 offset:8192
  v_add_u32 v129, s28, v0
  v_mfma_f32_16x16x32_bf16 v[148:151], a[208:211], a[68:71], v[148:151]
  s_waitcnt lgkmcnt(11)
  ds_read_b64_tr_b16 a[206:207], v244 offset:12288
  v_lshrrev_b32 v130, 4, v128
  v_mfma_f32_16x16x32_bf16 v[156:159], a[176:179], a[68:71], v[156:159]
  buffer_load_dwordx4 a[216:219], v137, s[36:39], s9 offen offset:0 sc1
  ds_read_b64_tr_b16 a[208:209], v245 offset:0
  v_mfma_f32_16x16x32_bf16 v[156:159], a[180:183], a[76:79], v[156:159]
  ds_read_b64_tr_b16 a[210:211], v245 offset:4096
  v_lshl_add_u32 v130, v130, 4, s28
  v_mfma_f32_16x16x32_bf16 v[152:155], a[180:183], a[72:75], v[152:155]
  ds_read_b64_tr_b16 a[212:213], v245 offset:8192
  ds_write_b128 v129, a[248:251]
  v_mfma_f32_16x16x32_bf16 v[152:155], a[176:179], a[64:67], v[152:155]
  s_waitcnt lgkmcnt(12)
  ds_read_b64_tr_b16 a[214:215], v245 offset:12288
  ds_read_b128 v[176:179], v130 offset:768
  v_mfma_f32_16x16x32_bf16 v[160:163], a[184:187], a[64:67], v[160:163]
  buffer_load_dwordx4 v134, s[24:27], s8 offen offset:1024 lds
  ds_read_b64_tr_b16 a[176:177], v246 offset:0
  v_mfma_f32_16x16x32_bf16 v[160:163], a[188:191], a[72:75], v[160:163]
  ds_read_b64_tr_b16 a[178:179], v246 offset:4096
  ds_read_b128 v[180:183], v130 offset:832
  v_mfma_f32_16x16x32_bf16 v[164:167], a[188:191], a[76:79], v[164:167]
  ds_read_b64_tr_b16 a[180:181], v246 offset:8192
  ds_read_b128 v[184:187], v130 offset:896
  v_mfma_f32_16x16x32_bf16 v[164:167], a[184:187], a[68:71], v[164:167]
  s_waitcnt lgkmcnt(15)
  ds_read_b64_tr_b16 a[182:183], v246 offset:12288
  ds_read_b128 v[188:191], v130 offset:960
  v_mfma_f32_16x16x32_bf16 v[172:175], a[192:195], a[68:71], v[172:175]
  buffer_load_dwordx4 a[220:223], v137, s[36:39], s9 offen offset:1024 sc1
  ds_read_b64_tr_b16 a[184:185], v247 offset:0
  v_mfma_f32_16x16x32_bf16 v[172:175], a[196:199], a[76:79], v[172:175]
  ds_read_b64_tr_b16 a[186:187], v247 offset:4096
  v_accvgpr_read_b32 v131, a232
  v_mfma_f32_16x16x32_bf16 v[168:171], a[196:199], a[72:75], v[168:171]
  ds_read_b64_tr_b16 a[188:189], v247 offset:8192
  v_lshlrev_b32 v64, 16, v131
  v_mfma_f32_16x16x32_bf16 v[168:171], a[192:195], a[64:67], v[168:171]
  s_waitcnt vmcnt(20) lgkmcnt(15)
  buffer_load_dwordx4 v135, s[24:27], s8 offen offset:2048 lds
  s_add_u32 s9, s9, 12288
  v_mfma_f32_16x16x32_bf16 v[32:35], a[200:203], a[80:83], v[32:35]
  ds_read_b64_tr_b16 a[190:191], v247 offset:12288
  ds_read_b64_tr_b16 a[192:193], v244 offset:2048
  v_mfma_f32_16x16x32_bf16 v[32:35], a[204:207], a[88:91], v[32:35]
  ds_read_b64_tr_b16 a[194:195], v244 offset:6144
  v_and_b32 v65, 0xffff0000, v131
  v_mfma_f32_16x16x32_bf16 v[36:39], a[204:207], a[92:95], v[36:39]
  ds_read_b64_tr_b16 a[196:197], v244 offset:10240
  v_accvgpr_read_b32 v131, a233
  v_mfma_f32_16x16x32_bf16 v[36:39], a[200:203], a[84:87], v[36:39]
  s_waitcnt lgkmcnt(15)
  buffer_load_dwordx4 a[224:227], v137, s[36:39], s9 offen offset:2048 sc1
  ds_read_b64_tr_b16 a[198:199], v244 offset:14336
  v_mfma_f32_16x16x32_bf16 v[44:47], a[208:211], a[84:87], v[44:47]
Hb2_2:
  s_cbranch_execz Hb2_3
  ds_read_b64_tr_b16 a[200:201], v245 offset:2048
  v_lshlrev_b32 v66, 16, v131
  v_mfma_f32_16x16x32_bf16 v[44:47], a[212:215], a[92:95], v[44:47]
  ds_read_b64_tr_b16 a[202:203], v245 offset:6144
  v_and_b32 v67, 0xffff0000, v131
  v_mfma_f32_16x16x32_bf16 v[40:43], a[212:215], a[88:91], v[40:43]
  ds_read_b64_tr_b16 a[204:205], v245 offset:10240
  v_accvgpr_read_b32 v131, a234
  v_mfma_f32_16x16x32_bf16 v[40:43], a[208:211], a[80:83], v[40:43]
  s_waitcnt vmcnt(15) lgkmcnt(12)
  s_barrier
  buffer_load_dwordx4 v136, s[24:27], s8 offen offset:3072 lds
  v_mfma_f32_16x16x32_bf16 v[48:51], a[176:179], a[80:83], v[48:51]
  ds_read_b64_tr_b16 a[206:207], v245 offset:14336
  ds_read_b64_tr_b16 a[208:209], v246 offset:2048
  v_mfma_f32_16x16x32_bf16 v[48:51], a[180:183], a[88:91], v[48:51]
  ds_read_b64_tr_b16 a[210:211], v246 offset:6144
  v_lshlrev_b32 v68, 16, v131
  v_mfma_f32_16x16x32_bf16 v[52:55], a[180:183], a[92:95], v[52:55]
  ds_read_b64_tr_b16 a[212:213], v246 offset:10240
  v_and_b32 v69, 0xffff0000, v131
  v_mfma_f32_16x16x32_bf16 v[52:55], a[176:179], a[84:87], v[52:55]
  s_waitcnt lgkmcnt(11)
  buffer_load_dwordx4 a[228:231], v137, s[36:39], s9 offen offset:3072 sc1
  s_add_u32 s12, s52, 10
  v_mfma_f32_16x16x32_bf16 v[60:63], a[184:187], a[84:87], v[60:63]
  s_and_b32 s12, s12, 3
  s_mul_i32 s12, s12, 14
  s_lshl_b32 s8, s12, 16
  v_mfma_f32_16x16x32_bf16 v[60:63], a[188:191], a[92:95], v[60:63]
  s_add_u32 s8, s8, s53
  s_add_u32 m0, s73, 131072
  ds_read_b64_tr_b16 a[214:215], v246 offset:14336
  v_mfma_f32_16x16x32_bf16 v[56:59], a[188:191], a[88:91], v[56:59]
  ds_read_b64_tr_b16 a[176:177], v247 offset:2048
  ds_read_b64_tr_b16 a[178:179], v247 offset:6144
  v_mfma_f32_16x16x32_bf16 v[56:59], a[184:187], a[80:83], v[56:59]
  s_waitcnt lgkmcnt(10)
  ds_read_b64_tr_b16 a[180:181], v247 offset:10240
  buffer_load_dwordx4 v133, s[24:27], s8 offen offset:0 lds
  v_mfma_f32_16x16x32_bf16 v[144:147], a[192:195], a[80:83], v[144:147]
  s_lshl_b32 s9, s12, 11
  ds_read_b64_tr_b16 a[182:183], v247 offset:14336
  ds_read_b64_tr_b16 a[184:185], v244 offset:16384
  v_mfma_f32_16x16x32_bf16 v[144:147], a[196:199], a[88:91], v[144:147]
  ds_read_b64_tr_b16 a[186:187], v244 offset:20480
  v_accvgpr_read_b32 v131, a235
  v_mfma_f32_16x16x32_bf16 v[148:151], a[196:199], a[92:95], v[148:151]
  buffer_load_dwordx4 a[0:3], v137, s[36:39], s9 offen offset:0 sc1
  ds_read_b64_tr_b16 a[188:189], v244 offset:24576
  v_mfma_f32_16x16x32_bf16 v[148:151], a[192:195], a[84:87], v[148:151]
  s_waitcnt lgkmcnt(11)
  ds_read_b64_tr_b16 a[190:191], v244 offset:28672
  v_lshlrev_b32 v70, 16, v131
  v_mfma_f32_16x16x32_bf16 v[156:159], a[200:203], a[84:87], v[156:159]
  ds_read_b64_tr_b16 a[192:193], v245 offset:16384
  v_and_b32 v71, 0xffff0000, v131
  v_mfma_f32_16x16x32_bf16 v[156:159], a[204:207], a[92:95], v[156:159]
  ds_read_b64_tr_b16 a[194:195], v245 offset:20480
  v_accvgpr_read_b32 v131, a236
  v_mfma_f32_16x16x32_bf16 v[152:155], a[204:207], a[88:91], v[152:155]
  buffer_load_dwordx4 v134, s[24:27], s8 offen offset:1024 lds
  ds_read_b64_tr_b16 a[196:197], v245 offset:24576
  v_mfma_f32_16x16x32_bf16 v[152:155], a[200:203], a[80:83], v[152:155]
  s_waitcnt lgkmcnt(11)
  ds_read_b64_tr_b16 a[198:199], v245 offset:28672
  v_lshlrev_b32 v72, 16, v131
  v_mfma_f32_16x16x32_bf16 v[160:163], a[208:211], a[80:83], v[160:163]
  ds_read_b64_tr_b16 a[200:201], v246 offset:16384
  v_and_b32 v73, 0xffff0000, v131
  v_mfma_f32_16x16x32_bf16 v[160:163], a[212:215], a[88:91], v[160:163]
  ds_read_b64_tr_b16 a[202:203], v246 offset:20480
  v_accvgpr_read_b32 v131, a237
  v_mfma_f32_16x16x32_bf16 v[164:167], a[212:215], a[92:95], v[164:167]
  buffer_load_dword v139, v138, s[36:39], s60 offen sc1
  ds_read_b64_tr_b16 a[204:205], v246 offset:24576
  v_mfma_f32_16x16x32_bf16 v[164:167], a[208:211], a[84:87], v[164:167]
  s_waitcnt lgkmcnt(11)
  ds_read_b64_tr_b16 a[206:207], v246 offset:28672
  v_lshlrev_b32 v74, 16, v131
  v_mfma_f32_16x16x32_bf16 v[172:175], a[176:179], a[84:87], v[172:175]
  ds_read_b64_tr_b16 a[208:209], v247 offset:16384
  v_and_b32 v75, 0xffff0000, v131
  v_mfma_f32_16x16x32_bf16 v[172:175], a[180:183], a[92:95], v[172:175]
  buffer_load_dwordx4 a[4:7], v137, s[36:39], s9 offen offset:1024 sc1
  ds_read_b64_tr_b16 a[210:211], v247 offset:20480
  v_mfma_f32_16x16x32_bf16 v[168:171], a[180:183], a[88:91], v[168:171]
  ds_read_b64_tr_b16 a[212:213], v247 offset:24576
  v_accvgpr_read_b32 v131, a238
  v_mfma_f32_16x16x32_bf16 v[168:171], a[176:179], a[80:83], v[168:171]
  s_waitcnt vmcnt(21) lgkmcnt(11)
  ds_read_b64_tr_b16 a[214:215], v247 offset:28672
  v_lshlrev_b32 v76, 16, v131
  v_mfma_f32_16x16x32_bf16 v[32:35], a[184:187], a[96:99], v[32:35]
  buffer_load_dwordx4 v135, s[24:27], s8 offen offset:2048 lds
  s_add_u32 s9, s9, 12288
  v_mfma_f32_16x16x32_bf16 v[32:35], a[188:191], a[104:107], v[32:35]
  ds_read_b64_tr_b16 a[176:177], v244 offset:18432
  ds_read_b64_tr_b16 a[178:179], v244 offset:22528
  v_mfma_f32_16x16x32_bf16 v[36:39], a[188:191], a[108:111], v[36:39]
  ds_read_b64_tr_b16 a[180:181], v244 offset:26624
  v_and_b32 v77, 0xffff0000, v131
  v_mfma_f32_16x16x32_bf16 v[36:39], a[184:187], a[100:103], v[36:39]
  s_waitcnt lgkmcnt(11)
  buffer_load_dwordx4 a[8:11], v137, s[36:39], s9 offen offset:2048 sc1
  ds_read_b64_tr_b16 a[182:183], v244 offset:30720
  v_mfma_f32_16x16x32_bf16 v[44:47], a[192:195], a[100:103], v[44:47]
  ds_read_b64_tr_b16 a[184:185], v245 offset:18432
  v_accvgpr_read_b32 v131, a239
  v_mfma_f32_16x16x32_bf16 v[44:47], a[196:199], a[108:111], v[44:47]
  ds_read_b64_tr_b16 a[186:187], v245 offset:22528
  v_lshlrev_b32 v78, 16, v131
  v_mfma_f32_16x16x32_bf16 v[40:43], a[196:199], a[104:107], v[40:43]
  buffer_load_dwordx4 v136, s[24:27], s8 offen offset:3072 lds
  ds_read_b64_tr_b16 a[188:189], v245 offset:26624
  v_mfma_f32_16x16x32_bf16 v[40:43], a[192:195], a[96:99], v[40:43]
  s_waitcnt vmcnt(17) lgkmcnt(11)
  s_barrier
  ds_read_b64_tr_b16 a[190:191], v245 offset:30720
  v_mfma_f32_16x16x32_bf16 v[48:51], a[200:203], a[96:99], v[48:51]
  ds_read_b64_tr_b16 a[192:193], v246 offset:18432
  v_and_b32 v79, 0xffff0000, v131
  v_mfma_f32_16x16x32_bf16 v[48:51], a[204:207], a[104:107], v[48:51]
  buffer_load_dwordx4 a[12:15], v137, s[36:39], s9 offen offset:3072 sc1
  s_add_u32 s13, s52, 11
  v_mfma_f32_16x16x32_bf16 v[52:55], a[204:207], a[108:111], v[52:55]
  s_and_b32 s13, s13, 3
  s_mul_i32 s13, s13, 14
  s_lshl_b32 s8, s13, 16
  v_mfma_f32_16x16x32_bf16 v[52:55], a[200:203], a[100:103], v[52:55]
  s_waitcnt lgkmcnt(9)
  s_add_u32 s8, s8, s53
  s_add_u32 m0, s73, 0
  v_mfma_f32_16x16x32_bf16 v[60:63], a[208:211], a[100:103], v[60:63]
  ds_read_b64_tr_b16 a[194:195], v246 offset:22528
  ds_read_b64_tr_b16 a[196:197], v246 offset:26624
  v_mfma_f32_16x16x32_bf16 v[60:63], a[212:215], a[108:111], v[60:63]
  ds_read_b64_tr_b16 a[198:199], v246 offset:30720
  ds_read_b64_tr_b16 a[200:201], v247 offset:18432
  v_mfma_f32_16x16x32_bf16 v[56:59], a[212:215], a[104:107], v[56:59]
  buffer_load_dwordx4 v133, s[24:27], s8 offen offset:0 lds
  s_lshl_b32 s9, s13, 11
  v_mfma_f32_16x16x32_bf16 v[56:59], a[208:211], a[96:99], v[56:59]
  s_waitcnt lgkmcnt(9)
  ds_read_b64_tr_b16 a[202:203], v247 offset:22528
  ds_read_b64_tr_b16 a[204:205], v247 offset:26624
  v_mfma_f32_16x16x32_bf16 v[144:147], a[176:179], a[96:99], v[144:147]
  ds_read_b64_tr_b16 a[206:207], v247 offset:30720
  ds_read_b64_tr_b16 a[208:209], v244 offset:32768
  v_mfma_f32_16x16x32_bf16 v[144:147], a[180:183], a[104:107], v[144:147]
  buffer_load_dwordx4 a[16:19], v137, s[36:39], s9 offen offset:0 sc1
  ds_read_b64_tr_b16 a[210:211], v244 offset:36864
  v_mfma_f32_16x16x32_bf16 v[148:151], a[180:183], a[108:111], v[148:151]
  ds_read_b64_tr_b16 a[212:213], v244 offset:40960
  v_accvgpr_read_b32 v131, a240
  v_mfma_f32_16x16x32_bf16 v[148:151], a[176:179], a[100:103], v[148:151]
  s_waitcnt lgkmcnt(11)
  ds_read_b64_tr_b16 a[214:215], v244 offset:45056
  v_lshlrev_b32 v80, 16, v131
  v_mfma_f32_16x16x32_bf16 v[156:159], a[184:187], a[100:103], v[156:159]
  ds_read_b64_tr_b16 a[176:177], v245 offset:32768
  v_and_b32 v81, 0xffff0000, v131
  v_mfma_f32_16x16x32_bf16 v[156:159], a[188:191], a[108:111], v[156:159]
  buffer_load_dwordx4 v134, s[24:27], s8 offen offset:1024 lds
  ds_read_b64_tr_b16 a[178:179], v245 offset:36864
  v_mfma_f32_16x16x32_bf16 v[152:155], a[188:191], a[104:107], v[152:155]
  ds_read_b64_tr_b16 a[180:181], v245 offset:40960
  v_accvgpr_read_b32 v131, a241
  v_mfma_f32_16x16x32_bf16 v[152:155], a[184:187], a[96:99], v[152:155]
  s_waitcnt lgkmcnt(11)
  ds_read_b64_tr_b16 a[182:183], v245 offset:45056
  v_lshlrev_b32 v82, 16, v131
  v_mfma_f32_16x16x32_bf16 v[160:163], a[192:195], a[96:99], v[160:163]
  buffer_load_dwordx4 a[20:23], v137, s[36:39], s9 offen offset:1024 sc1
  ds_read_b64_tr_b16 a[184:185], v246 offset:32768
  v_mfma_f32_16x16x32_bf16 v[160:163], a[196:199], a[104:107], v[160:163]
  ds_read_b64_tr_b16 a[186:187], v246 offset:36864
  v_and_b32 v83, 0xffff0000, v131
  v_mfma_f32_16x16x32_bf16 v[164:167], a[196:199], a[108:111], v[164:167]
  ds_read_b64_tr_b16 a[188:189], v246 offset:40960
  v_accvgpr_read_b32 v131, a242
  v_mfma_f32_16x16x32_bf16 v[164:167], a[192:195], a[100:103], v[164:167]
  s_waitcnt lgkmcnt(11)
  ds_read_b64_tr_b16 a[190:191], v246 offset:45056
  v_lshlrev_b32 v84, 16, v131
  v_mfma_f32_16x16x32_bf16 v[172:175], a[200:203], a[100:103], v[172:175]
  buffer_load_dwordx4 v135, s[24:27], s8 offen offset:2048 lds
  s_add_u32 s9, s9, 12288
  v_mfma_f32_16x16x32_bf16 v[172:175], a[204:207], a[108:111], v[172:175]
  ds_read_b64_tr_b16 a[192:193], v247 offset:32768
  ds_read_b64_tr_b16 a[194:195], v247 offset:36864
  v_mfma_f32_16x16x32_bf16 v[168:171], a[204:207], a[104:107], v[168:171]
  ds_read_b64_tr_b16 a[196:197], v247 offset:40960
  v_and_b32 v85, 0xffff0000, v131
  v_mfma_f32_16x16x32_bf16 v[168:171], a[200:203], a[96:99], v[168:171]
  s_waitcnt vmcnt(22) lgkmcnt(11)
  ds_read_b64_tr_b16 a[198:199], v247 offset:45056
  v_accvgpr_read_b32 v131, a243
  v_mfma_f32_16x16x32_bf16 v[32:35], a[208:211], a[112:115], v[32:35]
  buffer_load_dwordx4 a[24:27], v137, s[36:39], s9 offen offset:2048 sc1
  ds_read_b64_tr_b16 a[200:201], v244 offset:34816
  v_mfma_f32_16x16x32_bf16 v[32:35], a[212:215], a[120:123], v[32:35]
  ds_read_b64_tr_b16 a[202:203], v244 offset:38912
  v_lshlrev_b32 v86, 16, v131
  v_mfma_f32_16x16x32_bf16 v[36:39], a[212:215], a[124:127], v[36:39]
  ds_read_b64_tr_b16 a[204:205], v244 offset:43008
  v_and_b32 v87, 0xffff0000, v131
  v_mfma_f32_16x16x32_bf16 v[36:39], a[208:211], a[116:119], v[36:39]
  s_waitcnt lgkmcnt(11)
  ds_read_b64_tr_b16 a[206:207], v244 offset:47104
  v_accvgpr_read_b32 v131, a244
  v_mfma_f32_16x16x32_bf16 v[44:47], a[176:179], a[116:119], v[44:47]
  buffer_load_dwordx4 v136, s[24:27], s8 offen offset:3072 lds
  ds_read_b64_tr_b16 a[208:209], v245 offset:34816
  v_mfma_f32_16x16x32_bf16 v[44:47], a[180:183], a[124:127], v[44:47]
  ds_read_b64_tr_b16 a[210:211], v245 offset:38912
  v_lshlrev_b32 v88, 16, v131
  v_mfma_f32_16x16x32_bf16 v[40:43], a[180:183], a[120:123], v[40:43]
  ds_read_b64_tr_b16 a[212:213], v245 offset:43008
  v_and_b32 v89, 0xffff0000, v131
  v_mfma_f32_16x16x32_bf16 v[40:43], a[176:179], a[112:115], v[40:43]
  s_waitcnt vmcnt(17) lgkmcnt(11)
  s_barrier
  ds_read_b64_tr_b16 a[214:215], v245 offset:47104
  v_mfma_f32_16x16x32_bf16 v[48:51], a[184:187], a[112:115], v[48:51]
  buffer_load_dwordx4 a[28:31], v137, s[36:39], s9 offen offset:3072 sc1
  s_mov_b32 s14, 1
  v_mfma_f32_16x16x32_bf16 v[48:51], a[188:191], a[120:123], v[48:51]
  s_lshl_b32 s8, s14, 16
  s_add_u32 m0, s73, 16384
  ds_read_b64_tr_b16 a[176:177], v246 offset:34816
  v_mfma_f32_16x16x32_bf16 v[52:55], a[188:191], a[124:127], v[52:55]
  ds_read_b64_tr_b16 a[178:179], v246 offset:38912
  ds_read_b64_tr_b16 a[180:181], v246 offset:43008
  v_mfma_f32_16x16x32_bf16 v[52:55], a[184:187], a[116:119], v[52:55]
  s_waitcnt lgkmcnt(11)
  buffer_load_dwordx4 v133, s[24:27], s8 offen offset:0 lds
  ds_read_b64_tr_b16 a[182:183], v246 offset:47104
  v_mfma_f32_16x16x32_bf16 v[60:63], a[192:195], a[116:119], v[60:63]
  s_waitcnt vmcnt(14)
  v_cmp_ne_u32 vcc, 1, v139
  s_nop 4
  s_cbranch_vccnz CK7s
CK7x:
  v_mfma_f32_16x16x32_bf16 v[60:63], a[196:199], a[124:127], v[60:63]
  s_lshl_b32 s9, s14, 11
  ds_read_b64_tr_b16 a[184:185], v247 offset:34816
  ds_read_b64_tr_b16 a[186:187], v247 offset:38912
  v_mfma_f32_16x16x32_bf16 v[56:59], a[196:199], a[120:123], v[56:59]
  ds_read_b64_tr_b16 a[188:189], v247 offset:43008
  v_accvgpr_read_b32 v131, a245
  v_mfma_f32_16x16x32_bf16 v[56:59], a[192:195], a[112:115], v[56:59]
  s_waitcnt lgkmcnt(11)
  buffer_load_dwordx4 a[32:35], v137, s[36:39], s9 offen offset:0 sc1
  ds_read_b64_tr_b16 a[190:191], v247 offset:47104
  v_mfma_f32_16x16x32_bf16 v[144:147], a[200:203], a[112:115], v[144:147]
  ds_read_b64_tr_b16 a[192:193], v244 offset:49152
  v_lshlrev_b32 v90, 16, v131
  v_mfma_f32_16x16x32_bf16 v[144:147], a[204:207], a[120:123], v[144:147]
  ds_read_b64_tr_b16 a[194:195], v244 offset:53248
  v_and_b32 v91, 0xffff0000, v131
  v_mfma_f32_16x16x32_bf16 v[148:151], a[204:207], a[124:127], v[148:151]
  ds_read_b64_tr_b16 a[196:197], v244 offset:57344
  v_accvgpr_read_b32 v131, a246
  v_mfma_f32_16x16x32_bf16 v[148:151], a[200:203], a[116:119], v[148:151]
  s_waitcnt lgkmcnt(11)
  buffer_load_dwordx4 v134, s[24:27], s8 offen offset:1024 lds
  ds_read_b64_tr_b16 a[198:199], v244 offset:61440
  v_mfma_f32_16x16x32_bf16 v[156:159], a[208:211], a[116:119], v[156:159]
  ds_read_b64_tr_b16 a[200:201], v245 offset:49152
  v_lshlrev_b32 v92, 16, v131
  v_mfma_f32_16x16x32_bf16 v[156:159], a[212:215], a[124:127], v[156:159]
  ds_read_b64_tr_b16 a[202:203], v245 offset:53248
  v_and_b32 v93, 0xffff0000, v131
  v_mfma_f32_16x16x32_bf16 v[152:155], a[212:215], a[120:123], v[152:155]
  ds_read_b64_tr_b16 a[204:205], v245 offset:57344
  v_accvgpr_read_b32 v131, a247
  v_mfma_f32_16x16x32_bf16 v[152:155], a[208:211], a[112:115], v[152:155]
  s_waitcnt lgkmcnt(11)
  buffer_load_dwordx4 a[36:39], v137, s[36:39], s9 offen offset:1024 sc1
  ds_read_b64_tr_b16 a[206:207], v245 offset:61440
  v_mfma_f32_16x16x32_bf16 v[160:163], a[176:179], a[112:115], v[160:163]
  ds_read_b64_tr_b16 a[208:209], v246 offset:49152
  v_lshlrev_b32 v94, 16, v131
  v_mfma_f32_16x16x32_bf16 v[160:163], a[180:183], a[120:123], v[160:163]
  ds_read_b64_tr_b16 a[210:211], v246 offset:53248
  v_and_b32 v95, 0xffff0000, v131
  v_mfma_f32_16x16x32_bf16 v[164:167], a[180:183], a[124:127], v[164:167]
  s_add_u32 s49, s72, 32768
  ds_read_b64_tr_b16 a[212:213], v246 offset:57344
  s_lshl_b32 s28, s2, 5
  v_mfma_f32_16x16x32_bf16 v[164:167], a[176:179], a[116:119], v[164:167]
  s_waitcnt lgkmcnt(11)
  buffer_load_dwordx4 v135, s[24:27], s8 offen offset:2048 lds
  ds_read_b64_tr_b16 a[214:215], v246 offset:61440
  v_mfma_f32_16x16x32_bf16 v[172:175], a[184:187], a[116:119], v[172:175]
  s_add_u32 s28, s28, s44
  ds_read_b64_tr_b16 a[176:177], v247 offset:49152
  s_lshl2_add_u32 s28, s28, 5472256
  v_mfma_f32_16x16x32_bf16 v[172:175], a[188:191], a[124:127], v[172:175]
  s_xor_b32 s29, s28, 128
  ds_read_b64_tr_b16 a[178:179], v247 offset:53248
  v_mov_b32 v132, 0
  v_mfma_f32_16x16x32_bf16 v[168:171], a[188:191], a[120:123], v[168:171]
  ds_read_b64_tr_b16 a[180:181], v247 offset:57344
  v_mfma_f32_16x16x32_bf16 v[168:171], a[184:187], a[112:115], v[168:171]
  s_waitcnt vmcnt(22) lgkmcnt(11)
  buffer_load_dwordx4 a[40:43], v137, s[36:39], s9 offen offset:2048 sc1
  ds_read_b64_tr_b16 a[182:183], v247 offset:61440
  v_mfma_f32_16x16x32_bf16 v[32:35], a[192:195], a[216:219], v[32:35]
  ds_read_b64_tr_b16 a[184:185], v244 offset:51200
  v_mfma_f32_16x16x32_bf16 v[32:35], a[196:199], a[224:227], v[32:35]
  ds_read_b64_tr_b16 a[186:187], v244 offset:55296
  v_mfma_f32_16x16x32_bf16 v[36:39], a[196:199], a[228:231], v[36:39]
  buffer_load_dwordx4 v136, s[24:27], s8 offen offset:3072 lds
  ds_read_b64_tr_b16 a[188:189], v244 offset:59392
  v_mfma_f32_16x16x32_bf16 v[36:39], a[192:195], a[220:223], v[36:39]
  s_waitcnt lgkmcnt(11)
  ds_read_b64_tr_b16 a[190:191], v244 offset:63488
  v_mfma_f32_16x16x32_bf16 v[44:47], a[200:203], a[220:223], v[44:47]
  ds_read_b64_tr_b16 a[192:193], v245 offset:51200
  v_mfma_f32_16x16x32_bf16 v[44:47], a[204:207], a[228:231], v[44:47]
  ds_read_b64_tr_b16 a[194:195], v245 offset:55296
  v_mfma_f32_16x16x32_bf16 v[40:43], a[204:207], a[224:227], v[40:43]
  buffer_load_dwordx4 a[44:47], v137, s[36:39], s9 offen offset:3072 sc1
  s_cmp_eq_u32 s52, 1
  v_mfma_f32_16x16x32_bf16 v[40:43], a[200:203], a[216:219], v[40:43]
  s_waitcnt vmcnt(17) lgkmcnt(10)
  s_barrier
  s_cselect_b32 s15, 19, 5
  v_mfma_f32_16x16x32_bf16 v[48:51], a[208:211], a[216:219], v[48:51]
  s_lshl_b32 s8, s15, 16
  s_add_u32 m0, s73, 32768
  ds_read_b64_tr_b16 a[196:197], v245 offset:59392
  v_mfma_f32_16x16x32_bf16 v[48:51], a[212:215], a[224:227], v[48:51]
  ds_read_b64_tr_b16 a[198:199], v245 offset:63488
  ds_read_b64_tr_b16 a[200:201], v246 offset:51200
  v_mfma_f32_16x16x32_bf16 v[52:55], a[212:215], a[228:231], v[52:55]
  ds_read_b64_tr_b16 a[202:203], v246 offset:55296
  buffer_load_dwordx4 v133, s[24:27], s8 offen offset:0 lds
  v_mfma_f32_16x16x32_bf16 v[52:55], a[208:211], a[220:223], v[52:55]
  s_waitcnt lgkmcnt(10)
  s_lshl_b32 s9, s15, 11
  ds_read_b64_tr_b16 a[204:205], v246 offset:59392
  v_mfma_f32_16x16x32_bf16 v[60:63], a[176:179], a[220:223], v[60:63]
  ds_read_b64_tr_b16 a[206:207], v246 offset:63488
  ds_read_b64_tr_b16 a[208:209], v247 offset:51200
  v_mfma_f32_16x16x32_bf16 v[60:63], a[180:183], a[228:231], v[60:63]
  ds_read_b64_tr_b16 a[210:211], v247 offset:55296
  v_mfma_f32_16x16x32_bf16 v[56:59], a[180:183], a[224:227], v[56:59]
  buffer_load_dwordx4 a[48:51], v137, s[36:39], s9 offen offset:0 sc1
  ds_read_b64_tr_b16 a[212:213], v247 offset:59392
  v_mfma_f32_16x16x32_bf16 v[56:59], a[176:179], a[216:219], v[56:59]
  s_waitcnt lgkmcnt(11)
  ds_read_b64_tr_b16 a[214:215], v247 offset:63488
  v_mfma_f32_16x16x32_bf16 v[144:147], a[184:187], a[216:219], v[144:147]
  ds_read_b64_tr_b16 a[176:177], v248 offset:0
  v_mfma_f32_16x16x32_bf16 v[144:147], a[188:191], a[224:227], v[144:147]
  ds_read_b64_tr_b16 a[178:179], v248 offset:4096
  v_mfma_f32_16x16x32_bf16 v[148:151], a[188:191], a[228:231], v[148:151]
  buffer_load_dwordx4 v134, s[24:27], s8 offen offset:1024 lds
  ds_read_b64_tr_b16 a[180:181], v248 offset:8192
  v_mfma_f32_16x16x32_bf16 v[148:151], a[184:187], a[220:223], v[148:151]
  s_waitcnt lgkmcnt(11)
  ds_read_b64_tr_b16 a[182:183], v248 offset:12288
  v_mfma_f32_16x16x32_bf16 v[156:159], a[192:195], a[220:223], v[156:159]
  ds_read_b64_tr_b16 a[184:185], v249 offset:0
  v_mfma_f32_16x16x32_bf16 v[156:159], a[196:199], a[228:231], v[156:159]
  buffer_load_dwordx4 a[52:55], v137, s[36:39], s9 offen offset:1024 sc1
  ds_read_b64_tr_b16 a[186:187], v249 offset:4096
  v_mfma_f32_16x16x32_bf16 v[152:155], a[196:199], a[224:227], v[152:155]
  ds_read_b64_tr_b16 a[188:189], v249 offset:8192
  v_mfma_f32_16x16x32_bf16 v[152:155], a[192:195], a[216:219], v[152:155]
  s_waitcnt lgkmcnt(11)
  ds_read_b64_tr_b16 a[190:191], v249 offset:12288
  v_mfma_f32_16x16x32_bf16 v[160:163], a[200:203], a[216:219], v[160:163]
  ds_read_b64_tr_b16 a[192:193], v250 offset:0
  v_mfma_f32_16x16x32_bf16 v[160:163], a[204:207], a[224:227], v[160:163]
  buffer_load_dwordx4 v135, s[24:27], s8 offen offset:2048 lds
  ds_read_b64_tr_b16 a[194:195], v250 offset:4096
  v_mfma_f32_16x16x32_bf16 v[164:167], a[204:207], a[228:231], v[164:167]
  ds_read_b64_tr_b16 a[196:197], v250 offset:8192
  v_mfma_f32_16x16x32_bf16 v[164:167], a[200:203], a[220:223], v[164:167]
  s_waitcnt lgkmcnt(11)
  ds_read_b64_tr_b16 a[198:199], v250 offset:12288
  v_mfma_f32_16x16x32_bf16 v[172:175], a[208:211], a[220:223], v[172:175]
  ds_read_b64_tr_b16 a[200:201], v251 offset:0
  v_mfma_f32_16x16x32_bf16 v[172:175], a[212:215], a[228:231], v[172:175]
  buffer_load_dwordx4 a[56:59], v137, s[36:39], s9 offen offset:2048 sc1
  ds_read_b64_tr_b16 a[202:203], v251 offset:4096
  v_mfma_f32_16x16x32_bf16 v[168:171], a[212:215], a[224:227], v[168:171]
  ds_read_b64_tr_b16 a[204:205], v251 offset:8192
  v_mfma_f32_16x16x32_bf16 v[168:171], a[208:211], a[216:219], v[168:171]
  s_waitcnt vmcnt(22) lgkmcnt(11)
  ds_read_b64_tr_b16 a[206:207], v251 offset:12288
  v_mfma_f32_16x16x32_bf16 v[32:35], a[176:179], a[0:3], v[32:35]
  ds_read_b64_tr_b16 a[208:209], v248 offset:2048
  v_mfma_f32_16x16x32_bf16 v[32:35], a[180:183], a[8:11], v[32:35]
  buffer_load_dwordx4 v136, s[24:27], s8 offen offset:3072 lds
  ds_read_b64_tr_b16 a[210:211], v248 offset:6144
  v_mfma_f32_16x16x32_bf16 v[36:39], a[180:183], a[12:15], v[36:39]
  ds_read_b64_tr_b16 a[212:213], v248 offset:10240
  v_mfma_f32_16x16x32_bf16 v[36:39], a[176:179], a[4:7], v[36:39]
  s_waitcnt lgkmcnt(11)
  ds_read_b64_tr_b16 a[214:215], v248 offset:14336
  v_mfma_f32_16x16x32_bf16 v[44:47], a[184:187], a[4:7], v[44:47]
  ds_read_b64_tr_b16 a[176:177], v249 offset:2048
  v_mfma_f32_16x16x32_bf16 v[44:47], a[188:191], a[12:15], v[44:47]
  buffer_load_dwordx4 a[60:63], v137, s[36:39], s9 offen offset:3072 sc1
  s_cmp_eq_u32 s52, 2
  v_mfma_f32_16x16x32_bf16 v[40:43], a[188:191], a[8:11], v[40:43]
  s_cselect_b32 s40, 22, 8
  s_lshl_b32 s8, s40, 16
  s_add_u32 m0, s73, 49152
  v_mfma_f32_16x16x32_bf16 v[40:43], a[184:187], a[0:3], v[40:43]
  s_waitcnt vmcnt(17) lgkmcnt(9)
  s_barrier
  ds_read_b64_tr_b16 a[178:179], v249 offset:6144
  v_mfma_f32_16x16x32_bf16 v[48:51], a[192:195], a[0:3], v[48:51]
  ds_read_b64_tr_b16 a[180:181], v249 offset:10240
  ds_read_b64_tr_b16 a[182:183], v249 offset:14336
  v_mfma_f32_16x16x32_bf16 v[48:51], a[196:199], a[8:11], v[48:51]
  buffer_load_dwordx4 v133, s[24:27], s8 offen offset:0 lds
  s_lshl_b32 s9, s40, 11
  v_mfma_f32_16x16x32_bf16 v[52:55], a[196:199], a[12:15], v[52:55]
  ds_read_b64_tr_b16 a[184:185], v250 offset:2048
  ds_read_b64_tr_b16 a[186:187], v250 offset:6144
  v_mfma_f32_16x16x32_bf16 v[52:55], a[192:195], a[4:7], v[52:55]
  s_waitcnt lgkmcnt(10)
  ds_read_b64_tr_b16 a[188:189], v250 offset:10240
  ds_read_b64_tr_b16 a[190:191], v250 offset:14336
  v_mfma_f32_16x16x32_bf16 v[60:63], a[200:203], a[4:7], v[60:63]
  buffer_load_dwordx4 a[64:67], v137, s[36:39], s9 offen offset:0 sc1
  ds_read_b64_tr_b16 a[192:193], v251 offset:2048
  v_mfma_f32_16x16x32_bf16 v[60:63], a[204:207], a[12:15], v[60:63]
  ds_read_b64_tr_b16 a[194:195], v251 offset:6144
  v_mfma_f32_16x16x32_bf16 v[56:59], a[204:207], a[8:11], v[56:59]
  ds_read_b64_tr_b16 a[196:197], v251 offset:10240
  v_mfma_f32_16x16x32_bf16 v[56:59], a[200:203], a[0:3], v[56:59]
  s_waitcnt lgkmcnt(11)
  ds_read_b64_tr_b16 a[198:199], v251 offset:14336
  v_mfma_f32_16x16x32_bf16 v[144:147], a[208:211], a[0:3], v[144:147]
  buffer_load_dwordx4 v134, s[24:27], s8 offen offset:1024 lds
  ds_read_b64_tr_b16 a[200:201], v240 offset:0
  v_mfma_f32_16x16x32_bf16 v[144:147], a[212:215], a[8:11], v[144:147]
  ds_read_b64_tr_b16 a[202:203], v240 offset:4096
  v_mfma_f32_16x16x32_bf16 v[148:151], a[212:215], a[12:15], v[148:151]
  ds_read_b64_tr_b16 a[204:205], v240 offset:8192
  v_mfma_f32_16x16x32_bf16 v[148:151], a[208:211], a[4:7], v[148:151]
  s_waitcnt lgkmcnt(11)
  ds_read_b64_tr_b16 a[206:207], v240 offset:12288
  v_mfma_f32_16x16x32_bf16 v[156:159], a[176:179], a[4:7], v[156:159]
  buffer_load_dwordx4 a[68:71], v137, s[36:39], s9 offen offset:1024 sc1
  ds_read_b64_tr_b16 a[208:209], v241 offset:0
  v_mfma_f32_16x16x32_bf16 v[156:159], a[180:183], a[12:15], v[156:159]
  ds_read_b64_tr_b16 a[210:211], v241 offset:4096
  v_mfma_f32_16x16x32_bf16 v[152:155], a[180:183], a[8:11], v[152:155]
  ds_read_b64_tr_b16 a[212:213], v241 offset:8192
  v_mfma_f32_16x16x32_bf16 v[152:155], a[176:179], a[0:3], v[152:155]
  s_waitcnt lgkmcnt(11)
  ds_read_b64_tr_b16 a[214:215], v241 offset:12288
  v_mfma_f32_16x16x32_bf16 v[160:163], a[184:187], a[0:3], v[160:163]
  buffer_load_dwordx4 v135, s[24:27], s8 offen offset:2048 lds
  ds_read_b64_tr_b16 a[176:177], v242 offset:0
  v_mfma_f32_16x16x32_bf16 v[160:163], a[188:191], a[8:11], v[160:163]
  ds_read_b64_tr_b16 a[178:179], v242 offset:4096
  v_mfma_f32_16x16x32_bf16 v[164:167], a[188:191], a[12:15], v[164:167]
  ds_read_b64_tr_b16 a[180:181], v242 offset:8192
  v_mfma_f32_16x16x32_bf16 v[164:167], a[184:187], a[4:7], v[164:167]
  s_waitcnt lgkmcnt(11)
  buffer_load_dwordx4 a[72:75], v137, s[36:39], s9 offen offset:2048 sc1
  ds_read_b64_tr_b16 a[182:183], v242 offset:12288
  v_mfma_f32_16x16x32_bf16 v[172:175], a[192:195], a[4:7], v[172:175]
  ds_read_b64_tr_b16 a[184:185], v243 offset:0
  v_mfma_f32_16x16x32_bf16 v[172:175], a[196:199], a[12:15], v[172:175]
  ds_read_b64_tr_b16 a[186:187], v243 offset:4096
  v_mfma_f32_16x16x32_bf16 v[168:171], a[196:199], a[8:11], v[168:171]
  ds_read_b64_tr_b16 a[188:189], v243 offset:8192
  v_mfma_f32_16x16x32_bf16 v[168:171], a[192:195], a[0:3], v[168:171]
  s_waitcnt vmcnt(22) lgkmcnt(11)
  buffer_load_dwordx4 v136, s[24:27], s8 offen offset:3072 lds
  ds_read_b64_tr_b16 a[190:191], v243 offset:12288
  v_mfma_f32_16x16x32_bf16 v[32:35], a[200:203], a[16:19], v[32:35]
  ds_read_b64_tr_b16 a[192:193], v240 offset:2048
  v_mfma_f32_16x16x32_bf16 v[32:35], a[204:207], a[24:27], v[32:35]
  ds_read_b64_tr_b16 a[194:195], v240 offset:6144
  v_mfma_f32_16x16x32_bf16 v[36:39], a[204:207], a[28:31], v[36:39]
  ds_read_b64_tr_b16 a[196:197], v240 offset:10240
  v_mfma_f32_16x16x32_bf16 v[36:39], a[200:203], a[20:23], v[36:39]
  s_waitcnt lgkmcnt(11)
  buffer_load_dwordx4 a[76:79], v137, s[36:39], s9 offen offset:3072 sc1
  s_cmp_eq_u32 s52, 3
  v_mfma_f32_16x16x32_bf16 v[44:47], a[208:211], a[20:23], v[44:47]
  s_cselect_b32 s41, 26, 12
  s_lshl_b32 s8, s41, 16
  s_add_u32 m0, s73, 65536
  v_mfma_f32_16x16x32_bf16 v[44:47], a[212:215], a[28:31], v[44:47]
  ds_read_b64_tr_b16 a[198:199], v240 offset:14336
  ds_read_b64_tr_b16 a[200:201], v241 offset:2048
  v_mfma_f32_16x16x32_bf16 v[40:43], a[212:215], a[24:27], v[40:43]
  ds_read_b64_tr_b16 a[202:203], v241 offset:6144
  ds_read_b64_tr_b16 a[204:205], v241 offset:10240
  v_mfma_f32_16x16x32_bf16 v[40:43], a[208:211], a[16:19], v[40:43]
  s_waitcnt vmcnt(17) lgkmcnt(11)
  s_barrier
  buffer_load_dwordx4 v133, s[24:27], s8 offen offset:0 lds
  v_mfma_f32_16x16x32_bf16 v[48:51], a[176:179], a[16:19], v[48:51]
  s_lshl_b32 s9, s41, 11
  ds_read_b64_tr_b16 a[206:207], v241 offset:14336
  ds_read_b64_tr_b16 a[208:209], v242 offset:2048
  v_mfma_f32_16x16x32_bf16 v[48:51], a[180:183], a[24:27], v[48:51]
  ds_read_b64_tr_b16 a[210:211], v242 offset:6144
  v_mfma_f32_16x16x32_bf16 v[52:55], a[180:183], a[28:31], v[52:55]
  ds_read_b64_tr_b16 a[212:213], v242 offset:10240
  v_mfma_f32_16x16x32_bf16 v[52:55], a[176:179], a[20:23], v[52:55]
  s_waitcnt lgkmcnt(11)
  buffer_load_dwordx4 a[80:83], v137, s[36:39], s9 offen offset:0 sc1
  ds_read_b64_tr_b16 a[214:215], v242 offset:14336
  v_mfma_f32_16x16x32_bf16 v[60:63], a[184:187], a[20:23], v[60:63]
  ds_read_b64_tr_b16 a[176:177], v243 offset:2048
  v_mfma_f32_16x16x32_bf16 v[60:63], a[188:191], a[28:31], v[60:63]
  ds_read_b64_tr_b16 a[178:179], v243 offset:6144
  v_mfma_f32_16x16x32_bf16 v[56:59], a[188:191], a[24:27], v[56:59]
  buffer_load_dwordx4 v134, s[24:27], s8 offen offset:1024 lds
  ds_read_b64_tr_b16 a[180:181], v243 offset:10240
  v_mfma_f32_16x16x32_bf16 v[56:59], a[184:187], a[16:19], v[56:59]
  s_waitcnt lgkmcnt(11)
  ds_read_b64_tr_b16 a[182:183], v243 offset:14336
  v_mfma_f32_16x16x32_bf16 v[144:147], a[192:195], a[16:19], v[144:147]
  ds_read_b64_tr_b16 a[184:185], v240 offset:16384
  v_mfma_f32_16x16x32_bf16 v[144:147], a[196:199], a[24:27], v[144:147]
  ds_read_b64_tr_b16 a[186:187], v240 offset:20480
  v_mfma_f32_16x16x32_bf16 v[148:151], a[196:199], a[28:31], v[148:151]
  buffer_load_dwordx4 a[84:87], v137, s[36:39], s9 offen offset:1024 sc1
  ds_read_b64_tr_b16 a[188:189], v240 offset:24576
  v_mfma_f32_16x16x32_bf16 v[148:151], a[192:195], a[20:23], v[148:151]
  s_waitcnt lgkmcnt(11)
  ds_read_b64_tr_b16 a[190:191], v240 offset:28672
  v_mfma_f32_16x16x32_bf16 v[156:159], a[200:203], a[20:23], v[156:159]
  ds_read_b64_tr_b16 a[192:193], v241 offset:16384
  v_mfma_f32_16x16x32_bf16 v[156:159], a[204:207], a[28:31], v[156:159]
  ds_read_b64_tr_b16 a[194:195], v241 offset:20480
  v_mfma_f32_16x16x32_bf16 v[152:155], a[204:207], a[24:27], v[152:155]
  buffer_load_dwordx4 v135, s[24:27], s8 offen offset:2048 lds
  ds_read_b64_tr_b16 a[196:197], v241 offset:24576
  v_mfma_f32_16x16x32_bf16 v[152:155], a[200:203], a[16:19], v[152:155]
  s_waitcnt lgkmcnt(11)
  ds_read_b64_tr_b16 a[198:199], v241 offset:28672
  v_mfma_f32_16x16x32_bf16 v[160:163], a[208:211], a[16:19], v[160:163]
  ds_read_b64_tr_b16 a[200:201], v242 offset:16384
  v_mfma_f32_16x16x32_bf16 v[160:163], a[212:215], a[24:27], v[160:163]
  ds_read_b64_tr_b16 a[202:203], v242 offset:20480
  v_mfma_f32_16x16x32_bf16 v[164:167], a[212:215], a[28:31], v[164:167]
  buffer_load_dwordx4 a[88:91], v137, s[36:39], s9 offen offset:2048 sc1
  ds_read_b64_tr_b16 a[204:205], v242 offset:24576
  v_mfma_f32_16x16x32_bf16 v[164:167], a[208:211], a[20:23], v[164:167]
  s_waitcnt lgkmcnt(11)
  ds_read_b64_tr_b16 a[206:207], v242 offset:28672
  v_mfma_f32_16x16x32_bf16 v[172:175], a[176:179], a[20:23], v[172:175]
  ds_read_b64_tr_b16 a[208:209], v243 offset:16384
  v_mfma_f32_16x16x32_bf16 v[172:175], a[180:183], a[28:31], v[172:175]
Hb0_3:
  s_cbranch_execz Rb
  ds_read_b64_tr_b16 a[210:211], v243 offset:20480
  v_mfma_f32_16x16x32_bf16 v[168:171], a[180:183], a[24:27], v[168:171]
  buffer_load_dwordx4 v136, s[24:27], s8 offen offset:3072 lds
  ds_read_b64_tr_b16 a[212:213], v243 offset:24576
  v_mfma_f32_16x16x32_bf16 v[168:171], a[176:179], a[16:19], v[168:171]
  s_waitcnt vmcnt(23) lgkmcnt(11)
  ds_read_b64_tr_b16 a[214:215], v243 offset:28672
  v_mfma_f32_16x16x32_bf16 v[32:35], a[184:187], a[32:35], v[32:35]
  ds_read_b64_tr_b16 a[176:177], v240 offset:18432
  v_mfma_f32_16x16x32_bf16 v[32:35], a[188:191], a[40:43], v[32:35]
  buffer_load_dwordx4 a[92:95], v137, s[36:39], s9 offen offset:3072 sc1
  s_cmp_eq_u32 s52, 0
  v_mfma_f32_16x16x32_bf16 v[36:39], a[188:191], a[44:47], v[36:39]
  s_cselect_b32 s42, 29, 15
  s_lshl_b32 s8, s42, 16
  s_add_u32 m0, s73, 81920
  v_mfma_f32_16x16x32_bf16 v[36:39], a[184:187], a[36:39], v[36:39]
  s_waitcnt lgkmcnt(9)
  ds_read_b64_tr_b16 a[178:179], v240 offset:22528
  ds_read_b64_tr_b16 a[180:181], v240 offset:26624
  v_mfma_f32_16x16x32_bf16 v[44:47], a[192:195], a[36:39], v[44:47]
  ds_read_b64_tr_b16 a[182:183], v240 offset:30720
  ds_read_b64_tr_b16 a[184:185], v241 offset:18432
  v_mfma_f32_16x16x32_bf16 v[44:47], a[196:199], a[44:47], v[44:47]
  buffer_load_dwordx4 v133, s[24:27], s8 offen offset:0 lds
  s_lshl_b32 s9, s42, 11
  v_mfma_f32_16x16x32_bf16 v[40:43], a[196:199], a[40:43], v[40:43]
  ds_read_b64_tr_b16 a[186:187], v241 offset:22528
  ds_read_b64_tr_b16 a[188:189], v241 offset:26624
  v_mfma_f32_16x16x32_bf16 v[40:43], a[192:195], a[32:35], v[40:43]
  s_waitcnt vmcnt(18) lgkmcnt(11)
  s_barrier
  ds_read_b64_tr_b16 a[190:191], v241 offset:30720
  v_mfma_f32_16x16x32_bf16 v[48:51], a[200:203], a[32:35], v[48:51]
  ds_read_b64_tr_b16 a[192:193], v242 offset:18432
  v_mfma_f32_16x16x32_bf16 v[48:51], a[204:207], a[40:43], v[48:51]
  buffer_load_dwordx4 a[96:99], v137, s[36:39], s9 offen offset:0 sc1
  ds_read_b64_tr_b16 a[194:195], v242 offset:22528
  v_mfma_f32_16x16x32_bf16 v[52:55], a[204:207], a[44:47], v[52:55]
  ds_read_b64_tr_b16 a[196:197], v242 offset:26624
  v_mfma_f32_16x16x32_bf16 v[52:55], a[200:203], a[36:39], v[52:55]
  s_waitcnt lgkmcnt(11)
  ds_read_b64_tr_b16 a[198:199], v242 offset:30720
  v_mfma_f32_16x16x32_bf16 v[60:63], a[208:211], a[36:39], v[60:63]
  ds_read_b64_tr_b16 a[200:201], v243 offset:18432
  v_mfma_f32_16x16x32_bf16 v[60:63], a[212:215], a[44:47], v[60:63]
  buffer_load_dwordx4 v134, s[24:27], s8 offen offset:1024 lds
  ds_read_b64_tr_b16 a[202:203], v243 offset:22528
  v_mfma_f32_16x16x32_bf16 v[56:59], a[212:215], a[40:43], v[56:59]
  ds_read_b64_tr_b16 a[204:205], v243 offset:26624
  v_mfma_f32_16x16x32_bf16 v[56:59], a[208:211], a[32:35], v[56:59]
  s_waitcnt lgkmcnt(11)
  ds_read_b64_tr_b16 a[206:207], v243 offset:30720
  v_mfma_f32_16x16x32_bf16 v[144:147], a[176:179], a[32:35], v[144:147]
  ds_read_b64_tr_b16 a[208:209], v240 offset:32768
  v_mfma_f32_16x16x32_bf16 v[144:147], a[180:183], a[40:43], v[144:147]
  buffer_load_dwordx4 a[100:103], v137, s[36:39], s9 offen offset:1024 sc1
  ds_read_b64_tr_b16 a[210:211], v240 offset:36864
  v_mfma_f32_16x16x32_bf16 v[148:151], a[180:183], a[44:47], v[148:151]
  ds_read_b64_tr_b16 a[212:213], v240 offset:40960
  v_mfma_f32_16x16x32_bf16 v[148:151], a[176:179], a[36:39], v[148:151]
  s_waitcnt lgkmcnt(11)
  ds_read_b64_tr_b16 a[214:215], v240 offset:45056
  v_mfma_f32_16x16x32_bf16 v[156:159], a[184:187], a[36:39], v[156:159]
  buffer_load_dwordx4 v135, s[24:27], s8 offen offset:2048 lds
  ds_read_b64_tr_b16 a[176:177], v241 offset:32768
  v_mfma_f32_16x16x32_bf16 v[156:159], a[188:191], a[44:47], v[156:159]
  ds_read_b64_tr_b16 a[178:179], v241 offset:36864
  v_mfma_f32_16x16x32_bf16 v[152:155], a[188:191], a[40:43], v[152:155]
  ds_read_b64_tr_b16 a[180:181], v241 offset:40960
  v_mfma_f32_16x16x32_bf16 v[152:155], a[184:187], a[32:35], v[152:155]
  s_waitcnt lgkmcnt(11)
  ds_read_b64_tr_b16 a[182:183], v241 offset:45056
  v_mfma_f32_16x16x32_bf16 v[160:163], a[192:195], a[32:35], v[160:163]
  buffer_load_dwordx4 a[104:107], v137, s[36:39], s9 offen offset:2048 sc1
  ds_read_b64_tr_b16 a[184:185], v242 offset:32768
  v_mfma_f32_16x16x32_bf16 v[160:163], a[196:199], a[40:43], v[160:163]
  ds_read_b64_tr_b16 a[186:187], v242 offset:36864
  v_mfma_f32_16x16x32_bf16 v[164:167], a[196:199], a[44:47], v[164:167]
  ds_read_b64_tr_b16 a[188:189], v242 offset:40960
  v_mfma_f32_16x16x32_bf16 v[164:167], a[192:195], a[36:39], v[164:167]
  s_waitcnt lgkmcnt(11)
  ds_read_b64_tr_b16 a[190:191], v242 offset:45056
  v_mfma_f32_16x16x32_bf16 v[172:175], a[200:203], a[36:39], v[172:175]
  buffer_load_dwordx4 v136, s[24:27], s8 offen offset:3072 lds
  ds_read_b64_tr_b16 a[192:193], v243 offset:32768
  v_mfma_f32_16x16x32_bf16 v[172:175], a[204:207], a[44:47], v[172:175]
  ds_read_b64_tr_b16 a[194:195], v243 offset:36864
  v_mfma_f32_16x16x32_bf16 v[168:171], a[204:207], a[40:43], v[168:171]
  ds_read_b64_tr_b16 a[196:197], v243 offset:40960
  v_mfma_f32_16x16x32_bf16 v[168:171], a[200:203], a[32:35], v[168:171]
  s_waitcnt vmcnt(23) lgkmcnt(11)
  ds_read_b64_tr_b16 a[198:199], v243 offset:45056
  v_mfma_f32_16x16x32_bf16 v[32:35], a[208:211], a[48:51], v[32:35]
  buffer_load_dwordx4 a[108:111], v137, s[36:39], s9 offen offset:3072 sc1
  s_cmp_eq_u32 s52, 1
  v_mfma_f32_16x16x32_bf16 v[32:35], a[212:215], a[56:59], v[32:35]
  s_cselect_b32 s43, 33, 19
  s_lshl_b32 s8, s43, 16
  s_add_u32 m0, s73, 98304
  v_mfma_f32_16x16x32_bf16 v[36:39], a[212:215], a[60:63], v[36:39]
  ds_read_b64_tr_b16 a[200:201], v240 offset:34816
  ds_read_b64_tr_b16 a[202:203], v240 offset:38912
  v_mfma_f32_16x16x32_bf16 v[36:39], a[208:211], a[52:55], v[36:39]
  s_waitcnt lgkmcnt(10)
  ds_read_b64_tr_b16 a[204:205], v240 offset:43008
  ds_read_b64_tr_b16 a[206:207], v240 offset:47104
  v_mfma_f32_16x16x32_bf16 v[44:47], a[176:179], a[52:55], v[44:47]
  buffer_load_dwordx4 v133, s[24:27], s8 offen offset:0 lds
  s_lshl_b32 s9, s43, 11
  v_mfma_f32_16x16x32_bf16 v[44:47], a[180:183], a[60:63], v[44:47]
  ds_read_b64_tr_b16 a[208:209], v241 offset:34816
  ds_read_b64_tr_b16 a[210:211], v241 offset:38912
  v_mfma_f32_16x16x32_bf16 v[40:43], a[180:183], a[56:59], v[40:43]
  ds_read_b64_tr_b16 a[212:213], v241 offset:43008
  v_mfma_f32_16x16x32_bf16 v[40:43], a[176:179], a[48:51], v[40:43]
  s_waitcnt vmcnt(18) lgkmcnt(11)
  s_barrier
  ds_read_b64_tr_b16 a[214:215], v241 offset:47104
  v_mfma_f32_16x16x32_bf16 v[48:51], a[184:187], a[48:51], v[48:51]
  buffer_load_dwordx4 a[112:115], v137, s[36:39], s9 offen offset:0 sc1
  ds_read_b64_tr_b16 a[176:177], v242 offset:34816
  v_mfma_f32_16x16x32_bf16 v[48:51], a[188:191], a[56:59], v[48:51]
  ds_read_b64_tr_b16 a[178:179], v242 offset:38912
  v_mfma_f32_16x16x32_bf16 v[52:55], a[188:191], a[60:63], v[52:55]
  ds_read_b64_tr_b16 a[180:181], v242 offset:43008
  v_mfma_f32_16x16x32_bf16 v[52:55], a[184:187], a[52:55], v[52:55]
  s_waitcnt lgkmcnt(11)
  buffer_load_dwordx4 v134, s[24:27], s8 offen offset:1024 lds
  ds_read_b64_tr_b16 a[182:183], v242 offset:47104
  v_mfma_f32_16x16x32_bf16 v[60:63], a[192:195], a[52:55], v[60:63]
  ds_read_b64_tr_b16 a[184:185], v243 offset:34816
  v_mfma_f32_16x16x32_bf16 v[60:63], a[196:199], a[60:63], v[60:63]
  ds_read_b64_tr_b16 a[186:187], v243 offset:38912
  v_mfma_f32_16x16x32_bf16 v[56:59], a[196:199], a[56:59], v[56:59]
  ds_read_b64_tr_b16 a[188:189], v243 offset:43008
  v_mfma_f32_16x16x32_bf16 v[56:59], a[192:195], a[48:51], v[56:59]
  s_waitcnt lgkmcnt(11)
  buffer_load_dwordx4 a[116:119], v137, s[36:39], s9 offen offset:1024 sc1
  ds_read_b64_tr_b16 a[190:191], v243 offset:47104
  v_mfma_f32_16x16x32_bf16 v[144:147], a[200:203], a[48:51], v[144:147]
  ds_read_b64_tr_b16 a[192:193], v240 offset:49152
  v_mfma_f32_16x16x32_bf16 v[144:147], a[204:207], a[56:59], v[144:147]
  ds_read_b64_tr_b16 a[194:195], v240 offset:53248
  v_mfma_f32_16x16x32_bf16 v[148:151], a[204:207], a[60:63], v[148:151]
  ds_read_b64_tr_b16 a[196:197], v240 offset:57344
  v_mfma_f32_16x16x32_bf16 v[148:151], a[200:203], a[52:55], v[148:151]
  s_waitcnt lgkmcnt(11)
  buffer_load_dwordx4 v135, s[24:27], s8 offen offset:2048 lds
  ds_read_b64_tr_b16 a[198:199], v240 offset:61440
  v_mfma_f32_16x16x32_bf16 v[156:159], a[208:211], a[52:55], v[156:159]
  ds_read_b64_tr_b16 a[200:201], v241 offset:49152
  v_mfma_f32_16x16x32_bf16 v[156:159], a[212:215], a[60:63], v[156:159]
  ds_read_b64_tr_b16 a[202:203], v241 offset:53248
  v_mfma_f32_16x16x32_bf16 v[152:155], a[212:215], a[56:59], v[152:155]
  ds_read_b64_tr_b16 a[204:205], v241 offset:57344
  v_mfma_f32_16x16x32_bf16 v[152:155], a[208:211], a[48:51], v[152:155]
  s_waitcnt lgkmcnt(11)
  buffer_load_dwordx4 a[120:123], v137, s[36:39], s9 offen offset:2048 sc1
  ds_read_b64_tr_b16 a[206:207], v241 offset:61440
  v_mfma_f32_16x16x32_bf16 v[160:163], a[176:179], a[48:51], v[160:163]
  ds_read_b64_tr_b16 a[208:209], v242 offset:49152
  v_mfma_f32_16x16x32_bf16 v[160:163], a[180:183], a[56:59], v[160:163]
  ds_read_b64_tr_b16 a[210:211], v242 offset:53248
  v_mfma_f32_16x16x32_bf16 v[164:167], a[180:183], a[60:63], v[164:167]
  ds_read_b64_tr_b16 a[212:213], v242 offset:57344
  v_mfma_f32_16x16x32_bf16 v[164:167], a[176:179], a[52:55], v[164:167]
  s_waitcnt lgkmcnt(11)
  buffer_load_dwordx4 v136, s[24:27], s8 offen offset:3072 lds
  ds_read_b64_tr_b16 a[214:215], v242 offset:61440
  v_mfma_f32_16x16x32_bf16 v[172:175], a[184:187], a[52:55], v[172:175]
  ds_read_b64_tr_b16 a[176:177], v243 offset:49152
  v_mfma_f32_16x16x32_bf16 v[172:175], a[188:191], a[60:63], v[172:175]
  ds_read_b64_tr_b16 a[178:179], v243 offset:53248
  v_mfma_f32_16x16x32_bf16 v[168:171], a[188:191], a[56:59], v[168:171]
  buffer_load_dwordx4 a[124:127], v137, s[36:39], s9 offen offset:3072 sc1
  s_cmp_eq_u32 s52, 2
  v_mfma_f32_16x16x32_bf16 v[168:171], a[184:187], a[48:51], v[168:171]
  s_waitcnt vmcnt(24) lgkmcnt(10)
  s_cselect_b32 s50, 36, 22
  s_lshl_b32 s8, s50, 16
  v_mfma_f32_16x16x32_bf16 v[32:35], a[192:195], a[64:67], v[32:35]
  s_add_u32 m0, s73, 114688
  ds_read_b64_tr_b16 a[180:181], v243 offset:57344
  ds_read_b64_tr_b16 a[182:183], v243 offset:61440
  v_mfma_f32_16x16x32_bf16 v[32:35], a[196:199], a[72:75], v[32:35]
  ds_read_b64_tr_b16 a[184:185], v240 offset:51200
  ds_read_b64_tr_b16 a[186:187], v240 offset:55296
  v_mfma_f32_16x16x32_bf16 v[36:39], a[196:199], a[76:79], v[36:39]
  buffer_load_dwordx4 v133, s[24:27], s8 offen offset:0 lds
  s_lshl_b32 s9, s50, 11
  v_mfma_f32_16x16x32_bf16 v[36:39], a[192:195], a[68:71], v[36:39]
  s_waitcnt lgkmcnt(10)
  ds_read_b64_tr_b16 a[188:189], v240 offset:59392
  ds_read_b64_tr_b16 a[190:191], v240 offset:63488
  v_mfma_f32_16x16x32_bf16 v[44:47], a[200:203], a[68:71], v[44:47]
  ds_read_b64_tr_b16 a[192:193], v241 offset:51200
  v_mfma_f32_16x16x32_bf16 v[44:47], a[204:207], a[76:79], v[44:47]
  ds_read_b64_tr_b16 a[194:195], v241 offset:55296
  v_mfma_f32_16x16x32_bf16 v[40:43], a[204:207], a[72:75], v[40:43]
  buffer_load_dwordx4 a[216:219], v137, s[36:39], s9 offen offset:0 sc1
  ds_read_b64_tr_b16 a[196:197], v241 offset:59392
  v_mfma_f32_16x16x32_bf16 v[40:43], a[200:203], a[64:67], v[40:43]
  s_waitcnt vmcnt(19) lgkmcnt(11)
  s_barrier
  ds_read_b64_tr_b16 a[198:199], v241 offset:63488
  v_mfma_f32_16x16x32_bf16 v[48:51], a[208:211], a[64:67], v[48:51]
  ds_read_b64_tr_b16 a[200:201], v242 offset:51200
  v_mfma_f32_16x16x32_bf16 v[48:51], a[212:215], a[72:75], v[48:51]
  ds_read_b64_tr_b16 a[202:203], v242 offset:55296
  v_mfma_f32_16x16x32_bf16 v[52:55], a[212:215], a[76:79], v[52:55]
  buffer_load_dwordx4 v134, s[24:27], s8 offen offset:1024 lds
  ds_read_b64_tr_b16 a[204:205], v242 offset:59392
  v_mfma_f32_16x16x32_bf16 v[52:55], a[208:211], a[68:71], v[52:55]
  s_waitcnt lgkmcnt(11)
  ds_read_b64_tr_b16 a[206:207], v242 offset:63488
  v_mfma_f32_16x16x32_bf16 v[60:63], a[176:179], a[68:71], v[60:63]
  ds_read_b64_tr_b16 a[208:209], v243 offset:51200
  v_mfma_f32_16x16x32_bf16 v[60:63], a[180:183], a[76:79], v[60:63]
  ds_read_b64_tr_b16 a[210:211], v243 offset:55296
  v_mfma_f32_16x16x32_bf16 v[56:59], a[180:183], a[72:75], v[56:59]
  buffer_load_dwordx4 a[220:223], v137, s[36:39], s9 offen offset:1024 sc1
  ds_read_b64_tr_b16 a[212:213], v243 offset:59392
  v_mfma_f32_16x16x32_bf16 v[56:59], a[176:179], a[64:67], v[56:59]
  s_waitcnt lgkmcnt(11)
  ds_read_b64_tr_b16 a[214:215], v243 offset:63488
  v_mfma_f32_16x16x32_bf16 v[144:147], a[184:187], a[64:67], v[144:147]
  ds_read_b64_tr_b16 a[176:177], v244 offset:0
  v_mfma_f32_16x16x32_bf16 v[144:147], a[188:191], a[72:75], v[144:147]
  buffer_load_dwordx4 v135, s[24:27], s8 offen offset:2048 lds
  ds_read_b64_tr_b16 a[178:179], v244 offset:4096
  v_mfma_f32_16x16x32_bf16 v[148:151], a[188:191], a[76:79], v[148:151]
  ds_read_b64_tr_b16 a[180:181], v244 offset:8192
  v_mfma_f32_16x16x32_bf16 v[148:151], a[184:187], a[68:71], v[148:151]
  s_waitcnt lgkmcnt(11)
  ds_read_b64_tr_b16 a[182:183], v244 offset:12288
  v_mfma_f32_16x16x32_bf16 v[156:159], a[192:195], a[68:71], v[156:159]
  ds_read_b64_tr_b16 a[184:185], v245 offset:0
  v_mfma_f32_16x16x32_bf16 v[156:159], a[196:199], a[76:79], v[156:159]
  buffer_load_dwordx4 a[224:227], v137, s[36:39], s9 offen offset:2048 sc1
  ds_read_b64_tr_b16 a[186:187], v245 offset:4096
  v_mfma_f32_16x16x32_bf16 v[152:155], a[196:199], a[72:75], v[152:155]
  ds_read_b64_tr_b16 a[188:189], v245 offset:8192
  v_mfma_f32_16x16x32_bf16 v[152:155], a[192:195], a[64:67], v[152:155]
  s_waitcnt lgkmcnt(11)
  ds_read_b64_tr_b16 a[190:191], v245 offset:12288
  v_mfma_f32_16x16x32_bf16 v[160:163], a[200:203], a[64:67], v[160:163]
  ds_read_b64_tr_b16 a[192:193], v246 offset:0
  v_mfma_f32_16x16x32_bf16 v[160:163], a[204:207], a[72:75], v[160:163]
  buffer_load_dwordx4 v136, s[24:27], s8 offen offset:3072 lds
  ds_read_b64_tr_b16 a[194:195], v246 offset:4096
  v_mfma_f32_16x16x32_bf16 v[164:167], a[204:207], a[76:79], v[164:167]
  ds_read_b64_tr_b16 a[196:197], v246 offset:8192
  v_mfma_f32_16x16x32_bf16 v[164:167], a[200:203], a[68:71], v[164:167]
  s_waitcnt lgkmcnt(11)
  ds_read_b64_tr_b16 a[198:199], v246 offset:12288
  v_mfma_f32_16x16x32_bf16 v[172:175], a[208:211], a[68:71], v[172:175]
  ds_read_b64_tr_b16 a[200:201], v247 offset:0
  v_mfma_f32_16x16x32_bf16 v[172:175], a[212:215], a[76:79], v[172:175]
  buffer_load_dwordx4 a[228:231], v137, s[36:39], s9 offen offset:3072 sc1
  s_cmp_eq_u32 s52, 3
  v_mfma_f32_16x16x32_bf16 v[168:171], a[212:215], a[72:75], v[168:171]
  s_cselect_b32 s51, 40, 26
  s_lshl_b32 s8, s51, 16
  s_add_u32 m0, s73, 131072
  v_mfma_f32_16x16x32_bf16 v[168:171], a[208:211], a[64:67], v[168:171]
  s_waitcnt vmcnt(24) lgkmcnt(9)
  ds_read_b64_tr_b16 a[202:203], v247 offset:4096
  ds_read_b64_tr_b16 a[204:205], v247 offset:8192
  v_mfma_f32_16x16x32_bf16 v[32:35], a[176:179], a[80:83], v[32:35]
  ds_read_b64_tr_b16 a[206:207], v247 offset:12288
  ds_read_b64_tr_b16 a[208:209], v244 offset:2048
  v_mfma_f32_16x16x32_bf16 v[32:35], a[180:183], a[88:91], v[32:35]
  buffer_load_dwordx4 v133, s[24:27], s8 offen offset:0 lds
  s_lshl_b32 s9, s51, 11
  v_mfma_f32_16x16x32_bf16 v[36:39], a[180:183], a[92:95], v[36:39]
  ds_read_b64_tr_b16 a[210:211], v244 offset:6144
  ds_read_b64_tr_b16 a[212:213], v244 offset:10240
  v_mfma_f32_16x16x32_bf16 v[36:39], a[176:179], a[84:87], v[36:39]
  s_waitcnt lgkmcnt(11)
  ds_read_b64_tr_b16 a[214:215], v244 offset:14336
  v_mfma_f32_16x16x32_bf16 v[44:47], a[184:187], a[84:87], v[44:47]
  buffer_load_dwordx4 a[0:3], v137, s[36:39], s9 offen offset:0 sc1
  ds_read_b64_tr_b16 a[176:177], v245 offset:2048
  v_mfma_f32_16x16x32_bf16 v[44:47], a[188:191], a[92:95], v[44:47]
  ds_read_b64_tr_b16 a[178:179], v245 offset:6144
  v_mfma_f32_16x16x32_bf16 v[40:43], a[188:191], a[88:91], v[40:43]
  ds_read_b64_tr_b16 a[180:181], v245 offset:10240
  v_mfma_f32_16x16x32_bf16 v[40:43], a[184:187], a[80:83], v[40:43]
  s_waitcnt vmcnt(19) lgkmcnt(11)
  s_barrier
  ds_read_b64_tr_b16 a[182:183], v245 offset:14336
  v_mfma_f32_16x16x32_bf16 v[48:51], a[192:195], a[80:83], v[48:51]
  buffer_load_dwordx4 v134, s[24:27], s8 offen offset:1024 lds
  ds_read_b64_tr_b16 a[184:185], v246 offset:2048
  v_mfma_f32_16x16x32_bf16 v[48:51], a[196:199], a[88:91], v[48:51]
  ds_read_b64_tr_b16 a[186:187], v246 offset:6144
  v_mfma_f32_16x16x32_bf16 v[52:55], a[196:199], a[92:95], v[52:55]
  ds_read_b64_tr_b16 a[188:189], v246 offset:10240
  v_mfma_f32_16x16x32_bf16 v[52:55], a[192:195], a[84:87], v[52:55]
  s_waitcnt lgkmcnt(11)
  ds_read_b64_tr_b16 a[190:191], v246 offset:14336
  v_mfma_f32_16x16x32_bf16 v[60:63], a[200:203], a[84:87], v[60:63]
  buffer_load_dwordx4 a[4:7], v137, s[36:39], s9 offen offset:1024 sc1
  ds_read_b64_tr_b16 a[192:193], v247 offset:2048
  v_mfma_f32_16x16x32_bf16 v[60:63], a[204:207], a[92:95], v[60:63]
  ds_read_b64_tr_b16 a[194:195], v247 offset:6144
  v_mfma_f32_16x16x32_bf16 v[56:59], a[204:207], a[88:91], v[56:59]
  ds_read_b64_tr_b16 a[196:197], v247 offset:10240
  v_mfma_f32_16x16x32_bf16 v[56:59], a[200:203], a[80:83], v[56:59]
  s_waitcnt lgkmcnt(11)
  ds_read_b64_tr_b16 a[198:199], v247 offset:14336
  v_mfma_f32_16x16x32_bf16 v[144:147], a[208:211], a[80:83], v[144:147]
  buffer_load_dwordx4 v135, s[24:27], s8 offen offset:2048 lds
  ds_read_b64_tr_b16 a[200:201], v244 offset:16384
  v_mfma_f32_16x16x32_bf16 v[144:147], a[212:215], a[88:91], v[144:147]
  ds_read_b64_tr_b16 a[202:203], v244 offset:20480
  v_mfma_f32_16x16x32_bf16 v[148:151], a[212:215], a[92:95], v[148:151]
  ds_read_b64_tr_b16 a[204:205], v244 offset:24576
  v_mfma_f32_16x16x32_bf16 v[148:151], a[208:211], a[84:87], v[148:151]
  s_waitcnt lgkmcnt(11)
  ds_read_b64_tr_b16 a[206:207], v244 offset:28672
  v_mfma_f32_16x16x32_bf16 v[156:159], a[176:179], a[84:87], v[156:159]
  buffer_load_dwordx4 a[8:11], v137, s[36:39], s9 offen offset:2048 sc1
  ds_read_b64_tr_b16 a[208:209], v245 offset:16384
  v_mfma_f32_16x16x32_bf16 v[156:159], a[180:183], a[92:95], v[156:159]
  ds_read_b64_tr_b16 a[210:211], v245 offset:20480
  v_mfma_f32_16x16x32_bf16 v[152:155], a[180:183], a[88:91], v[152:155]
  ds_read_b64_tr_b16 a[212:213], v245 offset:24576
  v_mfma_f32_16x16x32_bf16 v[152:155], a[176:179], a[80:83], v[152:155]
  s_waitcnt lgkmcnt(11)
  buffer_load_dwordx4 v136, s[24:27], s8 offen offset:3072 lds
  ds_read_b64_tr_b16 a[214:215], v245 offset:28672
  v_mfma_f32_16x16x32_bf16 v[160:163], a[184:187], a[80:83], v[160:163]
  ds_read_b64_tr_b16 a[176:177], v246 offset:16384
  v_mfma_f32_16x16x32_bf16 v[160:163], a[188:191], a[88:91], v[160:163]
  ds_read_b64_tr_b16 a[178:179], v246 offset:20480
  v_mfma_f32_16x16x32_bf16 v[164:167], a[188:191], a[92:95], v[164:167]
  ds_read_b64_tr_b16 a[180:181], v246 offset:24576
  v_mfma_f32_16x16x32_bf16 v[164:167], a[184:187], a[84:87], v[164:167]
  s_waitcnt lgkmcnt(11)
  buffer_load_dwordx4 a[12:15], v137, s[36:39], s9 offen offset:3072 sc1
  s_cmp_eq_u32 s52, 0
  v_mfma_f32_16x16x32_bf16 v[172:175], a[192:195], a[84:87], v[172:175]
  s_cselect_b32 s12, 43, 29
  s_lshl_b32 s8, s12, 16
  s_add_u32 m0, s73, 0
  v_mfma_f32_16x16x32_bf16 v[172:175], a[196:199], a[92:95], v[172:175]
  ds_read_b64_tr_b16 a[182:183], v246 offset:28672
  ds_read_b64_tr_b16 a[184:185], v247 offset:16384
  v_mfma_f32_16x16x32_bf16 v[168:171], a[196:199], a[88:91], v[168:171]
  ds_read_b64_tr_b16 a[186:187], v247 offset:20480
  ds_read_b64_tr_b16 a[188:189], v247 offset:24576
  v_mfma_f32_16x16x32_bf16 v[168:171], a[192:195], a[80:83], v[168:171]
  s_waitcnt vmcnt(24) lgkmcnt(11)
  buffer_load_dwordx4 v133, s[24:27], s8 offen offset:0 lds
  s_lshl_b32 s9, s12, 11
  v_mfma_f32_16x16x32_bf16 v[32:35], a[200:203], a[96:99], v[32:35]
  ds_read_b64_tr_b16 a[190:191], v247 offset:28672
  ds_read_b64_tr_b16 a[192:193], v244 offset:18432
  v_mfma_f32_16x16x32_bf16 v[32:35], a[204:207], a[104:107], v[32:35]
  ds_read_b64_tr_b16 a[194:195], v244 offset:22528
  v_mfma_f32_16x16x32_bf16 v[36:39], a[204:207], a[108:111], v[36:39]
  ds_read_b64_tr_b16 a[196:197], v244 offset:26624
  v_mfma_f32_16x16x32_bf16 v[36:39], a[200:203], a[100:103], v[36:39]
  s_waitcnt lgkmcnt(11)
  buffer_load_dwordx4 a[16:19], v137, s[36:39], s9 offen offset:0 sc1
  ds_read_b64_tr_b16 a[198:199], v244 offset:30720
  v_mfma_f32_16x16x32_bf16 v[44:47], a[208:211], a[100:103], v[44:47]
  ds_read_b64_tr_b16 a[200:201], v245 offset:18432
  v_mfma_f32_16x16x32_bf16 v[44:47], a[212:215], a[108:111], v[44:47]
  ds_read_b64_tr_b16 a[202:203], v245 offset:22528
  v_mfma_f32_16x16x32_bf16 v[40:43], a[212:215], a[104:107], v[40:43]
  ds_read_b64_tr_b16 a[204:205], v245 offset:26624
  v_mfma_f32_16x16x32_bf16 v[40:43], a[208:211], a[96:99], v[40:43]
  s_waitcnt vmcnt(19) lgkmcnt(11)
  s_barrier
  buffer_load_dwordx4 v134, s[24:27], s8 offen offset:1024 lds
  v_mfma_f32_16x16x32_bf16 v[48:51], a[176:179], a[96:99], v[48:51]
  ds_read_b64_tr_b16 a[206:207], v245 offset:30720
  ds_read_b64_tr_b16 a[208:209], v246 offset:18432
  v_mfma_f32_16x16x32_bf16 v[48:51], a[180:183], a[104:107], v[48:51]
  ds_read_b64_tr_b16 a[210:211], v246 offset:22528
  v_mfma_f32_16x16x32_bf16 v[52:55], a[180:183], a[108:111], v[52:55]
  buffer_load_dwordx4 a[20:23], v137, s[36:39], s9 offen offset:1024 sc1
  ds_read_b64_tr_b16 a[212:213], v246 offset:26624
  v_mfma_f32_16x16x32_bf16 v[52:55], a[176:179], a[100:103], v[52:55]
  s_waitcnt lgkmcnt(11)
  ds_read_b64_tr_b16 a[214:215], v246 offset:30720
  v_mfma_f32_16x16x32_bf16 v[60:63], a[184:187], a[100:103], v[60:63]
  ds_read_b64_tr_b16 a[176:177], v247 offset:18432
  v_mfma_f32_16x16x32_bf16 v[60:63], a[188:191], a[108:111], v[60:63]
  ds_read_b64_tr_b16 a[178:179], v247 offset:22528
  v_mfma_f32_16x16x32_bf16 v[56:59], a[188:191], a[104:107], v[56:59]
  buffer_load_dwordx4 v135, s[24:27], s8 offen offset:2048 lds
  ds_read_b64_tr_b16 a[180:181], v247 offset:26624
  v_mfma_f32_16x16x32_bf16 v[56:59], a[184:187], a[96:99], v[56:59]
  s_waitcnt lgkmcnt(11)
  ds_read_b64_tr_b16 a[182:183], v247 offset:30720
  v_mfma_f32_16x16x32_bf16 v[144:147], a[192:195], a[96:99], v[144:147]
  ds_read_b64_tr_b16 a[184:185], v244 offset:32768
  v_mfma_f32_16x16x32_bf16 v[144:147], a[196:199], a[104:107], v[144:147]
  ds_read_b64_tr_b16 a[186:187], v244 offset:36864
  v_mfma_f32_16x16x32_bf16 v[148:151], a[196:199], a[108:111], v[148:151]
  buffer_load_dwordx4 a[24:27], v137, s[36:39], s9 offen offset:2048 sc1
  ds_read_b64_tr_b16 a[188:189], v244 offset:40960
  v_mfma_f32_16x16x32_bf16 v[148:151], a[192:195], a[100:103], v[148:151]
  s_waitcnt lgkmcnt(11)
  ds_read_b64_tr_b16 a[190:191], v244 offset:45056
  v_mfma_f32_16x16x32_bf16 v[156:159], a[200:203], a[100:103], v[156:159]
  ds_read_b64_tr_b16 a[192:193], v245 offset:32768
  v_mfma_f32_16x16x32_bf16 v[156:159], a[204:207], a[108:111], v[156:159]
  ds_read_b64_tr_b16 a[194:195], v245 offset:36864
  v_mfma_f32_16x16x32_bf16 v[152:155], a[204:207], a[104:107], v[152:155]
  buffer_load_dwordx4 v136, s[24:27], s8 offen offset:3072 lds
  ds_read_b64_tr_b16 a[196:197], v245 offset:40960
  v_mfma_f32_16x16x32_bf16 v[152:155], a[200:203], a[96:99], v[152:155]
  s_waitcnt lgkmcnt(11)
  ds_read_b64_tr_b16 a[198:199], v245 offset:45056
  v_mfma_f32_16x16x32_bf16 v[160:163], a[208:211], a[96:99], v[160:163]
  ds_read_b64_tr_b16 a[200:201], v246 offset:32768
  v_mfma_f32_16x16x32_bf16 v[160:163], a[212:215], a[104:107], v[160:163]
  ds_read_b64_tr_b16 a[202:203], v246 offset:36864
  v_mfma_f32_16x16x32_bf16 v[164:167], a[212:215], a[108:111], v[164:167]
  buffer_load_dwordx4 a[28:31], v137, s[36:39], s9 offen offset:3072 sc1
  s_cmp_eq_u32 s52, 1
  v_mfma_f32_16x16x32_bf16 v[164:167], a[208:211], a[100:103], v[164:167]
  s_waitcnt lgkmcnt(10)
  s_cselect_b32 s13, 47, 33
  s_lshl_b32 s9, s13, 11
  v_mfma_f32_16x16x32_bf16 v[172:175], a[176:179], a[100:103], v[172:175]
  ds_read_b64_tr_b16 a[204:205], v246 offset:40960
  ds_read_b64_tr_b16 a[206:207], v246 offset:45056
  v_mfma_f32_16x16x32_bf16 v[172:175], a[180:183], a[108:111], v[172:175]
  ds_read_b64_tr_b16 a[208:209], v247 offset:32768
  buffer_load_dwordx4 a[32:35], v137, s[36:39], s9 offen offset:0 sc1
  v_mfma_f32_16x16x32_bf16 v[168:171], a[180:183], a[104:107], v[168:171]
  ds_read_b64_tr_b16 a[210:211], v247 offset:36864
  ds_read_b64_tr_b16 a[212:213], v247 offset:40960
  v_mfma_f32_16x16x32_bf16 v[168:171], a[176:179], a[96:99], v[168:171]
  s_waitcnt vmcnt(25) lgkmcnt(11)
  ds_read_b64_tr_b16 a[214:215], v247 offset:45056
  v_mfma_f32_16x16x32_bf16 v[32:35], a[184:187], a[112:115], v[32:35]
  ds_read_b64_tr_b16 a[176:177], v244 offset:34816
  v_mfma_f32_16x16x32_bf16 v[32:35], a[188:191], a[120:123], v[32:35]
  buffer_load_dwordx4 a[36:39], v137, s[36:39], s9 offen offset:1024 sc1
  s_lshl_b32 s8, s13, 16
  v_mfma_f32_16x16x32_bf16 v[36:39], a[188:191], a[124:127], v[36:39]
  s_add_u32 m0, s73, 16384
  ds_read_b64_tr_b16 a[178:179], v244 offset:38912
  ds_read_b64_tr_b16 a[180:181], v244 offset:43008
  v_mfma_f32_16x16x32_bf16 v[36:39], a[184:187], a[116:119], v[36:39]
  s_waitcnt lgkmcnt(11)
  ds_read_b64_tr_b16 a[182:183], v244 offset:47104
  v_mfma_f32_16x16x32_bf16 v[44:47], a[192:195], a[116:119], v[44:47]
  ds_read_b64_tr_b16 a[184:185], v245 offset:34816
  v_mfma_f32_16x16x32_bf16 v[44:47], a[196:199], a[124:127], v[44:47]
  buffer_load_dwordx4 v135, s[24:27], s8 offen offset:2048 lds
  ds_read_b64_tr_b16 a[186:187], v245 offset:38912
  v_mfma_f32_16x16x32_bf16 v[40:43], a[196:199], a[120:123], v[40:43]
  ds_read_b64_tr_b16 a[188:189], v245 offset:43008
  v_mfma_f32_16x16x32_bf16 v[40:43], a[192:195], a[112:115], v[40:43]
  s_waitcnt vmcnt(20) lgkmcnt(11)
  s_barrier
  ds_read_b64_tr_b16 a[190:191], v245 offset:47104
  v_mfma_f32_16x16x32_bf16 v[48:51], a[200:203], a[112:115], v[48:51]
  ds_read_b64_tr_b16 a[192:193], v246 offset:34816
  v_mfma_f32_16x16x32_bf16 v[48:51], a[204:207], a[120:123], v[48:51]
  buffer_load_dwordx4 a[40:43], v137, s[36:39], s9 offen offset:2048 sc1
  ds_read_b64_tr_b16 a[194:195], v246 offset:38912
  v_mfma_f32_16x16x32_bf16 v[52:55], a[204:207], a[124:127], v[52:55]
  ds_read_b64_tr_b16 a[196:197], v246 offset:43008
  v_mfma_f32_16x16x32_bf16 v[52:55], a[200:203], a[116:119], v[52:55]
  s_waitcnt lgkmcnt(11)
  ds_read_b64_tr_b16 a[198:199], v246 offset:47104
  v_mfma_f32_16x16x32_bf16 v[60:63], a[208:211], a[116:119], v[60:63]
  ds_read_b64_tr_b16 a[200:201], v247 offset:34816
  v_mfma_f32_16x16x32_bf16 v[60:63], a[212:215], a[124:127], v[60:63]
  buffer_load_dwordx4 v136, s[24:27], s8 offen offset:3072 lds
  ds_read_b64_tr_b16 a[202:203], v247 offset:38912
  v_mfma_f32_16x16x32_bf16 v[56:59], a[212:215], a[120:123], v[56:59]
  ds_read_b64_tr_b16 a[204:205], v247 offset:43008
  v_mfma_f32_16x16x32_bf16 v[56:59], a[208:211], a[112:115], v[56:59]
  s_waitcnt lgkmcnt(11)
  ds_read_b64_tr_b16 a[206:207], v247 offset:47104
  v_mfma_f32_16x16x32_bf16 v[144:147], a[176:179], a[112:115], v[144:147]
  ds_read_b64_tr_b16 a[208:209], v244 offset:49152
  v_mfma_f32_16x16x32_bf16 v[144:147], a[180:183], a[120:123], v[144:147]
  buffer_load_dwordx4 a[44:47], v137, s[36:39], s9 offen offset:3072 sc1
  s_cmp_eq_u32 s52, 2
  v_mfma_f32_16x16x32_bf16 v[148:151], a[180:183], a[124:127], v[148:151]
  s_cselect_b32 s14, 50, 36
  s_lshl_b32 s9, s14, 11
  ds_read_b64_tr_b16 a[210:211], v244 offset:53248
  v_mfma_f32_16x16x32_bf16 v[148:151], a[176:179], a[116:119], v[148:151]
  s_waitcnt lgkmcnt(10)
  ds_read_b64_tr_b16 a[212:213], v244 offset:57344
  ds_read_b64_tr_b16 a[214:215], v244 offset:61440
  v_mfma_f32_16x16x32_bf16 v[156:159], a[184:187], a[116:119], v[156:159]
  buffer_load_dwordx4 a[48:51], v137, s[36:39], s9 offen offset:0 sc1
  ds_read_b64_tr_b16 a[176:177], v245 offset:49152
  v_mfma_f32_16x16x32_bf16 v[156:159], a[188:191], a[124:127], v[156:159]
  ds_read_b64_tr_b16 a[178:179], v245 offset:53248
  v_mfma_f32_16x16x32_bf16 v[152:155], a[188:191], a[120:123], v[152:155]
  ds_read_b64_tr_b16 a[180:181], v245 offset:57344
  v_mfma_f32_16x16x32_bf16 v[152:155], a[184:187], a[112:115], v[152:155]
  s_waitcnt lgkmcnt(11)
  ds_read_b64_tr_b16 a[182:183], v245 offset:61440
  v_mfma_f32_16x16x32_bf16 v[160:163], a[192:195], a[112:115], v[160:163]
  buffer_load_dwordx4 a[52:55], v137, s[36:39], s9 offen offset:1024 sc1
  s_lshl_b32 s8, s14, 16
  v_mfma_f32_16x16x32_bf16 v[160:163], a[196:199], a[120:123], v[160:163]
  s_add_u32 m0, s73, 32768
  ds_read_b64_tr_b16 a[184:185], v246 offset:49152
  ds_read_b64_tr_b16 a[186:187], v246 offset:53248
  v_mfma_f32_16x16x32_bf16 v[164:167], a[196:199], a[124:127], v[164:167]
  ds_read_b64_tr_b16 a[188:189], v246 offset:57344
  v_mfma_f32_16x16x32_bf16 v[164:167], a[192:195], a[116:119], v[164:167]
  s_waitcnt lgkmcnt(11)
  ds_read_b64_tr_b16 a[190:191], v246 offset:61440
  v_mfma_f32_16x16x32_bf16 v[172:175], a[200:203], a[116:119], v[172:175]
  buffer_load_dwordx4 v135, s[24:27], s8 offen offset:2048 lds
  ds_read_b64_tr_b16 a[192:193], v247 offset:49152
  v_mfma_f32_16x16x32_bf16 v[172:175], a[204:207], a[124:127], v[172:175]
  ds_read_b64_tr_b16 a[194:195], v247 offset:53248
  v_mfma_f32_16x16x32_bf16 v[168:171], a[204:207], a[120:123], v[168:171]
  ds_read_b64_tr_b16 a[196:197], v247 offset:57344
  v_mfma_f32_16x16x32_bf16 v[168:171], a[200:203], a[112:115], v[168:171]
  s_waitcnt vmcnt(25) lgkmcnt(11)
  ds_read_b64_tr_b16 a[198:199], v247 offset:61440
  v_mfma_f32_16x16x32_bf16 v[32:35], a[208:211], a[216:219], v[32:35]
  buffer_load_dwordx4 a[56:59], v137, s[36:39], s9 offen offset:2048 sc1
  ds_read_b64_tr_b16 a[200:201], v244 offset:51200
  v_mfma_f32_16x16x32_bf16 v[32:35], a[212:215], a[224:227], v[32:35]
  ds_read_b64_tr_b16 a[202:203], v244 offset:55296
  v_mfma_f32_16x16x32_bf16 v[36:39], a[212:215], a[228:231], v[36:39]
  ds_read_b64_tr_b16 a[204:205], v244 offset:59392
  v_mfma_f32_16x16x32_bf16 v[36:39], a[208:211], a[220:223], v[36:39]
  s_waitcnt lgkmcnt(11)
  ds_read_b64_tr_b16 a[206:207], v244 offset:63488
  v_mfma_f32_16x16x32_bf16 v[44:47], a[176:179], a[220:223], v[44:47]
  buffer_load_dwordx4 v136, s[24:27], s8 offen offset:3072 lds
  ds_read_b64_tr_b16 a[208:209], v245 offset:51200
  v_mfma_f32_16x16x32_bf16 v[44:47], a[180:183], a[228:231], v[44:47]
  ds_read_b64_tr_b16 a[210:211], v245 offset:55296
  v_mfma_f32_16x16x32_bf16 v[40:43], a[180:183], a[224:227], v[40:43]
  ds_read_b64_tr_b16 a[212:213], v245 offset:59392
  v_mfma_f32_16x16x32_bf16 v[40:43], a[176:179], a[216:219], v[40:43]
  s_waitcnt vmcnt(20) lgkmcnt(11)
  s_barrier
  buffer_load_dwordx4 a[60:63], v137, s[36:39], s9 offen offset:3072 sc1
  v_mfma_f32_16x16x32_bf16 v[48:51], a[184:187], a[216:219], v[48:51]
  s_cmp_eq_u32 s52, 3
  s_cselect_b32 s15, 54, 40
  s_lshl_b32 s9, s15, 11
  v_mfma_f32_16x16x32_bf16 v[48:51], a[188:191], a[224:227], v[48:51]
Hb1_3:
  s_cbranch_execz Rb
  ds_read_b64_tr_b16 a[214:215], v245 offset:63488
  ds_read_b64_tr_b16 a[176:177], v246 offset:51200
  v_mfma_f32_16x16x32_bf16 v[52:55], a[188:191], a[228:231], v[52:55]
  ds_read_b64_tr_b16 a[178:179], v246 offset:55296
  ds_read_b64_tr_b16 a[180:181], v246 offset:59392
  v_mfma_f32_16x16x32_bf16 v[52:55], a[184:187], a[220:223], v[52:55]
  s_waitcnt lgkmcnt(11)
  buffer_load_dwordx4 a[64:67], v137, s[36:39], s9 offen offset:0 sc1
  ds_read_b64_tr_b16 a[182:183], v246 offset:63488
  v_mfma_f32_16x16x32_bf16 v[60:63], a[192:195], a[220:223], v[60:63]
  ds_read_b64_tr_b16 a[184:185], v247 offset:51200
  v_mfma_f32_16x16x32_bf16 v[60:63], a[196:199], a[228:231], v[60:63]
  ds_read_b64_tr_b16 a[186:187], v247 offset:55296
  v_mfma_f32_16x16x32_bf16 v[56:59], a[196:199], a[224:227], v[56:59]
  ds_read_b64_tr_b16 a[188:189], v247 offset:59392
  v_mfma_f32_16x16x32_bf16 v[56:59], a[192:195], a[216:219], v[56:59]
  s_waitcnt lgkmcnt(11)
  buffer_load_dwordx4 a[68:71], v137, s[36:39], s9 offen offset:1024 sc1
  s_lshl_b32 s8, s15, 16
  v_mfma_f32_16x16x32_bf16 v[144:147], a[200:203], a[216:219], v[144:147]
  s_add_u32 m0, s73, 49152
  ds_read_b64_tr_b16 a[190:191], v247 offset:63488
  ds_read_b64_tr_b16 a[192:193], v248 offset:0
  v_mfma_f32_16x16x32_bf16 v[144:147], a[204:207], a[224:227], v[144:147]
  ds_read_b64_tr_b16 a[194:195], v248 offset:4096
  v_mfma_f32_16x16x32_bf16 v[148:151], a[204:207], a[228:231], v[148:151]
  ds_read_b64_tr_b16 a[196:197], v248 offset:8192
  v_mfma_f32_16x16x32_bf16 v[148:151], a[200:203], a[220:223], v[148:151]
  s_waitcnt lgkmcnt(11)
  buffer_load_dwordx4 v135, s[24:27], s8 offen offset:2048 lds
  ds_read_b64_tr_b16 a[198:199], v248 offset:12288
  v_mfma_f32_16x16x32_bf16 v[156:159], a[208:211], a[220:223], v[156:159]
  ds_read_b64_tr_b16 a[200:201], v249 offset:0
  v_mfma_f32_16x16x32_bf16 v[156:159], a[212:215], a[228:231], v[156:159]
  ds_read_b64_tr_b16 a[202:203], v249 offset:4096
  v_mfma_f32_16x16x32_bf16 v[152:155], a[212:215], a[224:227], v[152:155]
  ds_read_b64_tr_b16 a[204:205], v249 offset:8192
  v_mfma_f32_16x16x32_bf16 v[152:155], a[208:211], a[216:219], v[152:155]
  s_waitcnt lgkmcnt(11)
  buffer_load_dwordx4 a[72:75], v137, s[36:39], s9 offen offset:2048 sc1
  ds_read_b64_tr_b16 a[206:207], v249 offset:12288
  v_mfma_f32_16x16x32_bf16 v[160:163], a[176:179], a[216:219], v[160:163]
  ds_read_b64_tr_b16 a[208:209], v250 offset:0
  v_mfma_f32_16x16x32_bf16 v[160:163], a[180:183], a[224:227], v[160:163]
  ds_read_b64_tr_b16 a[210:211], v250 offset:4096
  v_mfma_f32_16x16x32_bf16 v[164:167], a[180:183], a[228:231], v[164:167]
  buffer_load_dwordx4 v136, s[24:27], s8 offen offset:3072 lds
  ds_read_b64_tr_b16 a[212:213], v250 offset:8192
  v_mfma_f32_16x16x32_bf16 v[164:167], a[176:179], a[220:223], v[164:167]
  s_waitcnt lgkmcnt(11)
  ds_read_b64_tr_b16 a[214:215], v250 offset:12288
  v_mfma_f32_16x16x32_bf16 v[172:175], a[184:187], a[220:223], v[172:175]
  ds_read_b64_tr_b16 a[176:177], v251 offset:0
  v_mfma_f32_16x16x32_bf16 v[172:175], a[188:191], a[228:231], v[172:175]
  ds_read_b64_tr_b16 a[178:179], v251 offset:4096
  v_mfma_f32_16x16x32_bf16 v[168:171], a[188:191], a[224:227], v[168:171]
  buffer_load_dwordx4 a[76:79], v137, s[36:39], s9 offen offset:3072 sc1
  s_cmp_eq_u32 s52, 0
  v_mfma_f32_16x16x32_bf16 v[168:171], a[184:187], a[216:219], v[168:171]
  s_waitcnt vmcnt(26) lgkmcnt(10)
  s_cselect_b32 s40, 15, 43
  s_lshl_b32 s9, s40, 11
  v_mfma_f32_16x16x32_bf16 v[32:35], a[192:195], a[0:3], v[32:35]
  ds_read_b64_tr_b16 a[180:181], v251 offset:8192
  ds_read_b64_tr_b16 a[182:183], v251 offset:12288
  v_mfma_f32_16x16x32_bf16 v[32:35], a[196:199], a[8:11], v[32:35]
  ds_read_b64_tr_b16 a[184:185], v248 offset:2048
  ds_read_b64_tr_b16 a[186:187], v248 offset:6144
  v_mfma_f32_16x16x32_bf16 v[36:39], a[196:199], a[12:15], v[36:39]
  buffer_load_dwordx4 a[80:83], v137, s[36:39], s9 offen offset:0 sc1
  ds_read_b64_tr_b16 a[188:189], v248 offset:10240
  v_mfma_f32_16x16x32_bf16 v[36:39], a[192:195], a[4:7], v[36:39]
  s_waitcnt lgkmcnt(11)
  ds_read_b64_tr_b16 a[190:191], v248 offset:14336
  v_mfma_f32_16x16x32_bf16 v[44:47], a[200:203], a[4:7], v[44:47]
  ds_read_b64_tr_b16 a[192:193], v249 offset:2048
  v_mfma_f32_16x16x32_bf16 v[44:47], a[204:207], a[12:15], v[44:47]
  ds_read_b64_tr_b16 a[194:195], v249 offset:6144
  v_mfma_f32_16x16x32_bf16 v[40:43], a[204:207], a[8:11], v[40:43]
  buffer_load_dwordx4 a[84:87], v137, s[36:39], s9 offen offset:1024 sc1
  s_lshl_b32 s8, s40, 16
  v_mfma_f32_16x16x32_bf16 v[40:43], a[200:203], a[0:3], v[40:43]
  s_waitcnt vmcnt(21) lgkmcnt(10)
  s_barrier
  s_add_u32 m0, s73, 65536
  v_mfma_f32_16x16x32_bf16 v[48:51], a[208:211], a[0:3], v[48:51]
  ds_read_b64_tr_b16 a[196:197], v249 offset:10240
  ds_read_b64_tr_b16 a[198:199], v249 offset:14336
  v_mfma_f32_16x16x32_bf16 v[48:51], a[212:215], a[8:11], v[48:51]
  ds_read_b64_tr_b16 a[200:201], v250 offset:2048
  ds_read_b64_tr_b16 a[202:203], v250 offset:6144
  v_mfma_f32_16x16x32_bf16 v[52:55], a[212:215], a[12:15], v[52:55]
  buffer_load_dwordx4 v135, s[24:27], s8 offen offset:2048 lds
  ds_read_b64_tr_b16 a[204:205], v250 offset:10240
  v_mfma_f32_16x16x32_bf16 v[52:55], a[208:211], a[4:7], v[52:55]
  s_waitcnt lgkmcnt(11)
  ds_read_b64_tr_b16 a[206:207], v250 offset:14336
  v_mfma_f32_16x16x32_bf16 v[60:63], a[176:179], a[4:7], v[60:63]
  ds_read_b64_tr_b16 a[208:209], v251 offset:2048
  v_mfma_f32_16x16x32_bf16 v[60:63], a[180:183], a[12:15], v[60:63]
  buffer_load_dwordx4 a[88:91], v137, s[36:39], s9 offen offset:2048 sc1
  ds_read_b64_tr_b16 a[210:211], v251 offset:6144
  v_mfma_f32_16x16x32_bf16 v[56:59], a[180:183], a[8:11], v[56:59]
  ds_read_b64_tr_b16 a[212:213], v251 offset:10240
  v_mfma_f32_16x16x32_bf16 v[56:59], a[176:179], a[0:3], v[56:59]
  s_waitcnt lgkmcnt(11)
  ds_read_b64_tr_b16 a[214:215], v251 offset:14336
  v_mfma_f32_16x16x32_bf16 v[144:147], a[184:187], a[0:3], v[144:147]
  ds_read_b64_tr_b16 a[176:177], v240 offset:0
  v_mfma_f32_16x16x32_bf16 v[144:147], a[188:191], a[8:11], v[144:147]
  buffer_load_dwordx4 v136, s[24:27], s8 offen offset:3072 lds
  ds_read_b64_tr_b16 a[178:179], v240 offset:4096
  v_mfma_f32_16x16x32_bf16 v[148:151], a[188:191], a[12:15], v[148:151]
  ds_read_b64_tr_b16 a[180:181], v240 offset:8192
  v_mfma_f32_16x16x32_bf16 v[148:151], a[184:187], a[4:7], v[148:151]
  s_waitcnt lgkmcnt(11)
  ds_read_b64_tr_b16 a[182:183], v240 offset:12288
  v_mfma_f32_16x16x32_bf16 v[156:159], a[192:195], a[4:7], v[156:159]
  ds_read_b64_tr_b16 a[184:185], v241 offset:0
  v_mfma_f32_16x16x32_bf16 v[156:159], a[196:199], a[12:15], v[156:159]
  buffer_load_dwordx4 a[92:95], v137, s[36:39], s9 offen offset:3072 sc1
  s_cmp_eq_u32 s52, 1
  v_mfma_f32_16x16x32_bf16 v[152:155], a[196:199], a[8:11], v[152:155]
  s_cselect_b32 s41, 5, 47
  s_lshl_b32 s9, s41, 11
  ds_read_b64_tr_b16 a[186:187], v241 offset:4096
  v_mfma_f32_16x16x32_bf16 v[152:155], a[192:195], a[0:3], v[152:155]
  s_waitcnt lgkmcnt(10)
  ds_read_b64_tr_b16 a[188:189], v241 offset:8192
  ds_read_b64_tr_b16 a[190:191], v241 offset:12288
  v_mfma_f32_16x16x32_bf16 v[160:163], a[200:203], a[0:3], v[160:163]
  ds_read_b64_tr_b16 a[192:193], v242 offset:0
  v_mfma_f32_16x16x32_bf16 v[160:163], a[204:207], a[8:11], v[160:163]
  buffer_load_dwordx4 a[96:99], v137, s[36:39], s9 offen offset:0 sc1
  ds_read_b64_tr_b16 a[194:195], v242 offset:4096
  v_mfma_f32_16x16x32_bf16 v[164:167], a[204:207], a[12:15], v[164:167]
  ds_read_b64_tr_b16 a[196:197], v242 offset:8192
  v_mfma_f32_16x16x32_bf16 v[164:167], a[200:203], a[4:7], v[164:167]
  s_waitcnt lgkmcnt(11)
  ds_read_b64_tr_b16 a[198:199], v242 offset:12288
  v_mfma_f32_16x16x32_bf16 v[172:175], a[208:211], a[4:7], v[172:175]
  ds_read_b64_tr_b16 a[200:201], v243 offset:0
  v_mfma_f32_16x16x32_bf16 v[172:175], a[212:215], a[12:15], v[172:175]
  buffer_load_dwordx4 a[100:103], v137, s[36:39], s9 offen offset:1024 sc1
  s_lshl_b32 s8, s41, 16
  v_mfma_f32_16x16x32_bf16 v[168:171], a[212:215], a[8:11], v[168:171]
  s_add_u32 m0, s73, 81920
  ds_read_b64_tr_b16 a[202:203], v243 offset:4096
  ds_read_b64_tr_b16 a[204:205], v243 offset:8192
  v_mfma_f32_16x16x32_bf16 v[168:171], a[208:211], a[0:3], v[168:171]
  s_waitcnt vmcnt(26) lgkmcnt(11)
  ds_read_b64_tr_b16 a[206:207], v243 offset:12288
  v_mfma_f32_16x16x32_bf16 v[32:35], a[176:179], a[16:19], v[32:35]
  buffer_load_dwordx4 v135, s[24:27], s8 offen offset:2048 lds
  ds_read_b64_tr_b16 a[208:209], v240 offset:2048
  v_mfma_f32_16x16x32_bf16 v[32:35], a[180:183], a[24:27], v[32:35]
  ds_read_b64_tr_b16 a[210:211], v240 offset:6144
  v_mfma_f32_16x16x32_bf16 v[36:39], a[180:183], a[28:31], v[36:39]
  ds_read_b64_tr_b16 a[212:213], v240 offset:10240
  v_mfma_f32_16x16x32_bf16 v[36:39], a[176:179], a[20:23], v[36:39]
  s_waitcnt lgkmcnt(11)
  ds_read_b64_tr_b16 a[214:215], v240 offset:14336
  v_mfma_f32_16x16x32_bf16 v[44:47], a[184:187], a[20:23], v[44:47]
  buffer_load_dwordx4 a[104:107], v137, s[36:39], s9 offen offset:2048 sc1
  ds_read_b64_tr_b16 a[176:177], v241 offset:2048
  v_mfma_f32_16x16x32_bf16 v[44:47], a[188:191], a[28:31], v[44:47]
  ds_read_b64_tr_b16 a[178:179], v241 offset:6144
  v_mfma_f32_16x16x32_bf16 v[40:43], a[188:191], a[24:27], v[40:43]
  ds_read_b64_tr_b16 a[180:181], v241 offset:10240
  v_mfma_f32_16x16x32_bf16 v[40:43], a[184:187], a[16:19], v[40:43]
  s_waitcnt vmcnt(23) lgkmcnt(11)
  s_barrier
  ds_read_b64_tr_b16 a[182:183], v241 offset:14336
  v_mfma_f32_16x16x32_bf16 v[48:51], a[192:195], a[16:19], v[48:51]
  buffer_load_dwordx4 v136, s[24:27], s8 offen offset:3072 lds
  ds_read_b64_tr_b16 a[184:185], v242 offset:2048
  v_mfma_f32_16x16x32_bf16 v[48:51], a[196:199], a[24:27], v[48:51]
  ds_read_b64_tr_b16 a[186:187], v242 offset:6144
  v_mfma_f32_16x16x32_bf16 v[52:55], a[196:199], a[28:31], v[52:55]
  ds_read_b64_tr_b16 a[188:189], v242 offset:10240
  v_mfma_f32_16x16x32_bf16 v[52:55], a[192:195], a[20:23], v[52:55]
  s_waitcnt lgkmcnt(11)
  ds_read_b64_tr_b16 a[190:191], v242 offset:14336
  v_mfma_f32_16x16x32_bf16 v[60:63], a[200:203], a[20:23], v[60:63]
  buffer_load_dwordx4 a[108:111], v137, s[36:39], s9 offen offset:3072 sc1
  s_cmp_eq_u32 s52, 2
  v_mfma_f32_16x16x32_bf16 v[60:63], a[204:207], a[28:31], v[60:63]
  s_cselect_b32 s42, 8, 50
  s_lshl_b32 s9, s42, 11
  ds_read_b64_tr_b16 a[192:193], v243 offset:2048
  v_mfma_f32_16x16x32_bf16 v[56:59], a[204:207], a[24:27], v[56:59]
  ds_read_b64_tr_b16 a[194:195], v243 offset:6144
  ds_read_b64_tr_b16 a[196:197], v243 offset:10240
  v_mfma_f32_16x16x32_bf16 v[56:59], a[200:203], a[16:19], v[56:59]
  s_waitcnt lgkmcnt(11)
  ds_read_b64_tr_b16 a[198:199], v243 offset:14336
  v_mfma_f32_16x16x32_bf16 v[144:147], a[208:211], a[16:19], v[144:147]
  buffer_load_dwordx4 a[112:115], v137, s[36:39], s9 offen offset:0 sc1
  ds_read_b64_tr_b16 a[200:201], v240 offset:18432
  v_mfma_f32_16x16x32_bf16 v[144:147], a[212:215], a[24:27], v[144:147]
  ds_read_b64_tr_b16 a[202:203], v240 offset:22528
  v_mfma_f32_16x16x32_bf16 v[148:151], a[212:215], a[28:31], v[148:151]
  ds_read_b64_tr_b16 a[204:205], v240 offset:26624
  v_mfma_f32_16x16x32_bf16 v[148:151], a[208:211], a[20:23], v[148:151]
  s_waitcnt lgkmcnt(11)
  buffer_load_dwordx4 a[116:119], v137, s[36:39], s9 offen offset:1024 sc1
  s_lshl_b32 s8, s42, 16
  v_mfma_f32_16x16x32_bf16 v[156:159], a[176:179], a[20:23], v[156:159]
  s_add_u32 m0, s73, 98304
  ds_read_b64_tr_b16 a[206:207], v240 offset:30720
  ds_read_b64_tr_b16 a[208:209], v241 offset:18432
  v_mfma_f32_16x16x32_bf16 v[156:159], a[180:183], a[28:31], v[156:159]
  ds_read_b64_tr_b16 a[210:211], v241 offset:22528
  v_mfma_f32_16x16x32_bf16 v[152:155], a[180:183], a[24:27], v[152:155]
  ds_read_b64_tr_b16 a[212:213], v241 offset:26624
  v_mfma_f32_16x16x32_bf16 v[152:155], a[176:179], a[16:19], v[152:155]
  s_waitcnt vmcnt(21) lgkmcnt(11)
  s_barrier
  buffer_load_dwordx4 v135, s[24:27], s8 offen offset:2048 lds
  v_mfma_f32_16x16x32_bf16 v[160:163], a[184:187], a[16:19], v[160:163]
  ds_read_b64_tr_b16 a[214:215], v241 offset:30720
  ds_read_b64_tr_b16 a[176:177], v242 offset:18432
  v_mfma_f32_16x16x32_bf16 v[160:163], a[188:191], a[24:27], v[160:163]
  ds_read_b64_tr_b16 a[178:179], v242 offset:22528
  v_mfma_f32_16x16x32_bf16 v[164:167], a[188:191], a[28:31], v[164:167]
  ds_read_b64_tr_b16 a[180:181], v242 offset:26624
  v_mfma_f32_16x16x32_bf16 v[164:167], a[184:187], a[20:23], v[164:167]
  s_waitcnt lgkmcnt(11)
  buffer_load_dwordx4 a[120:123], v137, s[36:39], s9 offen offset:2048 sc1
  ds_read_b64_tr_b16 a[182:183], v242 offset:30720
  v_mfma_f32_16x16x32_bf16 v[172:175], a[192:195], a[20:23], v[172:175]
  ds_read_b64_tr_b16 a[184:185], v243 offset:18432
  v_mfma_f32_16x16x32_bf16 v[172:175], a[196:199], a[28:31], v[172:175]
  ds_read_b64_tr_b16 a[186:187], v243 offset:22528
  v_mfma_f32_16x16x32_bf16 v[168:171], a[196:199], a[24:27], v[168:171]
  ds_read_b64_tr_b16 a[188:189], v243 offset:26624
  v_mfma_f32_16x16x32_bf16 v[168:171], a[192:195], a[16:19], v[168:171]
  s_waitcnt vmcnt(28) lgkmcnt(11)
  buffer_load_dwordx4 v136, s[24:27], s8 offen offset:3072 lds
  ds_read_b64_tr_b16 a[190:191], v243 offset:30720
  v_mfma_f32_16x16x32_bf16 v[144:147], a[200:203], a[32:35], v[144:147]
  ds_read_b64_tr_b16 a[192:193], v240 offset:34816
  v_mfma_f32_16x16x32_bf16 v[144:147], a[204:207], a[40:43], v[144:147]
  ds_read_b64_tr_b16 a[194:195], v240 offset:38912
  v_mfma_f32_16x16x32_bf16 v[148:151], a[204:207], a[44:47], v[148:151]
  ds_read_b64_tr_b16 a[196:197], v240 offset:43008
  v_mfma_f32_16x16x32_bf16 v[148:151], a[200:203], a[36:39], v[148:151]
  s_waitcnt lgkmcnt(11)
  buffer_load_dwordx4 a[124:127], v137, s[36:39], s9 offen offset:3072 sc1
  s_cmp_eq_u32 s52, 3
  v_mfma_f32_16x16x32_bf16 v[156:159], a[208:211], a[36:39], v[156:159]
  s_cselect_b32 s43, 12, 54
  s_lshl_b32 s9, s43, 11
  ds_read_b64_tr_b16 a[198:199], v240 offset:47104
  v_mfma_f32_16x16x32_bf16 v[156:159], a[212:215], a[44:47], v[156:159]
  ds_read_b64_tr_b16 a[200:201], v241 offset:34816
  ds_read_b64_tr_b16 a[202:203], v241 offset:38912
  v_mfma_f32_16x16x32_bf16 v[152:155], a[212:215], a[40:43], v[152:155]
  buffer_load_dwordx4 a[216:219], v137, s[36:39], s9 offen offset:0 sc1
  ds_read_b64_tr_b16 a[204:205], v241 offset:43008
  v_mfma_f32_16x16x32_bf16 v[152:155], a[208:211], a[32:35], v[152:155]
  s_waitcnt vmcnt(20) lgkmcnt(11)
  s_barrier
  ds_read_b64_tr_b16 a[206:207], v241 offset:47104
  v_mfma_f32_16x16x32_bf16 v[160:163], a[176:179], a[32:35], v[160:163]
  ds_read_b64_tr_b16 a[208:209], v242 offset:34816
  v_mfma_f32_16x16x32_bf16 v[160:163], a[180:183], a[40:43], v[160:163]
  ds_read_b64_tr_b16 a[210:211], v242 offset:38912
  v_mfma_f32_16x16x32_bf16 v[164:167], a[180:183], a[44:47], v[164:167]
  buffer_load_dwordx4 a[220:223], v137, s[36:39], s9 offen offset:1024 sc1
  s_lshl_b32 s8, s43, 16
  v_mfma_f32_16x16x32_bf16 v[164:167], a[176:179], a[36:39], v[164:167]
  s_waitcnt lgkmcnt(10)
  s_add_u32 m0, s73, 114688
  ds_read_b64_tr_b16 a[212:213], v242 offset:43008
  v_mfma_f32_16x16x32_bf16 v[172:175], a[184:187], a[36:39], v[172:175]
  ds_read_b64_tr_b16 a[214:215], v242 offset:47104
  ds_read_b64_tr_b16 a[176:177], v243 offset:34816
  v_mfma_f32_16x16x32_bf16 v[172:175], a[188:191], a[44:47], v[172:175]
  ds_read_b64_tr_b16 a[178:179], v243 offset:38912
  v_mfma_f32_16x16x32_bf16 v[168:171], a[188:191], a[40:43], v[168:171]
  buffer_load_dwordx4 v135, s[24:27], s8 offen offset:2048 lds
  ds_read_b64_tr_b16 a[180:181], v243 offset:43008
  v_mfma_f32_16x16x32_bf16 v[168:171], a[184:187], a[32:35], v[168:171]
  s_waitcnt vmcnt(27) lgkmcnt(11)
  ds_read_b64_tr_b16 a[182:183], v243 offset:47104
  v_mfma_f32_16x16x32_bf16 v[144:147], a[192:195], a[48:51], v[144:147]
  ds_read_b64_tr_b16 a[184:185], v240 offset:51200
  v_mfma_f32_16x16x32_bf16 v[144:147], a[196:199], a[56:59], v[144:147]
  ds_read_b64_tr_b16 a[186:187], v240 offset:55296
  v_mfma_f32_16x16x32_bf16 v[148:151], a[196:199], a[60:63], v[148:151]
  buffer_load_dwordx4 a[224:227], v137, s[36:39], s9 offen offset:2048 sc1
  ds_read_b64_tr_b16 a[188:189], v240 offset:59392
  v_mfma_f32_16x16x32_bf16 v[148:151], a[192:195], a[52:55], v[148:151]
  s_waitcnt lgkmcnt(11)
  ds_read_b64_tr_b16 a[190:191], v240 offset:63488
  v_mfma_f32_16x16x32_bf16 v[156:159], a[200:203], a[52:55], v[156:159]
  ds_read_b64_tr_b16 a[192:193], v241 offset:51200
  v_mfma_f32_16x16x32_bf16 v[156:159], a[204:207], a[60:63], v[156:159]
  ds_read_b64_tr_b16 a[194:195], v241 offset:55296
  v_mfma_f32_16x16x32_bf16 v[152:155], a[204:207], a[56:59], v[152:155]
  buffer_load_dwordx4 v136, s[24:27], s8 offen offset:3072 lds
  ds_read_b64_tr_b16 a[196:197], v241 offset:59392
  v_mfma_f32_16x16x32_bf16 v[152:155], a[200:203], a[48:51], v[152:155]
  s_waitcnt vmcnt(18) lgkmcnt(11)
  s_barrier
  ds_read_b64_tr_b16 a[198:199], v241 offset:63488
  v_mfma_f32_16x16x32_bf16 v[160:163], a[208:211], a[48:51], v[160:163]
  ds_read_b64_tr_b16 a[200:201], v242 offset:51200
  v_mfma_f32_16x16x32_bf16 v[160:163], a[212:215], a[56:59], v[160:163]
  ds_read_b64_tr_b16 a[202:203], v242 offset:55296
  v_mfma_f32_16x16x32_bf16 v[164:167], a[212:215], a[60:63], v[164:167]
  buffer_load_dwordx4 a[228:231], v137, s[36:39], s9 offen offset:3072 sc1
  s_lshl_b32 s8, s13, 16
  v_mfma_f32_16x16x32_bf16 v[164:167], a[208:211], a[52:55], v[164:167]
  s_waitcnt lgkmcnt(10)
  s_add_u32 m0, s73, 16384
  ds_read_b64_tr_b16 a[204:205], v242 offset:59392
  v_mfma_f32_16x16x32_bf16 v[172:175], a[176:179], a[52:55], v[172:175]
  ds_read_b64_tr_b16 a[206:207], v242 offset:63488
  ds_read_b64_tr_b16 a[208:209], v243 offset:51200
  v_mfma_f32_16x16x32_bf16 v[172:175], a[180:183], a[60:63], v[172:175]
  ds_read_b64_tr_b16 a[210:211], v243 offset:55296
  v_mfma_f32_16x16x32_bf16 v[168:171], a[180:183], a[56:59], v[168:171]
  buffer_load_dwordx4 v133, s[24:27], s8 offen offset:0 lds
  ds_read_b64_tr_b16 a[212:213], v243 offset:59392
  v_mfma_f32_16x16x32_bf16 v[168:171], a[176:179], a[48:51], v[168:171]
  s_waitcnt vmcnt(25) lgkmcnt(11)
  ds_read_b64_tr_b16 a[214:215], v243 offset:63488
  v_mfma_f32_16x16x32_bf16 v[144:147], a[184:187], a[64:67], v[144:147]
  ds_read_b64_tr_b16 a[176:177], v244 offset:2048
  v_mfma_f32_16x16x32_bf16 v[144:147], a[188:191], a[72:75], v[144:147]
  ds_read_b64_tr_b16 a[178:179], v244 offset:6144
  v_mfma_f32_16x16x32_bf16 v[148:151], a[188:191], a[76:79], v[148:151]
  buffer_load_dwordx4 v134, s[24:27], s8 offen offset:1024 lds
  s_lshl_b32 s8, s14, 16
  v_mfma_f32_16x16x32_bf16 v[148:151], a[184:187], a[68:71], v[148:151]
  s_waitcnt lgkmcnt(10)
  s_add_u32 m0, s73, 32768
  ds_read_b64_tr_b16 a[180:181], v244 offset:10240
  v_mfma_f32_16x16x32_bf16 v[156:159], a[192:195], a[68:71], v[156:159]
  ds_read_b64_tr_b16 a[182:183], v244 offset:14336
  ds_read_b64_tr_b16 a[184:185], v245 offset:2048
  v_mfma_f32_16x16x32_bf16 v[156:159], a[196:199], a[76:79], v[156:159]
  ds_read_b64_tr_b16 a[186:187], v245 offset:6144
  v_mfma_f32_16x16x32_bf16 v[152:155], a[196:199], a[72:75], v[152:155]
  buffer_load_dwordx4 v133, s[24:27], s8 offen offset:0 lds
  ds_read_b64_tr_b16 a[188:189], v245 offset:10240
  v_mfma_f32_16x16x32_bf16 v[152:155], a[192:195], a[64:67], v[152:155]
  s_waitcnt vmcnt(16) lgkmcnt(11)
  s_barrier
  ds_read_b64_tr_b16 a[190:191], v245 offset:14336
  v_mfma_f32_16x16x32_bf16 v[160:163], a[200:203], a[64:67], v[160:163]
  ds_read_b64_tr_b16 a[192:193], v246 offset:2048
  v_mfma_f32_16x16x32_bf16 v[160:163], a[204:207], a[72:75], v[160:163]
  ds_read_b64_tr_b16 a[194:195], v246 offset:6144
  v_mfma_f32_16x16x32_bf16 v[164:167], a[204:207], a[76:79], v[164:167]
  buffer_load_dwordx4 v134, s[24:27], s8 offen offset:1024 lds
  s_lshl_b32 s8, s15, 16
  v_mfma_f32_16x16x32_bf16 v[164:167], a[200:203], a[68:71], v[164:167]
  s_waitcnt lgkmcnt(10)
  s_add_u32 m0, s73, 49152
  ds_read_b64_tr_b16 a[196:197], v246 offset:10240
  v_mfma_f32_16x16x32_bf16 v[172:175], a[208:211], a[68:71], v[172:175]
  ds_read_b64_tr_b16 a[198:199], v246 offset:14336
  ds_read_b64_tr_b16 a[200:201], v247 offset:2048
  v_mfma_f32_16x16x32_bf16 v[172:175], a[212:215], a[76:79], v[172:175]
  ds_read_b64_tr_b16 a[202:203], v247 offset:6144
  v_mfma_f32_16x16x32_bf16 v[168:171], a[212:215], a[72:75], v[168:171]
  buffer_load_dwordx4 v133, s[24:27], s8 offen offset:0 lds
  ds_read_b64_tr_b16 a[204:205], v247 offset:10240
  v_mfma_f32_16x16x32_bf16 v[168:171], a[208:211], a[64:67], v[168:171]
  s_waitcnt vmcnt(23) lgkmcnt(11)
  ds_read_b64_tr_b16 a[206:207], v247 offset:14336
  v_mfma_f32_16x16x32_bf16 v[144:147], a[176:179], a[80:83], v[144:147]
  ds_read_b64_tr_b16 a[208:209], v244 offset:18432
  v_mfma_f32_16x16x32_bf16 v[144:147], a[180:183], a[88:91], v[144:147]
  ds_read_b64_tr_b16 a[210:211], v244 offset:22528
  v_mfma_f32_16x16x32_bf16 v[148:151], a[180:183], a[92:95], v[148:151]
  buffer_load_dwordx4 v134, s[24:27], s8 offen offset:1024 lds
  s_lshl_b32 s8, s40, 16
  v_mfma_f32_16x16x32_bf16 v[148:151], a[176:179], a[84:87], v[148:151]
  s_waitcnt lgkmcnt(10)
  s_add_u32 m0, s73, 65536
  ds_read_b64_tr_b16 a[212:213], v244 offset:26624
  v_mfma_f32_16x16x32_bf16 v[156:159], a[184:187], a[84:87], v[156:159]
  ds_read_b64_tr_b16 a[214:215], v244 offset:30720
  ds_read_b64_tr_b16 a[176:177], v245 offset:18432
  v_mfma_f32_16x16x32_bf16 v[156:159], a[188:191], a[92:95], v[156:159]
  ds_read_b64_tr_b16 a[178:179], v245 offset:22528
  v_mfma_f32_16x16x32_bf16 v[152:155], a[188:191], a[88:91], v[152:155]
  buffer_load_dwordx4 v133, s[24:27], s8 offen offset:0 lds
  ds_read_b64_tr_b16 a[180:181], v245 offset:26624
  v_mfma_f32_16x16x32_bf16 v[152:155], a[184:187], a[80:83], v[152:155]
  s_waitcnt vmcnt(14) lgkmcnt(11)
  s_barrier
  ds_read_b64_tr_b16 a[182:183], v245 offset:30720
  v_mfma_f32_16x16x32_bf16 v[160:163], a[192:195], a[80:83], v[160:163]
  ds_read_b64_tr_b16 a[184:185], v246 offset:18432
  v_mfma_f32_16x16x32_bf16 v[160:163], a[196:199], a[88:91], v[160:163]
  ds_read_b64_tr_b16 a[186:187], v246 offset:22528
  v_mfma_f32_16x16x32_bf16 v[164:167], a[196:199], a[92:95], v[164:167]
  buffer_load_dwordx4 v134, s[24:27], s8 offen offset:1024 lds
  s_lshl_b32 s8, s41, 16
  v_mfma_f32_16x16x32_bf16 v[164:167], a[192:195], a[84:87], v[164:167]
  s_waitcnt lgkmcnt(10)
  s_add_u32 m0, s73, 81920
  ds_read_b64_tr_b16 a[188:189], v246 offset:26624
  v_mfma_f32_16x16x32_bf16 v[172:175], a[200:203], a[84:87], v[172:175]
  ds_read_b64_tr_b16 a[190:191], v246 offset:30720
  ds_read_b64_tr_b16 a[192:193], v247 offset:18432
  v_mfma_f32_16x16x32_bf16 v[172:175], a[204:207], a[92:95], v[172:175]
  ds_read_b64_tr_b16 a[194:195], v247 offset:22528
  v_mfma_f32_16x16x32_bf16 v[168:171], a[204:207], a[88:91], v[168:171]
  buffer_load_dwordx4 v133, s[24:27], s8 offen offset:0 lds
  ds_read_b64_tr_b16 a[196:197], v247 offset:26624
  v_mfma_f32_16x16x32_bf16 v[168:171], a[200:203], a[80:83], v[168:171]
  s_waitcnt vmcnt(21) lgkmcnt(11)
  ds_read_b64_tr_b16 a[198:199], v247 offset:30720
  v_mfma_f32_16x16x32_bf16 v[144:147], a[208:211], a[96:99], v[144:147]
  ds_read_b64_tr_b16 a[200:201], v244 offset:34816
  v_mfma_f32_16x16x32_bf16 v[144:147], a[212:215], a[104:107], v[144:147]
  ds_read_b64_tr_b16 a[202:203], v244 offset:38912
  v_mfma_f32_16x16x32_bf16 v[148:151], a[212:215], a[108:111], v[148:151]
  buffer_load_dwordx4 v134, s[24:27], s8 offen offset:1024 lds
  s_lshl_b32 s8, s42, 16
  v_mfma_f32_16x16x32_bf16 v[148:151], a[208:211], a[100:103], v[148:151]
  s_waitcnt lgkmcnt(10)
  s_add_u32 m0, s73, 98304
  ds_read_b64_tr_b16 a[204:205], v244 offset:43008
  v_mfma_f32_16x16x32_bf16 v[156:159], a[176:179], a[100:103], v[156:159]
  ds_read_b64_tr_b16 a[206:207], v244 offset:47104
  ds_read_b64_tr_b16 a[208:209], v245 offset:34816
  v_mfma_f32_16x16x32_bf16 v[156:159], a[180:183], a[108:111], v[156:159]
  ds_read_b64_tr_b16 a[210:211], v245 offset:38912
  v_mfma_f32_16x16x32_bf16 v[152:155], a[180:183], a[104:107], v[152:155]
  buffer_load_dwordx4 v133, s[24:27], s8 offen offset:0 lds
  ds_read_b64_tr_b16 a[212:213], v245 offset:43008
  v_mfma_f32_16x16x32_bf16 v[152:155], a[176:179], a[96:99], v[152:155]
  s_waitcnt vmcnt(12) lgkmcnt(11)
  s_barrier
  ds_read_b64_tr_b16 a[214:215], v245 offset:47104
  v_mfma_f32_16x16x32_bf16 v[160:163], a[184:187], a[96:99], v[160:163]
  ds_read_b64_tr_b16 a[176:177], v246 offset:34816
  v_mfma_f32_16x16x32_bf16 v[160:163], a[188:191], a[104:107], v[160:163]
  ds_read_b64_tr_b16 a[178:179], v246 offset:38912
  v_mfma_f32_16x16x32_bf16 v[164:167], a[188:191], a[108:111], v[164:167]
  buffer_load_dwordx4 v134, s[24:27], s8 offen offset:1024 lds
  s_lshl_b32 s8, s43, 16
  v_mfma_f32_16x16x32_bf16 v[164:167], a[184:187], a[100:103], v[164:167]
  s_waitcnt lgkmcnt(10)
  s_add_u32 m0, s73, 114688
  ds_read_b64_tr_b16 a[180:181], v246 offset:43008
  v_mfma_f32_16x16x32_bf16 v[172:175], a[192:195], a[100:103], v[172:175]
  ds_read_b64_tr_b16 a[182:183], v246 offset:47104
  ds_read_b64_tr_b16 a[184:185], v247 offset:34816
  v_mfma_f32_16x16x32_bf16 v[172:175], a[196:199], a[108:111], v[172:175]
  ds_read_b64_tr_b16 a[186:187], v247 offset:38912
  v_mfma_f32_16x16x32_bf16 v[168:171], a[196:199], a[104:107], v[168:171]
  buffer_load_dwordx4 v133, s[24:27], s8 offen offset:0 lds
  ds_read_b64_tr_b16 a[188:189], v247 offset:43008
  v_mfma_f32_16x16x32_bf16 v[168:171], a[192:195], a[96:99], v[168:171]
  s_waitcnt vmcnt(19) lgkmcnt(11)
  ds_read_b64_tr_b16 a[190:191], v247 offset:47104
  v_mfma_f32_16x16x32_bf16 v[144:147], a[200:203], a[112:115], v[144:147]
  ds_read_b64_tr_b16 a[192:193], v244 offset:51200
  v_mfma_f32_16x16x32_bf16 v[144:147], a[204:207], a[120:123], v[144:147]
  ds_read_b64_tr_b16 a[194:195], v244 offset:55296
  v_mfma_f32_16x16x32_bf16 v[148:151], a[204:207], a[124:127], v[148:151]
  buffer_load_dwordx4 v134, s[24:27], s8 offen offset:1024 lds
  ds_read_b64_tr_b16 a[196:197], v244 offset:59392
  v_mfma_f32_16x16x32_bf16 v[148:151], a[200:203], a[116:119], v[148:151]
  s_waitcnt lgkmcnt(11)
  ds_read_b64_tr_b16 a[198:199], v244 offset:63488
  v_mfma_f32_16x16x32_bf16 v[156:159], a[208:211], a[116:119], v[156:159]
  ds_read_b64_tr_b16 a[200:201], v245 offset:51200
  v_mfma_f32_16x16x32_bf16 v[156:159], a[212:215], a[124:127], v[156:159]
  ds_read_b64_tr_b16 a[202:203], v245 offset:55296
  v_mfma_f32_16x16x32_bf16 v[152:155], a[212:215], a[120:123], v[152:155]
  ds_read_b64_tr_b16 a[204:205], v245 offset:59392
  v_mfma_f32_16x16x32_bf16 v[152:155], a[208:211], a[112:115], v[152:155]
  s_waitcnt vmcnt(12) lgkmcnt(11)
  s_barrier
  ds_read_b64_tr_b16 a[206:207], v245 offset:63488
  v_mfma_f32_16x16x32_bf16 v[160:163], a[176:179], a[112:115], v[160:163]
  ds_read_b64_tr_b16 a[208:209], v246 offset:51200
  v_mfma_f32_16x16x32_bf16 v[160:163], a[180:183], a[120:123], v[160:163]
  ds_read_b64_tr_b16 a[210:211], v246 offset:55296
  v_mfma_f32_16x16x32_bf16 v[164:167], a[180:183], a[124:127], v[164:167]
  ds_read_b64_tr_b16 a[212:213], v246 offset:59392
  v_mfma_f32_16x16x32_bf16 v[164:167], a[176:179], a[116:119], v[164:167]
  s_waitcnt lgkmcnt(11)
  ds_read_b64_tr_b16 a[214:215], v246 offset:63488
  v_mfma_f32_16x16x32_bf16 v[172:175], a[184:187], a[116:119], v[172:175]
  ds_read_b64_tr_b16 a[176:177], v247 offset:51200
  v_mfma_f32_16x16x32_bf16 v[172:175], a[188:191], a[124:127], v[172:175]
  ds_read_b64_tr_b16 a[178:179], v247 offset:55296
  v_mfma_f32_16x16x32_bf16 v[168:171], a[188:191], a[120:123], v[168:171]
  ds_read_b64_tr_b16 a[180:181], v247 offset:59392
  v_mfma_f32_16x16x32_bf16 v[168:171], a[184:187], a[112:115], v[168:171]
  s_waitcnt vmcnt(14) lgkmcnt(11)
  ds_read_b64_tr_b16 a[182:183], v247 offset:63488
  v_mfma_f32_16x16x32_bf16 v[144:147], a[192:195], a[216:219], v[144:147]
  ds_read_b64_tr_b16 a[184:185], v240 offset:16384
  v_mfma_f32_16x16x32_bf16 v[144:147], a[196:199], a[224:227], v[144:147]
  ds_read_b64_tr_b16 a[186:187], v240 offset:20480
  v_mfma_f32_16x16x32_bf16 v[148:151], a[196:199], a[228:231], v[148:151]
  ds_read_b64_tr_b16 a[188:189], v240 offset:24576
  v_mfma_f32_16x16x32_bf16 v[148:151], a[192:195], a[220:223], v[148:151]
  s_waitcnt lgkmcnt(11)
  ds_read_b64_tr_b16 a[190:191], v240 offset:28672
  v_mfma_f32_16x16x32_bf16 v[156:159], a[200:203], a[220:223], v[156:159]
  ds_read_b64_tr_b16 a[192:193], v241 offset:16384
  v_mfma_f32_16x16x32_bf16 v[156:159], a[204:207], a[228:231], v[156:159]
  ds_read_b64_tr_b16 a[194:195], v241 offset:20480
  v_mfma_f32_16x16x32_bf16 v[152:155], a[204:207], a[224:227], v[152:155]
  ds_read_b64_tr_b16 a[196:197], v241 offset:24576
  v_mfma_f32_16x16x32_bf16 v[152:155], a[200:203], a[216:219], v[152:155]
  s_waitcnt vmcnt(10) lgkmcnt(11)
  s_barrier
  ds_read_b64_tr_b16 a[198:199], v241 offset:28672
  v_mfma_f32_16x16x32_bf16 v[160:163], a[208:211], a[216:219], v[160:163]
  ds_read_b64_tr_b16 a[200:201], v242 offset:16384
  buffer_store_dwordx4 v[144:147], v0, s[36:39], s4 offen offset:0 sc1
  v_mfma_f32_16x16x32_bf16 v[160:163], a[212:215], a[224:227], v[160:163]
  buffer_store_dwordx4 v[148:151], v0, s[36:39], s4 offen offset:1024 sc1
  ds_read_b64_tr_b16 a[202:203], v242 offset:20480
  v_mfma_f32_16x16x32_bf16 v[164:167], a[212:215], a[228:231], v[164:167]
  ds_read_b64_tr_b16 a[204:205], v242 offset:24576
  v_mfma_f32_16x16x32_bf16 v[164:167], a[208:211], a[220:223], v[164:167]
  s_waitcnt lgkmcnt(11)
  ds_read_b64_tr_b16 a[206:207], v242 offset:28672
  v_mfma_f32_16x16x32_bf16 v[172:175], a[176:179], a[220:223], v[172:175]
  ds_read_b64_tr_b16 a[208:209], v243 offset:16384
  buffer_store_dwordx4 v[152:155], v0, s[36:39], s4 offen offset:2048 sc1
  v_mfma_f32_16x16x32_bf16 v[172:175], a[180:183], a[228:231], v[172:175]
  buffer_store_dwordx4 v[156:159], v0, s[36:39], s4 offen offset:3072 sc1
  ds_read_b64_tr_b16 a[210:211], v243 offset:20480
  v_mfma_f32_16x16x32_bf16 v[168:171], a[180:183], a[224:227], v[168:171]
  ds_read_b64_tr_b16 a[212:213], v243 offset:24576
  v_mfma_f32_16x16x32_bf16 v[168:171], a[176:179], a[216:219], v[168:171]
  s_waitcnt lgkmcnt(11)
  ds_read_b64_tr_b16 a[214:215], v243 offset:28672
  v_mfma_f32_16x16x32_bf16 v[32:35], a[184:187], a[32:35], v[32:35]
  ds_read_b64_tr_b16 a[176:177], v240 offset:32768
  buffer_store_dwordx4 v[160:163], v0, s[36:39], s5 offen offset:0 sc1
  v_mfma_f32_16x16x32_bf16 v[32:35], a[188:191], a[40:43], v[32:35]
  buffer_store_dwordx4 v[164:167], v0, s[36:39], s5 offen offset:1024 sc1
  ds_read_b64_tr_b16 a[178:179], v240 offset:36864
  v_mfma_f32_16x16x32_bf16 v[36:39], a[188:191], a[44:47], v[36:39]
  ds_read_b64_tr_b16 a[180:181], v240 offset:40960
  v_mfma_f32_16x16x32_bf16 v[36:39], a[184:187], a[36:39], v[36:39]
  s_waitcnt lgkmcnt(11)
  ds_read_b64_tr_b16 a[182:183], v240 offset:45056
  v_mfma_f32_16x16x32_bf16 v[44:47], a[192:195], a[36:39], v[44:47]
Hb2_3:
  s_cbranch_execz Rb
  ds_read_b64_tr_b16 a[184:185], v241 offset:32768
  buffer_store_dwordx4 v[168:171], v0, s[36:39], s5 offen offset:2048 sc1
  v_mfma_f32_16x16x32_bf16 v[44:47], a[196:199], a[44:47], v[44:47]
  buffer_store_dwordx4 v[172:175], v0, s[36:39], s5 offen offset:3072 sc1
  ds_read_b64_tr_b16 a[186:187], v241 offset:36864
  v_mfma_f32_16x16x32_bf16 v[40:43], a[196:199], a[40:43], v[40:43]
  ds_read_b64_tr_b16 a[188:189], v241 offset:40960
  v_mfma_f32_16x16x32_bf16 v[40:43], a[192:195], a[32:35], v[40:43]
  s_waitcnt vmcnt(16) lgkmcnt(11)
  s_barrier
  ds_read_b64_tr_b16 a[190:191], v241 offset:45056
  v_mfma_f32_16x16x32_bf16 v[48:51], a[200:203], a[32:35], v[48:51]
  ds_read_b64_tr_b16 a[192:193], v242 offset:32768
  v_mfma_f32_16x16x32_bf16 v[48:51], a[204:207], a[40:43], v[48:51]
  ds_read_b64_tr_b16 a[194:195], v242 offset:36864
  v_mfma_f32_16x16x32_bf16 v[52:55], a[204:207], a[44:47], v[52:55]
  ds_read_b64_tr_b16 a[196:197], v242 offset:40960
  v_mfma_f32_16x16x32_bf16 v[52:55], a[200:203], a[36:39], v[52:55]
  s_waitcnt lgkmcnt(11)
  ds_read_b64_tr_b16 a[198:199], v242 offset:45056
  v_mfma_f32_16x16x32_bf16 v[60:63], a[208:211], a[36:39], v[60:63]
  ds_read_b64_tr_b16 a[200:201], v243 offset:32768
  v_mfma_f32_16x16x32_bf16 v[60:63], a[212:215], a[44:47], v[60:63]
  ds_read_b64_tr_b16 a[202:203], v243 offset:36864
  v_mfma_f32_16x16x32_bf16 v[56:59], a[212:215], a[40:43], v[56:59]
  ds_read_b64_tr_b16 a[204:205], v243 offset:40960
  v_mfma_f32_16x16x32_bf16 v[56:59], a[208:211], a[32:35], v[56:59]
  s_waitcnt lgkmcnt(11)
  ds_read_b64_tr_b16 a[206:207], v243 offset:45056
  v_mfma_f32_16x16x32_bf16 v[32:35], a[176:179], a[48:51], v[32:35]
  ds_read_b64_tr_b16 a[208:209], v240 offset:49152
  v_mfma_f32_16x16x32_bf16 v[32:35], a[180:183], a[56:59], v[32:35]
  ds_read_b64_tr_b16 a[210:211], v240 offset:53248
  v_mfma_f32_16x16x32_bf16 v[36:39], a[180:183], a[60:63], v[36:39]
  ds_read_b64_tr_b16 a[212:213], v240 offset:57344
  v_mfma_f32_16x16x32_bf16 v[36:39], a[176:179], a[52:55], v[36:39]
  s_waitcnt lgkmcnt(11)
  ds_read_b64_tr_b16 a[214:215], v240 offset:61440
  v_mfma_f32_16x16x32_bf16 v[44:47], a[184:187], a[52:55], v[44:47]
  ds_read_b64_tr_b16 a[176:177], v241 offset:49152
  v_mfma_f32_16x16x32_bf16 v[44:47], a[188:191], a[60:63], v[44:47]
  ds_read_b64_tr_b16 a[178:179], v241 offset:53248
  v_mfma_f32_16x16x32_bf16 v[40:43], a[188:191], a[56:59], v[40:43]
  ds_read_b64_tr_b16 a[180:181], v241 offset:57344
  v_mfma_f32_16x16x32_bf16 v[40:43], a[184:187], a[48:51], v[40:43]
  s_waitcnt vmcnt(14) lgkmcnt(11)
  s_barrier
  ds_read_b64_tr_b16 a[182:183], v241 offset:61440
  v_mfma_f32_16x16x32_bf16 v[48:51], a[192:195], a[48:51], v[48:51]
  ds_read_b64_tr_b16 a[184:185], v242 offset:49152
  v_mfma_f32_16x16x32_bf16 v[48:51], a[196:199], a[56:59], v[48:51]
  ds_read_b64_tr_b16 a[186:187], v242 offset:53248
  v_mfma_f32_16x16x32_bf16 v[52:55], a[196:199], a[60:63], v[52:55]
  ds_read_b64_tr_b16 a[188:189], v242 offset:57344
  v_mfma_f32_16x16x32_bf16 v[52:55], a[192:195], a[52:55], v[52:55]
  s_waitcnt lgkmcnt(11)
  ds_read_b64_tr_b16 a[190:191], v242 offset:61440
  v_mfma_f32_16x16x32_bf16 v[60:63], a[200:203], a[52:55], v[60:63]
  ds_read_b64_tr_b16 a[192:193], v243 offset:49152
  v_mfma_f32_16x16x32_bf16 v[60:63], a[204:207], a[60:63], v[60:63]
  ds_read_b64_tr_b16 a[194:195], v243 offset:53248
  v_mfma_f32_16x16x32_bf16 v[56:59], a[204:207], a[56:59], v[56:59]
  ds_read_b64_tr_b16 a[196:197], v243 offset:57344
  v_mfma_f32_16x16x32_bf16 v[56:59], a[200:203], a[48:51], v[56:59]
  s_waitcnt lgkmcnt(11)
  ds_read_b64_tr_b16 a[198:199], v243 offset:61440
  v_mfma_f32_16x16x32_bf16 v[32:35], a[208:211], a[64:67], v[32:35]
  ds_read_b64_tr_b16 a[200:201], v244 offset:0
  v_mfma_f32_16x16x32_bf16 v[32:35], a[212:215], a[72:75], v[32:35]
  ds_read_b64_tr_b16 a[202:203], v244 offset:4096
  v_mfma_f32_16x16x32_bf16 v[36:39], a[212:215], a[76:79], v[36:39]
  ds_read_b64_tr_b16 a[204:205], v244 offset:8192
  v_mfma_f32_16x16x32_bf16 v[36:39], a[208:211], a[68:71], v[36:39]
  s_waitcnt lgkmcnt(11)
  ds_read_b64_tr_b16 a[206:207], v244 offset:12288
  v_mfma_f32_16x16x32_bf16 v[44:47], a[176:179], a[68:71], v[44:47]
  ds_read_b64_tr_b16 a[208:209], v245 offset:0
  v_mfma_f32_16x16x32_bf16 v[44:47], a[180:183], a[76:79], v[44:47]
  ds_read_b64_tr_b16 a[210:211], v245 offset:4096
  v_mfma_f32_16x16x32_bf16 v[40:43], a[180:183], a[72:75], v[40:43]
  ds_read_b64_tr_b16 a[212:213], v245 offset:8192
  v_mfma_f32_16x16x32_bf16 v[40:43], a[176:179], a[64:67], v[40:43]
  s_waitcnt vmcnt(12) lgkmcnt(11)
  s_barrier
  ds_read_b64_tr_b16 a[214:215], v245 offset:12288
  v_mfma_f32_16x16x32_bf16 v[48:51], a[184:187], a[64:67], v[48:51]
  ds_read_b64_tr_b16 a[176:177], v246 offset:0
  v_mfma_f32_16x16x32_bf16 v[48:51], a[188:191], a[72:75], v[48:51]
  ds_read_b64_tr_b16 a[178:179], v246 offset:4096
  v_mfma_f32_16x16x32_bf16 v[52:55], a[188:191], a[76:79], v[52:55]
  ds_read_b64_tr_b16 a[180:181], v246 offset:8192
  v_mfma_f32_16x16x32_bf16 v[52:55], a[184:187], a[68:71], v[52:55]
  s_waitcnt lgkmcnt(11)
  ds_read_b64_tr_b16 a[182:183], v246 offset:12288
  v_mfma_f32_16x16x32_bf16 v[60:63], a[192:195], a[68:71], v[60:63]
  ds_read_b64_tr_b16 a[184:185], v247 offset:0
  v_mfma_f32_16x16x32_bf16 v[60:63], a[196:199], a[76:79], v[60:63]
  ds_read_b64_tr_b16 a[186:187], v247 offset:4096
  v_mfma_f32_16x16x32_bf16 v[56:59], a[196:199], a[72:75], v[56:59]
  ds_read_b64_tr_b16 a[188:189], v247 offset:8192
  v_mfma_f32_16x16x32_bf16 v[56:59], a[192:195], a[64:67], v[56:59]
  s_waitcnt lgkmcnt(11)
  ds_read_b64_tr_b16 a[190:191], v247 offset:12288
  v_mfma_f32_16x16x32_bf16 v[32:35], a[200:203], a[80:83], v[32:35]
  s_waitcnt vmcnt(0)
  ds_read_b64_tr_b16 a[192:193], v244 offset:16384
  s_mov_b64 exec, 1
  buffer_store_dword v254, v0, s[36:39], s28 offen sc1
  s_mov_b64 exec, -1
  v_mfma_f32_16x16x32_bf16 v[32:35], a[204:207], a[88:91], v[32:35]
  ds_read_b64_tr_b16 a[194:195], v244 offset:20480
  v_mfma_f32_16x16x32_bf16 v[36:39], a[204:207], a[92:95], v[36:39]
  ds_read_b64_tr_b16 a[196:197], v244 offset:24576
  v_mfma_f32_16x16x32_bf16 v[36:39], a[200:203], a[84:87], v[36:39]
  s_waitcnt lgkmcnt(11)
  ds_read_b64_tr_b16 a[198:199], v244 offset:28672
  v_mfma_f32_16x16x32_bf16 v[44:47], a[208:211], a[84:87], v[44:47]
  ds_read_b64_tr_b16 a[200:201], v245 offset:16384
  buffer_load_dword v139, v132, s[36:39], s29 offen sc1
  v_mfma_f32_16x16x32_bf16 v[44:47], a[212:215], a[92:95], v[44:47]
  ds_read_b64_tr_b16 a[202:203], v245 offset:20480
  v_mfma_f32_16x16x32_bf16 v[40:43], a[212:215], a[88:91], v[40:43]
  ds_read_b64_tr_b16 a[204:205], v245 offset:24576
  v_mfma_f32_16x16x32_bf16 v[40:43], a[208:211], a[80:83], v[40:43]
  s_waitcnt vmcnt(12) lgkmcnt(11)
  s_barrier
  ds_read_b64_tr_b16 a[206:207], v245 offset:28672
  v_mfma_f32_16x16x32_bf16 v[48:51], a[176:179], a[80:83], v[48:51]
  ds_read_b64_tr_b16 a[208:209], v246 offset:16384
  v_mfma_f32_16x16x32_bf16 v[48:51], a[180:183], a[88:91], v[48:51]
  ds_read_b64_tr_b16 a[210:211], v246 offset:20480
  v_mfma_f32_16x16x32_bf16 v[52:55], a[180:183], a[92:95], v[52:55]
  ds_read_b64_tr_b16 a[212:213], v246 offset:24576
  v_mfma_f32_16x16x32_bf16 v[52:55], a[176:179], a[84:87], v[52:55]
  s_waitcnt lgkmcnt(11)
  ds_read_b64_tr_b16 a[214:215], v246 offset:28672
  v_mfma_f32_16x16x32_bf16 v[60:63], a[184:187], a[84:87], v[60:63]
  ds_read_b64_tr_b16 a[176:177], v247 offset:16384
  v_mfma_f32_16x16x32_bf16 v[60:63], a[188:191], a[92:95], v[60:63]
  ds_read_b64_tr_b16 a[178:179], v247 offset:20480
  v_mfma_f32_16x16x32_bf16 v[56:59], a[188:191], a[88:91], v[56:59]
  ds_read_b64_tr_b16 a[180:181], v247 offset:24576
  v_mfma_f32_16x16x32_bf16 v[56:59], a[184:187], a[80:83], v[56:59]
  s_waitcnt lgkmcnt(11)
  ds_read_b64_tr_b16 a[182:183], v247 offset:28672
  v_mfma_f32_16x16x32_bf16 v[32:35], a[192:195], a[96:99], v[32:35]
  ds_read_b64_tr_b16 a[184:185], v244 offset:32768
  v_mfma_f32_16x16x32_bf16 v[32:35], a[196:199], a[104:107], v[32:35]
  ds_read_b64_tr_b16 a[186:187], v244 offset:36864
  v_mfma_f32_16x16x32_bf16 v[36:39], a[196:199], a[108:111], v[36:39]
  ds_read_b64_tr_b16 a[188:189], v244 offset:40960
  v_mfma_f32_16x16x32_bf16 v[36:39], a[192:195], a[100:103], v[36:39]
  s_waitcnt lgkmcnt(11)
  ds_read_b64_tr_b16 a[190:191], v244 offset:45056
  v_mfma_f32_16x16x32_bf16 v[44:47], a[200:203], a[100:103], v[44:47]
  ds_read_b64_tr_b16 a[192:193], v245 offset:32768
  v_mfma_f32_16x16x32_bf16 v[44:47], a[204:207], a[108:111], v[44:47]
  ds_read_b64_tr_b16 a[194:195], v245 offset:36864
  v_mfma_f32_16x16x32_bf16 v[40:43], a[204:207], a[104:107], v[40:43]
  ds_read_b64_tr_b16 a[196:197], v245 offset:40960
  v_mfma_f32_16x16x32_bf16 v[40:43], a[200:203], a[96:99], v[40:43]
  s_waitcnt vmcnt(10) lgkmcnt(11)
  s_barrier
  ds_read_b64_tr_b16 a[198:199], v245 offset:45056
  v_mfma_f32_16x16x32_bf16 v[48:51], a[208:211], a[96:99], v[48:51]
  ds_read_b64_tr_b16 a[200:201], v246 offset:32768
  v_mfma_f32_16x16x32_bf16 v[48:51], a[212:215], a[104:107], v[48:51]
  ds_read_b64_tr_b16 a[202:203], v246 offset:36864
  v_mfma_f32_16x16x32_bf16 v[52:55], a[212:215], a[108:111], v[52:55]
  ds_read_b64_tr_b16 a[204:205], v246 offset:40960
  v_mfma_f32_16x16x32_bf16 v[52:55], a[208:211], a[100:103], v[52:55]
  s_waitcnt lgkmcnt(11)
  ds_read_b64_tr_b16 a[206:207], v246 offset:45056
  v_mfma_f32_16x16x32_bf16 v[60:63], a[176:179], a[100:103], v[60:63]
  ds_read_b64_tr_b16 a[208:209], v247 offset:32768
  v_mfma_f32_16x16x32_bf16 v[60:63], a[180:183], a[108:111], v[60:63]
  ds_read_b64_tr_b16 a[210:211], v247 offset:36864
  v_mfma_f32_16x16x32_bf16 v[56:59], a[180:183], a[104:107], v[56:59]
  s_waitcnt vmcnt(0)
  ds_read_b64_tr_b16 a[212:213], v247 offset:40960
  v_readfirstlane_b32 s30, v139
  v_mfma_f32_16x16x32_bf16 v[56:59], a[176:179], a[96:99], v[56:59]
  s_waitcnt lgkmcnt(11)
  ds_read_b64_tr_b16 a[214:215], v247 offset:45056
  s_nop 0
  v_mfma_f32_16x16x32_bf16 v[32:35], a[184:187], a[112:115], v[32:35]
  s_cmp_eq_u32 s30, 1
  ds_read_b64_tr_b16 a[176:177], v244 offset:49152
  s_cselect_b32 s57, s6, 1073741824
  v_mfma_f32_16x16x32_bf16 v[32:35], a[188:191], a[120:123], v[32:35]
  s_cselect_b32 s58, s7, 1073741824
  ds_read_b64_tr_b16 a[178:179], v244 offset:53248
  buffer_load_dwordx4 v[96:99], v0, s[36:39], s57 offen offset:0 sc1
  v_mfma_f32_16x16x32_bf16 v[36:39], a[188:191], a[124:127], v[36:39]
  ds_read_b64_tr_b16 a[180:181], v244 offset:57344
  v_mfma_f32_16x16x32_bf16 v[36:39], a[184:187], a[116:119], v[36:39]
  s_waitcnt lgkmcnt(11)
  ds_read_b64_tr_b16 a[182:183], v244 offset:61440
  v_mfma_f32_16x16x32_bf16 v[44:47], a[192:195], a[116:119], v[44:47]
  ds_read_b64_tr_b16 a[184:185], v245 offset:49152
  buffer_load_dwordx4 v[100:103], v0, s[36:39], s57 offen offset:1024 sc1
  v_mfma_f32_16x16x32_bf16 v[44:47], a[196:199], a[124:127], v[44:47]
  ds_read_b64_tr_b16 a[186:187], v245 offset:53248
  v_mfma_f32_16x16x32_bf16 v[40:43], a[196:199], a[120:123], v[40:43]
  ds_read_b64_tr_b16 a[188:189], v245 offset:57344
  v_mfma_f32_16x16x32_bf16 v[40:43], a[192:195], a[112:115], v[40:43]
  s_waitcnt lgkmcnt(11)
  buffer_load_dwordx4 v[104:107], v0, s[36:39], s57 offen offset:2048 sc1
  ds_read_b64_tr_b16 a[190:191], v245 offset:61440
  v_mfma_f32_16x16x32_bf16 v[48:51], a[200:203], a[112:115], v[48:51]
  ds_read_b64_tr_b16 a[192:193], v246 offset:49152
  v_mfma_f32_16x16x32_bf16 v[48:51], a[204:207], a[120:123], v[48:51]
  buffer_load_dwordx4 v[108:111], v0, s[36:39], s57 offen offset:3072 sc1
  ds_read_b64_tr_b16 a[194:195], v246 offset:53248
  v_mfma_f32_16x16x32_bf16 v[52:55], a[204:207], a[124:127], v[52:55]
  ds_read_b64_tr_b16 a[196:197], v246 offset:57344
  v_mfma_f32_16x16x32_bf16 v[52:55], a[200:203], a[116:119], v[52:55]
  s_waitcnt lgkmcnt(11)
  buffer_load_dwordx4 v[112:115], v0, s[36:39], s58 offen offset:0 sc1
  ds_read_b64_tr_b16 a[198:199], v246 offset:61440
  v_mfma_f32_16x16x32_bf16 v[60:63], a[208:211], a[116:119], v[60:63]
  ds_read_b64_tr_b16 a[200:201], v247 offset:49152
  v_mfma_f32_16x16x32_bf16 v[60:63], a[212:215], a[124:127], v[60:63]
  buffer_load_dwordx4 v[116:119], v0, s[36:39], s58 offen offset:1024 sc1
  ds_read_b64_tr_b16 a[202:203], v247 offset:53248
  v_mfma_f32_16x16x32_bf16 v[56:59], a[212:215], a[120:123], v[56:59]
  ds_read_b64_tr_b16 a[204:205], v247 offset:57344
  v_mfma_f32_16x16x32_bf16 v[56:59], a[208:211], a[112:115], v[56:59]
  s_waitcnt lgkmcnt(11)
  buffer_load_dwordx4 v[120:123], v0, s[36:39], s58 offen offset:2048 sc1
  ds_read_b64_tr_b16 a[206:207], v247 offset:61440
  v_mfma_f32_16x16x32_bf16 v[32:35], a[176:179], a[216:219], v[32:35]
  v_mfma_f32_16x16x32_bf16 v[32:35], a[180:183], a[224:227], v[32:35]
  buffer_load_dwordx4 v[124:127], v0, s[36:39], s58 offen offset:3072 sc1
  v_mfma_f32_16x16x32_bf16 v[36:39], a[180:183], a[228:231], v[36:39]
  v_mfma_f32_16x16x32_bf16 v[36:39], a[176:179], a[220:223], v[36:39]
  s_waitcnt lgkmcnt(8)
  v_mfma_f32_16x16x32_bf16 v[44:47], a[184:187], a[220:223], v[44:47]
  v_mfma_f32_16x16x32_bf16 v[44:47], a[188:191], a[228:231], v[44:47]
  v_mfma_f32_16x16x32_bf16 v[40:43], a[188:191], a[224:227], v[40:43]
  v_mfma_f32_16x16x32_bf16 v[40:43], a[184:187], a[216:219], v[40:43]
  s_waitcnt lgkmcnt(4)
  v_mfma_f32_16x16x32_bf16 v[48:51], a[192:195], a[216:219], v[48:51]
  v_mfma_f32_16x16x32_bf16 v[48:51], a[196:199], a[224:227], v[48:51]
  v_mfma_f32_16x16x32_bf16 v[52:55], a[196:199], a[228:231], v[52:55]
  v_mfma_f32_16x16x32_bf16 v[52:55], a[192:195], a[220:223], v[52:55]
  s_waitcnt lgkmcnt(0)
  v_mfma_f32_16x16x32_bf16 v[60:63], a[200:203], a[220:223], v[60:63]
  v_mfma_f32_16x16x32_bf16 v[60:63], a[204:207], a[228:231], v[60:63]
  v_mfma_f32_16x16x32_bf16 v[56:59], a[204:207], a[224:227], v[56:59]
  v_mfma_f32_16x16x32_bf16 v[56:59], a[200:203], a[216:219], v[56:59]
  s_cmp_eq_u32 s30, 1
  s_cbranch_scc0 CKXs
CKXx:
  v_pk_fma_f32 v[64:65], v[176:177], v[32:33], v[64:65]
  v_pk_fma_f32 v[66:67], v[178:179], v[34:35], v[66:67]
  v_pk_fma_f32 v[80:81], v[176:177], v[36:37], v[80:81]
  v_pk_fma_f32 v[82:83], v[178:179], v[38:39], v[82:83]
  v_pk_fma_f32 v[68:69], v[180:181], v[40:41], v[68:69]
  v_pk_fma_f32 v[70:71], v[182:183], v[42:43], v[70:71]
  v_pk_fma_f32 v[84:85], v[180:181], v[44:45], v[84:85]
  v_pk_fma_f32 v[86:87], v[182:183], v[46:47], v[86:87]
  v_pk_fma_f32 v[72:73], v[184:185], v[48:49], v[72:73]
  v_pk_fma_f32 v[74:75], v[186:187], v[50:51], v[74:75]
  v_pk_fma_f32 v[88:89], v[184:185], v[52:53], v[88:89]
  v_pk_fma_f32 v[90:91], v[186:187], v[54:55], v[90:91]
  v_pk_fma_f32 v[76:77], v[188:189], v[56:57], v[76:77]
  v_pk_fma_f32 v[78:79], v[190:191], v[58:59], v[78:79]
  v_pk_fma_f32 v[92:93], v[188:189], v[60:61], v[92:93]
  v_pk_fma_f32 v[94:95], v[190:191], v[62:63], v[94:95]
  s_waitcnt vmcnt(7)
  v_pk_fma_f32 v[64:65], v[176:177], v[96:97], v[64:65]
  v_pk_fma_f32 v[66:67], v[178:179], v[98:99], v[66:67]
  v_cvt_pk_bf16_f32 v192, v64, v65
  v_cvt_pk_bf16_f32 v193, v66, v67
  ds_write_b64 v140, v[192:193] offset:0
  s_waitcnt vmcnt(6)
  v_pk_fma_f32 v[80:81], v[176:177], v[100:101], v[80:81]
  v_pk_fma_f32 v[82:83], v[178:179], v[102:103], v[82:83]
  v_cvt_pk_bf16_f32 v200, v80, v81
  v_cvt_pk_bf16_f32 v201, v82, v83
  ds_write_b64 v140, v[200:201] offset:2048
  s_waitcnt vmcnt(5)
  v_pk_fma_f32 v[68:69], v[180:181], v[104:105], v[68:69]
  v_pk_fma_f32 v[70:71], v[182:183], v[106:107], v[70:71]
  v_cvt_pk_bf16_f32 v194, v68, v69
  v_cvt_pk_bf16_f32 v195, v70, v71
  ds_write_b64 v141, v[194:195] offset:0
  s_waitcnt vmcnt(4)
  v_pk_fma_f32 v[84:85], v[180:181], v[108:109], v[84:85]
  v_pk_fma_f32 v[86:87], v[182:183], v[110:111], v[86:87]
  v_cvt_pk_bf16_f32 v202, v84, v85
  v_cvt_pk_bf16_f32 v203, v86, v87
  ds_write_b64 v141, v[202:203] offset:2048
  s_waitcnt vmcnt(3)
  v_pk_fma_f32 v[72:73], v[184:185], v[112:113], v[72:73]
  v_pk_fma_f32 v[74:75], v[186:187], v[114:115], v[74:75]
  v_cvt_pk_bf16_f32 v196, v72, v73
  v_cvt_pk_bf16_f32 v197, v74, v75
  ds_write_b64 v142, v[196:197] offset:0
  s_waitcnt vmcnt(2)
  v_pk_fma_f32 v[88:89], v[184:185], v[116:117], v[88:89]
  v_pk_fma_f32 v[90:91], v[186:187], v[118:119], v[90:91]
  v_cvt_pk_bf16_f32 v204, v88, v89
  v_cvt_pk_bf16_f32 v205, v90, v91
  ds_write_b64 v142, v[204:205] offset:2048
  s_waitcnt vmcnt(1)
  v_pk_fma_f32 v[76:77], v[188:189], v[120:121], v[76:77]
  v_pk_fma_f32 v[78:79], v[190:191], v[122:123], v[78:79]
  v_cvt_pk_bf16_f32 v198, v76, v77
  v_cvt_pk_bf16_f32 v199, v78, v79
  ds_write_b64 v143, v[198:199] offset:0
  s_waitcnt vmcnt(0)
  v_pk_fma_f32 v[92:93], v[188:189], v[124:125], v[92:93]
  v_pk_fma_f32 v[94:95], v[190:191], v[126:127], v[94:95]
  v_cvt_pk_bf16_f32 v206, v92, v93
  v_cvt_pk_bf16_f32 v207, v94, v95
  ds_write_b64 v143, v[206:207] offset:2048
  ds_read_b128 v[64:67], v255 offset:0
  ds_read_b128 v[68:71], v255 offset:1024
  ds_read_b128 v[72:75], v255 offset:2048
  ds_read_b128 v[76:79], v255 offset:3072
  s_waitcnt lgkmcnt(3)
  buffer_store_dwordx4 v[64:67], v252, s[32:35], s72 offen
  s_waitcnt lgkmcnt(2)
  buffer_store_dwordx4 v[68:71], v253, s[32:35], s72 offen
  s_waitcnt lgkmcnt(1)
  buffer_store_dwordx4 v[72:75], v252, s[32:35], s49 offen
  s_waitcnt lgkmcnt(0)
  buffer_store_dwordx4 v[76:79], v253, s[32:35], s49 offen
X_k3_main_kernel:
  s_endpgm
CK3s:
  s_mov_b32 s46, 30000
CK3:
  s_mov_b32 s49, 0
  buffer_load_dwordx4 v[156:159], v248, s[36:39], s49 offen sc1
  s_mov_b32 s49, 24576
  buffer_load_dwordx4 v[160:163], v248, s[36:39], s49 offen sc1
  s_mov_b32 s49, 49152
  buffer_load_dwordx4 v[164:167], v248, s[36:39], s49 offen sc1
  s_mov_b32 s49, 73728
  buffer_load_dwordx4 v[168:171], v248, s[36:39], s49 offen sc1
  s_sub_u32 s46, s46, 1
  s_waitcnt vmcnt(0)
  v_max_u32 v15, v156, v157
  v_max3_u32 v15, v15, v158, v159
  v_max3_u32 v15, v15, v160, v161
  v_max3_u32 v15, v15, v162, v163
  v_max3_u32 v15, v15, v164, v165
  v_max3_u32 v15, v15, v166, v167
  v_max3_u32 v15, v15, v168, v169
  v_max3_u32 v15, v15, v170, v171
  s_cmp_eq_u32 s46, 0
  s_cbranch_scc1 CK3x
  v_cmp_eq_u32 vcc, -1, v15
  s_nop 4
  s_cbranch_vccnz CK3
  s_branch CK3x
CK5s:
  s_mov_b32 s46, 30000
CK5:
  buffer_load_dwordx4 a[208:211], v25, s[36:39], s29 offen offset:0 sc1
  buffer_load_dwordx4 a[212:215], v25, s[36:39], s29 offen offset:2048 sc1
  buffer_load_dwordx4 a[216:219], v25, s[36:39], s28 offen offset:0 sc1
  buffer_load_dwordx4 a[220:223], v25, s[36:39], s28 offen offset:2048 sc1
  s_sub_u32 s46, s46, 1
  s_waitcnt vmcnt(0)
  v_accvgpr_read_b32 v26, a208
  v_accvgpr_read_b32 v27, a209
  v_accvgpr_read_b32 v28, a210
  v_accvgpr_read_b32 v29, a211
  v_max_u32 v31, v26, v27
  v_max3_u32 v31, v31, v28, v29
  v_accvgpr_read_b32 v22, a212
  v_accvgpr_read_b32 v23, a213
  v_max3_u32 v31, v31, v22, v23
  v_add_f32 v26, v26, v22
  v_add_f32 v27, v27, v23
  v_accvgpr_read_b32 v22, a214
  v_accvgpr_read_b32 v23, a215
  v_max3_u32 v31, v31, v22, v23
  v_add_f32 v28, v28, v22
  v_add_f32 v29, v29, v23
  v_accvgpr_read_b32 v22, a216
  v_accvgpr_read_b32 v23, a217
  v_max3_u32 v31, v31, v22, v23
  v_add_f32 v26, v26, v22
  v_add_f32 v27, v27, v23
  v_accvgpr_read_b32 v22, a218
  v_accvgpr_read_b32 v23, a219
  v_max3_u32 v31, v31, v22, v23
  v_add_f32 v28, v28, v22
  v_add_f32 v29, v29, v23
  v_accvgpr_read_b32 v22, a220
  v_accvgpr_read_b32 v23, a221
  v_max3_u32 v31, v31, v22, v23
  v_add_f32 v26, v26, v22
  v_add_f32 v27, v27, v23
  v_accvgpr_read_b32 v22, a222
  v_accvgpr_read_b32 v23, a223
  v_max3_u32 v31, v31, v22, v23
  v_add_f32 v28, v28, v22
  v_add_f32 v29, v29, v23
  s_cmp_eq_u32 s46, 0
  s_cbranch_scc1 CK5x
  v_cmp_eq_u32 vcc, -1, v31
  s_nop 4
  s_cbranch_vccnz CK5
  s_branch CK5x
CK6s:
  s_mov_b32 s46, 60000
CK6:
  buffer_load_dword v139, v138, s[36:39], s60 offen sc1
  s_sub_u32 s46, s46, 1
  s_cmp_eq_u32 s46, 0
  s_waitcnt vmcnt(0)
  s_cbranch_scc1 CK6x
  v_cmp_ne_u32 vcc, 1, v139
  s_nop 4
  s_cbranch_vccnz CK6
  s_branch CK6x
CK7s:
  s_mov_b32 s46, 60000
CK7:
  buffer_load_dword v139, v138, s[36:39], s60 offen sc1
  s_sub_u32 s46, s46, 1
  s_cmp_eq_u32 s46, 0
  s_waitcnt vmcnt(0)
  s_cbranch_scc1 CK7x
  v_cmp_ne_u32 vcc, 1, v139
  s_nop 4
  s_cbranch_vccnz CK7
  s_branch CK7x
CKXs:
  s_mov_b32 s46, 60000
CKX:
  buffer_load_dword v139, v132, s[36:39], s29 offen sc1
  s_sub_u32 s46, s46, 1
  s_cmp_eq_u32 s46, 0
  s_waitcnt vmcnt(0)
  s_cbranch_scc1 CKXy
  v_cmp_ne_u32 vcc, 1, v139
  s_nop 4
  s_cbranch_vccnz CKX
CKXy:
  buffer_load_dwordx4 v[96:99], v0, s[36:39], s6 offen offset:0 sc1
  buffer_load_dwordx4 v[100:103], v0, s[36:39], s6 offen offset:1024 sc1
  buffer_load_dwordx4 v[104:107], v0, s[36:39], s6 offen offset:2048 sc1
  buffer_load_dwordx4 v[108:111], v0, s[36:39], s6 offen offset:3072 sc1
  buffer_load_dwordx4 v[112:115], v0, s[36:39], s7 offen offset:0 sc1
  buffer_load_dwordx4 v[116:119], v0, s[36:39], s7 offen offset:1024 sc1
  buffer_load_dwordx4 v[120:123], v0, s[36:39], s7 offen offset:2048 sc1
  buffer_load_dwordx4 v[124:127], v0, s[36:39], s7 offen offset:3072 sc1
  s_branch CKXx
code_end:
.fill 2048, 4, 0xBF800000
.section .rodata,"a"
.p2align 6
.amdhsa_kernel k1_mod_kernel
  .amdhsa_next_free_vgpr 77
  .amdhsa_next_free_sgpr 48
  .amdhsa_accum_offset 80
  .amdhsa_group_segment_fixed_size 0
  .amdhsa_kernarg_size 96
  .amdhsa_user_sgpr_count 2
  .amdhsa_user_sgpr_kernarg_segment_ptr 1
  .amdhsa_system_sgpr_workgroup_id_x 1
  .amdhsa_float_denorm_mode_32 3
.end_amdhsa_kernel
.p2align 6
.amdhsa_kernel k3_main_kernel
  .amdhsa_next_free_vgpr 512
  .amdhsa_next_free_sgpr 102
  .amdhsa_accum_offset 256
  .amdhsa_group_segment_fixed_size 0
  .amdhsa_kernarg_size 96
  .amdhsa_user_sgpr_count 2
  .amdhsa_user_sgpr_kernarg_segment_ptr 1
  .amdhsa_system_sgpr_workgroup_id_x 1
  .amdhsa_float_denorm_mode_32 3
.end_amdhsa_kernel
```

```asm
; @launch kernel=k1_mod_kernel grid=(256,1,1) block=(256,1,1) lds=1024
; @launch kernel=k3_main_kernel grid=(256,1,1) block=(256,1,1) lds=163840
.amdgcn_target "amdgcn-amd-amdhsa--gfx950"
.text
.globl k1_mod_kernel
.type k1_mod_kernel,@function
.p2align 8
k1_mod_kernel:
  s_cmp_ge_u32 s2, 256
  s_cbranch_scc1 X_k1_mod_kernel
  s_load_dwordx2 s[4:5], s[0:1], 64
  s_load_dwordx2 s[8:9], s[0:1], 56
  s_load_dwordx2 s[12:13], s[0:1], 88
  s_load_dwordx2 s[16:17], s[0:1], 0
  s_load_dwordx2 s[20:21], s[0:1], 8
  s_load_dwordx2 s[24:25], s[0:1], 88
  s_load_dwordx2 s[32:33], s[0:1], 88
  v_lshrrev_b32 v11, 6, v0
  v_and_b32 v10, 63, v0
  v_readfirstlane_b32 s36, v11
  s_mov_b32 s37, s2
  s_mov_b32 s6, 12582912
  s_mov_b32 s7, 0x20000
  s_mov_b32 s10, 2048
  s_mov_b32 s11, 0x20000
  s_mov_b32 s14, 98304
  s_mov_b32 s15, 0x20000
  s_mov_b32 s18, 4194304
  s_mov_b32 s19, 0x20000
  s_mov_b32 s22, 6291456
  s_mov_b32 s23, 0x20000
  s_mov_b32 s26, 262144
  s_mov_b32 s27, 0x20000
  s_mov_b32 s34, 1048576
  s_mov_b32 s35, 0x20000
  s_waitcnt lgkmcnt(0)
  s_add_u32 s24, s24, 5242880
  s_addc_u32 s25, s25, 0
  s_cmp_lg_u32 s36, 2
  s_cbranch_scc1 F_zk1_mod_kernel
  s_lshl_b32 s28, s2, 7
  s_lshr_b32 s29, s2, 2
  s_lshl_b32 s29, s29, 7
  v_lshrrev_b32 v8, 3, v10
  v_mov_b32 v4, s28
  v_mov_b32 v5, s29
  v_cmp_eq_u32 vcc, 2, v8
  v_and_b32 v9, 7, v10
  v_lshlrev_b32 v8, 15, v8
  v_cndmask_b32 v4, v4, v5, vcc
  v_lshl_add_u32 v8, v9, 4, v8
  v_add_u32 v8, v8, v4
  v_mov_b32 v4, 0
  v_mov_b32 v5, 0
  v_mov_b32 v6, 0
  v_mov_b32 v7, 0
  buffer_store_dwordx4 v[4:7], v8, s[24:27], 0 offen
  s_nop 1
F_zk1_mod_kernel:
  s_cmp_lg_u32 s36, 1
  s_cbranch_scc1 F_sent
  v_mov_b32 v4, -1
  v_mov_b32 v5, -1
  v_mov_b32 v6, -1
  v_mov_b32 v7, -1
  v_lshlrev_b32 v8, 4, v10
  v_lshlrev_b32 v9, 2, v10
  s_lshl_b32 s28, s2, 11
  s_add_u32 s28, s28, 524288
  buffer_store_dwordx4 v[4:7], v8, s[32:35], s28 offen
  buffer_store_dwordx4 v[4:7], v8, s[32:35], s28 offen offset:1024
  s_and_b32 s28, s2, 3
  s_mul_i32 s28, s28, 24576
  s_lshr_b32 s29, s2, 2
  s_lshl_b32 s29, s29, 8
  s_add_u32 s28, s28, s29
  s_add_u32 s28, s28, 8192
  buffer_store_dword v4, v9, s[32:35], s28 offen
  s_nop 1
F_sent:
  s_cmp_ge_u32 s2, 128
  s_cbranch_scc1 T_k1_mod_kernel
  s_lshr_b32 s40, s37, 2
  s_add_u32 s40, s40, 0
  s_and_b32 s41, s37, 3
  s_lshl_b32 s38, s41, 8
  s_lshl_b32 s39, s36, 6
  s_add_u32 s38, s38, s39
  v_and_b32 v12, 0x38, v10
  v_add_u32 v12, s38, v12
  v_lshlrev_b32 v13, 1, v12
  v_mul_u32_u24 v16, 12288, v12
  v_and_b32 v14, 7, v10
  v_lshl_add_u32 v16, v14, 4, v16
  s_lshl_b32 s39, s40, 7
  buffer_load_dwordx4 v[20:23], v13, s[8:11], 0 offen
  buffer_load_dwordx4 v[32:35], v16, s[4:7], s39 offen nt
  s_add_u32 s39, s39, 12288
  buffer_load_dwordx4 v[36:39], v16, s[4:7], s39 offen nt
  s_add_u32 s39, s39, 12288
  buffer_load_dwordx4 v[40:43], v16, s[4:7], s39 offen nt
  s_add_u32 s39, s39, 12288
  buffer_load_dwordx4 v[44:47], v16, s[4:7], s39 offen nt
  s_add_u32 s39, s39, 12288
  buffer_load_dwordx4 v[48:51], v16, s[4:7], s39 offen nt
  s_add_u32 s39, s39, 12288
  buffer_load_dwordx4 v[52:55], v16, s[4:7], s39 offen nt
  s_add_u32 s39, s39, 12288
  buffer_load_dwordx4 v[56:59], v16, s[4:7], s39 offen nt
  s_add_u32 s39, s39, 12288
  buffer_load_dwordx4 v[60:63], v16, s[4:7], s39 offen nt
  s_lshr_b32 s44, s37, 3
  s_lshl_b32 s44, s44, 13
  s_cmp_lg_u32 s36, 3
  s_cbranch_scc1 TC1_k1_mod_kernel
  s_cmp_ge_u32 s44, code_end-k3_main_kernel
  s_cbranch_scc1 TC1_k1_mod_kernel
  s_getpc_b64 s[42:43]
TC1_k1_mod_kernelp:
  s_add_u32 s44, s44, k3_main_kernel-TC1_k1_mod_kernelp
  s_ashr_i32 vcc_hi, s44, 31
  s_add_u32 s42, s42, s44
  s_addc_u32 s43, s43, vcc_hi
  v_lshlrev_b32 v74, 7, v10
  v_mov_b32 v75, s43
  v_add_co_u32 v74, vcc, s42, v74
  s_nop 1
  v_addc_co_u32 v75, vcc, 0, v75, vcc
  global_load_dword v76, v[74:75], off
TC1_k1_mod_kernel:
  v_lshlrev_b32 v74, 7, v10
  s_lshl_b32 s42, s37, 1
  s_add_u32 s42, s42, s36
  s_lshl_b32 s42, s42, 13
  s_cmp_lt_u32 s36, 2
  s_cselect_b32 s42, s42, 0x40000000
  buffer_load_dword v76, v74, s[16:19], s42 offen
  v_lshlrev_b32 v74, 7, v10
  s_mul_i32 s42, s36, 256
  s_add_u32 s42, s42, s37
  s_lshl_b32 s42, s42, 13
  s_add_u32 s43, s42, 0
  s_cmp_lt_u32 s43, 2095104
  s_cselect_b32 s43, s43, 0x40000000
  buffer_load_dword v76, v74, s[20:23], s43 offen
  s_waitcnt vmcnt(10)
  v_lshlrev_b32 v24, 16, v20
  v_and_b32 v25, 0xffff0000, v20
  v_lshlrev_b32 v26, 16, v21
  v_and_b32 v27, 0xffff0000, v21
  v_lshlrev_b32 v28, 16, v22
  v_and_b32 v29, 0xffff0000, v22
  v_lshlrev_b32 v30, 16, v23
  v_and_b32 v31, 0xffff0000, v23
  v_mul_f32 v64, 0xbfb8aa3b, v24
  v_mul_f32 v65, 0xbfb8aa3b, v25
  v_mul_f32 v66, 0xbfb8aa3b, v26
  v_mul_f32 v67, 0xbfb8aa3b, v27
  v_mul_f32 v68, 0xbfb8aa3b, v28
  v_mul_f32 v69, 0xbfb8aa3b, v29
  v_mul_f32 v70, 0xbfb8aa3b, v30
  v_mul_f32 v71, 0xbfb8aa3b, v31
  v_exp_f32 v64, v64
  v_exp_f32 v65, v65
  v_exp_f32 v66, v66
  v_exp_f32 v67, v67
  v_exp_f32 v68, v68
  v_exp_f32 v69, v69
  v_exp_f32 v70, v70
  v_exp_f32 v71, v71
  v_add_f32 v64, 1.0, v64
  v_add_f32 v65, 1.0, v65
  v_add_f32 v66, 1.0, v66
  v_add_f32 v67, 1.0, v67
  v_add_f32 v68, 1.0, v68
  v_add_f32 v69, 1.0, v69
  v_add_f32 v70, 1.0, v70
  v_add_f32 v71, 1.0, v71
  v_rcp_f32 v64, v64
  v_rcp_f32 v65, v65
  v_rcp_f32 v66, v66
  v_rcp_f32 v67, v67
  v_rcp_f32 v68, v68
  v_rcp_f32 v69, v69
  v_rcp_f32 v70, v70
  v_rcp_f32 v71, v71
  v_mul_f32 v24, v24, v64
  v_mul_f32 v25, v25, v65
  v_mul_f32 v26, v26, v66
  v_mul_f32 v27, v27, v67
  v_mul_f32 v28, v28, v68
  v_mul_f32 v29, v29, v69
  v_mul_f32 v30, v30, v70
  v_mul_f32 v31, v31, v71
  v_cvt_pk_bf16_f32 v72, v24, v25
  v_lshlrev_b32 v24, 16, v72
  v_and_b32 v25, 0xffff0000, v72
  v_cvt_pk_bf16_f32 v72, v26, v27
  v_lshlrev_b32 v26, 16, v72
  v_and_b32 v27, 0xffff0000, v72
  v_cvt_pk_bf16_f32 v72, v28, v29
  v_lshlrev_b32 v28, 16, v72
  v_and_b32 v29, 0xffff0000, v72
  v_cvt_pk_bf16_f32 v72, v30, v31
  v_lshlrev_b32 v30, 16, v72
  v_and_b32 v31, 0xffff0000, v72
  v_and_b32 v12, 7, v10
  v_lshlrev_b32 v12, 5, v12
  v_lshrrev_b32 v13, 4, v10
  v_lshl_add_u32 v12, v13, 3, v12
  s_lshl_b32 s38, s36, 8
  v_add_u32 v12, s38, v12
  v_lshlrev_b32 v13, 2, v10
  s_mul_i32 s38, s41, 24576
  s_lshl_b32 s39, s40, 8
  s_add_u32 s38, s38, s39
  s_waitcnt vmcnt(9)
  v_lshlrev_b32 v72, 16, v32
  v_and_b32 v73, 0xffff0000, v32
  v_mul_f32 v64, v24, v72
  v_mul_f32 v65, v24, v73
  v_lshlrev_b32 v72, 16, v33
  v_and_b32 v73, 0xffff0000, v33
  v_mul_f32 v66, v24, v72
  v_mul_f32 v67, v24, v73
  v_lshlrev_b32 v72, 16, v34
  v_and_b32 v73, 0xffff0000, v34
  v_mul_f32 v68, v24, v72
  v_mul_f32 v69, v24, v73
  v_lshlrev_b32 v72, 16, v35
  v_and_b32 v73, 0xffff0000, v35
  v_mul_f32 v70, v24, v72
  v_mul_f32 v71, v24, v73
  s_waitcnt vmcnt(8)
  v_lshlrev_b32 v72, 16, v36
  v_and_b32 v73, 0xffff0000, v36
  v_fmac_f32 v64, v25, v72
  v_fmac_f32 v65, v25, v73
  v_lshlrev_b32 v72, 16, v37
  v_and_b32 v73, 0xffff0000, v37
  v_fmac_f32 v66, v25, v72
  v_fmac_f32 v67, v25, v73
  v_lshlrev_b32 v72, 16, v38
  v_and_b32 v73, 0xffff0000, v38
  v_fmac_f32 v68, v25, v72
  v_fmac_f32 v69, v25, v73
  v_lshlrev_b32 v72, 16, v39
  v_and_b32 v73, 0xffff0000, v39
  v_fmac_f32 v70, v25, v72
  v_fmac_f32 v71, v25, v73
  s_waitcnt vmcnt(7)
  v_lshlrev_b32 v72, 16, v40
  v_and_b32 v73, 0xffff0000, v40
  v_fmac_f32 v64, v26, v72
  v_fmac_f32 v65, v26, v73
  v_lshlrev_b32 v72, 16, v41
  v_and_b32 v73, 0xffff0000, v41
  v_fmac_f32 v66, v26, v72
  v_fmac_f32 v67, v26, v73
  v_lshlrev_b32 v72, 16, v42
  v_and_b32 v73, 0xffff0000, v42
  v_fmac_f32 v68, v26, v72
  v_fmac_f32 v69, v26, v73
  v_lshlrev_b32 v72, 16, v43
  v_and_b32 v73, 0xffff0000, v43
  v_fmac_f32 v70, v26, v72
  v_fmac_f32 v71, v26, v73
  s_waitcnt vmcnt(6)
  v_lshlrev_b32 v72, 16, v44
  v_and_b32 v73, 0xffff0000, v44
  v_fmac_f32 v64, v27, v72
  v_fmac_f32 v65, v27, v73
  v_lshlrev_b32 v72, 16, v45
  v_and_b32 v73, 0xffff0000, v45
  v_fmac_f32 v66, v27, v72
  v_fmac_f32 v67, v27, v73
  v_lshlrev_b32 v72, 16, v46
  v_and_b32 v73, 0xffff0000, v46
  v_fmac_f32 v68, v27, v72
  v_fmac_f32 v69, v27, v73
  v_lshlrev_b32 v72, 16, v47
  v_and_b32 v73, 0xffff0000, v47
  v_fmac_f32 v70, v27, v72
  v_fmac_f32 v71, v27, v73
  s_waitcnt vmcnt(5)
  v_lshlrev_b32 v72, 16, v48
  v_and_b32 v73, 0xffff0000, v48
  v_fmac_f32 v64, v28, v72
  v_fmac_f32 v65, v28, v73
  v_lshlrev_b32 v72, 16, v49
  v_and_b32 v73, 0xffff0000, v49
  v_fmac_f32 v66, v28, v72
  v_fmac_f32 v67, v28, v73
  v_lshlrev_b32 v72, 16, v50
  v_and_b32 v73, 0xffff0000, v50
  v_fmac_f32 v68, v28, v72
  v_fmac_f32 v69, v28, v73
  v_lshlrev_b32 v72, 16, v51
  v_and_b32 v73, 0xffff0000, v51
  v_fmac_f32 v70, v28, v72
  v_fmac_f32 v71, v28, v73
  s_waitcnt vmcnt(4)
  v_lshlrev_b32 v72, 16, v52
  v_and_b32 v73, 0xffff0000, v52
  v_fmac_f32 v64, v29, v72
  v_fmac_f32 v65, v29, v73
  v_lshlrev_b32 v72, 16, v53
  v_and_b32 v73, 0xffff0000, v53
  v_fmac_f32 v66, v29, v72
  v_fmac_f32 v67, v29, v73
  v_lshlrev_b32 v72, 16, v54
  v_and_b32 v73, 0xffff0000, v54
  v_fmac_f32 v68, v29, v72
  v_fmac_f32 v69, v29, v73
  v_lshlrev_b32 v72, 16, v55
  v_and_b32 v73, 0xffff0000, v55
  v_fmac_f32 v70, v29, v72
  v_fmac_f32 v71, v29, v73
  s_waitcnt vmcnt(3)
  v_lshlrev_b32 v72, 16, v56
  v_and_b32 v73, 0xffff0000, v56
  v_fmac_f32 v64, v30, v72
  v_fmac_f32 v65, v30, v73
  v_lshlrev_b32 v72, 16, v57
  v_and_b32 v73, 0xffff0000, v57
  v_fmac_f32 v66, v30, v72
  v_fmac_f32 v67, v30, v73
  v_lshlrev_b32 v72, 16, v58
  v_and_b32 v73, 0xffff0000, v58
  v_fmac_f32 v68, v30, v72
  v_fmac_f32 v69, v30, v73
  v_lshlrev_b32 v72, 16, v59
  v_and_b32 v73, 0xffff0000, v59
  v_fmac_f32 v70, v30, v72
  v_fmac_f32 v71, v30, v73
  s_waitcnt vmcnt(2)
  v_lshlrev_b32 v72, 16, v60
  v_and_b32 v73, 0xffff0000, v60
  v_fmac_f32 v64, v31, v72
  v_fmac_f32 v65, v31, v73
  v_lshlrev_b32 v72, 16, v61
  v_and_b32 v73, 0xffff0000, v61
  v_fmac_f32 v66, v31, v72
  v_fmac_f32 v67, v31, v73
  v_lshlrev_b32 v72, 16, v62
  v_and_b32 v73, 0xffff0000, v62
  v_fmac_f32 v68, v31, v72
  v_fmac_f32 v69, v31, v73
  v_lshlrev_b32 v72, 16, v63
  v_and_b32 v73, 0xffff0000, v63
  v_fmac_f32 v70, v31, v72
  v_fmac_f32 v71, v31, v73
  s_nop 1
  v_permlane32_swap_b32 v64, v68
  v_permlane32_swap_b32 v65, v69
  v_permlane32_swap_b32 v66, v70
  v_permlane32_swap_b32 v67, v71
  s_nop 0
  v_add_f32 v64, v64, v68
  v_add_f32 v65, v65, v69
  v_add_f32 v66, v66, v70
  v_add_f32 v67, v67, v71
  s_nop 1
  v_permlane16_swap_b32 v64, v66
  v_permlane16_swap_b32 v65, v67
  s_nop 0
  v_add_f32 v64, v64, v66
  v_add_f32 v65, v65, v67
  s_nop 1
  v_add_f32_dpp v64, v64, v64 row_ror:8 row_mask:0xf bank_mask:0xf
  v_add_f32_dpp v65, v65, v65 row_ror:8 row_mask:0xf bank_mask:0xf
  ds_write_b64 v12, v[64:65]
  s_waitcnt lgkmcnt(0)
  s_barrier
  s_cmp_lg_u32 s36, 0
  s_cbranch_scc1 E_k1_mod_kernel
  ds_read_b32 v64, v13 offset:0
  ds_read_b32 v65, v13 offset:256
  ds_read_b32 v66, v13 offset:512
  ds_read_b32 v67, v13 offset:768
  s_waitcnt lgkmcnt(0)
  v_add_f32 v64, v64, v65
  v_add_f32 v66, v66, v67
  v_add_f32 v64, v64, v66
  buffer_store_dword v64, v13, s[12:15], s38 offen
  s_branch E_k1_mod_kernel
T_k1_mod_kernel:
  s_lshr_b32 s44, s37, 3
  s_lshl_b32 s44, s44, 13
  s_cmp_lg_u32 s36, 3
  s_cbranch_scc1 TC2_k1_mod_kernel
  s_cmp_ge_u32 s44, code_end-k3_main_kernel
  s_cbranch_scc1 TC2_k1_mod_kernel
  s_getpc_b64 s[42:43]
TC2_k1_mod_kernelp:
  s_add_u32 s44, s44, k3_main_kernel-TC2_k1_mod_kernelp
  s_ashr_i32 vcc_hi, s44, 31
  s_add_u32 s42, s42, s44
  s_addc_u32 s43, s43, vcc_hi
  v_lshlrev_b32 v74, 7, v10
  v_mov_b32 v75, s43
  v_add_co_u32 v74, vcc, s42, v74
  s_nop 1
  v_addc_co_u32 v75, vcc, 0, v75, vcc
  global_load_dword v76, v[74:75], off
TC2_k1_mod_kernel:
  v_lshlrev_b32 v74, 7, v10
  s_lshl_b32 s42, s37, 1
  s_add_u32 s42, s42, s36
  s_lshl_b32 s42, s42, 13
  s_cmp_lt_u32 s36, 2
  s_cselect_b32 s42, s42, 0x40000000
  buffer_load_dword v76, v74, s[16:19], s42 offen
  v_lshlrev_b32 v74, 7, v10
  s_mul_i32 s42, s36, 256
  s_add_u32 s42, s42, s37
  s_lshl_b32 s42, s42, 13
  s_add_u32 s43, s42, 0
  s_cmp_lt_u32 s43, 2095104
  s_cselect_b32 s43, s43, 0x40000000
  buffer_load_dword v76, v74, s[20:23], s43 offen
  s_sub_u32 s37, s37, 128
  s_waitcnt vmcnt(0)
  v_lshlrev_b32 v74, 7, v10
  s_mul_i32 s42, s36, 128
  s_add_u32 s42, s42, s37
  s_lshl_b32 s42, s42, 13
  s_add_u32 s43, s42, 0
  s_cmp_lt_u32 s43, 4196352
  s_cselect_b32 s43, s43, 0x40000000
  s_add_u32 s43, s43, 2095104
  buffer_load_dword v76, v74, s[20:23], s43 offen
  s_add_u32 s43, s42, 4194304
  s_cmp_lt_u32 s43, 4196352
  s_cselect_b32 s43, s43, 0x40000000
  s_add_u32 s43, s43, 2095104
  buffer_load_dword v76, v74, s[20:23], s43 offen
E_k1_mod_kernel:
X_k1_mod_kernel:
  s_endpgm
.globl k3_main_kernel
.type k3_main_kernel,@function
.p2align 12
.p2align 8
k3_main_kernel:
  s_cmp_ge_u32 s2, 256
  s_cbranch_scc1 X_k3_main_kernel
  s_load_dwordx2 s[4:5], s[0:1], 0
  s_load_dwordx2 s[36:37], s[0:1], 88
  s_load_dwordx2 s[8:9], s[0:1], 8
  s_load_dwordx2 s[28:29], s[0:1], 64
  s_load_dwordx2 s[40:41], s[0:1], 56
  s_load_dwordx2 s[12:13], s[0:1], 16
  s_load_dwordx2 s[16:17], s[0:1], 32
  s_load_dwordx2 s[20:21], s[0:1], 40
  s_load_dwordx2 s[24:25], s[0:1], 48
  s_load_dwordx2 s[32:33], s[0:1], 72
  v_lshrrev_b32 v1, 6, v0
  v_and_b32 v10, 63, v0
  v_readfirstlane_b32 s44, v1
  v_lshlrev_b32 v0, 4, v10
  s_mov_b32 s6, 4194304
  s_mov_b32 s7, 0x20000
  s_mov_b32 s38, 50331648
  s_mov_b32 s39, 0x20000
  s_mov_b32 s10, 6291456
  s_mov_b32 s11, 0x20000
  s_mov_b32 s30, 12582912
  s_mov_b32 s31, 0x20000
  s_mov_b32 s42, 2048
  s_mov_b32 s43, 0x20000
  s_mov_b32 s14, 2097152
  s_mov_b32 s15, 0x20000
  s_mov_b32 s18, 7340032
  s_mov_b32 s19, 0x20000
  s_mov_b32 s22, 7340032
  s_mov_b32 s23, 0x20000
  s_mov_b32 s26, 7340032
  s_mov_b32 s27, 0x20000
  s_mov_b32 s34, 4194304
  s_mov_b32 s35, 0x20000
  v_and_b32 v12, 7, v10
  v_lshrrev_b32 v13, 3, v10
  v_lshlrev_b32 v132, 11, v12
  v_lshl_add_u32 v132, v13, 4, v132
  s_lshl_b32 s48, s2, 14
  s_lshl_b32 s49, s44, 9
  s_add_u32 s48, s48, s49
  s_lshl_b32 s49, s44, 10
  s_waitcnt lgkmcnt(0)
  buffer_load_dwordx4 v[20:23], v132, s[4:7], s48 offen offset:0
  buffer_load_dwordx4 v[24:27], v132, s[4:7], s48 offen offset:128
  buffer_load_dwordx4 v[28:31], v132, s[4:7], s48 offen offset:256
  buffer_load_dwordx4 v[32:35], v132, s[4:7], s48 offen offset:384
  buffer_load_dwordx4 v[100:103], v0, s[36:39], s49 offen
  s_add_u32 s49, s49, 4096
  buffer_load_dwordx4 v[68:71], v0, s[36:39], s49 offen
  s_add_u32 s49, s49, 20480
  buffer_load_dwordx4 v[104:107], v0, s[36:39], s49 offen
  s_add_u32 s49, s49, 4096
  buffer_load_dwordx4 v[72:75], v0, s[36:39], s49 offen
  s_add_u32 s49, s49, 20480
  buffer_load_dwordx4 v[108:111], v0, s[36:39], s49 offen
  s_add_u32 s49, s49, 4096
  buffer_load_dwordx4 v[76:79], v0, s[36:39], s49 offen
  s_add_u32 s49, s49, 20480
  buffer_load_dwordx4 v[112:115], v0, s[36:39], s49 offen
  s_add_u32 s49, s49, 4096
  buffer_load_dwordx4 v[80:83], v0, s[36:39], s49 offen
  s_mul_i32 s48, s2, 7168
  s_lshl_b32 s49, s2, 13
  s_mov_b32 s55, 0x20000
  s_mov_b32 s54, 1835008
  s_cmp_eq_u32 s44, 1
  s_cselect_b64 s[52:53], s[16:17], s[20:21]
  s_cmp_eq_u32 s44, 0
  s_cselect_b64 s[52:53], s[12:13], s[52:53]
  s_cselect_b32 s54, s14, s54
  s_cselect_b32 s48, s49, s48
  s_lshr_b32 s49, s2, 3
  s_mul_i32 s50, s49, 43
  s_lshr_b32 s50, s50, 7
  s_mul_i32 s50, s50, 387072
  s_lshl_b32 s46, s49, 11
  s_add_u32 s50, s50, s46
  s_and_b32 s46, s2, 2
  s_lshl_b32 s46, s46, 9
  s_add_u32 s50, s50, s46
  s_and_b32 s46, s49, 1
  s_lshl_b32 s46, s46, 10
  s_lshr_b32 s49, s49, 1
  s_lshl_b32 s49, s49, 17
  s_add_u32 s49, s49, s46
  s_bitcmp1_b32 s2, 0
  s_cselect_b32 s49, 1073741824, s50
  s_cselect_b64 vcc, s[12:13], s[8:9]
  s_cselect_b32 s50, s14, s10
  s_cselect_b32 s47, 16, 48
  s_add_u32 s49, s49, 384
  s_cmp_eq_u32 s44, 3
  s_cselect_b64 s[52:53], vcc, s[52:53]
  s_cselect_b32 s54, s50, s54
  s_cselect_b32 s46, s49, s48
  s_cselect_b32 s49, s47, 1
  s_lshl_b32 s49, s49, 3
  v_mul_u32_u24 v19, s49, v0
  buffer_load_dword a252, v19, s[52:55], s46 offen
  s_getpc_b64 s[92:93]
PC0:
  s_lshl_b32 s48, s44, 10
  s_sub_u32 s48, s48, PC0-k3_main_kernel
  s_ashr_i32 s49, s48, 31
  s_add_u32 s92, s92, s48
  s_addc_u32 s93, s93, s49
  s_and_b32 s48, s2, 7
  s_lshr_b32 s49, s2, 3
  s_and_b32 s56, s48, 3
  s_lshl_b32 s56, s56, 2
  s_and_b32 s51, s49, 3
  s_add_u32 s56, s56, s51
  s_lshr_b32 s51, s48, 2
  s_lshl_b32 s51, s51, 3
  s_lshr_b32 s49, s49, 2
  s_add_u32 s51, s51, s49
  s_add_u32 s57, s51, s56
  s_and_b32 s57, s57, 3
  s_lshr_b32 s58, s44, 1
  s_and_b32 s59, s44, 1
  s_mul_i32 s62, s44, 3072
  s_lshl_b32 s63, s44, 11
  s_lshl_b32 s64, s44, 8
  v_bfe_u32 v14, v10, 4, 2
  v_bfe_u32 v15, v10, 1, 2
  v_xor_b32 v14, v14, v15
  v_lshlrev_b32 v14, 5, v14
  v_and_b32 v15, 1, v10
  v_lshl_add_u32 v150, v15, 4, v14
  s_lshl_b32 s48, s56, 7
  s_mul_i32 s49, s44, 49152
  s_add_u32 s48, s48, s49
  v_mul_u32_u24 v14, 6144, v13
  v_add3_u32 v139, v14, v150, s48
  v_add_u32 v140, 1024, v139
  v_add_u32 v141, 2048, v139
  v_bfe_u32 v14, v10, 3, 2
  v_lshlrev_b32 v14, 5, v14
  v_and_b32 v15, 3, v10
  v_lshl_add_u32 v151, v15, 3, v14
  v_bfe_u32 v14, v10, 2, 3
  v_lshrrev_b32 v15, 5, v10
  v_mul_u32_u24 v15, 24, v15
  v_add_lshl_u32 v14, v14, v15, 7
  s_lshl_b32 s48, s59, 1
  s_add_u32 s48, s48, s58
  s_lshl_b32 s48, s48, 5
  v_xor_b32 v15, s48, v151
  v_add_u32 v133, v14, v15
  v_xor_b32 v134, 32, v133
  v_add_u32 v135, 64512, v133
  v_add_u32 v136, 64512, v134
  v_add_u32 v137, 129024, v133
  v_add_u32 v138, 129024, v134
  s_lshl_b32 s48, s51, 2
  s_add_u32 s49, s48, s44
  s_lshl_b32 s49, s49, 16
  s_add_u32 s49, s49, 1048576
  v_add_u32 v142, s49, v0
  s_max_u32 s48, s48, 1
  s_lshl_b32 s48, s48, 16
  s_add_u32 s48, s48, 984064
  s_add_u32 s48, s48, s64
  v_lshl_add_u32 v143, v10, 2, s48
  s_lshl_b32 s48, s58, 12
  v_add_u32 v147, 0, v0
  v_add_u32 v144, s48, v147
  v_add_u32 v148, 64512, v0
  v_add_u32 v145, s48, v148
  v_add_u32 v149, 129024, v0
  v_add_u32 v146, s48, v149
  s_lshl_b32 s48, s51, 4
  s_sub_u32 s48, s48, 2
  v_min_u32 v152, 17, v10
  v_add_u32 v152, s48, v152
  v_max_i32 v152, 0, v152
  v_lshlrev_b32 v152, 7, v152
  s_add_u32 s48, s63, 150528
  v_add_u32 v14, s48, v0
  v_lshl_add_u32 v15, v13, 5, s48
  v_lshlrev_b32 v17, 5, v12
  v_add_u32 v17, 158720, v17
  s_lshl_b32 s48, s44, 3
  v_add_u32 v16, s48, v17
  v_bfe_u32 v18, v10, 3, 1
  v_lshlrev_b32 v132, 9, v18
  v_bfe_u32 v18, v10, 4, 1
  v_lshl_add_u32 v132, v18, 8, v132
  v_lshrrev_b32 v18, 5, v10
  v_lshl_add_u32 v132, v18, 11, v132
  v_lshl_add_u32 v132, v12, 4, v132
  s_lshr_b32 s50, s2, 2
  s_lshl_b32 s50, s50, 16
  s_bfe_u32 s48, s2, 0x10001
  s_lshl_b32 s48, s48, 10
  s_add_u32 s50, s50, s48
  s_and_b32 s48, s2, 1
  s_lshl_b32 s48, s48, 7
  s_add_u32 s50, s50, s48
  s_lshl_b32 s48, s44, 14
  s_add_u32 s50, s50, s48
  s_add_u32 s50, s50, 1048576
  s_lshl_b32 s45, s2, 7
  s_add_u32 s45, s45, 5242880
  s_cmp_eq_u32 s44, 0
  s_cselect_b32 s45, s45, 1073741824
  s_branch AL
.p2align 12
AL:
  s_waitcnt vmcnt(12)
  v_lshlrev_b32 v36, 16, v20
  v_and_b32 v37, 0xffff0000, v20
  v_lshlrev_b32 v38, 16, v21
  v_and_b32 v39, 0xffff0000, v21
  v_lshlrev_b32 v40, 16, v22
  v_and_b32 v41, 0xffff0000, v22
  v_lshlrev_b32 v42, 16, v23
  v_and_b32 v43, 0xffff0000, v23
  s_waitcnt vmcnt(11)
  v_lshlrev_b32 v44, 16, v24
  v_and_b32 v45, 0xffff0000, v24
  v_lshlrev_b32 v46, 16, v25
  v_and_b32 v47, 0xffff0000, v25
  v_lshlrev_b32 v48, 16, v26
  v_and_b32 v49, 0xffff0000, v26
  v_lshlrev_b32 v50, 16, v27
  v_and_b32 v51, 0xffff0000, v27
  s_waitcnt vmcnt(10)
  v_lshlrev_b32 v52, 16, v28
  v_and_b32 v53, 0xffff0000, v28
  v_lshlrev_b32 v54, 16, v29
  v_and_b32 v55, 0xffff0000, v29
  v_lshlrev_b32 v56, 16, v30
  v_and_b32 v57, 0xffff0000, v30
  v_lshlrev_b32 v58, 16, v31
  v_and_b32 v59, 0xffff0000, v31
  s_waitcnt vmcnt(9)
  v_lshlrev_b32 v60, 16, v32
  v_and_b32 v61, 0xffff0000, v32
  v_lshlrev_b32 v62, 16, v33
  v_and_b32 v63, 0xffff0000, v33
  v_lshlrev_b32 v64, 16, v34
  v_and_b32 v65, 0xffff0000, v34
  v_lshlrev_b32 v66, 16, v35
  v_and_b32 v67, 0xffff0000, v35
  v_add_f32 v20, v36, v37
  v_mul_f32 v21, v36, v36
  v_add_f32 v22, v38, v39
  v_mul_f32 v23, v37, v37
  v_fmac_f32 v21, v38, v38
  v_fmac_f32 v23, v39, v39
  v_fmac_f32 v21, v40, v40
  v_add_f32 v20, v20, v40
  v_fmac_f32 v23, v41, v41
  v_add_f32 v22, v22, v41
  v_fmac_f32 v21, v42, v42
  v_add_f32 v20, v20, v42
  v_fmac_f32 v23, v43, v43
  v_add_f32 v22, v22, v43
  v_fmac_f32 v21, v44, v44
  v_add_f32 v20, v20, v44
  v_fmac_f32 v23, v45, v45
  v_add_f32 v22, v22, v45
  v_fmac_f32 v21, v46, v46
  v_add_f32 v20, v20, v46
  v_fmac_f32 v23, v47, v47
  v_add_f32 v22, v22, v47
  v_fmac_f32 v21, v48, v48
  v_add_f32 v20, v20, v48
  v_fmac_f32 v23, v49, v49
  v_add_f32 v22, v22, v49
  v_fmac_f32 v21, v50, v50
  v_add_f32 v20, v20, v50
  v_fmac_f32 v23, v51, v51
  v_add_f32 v22, v22, v51
  v_fmac_f32 v21, v52, v52
  v_add_f32 v20, v20, v52
  v_fmac_f32 v23, v53, v53
  v_add_f32 v22, v22, v53
  v_fmac_f32 v21, v54, v54
  v_add_f32 v20, v20, v54
  v_fmac_f32 v23, v55, v55
  v_add_f32 v22, v22, v55
  v_fmac_f32 v21, v56, v56
  v_add_f32 v20, v20, v56
  v_fmac_f32 v23, v57, v57
  v_add_f32 v22, v22, v57
  v_fmac_f32 v21, v58, v58
  v_add_f32 v20, v20, v58
  v_fmac_f32 v23, v59, v59
  v_add_f32 v22, v22, v59
  v_fmac_f32 v21, v60, v60
  v_add_f32 v20, v20, v60
  v_fmac_f32 v23, v61, v61
  v_add_f32 v22, v22, v61
  v_fmac_f32 v21, v62, v62
  v_add_f32 v20, v20, v62
  v_fmac_f32 v23, v63, v63
  v_add_f32 v22, v22, v63
  v_fmac_f32 v21, v64, v64
  v_add_f32 v20, v20, v64
  v_fmac_f32 v23, v65, v65
  v_add_f32 v22, v22, v65
  v_fmac_f32 v21, v66, v66
  v_add_f32 v20, v20, v66
  v_fmac_f32 v23, v67, v67
  v_add_f32 v22, v22, v67
  v_add_f32 v20, v20, v22
  v_add_f32 v21, v21, v23
  s_nop 0
  v_add_f32_dpp v18, v20, v20 row_ror:8 row_mask:0xf bank_mask:0xf
  v_add_f32_dpp v19, v21, v21 row_ror:8 row_mask:0xf bank_mask:0xf
  v_mov_b32 v20, v18
  v_mov_b32 v21, v19
  s_nop 0
  v_permlane16_swap_b32 v18, v20
  v_permlane16_swap_b32 v19, v21
  v_add_f32 v18, v18, v20
  v_add_f32 v19, v19, v21
  v_mov_b32 v20, v18
  v_mov_b32 v21, v19
  s_nop 0
  v_permlane32_swap_b32 v18, v20
  v_permlane32_swap_b32 v19, v21
  v_add_f32 v18, v18, v20
  v_add_f32 v19, v19, v21
  ds_write_b64 v16, v[18:19]
  s_waitcnt vmcnt(1)
  v_add_f32 v68, v68, v76
  v_add_f32 v100, v100, v108
  v_add_f32 v69, v69, v77
  v_add_f32 v101, v101, v109
  v_add_f32 v70, v70, v78
  v_add_f32 v102, v102, v110
  v_add_f32 v71, v71, v79
  v_add_f32 v103, v103, v111
  v_add_f32 v72, v72, v80
  v_add_f32 v104, v104, v112
  v_add_f32 v73, v73, v81
  v_add_f32 v105, v105, v113
  v_add_f32 v74, v74, v82
  v_add_f32 v106, v106, v114
  v_add_f32 v75, v75, v83
  v_add_f32 v107, v107, v115
  v_add_f32 v68, v68, v72
  v_add_f32 v100, v100, v104
  v_add_f32 v69, v69, v73
  v_add_f32 v101, v101, v105
  v_add_f32 v70, v70, v74
  v_add_f32 v102, v102, v106
  v_add_f32 v71, v71, v75
  v_add_f32 v103, v103, v107
  v_cvt_pk_bf16_f32 v20, v68, v69
  v_lshlrev_b32 v68, 16, v20
  v_and_b32 v69, 0xffff0000, v20
  v_cvt_pk_bf16_f32 v20, v70, v71
  v_lshlrev_b32 v70, 16, v20
  v_and_b32 v71, 0xffff0000, v20
  v_cvt_pk_bf16_f32 v20, v100, v101
  v_lshlrev_b32 v100, 16, v20
  v_and_b32 v101, 0xffff0000, v20
  v_cvt_pk_bf16_f32 v20, v102, v103
  v_lshlrev_b32 v102, 16, v20
  v_and_b32 v103, 0xffff0000, v20
  v_add_f32 v68, 1.0, v68
  v_add_f32 v69, 1.0, v69
  v_add_f32 v70, 1.0, v70
  v_add_f32 v71, 1.0, v71
  v_cvt_pk_bf16_f32 v20, v68, v69
  v_lshlrev_b32 v68, 16, v20
  v_and_b32 v69, 0xffff0000, v20
  v_cvt_pk_bf16_f32 v20, v70, v71
  v_lshlrev_b32 v70, 16, v20
  v_and_b32 v71, 0xffff0000, v20
  ds_write_b128 v14, v[68:71]
  ds_write_b128 v14, v[100:103] offset:1024
  s_waitcnt lgkmcnt(0)
  s_barrier
  ds_read_b128 v[20:23], v17 offset:0
  ds_read_b128 v[24:27], v17 offset:16
  ds_read_b128 v[68:71], v15 offset:0
  ds_read_b128 v[100:103], v15 offset:1024
  ds_read_b128 v[72:75], v15 offset:16
  ds_read_b128 v[104:107], v15 offset:1040
  ds_read_b128 v[76:79], v15 offset:256
  ds_read_b128 v[108:111], v15 offset:1280
  ds_read_b128 v[80:83], v15 offset:272
  ds_read_b128 v[112:115], v15 offset:1296
  ds_read_b128 v[84:87], v15 offset:512
  ds_read_b128 v[116:119], v15 offset:1536
  ds_read_b128 v[88:91], v15 offset:528
  ds_read_b128 v[120:123], v15 offset:1552
  s_waitcnt lgkmcnt(12)
  v_add_f32 v20, v20, v24
  v_add_f32 v21, v21, v25
  v_add_f32 v22, v22, v26
  v_add_f32 v23, v23, v27
  v_add_f32 v20, v20, v22
  v_add_f32 v21, v21, v23
  ds_read_b128 v[92:95], v15 offset:768
  ds_read_b128 v[124:127], v15 offset:1792
  ds_read_b128 v[96:99], v15 offset:784
  ds_read_b128 v[128:131], v15 offset:1808
  v_mul_f32 v18, 0x3a800000, v20
  v_mul_f32 v19, 0x3a800000, v21
  v_fma_f32 v19, -v18, v18, v19
  v_max_f32 v19, 0, v19
  v_cvt_pk_bf16_f32 v19, v19, v19
  v_lshlrev_b32 v19, 16, v19
  v_add_f32 v19, 0x3727c5ac, v19
  v_cvt_pk_bf16_f32 v19, v19, v19
  v_lshlrev_b32 v19, 16, v19
  v_sqrt_f32 v19, v19
  v_cvt_pk_bf16_f32 v18, v18, v18
  v_lshlrev_b32 v18, 16, v18
  v_cvt_pk_bf16_f32 v19, v19, v19
  v_lshlrev_b32 v19, 16, v19
  v_rcp_f32 v19, v19
  s_nop 0
  v_mul_f32 v18, v18, v19
  v_fma_f32 v36, v36, v19, -v18
  v_fma_f32 v37, v37, v19, -v18
  v_fma_f32 v38, v38, v19, -v18
  v_fma_f32 v39, v39, v19, -v18
  v_fma_f32 v40, v40, v19, -v18
  v_fma_f32 v41, v41, v19, -v18
  v_fma_f32 v42, v42, v19, -v18
  v_fma_f32 v43, v43, v19, -v18
  s_waitcnt lgkmcnt(12)
  v_fma_f32 v36, v36, v68, v100
  v_fma_f32 v37, v37, v69, v101
  v_fma_f32 v38, v38, v70, v102
  v_fma_f32 v39, v39, v71, v103
  v_fma_f32 v40, v40, v72, v104
  v_fma_f32 v41, v41, v73, v105
  v_fma_f32 v42, v42, v74, v106
  v_fma_f32 v43, v43, v75, v107
  v_cvt_pk_bf16_f32 v20, v36, v37
  v_cvt_pk_bf16_f32 v21, v38, v39
  v_cvt_pk_bf16_f32 v22, v40, v41
  v_cvt_pk_bf16_f32 v23, v42, v43
  s_nop 1
  v_permlane16_swap_b32 v20, v22
  v_permlane16_swap_b32 v21, v23
  buffer_store_dwordx4 v[20:23], v132, s[36:39], s50 offen sc1
  s_add_u32 s50, s50, 4096
  v_fma_f32 v44, v44, v19, -v18
  v_fma_f32 v45, v45, v19, -v18
  v_fma_f32 v46, v46, v19, -v18
  v_fma_f32 v47, v47, v19, -v18
  v_fma_f32 v48, v48, v19, -v18
  v_fma_f32 v49, v49, v19, -v18
  v_fma_f32 v50, v50, v19, -v18
  v_fma_f32 v51, v51, v19, -v18
  s_waitcnt lgkmcnt(8)
  v_fma_f32 v44, v44, v76, v108
  v_fma_f32 v45, v45, v77, v109
  v_fma_f32 v46, v46, v78, v110
  v_fma_f32 v47, v47, v79, v111
  v_fma_f32 v48, v48, v80, v112
  v_fma_f32 v49, v49, v81, v113
  v_fma_f32 v50, v50, v82, v114
  v_fma_f32 v51, v51, v83, v115
  v_cvt_pk_bf16_f32 v24, v44, v45
  v_cvt_pk_bf16_f32 v25, v46, v47
  v_cvt_pk_bf16_f32 v26, v48, v49
  v_cvt_pk_bf16_f32 v27, v50, v51
  s_nop 1
  v_permlane16_swap_b32 v24, v26
  v_permlane16_swap_b32 v25, v27
  buffer_store_dwordx4 v[24:27], v132, s[36:39], s50 offen sc1
  s_add_u32 s50, s50, 4096
  v_fma_f32 v52, v52, v19, -v18
  v_fma_f32 v53, v53, v19, -v18
  v_fma_f32 v54, v54, v19, -v18
  v_fma_f32 v55, v55, v19, -v18
  v_fma_f32 v56, v56, v19, -v18
  v_fma_f32 v57, v57, v19, -v18
  v_fma_f32 v58, v58, v19, -v18
  v_fma_f32 v59, v59, v19, -v18
  s_waitcnt lgkmcnt(4)
  v_fma_f32 v52, v52, v84, v116
  v_fma_f32 v53, v53, v85, v117
  v_fma_f32 v54, v54, v86, v118
  v_fma_f32 v55, v55, v87, v119
  v_fma_f32 v56, v56, v88, v120
  v_fma_f32 v57, v57, v89, v121
  v_fma_f32 v58, v58, v90, v122
  v_fma_f32 v59, v59, v91, v123
  v_cvt_pk_bf16_f32 v28, v52, v53
  v_cvt_pk_bf16_f32 v29, v54, v55
  v_cvt_pk_bf16_f32 v30, v56, v57
  v_cvt_pk_bf16_f32 v31, v58, v59
  s_nop 1
  v_permlane16_swap_b32 v28, v30
  v_permlane16_swap_b32 v29, v31
  buffer_store_dwordx4 v[28:31], v132, s[36:39], s50 offen sc1
  s_add_u32 s50, s50, 4096
  v_fma_f32 v60, v60, v19, -v18
  v_fma_f32 v61, v61, v19, -v18
  v_fma_f32 v62, v62, v19, -v18
  v_fma_f32 v63, v63, v19, -v18
  v_fma_f32 v64, v64, v19, -v18
  v_fma_f32 v65, v65, v19, -v18
  v_fma_f32 v66, v66, v19, -v18
  v_fma_f32 v67, v67, v19, -v18
  s_waitcnt lgkmcnt(0)
  v_fma_f32 v60, v60, v92, v124
  v_fma_f32 v61, v61, v93, v125
  v_fma_f32 v62, v62, v94, v126
  v_fma_f32 v63, v63, v95, v127
  v_fma_f32 v64, v64, v96, v128
  v_fma_f32 v65, v65, v97, v129
  v_fma_f32 v66, v66, v98, v130
  v_fma_f32 v67, v67, v99, v131
  v_cvt_pk_bf16_f32 v32, v60, v61
  v_cvt_pk_bf16_f32 v33, v62, v63
  v_cvt_pk_bf16_f32 v34, v64, v65
  v_cvt_pk_bf16_f32 v35, v66, v67
  s_nop 1
  v_permlane16_swap_b32 v32, v34
  v_permlane16_swap_b32 v33, v35
  buffer_store_dwordx4 v[32:35], v132, s[36:39], s50 offen sc1
  v_mov_b32 v12, 1
  s_waitcnt vmcnt(0) lgkmcnt(0)
  s_barrier
  s_mov_b64 exec, 1
  buffer_store_dword v12, v0, s[36:39], s45 offen sc1
  s_mov_b64 exec, -1
  s_mov_b32 s65, 0
  s_mul_i32 s60, s65, 196608
  s_add_u32 m0, s62, 64512
  s_nop 0
  buffer_load_dwordx4 v139, s[8:11], s60 offen offset:0 lds
  buffer_load_dwordx4 v140, s[8:11], s60 offen offset:1024 lds
  buffer_load_dwordx4 v141, s[8:11], s60 offen offset:2048 lds
  s_mov_b32 s66, 1
  s_mul_i32 s60, s66, 196608
  s_add_u32 m0, s62, 86016
  s_nop 0
  buffer_load_dwordx4 v139, s[8:11], s60 offen offset:0 lds
  buffer_load_dwordx4 v140, s[8:11], s60 offen offset:1024 lds
  buffer_load_dwordx4 v141, s[8:11], s60 offen offset:2048 lds
  s_mov_b32 s67, 2
  s_mul_i32 s60, s67, 196608
  s_add_u32 m0, s62, 107520
  s_nop 0
  buffer_load_dwordx4 v139, s[8:11], s60 offen offset:0 lds
  buffer_load_dwordx4 v140, s[8:11], s60 offen offset:1024 lds
  buffer_load_dwordx4 v141, s[8:11], s60 offen offset:2048 lds
  s_mov_b32 s68, 3
  s_mul_i32 s60, s68, 196608
  s_add_u32 m0, s62, 129024
  s_nop 0
  buffer_load_dwordx4 v139, s[8:11], s60 offen offset:0 lds
  buffer_load_dwordx4 v140, s[8:11], s60 offen offset:1024 lds
  buffer_load_dwordx4 v141, s[8:11], s60 offen offset:2048 lds
  s_mov_b32 s69, 4
  s_mul_i32 s60, s69, 196608
  s_add_u32 m0, s62, 0
  s_nop 0
  buffer_load_dwordx4 v139, s[8:11], s60 offen offset:0 lds
  buffer_load_dwordx4 v140, s[8:11], s60 offen offset:1024 lds
  buffer_load_dwordx4 v141, s[8:11], s60 offen offset:2048 lds
  s_mov_b64 exec, 0
  s_cmp_eq_u32 s44, 1
  s_cbranch_scc1 Ha0
  s_cmp_eq_u32 s44, 2
  s_cbranch_scc1 Ha1
  s_cmp_eq_u32 s44, 3
  s_cbranch_scc1 Ha2
Ra:
  s_mov_b64 exec, -1
  s_cmp_lg_u32 s44, 0
  s_cbranch_scc1 SM1x
  s_mov_b32 s46, 60000
  s_mov_b32 s47, 5242880
SM1:
  buffer_load_dword v12, v152, s[36:39], s47 offen sc1
  s_sub_u32 s46, s46, 1
  s_cmp_eq_u32 s46, 0
  s_waitcnt vmcnt(0)
  s_cbranch_scc1 SM1x
  v_cmp_ne_u32 vcc, 1, v12
  s_nop 4
  s_cbranch_vccnz SM1
SM1x:
  s_barrier
  s_lshl_b32 s61, s65, 11
  s_add_u32 m0, s63, 76800
  s_nop 0
  buffer_load_dwordx4 v142, s[36:39], s61 offen offset:0 sc1 lds
  buffer_load_dwordx4 v142, s[36:39], s61 offen offset:1024 sc1 lds
  s_add_u32 m0, s64, 84992
  s_nop 0
  buffer_load_dword v143, s[36:39], s61 offen sc1 lds
  s_lshl_b32 s61, s66, 11
  s_add_u32 m0, s63, 98304
  s_nop 0
  buffer_load_dwordx4 v142, s[36:39], s61 offen offset:0 sc1 lds
  buffer_load_dwordx4 v142, s[36:39], s61 offen offset:1024 sc1 lds
  s_add_u32 m0, s64, 106496
  s_nop 0
  buffer_load_dword v143, s[36:39], s61 offen sc1 lds
  s_lshl_b32 s61, s67, 11
  s_add_u32 m0, s63, 119808
  s_nop 0
  buffer_load_dwordx4 v142, s[36:39], s61 offen offset:0 sc1 lds
  buffer_load_dwordx4 v142, s[36:39], s61 offen offset:1024 sc1 lds
  s_add_u32 m0, s64, 128000
  s_nop 0
  buffer_load_dword v143, s[36:39], s61 offen sc1 lds
  s_lshl_b32 s61, s68, 11
  s_add_u32 m0, s63, 141312
  s_nop 0
  buffer_load_dwordx4 v142, s[36:39], s61 offen offset:0 sc1 lds
  buffer_load_dwordx4 v142, s[36:39], s61 offen offset:1024 sc1 lds
  s_add_u32 m0, s64, 149504
  s_nop 0
  buffer_load_dword v143, s[36:39], s61 offen sc1 lds
  s_waitcnt vmcnt(9)
  s_barrier
  ds_read_b64_tr_b16 a[40:41], v135 offset:1024
  ds_read_b64_tr_b16 a[42:43], v135 offset:7168
  ds_read_b64_tr_b16 a[44:45], v136 offset:1024
  ds_read_b64_tr_b16 a[46:47], v136 offset:7168
  ds_read_b64_tr_b16 a[48:49], v135 offset:2048
  ds_read_b64_tr_b16 a[50:51], v135 offset:8192
  ds_read_b64_tr_b16 a[52:53], v136 offset:2048
  ds_read_b64_tr_b16 a[54:55], v136 offset:8192
  ds_read_b128 a[0:3], v145 offset:12288
  ds_read_b128 a[4:7], v145 offset:13312
  ds_read_b128 a[8:11], v145 offset:14336
  ds_read_b128 a[12:15], v145 offset:15360
  ds_read_b128 a[16:19], v148 offset:20480
  s_waitcnt lgkmcnt(0)
  v_mfma_f32_16x16x32_bf16 v[20:23], a[40:43], a[0:3], 0
  s_waitcnt vmcnt(6)
  s_barrier
  s_lshl_b32 s61, s69, 11
  v_mfma_f32_16x16x32_bf16 v[24:27], a[40:43], a[4:7], 0
  s_add_u32 m0, s63, 12288
  ds_read_b64_tr_b16 a[56:57], v135 offset:0
  v_mfma_f32_16x16x32_bf16 v[28:31], a[40:43], a[8:11], 0
  buffer_load_dwordx4 v142, s[36:39], s61 offen offset:0 sc1 lds
  v_mfma_f32_16x16x32_bf16 v[32:35], a[40:43], a[12:15], 0
  ds_read_b64_tr_b16 a[58:59], v135 offset:6144
  v_mfma_f32_16x16x32_bf16 v[116:119], a[40:43], a[16:19], 0
  ds_read_b64_tr_b16 a[60:61], v136 offset:0
  v_mfma_f32_16x16x32_bf16 v[48:51], a[44:47], a[12:15], 0
  v_mfma_f32_16x16x32_bf16 v[44:47], a[44:47], a[8:11], 0
  buffer_load_dwordx4 v142, s[36:39], s61 offen offset:1024 sc1 lds
  s_add_u32 m0, s64, 20480
  v_mfma_f32_16x16x32_bf16 v[40:43], a[44:47], a[4:7], 0
  ds_read_b64_tr_b16 a[62:63], v136 offset:6144
  v_mfma_f32_16x16x32_bf16 v[36:39], a[44:47], a[0:3], 0
  s_waitcnt lgkmcnt(9)
  ds_read_b64_tr_b16 a[64:65], v135 offset:22528
  v_mfma_f32_16x16x32_bf16 v[52:55], a[0:3], a[48:51], 0
  ds_read_b128 a[20:23], v145 offset:33792
  v_mfma_f32_16x16x32_bf16 v[56:59], a[4:7], a[48:51], 0
  buffer_load_dword v143, s[36:39], s61 offen sc1 lds
  s_mov_b32 s70, 5
  v_mfma_f32_16x16x32_bf16 v[60:63], a[8:11], a[48:51], 0
  s_mul_i32 s60, s70, 196608
  s_add_u32 m0, s62, 21504
  ds_read_b64_tr_b16 a[66:67], v135 offset:28672
  v_mfma_f32_16x16x32_bf16 v[64:67], a[12:15], a[48:51], 0
  ds_read_b128 a[24:27], v145 offset:34816
  v_mfma_f32_16x16x32_bf16 v[120:123], a[16:19], a[48:51], 0
  ds_read_b64_tr_b16 a[68:69], v136 offset:22528
  v_mfma_f32_16x16x32_bf16 v[80:83], a[12:15], a[52:55], 0
  buffer_load_dwordx4 v139, s[8:11], s60 offen offset:0 lds
  v_mfma_f32_16x16x32_bf16 v[76:79], a[8:11], a[52:55], 0
  ds_read_b128 a[28:31], v145 offset:35840
  v_mfma_f32_16x16x32_bf16 v[72:75], a[4:7], a[52:55], 0
  ds_read_b64_tr_b16 a[70:71], v136 offset:28672
  v_mfma_f32_16x16x32_bf16 v[68:71], a[0:3], a[52:55], 0
  s_waitcnt lgkmcnt(7)
  ds_read_b128 a[32:35], v145 offset:36864
  v_mfma_f32_16x16x32_bf16 v[84:87], a[56:59], a[0:3], 0
  buffer_load_dwordx4 v140, s[8:11], s60 offen offset:1024 lds
  v_mfma_f32_16x16x32_bf16 v[88:91], a[56:59], a[4:7], 0
  ds_read_b128 a[36:39], v148 offset:41984
  v_mfma_f32_16x16x32_bf16 v[92:95], a[56:59], a[8:11], 0
  ds_read_b64_tr_b16 a[40:41], v135 offset:23552
  v_mfma_f32_16x16x32_bf16 v[96:99], a[56:59], a[12:15], 0
  ds_read_b64_tr_b16 a[42:43], v135 offset:29696
  v_mfma_f32_16x16x32_bf16 v[112:115], a[60:63], a[12:15], 0
  buffer_load_dwordx4 v141, s[8:11], s60 offen offset:2048 lds
  s_lshl_b32 s61, s70, 11
  v_mfma_f32_16x16x32_bf16 v[108:111], a[60:63], a[8:11], 0
  s_add_u32 m0, s63, 33792
  ds_read_b64_tr_b16 a[44:45], v136 offset:23552
  v_mfma_f32_16x16x32_bf16 v[104:107], a[60:63], a[4:7], 0
  ds_read_b64_tr_b16 a[46:47], v136 offset:29696
  v_mfma_f32_16x16x32_bf16 v[100:103], a[60:63], a[0:3], 0
  s_waitcnt vmcnt(9) lgkmcnt(4)
  s_barrier
  v_mfma_f32_16x16x32_bf16 v[20:23], a[64:67], a[20:23], v[20:23]
  buffer_load_dwordx4 v142, s[36:39], s61 offen offset:0 sc1 lds
  v_mfma_f32_16x16x32_bf16 v[24:27], a[64:67], a[24:27], v[24:27]
  ds_read_b64_tr_b16 a[48:49], v135 offset:21504
  v_mfma_f32_16x16x32_bf16 v[28:31], a[64:67], a[28:31], v[28:31]
  ds_read_b64_tr_b16 a[50:51], v135 offset:27648
  v_mfma_f32_16x16x32_bf16 v[32:35], a[64:67], a[32:35], v[32:35]
  v_mfma_f32_16x16x32_bf16 v[116:119], a[64:67], a[36:39], v[116:119]
  buffer_load_dwordx4 v142, s[36:39], s61 offen offset:1024 sc1 lds
  s_add_u32 m0, s64, 41984
  v_mfma_f32_16x16x32_bf16 v[48:51], a[68:71], a[32:35], v[48:51]
  ds_read_b64_tr_b16 a[52:53], v136 offset:21504
  v_mfma_f32_16x16x32_bf16 v[44:47], a[68:71], a[28:31], v[44:47]
  ds_read_b64_tr_b16 a[54:55], v136 offset:27648
  v_mfma_f32_16x16x32_bf16 v[40:43], a[68:71], a[24:27], v[40:43]
  v_mfma_f32_16x16x32_bf16 v[36:39], a[68:71], a[20:23], v[36:39]
  s_waitcnt lgkmcnt(4)
  buffer_load_dword v143, s[36:39], s61 offen sc1 lds
  s_mov_b32 s65, 6
  v_mfma_f32_16x16x32_bf16 v[52:55], a[20:23], a[40:43], v[52:55]
  s_mul_i32 s60, s65, 196608
  s_add_u32 m0, s62, 43008
  ds_read_b64_tr_b16 a[56:57], v135 offset:44032
  v_mfma_f32_16x16x32_bf16 v[56:59], a[24:27], a[40:43], v[56:59]
  ds_read_b128 a[0:3], v145 offset:55296
  v_mfma_f32_16x16x32_bf16 v[60:63], a[28:31], a[40:43], v[60:63]
  ds_read_b64_tr_b16 a[58:59], v135 offset:50176
  v_mfma_f32_16x16x32_bf16 v[64:67], a[32:35], a[40:43], v[64:67]
  buffer_load_dwordx4 v139, s[8:11], s60 offen offset:0 lds
  v_mfma_f32_16x16x32_bf16 v[120:123], a[36:39], a[40:43], v[120:123]
  ds_read_b128 a[4:7], v145 offset:56320
  v_mfma_f32_16x16x32_bf16 v[80:83], a[32:35], a[44:47], v[80:83]
  ds_read_b64_tr_b16 a[60:61], v136 offset:44032
  v_mfma_f32_16x16x32_bf16 v[76:79], a[28:31], a[44:47], v[76:79]
  ds_read_b128 a[8:11], v145 offset:57344
  v_mfma_f32_16x16x32_bf16 v[72:75], a[24:27], a[44:47], v[72:75]
  buffer_load_dwordx4 v140, s[8:11], s60 offen offset:1024 lds
  v_mfma_f32_16x16x32_bf16 v[68:71], a[20:23], a[44:47], v[68:71]
  s_waitcnt lgkmcnt(6)
  ds_read_b64_tr_b16 a[62:63], v136 offset:50176
  v_mfma_f32_16x16x32_bf16 v[84:87], a[48:51], a[20:23], v[84:87]
  ds_read_b128 a[12:15], v145 offset:58368
  v_mfma_f32_16x16x32_bf16 v[88:91], a[48:51], a[24:27], v[88:91]
  ds_read_b128 a[16:19], v148 offset:63488
  v_mfma_f32_16x16x32_bf16 v[92:95], a[48:51], a[28:31], v[92:95]
  buffer_load_dwordx4 v141, s[8:11], s60 offen offset:2048 lds
  s_lshl_b32 s61, s65, 11
  v_mfma_f32_16x16x32_bf16 v[96:99], a[48:51], a[32:35], v[96:99]
  s_add_u32 m0, s63, 55296
  ds_read_b64_tr_b16 a[64:65], v135 offset:45056
  v_mfma_f32_16x16x32_bf16 v[112:115], a[52:55], a[32:35], v[112:115]
  ds_read_b64_tr_b16 a[66:67], v135 offset:51200
  v_mfma_f32_16x16x32_bf16 v[108:111], a[52:55], a[28:31], v[108:111]
  ds_read_b64_tr_b16 a[68:69], v136 offset:45056
  v_mfma_f32_16x16x32_bf16 v[104:107], a[52:55], a[24:27], v[104:107]
  buffer_load_dwordx4 v142, s[36:39], s61 offen offset:0 sc1 lds
  v_mfma_f32_16x16x32_bf16 v[100:103], a[52:55], a[20:23], v[100:103]
  s_waitcnt vmcnt(13) lgkmcnt(3)
  s_barrier
  ds_read_b64_tr_b16 a[70:71], v136 offset:51200
  v_mfma_f32_16x16x32_bf16 v[20:23], a[56:59], a[0:3], v[20:23]
  ds_read_b64_tr_b16 a[40:41], v135 offset:43008
  v_mfma_f32_16x16x32_bf16 v[24:27], a[56:59], a[4:7], v[24:27]
  v_mfma_f32_16x16x32_bf16 v[28:31], a[56:59], a[8:11], v[28:31]
  buffer_load_dwordx4 v142, s[36:39], s61 offen offset:1024 sc1 lds
  s_add_u32 m0, s64, 63488
  v_mfma_f32_16x16x32_bf16 v[32:35], a[56:59], a[12:15], v[32:35]
  ds_read_b64_tr_b16 a[42:43], v135 offset:49152
  v_mfma_f32_16x16x32_bf16 v[116:119], a[56:59], a[16:19], v[116:119]
  ds_read_b64_tr_b16 a[44:45], v136 offset:43008
  v_mfma_f32_16x16x32_bf16 v[48:51], a[60:63], a[12:15], v[48:51]
  v_mfma_f32_16x16x32_bf16 v[44:47], a[60:63], a[8:11], v[44:47]
  buffer_load_dword v143, s[36:39], s61 offen sc1 lds
  s_mov_b32 s66, 7
  v_mfma_f32_16x16x32_bf16 v[40:43], a[60:63], a[4:7], v[40:43]
  s_mul_i32 s60, s66, 196608
  s_add_u32 m0, s62, 64512
  ds_read_b64_tr_b16 a[46:47], v136 offset:49152
  v_mfma_f32_16x16x32_bf16 v[36:39], a[60:63], a[0:3], v[36:39]
  s_waitcnt lgkmcnt(4)
  ds_read_b64_tr_b16 a[48:49], v137 offset:1024
  v_mfma_f32_16x16x32_bf16 v[52:55], a[0:3], a[64:67], v[52:55]
  ds_read_b128 a[20:23], v146 offset:12288
  v_mfma_f32_16x16x32_bf16 v[56:59], a[4:7], a[64:67], v[56:59]
  buffer_load_dwordx4 v139, s[8:11], s60 offen offset:0 lds
  v_mfma_f32_16x16x32_bf16 v[60:63], a[8:11], a[64:67], v[60:63]
  ds_read_b64_tr_b16 a[50:51], v137 offset:7168
  v_mfma_f32_16x16x32_bf16 v[64:67], a[12:15], a[64:67], v[64:67]
  ds_read_b128 a[24:27], v146 offset:13312
  v_mfma_f32_16x16x32_bf16 v[120:123], a[16:19], a[64:67], v[120:123]
  ds_read_b64_tr_b16 a[52:53], v138 offset:1024
  v_mfma_f32_16x16x32_bf16 v[80:83], a[12:15], a[68:71], v[80:83]
  buffer_load_dwordx4 v140, s[8:11], s60 offen offset:1024 lds
  v_mfma_f32_16x16x32_bf16 v[76:79], a[8:11], a[68:71], v[76:79]
  ds_read_b128 a[28:31], v146 offset:14336
  v_mfma_f32_16x16x32_bf16 v[72:75], a[4:7], a[68:71], v[72:75]
  ds_read_b64_tr_b16 a[54:55], v138 offset:7168
  v_mfma_f32_16x16x32_bf16 v[68:71], a[0:3], a[68:71], v[68:71]
  s_waitcnt lgkmcnt(7)
  ds_read_b128 a[32:35], v146 offset:15360
  v_mfma_f32_16x16x32_bf16 v[84:87], a[40:43], a[0:3], v[84:87]
  buffer_load_dwordx4 v141, s[8:11], s60 offen offset:2048 lds
  s_lshl_b32 s61, s66, 11
  v_mfma_f32_16x16x32_bf16 v[88:91], a[40:43], a[4:7], v[88:91]
  s_add_u32 m0, s63, 76800
  ds_read_b128 a[36:39], v149 offset:20480
  v_mfma_f32_16x16x32_bf16 v[92:95], a[40:43], a[8:11], v[92:95]
  ds_read_b64_tr_b16 a[56:57], v137 offset:2048
  v_mfma_f32_16x16x32_bf16 v[96:99], a[40:43], a[12:15], v[96:99]
  ds_read_b64_tr_b16 a[58:59], v137 offset:8192
  v_mfma_f32_16x16x32_bf16 v[112:115], a[44:47], a[12:15], v[112:115]
  buffer_load_dwordx4 v142, s[36:39], s61 offen offset:0 sc1 lds
  v_mfma_f32_16x16x32_bf16 v[108:111], a[44:47], a[8:11], v[108:111]
  ds_read_b64_tr_b16 a[60:61], v138 offset:2048
  v_mfma_f32_16x16x32_bf16 v[104:107], a[44:47], a[4:7], v[104:107]
  ds_read_b64_tr_b16 a[62:63], v138 offset:8192
  v_mfma_f32_16x16x32_bf16 v[100:103], a[44:47], a[0:3], v[100:103]
  s_waitcnt vmcnt(16) lgkmcnt(4)
  s_barrier
  v_mfma_f32_16x16x32_bf16 v[20:23], a[48:51], a[20:23], v[20:23]
  buffer_load_dwordx4 v142, s[36:39], s61 offen offset:1024 sc1 lds
  s_add_u32 m0, s64, 84992
  v_mfma_f32_16x16x32_bf16 v[24:27], a[48:51], a[24:27], v[24:27]
  ds_read_b64_tr_b16 a[64:65], v137 offset:0
  v_mfma_f32_16x16x32_bf16 v[28:31], a[48:51], a[28:31], v[28:31]
  ds_read_b64_tr_b16 a[66:67], v137 offset:6144
  v_mfma_f32_16x16x32_bf16 v[32:35], a[48:51], a[32:35], v[32:35]
  v_mfma_f32_16x16x32_bf16 v[116:119], a[48:51], a[36:39], v[116:119]
  buffer_load_dword v143, s[36:39], s61 offen sc1 lds
  s_mov_b32 s67, 8
  v_mfma_f32_16x16x32_bf16 v[48:51], a[52:55], a[32:35], v[48:51]
  s_mul_i32 s60, s67, 196608
  s_add_u32 m0, s62, 86016
  ds_read_b64_tr_b16 a[68:69], v138 offset:0
  v_mfma_f32_16x16x32_bf16 v[44:47], a[52:55], a[28:31], v[44:47]
  ds_read_b64_tr_b16 a[70:71], v138 offset:6144
  v_mfma_f32_16x16x32_bf16 v[40:43], a[52:55], a[24:27], v[40:43]
  v_mfma_f32_16x16x32_bf16 v[36:39], a[52:55], a[20:23], v[36:39]
  s_waitcnt lgkmcnt(4)
  buffer_load_dwordx4 v139, s[8:11], s60 offen offset:0 lds
  v_mfma_f32_16x16x32_bf16 v[52:55], a[20:23], a[56:59], v[52:55]
  ds_read_b64_tr_b16 a[40:41], v133 offset:1024
  v_mfma_f32_16x16x32_bf16 v[56:59], a[24:27], a[56:59], v[56:59]
  ds_read_b128 a[0:3], v144 offset:12288
  v_mfma_f32_16x16x32_bf16 v[60:63], a[28:31], a[56:59], v[60:63]
Ha0:
  s_cbranch_execz Ha0_1
  ds_read_b64_tr_b16 a[42:43], v133 offset:7168
  v_mfma_f32_16x16x32_bf16 v[64:67], a[32:35], a[56:59], v[64:67]
  buffer_load_dwordx4 v140, s[8:11], s60 offen offset:1024 lds
  v_mfma_f32_16x16x32_bf16 v[120:123], a[36:39], a[56:59], v[120:123]
  ds_read_b128 a[4:7], v144 offset:13312
  v_mfma_f32_16x16x32_bf16 v[80:83], a[32:35], a[60:63], v[80:83]
  ds_read_b64_tr_b16 a[44:45], v134 offset:1024
  v_mfma_f32_16x16x32_bf16 v[76:79], a[28:31], a[60:63], v[76:79]
  ds_read_b128 a[8:11], v144 offset:14336
  v_mfma_f32_16x16x32_bf16 v[72:75], a[24:27], a[60:63], v[72:75]
  buffer_load_dwordx4 v141, s[8:11], s60 offen offset:2048 lds
  s_lshl_b32 s61, s67, 11
  v_mfma_f32_16x16x32_bf16 v[68:71], a[20:23], a[60:63], v[68:71]
  s_waitcnt lgkmcnt(6)
  s_add_u32 m0, s63, 98304
  ds_read_b64_tr_b16 a[46:47], v134 offset:7168
  v_mfma_f32_16x16x32_bf16 v[84:87], a[64:67], a[20:23], v[84:87]
  ds_read_b128 a[12:15], v144 offset:15360
  v_mfma_f32_16x16x32_bf16 v[88:91], a[64:67], a[24:27], v[88:91]
  ds_read_b128 a[16:19], v147 offset:20480
  v_mfma_f32_16x16x32_bf16 v[92:95], a[64:67], a[28:31], v[92:95]
  buffer_load_dwordx4 v142, s[36:39], s61 offen offset:0 sc1 lds
  v_mfma_f32_16x16x32_bf16 v[96:99], a[64:67], a[32:35], v[96:99]
  ds_read_b64_tr_b16 a[48:49], v133 offset:2048
  v_mfma_f32_16x16x32_bf16 v[112:115], a[68:71], a[32:35], v[112:115]
  s_and_b32 s48, s2, 3
  ds_read_b64_tr_b16 a[50:51], v133 offset:8192
  s_lshl_b32 s48, s48, 8
  v_mfma_f32_16x16x32_bf16 v[108:111], a[68:71], a[28:31], v[108:111]
  s_lshl_b32 s49, s44, 6
  ds_read_b64_tr_b16 a[52:53], v134 offset:2048
  s_add_u32 s48, s48, s49
  v_mfma_f32_16x16x32_bf16 v[104:107], a[68:71], a[24:27], v[104:107]
  buffer_load_dwordx4 v142, s[36:39], s61 offen offset:1024 sc1 lds
  s_add_u32 m0, s64, 106496
  v_mfma_f32_16x16x32_bf16 v[100:103], a[68:71], a[20:23], v[100:103]
  s_waitcnt vmcnt(17) lgkmcnt(3)
  s_barrier
  ds_read_b64_tr_b16 a[54:55], v134 offset:8192
  v_mfma_f32_16x16x32_bf16 v[20:23], a[40:43], a[0:3], v[20:23]
  ds_read_b64_tr_b16 a[56:57], v133 offset:0
  v_mfma_f32_16x16x32_bf16 v[24:27], a[40:43], a[4:7], v[24:27]
  v_mfma_f32_16x16x32_bf16 v[28:31], a[40:43], a[8:11], v[28:31]
  buffer_load_dword v143, s[36:39], s61 offen sc1 lds
  s_mov_b32 s68, 9
  v_mfma_f32_16x16x32_bf16 v[32:35], a[40:43], a[12:15], v[32:35]
  s_mul_i32 s60, s68, 196608
  s_add_u32 m0, s62, 107520
  ds_read_b64_tr_b16 a[58:59], v133 offset:6144
  v_mfma_f32_16x16x32_bf16 v[116:119], a[40:43], a[16:19], v[116:119]
  ds_read_b64_tr_b16 a[60:61], v134 offset:0
  v_and_b32 v196, 0x38, v10
  v_mfma_f32_16x16x32_bf16 v[48:51], a[44:47], a[12:15], v[48:51]
  v_add_u32 v196, s48, v196
  v_lshlrev_b32 v12, 1, v196
  v_mfma_f32_16x16x32_bf16 v[44:47], a[44:47], a[8:11], v[44:47]
  buffer_load_dwordx4 v139, s[8:11], s60 offen offset:0 lds
  v_mfma_f32_16x16x32_bf16 v[40:43], a[44:47], a[4:7], v[40:43]
  ds_read_b64_tr_b16 a[62:63], v134 offset:6144
  v_mfma_f32_16x16x32_bf16 v[36:39], a[44:47], a[0:3], v[36:39]
  s_waitcnt lgkmcnt(4)
  ds_read_b64_tr_b16 a[64:65], v133 offset:22528
  v_mfma_f32_16x16x32_bf16 v[52:55], a[0:3], a[48:51], v[52:55]
  ds_read_b128 a[20:23], v144 offset:33792
  v_mfma_f32_16x16x32_bf16 v[56:59], a[4:7], a[48:51], v[56:59]
  buffer_load_dwordx4 v140, s[8:11], s60 offen offset:1024 lds
  v_mfma_f32_16x16x32_bf16 v[60:63], a[8:11], a[48:51], v[60:63]
  ds_read_b64_tr_b16 a[66:67], v133 offset:28672
  v_mfma_f32_16x16x32_bf16 v[64:67], a[12:15], a[48:51], v[64:67]
  ds_read_b128 a[24:27], v144 offset:34816
  v_mfma_f32_16x16x32_bf16 v[120:123], a[16:19], a[48:51], v[120:123]
  buffer_load_dwordx4 v[208:211], v12, s[40:43], 0 offen
  v_mul_u32_u24 v196, 12288, v196
  v_mfma_f32_16x16x32_bf16 v[80:83], a[12:15], a[52:55], v[80:83]
  ds_read_b64_tr_b16 a[68:69], v134 offset:22528
  v_and_b32 v12, 7, v10
  v_mfma_f32_16x16x32_bf16 v[76:79], a[8:11], a[52:55], v[76:79]
  ds_read_b128 a[28:31], v144 offset:35840
  v_lshl_add_u32 v196, v12, 4, v196
  v_mfma_f32_16x16x32_bf16 v[72:75], a[4:7], a[52:55], v[72:75]
  ds_read_b64_tr_b16 a[70:71], v134 offset:28672
  v_lshlrev_b32 v12, 5, v12
  v_mfma_f32_16x16x32_bf16 v[68:71], a[0:3], a[52:55], v[68:71]
  s_waitcnt lgkmcnt(7)
  buffer_load_dwordx4 v141, s[8:11], s60 offen offset:2048 lds
  s_lshl_b32 s61, s68, 11
  v_mfma_f32_16x16x32_bf16 v[84:87], a[56:59], a[0:3], v[84:87]
  s_add_u32 m0, s63, 119808
  ds_read_b128 a[32:35], v144 offset:36864
  v_lshrrev_b32 v13, 4, v10
  v_mfma_f32_16x16x32_bf16 v[88:91], a[56:59], a[4:7], v[88:91]
  ds_read_b128 a[36:39], v147 offset:41984
  v_lshl_add_u32 v12, v13, 3, v12
  v_mfma_f32_16x16x32_bf16 v[92:95], a[56:59], a[8:11], v[92:95]
  s_add_u32 s48, s64, 162816
  ds_read_b64_tr_b16 a[40:41], v133 offset:23552
  v_add_u32 v197, s48, v12
  v_mfma_f32_16x16x32_bf16 v[96:99], a[56:59], a[12:15], v[96:99]
  buffer_load_dwordx4 v142, s[36:39], s61 offen offset:0 sc1 lds
  v_lshlrev_b32 v198, 2, v10
  v_mfma_f32_16x16x32_bf16 v[112:115], a[60:63], a[12:15], v[112:115]
  ds_read_b64_tr_b16 a[42:43], v133 offset:29696
  v_mfma_f32_16x16x32_bf16 v[108:111], a[60:63], a[8:11], v[108:111]
  s_lshr_b32 s48, s2, 2
  ds_read_b64_tr_b16 a[44:45], v134 offset:23552
  s_and_b32 s49, s2, 3
  v_mfma_f32_16x16x32_bf16 v[104:107], a[60:63], a[4:7], v[104:107]
  s_lshl_b32 s52, s48, 7
  ds_read_b64_tr_b16 a[46:47], v134 offset:29696
  v_mfma_f32_16x16x32_bf16 v[100:103], a[60:63], a[0:3], v[100:103]
  s_waitcnt vmcnt(17) lgkmcnt(4)
  s_barrier
  buffer_load_dwordx4 v142, s[36:39], s61 offen offset:1024 sc1 lds
  v_mfma_f32_16x16x32_bf16 v[20:23], a[64:67], a[20:23], v[20:23]
  s_add_u32 m0, s64, 128000
  ds_read_b64_tr_b16 a[48:49], v133 offset:21504
  v_mfma_f32_16x16x32_bf16 v[24:27], a[64:67], a[24:27], v[24:27]
  v_mfma_f32_16x16x32_bf16 v[28:31], a[64:67], a[28:31], v[28:31]
  s_mul_i32 s53, s49, 24576
  ds_read_b64_tr_b16 a[50:51], v133 offset:27648
  s_lshl1_add_u32 s53, s52, s53
  v_mfma_f32_16x16x32_bf16 v[32:35], a[64:67], a[32:35], v[32:35]
  s_add_u32 s53, s53, 8192
  buffer_load_dword v143, s[36:39], s61 offen sc1 lds
  s_mov_b32 s69, 10
  v_mfma_f32_16x16x32_bf16 v[116:119], a[64:67], a[36:39], v[116:119]
  s_mul_i32 s60, s69, 196608
  s_add_u32 m0, s62, 129024
  ds_read_b64_tr_b16 a[52:53], v134 offset:21504
  v_mfma_f32_16x16x32_bf16 v[48:51], a[68:71], a[32:35], v[48:51]
  s_add_u32 s52, s52, 4096
  v_mfma_f32_16x16x32_bf16 v[44:47], a[68:71], a[28:31], v[44:47]
  ds_read_b64_tr_b16 a[54:55], v134 offset:27648
  v_mfma_f32_16x16x32_bf16 v[40:43], a[68:71], a[24:27], v[40:43]
  buffer_load_dwordx4 v139, s[8:11], s60 offen offset:0 lds
  v_mfma_f32_16x16x32_bf16 v[36:39], a[68:71], a[20:23], v[36:39]
  s_waitcnt lgkmcnt(4)
  ds_read_b64_tr_b16 a[56:57], v133 offset:44032
  s_lshr_b32 s49, s2, 3
  v_mfma_f32_16x16x32_bf16 v[52:55], a[20:23], a[40:43], v[52:55]
  s_and_b32 s71, s49, 7
  ds_read_b128 a[0:3], v144 offset:55296
  s_and_b32 s48, s2, 1
  v_mfma_f32_16x16x32_bf16 v[56:59], a[24:27], a[40:43], v[56:59]
  s_lshl1_add_u32 s55, s71, s48
  ds_read_b64_tr_b16 a[58:59], v133 offset:50176
  v_mfma_f32_16x16x32_bf16 v[60:63], a[28:31], a[40:43], v[60:63]
  buffer_load_dwordx4 v140, s[8:11], s60 offen offset:1024 lds
  v_mfma_f32_16x16x32_bf16 v[64:67], a[32:35], a[40:43], v[64:67]
  ds_read_b128 a[4:7], v144 offset:56320
  v_mfma_f32_16x16x32_bf16 v[120:123], a[36:39], a[40:43], v[120:123]
  ds_read_b64_tr_b16 a[60:61], v134 offset:44032
  v_mfma_f32_16x16x32_bf16 v[80:83], a[32:35], a[44:47], v[80:83]
  s_and_b32 s79, s71, 0
  ds_read_b128 a[8:11], v144 offset:57344
  s_lshl_b32 s79, s79, 3
  v_mfma_f32_16x16x32_bf16 v[76:79], a[28:31], a[44:47], v[76:79]
  buffer_load_dwordx4 v141, s[8:11], s60 offen offset:2048 lds
  s_lshl_b32 s61, s69, 11
  v_mfma_f32_16x16x32_bf16 v[72:75], a[24:27], a[44:47], v[72:75]
  s_add_u32 m0, s63, 141312
  ds_read_b64_tr_b16 a[62:63], v134 offset:50176
  v_mfma_f32_16x16x32_bf16 v[68:71], a[20:23], a[44:47], v[68:71]
  s_waitcnt lgkmcnt(7)
  ds_read_b128 a[12:15], v144 offset:58368
  v_mfma_f32_16x16x32_bf16 v[84:87], a[48:51], a[20:23], v[84:87]
  s_bfe_u32 s54, s2, 0x20001
  ds_read_b128 a[16:19], v147 offset:63488
  s_lshr_b32 s49, s2, 6
  v_mfma_f32_16x16x32_bf16 v[88:91], a[48:51], a[24:27], v[88:91]
  s_lshl2_add_u32 s54, s54, s49
  buffer_load_dwordx4 v142, s[36:39], s61 offen offset:0 sc1 lds
  s_lshl_b32 s73, s44, 12
  v_mfma_f32_16x16x32_bf16 v[92:95], a[48:51], a[28:31], v[92:95]
  ds_read_b64_tr_b16 a[64:65], v133 offset:45056
  v_mfma_f32_16x16x32_bf16 v[96:99], a[48:51], a[32:35], v[96:99]
  ds_read_b64_tr_b16 a[66:67], v133 offset:51200
  v_mfma_f32_16x16x32_bf16 v[112:115], a[52:55], a[32:35], v[112:115]
  ds_read_b64_tr_b16 a[68:69], v134 offset:45056
  v_mfma_f32_16x16x32_bf16 v[108:111], a[52:55], a[28:31], v[108:111]
  buffer_load_dwordx4 v142, s[36:39], s61 offen offset:1024 sc1 lds
  s_add_u32 m0, s64, 149504
  v_mfma_f32_16x16x32_bf16 v[104:107], a[52:55], a[24:27], v[104:107]
  s_lshl_b32 s48, s55, 7
  ds_read_b64_tr_b16 a[70:71], v134 offset:51200
  s_lshl_b32 s49, s44, 16
  v_mfma_f32_16x16x32_bf16 v[100:103], a[52:55], a[20:23], v[100:103]
  s_waitcnt vmcnt(18) lgkmcnt(4)
  s_barrier
  s_add_u32 s48, s48, s49
  v_mfma_f32_16x16x32_bf16 v[20:23], a[56:59], a[0:3], v[20:23]
  ds_read_b64_tr_b16 a[40:41], v133 offset:43008
  v_lshrrev_b32 v12, 3, v10
  v_mfma_f32_16x16x32_bf16 v[24:27], a[56:59], a[4:7], v[24:27]
  buffer_load_dword v143, s[36:39], s61 offen sc1 lds
  s_mov_b32 s70, 11
  v_mfma_f32_16x16x32_bf16 v[28:31], a[56:59], a[8:11], v[28:31]
  s_mul_i32 s60, s70, 196608
  s_add_u32 m0, s62, 0
  ds_read_b64_tr_b16 a[42:43], v133 offset:49152
  v_mfma_f32_16x16x32_bf16 v[32:35], a[56:59], a[12:15], v[32:35]
  v_lshlrev_b32 v12, 11, v12
  v_add3_u32 v216, v12, v150, s48
  v_mfma_f32_16x16x32_bf16 v[116:119], a[56:59], a[16:19], v[116:119]
  ds_read_b64_tr_b16 a[44:45], v134 offset:43008
  v_mfma_f32_16x16x32_bf16 v[48:51], a[60:63], a[12:15], v[48:51]
  buffer_load_dwordx4 v139, s[8:11], s60 offen offset:0 lds
  v_mfma_f32_16x16x32_bf16 v[44:47], a[60:63], a[8:11], v[44:47]
  ds_read_b64_tr_b16 a[46:47], v134 offset:49152
  v_mfma_f32_16x16x32_bf16 v[40:43], a[60:63], a[4:7], v[40:43]
  v_mfma_f32_16x16x32_bf16 v[36:39], a[60:63], a[0:3], v[36:39]
  s_waitcnt lgkmcnt(4)
  ds_read_b64_tr_b16 a[48:49], v135 offset:1024
  v_add_u32 v217, 15360, v216
  v_mfma_f32_16x16x32_bf16 v[52:55], a[0:3], a[64:67], v[52:55]
  buffer_load_dwordx4 v140, s[8:11], s60 offen offset:1024 lds
  v_add_u32 v218, 30720, v216
  v_mfma_f32_16x16x32_bf16 v[56:59], a[4:7], a[64:67], v[56:59]
  ds_read_b128 a[20:23], v145 offset:12288
  v_mfma_f32_16x16x32_bf16 v[60:63], a[8:11], a[64:67], v[60:63]
  ds_read_b64_tr_b16 a[50:51], v135 offset:7168
  v_add_u32 v219, 46080, v216
  v_mfma_f32_16x16x32_bf16 v[64:67], a[12:15], a[64:67], v[64:67]
  s_lshl_b32 s72, s54, 18
  ds_read_b128 a[24:27], v145 offset:13312
  s_add_u32 s72, s72, s48
  v_mfma_f32_16x16x32_bf16 v[120:123], a[16:19], a[64:67], v[120:123]
  buffer_load_dwordx4 v141, s[8:11], s60 offen offset:2048 lds
  s_lshl_b32 s61, s70, 11
  v_mfma_f32_16x16x32_bf16 v[80:83], a[12:15], a[68:71], v[80:83]
  s_add_u32 m0, s63, 12288
  ds_read_b64_tr_b16 a[52:53], v136 offset:1024
  v_mfma_f32_16x16x32_bf16 v[76:79], a[8:11], a[68:71], v[76:79]
  ds_read_b128 a[28:31], v145 offset:14336
  v_and_b32 v13, 7, v10
  v_mfma_f32_16x16x32_bf16 v[72:75], a[4:7], a[68:71], v[72:75]
  ds_read_b64_tr_b16 a[54:55], v136 offset:7168
  v_lshrrev_b32 v14, 4, v10
  v_mfma_f32_16x16x32_bf16 v[68:71], a[0:3], a[68:71], v[68:71]
  s_waitcnt lgkmcnt(7)
  buffer_load_dwordx4 v142, s[36:39], s61 offen offset:0 sc1 lds
  v_xor_b32 v13, v13, v14
  v_mfma_f32_16x16x32_bf16 v[84:87], a[40:43], a[0:3], v[84:87]
  ds_read_b128 a[32:35], v145 offset:15360
  v_lshl_add_u32 v220, v13, 4, v12
  v_mfma_f32_16x16x32_bf16 v[88:91], a[40:43], a[4:7], v[88:91]
  ds_read_b128 a[36:39], v148 offset:20480
  v_xor_b32 v221, 64, v220
  v_mfma_f32_16x16x32_bf16 v[92:95], a[40:43], a[8:11], v[92:95]
  ds_read_b64_tr_b16 a[56:57], v135 offset:2048
  v_add_u32 v221, 15360, v221
  v_mfma_f32_16x16x32_bf16 v[96:99], a[40:43], a[12:15], v[96:99]
  buffer_load_dwordx4 v142, s[36:39], s61 offen offset:1024 sc1 lds
  s_add_u32 m0, s64, 20480
  v_mfma_f32_16x16x32_bf16 v[112:115], a[44:47], a[12:15], v[112:115]
  ds_read_b64_tr_b16 a[58:59], v135 offset:8192
  v_mfma_f32_16x16x32_bf16 v[108:111], a[44:47], a[8:11], v[108:111]
  ds_read_b64_tr_b16 a[60:61], v136 offset:2048
  v_mfma_f32_16x16x32_bf16 v[104:107], a[44:47], a[4:7], v[104:107]
  ds_read_b64_tr_b16 a[62:63], v136 offset:8192
  v_mfma_f32_16x16x32_bf16 v[100:103], a[44:47], a[0:3], v[100:103]
  s_waitcnt vmcnt(18) lgkmcnt(4)
  s_barrier
  buffer_load_dword v143, s[36:39], s61 offen sc1 lds
  v_mfma_f32_16x16x32_bf16 v[20:23], a[48:51], a[20:23], v[20:23]
  s_mov_b32 s65, 12
  s_mul_i32 s60, s65, 196608
  s_add_u32 m0, s62, 21504
  v_mfma_f32_16x16x32_bf16 v[24:27], a[48:51], a[24:27], v[24:27]
  s_lshl_b32 s48, s44, 10
  ds_read_b64_tr_b16 a[64:65], v135 offset:0
  s_add_u32 s48, s48, 147456
  v_mfma_f32_16x16x32_bf16 v[28:31], a[48:51], a[28:31], v[28:31]
  ds_read_b64_tr_b16 a[66:67], v135 offset:6144
  v_add_u32 v246, s48, v0
  v_mfma_f32_16x16x32_bf16 v[32:35], a[48:51], a[32:35], v[32:35]
  buffer_load_dwordx4 v139, s[8:11], s60 offen offset:0 lds
  v_lshl_add_u32 v244, v14, 4, s48
  v_mfma_f32_16x16x32_bf16 v[116:119], a[48:51], a[36:39], v[116:119]
  ds_read_b64_tr_b16 a[68:69], v136 offset:0
  v_and_b32 v12, 1, v10
  v_mfma_f32_16x16x32_bf16 v[48:51], a[52:55], a[32:35], v[48:51]
  v_lshlrev_b32 v12, 8, v12
  v_sub_u32 v245, v244, v12
  v_mfma_f32_16x16x32_bf16 v[44:47], a[52:55], a[28:31], v[44:47]
  ds_read_b64_tr_b16 a[70:71], v136 offset:6144
  v_mfma_f32_16x16x32_bf16 v[40:43], a[52:55], a[24:27], v[40:43]
  buffer_load_dwordx4 v140, s[8:11], s60 offen offset:1024 lds
  v_mfma_f32_16x16x32_bf16 v[36:39], a[52:55], a[20:23], v[36:39]
  s_waitcnt lgkmcnt(4)
  ds_read_b64_tr_b16 a[40:41], v135 offset:22528
  v_mfma_f32_16x16x32_bf16 v[52:55], a[20:23], a[56:59], v[52:55]
  ds_read_b128 a[0:3], v145 offset:33792
  v_mfma_f32_16x16x32_bf16 v[56:59], a[24:27], a[56:59], v[56:59]
  s_lshl_b32 s48, s55, 7
  ds_read_b64_tr_b16 a[42:43], v135 offset:28672
  v_and_b32 v13, 0xf0, v0
  v_mfma_f32_16x16x32_bf16 v[60:63], a[28:31], a[56:59], v[60:63]
  buffer_load_dwordx4 v141, s[8:11], s60 offen offset:2048 lds
  s_lshl_b32 s61, s65, 11
  v_mfma_f32_16x16x32_bf16 v[64:67], a[32:35], a[56:59], v[64:67]
  s_add_u32 m0, s63, 33792
  ds_read_b128 a[4:7], v145 offset:34816
  v_lshl_add_u32 v13, v14, 12, v13
  v_mfma_f32_16x16x32_bf16 v[120:123], a[36:39], a[56:59], v[120:123]
  s_lshl1_add_u32 s48, s48, 8192
  ds_read_b64_tr_b16 a[44:45], v136 offset:22528
  v_add_u32 v248, s48, v13
  v_mfma_f32_16x16x32_bf16 v[80:83], a[32:35], a[60:63], v[80:83]
  ds_read_b128 a[8:11], v145 offset:35840
  v_mfma_f32_16x16x32_bf16 v[76:79], a[28:31], a[60:63], v[76:79]
  buffer_load_dwordx4 v142, s[36:39], s61 offen offset:0 sc1 lds
  v_mfma_f32_16x16x32_bf16 v[72:75], a[24:27], a[60:63], v[72:75]
  ds_read_b64_tr_b16 a[46:47], v136 offset:28672
  v_mfma_f32_16x16x32_bf16 v[68:71], a[20:23], a[60:63], v[68:71]
  s_waitcnt lgkmcnt(7)
  ds_read_b128 a[12:15], v145 offset:36864
  v_mfma_f32_16x16x32_bf16 v[84:87], a[64:67], a[20:23], v[84:87]
  ds_read_b128 a[16:19], v148 offset:41984
  v_lshrrev_b32 v12, 2, v10
  v_mfma_f32_16x16x32_bf16 v[88:91], a[64:67], a[24:27], v[88:91]
  buffer_load_dwordx4 v142, s[36:39], s61 offen offset:1024 sc1 lds
  s_add_u32 m0, s64, 41984
  v_mfma_f32_16x16x32_bf16 v[92:95], a[64:67], a[28:31], v[92:95]
  ds_read_b64_tr_b16 a[48:49], v135 offset:23552
  v_lshl_add_u32 v231, v12, 7, v151
  v_mfma_f32_16x16x32_bf16 v[96:99], a[64:67], a[32:35], v[96:99]
  ds_read_b64_tr_b16 a[50:51], v135 offset:29696
  v_xor_b32 v232, 32, v231
  v_mfma_f32_16x16x32_bf16 v[112:115], a[68:71], a[32:35], v[112:115]
  ds_read_b64_tr_b16 a[52:53], v136 offset:23552
  v_mfma_f32_16x16x32_bf16 v[108:111], a[68:71], a[28:31], v[108:111]
  buffer_load_dword v143, s[36:39], s61 offen sc1 lds
  s_mov_b32 s66, 13
  v_mfma_f32_16x16x32_bf16 v[104:107], a[68:71], a[24:27], v[104:107]
  s_mul_i32 s60, s66, 196608
  s_add_u32 m0, s62, 43008
  ds_read_b64_tr_b16 a[54:55], v136 offset:29696
  v_mfma_f32_16x16x32_bf16 v[100:103], a[68:71], a[20:23], v[100:103]
  s_waitcnt vmcnt(18) lgkmcnt(4)
  s_barrier
  v_xor_b32 v233, 64, v231
  v_mfma_f32_16x16x32_bf16 v[20:23], a[40:43], a[0:3], v[20:23]
  ds_read_b64_tr_b16 a[56:57], v135 offset:21504
  v_xor_b32 v234, 96, v231
  v_mfma_f32_16x16x32_bf16 v[24:27], a[40:43], a[4:7], v[24:27]
  buffer_load_dwordx4 v139, s[8:11], s60 offen offset:0 lds
  v_xor_b32 v235, 65536, v231
  v_mfma_f32_16x16x32_bf16 v[28:31], a[40:43], a[8:11], v[28:31]
  ds_read_b64_tr_b16 a[58:59], v135 offset:27648
  v_xor_b32 v236, 65568, v231
  v_mfma_f32_16x16x32_bf16 v[32:35], a[40:43], a[12:15], v[32:35]
  v_xor_b32 v237, 65600, v231
  v_mfma_f32_16x16x32_bf16 v[116:119], a[40:43], a[16:19], v[116:119]
  ds_read_b64_tr_b16 a[60:61], v136 offset:21504
  v_mfma_f32_16x16x32_bf16 v[48:51], a[44:47], a[12:15], v[48:51]
  buffer_load_dwordx4 v140, s[8:11], s60 offen offset:1024 lds
  v_xor_b32 v238, 65632, v231
  v_mfma_f32_16x16x32_bf16 v[44:47], a[44:47], a[8:11], v[44:47]
  ds_read_b64_tr_b16 a[62:63], v136 offset:27648
  v_mfma_f32_16x16x32_bf16 v[40:43], a[44:47], a[4:7], v[40:43]
  s_add_u32 s48, s73, 131072
  v_and_b32 v12, 15, v10
  v_lshrrev_b32 v14, 1, v12
  v_mfma_f32_16x16x32_bf16 v[36:39], a[44:47], a[0:3], v[36:39]
  s_waitcnt lgkmcnt(4)
  ds_read_b64_tr_b16 a[64:65], v135 offset:44032
  v_lshrrev_b32 v13, 5, v10
  v_mfma_f32_16x16x32_bf16 v[52:55], a[0:3], a[48:51], v[52:55]
  buffer_load_dwordx4 v141, s[8:11], s60 offen offset:2048 lds
  s_lshl_b32 s61, s66, 11
  v_mfma_f32_16x16x32_bf16 v[56:59], a[4:7], a[48:51], v[56:59]
  s_add_u32 m0, s63, 55296
  ds_read_b128 a[20:23], v145 offset:55296
  v_xor_b32 v14, v14, v13
  v_mfma_f32_16x16x32_bf16 v[60:63], a[8:11], a[48:51], v[60:63]
  ds_read_b64_tr_b16 a[66:67], v135 offset:50176
  v_lshlrev_b32 v14, 4, v14
  v_mfma_f32_16x16x32_bf16 v[64:67], a[12:15], a[48:51], v[64:67]
  ds_read_b128 a[24:27], v145 offset:56320
  v_lshl_add_u32 v14, v12, 7, v14
  v_mfma_f32_16x16x32_bf16 v[120:123], a[16:19], a[48:51], v[120:123]
  buffer_load_dwordx4 v142, s[36:39], s61 offen offset:0 sc1 lds
  v_bfe_u32 v13, v10, 4, 1
  v_mfma_f32_16x16x32_bf16 v[80:83], a[12:15], a[52:55], v[80:83]
  ds_read_b64_tr_b16 a[68:69], v136 offset:44032
  v_lshl_add_u32 v14, v13, 3, v14
  v_mfma_f32_16x16x32_bf16 v[76:79], a[8:11], a[52:55], v[76:79]
  ds_read_b128 a[28:31], v145 offset:57344
  v_add_u32 v239, s48, v14
  v_mfma_f32_16x16x32_bf16 v[72:75], a[4:7], a[52:55], v[72:75]
  ds_read_b64_tr_b16 a[70:71], v136 offset:50176
  v_xor_b32 v240, 32, v239
  v_mfma_f32_16x16x32_bf16 v[68:71], a[0:3], a[52:55], v[68:71]
  s_waitcnt lgkmcnt(7)
  buffer_load_dwordx4 v142, s[36:39], s61 offen offset:1024 sc1 lds
  s_add_u32 m0, s64, 63488
  v_mfma_f32_16x16x32_bf16 v[84:87], a[56:59], a[0:3], v[84:87]
  ds_read_b128 a[32:35], v145 offset:58368
  v_xor_b32 v241, 64, v239
  v_mfma_f32_16x16x32_bf16 v[88:91], a[56:59], a[4:7], v[88:91]
  ds_read_b128 a[36:39], v148 offset:63488
  v_xor_b32 v242, 96, v239
  v_mfma_f32_16x16x32_bf16 v[92:95], a[56:59], a[8:11], v[92:95]
  ds_read_b64_tr_b16 a[40:41], v135 offset:45056
  v_mfma_f32_16x16x32_bf16 v[96:99], a[56:59], a[12:15], v[96:99]
  buffer_load_dword v143, s[36:39], s61 offen sc1 lds
  s_mov_b32 s67, 14
  v_mfma_f32_16x16x32_bf16 v[112:115], a[60:63], a[12:15], v[112:115]
  s_mul_i32 s60, s67, 196608
  s_add_u32 m0, s62, 64512
  ds_read_b64_tr_b16 a[42:43], v135 offset:51200
  v_mfma_f32_16x16x32_bf16 v[108:111], a[60:63], a[8:11], v[108:111]
  ds_read_b64_tr_b16 a[44:45], v136 offset:45056
  v_mfma_f32_16x16x32_bf16 v[104:107], a[60:63], a[4:7], v[104:107]
  ds_read_b64_tr_b16 a[46:47], v136 offset:51200
  v_mfma_f32_16x16x32_bf16 v[100:103], a[60:63], a[0:3], v[100:103]
  s_waitcnt vmcnt(18) lgkmcnt(4)
  s_barrier
  buffer_load_dwordx4 v139, s[8:11], s60 offen offset:0 lds
  v_mfma_f32_16x16x32_bf16 v[20:23], a[64:67], a[20:23], v[20:23]
  ds_read_b64_tr_b16 a[48:49], v135 offset:43008
  v_mfma_f32_16x16x32_bf16 v[24:27], a[64:67], a[24:27], v[24:27]
  s_lshl2_add_u32 s48, s54, s44
  s_lshl_b32 s49, s48, 16
  s_add_u32 s49, s49, 7340032
  v_mfma_f32_16x16x32_bf16 v[28:31], a[64:67], a[28:31], v[28:31]
  ds_read_b64_tr_b16 a[50:51], v135 offset:49152
  v_add_u32 v243, s49, v0
  v_mfma_f32_16x16x32_bf16 v[32:35], a[64:67], a[32:35], v[32:35]
  buffer_load_dwordx4 v140, s[8:11], s60 offen offset:1024 lds
  v_mfma_f32_16x16x32_bf16 v[116:119], a[64:67], a[36:39], v[116:119]
  ds_read_b64_tr_b16 a[52:53], v136 offset:43008
  v_mfma_f32_16x16x32_bf16 v[48:51], a[68:71], a[32:35], v[48:51]
  v_mfma_f32_16x16x32_bf16 v[44:47], a[68:71], a[28:31], v[44:47]
  ds_read_b64_tr_b16 a[54:55], v136 offset:49152
  v_mfma_f32_16x16x32_bf16 v[40:43], a[68:71], a[24:27], v[40:43]
  buffer_load_dwordx4 v141, s[8:11], s60 offen offset:2048 lds
  s_lshl_b32 s61, s67, 11
  v_mfma_f32_16x16x32_bf16 v[36:39], a[68:71], a[20:23], v[36:39]
  s_waitcnt lgkmcnt(4)
  s_add_u32 m0, s63, 76800
  ds_read_b64_tr_b16 a[56:57], v137 offset:1024
  v_mfma_f32_16x16x32_bf16 v[52:55], a[20:23], a[40:43], v[52:55]
  s_lshl4_add_u32 s77, s48, s55
  ds_read_b128 a[0:3], v146 offset:12288
  s_lshl_b32 s77, s77, 8
  v_mfma_f32_16x16x32_bf16 v[56:59], a[24:27], a[40:43], v[56:59]
  s_add_u32 s77, s77, 262144
  ds_read_b64_tr_b16 a[58:59], v137 offset:7168
  v_mfma_f32_16x16x32_bf16 v[60:63], a[28:31], a[40:43], v[60:63]
  buffer_load_dwordx4 v142, s[36:39], s61 offen offset:0 sc1 lds
  v_mfma_f32_16x16x32_bf16 v[64:67], a[32:35], a[40:43], v[64:67]
  ds_read_b128 a[4:7], v146 offset:13312
  v_mfma_f32_16x16x32_bf16 v[120:123], a[36:39], a[40:43], v[120:123]
  s_lshr_b32 s76, s48, 1
  ds_read_b64_tr_b16 a[60:61], v138 offset:1024
  s_lshl4_add_u32 s76, s76, s55
  v_mfma_f32_16x16x32_bf16 v[80:83], a[32:35], a[44:47], v[80:83]
  s_and_b32 s49, s48, 1
  ds_read_b128 a[8:11], v146 offset:14336
  s_lshl2_add_u32 s76, s76, s49
  v_mfma_f32_16x16x32_bf16 v[76:79], a[28:31], a[44:47], v[76:79]
  s_lshl_b32 s76, s76, 11
  buffer_load_dwordx4 v142, s[36:39], s61 offen offset:1024 sc1 lds
  s_add_u32 m0, s64, 84992
  v_mfma_f32_16x16x32_bf16 v[72:75], a[24:27], a[44:47], v[72:75]
  s_add_u32 s76, s76, 36700160
  ds_read_b64_tr_b16 a[62:63], v138 offset:7168
  v_mfma_f32_16x16x32_bf16 v[68:71], a[20:23], a[44:47], v[68:71]
  s_waitcnt lgkmcnt(7)
  ds_read_b128 a[12:15], v146 offset:15360
  v_mfma_f32_16x16x32_bf16 v[84:87], a[48:51], a[20:23], v[84:87]
  ds_read_b128 a[16:19], v149 offset:20480
  v_mfma_f32_16x16x32_bf16 v[88:91], a[48:51], a[24:27], v[88:91]
  buffer_load_dword v143, s[36:39], s61 offen sc1 lds
  s_mov_b32 s68, 15
  v_mfma_f32_16x16x32_bf16 v[92:95], a[48:51], a[28:31], v[92:95]
  s_mul_i32 s60, s68, 196608
  s_add_u32 m0, s62, 86016
  ds_read_b64_tr_b16 a[64:65], v137 offset:2048
  v_mfma_f32_16x16x32_bf16 v[96:99], a[48:51], a[32:35], v[96:99]
  ds_read_b64_tr_b16 a[66:67], v137 offset:8192
  v_mfma_f32_16x16x32_bf16 v[112:115], a[52:55], a[32:35], v[112:115]
  s_lshl1_add_u32 s78, s48, s55
  ds_read_b64_tr_b16 a[68:69], v138 offset:2048
  s_lshl_b32 s78, s78, 11
  v_mfma_f32_16x16x32_bf16 v[108:111], a[52:55], a[28:31], v[108:111]
  s_add_u32 s78, s78, 5767168
  buffer_load_dwordx4 v139, s[8:11], s60 offen offset:0 lds
  s_and_b32 s48, s48, 7
  v_mfma_f32_16x16x32_bf16 v[104:107], a[52:55], a[24:27], v[104:107]
  s_cselect_b32 s78, 1073741824, s78
  ds_read_b64_tr_b16 a[70:71], v138 offset:8192
  v_mfma_f32_16x16x32_bf16 v[100:103], a[52:55], a[20:23], v[100:103]
  s_waitcnt vmcnt(19) lgkmcnt(4)
  s_barrier
  v_mfma_f32_16x16x32_bf16 v[20:23], a[56:59], a[0:3], v[20:23]
  ds_read_b64_tr_b16 a[40:41], v137 offset:0
  v_mfma_f32_16x16x32_bf16 v[24:27], a[56:59], a[4:7], v[24:27]
  buffer_load_dwordx4 v140, s[8:11], s60 offen offset:1024 lds
  v_mfma_f32_16x16x32_bf16 v[28:31], a[56:59], a[8:11], v[28:31]
  ds_read_b64_tr_b16 a[42:43], v137 offset:6144
  v_mfma_f32_16x16x32_bf16 v[32:35], a[56:59], a[12:15], v[32:35]
  v_mfma_f32_16x16x32_bf16 v[116:119], a[56:59], a[16:19], v[116:119]
  s_and_b32 s48, s54, 7
  ds_read_b64_tr_b16 a[44:45], v138 offset:0
  s_lshl_b32 s48, s48, 5
  v_mfma_f32_16x16x32_bf16 v[48:51], a[60:63], a[12:15], v[48:51]
  s_lshr_b32 s49, s54, 3
  buffer_load_dwordx4 v141, s[8:11], s60 offen offset:2048 lds
  s_lshl_b32 s61, s68, 11
  v_mfma_f32_16x16x32_bf16 v[44:47], a[60:63], a[8:11], v[44:47]
  s_add_u32 m0, s63, 98304
  ds_read_b64_tr_b16 a[46:47], v138 offset:6144
  s_lshl2_add_u32 s48, s49, s48
  v_mfma_f32_16x16x32_bf16 v[40:43], a[60:63], a[4:7], v[40:43]
  v_mfma_f32_16x16x32_bf16 v[36:39], a[60:63], a[0:3], v[36:39]
  s_waitcnt lgkmcnt(4)
  ds_read_b64_tr_b16 a[48:49], v133 offset:1024
  v_mfma_f32_16x16x32_bf16 v[52:55], a[0:3], a[64:67], v[52:55]
  buffer_load_dwordx4 v142, s[36:39], s61 offen offset:0 sc1 lds
  v_mfma_f32_16x16x32_bf16 v[56:59], a[4:7], a[64:67], v[56:59]
  ds_read_b128 a[20:23], v144 offset:12288
  v_mfma_f32_16x16x32_bf16 v[60:63], a[8:11], a[64:67], v[60:63]
  ds_read_b64_tr_b16 a[50:51], v133 offset:7168
  v_and_b32 v12, 3, v10
  v_mfma_f32_16x16x32_bf16 v[64:67], a[12:15], a[64:67], v[64:67]
  ds_read_b128 a[24:27], v144 offset:13312
  v_bfe_u32 v13, v10, 2, 2
  v_mfma_f32_16x16x32_bf16 v[120:123], a[16:19], a[64:67], v[120:123]
  buffer_load_dwordx4 v142, s[36:39], s61 offen offset:1024 sc1 lds
  s_add_u32 m0, s64, 106496
  v_mfma_f32_16x16x32_bf16 v[80:83], a[12:15], a[68:71], v[80:83]
  ds_read_b64_tr_b16 a[52:53], v134 offset:1024
  v_lshl_add_u32 v12, v13, 3, v12
  v_mfma_f32_16x16x32_bf16 v[76:79], a[8:11], a[68:71], v[76:79]
  ds_read_b128 a[28:31], v144 offset:14336
  v_add_lshl_u32 v249, v12, s48, 7
  v_mfma_f32_16x16x32_bf16 v[72:75], a[4:7], a[68:71], v[72:75]
  ds_read_b64_tr_b16 a[54:55], v134 offset:7168
  v_mfma_f32_16x16x32_bf16 v[68:71], a[0:3], a[68:71], v[68:71]
  s_waitcnt lgkmcnt(7)
  buffer_load_dword v143, s[36:39], s61 offen sc1 lds
  s_mov_b32 s69, 16
  v_mfma_f32_16x16x32_bf16 v[84:87], a[40:43], a[0:3], v[84:87]
  s_mul_i32 s60, s69, 196608
  s_add_u32 m0, s62, 107520
  ds_read_b128 a[32:35], v144 offset:15360
  v_mfma_f32_16x16x32_bf16 v[88:91], a[40:43], a[4:7], v[88:91]
  s_waitcnt vmcnt(40)
  ds_read_b128 a[36:39], v147 offset:20480
  v_lshlrev_b32 v188, 16, v208
  v_mfma_f32_16x16x32_bf16 v[92:95], a[40:43], a[8:11], v[92:95]
  ds_read_b64_tr_b16 a[56:57], v133 offset:2048
  v_and_b32 v189, 0xffff0000, v208
  v_mfma_f32_16x16x32_bf16 v[96:99], a[40:43], a[12:15], v[96:99]
  buffer_load_dwordx4 v139, s[8:11], s60 offen offset:0 lds
  v_mfma_f32_16x16x32_bf16 v[112:115], a[44:47], a[12:15], v[112:115]
  ds_read_b64_tr_b16 a[58:59], v133 offset:8192
  v_lshlrev_b32 v190, 16, v209
  v_mfma_f32_16x16x32_bf16 v[108:111], a[44:47], a[8:11], v[108:111]
  ds_read_b64_tr_b16 a[60:61], v134 offset:2048
  v_mfma_f32_16x16x32_bf16 v[104:107], a[44:47], a[4:7], v[104:107]
  ds_read_b64_tr_b16 a[62:63], v134 offset:8192
  v_and_b32 v191, 0xffff0000, v209
  v_mfma_f32_16x16x32_bf16 v[100:103], a[44:47], a[0:3], v[100:103]
  s_waitcnt vmcnt(19) lgkmcnt(4)
  s_barrier
  buffer_load_dwordx4 v140, s[8:11], s60 offen offset:1024 lds
  v_mfma_f32_16x16x32_bf16 v[20:23], a[48:51], a[20:23], v[20:23]
  ds_read_b64_tr_b16 a[64:65], v133 offset:0
  v_lshlrev_b32 v192, 16, v210
  v_mfma_f32_16x16x32_bf16 v[24:27], a[48:51], a[24:27], v[24:27]
Ha1:
  s_cbranch_execz Ha1_1
  v_and_b32 v193, 0xffff0000, v210
  v_mfma_f32_16x16x32_bf16 v[28:31], a[48:51], a[28:31], v[28:31]
  ds_read_b64_tr_b16 a[66:67], v133 offset:6144
  v_lshlrev_b32 v194, 16, v211
  v_mfma_f32_16x16x32_bf16 v[32:35], a[48:51], a[32:35], v[32:35]
  buffer_load_dwordx4 v141, s[8:11], s60 offen offset:2048 lds
  s_lshl_b32 s61, s69, 11
  v_mfma_f32_16x16x32_bf16 v[116:119], a[48:51], a[36:39], v[116:119]
  s_add_u32 m0, s63, 119808
  ds_read_b64_tr_b16 a[68:69], v134 offset:0
  v_and_b32 v195, 0xffff0000, v211
  v_mfma_f32_16x16x32_bf16 v[48:51], a[52:55], a[32:35], v[48:51]
  v_mfma_f32_16x16x32_bf16 v[44:47], a[52:55], a[28:31], v[44:47]
  ds_read_b64_tr_b16 a[70:71], v134 offset:6144
  v_mul_f32 v200, 0xbfb8aa3b, v188
  v_mfma_f32_16x16x32_bf16 v[40:43], a[52:55], a[24:27], v[40:43]
  buffer_load_dwordx4 v142, s[36:39], s61 offen offset:0 sc1 lds
  v_mul_f32 v201, 0xbfb8aa3b, v189
  v_mfma_f32_16x16x32_bf16 v[36:39], a[52:55], a[20:23], v[36:39]
  s_waitcnt lgkmcnt(4)
  ds_read_b64_tr_b16 a[40:41], v133 offset:22528
  v_mfma_f32_16x16x32_bf16 v[52:55], a[20:23], a[56:59], v[52:55]
  ds_read_b128 a[0:3], v144 offset:33792
  v_mul_f32 v202, 0xbfb8aa3b, v190
  v_mfma_f32_16x16x32_bf16 v[56:59], a[24:27], a[56:59], v[56:59]
  ds_read_b64_tr_b16 a[42:43], v133 offset:28672
  v_mul_f32 v203, 0xbfb8aa3b, v191
  v_mfma_f32_16x16x32_bf16 v[60:63], a[28:31], a[56:59], v[60:63]
  buffer_load_dwordx4 v142, s[36:39], s61 offen offset:1024 sc1 lds
  s_add_u32 m0, s64, 128000
  v_mfma_f32_16x16x32_bf16 v[64:67], a[32:35], a[56:59], v[64:67]
  ds_read_b128 a[4:7], v144 offset:34816
  v_mul_f32 v204, 0xbfb8aa3b, v192
  v_mfma_f32_16x16x32_bf16 v[120:123], a[36:39], a[56:59], v[120:123]
  ds_read_b64_tr_b16 a[44:45], v134 offset:22528
  v_mfma_f32_16x16x32_bf16 v[80:83], a[32:35], a[60:63], v[80:83]
  ds_read_b128 a[8:11], v144 offset:35840
  v_mul_f32 v205, 0xbfb8aa3b, v193
  v_mfma_f32_16x16x32_bf16 v[76:79], a[28:31], a[60:63], v[76:79]
  buffer_load_dword v143, s[36:39], s61 offen sc1 lds
  s_mov_b32 s70, 17
  v_mfma_f32_16x16x32_bf16 v[72:75], a[24:27], a[60:63], v[72:75]
  s_mul_i32 s60, s70, 196608
  s_add_u32 m0, s62, 129024
  ds_read_b64_tr_b16 a[46:47], v134 offset:28672
  v_mfma_f32_16x16x32_bf16 v[68:71], a[20:23], a[60:63], v[68:71]
  s_waitcnt lgkmcnt(7)
  ds_read_b128 a[12:15], v144 offset:36864
  v_mul_f32 v206, 0xbfb8aa3b, v194
  v_mfma_f32_16x16x32_bf16 v[84:87], a[64:67], a[20:23], v[84:87]
  ds_read_b128 a[16:19], v147 offset:41984
  v_mul_f32 v207, 0xbfb8aa3b, v195
  v_mfma_f32_16x16x32_bf16 v[88:91], a[64:67], a[24:27], v[88:91]
  buffer_load_dwordx4 v139, s[8:11], s60 offen offset:0 lds
  v_mfma_f32_16x16x32_bf16 v[92:95], a[64:67], a[28:31], v[92:95]
  ds_read_b64_tr_b16 a[48:49], v133 offset:23552
  v_mfma_f32_16x16x32_bf16 v[96:99], a[64:67], a[32:35], v[96:99]
  ds_read_b64_tr_b16 a[50:51], v133 offset:29696
  v_mfma_f32_16x16x32_bf16 v[112:115], a[68:71], a[32:35], v[112:115]
  ds_read_b64_tr_b16 a[52:53], v134 offset:23552
  v_mfma_f32_16x16x32_bf16 v[108:111], a[68:71], a[28:31], v[108:111]
  buffer_load_dwordx4 v140, s[8:11], s60 offen offset:1024 lds
  v_mfma_f32_16x16x32_bf16 v[104:107], a[68:71], a[24:27], v[104:107]
  ds_read_b64_tr_b16 a[54:55], v134 offset:29696
  v_mfma_f32_16x16x32_bf16 v[100:103], a[68:71], a[20:23], v[100:103]
  s_waitcnt vmcnt(20) lgkmcnt(4)
  s_barrier
  v_mfma_f32_16x16x32_bf16 v[20:23], a[40:43], a[0:3], v[20:23]
  ds_read_b64_tr_b16 a[56:57], v133 offset:21504
  v_mfma_f32_16x16x32_bf16 v[24:27], a[40:43], a[4:7], v[24:27]
  buffer_load_dwordx4 v141, s[8:11], s60 offen offset:2048 lds
  s_lshl_b32 s61, s70, 11
  v_mfma_f32_16x16x32_bf16 v[28:31], a[40:43], a[8:11], v[28:31]
  s_add_u32 m0, s63, 141312
  ds_read_b64_tr_b16 a[58:59], v133 offset:27648
  v_mfma_f32_16x16x32_bf16 v[32:35], a[40:43], a[12:15], v[32:35]
  v_exp_f32 v200, v200
  v_mfma_f32_16x16x32_bf16 v[116:119], a[40:43], a[16:19], v[116:119]
  ds_read_b64_tr_b16 a[60:61], v134 offset:21504
  v_mfma_f32_16x16x32_bf16 v[48:51], a[44:47], a[12:15], v[48:51]
  buffer_load_dwordx4 v142, s[36:39], s61 offen offset:0 sc1 lds
  v_mfma_f32_16x16x32_bf16 v[44:47], a[44:47], a[8:11], v[44:47]
  ds_read_b64_tr_b16 a[62:63], v134 offset:27648
  v_mfma_f32_16x16x32_bf16 v[40:43], a[44:47], a[4:7], v[40:43]
  v_exp_f32 v201, v201
  v_mfma_f32_16x16x32_bf16 v[36:39], a[44:47], a[0:3], v[36:39]
  s_waitcnt lgkmcnt(4)
  ds_read_b64_tr_b16 a[64:65], v133 offset:44032
  v_mfma_f32_16x16x32_bf16 v[52:55], a[0:3], a[48:51], v[52:55]
  buffer_load_dwordx4 v142, s[36:39], s61 offen offset:1024 sc1 lds
  s_add_u32 m0, s64, 149504
  v_mfma_f32_16x16x32_bf16 v[56:59], a[4:7], a[48:51], v[56:59]
  ds_read_b128 a[20:23], v144 offset:55296
  v_mfma_f32_16x16x32_bf16 v[60:63], a[8:11], a[48:51], v[60:63]
  ds_read_b64_tr_b16 a[66:67], v133 offset:50176
  v_mfma_f32_16x16x32_bf16 v[64:67], a[12:15], a[48:51], v[64:67]
  ds_read_b128 a[24:27], v144 offset:56320
  v_mfma_f32_16x16x32_bf16 v[120:123], a[16:19], a[48:51], v[120:123]
  buffer_load_dword v143, s[36:39], s61 offen sc1 lds
  s_mov_b32 s65, 18
  v_mfma_f32_16x16x32_bf16 v[80:83], a[12:15], a[52:55], v[80:83]
  s_mul_i32 s60, s65, 196608
  s_add_u32 m0, s62, 0
  ds_read_b64_tr_b16 a[68:69], v134 offset:44032
  v_mfma_f32_16x16x32_bf16 v[76:79], a[8:11], a[52:55], v[76:79]
  ds_read_b128 a[28:31], v144 offset:57344
  v_mfma_f32_16x16x32_bf16 v[72:75], a[4:7], a[52:55], v[72:75]
  ds_read_b64_tr_b16 a[70:71], v134 offset:50176
  v_mfma_f32_16x16x32_bf16 v[68:71], a[0:3], a[52:55], v[68:71]
  s_waitcnt lgkmcnt(7)
  buffer_load_dwordx4 v139, s[8:11], s60 offen offset:0 lds
  v_mfma_f32_16x16x32_bf16 v[84:87], a[56:59], a[0:3], v[84:87]
  ds_read_b128 a[32:35], v144 offset:58368
  v_mfma_f32_16x16x32_bf16 v[88:91], a[56:59], a[4:7], v[88:91]
  ds_read_b128 a[36:39], v147 offset:63488
  v_mfma_f32_16x16x32_bf16 v[92:95], a[56:59], a[8:11], v[92:95]
  ds_read_b64_tr_b16 a[40:41], v133 offset:45056
  v_mfma_f32_16x16x32_bf16 v[96:99], a[56:59], a[12:15], v[96:99]
  buffer_load_dwordx4 v140, s[8:11], s60 offen offset:1024 lds
  v_mfma_f32_16x16x32_bf16 v[112:115], a[60:63], a[12:15], v[112:115]
  ds_read_b64_tr_b16 a[42:43], v133 offset:51200
  v_mfma_f32_16x16x32_bf16 v[108:111], a[60:63], a[8:11], v[108:111]
  ds_read_b64_tr_b16 a[44:45], v134 offset:45056
  v_mfma_f32_16x16x32_bf16 v[104:107], a[60:63], a[4:7], v[104:107]
  ds_read_b64_tr_b16 a[46:47], v134 offset:51200
  v_mfma_f32_16x16x32_bf16 v[100:103], a[60:63], a[0:3], v[100:103]
  s_waitcnt vmcnt(20) lgkmcnt(4)
  s_barrier
  buffer_load_dwordx4 v141, s[8:11], s60 offen offset:2048 lds
  v_mfma_f32_16x16x32_bf16 v[20:23], a[64:67], a[20:23], v[20:23]
  s_lshl_b32 s61, s65, 11
  s_add_u32 m0, s63, 12288
  ds_read_b64_tr_b16 a[48:49], v133 offset:43008
  v_mfma_f32_16x16x32_bf16 v[24:27], a[64:67], a[24:27], v[24:27]
  v_exp_f32 v202, v202
  v_mfma_f32_16x16x32_bf16 v[28:31], a[64:67], a[28:31], v[28:31]
  ds_read_b64_tr_b16 a[50:51], v133 offset:49152
  v_mfma_f32_16x16x32_bf16 v[32:35], a[64:67], a[32:35], v[32:35]
  buffer_load_dwordx4 v142, s[36:39], s61 offen offset:0 sc1 lds
  v_mfma_f32_16x16x32_bf16 v[116:119], a[64:67], a[36:39], v[116:119]
  ds_read_b64_tr_b16 a[52:53], v134 offset:43008
  v_mfma_f32_16x16x32_bf16 v[48:51], a[68:71], a[32:35], v[48:51]
  v_exp_f32 v203, v203
  v_mfma_f32_16x16x32_bf16 v[44:47], a[68:71], a[28:31], v[44:47]
  ds_read_b64_tr_b16 a[54:55], v134 offset:49152
  v_mfma_f32_16x16x32_bf16 v[40:43], a[68:71], a[24:27], v[40:43]
  buffer_load_dwordx4 v142, s[36:39], s61 offen offset:1024 sc1 lds
  s_add_u32 m0, s64, 20480
  v_mfma_f32_16x16x32_bf16 v[36:39], a[68:71], a[20:23], v[36:39]
  s_waitcnt lgkmcnt(4)
  ds_read_b64_tr_b16 a[56:57], v135 offset:1024
  v_mfma_f32_16x16x32_bf16 v[52:55], a[20:23], a[40:43], v[52:55]
  ds_read_b128 a[0:3], v145 offset:12288
  v_mfma_f32_16x16x32_bf16 v[56:59], a[24:27], a[40:43], v[56:59]
  ds_read_b64_tr_b16 a[58:59], v135 offset:7168
  v_mfma_f32_16x16x32_bf16 v[60:63], a[28:31], a[40:43], v[60:63]
  buffer_load_dword v143, s[36:39], s61 offen sc1 lds
  s_mov_b32 s66, 19
  v_mfma_f32_16x16x32_bf16 v[64:67], a[32:35], a[40:43], v[64:67]
  s_mul_i32 s60, s66, 196608
  s_add_u32 m0, s62, 21504
  ds_read_b128 a[4:7], v145 offset:13312
  v_mfma_f32_16x16x32_bf16 v[120:123], a[36:39], a[40:43], v[120:123]
  ds_read_b64_tr_b16 a[60:61], v136 offset:1024
  v_mfma_f32_16x16x32_bf16 v[80:83], a[32:35], a[44:47], v[80:83]
  ds_read_b128 a[8:11], v145 offset:14336
  v_mfma_f32_16x16x32_bf16 v[76:79], a[28:31], a[44:47], v[76:79]
  buffer_load_dwordx4 v139, s[8:11], s60 offen offset:0 lds
  v_mfma_f32_16x16x32_bf16 v[72:75], a[24:27], a[44:47], v[72:75]
  ds_read_b64_tr_b16 a[62:63], v136 offset:7168
  v_mfma_f32_16x16x32_bf16 v[68:71], a[20:23], a[44:47], v[68:71]
  s_waitcnt lgkmcnt(7)
  ds_read_b128 a[12:15], v145 offset:15360
  v_mfma_f32_16x16x32_bf16 v[84:87], a[48:51], a[20:23], v[84:87]
  ds_read_b128 a[16:19], v148 offset:20480
  v_mfma_f32_16x16x32_bf16 v[88:91], a[48:51], a[24:27], v[88:91]
  buffer_load_dwordx4 v140, s[8:11], s60 offen offset:1024 lds
  v_mfma_f32_16x16x32_bf16 v[92:95], a[48:51], a[28:31], v[92:95]
  ds_read_b64_tr_b16 a[64:65], v135 offset:2048
  v_mfma_f32_16x16x32_bf16 v[96:99], a[48:51], a[32:35], v[96:99]
  ds_read_b64_tr_b16 a[66:67], v135 offset:8192
  v_mfma_f32_16x16x32_bf16 v[112:115], a[52:55], a[32:35], v[112:115]
  ds_read_b64_tr_b16 a[68:69], v136 offset:2048
  v_mfma_f32_16x16x32_bf16 v[108:111], a[52:55], a[28:31], v[108:111]
  buffer_load_dwordx4 v141, s[8:11], s60 offen offset:2048 lds
  s_lshl_b32 s61, s66, 11
  v_mfma_f32_16x16x32_bf16 v[104:107], a[52:55], a[24:27], v[104:107]
  s_add_u32 m0, s63, 33792
  ds_read_b64_tr_b16 a[70:71], v136 offset:8192
  v_mfma_f32_16x16x32_bf16 v[100:103], a[52:55], a[20:23], v[100:103]
  s_waitcnt vmcnt(21) lgkmcnt(4)
  s_barrier
  v_mfma_f32_16x16x32_bf16 v[20:23], a[56:59], a[0:3], v[20:23]
  ds_read_b64_tr_b16 a[40:41], v135 offset:0
  v_mfma_f32_16x16x32_bf16 v[24:27], a[56:59], a[4:7], v[24:27]
  buffer_load_dwordx4 v142, s[36:39], s61 offen offset:0 sc1 lds
  v_mfma_f32_16x16x32_bf16 v[28:31], a[56:59], a[8:11], v[28:31]
  ds_read_b64_tr_b16 a[42:43], v135 offset:6144
  v_mfma_f32_16x16x32_bf16 v[32:35], a[56:59], a[12:15], v[32:35]
  v_exp_f32 v204, v204
  v_mfma_f32_16x16x32_bf16 v[116:119], a[56:59], a[16:19], v[116:119]
  ds_read_b64_tr_b16 a[44:45], v136 offset:0
  v_mfma_f32_16x16x32_bf16 v[48:51], a[60:63], a[12:15], v[48:51]
  buffer_load_dwordx4 v142, s[36:39], s61 offen offset:1024 sc1 lds
  s_add_u32 m0, s64, 41984
  v_mfma_f32_16x16x32_bf16 v[44:47], a[60:63], a[8:11], v[44:47]
  ds_read_b64_tr_b16 a[46:47], v136 offset:6144
  v_mfma_f32_16x16x32_bf16 v[40:43], a[60:63], a[4:7], v[40:43]
  v_exp_f32 v205, v205
  v_mfma_f32_16x16x32_bf16 v[36:39], a[60:63], a[0:3], v[36:39]
  s_waitcnt lgkmcnt(4)
  ds_read_b64_tr_b16 a[48:49], v135 offset:22528
  v_mfma_f32_16x16x32_bf16 v[52:55], a[0:3], a[64:67], v[52:55]
  buffer_load_dword v143, s[36:39], s61 offen sc1 lds
  s_mov_b32 s67, 20
  v_mfma_f32_16x16x32_bf16 v[56:59], a[4:7], a[64:67], v[56:59]
  s_mul_i32 s60, s67, 196608
  s_add_u32 m0, s62, 43008
  ds_read_b128 a[20:23], v145 offset:33792
  v_mfma_f32_16x16x32_bf16 v[60:63], a[8:11], a[64:67], v[60:63]
  ds_read_b64_tr_b16 a[50:51], v135 offset:28672
  v_mfma_f32_16x16x32_bf16 v[64:67], a[12:15], a[64:67], v[64:67]
  ds_read_b128 a[24:27], v145 offset:34816
  v_mfma_f32_16x16x32_bf16 v[120:123], a[16:19], a[64:67], v[120:123]
  buffer_load_dwordx4 v139, s[8:11], s60 offen offset:0 lds
  v_mfma_f32_16x16x32_bf16 v[80:83], a[12:15], a[68:71], v[80:83]
  ds_read_b64_tr_b16 a[52:53], v136 offset:22528
  v_mfma_f32_16x16x32_bf16 v[76:79], a[8:11], a[68:71], v[76:79]
  ds_read_b128 a[28:31], v145 offset:35840
  v_mfma_f32_16x16x32_bf16 v[72:75], a[4:7], a[68:71], v[72:75]
  ds_read_b64_tr_b16 a[54:55], v136 offset:28672
  v_mfma_f32_16x16x32_bf16 v[68:71], a[0:3], a[68:71], v[68:71]
  s_waitcnt lgkmcnt(7)
  buffer_load_dwordx4 v140, s[8:11], s60 offen offset:1024 lds
  v_mfma_f32_16x16x32_bf16 v[84:87], a[40:43], a[0:3], v[84:87]
  ds_read_b128 a[32:35], v145 offset:36864
  v_mfma_f32_16x16x32_bf16 v[88:91], a[40:43], a[4:7], v[88:91]
  ds_read_b128 a[36:39], v148 offset:41984
  v_mfma_f32_16x16x32_bf16 v[92:95], a[40:43], a[8:11], v[92:95]
  ds_read_b64_tr_b16 a[56:57], v135 offset:23552
  v_mfma_f32_16x16x32_bf16 v[96:99], a[40:43], a[12:15], v[96:99]
  buffer_load_dwordx4 v141, s[8:11], s60 offen offset:2048 lds
  s_lshl_b32 s61, s67, 11
  v_mfma_f32_16x16x32_bf16 v[112:115], a[44:47], a[12:15], v[112:115]
  s_add_u32 m0, s63, 55296
  ds_read_b64_tr_b16 a[58:59], v135 offset:29696
  v_mfma_f32_16x16x32_bf16 v[108:111], a[44:47], a[8:11], v[108:111]
  ds_read_b64_tr_b16 a[60:61], v136 offset:23552
  v_mfma_f32_16x16x32_bf16 v[104:107], a[44:47], a[4:7], v[104:107]
  ds_read_b64_tr_b16 a[62:63], v136 offset:29696
  v_mfma_f32_16x16x32_bf16 v[100:103], a[44:47], a[0:3], v[100:103]
  s_waitcnt vmcnt(21) lgkmcnt(4)
  s_barrier
  buffer_load_dwordx4 v142, s[36:39], s61 offen offset:0 sc1 lds
  v_mfma_f32_16x16x32_bf16 v[20:23], a[48:51], a[20:23], v[20:23]
  ds_read_b64_tr_b16 a[64:65], v135 offset:21504
  v_mfma_f32_16x16x32_bf16 v[24:27], a[48:51], a[24:27], v[24:27]
  v_exp_f32 v206, v206
  v_mfma_f32_16x16x32_bf16 v[28:31], a[48:51], a[28:31], v[28:31]
  ds_read_b64_tr_b16 a[66:67], v135 offset:27648
  v_mfma_f32_16x16x32_bf16 v[32:35], a[48:51], a[32:35], v[32:35]
  buffer_load_dwordx4 v142, s[36:39], s61 offen offset:1024 sc1 lds
  s_add_u32 m0, s64, 63488
  v_mfma_f32_16x16x32_bf16 v[116:119], a[48:51], a[36:39], v[116:119]
  ds_read_b64_tr_b16 a[68:69], v136 offset:21504
  v_mfma_f32_16x16x32_bf16 v[48:51], a[52:55], a[32:35], v[48:51]
  v_exp_f32 v207, v207
  v_mfma_f32_16x16x32_bf16 v[44:47], a[52:55], a[28:31], v[44:47]
  ds_read_b64_tr_b16 a[70:71], v136 offset:27648
  v_add_f32 v200, 1.0, v200
  v_mfma_f32_16x16x32_bf16 v[40:43], a[52:55], a[24:27], v[40:43]
  buffer_load_dword v143, s[36:39], s61 offen sc1 lds
  s_mov_b32 s68, 21
  v_mfma_f32_16x16x32_bf16 v[36:39], a[52:55], a[20:23], v[36:39]
  s_waitcnt lgkmcnt(4)
  s_mul_i32 s60, s68, 196608
  s_add_u32 m0, s62, 64512
  v_mfma_f32_16x16x32_bf16 v[52:55], a[20:23], a[56:59], v[52:55]
  ds_read_b64_tr_b16 a[40:41], v135 offset:44032
  v_add_f32 v201, 1.0, v201
  v_mfma_f32_16x16x32_bf16 v[56:59], a[24:27], a[56:59], v[56:59]
  ds_read_b128 a[0:3], v145 offset:55296
  v_add_f32 v202, 1.0, v202
  v_mfma_f32_16x16x32_bf16 v[60:63], a[28:31], a[56:59], v[60:63]
  buffer_load_dwordx4 v139, s[8:11], s60 offen offset:0 lds
  v_add_f32 v203, 1.0, v203
  v_mfma_f32_16x16x32_bf16 v[64:67], a[32:35], a[56:59], v[64:67]
  ds_read_b64_tr_b16 a[42:43], v135 offset:50176
  v_add_f32 v204, 1.0, v204
  v_mfma_f32_16x16x32_bf16 v[120:123], a[36:39], a[56:59], v[120:123]
  ds_read_b128 a[4:7], v145 offset:56320
  v_add_f32 v205, 1.0, v205
  v_mfma_f32_16x16x32_bf16 v[80:83], a[32:35], a[60:63], v[80:83]
  ds_read_b64_tr_b16 a[44:45], v136 offset:44032
  v_add_f32 v206, 1.0, v206
  v_mfma_f32_16x16x32_bf16 v[76:79], a[28:31], a[60:63], v[76:79]
  buffer_load_dwordx4 v140, s[8:11], s60 offen offset:1024 lds
  v_add_f32 v207, 1.0, v207
  v_mfma_f32_16x16x32_bf16 v[72:75], a[24:27], a[60:63], v[72:75]
  ds_read_b128 a[8:11], v145 offset:57344
  v_mfma_f32_16x16x32_bf16 v[68:71], a[20:23], a[60:63], v[68:71]
  s_waitcnt lgkmcnt(6)
  ds_read_b64_tr_b16 a[46:47], v136 offset:50176
  v_mfma_f32_16x16x32_bf16 v[84:87], a[64:67], a[20:23], v[84:87]
  ds_read_b128 a[12:15], v145 offset:58368
  v_mfma_f32_16x16x32_bf16 v[88:91], a[64:67], a[24:27], v[88:91]
  buffer_load_dwordx4 v141, s[8:11], s60 offen offset:2048 lds
  s_lshl_b32 s61, s68, 11
  v_mfma_f32_16x16x32_bf16 v[92:95], a[64:67], a[28:31], v[92:95]
  s_add_u32 m0, s63, 76800
  ds_read_b128 a[16:19], v148 offset:63488
  v_mfma_f32_16x16x32_bf16 v[96:99], a[64:67], a[32:35], v[96:99]
  ds_read_b64_tr_b16 a[48:49], v135 offset:45056
  v_mfma_f32_16x16x32_bf16 v[112:115], a[68:71], a[32:35], v[112:115]
  ds_read_b64_tr_b16 a[50:51], v135 offset:51200
  v_mfma_f32_16x16x32_bf16 v[108:111], a[68:71], a[28:31], v[108:111]
  buffer_load_dwordx4 v142, s[36:39], s61 offen offset:0 sc1 lds
  v_mfma_f32_16x16x32_bf16 v[104:107], a[68:71], a[24:27], v[104:107]
  ds_read_b64_tr_b16 a[52:53], v136 offset:45056
  v_mfma_f32_16x16x32_bf16 v[100:103], a[68:71], a[20:23], v[100:103]
  s_waitcnt vmcnt(22) lgkmcnt(3)
  s_barrier
  ds_read_b64_tr_b16 a[54:55], v136 offset:51200
  v_mfma_f32_16x16x32_bf16 v[20:23], a[40:43], a[0:3], v[20:23]
  ds_read_b64_tr_b16 a[56:57], v135 offset:43008
  v_mfma_f32_16x16x32_bf16 v[24:27], a[40:43], a[4:7], v[24:27]
  buffer_load_dwordx4 v142, s[36:39], s61 offen offset:1024 sc1 lds
  s_add_u32 m0, s64, 84992
  v_mfma_f32_16x16x32_bf16 v[28:31], a[40:43], a[8:11], v[28:31]
  ds_read_b64_tr_b16 a[58:59], v135 offset:49152
  v_mfma_f32_16x16x32_bf16 v[32:35], a[40:43], a[12:15], v[32:35]
  v_rcp_f32 v200, v200
  v_mfma_f32_16x16x32_bf16 v[116:119], a[40:43], a[16:19], v[116:119]
  ds_read_b64_tr_b16 a[60:61], v136 offset:43008
  v_mfma_f32_16x16x32_bf16 v[48:51], a[44:47], a[12:15], v[48:51]
  buffer_load_dword v143, s[36:39], s61 offen sc1 lds
  s_mov_b32 s69, 22
  v_mfma_f32_16x16x32_bf16 v[44:47], a[44:47], a[8:11], v[44:47]
  s_mul_i32 s60, s69, 196608
  s_add_u32 m0, s62, 86016
  ds_read_b64_tr_b16 a[62:63], v136 offset:49152
  v_mfma_f32_16x16x32_bf16 v[40:43], a[44:47], a[4:7], v[40:43]
  v_rcp_f32 v201, v201
  v_mfma_f32_16x16x32_bf16 v[36:39], a[44:47], a[0:3], v[36:39]
  s_waitcnt lgkmcnt(4)
  ds_read_b64_tr_b16 a[64:65], v137 offset:1024
  v_mfma_f32_16x16x32_bf16 v[52:55], a[0:3], a[48:51], v[52:55]
  buffer_load_dwordx4 v139, s[8:11], s60 offen offset:0 lds
  v_mfma_f32_16x16x32_bf16 v[56:59], a[4:7], a[48:51], v[56:59]
  ds_read_b128 a[20:23], v146 offset:12288
  v_mfma_f32_16x16x32_bf16 v[60:63], a[8:11], a[48:51], v[60:63]
  ds_read_b64_tr_b16 a[66:67], v137 offset:7168
  v_mfma_f32_16x16x32_bf16 v[64:67], a[12:15], a[48:51], v[64:67]
  ds_read_b128 a[24:27], v146 offset:13312
  v_mfma_f32_16x16x32_bf16 v[120:123], a[16:19], a[48:51], v[120:123]
  buffer_load_dwordx4 v140, s[8:11], s60 offen offset:1024 lds
  v_mfma_f32_16x16x32_bf16 v[80:83], a[12:15], a[52:55], v[80:83]
  ds_read_b64_tr_b16 a[68:69], v138 offset:1024
  v_mfma_f32_16x16x32_bf16 v[76:79], a[8:11], a[52:55], v[76:79]
  ds_read_b128 a[28:31], v146 offset:14336
  v_mfma_f32_16x16x32_bf16 v[72:75], a[4:7], a[52:55], v[72:75]
  ds_read_b64_tr_b16 a[70:71], v138 offset:7168
  v_mfma_f32_16x16x32_bf16 v[68:71], a[0:3], a[52:55], v[68:71]
  s_waitcnt lgkmcnt(7)
  buffer_load_dwordx4 v141, s[8:11], s60 offen offset:2048 lds
  s_lshl_b32 s61, s69, 11
  v_mfma_f32_16x16x32_bf16 v[84:87], a[56:59], a[0:3], v[84:87]
  s_add_u32 m0, s63, 98304
  ds_read_b128 a[32:35], v146 offset:15360
  v_mfma_f32_16x16x32_bf16 v[88:91], a[56:59], a[4:7], v[88:91]
  ds_read_b128 a[36:39], v149 offset:20480
  v_mfma_f32_16x16x32_bf16 v[92:95], a[56:59], a[8:11], v[92:95]
  ds_read_b64_tr_b16 a[40:41], v137 offset:2048
  v_mfma_f32_16x16x32_bf16 v[96:99], a[56:59], a[12:15], v[96:99]
  buffer_load_dwordx4 v142, s[36:39], s61 offen offset:0 sc1 lds
  v_mfma_f32_16x16x32_bf16 v[112:115], a[60:63], a[12:15], v[112:115]
  ds_read_b64_tr_b16 a[42:43], v137 offset:8192
  v_mfma_f32_16x16x32_bf16 v[108:111], a[60:63], a[8:11], v[108:111]
  ds_read_b64_tr_b16 a[44:45], v138 offset:2048
  v_mfma_f32_16x16x32_bf16 v[104:107], a[60:63], a[4:7], v[104:107]
  ds_read_b64_tr_b16 a[46:47], v138 offset:8192
  v_mfma_f32_16x16x32_bf16 v[100:103], a[60:63], a[0:3], v[100:103]
  s_waitcnt vmcnt(22) lgkmcnt(4)
  s_barrier
  buffer_load_dwordx4 v142, s[36:39], s61 offen offset:1024 sc1 lds
  v_mfma_f32_16x16x32_bf16 v[20:23], a[64:67], a[20:23], v[20:23]
  s_add_u32 m0, s64, 106496
  ds_read_b64_tr_b16 a[48:49], v137 offset:0
  v_mfma_f32_16x16x32_bf16 v[24:27], a[64:67], a[24:27], v[24:27]
  v_rcp_f32 v202, v202
  v_mfma_f32_16x16x32_bf16 v[28:31], a[64:67], a[28:31], v[28:31]
  ds_read_b64_tr_b16 a[50:51], v137 offset:6144
  v_mfma_f32_16x16x32_bf16 v[32:35], a[64:67], a[32:35], v[32:35]
  buffer_load_dword v143, s[36:39], s61 offen sc1 lds
  s_mov_b32 s70, 23
  v_mfma_f32_16x16x32_bf16 v[116:119], a[64:67], a[36:39], v[116:119]
  s_mul_i32 s60, s70, 196608
  s_add_u32 m0, s62, 107520
  ds_read_b64_tr_b16 a[52:53], v138 offset:0
  v_mfma_f32_16x16x32_bf16 v[48:51], a[68:71], a[32:35], v[48:51]
  v_rcp_f32 v203, v203
  v_mfma_f32_16x16x32_bf16 v[44:47], a[68:71], a[28:31], v[44:47]
  ds_read_b64_tr_b16 a[54:55], v138 offset:6144
  v_mfma_f32_16x16x32_bf16 v[40:43], a[68:71], a[24:27], v[40:43]
  buffer_load_dwordx4 v139, s[8:11], s60 offen offset:0 lds
  v_mfma_f32_16x16x32_bf16 v[36:39], a[68:71], a[20:23], v[36:39]
  s_waitcnt lgkmcnt(4)
  ds_read_b64_tr_b16 a[56:57], v133 offset:1024
  v_mfma_f32_16x16x32_bf16 v[52:55], a[20:23], a[40:43], v[52:55]
  ds_read_b128 a[0:3], v144 offset:12288
  v_mfma_f32_16x16x32_bf16 v[56:59], a[24:27], a[40:43], v[56:59]
  ds_read_b64_tr_b16 a[58:59], v133 offset:7168
  v_mfma_f32_16x16x32_bf16 v[60:63], a[28:31], a[40:43], v[60:63]
  buffer_load_dwordx4 v140, s[8:11], s60 offen offset:1024 lds
  v_mfma_f32_16x16x32_bf16 v[64:67], a[32:35], a[40:43], v[64:67]
  ds_read_b128 a[4:7], v144 offset:13312
  v_mfma_f32_16x16x32_bf16 v[120:123], a[36:39], a[40:43], v[120:123]
  ds_read_b64_tr_b16 a[60:61], v134 offset:1024
  v_mfma_f32_16x16x32_bf16 v[80:83], a[32:35], a[44:47], v[80:83]
  ds_read_b128 a[8:11], v144 offset:14336
  v_mfma_f32_16x16x32_bf16 v[76:79], a[28:31], a[44:47], v[76:79]
  buffer_load_dwordx4 v141, s[8:11], s60 offen offset:2048 lds
  s_lshl_b32 s61, s70, 11
  v_mfma_f32_16x16x32_bf16 v[72:75], a[24:27], a[44:47], v[72:75]
  s_add_u32 m0, s63, 119808
  ds_read_b64_tr_b16 a[62:63], v134 offset:7168
  v_mfma_f32_16x16x32_bf16 v[68:71], a[20:23], a[44:47], v[68:71]
  s_waitcnt lgkmcnt(7)
  ds_read_b128 a[12:15], v144 offset:15360
  v_mfma_f32_16x16x32_bf16 v[84:87], a[48:51], a[20:23], v[84:87]
  ds_read_b128 a[16:19], v147 offset:20480
  v_mfma_f32_16x16x32_bf16 v[88:91], a[48:51], a[24:27], v[88:91]
  buffer_load_dwordx4 v142, s[36:39], s61 offen offset:0 sc1 lds
  v_mfma_f32_16x16x32_bf16 v[92:95], a[48:51], a[28:31], v[92:95]
  ds_read_b64_tr_b16 a[64:65], v133 offset:2048
  v_mfma_f32_16x16x32_bf16 v[96:99], a[48:51], a[32:35], v[96:99]
  ds_read_b64_tr_b16 a[66:67], v133 offset:8192
  v_mfma_f32_16x16x32_bf16 v[112:115], a[52:55], a[32:35], v[112:115]
  ds_read_b64_tr_b16 a[68:69], v134 offset:2048
  v_mfma_f32_16x16x32_bf16 v[108:111], a[52:55], a[28:31], v[108:111]
  buffer_load_dwordx4 v142, s[36:39], s61 offen offset:1024 sc1 lds
  s_add_u32 m0, s64, 128000
  v_mfma_f32_16x16x32_bf16 v[104:107], a[52:55], a[24:27], v[104:107]
  ds_read_b64_tr_b16 a[70:71], v134 offset:8192
  v_mfma_f32_16x16x32_bf16 v[100:103], a[52:55], a[20:23], v[100:103]
  s_waitcnt vmcnt(23) lgkmcnt(4)
  s_barrier
  v_mfma_f32_16x16x32_bf16 v[20:23], a[56:59], a[0:3], v[20:23]
  ds_read_b64_tr_b16 a[40:41], v133 offset:0
  v_mfma_f32_16x16x32_bf16 v[24:27], a[56:59], a[4:7], v[24:27]
  buffer_load_dword v143, s[36:39], s61 offen sc1 lds
  s_mov_b32 s65, 24
  v_mfma_f32_16x16x32_bf16 v[28:31], a[56:59], a[8:11], v[28:31]
  s_mul_i32 s60, s65, 196608
  s_add_u32 m0, s62, 129024
  ds_read_b64_tr_b16 a[42:43], v133 offset:6144
  v_mfma_f32_16x16x32_bf16 v[32:35], a[56:59], a[12:15], v[32:35]
  v_rcp_f32 v204, v204
  v_mfma_f32_16x16x32_bf16 v[116:119], a[56:59], a[16:19], v[116:119]
  ds_read_b64_tr_b16 a[44:45], v134 offset:0
  v_mfma_f32_16x16x32_bf16 v[48:51], a[60:63], a[12:15], v[48:51]
  buffer_load_dwordx4 v139, s[8:11], s60 offen offset:0 lds
  v_mfma_f32_16x16x32_bf16 v[44:47], a[60:63], a[8:11], v[44:47]
  ds_read_b64_tr_b16 a[46:47], v134 offset:6144
  v_mfma_f32_16x16x32_bf16 v[40:43], a[60:63], a[4:7], v[40:43]
  v_rcp_f32 v205, v205
  v_mfma_f32_16x16x32_bf16 v[36:39], a[60:63], a[0:3], v[36:39]
  s_waitcnt lgkmcnt(4)
  ds_read_b64_tr_b16 a[48:49], v133 offset:22528
  v_mfma_f32_16x16x32_bf16 v[52:55], a[0:3], a[64:67], v[52:55]
  buffer_load_dwordx4 v140, s[8:11], s60 offen offset:1024 lds
  v_mfma_f32_16x16x32_bf16 v[56:59], a[4:7], a[64:67], v[56:59]
  ds_read_b128 a[20:23], v144 offset:33792
  v_mfma_f32_16x16x32_bf16 v[60:63], a[8:11], a[64:67], v[60:63]
  ds_read_b64_tr_b16 a[50:51], v133 offset:28672
  v_mfma_f32_16x16x32_bf16 v[64:67], a[12:15], a[64:67], v[64:67]
  ds_read_b128 a[24:27], v144 offset:34816
  v_mfma_f32_16x16x32_bf16 v[120:123], a[16:19], a[64:67], v[120:123]
  buffer_load_dwordx4 v141, s[8:11], s60 offen offset:2048 lds
  s_lshl_b32 s61, s65, 11
  v_mfma_f32_16x16x32_bf16 v[80:83], a[12:15], a[68:71], v[80:83]
  s_add_u32 m0, s63, 141312
  ds_read_b64_tr_b16 a[52:53], v134 offset:22528
  v_mfma_f32_16x16x32_bf16 v[76:79], a[8:11], a[68:71], v[76:79]
  ds_read_b128 a[28:31], v144 offset:35840
  v_mfma_f32_16x16x32_bf16 v[72:75], a[4:7], a[68:71], v[72:75]
  ds_read_b64_tr_b16 a[54:55], v134 offset:28672
  v_mfma_f32_16x16x32_bf16 v[68:71], a[0:3], a[68:71], v[68:71]
  s_waitcnt lgkmcnt(7)
  buffer_load_dwordx4 v142, s[36:39], s61 offen offset:0 sc1 lds
  v_mfma_f32_16x16x32_bf16 v[84:87], a[40:43], a[0:3], v[84:87]
  ds_read_b128 a[32:35], v144 offset:36864
  v_mfma_f32_16x16x32_bf16 v[88:91], a[40:43], a[4:7], v[88:91]
  ds_read_b128 a[36:39], v147 offset:41984
  v_mfma_f32_16x16x32_bf16 v[92:95], a[40:43], a[8:11], v[92:95]
  ds_read_b64_tr_b16 a[56:57], v133 offset:23552
  v_mfma_f32_16x16x32_bf16 v[96:99], a[40:43], a[12:15], v[96:99]
  buffer_load_dwordx4 v142, s[36:39], s61 offen offset:1024 sc1 lds
  s_add_u32 m0, s64, 149504
  v_mfma_f32_16x16x32_bf16 v[112:115], a[44:47], a[12:15], v[112:115]
  ds_read_b64_tr_b16 a[58:59], v133 offset:29696
  v_mfma_f32_16x16x32_bf16 v[108:111], a[44:47], a[8:11], v[108:111]
  ds_read_b64_tr_b16 a[60:61], v134 offset:23552
  v_mfma_f32_16x16x32_bf16 v[104:107], a[44:47], a[4:7], v[104:107]
  ds_read_b64_tr_b16 a[62:63], v134 offset:29696
  v_mfma_f32_16x16x32_bf16 v[100:103], a[44:47], a[0:3], v[100:103]
  s_waitcnt vmcnt(23) lgkmcnt(4)
  s_barrier
  buffer_load_dword v143, s[36:39], s61 offen sc1 lds
  v_mfma_f32_16x16x32_bf16 v[20:23], a[48:51], a[20:23], v[20:23]
  s_mov_b32 s66, 25
  s_mul_i32 s60, s66, 196608
  s_add_u32 m0, s62, 0
  v_mfma_f32_16x16x32_bf16 v[24:27], a[48:51], a[24:27], v[24:27]
  ds_read_b64_tr_b16 a[64:65], v133 offset:21504
  v_mfma_f32_16x16x32_bf16 v[28:31], a[48:51], a[28:31], v[28:31]
  ds_read_b64_tr_b16 a[66:67], v133 offset:27648
  v_mfma_f32_16x16x32_bf16 v[32:35], a[48:51], a[32:35], v[32:35]
  buffer_load_dwordx4 v139, s[8:11], s60 offen offset:0 lds
  v_mfma_f32_16x16x32_bf16 v[116:119], a[48:51], a[36:39], v[116:119]
  ds_read_b64_tr_b16 a[68:69], v134 offset:21504
  v_mfma_f32_16x16x32_bf16 v[48:51], a[52:55], a[32:35], v[48:51]
  v_rcp_f32 v206, v206
  v_mfma_f32_16x16x32_bf16 v[44:47], a[52:55], a[28:31], v[44:47]
  ds_read_b64_tr_b16 a[70:71], v134 offset:27648
  v_mfma_f32_16x16x32_bf16 v[40:43], a[52:55], a[24:27], v[40:43]
  buffer_load_dwordx4 v140, s[8:11], s60 offen offset:1024 lds
  v_mfma_f32_16x16x32_bf16 v[36:39], a[52:55], a[20:23], v[36:39]
  s_waitcnt lgkmcnt(4)
  ds_read_b64_tr_b16 a[40:41], v133 offset:44032
  v_mfma_f32_16x16x32_bf16 v[52:55], a[20:23], a[56:59], v[52:55]
  ds_read_b128 a[0:3], v144 offset:55296
  v_mfma_f32_16x16x32_bf16 v[56:59], a[24:27], a[56:59], v[56:59]
  ds_read_b64_tr_b16 a[42:43], v133 offset:50176
  v_mfma_f32_16x16x32_bf16 v[60:63], a[28:31], a[56:59], v[60:63]
  buffer_load_dwordx4 v141, s[8:11], s60 offen offset:2048 lds
  s_lshl_b32 s61, s66, 11
  v_mfma_f32_16x16x32_bf16 v[64:67], a[32:35], a[56:59], v[64:67]
  s_add_u32 m0, s63, 12288
  ds_read_b128 a[4:7], v144 offset:56320
  v_mfma_f32_16x16x32_bf16 v[120:123], a[36:39], a[56:59], v[120:123]
  ds_read_b64_tr_b16 a[44:45], v134 offset:44032
  v_mfma_f32_16x16x32_bf16 v[80:83], a[32:35], a[60:63], v[80:83]
  ds_read_b128 a[8:11], v144 offset:57344
  v_mfma_f32_16x16x32_bf16 v[76:79], a[28:31], a[60:63], v[76:79]
  buffer_load_dwordx4 v142, s[36:39], s61 offen offset:0 sc1 lds
  v_mfma_f32_16x16x32_bf16 v[72:75], a[24:27], a[60:63], v[72:75]
  ds_read_b64_tr_b16 a[46:47], v134 offset:50176
  v_mfma_f32_16x16x32_bf16 v[68:71], a[20:23], a[60:63], v[68:71]
  s_waitcnt lgkmcnt(7)
  ds_read_b128 a[12:15], v144 offset:58368
  v_mfma_f32_16x16x32_bf16 v[84:87], a[64:67], a[20:23], v[84:87]
Ha2:
  s_cbranch_execz Ha2_1
  ds_read_b128 a[16:19], v147 offset:63488
  v_mfma_f32_16x16x32_bf16 v[88:91], a[64:67], a[24:27], v[88:91]
  ds_read_b64_tr_b16 a[48:49], v133 offset:45056
  v_mfma_f32_16x16x32_bf16 v[92:95], a[64:67], a[28:31], v[92:95]
  buffer_load_dwordx4 v142, s[36:39], s61 offen offset:1024 sc1 lds
  s_add_u32 m0, s64, 20480
  v_mfma_f32_16x16x32_bf16 v[96:99], a[64:67], a[32:35], v[96:99]
  ds_read_b64_tr_b16 a[50:51], v133 offset:51200
  v_mfma_f32_16x16x32_bf16 v[112:115], a[68:71], a[32:35], v[112:115]
  ds_read_b64_tr_b16 a[52:53], v134 offset:45056
  v_mfma_f32_16x16x32_bf16 v[108:111], a[68:71], a[28:31], v[108:111]
  v_rcp_f32 v207, v207
  v_mfma_f32_16x16x32_bf16 v[104:107], a[68:71], a[24:27], v[104:107]
  buffer_load_dword v143, s[36:39], s61 offen sc1 lds
  s_mov_b32 s67, 26
  v_mfma_f32_16x16x32_bf16 v[100:103], a[68:71], a[20:23], v[100:103]
  s_waitcnt vmcnt(24) lgkmcnt(3)
  s_barrier
  s_mul_i32 s60, s67, 196608
  v_mfma_f32_16x16x32_bf16 v[20:23], a[40:43], a[0:3], v[20:23]
  s_add_u32 m0, s62, 21504
  ds_read_b64_tr_b16 a[54:55], v134 offset:51200
  v_mul_f32 v188, v188, v200
  v_mfma_f32_16x16x32_bf16 v[24:27], a[40:43], a[4:7], v[24:27]
  ds_read_b64_tr_b16 a[56:57], v133 offset:43008
  v_mul_f32 v189, v189, v201
  v_mfma_f32_16x16x32_bf16 v[28:31], a[40:43], a[8:11], v[28:31]
  buffer_load_dwordx4 v139, s[8:11], s60 offen offset:0 lds
  v_mul_f32 v190, v190, v202
  v_mfma_f32_16x16x32_bf16 v[32:35], a[40:43], a[12:15], v[32:35]
  ds_read_b64_tr_b16 a[58:59], v133 offset:49152
  v_mul_f32 v191, v191, v203
  v_mfma_f32_16x16x32_bf16 v[116:119], a[40:43], a[16:19], v[116:119]
  ds_read_b64_tr_b16 a[60:61], v134 offset:43008
  v_mul_f32 v192, v192, v204
  v_mfma_f32_16x16x32_bf16 v[48:51], a[44:47], a[12:15], v[48:51]
  v_mul_f32 v193, v193, v205
  v_mul_f32 v194, v194, v206
  v_mfma_f32_16x16x32_bf16 v[44:47], a[44:47], a[8:11], v[44:47]
  buffer_load_dwordx4 v140, s[8:11], s60 offen offset:1024 lds
  v_mul_f32 v195, v195, v207
  v_mfma_f32_16x16x32_bf16 v[40:43], a[44:47], a[4:7], v[40:43]
  ds_read_b64_tr_b16 a[62:63], v134 offset:49152
  v_cvt_pk_bf16_f32 v212, v188, v189
  v_mfma_f32_16x16x32_bf16 v[36:39], a[44:47], a[0:3], v[36:39]
  s_waitcnt lgkmcnt(4)
  ds_read_b64_tr_b16 a[64:65], v135 offset:1024
  v_lshlrev_b32 v188, 16, v212
  v_mfma_f32_16x16x32_bf16 v[52:55], a[0:3], a[48:51], v[52:55]
  ds_read_b128 a[20:23], v145 offset:12288
  v_and_b32 v189, 0xffff0000, v212
  v_mfma_f32_16x16x32_bf16 v[56:59], a[4:7], a[48:51], v[56:59]
  buffer_load_dwordx4 v141, s[8:11], s60 offen offset:2048 lds
  v_cvt_pk_bf16_f32 v212, v190, v191
  v_mfma_f32_16x16x32_bf16 v[60:63], a[8:11], a[48:51], v[60:63]
  s_lshl_b32 s61, s67, 11
  ds_read_b64_tr_b16 a[66:67], v135 offset:7168
  s_add_u32 m0, s63, 33792
  v_mfma_f32_16x16x32_bf16 v[64:67], a[12:15], a[48:51], v[64:67]
  ds_read_b128 a[24:27], v145 offset:13312
  v_lshlrev_b32 v190, 16, v212
  v_mfma_f32_16x16x32_bf16 v[120:123], a[16:19], a[48:51], v[120:123]
  ds_read_b64_tr_b16 a[68:69], v136 offset:1024
  v_and_b32 v191, 0xffff0000, v212
  v_mfma_f32_16x16x32_bf16 v[80:83], a[12:15], a[52:55], v[80:83]
  ds_read_b128 a[28:31], v145 offset:14336
  v_cvt_pk_bf16_f32 v212, v192, v193
  v_mfma_f32_16x16x32_bf16 v[76:79], a[8:11], a[52:55], v[76:79]
  buffer_load_dwordx4 v142, s[36:39], s61 offen offset:0 sc1 lds
  v_lshlrev_b32 v192, 16, v212
  v_mfma_f32_16x16x32_bf16 v[72:75], a[4:7], a[52:55], v[72:75]
  ds_read_b64_tr_b16 a[70:71], v136 offset:7168
  v_and_b32 v193, 0xffff0000, v212
  v_mfma_f32_16x16x32_bf16 v[68:71], a[0:3], a[52:55], v[68:71]
  s_waitcnt lgkmcnt(7)
  ds_read_b128 a[32:35], v145 offset:15360
  v_cvt_pk_bf16_f32 v212, v194, v195
  v_mfma_f32_16x16x32_bf16 v[84:87], a[56:59], a[0:3], v[84:87]
  ds_read_b128 a[36:39], v148 offset:20480
  v_lshlrev_b32 v194, 16, v212
  v_mfma_f32_16x16x32_bf16 v[88:91], a[56:59], a[4:7], v[88:91]
  ds_read_b64_tr_b16 a[40:41], v135 offset:2048
  v_and_b32 v195, 0xffff0000, v212
  v_mfma_f32_16x16x32_bf16 v[92:95], a[56:59], a[8:11], v[92:95]
  s_lshl_b32 s48, s58, 3
  buffer_load_dwordx4 v142, s[36:39], s61 offen offset:1024 sc1 lds
  s_add_u32 m0, s64, 41984
  v_mfma_f32_16x16x32_bf16 v[96:99], a[56:59], a[12:15], v[96:99]
  s_add_u32 s48, s48, 150528
  ds_read_b64_tr_b16 a[42:43], v135 offset:8192
  v_add_u32 v12, s48, v0
  v_mfma_f32_16x16x32_bf16 v[112:115], a[60:63], a[12:15], v[112:115]
  ds_read_b64_tr_b16 a[44:45], v136 offset:2048
  v_add_u32 v222, s63, v12
  v_mfma_f32_16x16x32_bf16 v[108:111], a[60:63], a[8:11], v[108:111]
  v_xor_b32 v223, 8, v222
  s_lshl_b32 s48, s59, 11
  v_mfma_f32_16x16x32_bf16 v[104:107], a[60:63], a[4:7], v[104:107]
  s_add_u32 s48, s48, 8192
  buffer_load_dword v143, s[36:39], s61 offen sc1 lds
  s_mov_b32 s68, 27
  v_mfma_f32_16x16x32_bf16 v[100:103], a[60:63], a[0:3], v[100:103]
  s_waitcnt vmcnt(24) lgkmcnt(3)
  s_barrier
  s_mul_i32 s60, s68, 196608
  v_mfma_f32_16x16x32_bf16 v[20:23], a[64:67], a[20:23], v[20:23]
  s_add_u32 m0, s62, 43008
  ds_read_b64_tr_b16 a[46:47], v136 offset:8192
  v_add_u32 v224, s48, v12
  v_mfma_f32_16x16x32_bf16 v[24:27], a[64:67], a[24:27], v[24:27]
  s_lshl_b32 s48, s58, 13
  ds_read_b64_tr_b16 a[48:49], v135 offset:0
  v_subrev_u32 v225, s48, v224
  v_mfma_f32_16x16x32_bf16 v[28:31], a[64:67], a[28:31], v[28:31]
  buffer_load_dwordx4 v139, s[8:11], s60 offen offset:0 lds
  v_xor_b32 v226, 8, v225
  v_mfma_f32_16x16x32_bf16 v[32:35], a[64:67], a[32:35], v[32:35]
  s_mov_b32 s80, 0xaaaaaaaa
  ds_read_b64_tr_b16 a[50:51], v135 offset:6144
  s_mov_b32 s81, 0xaaaaaaaa
  v_mfma_f32_16x16x32_bf16 v[116:119], a[64:67], a[36:39], v[116:119]
  s_mov_b32 s82, 0x000f0000
  ds_read_b64_tr_b16 a[52:53], v136 offset:0
  s_mov_b32 s83, 0x0fff00ff
  v_mfma_f32_16x16x32_bf16 v[48:51], a[68:71], a[32:35], v[48:51]
  s_mov_b32 s84, 0x003f0003
  s_mov_b32 s85, 0x3fff03ff
  v_mov_b32 v12, 0xffff
  v_mfma_f32_16x16x32_bf16 v[44:47], a[68:71], a[28:31], v[44:47]
  buffer_load_dwordx4 v140, s[8:11], s60 offen offset:1024 lds
  v_mov_b32 v13, 0xffff0000
  v_mfma_f32_16x16x32_bf16 v[40:43], a[68:71], a[24:27], v[40:43]
  ds_read_b64_tr_b16 a[54:55], v136 offset:6144
  v_cndmask_b32 v12, v12, v13, s[80:81]
  v_mfma_f32_16x16x32_bf16 v[36:39], a[68:71], a[20:23], v[36:39]
  s_waitcnt lgkmcnt(4)
  ds_read_b64_tr_b16 a[56:57], v135 offset:22528
  v_cndmask_b32 v227, 0, v12, s[82:83]
  v_mfma_f32_16x16x32_bf16 v[52:55], a[20:23], a[40:43], v[52:55]
  ds_read_b128 a[0:3], v145 offset:33792
  v_cndmask_b32 v228, 0, v12, s[84:85]
  v_mfma_f32_16x16x32_bf16 v[56:59], a[24:27], a[40:43], v[56:59]
  buffer_load_dwordx4 v141, s[8:11], s60 offen offset:2048 lds
  v_xor_b32 v229, v227, v12
  v_mfma_f32_16x16x32_bf16 v[60:63], a[28:31], a[40:43], v[60:63]
  s_lshl_b32 s61, s68, 11
  ds_read_b64_tr_b16 a[58:59], v135 offset:28672
  s_add_u32 m0, s63, 55296
  v_mfma_f32_16x16x32_bf16 v[64:67], a[32:35], a[40:43], v[64:67]
  ds_read_b128 a[4:7], v145 offset:34816
  v_xor_b32 v230, v228, v12
  v_mfma_f32_16x16x32_bf16 v[120:123], a[36:39], a[40:43], v[120:123]
  s_lshl1_add_u32 s48, s51, s58
  ds_read_b64_tr_b16 a[60:61], v136 offset:22528
  s_lshl_b32 s74, s48, 17
  v_mfma_f32_16x16x32_bf16 v[80:83], a[32:35], a[44:47], v[80:83]
  s_lshl1_add_u32 s48, s56, s59
  ds_read_b128 a[8:11], v145 offset:35840
  s_lshl_b32 s48, s48, 11
  v_mfma_f32_16x16x32_bf16 v[76:79], a[28:31], a[44:47], v[76:79]
  s_add_u32 s74, s74, s48
  buffer_load_dwordx4 v142, s[36:39], s61 offen offset:0 sc1 lds
  s_add_u32 s74, s74, 7340032
  v_mfma_f32_16x16x32_bf16 v[72:75], a[24:27], a[44:47], v[72:75]
  s_add_u32 s75, s74, 65536
  ds_read_b64_tr_b16 a[62:63], v136 offset:28672
  s_or_b32 s51, s51, s58
  v_mfma_f32_16x16x32_bf16 v[68:71], a[20:23], a[44:47], v[68:71]
  s_waitcnt lgkmcnt(7)
  ds_read_b128 a[12:15], v145 offset:36864
  s_lshl_b32 s45, s2, 7
  v_mfma_f32_16x16x32_bf16 v[84:87], a[48:51], a[20:23], v[84:87]
  s_add_u32 s45, s45, 5275648
  ds_read_b128 a[16:19], v148 offset:41984
  s_cmp_eq_u32 s44, 0
  v_mfma_f32_16x16x32_bf16 v[88:91], a[48:51], a[24:27], v[88:91]
  s_cselect_b32 s45, s45, 1073741824
  ds_read_b64_tr_b16 a[64:65], v135 offset:23552
  s_lshr_b32 s49, s2, 3
  v_mfma_f32_16x16x32_bf16 v[92:95], a[48:51], a[28:31], v[92:95]
  s_and_b32 s59, s49, 3
  buffer_load_dwordx4 v142, s[36:39], s61 offen offset:1024 sc1 lds
  s_add_u32 m0, s64, 63488
  v_mfma_f32_16x16x32_bf16 v[96:99], a[48:51], a[32:35], v[96:99]
  s_lshr_b32 s56, s49, 2
  ds_read_b64_tr_b16 a[66:67], v135 offset:29696
  s_lshl1_add_u32 s49, s59, s56
  v_mfma_f32_16x16x32_bf16 v[112:115], a[52:55], a[32:35], v[112:115]
  s_and_b32 s49, s49, 7
  ds_read_b64_tr_b16 a[68:69], v136 offset:23552
  s_and_b32 s48, s2, 7
  v_mfma_f32_16x16x32_bf16 v[108:111], a[52:55], a[28:31], v[108:111]
  s_lshl2_add_u32 s59, s48, s59
  s_mov_b32 s86, 0xc0653421
  s_mov_b32 s87, 0xfedba987
  v_mfma_f32_16x16x32_bf16 v[104:107], a[52:55], a[24:27], v[104:107]
  s_cmp_eq_u32 s49, 1
  buffer_load_dword v143, s[36:39], s61 offen sc1 lds
  s_mov_b32 s69, 28
  v_mfma_f32_16x16x32_bf16 v[100:103], a[52:55], a[20:23], v[100:103]
  s_waitcnt vmcnt(24) lgkmcnt(3)
  s_barrier
  s_mul_i32 s60, s69, 196608
  v_mfma_f32_16x16x32_bf16 v[20:23], a[56:59], a[0:3], v[20:23]
  s_cselect_b32 s86, 0xd1643520, s86
  ds_read_b64_tr_b16 a[70:71], v136 offset:29696
  s_cselect_b32 s87, 0xfecba897, s87
  v_mfma_f32_16x16x32_bf16 v[24:27], a[56:59], a[4:7], v[24:27]
  s_add_u32 m0, s62, 64512
  ds_read_b64_tr_b16 a[40:41], v135 offset:21504
  s_cmp_eq_u32 s49, 2
  v_mfma_f32_16x16x32_bf16 v[28:31], a[56:59], a[8:11], v[28:31]
  s_cselect_b32 s86, 0x72546310, s86
  buffer_load_dwordx4 v139, s[8:11], s60 offen offset:0 lds
  s_cselect_b32 s87, 0xfdcb98ae, s87
  v_mfma_f32_16x16x32_bf16 v[32:35], a[56:59], a[12:15], v[32:35]
  s_cmp_eq_u32 s49, 3
  ds_read_b64_tr_b16 a[42:43], v135 offset:27648
  s_cselect_b32 s86, 0x63547210, s86
  v_mfma_f32_16x16x32_bf16 v[116:119], a[56:59], a[16:19], v[116:119]
  s_cselect_b32 s87, 0xfedca9b8, s87
  ds_read_b64_tr_b16 a[44:45], v136 offset:21504
  s_cmp_eq_u32 s49, 4
  v_mfma_f32_16x16x32_bf16 v[48:51], a[60:63], a[12:15], v[48:51]
  s_cselect_b32 s86, 0x64583210, s86
  s_cselect_b32 s87, 0xfedba9c7, s87
  s_cmp_eq_u32 s49, 5
  v_mfma_f32_16x16x32_bf16 v[44:47], a[60:63], a[8:11], v[44:47]
  s_cselect_b32 s86, 0x65493210, s86
  buffer_load_dwordx4 v140, s[8:11], s60 offen offset:1024 lds
  s_cselect_b32 s87, 0xfecba8d7, s87
  v_mfma_f32_16x16x32_bf16 v[40:43], a[60:63], a[4:7], v[40:43]
  s_cmp_eq_u32 s49, 6
  ds_read_b64_tr_b16 a[46:47], v136 offset:27648
  s_cselect_b32 s86, 0x56a43210, s86
  v_mfma_f32_16x16x32_bf16 v[36:39], a[60:63], a[0:3], v[36:39]
  s_waitcnt lgkmcnt(4)
  ds_read_b64_tr_b16 a[48:49], v135 offset:44032
  s_cselect_b32 s87, 0xfdcb98e7, s87
  v_mfma_f32_16x16x32_bf16 v[52:55], a[0:3], a[64:67], v[52:55]
  s_cmp_eq_u32 s49, 7
  ds_read_b128 a[20:23], v145 offset:55296
  s_cselect_b32 s86, 0x57b43210, s86
  v_mfma_f32_16x16x32_bf16 v[56:59], a[4:7], a[64:67], v[56:59]
  s_cselect_b32 s87, 0xedca98f6, s87
  buffer_load_dwordx4 v141, s[8:11], s60 offen offset:2048 lds
  s_mul_i32 s88, s44, 7168
  v_mfma_f32_16x16x32_bf16 v[60:63], a[8:11], a[64:67], v[60:63]
  s_lshl_b32 s61, s69, 11
  ds_read_b64_tr_b16 a[50:51], v135 offset:50176
  s_add_u32 m0, s63, 76800
  v_mfma_f32_16x16x32_bf16 v[64:67], a[12:15], a[64:67], v[64:67]
  s_lshl2_add_u32 s89, s56, s44
  ds_read_b128 a[24:27], v145 offset:56320
  s_lshl_b32 s89, s89, 17
  v_mfma_f32_16x16x32_bf16 v[120:123], a[16:19], a[64:67], v[120:123]
  s_add_u32 s89, s89, 36700160
  ds_read_b64_tr_b16 a[52:53], v136 offset:44032
  s_cmp_ge_u32 s44, 2
  v_mfma_f32_16x16x32_bf16 v[80:83], a[12:15], a[68:71], v[80:83]
  s_cselect_b64 s[16:17], s[20:21], s[16:17]
  ds_read_b128 a[28:31], v145 offset:57344
  v_lshrrev_b32 v12, 2, v10
  v_mfma_f32_16x16x32_bf16 v[76:79], a[8:11], a[68:71], v[76:79]
  buffer_load_dwordx4 v142, s[36:39], s61 offen offset:0 sc1 lds
  v_mul_u32_u24 v12, 224, v12
  v_mfma_f32_16x16x32_bf16 v[72:75], a[4:7], a[68:71], v[72:75]
  ds_read_b64_tr_b16 a[54:55], v136 offset:50176
  v_and_b32 v13, 3, v10
  v_mfma_f32_16x16x32_bf16 v[68:71], a[0:3], a[68:71], v[68:71]
  s_waitcnt lgkmcnt(7)
  ds_read_b128 a[32:35], v145 offset:58368
  v_lshl_add_u32 v1, v13, 3, v12
  v_mfma_f32_16x16x32_bf16 v[84:87], a[40:43], a[0:3], v[84:87]
  ds_read_b128 a[36:39], v148 offset:63488
  v_add_u32 v2, 57344, v1
  v_mfma_f32_16x16x32_bf16 v[88:91], a[40:43], a[4:7], v[88:91]
  s_mul_i32 s48, s59, 224
  ds_read_b64_tr_b16 a[56:57], v135 offset:45056
  s_and_b32 s49, s44, 1
  v_mfma_f32_16x16x32_bf16 v[92:95], a[40:43], a[8:11], v[92:95]
  s_mul_i32 s49, s49, 229376
  buffer_load_dwordx4 v142, s[36:39], s61 offen offset:1024 sc1 lds
  s_add_u32 m0, s64, 84992
  v_mfma_f32_16x16x32_bf16 v[96:99], a[40:43], a[12:15], v[96:99]
  s_add_u32 s48, s48, s49
  ds_read_b64_tr_b16 a[58:59], v135 offset:51200
  s_and_b32 s49, s59, 1
  v_mfma_f32_16x16x32_bf16 v[112:115], a[44:47], a[12:15], v[112:115]
  s_lshl_b32 s49, s49, 1
  ds_read_b64_tr_b16 a[60:61], v136 offset:45056
  v_add_u32 v12, 0, v10
  v_mfma_f32_16x16x32_bf16 v[108:111], a[44:47], a[8:11], v[108:111]
  v_mul_u32_u24 v13, 4682, v12
  v_lshrrev_b32 v13, 16, v13
  v_mfma_f32_16x16x32_bf16 v[104:107], a[44:47], a[4:7], v[104:107]
  buffer_load_dword v143, s[36:39], s61 offen sc1 lds
  s_mov_b32 s70, 29
  v_mfma_f32_16x16x32_bf16 v[100:103], a[44:47], a[0:3], v[100:103]
  s_waitcnt vmcnt(24) lgkmcnt(3)
  s_barrier
  s_mul_i32 s60, s70, 196608
  v_mfma_f32_16x16x32_bf16 v[20:23], a[48:51], a[20:23], v[20:23]
  s_add_u32 m0, s62, 86016
  ds_read_b64_tr_b16 a[62:63], v136 offset:51200
  v_mul_i32_i24 v14, -14, v13
  v_mfma_f32_16x16x32_bf16 v[24:27], a[48:51], a[24:27], v[24:27]
  ds_read_b64_tr_b16 a[64:65], v135 offset:43008
  v_add3_u32 v12, v12, v14, s49
  v_mfma_f32_16x16x32_bf16 v[28:31], a[48:51], a[28:31], v[28:31]
  buffer_load_dwordx4 v139, s[8:11], s60 offen offset:0 lds
  v_add_u32 v14, -14, v12
  v_mfma_f32_16x16x32_bf16 v[32:35], a[48:51], a[32:35], v[32:35]
  ds_read_b64_tr_b16 a[66:67], v135 offset:49152
  v_min_u32 v12, v12, v14
  v_mfma_f32_16x16x32_bf16 v[116:119], a[48:51], a[36:39], v[116:119]
  ds_read_b64_tr_b16 a[68:69], v136 offset:43008
  v_mul_u32_u24 v13, 7168, v13
  v_mfma_f32_16x16x32_bf16 v[48:51], a[52:55], a[32:35], v[48:51]
  v_lshl_add_u32 v12, v12, 4, v13
  v_add_u32 v3, s48, v12
  v_mfma_f32_16x16x32_bf16 v[44:47], a[52:55], a[28:31], v[44:47]
  s_sub_u32 s48, s48, 1024
  buffer_load_dwordx4 v140, s[8:11], s60 offen offset:1024 lds
  v_add_u32 v12, 64, v10
  v_mfma_f32_16x16x32_bf16 v[40:43], a[52:55], a[24:27], v[40:43]
  ds_read_b64_tr_b16 a[70:71], v136 offset:49152
  v_mul_u32_u24 v13, 4682, v12
  v_mfma_f32_16x16x32_bf16 v[36:39], a[52:55], a[20:23], v[36:39]
  s_waitcnt lgkmcnt(4)
  ds_read_b64_tr_b16 a[40:41], v137 offset:1024
  v_lshrrev_b32 v13, 16, v13
  v_mfma_f32_16x16x32_bf16 v[52:55], a[20:23], a[56:59], v[52:55]
  ds_read_b128 a[0:3], v146 offset:12288
  v_mul_i32_i24 v14, -14, v13
  v_mfma_f32_16x16x32_bf16 v[56:59], a[24:27], a[56:59], v[56:59]
  buffer_load_dwordx4 v141, s[8:11], s60 offen offset:2048 lds
  v_add3_u32 v12, v12, v14, s49
  v_mfma_f32_16x16x32_bf16 v[60:63], a[28:31], a[56:59], v[60:63]
  s_lshl_b32 s61, s70, 11
  ds_read_b64_tr_b16 a[42:43], v137 offset:7168
  s_add_u32 m0, s63, 98304
  v_mfma_f32_16x16x32_bf16 v[64:67], a[32:35], a[56:59], v[64:67]
  ds_read_b128 a[4:7], v146 offset:13312
  v_add_u32 v14, -14, v12
  v_mfma_f32_16x16x32_bf16 v[120:123], a[36:39], a[56:59], v[120:123]
  ds_read_b64_tr_b16 a[44:45], v138 offset:1024
  v_min_u32 v12, v12, v14
  v_mfma_f32_16x16x32_bf16 v[80:83], a[32:35], a[60:63], v[80:83]
  ds_read_b128 a[8:11], v146 offset:14336
  v_mul_u32_u24 v13, 7168, v13
  v_mfma_f32_16x16x32_bf16 v[76:79], a[28:31], a[60:63], v[76:79]
  buffer_load_dwordx4 v142, s[36:39], s61 offen offset:0 sc1 lds
  v_lshl_add_u32 v12, v12, 4, v13
  v_mfma_f32_16x16x32_bf16 v[72:75], a[24:27], a[60:63], v[72:75]
  ds_read_b64_tr_b16 a[46:47], v138 offset:7168
  v_add_u32 v4, s48, v12
  v_mfma_f32_16x16x32_bf16 v[68:71], a[20:23], a[60:63], v[68:71]
  s_waitcnt lgkmcnt(7)
  ds_read_b128 a[12:15], v146 offset:15360
  s_sub_u32 s48, s48, 1024
  v_mfma_f32_16x16x32_bf16 v[84:87], a[64:67], a[20:23], v[84:87]
  ds_read_b128 a[16:19], v149 offset:20480
  v_add_u32 v12, 128, v10
  v_mfma_f32_16x16x32_bf16 v[88:91], a[64:67], a[24:27], v[88:91]
  ds_read_b64_tr_b16 a[48:49], v137 offset:2048
  v_mul_u32_u24 v13, 4682, v12
  v_mfma_f32_16x16x32_bf16 v[92:95], a[64:67], a[28:31], v[92:95]
  buffer_load_dwordx4 v142, s[36:39], s61 offen offset:1024 sc1 lds
  s_add_u32 m0, s64, 106496
  v_mfma_f32_16x16x32_bf16 v[96:99], a[64:67], a[32:35], v[96:99]
  ds_read_b64_tr_b16 a[50:51], v137 offset:8192
  v_lshrrev_b32 v13, 16, v13
  v_mfma_f32_16x16x32_bf16 v[112:115], a[68:71], a[32:35], v[112:115]
  ds_read_b64_tr_b16 a[52:53], v138 offset:2048
  v_mul_i32_i24 v14, -14, v13
  v_mfma_f32_16x16x32_bf16 v[108:111], a[68:71], a[28:31], v[108:111]
  v_add3_u32 v12, v12, v14, s49
  v_add_u32 v14, -14, v12
  v_mfma_f32_16x16x32_bf16 v[104:107], a[68:71], a[24:27], v[104:107]
  buffer_load_dword v143, s[36:39], s61 offen sc1 lds
  s_mov_b32 s65, 30
  v_mfma_f32_16x16x32_bf16 v[100:103], a[68:71], a[20:23], v[100:103]
  s_waitcnt vmcnt(24) lgkmcnt(3)
  s_barrier
  s_mul_i32 s60, s65, 196608
  v_mfma_f32_16x16x32_bf16 v[20:23], a[40:43], a[0:3], v[20:23]
  s_add_u32 m0, s62, 107520
  ds_read_b64_tr_b16 a[54:55], v138 offset:8192
  v_min_u32 v12, v12, v14
  v_mfma_f32_16x16x32_bf16 v[24:27], a[40:43], a[4:7], v[24:27]
  ds_read_b64_tr_b16 a[56:57], v137 offset:0
  v_mul_u32_u24 v13, 7168, v13
  v_mfma_f32_16x16x32_bf16 v[28:31], a[40:43], a[8:11], v[28:31]
  buffer_load_dwordx4 v139, s[8:11], s60 offen offset:0 lds
  v_lshl_add_u32 v12, v12, 4, v13
  v_mfma_f32_16x16x32_bf16 v[32:35], a[40:43], a[12:15], v[32:35]
  ds_read_b64_tr_b16 a[58:59], v137 offset:6144
  v_add_u32 v5, s48, v12
  v_mfma_f32_16x16x32_bf16 v[116:119], a[40:43], a[16:19], v[116:119]
  s_sub_u32 s48, s48, 1024
  ds_read_b64_tr_b16 a[60:61], v138 offset:0
  v_add_u32 v12, 192, v10
  v_mfma_f32_16x16x32_bf16 v[48:51], a[44:47], a[12:15], v[48:51]
  v_mul_u32_u24 v13, 4682, v12
  v_lshrrev_b32 v13, 16, v13
  v_mfma_f32_16x16x32_bf16 v[44:47], a[44:47], a[8:11], v[44:47]
  buffer_load_dwordx4 v140, s[8:11], s60 offen offset:1024 lds
  v_mul_i32_i24 v14, -14, v13
  v_mfma_f32_16x16x32_bf16 v[40:43], a[44:47], a[4:7], v[40:43]
  ds_read_b64_tr_b16 a[62:63], v138 offset:6144
  v_add3_u32 v12, v12, v14, s49
  v_mfma_f32_16x16x32_bf16 v[36:39], a[44:47], a[0:3], v[36:39]
  s_waitcnt lgkmcnt(4)
  ds_read_b64_tr_b16 a[64:65], v133 offset:1024
  v_add_u32 v14, -14, v12
  v_mfma_f32_16x16x32_bf16 v[52:55], a[0:3], a[48:51], v[52:55]
  ds_read_b128 a[20:23], v144 offset:12288
  v_min_u32 v12, v12, v14
  v_mfma_f32_16x16x32_bf16 v[56:59], a[4:7], a[48:51], v[56:59]
  buffer_load_dwordx4 v141, s[8:11], s60 offen offset:2048 lds
  v_mul_u32_u24 v13, 7168, v13
  v_mfma_f32_16x16x32_bf16 v[60:63], a[8:11], a[48:51], v[60:63]
  s_lshl_b32 s61, s65, 11
  ds_read_b64_tr_b16 a[66:67], v133 offset:7168
  s_add_u32 m0, s63, 119808
  v_mfma_f32_16x16x32_bf16 v[64:67], a[12:15], a[48:51], v[64:67]
  ds_read_b128 a[24:27], v144 offset:13312
  v_lshl_add_u32 v12, v12, 4, v13
  v_mfma_f32_16x16x32_bf16 v[120:123], a[16:19], a[48:51], v[120:123]
  ds_read_b64_tr_b16 a[68:69], v134 offset:1024
  v_add_u32 v6, s48, v12
  v_mfma_f32_16x16x32_bf16 v[80:83], a[12:15], a[52:55], v[80:83]
  s_sub_u32 s48, s48, -3072
  ds_read_b128 a[28:31], v144 offset:14336
  v_add_u32 v12, 256, v10
  v_mfma_f32_16x16x32_bf16 v[76:79], a[8:11], a[52:55], v[76:79]
  buffer_load_dwordx4 v142, s[36:39], s61 offen offset:0 sc1 lds
  v_mul_u32_u24 v13, 4682, v12
  v_mfma_f32_16x16x32_bf16 v[72:75], a[4:7], a[52:55], v[72:75]
  ds_read_b64_tr_b16 a[70:71], v134 offset:7168
  v_lshrrev_b32 v13, 16, v13
  v_mfma_f32_16x16x32_bf16 v[68:71], a[0:3], a[52:55], v[68:71]
  s_waitcnt lgkmcnt(7)
  ds_read_b128 a[32:35], v144 offset:15360
  v_mul_i32_i24 v14, -14, v13
  v_mfma_f32_16x16x32_bf16 v[84:87], a[56:59], a[0:3], v[84:87]
  ds_read_b128 a[36:39], v147 offset:20480
  v_add3_u32 v12, v12, v14, s49
  v_mfma_f32_16x16x32_bf16 v[88:91], a[56:59], a[4:7], v[88:91]
  ds_read_b64_tr_b16 a[40:41], v133 offset:2048
  v_add_u32 v14, -14, v12
  v_mfma_f32_16x16x32_bf16 v[92:95], a[56:59], a[8:11], v[92:95]
  buffer_load_dwordx4 v142, s[36:39], s61 offen offset:1024 sc1 lds
  s_add_u32 m0, s64, 128000
  v_mfma_f32_16x16x32_bf16 v[96:99], a[56:59], a[12:15], v[96:99]
  ds_read_b64_tr_b16 a[42:43], v133 offset:8192
  v_min_u32 v12, v12, v14
  v_mfma_f32_16x16x32_bf16 v[112:115], a[60:63], a[12:15], v[112:115]
  ds_read_b64_tr_b16 a[44:45], v134 offset:2048
  v_mul_u32_u24 v13, 7168, v13
  v_mfma_f32_16x16x32_bf16 v[108:111], a[60:63], a[8:11], v[108:111]
  v_lshl_add_u32 v12, v12, 4, v13
  v_add_u32 v7, s48, v12
  v_mfma_f32_16x16x32_bf16 v[104:107], a[60:63], a[4:7], v[104:107]
  s_sub_u32 s48, s48, 1024
  buffer_load_dword v143, s[36:39], s61 offen sc1 lds
  s_mov_b32 s66, 31
  v_mfma_f32_16x16x32_bf16 v[100:103], a[60:63], a[0:3], v[100:103]
  s_waitcnt vmcnt(24) lgkmcnt(3)
  s_barrier
  s_mul_i32 s60, s66, 196608
  v_mfma_f32_16x16x32_bf16 v[20:23], a[64:67], a[20:23], v[20:23]
  s_add_u32 m0, s62, 129024
  ds_read_b64_tr_b16 a[46:47], v134 offset:8192
  v_add_u32 v12, 320, v10
  v_mfma_f32_16x16x32_bf16 v[24:27], a[64:67], a[24:27], v[24:27]
  ds_read_b64_tr_b16 a[48:49], v133 offset:0
  v_mul_u32_u24 v13, 4682, v12
  v_mfma_f32_16x16x32_bf16 v[28:31], a[64:67], a[28:31], v[28:31]
  buffer_load_dwordx4 v139, s[8:11], s60 offen offset:0 lds
  v_lshrrev_b32 v13, 16, v13
  v_mfma_f32_16x16x32_bf16 v[32:35], a[64:67], a[32:35], v[32:35]
  ds_read_b64_tr_b16 a[50:51], v133 offset:6144
  v_mul_i32_i24 v14, -14, v13
  v_mfma_f32_16x16x32_bf16 v[116:119], a[64:67], a[36:39], v[116:119]
  ds_read_b64_tr_b16 a[52:53], v134 offset:0
  v_add3_u32 v12, v12, v14, s49
  v_mfma_f32_16x16x32_bf16 v[48:51], a[68:71], a[32:35], v[48:51]
  v_add_u32 v14, -14, v12
  v_min_u32 v12, v12, v14
  v_mfma_f32_16x16x32_bf16 v[44:47], a[68:71], a[28:31], v[44:47]
  buffer_load_dwordx4 v140, s[8:11], s60 offen offset:1024 lds
  v_mul_u32_u24 v13, 7168, v13
  v_mfma_f32_16x16x32_bf16 v[40:43], a[68:71], a[24:27], v[40:43]
  ds_read_b64_tr_b16 a[54:55], v134 offset:6144
  v_lshl_add_u32 v12, v12, 4, v13
  v_mfma_f32_16x16x32_bf16 v[36:39], a[68:71], a[20:23], v[36:39]
  s_waitcnt lgkmcnt(4)
  ds_read_b64_tr_b16 a[56:57], v133 offset:22528
  v_add_u32 v8, s48, v12
  v_mfma_f32_16x16x32_bf16 v[52:55], a[20:23], a[40:43], v[52:55]
  s_sub_u32 s48, s48, 1024
  ds_read_b128 a[0:3], v144 offset:33792
  v_add_u32 v12, 384, v10
  v_mfma_f32_16x16x32_bf16 v[56:59], a[24:27], a[40:43], v[56:59]
  buffer_load_dwordx4 v141, s[8:11], s60 offen offset:2048 lds
  v_mul_u32_u24 v13, 4682, v12
  v_mfma_f32_16x16x32_bf16 v[60:63], a[28:31], a[40:43], v[60:63]
  s_lshl_b32 s61, s66, 11
  ds_read_b64_tr_b16 a[58:59], v133 offset:28672
  s_add_u32 m0, s63, 141312
  v_mfma_f32_16x16x32_bf16 v[64:67], a[32:35], a[40:43], v[64:67]
  ds_read_b128 a[4:7], v144 offset:34816
  v_lshrrev_b32 v13, 16, v13
  v_mfma_f32_16x16x32_bf16 v[120:123], a[36:39], a[40:43], v[120:123]
  ds_read_b64_tr_b16 a[60:61], v134 offset:22528
  v_mul_i32_i24 v14, -14, v13
  v_mfma_f32_16x16x32_bf16 v[80:83], a[32:35], a[44:47], v[80:83]
  ds_read_b128 a[8:11], v144 offset:35840
  v_add3_u32 v12, v12, v14, s49
  v_mfma_f32_16x16x32_bf16 v[76:79], a[28:31], a[44:47], v[76:79]
  buffer_load_dwordx4 v142, s[36:39], s61 offen offset:0 sc1 lds
  v_add_u32 v14, -14, v12
  v_mfma_f32_16x16x32_bf16 v[72:75], a[24:27], a[44:47], v[72:75]
  ds_read_b64_tr_b16 a[62:63], v134 offset:28672
  v_min_u32 v12, v12, v14
  v_mfma_f32_16x16x32_bf16 v[68:71], a[20:23], a[44:47], v[68:71]
  s_waitcnt lgkmcnt(7)
  ds_read_b128 a[12:15], v144 offset:36864
  v_mul_u32_u24 v13, 7168, v13
  v_mfma_f32_16x16x32_bf16 v[84:87], a[48:51], a[20:23], v[84:87]
  ds_read_b128 a[16:19], v147 offset:41984
  v_lshl_add_u32 v12, v12, 4, v13
  v_mfma_f32_16x16x32_bf16 v[88:91], a[48:51], a[24:27], v[88:91]
  ds_read_b64_tr_b16 a[64:65], v133 offset:23552
  v_add_u32 v9, s48, v12
  v_mfma_f32_16x16x32_bf16 v[92:95], a[48:51], a[28:31], v[92:95]
  s_sub_u32 s48, s48, 1024
  buffer_load_dwordx4 v142, s[36:39], s61 offen offset:1024 sc1 lds
  s_add_u32 m0, s64, 149504
  v_mfma_f32_16x16x32_bf16 v[96:99], a[48:51], a[32:35], v[96:99]
  s_and_b32 s48, s56, 1
  ds_read_b64_tr_b16 a[66:67], v133 offset:29696
  s_lshl_b32 s48, s48, 7
  v_mfma_f32_16x16x32_bf16 v[112:115], a[52:55], a[32:35], v[112:115]
  s_and_b32 s49, s56, 6
  ds_read_b64_tr_b16 a[68:69], v134 offset:23552
  s_add_u32 s48, s48, s49
  v_mfma_f32_16x16x32_bf16 v[108:111], a[52:55], a[28:31], v[108:111]
  v_bfe_u32 v12, v10, 1, 4
  v_and_b32 v13, 1, v10
  v_mfma_f32_16x16x32_bf16 v[104:107], a[52:55], a[24:27], v[104:107]
  buffer_load_dword v143, s[36:39], s61 offen sc1 lds
  s_nop 0
  v_mfma_f32_16x16x32_bf16 v[100:103], a[52:55], a[20:23], v[100:103]
  s_waitcnt vmcnt(24) lgkmcnt(3)
  s_barrier
  s_add_u32 s50, s79, 0
  v_mfma_f32_16x16x32_bf16 v[20:23], a[56:59], a[0:3], v[20:23]
  s_and_b32 s50, s50, 7
  s_lshl_b32 s50, s50, 18
  s_add_u32 m0, s73, 0
  v_mfma_f32_16x16x32_bf16 v[24:27], a[56:59], a[4:7], v[24:27]
  ds_read_b64_tr_b16 a[70:71], v134 offset:29696
  v_lshl_add_u32 v12, v12, 3, v13
  v_mfma_f32_16x16x32_bf16 v[28:31], a[56:59], a[8:11], v[28:31]
  ds_read_b64_tr_b16 a[40:41], v133 offset:21504
  v_add_lshl_u32 v250, v12, s48, 7
  v_mfma_f32_16x16x32_bf16 v[32:35], a[56:59], a[12:15], v[32:35]
  buffer_load_dwordx4 v216, s[12:15], s50 offen offset:0 lds
  v_mfma_f32_16x16x32_bf16 v[116:119], a[56:59], a[16:19], v[116:119]
  ds_read_b64_tr_b16 a[42:43], v133 offset:27648
  v_mfma_f32_16x16x32_bf16 v[48:51], a[60:63], a[12:15], v[48:51]
  ds_read_b64_tr_b16 a[44:45], v134 offset:21504
  v_mfma_f32_16x16x32_bf16 v[44:47], a[60:63], a[8:11], v[44:47]
  ds_read_b64_tr_b16 a[46:47], v134 offset:27648
  v_mfma_f32_16x16x32_bf16 v[40:43], a[60:63], a[4:7], v[40:43]
  buffer_load_dwordx4 v217, s[12:15], s50 offen offset:1024 lds
  v_mfma_f32_16x16x32_bf16 v[36:39], a[60:63], a[0:3], v[36:39]
  s_waitcnt lgkmcnt(4)
  ds_read_b64_tr_b16 a[48:49], v133 offset:44032
  v_mfma_f32_16x16x32_bf16 v[52:55], a[0:3], a[64:67], v[52:55]
Ha0_1:
  s_cbranch_execz Ha0_2
  ds_read_b128 a[20:23], v144 offset:55296
  v_mfma_f32_16x16x32_bf16 v[56:59], a[4:7], a[64:67], v[56:59]
  ds_read_b64_tr_b16 a[50:51], v133 offset:50176
  v_mfma_f32_16x16x32_bf16 v[60:63], a[8:11], a[64:67], v[60:63]
  buffer_load_dwordx4 v218, s[12:15], s50 offen offset:2048 lds
  v_mfma_f32_16x16x32_bf16 v[64:67], a[12:15], a[64:67], v[64:67]
  ds_read_b128 a[24:27], v144 offset:56320
  v_mfma_f32_16x16x32_bf16 v[120:123], a[16:19], a[64:67], v[120:123]
  ds_read_b64_tr_b16 a[52:53], v134 offset:44032
  v_mfma_f32_16x16x32_bf16 v[80:83], a[12:15], a[68:71], v[80:83]
  ds_read_b128 a[28:31], v144 offset:57344
  v_mfma_f32_16x16x32_bf16 v[76:79], a[8:11], a[68:71], v[76:79]
  buffer_load_dwordx4 v219, s[12:15], s50 offen offset:3072 lds
  v_mfma_f32_16x16x32_bf16 v[72:75], a[4:7], a[68:71], v[72:75]
  ds_read_b64_tr_b16 a[54:55], v134 offset:50176
  v_mfma_f32_16x16x32_bf16 v[68:71], a[0:3], a[68:71], v[68:71]
  s_waitcnt lgkmcnt(7)
  ds_read_b128 a[32:35], v144 offset:58368
  v_mfma_f32_16x16x32_bf16 v[84:87], a[40:43], a[0:3], v[84:87]
  ds_read_b128 a[36:39], v147 offset:63488
  v_mfma_f32_16x16x32_bf16 v[88:91], a[40:43], a[4:7], v[88:91]
  buffer_load_dwordx4 v[156:159], v196, s[28:31], s52 offen nt
  s_add_u32 s52, s52, 12288
  v_mfma_f32_16x16x32_bf16 v[92:95], a[40:43], a[8:11], v[92:95]
  ds_read_b64_tr_b16 a[56:57], v133 offset:45056
  v_mfma_f32_16x16x32_bf16 v[96:99], a[40:43], a[12:15], v[96:99]
  ds_read_b64_tr_b16 a[58:59], v133 offset:51200
  v_mfma_f32_16x16x32_bf16 v[112:115], a[44:47], a[12:15], v[112:115]
  ds_read_b64_tr_b16 a[60:61], v134 offset:45056
  v_mfma_f32_16x16x32_bf16 v[108:111], a[44:47], a[8:11], v[108:111]
  buffer_load_dwordx4 v[160:163], v196, s[28:31], s52 offen nt
  s_add_u32 s52, s52, 12288
  v_mfma_f32_16x16x32_bf16 v[104:107], a[44:47], a[4:7], v[104:107]
  ds_read_b64_tr_b16 a[62:63], v134 offset:51200
  v_mfma_f32_16x16x32_bf16 v[100:103], a[44:47], a[0:3], v[100:103]
  s_waitcnt vmcnt(24) lgkmcnt(4)
  s_barrier
  v_mfma_f32_16x16x32_bf16 v[20:23], a[48:51], a[20:23], v[20:23]
  ds_read_b64_tr_b16 a[64:65], v133 offset:43008
  v_mfma_f32_16x16x32_bf16 v[24:27], a[48:51], a[24:27], v[24:27]
  buffer_load_dwordx4 v[164:167], v196, s[28:31], s52 offen nt
  s_add_u32 s52, s52, 12288
  v_mfma_f32_16x16x32_bf16 v[28:31], a[48:51], a[28:31], v[28:31]
  ds_read_b64_tr_b16 a[66:67], v133 offset:49152
  v_mfma_f32_16x16x32_bf16 v[32:35], a[48:51], a[32:35], v[32:35]
  v_mfma_f32_16x16x32_bf16 v[116:119], a[48:51], a[36:39], v[116:119]
  ds_read_b64_tr_b16 a[68:69], v134 offset:43008
  v_mfma_f32_16x16x32_bf16 v[48:51], a[52:55], a[32:35], v[48:51]
  buffer_load_dwordx4 v[168:171], v196, s[28:31], s52 offen nt
  s_add_u32 s52, s52, 12288
  v_mfma_f32_16x16x32_bf16 v[44:47], a[52:55], a[28:31], v[44:47]
  ds_read_b64_tr_b16 a[70:71], v134 offset:49152
  v_mfma_f32_16x16x32_bf16 v[40:43], a[52:55], a[24:27], v[40:43]
  v_mfma_f32_16x16x32_bf16 v[36:39], a[52:55], a[20:23], v[36:39]
  s_waitcnt lgkmcnt(4)
  ds_read_b64_tr_b16 a[40:41], v135 offset:1024
  v_mfma_f32_16x16x32_bf16 v[52:55], a[20:23], a[56:59], v[52:55]
  buffer_load_dwordx4 v[172:175], v196, s[28:31], s52 offen nt
  s_add_u32 s52, s52, 12288
  v_mfma_f32_16x16x32_bf16 v[56:59], a[24:27], a[56:59], v[56:59]
  ds_read_b128 a[0:3], v145 offset:12288
  v_mfma_f32_16x16x32_bf16 v[60:63], a[28:31], a[56:59], v[60:63]
  ds_read_b64_tr_b16 a[42:43], v135 offset:7168
  v_mfma_f32_16x16x32_bf16 v[64:67], a[32:35], a[56:59], v[64:67]
  ds_read_b128 a[4:7], v145 offset:13312
  v_mfma_f32_16x16x32_bf16 v[120:123], a[36:39], a[56:59], v[120:123]
  buffer_load_dwordx4 v[176:179], v196, s[28:31], s52 offen nt
  s_add_u32 s52, s52, 12288
  v_mfma_f32_16x16x32_bf16 v[80:83], a[32:35], a[60:63], v[80:83]
  ds_read_b64_tr_b16 a[44:45], v136 offset:1024
  v_mfma_f32_16x16x32_bf16 v[76:79], a[28:31], a[60:63], v[76:79]
  ds_read_b128 a[8:11], v145 offset:14336
  v_mfma_f32_16x16x32_bf16 v[72:75], a[24:27], a[60:63], v[72:75]
  ds_read_b64_tr_b16 a[46:47], v136 offset:7168
  v_mfma_f32_16x16x32_bf16 v[68:71], a[20:23], a[60:63], v[68:71]
  s_waitcnt lgkmcnt(7)
  buffer_load_dwordx4 v[180:183], v196, s[28:31], s52 offen nt
  s_add_u32 s52, s52, 12288
  v_mfma_f32_16x16x32_bf16 v[84:87], a[64:67], a[20:23], v[84:87]
  ds_read_b128 a[12:15], v145 offset:15360
  v_mfma_f32_16x16x32_bf16 v[88:91], a[64:67], a[24:27], v[88:91]
  ds_read_b128 a[16:19], v148 offset:20480
  v_mfma_f32_16x16x32_bf16 v[92:95], a[64:67], a[28:31], v[92:95]
  ds_read_b64_tr_b16 a[48:49], v135 offset:2048
  v_mfma_f32_16x16x32_bf16 v[96:99], a[64:67], a[32:35], v[96:99]
  buffer_load_dwordx4 v[184:187], v196, s[28:31], s52 offen nt
  v_mfma_f32_16x16x32_bf16 v[112:115], a[68:71], a[32:35], v[112:115]
  ds_read_b64_tr_b16 a[50:51], v135 offset:8192
  v_mfma_f32_16x16x32_bf16 v[108:111], a[68:71], a[28:31], v[108:111]
  ds_read_b64_tr_b16 a[52:53], v136 offset:2048
  v_mfma_f32_16x16x32_bf16 v[104:107], a[68:71], a[24:27], v[104:107]
  ds_read_b64_tr_b16 a[54:55], v136 offset:8192
  v_mfma_f32_16x16x32_bf16 v[100:103], a[68:71], a[20:23], v[100:103]
  s_waitcnt vmcnt(24) lgkmcnt(4)
  s_barrier
  v_mfma_f32_16x16x32_bf16 v[20:23], a[40:43], a[0:3], v[20:23]
  ds_read_b64_tr_b16 a[56:57], v135 offset:0
  v_mfma_f32_16x16x32_bf16 v[24:27], a[40:43], a[4:7], v[24:27]
  v_mfma_f32_16x16x32_bf16 v[28:31], a[40:43], a[8:11], v[28:31]
  ds_read_b64_tr_b16 a[58:59], v135 offset:6144
  v_mfma_f32_16x16x32_bf16 v[32:35], a[40:43], a[12:15], v[32:35]
  v_mfma_f32_16x16x32_bf16 v[116:119], a[40:43], a[16:19], v[116:119]
  ds_read_b64_tr_b16 a[60:61], v136 offset:0
  v_mfma_f32_16x16x32_bf16 v[48:51], a[44:47], a[12:15], v[48:51]
  v_mfma_f32_16x16x32_bf16 v[44:47], a[44:47], a[8:11], v[44:47]
  ds_read_b64_tr_b16 a[62:63], v136 offset:6144
  v_mfma_f32_16x16x32_bf16 v[40:43], a[44:47], a[4:7], v[40:43]
  v_mfma_f32_16x16x32_bf16 v[36:39], a[44:47], a[0:3], v[36:39]
  s_waitcnt lgkmcnt(4)
  ds_read_b64_tr_b16 a[64:65], v135 offset:22528
  v_mfma_f32_16x16x32_bf16 v[52:55], a[0:3], a[48:51], v[52:55]
  ds_read_b128 a[20:23], v145 offset:33792
  v_mfma_f32_16x16x32_bf16 v[56:59], a[4:7], a[48:51], v[56:59]
  ds_read_b64_tr_b16 a[66:67], v135 offset:28672
  v_mfma_f32_16x16x32_bf16 v[60:63], a[8:11], a[48:51], v[60:63]
  ds_read_b128 a[24:27], v145 offset:34816
  v_mfma_f32_16x16x32_bf16 v[64:67], a[12:15], a[48:51], v[64:67]
  v_mfma_f32_16x16x32_bf16 v[120:123], a[16:19], a[48:51], v[120:123]
  ds_read_b64_tr_b16 a[68:69], v136 offset:22528
  v_mfma_f32_16x16x32_bf16 v[80:83], a[12:15], a[52:55], v[80:83]
  ds_read_b128 a[28:31], v145 offset:35840
  v_mfma_f32_16x16x32_bf16 v[76:79], a[8:11], a[52:55], v[76:79]
  ds_read_b64_tr_b16 a[70:71], v136 offset:28672
  v_mfma_f32_16x16x32_bf16 v[72:75], a[4:7], a[52:55], v[72:75]
  ds_read_b128 a[32:35], v145 offset:36864
  v_mfma_f32_16x16x32_bf16 v[68:71], a[0:3], a[52:55], v[68:71]
  s_waitcnt lgkmcnt(8)
  ds_read_b128 a[36:39], v148 offset:41984
  v_mfma_f32_16x16x32_bf16 v[84:87], a[56:59], a[0:3], v[84:87]
  ds_read_b64_tr_b16 a[40:41], v135 offset:23552
  v_mfma_f32_16x16x32_bf16 v[88:91], a[56:59], a[4:7], v[88:91]
  ds_read_b64_tr_b16 a[42:43], v135 offset:29696
  v_mfma_f32_16x16x32_bf16 v[92:95], a[56:59], a[8:11], v[92:95]
  v_mfma_f32_16x16x32_bf16 v[96:99], a[56:59], a[12:15], v[96:99]
  v_mfma_f32_16x16x32_bf16 v[112:115], a[60:63], a[12:15], v[112:115]
  ds_read_b64_tr_b16 a[44:45], v136 offset:23552
  v_mfma_f32_16x16x32_bf16 v[108:111], a[60:63], a[8:11], v[108:111]
  v_mfma_f32_16x16x32_bf16 v[104:107], a[60:63], a[4:7], v[104:107]
  ds_read_b64_tr_b16 a[46:47], v136 offset:29696
  v_mfma_f32_16x16x32_bf16 v[100:103], a[60:63], a[0:3], v[100:103]
  s_waitcnt vmcnt(18) lgkmcnt(4)
  s_barrier
  v_mfma_f32_16x16x32_bf16 v[20:23], a[64:67], a[20:23], v[20:23]
  ds_read_b64_tr_b16 a[48:49], v135 offset:21504
  v_mfma_f32_16x16x32_bf16 v[24:27], a[64:67], a[24:27], v[24:27]
  v_mfma_f32_16x16x32_bf16 v[28:31], a[64:67], a[28:31], v[28:31]
  ds_read_b64_tr_b16 a[50:51], v135 offset:27648
  v_mfma_f32_16x16x32_bf16 v[32:35], a[64:67], a[32:35], v[32:35]
  v_mfma_f32_16x16x32_bf16 v[116:119], a[64:67], a[36:39], v[116:119]
  ds_read_b64_tr_b16 a[52:53], v136 offset:21504
  v_mfma_f32_16x16x32_bf16 v[48:51], a[68:71], a[32:35], v[48:51]
  v_mfma_f32_16x16x32_bf16 v[44:47], a[68:71], a[28:31], v[44:47]
  ds_read_b64_tr_b16 a[54:55], v136 offset:27648
  v_mfma_f32_16x16x32_bf16 v[40:43], a[68:71], a[24:27], v[40:43]
  v_mfma_f32_16x16x32_bf16 v[36:39], a[68:71], a[20:23], v[36:39]
  s_waitcnt lgkmcnt(4)
  ds_read_b64_tr_b16 a[56:57], v135 offset:44032
  v_mfma_f32_16x16x32_bf16 v[52:55], a[20:23], a[40:43], v[52:55]
  ds_read_b128 a[0:3], v145 offset:55296
  v_mfma_f32_16x16x32_bf16 v[56:59], a[24:27], a[40:43], v[56:59]
  ds_read_b64_tr_b16 a[58:59], v135 offset:50176
  v_mfma_f32_16x16x32_bf16 v[60:63], a[28:31], a[40:43], v[60:63]
  ds_read_b128 a[4:7], v145 offset:56320
  v_mfma_f32_16x16x32_bf16 v[64:67], a[32:35], a[40:43], v[64:67]
  v_mfma_f32_16x16x32_bf16 v[120:123], a[36:39], a[40:43], v[120:123]
  ds_read_b64_tr_b16 a[60:61], v136 offset:44032
  v_mfma_f32_16x16x32_bf16 v[80:83], a[32:35], a[44:47], v[80:83]
  ds_read_b128 a[8:11], v145 offset:57344
  v_mfma_f32_16x16x32_bf16 v[76:79], a[28:31], a[44:47], v[76:79]
  ds_read_b64_tr_b16 a[62:63], v136 offset:50176
  v_mfma_f32_16x16x32_bf16 v[72:75], a[24:27], a[44:47], v[72:75]
  ds_read_b128 a[12:15], v145 offset:58368
  v_mfma_f32_16x16x32_bf16 v[68:71], a[20:23], a[44:47], v[68:71]
  s_waitcnt lgkmcnt(8)
  ds_read_b128 a[16:19], v148 offset:63488
  v_mfma_f32_16x16x32_bf16 v[84:87], a[48:51], a[20:23], v[84:87]
  ds_read_b64_tr_b16 a[64:65], v135 offset:45056
  v_mfma_f32_16x16x32_bf16 v[88:91], a[48:51], a[24:27], v[88:91]
  ds_read_b64_tr_b16 a[66:67], v135 offset:51200
  v_mfma_f32_16x16x32_bf16 v[92:95], a[48:51], a[28:31], v[92:95]
  v_mfma_f32_16x16x32_bf16 v[96:99], a[48:51], a[32:35], v[96:99]
  v_mfma_f32_16x16x32_bf16 v[112:115], a[52:55], a[32:35], v[112:115]
  ds_read_b64_tr_b16 a[68:69], v136 offset:45056
  v_mfma_f32_16x16x32_bf16 v[108:111], a[52:55], a[28:31], v[108:111]
  v_mfma_f32_16x16x32_bf16 v[104:107], a[52:55], a[24:27], v[104:107]
  ds_read_b64_tr_b16 a[70:71], v136 offset:51200
  v_mfma_f32_16x16x32_bf16 v[100:103], a[52:55], a[20:23], v[100:103]
  s_waitcnt vmcnt(12) lgkmcnt(4)
  s_barrier
  v_mfma_f32_16x16x32_bf16 v[20:23], a[56:59], a[0:3], v[20:23]
  ds_read_b64_tr_b16 a[40:41], v135 offset:43008
  v_mfma_f32_16x16x32_bf16 v[24:27], a[56:59], a[4:7], v[24:27]
  s_add_u32 s50, s79, 1
  s_and_b32 s50, s50, 7
  s_lshl_b32 s50, s50, 18
  v_mfma_f32_16x16x32_bf16 v[28:31], a[56:59], a[8:11], v[28:31]
  s_add_u32 m0, s73, 16384
  ds_read_b64_tr_b16 a[42:43], v135 offset:49152
  v_mfma_f32_16x16x32_bf16 v[32:35], a[56:59], a[12:15], v[32:35]
  v_mfma_f32_16x16x32_bf16 v[116:119], a[56:59], a[16:19], v[116:119]
  ds_read_b64_tr_b16 a[44:45], v136 offset:43008
  v_mfma_f32_16x16x32_bf16 v[48:51], a[60:63], a[12:15], v[48:51]
  buffer_load_dwordx4 v216, s[12:15], s50 offen offset:0 lds
  v_mfma_f32_16x16x32_bf16 v[44:47], a[60:63], a[8:11], v[44:47]
  ds_read_b64_tr_b16 a[46:47], v136 offset:49152
  v_mfma_f32_16x16x32_bf16 v[40:43], a[60:63], a[4:7], v[40:43]
  v_mfma_f32_16x16x32_bf16 v[36:39], a[60:63], a[0:3], v[36:39]
  s_waitcnt lgkmcnt(4)
  ds_read_b64_tr_b16 a[48:49], v137 offset:1024
  v_mfma_f32_16x16x32_bf16 v[52:55], a[0:3], a[64:67], v[52:55]
  buffer_load_dwordx4 v217, s[12:15], s50 offen offset:1024 lds
  v_mfma_f32_16x16x32_bf16 v[56:59], a[4:7], a[64:67], v[56:59]
  ds_read_b128 a[20:23], v146 offset:12288
  v_mfma_f32_16x16x32_bf16 v[60:63], a[8:11], a[64:67], v[60:63]
  ds_read_b64_tr_b16 a[50:51], v137 offset:7168
  v_mfma_f32_16x16x32_bf16 v[64:67], a[12:15], a[64:67], v[64:67]
  ds_read_b128 a[24:27], v146 offset:13312
  v_mfma_f32_16x16x32_bf16 v[120:123], a[16:19], a[64:67], v[120:123]
  buffer_load_dwordx4 v218, s[12:15], s50 offen offset:2048 lds
  v_mfma_f32_16x16x32_bf16 v[80:83], a[12:15], a[68:71], v[80:83]
  ds_read_b64_tr_b16 a[52:53], v138 offset:1024
  v_mfma_f32_16x16x32_bf16 v[76:79], a[8:11], a[68:71], v[76:79]
  ds_read_b128 a[28:31], v146 offset:14336
  v_mfma_f32_16x16x32_bf16 v[72:75], a[4:7], a[68:71], v[72:75]
  ds_read_b64_tr_b16 a[54:55], v138 offset:7168
  v_mfma_f32_16x16x32_bf16 v[68:71], a[0:3], a[68:71], v[68:71]
  s_waitcnt lgkmcnt(7)
  ds_read_b128 a[32:35], v146 offset:15360
  v_mfma_f32_16x16x32_bf16 v[84:87], a[40:43], a[0:3], v[84:87]
  buffer_load_dwordx4 v219, s[12:15], s50 offen offset:3072 lds
  s_add_u32 s50, s79, 2
  v_mfma_f32_16x16x32_bf16 v[88:91], a[40:43], a[4:7], v[88:91]
  s_and_b32 s50, s50, 7
  s_lshl_b32 s50, s50, 18
  s_add_u32 m0, s73, 32768
  v_mfma_f32_16x16x32_bf16 v[92:95], a[40:43], a[8:11], v[92:95]
  ds_read_b128 a[36:39], v149 offset:20480
  v_mfma_f32_16x16x32_bf16 v[96:99], a[40:43], a[12:15], v[96:99]
  ds_read_b64_tr_b16 a[56:57], v137 offset:2048
  v_mfma_f32_16x16x32_bf16 v[112:115], a[44:47], a[12:15], v[112:115]
  ds_read_b64_tr_b16 a[58:59], v137 offset:8192
  v_mfma_f32_16x16x32_bf16 v[108:111], a[44:47], a[8:11], v[108:111]
  buffer_load_dwordx4 v216, s[12:15], s50 offen offset:0 lds
  v_mfma_f32_16x16x32_bf16 v[104:107], a[44:47], a[4:7], v[104:107]
  ds_read_b64_tr_b16 a[60:61], v138 offset:2048
  v_mfma_f32_16x16x32_bf16 v[100:103], a[44:47], a[0:3], v[100:103]
  s_waitcnt lgkmcnt(3)
  ds_read_b64_tr_b16 a[62:63], v138 offset:8192
  v_mfma_f32_16x16x32_bf16 v[20:23], a[48:51], a[20:23], v[20:23]
  ds_read_b64_tr_b16 a[64:65], v137 offset:0
  v_mfma_f32_16x16x32_bf16 v[24:27], a[48:51], a[24:27], v[24:27]
  buffer_load_dwordx4 v217, s[12:15], s50 offen offset:1024 lds
  v_mfma_f32_16x16x32_bf16 v[28:31], a[48:51], a[28:31], v[28:31]
  ds_read_b64_tr_b16 a[66:67], v137 offset:6144
  v_mfma_f32_16x16x32_bf16 v[32:35], a[48:51], a[32:35], v[32:35]
  v_mfma_f32_16x16x32_bf16 v[116:119], a[48:51], a[36:39], v[116:119]
  ds_read_b64_tr_b16 a[68:69], v138 offset:0
  v_mfma_f32_16x16x32_bf16 v[48:51], a[52:55], a[32:35], v[48:51]
  buffer_load_dwordx4 v218, s[12:15], s50 offen offset:2048 lds
  v_mfma_f32_16x16x32_bf16 v[44:47], a[52:55], a[28:31], v[44:47]
  ds_read_b64_tr_b16 a[70:71], v138 offset:6144
  v_mfma_f32_16x16x32_bf16 v[40:43], a[52:55], a[24:27], v[40:43]
  v_mfma_f32_16x16x32_bf16 v[36:39], a[52:55], a[20:23], v[36:39]
  s_waitcnt lgkmcnt(4)
  v_mfma_f32_16x16x32_bf16 v[52:55], a[20:23], a[56:59], v[52:55]
  buffer_load_dwordx4 v219, s[12:15], s50 offen offset:3072 lds
  v_cvt_pk_bf16_f32 v116, v116, v117
  v_mfma_f32_16x16x32_bf16 v[56:59], a[24:27], a[56:59], v[56:59]
  v_cvt_pk_bf16_f32 v117, v118, v119
  v_cvt_pk_bf16_f32 v32, v32, v33
  v_mfma_f32_16x16x32_bf16 v[60:63], a[28:31], a[56:59], v[60:63]
  v_cvt_pk_bf16_f32 v33, v34, v35
  v_cvt_pk_bf16_f32 v34, v48, v49
  v_mfma_f32_16x16x32_bf16 v[64:67], a[32:35], a[56:59], v[64:67]
  v_cvt_pk_bf16_f32 v35, v50, v51
  v_mfma_f32_16x16x32_bf16 v[120:123], a[36:39], a[56:59], v[120:123]
  ds_write_b64 v224, v[116:117]
  v_mfma_f32_16x16x32_bf16 v[80:83], a[32:35], a[60:63], v[80:83]
  ds_write_b64 v222, v[32:33]
  v_mfma_f32_16x16x32_bf16 v[76:79], a[28:31], a[60:63], v[76:79]
  ds_write_b64 v223, v[34:35]
  v_cvt_pk_bf16_f32 v55, v54, v55
  v_mfma_f32_16x16x32_bf16 v[72:75], a[24:27], a[60:63], v[72:75]
  v_cvt_pk_bf16_f32 v54, v52, v53
  v_cvt_pk_bf16_f32 v56, v56, v57
  v_mfma_f32_16x16x32_bf16 v[68:71], a[20:23], a[60:63], v[68:71]
  s_waitcnt lgkmcnt(3)
  v_cvt_pk_bf16_f32 v57, v58, v59
  v_cvt_pk_bf16_f32 v58, v60, v61
  v_mfma_f32_16x16x32_bf16 v[84:87], a[64:67], a[20:23], v[84:87]
  v_cvt_pk_bf16_f32 v59, v62, v63
  v_cvt_pk_bf16_f32 v60, v64, v65
  v_mfma_f32_16x16x32_bf16 v[88:91], a[64:67], a[24:27], v[88:91]
  v_cvt_pk_bf16_f32 v61, v66, v67
  v_cvt_pk_bf16_f32 v120, v120, v121
  v_mfma_f32_16x16x32_bf16 v[92:95], a[64:67], a[28:31], v[92:95]
  v_cvt_pk_bf16_f32 v121, v122, v123
  v_mfma_f32_16x16x32_bf16 v[96:99], a[64:67], a[32:35], v[96:99]
  ds_write_b64 v222, v[60:61] offset:1024
  v_mfma_f32_16x16x32_bf16 v[112:115], a[68:71], a[32:35], v[112:115]
  ds_write_b64 v224, v[120:121] offset:1024
  v_cvt_pk_bf16_f32 v71, v70, v71
  v_mfma_f32_16x16x32_bf16 v[108:111], a[68:71], a[28:31], v[108:111]
  v_cvt_pk_bf16_f32 v70, v68, v69
  v_cvt_pk_bf16_f32 v72, v72, v73
  v_mfma_f32_16x16x32_bf16 v[104:107], a[68:71], a[24:27], v[104:107]
  v_cvt_pk_bf16_f32 v73, v74, v75
  v_cvt_pk_bf16_f32 v74, v76, v77
  v_mfma_f32_16x16x32_bf16 v[100:103], a[68:71], a[20:23], v[100:103]
  v_cvt_pk_bf16_f32 v75, v78, v79
  v_cvt_pk_bf16_f32 v76, v80, v81
  v_cvt_pk_bf16_f32 v77, v82, v83
  ds_write_b64 v223, v[76:77] offset:1024
  v_cvt_pk_bf16_f32 v28, v28, v29
  v_cvt_pk_bf16_f32 v29, v30, v31
  v_cvt_pk_bf16_f32 v30, v44, v45
  v_cvt_pk_bf16_f32 v31, v46, v47
  v_cvt_pk_bf16_f32 v24, v24, v25
  v_cvt_pk_bf16_f32 v25, v26, v27
  v_cvt_pk_bf16_f32 v26, v40, v41
  v_cvt_pk_bf16_f32 v27, v42, v43
  v_cvt_pk_bf16_f32 v20, v20, v21
  v_cvt_pk_bf16_f32 v21, v22, v23
  v_cvt_pk_bf16_f32 v22, v36, v37
  v_cvt_pk_bf16_f32 v23, v38, v39
  s_waitcnt lgkmcnt(0)
  s_barrier
  ds_read_b64 v[124:125], v225
  ds_read_b64 v[126:127], v226
  ds_read_b64 v[52:53], v225 offset:1024
  ds_read_b64 v[68:69], v226 offset:1024
  s_cmp_eq_u32 s51, 0
  s_cselect_b64 s[66:67], s[82:83], 0
  s_cselect_b64 s[68:69], s[84:85], 0
  v_cvt_pk_bf16_f32 v96, v96, v97
  v_cvt_pk_bf16_f32 v97, v98, v99
  v_cvt_pk_bf16_f32 v98, v112, v113
  v_cvt_pk_bf16_f32 v99, v114, v115
  v_cvt_pk_bf16_f32 v92, v92, v93
  v_cvt_pk_bf16_f32 v93, v94, v95
  v_cvt_pk_bf16_f32 v94, v108, v109
  s_add_u32 s50, s79, 3
  s_and_b32 s50, s50, 7
  s_lshl_b32 s50, s50, 18
  s_add_u32 m0, s73, 49152
  s_nop 0
  buffer_load_dwordx4 v216, s[12:15], s50 offen offset:0 lds
  v_cvt_pk_bf16_f32 v95, v110, v111
  v_cvt_pk_bf16_f32 v88, v88, v89
  v_cvt_pk_bf16_f32 v89, v90, v91
  v_cvt_pk_bf16_f32 v90, v104, v105
  v_cvt_pk_bf16_f32 v91, v106, v107
  v_cvt_pk_bf16_f32 v84, v84, v85
  v_cvt_pk_bf16_f32 v85, v86, v87
  v_cvt_pk_bf16_f32 v86, v100, v101
  v_cvt_pk_bf16_f32 v87, v102, v103
  v_mov_b32 v12, 0xce6e6b28
  buffer_load_dwordx4 v217, s[12:15], s50 offen offset:1024 lds
  v_mfma_f32_16x16x32_bf16 v[112:115], v[32:35], v[96:99], 0
  v_mfma_f32_16x16x32_bf16 v[48:51], v[28:31], v[96:99], 0
  v_mfma_f32_16x16x32_bf16 v[108:111], v[28:31], v[92:95], 0
  v_mfma_f32_16x16x32_bf16 v[44:47], v[24:27], v[92:95], 0
  v_mfma_f32_16x16x32_bf16 v[104:107], v[24:27], v[88:91], 0
  v_mfma_f32_16x16x32_bf16 v[40:43], v[20:23], v[88:91], 0
  s_waitcnt lgkmcnt(2)
  v_mfma_f32_16x16x32_bf16 v[100:103], v[20:23], v[84:87], 0
  v_mfma_f32_16x16x32_bf16 v[36:39], v[124:127], v[84:87], 0
  s_nop 1
  v_cndmask_b32 v214, v112, v113, s[80:81]
  buffer_load_dwordx4 v218, s[12:15], s50 offen offset:2048 lds
  v_cndmask_b32 v215, v114, v115, s[80:81]
  v_cndmask_b32 v212, v48, v49, s[80:81]
  v_cndmask_b32 v213, v50, v51, s[80:81]
  v_cndmask_b32 v210, v108, v109, s[80:81]
  v_cndmask_b32 v211, v110, v111, s[80:81]
  v_cndmask_b32 v208, v44, v45, s[80:81]
  v_cndmask_b32 v209, v46, v47, s[80:81]
  v_cndmask_b32 v206, v104, v105, s[80:81]
  v_cndmask_b32 v207, v106, v107, s[80:81]
  v_cndmask_b32 v204, v40, v41, s[80:81]
  buffer_load_dwordx4 v219, s[12:15], s50 offen offset:3072 lds
  v_cndmask_b32 v205, v42, v43, s[80:81]
  v_cndmask_b32 v202, v100, v101, s[80:81]
  v_cndmask_b32 v203, v102, v103, s[80:81]
  v_cndmask_b32 v200, v36, v37, s[80:81]
  v_cndmask_b32 v201, v38, v39, s[80:81]
  v_cndmask_b32 v212, v214, v212, s[82:83]
  v_cndmask_b32 v213, v215, v213, s[84:85]
  v_cndmask_b32 v208, v210, v208, s[82:83]
  v_cndmask_b32 v209, v211, v209, s[84:85]
  v_cndmask_b32 v204, v206, v204, s[82:83]
  s_add_u32 s50, s79, 4
  s_and_b32 s50, s50, 7
  s_lshl_b32 s50, s50, 18
  s_add_u32 m0, s73, 65536
  s_nop 0
  buffer_load_dwordx4 v216, s[12:15], s50 offen offset:0 lds
  v_cndmask_b32 v205, v207, v205, s[84:85]
  v_cndmask_b32 v200, v202, v200, s[82:83]
  v_cndmask_b32 v201, v203, v201, s[84:85]
  v_mul_f32 v212, 0x3e8293ee, v212
  v_mul_f32 v213, 0x3e8293ee, v213
  v_mul_f32 v208, 0x3e8293ee, v208
  v_mul_f32 v209, 0x3e8293ee, v209
  v_mul_f32 v204, 0x3e8293ee, v204
  v_mul_f32 v205, 0x3e8293ee, v205
  v_mul_f32 v200, 0x3e8293ee, v200
  buffer_load_dwordx4 v217, s[12:15], s50 offen offset:1024 lds
  v_mul_f32 v201, 0x3e8293ee, v201
  v_cndmask_b32 v200, v200, v12, s[66:67]
  v_cndmask_b32 v201, v201, v12, s[68:69]
  v_max_f32 v214, v212, v213
  v_max_f32 v210, v208, v209
  v_max_f32 v206, v204, v205
  v_max_f32 v202, v200, v201
  v_mov_b32 v215, v214
  v_mov_b32 v211, v210
  v_mov_b32 v207, v206
  buffer_load_dwordx4 v218, s[12:15], s50 offen offset:2048 lds
  v_mov_b32 v203, v202
  v_permlane16_swap_b32 v214, v215
  v_permlane16_swap_b32 v210, v211
  v_permlane16_swap_b32 v206, v207
  v_permlane16_swap_b32 v202, v203
  v_max_f32 v214, v214, v215
  v_max_f32 v210, v210, v211
  v_max_f32 v206, v206, v207
  v_max_f32 v202, v202, v203
  v_mov_b32 v215, v214
  buffer_load_dwordx4 v219, s[12:15], s50 offen offset:3072 lds
  v_mov_b32 v211, v210
  v_mov_b32 v207, v206
  v_mov_b32 v203, v202
  v_permlane32_swap_b32 v214, v215
  v_permlane32_swap_b32 v210, v211
  v_permlane32_swap_b32 v206, v207
  v_permlane32_swap_b32 v202, v203
  v_max_f32 v214, v214, v215
  v_max_f32 v210, v210, v211
  v_max_f32 v206, v206, v207
  v_max_f32 v202, v202, v203
  v_sub_f32 v212, v212, v214
  v_sub_f32 v213, v213, v214
  v_sub_f32 v208, v208, v210
  v_sub_f32 v209, v209, v210
  v_sub_f32 v204, v204, v206
  v_sub_f32 v205, v205, v206
  v_sub_f32 v200, v200, v202
  v_sub_f32 v201, v201, v202
  v_exp_f32 v212, v212
  v_exp_f32 v213, v213
  v_exp_f32 v208, v208
  v_exp_f32 v209, v209
  v_exp_f32 v204, v204
  v_exp_f32 v205, v205
  v_exp_f32 v200, v200
  v_exp_f32 v201, v201
  v_add_f32 v214, v212, v213
  v_add_f32 v210, v208, v209
  v_add_f32 v206, v204, v205
  v_add_f32 v202, v200, v201
  v_mov_b32 v215, v214
  v_mov_b32 v211, v210
  v_mov_b32 v207, v206
  v_mov_b32 v203, v202
  v_permlane16_swap_b32 v214, v215
  v_permlane16_swap_b32 v210, v211
  v_permlane16_swap_b32 v206, v207
  v_permlane16_swap_b32 v202, v203
  v_add_f32 v214, v214, v215
  v_add_f32 v210, v210, v211
  v_add_f32 v206, v206, v207
  v_add_f32 v202, v202, v203
  v_mov_b32 v215, v214
  v_mov_b32 v211, v210
  v_mov_b32 v207, v206
  v_mov_b32 v203, v202
  v_permlane32_swap_b32 v214, v215
  v_permlane32_swap_b32 v210, v211
  v_permlane32_swap_b32 v206, v207
  v_permlane32_swap_b32 v202, v203
  v_add_f32 v214, v214, v215
  v_add_f32 v210, v210, v211
  v_add_f32 v206, v206, v207
  v_add_f32 v202, v202, v203
  v_rcp_f32 v214, v214
  v_rcp_f32 v210, v210
  v_rcp_f32 v206, v206
  v_rcp_f32 v202, v202
  v_mul_f32 v212, v212, v214
  v_mul_f32 v213, v213, v214
  v_mul_f32 v208, v208, v210
  v_mul_f32 v209, v209, v210
  v_mul_f32 v204, v204, v206
  v_mul_f32 v205, v205, v206
  v_mul_f32 v200, v200, v202
  v_mul_f32 v201, v201, v202
  v_cvt_pk_bf16_f32 v212, v212, v212
  v_cvt_pk_bf16_f32 v213, v213, v213
  v_cvt_pk_bf16_f32 v208, v208, v208
  v_cvt_pk_bf16_f32 v209, v209, v209
  v_cvt_pk_bf16_f32 v204, v204, v204
  v_cvt_pk_bf16_f32 v205, v205, v205
  v_cvt_pk_bf16_f32 v200, v200, v200
  v_cvt_pk_bf16_f32 v201, v201, v201
  v_and_b32 v48, v227, v212
  v_and_b32 v49, v228, v213
  v_and_b32 v50, v229, v212
  v_and_b32 v51, v230, v213
  v_and_b32 v44, v227, v208
  v_and_b32 v45, v228, v209
  v_and_b32 v46, v229, v208
  v_and_b32 v47, v230, v209
  v_and_b32 v40, v227, v204
  v_and_b32 v41, v228, v205
  v_and_b32 v42, v229, v204
  v_and_b32 v43, v230, v205
  v_and_b32 v36, v227, v200
  v_and_b32 v37, v228, v201
  v_and_b32 v38, v229, v200
  v_and_b32 v39, v230, v201
  s_waitcnt lgkmcnt(0)
  v_mfma_f32_16x16x32_bf16 v[32:35], v[58:61], v[48:51], 0
  v_mfma_f32_16x16x32_bf16 v[96:99], v[74:77], v[48:51], 0
  v_mfma_f32_16x16x32_bf16 v[28:31], v[56:59], v[44:47], 0
  v_mfma_f32_16x16x32_bf16 v[92:95], v[72:75], v[44:47], 0
  v_mfma_f32_16x16x32_bf16 v[24:27], v[54:57], v[40:43], 0
  v_mfma_f32_16x16x32_bf16 v[88:91], v[70:73], v[40:43], 0
  v_mfma_f32_16x16x32_bf16 v[20:23], v[52:55], v[36:39], 0
  v_mfma_f32_16x16x32_bf16 v[84:87], v[68:71], v[36:39], 0
  s_cmp_eq_u32 s58, 1
  s_cselect_b64 vcc, -1, 0
  v_cvt_pk_bf16_f32 v112, v32, v33
  v_cvt_pk_bf16_f32 v113, v34, v35
  v_cvt_pk_bf16_f32 v114, v96, v97
  v_cvt_pk_bf16_f32 v115, v98, v99
  v_cndmask_b32 v212, v112, v114, vcc
  v_cndmask_b32 v213, v113, v115, vcc
  v_cndmask_b32 v214, v114, v112, vcc
  v_cndmask_b32 v215, v115, v113, vcc
  buffer_store_dwordx4 v[212:215], v0, s[36:39], s75 offen offset:1024 sc1
  v_cvt_pk_bf16_f32 v108, v28, v29
  v_cvt_pk_bf16_f32 v109, v30, v31
  v_cvt_pk_bf16_f32 v110, v92, v93
  v_cvt_pk_bf16_f32 v111, v94, v95
  v_cndmask_b32 v208, v108, v110, vcc
  v_cndmask_b32 v209, v109, v111, vcc
  v_cndmask_b32 v210, v110, v108, vcc
  v_cndmask_b32 v211, v111, v109, vcc
  buffer_store_dwordx4 v[208:211], v0, s[36:39], s75 offen offset:0 sc1
  v_cvt_pk_bf16_f32 v104, v24, v25
  v_cvt_pk_bf16_f32 v105, v26, v27
  v_cvt_pk_bf16_f32 v106, v88, v89
  v_cvt_pk_bf16_f32 v107, v90, v91
  v_cndmask_b32 v204, v104, v106, vcc
  v_cndmask_b32 v205, v105, v107, vcc
  v_cndmask_b32 v206, v106, v104, vcc
  v_cndmask_b32 v207, v107, v105, vcc
  buffer_store_dwordx4 v[204:207], v0, s[36:39], s74 offen offset:1024 sc1
  v_cvt_pk_bf16_f32 v100, v20, v21
  v_cvt_pk_bf16_f32 v101, v22, v23
  v_cvt_pk_bf16_f32 v102, v84, v85
  v_cvt_pk_bf16_f32 v103, v86, v87
  v_cndmask_b32 v200, v100, v102, vcc
  v_cndmask_b32 v201, v101, v103, vcc
  v_cndmask_b32 v202, v102, v100, vcc
  v_cndmask_b32 v203, v103, v101, vcc
  buffer_store_dwordx4 v[200:203], v0, s[36:39], s74 offen offset:0 sc1
  v_mov_b32 v12, 1
  s_waitcnt vmcnt(0) lgkmcnt(0)
  s_barrier
  s_mov_b64 exec, 1
  buffer_store_dword v12, v0, s[36:39], s45 offen sc1
  s_mov_b64 exec, -1
  v_lshlrev_b32 v28, 16, v156
  v_lshrrev_b32 v14, 2, v10
  v_min_u32 v14, (X_k3_main_kernel-G3S)/4096, v14
  v_and_b32 v15, 3, v10
  v_lshlrev_b32 v15, 7, v15
  v_lshl_add_u32 v14, v14, 12, v15
  s_lshl_b32 s94, s44, 10
  s_sub_u32 s94, AL-k3_main_kernel+((G3S-AL+4095)/4096)*4096, s94
  s_add_u32 s94, s92, s94
  s_addc_u32 s95, s93, 0
  global_load_dword a252, v14, s[94:95]
  v_and_b32 v29, 0xffff0000, v156
  v_lshlrev_b32 v30, 16, v157
  v_and_b32 v31, 0xffff0000, v157
  v_mul_f32 v20, v188, v28
  v_mul_f32 v21, v188, v29
  v_mul_f32 v22, v188, v30
  s_add_u32 s50, s79, 5
  s_and_b32 s50, s50, 7
  s_lshl_b32 s50, s50, 18
  s_add_u32 m0, s73, 81920
  s_nop 0
  buffer_load_dwordx4 v216, s[12:15], s50 offen offset:0 lds
  v_mul_f32 v23, v188, v31
  v_lshlrev_b32 v28, 16, v158
  v_and_b32 v29, 0xffff0000, v158
  v_lshlrev_b32 v30, 16, v159
  v_and_b32 v31, 0xffff0000, v159
  v_mul_f32 v24, v188, v28
  buffer_load_dwordx4 v217, s[12:15], s50 offen offset:1024 lds
  v_mul_f32 v25, v188, v29
  v_mul_f32 v26, v188, v30
  v_mul_f32 v27, v188, v31
  v_lshlrev_b32 v28, 16, v160
  v_and_b32 v29, 0xffff0000, v160
  v_lshlrev_b32 v30, 16, v161
Ha1_1:
  s_cbranch_execz Ra
  buffer_load_dwordx4 v218, s[12:15], s50 offen offset:2048 lds
  v_and_b32 v31, 0xffff0000, v161
  v_fmac_f32 v20, v189, v28
  v_fmac_f32 v21, v189, v29
  v_fmac_f32 v22, v189, v30
  v_fmac_f32 v23, v189, v31
  v_lshlrev_b32 v28, 16, v162
  buffer_load_dwordx4 v219, s[12:15], s50 offen offset:3072 lds
  v_and_b32 v29, 0xffff0000, v162
  v_lshlrev_b32 v30, 16, v163
  v_and_b32 v31, 0xffff0000, v163
  v_fmac_f32 v24, v189, v28
  v_fmac_f32 v25, v189, v29
  v_fmac_f32 v26, v189, v30
  s_add_u32 s50, s79, 6
  s_and_b32 s50, s50, 7
  s_lshl_b32 s50, s50, 18
  s_add_u32 m0, s73, 98304
  s_nop 0
  buffer_load_dwordx4 v216, s[12:15], s50 offen offset:0 lds
  v_fmac_f32 v27, v189, v31
  v_lshlrev_b32 v28, 16, v164
  v_and_b32 v29, 0xffff0000, v164
  v_lshlrev_b32 v30, 16, v165
  v_and_b32 v31, 0xffff0000, v165
  v_fmac_f32 v20, v190, v28
  buffer_load_dwordx4 v217, s[12:15], s50 offen offset:1024 lds
  v_fmac_f32 v21, v190, v29
  v_fmac_f32 v22, v190, v30
  v_fmac_f32 v23, v190, v31
  v_lshlrev_b32 v28, 16, v166
  v_and_b32 v29, 0xffff0000, v166
  v_lshlrev_b32 v30, 16, v167
  buffer_load_dwordx4 v218, s[12:15], s50 offen offset:2048 lds
  v_and_b32 v31, 0xffff0000, v167
  v_fmac_f32 v24, v190, v28
  v_fmac_f32 v25, v190, v29
  v_fmac_f32 v26, v190, v30
  v_fmac_f32 v27, v190, v31
  v_lshlrev_b32 v28, 16, v168
  buffer_load_dwordx4 v219, s[12:15], s50 offen offset:3072 lds
  v_and_b32 v29, 0xffff0000, v168
  v_lshlrev_b32 v30, 16, v169
  v_and_b32 v31, 0xffff0000, v169
  v_fmac_f32 v20, v191, v28
  v_fmac_f32 v21, v191, v29
  v_fmac_f32 v22, v191, v30
  s_add_u32 s50, s79, 7
  s_and_b32 s50, s50, 7
  s_lshl_b32 s50, s50, 18
  s_add_u32 m0, s73, 114688
  s_nop 0
  buffer_load_dwordx4 v216, s[12:15], s50 offen offset:0 lds
  v_fmac_f32 v23, v191, v31
  v_lshlrev_b32 v28, 16, v170
  v_and_b32 v29, 0xffff0000, v170
  v_lshlrev_b32 v30, 16, v171
  v_and_b32 v31, 0xffff0000, v171
  v_fmac_f32 v24, v191, v28
  buffer_load_dwordx4 v217, s[12:15], s50 offen offset:1024 lds
  v_fmac_f32 v25, v191, v29
  v_fmac_f32 v26, v191, v30
  v_fmac_f32 v27, v191, v31
  v_lshlrev_b32 v28, 16, v172
  v_and_b32 v29, 0xffff0000, v172
  v_lshlrev_b32 v30, 16, v173
  buffer_load_dwordx4 v218, s[12:15], s50 offen offset:2048 lds
  v_and_b32 v31, 0xffff0000, v173
  v_fmac_f32 v20, v192, v28
  v_fmac_f32 v21, v192, v29
  v_fmac_f32 v22, v192, v30
  v_fmac_f32 v23, v192, v31
  v_lshlrev_b32 v28, 16, v174
  buffer_load_dwordx4 v219, s[12:15], s50 offen offset:3072 lds
  v_and_b32 v29, 0xffff0000, v174
  v_lshlrev_b32 v30, 16, v175
  v_and_b32 v31, 0xffff0000, v175
  v_fmac_f32 v24, v192, v28
  v_fmac_f32 v25, v192, v29
  v_fmac_f32 v26, v192, v30
  s_add_u32 m0, s73, 131072
  s_nop 0
  buffer_load_dwordx4 v220, s[4:7], s72 offen offset:0 lds
  v_fmac_f32 v27, v192, v31
  v_lshlrev_b32 v28, 16, v176
  v_and_b32 v29, 0xffff0000, v176
  v_lshlrev_b32 v30, 16, v177
  v_and_b32 v31, 0xffff0000, v177
  v_fmac_f32 v20, v193, v28
  buffer_load_dwordx4 v221, s[4:7], s72 offen offset:1024 lds
  v_fmac_f32 v21, v193, v29
  v_fmac_f32 v22, v193, v30
  v_fmac_f32 v23, v193, v31
  v_lshlrev_b32 v28, 16, v178
  v_and_b32 v29, 0xffff0000, v178
  v_lshlrev_b32 v30, 16, v179
  s_add_u32 m0, s73, 133120
  s_add_u32 s48, s72, 32768
  buffer_load_dwordx4 v220, s[4:7], s48 offen offset:0 lds
  v_and_b32 v31, 0xffff0000, v179
  v_fmac_f32 v24, v193, v28
  v_fmac_f32 v25, v193, v29
  v_fmac_f32 v26, v193, v30
  v_fmac_f32 v27, v193, v31
  v_lshlrev_b32 v28, 16, v180
  buffer_load_dwordx4 v221, s[4:7], s48 offen offset:1024 lds
  v_and_b32 v29, 0xffff0000, v180
  v_lshlrev_b32 v30, 16, v181
  v_and_b32 v31, 0xffff0000, v181
  v_fmac_f32 v20, v194, v28
  v_fmac_f32 v21, v194, v29
  v_fmac_f32 v22, v194, v30
  v_fmac_f32 v23, v194, v31
  v_lshlrev_b32 v28, 16, v182
  v_and_b32 v29, 0xffff0000, v182
  v_lshlrev_b32 v30, 16, v183
  v_and_b32 v31, 0xffff0000, v183
  v_fmac_f32 v24, v194, v28
  v_fmac_f32 v25, v194, v29
  v_fmac_f32 v26, v194, v30
  v_fmac_f32 v27, v194, v31
  v_lshlrev_b32 v28, 16, v184
  v_and_b32 v29, 0xffff0000, v184
  v_lshlrev_b32 v30, 16, v185
  v_and_b32 v31, 0xffff0000, v185
  v_fmac_f32 v20, v195, v28
  v_fmac_f32 v21, v195, v29
  v_fmac_f32 v22, v195, v30
  v_fmac_f32 v23, v195, v31
  v_lshlrev_b32 v28, 16, v186
  v_and_b32 v29, 0xffff0000, v186
  v_lshlrev_b32 v30, 16, v187
  v_and_b32 v31, 0xffff0000, v187
  v_fmac_f32 v24, v195, v28
  v_fmac_f32 v25, v195, v29
  v_fmac_f32 v26, v195, v30
  v_fmac_f32 v27, v195, v31
  s_nop 0
  v_permlane32_swap_b32 v20, v24
  v_permlane32_swap_b32 v21, v25
  v_permlane32_swap_b32 v22, v26
  v_permlane32_swap_b32 v23, v27
  v_add_f32 v20, v20, v24
  v_add_f32 v21, v21, v25
  v_add_f32 v22, v22, v26
  v_add_f32 v23, v23, v27
  s_nop 0
  v_permlane16_swap_b32 v20, v22
  v_permlane16_swap_b32 v21, v23
  v_add_f32 v20, v20, v22
  v_add_f32 v21, v21, v23
  v_add_u32 v196, 162816, v198
  v_add_f32_dpp v20, v20, v20 row_ror:8 row_mask:0xf bank_mask:0xf
  v_add_f32_dpp v21, v21, v21 row_ror:8 row_mask:0xf bank_mask:0xf
  ds_write_b64 v197, v[20:21]
  s_lshl_b32 s45, s2, 7
  s_add_u32 s45, s45, 5341184
  s_cmp_eq_u32 s44, 0
  s_cselect_b32 s45, s45, 1073741824
  s_waitcnt lgkmcnt(0)
  s_barrier
  ds_read_b32 v200, v196 offset:0
  ds_read_b32 v201, v196 offset:256
  ds_read_b32 v202, v196 offset:512
  ds_read_b32 v203, v196 offset:768
  s_cmp_eq_u32 s44, 1
  s_cselect_b32 s48, s53, 1073741824
  s_waitcnt lgkmcnt(0)
  v_add_f32 v200, v200, v201
  v_add_f32 v202, v202, v203
  v_add_f32 v200, v200, v202
  buffer_store_dword v200, v198, s[36:39], s48 offen sc1
  ds_read_b64_tr_b16 a[80:81], v231 offset:0
  ds_read_b64_tr_b16 a[82:83], v231 offset:2048
  ds_read_b64_tr_b16 a[84:85], v231 offset:4096
  ds_read_b64_tr_b16 a[86:87], v231 offset:6144
  ds_read_b64_tr_b16 a[88:89], v232 offset:0
  ds_read_b64_tr_b16 a[90:91], v232 offset:2048
  ds_read_b64_tr_b16 a[92:93], v232 offset:4096
  ds_read_b64_tr_b16 a[94:95], v232 offset:6144
  ds_read_b64_tr_b16 a[96:97], v233 offset:0
  ds_read_b64_tr_b16 a[98:99], v233 offset:2048
  ds_read_b64_tr_b16 a[100:101], v233 offset:4096
  ds_read_b64_tr_b16 a[102:103], v233 offset:6144
  ds_read_b64_tr_b16 a[104:105], v234 offset:0
  ds_read_b64_tr_b16 a[106:107], v234 offset:2048
  ds_read_b64_tr_b16 a[108:109], v234 offset:4096
  ds_read_b64_tr_b16 a[110:111], v234 offset:6144
  ds_read_b64_tr_b16 a[112:113], v231 offset:8192
  ds_read_b64_tr_b16 a[114:115], v231 offset:10240
  ds_read_b64_tr_b16 a[116:117], v231 offset:12288
  ds_read_b64_tr_b16 a[118:119], v231 offset:14336
  ds_read_b64_tr_b16 a[120:121], v232 offset:8192
  ds_read_b64_tr_b16 a[122:123], v232 offset:10240
  ds_read_b64_tr_b16 a[124:125], v232 offset:12288
  ds_read_b64_tr_b16 a[126:127], v232 offset:14336
  ds_read_b64_tr_b16 a[128:129], v233 offset:8192
  ds_read_b64_tr_b16 a[130:131], v233 offset:10240
  ds_read_b64_tr_b16 a[132:133], v233 offset:12288
  ds_read_b64_tr_b16 a[134:135], v233 offset:14336
  ds_read_b64_tr_b16 a[136:137], v234 offset:8192
  ds_read_b64_tr_b16 a[138:139], v234 offset:10240
  ds_read_b64_tr_b16 a[140:141], v234 offset:12288
  ds_read_b64_tr_b16 a[142:143], v234 offset:14336
  s_cmp_lg_u32 s44, 0
  s_cbranch_scc1 SM2x
  s_mov_b32 s46, 60000
  s_mov_b32 s47, 5275648
SM2:
  buffer_load_dword v13, v249, s[36:39], s47 offen sc1
  s_sub_u32 s46, s46, 1
  s_cmp_eq_u32 s46, 0
  s_waitcnt vmcnt(0)
  s_cbranch_scc1 SM2x
  v_cmp_ne_u32 vcc, 1, v13
  s_nop 4
  s_cbranch_vccnz SM2
SM2x:
  s_waitcnt vmcnt(1)
  s_barrier
  s_lshl_b32 s50, s79, 13
  buffer_load_dwordx4 a[0:3], v243, s[36:39], s50 offen offset:0 sc1
  buffer_load_dwordx4 a[8:11], v243, s[36:39], s50 offen offset:2048 sc1
  buffer_load_dwordx4 a[4:7], v243, s[36:39], s50 offen offset:1024 sc1
  buffer_load_dwordx4 a[12:15], v243, s[36:39], s50 offen offset:3072 sc1
  s_add_u32 s50, s50, 4096
  s_and_b32 s50, s50, 0xffff
  buffer_load_dwordx4 a[16:19], v243, s[36:39], s50 offen offset:0 sc1
  buffer_load_dwordx4 a[20:23], v243, s[36:39], s50 offen offset:1024 sc1
  buffer_load_dwordx4 a[24:27], v243, s[36:39], s50 offen offset:2048 sc1
  buffer_load_dwordx4 a[28:31], v243, s[36:39], s50 offen offset:3072 sc1
  ds_read_b64_tr_b16 a[144:145], v231 offset:16384
  ds_read_b64_tr_b16 a[146:147], v231 offset:18432
  ds_read_b64_tr_b16 a[148:149], v231 offset:20480
  ds_read_b64_tr_b16 a[150:151], v231 offset:22528
  ds_read_b64_tr_b16 a[152:153], v232 offset:16384
  ds_read_b64_tr_b16 a[154:155], v232 offset:18432
  ds_read_b64_tr_b16 a[156:157], v232 offset:20480
  ds_read_b64_tr_b16 a[158:159], v232 offset:22528
  ds_read_b64_tr_b16 a[160:161], v233 offset:16384
  ds_read_b64_tr_b16 a[162:163], v233 offset:18432
  ds_read_b64_tr_b16 a[164:165], v233 offset:20480
  ds_read_b64_tr_b16 a[166:167], v233 offset:22528
  ds_read_b64_tr_b16 a[168:169], v234 offset:16384
  ds_read_b64_tr_b16 a[170:171], v234 offset:18432
  ds_read_b64_tr_b16 a[172:173], v234 offset:20480
  ds_read_b64_tr_b16 a[174:175], v234 offset:22528
  ds_read_b64_tr_b16 a[176:177], v231 offset:24576
  ds_read_b64_tr_b16 a[178:179], v231 offset:26624
  ds_read_b64_tr_b16 a[180:181], v231 offset:28672
  ds_read_b64_tr_b16 a[182:183], v231 offset:30720
  ds_read_b64_tr_b16 a[184:185], v232 offset:24576
  ds_read_b64_tr_b16 a[186:187], v232 offset:26624
  ds_read_b64_tr_b16 a[188:189], v232 offset:28672
  ds_read_b64_tr_b16 a[190:191], v232 offset:30720
  ds_read_b64_tr_b16 a[192:193], v233 offset:24576
  ds_read_b64_tr_b16 a[194:195], v233 offset:26624
  ds_read_b64_tr_b16 a[196:197], v233 offset:28672
  ds_read_b64_tr_b16 a[198:199], v233 offset:30720
  ds_read_b64_tr_b16 a[200:201], v234 offset:24576
  ds_read_b64_tr_b16 a[202:203], v234 offset:26624
  ds_read_b64_tr_b16 a[204:205], v234 offset:28672
  ds_read_b64_tr_b16 a[206:207], v234 offset:30720
  ds_read_b64_tr_b16 a[208:209], v231 offset:32768
  ds_read_b64_tr_b16 a[210:211], v231 offset:34816
  ds_read_b64_tr_b16 a[212:213], v231 offset:36864
  ds_read_b64_tr_b16 a[214:215], v231 offset:38912
  ds_read_b64_tr_b16 a[216:217], v232 offset:32768
  ds_read_b64_tr_b16 a[218:219], v232 offset:34816
  ds_read_b64_tr_b16 a[220:221], v232 offset:36864
  ds_read_b64_tr_b16 a[222:223], v232 offset:38912
  ds_read_b64 v[116:117], v239 offset:0
  ds_read_b64 v[118:119], v240 offset:0
  ds_read_b64 v[120:121], v241 offset:0
  ds_read_b64 v[122:123], v242 offset:0
  ds_read_b64 v[124:125], v239 offset:2048
  ds_read_b64 v[126:127], v240 offset:2048
  ds_read_b64 v[128:129], v241 offset:2048
  ds_read_b64 v[130:131], v242 offset:2048
  v_lshrrev_b32 v13, 4, v10
  v_cmp_eq_u32 vcc, 2, v13
  s_add_u32 s51, s76, 4096
  s_nop 0
  v_cndmask_b32 v13, 0, 1.0, vcc
  s_waitcnt lgkmcnt(0)
  v_lshlrev_b32 v52, 16, v116
  v_and_b32 v53, 0xffff0000, v116
  v_lshlrev_b32 v54, 16, v117
  v_and_b32 v55, 0xffff0000, v117
  v_lshlrev_b32 v56, 16, v118
  v_and_b32 v57, 0xffff0000, v118
  v_lshlrev_b32 v58, 16, v119
  v_and_b32 v59, 0xffff0000, v119
  v_lshlrev_b32 v60, 16, v120
  v_and_b32 v61, 0xffff0000, v120
  v_lshlrev_b32 v62, 16, v121
  v_and_b32 v63, 0xffff0000, v121
  v_lshlrev_b32 v64, 16, v122
  v_and_b32 v65, 0xffff0000, v122
  v_lshlrev_b32 v66, 16, v123
  v_and_b32 v67, 0xffff0000, v123
  v_lshlrev_b32 v68, 16, v124
  v_and_b32 v69, 0xffff0000, v124
  v_lshlrev_b32 v70, 16, v125
  v_and_b32 v71, 0xffff0000, v125
  v_lshlrev_b32 v72, 16, v126
  v_and_b32 v73, 0xffff0000, v126
  v_lshlrev_b32 v74, 16, v127
  v_and_b32 v75, 0xffff0000, v127
  v_lshlrev_b32 v76, 16, v128
  v_and_b32 v77, 0xffff0000, v128
  v_lshlrev_b32 v78, 16, v129
  v_and_b32 v79, 0xffff0000, v129
  v_lshlrev_b32 v80, 16, v130
  v_and_b32 v81, 0xffff0000, v130
  v_lshlrev_b32 v82, 16, v131
  v_and_b32 v83, 0xffff0000, v131
  s_waitcnt vmcnt(7) lgkmcnt(15)
  v_mfma_f32_16x16x32_bf16 v[20:23], a[80:83], a[0:3], 0
  s_waitcnt vmcnt(6)
  s_add_u32 s50, s50, 4096
  s_and_b32 s50, s50, 0xffff
  v_mfma_f32_16x16x32_bf16 v[20:23], a[84:87], a[8:11], v[20:23]
  s_waitcnt vmcnt(4)
  buffer_load_dwordx4 a[32:35], v243, s[36:39], s50 offen offset:0 sc1
  v_mfma_f32_16x16x32_bf16 v[24:27], a[84:87], a[12:15], 0
  s_waitcnt vmcnt(6)
  buffer_load_dwordx4 a[36:39], v243, s[36:39], s50 offen offset:1024 sc1
  v_mfma_f32_16x16x32_bf16 v[24:27], a[80:83], a[4:7], v[24:27]
  s_waitcnt lgkmcnt(15)
  ds_read_b64_tr_b16 a[80:81], v233 offset:32768
  ds_read_b64_tr_b16 a[82:83], v233 offset:34816
  v_mfma_f32_16x16x32_bf16 v[32:35], a[88:91], a[4:7], 0
  ds_read_b64_tr_b16 a[84:85], v233 offset:36864
  ds_read_b64_tr_b16 a[86:87], v233 offset:38912
  v_mfma_f32_16x16x32_bf16 v[32:35], a[92:95], a[12:15], v[32:35]
  buffer_load_dwordx4 a[40:43], v243, s[36:39], s50 offen offset:2048 sc1
  v_mfma_f32_16x16x32_bf16 v[28:31], a[92:95], a[8:11], 0
  buffer_load_dwordx4 a[44:47], v243, s[36:39], s50 offen offset:3072 sc1
  v_mfma_f32_16x16x32_bf16 v[28:31], a[88:91], a[0:3], v[28:31]
  s_waitcnt lgkmcnt(15)
  s_add_u32 s50, s50, 4096
  s_and_b32 s50, s50, 0xffff
  v_mfma_f32_16x16x32_bf16 v[36:39], a[96:99], a[0:3], 0
  ds_read_b64_tr_b16 a[88:89], v234 offset:32768
  ds_read_b64_tr_b16 a[90:91], v234 offset:34816
  v_mfma_f32_16x16x32_bf16 v[36:39], a[100:103], a[8:11], v[36:39]
  ds_read_b64_tr_b16 a[92:93], v234 offset:36864
  buffer_load_dwordx4 a[48:51], v243, s[36:39], s50 offen offset:0 sc1
  v_mfma_f32_16x16x32_bf16 v[40:43], a[100:103], a[12:15], 0
  ds_read_b64_tr_b16 a[94:95], v234 offset:38912
  buffer_load_dwordx4 a[52:55], v243, s[36:39], s50 offen offset:1024 sc1
  v_mfma_f32_16x16x32_bf16 v[40:43], a[96:99], a[4:7], v[40:43]
  s_waitcnt lgkmcnt(15)
  ds_read_b64_tr_b16 a[96:97], v231 offset:40960
  ds_read_b64_tr_b16 a[98:99], v231 offset:43008
  v_mfma_f32_16x16x32_bf16 v[48:51], a[104:107], a[4:7], 0
  s_mov_b32 s49, 0
  buffer_load_dwordx4 a[56:59], v243, s[36:39], s50 offen offset:2048 sc1
  ds_read_b64_tr_b16 a[100:101], v231 offset:45056
  v_mfma_f32_16x16x32_bf16 v[48:51], a[108:111], a[12:15], v[48:51]
  buffer_load_dwordx4 v[156:159], v248, s[36:39], s49 offen sc1
  s_mov_b32 s49, 24576
  v_mfma_f32_16x16x32_bf16 v[44:47], a[108:111], a[8:11], 0
  buffer_load_dwordx4 v[160:163], v248, s[36:39], s49 offen sc1
  s_mov_b32 s49, 49152
  v_mfma_f32_16x16x32_bf16 v[44:47], a[104:107], a[0:3], v[44:47]
  s_waitcnt vmcnt(9) lgkmcnt(15)
  buffer_load_dwordx4 v[164:167], v248, s[36:39], s49 offen sc1
  s_mov_b32 s49, 73728
  v_mfma_f32_16x16x32_bf16 v[20:23], a[112:115], a[16:19], v[20:23]
  buffer_load_dwordx4 v[168:171], v248, s[36:39], s49 offen sc1
  buffer_load_dwordx4 a[60:63], v243, s[36:39], s50 offen offset:3072 sc1
  v_mfma_f32_16x16x32_bf16 v[20:23], a[116:119], a[24:27], v[20:23]
  s_add_u32 s50, s50, 4096
  ds_read_b64_tr_b16 a[102:103], v231 offset:47104
  s_and_b32 s50, s50, 0xffff
  v_mfma_f32_16x16x32_bf16 v[24:27], a[116:119], a[28:31], v[24:27]
  ds_read_b64_tr_b16 a[104:105], v232 offset:40960
  buffer_load_dwordx4 a[64:67], v243, s[36:39], s50 offen offset:0 sc1
  v_mfma_f32_16x16x32_bf16 v[24:27], a[112:115], a[20:23], v[24:27]
  s_waitcnt lgkmcnt(15)
  ds_read_b64_tr_b16 a[106:107], v232 offset:43008
  ds_read_b64_tr_b16 a[108:109], v232 offset:45056
  v_mfma_f32_16x16x32_bf16 v[32:35], a[120:123], a[20:23], v[32:35]
  buffer_load_dwordx4 a[68:71], v243, s[36:39], s50 offen offset:1024 sc1
  ds_read_b64_tr_b16 a[110:111], v232 offset:47104
  v_mfma_f32_16x16x32_bf16 v[32:35], a[124:127], a[28:31], v[32:35]
  buffer_load_dwordx4 a[72:75], v243, s[36:39], s50 offen offset:2048 sc1
  ds_read_b64_tr_b16 a[112:113], v233 offset:40960
  v_mfma_f32_16x16x32_bf16 v[28:31], a[124:127], a[24:27], v[28:31]
  ds_read_b64_tr_b16 a[114:115], v233 offset:43008
  buffer_load_dwordx4 a[76:79], v243, s[36:39], s50 offen offset:3072 sc1
  v_mfma_f32_16x16x32_bf16 v[28:31], a[120:123], a[16:19], v[28:31]
  s_waitcnt lgkmcnt(15)
  s_add_u32 s50, s50, 4096
  s_and_b32 s50, s50, 0xffff
  v_mfma_f32_16x16x32_bf16 v[36:39], a[128:131], a[16:19], v[36:39]
  ds_read_b64_tr_b16 a[116:117], v233 offset:45056
  buffer_load_dwordx4 a[0:3], v243, s[36:39], s50 offen offset:0 sc1
  v_mfma_f32_16x16x32_bf16 v[36:39], a[132:135], a[24:27], v[36:39]
  ds_read_b64_tr_b16 a[118:119], v233 offset:47104
  ds_read_b64_tr_b16 a[120:121], v234 offset:40960
  v_mfma_f32_16x16x32_bf16 v[40:43], a[132:135], a[28:31], v[40:43]
  buffer_load_dwordx4 a[4:7], v243, s[36:39], s50 offen offset:1024 sc1
  ds_read_b64_tr_b16 a[122:123], v234 offset:43008
  v_mfma_f32_16x16x32_bf16 v[40:43], a[128:131], a[20:23], v[40:43]
  s_waitcnt lgkmcnt(15)
  v_mfma_f32_16x16x32_bf16 v[48:51], a[136:139], a[20:23], v[48:51]
  buffer_load_dwordx4 a[8:11], v243, s[36:39], s50 offen offset:2048 sc1
  ds_read_b64_tr_b16 a[124:125], v234 offset:45056
  v_mfma_f32_16x16x32_bf16 v[48:51], a[140:143], a[28:31], v[48:51]
  ds_read_b64_tr_b16 a[126:127], v234 offset:47104
  v_mfma_f32_16x16x32_bf16 v[44:47], a[140:143], a[24:27], v[44:47]
  buffer_load_dwordx4 a[12:15], v243, s[36:39], s50 offen offset:3072 sc1
  ds_read_b64_tr_b16 a[128:129], v231 offset:49152
  v_mfma_f32_16x16x32_bf16 v[44:47], a[136:139], a[16:19], v[44:47]
  s_waitcnt vmcnt(16) lgkmcnt(15)
  v_mfma_f32_16x16x32_bf16 v[20:23], a[144:147], a[32:35], v[20:23]
  s_add_u32 s50, s50, 4096
  s_and_b32 s50, s50, 0xffff
  ds_read_b64_tr_b16 a[130:131], v231 offset:51200
  v_mfma_f32_16x16x32_bf16 v[20:23], a[148:151], a[40:43], v[20:23]
  buffer_load_dwordx4 a[16:19], v243, s[36:39], s50 offen offset:0 sc1
  ds_read_b64_tr_b16 a[132:133], v231 offset:53248
  v_mfma_f32_16x16x32_bf16 v[24:27], a[148:151], a[44:47], v[24:27]
  ds_read_b64_tr_b16 a[134:135], v231 offset:55296
  v_mfma_f32_16x16x32_bf16 v[24:27], a[144:147], a[36:39], v[24:27]
  s_waitcnt lgkmcnt(15)
  ds_read_b64_tr_b16 a[136:137], v232 offset:49152
  v_mfma_f32_16x16x32_bf16 v[32:35], a[152:155], a[36:39], v[32:35]
  v_mfma_f32_16x16x32_bf16 v[32:35], a[156:159], a[44:47], v[32:35]
  buffer_load_dwordx4 a[20:23], v243, s[36:39], s50 offen offset:1024 sc1
  ds_read_b64_tr_b16 a[138:139], v232 offset:51200
  v_mfma_f32_16x16x32_bf16 v[28:31], a[156:159], a[40:43], v[28:31]
  ds_read_b64_tr_b16 a[140:141], v232 offset:53248
  v_mfma_f32_16x16x32_bf16 v[28:31], a[152:155], a[32:35], v[28:31]
  s_waitcnt lgkmcnt(15)
  ds_read_b64_tr_b16 a[142:143], v232 offset:55296
  v_mfma_f32_16x16x32_bf16 v[36:39], a[160:163], a[32:35], v[36:39]
  v_mfma_f32_16x16x32_bf16 v[36:39], a[164:167], a[40:43], v[36:39]
  buffer_load_dwordx4 a[24:27], v243, s[36:39], s50 offen offset:2048 sc1
  ds_read_b64_tr_b16 a[144:145], v233 offset:49152
  v_mfma_f32_16x16x32_bf16 v[40:43], a[164:167], a[44:47], v[40:43]
  ds_read_b64_tr_b16 a[146:147], v233 offset:51200
  v_mfma_f32_16x16x32_bf16 v[40:43], a[160:163], a[36:39], v[40:43]
  s_waitcnt lgkmcnt(15)
  ds_read_b64_tr_b16 a[148:149], v233 offset:53248
  v_mfma_f32_16x16x32_bf16 v[48:51], a[168:171], a[36:39], v[48:51]
  ds_read_b64_tr_b16 a[150:151], v233 offset:55296
  v_mfma_f32_16x16x32_bf16 v[48:51], a[172:175], a[44:47], v[48:51]
  buffer_load_dwordx4 a[28:31], v243, s[36:39], s50 offen offset:3072 sc1
  v_mfma_f32_16x16x32_bf16 v[44:47], a[172:175], a[40:43], v[44:47]
  ds_read_b64_tr_b16 a[152:153], v234 offset:49152
  v_mfma_f32_16x16x32_bf16 v[44:47], a[168:171], a[32:35], v[44:47]
  s_waitcnt vmcnt(12) lgkmcnt(15)
  ds_read_b64_tr_b16 a[154:155], v234 offset:51200
  v_mfma_f32_16x16x32_bf16 v[20:23], a[176:179], a[48:51], v[20:23]
  s_add_u32 s50, s50, 4096
  s_and_b32 s50, s50, 0xffff
  ds_read_b64_tr_b16 a[156:157], v234 offset:53248
  v_mfma_f32_16x16x32_bf16 v[20:23], a[180:183], a[56:59], v[20:23]
  buffer_load_dwordx4 a[32:35], v243, s[36:39], s50 offen offset:0 sc1
  v_mfma_f32_16x16x32_bf16 v[24:27], a[180:183], a[60:63], v[24:27]
  ds_read_b64_tr_b16 a[158:159], v234 offset:55296
  v_mfma_f32_16x16x32_bf16 v[24:27], a[176:179], a[52:55], v[24:27]
  s_waitcnt lgkmcnt(15)
  ds_read_b64_tr_b16 a[160:161], v231 offset:57344
  v_mfma_f32_16x16x32_bf16 v[32:35], a[184:187], a[52:55], v[32:35]
  ds_read_b64_tr_b16 a[162:163], v231 offset:59392
  v_mfma_f32_16x16x32_bf16 v[32:35], a[188:191], a[60:63], v[32:35]
  buffer_load_dwordx4 a[36:39], v243, s[36:39], s50 offen offset:1024 sc1
  ds_read_b64_tr_b16 a[164:165], v231 offset:61440
  v_mfma_f32_16x16x32_bf16 v[28:31], a[188:191], a[56:59], v[28:31]
  v_mfma_f32_16x16x32_bf16 v[28:31], a[184:187], a[48:51], v[28:31]
  s_waitcnt lgkmcnt(15)
  ds_read_b64_tr_b16 a[166:167], v231 offset:63488
  v_mfma_f32_16x16x32_bf16 v[36:39], a[192:195], a[48:51], v[36:39]
  ds_read_b64_tr_b16 a[168:169], v232 offset:57344
  v_mfma_f32_16x16x32_bf16 v[36:39], a[196:199], a[56:59], v[36:39]
  buffer_load_dwordx4 a[40:43], v243, s[36:39], s50 offen offset:2048 sc1
  ds_read_b64_tr_b16 a[170:171], v232 offset:59392
  v_mfma_f32_16x16x32_bf16 v[40:43], a[196:199], a[60:63], v[40:43]
  v_mfma_f32_16x16x32_bf16 v[40:43], a[192:195], a[52:55], v[40:43]
  s_waitcnt lgkmcnt(15)
  ds_read_b64_tr_b16 a[172:173], v232 offset:61440
  v_mfma_f32_16x16x32_bf16 v[48:51], a[200:203], a[52:55], v[48:51]
  ds_read_b64_tr_b16 a[174:175], v232 offset:63488
  v_mfma_f32_16x16x32_bf16 v[48:51], a[204:207], a[60:63], v[48:51]
  buffer_load_dwordx4 a[44:47], v243, s[36:39], s50 offen offset:3072 sc1
  ds_read_b64_tr_b16 a[176:177], v233 offset:57344
  v_mfma_f32_16x16x32_bf16 v[44:47], a[204:207], a[56:59], v[44:47]
  ds_read_b64_tr_b16 a[178:179], v233 offset:59392
  v_mfma_f32_16x16x32_bf16 v[44:47], a[200:203], a[48:51], v[44:47]
  s_waitcnt vmcnt(12) lgkmcnt(15)
  v_mfma_f32_16x16x32_bf16 v[20:23], a[208:211], a[64:67], v[20:23]
  s_add_u32 s50, s50, 4096
  s_and_b32 s50, s50, 0xffff
  ds_read_b64_tr_b16 a[180:181], v233 offset:61440
  v_mfma_f32_16x16x32_bf16 v[20:23], a[212:215], a[72:75], v[20:23]
  buffer_load_dwordx4 a[48:51], v243, s[36:39], s50 offen offset:0 sc1
  ds_read_b64_tr_b16 a[182:183], v233 offset:63488
  v_mfma_f32_16x16x32_bf16 v[24:27], a[212:215], a[76:79], v[24:27]
  ds_read_b64_tr_b16 a[184:185], v234 offset:57344
  v_mfma_f32_16x16x32_bf16 v[24:27], a[208:211], a[68:71], v[24:27]
  s_waitcnt lgkmcnt(15)
  ds_read_b64_tr_b16 a[186:187], v234 offset:59392
  v_mfma_f32_16x16x32_bf16 v[32:35], a[216:219], a[68:71], v[32:35]
  v_mfma_f32_16x16x32_bf16 v[32:35], a[220:223], a[76:79], v[32:35]
  buffer_load_dwordx4 a[52:55], v243, s[36:39], s50 offen offset:1024 sc1
  ds_read_b64_tr_b16 a[188:189], v234 offset:61440
  v_mfma_f32_16x16x32_bf16 v[28:31], a[220:223], a[72:75], v[28:31]
  ds_read_b64_tr_b16 a[190:191], v234 offset:63488
  v_mfma_f32_16x16x32_bf16 v[28:31], a[216:219], a[64:67], v[28:31]
  s_waitcnt lgkmcnt(15)
  ds_read_b64_tr_b16 a[192:193], v235 offset:0
  v_mfma_f32_16x16x32_bf16 v[36:39], a[80:83], a[64:67], v[36:39]
  v_mfma_f32_16x16x32_bf16 v[36:39], a[84:87], a[72:75], v[36:39]
  buffer_load_dwordx4 a[56:59], v243, s[36:39], s50 offen offset:2048 sc1
  ds_read_b64_tr_b16 a[194:195], v235 offset:2048
  v_mfma_f32_16x16x32_bf16 v[40:43], a[84:87], a[76:79], v[40:43]
  ds_read_b64_tr_b16 a[196:197], v235 offset:4096
  v_mfma_f32_16x16x32_bf16 v[40:43], a[80:83], a[68:71], v[40:43]
  s_waitcnt lgkmcnt(15)
  ds_read_b64_tr_b16 a[198:199], v235 offset:6144
  v_mfma_f32_16x16x32_bf16 v[48:51], a[88:91], a[68:71], v[48:51]
  ds_read_b64_tr_b16 a[200:201], v236 offset:0
  v_mfma_f32_16x16x32_bf16 v[48:51], a[92:95], a[76:79], v[48:51]
  buffer_load_dwordx4 a[60:63], v243, s[36:39], s50 offen offset:3072 sc1
  v_mfma_f32_16x16x32_bf16 v[44:47], a[92:95], a[72:75], v[44:47]
  ds_read_b64_tr_b16 a[202:203], v236 offset:2048
  v_mfma_f32_16x16x32_bf16 v[44:47], a[88:91], a[64:67], v[44:47]
  s_waitcnt vmcnt(12) lgkmcnt(15)
  ds_read_b64_tr_b16 a[204:205], v236 offset:4096
  v_mfma_f32_16x16x32_bf16 v[20:23], a[96:99], a[0:3], v[20:23]
  s_add_u32 s50, s50, 4096
  s_and_b32 s50, s50, 0xffff
  ds_read_b64_tr_b16 a[206:207], v236 offset:6144
  v_mfma_f32_16x16x32_bf16 v[20:23], a[100:103], a[8:11], v[20:23]
  buffer_load_dwordx4 a[64:67], v243, s[36:39], s50 offen offset:0 sc1
  v_mfma_f32_16x16x32_bf16 v[24:27], a[100:103], a[12:15], v[24:27]
  ds_read_b64_tr_b16 a[208:209], v237 offset:0
  v_mfma_f32_16x16x32_bf16 v[24:27], a[96:99], a[4:7], v[24:27]
  s_waitcnt lgkmcnt(15)
  ds_read_b64_tr_b16 a[210:211], v237 offset:2048
  v_mfma_f32_16x16x32_bf16 v[32:35], a[104:107], a[4:7], v[32:35]
  ds_read_b64_tr_b16 a[212:213], v237 offset:4096
  v_mfma_f32_16x16x32_bf16 v[32:35], a[108:111], a[12:15], v[32:35]
  buffer_load_dwordx4 a[68:71], v243, s[36:39], s50 offen offset:1024 sc1
  ds_read_b64_tr_b16 a[214:215], v237 offset:6144
  v_mfma_f32_16x16x32_bf16 v[28:31], a[108:111], a[8:11], v[28:31]
  v_mfma_f32_16x16x32_bf16 v[28:31], a[104:107], a[0:3], v[28:31]
  s_waitcnt lgkmcnt(15)
  ds_read_b64_tr_b16 a[216:217], v238 offset:0
  v_mfma_f32_16x16x32_bf16 v[36:39], a[112:115], a[0:3], v[36:39]
  s_waitcnt vmcnt(23)
  ds_read_b64_tr_b16 a[218:219], v238 offset:2048
  v_max_u32 v15, v156, v157
  v_mfma_f32_16x16x32_bf16 v[36:39], a[116:119], a[8:11], v[36:39]
  buffer_load_dwordx4 a[72:75], v243, s[36:39], s50 offen offset:2048 sc1
  ds_read_b64_tr_b16 a[220:221], v238 offset:4096
  v_mfma_f32_16x16x32_bf16 v[40:43], a[116:119], a[12:15], v[40:43]
  v_max3_u32 v15, v15, v158, v159
  v_max3_u32 v15, v15, v160, v161
  v_mfma_f32_16x16x32_bf16 v[40:43], a[112:115], a[4:7], v[40:43]
  s_waitcnt lgkmcnt(15)
  ds_read_b64_tr_b16 a[222:223], v238 offset:6144
  v_max3_u32 v15, v15, v162, v163
  v_mfma_f32_16x16x32_bf16 v[48:51], a[120:123], a[4:7], v[48:51]
  ds_read_b64_tr_b16 a[80:81], v235 offset:8192
  v_max3_u32 v15, v15, v164, v165
  v_mfma_f32_16x16x32_bf16 v[48:51], a[124:127], a[12:15], v[48:51]
  buffer_load_dwordx4 a[76:79], v243, s[36:39], s50 offen offset:3072 sc1
  ds_read_b64_tr_b16 a[82:83], v235 offset:10240
  v_mfma_f32_16x16x32_bf16 v[44:47], a[124:127], a[8:11], v[44:47]
  ds_read_b64_tr_b16 a[84:85], v235 offset:12288
  v_max3_u32 v15, v15, v166, v167
  v_mfma_f32_16x16x32_bf16 v[44:47], a[120:123], a[0:3], v[44:47]
  s_waitcnt vmcnt(12) lgkmcnt(15)
  v_max3_u32 v15, v15, v168, v169
  v_max3_u32 v15, v15, v170, v171
  v_mfma_f32_16x16x32_bf16 v[20:23], a[128:131], a[16:19], v[20:23]
  s_add_u32 s50, s50, 4096
  s_and_b32 s50, s50, 0xffff
  ds_read_b64_tr_b16 a[86:87], v235 offset:14336
  v_mfma_f32_16x16x32_bf16 v[20:23], a[132:135], a[24:27], v[20:23]
  buffer_load_dwordx4 a[0:3], v243, s[36:39], s50 offen offset:0 sc1
  ds_read_b64_tr_b16 a[88:89], v236 offset:8192
  v_mfma_f32_16x16x32_bf16 v[24:27], a[132:135], a[28:31], v[24:27]
  ds_read_b64_tr_b16 a[90:91], v236 offset:10240
  v_mfma_f32_16x16x32_bf16 v[24:27], a[128:131], a[20:23], v[24:27]
  s_waitcnt lgkmcnt(15)
  v_cmp_eq_u32 vcc, -1, v15
  s_nop 4
  s_cbranch_vccnz CK3s
CK3x:
  v_mfma_f32_16x16x32_bf16 v[32:35], a[136:139], a[20:23], v[32:35]
  ds_read_b64_tr_b16 a[92:93], v236 offset:12288
  v_add_f32 v156, v156, v164
  v_mfma_f32_16x16x32_bf16 v[32:35], a[140:143], a[28:31], v[32:35]
  buffer_load_dwordx4 a[4:7], v243, s[36:39], s50 offen offset:1024 sc1
  ds_read_b64_tr_b16 a[94:95], v236 offset:14336
  v_mfma_f32_16x16x32_bf16 v[28:31], a[140:143], a[24:27], v[28:31]
Ha2_1:
  s_cbranch_execz Ra
  ds_read_b64_tr_b16 a[96:97], v237 offset:8192
  v_add_f32 v157, v157, v165
  v_mfma_f32_16x16x32_bf16 v[28:31], a[136:139], a[16:19], v[28:31]
  s_waitcnt lgkmcnt(15)
  ds_read_b64_tr_b16 a[98:99], v237 offset:10240
  v_add_f32 v158, v158, v166
  v_mfma_f32_16x16x32_bf16 v[36:39], a[144:147], a[16:19], v[36:39]
  v_add_f32 v159, v159, v167
  v_add_f32 v160, v160, v168
  v_mfma_f32_16x16x32_bf16 v[36:39], a[148:151], a[24:27], v[36:39]
  buffer_load_dwordx4 a[8:11], v243, s[36:39], s50 offen offset:2048 sc1
  ds_read_b64_tr_b16 a[100:101], v237 offset:12288
  v_mfma_f32_16x16x32_bf16 v[40:43], a[148:151], a[28:31], v[40:43]
  ds_read_b64_tr_b16 a[102:103], v237 offset:14336
  v_add_f32 v161, v161, v169
  v_mfma_f32_16x16x32_bf16 v[40:43], a[144:147], a[20:23], v[40:43]
  s_waitcnt lgkmcnt(15)
  ds_read_b64_tr_b16 a[104:105], v238 offset:8192
  v_add_f32 v162, v162, v170
  v_mfma_f32_16x16x32_bf16 v[48:51], a[152:155], a[20:23], v[48:51]
  v_add_f32 v163, v163, v171
  v_add_f32 v156, v156, v160
  v_mfma_f32_16x16x32_bf16 v[48:51], a[156:159], a[28:31], v[48:51]
  buffer_load_dwordx4 a[12:15], v243, s[36:39], s50 offen offset:3072 sc1
  ds_read_b64_tr_b16 a[106:107], v238 offset:10240
  v_mfma_f32_16x16x32_bf16 v[44:47], a[156:159], a[24:27], v[44:47]
  ds_read_b64_tr_b16 a[108:109], v238 offset:12288
  v_add_f32 v157, v157, v161
  v_mfma_f32_16x16x32_bf16 v[44:47], a[152:155], a[16:19], v[44:47]
  s_waitcnt vmcnt(12) lgkmcnt(15)
  ds_read_b64_tr_b16 a[110:111], v238 offset:14336
  v_add_f32 v158, v158, v162
  v_mfma_f32_16x16x32_bf16 v[20:23], a[160:163], a[32:35], v[20:23]
  s_add_u32 s50, s50, 4096
  s_and_b32 s50, s50, 0xffff
  ds_read_b64_tr_b16 a[112:113], v235 offset:16384
  v_mfma_f32_16x16x32_bf16 v[20:23], a[164:167], a[40:43], v[20:23]
  buffer_load_dwordx4 a[16:19], v243, s[36:39], s50 offen offset:0 sc1
  v_add_f32 v159, v159, v163
  v_mfma_f32_16x16x32_bf16 v[24:27], a[164:167], a[44:47], v[24:27]
  ds_read_b64_tr_b16 a[114:115], v235 offset:18432
  v_cvt_pk_bf16_f32 v160, v156, v157
  v_mfma_f32_16x16x32_bf16 v[24:27], a[160:163], a[36:39], v[24:27]
  s_waitcnt lgkmcnt(15)
  ds_read_b64_tr_b16 a[116:117], v235 offset:20480
  v_lshlrev_b32 v156, 16, v160
  v_mfma_f32_16x16x32_bf16 v[32:35], a[168:171], a[36:39], v[32:35]
  ds_read_b64_tr_b16 a[118:119], v235 offset:22528
  v_and_b32 v157, 0xffff0000, v160
  v_mfma_f32_16x16x32_bf16 v[32:35], a[172:175], a[44:47], v[32:35]
  buffer_load_dwordx4 a[20:23], v243, s[36:39], s50 offen offset:1024 sc1
  v_cvt_pk_bf16_f32 v161, v158, v159
  v_mfma_f32_16x16x32_bf16 v[28:31], a[172:175], a[40:43], v[28:31]
  ds_read_b64_tr_b16 a[120:121], v236 offset:16384
  v_lshlrev_b32 v158, 16, v161
  v_mfma_f32_16x16x32_bf16 v[28:31], a[168:171], a[32:35], v[28:31]
  s_waitcnt lgkmcnt(15)
  ds_read_b64_tr_b16 a[122:123], v236 offset:18432
  v_and_b32 v159, 0xffff0000, v161
  v_mfma_f32_16x16x32_bf16 v[36:39], a[176:179], a[32:35], v[36:39]
  ds_read_b64_tr_b16 a[124:125], v236 offset:20480
  v_add_f32 v156, v13, v156
  v_mfma_f32_16x16x32_bf16 v[36:39], a[180:183], a[40:43], v[36:39]
  buffer_load_dwordx4 a[24:27], v243, s[36:39], s50 offen offset:2048 sc1
  ds_read_b64_tr_b16 a[126:127], v236 offset:22528
  v_mfma_f32_16x16x32_bf16 v[40:43], a[180:183], a[44:47], v[40:43]
  v_add_f32 v157, v13, v157
  v_add_f32 v158, v13, v158
  v_mfma_f32_16x16x32_bf16 v[40:43], a[176:179], a[36:39], v[40:43]
  s_waitcnt lgkmcnt(15)
  ds_read_b64_tr_b16 a[128:129], v237 offset:16384
  v_add_f32 v159, v13, v159
  v_mfma_f32_16x16x32_bf16 v[48:51], a[184:187], a[36:39], v[48:51]
  ds_read_b64_tr_b16 a[130:131], v237 offset:18432
  v_cvt_pk_bf16_f32 v160, v156, v157
  v_mfma_f32_16x16x32_bf16 v[48:51], a[188:191], a[44:47], v[48:51]
  buffer_load_dwordx4 a[28:31], v243, s[36:39], s50 offen offset:3072 sc1
  ds_read_b64_tr_b16 a[132:133], v237 offset:20480
  v_mfma_f32_16x16x32_bf16 v[44:47], a[188:191], a[40:43], v[44:47]
  ds_read_b64_tr_b16 a[134:135], v237 offset:22528
  v_lshlrev_b32 v156, 16, v160
  v_mfma_f32_16x16x32_bf16 v[44:47], a[184:187], a[32:35], v[44:47]
  s_waitcnt vmcnt(12) lgkmcnt(15)
  v_and_b32 v157, 0xffff0000, v160
  v_cvt_pk_bf16_f32 v161, v158, v159
  v_mfma_f32_16x16x32_bf16 v[20:23], a[192:195], a[48:51], v[20:23]
  s_add_u32 s50, s50, 4096
  s_and_b32 s50, s50, 0xffff
  ds_read_b64_tr_b16 a[136:137], v238 offset:16384
  v_mfma_f32_16x16x32_bf16 v[20:23], a[196:199], a[56:59], v[20:23]
  buffer_load_dwordx4 a[32:35], v243, s[36:39], s50 offen offset:0 sc1
  ds_read_b64_tr_b16 a[138:139], v238 offset:18432
  v_mfma_f32_16x16x32_bf16 v[24:27], a[196:199], a[60:63], v[24:27]
  ds_read_b64_tr_b16 a[140:141], v238 offset:20480
  v_lshlrev_b32 v158, 16, v161
  v_mfma_f32_16x16x32_bf16 v[24:27], a[192:195], a[52:55], v[24:27]
  s_waitcnt lgkmcnt(15)
  v_and_b32 v159, 0xffff0000, v161
  v_mfma_f32_16x16x32_bf16 v[32:35], a[200:203], a[52:55], v[32:35]
  ds_write_b128 v246, v[156:159]
  ds_read_b128 v[84:87], v244 offset:0
  v_mfma_f32_16x16x32_bf16 v[32:35], a[204:207], a[60:63], v[32:35]
  ds_read_b128 v[100:103], v244 offset:512
  ds_read_b128 v[88:91], v244 offset:64
  v_mfma_f32_16x16x32_bf16 v[28:31], a[204:207], a[56:59], v[28:31]
  ds_read_b128 v[104:107], v244 offset:576
  ds_read_b128 v[92:95], v244 offset:128
  v_mfma_f32_16x16x32_bf16 v[28:31], a[200:203], a[48:51], v[28:31]
  s_waitcnt lgkmcnt(15)
  ds_read_b128 v[108:111], v244 offset:640
  ds_read_b128 v[96:99], v244 offset:192
  v_mfma_f32_16x16x32_bf16 v[36:39], a[208:211], a[48:51], v[36:39]
  ds_read_b128 v[112:115], v244 offset:704
  ds_read_b128 v[116:119], v245 offset:512
  v_mfma_f32_16x16x32_bf16 v[36:39], a[212:215], a[56:59], v[36:39]
  ds_read_b128 v[120:123], v245 offset:576
  ds_read_b128 v[124:127], v245 offset:640
  v_mfma_f32_16x16x32_bf16 v[40:43], a[212:215], a[60:63], v[40:43]
  ds_read_b128 v[128:131], v245 offset:704
  ds_read_b64_tr_b16 a[142:143], v238 offset:22528
  v_mfma_f32_16x16x32_bf16 v[40:43], a[208:211], a[52:55], v[40:43]
  s_waitcnt lgkmcnt(15)
  buffer_load_dwordx4 a[36:39], v243, s[36:39], s50 offen offset:1024 sc1
  ds_read_b64_tr_b16 a[144:145], v235 offset:24576
  v_mfma_f32_16x16x32_bf16 v[48:51], a[216:219], a[52:55], v[48:51]
  ds_read_b64_tr_b16 a[146:147], v235 offset:26624
  ds_read_b64_tr_b16 a[148:149], v235 offset:28672
  v_mfma_f32_16x16x32_bf16 v[48:51], a[220:223], a[60:63], v[48:51]
  buffer_load_dwordx4 a[40:43], v243, s[36:39], s50 offen offset:2048 sc1
  ds_read_b64_tr_b16 a[150:151], v235 offset:30720
  v_mfma_f32_16x16x32_bf16 v[44:47], a[220:223], a[56:59], v[44:47]
  ds_read_b64_tr_b16 a[152:153], v236 offset:24576
  ds_read_b64_tr_b16 a[154:155], v236 offset:26624
  v_mfma_f32_16x16x32_bf16 v[44:47], a[216:219], a[48:51], v[44:47]
  s_waitcnt vmcnt(11) lgkmcnt(15)
  buffer_load_dwordx4 a[44:47], v243, s[36:39], s50 offen offset:3072 sc1
  ds_read_b64_tr_b16 a[156:157], v236 offset:28672
  v_mfma_f32_16x16x32_bf16 v[20:23], a[80:83], a[64:67], v[20:23]
  s_add_u32 s50, s50, 4096
  ds_read_b64_tr_b16 a[158:159], v236 offset:30720
  ds_read_b64_tr_b16 a[160:161], v237 offset:24576
  v_mfma_f32_16x16x32_bf16 v[20:23], a[84:87], a[72:75], v[20:23]
  s_and_b32 s50, s50, 0xffff
  ds_read_b64_tr_b16 a[162:163], v237 offset:26624
  buffer_load_dwordx4 a[48:51], v243, s[36:39], s50 offen offset:0 sc1
  v_mfma_f32_16x16x32_bf16 v[24:27], a[84:87], a[76:79], v[24:27]
  ds_read_b64_tr_b16 a[164:165], v237 offset:28672
  v_accvgpr_write_b32 a248, v156
  v_mfma_f32_16x16x32_bf16 v[24:27], a[80:83], a[68:71], v[24:27]
  s_waitcnt lgkmcnt(15)
  ds_read_b64_tr_b16 a[166:167], v237 offset:30720
  v_accvgpr_write_b32 a249, v157
  v_mfma_f32_16x16x32_bf16 v[32:35], a[88:91], a[68:71], v[32:35]
  ds_read_b64_tr_b16 a[168:169], v238 offset:24576
  v_accvgpr_write_b32 a250, v158
  v_mfma_f32_16x16x32_bf16 v[32:35], a[92:95], a[76:79], v[32:35]
  buffer_load_dwordx4 a[52:55], v243, s[36:39], s50 offen offset:1024 sc1
  v_accvgpr_write_b32 a251, v159
  v_mfma_f32_16x16x32_bf16 v[28:31], a[92:95], a[72:75], v[28:31]
  s_waitcnt lgkmcnt(14)
  ds_read_b64_tr_b16 a[170:171], v238 offset:26624
  v_cvt_pk_bf16_f32 v148, v116, v117
  v_mfma_f32_16x16x32_bf16 v[28:31], a[88:91], a[64:67], v[28:31]
  s_waitcnt lgkmcnt(15)
  ds_read_b64_tr_b16 a[172:173], v238 offset:28672
  v_cvt_pk_bf16_f32 v149, v118, v119
  v_mfma_f32_16x16x32_bf16 v[36:39], a[96:99], a[64:67], v[36:39]
  ds_read_b64_tr_b16 a[174:175], v238 offset:30720
  v_cvt_pk_bf16_f32 v150, v120, v121
  v_mfma_f32_16x16x32_bf16 v[36:39], a[100:103], a[72:75], v[36:39]
  buffer_load_dwordx4 a[56:59], v243, s[36:39], s50 offen offset:2048 sc1
  ds_read_b64_tr_b16 a[176:177], v235 offset:32768
  v_mfma_f32_16x16x32_bf16 v[40:43], a[100:103], a[76:79], v[40:43]
  v_cvt_pk_bf16_f32 v151, v122, v123
  v_cvt_pk_bf16_f32 v152, v124, v125
  v_mfma_f32_16x16x32_bf16 v[40:43], a[96:99], a[68:71], v[40:43]
  s_waitcnt lgkmcnt(15)
  ds_read_b64_tr_b16 a[178:179], v235 offset:34816
  v_cvt_pk_bf16_f32 v153, v126, v127
  v_mfma_f32_16x16x32_bf16 v[48:51], a[104:107], a[68:71], v[48:51]
  ds_read_b64_tr_b16 a[180:181], v235 offset:36864
  v_cvt_pk_bf16_f32 v154, v128, v129
  v_mfma_f32_16x16x32_bf16 v[48:51], a[108:111], a[76:79], v[48:51]
  buffer_load_dwordx4 a[60:63], v243, s[36:39], s50 offen offset:3072 sc1
  ds_read_b64_tr_b16 a[182:183], v235 offset:38912
  v_mfma_f32_16x16x32_bf16 v[44:47], a[108:111], a[72:75], v[44:47]
  v_cvt_pk_bf16_f32 v155, v130, v131
  v_mfma_f32_16x16x32_bf16 v[44:47], a[104:107], a[64:67], v[44:47]
  s_waitcnt vmcnt(12) lgkmcnt(15)
  buffer_store_dwordx4 v[148:151], v0, s[36:39], s78 offen offset:0 sc1
  buffer_store_dwordx4 v[152:155], v0, s[36:39], s78 offen offset:1024 sc1
  v_mfma_f32_16x16x32_bf16 v[20:23], a[112:115], a[0:3], v[20:23]
  s_add_u32 s50, s50, 4096
  ds_read_b64_tr_b16 a[184:185], v236 offset:32768
  s_and_b32 s50, s50, 0xffff
  v_mfma_f32_16x16x32_bf16 v[20:23], a[116:119], a[8:11], v[20:23]
  ds_read_b64_tr_b16 a[186:187], v236 offset:34816
  buffer_load_dwordx4 a[64:67], v243, s[36:39], s50 offen offset:0 sc1
  v_mfma_f32_16x16x32_bf16 v[24:27], a[116:119], a[12:15], v[24:27]
  ds_read_b64_tr_b16 a[188:189], v236 offset:36864
  ds_read_b64_tr_b16 a[190:191], v236 offset:38912
  v_mfma_f32_16x16x32_bf16 v[24:27], a[112:115], a[4:7], v[24:27]
  s_waitcnt lgkmcnt(15)
  v_mfma_f32_16x16x32_bf16 v[32:35], a[120:123], a[4:7], v[32:35]
  ds_read_b64_tr_b16 a[192:193], v237 offset:32768
  v_mfma_f32_16x16x32_bf16 v[32:35], a[124:127], a[12:15], v[32:35]
  buffer_load_dwordx4 a[68:71], v243, s[36:39], s50 offen offset:1024 sc1
  ds_read_b64_tr_b16 a[194:195], v237 offset:34816
  v_mfma_f32_16x16x32_bf16 v[28:31], a[124:127], a[8:11], v[28:31]
  ds_read_b64_tr_b16 a[196:197], v237 offset:36864
  v_mfma_f32_16x16x32_bf16 v[28:31], a[120:123], a[0:3], v[28:31]
  s_waitcnt lgkmcnt(15)
  v_mfma_f32_16x16x32_bf16 v[36:39], a[128:131], a[0:3], v[36:39]
  ds_read_b64_tr_b16 a[198:199], v237 offset:38912
  v_mfma_f32_16x16x32_bf16 v[36:39], a[132:135], a[8:11], v[36:39]
  buffer_load_dwordx4 a[72:75], v243, s[36:39], s50 offen offset:2048 sc1
  ds_read_b64_tr_b16 a[200:201], v238 offset:32768
  v_mfma_f32_16x16x32_bf16 v[40:43], a[132:135], a[12:15], v[40:43]
  ds_read_b64_tr_b16 a[202:203], v238 offset:34816
  v_mfma_f32_16x16x32_bf16 v[40:43], a[128:131], a[4:7], v[40:43]
  s_waitcnt lgkmcnt(15)
  ds_read_b64_tr_b16 a[204:205], v238 offset:36864
  v_mfma_f32_16x16x32_bf16 v[48:51], a[136:139], a[4:7], v[48:51]
  v_mfma_f32_16x16x32_bf16 v[48:51], a[140:143], a[12:15], v[48:51]
  buffer_load_dwordx4 a[76:79], v243, s[36:39], s50 offen offset:3072 sc1
  ds_read_b64_tr_b16 a[206:207], v238 offset:38912
  v_mfma_f32_16x16x32_bf16 v[44:47], a[140:143], a[8:11], v[44:47]
  ds_read_b64_tr_b16 a[208:209], v235 offset:40960
  v_mfma_f32_16x16x32_bf16 v[44:47], a[136:139], a[0:3], v[44:47]
  s_waitcnt vmcnt(14) lgkmcnt(15)
  ds_read_b64_tr_b16 a[210:211], v235 offset:43008
  v_mfma_f32_16x16x32_bf16 v[20:23], a[144:147], a[16:19], v[20:23]
  s_add_u32 s50, s50, 4096
  s_and_b32 s50, s50, 0xffff
  v_mfma_f32_16x16x32_bf16 v[20:23], a[148:151], a[24:27], v[20:23]
  buffer_load_dwordx4 a[0:3], v243, s[36:39], s50 offen offset:0 sc1
  ds_read_b64_tr_b16 a[212:213], v235 offset:45056
  v_mfma_f32_16x16x32_bf16 v[24:27], a[148:151], a[28:31], v[24:27]
  ds_read_b64_tr_b16 a[214:215], v235 offset:47104
  v_mfma_f32_16x16x32_bf16 v[24:27], a[144:147], a[20:23], v[24:27]
  s_waitcnt lgkmcnt(15)
  ds_read_b64_tr_b16 a[216:217], v236 offset:40960
  v_mfma_f32_16x16x32_bf16 v[32:35], a[152:155], a[20:23], v[32:35]
  ds_read_b64_tr_b16 a[218:219], v236 offset:43008
  v_mfma_f32_16x16x32_bf16 v[32:35], a[156:159], a[28:31], v[32:35]
  buffer_load_dwordx4 a[4:7], v243, s[36:39], s50 offen offset:1024 sc1
  v_mfma_f32_16x16x32_bf16 v[28:31], a[156:159], a[24:27], v[28:31]
  ds_read_b64_tr_b16 a[220:221], v236 offset:45056
  v_mfma_f32_16x16x32_bf16 v[28:31], a[152:155], a[16:19], v[28:31]
  s_waitcnt lgkmcnt(15)
  ds_read_b64_tr_b16 a[222:223], v236 offset:47104
  v_mfma_f32_16x16x32_bf16 v[36:39], a[160:163], a[16:19], v[36:39]
  ds_read_b64_tr_b16 a[80:81], v237 offset:40960
  v_mfma_f32_16x16x32_bf16 v[36:39], a[164:167], a[24:27], v[36:39]
  buffer_load_dwordx4 a[8:11], v243, s[36:39], s50 offen offset:2048 sc1
  ds_read_b64_tr_b16 a[82:83], v237 offset:43008
  v_mfma_f32_16x16x32_bf16 v[40:43], a[164:167], a[28:31], v[40:43]
  v_mfma_f32_16x16x32_bf16 v[40:43], a[160:163], a[20:23], v[40:43]
  s_waitcnt lgkmcnt(15)
  ds_read_b64_tr_b16 a[84:85], v237 offset:45056
  v_mfma_f32_16x16x32_bf16 v[48:51], a[168:171], a[20:23], v[48:51]
  ds_read_b64_tr_b16 a[86:87], v237 offset:47104
  v_mfma_f32_16x16x32_bf16 v[48:51], a[172:175], a[28:31], v[48:51]
  buffer_load_dwordx4 a[12:15], v243, s[36:39], s50 offen offset:3072 sc1
  ds_read_b64_tr_b16 a[88:89], v238 offset:40960
  v_mfma_f32_16x16x32_bf16 v[44:47], a[172:175], a[24:27], v[44:47]
  v_mfma_f32_16x16x32_bf16 v[44:47], a[168:171], a[16:19], v[44:47]
  s_waitcnt vmcnt(14) lgkmcnt(15)
  ds_read_b64_tr_b16 a[90:91], v238 offset:43008
  v_mfma_f32_16x16x32_bf16 v[20:23], a[176:179], a[32:35], v[20:23]
  ds_read_b64_tr_b16 a[92:93], v238 offset:45056
  v_mfma_f32_16x16x32_bf16 v[20:23], a[180:183], a[40:43], v[20:23]
  ds_read_b64_tr_b16 a[94:95], v238 offset:47104
  v_mfma_f32_16x16x32_bf16 v[24:27], a[180:183], a[44:47], v[24:27]
  ds_read_b64_tr_b16 a[96:97], v235 offset:49152
  v_mfma_f32_16x16x32_bf16 v[24:27], a[176:179], a[36:39], v[24:27]
  s_waitcnt lgkmcnt(15)
  v_mfma_f32_16x16x32_bf16 v[32:35], a[184:187], a[36:39], v[32:35]
  ds_read_b64_tr_b16 a[98:99], v235 offset:51200
  v_mfma_f32_16x16x32_bf16 v[32:35], a[188:191], a[44:47], v[32:35]
  ds_read_b64_tr_b16 a[100:101], v235 offset:53248
  v_mfma_f32_16x16x32_bf16 v[28:31], a[188:191], a[40:43], v[28:31]
  ds_read_b64_tr_b16 a[102:103], v235 offset:55296
  v_mfma_f32_16x16x32_bf16 v[28:31], a[184:187], a[32:35], v[28:31]
  s_waitcnt lgkmcnt(15)
  v_mfma_f32_16x16x32_bf16 v[36:39], a[192:195], a[32:35], v[36:39]
  ds_read_b64_tr_b16 a[104:105], v236 offset:49152
  v_mfma_f32_16x16x32_bf16 v[36:39], a[196:199], a[40:43], v[36:39]
  ds_read_b64_tr_b16 a[106:107], v236 offset:51200
  v_mfma_f32_16x16x32_bf16 v[40:43], a[196:199], a[44:47], v[40:43]
  ds_read_b64_tr_b16 a[108:109], v236 offset:53248
  v_mfma_f32_16x16x32_bf16 v[40:43], a[192:195], a[36:39], v[40:43]
  s_waitcnt lgkmcnt(15)
  ds_read_b64_tr_b16 a[110:111], v236 offset:55296
  v_mfma_f32_16x16x32_bf16 v[48:51], a[200:203], a[36:39], v[48:51]
  v_mfma_f32_16x16x32_bf16 v[48:51], a[204:207], a[44:47], v[48:51]
  ds_read_b64_tr_b16 a[112:113], v237 offset:49152
  v_mfma_f32_16x16x32_bf16 v[44:47], a[204:207], a[40:43], v[44:47]
  ds_read_b64_tr_b16 a[114:115], v237 offset:51200
  v_mfma_f32_16x16x32_bf16 v[44:47], a[200:203], a[32:35], v[44:47]
  s_waitcnt vmcnt(10) lgkmcnt(15)
  ds_read_b64_tr_b16 a[116:117], v237 offset:53248
  v_mfma_f32_16x16x32_bf16 v[20:23], a[208:211], a[48:51], v[20:23]
  v_mfma_f32_16x16x32_bf16 v[20:23], a[212:215], a[56:59], v[20:23]
  ds_read_b64_tr_b16 a[118:119], v237 offset:55296
  v_mfma_f32_16x16x32_bf16 v[24:27], a[212:215], a[60:63], v[24:27]
  ds_read_b64_tr_b16 a[120:121], v238 offset:49152
  v_mfma_f32_16x16x32_bf16 v[24:27], a[208:211], a[52:55], v[24:27]
  s_waitcnt lgkmcnt(15)
  ds_read_b64_tr_b16 a[122:123], v238 offset:51200
  v_mfma_f32_16x16x32_bf16 v[32:35], a[216:219], a[52:55], v[32:35]
  ds_read_b64_tr_b16 a[124:125], v238 offset:53248
  v_mfma_f32_16x16x32_bf16 v[32:35], a[220:223], a[60:63], v[32:35]
  v_mfma_f32_16x16x32_bf16 v[28:31], a[220:223], a[56:59], v[28:31]
  ds_read_b64_tr_b16 a[126:127], v238 offset:55296
  v_mfma_f32_16x16x32_bf16 v[28:31], a[216:219], a[48:51], v[28:31]
  s_waitcnt lgkmcnt(15)
  ds_read_b64_tr_b16 a[128:129], v235 offset:57344
  v_mfma_f32_16x16x32_bf16 v[36:39], a[80:83], a[48:51], v[36:39]
  ds_read_b64_tr_b16 a[130:131], v235 offset:59392
  v_mfma_f32_16x16x32_bf16 v[36:39], a[84:87], a[56:59], v[36:39]
  v_mfma_f32_16x16x32_bf16 v[40:43], a[84:87], a[60:63], v[40:43]
  ds_read_b64_tr_b16 a[132:133], v235 offset:61440
  v_mfma_f32_16x16x32_bf16 v[40:43], a[80:83], a[52:55], v[40:43]
  s_waitcnt lgkmcnt(15)
  ds_read_b64_tr_b16 a[134:135], v235 offset:63488
  v_mfma_f32_16x16x32_bf16 v[48:51], a[88:91], a[52:55], v[48:51]
  ds_read_b64_tr_b16 a[136:137], v236 offset:57344
  v_mfma_f32_16x16x32_bf16 v[48:51], a[92:95], a[60:63], v[48:51]
  ds_read_b64_tr_b16 a[138:139], v236 offset:59392
  v_mfma_f32_16x16x32_bf16 v[44:47], a[92:95], a[56:59], v[44:47]
  v_mfma_f32_16x16x32_bf16 v[44:47], a[88:91], a[48:51], v[44:47]
  s_waitcnt vmcnt(4) lgkmcnt(15)
  ds_read_b64_tr_b16 a[140:141], v236 offset:61440
  v_mfma_f32_16x16x32_bf16 v[20:23], a[96:99], a[64:67], v[20:23]
  ds_read_b64_tr_b16 a[142:143], v236 offset:63488
  v_mfma_f32_16x16x32_bf16 v[20:23], a[100:103], a[72:75], v[20:23]
  ds_read_b64_tr_b16 a[144:145], v237 offset:57344
  v_mfma_f32_16x16x32_bf16 v[24:27], a[100:103], a[76:79], v[24:27]
  v_mfma_f32_16x16x32_bf16 v[24:27], a[96:99], a[68:71], v[24:27]
  s_waitcnt lgkmcnt(15)
  ds_read_b64_tr_b16 a[146:147], v237 offset:59392
  v_mfma_f32_16x16x32_bf16 v[32:35], a[104:107], a[68:71], v[32:35]
  ds_read_b64_tr_b16 a[148:149], v237 offset:61440
  v_mfma_f32_16x16x32_bf16 v[32:35], a[108:111], a[76:79], v[32:35]
  ds_read_b64_tr_b16 a[150:151], v237 offset:63488
  v_mfma_f32_16x16x32_bf16 v[28:31], a[108:111], a[72:75], v[28:31]
  ds_read_b64_tr_b16 a[152:153], v238 offset:57344
  v_mfma_f32_16x16x32_bf16 v[28:31], a[104:107], a[64:67], v[28:31]
  s_waitcnt lgkmcnt(15)
  v_mfma_f32_16x16x32_bf16 v[36:39], a[112:115], a[64:67], v[36:39]
  ds_read_b64_tr_b16 a[154:155], v238 offset:59392
  v_mfma_f32_16x16x32_bf16 v[36:39], a[116:119], a[72:75], v[36:39]
  ds_read_b64_tr_b16 a[156:157], v238 offset:61440
  v_mfma_f32_16x16x32_bf16 v[40:43], a[116:119], a[76:79], v[40:43]
  ds_read_b64_tr_b16 a[158:159], v238 offset:63488
  v_mfma_f32_16x16x32_bf16 v[40:43], a[112:115], a[68:71], v[40:43]
  s_waitcnt lgkmcnt(15)
  v_mfma_f32_16x16x32_bf16 v[48:51], a[120:123], a[68:71], v[48:51]
  v_mfma_f32_16x16x32_bf16 v[48:51], a[124:127], a[76:79], v[48:51]
  v_mfma_f32_16x16x32_bf16 v[44:47], a[124:127], a[72:75], v[44:47]
  v_mfma_f32_16x16x32_bf16 v[44:47], a[120:123], a[64:67], v[44:47]
  s_waitcnt vmcnt(0) lgkmcnt(12)
  v_mfma_f32_16x16x32_bf16 v[20:23], a[128:131], a[0:3], v[20:23]
  v_mfma_f32_16x16x32_bf16 v[20:23], a[132:135], a[8:11], v[20:23]
  v_mfma_f32_16x16x32_bf16 v[24:27], a[132:135], a[12:15], v[24:27]
  v_mfma_f32_16x16x32_bf16 v[24:27], a[128:131], a[4:7], v[24:27]
  s_waitcnt lgkmcnt(8)
  v_mfma_f32_16x16x32_bf16 v[32:35], a[136:139], a[4:7], v[32:35]
  v_mfma_f32_16x16x32_bf16 v[32:35], a[140:143], a[12:15], v[32:35]
  v_mfma_f32_16x16x32_bf16 v[28:31], a[140:143], a[8:11], v[28:31]
  v_mfma_f32_16x16x32_bf16 v[28:31], a[136:139], a[0:3], v[28:31]
  s_waitcnt lgkmcnt(4)
  v_mfma_f32_16x16x32_bf16 v[36:39], a[144:147], a[0:3], v[36:39]
  v_mfma_f32_16x16x32_bf16 v[36:39], a[148:151], a[8:11], v[36:39]
  v_mfma_f32_16x16x32_bf16 v[40:43], a[148:151], a[12:15], v[40:43]
  v_mfma_f32_16x16x32_bf16 v[40:43], a[144:147], a[4:7], v[40:43]
  s_waitcnt lgkmcnt(0)
  v_mfma_f32_16x16x32_bf16 v[48:51], a[152:155], a[4:7], v[48:51]
  v_mfma_f32_16x16x32_bf16 v[48:51], a[156:159], a[12:15], v[48:51]
  v_mfma_f32_16x16x32_bf16 v[44:47], a[156:159], a[8:11], v[44:47]
  v_mfma_f32_16x16x32_bf16 v[44:47], a[152:155], a[0:3], v[44:47]
  s_waitcnt lgkmcnt(0)
  s_nop 2
  v_fmac_f32 v52, v84, v20
  v_fmac_f32 v53, v85, v21
  v_fmac_f32 v54, v86, v22
  v_fmac_f32 v55, v87, v23
  v_mul_f32 v20, v52, v100
  v_mul_f32 v21, v53, v101
  v_mul_f32 v22, v54, v102
  v_mul_f32 v23, v55, v103
  v_cvt_pk_bf16_f32 v132, v20, v21
  v_cvt_pk_bf16_f32 v133, v22, v23
  v_fmac_f32 v56, v88, v28
  v_fmac_f32 v57, v89, v29
  v_fmac_f32 v58, v90, v30
  v_fmac_f32 v59, v91, v31
  v_mul_f32 v28, v56, v104
  v_mul_f32 v29, v57, v105
  v_mul_f32 v30, v58, v106
  v_mul_f32 v31, v59, v107
  v_cvt_pk_bf16_f32 v134, v28, v29
  v_cvt_pk_bf16_f32 v135, v30, v31
  buffer_store_dwordx4 v[132:135], v0, s[36:39], s76 offen offset:0 sc1
  v_fmac_f32 v60, v92, v36
  v_fmac_f32 v61, v93, v37
  v_fmac_f32 v62, v94, v38
  v_fmac_f32 v63, v95, v39
  v_mul_f32 v36, v60, v108
  v_mul_f32 v37, v61, v109
  v_mul_f32 v38, v62, v110
  v_mul_f32 v39, v63, v111
  v_cvt_pk_bf16_f32 v136, v36, v37
  v_cvt_pk_bf16_f32 v137, v38, v39
  v_fmac_f32 v64, v96, v44
  v_fmac_f32 v65, v97, v45
  v_fmac_f32 v66, v98, v46
  v_fmac_f32 v67, v99, v47
  v_mul_f32 v44, v64, v112
  v_mul_f32 v45, v65, v113
  v_mul_f32 v46, v66, v114
  v_mul_f32 v47, v67, v115
  v_cvt_pk_bf16_f32 v138, v44, v45
  v_cvt_pk_bf16_f32 v139, v46, v47
  buffer_store_dwordx4 v[136:139], v0, s[36:39], s51 offen offset:0 sc1
  v_fmac_f32 v68, v84, v24
  v_fmac_f32 v69, v85, v25
  v_fmac_f32 v70, v86, v26
  v_fmac_f32 v71, v87, v27
  v_mul_f32 v24, v68, v100
  v_mul_f32 v25, v69, v101
  v_mul_f32 v26, v70, v102
  v_mul_f32 v27, v71, v103
  v_cvt_pk_bf16_f32 v140, v24, v25
  v_cvt_pk_bf16_f32 v141, v26, v27
  v_fmac_f32 v72, v88, v32
  v_fmac_f32 v73, v89, v33
  v_fmac_f32 v74, v90, v34
  v_fmac_f32 v75, v91, v35
  v_mul_f32 v32, v72, v104
  v_mul_f32 v33, v73, v105
  v_mul_f32 v34, v74, v106
  v_mul_f32 v35, v75, v107
  v_cvt_pk_bf16_f32 v142, v32, v33
  v_cvt_pk_bf16_f32 v143, v34, v35
  buffer_store_dwordx4 v[140:143], v0, s[36:39], s76 offen offset:1024 sc1
  v_fmac_f32 v76, v92, v40
  v_fmac_f32 v77, v93, v41
  v_fmac_f32 v78, v94, v42
  v_fmac_f32 v79, v95, v43
  v_mul_f32 v40, v76, v108
  v_mul_f32 v41, v77, v109
  v_mul_f32 v42, v78, v110
  v_mul_f32 v43, v79, v111
  v_cvt_pk_bf16_f32 v144, v40, v41
  v_cvt_pk_bf16_f32 v145, v42, v43
  v_fmac_f32 v80, v96, v48
  v_fmac_f32 v81, v97, v49
  v_fmac_f32 v82, v98, v50
  v_fmac_f32 v83, v99, v51
  v_mul_f32 v48, v80, v112
  v_mul_f32 v49, v81, v113
  v_mul_f32 v50, v82, v114
  v_mul_f32 v51, v83, v115
  v_cvt_pk_bf16_f32 v146, v48, v49
  v_cvt_pk_bf16_f32 v147, v50, v51
  buffer_store_dwordx4 v[144:147], v0, s[36:39], s51 offen offset:1024 sc1
  v_add_f32 v20, v52, v53
  v_mul_f32 v21, v52, v52
  v_add_f32 v24, v54, v55
  v_mul_f32 v25, v53, v53
  v_fmac_f32 v21, v54, v54
  v_fmac_f32 v25, v55, v55
  v_fmac_f32 v21, v56, v56
  v_add_f32 v20, v20, v56
  v_fmac_f32 v25, v57, v57
  v_add_f32 v24, v24, v57
  v_fmac_f32 v21, v58, v58
  v_add_f32 v20, v20, v58
  v_fmac_f32 v25, v59, v59
  v_add_f32 v24, v24, v59
  v_fmac_f32 v21, v60, v60
  v_add_f32 v20, v20, v60
  v_fmac_f32 v25, v61, v61
  v_add_f32 v24, v24, v61
  v_fmac_f32 v21, v62, v62
  v_add_f32 v20, v20, v62
  v_fmac_f32 v25, v63, v63
  v_add_f32 v24, v24, v63
  v_fmac_f32 v21, v64, v64
  v_add_f32 v20, v20, v64
  v_fmac_f32 v25, v65, v65
  v_add_f32 v24, v24, v65
  v_fmac_f32 v21, v66, v66
  v_add_f32 v20, v20, v66
  v_fmac_f32 v25, v67, v67
  v_add_f32 v24, v24, v67
  v_add_f32 v22, v68, v69
  v_mul_f32 v23, v68, v68
  v_add_f32 v26, v70, v71
  v_mul_f32 v27, v69, v69
  v_fmac_f32 v23, v70, v70
  v_fmac_f32 v27, v71, v71
  v_fmac_f32 v23, v72, v72
  v_add_f32 v22, v22, v72
  v_fmac_f32 v27, v73, v73
  v_add_f32 v26, v26, v73
  v_fmac_f32 v23, v74, v74
  v_add_f32 v22, v22, v74
  v_fmac_f32 v27, v75, v75
  v_add_f32 v26, v26, v75
  v_fmac_f32 v23, v76, v76
  v_add_f32 v22, v22, v76
  v_fmac_f32 v27, v77, v77
  v_add_f32 v26, v26, v77
  v_fmac_f32 v23, v78, v78
  v_add_f32 v22, v22, v78
  v_fmac_f32 v27, v79, v79
  v_add_f32 v26, v26, v79
  v_fmac_f32 v23, v80, v80
  v_add_f32 v22, v22, v80
  v_fmac_f32 v27, v81, v81
  v_add_f32 v26, v26, v81
  v_fmac_f32 v23, v82, v82
  v_add_f32 v22, v22, v82
  v_fmac_f32 v27, v83, v83
  v_add_f32 v26, v26, v83
  v_add_f32 v20, v20, v24
  v_add_f32 v21, v21, v25
  v_add_f32 v22, v22, v26
  v_add_f32 v23, v23, v27
  v_mov_b32 v24, v20
  v_mov_b32 v25, v21
  v_mov_b32 v26, v22
  v_mov_b32 v27, v23
  v_permlane16_swap_b32 v20, v24
  v_permlane16_swap_b32 v21, v25
  v_permlane16_swap_b32 v22, v26
  v_permlane16_swap_b32 v23, v27
  v_add_f32 v20, v20, v24
  v_add_f32 v21, v21, v25
  v_add_f32 v22, v22, v26
  v_add_f32 v23, v23, v27
  v_mov_b32 v24, v20
  v_mov_b32 v25, v21
  v_mov_b32 v26, v22
  v_mov_b32 v27, v23
  v_permlane32_swap_b32 v20, v24
  v_permlane32_swap_b32 v21, v25
  v_permlane32_swap_b32 v22, v26
  v_permlane32_swap_b32 v23, v27
  v_add_f32 v20, v20, v24
  v_add_f32 v21, v21, v25
  v_add_f32 v22, v22, v26
  v_add_f32 v23, v23, v27
  s_mov_b64 exec, 0xffff
  buffer_store_dwordx4 v[20:23], v0, s[36:39], s77 offen sc1
  s_mov_b64 exec, -1
  v_cvt_pk_bf16_f32 v116, v52, v53
  v_cvt_pk_bf16_f32 v117, v54, v55
  v_cvt_pk_bf16_f32 v118, v56, v57
  v_cvt_pk_bf16_f32 v119, v58, v59
  v_cvt_pk_bf16_f32 v120, v60, v61
  v_cvt_pk_bf16_f32 v121, v62, v63
  v_cvt_pk_bf16_f32 v122, v64, v65
  v_cvt_pk_bf16_f32 v123, v66, v67
  v_cvt_pk_bf16_f32 v124, v68, v69
  v_cvt_pk_bf16_f32 v125, v70, v71
  v_cvt_pk_bf16_f32 v126, v72, v73
  v_cvt_pk_bf16_f32 v127, v74, v75
  v_cvt_pk_bf16_f32 v128, v76, v77
  v_cvt_pk_bf16_f32 v129, v78, v79
  v_cvt_pk_bf16_f32 v130, v80, v81
  v_cvt_pk_bf16_f32 v131, v82, v83
  v_accvgpr_write_b32 a232, v116
  v_accvgpr_write_b32 a233, v117
  v_accvgpr_write_b32 a234, v118
  v_accvgpr_write_b32 a235, v119
  v_accvgpr_write_b32 a236, v120
  v_accvgpr_write_b32 a237, v121
  v_accvgpr_write_b32 a238, v122
  v_accvgpr_write_b32 a239, v123
  v_accvgpr_write_b32 a240, v124
  v_accvgpr_write_b32 a241, v125
  v_accvgpr_write_b32 a242, v126
  v_accvgpr_write_b32 a243, v127
  v_accvgpr_write_b32 a244, v128
  v_accvgpr_write_b32 a245, v129
  v_accvgpr_write_b32 a246, v130
  v_accvgpr_write_b32 a247, v131
  v_mov_b32 v12, 1
  s_waitcnt vmcnt(0) lgkmcnt(0)
  s_barrier
  s_mov_b64 exec, 1
  buffer_store_dword v12, v0, s[36:39], s45 offen sc1
  s_mov_b64 exec, -1
  s_bfe_u32 s52, s86, 0x40000
  s_mul_i32 s52, s52, 458752
  s_add_u32 m0, s88, 0
  s_nop 0
  buffer_load_dwordx4 v3, s[16:19], s52 offen offset:0 lds
  buffer_load_dwordx4 v4, s[16:19], s52 offen offset:1024 lds
  buffer_load_dwordx4 v5, s[16:19], s52 offen offset:2048 lds
  buffer_load_dwordx4 v6, s[16:19], s52 offen offset:3072 lds
  s_add_u32 m0, s88, 4096
  s_nop 0
  buffer_load_dwordx4 v7, s[16:19], s52 offen offset:0 lds
  buffer_load_dwordx4 v8, s[16:19], s52 offen offset:1024 lds
  buffer_load_dwordx4 v9, s[16:19], s52 offen offset:2048 lds
  s_bfe_u32 s52, s86, 0x40004
  s_mul_i32 s52, s52, 458752
  s_add_u32 m0, s88, 28672
  s_nop 0
  buffer_load_dwordx4 v3, s[16:19], s52 offen offset:0 lds
  buffer_load_dwordx4 v4, s[16:19], s52 offen offset:1024 lds
  buffer_load_dwordx4 v5, s[16:19], s52 offen offset:2048 lds
  buffer_load_dwordx4 v6, s[16:19], s52 offen offset:3072 lds
  s_add_u32 m0, s88, 32768
  s_nop 0
  buffer_load_dwordx4 v7, s[16:19], s52 offen offset:0 lds
  buffer_load_dwordx4 v8, s[16:19], s52 offen offset:1024 lds
  buffer_load_dwordx4 v9, s[16:19], s52 offen offset:2048 lds
  s_bfe_u32 s53, s86, 0x40000
  s_lshl_b32 s53, s53, 13
  s_add_u32 s53, s53, s89
  s_mov_b64 exec, 0
  s_cmp_eq_u32 s44, 1
  s_cbranch_scc1 Hb0
  s_cmp_eq_u32 s44, 2
Ha0_2:
  s_cbranch_execz Ra
  s_cbranch_scc1 Hb1
  s_cmp_eq_u32 s44, 3
  s_cbranch_scc1 Hb2
Rb:
  s_mov_b64 exec, -1
G3S:
  s_cmp_lg_u32 s44, 0
  s_cbranch_scc1 SM4x
  s_mov_b32 s46, 60000
  s_mov_b32 s47, 5341184
SM4:
  buffer_load_dword v13, v250, s[36:39], s47 offen sc1
  s_sub_u32 s46, s46, 1
  s_cmp_eq_u32 s46, 0
  s_waitcnt vmcnt(0)
  s_cbranch_scc1 SM4x
  v_cmp_ne_u32 vcc, 1, v13
  s_nop 4
  s_cbranch_vccnz SM4
SM4x:
  s_waitcnt vmcnt(7)
  s_barrier
  buffer_load_dwordx4 a[0:3], v0, s[36:39], s53 offen offset:0 sc1
  buffer_load_dwordx4 a[4:7], v0, s[36:39], s53 offen offset:1024 sc1
  buffer_load_dwordx4 a[8:11], v0, s[36:39], s53 offen offset:2048 sc1
  buffer_load_dwordx4 a[12:15], v0, s[36:39], s53 offen offset:3072 sc1
  s_add_u32 s53, s53, 4096
  buffer_load_dwordx4 a[16:19], v0, s[36:39], s53 offen offset:0 sc1
  buffer_load_dwordx4 a[20:23], v0, s[36:39], s53 offen offset:1024 sc1
  buffer_load_dwordx4 a[24:27], v0, s[36:39], s53 offen offset:2048 sc1
  buffer_load_dwordx4 a[28:31], v0, s[36:39], s53 offen offset:3072 sc1
  ds_read_b64_tr_b16 a[128:129], v1 offset:0
  ds_read_b64_tr_b16 a[130:131], v1 offset:3584
  ds_read_b64_tr_b16 a[132:133], v1 offset:7168
  ds_read_b64_tr_b16 a[134:135], v1 offset:10752
  ds_read_b64_tr_b16 a[136:137], v1 offset:32
  ds_read_b64_tr_b16 a[138:139], v1 offset:3616
  ds_read_b64_tr_b16 a[140:141], v1 offset:7200
  ds_read_b64_tr_b16 a[142:143], v1 offset:10784
  ds_read_b64_tr_b16 a[144:145], v1 offset:64
  ds_read_b64_tr_b16 a[146:147], v1 offset:3648
  ds_read_b64_tr_b16 a[148:149], v1 offset:7232
  ds_read_b64_tr_b16 a[150:151], v1 offset:10816
  ds_read_b64_tr_b16 a[152:153], v1 offset:96
  ds_read_b64_tr_b16 a[154:155], v1 offset:3680
  ds_read_b64_tr_b16 a[156:157], v1 offset:7264
  ds_read_b64_tr_b16 a[158:159], v1 offset:10848
  s_waitcnt vmcnt(7) lgkmcnt(8)
  v_mfma_f32_16x16x32_bf16 v[32:35], a[128:131], a[0:3], 0
  s_waitcnt vmcnt(3)
  s_bfe_u32 s53, s86, 0x40004
  s_lshl_b32 s53, s53, 13
  v_mfma_f32_16x16x32_bf16 v[32:35], a[132:135], a[16:19], v[32:35]
  s_waitcnt vmcnt(2)
  s_add_u32 s53, s53, s89
  buffer_load_dwordx4 a[32:35], v0, s[36:39], s53 offen offset:0 sc1
  v_mfma_f32_16x16x32_bf16 v[36:39], a[132:135], a[20:23], 0
  s_waitcnt vmcnt(7)
  ds_read_b64_tr_b16 a[160:161], v1 offset:128
  v_mfma_f32_16x16x32_bf16 v[36:39], a[128:131], a[4:7], v[36:39]
  s_waitcnt vmcnt(6)
  ds_read_b64_tr_b16 a[162:163], v1 offset:3712
  v_mfma_f32_16x16x32_bf16 v[40:43], a[128:131], a[8:11], 0
  s_waitcnt vmcnt(2)
  ds_read_b64_tr_b16 a[164:165], v1 offset:7296
  v_mfma_f32_16x16x32_bf16 v[40:43], a[132:135], a[24:27], v[40:43]
  s_waitcnt vmcnt(1)
  v_mfma_f32_16x16x32_bf16 v[44:47], a[132:135], a[28:31], 0
  s_waitcnt vmcnt(5)
  buffer_load_dwordx4 a[36:39], v0, s[36:39], s53 offen offset:1024 sc1
  v_mfma_f32_16x16x32_bf16 v[44:47], a[128:131], a[12:15], v[44:47]
  ds_read_b64_tr_b16 a[166:167], v1 offset:10880
  v_mfma_f32_16x16x32_bf16 v[60:63], a[136:139], a[12:15], 0
  ds_read_b64_tr_b16 a[168:169], v1 offset:160
  v_mfma_f32_16x16x32_bf16 v[60:63], a[140:143], a[28:31], v[60:63]
  v_mfma_f32_16x16x32_bf16 v[56:59], a[140:143], a[24:27], 0
  ds_read_b64_tr_b16 a[170:171], v1 offset:3744
  v_mfma_f32_16x16x32_bf16 v[56:59], a[136:139], a[8:11], v[56:59]
  buffer_load_dwordx4 a[40:43], v0, s[36:39], s53 offen offset:2048 sc1
  v_mfma_f32_16x16x32_bf16 v[52:55], a[136:139], a[4:7], 0
  ds_read_b64_tr_b16 a[172:173], v1 offset:7328
  v_mfma_f32_16x16x32_bf16 v[52:55], a[140:143], a[20:23], v[52:55]
  v_mfma_f32_16x16x32_bf16 v[48:51], a[140:143], a[16:19], 0
  ds_read_b64_tr_b16 a[174:175], v1 offset:10912
  v_mfma_f32_16x16x32_bf16 v[48:51], a[136:139], a[0:3], v[48:51]
  s_waitcnt lgkmcnt(8)
  v_mfma_f32_16x16x32_bf16 v[64:67], a[144:147], a[0:3], 0
  buffer_load_dwordx4 a[44:47], v0, s[36:39], s53 offen offset:3072 sc1
  s_bfe_u32 s52, s86, 0x40008
  v_mfma_f32_16x16x32_bf16 v[64:67], a[148:151], a[16:19], v[64:67]
  s_mul_i32 s52, s52, 458752
  s_add_u32 m0, s88, 57344
  ds_read_b64_tr_b16 a[128:129], v1 offset:192
  v_mfma_f32_16x16x32_bf16 v[68:71], a[148:151], a[20:23], 0
  ds_read_b64_tr_b16 a[130:131], v1 offset:3776
  v_mfma_f32_16x16x32_bf16 v[68:71], a[144:147], a[4:7], v[68:71]
  v_mfma_f32_16x16x32_bf16 v[72:75], a[144:147], a[8:11], 0
  ds_read_b64_tr_b16 a[132:133], v1 offset:7360
  v_mfma_f32_16x16x32_bf16 v[72:75], a[148:151], a[24:27], v[72:75]
  buffer_load_dwordx4 v3, s[16:19], s52 offen offset:0 lds
  s_add_u32 s53, s53, 4096
  v_mfma_f32_16x16x32_bf16 v[76:79], a[148:151], a[28:31], 0
  ds_read_b64_tr_b16 a[134:135], v1 offset:10944
  v_mfma_f32_16x16x32_bf16 v[76:79], a[144:147], a[12:15], v[76:79]
  v_mfma_f32_16x16x32_bf16 v[92:95], a[152:155], a[12:15], 0
  ds_read_b64_tr_b16 a[136:137], v1 offset:14336
  v_mfma_f32_16x16x32_bf16 v[92:95], a[156:159], a[28:31], v[92:95]
  v_mfma_f32_16x16x32_bf16 v[88:91], a[156:159], a[24:27], 0
  buffer_load_dwordx4 a[48:51], v0, s[36:39], s53 offen offset:0 sc1
  v_mfma_f32_16x16x32_bf16 v[88:91], a[152:155], a[8:11], v[88:91]
  ds_read_b64_tr_b16 a[138:139], v1 offset:17920
  v_mfma_f32_16x16x32_bf16 v[84:87], a[152:155], a[4:7], 0
  ds_read_b64_tr_b16 a[140:141], v1 offset:21504
  v_mfma_f32_16x16x32_bf16 v[84:87], a[156:159], a[20:23], v[84:87]
  v_mfma_f32_16x16x32_bf16 v[80:83], a[156:159], a[16:19], 0
  ds_read_b64_tr_b16 a[142:143], v1 offset:25088
  v_mfma_f32_16x16x32_bf16 v[80:83], a[152:155], a[0:3], v[80:83]
  s_waitcnt lgkmcnt(8)
  buffer_load_dwordx4 v4, s[16:19], s52 offen offset:1024 lds
  v_mfma_f32_16x16x32_bf16 v[96:99], a[160:163], a[0:3], 0
  ds_read_b64_tr_b16 a[144:145], v1 offset:14368
  v_mfma_f32_16x16x32_bf16 v[96:99], a[164:167], a[16:19], v[96:99]
  v_mfma_f32_16x16x32_bf16 v[100:103], a[164:167], a[20:23], 0
  ds_read_b64_tr_b16 a[146:147], v1 offset:17952
  v_mfma_f32_16x16x32_bf16 v[100:103], a[160:163], a[4:7], v[100:103]
  v_mfma_f32_16x16x32_bf16 v[104:107], a[160:163], a[8:11], 0
  buffer_load_dwordx4 a[52:55], v0, s[36:39], s53 offen offset:1024 sc1
  v_mfma_f32_16x16x32_bf16 v[104:107], a[164:167], a[24:27], v[104:107]
  ds_read_b64_tr_b16 a[148:149], v1 offset:21536
  v_mfma_f32_16x16x32_bf16 v[108:111], a[164:167], a[28:31], 0
  ds_read_b64_tr_b16 a[150:151], v1 offset:25120
  v_mfma_f32_16x16x32_bf16 v[108:111], a[160:163], a[12:15], v[108:111]
  v_mfma_f32_16x16x32_bf16 v[124:127], a[168:171], a[12:15], 0
  s_bfe_u32 s57, s86, 0x40018
  s_lshl4_add_u32 s57, s56, s57
  s_lshl_b32 s57, s57, 11
  v_mfma_f32_16x16x32_bf16 v[124:127], a[172:175], a[28:31], v[124:127]
  s_add_u32 s57, s57, 5767168
  buffer_load_dwordx4 v5, s[16:19], s52 offen offset:2048 lds
  s_lshr_b32 s67, s44, 1
  v_mfma_f32_16x16x32_bf16 v[120:123], a[172:175], a[24:27], 0
  s_mul_i32 s67, s67, 14336
  ds_read_b64_tr_b16 a[152:153], v1 offset:14400
  s_and_b32 s68, s44, 1
  v_mfma_f32_16x16x32_bf16 v[120:123], a[168:171], a[8:11], v[120:123]
  s_lshl_b32 s68, s68, 7
  ds_read_b64_tr_b16 a[154:155], v1 offset:17984
  s_add_u32 s67, s67, s68
  v_mfma_f32_16x16x32_bf16 v[116:119], a[168:171], a[4:7], 0
  ds_read_b64_tr_b16 a[156:157], v1 offset:21568
  v_add_u32 v31, s67, v1
  v_mfma_f32_16x16x32_bf16 v[116:119], a[172:175], a[20:23], v[116:119]
  s_lshl_b32 s60, s2, 15
  s_lshl1_add_u32 s60, s73, s60
  s_xor_b32 s62, s60, 32768
  v_mfma_f32_16x16x32_bf16 v[112:115], a[172:175], a[16:19], 0
  s_add_u32 s60, s60, 41943040
  buffer_load_dwordx4 a[56:59], v0, s[36:39], s53 offen offset:2048 sc1
  s_add_u32 s61, s60, 4096
  v_mfma_f32_16x16x32_bf16 v[112:115], a[168:171], a[0:3], v[112:115]
  s_waitcnt lgkmcnt(7)
  ds_read_b64_tr_b16 a[158:159], v1 offset:25152
  s_add_u32 s62, s62, 41943040
  v_mfma_f32_16x16x32_bf16 v[128:131], a[128:131], a[0:3], 0
  s_add_u32 s63, s62, 4096
  ds_read_b64_tr_b16 a[160:161], v1 offset:14432
  v_mfma_f32_16x16x32_bf16 v[128:131], a[132:135], a[16:19], v[128:131]
  v_mfma_f32_16x16x32_bf16 v[132:135], a[132:135], a[20:23], 0
  ds_read_b64_tr_b16 a[162:163], v1 offset:18016
  v_mfma_f32_16x16x32_bf16 v[132:135], a[128:131], a[4:7], v[132:135]
  buffer_load_dwordx4 v6, s[16:19], s52 offen offset:3072 lds
  v_mfma_f32_16x16x32_bf16 v[136:139], a[128:131], a[8:11], 0
  ds_read_b64_tr_b16 a[164:165], v1 offset:21600
  v_mfma_f32_16x16x32_bf16 v[136:139], a[132:135], a[24:27], v[136:139]
  v_mfma_f32_16x16x32_bf16 v[140:143], a[132:135], a[28:31], 0
  ds_read_b64_tr_b16 a[166:167], v1 offset:25184
  v_mfma_f32_16x16x32_bf16 v[140:143], a[128:131], a[12:15], v[140:143]
  v_mfma_f32_16x16x32_bf16 v[156:159], a[136:139], a[12:15], 0
  buffer_load_dwordx4 a[60:63], v0, s[36:39], s53 offen offset:3072 sc1
  s_add_u32 m0, s88, 61440
  v_mfma_f32_16x16x32_bf16 v[156:159], a[140:143], a[28:31], v[156:159]
  ds_read_b64_tr_b16 a[168:169], v1 offset:14464
  v_mfma_f32_16x16x32_bf16 v[152:155], a[140:143], a[24:27], 0
  ds_read_b64_tr_b16 a[170:171], v1 offset:18048
  v_mfma_f32_16x16x32_bf16 v[152:155], a[136:139], a[8:11], v[152:155]
  v_mfma_f32_16x16x32_bf16 v[148:151], a[136:139], a[4:7], 0
  ds_read_b64_tr_b16 a[172:173], v1 offset:21632
  v_mfma_f32_16x16x32_bf16 v[148:151], a[140:143], a[20:23], v[148:151]
  buffer_load_dwordx4 v7, s[16:19], s52 offen offset:0 lds
  s_bfe_u32 s53, s86, 0x40008
  v_mfma_f32_16x16x32_bf16 v[144:147], a[140:143], a[16:19], 0
  s_lshl_b32 s53, s53, 13
  s_add_u32 s53, s53, s89
  ds_read_b64_tr_b16 a[174:175], v1 offset:25216
  v_mfma_f32_16x16x32_bf16 v[144:147], a[136:139], a[0:3], v[144:147]
  s_waitcnt lgkmcnt(8)
  v_mfma_f32_16x16x32_bf16 v[160:163], a[144:147], a[0:3], 0
  ds_read_b64_tr_b16 a[128:129], v1 offset:14496
  v_mfma_f32_16x16x32_bf16 v[160:163], a[148:151], a[16:19], v[160:163]
  v_mfma_f32_16x16x32_bf16 v[164:167], a[148:151], a[20:23], 0
  buffer_load_dwordx4 a[64:67], v0, s[36:39], s53 offen offset:0 sc1
  v_mfma_f32_16x16x32_bf16 v[164:167], a[144:147], a[4:7], v[164:167]
  ds_read_b64_tr_b16 a[130:131], v1 offset:18080
  v_mfma_f32_16x16x32_bf16 v[168:171], a[144:147], a[8:11], 0
  ds_read_b64_tr_b16 a[132:133], v1 offset:21664
  v_mfma_f32_16x16x32_bf16 v[168:171], a[148:151], a[24:27], v[168:171]
  v_mfma_f32_16x16x32_bf16 v[172:175], a[148:151], a[28:31], 0
  ds_read_b64_tr_b16 a[134:135], v1 offset:25248
  v_mfma_f32_16x16x32_bf16 v[172:175], a[144:147], a[12:15], v[172:175]
  s_waitcnt vmcnt(22)
  s_barrier
  buffer_load_dwordx4 v8, s[16:19], s52 offen offset:1024 lds
  v_mfma_f32_16x16x32_bf16 v[188:191], a[152:155], a[12:15], 0
  ds_read_b64_tr_b16 a[136:137], v1 offset:14528
  v_mfma_f32_16x16x32_bf16 v[188:191], a[156:159], a[28:31], v[188:191]
  v_mfma_f32_16x16x32_bf16 v[184:187], a[156:159], a[24:27], 0
  ds_read_b64_tr_b16 a[138:139], v1 offset:18112
  v_mfma_f32_16x16x32_bf16 v[184:187], a[152:155], a[8:11], v[184:187]
  v_mfma_f32_16x16x32_bf16 v[180:183], a[152:155], a[4:7], 0
  buffer_load_dwordx4 a[68:71], v0, s[36:39], s53 offen offset:1024 sc1
  v_mfma_f32_16x16x32_bf16 v[180:183], a[156:159], a[20:23], v[180:183]
  ds_read_b64_tr_b16 a[140:141], v1 offset:21696
  v_mfma_f32_16x16x32_bf16 v[176:179], a[156:159], a[16:19], 0
  ds_read_b64_tr_b16 a[142:143], v1 offset:25280
  v_mfma_f32_16x16x32_bf16 v[176:179], a[152:155], a[0:3], v[176:179]
  s_waitcnt lgkmcnt(8)
  v_mfma_f32_16x16x32_bf16 v[192:195], a[160:163], a[0:3], 0
  ds_read_b64_tr_b16 a[144:145], v1 offset:28672
  v_mfma_f32_16x16x32_bf16 v[192:195], a[164:167], a[16:19], v[192:195]
  v_mfma_f32_16x16x32_bf16 v[196:199], a[164:167], a[20:23], 0
  ds_read_b64_tr_b16 a[146:147], v1 offset:32256
  v_mfma_f32_16x16x32_bf16 v[196:199], a[160:163], a[4:7], v[196:199]
  v_mfma_f32_16x16x32_bf16 v[200:203], a[160:163], a[8:11], 0
  ds_read_b64_tr_b16 a[148:149], v1 offset:35840
  v_mfma_f32_16x16x32_bf16 v[200:203], a[164:167], a[24:27], v[200:203]
  v_mfma_f32_16x16x32_bf16 v[204:207], a[164:167], a[28:31], 0
  buffer_load_dwordx4 v9, s[16:19], s52 offen offset:2048 lds
  v_mfma_f32_16x16x32_bf16 v[204:207], a[160:163], a[12:15], v[204:207]
  ds_read_b64_tr_b16 a[150:151], v1 offset:39424
  v_mfma_f32_16x16x32_bf16 v[220:223], a[168:171], a[12:15], 0
  ds_read_b64_tr_b16 a[152:153], v1 offset:28704
  v_mfma_f32_16x16x32_bf16 v[220:223], a[172:175], a[28:31], v[220:223]
  v_mfma_f32_16x16x32_bf16 v[216:219], a[172:175], a[24:27], 0
  ds_read_b64_tr_b16 a[154:155], v1 offset:32288
  v_mfma_f32_16x16x32_bf16 v[216:219], a[168:171], a[8:11], v[216:219]
  buffer_load_dwordx4 a[72:75], v0, s[36:39], s53 offen offset:2048 sc1
  v_mfma_f32_16x16x32_bf16 v[212:215], a[168:171], a[4:7], 0
  ds_read_b64_tr_b16 a[156:157], v1 offset:35872
  v_mfma_f32_16x16x32_bf16 v[212:215], a[172:175], a[20:23], v[212:215]
  v_mfma_f32_16x16x32_bf16 v[208:211], a[172:175], a[16:19], 0
  ds_read_b64_tr_b16 a[158:159], v1 offset:39456
  v_mfma_f32_16x16x32_bf16 v[208:211], a[168:171], a[0:3], v[208:211]
  s_waitcnt lgkmcnt(8)
  v_mfma_f32_16x16x32_bf16 v[224:227], a[128:131], a[0:3], 0
  ds_read_b64_tr_b16 a[160:161], v1 offset:28736
  v_mfma_f32_16x16x32_bf16 v[224:227], a[132:135], a[16:19], v[224:227]
  v_mfma_f32_16x16x32_bf16 v[228:231], a[132:135], a[20:23], 0
  ds_read_b64_tr_b16 a[162:163], v1 offset:32320
  v_mfma_f32_16x16x32_bf16 v[228:231], a[128:131], a[4:7], v[228:231]
  v_mfma_f32_16x16x32_bf16 v[232:235], a[128:131], a[8:11], 0
  ds_read_b64_tr_b16 a[164:165], v1 offset:35904
  v_mfma_f32_16x16x32_bf16 v[232:235], a[132:135], a[24:27], v[232:235]
  buffer_load_dwordx4 a[76:79], v0, s[36:39], s53 offen offset:3072 sc1
  v_mfma_f32_16x16x32_bf16 v[236:239], a[132:135], a[28:31], 0
  ds_read_b64_tr_b16 a[166:167], v1 offset:39488
  v_mfma_f32_16x16x32_bf16 v[236:239], a[128:131], a[12:15], v[236:239]
  v_mfma_f32_16x16x32_bf16 v[252:255], a[136:139], a[12:15], 0
  ds_read_b64_tr_b16 a[168:169], v1 offset:28768
  v_mfma_f32_16x16x32_bf16 v[252:255], a[140:143], a[28:31], v[252:255]
  s_bfe_u32 s52, s86, 0x4000c
  s_mul_i32 s52, s52, 458752
  s_add_u32 m0, s88, 86016
  v_mfma_f32_16x16x32_bf16 v[248:251], a[140:143], a[24:27], 0
  ds_read_b64_tr_b16 a[170:171], v1 offset:32352
  v_mfma_f32_16x16x32_bf16 v[248:251], a[136:139], a[8:11], v[248:251]
  v_mfma_f32_16x16x32_bf16 v[244:247], a[136:139], a[4:7], 0
  ds_read_b64_tr_b16 a[172:173], v1 offset:35936
  v_mfma_f32_16x16x32_bf16 v[244:247], a[140:143], a[20:23], v[244:247]
  buffer_load_dwordx4 v3, s[16:19], s52 offen offset:0 lds
  v_mfma_f32_16x16x32_bf16 v[240:243], a[140:143], a[16:19], 0
  ds_read_b64_tr_b16 a[174:175], v1 offset:39520
  v_mfma_f32_16x16x32_bf16 v[240:243], a[136:139], a[0:3], v[240:243]
  s_waitcnt vmcnt(8) lgkmcnt(8)
  v_mfma_f32_16x16x32_bf16 v[32:35], a[144:147], a[32:35], v[32:35]
  s_add_u32 s53, s53, 4096
  ds_read_b64_tr_b16 a[128:129], v1 offset:28800
  v_mfma_f32_16x16x32_bf16 v[32:35], a[148:151], a[48:51], v[32:35]
  v_mfma_f32_16x16x32_bf16 v[36:39], a[148:151], a[52:55], v[36:39]
  ds_read_b64_tr_b16 a[130:131], v1 offset:32384
  v_mfma_f32_16x16x32_bf16 v[36:39], a[144:147], a[36:39], v[36:39]
  v_mfma_f32_16x16x32_bf16 v[40:43], a[144:147], a[40:43], v[40:43]
  buffer_load_dwordx4 a[80:83], v0, s[36:39], s53 offen offset:0 sc1
  v_mfma_f32_16x16x32_bf16 v[40:43], a[148:151], a[56:59], v[40:43]
  ds_read_b64_tr_b16 a[132:133], v1 offset:35968
  v_mfma_f32_16x16x32_bf16 v[44:47], a[148:151], a[60:63], v[44:47]
  ds_read_b64_tr_b16 a[134:135], v1 offset:39552
  v_mfma_f32_16x16x32_bf16 v[44:47], a[144:147], a[44:47], v[44:47]
  v_mfma_f32_16x16x32_bf16 v[60:63], a[152:155], a[44:47], v[60:63]
  ds_read_b64_tr_b16 a[136:137], v1 offset:28832
  v_mfma_f32_16x16x32_bf16 v[60:63], a[156:159], a[60:63], v[60:63]
  v_mfma_f32_16x16x32_bf16 v[56:59], a[156:159], a[56:59], v[56:59]
  ds_read_b64_tr_b16 a[138:139], v1 offset:32416
  v_mfma_f32_16x16x32_bf16 v[56:59], a[152:155], a[40:43], v[56:59]
  buffer_load_dwordx4 v4, s[16:19], s52 offen offset:1024 lds
  v_mfma_f32_16x16x32_bf16 v[52:55], a[152:155], a[36:39], v[52:55]
  ds_read_b64_tr_b16 a[140:141], v1 offset:36000
  v_mfma_f32_16x16x32_bf16 v[52:55], a[156:159], a[52:55], v[52:55]
  v_mfma_f32_16x16x32_bf16 v[48:51], a[156:159], a[48:51], v[48:51]
  ds_read_b64_tr_b16 a[142:143], v1 offset:39584
  v_mfma_f32_16x16x32_bf16 v[48:51], a[152:155], a[32:35], v[48:51]
  s_waitcnt lgkmcnt(8)
  v_mfma_f32_16x16x32_bf16 v[64:67], a[160:163], a[32:35], v[64:67]
  ds_read_b64_tr_b16 a[144:145], v1 offset:28864
  v_mfma_f32_16x16x32_bf16 v[64:67], a[164:167], a[48:51], v[64:67]
  v_mfma_f32_16x16x32_bf16 v[68:71], a[164:167], a[52:55], v[68:71]
  ds_read_b64_tr_b16 a[146:147], v1 offset:32448
  v_mfma_f32_16x16x32_bf16 v[68:71], a[160:163], a[36:39], v[68:71]
  buffer_load_dwordx4 a[84:87], v0, s[36:39], s53 offen offset:1024 sc1
  v_mfma_f32_16x16x32_bf16 v[72:75], a[160:163], a[40:43], v[72:75]
  ds_read_b64_tr_b16 a[148:149], v1 offset:36032
  v_mfma_f32_16x16x32_bf16 v[72:75], a[164:167], a[56:59], v[72:75]
  v_mfma_f32_16x16x32_bf16 v[76:79], a[164:167], a[60:63], v[76:79]
  ds_read_b64_tr_b16 a[150:151], v1 offset:39616
  v_mfma_f32_16x16x32_bf16 v[76:79], a[160:163], a[44:47], v[76:79]
  v_mfma_f32_16x16x32_bf16 v[92:95], a[168:171], a[44:47], v[92:95]
  ds_read_b64_tr_b16 a[152:153], v1 offset:43008
  v_mfma_f32_16x16x32_bf16 v[92:95], a[172:175], a[60:63], v[92:95]
  v_mfma_f32_16x16x32_bf16 v[88:91], a[172:175], a[56:59], v[88:91]
  buffer_load_dwordx4 v5, s[16:19], s52 offen offset:2048 lds
  v_mfma_f32_16x16x32_bf16 v[88:91], a[168:171], a[40:43], v[88:91]
  ds_read_b64_tr_b16 a[154:155], v1 offset:46592
  v_mfma_f32_16x16x32_bf16 v[84:87], a[168:171], a[36:39], v[84:87]
  ds_read_b64_tr_b16 a[156:157], v1 offset:50176
  v_mfma_f32_16x16x32_bf16 v[84:87], a[172:175], a[52:55], v[84:87]
  v_mfma_f32_16x16x32_bf16 v[80:83], a[172:175], a[48:51], v[80:83]
  ds_read_b64_tr_b16 a[158:159], v1 offset:53760
  v_mfma_f32_16x16x32_bf16 v[80:83], a[168:171], a[32:35], v[80:83]
  s_waitcnt lgkmcnt(8)
  v_mfma_f32_16x16x32_bf16 v[96:99], a[128:131], a[32:35], v[96:99]
  ds_read_b64_tr_b16 a[160:161], v1 offset:43040
  v_mfma_f32_16x16x32_bf16 v[96:99], a[132:135], a[48:51], v[96:99]
  v_mfma_f32_16x16x32_bf16 v[100:103], a[132:135], a[52:55], v[100:103]
  buffer_load_dwordx4 a[88:91], v0, s[36:39], s53 offen offset:2048 sc1
  v_mfma_f32_16x16x32_bf16 v[100:103], a[128:131], a[36:39], v[100:103]
  ds_read_b64_tr_b16 a[162:163], v1 offset:46624
  v_mfma_f32_16x16x32_bf16 v[104:107], a[128:131], a[40:43], v[104:107]
  ds_read_b64_tr_b16 a[164:165], v1 offset:50208
  v_mfma_f32_16x16x32_bf16 v[104:107], a[132:135], a[56:59], v[104:107]
  v_mfma_f32_16x16x32_bf16 v[108:111], a[132:135], a[60:63], v[108:111]
  ds_read_b64_tr_b16 a[166:167], v1 offset:53792
  v_mfma_f32_16x16x32_bf16 v[108:111], a[128:131], a[44:47], v[108:111]
  v_mfma_f32_16x16x32_bf16 v[124:127], a[136:139], a[44:47], v[124:127]
  ds_read_b64_tr_b16 a[168:169], v1 offset:43072
  v_mfma_f32_16x16x32_bf16 v[124:127], a[140:143], a[60:63], v[124:127]
  buffer_load_dwordx4 v6, s[16:19], s52 offen offset:3072 lds
  v_mfma_f32_16x16x32_bf16 v[120:123], a[140:143], a[56:59], v[120:123]
  ds_read_b64_tr_b16 a[170:171], v1 offset:46656
  v_mfma_f32_16x16x32_bf16 v[120:123], a[136:139], a[40:43], v[120:123]
  v_mfma_f32_16x16x32_bf16 v[116:119], a[136:139], a[36:39], v[116:119]
  ds_read_b64_tr_b16 a[172:173], v1 offset:50240
  v_mfma_f32_16x16x32_bf16 v[116:119], a[140:143], a[52:55], v[116:119]
  v_mfma_f32_16x16x32_bf16 v[112:115], a[140:143], a[48:51], v[112:115]
  ds_read_b64_tr_b16 a[174:175], v1 offset:53824
  v_mfma_f32_16x16x32_bf16 v[112:115], a[136:139], a[32:35], v[112:115]
  s_waitcnt lgkmcnt(8)
  v_mfma_f32_16x16x32_bf16 v[128:131], a[144:147], a[32:35], v[128:131]
  ds_read_b64_tr_b16 a[128:129], v1 offset:43104
  v_mfma_f32_16x16x32_bf16 v[128:131], a[148:151], a[48:51], v[128:131]
  buffer_load_dwordx4 a[92:95], v0, s[36:39], s53 offen offset:3072 sc1
  v_mfma_f32_16x16x32_bf16 v[132:135], a[148:151], a[52:55], v[132:135]
  ds_read_b64_tr_b16 a[130:131], v1 offset:46688
  v_mfma_f32_16x16x32_bf16 v[132:135], a[144:147], a[36:39], v[132:135]
  v_mfma_f32_16x16x32_bf16 v[136:139], a[144:147], a[40:43], v[136:139]
  s_add_u32 m0, s88, 90112
  ds_read_b64_tr_b16 a[132:133], v1 offset:50272
  v_mfma_f32_16x16x32_bf16 v[136:139], a[148:151], a[56:59], v[136:139]
  v_mfma_f32_16x16x32_bf16 v[140:143], a[148:151], a[60:63], v[140:143]
  ds_read_b64_tr_b16 a[134:135], v1 offset:53856
  v_mfma_f32_16x16x32_bf16 v[140:143], a[144:147], a[44:47], v[140:143]
  v_mfma_f32_16x16x32_bf16 v[156:159], a[152:155], a[44:47], v[156:159]
  buffer_load_dwordx4 v7, s[16:19], s52 offen offset:0 lds
  s_bfe_u32 s53, s86, 0x4000c
  v_mfma_f32_16x16x32_bf16 v[156:159], a[156:159], a[60:63], v[156:159]
  s_lshl_b32 s53, s53, 13
  s_add_u32 s53, s53, s89
  ds_read_b64_tr_b16 a[136:137], v1 offset:43136
  v_mfma_f32_16x16x32_bf16 v[152:155], a[156:159], a[56:59], v[152:155]
  ds_read_b64_tr_b16 a[138:139], v1 offset:46720
  v_mfma_f32_16x16x32_bf16 v[152:155], a[152:155], a[40:43], v[152:155]
  v_mfma_f32_16x16x32_bf16 v[148:151], a[152:155], a[36:39], v[148:151]
  ds_read_b64_tr_b16 a[140:141], v1 offset:50304
  v_mfma_f32_16x16x32_bf16 v[148:151], a[156:159], a[52:55], v[148:151]
  buffer_load_dwordx4 a[96:99], v0, s[36:39], s53 offen offset:0 sc1
  v_mfma_f32_16x16x32_bf16 v[144:147], a[156:159], a[48:51], v[144:147]
  ds_read_b64_tr_b16 a[142:143], v1 offset:53888
  v_mfma_f32_16x16x32_bf16 v[144:147], a[152:155], a[32:35], v[144:147]
  s_waitcnt lgkmcnt(8)
  v_mfma_f32_16x16x32_bf16 v[160:163], a[160:163], a[32:35], v[160:163]
  ds_read_b64_tr_b16 a[144:145], v1 offset:43168
  v_mfma_f32_16x16x32_bf16 v[160:163], a[164:167], a[48:51], v[160:163]
  v_mfma_f32_16x16x32_bf16 v[164:167], a[164:167], a[52:55], v[164:167]
  ds_read_b64_tr_b16 a[146:147], v1 offset:46752
  v_mfma_f32_16x16x32_bf16 v[164:167], a[160:163], a[36:39], v[164:167]
  v_mfma_f32_16x16x32_bf16 v[168:171], a[160:163], a[40:43], v[168:171]
  ds_read_b64_tr_b16 a[148:149], v1 offset:50336
  v_mfma_f32_16x16x32_bf16 v[168:171], a[164:167], a[56:59], v[168:171]
  v_mfma_f32_16x16x32_bf16 v[172:175], a[164:167], a[60:63], v[172:175]
  ds_read_b64_tr_b16 a[150:151], v1 offset:53920
  v_mfma_f32_16x16x32_bf16 v[172:175], a[160:163], a[44:47], v[172:175]
  s_waitcnt vmcnt(12)
  s_barrier
  buffer_load_dwordx4 v8, s[16:19], s52 offen offset:1024 lds
  v_mfma_f32_16x16x32_bf16 v[188:191], a[168:171], a[44:47], v[188:191]
  ds_read_b64_tr_b16 a[152:153], v1 offset:43200
  v_mfma_f32_16x16x32_bf16 v[188:191], a[172:175], a[60:63], v[188:191]
  v_mfma_f32_16x16x32_bf16 v[184:187], a[172:175], a[56:59], v[184:187]
  ds_read_b64_tr_b16 a[154:155], v1 offset:46784
  v_mfma_f32_16x16x32_bf16 v[184:187], a[168:171], a[40:43], v[184:187]
  v_mfma_f32_16x16x32_bf16 v[180:183], a[168:171], a[36:39], v[180:183]
  buffer_load_dwordx4 a[100:103], v0, s[36:39], s53 offen offset:1024 sc1
  v_mfma_f32_16x16x32_bf16 v[180:183], a[172:175], a[52:55], v[180:183]
  ds_read_b64_tr_b16 a[156:157], v1 offset:50368
  v_mfma_f32_16x16x32_bf16 v[176:179], a[172:175], a[48:51], v[176:179]
  ds_read_b64_tr_b16 a[158:159], v1 offset:53952
  v_mfma_f32_16x16x32_bf16 v[176:179], a[168:171], a[32:35], v[176:179]
  s_waitcnt lgkmcnt(8)
  v_mfma_f32_16x16x32_bf16 v[192:195], a[128:131], a[32:35], v[192:195]
  ds_read_b64_tr_b16 a[160:161], v2 offset:0
  v_mfma_f32_16x16x32_bf16 v[192:195], a[132:135], a[48:51], v[192:195]
  v_mfma_f32_16x16x32_bf16 v[196:199], a[132:135], a[52:55], v[196:199]
  ds_read_b64_tr_b16 a[162:163], v2 offset:3584
  v_mfma_f32_16x16x32_bf16 v[196:199], a[128:131], a[36:39], v[196:199]
  v_mfma_f32_16x16x32_bf16 v[200:203], a[128:131], a[40:43], v[200:203]
  ds_read_b64_tr_b16 a[164:165], v2 offset:7168
  v_mfma_f32_16x16x32_bf16 v[200:203], a[132:135], a[56:59], v[200:203]
  v_mfma_f32_16x16x32_bf16 v[204:207], a[132:135], a[60:63], v[204:207]
  buffer_load_dwordx4 v9, s[16:19], s52 offen offset:2048 lds
  v_mfma_f32_16x16x32_bf16 v[204:207], a[128:131], a[44:47], v[204:207]
  ds_read_b64_tr_b16 a[166:167], v2 offset:10752
  v_mfma_f32_16x16x32_bf16 v[220:223], a[136:139], a[44:47], v[220:223]
  ds_read_b64_tr_b16 a[168:169], v2 offset:32
  v_mfma_f32_16x16x32_bf16 v[220:223], a[140:143], a[60:63], v[220:223]
  v_mfma_f32_16x16x32_bf16 v[216:219], a[140:143], a[56:59], v[216:219]
  ds_read_b64_tr_b16 a[170:171], v2 offset:3616
  v_mfma_f32_16x16x32_bf16 v[216:219], a[136:139], a[40:43], v[216:219]
  buffer_load_dwordx4 a[104:107], v0, s[36:39], s53 offen offset:2048 sc1
  v_mfma_f32_16x16x32_bf16 v[212:215], a[136:139], a[36:39], v[212:215]
  ds_read_b64_tr_b16 a[172:173], v2 offset:7200
  v_mfma_f32_16x16x32_bf16 v[212:215], a[140:143], a[52:55], v[212:215]
  v_mfma_f32_16x16x32_bf16 v[208:211], a[140:143], a[48:51], v[208:211]
  ds_read_b64_tr_b16 a[174:175], v2 offset:10784
  v_mfma_f32_16x16x32_bf16 v[208:211], a[136:139], a[32:35], v[208:211]
  s_waitcnt lgkmcnt(8)
  v_mfma_f32_16x16x32_bf16 v[224:227], a[144:147], a[32:35], v[224:227]
  ds_read_b64_tr_b16 a[128:129], v2 offset:64
  v_mfma_f32_16x16x32_bf16 v[224:227], a[148:151], a[48:51], v[224:227]
  v_mfma_f32_16x16x32_bf16 v[228:231], a[148:151], a[52:55], v[228:231]
  ds_read_b64_tr_b16 a[130:131], v2 offset:3648
  v_mfma_f32_16x16x32_bf16 v[228:231], a[144:147], a[36:39], v[228:231]
  v_mfma_f32_16x16x32_bf16 v[232:235], a[144:147], a[40:43], v[232:235]
  ds_read_b64_tr_b16 a[132:133], v2 offset:7232
  v_mfma_f32_16x16x32_bf16 v[232:235], a[148:151], a[56:59], v[232:235]
  buffer_load_dwordx4 a[108:111], v0, s[36:39], s53 offen offset:3072 sc1
  v_mfma_f32_16x16x32_bf16 v[236:239], a[148:151], a[60:63], v[236:239]
  ds_read_b64_tr_b16 a[134:135], v2 offset:10816
  v_mfma_f32_16x16x32_bf16 v[236:239], a[144:147], a[44:47], v[236:239]
  v_mfma_f32_16x16x32_bf16 v[252:255], a[152:155], a[44:47], v[252:255]
  ds_read_b64_tr_b16 a[136:137], v2 offset:96
  v_mfma_f32_16x16x32_bf16 v[252:255], a[156:159], a[60:63], v[252:255]
  s_bfe_u32 s52, s86, 0x40010
  s_mul_i32 s52, s52, 458752
  s_add_u32 m0, s88, 0
  v_mfma_f32_16x16x32_bf16 v[248:251], a[156:159], a[56:59], v[248:251]
  ds_read_b64_tr_b16 a[138:139], v2 offset:3680
  v_mfma_f32_16x16x32_bf16 v[248:251], a[152:155], a[40:43], v[248:251]
  v_mfma_f32_16x16x32_bf16 v[244:247], a[152:155], a[36:39], v[244:247]
  ds_read_b64_tr_b16 a[140:141], v2 offset:7264
  v_mfma_f32_16x16x32_bf16 v[244:247], a[156:159], a[52:55], v[244:247]
  buffer_load_dwordx4 v3, s[16:19], s52 offen offset:0 lds
  v_mfma_f32_16x16x32_bf16 v[240:243], a[156:159], a[48:51], v[240:243]
  ds_read_b64_tr_b16 a[142:143], v2 offset:10848
  v_mfma_f32_16x16x32_bf16 v[240:243], a[152:155], a[32:35], v[240:243]
  s_waitcnt vmcnt(8) lgkmcnt(8)
  v_mfma_f32_16x16x32_bf16 v[32:35], a[160:163], a[64:67], v[32:35]
  s_add_u32 s53, s53, 4096
  ds_read_b64_tr_b16 a[144:145], v2 offset:128
  v_mfma_f32_16x16x32_bf16 v[32:35], a[164:167], a[80:83], v[32:35]
  v_mfma_f32_16x16x32_bf16 v[36:39], a[164:167], a[84:87], v[36:39]
  ds_read_b64_tr_b16 a[146:147], v2 offset:3712
  v_mfma_f32_16x16x32_bf16 v[36:39], a[160:163], a[68:71], v[36:39]
  v_mfma_f32_16x16x32_bf16 v[40:43], a[160:163], a[72:75], v[40:43]
  buffer_load_dwordx4 a[112:115], v0, s[36:39], s53 offen offset:0 sc1
  v_mfma_f32_16x16x32_bf16 v[40:43], a[164:167], a[88:91], v[40:43]
  ds_read_b64_tr_b16 a[148:149], v2 offset:7296
  v_mfma_f32_16x16x32_bf16 v[44:47], a[164:167], a[92:95], v[44:47]
  ds_read_b64_tr_b16 a[150:151], v2 offset:10880
  v_mfma_f32_16x16x32_bf16 v[44:47], a[160:163], a[76:79], v[44:47]
  v_mfma_f32_16x16x32_bf16 v[60:63], a[168:171], a[76:79], v[60:63]
  ds_read_b64_tr_b16 a[152:153], v2 offset:160
  v_mfma_f32_16x16x32_bf16 v[60:63], a[172:175], a[92:95], v[60:63]
  v_mfma_f32_16x16x32_bf16 v[56:59], a[172:175], a[88:91], v[56:59]
  ds_read_b64_tr_b16 a[154:155], v2 offset:3744
  v_mfma_f32_16x16x32_bf16 v[56:59], a[168:171], a[72:75], v[56:59]
  buffer_load_dwordx4 v4, s[16:19], s52 offen offset:1024 lds
  v_mfma_f32_16x16x32_bf16 v[52:55], a[168:171], a[68:71], v[52:55]
  ds_read_b64_tr_b16 a[156:157], v2 offset:7328
  v_mfma_f32_16x16x32_bf16 v[52:55], a[172:175], a[84:87], v[52:55]
  v_mfma_f32_16x16x32_bf16 v[48:51], a[172:175], a[80:83], v[48:51]
  ds_read_b64_tr_b16 a[158:159], v2 offset:10912
  v_mfma_f32_16x16x32_bf16 v[48:51], a[168:171], a[64:67], v[48:51]
  s_waitcnt lgkmcnt(8)
  v_mfma_f32_16x16x32_bf16 v[64:67], a[128:131], a[64:67], v[64:67]
  ds_read_b64_tr_b16 a[160:161], v2 offset:192
  v_mfma_f32_16x16x32_bf16 v[64:67], a[132:135], a[80:83], v[64:67]
  v_mfma_f32_16x16x32_bf16 v[68:71], a[132:135], a[84:87], v[68:71]
  ds_read_b64_tr_b16 a[162:163], v2 offset:3776
  v_mfma_f32_16x16x32_bf16 v[68:71], a[128:131], a[68:71], v[68:71]
  buffer_load_dwordx4 a[116:119], v0, s[36:39], s53 offen offset:1024 sc1
  v_mfma_f32_16x16x32_bf16 v[72:75], a[128:131], a[72:75], v[72:75]
  ds_read_b64_tr_b16 a[164:165], v2 offset:7360
  v_mfma_f32_16x16x32_bf16 v[72:75], a[132:135], a[88:91], v[72:75]
  v_mfma_f32_16x16x32_bf16 v[76:79], a[132:135], a[92:95], v[76:79]
  ds_read_b64_tr_b16 a[166:167], v2 offset:10944
  v_mfma_f32_16x16x32_bf16 v[76:79], a[128:131], a[76:79], v[76:79]
  v_mfma_f32_16x16x32_bf16 v[92:95], a[136:139], a[76:79], v[92:95]
  ds_read_b64_tr_b16 a[168:169], v2 offset:14336
  v_mfma_f32_16x16x32_bf16 v[92:95], a[140:143], a[92:95], v[92:95]
  v_mfma_f32_16x16x32_bf16 v[88:91], a[140:143], a[88:91], v[88:91]
  buffer_load_dwordx4 v5, s[16:19], s52 offen offset:2048 lds
  v_mfma_f32_16x16x32_bf16 v[88:91], a[136:139], a[72:75], v[88:91]
  ds_read_b64_tr_b16 a[170:171], v2 offset:17920
  v_mfma_f32_16x16x32_bf16 v[84:87], a[136:139], a[68:71], v[84:87]
  ds_read_b64_tr_b16 a[172:173], v2 offset:21504
  v_mfma_f32_16x16x32_bf16 v[84:87], a[140:143], a[84:87], v[84:87]
  v_mfma_f32_16x16x32_bf16 v[80:83], a[140:143], a[80:83], v[80:83]
  ds_read_b64_tr_b16 a[174:175], v2 offset:25088
  v_mfma_f32_16x16x32_bf16 v[80:83], a[136:139], a[64:67], v[80:83]
  s_waitcnt lgkmcnt(8)
  v_mfma_f32_16x16x32_bf16 v[96:99], a[144:147], a[64:67], v[96:99]
  ds_read_b64_tr_b16 a[128:129], v2 offset:14368
  v_mfma_f32_16x16x32_bf16 v[96:99], a[148:151], a[80:83], v[96:99]
Hb0:
  s_cbranch_execz Hb0_1
  v_mfma_f32_16x16x32_bf16 v[100:103], a[148:151], a[84:87], v[100:103]
  buffer_load_dwordx4 a[120:123], v0, s[36:39], s53 offen offset:2048 sc1
  v_mfma_f32_16x16x32_bf16 v[100:103], a[144:147], a[68:71], v[100:103]
  ds_read_b64_tr_b16 a[130:131], v2 offset:17952
  v_mfma_f32_16x16x32_bf16 v[104:107], a[144:147], a[72:75], v[104:107]
  ds_read_b64_tr_b16 a[132:133], v2 offset:21536
  v_mfma_f32_16x16x32_bf16 v[104:107], a[148:151], a[88:91], v[104:107]
  v_mfma_f32_16x16x32_bf16 v[108:111], a[148:151], a[92:95], v[108:111]
  ds_read_b64_tr_b16 a[134:135], v2 offset:25120
  v_mfma_f32_16x16x32_bf16 v[108:111], a[144:147], a[76:79], v[108:111]
  v_mfma_f32_16x16x32_bf16 v[124:127], a[152:155], a[76:79], v[124:127]
  ds_read_b64_tr_b16 a[136:137], v2 offset:14400
  v_mfma_f32_16x16x32_bf16 v[124:127], a[156:159], a[92:95], v[124:127]
  buffer_load_dwordx4 v6, s[16:19], s52 offen offset:3072 lds
  v_mfma_f32_16x16x32_bf16 v[120:123], a[156:159], a[88:91], v[120:123]
  ds_read_b64_tr_b16 a[138:139], v2 offset:17984
  v_mfma_f32_16x16x32_bf16 v[120:123], a[152:155], a[72:75], v[120:123]
  v_mfma_f32_16x16x32_bf16 v[116:119], a[152:155], a[68:71], v[116:119]
  ds_read_b64_tr_b16 a[140:141], v2 offset:21568
  v_mfma_f32_16x16x32_bf16 v[116:119], a[156:159], a[84:87], v[116:119]
  v_mfma_f32_16x16x32_bf16 v[112:115], a[156:159], a[80:83], v[112:115]
  ds_read_b64_tr_b16 a[142:143], v2 offset:25152
  v_mfma_f32_16x16x32_bf16 v[112:115], a[152:155], a[64:67], v[112:115]
  s_waitcnt lgkmcnt(8)
  v_mfma_f32_16x16x32_bf16 v[128:131], a[160:163], a[64:67], v[128:131]
  ds_read_b64_tr_b16 a[144:145], v2 offset:14432
  v_mfma_f32_16x16x32_bf16 v[128:131], a[164:167], a[80:83], v[128:131]
  buffer_load_dwordx4 a[124:127], v0, s[36:39], s53 offen offset:3072 sc1
  v_mfma_f32_16x16x32_bf16 v[132:135], a[164:167], a[84:87], v[132:135]
  ds_read_b64_tr_b16 a[146:147], v2 offset:18016
  v_mfma_f32_16x16x32_bf16 v[132:135], a[160:163], a[68:71], v[132:135]
  v_mfma_f32_16x16x32_bf16 v[136:139], a[160:163], a[72:75], v[136:139]
  s_add_u32 m0, s88, 4096
  ds_read_b64_tr_b16 a[148:149], v2 offset:21600
  v_mfma_f32_16x16x32_bf16 v[136:139], a[164:167], a[88:91], v[136:139]
  v_mfma_f32_16x16x32_bf16 v[140:143], a[164:167], a[92:95], v[140:143]
  ds_read_b64_tr_b16 a[150:151], v2 offset:25184
  v_mfma_f32_16x16x32_bf16 v[140:143], a[160:163], a[76:79], v[140:143]
  v_mfma_f32_16x16x32_bf16 v[156:159], a[168:171], a[76:79], v[156:159]
  buffer_load_dwordx4 v7, s[16:19], s52 offen offset:0 lds
  s_bfe_u32 s53, s86, 0x40010
  v_mfma_f32_16x16x32_bf16 v[156:159], a[172:175], a[92:95], v[156:159]
  s_lshl_b32 s53, s53, 13
  s_add_u32 s53, s53, s89
  ds_read_b64_tr_b16 a[152:153], v2 offset:14464
  v_mfma_f32_16x16x32_bf16 v[152:155], a[172:175], a[88:91], v[152:155]
  ds_read_b64_tr_b16 a[154:155], v2 offset:18048
  v_mfma_f32_16x16x32_bf16 v[152:155], a[168:171], a[72:75], v[152:155]
  v_mfma_f32_16x16x32_bf16 v[148:151], a[168:171], a[68:71], v[148:151]
  ds_read_b64_tr_b16 a[156:157], v2 offset:21632
  v_mfma_f32_16x16x32_bf16 v[148:151], a[172:175], a[84:87], v[148:151]
  buffer_load_dwordx4 a[0:3], v0, s[36:39], s53 offen offset:0 sc1
  v_mfma_f32_16x16x32_bf16 v[144:147], a[172:175], a[80:83], v[144:147]
  ds_read_b64_tr_b16 a[158:159], v2 offset:25216
  v_mfma_f32_16x16x32_bf16 v[144:147], a[168:171], a[64:67], v[144:147]
  s_waitcnt lgkmcnt(8)
  v_mfma_f32_16x16x32_bf16 v[160:163], a[128:131], a[64:67], v[160:163]
  ds_read_b64_tr_b16 a[160:161], v2 offset:14496
  v_mfma_f32_16x16x32_bf16 v[160:163], a[132:135], a[80:83], v[160:163]
  v_mfma_f32_16x16x32_bf16 v[164:167], a[132:135], a[84:87], v[164:167]
  ds_read_b64_tr_b16 a[162:163], v2 offset:18080
  v_mfma_f32_16x16x32_bf16 v[164:167], a[128:131], a[68:71], v[164:167]
  v_mfma_f32_16x16x32_bf16 v[168:171], a[128:131], a[72:75], v[168:171]
  ds_read_b64_tr_b16 a[164:165], v2 offset:21664
  v_mfma_f32_16x16x32_bf16 v[168:171], a[132:135], a[88:91], v[168:171]
  v_mfma_f32_16x16x32_bf16 v[172:175], a[132:135], a[92:95], v[172:175]
  ds_read_b64_tr_b16 a[166:167], v2 offset:25248
  v_mfma_f32_16x16x32_bf16 v[172:175], a[128:131], a[76:79], v[172:175]
  s_waitcnt vmcnt(12)
  s_barrier
  buffer_load_dwordx4 v8, s[16:19], s52 offen offset:1024 lds
  v_mfma_f32_16x16x32_bf16 v[188:191], a[136:139], a[76:79], v[188:191]
  ds_read_b64_tr_b16 a[168:169], v2 offset:14528
  v_mfma_f32_16x16x32_bf16 v[188:191], a[140:143], a[92:95], v[188:191]
  v_mfma_f32_16x16x32_bf16 v[184:187], a[140:143], a[88:91], v[184:187]
  ds_read_b64_tr_b16 a[170:171], v2 offset:18112
  v_mfma_f32_16x16x32_bf16 v[184:187], a[136:139], a[72:75], v[184:187]
  v_mfma_f32_16x16x32_bf16 v[180:183], a[136:139], a[68:71], v[180:183]
  buffer_load_dwordx4 a[4:7], v0, s[36:39], s53 offen offset:1024 sc1
  v_mfma_f32_16x16x32_bf16 v[180:183], a[140:143], a[84:87], v[180:183]
  ds_read_b64_tr_b16 a[172:173], v2 offset:21696
  v_mfma_f32_16x16x32_bf16 v[176:179], a[140:143], a[80:83], v[176:179]
  ds_read_b64_tr_b16 a[174:175], v2 offset:25280
  v_mfma_f32_16x16x32_bf16 v[176:179], a[136:139], a[64:67], v[176:179]
  s_waitcnt lgkmcnt(8)
  v_mfma_f32_16x16x32_bf16 v[192:195], a[144:147], a[64:67], v[192:195]
  ds_read_b64_tr_b16 a[128:129], v2 offset:28672
  v_mfma_f32_16x16x32_bf16 v[192:195], a[148:151], a[80:83], v[192:195]
  v_mfma_f32_16x16x32_bf16 v[196:199], a[148:151], a[84:87], v[196:199]
  ds_read_b64_tr_b16 a[130:131], v2 offset:32256
  v_mfma_f32_16x16x32_bf16 v[196:199], a[144:147], a[68:71], v[196:199]
  v_mfma_f32_16x16x32_bf16 v[200:203], a[144:147], a[72:75], v[200:203]
  ds_read_b64_tr_b16 a[132:133], v2 offset:35840
  v_mfma_f32_16x16x32_bf16 v[200:203], a[148:151], a[88:91], v[200:203]
  v_mfma_f32_16x16x32_bf16 v[204:207], a[148:151], a[92:95], v[204:207]
  buffer_load_dwordx4 v9, s[16:19], s52 offen offset:2048 lds
  v_mfma_f32_16x16x32_bf16 v[204:207], a[144:147], a[76:79], v[204:207]
  ds_read_b64_tr_b16 a[134:135], v2 offset:39424
  v_mfma_f32_16x16x32_bf16 v[220:223], a[152:155], a[76:79], v[220:223]
  ds_read_b64_tr_b16 a[136:137], v2 offset:28704
  v_mfma_f32_16x16x32_bf16 v[220:223], a[156:159], a[92:95], v[220:223]
  v_mfma_f32_16x16x32_bf16 v[216:219], a[156:159], a[88:91], v[216:219]
  ds_read_b64_tr_b16 a[138:139], v2 offset:32288
  v_mfma_f32_16x16x32_bf16 v[216:219], a[152:155], a[72:75], v[216:219]
  buffer_load_dwordx4 a[8:11], v0, s[36:39], s53 offen offset:2048 sc1
  v_mfma_f32_16x16x32_bf16 v[212:215], a[152:155], a[68:71], v[212:215]
  ds_read_b64_tr_b16 a[140:141], v2 offset:35872
  v_mfma_f32_16x16x32_bf16 v[212:215], a[156:159], a[84:87], v[212:215]
  v_mfma_f32_16x16x32_bf16 v[208:211], a[156:159], a[80:83], v[208:211]
  ds_read_b64_tr_b16 a[142:143], v2 offset:39456
  v_mfma_f32_16x16x32_bf16 v[208:211], a[152:155], a[64:67], v[208:211]
  s_waitcnt lgkmcnt(8)
  v_mfma_f32_16x16x32_bf16 v[224:227], a[160:163], a[64:67], v[224:227]
  ds_read_b64_tr_b16 a[144:145], v2 offset:28736
  v_mfma_f32_16x16x32_bf16 v[224:227], a[164:167], a[80:83], v[224:227]
  v_mfma_f32_16x16x32_bf16 v[228:231], a[164:167], a[84:87], v[228:231]
  ds_read_b64_tr_b16 a[146:147], v2 offset:32320
  v_mfma_f32_16x16x32_bf16 v[228:231], a[160:163], a[68:71], v[228:231]
  v_mfma_f32_16x16x32_bf16 v[232:235], a[160:163], a[72:75], v[232:235]
  ds_read_b64_tr_b16 a[148:149], v2 offset:35904
  v_mfma_f32_16x16x32_bf16 v[232:235], a[164:167], a[88:91], v[232:235]
  buffer_load_dwordx4 a[12:15], v0, s[36:39], s53 offen offset:3072 sc1
  v_mfma_f32_16x16x32_bf16 v[236:239], a[164:167], a[92:95], v[236:239]
  ds_read_b64_tr_b16 a[150:151], v2 offset:39488
  v_mfma_f32_16x16x32_bf16 v[236:239], a[160:163], a[76:79], v[236:239]
  v_mfma_f32_16x16x32_bf16 v[252:255], a[168:171], a[76:79], v[252:255]
  ds_read_b64_tr_b16 a[152:153], v2 offset:28768
  v_mfma_f32_16x16x32_bf16 v[252:255], a[172:175], a[92:95], v[252:255]
  s_bfe_u32 s52, s86, 0x40014
  s_mul_i32 s52, s52, 458752
  s_add_u32 m0, s88, 28672
  v_mfma_f32_16x16x32_bf16 v[248:251], a[172:175], a[88:91], v[248:251]
  ds_read_b64_tr_b16 a[154:155], v2 offset:32352
  v_mfma_f32_16x16x32_bf16 v[248:251], a[168:171], a[72:75], v[248:251]
  v_mfma_f32_16x16x32_bf16 v[244:247], a[168:171], a[68:71], v[244:247]
  ds_read_b64_tr_b16 a[156:157], v2 offset:35936
  v_mfma_f32_16x16x32_bf16 v[244:247], a[172:175], a[84:87], v[244:247]
  buffer_load_dwordx4 v3, s[16:19], s52 offen offset:0 lds
  v_mfma_f32_16x16x32_bf16 v[240:243], a[172:175], a[80:83], v[240:243]
  ds_read_b64_tr_b16 a[158:159], v2 offset:39520
  v_mfma_f32_16x16x32_bf16 v[240:243], a[168:171], a[64:67], v[240:243]
  s_waitcnt vmcnt(8) lgkmcnt(8)
  v_mfma_f32_16x16x32_bf16 v[32:35], a[128:131], a[96:99], v[32:35]
  s_add_u32 s53, s53, 4096
  ds_read_b64_tr_b16 a[160:161], v2 offset:28800
  v_mfma_f32_16x16x32_bf16 v[32:35], a[132:135], a[112:115], v[32:35]
  v_mfma_f32_16x16x32_bf16 v[36:39], a[132:135], a[116:119], v[36:39]
  ds_read_b64_tr_b16 a[162:163], v2 offset:32384
  v_mfma_f32_16x16x32_bf16 v[36:39], a[128:131], a[100:103], v[36:39]
  v_mfma_f32_16x16x32_bf16 v[40:43], a[128:131], a[104:107], v[40:43]
  buffer_load_dwordx4 a[16:19], v0, s[36:39], s53 offen offset:0 sc1
  v_mfma_f32_16x16x32_bf16 v[40:43], a[132:135], a[120:123], v[40:43]
  ds_read_b64_tr_b16 a[164:165], v2 offset:35968
  v_mfma_f32_16x16x32_bf16 v[44:47], a[132:135], a[124:127], v[44:47]
  ds_read_b64_tr_b16 a[166:167], v2 offset:39552
  v_mfma_f32_16x16x32_bf16 v[44:47], a[128:131], a[108:111], v[44:47]
  v_mfma_f32_16x16x32_bf16 v[60:63], a[136:139], a[108:111], v[60:63]
  ds_read_b64_tr_b16 a[168:169], v2 offset:28832
  v_mfma_f32_16x16x32_bf16 v[60:63], a[140:143], a[124:127], v[60:63]
  v_mfma_f32_16x16x32_bf16 v[56:59], a[140:143], a[120:123], v[56:59]
  ds_read_b64_tr_b16 a[170:171], v2 offset:32416
  v_mfma_f32_16x16x32_bf16 v[56:59], a[136:139], a[104:107], v[56:59]
  buffer_load_dwordx4 v4, s[16:19], s52 offen offset:1024 lds
  v_mfma_f32_16x16x32_bf16 v[52:55], a[136:139], a[100:103], v[52:55]
  ds_read_b64_tr_b16 a[172:173], v2 offset:36000
  v_mfma_f32_16x16x32_bf16 v[52:55], a[140:143], a[116:119], v[52:55]
  v_mfma_f32_16x16x32_bf16 v[48:51], a[140:143], a[112:115], v[48:51]
  ds_read_b64_tr_b16 a[174:175], v2 offset:39584
  v_mfma_f32_16x16x32_bf16 v[48:51], a[136:139], a[96:99], v[48:51]
  s_waitcnt lgkmcnt(8)
  v_mfma_f32_16x16x32_bf16 v[64:67], a[144:147], a[96:99], v[64:67]
  ds_read_b64_tr_b16 a[128:129], v2 offset:28864
  v_mfma_f32_16x16x32_bf16 v[64:67], a[148:151], a[112:115], v[64:67]
  v_mfma_f32_16x16x32_bf16 v[68:71], a[148:151], a[116:119], v[68:71]
  ds_read_b64_tr_b16 a[130:131], v2 offset:32448
  v_mfma_f32_16x16x32_bf16 v[68:71], a[144:147], a[100:103], v[68:71]
  buffer_load_dwordx4 a[20:23], v0, s[36:39], s53 offen offset:1024 sc1
  v_mfma_f32_16x16x32_bf16 v[72:75], a[144:147], a[104:107], v[72:75]
  ds_read_b64_tr_b16 a[132:133], v2 offset:36032
  v_mfma_f32_16x16x32_bf16 v[72:75], a[148:151], a[120:123], v[72:75]
  v_mfma_f32_16x16x32_bf16 v[76:79], a[148:151], a[124:127], v[76:79]
  ds_read_b64_tr_b16 a[134:135], v2 offset:39616
  v_mfma_f32_16x16x32_bf16 v[76:79], a[144:147], a[108:111], v[76:79]
  v_mfma_f32_16x16x32_bf16 v[92:95], a[152:155], a[108:111], v[92:95]
  ds_read_b64_tr_b16 a[136:137], v2 offset:43008
  v_mfma_f32_16x16x32_bf16 v[92:95], a[156:159], a[124:127], v[92:95]
  v_mfma_f32_16x16x32_bf16 v[88:91], a[156:159], a[120:123], v[88:91]
  buffer_load_dwordx4 v5, s[16:19], s52 offen offset:2048 lds
  v_mfma_f32_16x16x32_bf16 v[88:91], a[152:155], a[104:107], v[88:91]
  ds_read_b64_tr_b16 a[138:139], v2 offset:46592
  v_mfma_f32_16x16x32_bf16 v[84:87], a[152:155], a[100:103], v[84:87]
  ds_read_b64_tr_b16 a[140:141], v2 offset:50176
  v_mfma_f32_16x16x32_bf16 v[84:87], a[156:159], a[116:119], v[84:87]
  v_mfma_f32_16x16x32_bf16 v[80:83], a[156:159], a[112:115], v[80:83]
  ds_read_b64_tr_b16 a[142:143], v2 offset:53760
  v_mfma_f32_16x16x32_bf16 v[80:83], a[152:155], a[96:99], v[80:83]
  s_waitcnt lgkmcnt(8)
  v_mfma_f32_16x16x32_bf16 v[96:99], a[160:163], a[96:99], v[96:99]
  ds_read_b64_tr_b16 a[144:145], v2 offset:43040
  v_mfma_f32_16x16x32_bf16 v[96:99], a[164:167], a[112:115], v[96:99]
  v_mfma_f32_16x16x32_bf16 v[100:103], a[164:167], a[116:119], v[100:103]
  buffer_load_dwordx4 a[24:27], v0, s[36:39], s53 offen offset:2048 sc1
  v_mfma_f32_16x16x32_bf16 v[100:103], a[160:163], a[100:103], v[100:103]
  ds_read_b64_tr_b16 a[146:147], v2 offset:46624
  v_mfma_f32_16x16x32_bf16 v[104:107], a[160:163], a[104:107], v[104:107]
  ds_read_b64_tr_b16 a[148:149], v2 offset:50208
  v_mfma_f32_16x16x32_bf16 v[104:107], a[164:167], a[120:123], v[104:107]
  v_mfma_f32_16x16x32_bf16 v[108:111], a[164:167], a[124:127], v[108:111]
  ds_read_b64_tr_b16 a[150:151], v2 offset:53792
  v_mfma_f32_16x16x32_bf16 v[108:111], a[160:163], a[108:111], v[108:111]
  v_mfma_f32_16x16x32_bf16 v[124:127], a[168:171], a[108:111], v[124:127]
  ds_read_b64_tr_b16 a[152:153], v2 offset:43072
  v_mfma_f32_16x16x32_bf16 v[124:127], a[172:175], a[124:127], v[124:127]
  buffer_load_dwordx4 v6, s[16:19], s52 offen offset:3072 lds
  v_mfma_f32_16x16x32_bf16 v[120:123], a[172:175], a[120:123], v[120:123]
  ds_read_b64_tr_b16 a[154:155], v2 offset:46656
  v_mfma_f32_16x16x32_bf16 v[120:123], a[168:171], a[104:107], v[120:123]
  v_mfma_f32_16x16x32_bf16 v[116:119], a[168:171], a[100:103], v[116:119]
  ds_read_b64_tr_b16 a[156:157], v2 offset:50240
  v_mfma_f32_16x16x32_bf16 v[116:119], a[172:175], a[116:119], v[116:119]
  v_mfma_f32_16x16x32_bf16 v[112:115], a[172:175], a[112:115], v[112:115]
  ds_read_b64_tr_b16 a[158:159], v2 offset:53824
  v_mfma_f32_16x16x32_bf16 v[112:115], a[168:171], a[96:99], v[112:115]
  s_waitcnt lgkmcnt(8)
  v_mfma_f32_16x16x32_bf16 v[128:131], a[128:131], a[96:99], v[128:131]
  ds_read_b64_tr_b16 a[160:161], v2 offset:43104
  v_mfma_f32_16x16x32_bf16 v[128:131], a[132:135], a[112:115], v[128:131]
  buffer_load_dwordx4 a[28:31], v0, s[36:39], s53 offen offset:3072 sc1
  v_mfma_f32_16x16x32_bf16 v[132:135], a[132:135], a[116:119], v[132:135]
  ds_read_b64_tr_b16 a[162:163], v2 offset:46688
  v_mfma_f32_16x16x32_bf16 v[132:135], a[128:131], a[100:103], v[132:135]
  v_mfma_f32_16x16x32_bf16 v[136:139], a[128:131], a[104:107], v[136:139]
  s_add_u32 m0, s88, 32768
  ds_read_b64_tr_b16 a[164:165], v2 offset:50272
  v_mfma_f32_16x16x32_bf16 v[136:139], a[132:135], a[120:123], v[136:139]
  v_mfma_f32_16x16x32_bf16 v[140:143], a[132:135], a[124:127], v[140:143]
  ds_read_b64_tr_b16 a[166:167], v2 offset:53856
  v_mfma_f32_16x16x32_bf16 v[140:143], a[128:131], a[108:111], v[140:143]
  v_mfma_f32_16x16x32_bf16 v[156:159], a[136:139], a[108:111], v[156:159]
  buffer_load_dwordx4 v7, s[16:19], s52 offen offset:0 lds
  s_bfe_u32 s53, s86, 0x40014
  v_mfma_f32_16x16x32_bf16 v[156:159], a[140:143], a[124:127], v[156:159]
  s_lshl_b32 s53, s53, 13
  s_add_u32 s53, s53, s89
  ds_read_b64_tr_b16 a[168:169], v2 offset:43136
  v_mfma_f32_16x16x32_bf16 v[152:155], a[140:143], a[120:123], v[152:155]
  ds_read_b64_tr_b16 a[170:171], v2 offset:46720
  v_mfma_f32_16x16x32_bf16 v[152:155], a[136:139], a[104:107], v[152:155]
  v_mfma_f32_16x16x32_bf16 v[148:151], a[136:139], a[100:103], v[148:151]
  ds_read_b64_tr_b16 a[172:173], v2 offset:50304
  v_mfma_f32_16x16x32_bf16 v[148:151], a[140:143], a[116:119], v[148:151]
  buffer_load_dwordx4 a[32:35], v0, s[36:39], s53 offen offset:0 sc1
  v_mfma_f32_16x16x32_bf16 v[144:147], a[140:143], a[112:115], v[144:147]
  ds_read_b64_tr_b16 a[174:175], v2 offset:53888
  v_mfma_f32_16x16x32_bf16 v[144:147], a[136:139], a[96:99], v[144:147]
  s_waitcnt lgkmcnt(8)
  v_mfma_f32_16x16x32_bf16 v[160:163], a[144:147], a[96:99], v[160:163]
  ds_read_b64_tr_b16 a[128:129], v2 offset:43168
  v_mfma_f32_16x16x32_bf16 v[160:163], a[148:151], a[112:115], v[160:163]
  v_mfma_f32_16x16x32_bf16 v[164:167], a[148:151], a[116:119], v[164:167]
  ds_read_b64_tr_b16 a[130:131], v2 offset:46752
  v_mfma_f32_16x16x32_bf16 v[164:167], a[144:147], a[100:103], v[164:167]
  v_mfma_f32_16x16x32_bf16 v[168:171], a[144:147], a[104:107], v[168:171]
  ds_read_b64_tr_b16 a[132:133], v2 offset:50336
  v_mfma_f32_16x16x32_bf16 v[168:171], a[148:151], a[120:123], v[168:171]
  v_mfma_f32_16x16x32_bf16 v[172:175], a[148:151], a[124:127], v[172:175]
  ds_read_b64_tr_b16 a[134:135], v2 offset:53920
  v_mfma_f32_16x16x32_bf16 v[172:175], a[144:147], a[108:111], v[172:175]
  s_waitcnt vmcnt(12)
  s_barrier
  buffer_load_dwordx4 v8, s[16:19], s52 offen offset:1024 lds
  v_mfma_f32_16x16x32_bf16 v[188:191], a[152:155], a[108:111], v[188:191]
  ds_read_b64_tr_b16 a[136:137], v2 offset:43200
  v_mfma_f32_16x16x32_bf16 v[188:191], a[156:159], a[124:127], v[188:191]
  v_mfma_f32_16x16x32_bf16 v[184:187], a[156:159], a[120:123], v[184:187]
  ds_read_b64_tr_b16 a[138:139], v2 offset:46784
  v_mfma_f32_16x16x32_bf16 v[184:187], a[152:155], a[104:107], v[184:187]
  v_mfma_f32_16x16x32_bf16 v[180:183], a[152:155], a[100:103], v[180:183]
  buffer_load_dwordx4 a[36:39], v0, s[36:39], s53 offen offset:1024 sc1
  v_mfma_f32_16x16x32_bf16 v[180:183], a[156:159], a[116:119], v[180:183]
  ds_read_b64_tr_b16 a[140:141], v2 offset:50368
  v_mfma_f32_16x16x32_bf16 v[176:179], a[156:159], a[112:115], v[176:179]
  ds_read_b64_tr_b16 a[142:143], v2 offset:53952
  v_mfma_f32_16x16x32_bf16 v[176:179], a[152:155], a[96:99], v[176:179]
  s_waitcnt lgkmcnt(8)
  v_mfma_f32_16x16x32_bf16 v[192:195], a[160:163], a[96:99], v[192:195]
  ds_read_b64_tr_b16 a[144:145], v1 offset:0
  v_mfma_f32_16x16x32_bf16 v[192:195], a[164:167], a[112:115], v[192:195]
  v_mfma_f32_16x16x32_bf16 v[196:199], a[164:167], a[116:119], v[196:199]
  ds_read_b64_tr_b16 a[146:147], v1 offset:3584
  v_mfma_f32_16x16x32_bf16 v[196:199], a[160:163], a[100:103], v[196:199]
  v_mfma_f32_16x16x32_bf16 v[200:203], a[160:163], a[104:107], v[200:203]
  ds_read_b64_tr_b16 a[148:149], v1 offset:7168
  v_mfma_f32_16x16x32_bf16 v[200:203], a[164:167], a[120:123], v[200:203]
  v_mfma_f32_16x16x32_bf16 v[204:207], a[164:167], a[124:127], v[204:207]
  buffer_load_dwordx4 v9, s[16:19], s52 offen offset:2048 lds
  v_mfma_f32_16x16x32_bf16 v[204:207], a[160:163], a[108:111], v[204:207]
  ds_read_b64_tr_b16 a[150:151], v1 offset:10752
  v_mfma_f32_16x16x32_bf16 v[220:223], a[168:171], a[108:111], v[220:223]
  ds_read_b64_tr_b16 a[152:153], v1 offset:32
  v_mfma_f32_16x16x32_bf16 v[220:223], a[172:175], a[124:127], v[220:223]
  v_mfma_f32_16x16x32_bf16 v[216:219], a[172:175], a[120:123], v[216:219]
  ds_read_b64_tr_b16 a[154:155], v1 offset:3616
  v_mfma_f32_16x16x32_bf16 v[216:219], a[168:171], a[104:107], v[216:219]
  buffer_load_dwordx4 a[40:43], v0, s[36:39], s53 offen offset:2048 sc1
  v_mfma_f32_16x16x32_bf16 v[212:215], a[168:171], a[100:103], v[212:215]
  ds_read_b64_tr_b16 a[156:157], v1 offset:7200
  v_mfma_f32_16x16x32_bf16 v[212:215], a[172:175], a[116:119], v[212:215]
  v_mfma_f32_16x16x32_bf16 v[208:211], a[172:175], a[112:115], v[208:211]
  ds_read_b64_tr_b16 a[158:159], v1 offset:10784
  v_mfma_f32_16x16x32_bf16 v[208:211], a[168:171], a[96:99], v[208:211]
  s_waitcnt lgkmcnt(8)
  v_mfma_f32_16x16x32_bf16 v[224:227], a[128:131], a[96:99], v[224:227]
  ds_read_b64_tr_b16 a[160:161], v1 offset:64
  v_mfma_f32_16x16x32_bf16 v[224:227], a[132:135], a[112:115], v[224:227]
  v_mfma_f32_16x16x32_bf16 v[228:231], a[132:135], a[116:119], v[228:231]
  ds_read_b64_tr_b16 a[162:163], v1 offset:3648
  v_mfma_f32_16x16x32_bf16 v[228:231], a[128:131], a[100:103], v[228:231]
  v_mfma_f32_16x16x32_bf16 v[232:235], a[128:131], a[104:107], v[232:235]
  ds_read_b64_tr_b16 a[164:165], v1 offset:7232
  v_mfma_f32_16x16x32_bf16 v[232:235], a[132:135], a[120:123], v[232:235]
  buffer_load_dwordx4 a[44:47], v0, s[36:39], s53 offen offset:3072 sc1
  v_mfma_f32_16x16x32_bf16 v[236:239], a[132:135], a[124:127], v[236:239]
  ds_read_b64_tr_b16 a[166:167], v1 offset:10816
  v_mfma_f32_16x16x32_bf16 v[236:239], a[128:131], a[108:111], v[236:239]
  v_mfma_f32_16x16x32_bf16 v[252:255], a[136:139], a[108:111], v[252:255]
  ds_read_b64_tr_b16 a[168:169], v1 offset:96
  v_mfma_f32_16x16x32_bf16 v[252:255], a[140:143], a[124:127], v[252:255]
  s_bfe_u32 s52, s86, 0x40018
  s_mul_i32 s52, s52, 458752
  s_add_u32 m0, s88, 57344
  v_mfma_f32_16x16x32_bf16 v[248:251], a[140:143], a[120:123], v[248:251]
  ds_read_b64_tr_b16 a[170:171], v1 offset:3680
  v_mfma_f32_16x16x32_bf16 v[248:251], a[136:139], a[104:107], v[248:251]
  v_mfma_f32_16x16x32_bf16 v[244:247], a[136:139], a[100:103], v[244:247]
  ds_read_b64_tr_b16 a[172:173], v1 offset:7264
  v_mfma_f32_16x16x32_bf16 v[244:247], a[140:143], a[116:119], v[244:247]
  buffer_load_dwordx4 v3, s[16:19], s52 offen offset:0 lds
  v_mfma_f32_16x16x32_bf16 v[240:243], a[140:143], a[112:115], v[240:243]
  ds_read_b64_tr_b16 a[174:175], v1 offset:10848
  v_mfma_f32_16x16x32_bf16 v[240:243], a[136:139], a[96:99], v[240:243]
  s_waitcnt vmcnt(8) lgkmcnt(8)
  v_mfma_f32_16x16x32_bf16 v[32:35], a[144:147], a[0:3], v[32:35]
  s_add_u32 s53, s53, 4096
  ds_read_b64_tr_b16 a[128:129], v1 offset:128
  v_mfma_f32_16x16x32_bf16 v[32:35], a[148:151], a[16:19], v[32:35]
  v_mfma_f32_16x16x32_bf16 v[36:39], a[148:151], a[20:23], v[36:39]
  ds_read_b64_tr_b16 a[130:131], v1 offset:3712
  v_mfma_f32_16x16x32_bf16 v[36:39], a[144:147], a[4:7], v[36:39]
  v_mfma_f32_16x16x32_bf16 v[40:43], a[144:147], a[8:11], v[40:43]
  buffer_load_dwordx4 a[48:51], v0, s[36:39], s53 offen offset:0 sc1
  v_mfma_f32_16x16x32_bf16 v[40:43], a[148:151], a[24:27], v[40:43]
  ds_read_b64_tr_b16 a[132:133], v1 offset:7296
  v_mfma_f32_16x16x32_bf16 v[44:47], a[148:151], a[28:31], v[44:47]
  ds_read_b64_tr_b16 a[134:135], v1 offset:10880
  v_mfma_f32_16x16x32_bf16 v[44:47], a[144:147], a[12:15], v[44:47]
  v_mfma_f32_16x16x32_bf16 v[60:63], a[152:155], a[12:15], v[60:63]
  ds_read_b64_tr_b16 a[136:137], v1 offset:160
  v_mfma_f32_16x16x32_bf16 v[60:63], a[156:159], a[28:31], v[60:63]
  v_mfma_f32_16x16x32_bf16 v[56:59], a[156:159], a[24:27], v[56:59]
  ds_read_b64_tr_b16 a[138:139], v1 offset:3744
  v_mfma_f32_16x16x32_bf16 v[56:59], a[152:155], a[8:11], v[56:59]
  buffer_load_dwordx4 v4, s[16:19], s52 offen offset:1024 lds
  v_mfma_f32_16x16x32_bf16 v[52:55], a[152:155], a[4:7], v[52:55]
  ds_read_b64_tr_b16 a[140:141], v1 offset:7328
  v_mfma_f32_16x16x32_bf16 v[52:55], a[156:159], a[20:23], v[52:55]
  v_mfma_f32_16x16x32_bf16 v[48:51], a[156:159], a[16:19], v[48:51]
  ds_read_b64_tr_b16 a[142:143], v1 offset:10912
  v_mfma_f32_16x16x32_bf16 v[48:51], a[152:155], a[0:3], v[48:51]
  s_waitcnt lgkmcnt(8)
  v_mfma_f32_16x16x32_bf16 v[64:67], a[160:163], a[0:3], v[64:67]
  ds_read_b64_tr_b16 a[144:145], v1 offset:192
  v_mfma_f32_16x16x32_bf16 v[64:67], a[164:167], a[16:19], v[64:67]
  v_mfma_f32_16x16x32_bf16 v[68:71], a[164:167], a[20:23], v[68:71]
  ds_read_b64_tr_b16 a[146:147], v1 offset:3776
  v_mfma_f32_16x16x32_bf16 v[68:71], a[160:163], a[4:7], v[68:71]
  buffer_load_dwordx4 a[52:55], v0, s[36:39], s53 offen offset:1024 sc1
  v_mfma_f32_16x16x32_bf16 v[72:75], a[160:163], a[8:11], v[72:75]
  ds_read_b64_tr_b16 a[148:149], v1 offset:7360
  v_mfma_f32_16x16x32_bf16 v[72:75], a[164:167], a[24:27], v[72:75]
  v_mfma_f32_16x16x32_bf16 v[76:79], a[164:167], a[28:31], v[76:79]
  ds_read_b64_tr_b16 a[150:151], v1 offset:10944
  v_mfma_f32_16x16x32_bf16 v[76:79], a[160:163], a[12:15], v[76:79]
  v_mfma_f32_16x16x32_bf16 v[92:95], a[168:171], a[12:15], v[92:95]
  ds_read_b64_tr_b16 a[152:153], v1 offset:14336
  v_mfma_f32_16x16x32_bf16 v[92:95], a[172:175], a[28:31], v[92:95]
  v_mfma_f32_16x16x32_bf16 v[88:91], a[172:175], a[24:27], v[88:91]
  buffer_load_dwordx4 v5, s[16:19], s52 offen offset:2048 lds
  v_mfma_f32_16x16x32_bf16 v[88:91], a[168:171], a[8:11], v[88:91]
  ds_read_b64_tr_b16 a[154:155], v1 offset:17920
  v_mfma_f32_16x16x32_bf16 v[84:87], a[168:171], a[4:7], v[84:87]
  ds_read_b64_tr_b16 a[156:157], v1 offset:21504
  v_mfma_f32_16x16x32_bf16 v[84:87], a[172:175], a[20:23], v[84:87]
  v_mfma_f32_16x16x32_bf16 v[80:83], a[172:175], a[16:19], v[80:83]
  ds_read_b64_tr_b16 a[158:159], v1 offset:25088
  v_mfma_f32_16x16x32_bf16 v[80:83], a[168:171], a[0:3], v[80:83]
  s_waitcnt lgkmcnt(8)
  v_mfma_f32_16x16x32_bf16 v[96:99], a[128:131], a[0:3], v[96:99]
  ds_read_b64_tr_b16 a[160:161], v1 offset:14368
  v_mfma_f32_16x16x32_bf16 v[96:99], a[132:135], a[16:19], v[96:99]
  v_mfma_f32_16x16x32_bf16 v[100:103], a[132:135], a[20:23], v[100:103]
  buffer_load_dwordx4 a[56:59], v0, s[36:39], s53 offen offset:2048 sc1
  v_mfma_f32_16x16x32_bf16 v[100:103], a[128:131], a[4:7], v[100:103]
  ds_read_b64_tr_b16 a[162:163], v1 offset:17952
  v_mfma_f32_16x16x32_bf16 v[104:107], a[128:131], a[8:11], v[104:107]
  ds_read_b64_tr_b16 a[164:165], v1 offset:21536
  v_mfma_f32_16x16x32_bf16 v[104:107], a[132:135], a[24:27], v[104:107]
  v_mfma_f32_16x16x32_bf16 v[108:111], a[132:135], a[28:31], v[108:111]
  ds_read_b64_tr_b16 a[166:167], v1 offset:25120
  v_mfma_f32_16x16x32_bf16 v[108:111], a[128:131], a[12:15], v[108:111]
  v_mfma_f32_16x16x32_bf16 v[124:127], a[136:139], a[12:15], v[124:127]
  ds_read_b64_tr_b16 a[168:169], v1 offset:14400
  v_mfma_f32_16x16x32_bf16 v[124:127], a[140:143], a[28:31], v[124:127]
  buffer_load_dwordx4 v6, s[16:19], s52 offen offset:3072 lds
  v_mfma_f32_16x16x32_bf16 v[120:123], a[140:143], a[24:27], v[120:123]
  ds_read_b64_tr_b16 a[170:171], v1 offset:17984
  v_mfma_f32_16x16x32_bf16 v[120:123], a[136:139], a[8:11], v[120:123]
  v_mfma_f32_16x16x32_bf16 v[116:119], a[136:139], a[4:7], v[116:119]
  ds_read_b64_tr_b16 a[172:173], v1 offset:21568
  v_mfma_f32_16x16x32_bf16 v[116:119], a[140:143], a[20:23], v[116:119]
  v_mfma_f32_16x16x32_bf16 v[112:115], a[140:143], a[16:19], v[112:115]
  ds_read_b64_tr_b16 a[174:175], v1 offset:25152
  v_mfma_f32_16x16x32_bf16 v[112:115], a[136:139], a[0:3], v[112:115]
  s_waitcnt lgkmcnt(8)
  v_mfma_f32_16x16x32_bf16 v[128:131], a[144:147], a[0:3], v[128:131]
  ds_read_b64_tr_b16 a[128:129], v1 offset:14432
  v_mfma_f32_16x16x32_bf16 v[128:131], a[148:151], a[16:19], v[128:131]
  buffer_load_dwordx4 a[60:63], v0, s[36:39], s53 offen offset:3072 sc1
  v_mfma_f32_16x16x32_bf16 v[132:135], a[148:151], a[20:23], v[132:135]
  ds_read_b64_tr_b16 a[130:131], v1 offset:18016
  v_mfma_f32_16x16x32_bf16 v[132:135], a[144:147], a[4:7], v[132:135]
  v_mfma_f32_16x16x32_bf16 v[136:139], a[144:147], a[8:11], v[136:139]
  s_add_u32 m0, s88, 61440
  ds_read_b64_tr_b16 a[132:133], v1 offset:21600
  v_mfma_f32_16x16x32_bf16 v[136:139], a[148:151], a[24:27], v[136:139]
  v_mfma_f32_16x16x32_bf16 v[140:143], a[148:151], a[28:31], v[140:143]
  ds_read_b64_tr_b16 a[134:135], v1 offset:25184
  v_mfma_f32_16x16x32_bf16 v[140:143], a[144:147], a[12:15], v[140:143]
  v_mfma_f32_16x16x32_bf16 v[156:159], a[152:155], a[12:15], v[156:159]
  buffer_load_dwordx4 v7, s[16:19], s52 offen offset:0 lds
  s_bfe_u32 s53, s86, 0x40018
  v_mfma_f32_16x16x32_bf16 v[156:159], a[156:159], a[28:31], v[156:159]
  s_lshl_b32 s53, s53, 13
  s_add_u32 s53, s53, s89
  ds_read_b64_tr_b16 a[136:137], v1 offset:14464
  v_mfma_f32_16x16x32_bf16 v[152:155], a[156:159], a[24:27], v[152:155]
  ds_read_b64_tr_b16 a[138:139], v1 offset:18048
  v_mfma_f32_16x16x32_bf16 v[152:155], a[152:155], a[8:11], v[152:155]
  v_mfma_f32_16x16x32_bf16 v[148:151], a[152:155], a[4:7], v[148:151]
  ds_read_b64_tr_b16 a[140:141], v1 offset:21632
  v_mfma_f32_16x16x32_bf16 v[148:151], a[156:159], a[20:23], v[148:151]
  buffer_load_dwordx4 a[64:67], v0, s[36:39], s53 offen offset:0 sc1
  v_mfma_f32_16x16x32_bf16 v[144:147], a[156:159], a[16:19], v[144:147]
  ds_read_b64_tr_b16 a[142:143], v1 offset:25216
  v_mfma_f32_16x16x32_bf16 v[144:147], a[152:155], a[0:3], v[144:147]
  s_waitcnt lgkmcnt(8)
  v_mfma_f32_16x16x32_bf16 v[160:163], a[160:163], a[0:3], v[160:163]
  ds_read_b64_tr_b16 a[144:145], v1 offset:14496
  v_mfma_f32_16x16x32_bf16 v[160:163], a[164:167], a[16:19], v[160:163]
  v_mfma_f32_16x16x32_bf16 v[164:167], a[164:167], a[20:23], v[164:167]
  ds_read_b64_tr_b16 a[146:147], v1 offset:18080
  v_mfma_f32_16x16x32_bf16 v[164:167], a[160:163], a[4:7], v[164:167]
  v_mfma_f32_16x16x32_bf16 v[168:171], a[160:163], a[8:11], v[168:171]
  ds_read_b64_tr_b16 a[148:149], v1 offset:21664
  v_mfma_f32_16x16x32_bf16 v[168:171], a[164:167], a[24:27], v[168:171]
  v_mfma_f32_16x16x32_bf16 v[172:175], a[164:167], a[28:31], v[172:175]
  ds_read_b64_tr_b16 a[150:151], v1 offset:25248
  v_mfma_f32_16x16x32_bf16 v[172:175], a[160:163], a[12:15], v[172:175]
  s_waitcnt vmcnt(12)
  s_barrier
  buffer_load_dwordx4 v8, s[16:19], s52 offen offset:1024 lds
  v_mfma_f32_16x16x32_bf16 v[188:191], a[168:171], a[12:15], v[188:191]
  ds_read_b64_tr_b16 a[152:153], v1 offset:14528
  v_mfma_f32_16x16x32_bf16 v[188:191], a[172:175], a[28:31], v[188:191]
  v_mfma_f32_16x16x32_bf16 v[184:187], a[172:175], a[24:27], v[184:187]
  ds_read_b64_tr_b16 a[154:155], v1 offset:18112
  v_mfma_f32_16x16x32_bf16 v[184:187], a[168:171], a[8:11], v[184:187]
  v_mfma_f32_16x16x32_bf16 v[180:183], a[168:171], a[4:7], v[180:183]
  buffer_load_dwordx4 a[68:71], v0, s[36:39], s53 offen offset:1024 sc1
  v_mfma_f32_16x16x32_bf16 v[180:183], a[172:175], a[20:23], v[180:183]
  ds_read_b64_tr_b16 a[156:157], v1 offset:21696
  v_mfma_f32_16x16x32_bf16 v[176:179], a[172:175], a[16:19], v[176:179]
  ds_read_b64_tr_b16 a[158:159], v1 offset:25280
  v_mfma_f32_16x16x32_bf16 v[176:179], a[168:171], a[0:3], v[176:179]
  s_waitcnt lgkmcnt(8)
  v_mfma_f32_16x16x32_bf16 v[192:195], a[128:131], a[0:3], v[192:195]
  ds_read_b64_tr_b16 a[160:161], v1 offset:28672
  v_mfma_f32_16x16x32_bf16 v[192:195], a[132:135], a[16:19], v[192:195]
  v_mfma_f32_16x16x32_bf16 v[196:199], a[132:135], a[20:23], v[196:199]
  ds_read_b64_tr_b16 a[162:163], v1 offset:32256
  v_mfma_f32_16x16x32_bf16 v[196:199], a[128:131], a[4:7], v[196:199]
  v_mfma_f32_16x16x32_bf16 v[200:203], a[128:131], a[8:11], v[200:203]
  ds_read_b64_tr_b16 a[164:165], v1 offset:35840
  v_mfma_f32_16x16x32_bf16 v[200:203], a[132:135], a[24:27], v[200:203]
  v_mfma_f32_16x16x32_bf16 v[204:207], a[132:135], a[28:31], v[204:207]
  buffer_load_dwordx4 v9, s[16:19], s52 offen offset:2048 lds
  v_mfma_f32_16x16x32_bf16 v[204:207], a[128:131], a[12:15], v[204:207]
  ds_read_b64_tr_b16 a[166:167], v1 offset:39424
  v_mfma_f32_16x16x32_bf16 v[220:223], a[136:139], a[12:15], v[220:223]
  ds_read_b64_tr_b16 a[168:169], v1 offset:28704
  v_mfma_f32_16x16x32_bf16 v[220:223], a[140:143], a[28:31], v[220:223]
  v_mfma_f32_16x16x32_bf16 v[216:219], a[140:143], a[24:27], v[216:219]
  ds_read_b64_tr_b16 a[170:171], v1 offset:32288
  v_mfma_f32_16x16x32_bf16 v[216:219], a[136:139], a[8:11], v[216:219]
  buffer_load_dwordx4 a[72:75], v0, s[36:39], s53 offen offset:2048 sc1
  v_mfma_f32_16x16x32_bf16 v[212:215], a[136:139], a[4:7], v[212:215]
  ds_read_b64_tr_b16 a[172:173], v1 offset:35872
  v_mfma_f32_16x16x32_bf16 v[212:215], a[140:143], a[20:23], v[212:215]
  v_mfma_f32_16x16x32_bf16 v[208:211], a[140:143], a[16:19], v[208:211]
  ds_read_b64_tr_b16 a[174:175], v1 offset:39456
  v_mfma_f32_16x16x32_bf16 v[208:211], a[136:139], a[0:3], v[208:211]
  s_waitcnt lgkmcnt(8)
  v_mfma_f32_16x16x32_bf16 v[224:227], a[144:147], a[0:3], v[224:227]
  ds_read_b64_tr_b16 a[128:129], v1 offset:28736
  v_mfma_f32_16x16x32_bf16 v[224:227], a[148:151], a[16:19], v[224:227]
  v_mfma_f32_16x16x32_bf16 v[228:231], a[148:151], a[20:23], v[228:231]
  ds_read_b64_tr_b16 a[130:131], v1 offset:32320
  v_mfma_f32_16x16x32_bf16 v[228:231], a[144:147], a[4:7], v[228:231]
  v_mfma_f32_16x16x32_bf16 v[232:235], a[144:147], a[8:11], v[232:235]
  ds_read_b64_tr_b16 a[132:133], v1 offset:35904
  v_mfma_f32_16x16x32_bf16 v[232:235], a[148:151], a[24:27], v[232:235]
  buffer_load_dwordx4 a[76:79], v0, s[36:39], s53 offen offset:3072 sc1
  v_mfma_f32_16x16x32_bf16 v[236:239], a[148:151], a[28:31], v[236:239]
  ds_read_b64_tr_b16 a[134:135], v1 offset:39488
  v_mfma_f32_16x16x32_bf16 v[236:239], a[144:147], a[12:15], v[236:239]
Hb1:
  s_cbranch_execz Hb1_1
  v_mfma_f32_16x16x32_bf16 v[252:255], a[152:155], a[12:15], v[252:255]
  ds_read_b64_tr_b16 a[136:137], v1 offset:28768
  v_mfma_f32_16x16x32_bf16 v[252:255], a[156:159], a[28:31], v[252:255]
  s_bfe_u32 s52, s86, 0x4001c
  s_mul_i32 s52, s52, 458752
  s_add_u32 m0, s88, 86016
  v_mfma_f32_16x16x32_bf16 v[248:251], a[156:159], a[24:27], v[248:251]
  buffer_load_dwordx4 a[208:211], v0, s[36:39], s57 offen offset:0 sc1
  v_add_u32 v31, 57344, v31
  v_mfma_f32_16x16x32_bf16 v[248:251], a[152:155], a[8:11], v[248:251]
  ds_read_b64_tr_b16 a[138:139], v1 offset:32352
  v_mfma_f32_16x16x32_bf16 v[244:247], a[152:155], a[4:7], v[244:247]
  ds_read_b64_tr_b16 a[140:141], v1 offset:35936
  v_mfma_f32_16x16x32_bf16 v[244:247], a[156:159], a[20:23], v[244:247]
  v_mfma_f32_16x16x32_bf16 v[240:243], a[156:159], a[16:19], v[240:243]
  ds_read_b64_tr_b16 a[142:143], v1 offset:39520
  v_mfma_f32_16x16x32_bf16 v[240:243], a[152:155], a[0:3], v[240:243]
  s_waitcnt vmcnt(8) lgkmcnt(8)
  buffer_load_dwordx4 a[212:215], v0, s[36:39], s57 offen offset:1024 sc1
  v_mfma_f32_16x16x32_bf16 v[32:35], a[160:163], a[32:35], v[32:35]
  ds_read_b64_tr_b16 a[144:145], v1 offset:28800
  v_mfma_f32_16x16x32_bf16 v[32:35], a[164:167], a[48:51], v[32:35]
  v_mfma_f32_16x16x32_bf16 v[36:39], a[164:167], a[52:55], v[36:39]
  ds_read_b64_tr_b16 a[146:147], v1 offset:32384
  v_mfma_f32_16x16x32_bf16 v[36:39], a[160:163], a[36:39], v[36:39]
  v_mfma_f32_16x16x32_bf16 v[40:43], a[160:163], a[40:43], v[40:43]
  buffer_load_dwordx4 v3, s[16:19], s52 offen offset:0 lds
  s_add_u32 s53, s53, 4096
  v_mfma_f32_16x16x32_bf16 v[40:43], a[164:167], a[56:59], v[40:43]
  ds_read_b64_tr_b16 a[148:149], v1 offset:35968
  v_mfma_f32_16x16x32_bf16 v[44:47], a[164:167], a[60:63], v[44:47]
  ds_read_b64_tr_b16 a[150:151], v1 offset:39552
  v_mfma_f32_16x16x32_bf16 v[44:47], a[160:163], a[44:47], v[44:47]
  v_mfma_f32_16x16x32_bf16 v[60:63], a[168:171], a[44:47], v[60:63]
  ds_read_b64_tr_b16 a[152:153], v1 offset:28832
  v_mfma_f32_16x16x32_bf16 v[60:63], a[172:175], a[60:63], v[60:63]
  buffer_load_dwordx4 a[80:83], v0, s[36:39], s53 offen offset:0 sc1
  v_mfma_f32_16x16x32_bf16 v[56:59], a[172:175], a[56:59], v[56:59]
  ds_read_b64_tr_b16 a[154:155], v1 offset:32416
  v_mfma_f32_16x16x32_bf16 v[56:59], a[168:171], a[40:43], v[56:59]
  v_mfma_f32_16x16x32_bf16 v[52:55], a[168:171], a[36:39], v[52:55]
  ds_read_b64_tr_b16 a[156:157], v1 offset:36000
  v_mfma_f32_16x16x32_bf16 v[52:55], a[172:175], a[52:55], v[52:55]
  v_mfma_f32_16x16x32_bf16 v[48:51], a[172:175], a[48:51], v[48:51]
  buffer_load_dwordx4 v4, s[16:19], s52 offen offset:1024 lds
  v_mfma_f32_16x16x32_bf16 v[48:51], a[168:171], a[32:35], v[48:51]
  s_waitcnt lgkmcnt(7)
  ds_read_b64_tr_b16 a[158:159], v1 offset:39584
  v_mfma_f32_16x16x32_bf16 v[64:67], a[128:131], a[32:35], v[64:67]
  ds_read_b64_tr_b16 a[160:161], v1 offset:28864
  v_mfma_f32_16x16x32_bf16 v[64:67], a[132:135], a[48:51], v[64:67]
  v_mfma_f32_16x16x32_bf16 v[68:71], a[132:135], a[52:55], v[68:71]
  ds_read_b64_tr_b16 a[162:163], v1 offset:32448
  v_mfma_f32_16x16x32_bf16 v[68:71], a[128:131], a[36:39], v[68:71]
  buffer_load_dwordx4 a[84:87], v0, s[36:39], s53 offen offset:1024 sc1
  v_mfma_f32_16x16x32_bf16 v[72:75], a[128:131], a[40:43], v[72:75]
  ds_read_b64_tr_b16 a[164:165], v1 offset:36032
  v_mfma_f32_16x16x32_bf16 v[72:75], a[132:135], a[56:59], v[72:75]
  v_mfma_f32_16x16x32_bf16 v[76:79], a[132:135], a[60:63], v[76:79]
  ds_read_b64_tr_b16 a[166:167], v1 offset:39616
  v_mfma_f32_16x16x32_bf16 v[76:79], a[128:131], a[44:47], v[76:79]
  v_mfma_f32_16x16x32_bf16 v[92:95], a[136:139], a[44:47], v[92:95]
  ds_read_b64_tr_b16 a[168:169], v1 offset:43008
  v_mfma_f32_16x16x32_bf16 v[92:95], a[140:143], a[60:63], v[92:95]
  v_mfma_f32_16x16x32_bf16 v[88:91], a[140:143], a[56:59], v[88:91]
  buffer_load_dwordx4 v5, s[16:19], s52 offen offset:2048 lds
  v_mfma_f32_16x16x32_bf16 v[88:91], a[136:139], a[40:43], v[88:91]
  ds_read_b64_tr_b16 a[170:171], v1 offset:46592
  v_mfma_f32_16x16x32_bf16 v[84:87], a[136:139], a[36:39], v[84:87]
  ds_read_b64_tr_b16 a[172:173], v1 offset:50176
  v_mfma_f32_16x16x32_bf16 v[84:87], a[140:143], a[52:55], v[84:87]
  v_mfma_f32_16x16x32_bf16 v[80:83], a[140:143], a[48:51], v[80:83]
  ds_read_b64_tr_b16 a[174:175], v1 offset:53760
  v_mfma_f32_16x16x32_bf16 v[80:83], a[136:139], a[32:35], v[80:83]
  s_waitcnt lgkmcnt(8)
  v_mfma_f32_16x16x32_bf16 v[96:99], a[144:147], a[32:35], v[96:99]
  ds_read_b64_tr_b16 a[128:129], v1 offset:43040
  v_mfma_f32_16x16x32_bf16 v[96:99], a[148:151], a[48:51], v[96:99]
  v_mfma_f32_16x16x32_bf16 v[100:103], a[148:151], a[52:55], v[100:103]
  buffer_load_dwordx4 a[88:91], v0, s[36:39], s53 offen offset:2048 sc1
  v_mfma_f32_16x16x32_bf16 v[100:103], a[144:147], a[36:39], v[100:103]
  ds_read_b64_tr_b16 a[130:131], v1 offset:46624
  v_mfma_f32_16x16x32_bf16 v[104:107], a[144:147], a[40:43], v[104:107]
  ds_read_b64_tr_b16 a[132:133], v1 offset:50208
  v_mfma_f32_16x16x32_bf16 v[104:107], a[148:151], a[56:59], v[104:107]
  v_mfma_f32_16x16x32_bf16 v[108:111], a[148:151], a[60:63], v[108:111]
  ds_read_b64_tr_b16 a[134:135], v1 offset:53792
  v_mfma_f32_16x16x32_bf16 v[108:111], a[144:147], a[44:47], v[108:111]
  v_mfma_f32_16x16x32_bf16 v[124:127], a[152:155], a[44:47], v[124:127]
  ds_read_b64_tr_b16 a[136:137], v1 offset:43072
  v_mfma_f32_16x16x32_bf16 v[124:127], a[156:159], a[60:63], v[124:127]
  buffer_load_dwordx4 v6, s[16:19], s52 offen offset:3072 lds
  v_mfma_f32_16x16x32_bf16 v[120:123], a[156:159], a[56:59], v[120:123]
  ds_read_b64_tr_b16 a[138:139], v1 offset:46656
  v_mfma_f32_16x16x32_bf16 v[120:123], a[152:155], a[40:43], v[120:123]
  v_mfma_f32_16x16x32_bf16 v[116:119], a[152:155], a[36:39], v[116:119]
  ds_read_b64_tr_b16 a[140:141], v1 offset:50240
  v_mfma_f32_16x16x32_bf16 v[116:119], a[156:159], a[52:55], v[116:119]
  v_mfma_f32_16x16x32_bf16 v[112:115], a[156:159], a[48:51], v[112:115]
  ds_read_b64_tr_b16 a[142:143], v1 offset:53824
  v_mfma_f32_16x16x32_bf16 v[112:115], a[152:155], a[32:35], v[112:115]
  s_waitcnt lgkmcnt(8)
  v_mfma_f32_16x16x32_bf16 v[128:131], a[160:163], a[32:35], v[128:131]
  ds_read_b64_tr_b16 a[144:145], v1 offset:43104
  v_mfma_f32_16x16x32_bf16 v[128:131], a[164:167], a[48:51], v[128:131]
  buffer_load_dwordx4 a[92:95], v0, s[36:39], s53 offen offset:3072 sc1
  v_mfma_f32_16x16x32_bf16 v[132:135], a[164:167], a[52:55], v[132:135]
  ds_read_b64_tr_b16 a[146:147], v1 offset:46688
  v_mfma_f32_16x16x32_bf16 v[132:135], a[160:163], a[36:39], v[132:135]
  v_mfma_f32_16x16x32_bf16 v[136:139], a[160:163], a[40:43], v[136:139]
  s_add_u32 m0, s88, 90112
  ds_read_b64_tr_b16 a[148:149], v1 offset:50272
  v_mfma_f32_16x16x32_bf16 v[136:139], a[164:167], a[56:59], v[136:139]
  v_mfma_f32_16x16x32_bf16 v[140:143], a[164:167], a[60:63], v[140:143]
  ds_read_b64_tr_b16 a[150:151], v1 offset:53856
  v_mfma_f32_16x16x32_bf16 v[140:143], a[160:163], a[44:47], v[140:143]
  v_mfma_f32_16x16x32_bf16 v[156:159], a[168:171], a[44:47], v[156:159]
  buffer_load_dwordx4 v7, s[16:19], s52 offen offset:0 lds
  s_bfe_u32 s53, s86, 0x4001c
  v_mfma_f32_16x16x32_bf16 v[156:159], a[172:175], a[60:63], v[156:159]
  s_lshl_b32 s53, s53, 13
  s_add_u32 s53, s53, s89
  ds_read_b64_tr_b16 a[152:153], v1 offset:43136
  v_mfma_f32_16x16x32_bf16 v[152:155], a[172:175], a[56:59], v[152:155]
  ds_read_b64_tr_b16 a[154:155], v1 offset:46720
  v_mfma_f32_16x16x32_bf16 v[152:155], a[168:171], a[40:43], v[152:155]
  v_mfma_f32_16x16x32_bf16 v[148:151], a[168:171], a[36:39], v[148:151]
  ds_read_b64_tr_b16 a[156:157], v1 offset:50304
  v_mfma_f32_16x16x32_bf16 v[148:151], a[172:175], a[52:55], v[148:151]
  buffer_load_dwordx4 a[96:99], v0, s[36:39], s53 offen offset:0 sc1
  v_mfma_f32_16x16x32_bf16 v[144:147], a[172:175], a[48:51], v[144:147]
  ds_read_b64_tr_b16 a[158:159], v1 offset:53888
  v_mfma_f32_16x16x32_bf16 v[144:147], a[168:171], a[32:35], v[144:147]
  s_waitcnt lgkmcnt(8)
  v_mfma_f32_16x16x32_bf16 v[160:163], a[128:131], a[32:35], v[160:163]
  ds_read_b64_tr_b16 a[160:161], v1 offset:43168
  v_mfma_f32_16x16x32_bf16 v[160:163], a[132:135], a[48:51], v[160:163]
  v_mfma_f32_16x16x32_bf16 v[164:167], a[132:135], a[52:55], v[164:167]
  ds_read_b64_tr_b16 a[162:163], v1 offset:46752
  v_mfma_f32_16x16x32_bf16 v[164:167], a[128:131], a[36:39], v[164:167]
  v_mfma_f32_16x16x32_bf16 v[168:171], a[128:131], a[40:43], v[168:171]
  ds_read_b64_tr_b16 a[164:165], v1 offset:50336
  v_mfma_f32_16x16x32_bf16 v[168:171], a[132:135], a[56:59], v[168:171]
  v_mfma_f32_16x16x32_bf16 v[172:175], a[132:135], a[60:63], v[172:175]
  ds_read_b64_tr_b16 a[166:167], v1 offset:53920
  v_mfma_f32_16x16x32_bf16 v[172:175], a[128:131], a[44:47], v[172:175]
  s_waitcnt vmcnt(14)
  s_barrier
  buffer_load_dwordx4 v8, s[16:19], s52 offen offset:1024 lds
  v_mfma_f32_16x16x32_bf16 v[188:191], a[136:139], a[44:47], v[188:191]
  ds_read_b64_tr_b16 a[168:169], v1 offset:43200
  v_mfma_f32_16x16x32_bf16 v[188:191], a[140:143], a[60:63], v[188:191]
  v_mfma_f32_16x16x32_bf16 v[184:187], a[140:143], a[56:59], v[184:187]
  ds_read_b64_tr_b16 a[170:171], v1 offset:46784
  v_mfma_f32_16x16x32_bf16 v[184:187], a[136:139], a[40:43], v[184:187]
  v_mfma_f32_16x16x32_bf16 v[180:183], a[136:139], a[36:39], v[180:183]
  buffer_load_dwordx4 a[100:103], v0, s[36:39], s53 offen offset:1024 sc1
  v_mfma_f32_16x16x32_bf16 v[180:183], a[140:143], a[52:55], v[180:183]
  ds_read_b64_tr_b16 a[172:173], v1 offset:50368
  v_mfma_f32_16x16x32_bf16 v[176:179], a[140:143], a[48:51], v[176:179]
  ds_read_b64_tr_b16 a[174:175], v1 offset:53952
  v_mfma_f32_16x16x32_bf16 v[176:179], a[136:139], a[32:35], v[176:179]
  s_waitcnt lgkmcnt(8)
  v_mfma_f32_16x16x32_bf16 v[192:195], a[144:147], a[32:35], v[192:195]
  ds_read_b64_tr_b16 a[128:129], v2 offset:0
  v_mfma_f32_16x16x32_bf16 v[192:195], a[148:151], a[48:51], v[192:195]
  v_mfma_f32_16x16x32_bf16 v[196:199], a[148:151], a[52:55], v[196:199]
  ds_read_b64_tr_b16 a[130:131], v2 offset:3584
  v_mfma_f32_16x16x32_bf16 v[196:199], a[144:147], a[36:39], v[196:199]
  v_mfma_f32_16x16x32_bf16 v[200:203], a[144:147], a[40:43], v[200:203]
  ds_read_b64_tr_b16 a[132:133], v2 offset:7168
  v_mfma_f32_16x16x32_bf16 v[200:203], a[148:151], a[56:59], v[200:203]
  ds_read_b64_tr_b16 a[176:177], v31 offset:0
  v_mfma_f32_16x16x32_bf16 v[204:207], a[148:151], a[60:63], v[204:207]
  buffer_load_dwordx4 v9, s[16:19], s52 offen offset:2048 lds
  v_mfma_f32_16x16x32_bf16 v[204:207], a[144:147], a[44:47], v[204:207]
  ds_read_b64_tr_b16 a[134:135], v2 offset:10752
  v_mfma_f32_16x16x32_bf16 v[220:223], a[152:155], a[44:47], v[220:223]
  ds_read_b64_tr_b16 a[136:137], v2 offset:32
  v_mfma_f32_16x16x32_bf16 v[220:223], a[156:159], a[60:63], v[220:223]
  ds_read_b64_tr_b16 a[178:179], v31 offset:3584
  v_mfma_f32_16x16x32_bf16 v[216:219], a[156:159], a[56:59], v[216:219]
  ds_read_b64_tr_b16 a[138:139], v2 offset:3616
  v_mfma_f32_16x16x32_bf16 v[216:219], a[152:155], a[40:43], v[216:219]
  buffer_load_dwordx4 a[104:107], v0, s[36:39], s53 offen offset:2048 sc1
  v_mfma_f32_16x16x32_bf16 v[212:215], a[152:155], a[36:39], v[212:215]
  ds_read_b64_tr_b16 a[140:141], v2 offset:7200
  v_mfma_f32_16x16x32_bf16 v[212:215], a[156:159], a[52:55], v[212:215]
  ds_read_b64_tr_b16 a[180:181], v31 offset:7168
  v_mfma_f32_16x16x32_bf16 v[208:211], a[156:159], a[48:51], v[208:211]
  ds_read_b64_tr_b16 a[142:143], v2 offset:10784
  v_mfma_f32_16x16x32_bf16 v[208:211], a[152:155], a[32:35], v[208:211]
  s_waitcnt lgkmcnt(11)
  ds_read_b64_tr_b16 a[182:183], v31 offset:10752
  v_mfma_f32_16x16x32_bf16 v[224:227], a[160:163], a[32:35], v[224:227]
  ds_read_b64_tr_b16 a[144:145], v2 offset:64
  v_mfma_f32_16x16x32_bf16 v[224:227], a[164:167], a[48:51], v[224:227]
  ds_read_b64_tr_b16 a[184:185], v31 offset:32
  v_mfma_f32_16x16x32_bf16 v[228:231], a[164:167], a[52:55], v[228:231]
  ds_read_b64_tr_b16 a[146:147], v2 offset:3648
  v_mfma_f32_16x16x32_bf16 v[228:231], a[160:163], a[36:39], v[228:231]
  ds_read_b64_tr_b16 a[186:187], v31 offset:3616
  v_mfma_f32_16x16x32_bf16 v[232:235], a[160:163], a[40:43], v[232:235]
  ds_read_b64_tr_b16 a[148:149], v2 offset:7232
  v_mfma_f32_16x16x32_bf16 v[232:235], a[164:167], a[56:59], v[232:235]
  buffer_load_dwordx4 a[108:111], v0, s[36:39], s53 offen offset:3072 sc1
  v_mfma_f32_16x16x32_bf16 v[236:239], a[164:167], a[60:63], v[236:239]
  ds_read_b64_tr_b16 a[150:151], v2 offset:10816
  v_mfma_f32_16x16x32_bf16 v[236:239], a[160:163], a[44:47], v[236:239]
  ds_read_b64_tr_b16 a[188:189], v31 offset:7200
  v_mfma_f32_16x16x32_bf16 v[252:255], a[168:171], a[44:47], v[252:255]
  ds_read_b64_tr_b16 a[152:153], v2 offset:96
  v_mfma_f32_16x16x32_bf16 v[252:255], a[172:175], a[60:63], v[252:255]
  s_bfe_u32 s52, s87, 0x40000
  s_mul_i32 s52, s52, 458752
  s_add_u32 m0, s88, 0
  v_mfma_f32_16x16x32_bf16 v[248:251], a[172:175], a[56:59], v[248:251]
  ds_read_b64_tr_b16 a[154:155], v2 offset:3680
  v_mfma_f32_16x16x32_bf16 v[248:251], a[168:171], a[40:43], v[248:251]
  ds_read_b64_tr_b16 a[190:191], v31 offset:10784
  v_mfma_f32_16x16x32_bf16 v[244:247], a[168:171], a[36:39], v[244:247]
  ds_read_b64_tr_b16 a[156:157], v2 offset:7264
  v_mfma_f32_16x16x32_bf16 v[244:247], a[172:175], a[52:55], v[244:247]
  buffer_load_dwordx4 v3, s[16:19], s52 offen offset:0 lds
  v_mfma_f32_16x16x32_bf16 v[240:243], a[172:175], a[48:51], v[240:243]
  ds_read_b64_tr_b16 a[158:159], v2 offset:10848
  v_mfma_f32_16x16x32_bf16 v[240:243], a[168:171], a[32:35], v[240:243]
  s_waitcnt vmcnt(8) lgkmcnt(13)
  ds_read_b64_tr_b16 a[192:193], v31 offset:64
  v_mfma_f32_16x16x32_bf16 v[32:35], a[128:131], a[64:67], v[32:35]
  s_add_u32 s53, s53, 4096
  ds_read_b64_tr_b16 a[194:195], v31 offset:3648
  v_mfma_f32_16x16x32_bf16 v[32:35], a[132:135], a[80:83], v[32:35]
  ds_read_b64_tr_b16 a[196:197], v31 offset:7232
  v_mfma_f32_16x16x32_bf16 v[36:39], a[132:135], a[84:87], v[36:39]
  ds_read_b64_tr_b16 a[198:199], v31 offset:10816
  v_mfma_f32_16x16x32_bf16 v[36:39], a[128:131], a[68:71], v[36:39]
  ds_read_b64_tr_b16 a[200:201], v31 offset:96
  v_mfma_f32_16x16x32_bf16 v[40:43], a[128:131], a[72:75], v[40:43]
  buffer_load_dwordx4 a[112:115], v0, s[36:39], s53 offen offset:0 sc1
  v_mfma_f32_16x16x32_bf16 v[40:43], a[132:135], a[88:91], v[40:43]
  ds_read_b64_tr_b16 a[202:203], v31 offset:3680
  v_mfma_f32_16x16x32_bf16 v[44:47], a[132:135], a[92:95], v[44:47]
  ds_read_b64_tr_b16 a[204:205], v31 offset:7264
  v_mfma_f32_16x16x32_bf16 v[44:47], a[128:131], a[76:79], v[44:47]
  ds_read_b64_tr_b16 a[206:207], v31 offset:10848
  v_mfma_f32_16x16x32_bf16 v[60:63], a[136:139], a[76:79], v[60:63]
  ds_read_b64_tr_b16 a[160:161], v2 offset:128
  v_mfma_f32_16x16x32_bf16 v[60:63], a[140:143], a[92:95], v[60:63]
  v_mfma_f32_16x16x32_bf16 v[56:59], a[140:143], a[88:91], v[56:59]
  ds_read_b64_tr_b16 a[162:163], v2 offset:3712
  v_mfma_f32_16x16x32_bf16 v[56:59], a[136:139], a[72:75], v[56:59]
  buffer_load_dwordx4 v4, s[16:19], s52 offen offset:1024 lds
  v_mfma_f32_16x16x32_bf16 v[52:55], a[136:139], a[68:71], v[52:55]
  ds_read_b64_tr_b16 a[164:165], v2 offset:7296
  v_mfma_f32_16x16x32_bf16 v[52:55], a[140:143], a[84:87], v[52:55]
  v_mfma_f32_16x16x32_bf16 v[48:51], a[140:143], a[80:83], v[48:51]
  ds_read_b64_tr_b16 a[166:167], v2 offset:10880
  v_mfma_f32_16x16x32_bf16 v[48:51], a[136:139], a[64:67], v[48:51]
  s_waitcnt lgkmcnt(12)
  v_mfma_f32_16x16x32_bf16 v[64:67], a[144:147], a[64:67], v[64:67]
  ds_read_b64_tr_b16 a[168:169], v2 offset:160
  v_mfma_f32_16x16x32_bf16 v[64:67], a[148:151], a[80:83], v[64:67]
  v_mfma_f32_16x16x32_bf16 v[68:71], a[148:151], a[84:87], v[68:71]
  ds_read_b64_tr_b16 a[170:171], v2 offset:3744
  v_mfma_f32_16x16x32_bf16 v[68:71], a[144:147], a[68:71], v[68:71]
  buffer_load_dwordx4 a[116:119], v0, s[36:39], s53 offen offset:1024 sc1
  v_mfma_f32_16x16x32_bf16 v[72:75], a[144:147], a[72:75], v[72:75]
  ds_read_b64_tr_b16 a[172:173], v2 offset:7328
  v_mfma_f32_16x16x32_bf16 v[72:75], a[148:151], a[88:91], v[72:75]
  v_mfma_f32_16x16x32_bf16 v[76:79], a[148:151], a[92:95], v[76:79]
  ds_read_b64_tr_b16 a[174:175], v2 offset:10912
  v_mfma_f32_16x16x32_bf16 v[76:79], a[144:147], a[76:79], v[76:79]
  v_mfma_f32_16x16x32_bf16 v[92:95], a[152:155], a[76:79], v[92:95]
  ds_read_b64_tr_b16 a[128:129], v2 offset:192
  v_mfma_f32_16x16x32_bf16 v[92:95], a[156:159], a[92:95], v[92:95]
  v_mfma_f32_16x16x32_bf16 v[88:91], a[156:159], a[88:91], v[88:91]
  buffer_load_dwordx4 v5, s[16:19], s52 offen offset:2048 lds
  v_mfma_f32_16x16x32_bf16 v[88:91], a[152:155], a[72:75], v[88:91]
  ds_read_b64_tr_b16 a[130:131], v2 offset:3776
  v_mfma_f32_16x16x32_bf16 v[84:87], a[152:155], a[68:71], v[84:87]
  ds_read_b64_tr_b16 a[132:133], v2 offset:7360
  v_mfma_f32_16x16x32_bf16 v[84:87], a[156:159], a[84:87], v[84:87]
  v_mfma_f32_16x16x32_bf16 v[80:83], a[156:159], a[80:83], v[80:83]
  ds_read_b64_tr_b16 a[134:135], v2 offset:10944
  v_mfma_f32_16x16x32_bf16 v[80:83], a[152:155], a[64:67], v[80:83]
  s_waitcnt vmcnt(20) lgkmcnt(12)
  v_mfma_f32_16x16x32_bf16 a[216:219], a[176:179], a[208:211], 0
  ds_read_b64_tr_b16 a[136:137], v2 offset:14336
  v_mfma_f32_16x16x32_bf16 a[216:219], a[180:183], a[212:215], a[216:219]
  v_mfma_f32_16x16x32_bf16 a[220:223], a[184:187], a[208:211], 0
  buffer_load_dwordx4 a[120:123], v0, s[36:39], s53 offen offset:2048 sc1
  v_mfma_f32_16x16x32_bf16 a[220:223], a[188:191], a[212:215], a[220:223]
  ds_read_b64_tr_b16 a[138:139], v2 offset:17920
  v_mfma_f32_16x16x32_bf16 a[224:227], a[192:195], a[208:211], 0
  ds_read_b64_tr_b16 a[140:141], v2 offset:21504
  v_mfma_f32_16x16x32_bf16 a[224:227], a[196:199], a[212:215], a[224:227]
  v_mfma_f32_16x16x32_bf16 a[228:231], a[200:203], a[208:211], 0
  ds_read_b64_tr_b16 a[142:143], v2 offset:25088
  v_mfma_f32_16x16x32_bf16 a[228:231], a[204:207], a[212:215], a[228:231]
  s_waitcnt lgkmcnt(8)
  v_mfma_f32_16x16x32_bf16 v[96:99], a[160:163], a[64:67], v[96:99]
  ds_read_b64_tr_b16 a[144:145], v2 offset:14368
  v_mfma_f32_16x16x32_bf16 v[96:99], a[164:167], a[80:83], v[96:99]
  buffer_load_dwordx4 v6, s[16:19], s52 offen offset:3072 lds
  v_mfma_f32_16x16x32_bf16 v[100:103], a[164:167], a[84:87], v[100:103]
  s_lshl2_add_u32 s67, s56, s44
  ds_read_b64_tr_b16 a[146:147], v2 offset:17952
  s_lshl_b32 s67, s67, 13
  v_mfma_f32_16x16x32_bf16 v[100:103], a[160:163], a[68:71], v[100:103]
  s_add_u32 s67, s67, 262144
  s_add_u32 s68, s67, 4096
  v_mfma_f32_16x16x32_bf16 v[104:107], a[160:163], a[72:75], v[104:107]
  ds_read_b64_tr_b16 a[148:149], v2 offset:21536
  v_mfma_f32_16x16x32_bf16 v[104:107], a[164:167], a[88:91], v[104:107]
  v_mfma_f32_16x16x32_bf16 v[108:111], a[164:167], a[92:95], v[108:111]
  ds_read_b64_tr_b16 a[150:151], v2 offset:25120
  v_mfma_f32_16x16x32_bf16 v[108:111], a[160:163], a[76:79], v[108:111]
  buffer_load_dwordx4 a[176:179], v0, s[36:39], s67 offen offset:0 sc1
  v_mfma_f32_16x16x32_bf16 v[124:127], a[168:171], a[76:79], v[124:127]
  ds_read_b64_tr_b16 a[152:153], v2 offset:14400
  v_mfma_f32_16x16x32_bf16 v[124:127], a[172:175], a[92:95], v[124:127]
  v_mfma_f32_16x16x32_bf16 v[120:123], a[172:175], a[88:91], v[120:123]
  ds_read_b64_tr_b16 a[154:155], v2 offset:17984
  v_mfma_f32_16x16x32_bf16 v[120:123], a[168:171], a[72:75], v[120:123]
  v_mfma_f32_16x16x32_bf16 v[116:119], a[168:171], a[68:71], v[116:119]
  buffer_load_dwordx4 a[124:127], v0, s[36:39], s53 offen offset:3072 sc1
  s_add_u32 m0, s88, 4096
  v_mfma_f32_16x16x32_bf16 v[116:119], a[172:175], a[84:87], v[116:119]
  ds_read_b64_tr_b16 a[156:157], v2 offset:21568
  v_mfma_f32_16x16x32_bf16 v[112:115], a[172:175], a[80:83], v[112:115]
  ds_read_b64_tr_b16 a[158:159], v2 offset:25152
  v_mfma_f32_16x16x32_bf16 v[112:115], a[168:171], a[64:67], v[112:115]
  s_waitcnt lgkmcnt(8)
  v_mfma_f32_16x16x32_bf16 v[128:131], a[128:131], a[64:67], v[128:131]
  ds_read_b64_tr_b16 a[160:161], v2 offset:14432
  v_mfma_f32_16x16x32_bf16 v[128:131], a[132:135], a[80:83], v[128:131]
  buffer_load_dwordx4 v7, s[16:19], s52 offen offset:0 lds
  s_bfe_u32 s53, s87, 0x40000
  v_mfma_f32_16x16x32_bf16 v[132:135], a[132:135], a[84:87], v[132:135]
  s_lshl_b32 s53, s53, 13
  s_add_u32 s53, s53, s89
  ds_read_b64_tr_b16 a[162:163], v2 offset:18016
  v_mfma_f32_16x16x32_bf16 v[132:135], a[128:131], a[68:71], v[132:135]
  v_mfma_f32_16x16x32_bf16 v[136:139], a[128:131], a[72:75], v[136:139]
  ds_read_b64_tr_b16 a[164:165], v2 offset:21600
  v_mfma_f32_16x16x32_bf16 v[136:139], a[132:135], a[88:91], v[136:139]
  v_mfma_f32_16x16x32_bf16 v[140:143], a[132:135], a[92:95], v[140:143]
  buffer_load_dwordx4 a[0:3], v0, s[36:39], s53 offen offset:0 sc1
  v_mfma_f32_16x16x32_bf16 v[140:143], a[128:131], a[76:79], v[140:143]
  ds_read_b64_tr_b16 a[166:167], v2 offset:25184
  v_mfma_f32_16x16x32_bf16 v[156:159], a[136:139], a[76:79], v[156:159]
  ds_read_b64_tr_b16 a[168:169], v2 offset:14464
  v_mfma_f32_16x16x32_bf16 v[156:159], a[140:143], a[92:95], v[156:159]
  v_mfma_f32_16x16x32_bf16 v[152:155], a[140:143], a[88:91], v[152:155]
  ds_read_b64_tr_b16 a[170:171], v2 offset:18048
  v_mfma_f32_16x16x32_bf16 v[152:155], a[136:139], a[72:75], v[152:155]
  buffer_load_dwordx4 a[180:183], v0, s[36:39], s67 offen offset:1024 sc1
  v_mfma_f32_16x16x32_bf16 v[148:151], a[136:139], a[68:71], v[148:151]
  ds_read_b64_tr_b16 a[172:173], v2 offset:21632
  v_mfma_f32_16x16x32_bf16 v[148:151], a[140:143], a[84:87], v[148:151]
  v_mfma_f32_16x16x32_bf16 v[144:147], a[140:143], a[80:83], v[144:147]
  ds_read_b64_tr_b16 a[174:175], v2 offset:25216
  v_mfma_f32_16x16x32_bf16 v[144:147], a[136:139], a[64:67], v[144:147]
  s_waitcnt lgkmcnt(8)
  v_mfma_f32_16x16x32_bf16 v[160:163], a[144:147], a[64:67], v[160:163]
  buffer_load_dwordx4 v8, s[16:19], s52 offen offset:1024 lds
  v_mfma_f32_16x16x32_bf16 v[160:163], a[148:151], a[80:83], v[160:163]
  ds_read_b64_tr_b16 a[128:129], v2 offset:14496
  v_mfma_f32_16x16x32_bf16 v[164:167], a[148:151], a[84:87], v[164:167]
  ds_read_b64_tr_b16 a[130:131], v2 offset:18080
  v_mfma_f32_16x16x32_bf16 v[164:167], a[144:147], a[68:71], v[164:167]
  v_mfma_f32_16x16x32_bf16 v[168:171], a[144:147], a[72:75], v[168:171]
  ds_read_b64_tr_b16 a[132:133], v2 offset:21664
  v_mfma_f32_16x16x32_bf16 v[168:171], a[148:151], a[88:91], v[168:171]
  buffer_load_dwordx4 a[4:7], v0, s[36:39], s53 offen offset:1024 sc1
  v_mfma_f32_16x16x32_bf16 v[172:175], a[148:151], a[92:95], v[172:175]
  ds_read_b64_tr_b16 a[134:135], v2 offset:25248
  v_mfma_f32_16x16x32_bf16 v[172:175], a[144:147], a[76:79], v[172:175]
  s_waitcnt vmcnt(16)
  s_barrier
  v_mfma_f32_16x16x32_bf16 v[188:191], a[152:155], a[76:79], v[188:191]
  ds_read_b64_tr_b16 a[136:137], v2 offset:14528
  v_mfma_f32_16x16x32_bf16 v[188:191], a[156:159], a[92:95], v[188:191]
  v_mfma_f32_16x16x32_bf16 v[184:187], a[156:159], a[88:91], v[184:187]
  ds_read_b64_tr_b16 a[138:139], v2 offset:18112
  v_mfma_f32_16x16x32_bf16 v[184:187], a[152:155], a[72:75], v[184:187]
  buffer_load_dwordx4 a[184:187], v0, s[36:39], s67 offen offset:2048 sc1
  v_mfma_f32_16x16x32_bf16 v[180:183], a[152:155], a[68:71], v[180:183]
  ds_read_b64_tr_b16 a[140:141], v2 offset:21696
  v_mfma_f32_16x16x32_bf16 v[180:183], a[156:159], a[84:87], v[180:183]
  v_mfma_f32_16x16x32_bf16 v[176:179], a[156:159], a[80:83], v[176:179]
  ds_read_b64_tr_b16 a[142:143], v2 offset:25280
  v_mfma_f32_16x16x32_bf16 v[176:179], a[152:155], a[64:67], v[176:179]
  s_waitcnt lgkmcnt(8)
  v_mfma_f32_16x16x32_bf16 v[192:195], a[160:163], a[64:67], v[192:195]
  buffer_load_dwordx4 v9, s[16:19], s52 offen offset:2048 lds
  v_mfma_f32_16x16x32_bf16 v[192:195], a[164:167], a[80:83], v[192:195]
  ds_read_b64_tr_b16 a[144:145], v2 offset:28672
  v_mfma_f32_16x16x32_bf16 v[196:199], a[164:167], a[84:87], v[196:199]
  ds_read_b64_tr_b16 a[146:147], v2 offset:32256
  v_mfma_f32_16x16x32_bf16 v[196:199], a[160:163], a[68:71], v[196:199]
  v_mfma_f32_16x16x32_bf16 v[200:203], a[160:163], a[72:75], v[200:203]
  ds_read_b64_tr_b16 a[148:149], v2 offset:35840
  v_mfma_f32_16x16x32_bf16 v[200:203], a[164:167], a[88:91], v[200:203]
  buffer_load_dwordx4 a[8:11], v0, s[36:39], s53 offen offset:2048 sc1
  v_mfma_f32_16x16x32_bf16 v[204:207], a[164:167], a[92:95], v[204:207]
  ds_read_b64_tr_b16 a[150:151], v2 offset:39424
  v_mfma_f32_16x16x32_bf16 v[204:207], a[160:163], a[76:79], v[204:207]
  v_mfma_f32_16x16x32_bf16 v[220:223], a[168:171], a[76:79], v[220:223]
  ds_read_b64_tr_b16 a[152:153], v2 offset:28704
  v_mfma_f32_16x16x32_bf16 v[220:223], a[172:175], a[92:95], v[220:223]
  buffer_load_dwordx4 a[188:191], v0, s[36:39], s67 offen offset:3072 sc1
  v_mfma_f32_16x16x32_bf16 v[216:219], a[172:175], a[88:91], v[216:219]
  ds_read_b64_tr_b16 a[154:155], v2 offset:32288
  v_mfma_f32_16x16x32_bf16 v[216:219], a[168:171], a[72:75], v[216:219]
  v_mfma_f32_16x16x32_bf16 v[212:215], a[168:171], a[68:71], v[212:215]
  ds_read_b64_tr_b16 a[156:157], v2 offset:35872
  v_mfma_f32_16x16x32_bf16 v[212:215], a[172:175], a[84:87], v[212:215]
  v_mfma_f32_16x16x32_bf16 v[208:211], a[172:175], a[80:83], v[208:211]
  buffer_load_dwordx4 a[12:15], v0, s[36:39], s53 offen offset:3072 sc1
  v_mfma_f32_16x16x32_bf16 v[208:211], a[168:171], a[64:67], v[208:211]
  s_waitcnt lgkmcnt(7)
  ds_read_b64_tr_b16 a[158:159], v2 offset:39456
  v_mfma_f32_16x16x32_bf16 v[224:227], a[128:131], a[64:67], v[224:227]
  ds_read_b64_tr_b16 a[160:161], v2 offset:28736
  v_mfma_f32_16x16x32_bf16 v[224:227], a[132:135], a[80:83], v[224:227]
  s_bfe_u32 s52, s87, 0x40004
  s_mul_i32 s52, s52, 458752
  s_add_u32 m0, s88, 28672
  v_mfma_f32_16x16x32_bf16 v[228:231], a[132:135], a[84:87], v[228:231]
  buffer_load_dwordx4 a[192:195], v0, s[36:39], s68 offen offset:0 sc1
  v_mfma_f32_16x16x32_bf16 v[228:231], a[128:131], a[68:71], v[228:231]
  ds_read_b64_tr_b16 a[162:163], v2 offset:32320
  v_mfma_f32_16x16x32_bf16 v[232:235], a[128:131], a[72:75], v[232:235]
  ds_read_b64_tr_b16 a[164:165], v2 offset:35904
  v_mfma_f32_16x16x32_bf16 v[232:235], a[132:135], a[88:91], v[232:235]
  v_mfma_f32_16x16x32_bf16 v[236:239], a[132:135], a[92:95], v[236:239]
  ds_read_b64_tr_b16 a[166:167], v2 offset:39488
  v_mfma_f32_16x16x32_bf16 v[236:239], a[128:131], a[76:79], v[236:239]
  buffer_load_dwordx4 v3, s[16:19], s52 offen offset:0 lds
  v_mfma_f32_16x16x32_bf16 v[252:255], a[136:139], a[76:79], v[252:255]
  ds_read_b64_tr_b16 a[168:169], v2 offset:28768
  v_mfma_f32_16x16x32_bf16 v[252:255], a[140:143], a[92:95], v[252:255]
  v_mfma_f32_16x16x32_bf16 v[248:251], a[140:143], a[88:91], v[248:251]
  ds_read_b64_tr_b16 a[170:171], v2 offset:32352
  v_mfma_f32_16x16x32_bf16 v[248:251], a[136:139], a[72:75], v[248:251]
  buffer_load_dwordx4 a[196:199], v0, s[36:39], s68 offen offset:1024 sc1
  v_mfma_f32_16x16x32_bf16 v[244:247], a[136:139], a[68:71], v[244:247]
  ds_read_b64_tr_b16 a[172:173], v2 offset:35936
  v_mfma_f32_16x16x32_bf16 v[244:247], a[140:143], a[84:87], v[244:247]
  v_mfma_f32_16x16x32_bf16 v[240:243], a[140:143], a[80:83], v[240:243]
  ds_read_b64_tr_b16 a[174:175], v2 offset:39520
  v_mfma_f32_16x16x32_bf16 v[240:243], a[136:139], a[64:67], v[240:243]
  s_waitcnt vmcnt(13) lgkmcnt(8)
  v_mfma_f32_16x16x32_bf16 v[32:35], a[144:147], a[96:99], v[32:35]
  s_add_u32 s53, s53, 4096
  ds_read_b64_tr_b16 a[128:129], v2 offset:28800
  v_mfma_f32_16x16x32_bf16 v[32:35], a[148:151], a[112:115], v[32:35]
  buffer_load_dwordx4 a[200:203], v0, s[36:39], s68 offen offset:2048 sc1
  v_mfma_f32_16x16x32_bf16 v[36:39], a[148:151], a[116:119], v[36:39]
  ds_read_b64_tr_b16 a[130:131], v2 offset:32384
  v_mfma_f32_16x16x32_bf16 v[36:39], a[144:147], a[100:103], v[36:39]
  v_mfma_f32_16x16x32_bf16 v[40:43], a[144:147], a[104:107], v[40:43]
  ds_read_b64_tr_b16 a[132:133], v2 offset:35968
  v_mfma_f32_16x16x32_bf16 v[40:43], a[148:151], a[120:123], v[40:43]
  v_mfma_f32_16x16x32_bf16 v[44:47], a[148:151], a[124:127], v[44:47]
  buffer_load_dwordx4 a[16:19], v0, s[36:39], s53 offen offset:0 sc1
  v_mfma_f32_16x16x32_bf16 v[44:47], a[144:147], a[108:111], v[44:47]
  ds_read_b64_tr_b16 a[134:135], v2 offset:39552
  v_mfma_f32_16x16x32_bf16 v[60:63], a[152:155], a[108:111], v[60:63]
  ds_read_b64_tr_b16 a[136:137], v2 offset:28832
  v_mfma_f32_16x16x32_bf16 v[60:63], a[156:159], a[124:127], v[60:63]
  v_mfma_f32_16x16x32_bf16 v[56:59], a[156:159], a[120:123], v[56:59]
  ds_read_b64_tr_b16 a[138:139], v2 offset:32416
  v_mfma_f32_16x16x32_bf16 v[56:59], a[152:155], a[104:107], v[56:59]
  buffer_load_dwordx4 v4, s[16:19], s52 offen offset:1024 lds
  v_mfma_f32_16x16x32_bf16 v[52:55], a[152:155], a[100:103], v[52:55]
  ds_read_b64_tr_b16 a[140:141], v2 offset:36000
  v_mfma_f32_16x16x32_bf16 v[52:55], a[156:159], a[116:119], v[52:55]
  buffer_load_dwordx4 a[204:207], v0, s[36:39], s68 offen offset:3072 sc1
  v_mfma_f32_16x16x32_bf16 v[48:51], a[156:159], a[112:115], v[48:51]
  ds_read_b64_tr_b16 a[142:143], v2 offset:39584
  v_mfma_f32_16x16x32_bf16 v[48:51], a[152:155], a[96:99], v[48:51]
  s_waitcnt lgkmcnt(8)
  v_mfma_f32_16x16x32_bf16 v[64:67], a[160:163], a[96:99], v[64:67]
  ds_read_b64_tr_b16 a[144:145], v2 offset:28864
  v_mfma_f32_16x16x32_bf16 v[64:67], a[164:167], a[112:115], v[64:67]
  v_mfma_f32_16x16x32_bf16 v[68:71], a[164:167], a[116:119], v[68:71]
  ds_read_b64_tr_b16 a[146:147], v2 offset:32448
  v_mfma_f32_16x16x32_bf16 v[68:71], a[160:163], a[100:103], v[68:71]
  buffer_load_dwordx4 a[20:23], v0, s[36:39], s53 offen offset:1024 sc1
  v_mfma_f32_16x16x32_bf16 v[72:75], a[160:163], a[104:107], v[72:75]
  ds_read_b64_tr_b16 a[148:149], v2 offset:36032
  v_mfma_f32_16x16x32_bf16 v[72:75], a[164:167], a[120:123], v[72:75]
  v_mfma_f32_16x16x32_bf16 v[76:79], a[164:167], a[124:127], v[76:79]
  ds_read_b64_tr_b16 a[150:151], v2 offset:39616
  v_mfma_f32_16x16x32_bf16 v[76:79], a[160:163], a[108:111], v[76:79]
  v_mfma_f32_16x16x32_bf16 v[92:95], a[168:171], a[108:111], v[92:95]
  ds_read_b64_tr_b16 a[152:153], v2 offset:43008
  v_mfma_f32_16x16x32_bf16 v[92:95], a[172:175], a[124:127], v[92:95]
  v_mfma_f32_16x16x32_bf16 v[88:91], a[172:175], a[120:123], v[88:91]
  buffer_load_dwordx4 v5, s[16:19], s52 offen offset:2048 lds
  v_mfma_f32_16x16x32_bf16 v[88:91], a[168:171], a[104:107], v[88:91]
  ds_read_b64_tr_b16 a[154:155], v2 offset:46592
  v_mfma_f32_16x16x32_bf16 v[84:87], a[168:171], a[100:103], v[84:87]
  ds_read_b64_tr_b16 a[156:157], v2 offset:50176
  v_mfma_f32_16x16x32_bf16 v[84:87], a[172:175], a[116:119], v[84:87]
  v_mfma_f32_16x16x32_bf16 v[80:83], a[172:175], a[112:115], v[80:83]
  ds_read_b64_tr_b16 a[158:159], v2 offset:53760
  v_mfma_f32_16x16x32_bf16 v[80:83], a[168:171], a[96:99], v[80:83]
  s_waitcnt lgkmcnt(8)
  v_mfma_f32_16x16x32_bf16 v[96:99], a[128:131], a[96:99], v[96:99]
  ds_read_b64_tr_b16 a[160:161], v2 offset:43040
  v_mfma_f32_16x16x32_bf16 v[96:99], a[132:135], a[112:115], v[96:99]
  v_mfma_f32_16x16x32_bf16 v[100:103], a[132:135], a[116:119], v[100:103]
  buffer_load_dwordx4 a[24:27], v0, s[36:39], s53 offen offset:2048 sc1
  v_mfma_f32_16x16x32_bf16 v[100:103], a[128:131], a[100:103], v[100:103]
  ds_read_b64_tr_b16 a[162:163], v2 offset:46624
  v_mfma_f32_16x16x32_bf16 v[104:107], a[128:131], a[104:107], v[104:107]
  ds_read_b64_tr_b16 a[164:165], v2 offset:50208
  v_mfma_f32_16x16x32_bf16 v[104:107], a[132:135], a[120:123], v[104:107]
  v_mfma_f32_16x16x32_bf16 v[108:111], a[132:135], a[124:127], v[108:111]
  ds_read_b64_tr_b16 a[166:167], v2 offset:53792
  v_mfma_f32_16x16x32_bf16 v[108:111], a[128:131], a[108:111], v[108:111]
  v_mfma_f32_16x16x32_bf16 v[124:127], a[136:139], a[108:111], v[124:127]
Hb2:
  s_cbranch_execz Hb2_1
  ds_read_b64_tr_b16 a[168:169], v2 offset:43072
  v_mfma_f32_16x16x32_bf16 v[124:127], a[140:143], a[124:127], v[124:127]
  buffer_load_dwordx4 v6, s[16:19], s52 offen offset:3072 lds
  v_mfma_f32_16x16x32_bf16 v[120:123], a[140:143], a[120:123], v[120:123]
  ds_read_b64_tr_b16 a[170:171], v2 offset:46656
  v_mfma_f32_16x16x32_bf16 v[120:123], a[136:139], a[104:107], v[120:123]
  v_mfma_f32_16x16x32_bf16 v[116:119], a[136:139], a[100:103], v[116:119]
  ds_read_b64_tr_b16 a[172:173], v2 offset:50240
  v_mfma_f32_16x16x32_bf16 v[116:119], a[140:143], a[116:119], v[116:119]
  v_mfma_f32_16x16x32_bf16 v[112:115], a[140:143], a[112:115], v[112:115]
  ds_read_b64_tr_b16 a[174:175], v2 offset:53824
  v_mfma_f32_16x16x32_bf16 v[112:115], a[136:139], a[96:99], v[112:115]
  s_waitcnt lgkmcnt(8)
  v_mfma_f32_16x16x32_bf16 v[128:131], a[144:147], a[96:99], v[128:131]
  ds_read_b64_tr_b16 a[128:129], v2 offset:43104
  v_mfma_f32_16x16x32_bf16 v[128:131], a[148:151], a[112:115], v[128:131]
  buffer_load_dwordx4 a[28:31], v0, s[36:39], s53 offen offset:3072 sc1
  v_mfma_f32_16x16x32_bf16 v[132:135], a[148:151], a[116:119], v[132:135]
  ds_read_b64_tr_b16 a[130:131], v2 offset:46688
  v_mfma_f32_16x16x32_bf16 v[132:135], a[144:147], a[100:103], v[132:135]
  v_mfma_f32_16x16x32_bf16 v[136:139], a[144:147], a[104:107], v[136:139]
  s_add_u32 m0, s88, 32768
  ds_read_b64_tr_b16 a[132:133], v2 offset:50272
  v_mfma_f32_16x16x32_bf16 v[136:139], a[148:151], a[120:123], v[136:139]
  v_mfma_f32_16x16x32_bf16 v[140:143], a[148:151], a[124:127], v[140:143]
  ds_read_b64_tr_b16 a[134:135], v2 offset:53856
  v_mfma_f32_16x16x32_bf16 v[140:143], a[144:147], a[108:111], v[140:143]
  v_mfma_f32_16x16x32_bf16 v[156:159], a[152:155], a[108:111], v[156:159]
  buffer_load_dwordx4 v7, s[16:19], s52 offen offset:0 lds
  s_bfe_u32 s53, s87, 0x40004
  v_mfma_f32_16x16x32_bf16 v[156:159], a[156:159], a[124:127], v[156:159]
  s_lshl_b32 s53, s53, 13
  s_add_u32 s53, s53, s89
  ds_read_b64_tr_b16 a[136:137], v2 offset:43136
  v_mfma_f32_16x16x32_bf16 v[152:155], a[156:159], a[120:123], v[152:155]
  ds_read_b64_tr_b16 a[138:139], v2 offset:46720
  v_mfma_f32_16x16x32_bf16 v[152:155], a[152:155], a[104:107], v[152:155]
  v_mfma_f32_16x16x32_bf16 v[148:151], a[152:155], a[100:103], v[148:151]
  ds_read_b64_tr_b16 a[140:141], v2 offset:50304
  v_mfma_f32_16x16x32_bf16 v[148:151], a[156:159], a[116:119], v[148:151]
  buffer_load_dwordx4 a[32:35], v0, s[36:39], s53 offen offset:0 sc1
  v_mfma_f32_16x16x32_bf16 v[144:147], a[156:159], a[112:115], v[144:147]
  ds_read_b64_tr_b16 a[142:143], v2 offset:53888
  v_mfma_f32_16x16x32_bf16 v[144:147], a[152:155], a[96:99], v[144:147]
  s_waitcnt lgkmcnt(8)
  v_mfma_f32_16x16x32_bf16 v[160:163], a[160:163], a[96:99], v[160:163]
  s_waitcnt vmcnt(7)
  ds_read_b64_tr_b16 a[144:145], v2 offset:43168
  v_accvgpr_read_b32 v22, a176
  v_mfma_f32_16x16x32_bf16 v[160:163], a[164:167], a[112:115], v[160:163]
  v_accvgpr_read_b32 v23, a177
  v_accvgpr_read_b32 v24, a178
  v_mfma_f32_16x16x32_bf16 v[164:167], a[164:167], a[116:119], v[164:167]
  ds_read_b64_tr_b16 a[146:147], v2 offset:46752
  v_accvgpr_read_b32 v25, a179
  v_mfma_f32_16x16x32_bf16 v[164:167], a[160:163], a[100:103], v[164:167]
  v_accvgpr_read_b32 v26, a180
  v_accvgpr_read_b32 v27, a181
  v_mfma_f32_16x16x32_bf16 v[168:171], a[160:163], a[104:107], v[168:171]
  ds_read_b64_tr_b16 a[148:149], v2 offset:50336
  v_accvgpr_read_b32 v28, a182
  v_mfma_f32_16x16x32_bf16 v[168:171], a[164:167], a[120:123], v[168:171]
  v_accvgpr_read_b32 v29, a183
  v_add_f32 v22, v22, v26
  v_mfma_f32_16x16x32_bf16 v[172:175], a[164:167], a[124:127], v[172:175]
  ds_read_b64_tr_b16 a[150:151], v2 offset:53920
  v_add_f32 v23, v23, v27
  v_mfma_f32_16x16x32_bf16 v[172:175], a[160:163], a[108:111], v[172:175]
  s_waitcnt vmcnt(17)
  s_barrier
  buffer_load_dwordx4 v8, s[16:19], s52 offen offset:1024 lds
  v_add_f32 v24, v24, v28
  v_mfma_f32_16x16x32_bf16 v[188:191], a[168:171], a[108:111], v[188:191]
  ds_read_b64_tr_b16 a[152:153], v2 offset:43200
  v_add_f32 v25, v25, v29
  v_mfma_f32_16x16x32_bf16 v[188:191], a[172:175], a[124:127], v[188:191]
  v_accvgpr_read_b32 v26, a184
  v_accvgpr_read_b32 v27, a185
  v_mfma_f32_16x16x32_bf16 v[184:187], a[172:175], a[120:123], v[184:187]
  ds_read_b64_tr_b16 a[154:155], v2 offset:46784
  v_accvgpr_read_b32 v28, a186
  v_mfma_f32_16x16x32_bf16 v[184:187], a[168:171], a[104:107], v[184:187]
  v_accvgpr_read_b32 v29, a187
  v_add_f32 v22, v22, v26
  v_mfma_f32_16x16x32_bf16 v[180:183], a[168:171], a[100:103], v[180:183]
  buffer_load_dwordx4 a[36:39], v0, s[36:39], s53 offen offset:1024 sc1
  v_add_f32 v23, v23, v27
  v_mfma_f32_16x16x32_bf16 v[180:183], a[172:175], a[116:119], v[180:183]
  ds_read_b64_tr_b16 a[156:157], v2 offset:50368
  v_add_f32 v24, v24, v28
  v_mfma_f32_16x16x32_bf16 v[176:179], a[172:175], a[112:115], v[176:179]
  ds_read_b64_tr_b16 a[158:159], v2 offset:53952
  v_add_f32 v25, v25, v29
  v_mfma_f32_16x16x32_bf16 v[176:179], a[168:171], a[96:99], v[176:179]
  s_waitcnt lgkmcnt(8)
  v_accvgpr_read_b32 v26, a188
  v_accvgpr_read_b32 v27, a189
  v_mfma_f32_16x16x32_bf16 v[192:195], a[128:131], a[96:99], v[192:195]
  ds_read_b64_tr_b16 a[160:161], v1 offset:0
  v_accvgpr_read_b32 v28, a190
  v_mfma_f32_16x16x32_bf16 v[192:195], a[132:135], a[112:115], v[192:195]
  v_accvgpr_read_b32 v29, a191
  v_add_f32 v22, v22, v26
  v_mfma_f32_16x16x32_bf16 v[196:199], a[132:135], a[116:119], v[196:199]
  ds_read_b64_tr_b16 a[162:163], v1 offset:3584
  v_add_f32 v23, v23, v27
  v_mfma_f32_16x16x32_bf16 v[196:199], a[128:131], a[100:103], v[196:199]
  v_add_f32 v24, v24, v28
  v_add_f32 v25, v25, v29
  v_mfma_f32_16x16x32_bf16 v[200:203], a[128:131], a[104:107], v[200:203]
  ds_read_b64_tr_b16 a[164:165], v1 offset:7168
  v_mov_b32 v26, v22
  v_mfma_f32_16x16x32_bf16 v[200:203], a[132:135], a[120:123], v[200:203]
  v_mov_b32 v27, v23
  v_mov_b32 v28, v24
  v_mfma_f32_16x16x32_bf16 v[204:207], a[132:135], a[124:127], v[204:207]
  buffer_load_dwordx4 v9, s[16:19], s52 offen offset:2048 lds
  v_mov_b32 v29, v25
  v_mfma_f32_16x16x32_bf16 v[204:207], a[128:131], a[108:111], v[204:207]
  ds_read_b64_tr_b16 a[166:167], v1 offset:10752
  v_permlane16_swap_b32 v22, v26
  v_mfma_f32_16x16x32_bf16 v[220:223], a[136:139], a[108:111], v[220:223]
  ds_read_b64_tr_b16 a[168:169], v1 offset:32
  v_permlane16_swap_b32 v23, v27
  v_mfma_f32_16x16x32_bf16 v[220:223], a[140:143], a[124:127], v[220:223]
  v_permlane16_swap_b32 v24, v28
  v_permlane16_swap_b32 v25, v29
  v_mfma_f32_16x16x32_bf16 v[216:219], a[140:143], a[120:123], v[216:219]
  s_add_u32 s57, s57, 16384
  ds_read_b64_tr_b16 a[170:171], v1 offset:3616
  v_add_f32 v22, v22, v26
  v_mfma_f32_16x16x32_bf16 v[216:219], a[136:139], a[104:107], v[216:219]
  buffer_load_dwordx4 a[40:43], v0, s[36:39], s53 offen offset:2048 sc1
  v_add_f32 v23, v23, v27
  v_mfma_f32_16x16x32_bf16 v[212:215], a[136:139], a[100:103], v[212:215]
  ds_read_b64_tr_b16 a[172:173], v1 offset:7200
  v_add_f32 v24, v24, v28
  v_mfma_f32_16x16x32_bf16 v[212:215], a[140:143], a[116:119], v[212:215]
  v_add_f32 v25, v25, v29
  v_mov_b32 v26, v22
  v_mfma_f32_16x16x32_bf16 v[208:211], a[140:143], a[112:115], v[208:211]
  ds_read_b64_tr_b16 a[174:175], v1 offset:10784
  v_mov_b32 v27, v23
  v_mfma_f32_16x16x32_bf16 v[208:211], a[136:139], a[96:99], v[208:211]
  s_waitcnt lgkmcnt(8)
  v_mov_b32 v28, v24
  v_mov_b32 v29, v25
  v_mfma_f32_16x16x32_bf16 v[224:227], a[144:147], a[96:99], v[224:227]
  buffer_load_dwordx4 a[208:211], v0, s[36:39], s57 offen offset:0 sc1
  v_permlane32_swap_b32 v22, v26
  v_mfma_f32_16x16x32_bf16 v[224:227], a[148:151], a[112:115], v[224:227]
  ds_read_b64_tr_b16 a[128:129], v1 offset:64
  v_permlane32_swap_b32 v23, v27
  v_mfma_f32_16x16x32_bf16 v[228:231], a[148:151], a[116:119], v[228:231]
  ds_read_b64_tr_b16 a[130:131], v1 offset:3648
  v_permlane32_swap_b32 v24, v28
  v_mfma_f32_16x16x32_bf16 v[228:231], a[144:147], a[100:103], v[228:231]
  v_permlane32_swap_b32 v25, v29
  v_add_f32 v22, v22, v26
  v_mfma_f32_16x16x32_bf16 v[232:235], a[144:147], a[104:107], v[232:235]
  ds_read_b64_tr_b16 a[132:133], v1 offset:7232
  v_add_f32 v23, v23, v27
  v_mfma_f32_16x16x32_bf16 v[232:235], a[148:151], a[120:123], v[232:235]
  buffer_load_dwordx4 a[212:215], v0, s[36:39], s57 offen offset:1024 sc1
  v_add_f32 v24, v24, v28
  v_mfma_f32_16x16x32_bf16 v[236:239], a[148:151], a[124:127], v[236:239]
  ds_read_b64_tr_b16 a[134:135], v1 offset:10816
  v_add_f32 v25, v25, v29
  v_mfma_f32_16x16x32_bf16 v[236:239], a[144:147], a[108:111], v[236:239]
  v_mul_f32 v22, 0x3a800000, v22
  v_mul_f32 v23, 0x3a800000, v23
  v_mfma_f32_16x16x32_bf16 v[252:255], a[152:155], a[108:111], v[252:255]
  ds_read_b64_tr_b16 a[136:137], v1 offset:96
  v_fma_f32 v23, -v22, v22, v23
  v_mfma_f32_16x16x32_bf16 v[252:255], a[156:159], a[124:127], v[252:255]
  v_max_f32 v23, 0, v23
  v_cvt_pk_bf16_f32 v23, v23, v23
  v_mfma_f32_16x16x32_bf16 v[248:251], a[156:159], a[120:123], v[248:251]
  buffer_load_dwordx4 a[44:47], v0, s[36:39], s53 offen offset:3072 sc1
  s_bfe_u32 s52, s87, 0x40008
  v_mfma_f32_16x16x32_bf16 v[248:251], a[152:155], a[104:107], v[248:251]
  s_mul_i32 s52, s52, 458752
  s_add_u32 m0, s88, 57344
  ds_read_b64_tr_b16 a[138:139], v1 offset:3680
  v_mfma_f32_16x16x32_bf16 v[244:247], a[152:155], a[100:103], v[244:247]
  ds_read_b64_tr_b16 a[140:141], v1 offset:7264
  v_lshlrev_b32 v23, 16, v23
  v_mfma_f32_16x16x32_bf16 v[244:247], a[156:159], a[116:119], v[244:247]
  v_add_f32 v23, 0x3727c5ac, v23
  v_cvt_pk_bf16_f32 v23, v23, v23
  v_mfma_f32_16x16x32_bf16 v[240:243], a[156:159], a[112:115], v[240:243]
  ds_read_b64_tr_b16 a[142:143], v1 offset:10848
  v_lshlrev_b32 v23, 16, v23
  v_mfma_f32_16x16x32_bf16 v[240:243], a[152:155], a[96:99], v[240:243]
  s_waitcnt vmcnt(9) lgkmcnt(8)
  buffer_load_dwordx4 v3, s[16:19], s52 offen offset:0 lds
  v_mfma_f32_16x16x32_bf16 v[32:35], a[160:163], a[0:3], v[32:35]
  s_add_u32 s53, s53, 4096
  ds_read_b64_tr_b16 a[144:145], v1 offset:128
  v_mfma_f32_16x16x32_bf16 v[32:35], a[164:167], a[16:19], v[32:35]
  s_barrier
  v_sqrt_f32 v23, v23
  v_mfma_f32_16x16x32_bf16 v[36:39], a[164:167], a[20:23], v[36:39]
  s_nop 0
  ds_read_b64_tr_b16 a[146:147], v1 offset:3712
  v_cvt_pk_bf16_f32 v12, -v22, v23
  v_mfma_f32_16x16x32_bf16 v[36:39], a[160:163], a[4:7], v[36:39]
  v_and_b32 v23, 0xffff0000, v12
  v_mfma_f32_16x16x32_bf16 v[40:43], a[160:163], a[8:11], v[40:43]
  buffer_load_dwordx4 a[48:51], v0, s[36:39], s53 offen offset:0 sc1
  v_mfma_f32_16x16x32_bf16 v[40:43], a[164:167], a[24:27], v[40:43]
  ds_read_b64_tr_b16 a[148:149], v1 offset:7296
  v_mfma_f32_16x16x32_bf16 v[44:47], a[164:167], a[28:31], v[44:47]
  ds_read_b64_tr_b16 a[150:151], v1 offset:10880
  v_mfma_f32_16x16x32_bf16 v[44:47], a[160:163], a[12:15], v[44:47]
  v_rcp_f32 v10, v23
  v_mfma_f32_16x16x32_bf16 v[60:63], a[168:171], a[12:15], v[60:63]
  ds_read_b64_tr_b16 a[152:153], v1 offset:160
  v_mul_f32 v11, v23, v23
  v_mfma_f32_16x16x32_bf16 v[60:63], a[172:175], a[28:31], v[60:63]
  v_mul_f32 v10, 0xbfb8aa3b, v10
  v_mul_f32 v24, 0x3a800000, v24
  v_mfma_f32_16x16x32_bf16 v[56:59], a[172:175], a[24:27], v[56:59]
  ds_read_b64_tr_b16 a[154:155], v1 offset:3744
  v_mul_f32 v25, 0x3a800000, v25
  v_mfma_f32_16x16x32_bf16 v[56:59], a[168:171], a[8:11], v[56:59]
  buffer_load_dwordx4 v4, s[16:19], s52 offen offset:1024 lds
  v_fma_f32 v25, -v24, v24, v25
  v_mfma_f32_16x16x32_bf16 v[52:55], a[168:171], a[4:7], v[52:55]
  ds_read_b64_tr_b16 a[156:157], v1 offset:7328
  v_max_f32 v25, 0, v25
  v_mfma_f32_16x16x32_bf16 v[52:55], a[172:175], a[20:23], v[52:55]
  v_cvt_pk_bf16_f32 v25, v25, v25
  v_lshlrev_b32 v25, 16, v25
  v_mfma_f32_16x16x32_bf16 v[48:51], a[172:175], a[16:19], v[48:51]
  ds_read_b64_tr_b16 a[158:159], v1 offset:10912
  v_add_f32 v25, 0x3727c5ac, v25
  v_mfma_f32_16x16x32_bf16 v[48:51], a[168:171], a[0:3], v[48:51]
  s_waitcnt lgkmcnt(8)
  v_cvt_pk_bf16_f32 v25, v25, v25
  v_lshlrev_b32 v25, 16, v25
  v_mfma_f32_16x16x32_bf16 v[64:67], a[128:131], a[0:3], v[64:67]
  ds_read_b64_tr_b16 a[160:161], v1 offset:192
  v_mfma_f32_16x16x32_bf16 v[64:67], a[132:135], a[16:19], v[64:67]
  v_sqrt_f32 v25, v25
  v_mfma_f32_16x16x32_bf16 v[68:71], a[132:135], a[20:23], v[68:71]
  s_nop 0
  ds_read_b64_tr_b16 a[162:163], v1 offset:3776
  v_cvt_pk_bf16_f32 v15, -v24, v25
  v_mfma_f32_16x16x32_bf16 v[68:71], a[128:131], a[4:7], v[68:71]
  buffer_load_dwordx4 a[52:55], v0, s[36:39], s53 offen offset:1024 sc1
  v_and_b32 v25, 0xffff0000, v15
  v_mfma_f32_16x16x32_bf16 v[72:75], a[128:131], a[8:11], v[72:75]
  ds_read_b64_tr_b16 a[164:165], v1 offset:7360
  v_mfma_f32_16x16x32_bf16 v[72:75], a[132:135], a[24:27], v[72:75]
  v_rcp_f32 v13, v25
  v_mfma_f32_16x16x32_bf16 v[76:79], a[132:135], a[28:31], v[76:79]
  ds_read_b64_tr_b16 a[166:167], v1 offset:10944
  v_mul_f32 v14, v25, v25
  v_mfma_f32_16x16x32_bf16 v[76:79], a[128:131], a[12:15], v[76:79]
  v_mul_f32 v13, 0xbfb8aa3b, v13
  v_accvgpr_read_b32 v22, a192
  v_mfma_f32_16x16x32_bf16 v[92:95], a[136:139], a[12:15], v[92:95]
  ds_read_b64_tr_b16 a[168:169], v1 offset:14336
  v_accvgpr_read_b32 v23, a193
  v_mfma_f32_16x16x32_bf16 v[92:95], a[140:143], a[28:31], v[92:95]
  v_accvgpr_read_b32 v24, a194
  v_accvgpr_read_b32 v25, a195
  v_mfma_f32_16x16x32_bf16 v[88:91], a[140:143], a[24:27], v[88:91]
  buffer_load_dwordx4 v5, s[16:19], s52 offen offset:2048 lds
  v_accvgpr_read_b32 v26, a196
  v_mfma_f32_16x16x32_bf16 v[88:91], a[136:139], a[8:11], v[88:91]
  ds_read_b64_tr_b16 a[170:171], v1 offset:17920
  v_accvgpr_read_b32 v27, a197
  v_mfma_f32_16x16x32_bf16 v[84:87], a[136:139], a[4:7], v[84:87]
  ds_read_b64_tr_b16 a[172:173], v1 offset:21504
  v_accvgpr_read_b32 v28, a198
  v_mfma_f32_16x16x32_bf16 v[84:87], a[140:143], a[20:23], v[84:87]
  v_accvgpr_read_b32 v29, a199
  v_add_f32 v22, v22, v26
  v_mfma_f32_16x16x32_bf16 v[80:83], a[140:143], a[16:19], v[80:83]
  ds_read_b64_tr_b16 a[174:175], v1 offset:25088
  v_add_f32 v23, v23, v27
  v_mfma_f32_16x16x32_bf16 v[80:83], a[136:139], a[0:3], v[80:83]
  s_waitcnt lgkmcnt(8)
  v_add_f32 v24, v24, v28
  v_add_f32 v25, v25, v29
  v_mfma_f32_16x16x32_bf16 v[96:99], a[144:147], a[0:3], v[96:99]
  ds_read_b64_tr_b16 a[128:129], v1 offset:14368
  v_accvgpr_read_b32 v26, a200
  v_mfma_f32_16x16x32_bf16 v[96:99], a[148:151], a[16:19], v[96:99]
  v_accvgpr_read_b32 v27, a201
  v_accvgpr_read_b32 v28, a202
  v_mfma_f32_16x16x32_bf16 v[100:103], a[148:151], a[20:23], v[100:103]
  buffer_load_dwordx4 a[56:59], v0, s[36:39], s53 offen offset:2048 sc1
  v_accvgpr_read_b32 v29, a203
  v_mfma_f32_16x16x32_bf16 v[100:103], a[144:147], a[4:7], v[100:103]
  ds_read_b64_tr_b16 a[130:131], v1 offset:17952
  v_add_f32 v22, v22, v26
  v_mfma_f32_16x16x32_bf16 v[104:107], a[144:147], a[8:11], v[104:107]
  ds_read_b64_tr_b16 a[132:133], v1 offset:21536
  v_add_f32 v23, v23, v27
  v_mfma_f32_16x16x32_bf16 v[104:107], a[148:151], a[24:27], v[104:107]
  v_add_f32 v24, v24, v28
  v_add_f32 v25, v25, v29
  v_mfma_f32_16x16x32_bf16 v[108:111], a[148:151], a[28:31], v[108:111]
  ds_read_b64_tr_b16 a[134:135], v1 offset:25120
  v_accvgpr_read_b32 v26, a204
  v_mfma_f32_16x16x32_bf16 v[108:111], a[144:147], a[12:15], v[108:111]
  v_accvgpr_read_b32 v27, a205
  v_accvgpr_read_b32 v28, a206
  v_mfma_f32_16x16x32_bf16 v[124:127], a[152:155], a[12:15], v[124:127]
  ds_read_b64_tr_b16 a[136:137], v1 offset:14400
  v_accvgpr_read_b32 v29, a207
  v_mfma_f32_16x16x32_bf16 v[124:127], a[156:159], a[28:31], v[124:127]
  buffer_load_dwordx4 v6, s[16:19], s52 offen offset:3072 lds
  v_add_f32 v22, v22, v26
  v_mfma_f32_16x16x32_bf16 v[120:123], a[156:159], a[24:27], v[120:123]
  ds_read_b64_tr_b16 a[138:139], v1 offset:17984
  v_add_f32 v23, v23, v27
  v_mfma_f32_16x16x32_bf16 v[120:123], a[152:155], a[8:11], v[120:123]
  v_add_f32 v24, v24, v28
  v_add_f32 v25, v25, v29
  v_mfma_f32_16x16x32_bf16 v[116:119], a[152:155], a[4:7], v[116:119]
  ds_read_b64_tr_b16 a[140:141], v1 offset:21568
  v_mov_b32 v26, v22
  v_mfma_f32_16x16x32_bf16 v[116:119], a[156:159], a[20:23], v[116:119]
  v_mov_b32 v27, v23
  v_mov_b32 v28, v24
  v_mfma_f32_16x16x32_bf16 v[112:115], a[156:159], a[16:19], v[112:115]
  ds_read_b64_tr_b16 a[142:143], v1 offset:25152
  v_mov_b32 v29, v25
  v_mfma_f32_16x16x32_bf16 v[112:115], a[152:155], a[0:3], v[112:115]
  s_waitcnt lgkmcnt(8)
  v_permlane16_swap_b32 v22, v26
  v_permlane16_swap_b32 v23, v27
  v_mfma_f32_16x16x32_bf16 v[128:131], a[160:163], a[0:3], v[128:131]
  ds_read_b64_tr_b16 a[144:145], v1 offset:14432
  v_permlane16_swap_b32 v24, v28
  v_mfma_f32_16x16x32_bf16 v[128:131], a[164:167], a[16:19], v[128:131]
  buffer_load_dwordx4 a[60:63], v0, s[36:39], s53 offen offset:3072 sc1
  v_permlane16_swap_b32 v25, v29
  v_mfma_f32_16x16x32_bf16 v[132:135], a[164:167], a[20:23], v[132:135]
  s_add_u32 m0, s88, 61440
  ds_read_b64_tr_b16 a[146:147], v1 offset:18016
  v_add_f32 v22, v22, v26
  v_mfma_f32_16x16x32_bf16 v[132:135], a[160:163], a[4:7], v[132:135]
  v_add_f32 v23, v23, v27
  v_add_f32 v24, v24, v28
  v_mfma_f32_16x16x32_bf16 v[136:139], a[160:163], a[8:11], v[136:139]
  ds_read_b64_tr_b16 a[148:149], v1 offset:21600
  v_add_f32 v25, v25, v29
  v_mfma_f32_16x16x32_bf16 v[136:139], a[164:167], a[24:27], v[136:139]
  v_mov_b32 v26, v22
  v_mov_b32 v27, v23
  v_mfma_f32_16x16x32_bf16 v[140:143], a[164:167], a[28:31], v[140:143]
  buffer_load_dwordx4 v7, s[16:19], s52 offen offset:0 lds
  s_bfe_u32 s53, s87, 0x40008
  v_mfma_f32_16x16x32_bf16 v[140:143], a[160:163], a[12:15], v[140:143]
  s_lshl_b32 s53, s53, 13
  s_add_u32 s53, s53, s89
  ds_read_b64_tr_b16 a[150:151], v1 offset:25184
  v_mfma_f32_16x16x32_bf16 v[156:159], a[168:171], a[12:15], v[156:159]
  ds_read_b64_tr_b16 a[152:153], v1 offset:14464
  v_mov_b32 v28, v24
  v_mfma_f32_16x16x32_bf16 v[156:159], a[172:175], a[28:31], v[156:159]
  v_mov_b32 v29, v25
  v_permlane32_swap_b32 v22, v26
  v_mfma_f32_16x16x32_bf16 v[152:155], a[172:175], a[24:27], v[152:155]
  ds_read_b64_tr_b16 a[154:155], v1 offset:18048
  v_permlane32_swap_b32 v23, v27
  v_mfma_f32_16x16x32_bf16 v[152:155], a[168:171], a[8:11], v[152:155]
  buffer_load_dwordx4 a[64:67], v0, s[36:39], s53 offen offset:0 sc1
  v_permlane32_swap_b32 v24, v28
  v_mfma_f32_16x16x32_bf16 v[148:151], a[168:171], a[4:7], v[148:151]
  ds_read_b64_tr_b16 a[156:157], v1 offset:21632
  v_permlane32_swap_b32 v25, v29
  v_mfma_f32_16x16x32_bf16 v[148:151], a[172:175], a[20:23], v[148:151]
  v_add_f32 v22, v22, v26
  v_add_f32 v23, v23, v27
  v_mfma_f32_16x16x32_bf16 v[144:147], a[172:175], a[16:19], v[144:147]
  ds_read_b64_tr_b16 a[158:159], v1 offset:25216
  v_add_f32 v24, v24, v28
  v_mfma_f32_16x16x32_bf16 v[144:147], a[168:171], a[0:3], v[144:147]
  s_waitcnt lgkmcnt(8)
  v_add_f32 v25, v25, v29
  v_mul_f32 v22, 0x3a800000, v22
  v_mfma_f32_16x16x32_bf16 v[160:163], a[128:131], a[0:3], v[160:163]
  ds_read_b64_tr_b16 a[160:161], v1 offset:14496
  v_mul_f32 v23, 0x3a800000, v23
  v_mfma_f32_16x16x32_bf16 v[160:163], a[132:135], a[16:19], v[160:163]
  v_fma_f32 v23, -v22, v22, v23
  v_max_f32 v23, 0, v23
  v_mfma_f32_16x16x32_bf16 v[164:167], a[132:135], a[20:23], v[164:167]
  buffer_load_dwordx4 v8, s[16:19], s52 offen offset:1024 lds
  v_cvt_pk_bf16_f32 v23, v23, v23
  v_mfma_f32_16x16x32_bf16 v[164:167], a[128:131], a[4:7], v[164:167]
  ds_read_b64_tr_b16 a[162:163], v1 offset:18080
  v_lshlrev_b32 v23, 16, v23
  v_mfma_f32_16x16x32_bf16 v[168:171], a[128:131], a[8:11], v[168:171]
  ds_read_b64_tr_b16 a[164:165], v1 offset:21664
  v_add_f32 v23, 0x3727c5ac, v23
  v_mfma_f32_16x16x32_bf16 v[168:171], a[132:135], a[24:27], v[168:171]
  v_cvt_pk_bf16_f32 v23, v23, v23
  v_lshlrev_b32 v23, 16, v23
  v_mfma_f32_16x16x32_bf16 v[172:175], a[132:135], a[28:31], v[172:175]
  ds_read_b64_tr_b16 a[166:167], v1 offset:25248
  v_mfma_f32_16x16x32_bf16 v[172:175], a[128:131], a[12:15], v[172:175]
  s_waitcnt vmcnt(15)
  s_barrier
  buffer_load_dwordx4 a[68:71], v0, s[36:39], s53 offen offset:1024 sc1
  v_mfma_f32_16x16x32_bf16 v[188:191], a[136:139], a[12:15], v[188:191]
  ds_read_b64_tr_b16 a[168:169], v1 offset:14528
  v_mfma_f32_16x16x32_bf16 v[188:191], a[140:143], a[28:31], v[188:191]
  v_sqrt_f32 v23, v23
  v_mfma_f32_16x16x32_bf16 v[184:187], a[140:143], a[24:27], v[184:187]
  s_nop 0
  ds_read_b64_tr_b16 a[170:171], v1 offset:18112
  v_cvt_pk_bf16_f32 v18, -v22, v23
  v_mfma_f32_16x16x32_bf16 v[184:187], a[136:139], a[8:11], v[184:187]
  v_and_b32 v23, 0xffff0000, v18
  v_mfma_f32_16x16x32_bf16 v[180:183], a[136:139], a[4:7], v[180:183]
  ds_read_b64_tr_b16 a[172:173], v1 offset:21696
  v_mfma_f32_16x16x32_bf16 v[180:183], a[140:143], a[20:23], v[180:183]
  v_rcp_f32 v16, v23
  v_mfma_f32_16x16x32_bf16 v[176:179], a[140:143], a[16:19], v[176:179]
  buffer_load_dwordx4 v9, s[16:19], s52 offen offset:2048 lds
  v_mul_f32 v17, v23, v23
  v_mfma_f32_16x16x32_bf16 v[176:179], a[136:139], a[0:3], v[176:179]
  s_waitcnt lgkmcnt(7)
  ds_read_b64_tr_b16 a[174:175], v1 offset:25280
  v_mul_f32 v16, 0xbfb8aa3b, v16
  v_mfma_f32_16x16x32_bf16 v[192:195], a[144:147], a[0:3], v[192:195]
  ds_read_b64_tr_b16 a[128:129], v1 offset:28672
  v_mul_f32 v24, 0x3a800000, v24
  v_mfma_f32_16x16x32_bf16 v[192:195], a[148:151], a[16:19], v[192:195]
  v_mul_f32 v25, 0x3a800000, v25
  v_fma_f32 v25, -v24, v24, v25
  v_mfma_f32_16x16x32_bf16 v[196:199], a[148:151], a[20:23], v[196:199]
  ds_read_b64_tr_b16 a[130:131], v1 offset:32256
  v_max_f32 v25, 0, v25
  v_mfma_f32_16x16x32_bf16 v[196:199], a[144:147], a[4:7], v[196:199]
  v_cvt_pk_bf16_f32 v25, v25, v25
  v_lshlrev_b32 v25, 16, v25
  v_mfma_f32_16x16x32_bf16 v[200:203], a[144:147], a[8:11], v[200:203]
  ds_read_b64_tr_b16 a[132:133], v1 offset:35840
  v_add_f32 v25, 0x3727c5ac, v25
  v_mfma_f32_16x16x32_bf16 v[200:203], a[148:151], a[24:27], v[200:203]
  v_cvt_pk_bf16_f32 v25, v25, v25
  v_lshlrev_b32 v25, 16, v25
  v_mfma_f32_16x16x32_bf16 v[204:207], a[148:151], a[28:31], v[204:207]
  buffer_load_dwordx4 a[72:75], v0, s[36:39], s53 offen offset:2048 sc1
  v_mfma_f32_16x16x32_bf16 v[204:207], a[144:147], a[12:15], v[204:207]
  ds_read_b64_tr_b16 a[134:135], v1 offset:39424
  v_mfma_f32_16x16x32_bf16 v[220:223], a[152:155], a[12:15], v[220:223]
  ds_read_b64_tr_b16 a[136:137], v1 offset:28704
  v_mfma_f32_16x16x32_bf16 v[220:223], a[156:159], a[28:31], v[220:223]
  v_sqrt_f32 v25, v25
  v_mfma_f32_16x16x32_bf16 v[216:219], a[156:159], a[24:27], v[216:219]
  s_nop 0
  ds_read_b64_tr_b16 a[138:139], v1 offset:32288
  v_cvt_pk_bf16_f32 v21, -v24, v25
  v_mfma_f32_16x16x32_bf16 v[216:219], a[152:155], a[8:11], v[216:219]
  v_and_b32 v25, 0xffff0000, v21
  v_mfma_f32_16x16x32_bf16 v[212:215], a[152:155], a[4:7], v[212:215]
  s_bfe_u32 s52, s87, 0x4000c
  s_mul_i32 s52, s52, 458752
  s_add_u32 m0, s88, 86016
  v_mfma_f32_16x16x32_bf16 v[212:215], a[156:159], a[20:23], v[212:215]
  ds_read_b64_tr_b16 a[140:141], v1 offset:35872
  v_mfma_f32_16x16x32_bf16 v[208:211], a[156:159], a[16:19], v[208:211]
  ds_read_b64_tr_b16 a[142:143], v1 offset:39456
  v_mfma_f32_16x16x32_bf16 v[208:211], a[152:155], a[0:3], v[208:211]
  s_waitcnt lgkmcnt(8)
  v_rcp_f32 v19, v25
  v_mfma_f32_16x16x32_bf16 v[224:227], a[160:163], a[0:3], v[224:227]
  buffer_load_dwordx4 v3, s[16:19], s52 offen offset:0 lds
  v_mul_f32 v20, v25, v25
  v_mfma_f32_16x16x32_bf16 v[224:227], a[164:167], a[16:19], v[224:227]
  v_mul_f32 v19, 0xbfb8aa3b, v19
  v_add_u32 v31, -28672, v31
  v_mfma_f32_16x16x32_bf16 v[228:231], a[164:167], a[20:23], v[228:231]
  ds_read_b64_tr_b16 a[176:177], v31 offset:0
  v_mfma_f32_16x16x32_bf16 v[228:231], a[160:163], a[4:7], v[228:231]
  ds_read_b64_tr_b16 a[178:179], v31 offset:3584
  v_mfma_f32_16x16x32_bf16 v[232:235], a[160:163], a[8:11], v[232:235]
  ds_read_b64_tr_b16 a[180:181], v31 offset:7168
  v_mfma_f32_16x16x32_bf16 v[232:235], a[164:167], a[24:27], v[232:235]
  buffer_load_dwordx4 a[76:79], v0, s[36:39], s53 offen offset:3072 sc1
  v_mfma_f32_16x16x32_bf16 v[236:239], a[164:167], a[28:31], v[236:239]
  ds_read_b64_tr_b16 a[182:183], v31 offset:10752
  v_mfma_f32_16x16x32_bf16 v[236:239], a[160:163], a[12:15], v[236:239]
  ds_read_b64_tr_b16 a[184:185], v31 offset:32
  v_mfma_f32_16x16x32_bf16 v[252:255], a[168:171], a[12:15], v[252:255]
  ds_read_b64_tr_b16 a[144:145], v1 offset:28736
  v_mfma_f32_16x16x32_bf16 v[252:255], a[172:175], a[28:31], v[252:255]
  ds_read_b64_tr_b16 a[186:187], v31 offset:3616
  v_mfma_f32_16x16x32_bf16 v[248:251], a[172:175], a[24:27], v[248:251]
  ds_read_b64_tr_b16 a[146:147], v1 offset:32320
  v_mfma_f32_16x16x32_bf16 v[248:251], a[168:171], a[8:11], v[248:251]
  ds_read_b64_tr_b16 a[188:189], v31 offset:7200
  v_mfma_f32_16x16x32_bf16 v[244:247], a[168:171], a[4:7], v[244:247]
  buffer_load_dwordx4 v4, s[16:19], s52 offen offset:1024 lds
  v_mfma_f32_16x16x32_bf16 v[244:247], a[172:175], a[20:23], v[244:247]
  ds_read_b64_tr_b16 a[148:149], v1 offset:35904
  v_mfma_f32_16x16x32_bf16 v[240:243], a[172:175], a[16:19], v[240:243]
  s_add_u32 s53, s53, 4096
  ds_read_b64_tr_b16 a[150:151], v1 offset:39488
  v_mfma_f32_16x16x32_bf16 v[240:243], a[168:171], a[0:3], v[240:243]
  s_waitcnt vmcnt(9) lgkmcnt(11)
  ds_read_b64_tr_b16 a[190:191], v31 offset:10784
  v_mfma_f32_16x16x32_bf16 v[32:35], a[128:131], a[32:35], v[32:35]
  ds_read_b64_tr_b16 a[152:153], v1 offset:28768
  v_mfma_f32_16x16x32_bf16 v[32:35], a[132:135], a[48:51], v[32:35]
  s_barrier
  ds_read_b64_tr_b16 a[192:193], v31 offset:64
  v_mfma_f32_16x16x32_bf16 v[36:39], a[132:135], a[52:55], v[36:39]
  buffer_load_dwordx4 a[80:83], v0, s[36:39], s53 offen offset:0 sc1
  v_mfma_f32_16x16x32_bf16 v[36:39], a[128:131], a[36:39], v[36:39]
  ds_read_b64_tr_b16 a[154:155], v1 offset:32352
  v_mfma_f32_16x16x32_bf16 v[40:43], a[128:131], a[40:43], v[40:43]
  ds_read_b64_tr_b16 a[156:157], v1 offset:35936
  v_mfma_f32_16x16x32_bf16 v[40:43], a[132:135], a[56:59], v[40:43]
  ds_read_b64_tr_b16 a[194:195], v31 offset:3648
  v_mfma_f32_16x16x32_bf16 v[44:47], a[132:135], a[60:63], v[44:47]
  ds_read_b64_tr_b16 a[196:197], v31 offset:7232
  ds_read_b64_tr_b16 a[198:199], v31 offset:10816
  ds_read_b64_tr_b16 a[200:201], v31 offset:96
  ds_read_b64_tr_b16 a[202:203], v31 offset:3680
  ds_read_b64_tr_b16 a[204:205], v31 offset:7264
  ds_read_b64_tr_b16 a[206:207], v31 offset:10848
  v_mfma_f32_16x16x32_bf16 v[44:47], a[128:131], a[44:47], v[44:47]
  ds_read_b64_tr_b16 a[158:159], v1 offset:39520
  v_lshrrev_b32 v22, 4, v0
  v_mfma_f32_16x16x32_bf16 v[60:63], a[136:139], a[44:47], v[60:63]
  buffer_load_dwordx4 v5, s[16:19], s52 offen offset:2048 lds
  v_and_b32 v23, 14, v22
  v_mfma_f32_16x16x32_bf16 v[60:63], a[140:143], a[60:63], v[60:63]
  ds_read_b64_tr_b16 a[160:161], v1 offset:28800
  v_lshlrev_b32 v23, 27, v23
  v_mfma_f32_16x16x32_bf16 v[56:59], a[140:143], a[56:59], v[56:59]
  ds_read_b64_tr_b16 a[162:163], v1 offset:32384
  v_and_b32 v24, 1, v22
  v_mfma_f32_16x16x32_bf16 v[56:59], a[136:139], a[40:43], v[56:59]
  v_lshl_add_u32 v23, v24, 9, v23
  v_and_b32 v22, 0x30, v22
  v_mfma_f32_16x16x32_bf16 v[52:55], a[136:139], a[36:39], v[52:55]
  ds_read_b64_tr_b16 a[164:165], v1 offset:35968
  v_add_u32 v22, v22, v23
  v_mfma_f32_16x16x32_bf16 v[52:55], a[140:143], a[52:55], v[52:55]
  s_lshl3_add_u32 s67, s59, s56
  buffer_load_dwordx4 a[84:87], v0, s[36:39], s53 offen offset:1024 sc1
  s_lshr_b32 s68, s44, 1
  v_mfma_f32_16x16x32_bf16 v[48:51], a[140:143], a[48:51], v[48:51]
  s_lshl1_add_u32 s67, s67, s68
  ds_read_b64_tr_b16 a[166:167], v1 offset:39552
  s_and_b32 s68, s44, 1
  v_mfma_f32_16x16x32_bf16 v[48:51], a[136:139], a[32:35], v[48:51]
  s_waitcnt vmcnt(21) lgkmcnt(5)
  s_lshl2_add_u32 s67, s67, s68
  s_lshl_b32 s67, s67, 8
  v_mfma_f32_16x16x32_bf16 a[216:219], a[176:179], a[208:211], a[216:219]
  s_add_u32 s67, s67, 524288
  ds_read_b64_tr_b16 a[168:169], v1 offset:28832
  v_mfma_f32_16x16x32_bf16 a[216:219], a[180:183], a[212:215], a[216:219]
  v_mfma_f32_16x16x32_bf16 a[220:223], a[184:187], a[208:211], a[220:223]
  ds_read_b64_tr_b16 a[170:171], v1 offset:32416
  v_mfma_f32_16x16x32_bf16 a[220:223], a[188:191], a[212:215], a[220:223]
  v_mfma_f32_16x16x32_bf16 a[224:227], a[192:195], a[208:211], a[224:227]
  buffer_load_dwordx4 v6, s[16:19], s52 offen offset:3072 lds
  v_mfma_f32_16x16x32_bf16 a[224:227], a[196:199], a[212:215], a[224:227]
  ds_read_b64_tr_b16 a[172:173], v1 offset:36000
  v_mfma_f32_16x16x32_bf16 a[228:231], a[200:203], a[208:211], a[228:231]
  ds_read_b64_tr_b16 a[174:175], v1 offset:39584
  v_mfma_f32_16x16x32_bf16 a[228:231], a[204:207], a[212:215], a[228:231]
  s_waitcnt lgkmcnt(8)
  v_mfma_f32_16x16x32_bf16 v[64:67], a[144:147], a[32:35], v[64:67]
  ds_read_b64_tr_b16 a[128:129], v1 offset:28864
  v_mfma_f32_16x16x32_bf16 v[64:67], a[148:151], a[48:51], v[64:67]
  buffer_load_dwordx4 a[88:91], v0, s[36:39], s53 offen offset:2048 sc1
  v_mfma_f32_16x16x32_bf16 v[68:71], a[148:151], a[52:55], v[68:71]
Hb0_1:
  s_cbranch_execz Hb0_2
  ds_read_b64_tr_b16 a[130:131], v1 offset:32448
  v_mfma_f32_16x16x32_bf16 v[68:71], a[144:147], a[36:39], v[68:71]
  s_add_u32 m0, s88, 90112
  v_mfma_f32_16x16x32_bf16 v[72:75], a[144:147], a[40:43], v[72:75]
  ds_read_b64_tr_b16 a[132:133], v1 offset:36032
  v_mfma_f32_16x16x32_bf16 v[72:75], a[148:151], a[56:59], v[72:75]
  v_mfma_f32_16x16x32_bf16 v[76:79], a[148:151], a[60:63], v[76:79]
  ds_read_b64_tr_b16 a[134:135], v1 offset:39616
  v_mfma_f32_16x16x32_bf16 v[76:79], a[144:147], a[44:47], v[76:79]
  buffer_load_dwordx4 v7, s[16:19], s52 offen offset:0 lds
  v_mfma_f32_16x16x32_bf16 v[92:95], a[152:155], a[44:47], v[92:95]
  ds_read_b64_tr_b16 a[136:137], v1 offset:43008
  v_mfma_f32_16x16x32_bf16 v[92:95], a[156:159], a[60:63], v[92:95]
  v_mfma_f32_16x16x32_bf16 v[88:91], a[156:159], a[56:59], v[88:91]
  ds_read_b64_tr_b16 a[138:139], v1 offset:46592
  v_mfma_f32_16x16x32_bf16 v[88:91], a[152:155], a[40:43], v[88:91]
  v_mfma_f32_16x16x32_bf16 v[84:87], a[152:155], a[36:39], v[84:87]
  buffer_load_dwordx4 a[92:95], v0, s[36:39], s53 offen offset:3072 sc1
  s_bfe_u32 s53, s87, 0x4000c
  v_mfma_f32_16x16x32_bf16 v[84:87], a[156:159], a[52:55], v[84:87]
  s_lshl_b32 s53, s53, 13
  s_add_u32 s53, s53, s89
  ds_read_b64_tr_b16 a[140:141], v1 offset:50176
  v_mfma_f32_16x16x32_bf16 v[80:83], a[156:159], a[48:51], v[80:83]
  ds_read_b64_tr_b16 a[142:143], v1 offset:53760
  v_mfma_f32_16x16x32_bf16 v[80:83], a[152:155], a[32:35], v[80:83]
  s_waitcnt lgkmcnt(8)
  v_mfma_f32_16x16x32_bf16 v[96:99], a[160:163], a[32:35], v[96:99]
  ds_read_b64_tr_b16 a[144:145], v1 offset:43040
  v_mfma_f32_16x16x32_bf16 v[96:99], a[164:167], a[48:51], v[96:99]
  buffer_load_dwordx4 a[96:99], v0, s[36:39], s53 offen offset:0 sc1
  v_mfma_f32_16x16x32_bf16 v[100:103], a[164:167], a[52:55], v[100:103]
  buffer_store_dwordx4 a[216:219], v22, s[36:39], s67 offen offset:0 sc1
  v_mfma_f32_16x16x32_bf16 v[100:103], a[160:163], a[36:39], v[100:103]
  ds_read_b64_tr_b16 a[146:147], v1 offset:46624
  v_mfma_f32_16x16x32_bf16 v[104:107], a[160:163], a[40:43], v[104:107]
  ds_read_b64_tr_b16 a[148:149], v1 offset:50208
  v_mfma_f32_16x16x32_bf16 v[104:107], a[164:167], a[56:59], v[104:107]
  v_mfma_f32_16x16x32_bf16 v[108:111], a[164:167], a[60:63], v[108:111]
  buffer_store_dwordx4 a[220:223], v22, s[36:39], s67 offen offset:64 sc1
  v_mfma_f32_16x16x32_bf16 v[108:111], a[160:163], a[44:47], v[108:111]
  ds_read_b64_tr_b16 a[150:151], v1 offset:53792
  v_mfma_f32_16x16x32_bf16 v[124:127], a[168:171], a[44:47], v[124:127]
  ds_read_b64_tr_b16 a[152:153], v1 offset:43072
  v_mfma_f32_16x16x32_bf16 v[124:127], a[172:175], a[60:63], v[124:127]
  v_mfma_f32_16x16x32_bf16 v[120:123], a[172:175], a[56:59], v[120:123]
  buffer_store_dwordx4 a[224:227], v22, s[36:39], s67 offen offset:128 sc1
  v_mfma_f32_16x16x32_bf16 v[120:123], a[168:171], a[40:43], v[120:123]
  ds_read_b64_tr_b16 a[154:155], v1 offset:46656
  v_mfma_f32_16x16x32_bf16 v[116:119], a[168:171], a[36:39], v[116:119]
  ds_read_b64_tr_b16 a[156:157], v1 offset:50240
  v_mfma_f32_16x16x32_bf16 v[116:119], a[172:175], a[52:55], v[116:119]
  v_mfma_f32_16x16x32_bf16 v[112:115], a[172:175], a[48:51], v[112:115]
  buffer_store_dwordx4 a[228:231], v22, s[36:39], s67 offen offset:192 sc1
  s_lshl_b32 s68, s59, 14
  v_mfma_f32_16x16x32_bf16 v[112:115], a[168:171], a[32:35], v[112:115]
  s_waitcnt lgkmcnt(7)
  ds_read_b64_tr_b16 a[158:159], v1 offset:53824
  s_lshl_b32 s69, s44, 9
  v_mfma_f32_16x16x32_bf16 v[128:131], a[128:131], a[32:35], v[128:131]
  s_add_u32 s68, s68, s69
  ds_read_b64_tr_b16 a[160:161], v1 offset:43104
  s_add_u32 s68, s68, 524288
  v_mfma_f32_16x16x32_bf16 v[128:131], a[132:135], a[48:51], v[128:131]
  s_lshr_b32 s69, s44, 1
  s_lshl_b32 s69, s69, 8
  s_and_b32 s64, s44, 1
  v_mfma_f32_16x16x32_bf16 v[132:135], a[132:135], a[52:55], v[132:135]
  s_add_u32 s69, s69, s64
  ds_read_b64_tr_b16 a[162:163], v1 offset:46688
  s_lshl3_add_u32 s69, s69, 159744
  v_mfma_f32_16x16x32_bf16 v[132:135], a[128:131], a[36:39], v[132:135]
  buffer_load_dwordx4 v8, s[16:19], s52 offen offset:1024 lds
  v_and_b32 v24, 0x1f0, v0
  v_mfma_f32_16x16x32_bf16 v[136:139], a[128:131], a[40:43], v[136:139]
  ds_read_b64_tr_b16 a[164:165], v1 offset:50272
  v_min_u32 v24, 432, v24
  v_mfma_f32_16x16x32_bf16 v[136:139], a[132:135], a[56:59], v[136:139]
  v_and_b32 v26, 0x200, v0
  v_lshl_add_u32 v25, v26, 4, v24
  v_mfma_f32_16x16x32_bf16 v[140:143], a[132:135], a[60:63], v[140:143]
  ds_read_b64_tr_b16 a[166:167], v1 offset:53856
  v_lshrrev_b32 v26, 4, v26
  v_mfma_f32_16x16x32_bf16 v[140:143], a[128:131], a[44:47], v[140:143]
  v_lshl_add_u32 v24, v24, 2, v26
  v_add_u32 v24, s69, v24
  v_mfma_f32_16x16x32_bf16 v[156:159], a[136:139], a[44:47], v[156:159]
  s_lshl2_add_u32 s64, s56, s44
  buffer_load_dwordx4 a[100:103], v0, s[36:39], s53 offen offset:1024 sc1
  s_lshl_b32 s64, s64, 19
  v_mfma_f32_16x16x32_bf16 v[156:159], a[140:143], a[60:63], v[156:159]
  s_mul_i32 s65, s59, 7
  ds_read_b64_tr_b16 a[168:169], v1 offset:43136
  s_and_b32 s69, s59, 1
  v_mfma_f32_16x16x32_bf16 v[152:155], a[140:143], a[56:59], v[152:155]
  s_add_u32 s65, s65, s69
  ds_read_b64_tr_b16 a[170:171], v1 offset:46720
  s_lshl_b32 s65, s65, 10
  v_mfma_f32_16x16x32_bf16 v[152:155], a[136:139], a[40:43], v[152:155]
  s_add_u32 s64, s64, s65
  s_add_u32 s66, s64, 19922944
  s_mul_i32 s69, s69, 8184
  v_mfma_f32_16x16x32_bf16 v[148:151], a[136:139], a[36:39], v[148:151]
  s_sub_u32 s64, s66, s69
  ds_read_b64_tr_b16 a[172:173], v1 offset:50304
  s_add_u32 s64, s64, 6144
  v_mfma_f32_16x16x32_bf16 v[148:151], a[140:143], a[52:55], v[148:151]
  s_add_u32 s65, s64, 262144
  buffer_load_dwordx4 v9, s[16:19], s52 offen offset:2048 lds
  s_lshl_b32 s45, s2, 7
  v_mfma_f32_16x16x32_bf16 v[144:147], a[140:143], a[48:51], v[144:147]
  s_add_u32 s45, s45, 5406720
  ds_read_b64_tr_b16 a[174:175], v1 offset:53888
  s_cmp_eq_u32 s44, 0
  v_mfma_f32_16x16x32_bf16 v[144:147], a[136:139], a[32:35], v[144:147]
  s_waitcnt lgkmcnt(8)
  s_cselect_b32 s45, s45, 1073741824
  s_add_u32 s67, s68, 4096
  v_mfma_f32_16x16x32_bf16 v[160:163], a[144:147], a[32:35], v[160:163]
  ds_read_b64_tr_b16 a[128:129], v1 offset:43168
  v_mfma_f32_16x16x32_bf16 v[160:163], a[148:151], a[48:51], v[160:163]
  v_mfma_f32_16x16x32_bf16 v[164:167], a[148:151], a[52:55], v[164:167]
  buffer_load_dwordx4 a[104:107], v0, s[36:39], s53 offen offset:2048 sc1
  v_mfma_f32_16x16x32_bf16 v[164:167], a[144:147], a[36:39], v[164:167]
  ds_read_b64_tr_b16 a[130:131], v1 offset:46752
  v_mfma_f32_16x16x32_bf16 v[168:171], a[144:147], a[40:43], v[168:171]
  ds_read_b64_tr_b16 a[132:133], v1 offset:50336
  v_mfma_f32_16x16x32_bf16 v[168:171], a[148:151], a[56:59], v[168:171]
  v_mfma_f32_16x16x32_bf16 v[172:175], a[148:151], a[60:63], v[172:175]
  ds_read_b64_tr_b16 a[134:135], v1 offset:53920
  v_mfma_f32_16x16x32_bf16 v[172:175], a[144:147], a[44:47], v[172:175]
  s_waitcnt vmcnt(20)
  s_barrier
  buffer_load_dwordx4 a[108:111], v0, s[36:39], s53 offen offset:3072 sc1
  s_bfe_u32 s52, s87, 0x40010
  v_mfma_f32_16x16x32_bf16 v[188:191], a[152:155], a[44:47], v[188:191]
  s_mul_i32 s52, s52, 458752
  s_add_u32 m0, s88, 0
  ds_read_b64_tr_b16 a[136:137], v1 offset:43200
  v_mfma_f32_16x16x32_bf16 v[188:191], a[156:159], a[60:63], v[188:191]
  v_mfma_f32_16x16x32_bf16 v[184:187], a[156:159], a[56:59], v[184:187]
  ds_read_b64_tr_b16 a[138:139], v1 offset:46784
  v_mfma_f32_16x16x32_bf16 v[184:187], a[152:155], a[40:43], v[184:187]
  v_mfma_f32_16x16x32_bf16 v[180:183], a[152:155], a[36:39], v[180:183]
  buffer_load_dwordx4 v3, s[16:19], s52 offen offset:0 lds
  s_add_u32 s53, s53, 4096
  v_mfma_f32_16x16x32_bf16 v[180:183], a[156:159], a[52:55], v[180:183]
  ds_read_b64_tr_b16 a[140:141], v1 offset:50368
  v_mfma_f32_16x16x32_bf16 v[176:179], a[156:159], a[48:51], v[176:179]
  ds_read_b64_tr_b16 a[142:143], v1 offset:53952
  v_mfma_f32_16x16x32_bf16 v[176:179], a[152:155], a[32:35], v[176:179]
  s_waitcnt lgkmcnt(8)
  v_mfma_f32_16x16x32_bf16 v[192:195], a[160:163], a[32:35], v[192:195]
  ds_read_b64_tr_b16 a[144:145], v2 offset:0
  v_mfma_f32_16x16x32_bf16 v[192:195], a[164:167], a[48:51], v[192:195]
  buffer_load_dwordx4 a[112:115], v0, s[36:39], s53 offen offset:0 sc1
  v_mfma_f32_16x16x32_bf16 v[196:199], a[164:167], a[52:55], v[196:199]
  ds_read_b64_tr_b16 a[146:147], v2 offset:3584
  v_mfma_f32_16x16x32_bf16 v[196:199], a[160:163], a[36:39], v[196:199]
  v_mfma_f32_16x16x32_bf16 v[200:203], a[160:163], a[40:43], v[200:203]
  ds_read_b64_tr_b16 a[148:149], v2 offset:7168
  v_mfma_f32_16x16x32_bf16 v[200:203], a[164:167], a[56:59], v[200:203]
  v_mfma_f32_16x16x32_bf16 v[204:207], a[164:167], a[60:63], v[204:207]
  buffer_load_dwordx4 v4, s[16:19], s52 offen offset:1024 lds
  v_mfma_f32_16x16x32_bf16 v[204:207], a[160:163], a[44:47], v[204:207]
  ds_read_b64_tr_b16 a[150:151], v2 offset:10752
  v_mfma_f32_16x16x32_bf16 v[220:223], a[168:171], a[44:47], v[220:223]
  ds_read_b64_tr_b16 a[152:153], v2 offset:32
  v_mfma_f32_16x16x32_bf16 v[220:223], a[172:175], a[60:63], v[220:223]
  v_mfma_f32_16x16x32_bf16 v[216:219], a[172:175], a[56:59], v[216:219]
  ds_read_b64_tr_b16 a[154:155], v2 offset:3616
  v_mfma_f32_16x16x32_bf16 v[216:219], a[168:171], a[40:43], v[216:219]
  buffer_load_dwordx4 a[116:119], v0, s[36:39], s53 offen offset:1024 sc1
  v_mfma_f32_16x16x32_bf16 v[212:215], a[168:171], a[36:39], v[212:215]
  ds_read_b64_tr_b16 a[156:157], v2 offset:7200
  v_mfma_f32_16x16x32_bf16 v[212:215], a[172:175], a[52:55], v[212:215]
  v_mfma_f32_16x16x32_bf16 v[208:211], a[172:175], a[48:51], v[208:211]
  ds_read_b64_tr_b16 a[158:159], v2 offset:10784
  v_mfma_f32_16x16x32_bf16 v[208:211], a[168:171], a[32:35], v[208:211]
  s_waitcnt lgkmcnt(8)
  v_mfma_f32_16x16x32_bf16 v[224:227], a[128:131], a[32:35], v[224:227]
  buffer_load_dwordx4 a[120:123], v0, s[36:39], s53 offen offset:2048 sc1
  v_mfma_f32_16x16x32_bf16 v[224:227], a[132:135], a[48:51], v[224:227]
  ds_read_b64_tr_b16 a[160:161], v2 offset:64
  v_mfma_f32_16x16x32_bf16 v[228:231], a[132:135], a[52:55], v[228:231]
  ds_read_b64_tr_b16 a[162:163], v2 offset:3648
  v_mfma_f32_16x16x32_bf16 v[228:231], a[128:131], a[36:39], v[228:231]
  v_mfma_f32_16x16x32_bf16 v[232:235], a[128:131], a[40:43], v[232:235]
  ds_read_b64_tr_b16 a[164:165], v2 offset:7232
  v_mfma_f32_16x16x32_bf16 v[232:235], a[132:135], a[56:59], v[232:235]
  buffer_load_dwordx4 v5, s[16:19], s52 offen offset:2048 lds
  v_mfma_f32_16x16x32_bf16 v[236:239], a[132:135], a[60:63], v[236:239]
  ds_read_b64_tr_b16 a[166:167], v2 offset:10816
  v_mfma_f32_16x16x32_bf16 v[236:239], a[128:131], a[44:47], v[236:239]
  v_mfma_f32_16x16x32_bf16 v[252:255], a[136:139], a[44:47], v[252:255]
  ds_read_b64_tr_b16 a[168:169], v2 offset:96
  v_mfma_f32_16x16x32_bf16 v[252:255], a[140:143], a[60:63], v[252:255]
  v_mfma_f32_16x16x32_bf16 v[248:251], a[140:143], a[56:59], v[248:251]
  buffer_load_dwordx4 a[124:127], v0, s[36:39], s53 offen offset:3072 sc1
  v_mfma_f32_16x16x32_bf16 v[248:251], a[136:139], a[40:43], v[248:251]
  ds_read_b64_tr_b16 a[170:171], v2 offset:3680
  v_mfma_f32_16x16x32_bf16 v[244:247], a[136:139], a[36:39], v[244:247]
  ds_read_b64_tr_b16 a[172:173], v2 offset:7264
  v_mfma_f32_16x16x32_bf16 v[244:247], a[140:143], a[52:55], v[244:247]
  v_mfma_f32_16x16x32_bf16 v[240:243], a[140:143], a[48:51], v[240:243]
  ds_read_b64_tr_b16 a[174:175], v2 offset:10848
  v_mfma_f32_16x16x32_bf16 v[240:243], a[136:139], a[32:35], v[240:243]
  s_waitcnt vmcnt(17) lgkmcnt(8)
  buffer_load_dwordx4 v6, s[16:19], s52 offen offset:3072 lds
  s_bfe_u32 s53, s87, 0x40010
  v_mfma_f32_16x16x32_bf16 v[32:35], a[144:147], a[64:67], v[32:35]
  s_lshl_b32 s53, s53, 13
  s_add_u32 s53, s53, s89
  ds_read_b64_tr_b16 a[128:129], v2 offset:128
  v_mfma_f32_16x16x32_bf16 v[32:35], a[148:151], a[80:83], v[32:35]
  s_barrier
  v_mfma_f32_16x16x32_bf16 v[36:39], a[148:151], a[84:87], v[36:39]
  ds_read_b64_tr_b16 a[130:131], v2 offset:3712
  v_mfma_f32_16x16x32_bf16 v[36:39], a[144:147], a[68:71], v[36:39]
  v_mfma_f32_16x16x32_bf16 v[40:43], a[144:147], a[72:75], v[40:43]
  buffer_load_dwordx4 a[0:3], v0, s[36:39], s53 offen offset:0 sc1
  v_mfma_f32_16x16x32_bf16 v[40:43], a[148:151], a[88:91], v[40:43]
  s_add_u32 m0, s88, 4096
  ds_read_b64_tr_b16 a[132:133], v2 offset:7296
  v_mfma_f32_16x16x32_bf16 v[44:47], a[148:151], a[92:95], v[44:47]
  ds_read_b64_tr_b16 a[134:135], v2 offset:10880
  v_mfma_f32_16x16x32_bf16 v[44:47], a[144:147], a[76:79], v[44:47]
  v_mfma_f32_16x16x32_bf16 v[60:63], a[152:155], a[76:79], v[60:63]
  ds_read_b64_tr_b16 a[136:137], v2 offset:160
  v_mfma_f32_16x16x32_bf16 v[60:63], a[156:159], a[92:95], v[60:63]
  buffer_load_dwordx4 v7, s[16:19], s52 offen offset:0 lds
  v_mfma_f32_16x16x32_bf16 v[56:59], a[156:159], a[88:91], v[56:59]
  ds_read_b64_tr_b16 a[138:139], v2 offset:3744
  v_mfma_f32_16x16x32_bf16 v[56:59], a[152:155], a[72:75], v[56:59]
  v_mfma_f32_16x16x32_bf16 v[52:55], a[152:155], a[68:71], v[52:55]
  ds_read_b64_tr_b16 a[140:141], v2 offset:7328
  v_mfma_f32_16x16x32_bf16 v[52:55], a[156:159], a[84:87], v[52:55]
  v_mfma_f32_16x16x32_bf16 v[48:51], a[156:159], a[80:83], v[48:51]
  buffer_load_dwordx4 a[4:7], v0, s[36:39], s53 offen offset:1024 sc1
  v_mfma_f32_16x16x32_bf16 v[48:51], a[152:155], a[64:67], v[48:51]
  s_waitcnt lgkmcnt(7)
  ds_read_b64_tr_b16 a[142:143], v2 offset:10912
  v_mfma_f32_16x16x32_bf16 v[64:67], a[160:163], a[64:67], v[64:67]
  ds_read_b64_tr_b16 a[144:145], v2 offset:192
  v_mfma_f32_16x16x32_bf16 v[64:67], a[164:167], a[80:83], v[64:67]
  v_mfma_f32_16x16x32_bf16 v[68:71], a[164:167], a[84:87], v[68:71]
  ds_read_b64_tr_b16 a[146:147], v2 offset:3776
  v_mfma_f32_16x16x32_bf16 v[68:71], a[160:163], a[68:71], v[68:71]
  v_mfma_f32_16x16x32_bf16 v[72:75], a[160:163], a[72:75], v[72:75]
  buffer_load_dwordx4 a[8:11], v0, s[36:39], s53 offen offset:2048 sc1
  v_mfma_f32_16x16x32_bf16 v[72:75], a[164:167], a[88:91], v[72:75]
  ds_read_b64_tr_b16 a[148:149], v2 offset:7360
  v_mfma_f32_16x16x32_bf16 v[76:79], a[164:167], a[92:95], v[76:79]
  ds_read_b64_tr_b16 a[150:151], v2 offset:10944
  v_mfma_f32_16x16x32_bf16 v[76:79], a[160:163], a[76:79], v[76:79]
  v_mfma_f32_16x16x32_bf16 v[92:95], a[168:171], a[76:79], v[92:95]
  ds_read_b64_tr_b16 a[152:153], v2 offset:14336
  v_mfma_f32_16x16x32_bf16 v[92:95], a[172:175], a[92:95], v[92:95]
  buffer_load_dwordx4 v8, s[16:19], s52 offen offset:1024 lds
  v_mfma_f32_16x16x32_bf16 v[88:91], a[172:175], a[88:91], v[88:91]
  ds_read_b64_tr_b16 a[154:155], v2 offset:17920
  v_mfma_f32_16x16x32_bf16 v[88:91], a[168:171], a[72:75], v[88:91]
  v_mfma_f32_16x16x32_bf16 v[84:87], a[168:171], a[68:71], v[84:87]
  ds_read_b64_tr_b16 a[156:157], v2 offset:21504
  v_mfma_f32_16x16x32_bf16 v[84:87], a[172:175], a[84:87], v[84:87]
  v_mfma_f32_16x16x32_bf16 v[80:83], a[172:175], a[80:83], v[80:83]
  buffer_load_dwordx4 a[12:15], v0, s[36:39], s53 offen offset:3072 sc1
  v_mfma_f32_16x16x32_bf16 v[80:83], a[168:171], a[64:67], v[80:83]
  s_waitcnt lgkmcnt(7)
  ds_read_b64_tr_b16 a[158:159], v2 offset:25088
  v_mfma_f32_16x16x32_bf16 v[96:99], a[128:131], a[64:67], v[96:99]
  ds_read_b64_tr_b16 a[160:161], v2 offset:14368
  v_mfma_f32_16x16x32_bf16 v[96:99], a[132:135], a[80:83], v[96:99]
  v_mfma_f32_16x16x32_bf16 v[100:103], a[132:135], a[84:87], v[100:103]
  ds_read_b64_tr_b16 a[162:163], v2 offset:17952
  v_mfma_f32_16x16x32_bf16 v[100:103], a[128:131], a[68:71], v[100:103]
  buffer_load_dwordx4 v9, s[16:19], s52 offen offset:2048 lds
  v_mfma_f32_16x16x32_bf16 v[104:107], a[128:131], a[72:75], v[104:107]
  s_add_u32 s53, s53, 4096
  ds_read_b64_tr_b16 a[164:165], v2 offset:21536
  v_mfma_f32_16x16x32_bf16 v[104:107], a[132:135], a[88:91], v[104:107]
  v_mfma_f32_16x16x32_bf16 v[108:111], a[132:135], a[92:95], v[108:111]
  ds_read_b64_tr_b16 a[166:167], v2 offset:25120
  v_mfma_f32_16x16x32_bf16 v[108:111], a[128:131], a[76:79], v[108:111]
  v_mfma_f32_16x16x32_bf16 v[124:127], a[136:139], a[76:79], v[124:127]
  buffer_load_dwordx4 a[16:19], v0, s[36:39], s53 offen offset:0 sc1
  v_mfma_f32_16x16x32_bf16 v[124:127], a[140:143], a[92:95], v[124:127]
  ds_read_b64_tr_b16 a[168:169], v2 offset:14400
  v_mfma_f32_16x16x32_bf16 v[120:123], a[140:143], a[88:91], v[120:123]
  ds_read_b64_tr_b16 a[170:171], v2 offset:17984
  v_mfma_f32_16x16x32_bf16 v[120:123], a[136:139], a[72:75], v[120:123]
  v_mfma_f32_16x16x32_bf16 v[116:119], a[136:139], a[68:71], v[116:119]
  ds_read_b64_tr_b16 a[172:173], v2 offset:21568
  v_mfma_f32_16x16x32_bf16 v[116:119], a[140:143], a[84:87], v[116:119]
  v_mfma_f32_16x16x32_bf16 v[112:115], a[140:143], a[80:83], v[112:115]
  ds_read_b64_tr_b16 a[174:175], v2 offset:25152
  v_mfma_f32_16x16x32_bf16 v[112:115], a[136:139], a[64:67], v[112:115]
  s_waitcnt lgkmcnt(8)
  v_mfma_f32_16x16x32_bf16 v[128:131], a[144:147], a[64:67], v[128:131]
  ds_read_b64_tr_b16 a[128:129], v2 offset:14432
  v_mfma_f32_16x16x32_bf16 v[128:131], a[148:151], a[80:83], v[128:131]
  v_mfma_f32_16x16x32_bf16 v[132:135], a[148:151], a[84:87], v[132:135]
  buffer_load_dwordx4 a[20:23], v0, s[36:39], s53 offen offset:1024 sc1
  s_bfe_u32 s52, s87, 0x40014
  v_mfma_f32_16x16x32_bf16 v[132:135], a[144:147], a[68:71], v[132:135]
  s_mul_i32 s52, s52, 458752
  s_add_u32 m0, s88, 28672
  ds_read_b64_tr_b16 a[130:131], v2 offset:18016
  v_mfma_f32_16x16x32_bf16 v[136:139], a[144:147], a[72:75], v[136:139]
  ds_read_b64_tr_b16 a[132:133], v2 offset:21600
  v_mfma_f32_16x16x32_bf16 v[136:139], a[148:151], a[88:91], v[136:139]
  v_mfma_f32_16x16x32_bf16 v[140:143], a[148:151], a[92:95], v[140:143]
  ds_read_b64_tr_b16 a[134:135], v2 offset:25184
  v_mfma_f32_16x16x32_bf16 v[140:143], a[144:147], a[76:79], v[140:143]
  buffer_load_dwordx4 v3, s[16:19], s52 offen offset:0 lds
  v_mfma_f32_16x16x32_bf16 v[156:159], a[152:155], a[76:79], v[156:159]
  ds_read_b64_tr_b16 a[136:137], v2 offset:14464
  v_mfma_f32_16x16x32_bf16 v[156:159], a[156:159], a[92:95], v[156:159]
  v_mfma_f32_16x16x32_bf16 v[152:155], a[156:159], a[88:91], v[152:155]
  ds_read_b64_tr_b16 a[138:139], v2 offset:18048
  v_mfma_f32_16x16x32_bf16 v[152:155], a[152:155], a[72:75], v[152:155]
  v_mfma_f32_16x16x32_bf16 v[148:151], a[152:155], a[68:71], v[148:151]
  buffer_load_dwordx4 a[24:27], v0, s[36:39], s53 offen offset:2048 sc1
  v_mfma_f32_16x16x32_bf16 v[148:151], a[156:159], a[84:87], v[148:151]
  ds_read_b64_tr_b16 a[140:141], v2 offset:21632
  v_mfma_f32_16x16x32_bf16 v[144:147], a[156:159], a[80:83], v[144:147]
  ds_read_b64_tr_b16 a[142:143], v2 offset:25216
  v_mfma_f32_16x16x32_bf16 v[144:147], a[152:155], a[64:67], v[144:147]
  s_waitcnt lgkmcnt(8)
  v_mfma_f32_16x16x32_bf16 v[160:163], a[160:163], a[64:67], v[160:163]
  ds_read_b64_tr_b16 a[144:145], v2 offset:14496
  v_mfma_f32_16x16x32_bf16 v[160:163], a[164:167], a[80:83], v[160:163]
  buffer_load_dwordx4 v4, s[16:19], s52 offen offset:1024 lds
  v_mfma_f32_16x16x32_bf16 v[164:167], a[164:167], a[84:87], v[164:167]
  ds_read_b64_tr_b16 a[146:147], v2 offset:18080
  v_mfma_f32_16x16x32_bf16 v[164:167], a[160:163], a[68:71], v[164:167]
  v_mfma_f32_16x16x32_bf16 v[168:171], a[160:163], a[72:75], v[168:171]
  ds_read_b64_tr_b16 a[148:149], v2 offset:21664
  v_mfma_f32_16x16x32_bf16 v[168:171], a[164:167], a[88:91], v[168:171]
  v_mfma_f32_16x16x32_bf16 v[172:175], a[164:167], a[92:95], v[172:175]
  buffer_load_dwordx4 a[28:31], v0, s[36:39], s53 offen offset:3072 sc1
  v_mfma_f32_16x16x32_bf16 v[172:175], a[160:163], a[76:79], v[172:175]
  s_waitcnt vmcnt(23)
  s_barrier
  ds_read_b64_tr_b16 a[150:151], v2 offset:25248
  v_mfma_f32_16x16x32_bf16 v[188:191], a[168:171], a[76:79], v[188:191]
  ds_read_b64_tr_b16 a[152:153], v2 offset:14528
  v_mfma_f32_16x16x32_bf16 v[188:191], a[172:175], a[92:95], v[188:191]
  v_mfma_f32_16x16x32_bf16 v[184:187], a[172:175], a[88:91], v[184:187]
  ds_read_b64_tr_b16 a[154:155], v2 offset:18112
  v_mfma_f32_16x16x32_bf16 v[184:187], a[168:171], a[72:75], v[184:187]
  buffer_load_dwordx4 v5, s[16:19], s52 offen offset:2048 lds
  s_bfe_u32 s53, s87, 0x40014
  v_mfma_f32_16x16x32_bf16 v[180:183], a[168:171], a[68:71], v[180:183]
  s_lshl_b32 s53, s53, 13
  s_add_u32 s53, s53, s89
  ds_read_b64_tr_b16 a[156:157], v2 offset:21696
  v_mfma_f32_16x16x32_bf16 v[180:183], a[172:175], a[84:87], v[180:183]
  v_mfma_f32_16x16x32_bf16 v[176:179], a[172:175], a[80:83], v[176:179]
  ds_read_b64_tr_b16 a[158:159], v2 offset:25280
  v_mfma_f32_16x16x32_bf16 v[176:179], a[168:171], a[64:67], v[176:179]
  s_waitcnt lgkmcnt(8)
  v_mfma_f32_16x16x32_bf16 v[192:195], a[128:131], a[64:67], v[192:195]
  buffer_load_dwordx4 a[32:35], v0, s[36:39], s53 offen offset:0 sc1
  v_mfma_f32_16x16x32_bf16 v[192:195], a[132:135], a[80:83], v[192:195]
  ds_read_b64_tr_b16 a[160:161], v2 offset:28672
  v_mfma_f32_16x16x32_bf16 v[196:199], a[132:135], a[84:87], v[196:199]
  ds_read_b64_tr_b16 a[162:163], v2 offset:32256
  v_mfma_f32_16x16x32_bf16 v[196:199], a[128:131], a[68:71], v[196:199]
  v_mfma_f32_16x16x32_bf16 v[200:203], a[128:131], a[72:75], v[200:203]
  ds_read_b64_tr_b16 a[164:165], v2 offset:35840
  v_mfma_f32_16x16x32_bf16 v[200:203], a[132:135], a[88:91], v[200:203]
  buffer_load_dwordx4 a[36:39], v0, s[36:39], s53 offen offset:1024 sc1
  v_mfma_f32_16x16x32_bf16 v[204:207], a[132:135], a[92:95], v[204:207]
  ds_read_b64_tr_b16 a[166:167], v2 offset:39424
  v_mfma_f32_16x16x32_bf16 v[204:207], a[128:131], a[76:79], v[204:207]
  v_mfma_f32_16x16x32_bf16 v[220:223], a[136:139], a[76:79], v[220:223]
  ds_read_b64_tr_b16 a[168:169], v2 offset:28704
  v_mfma_f32_16x16x32_bf16 v[220:223], a[140:143], a[92:95], v[220:223]
  v_mfma_f32_16x16x32_bf16 v[216:219], a[140:143], a[88:91], v[216:219]
  buffer_load_dwordx4 v6, s[16:19], s52 offen offset:3072 lds
  v_mfma_f32_16x16x32_bf16 v[216:219], a[136:139], a[72:75], v[216:219]
  ds_read_b64_tr_b16 a[170:171], v2 offset:32288
  v_mfma_f32_16x16x32_bf16 v[212:215], a[136:139], a[68:71], v[212:215]
  ds_read_b64_tr_b16 a[172:173], v2 offset:35872
  v_mfma_f32_16x16x32_bf16 v[212:215], a[140:143], a[84:87], v[212:215]
  v_mfma_f32_16x16x32_bf16 v[208:211], a[140:143], a[80:83], v[208:211]
  ds_read_b64_tr_b16 a[174:175], v2 offset:39456
  v_mfma_f32_16x16x32_bf16 v[208:211], a[136:139], a[64:67], v[208:211]
  s_waitcnt lgkmcnt(8)
  buffer_load_dwordx4 a[40:43], v0, s[36:39], s53 offen offset:2048 sc1
  s_add_u32 m0, s88, 32768
  v_mfma_f32_16x16x32_bf16 v[224:227], a[144:147], a[64:67], v[224:227]
  ds_read_b64_tr_b16 a[128:129], v2 offset:28736
  v_mfma_f32_16x16x32_bf16 v[224:227], a[148:151], a[80:83], v[224:227]
  v_mfma_f32_16x16x32_bf16 v[228:231], a[148:151], a[84:87], v[228:231]
  ds_read_b64_tr_b16 a[130:131], v2 offset:32320
  v_mfma_f32_16x16x32_bf16 v[228:231], a[144:147], a[68:71], v[228:231]
  v_mfma_f32_16x16x32_bf16 v[232:235], a[144:147], a[72:75], v[232:235]
  buffer_load_dwordx4 v7, s[16:19], s52 offen offset:0 lds
  v_mfma_f32_16x16x32_bf16 v[232:235], a[148:151], a[88:91], v[232:235]
  ds_read_b64_tr_b16 a[132:133], v2 offset:35904
  v_mfma_f32_16x16x32_bf16 v[236:239], a[148:151], a[92:95], v[236:239]
  ds_read_b64_tr_b16 a[134:135], v2 offset:39488
  v_mfma_f32_16x16x32_bf16 v[236:239], a[144:147], a[76:79], v[236:239]
  v_mfma_f32_16x16x32_bf16 v[252:255], a[152:155], a[76:79], v[252:255]
  ds_read_b64_tr_b16 a[136:137], v2 offset:28768
  v_mfma_f32_16x16x32_bf16 v[252:255], a[156:159], a[92:95], v[252:255]
  buffer_load_dwordx4 a[44:47], v0, s[36:39], s53 offen offset:3072 sc1
  v_mfma_f32_16x16x32_bf16 v[248:251], a[156:159], a[88:91], v[248:251]
  ds_read_b64_tr_b16 a[138:139], v2 offset:32352
  v_mfma_f32_16x16x32_bf16 v[248:251], a[152:155], a[72:75], v[248:251]
  v_mfma_f32_16x16x32_bf16 v[244:247], a[152:155], a[68:71], v[244:247]
  ds_read_b64_tr_b16 a[140:141], v2 offset:35936
  v_mfma_f32_16x16x32_bf16 v[244:247], a[156:159], a[84:87], v[244:247]
  v_mfma_f32_16x16x32_bf16 v[240:243], a[156:159], a[80:83], v[240:243]
  ds_read_b64_tr_b16 a[142:143], v2 offset:39520
  v_mfma_f32_16x16x32_bf16 v[240:243], a[152:155], a[64:67], v[240:243]
  s_waitcnt vmcnt(21) lgkmcnt(8)
  buffer_load_dwordx4 v8, s[16:19], s52 offen offset:1024 lds
  s_add_u32 s53, s53, 4096
  v_mfma_f32_16x16x32_bf16 v[32:35], a[160:163], a[96:99], v[32:35]
  ds_read_b64_tr_b16 a[144:145], v2 offset:28800
  v_mfma_f32_16x16x32_bf16 v[32:35], a[164:167], a[112:115], v[32:35]
  s_barrier
  v_mfma_f32_16x16x32_bf16 v[36:39], a[164:167], a[116:119], v[36:39]
  ds_read_b64_tr_b16 a[146:147], v2 offset:32384
  v_mfma_f32_16x16x32_bf16 v[36:39], a[160:163], a[100:103], v[36:39]
  v_mfma_f32_16x16x32_bf16 v[40:43], a[160:163], a[104:107], v[40:43]
  buffer_load_dwordx4 a[48:51], v0, s[36:39], s53 offen offset:0 sc1
  v_mfma_f32_16x16x32_bf16 v[40:43], a[164:167], a[120:123], v[40:43]
  ds_read_b64_tr_b16 a[148:149], v2 offset:35968
  v_mfma_f32_16x16x32_bf16 v[44:47], a[164:167], a[124:127], v[44:47]
  ds_read_b64_tr_b16 a[150:151], v2 offset:39552
  v_mfma_f32_16x16x32_bf16 v[44:47], a[160:163], a[108:111], v[44:47]
  v_mfma_f32_16x16x32_bf16 v[60:63], a[168:171], a[108:111], v[60:63]
  ds_read_b64_tr_b16 a[152:153], v2 offset:28832
  v_mfma_f32_16x16x32_bf16 v[60:63], a[172:175], a[124:127], v[60:63]
  v_mfma_f32_16x16x32_bf16 v[56:59], a[172:175], a[120:123], v[56:59]
  ds_read_b64_tr_b16 a[154:155], v2 offset:32416
  v_mfma_f32_16x16x32_bf16 v[56:59], a[168:171], a[104:107], v[56:59]
  buffer_load_dwordx4 v9, s[16:19], s52 offen offset:2048 lds
  v_mfma_f32_16x16x32_bf16 v[52:55], a[168:171], a[100:103], v[52:55]
  ds_read_b64_tr_b16 a[156:157], v2 offset:36000
  v_mfma_f32_16x16x32_bf16 v[52:55], a[172:175], a[116:119], v[52:55]
  v_mfma_f32_16x16x32_bf16 v[48:51], a[172:175], a[112:115], v[48:51]
  ds_read_b64_tr_b16 a[158:159], v2 offset:39584
  v_mfma_f32_16x16x32_bf16 v[48:51], a[168:171], a[96:99], v[48:51]
  s_waitcnt lgkmcnt(8)
  v_mfma_f32_16x16x32_bf16 v[64:67], a[128:131], a[96:99], v[64:67]
  buffer_load_dwordx4 a[52:55], v0, s[36:39], s53 offen offset:1024 sc1
  v_mfma_f32_16x16x32_bf16 v[64:67], a[132:135], a[112:115], v[64:67]
  ds_read_b64_tr_b16 a[160:161], v2 offset:28864
  v_mfma_f32_16x16x32_bf16 v[68:71], a[132:135], a[116:119], v[68:71]
  ds_read_b64_tr_b16 a[162:163], v2 offset:32448
  v_mfma_f32_16x16x32_bf16 v[68:71], a[128:131], a[100:103], v[68:71]
  v_mfma_f32_16x16x32_bf16 v[72:75], a[128:131], a[104:107], v[72:75]
  ds_read_b64_tr_b16 a[164:165], v2 offset:36032
  v_mfma_f32_16x16x32_bf16 v[72:75], a[132:135], a[120:123], v[72:75]
  v_mfma_f32_16x16x32_bf16 v[76:79], a[132:135], a[124:127], v[76:79]
  buffer_load_dwordx4 a[56:59], v0, s[36:39], s53 offen offset:2048 sc1
  v_mfma_f32_16x16x32_bf16 v[76:79], a[128:131], a[108:111], v[76:79]
  ds_read_b64_tr_b16 a[166:167], v2 offset:39616
  v_mfma_f32_16x16x32_bf16 v[92:95], a[136:139], a[108:111], v[92:95]
  s_bfe_u32 s52, s87, 0x40018
  s_mul_i32 s52, s52, 458752
  s_add_u32 m0, s88, 57344
  v_mfma_f32_16x16x32_bf16 v[92:95], a[140:143], a[124:127], v[92:95]
  ds_read_b64_tr_b16 a[168:169], v2 offset:43008
  v_mfma_f32_16x16x32_bf16 v[88:91], a[140:143], a[120:123], v[88:91]
  ds_read_b64_tr_b16 a[170:171], v2 offset:46592
  v_mfma_f32_16x16x32_bf16 v[88:91], a[136:139], a[104:107], v[88:91]
  v_mfma_f32_16x16x32_bf16 v[84:87], a[136:139], a[100:103], v[84:87]
  buffer_load_dwordx4 v3, s[16:19], s52 offen offset:0 lds
  v_mfma_f32_16x16x32_bf16 v[84:87], a[140:143], a[116:119], v[84:87]
  ds_read_b64_tr_b16 a[172:173], v2 offset:50176
  v_mfma_f32_16x16x32_bf16 v[80:83], a[140:143], a[112:115], v[80:83]
  ds_read_b64_tr_b16 a[174:175], v2 offset:53760
  v_mfma_f32_16x16x32_bf16 v[80:83], a[136:139], a[96:99], v[80:83]
  s_waitcnt lgkmcnt(8)
  v_mfma_f32_16x16x32_bf16 v[96:99], a[144:147], a[96:99], v[96:99]
  ds_read_b64_tr_b16 a[128:129], v2 offset:43040
  v_mfma_f32_16x16x32_bf16 v[96:99], a[148:151], a[112:115], v[96:99]
  buffer_load_dwordx4 a[60:63], v0, s[36:39], s53 offen offset:3072 sc1
  s_bfe_u32 s53, s87, 0x40018
  v_mfma_f32_16x16x32_bf16 v[100:103], a[148:151], a[116:119], v[100:103]
  s_lshl_b32 s53, s53, 13
  s_add_u32 s53, s53, s89
  ds_read_b64_tr_b16 a[130:131], v2 offset:46624
  v_mfma_f32_16x16x32_bf16 v[100:103], a[144:147], a[100:103], v[100:103]
  v_mfma_f32_16x16x32_bf16 v[104:107], a[144:147], a[104:107], v[104:107]
  buffer_load_dwordx4 a[208:211], v25, s[36:39], s68 offen offset:0 sc1
  v_mfma_f32_16x16x32_bf16 v[104:107], a[148:151], a[120:123], v[104:107]
  ds_read_b64_tr_b16 a[132:133], v2 offset:50208
  v_mfma_f32_16x16x32_bf16 v[108:111], a[148:151], a[124:127], v[108:111]
  ds_read_b64_tr_b16 a[134:135], v2 offset:53792
  v_mfma_f32_16x16x32_bf16 v[108:111], a[144:147], a[108:111], v[108:111]
  v_mfma_f32_16x16x32_bf16 v[124:127], a[152:155], a[108:111], v[124:127]
  ds_read_b64_tr_b16 a[136:137], v2 offset:43072
  v_mfma_f32_16x16x32_bf16 v[124:127], a[156:159], a[124:127], v[124:127]
  buffer_load_dwordx4 a[212:215], v25, s[36:39], s68 offen offset:2048 sc1
  v_mfma_f32_16x16x32_bf16 v[120:123], a[156:159], a[120:123], v[120:123]
  ds_read_b64_tr_b16 a[138:139], v2 offset:46656
  v_mfma_f32_16x16x32_bf16 v[120:123], a[152:155], a[104:107], v[120:123]
  v_mfma_f32_16x16x32_bf16 v[116:119], a[152:155], a[100:103], v[116:119]
  ds_read_b64_tr_b16 a[140:141], v2 offset:50240
  v_mfma_f32_16x16x32_bf16 v[116:119], a[156:159], a[116:119], v[116:119]
  v_mfma_f32_16x16x32_bf16 v[112:115], a[156:159], a[112:115], v[112:115]
  buffer_load_dwordx4 a[216:219], v25, s[36:39], s67 offen offset:0 sc1
  v_mfma_f32_16x16x32_bf16 v[112:115], a[152:155], a[96:99], v[112:115]
  s_waitcnt lgkmcnt(7)
  ds_read_b64_tr_b16 a[142:143], v2 offset:53824
  v_mfma_f32_16x16x32_bf16 v[128:131], a[160:163], a[96:99], v[128:131]
  ds_read_b64_tr_b16 a[144:145], v2 offset:43104
  v_mfma_f32_16x16x32_bf16 v[128:131], a[164:167], a[112:115], v[128:131]
  v_mfma_f32_16x16x32_bf16 v[132:135], a[164:167], a[116:119], v[132:135]
  ds_read_b64_tr_b16 a[146:147], v2 offset:46688
  v_mfma_f32_16x16x32_bf16 v[132:135], a[160:163], a[100:103], v[132:135]
  buffer_load_dwordx4 a[220:223], v25, s[36:39], s67 offen offset:2048 sc1
  v_mfma_f32_16x16x32_bf16 v[136:139], a[160:163], a[104:107], v[136:139]
  ds_read_b64_tr_b16 a[148:149], v2 offset:50272
  v_mfma_f32_16x16x32_bf16 v[136:139], a[164:167], a[120:123], v[136:139]
  v_mfma_f32_16x16x32_bf16 v[140:143], a[164:167], a[124:127], v[140:143]
  ds_read_b64_tr_b16 a[150:151], v2 offset:53856
  v_mfma_f32_16x16x32_bf16 v[140:143], a[160:163], a[108:111], v[140:143]
  v_mfma_f32_16x16x32_bf16 v[156:159], a[168:171], a[108:111], v[156:159]
  buffer_load_dwordx4 a[64:67], v0, s[36:39], s53 offen offset:0 sc1
  v_mfma_f32_16x16x32_bf16 v[156:159], a[172:175], a[124:127], v[156:159]
  ds_read_b64_tr_b16 a[152:153], v2 offset:43136
  v_mfma_f32_16x16x32_bf16 v[152:155], a[172:175], a[120:123], v[152:155]
  ds_read_b64_tr_b16 a[154:155], v2 offset:46720
  v_mfma_f32_16x16x32_bf16 v[152:155], a[168:171], a[104:107], v[152:155]
  v_mfma_f32_16x16x32_bf16 v[148:151], a[168:171], a[100:103], v[148:151]
  ds_read_b64_tr_b16 a[156:157], v2 offset:50304
  v_mfma_f32_16x16x32_bf16 v[148:151], a[172:175], a[116:119], v[148:151]
  buffer_load_dwordx4 v4, s[16:19], s52 offen offset:1024 lds
  v_mfma_f32_16x16x32_bf16 v[144:147], a[172:175], a[112:115], v[144:147]
Hb1_1:
  s_cbranch_execz Hb1_2
  ds_read_b64_tr_b16 a[158:159], v2 offset:53888
  v_mfma_f32_16x16x32_bf16 v[144:147], a[168:171], a[96:99], v[144:147]
  s_waitcnt lgkmcnt(8)
  v_mfma_f32_16x16x32_bf16 v[160:163], a[128:131], a[96:99], v[160:163]
  ds_read_b64_tr_b16 a[160:161], v2 offset:43168
  v_mfma_f32_16x16x32_bf16 v[160:163], a[132:135], a[112:115], v[160:163]
  v_mfma_f32_16x16x32_bf16 v[164:167], a[132:135], a[116:119], v[164:167]
  buffer_load_dwordx4 a[68:71], v0, s[36:39], s53 offen offset:1024 sc1
  v_mfma_f32_16x16x32_bf16 v[164:167], a[128:131], a[100:103], v[164:167]
  ds_read_b64_tr_b16 a[162:163], v2 offset:46752
  v_mfma_f32_16x16x32_bf16 v[168:171], a[128:131], a[104:107], v[168:171]
  ds_read_b64_tr_b16 a[164:165], v2 offset:50336
  v_mfma_f32_16x16x32_bf16 v[168:171], a[132:135], a[120:123], v[168:171]
  v_mfma_f32_16x16x32_bf16 v[172:175], a[132:135], a[124:127], v[172:175]
  ds_read_b64_tr_b16 a[166:167], v2 offset:53920
  v_mfma_f32_16x16x32_bf16 v[172:175], a[128:131], a[108:111], v[172:175]
  s_waitcnt vmcnt(27)
  s_barrier
  buffer_load_dwordx4 v5, s[16:19], s52 offen offset:2048 lds
  v_mfma_f32_16x16x32_bf16 v[188:191], a[136:139], a[108:111], v[188:191]
  ds_read_b64_tr_b16 a[168:169], v2 offset:43200
  v_mfma_f32_16x16x32_bf16 v[188:191], a[140:143], a[124:127], v[188:191]
  v_mfma_f32_16x16x32_bf16 v[184:187], a[140:143], a[120:123], v[184:187]
  ds_read_b64_tr_b16 a[170:171], v2 offset:46784
  v_mfma_f32_16x16x32_bf16 v[184:187], a[136:139], a[104:107], v[184:187]
  v_mfma_f32_16x16x32_bf16 v[180:183], a[136:139], a[100:103], v[180:183]
  buffer_load_dwordx4 a[72:75], v0, s[36:39], s53 offen offset:2048 sc1
  v_mfma_f32_16x16x32_bf16 v[180:183], a[140:143], a[116:119], v[180:183]
  ds_read_b64_tr_b16 a[172:173], v2 offset:50368
  v_mfma_f32_16x16x32_bf16 v[176:179], a[140:143], a[112:115], v[176:179]
  ds_read_b64_tr_b16 a[174:175], v2 offset:53952
  v_mfma_f32_16x16x32_bf16 v[176:179], a[136:139], a[96:99], v[176:179]
  s_waitcnt lgkmcnt(8)
  v_mfma_f32_16x16x32_bf16 v[192:195], a[144:147], a[96:99], v[192:195]
  ds_read_b64_tr_b16 a[128:129], v1 offset:0
  v_mfma_f32_16x16x32_bf16 v[192:195], a[148:151], a[112:115], v[192:195]
  buffer_load_dwordx4 v6, s[16:19], s52 offen offset:3072 lds
  v_mfma_f32_16x16x32_bf16 v[196:199], a[148:151], a[116:119], v[196:199]
  ds_read_b64_tr_b16 a[130:131], v1 offset:3584
  v_mfma_f32_16x16x32_bf16 v[196:199], a[144:147], a[100:103], v[196:199]
  v_mfma_f32_16x16x32_bf16 v[200:203], a[144:147], a[104:107], v[200:203]
  ds_read_b64_tr_b16 a[132:133], v1 offset:7168
  v_mfma_f32_16x16x32_bf16 v[200:203], a[148:151], a[120:123], v[200:203]
  v_mfma_f32_16x16x32_bf16 v[204:207], a[148:151], a[124:127], v[204:207]
  buffer_load_dwordx4 a[76:79], v0, s[36:39], s53 offen offset:3072 sc1
  s_add_u32 m0, s88, 61440
  v_mfma_f32_16x16x32_bf16 v[204:207], a[144:147], a[108:111], v[204:207]
  ds_read_b64_tr_b16 a[134:135], v1 offset:10752
  v_mfma_f32_16x16x32_bf16 v[220:223], a[152:155], a[108:111], v[220:223]
  ds_read_b64_tr_b16 a[136:137], v1 offset:32
  v_mfma_f32_16x16x32_bf16 v[220:223], a[156:159], a[124:127], v[220:223]
  v_mfma_f32_16x16x32_bf16 v[216:219], a[156:159], a[120:123], v[216:219]
  ds_read_b64_tr_b16 a[138:139], v1 offset:3616
  v_mfma_f32_16x16x32_bf16 v[216:219], a[152:155], a[104:107], v[216:219]
  buffer_load_dwordx4 v7, s[16:19], s52 offen offset:0 lds
  s_add_u32 s53, s53, 4096
  v_mfma_f32_16x16x32_bf16 v[212:215], a[152:155], a[100:103], v[212:215]
  ds_read_b64_tr_b16 a[140:141], v1 offset:7200
  v_mfma_f32_16x16x32_bf16 v[212:215], a[156:159], a[116:119], v[212:215]
  v_mfma_f32_16x16x32_bf16 v[208:211], a[156:159], a[112:115], v[208:211]
  ds_read_b64_tr_b16 a[142:143], v1 offset:10784
  v_mfma_f32_16x16x32_bf16 v[208:211], a[152:155], a[96:99], v[208:211]
  s_waitcnt lgkmcnt(8)
  v_mfma_f32_16x16x32_bf16 v[224:227], a[160:163], a[96:99], v[224:227]
  buffer_load_dwordx4 a[80:83], v0, s[36:39], s53 offen offset:0 sc1
  v_mfma_f32_16x16x32_bf16 v[224:227], a[164:167], a[112:115], v[224:227]
  ds_read_b64_tr_b16 a[144:145], v1 offset:64
  v_mfma_f32_16x16x32_bf16 v[228:231], a[164:167], a[116:119], v[228:231]
  ds_read_b64_tr_b16 a[146:147], v1 offset:3648
  v_mfma_f32_16x16x32_bf16 v[228:231], a[160:163], a[100:103], v[228:231]
  v_mfma_f32_16x16x32_bf16 v[232:235], a[160:163], a[104:107], v[232:235]
  ds_read_b64_tr_b16 a[148:149], v1 offset:7232
  v_mfma_f32_16x16x32_bf16 v[232:235], a[164:167], a[120:123], v[232:235]
  buffer_load_dwordx4 a[84:87], v0, s[36:39], s53 offen offset:1024 sc1
  v_mfma_f32_16x16x32_bf16 v[236:239], a[164:167], a[124:127], v[236:239]
  ds_read_b64_tr_b16 a[150:151], v1 offset:10816
  v_mfma_f32_16x16x32_bf16 v[236:239], a[160:163], a[108:111], v[236:239]
  v_mfma_f32_16x16x32_bf16 v[252:255], a[168:171], a[108:111], v[252:255]
  ds_read_b64_tr_b16 a[152:153], v1 offset:96
  v_mfma_f32_16x16x32_bf16 v[252:255], a[172:175], a[124:127], v[252:255]
  v_mfma_f32_16x16x32_bf16 v[248:251], a[172:175], a[120:123], v[248:251]
  buffer_load_dwordx4 v8, s[16:19], s52 offen offset:1024 lds
  v_mfma_f32_16x16x32_bf16 v[248:251], a[168:171], a[104:107], v[248:251]
  ds_read_b64_tr_b16 a[154:155], v1 offset:3680
  v_mfma_f32_16x16x32_bf16 v[244:247], a[168:171], a[100:103], v[244:247]
  ds_read_b64_tr_b16 a[156:157], v1 offset:7264
  v_mfma_f32_16x16x32_bf16 v[244:247], a[172:175], a[116:119], v[244:247]
  v_mfma_f32_16x16x32_bf16 v[240:243], a[172:175], a[112:115], v[240:243]
  ds_read_b64_tr_b16 a[158:159], v1 offset:10848
  v_mfma_f32_16x16x32_bf16 v[240:243], a[168:171], a[96:99], v[240:243]
  s_waitcnt vmcnt(29) lgkmcnt(8)
  buffer_load_dwordx4 a[88:91], v0, s[36:39], s53 offen offset:2048 sc1
  v_mfma_f32_16x16x32_bf16 v[32:35], a[128:131], a[0:3], v[32:35]
  ds_read_b64_tr_b16 a[160:161], v1 offset:128
  v_mfma_f32_16x16x32_bf16 v[32:35], a[132:135], a[16:19], v[32:35]
  s_waitcnt vmcnt(20)
  s_barrier
  v_mfma_f32_16x16x32_bf16 v[36:39], a[132:135], a[20:23], v[36:39]
  ds_read_b64_tr_b16 a[162:163], v1 offset:3712
  v_mfma_f32_16x16x32_bf16 v[36:39], a[128:131], a[4:7], v[36:39]
  v_mfma_f32_16x16x32_bf16 v[40:43], a[128:131], a[8:11], v[40:43]
  buffer_load_dwordx4 v9, s[16:19], s52 offen offset:2048 lds
  v_mfma_f32_16x16x32_bf16 v[40:43], a[132:135], a[24:27], v[40:43]
  ds_read_b64_tr_b16 a[164:165], v1 offset:7296
  v_mfma_f32_16x16x32_bf16 v[44:47], a[132:135], a[28:31], v[44:47]
  ds_read_b64_tr_b16 a[166:167], v1 offset:10880
  v_mfma_f32_16x16x32_bf16 v[44:47], a[128:131], a[12:15], v[44:47]
  v_mfma_f32_16x16x32_bf16 v[60:63], a[136:139], a[12:15], v[60:63]
  ds_read_b64_tr_b16 a[168:169], v1 offset:160
  v_mfma_f32_16x16x32_bf16 v[60:63], a[140:143], a[28:31], v[60:63]
  buffer_load_dwordx4 a[92:95], v0, s[36:39], s53 offen offset:3072 sc1
  s_bfe_u32 s53, s87, 0x4001c
  v_mfma_f32_16x16x32_bf16 v[56:59], a[140:143], a[24:27], v[56:59]
  s_lshl_b32 s53, s53, 13
  s_add_u32 s53, s53, s89
  ds_read_b64_tr_b16 a[170:171], v1 offset:3744
  v_mfma_f32_16x16x32_bf16 v[56:59], a[136:139], a[8:11], v[56:59]
  v_mfma_f32_16x16x32_bf16 v[52:55], a[136:139], a[4:7], v[52:55]
  ds_read_b64_tr_b16 a[172:173], v1 offset:7328
  v_mfma_f32_16x16x32_bf16 v[52:55], a[140:143], a[20:23], v[52:55]
  s_waitcnt vmcnt(14)
  v_accvgpr_read_b32 v26, a208
  v_accvgpr_read_b32 v27, a209
  v_mfma_f32_16x16x32_bf16 v[48:51], a[140:143], a[16:19], v[48:51]
  buffer_load_dwordx4 a[96:99], v0, s[36:39], s53 offen offset:0 sc1
  s_bfe_u32 s52, s87, 0x4001c
  v_mfma_f32_16x16x32_bf16 v[48:51], a[136:139], a[0:3], v[48:51]
  s_waitcnt lgkmcnt(7)
  s_mul_i32 s52, s52, 458752
  s_add_u32 m0, s88, 86016
  v_mfma_f32_16x16x32_bf16 v[64:67], a[144:147], a[0:3], v[64:67]
  ds_read_b64_tr_b16 a[174:175], v1 offset:10912
  v_accvgpr_read_b32 v28, a210
  v_mfma_f32_16x16x32_bf16 v[64:67], a[148:151], a[16:19], v[64:67]
  ds_read_b64_tr_b16 a[128:129], v1 offset:192
  v_accvgpr_read_b32 v29, a211
  v_mfma_f32_16x16x32_bf16 v[68:71], a[148:151], a[20:23], v[68:71]
  ds_read_b64_tr_b16 a[130:131], v1 offset:3776
  v_max_u32 v31, v26, v27
  v_mfma_f32_16x16x32_bf16 v[68:71], a[144:147], a[4:7], v[68:71]
  buffer_load_dwordx4 v3, s[16:19], s52 offen offset:0 lds
  v_max3_u32 v31, v31, v28, v29
  v_mfma_f32_16x16x32_bf16 v[72:75], a[144:147], a[8:11], v[72:75]
  ds_read_b64_tr_b16 a[132:133], v1 offset:7360
  v_accvgpr_read_b32 v22, a212
  v_mfma_f32_16x16x32_bf16 v[72:75], a[148:151], a[24:27], v[72:75]
  v_accvgpr_read_b32 v23, a213
  v_max3_u32 v31, v31, v22, v23
  v_mfma_f32_16x16x32_bf16 v[76:79], a[148:151], a[28:31], v[76:79]
  ds_read_b64_tr_b16 a[134:135], v1 offset:10944
  v_add_f32 v26, v26, v22
  v_mfma_f32_16x16x32_bf16 v[76:79], a[144:147], a[12:15], v[76:79]
  v_add_f32 v27, v27, v23
  v_accvgpr_read_b32 v22, a214
  v_mfma_f32_16x16x32_bf16 v[92:95], a[152:155], a[12:15], v[92:95]
  buffer_load_dwordx4 a[100:103], v0, s[36:39], s53 offen offset:1024 sc1
  v_accvgpr_read_b32 v23, a215
  v_mfma_f32_16x16x32_bf16 v[92:95], a[156:159], a[28:31], v[92:95]
  ds_read_b64_tr_b16 a[136:137], v1 offset:14336
  v_max3_u32 v31, v31, v22, v23
  v_mfma_f32_16x16x32_bf16 v[88:91], a[156:159], a[24:27], v[88:91]
  ds_read_b64_tr_b16 a[138:139], v1 offset:17920
  v_add_f32 v28, v28, v22
  v_mfma_f32_16x16x32_bf16 v[88:91], a[152:155], a[8:11], v[88:91]
  v_add_f32 v29, v29, v23
  v_accvgpr_read_b32 v22, a216
  v_mfma_f32_16x16x32_bf16 v[84:87], a[152:155], a[4:7], v[84:87]
  ds_read_b64_tr_b16 a[140:141], v1 offset:21504
  v_accvgpr_read_b32 v23, a217
  v_mfma_f32_16x16x32_bf16 v[84:87], a[156:159], a[20:23], v[84:87]
  buffer_load_dwordx4 v4, s[16:19], s52 offen offset:1024 lds
  v_max3_u32 v31, v31, v22, v23
  v_mfma_f32_16x16x32_bf16 v[80:83], a[156:159], a[16:19], v[80:83]
  ds_read_b64_tr_b16 a[142:143], v1 offset:25088
  v_add_f32 v26, v26, v22
  v_mfma_f32_16x16x32_bf16 v[80:83], a[152:155], a[0:3], v[80:83]
  s_waitcnt lgkmcnt(8)
  v_add_f32 v27, v27, v23
  v_accvgpr_read_b32 v22, a218
  v_mfma_f32_16x16x32_bf16 v[96:99], a[160:163], a[0:3], v[96:99]
  ds_read_b64_tr_b16 a[144:145], v1 offset:14368
  v_accvgpr_read_b32 v23, a219
  v_mfma_f32_16x16x32_bf16 v[96:99], a[164:167], a[16:19], v[96:99]
  v_max3_u32 v31, v31, v22, v23
  v_add_f32 v28, v28, v22
  v_mfma_f32_16x16x32_bf16 v[100:103], a[164:167], a[20:23], v[100:103]
  buffer_load_dwordx4 a[104:107], v0, s[36:39], s53 offen offset:2048 sc1
  v_add_f32 v29, v29, v23
  v_mfma_f32_16x16x32_bf16 v[100:103], a[160:163], a[4:7], v[100:103]
  ds_read_b64_tr_b16 a[146:147], v1 offset:17952
  v_accvgpr_read_b32 v22, a220
  v_mfma_f32_16x16x32_bf16 v[104:107], a[160:163], a[8:11], v[104:107]
  ds_read_b64_tr_b16 a[148:149], v1 offset:21536
  v_accvgpr_read_b32 v23, a221
  v_mfma_f32_16x16x32_bf16 v[104:107], a[164:167], a[24:27], v[104:107]
  v_max3_u32 v31, v31, v22, v23
  v_add_f32 v26, v26, v22
  v_mfma_f32_16x16x32_bf16 v[108:111], a[164:167], a[28:31], v[108:111]
  ds_read_b64_tr_b16 a[150:151], v1 offset:25120
  v_add_f32 v27, v27, v23
  v_mfma_f32_16x16x32_bf16 v[108:111], a[160:163], a[12:15], v[108:111]
  buffer_load_dwordx4 v5, s[16:19], s52 offen offset:2048 lds
  v_accvgpr_read_b32 v22, a222
  v_mfma_f32_16x16x32_bf16 v[124:127], a[168:171], a[12:15], v[124:127]
  ds_read_b64_tr_b16 a[152:153], v1 offset:14400
  v_accvgpr_read_b32 v23, a223
  v_mfma_f32_16x16x32_bf16 v[124:127], a[172:175], a[28:31], v[124:127]
  v_max3_u32 v31, v31, v22, v23
  v_add_f32 v28, v28, v22
  v_mfma_f32_16x16x32_bf16 v[120:123], a[172:175], a[24:27], v[120:123]
  ds_read_b64_tr_b16 a[154:155], v1 offset:17984
  v_add_f32 v29, v29, v23
  v_mfma_f32_16x16x32_bf16 v[120:123], a[168:171], a[8:11], v[120:123]
  v_cmp_eq_u32 vcc, -1, v31
  s_nop 4
  s_cbranch_vccnz CK5s
CK5x:
  v_mfma_f32_16x16x32_bf16 v[116:119], a[168:171], a[4:7], v[116:119]
  s_nop 0
  buffer_load_dwordx4 a[108:111], v0, s[36:39], s53 offen offset:3072 sc1
  v_permlane32_swap_b32 v26, v28
  v_mfma_f32_16x16x32_bf16 v[116:119], a[172:175], a[20:23], v[116:119]
  ds_read_b64_tr_b16 a[156:157], v1 offset:21568
  v_permlane32_swap_b32 v27, v29
  v_mfma_f32_16x16x32_bf16 v[112:115], a[172:175], a[16:19], v[112:115]
  ds_read_b64_tr_b16 a[158:159], v1 offset:25152
  v_add_f32 v26, v26, v28
  v_mfma_f32_16x16x32_bf16 v[112:115], a[168:171], a[0:3], v[112:115]
  s_waitcnt lgkmcnt(8)
  v_add_f32 v27, v27, v29
  v_cvt_pk_bf16_f32 v25, v26, v26
  v_mfma_f32_16x16x32_bf16 v[128:131], a[128:131], a[0:3], v[128:131]
  ds_read_b64_tr_b16 a[160:161], v1 offset:14432
  v_lshlrev_b32 v25, 16, v25
  v_mfma_f32_16x16x32_bf16 v[128:131], a[132:135], a[16:19], v[128:131]
  buffer_load_dwordx4 v6, s[16:19], s52 offen offset:3072 lds
  s_add_u32 s53, s53, 4096
  v_mfma_f32_16x16x32_bf16 v[132:135], a[132:135], a[20:23], v[132:135]
  ds_read_b64_tr_b16 a[162:163], v1 offset:18016
  v_sub_f32 v30, v26, v25
  v_mfma_f32_16x16x32_bf16 v[132:135], a[128:131], a[4:7], v[132:135]
  v_cvt_pk_bf16_f32 v22, v26, v30
  v_and_b32 v25, 0xffff0000, v22
  v_mfma_f32_16x16x32_bf16 v[136:139], a[128:131], a[8:11], v[136:139]
  ds_read_b64_tr_b16 a[164:165], v1 offset:21600
  v_sub_f32 v30, v30, v25
  v_mfma_f32_16x16x32_bf16 v[136:139], a[132:135], a[24:27], v[136:139]
  v_cvt_pk_bf16_f32 v23, v30, 0
  v_mfma_f32_16x16x32_bf16 v[140:143], a[132:135], a[28:31], v[140:143]
  buffer_load_dwordx4 a[112:115], v0, s[36:39], s53 offen offset:0 sc1
  s_add_u32 m0, s88, 90112
  v_mfma_f32_16x16x32_bf16 v[140:143], a[128:131], a[12:15], v[140:143]
  ds_read_b64_tr_b16 a[166:167], v1 offset:25184
  v_mfma_f32_16x16x32_bf16 v[156:159], a[136:139], a[12:15], v[156:159]
  ds_read_b64_tr_b16 a[168:169], v1 offset:14464
  v_mfma_f32_16x16x32_bf16 v[156:159], a[140:143], a[28:31], v[156:159]
  ds_write_b64 v24, v[22:23] offset:0
  v_cvt_pk_bf16_f32 v25, v27, v27
  v_mfma_f32_16x16x32_bf16 v[152:155], a[140:143], a[24:27], v[152:155]
  ds_read_b64_tr_b16 a[170:171], v1 offset:18048
  v_lshlrev_b32 v25, 16, v25
  v_mfma_f32_16x16x32_bf16 v[152:155], a[136:139], a[8:11], v[152:155]
  buffer_load_dwordx4 v7, s[16:19], s52 offen offset:0 lds
  v_sub_f32 v30, v27, v25
  v_mfma_f32_16x16x32_bf16 v[148:151], a[136:139], a[4:7], v[148:151]
  ds_read_b64_tr_b16 a[172:173], v1 offset:21632
  v_cvt_pk_bf16_f32 v28, v27, v30
  v_mfma_f32_16x16x32_bf16 v[148:151], a[140:143], a[20:23], v[148:151]
  v_and_b32 v25, 0xffff0000, v28
  v_sub_f32 v30, v30, v25
  v_mfma_f32_16x16x32_bf16 v[144:147], a[140:143], a[16:19], v[144:147]
  ds_read_b64_tr_b16 a[174:175], v1 offset:25216
  v_cvt_pk_bf16_f32 v29, v30, 0
  v_mfma_f32_16x16x32_bf16 v[144:147], a[136:139], a[0:3], v[144:147]
  s_waitcnt lgkmcnt(9)
  ds_write_b64 v24, v[28:29] offset:16
  s_waitcnt lgkmcnt(0)
  v_mfma_f32_16x16x32_bf16 v[160:163], a[144:147], a[0:3], v[160:163]
  buffer_load_dwordx4 a[116:119], v0, s[36:39], s53 offen offset:1024 sc1
  v_mfma_f32_16x16x32_bf16 v[160:163], a[148:151], a[16:19], v[160:163]
  s_lshl_b32 s58, s44, 8
  ds_read_b64_tr_b16 a[128:129], v1 offset:14496
  s_add_u32 s58, s58, s2
  v_mfma_f32_16x16x32_bf16 v[164:167], a[148:151], a[20:23], v[164:167]
  s_mul_i32 s58, s58, 7168
  ds_read_b64_tr_b16 a[130:131], v1 offset:18080
  v_mfma_f32_16x16x32_bf16 v[164:167], a[144:147], a[4:7], v[164:167]
  v_mfma_f32_16x16x32_bf16 v[168:171], a[144:147], a[8:11], v[168:171]
  ds_read_b64_tr_b16 a[132:133], v1 offset:21664
  v_mfma_f32_16x16x32_bf16 v[168:171], a[148:151], a[24:27], v[168:171]
  buffer_load_dwordx4 v8, s[16:19], s52 offen offset:1024 lds
  v_mfma_f32_16x16x32_bf16 v[172:175], a[148:151], a[28:31], v[172:175]
  ds_read_b64_tr_b16 a[134:135], v1 offset:25248
  v_mfma_f32_16x16x32_bf16 v[172:175], a[144:147], a[12:15], v[172:175]
  v_mfma_f32_16x16x32_bf16 v[188:191], a[152:155], a[12:15], v[188:191]
  ds_read_b64_tr_b16 a[136:137], v1 offset:14528
  v_mfma_f32_16x16x32_bf16 v[188:191], a[156:159], a[28:31], v[188:191]
  v_mfma_f32_16x16x32_bf16 v[184:187], a[156:159], a[24:27], v[184:187]
  buffer_load_dwordx4 a[120:123], v0, s[36:39], s53 offen offset:2048 sc1
  v_mfma_f32_16x16x32_bf16 v[184:187], a[152:155], a[8:11], v[184:187]
  ds_read_b64_tr_b16 a[138:139], v1 offset:18112
  v_mfma_f32_16x16x32_bf16 v[180:183], a[152:155], a[4:7], v[180:183]
  ds_read_b64_tr_b16 a[140:141], v1 offset:21696
  v_mfma_f32_16x16x32_bf16 v[180:183], a[156:159], a[20:23], v[180:183]
  v_mfma_f32_16x16x32_bf16 v[176:179], a[156:159], a[16:19], v[176:179]
  ds_read_b64_tr_b16 a[142:143], v1 offset:25280
  v_mfma_f32_16x16x32_bf16 v[176:179], a[152:155], a[0:3], v[176:179]
  s_waitcnt lgkmcnt(9)
  buffer_load_dwordx4 v9, s[16:19], s52 offen offset:2048 lds
  v_mfma_f32_16x16x32_bf16 v[192:195], a[160:163], a[0:3], v[192:195]
  ds_read_b64_tr_b16 a[144:145], v1 offset:28864
  v_mfma_f32_16x16x32_bf16 v[192:195], a[164:167], a[16:19], v[192:195]
  v_mfma_f32_16x16x32_bf16 v[196:199], a[164:167], a[20:23], v[196:199]
  ds_read_b64_tr_b16 a[146:147], v1 offset:32448
  v_mfma_f32_16x16x32_bf16 v[196:199], a[160:163], a[4:7], v[196:199]
  v_mfma_f32_16x16x32_bf16 v[200:203], a[160:163], a[8:11], v[200:203]
  buffer_load_dwordx4 a[124:127], v0, s[36:39], s53 offen offset:3072 sc1
  v_mfma_f32_16x16x32_bf16 v[200:203], a[164:167], a[24:27], v[200:203]
  ds_read_b64_tr_b16 a[148:149], v1 offset:36032
  v_mfma_f32_16x16x32_bf16 v[204:207], a[164:167], a[28:31], v[204:207]
  ds_read_b64_tr_b16 a[150:151], v1 offset:39616
  v_mfma_f32_16x16x32_bf16 v[204:207], a[160:163], a[12:15], v[204:207]
  s_waitcnt vmcnt(16)
  s_barrier
  v_mfma_f32_16x16x32_bf16 v[220:223], a[168:171], a[12:15], v[220:223]
  ds_read_b64_tr_b16 a[152:153], v1 offset:43200
  v_mfma_f32_16x16x32_bf16 v[220:223], a[172:175], a[28:31], v[220:223]
  v_mfma_f32_16x16x32_bf16 v[216:219], a[172:175], a[24:27], v[216:219]
  ds_read_b64_tr_b16 a[154:155], v1 offset:46784
  v_mfma_f32_16x16x32_bf16 v[216:219], a[168:171], a[8:11], v[216:219]
  v_mfma_f32_16x16x32_bf16 v[212:215], a[168:171], a[4:7], v[212:215]
  ds_read_b64_tr_b16 a[156:157], v1 offset:50368
  v_mfma_f32_16x16x32_bf16 v[212:215], a[172:175], a[20:23], v[212:215]
  v_mfma_f32_16x16x32_bf16 v[208:211], a[172:175], a[16:19], v[208:211]
  ds_read_b64_tr_b16 a[158:159], v1 offset:53952
  v_mfma_f32_16x16x32_bf16 v[208:211], a[168:171], a[0:3], v[208:211]
  s_waitcnt lgkmcnt(8)
  v_mfma_f32_16x16x32_bf16 v[224:227], a[128:131], a[0:3], v[224:227]
  ds_read_b64_tr_b16 a[160:161], v2 offset:192
  v_mfma_f32_16x16x32_bf16 v[224:227], a[132:135], a[16:19], v[224:227]
  v_mfma_f32_16x16x32_bf16 v[228:231], a[132:135], a[20:23], v[228:231]
  ds_read_b64_tr_b16 a[162:163], v2 offset:3776
  v_mfma_f32_16x16x32_bf16 v[228:231], a[128:131], a[4:7], v[228:231]
  v_mfma_f32_16x16x32_bf16 v[232:235], a[128:131], a[8:11], v[232:235]
  ds_read_b64_tr_b16 a[164:165], v2 offset:7360
  v_mfma_f32_16x16x32_bf16 v[232:235], a[132:135], a[24:27], v[232:235]
  v_mfma_f32_16x16x32_bf16 v[236:239], a[132:135], a[28:31], v[236:239]
  ds_read_b64_tr_b16 a[166:167], v2 offset:10944
  v_mfma_f32_16x16x32_bf16 v[236:239], a[128:131], a[12:15], v[236:239]
  v_mfma_f32_16x16x32_bf16 v[252:255], a[136:139], a[12:15], v[252:255]
  ds_read_b64_tr_b16 a[168:169], v2 offset:14528
  v_mfma_f32_16x16x32_bf16 v[252:255], a[140:143], a[28:31], v[252:255]
  v_mfma_f32_16x16x32_bf16 v[248:251], a[140:143], a[24:27], v[248:251]
  ds_read_b64_tr_b16 a[170:171], v2 offset:18112
  v_mfma_f32_16x16x32_bf16 v[248:251], a[136:139], a[8:11], v[248:251]
  v_mfma_f32_16x16x32_bf16 v[244:247], a[136:139], a[4:7], v[244:247]
  ds_read_b64_tr_b16 a[172:173], v2 offset:21696
  v_mfma_f32_16x16x32_bf16 v[244:247], a[140:143], a[20:23], v[244:247]
  v_mfma_f32_16x16x32_bf16 v[240:243], a[140:143], a[16:19], v[240:243]
  ds_read_b64_tr_b16 a[174:175], v2 offset:25280
  v_mfma_f32_16x16x32_bf16 v[240:243], a[136:139], a[0:3], v[240:243]
  s_waitcnt vmcnt(1) lgkmcnt(8)
  s_barrier
  v_mfma_f32_16x16x32_bf16 v[128:131], a[144:147], a[32:35], v[128:131]
  v_and_b32 v31, 0xf0, v0
  v_add_u32 v31, 159744, v31
  v_mfma_f32_16x16x32_bf16 v[128:131], a[148:151], a[48:51], v[128:131]
  s_barrier
  v_cmp_gt_u32 vcc, 0x100, v0
  s_mov_b32 s67, 0x01000100
  v_mfma_f32_16x16x32_bf16 v[132:135], a[148:151], a[52:55], v[132:135]
  s_mov_b32 s68, 0x03020302
  v_cndmask_b32 v12, 0, v12, vcc
  v_perm_b32 v22, v12, v12, s67
  v_mfma_f32_16x16x32_bf16 v[132:135], a[144:147], a[36:39], v[132:135]
  v_min_u32 v3, 880, v0
  v_lshlrev_b32 v3, 3, v3
  v_mfma_f32_16x16x32_bf16 v[136:139], a[144:147], a[40:43], v[136:139]
  buffer_load_dword a252, v3, s[24:27], s58 offen
  v_and_b32 v23, 0xffff, v12
  v_mfma_f32_16x16x32_bf16 v[136:139], a[148:151], a[56:59], v[136:139]
  v_perm_b32 v24, v12, v12, s68
  v_lshrrev_b32 v25, 16, v12
  v_mfma_f32_16x16x32_bf16 v[140:143], a[148:151], a[60:63], v[140:143]
  v_accvgpr_write_b32 a0, v22
  v_accvgpr_write_b32 a1, v23
  v_mfma_f32_16x16x32_bf16 v[140:143], a[144:147], a[44:47], v[140:143]
  v_accvgpr_write_b32 a2, v24
  v_accvgpr_write_b32 a3, v25
  v_mfma_f32_16x16x32_bf16 v[252:255], a[152:155], a[44:47], v[252:255]
  ds_read_b64_tr_b16 a[128:129], v2 offset:28864
  v_cndmask_b32 v15, 0, v15, vcc
  v_mfma_f32_16x16x32_bf16 v[252:255], a[156:159], a[60:63], v[252:255]
  v_perm_b32 v26, v15, v15, s67
  v_and_b32 v27, 0xffff, v15
  v_mfma_f32_16x16x32_bf16 v[248:251], a[156:159], a[56:59], v[248:251]
  ds_read_b64_tr_b16 a[130:131], v2 offset:32448
  v_perm_b32 v28, v15, v15, s68
  v_mfma_f32_16x16x32_bf16 v[248:251], a[152:155], a[40:43], v[248:251]
  v_lshrrev_b32 v29, 16, v15
  v_accvgpr_write_b32 a4, v26
  v_mfma_f32_16x16x32_bf16 v[244:247], a[152:155], a[36:39], v[244:247]
  ds_read_b64_tr_b16 a[132:133], v2 offset:36032
  v_accvgpr_write_b32 a5, v27
  v_mfma_f32_16x16x32_bf16 v[244:247], a[156:159], a[52:55], v[244:247]
  ds_read_b128 a[16:19], v31 offset:1536
  v_accvgpr_write_b32 a6, v28
  v_mfma_f32_16x16x32_bf16 v[240:243], a[156:159], a[48:51], v[240:243]
  ds_read_b128 a[20:23], v31 offset:3584
  v_accvgpr_write_b32 a7, v29
  v_mfma_f32_16x16x32_bf16 v[240:243], a[152:155], a[32:35], v[240:243]
  s_waitcnt vmcnt(16) lgkmcnt(5)
  ds_read_b64_tr_b16 a[134:135], v2 offset:39616
  v_cndmask_b32 v18, 0, v18, vcc
  v_mfma_f32_16x16x32_bf16 v[128:131], a[160:163], a[64:67], v[128:131]
  ds_read_b64_tr_b16 a[136:137], v2 offset:43200
  v_perm_b32 v22, v18, v18, s67
  v_mfma_f32_16x16x32_bf16 v[128:131], a[164:167], a[80:83], v[128:131]
  v_and_b32 v23, 0xffff, v18
  v_perm_b32 v24, v18, v18, s68
  v_mfma_f32_16x16x32_bf16 v[132:135], a[164:167], a[84:87], v[132:135]
  ds_read_b64_tr_b16 a[138:139], v2 offset:46784
  v_lshrrev_b32 v25, 16, v18
  v_mfma_f32_16x16x32_bf16 v[132:135], a[160:163], a[68:71], v[132:135]
  v_accvgpr_write_b32 a8, v22
  v_accvgpr_write_b32 a9, v23
  v_mfma_f32_16x16x32_bf16 v[136:139], a[160:163], a[72:75], v[136:139]
  ds_read_b64_tr_b16 a[140:141], v2 offset:50368
  v_accvgpr_write_b32 a10, v24
  v_mfma_f32_16x16x32_bf16 v[136:139], a[164:167], a[88:91], v[136:139]
  v_accvgpr_write_b32 a11, v25
  v_cndmask_b32 v21, 0, v21, vcc
  v_mfma_f32_16x16x32_bf16 v[140:143], a[164:167], a[92:95], v[140:143]
  ds_read_b64_tr_b16 a[142:143], v2 offset:53952
  v_perm_b32 v26, v21, v21, s67
  v_mfma_f32_16x16x32_bf16 v[140:143], a[160:163], a[76:79], v[140:143]
  v_and_b32 v27, 0xffff, v21
  v_perm_b32 v28, v21, v21, s68
  v_mfma_f32_16x16x32_bf16 v[252:255], a[168:171], a[76:79], v[252:255]
  ds_read_b64_tr_b16 a[144:145], v1 offset:28672
  v_lshrrev_b32 v29, 16, v21
  v_mfma_f32_16x16x32_bf16 v[252:255], a[172:175], a[92:95], v[252:255]
  v_accvgpr_write_b32 a12, v26
  v_accvgpr_write_b32 a13, v27
  v_mfma_f32_16x16x32_bf16 v[248:251], a[172:175], a[88:91], v[248:251]
  ds_read_b64_tr_b16 a[146:147], v1 offset:32256
  v_accvgpr_write_b32 a14, v28
  v_mfma_f32_16x16x32_bf16 v[248:251], a[168:171], a[72:75], v[248:251]
  v_accvgpr_write_b32 a15, v29
  v_mfma_f32_16x16x32_bf16 v[244:247], a[168:171], a[68:71], v[244:247]
  ds_read_b64_tr_b16 a[148:149], v1 offset:35840
  v_mfma_f32_16x16x32_bf16 v[244:247], a[172:175], a[84:87], v[244:247]
  v_mfma_f32_16x16x32_bf16 v[240:243], a[172:175], a[80:83], v[240:243]
  ds_read_b64_tr_b16 a[150:151], v1 offset:39424
  v_mfma_f32_16x16x32_bf16 v[240:243], a[168:171], a[64:67], v[240:243]
  s_waitcnt lgkmcnt(9)
  v_mfma_f32_16x16x32_bf16 v[128:131], a[16:19], a[0:3], v[128:131]
  v_mfma_f32_16x16x32_bf16 v[132:135], a[16:19], a[4:7], v[132:135]
  v_mfma_f32_16x16x32_bf16 v[136:139], a[16:19], a[8:11], v[136:139]
  v_mfma_f32_16x16x32_bf16 v[140:143], a[16:19], a[12:15], v[140:143]
  v_mfma_f32_16x16x32_bf16 v[240:243], a[20:23], a[0:3], v[240:243]
  v_mfma_f32_16x16x32_bf16 v[244:247], a[20:23], a[4:7], v[244:247]
  v_mfma_f32_16x16x32_bf16 v[248:251], a[20:23], a[8:11], v[248:251]
  v_mfma_f32_16x16x32_bf16 v[252:255], a[20:23], a[12:15], v[252:255]
  s_waitcnt vmcnt(1) lgkmcnt(4)
  v_mfma_f32_16x16x32_bf16 v[128:131], a[128:131], a[96:99], v[128:131]
  ds_read_b128 a[24:27], v31 offset:0
  v_mfma_f32_16x16x32_bf16 v[128:131], a[132:135], a[112:115], v[128:131]
  ds_read_b64_tr_b16 a[152:153], v1 offset:43008
  v_mfma_f32_16x16x32_bf16 v[132:135], a[132:135], a[116:119], v[132:135]
  ds_read_b128 a[28:31], v31 offset:2048
  v_mfma_f32_16x16x32_bf16 v[132:135], a[128:131], a[100:103], v[132:135]
  ds_read_b64_tr_b16 a[154:155], v1 offset:46592
  v_mfma_f32_16x16x32_bf16 v[136:139], a[128:131], a[104:107], v[136:139]
  ds_read_b64_tr_b16 a[156:157], v1 offset:50176
  v_mfma_f32_16x16x32_bf16 v[136:139], a[132:135], a[120:123], v[136:139]
  v_mfma_f32_16x16x32_bf16 v[140:143], a[132:135], a[124:127], v[140:143]
  ds_read_b64_tr_b16 a[158:159], v1 offset:53760
  v_mfma_f32_16x16x32_bf16 v[140:143], a[128:131], a[108:111], v[140:143]
  v_mfma_f32_16x16x32_bf16 v[252:255], a[136:139], a[108:111], v[252:255]
  ds_read_b64_tr_b16 a[160:161], v2 offset:0
  v_mul_f32 v22, v10, v128
  v_mul_f32 v23, v10, v129
  v_mul_f32 v24, v10, v130
  v_mfma_f32_16x16x32_bf16 v[252:255], a[140:143], a[124:127], v[252:255]
  v_mul_f32 v25, v10, v131
  v_exp_f32 v22, v22
  v_mul_f32 v26, v13, v132
  v_mfma_f32_16x16x32_bf16 v[248:251], a[140:143], a[120:123], v[248:251]
  ds_read_b64_tr_b16 a[162:163], v2 offset:3584
  v_exp_f32 v23, v23
  v_mul_f32 v27, v13, v133
  v_mfma_f32_16x16x32_bf16 v[248:251], a[136:139], a[104:107], v[248:251]
  v_exp_f32 v24, v24
  v_mul_f32 v28, v13, v134
  v_mfma_f32_16x16x32_bf16 v[244:247], a[136:139], a[100:103], v[244:247]
  ds_read_b64_tr_b16 a[164:165], v2 offset:7168
  v_exp_f32 v25, v25
  v_mul_f32 v29, v13, v135
  v_mfma_f32_16x16x32_bf16 v[244:247], a[140:143], a[116:119], v[244:247]
  v_exp_f32 v26, v26
  v_fma_f32 v22, v22, v11, v11
  v_mfma_f32_16x16x32_bf16 v[240:243], a[140:143], a[112:115], v[240:243]
  ds_read_b64_tr_b16 a[166:167], v2 offset:10752
  v_exp_f32 v27, v27
  v_fma_f32 v23, v23, v11, v11
  v_mfma_f32_16x16x32_bf16 v[240:243], a[136:139], a[96:99], v[240:243]
  s_waitcnt lgkmcnt(4)
  v_exp_f32 v28, v28
  v_fma_f32 v24, v24, v11, v11
  v_mfma_f32_16x16x32_bf16 v[32:35], a[144:147], a[32:35], v[32:35]
  ds_read_b64_tr_b16 a[168:169], v2 offset:14336
  v_exp_f32 v29, v29
  v_fma_f32 v25, v25, v11, v11
  v_mfma_f32_16x16x32_bf16 v[32:35], a[148:151], a[48:51], v[32:35]
  v_rcp_f32 v22, v22
  v_fma_f32 v26, v26, v14, v14
  v_mfma_f32_16x16x32_bf16 v[36:39], a[148:151], a[52:55], v[36:39]
  ds_read_b64_tr_b16 a[170:171], v2 offset:17920
  v_rcp_f32 v23, v23
  v_fma_f32 v27, v27, v14, v14
  v_mfma_f32_16x16x32_bf16 v[36:39], a[144:147], a[36:39], v[36:39]
  v_rcp_f32 v24, v24
  v_fma_f32 v28, v28, v14, v14
  v_mfma_f32_16x16x32_bf16 v[40:43], a[144:147], a[40:43], v[40:43]
  ds_read_b64_tr_b16 a[172:173], v2 offset:21504
  v_rcp_f32 v25, v25
  v_fma_f32 v29, v29, v14, v14
  v_mfma_f32_16x16x32_bf16 v[40:43], a[148:151], a[56:59], v[40:43]
  v_rcp_f32 v26, v26
  v_mul_f32 v240, v128, v240
  v_mfma_f32_16x16x32_bf16 v[44:47], a[148:151], a[60:63], v[44:47]
  ds_read_b64_tr_b16 a[174:175], v2 offset:25088
  v_rcp_f32 v27, v27
  v_mul_f32 v241, v129, v241
  v_mfma_f32_16x16x32_bf16 v[44:47], a[144:147], a[44:47], v[44:47]
  s_waitcnt lgkmcnt(11)
  v_rcp_f32 v28, v28
  v_mul_f32 v242, v130, v242
  v_mfma_f32_16x16x32_bf16 v[32:35], a[24:27], a[0:3], v[32:35]
  ds_read_b64_tr_b16 a[128:129], v2 offset:28672
  v_rcp_f32 v29, v29
  v_mul_f32 v243, v131, v243
  v_mfma_f32_16x16x32_bf16 v[36:39], a[24:27], a[4:7], v[36:39]
  v_mul_f32 v240, v240, v22
  v_mul_f32 v241, v241, v23
  v_mul_f32 v242, v242, v24
  v_mul_f32 v243, v243, v25
  v_mfma_f32_16x16x32_bf16 v[40:43], a[24:27], a[8:11], v[40:43]
  ds_read_b64_tr_b16 a[130:131], v2 offset:32256
  v_mul_f32 v22, v16, v136
  v_mul_f32 v23, v16, v137
  v_mul_f32 v24, v16, v138
  v_mfma_f32_16x16x32_bf16 v[44:47], a[24:27], a[12:15], v[44:47]
  v_mul_f32 v25, v16, v139
  v_exp_f32 v22, v22
  v_mul_f32 v244, v132, v244
  v_mfma_f32_16x16x32_bf16 v[144:147], a[28:31], a[0:3], v[144:147]
  ds_read_b64_tr_b16 a[132:133], v2 offset:35840
  v_exp_f32 v23, v23
  v_mul_f32 v245, v133, v245
  v_mfma_f32_16x16x32_bf16 v[148:151], a[28:31], a[4:7], v[148:151]
  v_exp_f32 v24, v24
  v_mul_f32 v246, v134, v246
  v_mfma_f32_16x16x32_bf16 v[152:155], a[28:31], a[8:11], v[152:155]
  ds_read_b64_tr_b16 a[134:135], v2 offset:39424
  v_exp_f32 v25, v25
  v_mul_f32 v247, v135, v247
  v_mfma_f32_16x16x32_bf16 v[156:159], a[28:31], a[12:15], v[156:159]
Hb2_1:
  s_cbranch_execz Hb2_2
  v_mul_f32 v244, v244, v26
  v_mul_f32 v245, v245, v27
  v_mul_f32 v246, v246, v28
  v_mul_f32 v247, v247, v29
  v_mfma_f32_16x16x32_bf16 v[156:159], a[152:155], a[44:47], v[156:159]
  ds_read_b64_tr_b16 a[136:137], v2 offset:43008
  v_cvt_pk_bf16_f32 v128, v240, v241
  v_cvt_pk_bf16_f32 v129, v242, v243
  v_mfma_f32_16x16x32_bf16 v[156:159], a[156:159], a[60:63], v[156:159]
  buffer_store_dwordx2 v[128:129], v0, s[36:39], s64 offen offset:0 sc1
  v_mul_f32 v26, v19, v140
  v_mul_f32 v27, v19, v141
  v_mul_f32 v28, v19, v142
  v_mfma_f32_16x16x32_bf16 v[152:155], a[156:159], a[56:59], v[152:155]
  ds_read_b64_tr_b16 a[138:139], v2 offset:46592
  v_mul_f32 v29, v19, v143
  v_exp_f32 v26, v26
  v_mfma_f32_16x16x32_bf16 v[152:155], a[152:155], a[40:43], v[152:155]
  v_fma_f32 v22, v22, v17, v17
  v_exp_f32 v27, v27
  v_fma_f32 v23, v23, v17, v17
  v_mfma_f32_16x16x32_bf16 v[148:151], a[152:155], a[36:39], v[148:151]
  ds_read_b64_tr_b16 a[140:141], v2 offset:50176
  v_exp_f32 v28, v28
  v_fma_f32 v24, v24, v17, v17
  v_mfma_f32_16x16x32_bf16 v[148:151], a[156:159], a[52:55], v[148:151]
  v_exp_f32 v29, v29
  v_fma_f32 v25, v25, v17, v17
  v_cvt_pk_bf16_f32 v132, v244, v245
  v_mfma_f32_16x16x32_bf16 v[144:147], a[156:159], a[48:51], v[144:147]
  ds_read_b64_tr_b16 a[142:143], v2 offset:53760
  v_cvt_pk_bf16_f32 v133, v246, v247
  v_mfma_f32_16x16x32_bf16 v[144:147], a[152:155], a[32:35], v[144:147]
  s_waitcnt lgkmcnt(8)
  buffer_store_dwordx2 v[132:133], v0, s[36:39], s64 offen offset:1024 sc1
  v_rcp_f32 v22, v22
  v_fma_f32 v26, v26, v20, v20
  v_mfma_f32_16x16x32_bf16 v[32:35], a[160:163], a[64:67], v[32:35]
  ds_read_b64_tr_b16 a[144:145], v1 offset:28704
  v_rcp_f32 v23, v23
  v_fma_f32 v27, v27, v20, v20
  v_mfma_f32_16x16x32_bf16 v[32:35], a[164:167], a[80:83], v[32:35]
  v_rcp_f32 v24, v24
  v_fma_f32 v28, v28, v20, v20
  v_mfma_f32_16x16x32_bf16 v[36:39], a[164:167], a[84:87], v[36:39]
  ds_read_b64_tr_b16 a[146:147], v1 offset:32288
  v_rcp_f32 v25, v25
  v_fma_f32 v29, v29, v20, v20
  v_mfma_f32_16x16x32_bf16 v[36:39], a[160:163], a[68:71], v[36:39]
  v_rcp_f32 v26, v26
  v_mul_f32 v248, v136, v248
  v_mfma_f32_16x16x32_bf16 v[40:43], a[160:163], a[72:75], v[40:43]
  ds_read_b64_tr_b16 a[148:149], v1 offset:35872
  v_rcp_f32 v27, v27
  v_mul_f32 v249, v137, v249
  v_mfma_f32_16x16x32_bf16 v[40:43], a[164:167], a[88:91], v[40:43]
  v_rcp_f32 v28, v28
  v_mul_f32 v250, v138, v250
  v_mfma_f32_16x16x32_bf16 v[44:47], a[164:167], a[92:95], v[44:47]
  ds_read_b64_tr_b16 a[150:151], v1 offset:39456
  v_rcp_f32 v29, v29
  v_mul_f32 v251, v139, v251
  v_mfma_f32_16x16x32_bf16 v[44:47], a[160:163], a[76:79], v[44:47]
  v_mul_f32 v248, v248, v22
  v_mul_f32 v249, v249, v23
  v_mul_f32 v250, v250, v24
  v_mul_f32 v251, v251, v25
  v_mfma_f32_16x16x32_bf16 v[156:159], a[168:171], a[76:79], v[156:159]
  v_mul_f32 v252, v140, v252
  v_mul_f32 v253, v141, v253
  v_mul_f32 v254, v142, v254
  v_mul_f32 v255, v143, v255
  v_mfma_f32_16x16x32_bf16 v[156:159], a[172:175], a[92:95], v[156:159]
  v_cvt_pk_bf16_f32 v136, v248, v249
  v_cvt_pk_bf16_f32 v137, v250, v251
  v_mfma_f32_16x16x32_bf16 v[152:155], a[172:175], a[88:91], v[152:155]
  buffer_store_dwordx2 v[136:137], v0, s[36:39], s65 offen offset:0 sc1
  v_mul_f32 v252, v252, v26
  v_mul_f32 v253, v253, v27
  v_mul_f32 v254, v254, v28
  v_mfma_f32_16x16x32_bf16 v[152:155], a[168:171], a[72:75], v[152:155]
  v_mul_f32 v255, v255, v29
  v_cvt_pk_bf16_f32 v140, v252, v253
  v_cvt_pk_bf16_f32 v141, v254, v255
  v_mfma_f32_16x16x32_bf16 v[148:151], a[168:171], a[68:71], v[148:151]
  buffer_store_dwordx2 v[140:141], v0, s[36:39], s65 offen offset:1024 sc1
  s_mov_b32 s64, s66
  s_add_u32 s65, s66, 262144
  v_mfma_f32_16x16x32_bf16 v[148:151], a[172:175], a[84:87], v[148:151]
  v_lshrrev_b32 v128, 4, v0
  s_add_u32 s83, s54, s71
  s_and_b32 s83, s83, 3
  s_and_b32 s90, s2, 1
  v_mfma_f32_16x16x32_bf16 v[144:147], a[172:175], a[80:83], v[144:147]
  s_lshl_b32 s85, s55, 7
  s_lshl3_add_u32 s85, s73, s85
  s_mul_i32 s84, s90, 3670016
  s_add_u32 s85, s85, s84
  s_lshr_b32 s84, s44, 1
  v_mfma_f32_16x16x32_bf16 v[144:147], a[168:171], a[64:67], v[144:147]
  s_waitcnt lgkmcnt(4)
  s_mul_i32 s84, s84, 393216
  v_bfe_u32 v129, v128, 4, 2
  v_bfe_u32 v130, v128, 1, 2
  v_xor_b32 v129, v129, v130
  v_mfma_f32_16x16x32_bf16 v[32:35], a[128:131], a[96:99], v[32:35]
  ds_read_b128 a[16:19], v31 offset:256
  v_lshlrev_b32 v129, 5, v129
  v_and_b32 v130, 1, v128
  v_lshl_add_u32 v129, v130, 4, v129
  v_mfma_f32_16x16x32_bf16 v[32:35], a[132:135], a[112:115], v[32:35]
  ds_read_b64_tr_b16 a[152:153], v1 offset:43040
  v_lshrrev_b32 v130, 3, v128
  v_lshlrev_b32 v130, 11, v130
  s_sub_u32 s24, s24, 2048
  v_mfma_f32_16x16x32_bf16 v[36:39], a[132:135], a[116:119], v[36:39]
  s_subb_u32 s25, s25, 0
  s_mov_b32 s26, 7342080
  ds_read_b128 a[20:23], v31 offset:2304
  v_add3_u32 v129, v129, v130, s85
  v_add_u32 v133, 2048, v129
  v_mfma_f32_16x16x32_bf16 v[36:39], a[128:131], a[100:103], v[36:39]
  ds_read_b64_tr_b16 a[154:155], v1 offset:46624
  v_add_u32 v134, 17408, v129
  v_xor_b32 v135, 128, v129
  v_add_u32 v136, 15360, v135
  v_mfma_f32_16x16x32_bf16 v[40:43], a[128:131], a[104:107], v[40:43]
  ds_read_b64_tr_b16 a[156:157], v1 offset:50208
  v_and_b32 v129, 7, v128
  v_lshrrev_b32 v131, 4, v128
  v_xor_b32 v129, v129, v131
  v_mfma_f32_16x16x32_bf16 v[40:43], a[132:135], a[120:123], v[40:43]
  v_lshl_add_u32 v252, v129, 4, v130
  v_xor_b32 v253, 64, v252
  v_add_u32 v253, 16384, v253
  s_lshl2_add_u32 s85, s54, s44
  v_mfma_f32_16x16x32_bf16 v[44:47], a[132:135], a[124:127], v[44:47]
  s_lshl_b32 s85, s85, 18
  s_mul_i32 s91, s90, 114688
  s_add_u32 s85, s85, s91
  s_add_u32 s85, s85, 19922944
  ds_read_b64_tr_b16 a[158:159], v1 offset:53792
  v_mfma_f32_16x16x32_bf16 v[44:47], a[128:131], a[108:111], v[44:47]
  v_add_u32 v137, s85, v0
  v_bfe_u32 v129, v128, 3, 2
  v_lshlrev_b32 v129, 5, v129
  v_and_b32 v130, 3, v128
  v_mfma_f32_16x16x32_bf16 v[156:159], a[136:139], a[108:111], v[156:159]
  ds_read_b64_tr_b16 a[160:161], v2 offset:32
  v_lshl_add_u32 v129, v130, 3, v129
  v_lshrrev_b32 v130, 2, v128
  v_lshl_add_u32 v240, v130, 7, v129
  v_mfma_f32_16x16x32_bf16 v[156:159], a[140:143], a[124:127], v[156:159]
  v_xor_b32 v241, 32, v240
  v_xor_b32 v242, 64, v240
  v_xor_b32 v243, 96, v240
  v_xor_b32 v244, 65536, v240
  v_mfma_f32_16x16x32_bf16 v[152:155], a[140:143], a[120:123], v[152:155]
  ds_read_b64_tr_b16 a[162:163], v2 offset:3616
  v_xor_b32 v245, 65568, v240
  v_xor_b32 v246, 65600, v240
  v_xor_b32 v247, 65632, v240
  v_mfma_f32_16x16x32_bf16 v[152:155], a[136:139], a[104:107], v[152:155]
  v_xor_b32 v248, 131072, v240
  v_xor_b32 v249, 131104, v240
  v_xor_b32 v250, 131136, v240
  v_xor_b32 v251, 131168, v240
  v_mfma_f32_16x16x32_bf16 v[148:151], a[136:139], a[100:103], v[148:151]
  s_lshr_b32 s85, s54, 1
  s_lshl_b32 s85, s85, 5
  s_lshl2_add_u32 s85, s90, s85
  ds_read_b64_tr_b16 a[164:165], v2 offset:7200
  v_and_b32 v129, 3, v128
  v_mfma_f32_16x16x32_bf16 v[148:151], a[140:143], a[116:119], v[148:151]
  v_bfe_u32 v130, v128, 2, 2
  v_lshl_add_u32 v129, v129, 3, v130
  v_add_lshl_u32 v138, v129, s85, 7
  v_mov_b32 v254, 1
  v_mfma_f32_16x16x32_bf16 v[144:147], a[140:143], a[112:115], v[144:147]
  s_mov_b32 s91, 5406720
  ds_read_b64_tr_b16 a[166:167], v2 offset:10784
  v_mul_f32 v22, v10, v32
  v_mul_f32 v23, v10, v33
  v_mul_f32 v24, v10, v34
  v_mfma_f32_16x16x32_bf16 v[144:147], a[136:139], a[96:99], v[144:147]
  s_waitcnt lgkmcnt(4)
  v_mul_f32 v25, v10, v35
  v_exp_f32 v22, v22
  v_mul_f32 v26, v13, v36
  v_mfma_f32_16x16x32_bf16 v[48:51], a[144:147], a[32:35], v[48:51]
  ds_read_b64_tr_b16 a[168:169], v2 offset:14368
  v_exp_f32 v23, v23
  v_mul_f32 v27, v13, v37
  v_mfma_f32_16x16x32_bf16 v[48:51], a[148:151], a[48:51], v[48:51]
  v_exp_f32 v24, v24
  v_mul_f32 v28, v13, v38
  v_mfma_f32_16x16x32_bf16 v[52:55], a[148:151], a[52:55], v[52:55]
  ds_read_b64_tr_b16 a[170:171], v2 offset:17952
  v_exp_f32 v25, v25
  v_mul_f32 v29, v13, v39
  v_mfma_f32_16x16x32_bf16 v[52:55], a[144:147], a[36:39], v[52:55]
  v_exp_f32 v26, v26
  v_fma_f32 v22, v22, v11, v11
  v_mfma_f32_16x16x32_bf16 v[56:59], a[144:147], a[40:43], v[56:59]
  ds_read_b64_tr_b16 a[172:173], v2 offset:21536
  v_exp_f32 v27, v27
  v_fma_f32 v23, v23, v11, v11
  v_mfma_f32_16x16x32_bf16 v[56:59], a[148:151], a[56:59], v[56:59]
  v_exp_f32 v28, v28
  v_fma_f32 v24, v24, v11, v11
  v_mfma_f32_16x16x32_bf16 v[60:63], a[148:151], a[60:63], v[60:63]
  ds_read_b64_tr_b16 a[174:175], v2 offset:25120
  v_exp_f32 v29, v29
  v_fma_f32 v25, v25, v11, v11
  v_mfma_f32_16x16x32_bf16 v[60:63], a[144:147], a[44:47], v[60:63]
  s_waitcnt lgkmcnt(11)
  v_rcp_f32 v22, v22
  v_fma_f32 v26, v26, v14, v14
  v_mfma_f32_16x16x32_bf16 v[48:51], a[16:19], a[0:3], v[48:51]
  ds_read_b64_tr_b16 a[128:129], v2 offset:28704
  v_rcp_f32 v23, v23
  v_fma_f32 v27, v27, v14, v14
  v_mfma_f32_16x16x32_bf16 v[52:55], a[16:19], a[4:7], v[52:55]
  v_rcp_f32 v24, v24
  v_fma_f32 v28, v28, v14, v14
  v_mfma_f32_16x16x32_bf16 v[56:59], a[16:19], a[8:11], v[56:59]
  ds_read_b64_tr_b16 a[130:131], v2 offset:32288
  v_rcp_f32 v25, v25
  v_fma_f32 v29, v29, v14, v14
  v_mfma_f32_16x16x32_bf16 v[60:63], a[16:19], a[12:15], v[60:63]
  v_rcp_f32 v26, v26
  v_mul_f32 v144, v32, v144
  v_mfma_f32_16x16x32_bf16 v[160:163], a[20:23], a[0:3], v[160:163]
  ds_read_b64_tr_b16 a[132:133], v2 offset:35872
  v_rcp_f32 v27, v27
  v_mul_f32 v145, v33, v145
  v_mfma_f32_16x16x32_bf16 v[164:167], a[20:23], a[4:7], v[164:167]
  v_rcp_f32 v28, v28
  v_mul_f32 v146, v34, v146
  v_mfma_f32_16x16x32_bf16 v[168:171], a[20:23], a[8:11], v[168:171]
  ds_read_b64_tr_b16 a[134:135], v2 offset:39456
  v_rcp_f32 v29, v29
  v_mul_f32 v147, v35, v147
  v_mfma_f32_16x16x32_bf16 v[172:175], a[20:23], a[12:15], v[172:175]
  v_mul_f32 v144, v144, v22
  v_mul_f32 v145, v145, v23
  v_mul_f32 v146, v146, v24
  v_mul_f32 v147, v147, v25
  v_mfma_f32_16x16x32_bf16 v[172:175], a[152:155], a[44:47], v[172:175]
  ds_read_b64_tr_b16 a[136:137], v2 offset:43040
  v_mul_f32 v22, v16, v40
  v_mul_f32 v23, v16, v41
  v_mul_f32 v24, v16, v42
  v_mul_f32 v25, v16, v43
  v_mfma_f32_16x16x32_bf16 v[172:175], a[156:159], a[60:63], v[172:175]
  v_exp_f32 v22, v22
  v_mul_f32 v148, v36, v148
  v_mfma_f32_16x16x32_bf16 v[168:171], a[156:159], a[56:59], v[168:171]
  ds_read_b64_tr_b16 a[138:139], v2 offset:46624
  v_exp_f32 v23, v23
  v_mul_f32 v149, v37, v149
  v_mfma_f32_16x16x32_bf16 v[168:171], a[152:155], a[40:43], v[168:171]
  v_exp_f32 v24, v24
  v_mul_f32 v150, v38, v150
  v_mfma_f32_16x16x32_bf16 v[164:167], a[152:155], a[36:39], v[164:167]
  ds_read_b64_tr_b16 a[140:141], v2 offset:50208
  v_exp_f32 v25, v25
  v_mul_f32 v151, v39, v151
  v_mfma_f32_16x16x32_bf16 v[164:167], a[156:159], a[52:55], v[164:167]
  v_mul_f32 v148, v148, v26
  v_mul_f32 v149, v149, v27
  v_mul_f32 v150, v150, v28
  v_mul_f32 v151, v151, v29
  v_mfma_f32_16x16x32_bf16 v[160:163], a[156:159], a[48:51], v[160:163]
  ds_read_b64_tr_b16 a[142:143], v2 offset:53792
  v_cvt_pk_bf16_f32 v32, v144, v145
  v_cvt_pk_bf16_f32 v33, v146, v147
  v_mul_f32 v26, v19, v44
  v_mfma_f32_16x16x32_bf16 v[160:163], a[152:155], a[32:35], v[160:163]
  s_waitcnt lgkmcnt(8)
  v_mul_f32 v27, v19, v45
  v_mul_f32 v28, v19, v46
  v_mul_f32 v29, v19, v47
  v_mfma_f32_16x16x32_bf16 v[48:51], a[160:163], a[64:67], v[48:51]
  ds_read_b64_tr_b16 a[144:145], v1 offset:28736
  v_exp_f32 v26, v26
  v_fma_f32 v22, v22, v17, v17
  v_mfma_f32_16x16x32_bf16 v[48:51], a[164:167], a[80:83], v[48:51]
  v_exp_f32 v27, v27
  v_fma_f32 v23, v23, v17, v17
  v_mfma_f32_16x16x32_bf16 v[52:55], a[164:167], a[84:87], v[52:55]
  s_mov_b32 s70, 3
  s_lshl_b32 s50, s70, 16
  s_add_u32 m0, s73, 114688
  ds_read_b64_tr_b16 a[146:147], v1 offset:32320
  v_mfma_f32_16x16x32_bf16 v[52:55], a[160:163], a[68:71], v[52:55]
  v_exp_f32 v28, v28
  v_fma_f32 v24, v24, v17, v17
  v_mfma_f32_16x16x32_bf16 v[56:59], a[160:163], a[72:75], v[56:59]
  ds_read_b64_tr_b16 a[148:149], v1 offset:35904
  v_exp_f32 v29, v29
  v_fma_f32 v25, v25, v17, v17
  v_mfma_f32_16x16x32_bf16 v[56:59], a[164:167], a[88:91], v[56:59]
  v_cvt_pk_bf16_f32 v36, v148, v149
  v_cvt_pk_bf16_f32 v37, v150, v151
  v_rcp_f32 v22, v22
  v_mfma_f32_16x16x32_bf16 v[60:63], a[164:167], a[92:95], v[60:63]
  buffer_load_dwordx4 v133, s[24:27], s50 offen offset:0 lds
  v_fma_f32 v26, v26, v20, v20
  v_rcp_f32 v23, v23
  v_mfma_f32_16x16x32_bf16 v[60:63], a[160:163], a[76:79], v[60:63]
  ds_read_b64_tr_b16 a[150:151], v1 offset:39488
  v_fma_f32 v27, v27, v20, v20
  v_rcp_f32 v24, v24
  v_mfma_f32_16x16x32_bf16 v[172:175], a[168:171], a[76:79], v[172:175]
  v_fma_f32 v28, v28, v20, v20
  v_rcp_f32 v25, v25
  v_fma_f32 v29, v29, v20, v20
  v_mfma_f32_16x16x32_bf16 v[172:175], a[172:175], a[92:95], v[172:175]
  v_rcp_f32 v26, v26
  v_mul_f32 v152, v40, v152
  v_mfma_f32_16x16x32_bf16 v[168:171], a[172:175], a[88:91], v[168:171]
  v_rcp_f32 v27, v27
  v_mul_f32 v153, v41, v153
  v_mfma_f32_16x16x32_bf16 v[168:171], a[168:171], a[72:75], v[168:171]
  buffer_load_dwordx4 v134, s[24:27], s50 offen offset:1024 lds
  v_rcp_f32 v28, v28
  v_mul_f32 v154, v42, v154
  v_mfma_f32_16x16x32_bf16 v[164:167], a[168:171], a[68:71], v[164:167]
  v_rcp_f32 v29, v29
  v_mul_f32 v155, v43, v155
  v_mul_f32 v152, v152, v22
  v_mfma_f32_16x16x32_bf16 v[164:167], a[172:175], a[84:87], v[164:167]
  v_mul_f32 v153, v153, v23
  v_mul_f32 v154, v154, v24
  v_mul_f32 v155, v155, v25
  v_mul_f32 v156, v44, v156
  v_mfma_f32_16x16x32_bf16 v[160:163], a[172:175], a[80:83], v[160:163]
  v_mul_f32 v157, v45, v157
  v_mul_f32 v158, v46, v158
  v_mul_f32 v159, v47, v159
  v_cvt_pk_bf16_f32 v40, v152, v153
  v_mfma_f32_16x16x32_bf16 v[160:163], a[168:171], a[64:67], v[160:163]
  s_waitcnt lgkmcnt(4)
  v_cvt_pk_bf16_f32 v41, v154, v155
  v_mul_f32 v156, v156, v26
  v_mul_f32 v157, v157, v27
  v_mul_f32 v158, v158, v28
  v_mfma_f32_16x16x32_bf16 v[48:51], a[128:131], a[96:99], v[48:51]
  ds_read_b128 a[24:27], v31 offset:512
  v_mul_f32 v159, v159, v29
  v_cvt_pk_bf16_f32 v44, v156, v157
  v_cvt_pk_bf16_f32 v45, v158, v159
  v_mfma_f32_16x16x32_bf16 v[48:51], a[132:135], a[112:115], v[48:51]
  buffer_load_dwordx4 v135, s[24:27], s50 offen offset:2048 lds
  v_mfma_f32_16x16x32_bf16 v[52:55], a[132:135], a[116:119], v[52:55]
  ds_read_b64_tr_b16 a[152:153], v1 offset:43072
  v_mfma_f32_16x16x32_bf16 v[52:55], a[128:131], a[100:103], v[52:55]
  ds_read_b128 a[28:31], v31 offset:2560
  v_mfma_f32_16x16x32_bf16 v[56:59], a[128:131], a[104:107], v[56:59]
  ds_read_b64_tr_b16 a[154:155], v1 offset:46656
  v_mfma_f32_16x16x32_bf16 v[56:59], a[132:135], a[120:123], v[56:59]
  ds_read_b64_tr_b16 a[156:157], v1 offset:50240
  v_mfma_f32_16x16x32_bf16 v[60:63], a[132:135], a[124:127], v[60:63]
  buffer_load_dwordx4 v136, s[24:27], s50 offen offset:3072 lds
  s_cmp_eq_u32 s83, 1
  s_cselect_b32 s74, 38, 10
  s_lshl_b32 s50, s74, 16
  v_mfma_f32_16x16x32_bf16 v[60:63], a[128:131], a[108:111], v[60:63]
  s_add_u32 m0, s73, 131072
  ds_read_b64_tr_b16 a[158:159], v1 offset:53824
  v_mfma_f32_16x16x32_bf16 v[172:175], a[136:139], a[108:111], v[172:175]
  ds_read_b64_tr_b16 a[160:161], v2 offset:64
  v_mul_f32 v22, v10, v48
  v_mul_f32 v23, v10, v49
  v_mul_f32 v24, v10, v50
  v_mfma_f32_16x16x32_bf16 v[172:175], a[140:143], a[124:127], v[172:175]
  v_mul_f32 v25, v10, v51
  v_exp_f32 v22, v22
  v_mul_f32 v26, v13, v52
  v_mfma_f32_16x16x32_bf16 v[168:171], a[140:143], a[120:123], v[168:171]
  buffer_load_dwordx4 v133, s[24:27], s50 offen offset:0 lds
  v_exp_f32 v23, v23
  v_mul_f32 v27, v13, v53
  v_mfma_f32_16x16x32_bf16 v[168:171], a[136:139], a[104:107], v[168:171]
  ds_read_b64_tr_b16 a[162:163], v2 offset:3648
  v_exp_f32 v24, v24
  v_mul_f32 v28, v13, v54
  v_mfma_f32_16x16x32_bf16 v[164:167], a[136:139], a[100:103], v[164:167]
  ds_read_b64_tr_b16 a[164:165], v2 offset:7232
  v_exp_f32 v25, v25
  v_mul_f32 v29, v13, v55
  v_mfma_f32_16x16x32_bf16 v[164:167], a[140:143], a[116:119], v[164:167]
  v_exp_f32 v26, v26
  v_fma_f32 v22, v22, v11, v11
  v_mfma_f32_16x16x32_bf16 v[160:163], a[140:143], a[112:115], v[160:163]
  ds_read_b64_tr_b16 a[166:167], v2 offset:10816
  v_exp_f32 v27, v27
  v_fma_f32 v23, v23, v11, v11
  v_mfma_f32_16x16x32_bf16 v[160:163], a[136:139], a[96:99], v[160:163]
  s_waitcnt lgkmcnt(4)
  buffer_load_dwordx4 v134, s[24:27], s50 offen offset:1024 lds
  v_exp_f32 v28, v28
  v_fma_f32 v24, v24, v11, v11
  v_mfma_f32_16x16x32_bf16 v[64:67], a[144:147], a[32:35], v[64:67]
  ds_read_b64_tr_b16 a[168:169], v2 offset:14400
  v_exp_f32 v29, v29
  v_fma_f32 v25, v25, v11, v11
  v_mfma_f32_16x16x32_bf16 v[64:67], a[148:151], a[48:51], v[64:67]
  v_rcp_f32 v22, v22
  v_fma_f32 v26, v26, v14, v14
  v_mfma_f32_16x16x32_bf16 v[68:71], a[148:151], a[52:55], v[68:71]
  ds_read_b64_tr_b16 a[170:171], v2 offset:17984
  v_rcp_f32 v23, v23
  v_fma_f32 v27, v27, v14, v14
  v_mfma_f32_16x16x32_bf16 v[68:71], a[144:147], a[36:39], v[68:71]
  v_rcp_f32 v24, v24
  v_fma_f32 v28, v28, v14, v14
  v_mfma_f32_16x16x32_bf16 v[72:75], a[144:147], a[40:43], v[72:75]
  buffer_load_dwordx4 v135, s[24:27], s50 offen offset:2048 lds
  v_rcp_f32 v25, v25
  v_fma_f32 v29, v29, v14, v14
  v_mfma_f32_16x16x32_bf16 v[72:75], a[148:151], a[56:59], v[72:75]
  ds_read_b64_tr_b16 a[172:173], v2 offset:21568
  v_rcp_f32 v26, v26
  v_mul_f32 v160, v48, v160
  v_mfma_f32_16x16x32_bf16 v[76:79], a[148:151], a[60:63], v[76:79]
  ds_read_b64_tr_b16 a[174:175], v2 offset:25152
  v_rcp_f32 v27, v27
  v_mul_f32 v161, v49, v161
  v_mfma_f32_16x16x32_bf16 v[76:79], a[144:147], a[44:47], v[76:79]
  s_waitcnt lgkmcnt(11)
  v_rcp_f32 v28, v28
  v_mul_f32 v162, v50, v162
  v_mfma_f32_16x16x32_bf16 v[64:67], a[24:27], a[0:3], v[64:67]
  ds_read_b64_tr_b16 a[128:129], v2 offset:28736
  v_rcp_f32 v29, v29
  v_mul_f32 v163, v51, v163
  v_mfma_f32_16x16x32_bf16 v[68:71], a[24:27], a[4:7], v[68:71]
  buffer_load_dwordx4 v136, s[24:27], s50 offen offset:3072 lds
  v_mul_f32 v160, v160, v22
  v_mul_f32 v161, v161, v23
  v_mul_f32 v162, v162, v24
  v_mfma_f32_16x16x32_bf16 v[72:75], a[24:27], a[8:11], v[72:75]
  s_cmp_eq_u32 s83, 2
  s_cselect_b32 s75, 45, 17
  s_lshl_b32 s50, s75, 16
  s_add_u32 m0, s73, 0
  ds_read_b64_tr_b16 a[130:131], v2 offset:32320
  v_mfma_f32_16x16x32_bf16 v[76:79], a[24:27], a[12:15], v[76:79]
  v_mul_f32 v163, v163, v25
  v_mul_f32 v22, v16, v56
  v_mul_f32 v23, v16, v57
  v_mul_f32 v24, v16, v58
  v_mfma_f32_16x16x32_bf16 v[176:179], a[28:31], a[0:3], v[176:179]
  ds_read_b64_tr_b16 a[132:133], v2 offset:35904
  v_mul_f32 v25, v16, v59
  v_exp_f32 v22, v22
  v_mfma_f32_16x16x32_bf16 v[180:183], a[28:31], a[4:7], v[180:183]
  v_mul_f32 v164, v52, v164
  v_exp_f32 v23, v23
  v_mul_f32 v165, v53, v165
  v_mfma_f32_16x16x32_bf16 v[184:187], a[28:31], a[8:11], v[184:187]
  buffer_load_dwordx4 v133, s[24:27], s50 offen offset:0 lds
  v_exp_f32 v24, v24
  v_mul_f32 v166, v54, v166
  v_mfma_f32_16x16x32_bf16 v[188:191], a[28:31], a[12:15], v[188:191]
  ds_read_b64_tr_b16 a[134:135], v2 offset:39488
  v_exp_f32 v25, v25
  v_mul_f32 v167, v55, v167
  v_mfma_f32_16x16x32_bf16 v[188:191], a[152:155], a[44:47], v[188:191]
  ds_read_b64_tr_b16 a[136:137], v2 offset:43072
  v_mul_f32 v164, v164, v26
  v_mul_f32 v165, v165, v27
  v_mul_f32 v166, v166, v28
  v_mfma_f32_16x16x32_bf16 v[188:191], a[156:159], a[60:63], v[188:191]
  v_mul_f32 v167, v167, v29
  v_cvt_pk_bf16_f32 v34, v160, v161
  v_cvt_pk_bf16_f32 v35, v162, v163
  v_mfma_f32_16x16x32_bf16 v[184:187], a[156:159], a[56:59], v[184:187]
  ds_read_b64_tr_b16 a[138:139], v2 offset:46656
  v_mfma_f32_16x16x32_bf16 v[184:187], a[152:155], a[40:43], v[184:187]
  buffer_load_dwordx4 v134, s[24:27], s50 offen offset:1024 lds
  v_mfma_f32_16x16x32_bf16 v[180:183], a[152:155], a[36:39], v[180:183]
  ds_read_b64_tr_b16 a[140:141], v2 offset:50240
  v_mfma_f32_16x16x32_bf16 v[180:183], a[156:159], a[52:55], v[180:183]
  buffer_store_dwordx4 v[32:35], v0, s[36:39], s64 offen offset:0 sc1
  v_mul_f32 v26, v19, v60
  v_mul_f32 v27, v19, v61
  v_mul_f32 v28, v19, v62
  v_mfma_f32_16x16x32_bf16 v[176:179], a[156:159], a[48:51], v[176:179]
  ds_read_b64_tr_b16 a[142:143], v2 offset:53824
  v_mul_f32 v29, v19, v63
  v_exp_f32 v26, v26
  v_mfma_f32_16x16x32_bf16 v[176:179], a[152:155], a[32:35], v[176:179]
  s_waitcnt lgkmcnt(8)
  v_fma_f32 v22, v22, v17, v17
  v_exp_f32 v27, v27
  v_fma_f32 v23, v23, v17, v17
  v_mfma_f32_16x16x32_bf16 v[64:67], a[160:163], a[64:67], v[64:67]
  buffer_load_dwordx4 v135, s[24:27], s50 offen offset:2048 lds
  v_exp_f32 v28, v28
  v_fma_f32 v24, v24, v17, v17
  v_mfma_f32_16x16x32_bf16 v[64:67], a[164:167], a[80:83], v[64:67]
  ds_read_b64_tr_b16 a[144:145], v1 offset:28768
  v_exp_f32 v29, v29
  v_fma_f32 v25, v25, v17, v17
  v_mfma_f32_16x16x32_bf16 v[68:71], a[164:167], a[84:87], v[68:71]
  ds_read_b64_tr_b16 a[146:147], v1 offset:32352
  v_cvt_pk_bf16_f32 v38, v164, v165
  v_cvt_pk_bf16_f32 v39, v166, v167
  v_mfma_f32_16x16x32_bf16 v[68:71], a[160:163], a[68:71], v[68:71]
  buffer_store_dwordx4 v[36:39], v0, s[36:39], s64 offen offset:1024 sc1
  v_rcp_f32 v22, v22
  v_fma_f32 v26, v26, v20, v20
  v_mfma_f32_16x16x32_bf16 v[72:75], a[160:163], a[72:75], v[72:75]
  ds_read_b64_tr_b16 a[148:149], v1 offset:35936
  v_rcp_f32 v23, v23
  v_fma_f32 v27, v27, v20, v20
  v_mfma_f32_16x16x32_bf16 v[72:75], a[164:167], a[88:91], v[72:75]
  buffer_load_dwordx4 v136, s[24:27], s50 offen offset:3072 lds
  v_rcp_f32 v24, v24
  v_fma_f32 v28, v28, v20, v20
  v_mfma_f32_16x16x32_bf16 v[76:79], a[164:167], a[92:95], v[76:79]
  ds_read_b64_tr_b16 a[150:151], v1 offset:39520
  v_rcp_f32 v25, v25
  v_fma_f32 v29, v29, v20, v20
  v_mfma_f32_16x16x32_bf16 v[76:79], a[160:163], a[76:79], v[76:79]
  v_rcp_f32 v26, v26
  v_mul_f32 v168, v56, v168
  v_mfma_f32_16x16x32_bf16 v[188:191], a[168:171], a[76:79], v[188:191]
  v_rcp_f32 v27, v27
  v_mul_f32 v169, v57, v169
  v_mfma_f32_16x16x32_bf16 v[188:191], a[172:175], a[92:95], v[188:191]
  v_rcp_f32 v28, v28
  v_mul_f32 v170, v58, v170
  v_mfma_f32_16x16x32_bf16 v[184:187], a[172:175], a[88:91], v[184:187]
  v_rcp_f32 v29, v29
  v_mul_f32 v171, v59, v171
  v_mul_f32 v168, v168, v22
  v_mfma_f32_16x16x32_bf16 v[184:187], a[168:171], a[72:75], v[184:187]
  v_mul_f32 v169, v169, v23
  v_mul_f32 v170, v170, v24
  v_mul_f32 v171, v171, v25
  v_mul_f32 v172, v60, v172
  v_mfma_f32_16x16x32_bf16 v[180:183], a[168:171], a[68:71], v[180:183]
  v_mul_f32 v173, v61, v173
  v_mul_f32 v174, v62, v174
  v_mul_f32 v175, v63, v175
  v_cvt_pk_bf16_f32 v42, v168, v169
  v_mfma_f32_16x16x32_bf16 v[180:183], a[172:175], a[84:87], v[180:183]
  v_cvt_pk_bf16_f32 v43, v170, v171
  v_mfma_f32_16x16x32_bf16 v[176:179], a[172:175], a[80:83], v[176:179]
  buffer_store_dwordx4 v[40:43], v0, s[36:39], s65 offen offset:0 sc1
  v_mul_f32 v172, v172, v26
  v_mul_f32 v173, v173, v27
  v_mul_f32 v174, v174, v28
  v_mfma_f32_16x16x32_bf16 v[176:179], a[168:171], a[64:67], v[176:179]
  s_waitcnt lgkmcnt(4)
  v_mul_f32 v175, v175, v29
  v_cvt_pk_bf16_f32 v46, v172, v173
  v_cvt_pk_bf16_f32 v47, v174, v175
  v_mfma_f32_16x16x32_bf16 v[64:67], a[128:131], a[96:99], v[64:67]
  ds_read_b128 a[16:19], v31 offset:768
  v_mfma_f32_16x16x32_bf16 v[64:67], a[132:135], a[112:115], v[64:67]
  ds_read_b64_tr_b16 a[152:153], v1 offset:43104
  v_mfma_f32_16x16x32_bf16 v[68:71], a[132:135], a[116:119], v[68:71]
  ds_read_b128 a[20:23], v31 offset:2816
  v_mfma_f32_16x16x32_bf16 v[68:71], a[128:131], a[100:103], v[68:71]
  ds_read_b64_tr_b16 a[154:155], v1 offset:46688
  v_mfma_f32_16x16x32_bf16 v[72:75], a[128:131], a[104:107], v[72:75]
  ds_read_b64_tr_b16 a[156:157], v1 offset:50272
  v_mfma_f32_16x16x32_bf16 v[72:75], a[132:135], a[120:123], v[72:75]
  buffer_store_dwordx4 v[44:47], v0, s[36:39], s65 offen offset:1024 sc1
  s_add_u32 s64, s64, 2048
  s_add_u32 s65, s65, 2048
  v_mfma_f32_16x16x32_bf16 v[76:79], a[132:135], a[124:127], v[76:79]
  ds_read_b64_tr_b16 a[158:159], v1 offset:53856
  v_mfma_f32_16x16x32_bf16 v[76:79], a[128:131], a[108:111], v[76:79]
  v_mfma_f32_16x16x32_bf16 v[188:191], a[136:139], a[108:111], v[188:191]
  ds_read_b64_tr_b16 a[160:161], v2 offset:96
  v_mul_f32 v22, v10, v64
  v_mul_f32 v23, v10, v65
  v_mul_f32 v24, v10, v66
  v_mfma_f32_16x16x32_bf16 v[188:191], a[140:143], a[124:127], v[188:191]
  v_mul_f32 v25, v10, v67
  v_exp_f32 v22, v22
  v_mul_f32 v26, v13, v68
  v_mfma_f32_16x16x32_bf16 v[184:187], a[140:143], a[120:123], v[184:187]
  ds_read_b64_tr_b16 a[162:163], v2 offset:3680
  v_exp_f32 v23, v23
  v_mul_f32 v27, v13, v69
  v_mfma_f32_16x16x32_bf16 v[184:187], a[136:139], a[104:107], v[184:187]
  v_exp_f32 v24, v24
  v_mul_f32 v28, v13, v70
  v_mfma_f32_16x16x32_bf16 v[180:183], a[136:139], a[100:103], v[180:183]
  ds_read_b64_tr_b16 a[164:165], v2 offset:7264
  v_exp_f32 v25, v25
  v_mul_f32 v29, v13, v71
  v_mfma_f32_16x16x32_bf16 v[180:183], a[140:143], a[116:119], v[180:183]
  v_exp_f32 v26, v26
  v_fma_f32 v22, v22, v11, v11
  v_mfma_f32_16x16x32_bf16 v[176:179], a[140:143], a[112:115], v[176:179]
  ds_read_b64_tr_b16 a[166:167], v2 offset:10848
  v_exp_f32 v27, v27
  v_fma_f32 v23, v23, v11, v11
  v_mfma_f32_16x16x32_bf16 v[176:179], a[136:139], a[96:99], v[176:179]
  s_waitcnt lgkmcnt(4)
  v_exp_f32 v28, v28
  v_fma_f32 v24, v24, v11, v11
  v_mfma_f32_16x16x32_bf16 v[80:83], a[144:147], a[32:35], v[80:83]
  ds_read_b64_tr_b16 a[168:169], v2 offset:14432
  v_exp_f32 v29, v29
  v_fma_f32 v25, v25, v11, v11
  v_mfma_f32_16x16x32_bf16 v[80:83], a[148:151], a[48:51], v[80:83]
  v_rcp_f32 v22, v22
  v_fma_f32 v26, v26, v14, v14
  v_mfma_f32_16x16x32_bf16 v[84:87], a[148:151], a[52:55], v[84:87]
  ds_read_b64_tr_b16 a[170:171], v2 offset:18016
  v_rcp_f32 v23, v23
  v_fma_f32 v27, v27, v14, v14
  v_mfma_f32_16x16x32_bf16 v[84:87], a[144:147], a[36:39], v[84:87]
  v_rcp_f32 v24, v24
  v_fma_f32 v28, v28, v14, v14
  v_mfma_f32_16x16x32_bf16 v[88:91], a[144:147], a[40:43], v[88:91]
  ds_read_b64_tr_b16 a[172:173], v2 offset:21600
  v_rcp_f32 v25, v25
  v_fma_f32 v29, v29, v14, v14
  v_mfma_f32_16x16x32_bf16 v[88:91], a[148:151], a[56:59], v[88:91]
  v_rcp_f32 v26, v26
  v_mul_f32 v176, v64, v176
  v_mfma_f32_16x16x32_bf16 v[92:95], a[148:151], a[60:63], v[92:95]
  ds_read_b64_tr_b16 a[174:175], v2 offset:25184
  v_rcp_f32 v27, v27
  v_mul_f32 v177, v65, v177
  v_mfma_f32_16x16x32_bf16 v[92:95], a[144:147], a[44:47], v[92:95]
  s_waitcnt lgkmcnt(11)
  v_rcp_f32 v28, v28
  v_mul_f32 v178, v66, v178
  v_mfma_f32_16x16x32_bf16 v[80:83], a[16:19], a[0:3], v[80:83]
  ds_read_b64_tr_b16 a[128:129], v2 offset:28768
  v_rcp_f32 v29, v29
  v_mul_f32 v179, v67, v179
  v_mfma_f32_16x16x32_bf16 v[84:87], a[16:19], a[4:7], v[84:87]
  v_mul_f32 v176, v176, v22
  v_mul_f32 v177, v177, v23
  v_mul_f32 v178, v178, v24
  v_mul_f32 v179, v179, v25
  v_mfma_f32_16x16x32_bf16 v[88:91], a[16:19], a[8:11], v[88:91]
  ds_read_b64_tr_b16 a[130:131], v2 offset:32352
  v_mul_f32 v22, v16, v72
  v_mul_f32 v23, v16, v73
  v_mul_f32 v24, v16, v74
  v_mfma_f32_16x16x32_bf16 v[92:95], a[16:19], a[12:15], v[92:95]
Hb0_2:
  s_cbranch_execz Hb0_3
  v_mul_f32 v25, v16, v75
  v_exp_f32 v22, v22
  v_mul_f32 v180, v68, v180
  v_mfma_f32_16x16x32_bf16 v[192:195], a[20:23], a[0:3], v[192:195]
  ds_read_b64_tr_b16 a[132:133], v2 offset:35936
  v_exp_f32 v23, v23
  v_mul_f32 v181, v69, v181
  v_mfma_f32_16x16x32_bf16 v[196:199], a[20:23], a[4:7], v[196:199]
  v_exp_f32 v24, v24
  v_mul_f32 v182, v70, v182
  v_mfma_f32_16x16x32_bf16 v[200:203], a[20:23], a[8:11], v[200:203]
  ds_read_b64_tr_b16 a[134:135], v2 offset:39520
  v_exp_f32 v25, v25
  v_mul_f32 v183, v71, v183
  v_mfma_f32_16x16x32_bf16 v[204:207], a[20:23], a[12:15], v[204:207]
  v_mul_f32 v180, v180, v26
  v_mul_f32 v181, v181, v27
  v_mul_f32 v182, v182, v28
  v_mul_f32 v183, v183, v29
  v_mfma_f32_16x16x32_bf16 v[204:207], a[152:155], a[44:47], v[204:207]
  ds_read_b64_tr_b16 a[136:137], v2 offset:43104
  v_cvt_pk_bf16_f32 v64, v176, v177
  v_cvt_pk_bf16_f32 v65, v178, v179
  v_mul_f32 v26, v19, v76
  v_mfma_f32_16x16x32_bf16 v[204:207], a[156:159], a[60:63], v[204:207]
  v_mul_f32 v27, v19, v77
  v_mul_f32 v28, v19, v78
  v_mul_f32 v29, v19, v79
  v_mfma_f32_16x16x32_bf16 v[200:203], a[156:159], a[56:59], v[200:203]
  ds_read_b64_tr_b16 a[138:139], v2 offset:46688
  v_exp_f32 v26, v26
  v_fma_f32 v22, v22, v17, v17
  v_mfma_f32_16x16x32_bf16 v[200:203], a[152:155], a[40:43], v[200:203]
  v_exp_f32 v27, v27
  v_fma_f32 v23, v23, v17, v17
  v_mfma_f32_16x16x32_bf16 v[196:199], a[152:155], a[36:39], v[196:199]
  ds_read_b64_tr_b16 a[140:141], v2 offset:50272
  v_exp_f32 v28, v28
  v_fma_f32 v24, v24, v17, v17
  v_mfma_f32_16x16x32_bf16 v[196:199], a[156:159], a[52:55], v[196:199]
  v_exp_f32 v29, v29
  v_fma_f32 v25, v25, v17, v17
  v_cvt_pk_bf16_f32 v68, v180, v181
  v_mfma_f32_16x16x32_bf16 v[192:195], a[156:159], a[48:51], v[192:195]
  ds_read_b64_tr_b16 a[142:143], v2 offset:53856
  v_cvt_pk_bf16_f32 v69, v182, v183
  v_rcp_f32 v22, v22
  v_mfma_f32_16x16x32_bf16 v[192:195], a[152:155], a[32:35], v[192:195]
  s_waitcnt lgkmcnt(8)
  v_fma_f32 v26, v26, v20, v20
  v_rcp_f32 v23, v23
  v_fma_f32 v27, v27, v20, v20
  v_mfma_f32_16x16x32_bf16 v[80:83], a[160:163], a[64:67], v[80:83]
  ds_read_b64_tr_b16 a[144:145], v1 offset:28800
  v_rcp_f32 v24, v24
  v_fma_f32 v28, v28, v20, v20
  v_mfma_f32_16x16x32_bf16 v[80:83], a[164:167], a[80:83], v[80:83]
  v_rcp_f32 v25, v25
  v_fma_f32 v29, v29, v20, v20
  v_mfma_f32_16x16x32_bf16 v[84:87], a[164:167], a[84:87], v[84:87]
  ds_read_b64_tr_b16 a[146:147], v1 offset:32384
  v_rcp_f32 v26, v26
  v_mul_f32 v184, v72, v184
  v_mfma_f32_16x16x32_bf16 v[84:87], a[160:163], a[68:71], v[84:87]
  v_rcp_f32 v27, v27
  v_mul_f32 v185, v73, v185
  v_mfma_f32_16x16x32_bf16 v[88:91], a[160:163], a[72:75], v[88:91]
  ds_read_b64_tr_b16 a[148:149], v1 offset:35968
  v_rcp_f32 v28, v28
  v_mul_f32 v186, v74, v186
  v_mfma_f32_16x16x32_bf16 v[88:91], a[164:167], a[88:91], v[88:91]
  v_rcp_f32 v29, v29
  v_mul_f32 v187, v75, v187
  v_mul_f32 v184, v184, v22
  v_mfma_f32_16x16x32_bf16 v[92:95], a[164:167], a[92:95], v[92:95]
  ds_read_b64_tr_b16 a[150:151], v1 offset:39552
  v_mul_f32 v185, v185, v23
  v_mul_f32 v186, v186, v24
  v_mul_f32 v187, v187, v25
  v_mfma_f32_16x16x32_bf16 v[92:95], a[160:163], a[76:79], v[92:95]
  s_waitcnt vmcnt(0)
  s_barrier
  v_mul_f32 v188, v76, v188
  v_mul_f32 v189, v77, v189
  v_mul_f32 v190, v78, v190
  v_mfma_f32_16x16x32_bf16 v[204:207], a[168:171], a[76:79], v[204:207]
  s_mov_b64 exec, 1
  buffer_store_dword v254, v0, s[36:39], s45 offen sc1
  s_mov_b64 exec, -1
  s_lshl_b32 s45, s2, 7
  v_mfma_f32_16x16x32_bf16 v[204:207], a[172:175], a[92:95], v[204:207]
  s_add_u32 s45, s45, 5439488
  s_cmp_eq_u32 s44, 0
  s_cselect_b32 s45, s45, 1073741824
  v_mul_f32 v191, v79, v191
  v_cvt_pk_bf16_f32 v72, v184, v185
  v_mfma_f32_16x16x32_bf16 v[200:203], a[172:175], a[88:91], v[200:203]
  v_cvt_pk_bf16_f32 v73, v186, v187
  v_mul_f32 v188, v188, v26
  v_mul_f32 v189, v189, v27
  v_mul_f32 v190, v190, v28
  v_mfma_f32_16x16x32_bf16 v[200:203], a[168:171], a[72:75], v[200:203]
  v_mul_f32 v191, v191, v29
  v_cvt_pk_bf16_f32 v76, v188, v189
  v_cvt_pk_bf16_f32 v77, v190, v191
  v_mfma_f32_16x16x32_bf16 v[196:199], a[168:171], a[68:71], v[196:199]
  v_mfma_f32_16x16x32_bf16 v[196:199], a[172:175], a[84:87], v[196:199]
  v_mfma_f32_16x16x32_bf16 v[192:195], a[172:175], a[80:83], v[192:195]
  v_mfma_f32_16x16x32_bf16 v[192:195], a[168:171], a[64:67], v[192:195]
  s_waitcnt lgkmcnt(4)
  v_mfma_f32_16x16x32_bf16 v[80:83], a[128:131], a[96:99], v[80:83]
  ds_read_b128 a[24:27], v31 offset:1024
  v_mfma_f32_16x16x32_bf16 v[80:83], a[132:135], a[112:115], v[80:83]
  ds_read_b64_tr_b16 a[152:153], v1 offset:43136
  v_mfma_f32_16x16x32_bf16 v[84:87], a[132:135], a[116:119], v[84:87]
  ds_read_b128 a[28:31], v31 offset:3072
  v_mfma_f32_16x16x32_bf16 v[84:87], a[128:131], a[100:103], v[84:87]
  ds_read_b64_tr_b16 a[154:155], v1 offset:46720
  v_mfma_f32_16x16x32_bf16 v[88:91], a[128:131], a[104:107], v[88:91]
  ds_read_b64_tr_b16 a[156:157], v1 offset:50304
  v_mfma_f32_16x16x32_bf16 v[88:91], a[132:135], a[120:123], v[88:91]
  v_mfma_f32_16x16x32_bf16 v[92:95], a[132:135], a[124:127], v[92:95]
  ds_read_b64_tr_b16 a[158:159], v1 offset:53888
  v_mfma_f32_16x16x32_bf16 v[92:95], a[128:131], a[108:111], v[92:95]
  v_mfma_f32_16x16x32_bf16 v[204:207], a[136:139], a[108:111], v[204:207]
  ds_read_b64_tr_b16 a[160:161], v2 offset:128
  v_mul_f32 v22, v10, v80
  v_mul_f32 v23, v10, v81
  v_mul_f32 v24, v10, v82
  v_mfma_f32_16x16x32_bf16 v[204:207], a[140:143], a[124:127], v[204:207]
  v_mul_f32 v25, v10, v83
  v_exp_f32 v22, v22
  v_mul_f32 v26, v13, v84
  v_mfma_f32_16x16x32_bf16 v[200:203], a[140:143], a[120:123], v[200:203]
  ds_read_b64_tr_b16 a[162:163], v2 offset:3712
  v_exp_f32 v23, v23
  v_mul_f32 v27, v13, v85
  v_mfma_f32_16x16x32_bf16 v[200:203], a[136:139], a[104:107], v[200:203]
  v_exp_f32 v24, v24
  v_mul_f32 v28, v13, v86
  v_mfma_f32_16x16x32_bf16 v[196:199], a[136:139], a[100:103], v[196:199]
  ds_read_b64_tr_b16 a[164:165], v2 offset:7296
  v_exp_f32 v25, v25
  v_mul_f32 v29, v13, v87
  v_mfma_f32_16x16x32_bf16 v[196:199], a[140:143], a[116:119], v[196:199]
  v_exp_f32 v26, v26
  v_fma_f32 v22, v22, v11, v11
  v_mfma_f32_16x16x32_bf16 v[192:195], a[140:143], a[112:115], v[192:195]
  ds_read_b64_tr_b16 a[166:167], v2 offset:10880
  v_exp_f32 v27, v27
  v_fma_f32 v23, v23, v11, v11
  v_mfma_f32_16x16x32_bf16 v[192:195], a[136:139], a[96:99], v[192:195]
  s_waitcnt lgkmcnt(4)
  v_exp_f32 v28, v28
  v_fma_f32 v24, v24, v11, v11
  v_mfma_f32_16x16x32_bf16 v[96:99], a[144:147], a[32:35], v[96:99]
  ds_read_b64_tr_b16 a[168:169], v2 offset:14464
  v_exp_f32 v29, v29
  v_fma_f32 v25, v25, v11, v11
  v_mfma_f32_16x16x32_bf16 v[96:99], a[148:151], a[48:51], v[96:99]
  v_rcp_f32 v22, v22
  v_fma_f32 v26, v26, v14, v14
  v_mfma_f32_16x16x32_bf16 v[100:103], a[148:151], a[52:55], v[100:103]
  ds_read_b64_tr_b16 a[170:171], v2 offset:18048
  v_rcp_f32 v23, v23
  v_fma_f32 v27, v27, v14, v14
  v_mfma_f32_16x16x32_bf16 v[100:103], a[144:147], a[36:39], v[100:103]
  v_rcp_f32 v24, v24
  v_fma_f32 v28, v28, v14, v14
  v_mfma_f32_16x16x32_bf16 v[104:107], a[144:147], a[40:43], v[104:107]
  ds_read_b64_tr_b16 a[172:173], v2 offset:21632
  v_rcp_f32 v25, v25
  v_fma_f32 v29, v29, v14, v14
  v_mfma_f32_16x16x32_bf16 v[104:107], a[148:151], a[56:59], v[104:107]
  v_rcp_f32 v26, v26
  v_mul_f32 v192, v80, v192
  v_mfma_f32_16x16x32_bf16 v[108:111], a[148:151], a[60:63], v[108:111]
  ds_read_b64_tr_b16 a[174:175], v2 offset:25216
  v_rcp_f32 v27, v27
  v_mul_f32 v193, v81, v193
  v_mfma_f32_16x16x32_bf16 v[108:111], a[144:147], a[44:47], v[108:111]
  s_waitcnt lgkmcnt(11)
  v_rcp_f32 v28, v28
  v_mul_f32 v194, v82, v194
  v_mfma_f32_16x16x32_bf16 v[96:99], a[24:27], a[0:3], v[96:99]
  ds_read_b64_tr_b16 a[128:129], v2 offset:28800
  v_rcp_f32 v29, v29
  v_mul_f32 v195, v83, v195
  v_mfma_f32_16x16x32_bf16 v[100:103], a[24:27], a[4:7], v[100:103]
  v_mul_f32 v192, v192, v22
  v_mul_f32 v193, v193, v23
  v_mul_f32 v194, v194, v24
  v_mul_f32 v195, v195, v25
  v_mfma_f32_16x16x32_bf16 v[104:107], a[24:27], a[8:11], v[104:107]
  ds_read_b64_tr_b16 a[130:131], v2 offset:32384
  v_mul_f32 v22, v16, v88
  v_mul_f32 v23, v16, v89
  v_mul_f32 v24, v16, v90
  v_mfma_f32_16x16x32_bf16 v[108:111], a[24:27], a[12:15], v[108:111]
  v_mul_f32 v25, v16, v91
  v_exp_f32 v22, v22
  v_mul_f32 v196, v84, v196
  v_mfma_f32_16x16x32_bf16 v[208:211], a[28:31], a[0:3], v[208:211]
  ds_read_b64_tr_b16 a[132:133], v2 offset:35968
  v_exp_f32 v23, v23
  v_mul_f32 v197, v85, v197
  v_mfma_f32_16x16x32_bf16 v[212:215], a[28:31], a[4:7], v[212:215]
  v_exp_f32 v24, v24
  v_mul_f32 v198, v86, v198
  v_mfma_f32_16x16x32_bf16 v[216:219], a[28:31], a[8:11], v[216:219]
  ds_read_b64_tr_b16 a[134:135], v2 offset:39552
  v_exp_f32 v25, v25
  v_mul_f32 v199, v87, v199
  v_mfma_f32_16x16x32_bf16 v[220:223], a[28:31], a[12:15], v[220:223]
  v_mul_f32 v196, v196, v26
  v_mul_f32 v197, v197, v27
  v_mul_f32 v198, v198, v28
  v_mul_f32 v199, v199, v29
  v_mfma_f32_16x16x32_bf16 v[220:223], a[152:155], a[44:47], v[220:223]
  ds_read_b64_tr_b16 a[136:137], v2 offset:43136
  v_cvt_pk_bf16_f32 v66, v192, v193
  v_cvt_pk_bf16_f32 v67, v194, v195
  v_mfma_f32_16x16x32_bf16 v[220:223], a[156:159], a[60:63], v[220:223]
  buffer_store_dwordx4 v[64:67], v0, s[36:39], s64 offen offset:0 sc1
  v_mul_f32 v26, v19, v92
  v_mul_f32 v27, v19, v93
  v_mul_f32 v28, v19, v94
  v_mfma_f32_16x16x32_bf16 v[216:219], a[156:159], a[56:59], v[216:219]
  ds_read_b64_tr_b16 a[138:139], v2 offset:46720
  v_mul_f32 v29, v19, v95
  v_exp_f32 v26, v26
  v_mfma_f32_16x16x32_bf16 v[216:219], a[152:155], a[40:43], v[216:219]
  v_fma_f32 v22, v22, v17, v17
  v_exp_f32 v27, v27
  v_fma_f32 v23, v23, v17, v17
  v_mfma_f32_16x16x32_bf16 v[212:215], a[152:155], a[36:39], v[212:215]
  ds_read_b64_tr_b16 a[140:141], v2 offset:50304
  v_exp_f32 v28, v28
  v_fma_f32 v24, v24, v17, v17
  v_mfma_f32_16x16x32_bf16 v[212:215], a[156:159], a[52:55], v[212:215]
  v_exp_f32 v29, v29
  v_fma_f32 v25, v25, v17, v17
  v_cvt_pk_bf16_f32 v70, v196, v197
  v_mfma_f32_16x16x32_bf16 v[208:211], a[156:159], a[48:51], v[208:211]
  ds_read_b64_tr_b16 a[142:143], v2 offset:53888
  v_cvt_pk_bf16_f32 v71, v198, v199
  v_mfma_f32_16x16x32_bf16 v[208:211], a[152:155], a[32:35], v[208:211]
  s_waitcnt lgkmcnt(8)
  buffer_store_dwordx4 v[68:71], v0, s[36:39], s64 offen offset:1024 sc1
  v_rcp_f32 v22, v22
  v_fma_f32 v26, v26, v20, v20
  v_mfma_f32_16x16x32_bf16 v[96:99], a[160:163], a[64:67], v[96:99]
  ds_read_b64_tr_b16 a[144:145], v1 offset:28832
  v_rcp_f32 v23, v23
  v_fma_f32 v27, v27, v20, v20
  v_mfma_f32_16x16x32_bf16 v[96:99], a[164:167], a[80:83], v[96:99]
  v_rcp_f32 v24, v24
  v_fma_f32 v28, v28, v20, v20
  v_mfma_f32_16x16x32_bf16 v[100:103], a[164:167], a[84:87], v[100:103]
  ds_read_b64_tr_b16 a[146:147], v1 offset:32416
  v_rcp_f32 v25, v25
  v_fma_f32 v29, v29, v20, v20
  v_mfma_f32_16x16x32_bf16 v[100:103], a[160:163], a[68:71], v[100:103]
  v_rcp_f32 v26, v26
  v_mul_f32 v200, v88, v200
  v_mfma_f32_16x16x32_bf16 v[104:107], a[160:163], a[72:75], v[104:107]
  ds_read_b64_tr_b16 a[148:149], v1 offset:36000
  v_rcp_f32 v27, v27
  v_mul_f32 v201, v89, v201
  v_mfma_f32_16x16x32_bf16 v[104:107], a[164:167], a[88:91], v[104:107]
  v_rcp_f32 v28, v28
  v_mul_f32 v202, v90, v202
  v_mfma_f32_16x16x32_bf16 v[108:111], a[164:167], a[92:95], v[108:111]
  ds_read_b64_tr_b16 a[150:151], v1 offset:39584
  v_rcp_f32 v29, v29
  v_mul_f32 v203, v91, v203
  v_mfma_f32_16x16x32_bf16 v[108:111], a[160:163], a[76:79], v[108:111]
  v_mul_f32 v200, v200, v22
  v_mul_f32 v201, v201, v23
  v_mul_f32 v202, v202, v24
  v_mul_f32 v203, v203, v25
  v_mfma_f32_16x16x32_bf16 v[220:223], a[168:171], a[76:79], v[220:223]
  v_mul_f32 v204, v92, v204
  v_mul_f32 v205, v93, v205
  v_mul_f32 v206, v94, v206
  v_mul_f32 v207, v95, v207
  v_mfma_f32_16x16x32_bf16 v[220:223], a[172:175], a[92:95], v[220:223]
  v_cvt_pk_bf16_f32 v74, v200, v201
  v_cvt_pk_bf16_f32 v75, v202, v203
  v_mfma_f32_16x16x32_bf16 v[216:219], a[172:175], a[88:91], v[216:219]
  buffer_store_dwordx4 v[72:75], v0, s[36:39], s65 offen offset:0 sc1
  v_mul_f32 v204, v204, v26
  v_mul_f32 v205, v205, v27
  v_mul_f32 v206, v206, v28
  v_mfma_f32_16x16x32_bf16 v[216:219], a[168:171], a[72:75], v[216:219]
  v_mul_f32 v207, v207, v29
  v_cvt_pk_bf16_f32 v78, v204, v205
  v_cvt_pk_bf16_f32 v79, v206, v207
  v_mfma_f32_16x16x32_bf16 v[212:215], a[168:171], a[68:71], v[212:215]
  buffer_store_dwordx4 v[76:79], v0, s[36:39], s65 offen offset:1024 sc1
  s_add_u32 s64, s64, 2048
  s_add_u32 s65, s65, 2048
  v_mfma_f32_16x16x32_bf16 v[212:215], a[172:175], a[84:87], v[212:215]
  v_mfma_f32_16x16x32_bf16 v[208:211], a[172:175], a[80:83], v[208:211]
  v_mfma_f32_16x16x32_bf16 v[208:211], a[168:171], a[64:67], v[208:211]
  s_waitcnt lgkmcnt(4)
  v_mfma_f32_16x16x32_bf16 v[96:99], a[128:131], a[96:99], v[96:99]
  ds_read_b128 a[16:19], v31 offset:1280
  v_mfma_f32_16x16x32_bf16 v[96:99], a[132:135], a[112:115], v[96:99]
  ds_read_b64_tr_b16 a[152:153], v1 offset:43168
  v_mfma_f32_16x16x32_bf16 v[100:103], a[132:135], a[116:119], v[100:103]
  ds_read_b128 a[20:23], v31 offset:3328
  v_mfma_f32_16x16x32_bf16 v[100:103], a[128:131], a[100:103], v[100:103]
  ds_read_b64_tr_b16 a[154:155], v1 offset:46752
  v_mfma_f32_16x16x32_bf16 v[104:107], a[128:131], a[104:107], v[104:107]
  ds_read_b64_tr_b16 a[156:157], v1 offset:50336
  v_mfma_f32_16x16x32_bf16 v[104:107], a[132:135], a[120:123], v[104:107]
  v_mfma_f32_16x16x32_bf16 v[108:111], a[132:135], a[124:127], v[108:111]
  ds_read_b64_tr_b16 a[158:159], v1 offset:53920
  v_mfma_f32_16x16x32_bf16 v[108:111], a[128:131], a[108:111], v[108:111]
  v_mfma_f32_16x16x32_bf16 v[220:223], a[136:139], a[108:111], v[220:223]
  ds_read_b64_tr_b16 a[160:161], v2 offset:160
  v_mul_f32 v22, v10, v96
  v_mul_f32 v23, v10, v97
  v_mul_f32 v24, v10, v98
  v_mul_f32 v25, v10, v99
  v_mfma_f32_16x16x32_bf16 v[220:223], a[140:143], a[124:127], v[220:223]
  v_exp_f32 v22, v22
  v_mul_f32 v26, v13, v100
  v_mfma_f32_16x16x32_bf16 v[216:219], a[140:143], a[120:123], v[216:219]
  buffer_load_dword v139, v138, s[36:39], s91 offen sc1
  v_exp_f32 v23, v23
  v_mul_f32 v27, v13, v101
  v_mfma_f32_16x16x32_bf16 v[216:219], a[136:139], a[104:107], v[216:219]
  ds_read_b64_tr_b16 a[162:163], v2 offset:3744
  v_exp_f32 v24, v24
  v_mul_f32 v28, v13, v102
  v_mfma_f32_16x16x32_bf16 v[212:215], a[136:139], a[100:103], v[212:215]
  ds_read_b64_tr_b16 a[164:165], v2 offset:7328
  v_exp_f32 v25, v25
  v_mul_f32 v29, v13, v103
  v_mfma_f32_16x16x32_bf16 v[212:215], a[140:143], a[116:119], v[212:215]
  v_exp_f32 v26, v26
  v_fma_f32 v22, v22, v11, v11
  v_mfma_f32_16x16x32_bf16 v[208:211], a[140:143], a[112:115], v[208:211]
  ds_read_b64_tr_b16 a[166:167], v2 offset:10912
  v_exp_f32 v27, v27
  v_fma_f32 v23, v23, v11, v11
  v_mfma_f32_16x16x32_bf16 v[208:211], a[136:139], a[96:99], v[208:211]
  s_waitcnt lgkmcnt(4)
  v_exp_f32 v28, v28
  v_fma_f32 v24, v24, v11, v11
  v_mfma_f32_16x16x32_bf16 v[112:115], a[144:147], a[32:35], v[112:115]
  ds_read_b64_tr_b16 a[168:169], v2 offset:14496
  v_exp_f32 v29, v29
  v_fma_f32 v25, v25, v11, v11
  v_mfma_f32_16x16x32_bf16 v[112:115], a[148:151], a[48:51], v[112:115]
  v_rcp_f32 v22, v22
  v_fma_f32 v26, v26, v14, v14
  v_mfma_f32_16x16x32_bf16 v[116:119], a[148:151], a[52:55], v[116:119]
  ds_read_b64_tr_b16 a[170:171], v2 offset:18080
  v_rcp_f32 v23, v23
  v_fma_f32 v27, v27, v14, v14
  v_mfma_f32_16x16x32_bf16 v[116:119], a[144:147], a[36:39], v[116:119]
  v_rcp_f32 v24, v24
  v_fma_f32 v28, v28, v14, v14
  v_mfma_f32_16x16x32_bf16 v[120:123], a[144:147], a[40:43], v[120:123]
  ds_read_b64_tr_b16 a[172:173], v2 offset:21664
  v_rcp_f32 v25, v25
  v_fma_f32 v29, v29, v14, v14
  v_mfma_f32_16x16x32_bf16 v[120:123], a[148:151], a[56:59], v[120:123]
  v_rcp_f32 v26, v26
  v_mul_f32 v208, v96, v208
  v_mfma_f32_16x16x32_bf16 v[124:127], a[148:151], a[60:63], v[124:127]
  ds_read_b64_tr_b16 a[174:175], v2 offset:25248
  v_rcp_f32 v27, v27
  v_mul_f32 v209, v97, v209
  v_mfma_f32_16x16x32_bf16 v[124:127], a[144:147], a[44:47], v[124:127]
  s_waitcnt lgkmcnt(11)
  v_rcp_f32 v28, v28
  v_mul_f32 v210, v98, v210
  v_mfma_f32_16x16x32_bf16 v[112:115], a[16:19], a[0:3], v[112:115]
  ds_read_b64_tr_b16 a[128:129], v2 offset:28832
  v_rcp_f32 v29, v29
  v_mul_f32 v211, v99, v211
  v_mfma_f32_16x16x32_bf16 v[116:119], a[16:19], a[4:7], v[116:119]
  v_mul_f32 v208, v208, v22
  v_mul_f32 v209, v209, v23
  v_mul_f32 v210, v210, v24
  v_mul_f32 v211, v211, v25
  v_mfma_f32_16x16x32_bf16 v[120:123], a[16:19], a[8:11], v[120:123]
  ds_read_b64_tr_b16 a[130:131], v2 offset:32416
  v_mul_f32 v22, v16, v104
  v_mul_f32 v23, v16, v105
  v_mul_f32 v24, v16, v106
  v_mfma_f32_16x16x32_bf16 v[124:127], a[16:19], a[12:15], v[124:127]
  v_mul_f32 v25, v16, v107
  v_exp_f32 v22, v22
  v_mul_f32 v212, v100, v212
  v_mfma_f32_16x16x32_bf16 v[224:227], a[20:23], a[0:3], v[224:227]
  ds_read_b64_tr_b16 a[132:133], v2 offset:36000
  v_exp_f32 v23, v23
  v_mul_f32 v213, v101, v213
  v_mfma_f32_16x16x32_bf16 v[228:231], a[20:23], a[4:7], v[228:231]
  v_exp_f32 v24, v24
  v_mul_f32 v214, v102, v214
  v_mfma_f32_16x16x32_bf16 v[232:235], a[20:23], a[8:11], v[232:235]
  ds_read_b64_tr_b16 a[134:135], v2 offset:39584
  v_exp_f32 v25, v25
  v_mul_f32 v215, v103, v215
  v_mfma_f32_16x16x32_bf16 v[236:239], a[20:23], a[12:15], v[236:239]
  v_mul_f32 v212, v212, v26
  v_mul_f32 v213, v213, v27
  v_mul_f32 v214, v214, v28
  v_mul_f32 v215, v215, v29
  v_mfma_f32_16x16x32_bf16 v[236:239], a[152:155], a[44:47], v[236:239]
  ds_read_b64_tr_b16 a[136:137], v2 offset:43168
  v_cvt_pk_bf16_f32 v96, v208, v209
  v_cvt_pk_bf16_f32 v97, v210, v211
  v_mul_f32 v26, v19, v108
  v_mfma_f32_16x16x32_bf16 v[236:239], a[156:159], a[60:63], v[236:239]
  v_mul_f32 v27, v19, v109
  v_mul_f32 v28, v19, v110
  v_mul_f32 v29, v19, v111
  v_mfma_f32_16x16x32_bf16 v[232:235], a[156:159], a[56:59], v[232:235]
  ds_read_b64_tr_b16 a[138:139], v2 offset:46752
  v_exp_f32 v26, v26
  v_fma_f32 v22, v22, v17, v17
  v_mfma_f32_16x16x32_bf16 v[232:235], a[152:155], a[40:43], v[232:235]
  v_exp_f32 v27, v27
  v_fma_f32 v23, v23, v17, v17
  v_mfma_f32_16x16x32_bf16 v[228:231], a[152:155], a[36:39], v[228:231]
  ds_read_b64_tr_b16 a[140:141], v2 offset:50336
  v_exp_f32 v28, v28
  v_fma_f32 v24, v24, v17, v17
  v_mfma_f32_16x16x32_bf16 v[228:231], a[156:159], a[52:55], v[228:231]
  v_exp_f32 v29, v29
  v_fma_f32 v25, v25, v17, v17
  v_cvt_pk_bf16_f32 v100, v212, v213
  v_mfma_f32_16x16x32_bf16 v[224:227], a[156:159], a[48:51], v[224:227]
  s_waitcnt vmcnt(0)
  v_cmp_ne_u32 vcc, 1, v139
  s_nop 4
  s_cbranch_vccnz CK6s
CK6x:
  v_mfma_f32_16x16x32_bf16 v[224:227], a[152:155], a[32:35], v[224:227]
  s_waitcnt lgkmcnt(7)
  s_lshl_b32 s51, s70, 11
  s_mov_b32 s91, 5439488
  ds_read_b64_tr_b16 a[142:143], v2 offset:53920
  v_cvt_pk_bf16_f32 v101, v214, v215
  v_mfma_f32_16x16x32_bf16 v[112:115], a[160:163], a[64:67], v[112:115]
  buffer_load_dwordx4 a[216:219], v137, s[36:39], s51 offen offset:0 sc1
  v_rcp_f32 v22, v22
  v_fma_f32 v26, v26, v20, v20
  v_mfma_f32_16x16x32_bf16 v[112:115], a[164:167], a[80:83], v[112:115]
  v_rcp_f32 v23, v23
  v_fma_f32 v27, v27, v20, v20
  v_mfma_f32_16x16x32_bf16 v[116:119], a[164:167], a[84:87], v[116:119]
  buffer_load_dwordx4 a[220:223], v137, s[36:39], s51 offen offset:1024 sc1
  v_rcp_f32 v24, v24
  v_fma_f32 v28, v28, v20, v20
  v_mfma_f32_16x16x32_bf16 v[116:119], a[160:163], a[68:71], v[116:119]
  v_rcp_f32 v25, v25
  v_fma_f32 v29, v29, v20, v20
  v_mfma_f32_16x16x32_bf16 v[120:123], a[160:163], a[72:75], v[120:123]
  buffer_load_dwordx4 a[224:227], v137, s[36:39], s51 offen offset:2048 sc1
  v_rcp_f32 v26, v26
  v_mul_f32 v216, v104, v216
  v_mfma_f32_16x16x32_bf16 v[120:123], a[164:167], a[88:91], v[120:123]
  v_rcp_f32 v27, v27
  v_mul_f32 v217, v105, v217
  v_mfma_f32_16x16x32_bf16 v[124:127], a[164:167], a[92:95], v[124:127]
  buffer_load_dwordx4 a[228:231], v137, s[36:39], s51 offen offset:3072 sc1
  s_lshl_b32 s51, s74, 11
  v_rcp_f32 v28, v28
  v_mfma_f32_16x16x32_bf16 v[124:127], a[160:163], a[76:79], v[124:127]
  s_waitcnt vmcnt(22)
  s_barrier
  v_mul_f32 v218, v106, v218
  v_rcp_f32 v29, v29
  v_mfma_f32_16x16x32_bf16 v[236:239], a[168:171], a[76:79], v[236:239]
  buffer_load_dwordx4 a[0:3], v137, s[36:39], s51 offen offset:0 sc1
  v_mul_f32 v219, v107, v219
  v_mul_f32 v216, v216, v22
  v_mul_f32 v217, v217, v23
  v_mfma_f32_16x16x32_bf16 v[236:239], a[172:175], a[92:95], v[236:239]
  v_mul_f32 v218, v218, v24
  v_mul_f32 v219, v219, v25
  v_mul_f32 v220, v108, v220
  v_mul_f32 v221, v109, v221
  v_mfma_f32_16x16x32_bf16 v[232:235], a[172:175], a[88:91], v[232:235]
  buffer_load_dwordx4 a[4:7], v137, s[36:39], s51 offen offset:1024 sc1
  v_mul_f32 v222, v110, v222
  v_mul_f32 v223, v111, v223
  v_cvt_pk_bf16_f32 v104, v216, v217
  v_mfma_f32_16x16x32_bf16 v[232:235], a[168:171], a[72:75], v[232:235]
  v_cvt_pk_bf16_f32 v105, v218, v219
  v_mul_f32 v220, v220, v26
  v_mul_f32 v221, v221, v27
  v_mul_f32 v222, v222, v28
  v_mfma_f32_16x16x32_bf16 v[228:231], a[168:171], a[68:71], v[228:231]
  buffer_load_dwordx4 a[8:11], v137, s[36:39], s51 offen offset:2048 sc1
  v_mul_f32 v223, v223, v29
  v_cvt_pk_bf16_f32 v108, v220, v221
  v_cvt_pk_bf16_f32 v109, v222, v223
  v_mfma_f32_16x16x32_bf16 v[228:231], a[172:175], a[84:87], v[228:231]
  v_mfma_f32_16x16x32_bf16 v[224:227], a[172:175], a[80:83], v[224:227]
  buffer_load_dwordx4 a[12:15], v137, s[36:39], s51 offen offset:3072 sc1
  s_lshl_b32 s51, s75, 11
  v_mfma_f32_16x16x32_bf16 v[224:227], a[168:171], a[64:67], v[224:227]
  s_waitcnt lgkmcnt(0)
  v_mfma_f32_16x16x32_bf16 v[112:115], a[128:131], a[96:99], v[112:115]
  s_barrier
  buffer_load_dwordx4 a[16:19], v137, s[36:39], s51 offen offset:0 sc1
  ds_read_b64_tr_b16 a[176:177], v244 offset:49152
  v_mfma_f32_16x16x32_bf16 v[112:115], a[132:135], a[112:115], v[112:115]
  ds_read_b64_tr_b16 a[178:179], v244 offset:53248
  v_mfma_f32_16x16x32_bf16 v[116:119], a[132:135], a[116:119], v[116:119]
  buffer_load_dwordx4 a[20:23], v137, s[36:39], s51 offen offset:1024 sc1
  ds_read_b64_tr_b16 a[180:181], v244 offset:57344
  v_mfma_f32_16x16x32_bf16 v[116:119], a[128:131], a[100:103], v[116:119]
  ds_read_b64_tr_b16 a[182:183], v244 offset:61440
  v_mfma_f32_16x16x32_bf16 v[120:123], a[128:131], a[104:107], v[120:123]
  buffer_load_dwordx4 a[24:27], v137, s[36:39], s51 offen offset:2048 sc1
  ds_read_b64_tr_b16 a[184:185], v245 offset:49152
  v_mfma_f32_16x16x32_bf16 v[120:123], a[132:135], a[120:123], v[120:123]
  ds_read_b64_tr_b16 a[186:187], v245 offset:53248
  v_mfma_f32_16x16x32_bf16 v[124:127], a[132:135], a[124:127], v[124:127]
  buffer_load_dwordx4 a[28:31], v137, s[36:39], s51 offen offset:3072 sc1
  s_cmp_eq_u32 s83, 3
  s_cselect_b32 s76, 52, 24
  s_lshl_b32 s50, s76, 16
  v_mfma_f32_16x16x32_bf16 v[124:127], a[128:131], a[108:111], v[124:127]
  s_add_u32 m0, s73, 16384
  ds_read_b64_tr_b16 a[188:189], v245 offset:57344
  ds_read_b64_tr_b16 a[190:191], v245 offset:61440
  v_mfma_f32_16x16x32_bf16 v[236:239], a[136:139], a[108:111], v[236:239]
  ds_read_b64_tr_b16 a[192:193], v246 offset:49152
  v_mul_f32 v22, v10, v112
  v_mul_f32 v23, v10, v113
  v_mul_f32 v24, v10, v114
  v_mfma_f32_16x16x32_bf16 v[236:239], a[140:143], a[124:127], v[236:239]
  ds_read_b64_tr_b16 a[194:195], v246 offset:53248
  v_mul_f32 v25, v10, v115
  v_exp_f32 v22, v22
  v_mfma_f32_16x16x32_bf16 v[232:235], a[140:143], a[120:123], v[232:235]
  buffer_load_dwordx4 v133, s[24:27], s50 offen offset:0 lds
  ds_read_b64_tr_b16 a[196:197], v246 offset:57344
  v_mul_f32 v26, v13, v116
  v_mfma_f32_16x16x32_bf16 v[232:235], a[136:139], a[104:107], v[232:235]
  ds_read_b64_tr_b16 a[198:199], v246 offset:61440
  v_exp_f32 v23, v23
  v_mul_f32 v27, v13, v117
  v_mfma_f32_16x16x32_bf16 v[228:231], a[136:139], a[100:103], v[228:231]
  s_lshl_b32 s51, s76, 11
  ds_read_b64_tr_b16 a[200:201], v247 offset:49152
  v_exp_f32 v24, v24
  v_mul_f32 v28, v13, v118
  v_mfma_f32_16x16x32_bf16 v[228:231], a[140:143], a[116:119], v[228:231]
  ds_read_b64_tr_b16 a[202:203], v247 offset:53248
  v_exp_f32 v25, v25
  v_mul_f32 v29, v13, v119
  v_mfma_f32_16x16x32_bf16 v[224:227], a[140:143], a[112:115], v[224:227]
  ds_read_b64_tr_b16 a[204:205], v247 offset:57344
  v_exp_f32 v26, v26
  v_fma_f32 v22, v22, v11, v11
  v_mfma_f32_16x16x32_bf16 v[224:227], a[136:139], a[96:99], v[224:227]
  s_waitcnt vmcnt(9) lgkmcnt(11)
  ds_read_b64_tr_b16 a[206:207], v247 offset:61440
  v_exp_f32 v27, v27
  v_fma_f32 v23, v23, v11, v11
  v_mfma_f32_16x16x32_bf16 v[32:35], a[176:179], a[216:219], 0
  buffer_load_dwordx4 a[32:35], v137, s[36:39], s51 offen offset:0 sc1
  ds_read_b64_tr_b16 a[208:209], v244 offset:51200
  v_exp_f32 v28, v28
  v_mfma_f32_16x16x32_bf16 v[32:35], a[180:183], a[224:227], v[32:35]
  ds_read_b64_tr_b16 a[210:211], v244 offset:55296
  v_fma_f32 v24, v24, v11, v11
  v_exp_f32 v29, v29
  v_mfma_f32_16x16x32_bf16 v[36:39], a[180:183], a[228:231], 0
  buffer_load_dwordx4 v134, s[24:27], s50 offen offset:1024 lds
  ds_read_b64_tr_b16 a[212:213], v244 offset:59392
  v_fma_f32 v25, v25, v11, v11
  v_mfma_f32_16x16x32_bf16 v[36:39], a[176:179], a[220:223], v[36:39]
  s_waitcnt lgkmcnt(11)
  ds_read_b64_tr_b16 a[214:215], v244 offset:63488
  v_rcp_f32 v22, v22
  v_fma_f32 v26, v26, v14, v14
  v_mfma_f32_16x16x32_bf16 v[44:47], a[184:187], a[220:223], 0
  ds_read_b64_tr_b16 a[176:177], v245 offset:51200
  v_rcp_f32 v23, v23
  v_fma_f32 v27, v27, v14, v14
  v_mfma_f32_16x16x32_bf16 v[44:47], a[188:191], a[228:231], v[44:47]
  buffer_load_dwordx4 a[36:39], v137, s[36:39], s51 offen offset:1024 sc1
  ds_read_b64_tr_b16 a[178:179], v245 offset:55296
  v_rcp_f32 v24, v24
  v_mfma_f32_16x16x32_bf16 v[40:43], a[188:191], a[224:227], 0
  ds_read_b64_tr_b16 a[180:181], v245 offset:59392
  v_fma_f32 v28, v28, v14, v14
  v_rcp_f32 v25, v25
  v_mfma_f32_16x16x32_bf16 v[40:43], a[184:187], a[216:219], v[40:43]
  s_waitcnt vmcnt(30) lgkmcnt(11)
  s_barrier
  ds_read_b64_tr_b16 a[182:183], v245 offset:63488
  v_fma_f32 v29, v29, v14, v14
  v_mfma_f32_16x16x32_bf16 v[48:51], a[192:195], a[216:219], 0
  ds_read_b64_tr_b16 a[184:185], v246 offset:51200
  v_rcp_f32 v26, v26
  v_mul_f32 v224, v112, v224
  v_mfma_f32_16x16x32_bf16 v[48:51], a[196:199], a[224:227], v[48:51]
  buffer_load_dwordx4 v135, s[24:27], s50 offen offset:2048 lds
  ds_read_b64_tr_b16 a[186:187], v246 offset:55296
  v_rcp_f32 v27, v27
  v_mfma_f32_16x16x32_bf16 v[52:55], a[196:199], a[228:231], 0
  ds_read_b64_tr_b16 a[188:189], v246 offset:59392
  v_mul_f32 v225, v113, v225
  v_rcp_f32 v28, v28
  v_mfma_f32_16x16x32_bf16 v[52:55], a[192:195], a[220:223], v[52:55]
  s_waitcnt lgkmcnt(11)
  ds_read_b64_tr_b16 a[190:191], v246 offset:63488
  v_mul_f32 v226, v114, v226
  v_rcp_f32 v29, v29
  v_mfma_f32_16x16x32_bf16 v[60:63], a[200:203], a[220:223], 0
  ds_read_b64_tr_b16 a[192:193], v247 offset:51200
  v_mul_f32 v227, v115, v227
  v_mul_f32 v224, v224, v22
  v_mul_f32 v225, v225, v23
  v_mfma_f32_16x16x32_bf16 v[60:63], a[204:207], a[228:231], v[60:63]
  buffer_load_dwordx4 a[40:43], v137, s[36:39], s51 offen offset:2048 sc1
  ds_read_b64_tr_b16 a[194:195], v247 offset:55296
  v_mul_f32 v226, v226, v24
  v_mul_f32 v227, v227, v25
  v_mfma_f32_16x16x32_bf16 v[56:59], a[204:207], a[224:227], 0
  ds_read_b64_tr_b16 a[196:197], v247 offset:59392
  v_mul_f32 v22, v16, v120
  v_mul_f32 v23, v16, v121
  v_mul_f32 v24, v16, v122
  v_mfma_f32_16x16x32_bf16 v[56:59], a[200:203], a[216:219], v[56:59]
  s_waitcnt lgkmcnt(11)
  ds_read_b64_tr_b16 a[198:199], v247 offset:63488
  v_mul_f32 v25, v16, v123
  v_exp_f32 v22, v22
  v_mfma_f32_16x16x32_bf16 v[144:147], a[208:211], a[216:219], 0
  buffer_load_dwordx4 v136, s[24:27], s50 offen offset:3072 lds
  ds_read_b64_tr_b16 a[200:201], v248 offset:0
  v_mul_f32 v228, v116, v228
  v_mfma_f32_16x16x32_bf16 v[144:147], a[212:215], a[224:227], v[144:147]
  ds_read_b64_tr_b16 a[202:203], v248 offset:4096
  v_exp_f32 v23, v23
  v_mul_f32 v229, v117, v229
  v_mfma_f32_16x16x32_bf16 v[148:151], a[212:215], a[228:231], 0
Hb1_2:
  s_cbranch_execz Hb1_3
  ds_read_b64_tr_b16 a[204:205], v248 offset:8192
  v_exp_f32 v24, v24
  v_mul_f32 v230, v118, v230
  v_mfma_f32_16x16x32_bf16 v[148:151], a[208:211], a[220:223], v[148:151]
  s_waitcnt lgkmcnt(11)
  ds_read_b64_tr_b16 a[206:207], v248 offset:12288
  v_exp_f32 v25, v25
  v_mul_f32 v231, v119, v231
  v_mfma_f32_16x16x32_bf16 v[156:159], a[176:179], a[220:223], 0
  buffer_load_dwordx4 a[44:47], v137, s[36:39], s51 offen offset:3072 sc1
  s_mov_b32 s77, 31
  s_lshl_b32 s50, s77, 16
  s_add_u32 m0, s73, 32768
  v_mfma_f32_16x16x32_bf16 v[156:159], a[180:183], a[228:231], v[156:159]
  ds_read_b64_tr_b16 a[208:209], v249 offset:0
  ds_read_b64_tr_b16 a[210:211], v249 offset:4096
  v_mul_f32 v228, v228, v26
  v_mul_f32 v229, v229, v27
  v_mfma_f32_16x16x32_bf16 v[152:155], a[180:183], a[224:227], 0
  ds_read_b64_tr_b16 a[212:213], v249 offset:8192
  v_mul_f32 v230, v230, v28
  v_mul_f32 v231, v231, v29
  v_cvt_pk_bf16_f32 v98, v224, v225
  v_mfma_f32_16x16x32_bf16 v[152:155], a[176:179], a[216:219], v[152:155]
  s_waitcnt lgkmcnt(11)
  ds_read_b64_tr_b16 a[214:215], v249 offset:12288
  v_cvt_pk_bf16_f32 v99, v226, v227
  v_mfma_f32_16x16x32_bf16 v[160:163], a[184:187], a[216:219], 0
  buffer_load_dwordx4 v133, s[24:27], s50 offen offset:0 lds
  s_lshl_b32 s51, s77, 11
  ds_read_b64_tr_b16 a[176:177], v250 offset:0
  v_mfma_f32_16x16x32_bf16 v[160:163], a[188:191], a[224:227], v[160:163]
  ds_read_b64_tr_b16 a[178:179], v250 offset:4096
  v_mfma_f32_16x16x32_bf16 v[164:167], a[188:191], a[228:231], 0
  ds_read_b64_tr_b16 a[180:181], v250 offset:8192
  buffer_store_dwordx4 v[96:99], v0, s[36:39], s64 offen offset:0 sc1
  v_mul_f32 v26, v19, v124
  v_mul_f32 v27, v19, v125
  v_mfma_f32_16x16x32_bf16 v[164:167], a[184:187], a[220:223], v[164:167]
  s_waitcnt lgkmcnt(11)
  ds_read_b64_tr_b16 a[182:183], v250 offset:12288
  v_mul_f32 v28, v19, v126
  v_mul_f32 v29, v19, v127
  v_mfma_f32_16x16x32_bf16 v[172:175], a[192:195], a[220:223], 0
  buffer_load_dwordx4 a[48:51], v137, s[36:39], s51 offen offset:0 sc1
  ds_read_b64_tr_b16 a[184:185], v251 offset:0
  v_exp_f32 v26, v26
  v_mfma_f32_16x16x32_bf16 v[172:175], a[196:199], a[228:231], v[172:175]
  ds_read_b64_tr_b16 a[186:187], v251 offset:4096
  v_fma_f32 v22, v22, v17, v17
  v_exp_f32 v27, v27
  v_mfma_f32_16x16x32_bf16 v[168:171], a[196:199], a[224:227], 0
  ds_read_b64_tr_b16 a[188:189], v251 offset:8192
  v_fma_f32 v23, v23, v17, v17
  v_exp_f32 v28, v28
  v_mfma_f32_16x16x32_bf16 v[168:171], a[192:195], a[216:219], v[168:171]
  s_waitcnt vmcnt(15) lgkmcnt(11)
  ds_read_b64_tr_b16 a[190:191], v251 offset:12288
  v_fma_f32 v24, v24, v17, v17
  v_exp_f32 v29, v29
  v_mfma_f32_16x16x32_bf16 v[32:35], a[200:203], a[0:3], v[32:35]
  buffer_load_dwordx4 v134, s[24:27], s50 offen offset:1024 lds
  ds_read_b64_tr_b16 a[192:193], v248 offset:2048
  v_fma_f32 v25, v25, v17, v17
  v_cvt_pk_bf16_f32 v102, v228, v229
  v_mfma_f32_16x16x32_bf16 v[32:35], a[204:207], a[8:11], v[32:35]
  ds_read_b64_tr_b16 a[194:195], v248 offset:6144
  v_cvt_pk_bf16_f32 v103, v230, v231
  v_mfma_f32_16x16x32_bf16 v[36:39], a[204:207], a[12:15], v[36:39]
  ds_read_b64_tr_b16 a[196:197], v248 offset:10240
  buffer_store_dwordx4 v[100:103], v0, s[36:39], s64 offen offset:1024 sc1
  v_rcp_f32 v22, v22
  v_mfma_f32_16x16x32_bf16 v[36:39], a[200:203], a[4:7], v[36:39]
  s_waitcnt lgkmcnt(11)
  ds_read_b64_tr_b16 a[198:199], v248 offset:14336
  v_fma_f32 v26, v26, v20, v20
  v_rcp_f32 v23, v23
  v_mfma_f32_16x16x32_bf16 v[44:47], a[208:211], a[4:7], v[44:47]
  buffer_load_dwordx4 a[52:55], v137, s[36:39], s51 offen offset:1024 sc1
  ds_read_b64_tr_b16 a[200:201], v249 offset:2048
  v_fma_f32 v27, v27, v20, v20
  v_mfma_f32_16x16x32_bf16 v[44:47], a[212:215], a[12:15], v[44:47]
  ds_read_b64_tr_b16 a[202:203], v249 offset:6144
  v_rcp_f32 v24, v24
  v_fma_f32 v28, v28, v20, v20
  v_mfma_f32_16x16x32_bf16 v[40:43], a[212:215], a[8:11], v[40:43]
  ds_read_b64_tr_b16 a[204:205], v249 offset:10240
  v_rcp_f32 v25, v25
  v_fma_f32 v29, v29, v20, v20
  v_mfma_f32_16x16x32_bf16 v[40:43], a[208:211], a[0:3], v[40:43]
  s_waitcnt vmcnt(34) lgkmcnt(11)
  s_barrier
  buffer_load_dwordx4 v135, s[24:27], s50 offen offset:2048 lds
  ds_read_b64_tr_b16 a[206:207], v249 offset:14336
  v_mfma_f32_16x16x32_bf16 v[48:51], a[176:179], a[0:3], v[48:51]
  ds_read_b64_tr_b16 a[208:209], v250 offset:2048
  v_rcp_f32 v26, v26
  v_mul_f32 v232, v120, v232
  v_mfma_f32_16x16x32_bf16 v[48:51], a[180:183], a[8:11], v[48:51]
  ds_read_b64_tr_b16 a[210:211], v250 offset:6144
  v_rcp_f32 v27, v27
  v_mul_f32 v233, v121, v233
  v_mfma_f32_16x16x32_bf16 v[52:55], a[180:183], a[12:15], v[52:55]
  ds_read_b64_tr_b16 a[212:213], v250 offset:10240
  v_rcp_f32 v28, v28
  v_mul_f32 v234, v122, v234
  v_mfma_f32_16x16x32_bf16 v[52:55], a[176:179], a[4:7], v[52:55]
  s_waitcnt lgkmcnt(11)
  buffer_load_dwordx4 a[56:59], v137, s[36:39], s51 offen offset:2048 sc1
  ds_read_b64_tr_b16 a[214:215], v250 offset:14336
  v_rcp_f32 v29, v29
  v_mfma_f32_16x16x32_bf16 v[60:63], a[184:187], a[4:7], v[60:63]
  ds_read_b64_tr_b16 a[176:177], v251 offset:2048
  v_mul_f32 v235, v123, v235
  v_mul_f32 v232, v232, v22
  v_mul_f32 v233, v233, v23
  v_mfma_f32_16x16x32_bf16 v[60:63], a[188:191], a[12:15], v[60:63]
  ds_read_b64_tr_b16 a[178:179], v251 offset:6144
  v_mul_f32 v234, v234, v24
  v_mul_f32 v235, v235, v25
  v_mul_f32 v236, v124, v236
  v_mfma_f32_16x16x32_bf16 v[56:59], a[188:191], a[8:11], v[56:59]
  ds_read_b64_tr_b16 a[180:181], v251 offset:10240
  v_mul_f32 v237, v125, v237
  v_mul_f32 v238, v126, v238
  v_mul_f32 v239, v127, v239
  v_mfma_f32_16x16x32_bf16 v[56:59], a[184:187], a[0:3], v[56:59]
  s_waitcnt lgkmcnt(11)
  buffer_load_dwordx4 v136, s[24:27], s50 offen offset:3072 lds
  ds_read_b64_tr_b16 a[182:183], v251 offset:14336
  v_cvt_pk_bf16_f32 v106, v232, v233
  v_cvt_pk_bf16_f32 v107, v234, v235
  v_mfma_f32_16x16x32_bf16 v[144:147], a[192:195], a[0:3], v[144:147]
  ds_read_b64_tr_b16 a[184:185], v240 offset:0
  v_mfma_f32_16x16x32_bf16 v[144:147], a[196:199], a[8:11], v[144:147]
  ds_read_b64_tr_b16 a[186:187], v240 offset:4096
  buffer_store_dwordx4 v[104:107], v0, s[36:39], s65 offen offset:0 sc1
  v_mul_f32 v236, v236, v26
  v_mul_f32 v237, v237, v27
  v_mfma_f32_16x16x32_bf16 v[148:151], a[196:199], a[12:15], v[148:151]
  ds_read_b64_tr_b16 a[188:189], v240 offset:8192
  v_mul_f32 v238, v238, v28
  v_mul_f32 v239, v239, v29
  v_cvt_pk_bf16_f32 v110, v236, v237
  v_mfma_f32_16x16x32_bf16 v[148:151], a[192:195], a[4:7], v[148:151]
  s_waitcnt lgkmcnt(11)
  buffer_load_dwordx4 a[60:63], v137, s[36:39], s51 offen offset:3072 sc1
  s_cmp_eq_u32 s83, 1
  s_cselect_b32 s78, 10, 38
  s_lshl_b32 s50, s78, 16
  v_mfma_f32_16x16x32_bf16 v[156:159], a[200:203], a[4:7], v[156:159]
  s_add_u32 m0, s73, 49152
  ds_read_b64_tr_b16 a[190:191], v240 offset:12288
  ds_read_b64_tr_b16 a[192:193], v241 offset:0
  v_cvt_pk_bf16_f32 v111, v238, v239
  v_mfma_f32_16x16x32_bf16 v[156:159], a[204:207], a[12:15], v[156:159]
  ds_read_b64_tr_b16 a[194:195], v241 offset:4096
  buffer_store_dwordx4 v[108:111], v0, s[36:39], s65 offen offset:1024 sc1
  v_mfma_f32_16x16x32_bf16 v[152:155], a[204:207], a[8:11], v[152:155]
  ds_read_b64_tr_b16 a[196:197], v241 offset:8192
  v_mfma_f32_16x16x32_bf16 v[152:155], a[200:203], a[0:3], v[152:155]
  s_waitcnt lgkmcnt(11)
  buffer_load_dwordx4 v133, s[24:27], s50 offen offset:0 lds
  s_lshl_b32 s51, s78, 11
  ds_read_b64_tr_b16 a[198:199], v241 offset:12288
  v_mfma_f32_16x16x32_bf16 v[160:163], a[208:211], a[0:3], v[160:163]
  ds_read_b64_tr_b16 a[200:201], v242 offset:0
  v_mfma_f32_16x16x32_bf16 v[160:163], a[212:215], a[8:11], v[160:163]
  ds_read_b64_tr_b16 a[202:203], v242 offset:4096
  v_mfma_f32_16x16x32_bf16 v[164:167], a[212:215], a[12:15], v[164:167]
  buffer_load_dwordx4 a[64:67], v137, s[36:39], s51 offen offset:0 sc1
  ds_read_b64_tr_b16 a[204:205], v242 offset:8192
  v_mfma_f32_16x16x32_bf16 v[164:167], a[208:211], a[4:7], v[164:167]
  s_waitcnt lgkmcnt(11)
  ds_read_b64_tr_b16 a[206:207], v242 offset:12288
  v_mfma_f32_16x16x32_bf16 v[172:175], a[176:179], a[4:7], v[172:175]
  ds_read_b64_tr_b16 a[208:209], v243 offset:0
  v_mfma_f32_16x16x32_bf16 v[172:175], a[180:183], a[12:15], v[172:175]
  ds_read_b64_tr_b16 a[210:211], v243 offset:4096
  v_mfma_f32_16x16x32_bf16 v[168:171], a[180:183], a[8:11], v[168:171]
  buffer_load_dwordx4 v134, s[24:27], s50 offen offset:1024 lds
  ds_read_b64_tr_b16 a[212:213], v243 offset:8192
  v_mfma_f32_16x16x32_bf16 v[168:171], a[176:179], a[0:3], v[168:171]
  s_waitcnt vmcnt(23) lgkmcnt(11)
  ds_read_b64_tr_b16 a[214:215], v243 offset:12288
  v_mfma_f32_16x16x32_bf16 v[32:35], a[184:187], a[16:19], v[32:35]
  ds_read_b64_tr_b16 a[176:177], v240 offset:2048
  v_mfma_f32_16x16x32_bf16 v[32:35], a[188:191], a[24:27], v[32:35]
  ds_read_b64_tr_b16 a[178:179], v240 offset:6144
  v_mfma_f32_16x16x32_bf16 v[36:39], a[188:191], a[28:31], v[36:39]
  buffer_load_dwordx4 a[68:71], v137, s[36:39], s51 offen offset:1024 sc1
  ds_read_b64_tr_b16 a[180:181], v240 offset:10240
  v_mfma_f32_16x16x32_bf16 v[36:39], a[184:187], a[20:23], v[36:39]
  s_waitcnt lgkmcnt(11)
  ds_read_b64_tr_b16 a[182:183], v240 offset:14336
  v_mfma_f32_16x16x32_bf16 v[44:47], a[192:195], a[20:23], v[44:47]
  ds_read_b64_tr_b16 a[184:185], v241 offset:2048
  v_mfma_f32_16x16x32_bf16 v[44:47], a[196:199], a[28:31], v[44:47]
  ds_read_b64_tr_b16 a[186:187], v241 offset:6144
  v_mfma_f32_16x16x32_bf16 v[40:43], a[196:199], a[24:27], v[40:43]
  buffer_load_dwordx4 v135, s[24:27], s50 offen offset:2048 lds
  ds_read_b64_tr_b16 a[188:189], v241 offset:10240
  v_mfma_f32_16x16x32_bf16 v[40:43], a[192:195], a[16:19], v[40:43]
  s_waitcnt vmcnt(18) lgkmcnt(11)
  s_barrier
  ds_read_b64_tr_b16 a[190:191], v241 offset:14336
  v_mfma_f32_16x16x32_bf16 v[48:51], a[200:203], a[16:19], v[48:51]
  ds_read_b64_tr_b16 a[192:193], v242 offset:2048
  v_mfma_f32_16x16x32_bf16 v[48:51], a[204:207], a[24:27], v[48:51]
  buffer_load_dwordx4 a[72:75], v137, s[36:39], s51 offen offset:2048 sc1
  ds_read_b64_tr_b16 a[194:195], v242 offset:6144
  v_mfma_f32_16x16x32_bf16 v[52:55], a[204:207], a[28:31], v[52:55]
  ds_read_b64_tr_b16 a[196:197], v242 offset:10240
  v_mfma_f32_16x16x32_bf16 v[52:55], a[200:203], a[20:23], v[52:55]
  s_waitcnt lgkmcnt(11)
  ds_read_b64_tr_b16 a[198:199], v242 offset:14336
  v_mfma_f32_16x16x32_bf16 v[60:63], a[208:211], a[20:23], v[60:63]
  ds_read_b64_tr_b16 a[200:201], v243 offset:2048
  v_mfma_f32_16x16x32_bf16 v[60:63], a[212:215], a[28:31], v[60:63]
  buffer_load_dwordx4 v136, s[24:27], s50 offen offset:3072 lds
  ds_read_b64_tr_b16 a[202:203], v243 offset:6144
  v_mfma_f32_16x16x32_bf16 v[56:59], a[212:215], a[24:27], v[56:59]
  ds_read_b64_tr_b16 a[204:205], v243 offset:10240
  v_mfma_f32_16x16x32_bf16 v[56:59], a[208:211], a[16:19], v[56:59]
  s_waitcnt lgkmcnt(11)
  ds_read_b64_tr_b16 a[206:207], v243 offset:14336
  v_mfma_f32_16x16x32_bf16 v[144:147], a[176:179], a[16:19], v[144:147]
  ds_read_b64_tr_b16 a[208:209], v240 offset:16384
  v_mfma_f32_16x16x32_bf16 v[144:147], a[180:183], a[24:27], v[144:147]
  buffer_load_dwordx4 a[76:79], v137, s[36:39], s51 offen offset:3072 sc1
  s_cmp_eq_u32 s83, 2
  v_mfma_f32_16x16x32_bf16 v[148:151], a[180:183], a[28:31], v[148:151]
  s_cselect_b32 s79, 17, 45
  s_lshl_b32 s50, s79, 16
  s_add_u32 m0, s73, 65536
  v_mfma_f32_16x16x32_bf16 v[148:151], a[176:179], a[20:23], v[148:151]
  s_waitcnt lgkmcnt(9)
  ds_read_b64_tr_b16 a[210:211], v240 offset:20480
  ds_read_b64_tr_b16 a[212:213], v240 offset:24576
  v_mfma_f32_16x16x32_bf16 v[156:159], a[184:187], a[20:23], v[156:159]
  ds_read_b64_tr_b16 a[214:215], v240 offset:28672
  ds_read_b64_tr_b16 a[176:177], v241 offset:16384
  v_mfma_f32_16x16x32_bf16 v[156:159], a[188:191], a[28:31], v[156:159]
  buffer_load_dwordx4 v133, s[24:27], s50 offen offset:0 lds
  s_lshl_b32 s51, s79, 11
  v_mfma_f32_16x16x32_bf16 v[152:155], a[188:191], a[24:27], v[152:155]
  ds_read_b64_tr_b16 a[178:179], v241 offset:20480
  ds_read_b64_tr_b16 a[180:181], v241 offset:24576
  v_mfma_f32_16x16x32_bf16 v[152:155], a[184:187], a[16:19], v[152:155]
  s_waitcnt lgkmcnt(11)
  ds_read_b64_tr_b16 a[182:183], v241 offset:28672
  v_mfma_f32_16x16x32_bf16 v[160:163], a[192:195], a[16:19], v[160:163]
  ds_read_b64_tr_b16 a[184:185], v242 offset:16384
  v_mfma_f32_16x16x32_bf16 v[160:163], a[196:199], a[24:27], v[160:163]
  buffer_load_dwordx4 a[80:83], v137, s[36:39], s51 offen offset:0 sc1
  ds_read_b64_tr_b16 a[186:187], v242 offset:20480
  v_mfma_f32_16x16x32_bf16 v[164:167], a[196:199], a[28:31], v[164:167]
  ds_read_b64_tr_b16 a[188:189], v242 offset:24576
  v_mfma_f32_16x16x32_bf16 v[164:167], a[192:195], a[20:23], v[164:167]
  s_waitcnt lgkmcnt(11)
  ds_read_b64_tr_b16 a[190:191], v242 offset:28672
  v_mfma_f32_16x16x32_bf16 v[172:175], a[200:203], a[20:23], v[172:175]
  buffer_load_dwordx4 v134, s[24:27], s50 offen offset:1024 lds
  ds_read_b64_tr_b16 a[192:193], v243 offset:16384
  v_mfma_f32_16x16x32_bf16 v[172:175], a[204:207], a[28:31], v[172:175]
  ds_read_b64_tr_b16 a[194:195], v243 offset:20480
  v_mfma_f32_16x16x32_bf16 v[168:171], a[204:207], a[24:27], v[168:171]
  ds_read_b64_tr_b16 a[196:197], v243 offset:24576
  v_mfma_f32_16x16x32_bf16 v[168:171], a[200:203], a[16:19], v[168:171]
  s_waitcnt vmcnt(23) lgkmcnt(11)
  ds_read_b64_tr_b16 a[198:199], v243 offset:28672
  v_mfma_f32_16x16x32_bf16 v[32:35], a[208:211], a[32:35], v[32:35]
  buffer_load_dwordx4 a[84:87], v137, s[36:39], s51 offen offset:1024 sc1
  ds_read_b64_tr_b16 a[200:201], v240 offset:18432
  v_mfma_f32_16x16x32_bf16 v[32:35], a[212:215], a[40:43], v[32:35]
  ds_read_b64_tr_b16 a[202:203], v240 offset:22528
  v_mfma_f32_16x16x32_bf16 v[36:39], a[212:215], a[44:47], v[36:39]
  ds_read_b64_tr_b16 a[204:205], v240 offset:26624
  v_mfma_f32_16x16x32_bf16 v[36:39], a[208:211], a[36:39], v[36:39]
  s_waitcnt lgkmcnt(11)
  ds_read_b64_tr_b16 a[206:207], v240 offset:30720
  v_mfma_f32_16x16x32_bf16 v[44:47], a[176:179], a[36:39], v[44:47]
  buffer_load_dwordx4 v135, s[24:27], s50 offen offset:2048 lds
  ds_read_b64_tr_b16 a[208:209], v241 offset:18432
  v_mfma_f32_16x16x32_bf16 v[44:47], a[180:183], a[44:47], v[44:47]
  ds_read_b64_tr_b16 a[210:211], v241 offset:22528
  v_mfma_f32_16x16x32_bf16 v[40:43], a[180:183], a[40:43], v[40:43]
  s_waitcnt vmcnt(13)
  ds_read_b64_tr_b16 a[212:213], v241 offset:26624
  v_mfma_f32_16x16x32_bf16 v[40:43], a[176:179], a[32:35], v[40:43]
  s_waitcnt vmcnt(16) lgkmcnt(11)
  s_barrier
  ds_read_b64_tr_b16 a[214:215], v241 offset:30720
  v_mfma_f32_16x16x32_bf16 v[48:51], a[184:187], a[32:35], v[48:51]
  s_mov_b64 exec, 1
  buffer_store_dword v254, v0, s[36:39], s45 offen sc1
  s_mov_b64 exec, -1
  v_mfma_f32_16x16x32_bf16 v[48:51], a[188:191], a[40:43], v[48:51]
  buffer_load_dwordx4 a[88:91], v137, s[36:39], s51 offen offset:2048 sc1
  ds_read_b64_tr_b16 a[176:177], v242 offset:18432
  v_mfma_f32_16x16x32_bf16 v[52:55], a[188:191], a[44:47], v[52:55]
  ds_read_b64_tr_b16 a[178:179], v242 offset:22528
  ds_read_b64_tr_b16 a[180:181], v242 offset:26624
  v_mfma_f32_16x16x32_bf16 v[52:55], a[184:187], a[36:39], v[52:55]
  s_waitcnt lgkmcnt(11)
  ds_read_b64_tr_b16 a[182:183], v242 offset:30720
  v_mfma_f32_16x16x32_bf16 v[60:63], a[192:195], a[36:39], v[60:63]
  buffer_load_dwordx4 v136, s[24:27], s50 offen offset:3072 lds
  ds_read_b64_tr_b16 a[184:185], v243 offset:18432
  v_mfma_f32_16x16x32_bf16 v[60:63], a[196:199], a[44:47], v[60:63]
  ds_read_b64_tr_b16 a[186:187], v243 offset:22528
  v_mfma_f32_16x16x32_bf16 v[56:59], a[196:199], a[40:43], v[56:59]
  ds_read_b64_tr_b16 a[188:189], v243 offset:26624
  v_mfma_f32_16x16x32_bf16 v[56:59], a[192:195], a[32:35], v[56:59]
  s_waitcnt lgkmcnt(11)
  buffer_load_dwordx4 a[92:95], v137, s[36:39], s51 offen offset:3072 sc1
  s_cmp_eq_u32 s83, 3
  v_mfma_f32_16x16x32_bf16 v[144:147], a[200:203], a[32:35], v[144:147]
  s_cselect_b32 s80, 24, 52
  s_lshl_b32 s50, s80, 16
  s_add_u32 m0, s73, 81920
  v_mfma_f32_16x16x32_bf16 v[144:147], a[204:207], a[40:43], v[144:147]
  ds_read_b64_tr_b16 a[190:191], v243 offset:30720
  ds_read_b64_tr_b16 a[192:193], v240 offset:32768
  v_mfma_f32_16x16x32_bf16 v[148:151], a[204:207], a[44:47], v[148:151]
  ds_read_b64_tr_b16 a[194:195], v240 offset:36864
  ds_read_b64_tr_b16 a[196:197], v240 offset:40960
  v_mfma_f32_16x16x32_bf16 v[148:151], a[200:203], a[36:39], v[148:151]
  s_waitcnt lgkmcnt(11)
  buffer_load_dwordx4 v133, s[24:27], s50 offen offset:0 lds
  s_lshl_b32 s51, s80, 11
  v_mfma_f32_16x16x32_bf16 v[156:159], a[208:211], a[36:39], v[156:159]
  ds_read_b64_tr_b16 a[198:199], v240 offset:45056
  ds_read_b64_tr_b16 a[200:201], v241 offset:32768
  v_mfma_f32_16x16x32_bf16 v[156:159], a[212:215], a[44:47], v[156:159]
  ds_read_b64_tr_b16 a[202:203], v241 offset:36864
  v_mfma_f32_16x16x32_bf16 v[152:155], a[212:215], a[40:43], v[152:155]
  ds_read_b64_tr_b16 a[204:205], v241 offset:40960
  v_mfma_f32_16x16x32_bf16 v[152:155], a[208:211], a[32:35], v[152:155]
  s_waitcnt lgkmcnt(11)
  buffer_load_dwordx4 a[96:99], v137, s[36:39], s51 offen offset:0 sc1
  ds_read_b64_tr_b16 a[206:207], v241 offset:45056
  v_mfma_f32_16x16x32_bf16 v[160:163], a[176:179], a[32:35], v[160:163]
  ds_read_b64_tr_b16 a[208:209], v242 offset:32768
  v_mfma_f32_16x16x32_bf16 v[160:163], a[180:183], a[40:43], v[160:163]
  ds_read_b64_tr_b16 a[210:211], v242 offset:36864
  v_mfma_f32_16x16x32_bf16 v[164:167], a[180:183], a[44:47], v[164:167]
  ds_read_b64_tr_b16 a[212:213], v242 offset:40960
  v_mfma_f32_16x16x32_bf16 v[164:167], a[176:179], a[36:39], v[164:167]
  s_waitcnt lgkmcnt(11)
  buffer_load_dwordx4 v134, s[24:27], s50 offen offset:1024 lds
  ds_read_b64_tr_b16 a[214:215], v242 offset:45056
  v_mfma_f32_16x16x32_bf16 v[172:175], a[184:187], a[36:39], v[172:175]
  ds_read_b64_tr_b16 a[176:177], v243 offset:32768
  v_mfma_f32_16x16x32_bf16 v[172:175], a[188:191], a[44:47], v[172:175]
  ds_read_b64_tr_b16 a[178:179], v243 offset:36864
  v_mfma_f32_16x16x32_bf16 v[168:171], a[188:191], a[40:43], v[168:171]
  ds_read_b64_tr_b16 a[180:181], v243 offset:40960
  v_mfma_f32_16x16x32_bf16 v[168:171], a[184:187], a[32:35], v[168:171]
  s_waitcnt vmcnt(21) lgkmcnt(11)
  buffer_load_dwordx4 a[100:103], v137, s[36:39], s51 offen offset:1024 sc1
  ds_read_b64_tr_b16 a[182:183], v243 offset:45056
  v_mfma_f32_16x16x32_bf16 v[32:35], a[192:195], a[48:51], v[32:35]
  ds_read_b64_tr_b16 a[184:185], v240 offset:34816
  v_mfma_f32_16x16x32_bf16 v[32:35], a[196:199], a[56:59], v[32:35]
  ds_read_b64_tr_b16 a[186:187], v240 offset:38912
  v_mfma_f32_16x16x32_bf16 v[36:39], a[196:199], a[60:63], v[36:39]
  buffer_load_dwordx4 v135, s[24:27], s50 offen offset:2048 lds
  ds_read_b64_tr_b16 a[188:189], v240 offset:43008
  v_mfma_f32_16x16x32_bf16 v[36:39], a[192:195], a[52:55], v[36:39]
  s_waitcnt lgkmcnt(11)
  ds_read_b64_tr_b16 a[190:191], v240 offset:47104
  v_mfma_f32_16x16x32_bf16 v[44:47], a[200:203], a[52:55], v[44:47]
  ds_read_b64_tr_b16 a[192:193], v241 offset:34816
  v_mfma_f32_16x16x32_bf16 v[44:47], a[204:207], a[60:63], v[44:47]
  ds_read_b64_tr_b16 a[194:195], v241 offset:38912
  v_mfma_f32_16x16x32_bf16 v[40:43], a[204:207], a[56:59], v[40:43]
  buffer_load_dwordx4 a[104:107], v137, s[36:39], s51 offen offset:2048 sc1
  ds_read_b64_tr_b16 a[196:197], v241 offset:43008
  v_mfma_f32_16x16x32_bf16 v[40:43], a[200:203], a[48:51], v[40:43]
  s_waitcnt vmcnt(16) lgkmcnt(11)
  s_barrier
  ds_read_b64_tr_b16 a[198:199], v241 offset:47104
  v_mfma_f32_16x16x32_bf16 v[48:51], a[208:211], a[48:51], v[48:51]
  ds_read_b64_tr_b16 a[200:201], v242 offset:34816
  v_mfma_f32_16x16x32_bf16 v[48:51], a[212:215], a[56:59], v[48:51]
  ds_read_b64_tr_b16 a[202:203], v242 offset:38912
  v_mfma_f32_16x16x32_bf16 v[52:55], a[212:215], a[60:63], v[52:55]
  buffer_load_dwordx4 v136, s[24:27], s50 offen offset:3072 lds
  ds_read_b64_tr_b16 a[204:205], v242 offset:43008
  v_mfma_f32_16x16x32_bf16 v[52:55], a[208:211], a[52:55], v[52:55]
  s_waitcnt lgkmcnt(11)
  ds_read_b64_tr_b16 a[206:207], v242 offset:47104
  v_mfma_f32_16x16x32_bf16 v[60:63], a[176:179], a[52:55], v[60:63]
  ds_read_b64_tr_b16 a[208:209], v243 offset:34816
  v_mfma_f32_16x16x32_bf16 v[60:63], a[180:183], a[60:63], v[60:63]
  ds_read_b64_tr_b16 a[210:211], v243 offset:38912
  v_mfma_f32_16x16x32_bf16 v[56:59], a[180:183], a[56:59], v[56:59]
  buffer_load_dwordx4 a[108:111], v137, s[36:39], s51 offen offset:3072 sc1
  s_add_u32 s81, s83, 8
  v_mfma_f32_16x16x32_bf16 v[56:59], a[176:179], a[48:51], v[56:59]
  s_waitcnt lgkmcnt(10)
  s_and_b32 s81, s81, 3
  s_mul_i32 s81, s81, 14
  v_mfma_f32_16x16x32_bf16 v[144:147], a[184:187], a[48:51], v[144:147]
  s_lshl_b32 s50, s81, 16
  s_add_u32 s50, s50, s84
  s_add_u32 m0, s73, 98304
  v_mfma_f32_16x16x32_bf16 v[144:147], a[188:191], a[56:59], v[144:147]
  ds_read_b64_tr_b16 a[212:213], v243 offset:43008
  ds_read_b64_tr_b16 a[214:215], v243 offset:47104
  v_mfma_f32_16x16x32_bf16 v[148:151], a[188:191], a[60:63], v[148:151]
  ds_read_b64_tr_b16 a[176:177], v240 offset:49152
  ds_read_b64_tr_b16 a[178:179], v240 offset:53248
  v_mfma_f32_16x16x32_bf16 v[148:151], a[184:187], a[52:55], v[148:151]
  s_waitcnt lgkmcnt(10)
  buffer_load_dwordx4 v133, s[24:27], s50 offen offset:0 lds
  s_lshl_b32 s51, s81, 11
  v_mfma_f32_16x16x32_bf16 v[156:159], a[192:195], a[52:55], v[156:159]
  ds_read_b64_tr_b16 a[180:181], v240 offset:57344
  ds_read_b64_tr_b16 a[182:183], v240 offset:61440
  v_mfma_f32_16x16x32_bf16 v[156:159], a[196:199], a[60:63], v[156:159]
  ds_read_b64_tr_b16 a[184:185], v241 offset:49152
  ds_read_b64_tr_b16 a[186:187], v241 offset:53248
  v_mfma_f32_16x16x32_bf16 v[152:155], a[196:199], a[56:59], v[152:155]
  s_add_u32 s67, s73, 16384
  buffer_load_dwordx4 a[112:115], v137, s[36:39], s51 offen offset:0 sc1
  ds_read_b64_tr_b16 a[188:189], v241 offset:57344
  v_mfma_f32_16x16x32_bf16 v[152:155], a[192:195], a[48:51], v[152:155]
  s_waitcnt lgkmcnt(11)
  ds_read_b64_tr_b16 a[190:191], v241 offset:61440
  v_and_b32 v129, 15, v128
  v_mfma_f32_16x16x32_bf16 v[160:163], a[200:203], a[48:51], v[160:163]
  ds_read_b64_tr_b16 a[192:193], v242 offset:49152
  v_lshrrev_b32 v131, 1, v129
  v_mfma_f32_16x16x32_bf16 v[160:163], a[204:207], a[56:59], v[160:163]
  buffer_load_dwordx4 v134, s[24:27], s50 offen offset:1024 lds
  ds_read_b64_tr_b16 a[194:195], v242 offset:53248
  v_mfma_f32_16x16x32_bf16 v[164:167], a[204:207], a[60:63], v[164:167]
  ds_read_b64_tr_b16 a[196:197], v242 offset:57344
  v_lshrrev_b32 v130, 5, v128
  v_mfma_f32_16x16x32_bf16 v[164:167], a[200:203], a[52:55], v[164:167]
  s_waitcnt lgkmcnt(11)
  ds_read_b64_tr_b16 a[198:199], v242 offset:61440
  v_xor_b32 v131, v131, v130
  v_mfma_f32_16x16x32_bf16 v[172:175], a[208:211], a[52:55], v[172:175]
  ds_read_b64_tr_b16 a[200:201], v243 offset:49152
  v_lshlrev_b32 v131, 4, v131
  v_mfma_f32_16x16x32_bf16 v[172:175], a[212:215], a[60:63], v[172:175]
  buffer_load_dwordx4 a[116:119], v137, s[36:39], s51 offen offset:1024 sc1
  ds_read_b64_tr_b16 a[202:203], v243 offset:53248
  v_mfma_f32_16x16x32_bf16 v[168:171], a[212:215], a[56:59], v[168:171]
  ds_read_b64_tr_b16 a[204:205], v243 offset:57344
  v_lshl_add_u32 v131, v129, 7, v131
  v_mfma_f32_16x16x32_bf16 v[168:171], a[208:211], a[48:51], v[168:171]
  s_waitcnt vmcnt(21) lgkmcnt(11)
  ds_read_b64_tr_b16 a[206:207], v243 offset:61440
  v_bfe_u32 v130, v128, 4, 1
  v_mfma_f32_16x16x32_bf16 v[32:35], a[176:179], a[64:67], v[32:35]
  ds_read_b64_tr_b16 a[208:209], v240 offset:51200
  v_lshl_add_u32 v131, v130, 3, v131
  v_mfma_f32_16x16x32_bf16 v[32:35], a[180:183], a[72:75], v[32:35]
  buffer_load_dwordx4 v135, s[24:27], s50 offen offset:2048 lds
  s_add_u32 s51, s51, 12288
  v_mfma_f32_16x16x32_bf16 v[36:39], a[180:183], a[76:79], v[36:39]
  ds_read_b64_tr_b16 a[210:211], v240 offset:55296
  ds_read_b64_tr_b16 a[212:213], v240 offset:59392
  v_mfma_f32_16x16x32_bf16 v[36:39], a[176:179], a[68:71], v[36:39]
  s_waitcnt lgkmcnt(11)
  ds_read_b64_tr_b16 a[214:215], v240 offset:63488
  v_add_u32 v140, s67, v131
  v_mfma_f32_16x16x32_bf16 v[44:47], a[184:187], a[68:71], v[44:47]
  ds_read_b64_tr_b16 a[176:177], v241 offset:51200
  v_xor_b32 v141, 32, v140
  v_mfma_f32_16x16x32_bf16 v[44:47], a[188:191], a[76:79], v[44:47]
  buffer_load_dwordx4 a[120:123], v137, s[36:39], s51 offen offset:2048 sc1
  ds_read_b64_tr_b16 a[178:179], v241 offset:55296
  v_mfma_f32_16x16x32_bf16 v[40:43], a[188:191], a[72:75], v[40:43]
  ds_read_b64_tr_b16 a[180:181], v241 offset:59392
  v_xor_b32 v142, 64, v140
  v_mfma_f32_16x16x32_bf16 v[40:43], a[184:187], a[64:67], v[40:43]
  s_waitcnt vmcnt(15) lgkmcnt(11)
  s_barrier
  ds_read_b64_tr_b16 a[182:183], v241 offset:63488
  v_mfma_f32_16x16x32_bf16 v[48:51], a[192:195], a[64:67], v[48:51]
  ds_read_b64_tr_b16 a[184:185], v242 offset:51200
  v_xor_b32 v143, 96, v140
  v_mfma_f32_16x16x32_bf16 v[48:51], a[196:199], a[72:75], v[48:51]
  buffer_load_dwordx4 v136, s[24:27], s50 offen offset:3072 lds
  ds_read_b64_tr_b16 a[186:187], v242 offset:55296
  v_mfma_f32_16x16x32_bf16 v[52:55], a[196:199], a[76:79], v[52:55]
  ds_read_b64_tr_b16 a[188:189], v242 offset:59392
  v_add_u32 v255, s67, v0
  v_mfma_f32_16x16x32_bf16 v[52:55], a[192:195], a[68:71], v[52:55]
  s_waitcnt lgkmcnt(11)
  ds_read_b64_tr_b16 a[190:191], v242 offset:63488
  s_lshl_b32 s67, s44, 10
  v_mfma_f32_16x16x32_bf16 v[60:63], a[200:203], a[68:71], v[60:63]
  s_add_u32 s67, s67, 151552
  buffer_load_dwordx4 a[124:127], v137, s[36:39], s51 offen offset:3072 sc1
  s_add_u32 s82, s83, 9
  v_mfma_f32_16x16x32_bf16 v[60:63], a[204:207], a[76:79], v[60:63]
  s_and_b32 s82, s82, 3
  s_mul_i32 s82, s82, 14
  s_lshl_b32 s50, s82, 16
  v_mfma_f32_16x16x32_bf16 v[56:59], a[204:207], a[72:75], v[56:59]
  s_add_u32 s50, s50, s84
  s_add_u32 m0, s73, 114688
  ds_read_b64_tr_b16 a[192:193], v243 offset:51200
  v_mfma_f32_16x16x32_bf16 v[56:59], a[200:203], a[64:67], v[56:59]
  s_waitcnt lgkmcnt(9)
  ds_read_b64_tr_b16 a[194:195], v243 offset:55296
  ds_read_b64_tr_b16 a[196:197], v243 offset:59392
  v_mfma_f32_16x16x32_bf16 v[144:147], a[208:211], a[64:67], v[144:147]
  ds_read_b64_tr_b16 a[198:199], v243 offset:63488
  buffer_load_dwordx4 v133, s[24:27], s50 offen offset:0 lds
  v_mfma_f32_16x16x32_bf16 v[144:147], a[212:215], a[72:75], v[144:147]
  s_lshl_b32 s51, s82, 11
  ds_read_b64_tr_b16 a[200:201], v244 offset:0
  ds_read_b64_tr_b16 a[202:203], v244 offset:4096
  v_mfma_f32_16x16x32_bf16 v[148:151], a[212:215], a[76:79], v[148:151]
  ds_read_b64_tr_b16 a[204:205], v244 offset:8192
  v_add_u32 v129, s67, v0
  v_mfma_f32_16x16x32_bf16 v[148:151], a[208:211], a[68:71], v[148:151]
  s_waitcnt lgkmcnt(11)
  ds_read_b64_tr_b16 a[206:207], v244 offset:12288
  v_lshrrev_b32 v130, 4, v128
  v_mfma_f32_16x16x32_bf16 v[156:159], a[176:179], a[68:71], v[156:159]
  buffer_load_dwordx4 a[216:219], v137, s[36:39], s51 offen offset:0 sc1
  ds_read_b64_tr_b16 a[208:209], v245 offset:0
  v_mfma_f32_16x16x32_bf16 v[156:159], a[180:183], a[76:79], v[156:159]
  ds_read_b64_tr_b16 a[210:211], v245 offset:4096
  v_lshl_add_u32 v130, v130, 4, s67
  v_mfma_f32_16x16x32_bf16 v[152:155], a[180:183], a[72:75], v[152:155]
  ds_read_b64_tr_b16 a[212:213], v245 offset:8192
  ds_write_b128 v129, a[248:251]
  v_mfma_f32_16x16x32_bf16 v[152:155], a[176:179], a[64:67], v[152:155]
  s_waitcnt lgkmcnt(12)
  ds_read_b64_tr_b16 a[214:215], v245 offset:12288
  ds_read_b128 v[176:179], v130 offset:768
  v_mfma_f32_16x16x32_bf16 v[160:163], a[184:187], a[64:67], v[160:163]
  buffer_load_dwordx4 v134, s[24:27], s50 offen offset:1024 lds
  ds_read_b64_tr_b16 a[176:177], v246 offset:0
  v_mfma_f32_16x16x32_bf16 v[160:163], a[188:191], a[72:75], v[160:163]
  ds_read_b64_tr_b16 a[178:179], v246 offset:4096
  ds_read_b128 v[180:183], v130 offset:832
  v_mfma_f32_16x16x32_bf16 v[164:167], a[188:191], a[76:79], v[164:167]
  ds_read_b64_tr_b16 a[180:181], v246 offset:8192
  ds_read_b128 v[184:187], v130 offset:896
  v_mfma_f32_16x16x32_bf16 v[164:167], a[184:187], a[68:71], v[164:167]
  s_waitcnt lgkmcnt(15)
  ds_read_b64_tr_b16 a[182:183], v246 offset:12288
  ds_read_b128 v[188:191], v130 offset:960
  v_mfma_f32_16x16x32_bf16 v[172:175], a[192:195], a[68:71], v[172:175]
  buffer_load_dwordx4 a[220:223], v137, s[36:39], s51 offen offset:1024 sc1
  ds_read_b64_tr_b16 a[184:185], v247 offset:0
  v_mfma_f32_16x16x32_bf16 v[172:175], a[196:199], a[76:79], v[172:175]
  ds_read_b64_tr_b16 a[186:187], v247 offset:4096
  v_accvgpr_read_b32 v131, a232
  v_mfma_f32_16x16x32_bf16 v[168:171], a[196:199], a[72:75], v[168:171]
  ds_read_b64_tr_b16 a[188:189], v247 offset:8192
  v_lshlrev_b32 v64, 16, v131
  v_mfma_f32_16x16x32_bf16 v[168:171], a[192:195], a[64:67], v[168:171]
  s_waitcnt vmcnt(20) lgkmcnt(15)
  buffer_load_dwordx4 v135, s[24:27], s50 offen offset:2048 lds
  s_add_u32 s51, s51, 12288
  v_mfma_f32_16x16x32_bf16 v[32:35], a[200:203], a[80:83], v[32:35]
  ds_read_b64_tr_b16 a[190:191], v247 offset:12288
  ds_read_b64_tr_b16 a[192:193], v244 offset:2048
  v_mfma_f32_16x16x32_bf16 v[32:35], a[204:207], a[88:91], v[32:35]
  ds_read_b64_tr_b16 a[194:195], v244 offset:6144
  v_and_b32 v65, 0xffff0000, v131
  v_mfma_f32_16x16x32_bf16 v[36:39], a[204:207], a[92:95], v[36:39]
  ds_read_b64_tr_b16 a[196:197], v244 offset:10240
  v_accvgpr_read_b32 v131, a233
  v_mfma_f32_16x16x32_bf16 v[36:39], a[200:203], a[84:87], v[36:39]
  s_waitcnt lgkmcnt(15)
  buffer_load_dwordx4 a[224:227], v137, s[36:39], s51 offen offset:2048 sc1
  ds_read_b64_tr_b16 a[198:199], v244 offset:14336
  v_mfma_f32_16x16x32_bf16 v[44:47], a[208:211], a[84:87], v[44:47]
Hb2_2:
  s_cbranch_execz Hb2_3
  ds_read_b64_tr_b16 a[200:201], v245 offset:2048
  v_lshlrev_b32 v66, 16, v131
  v_mfma_f32_16x16x32_bf16 v[44:47], a[212:215], a[92:95], v[44:47]
  ds_read_b64_tr_b16 a[202:203], v245 offset:6144
  v_and_b32 v67, 0xffff0000, v131
  v_mfma_f32_16x16x32_bf16 v[40:43], a[212:215], a[88:91], v[40:43]
  ds_read_b64_tr_b16 a[204:205], v245 offset:10240
  v_accvgpr_read_b32 v131, a234
  v_mfma_f32_16x16x32_bf16 v[40:43], a[208:211], a[80:83], v[40:43]
  s_waitcnt vmcnt(15) lgkmcnt(12)
  s_barrier
  buffer_load_dwordx4 v136, s[24:27], s50 offen offset:3072 lds
  v_mfma_f32_16x16x32_bf16 v[48:51], a[176:179], a[80:83], v[48:51]
  ds_read_b64_tr_b16 a[206:207], v245 offset:14336
  ds_read_b64_tr_b16 a[208:209], v246 offset:2048
  v_mfma_f32_16x16x32_bf16 v[48:51], a[180:183], a[88:91], v[48:51]
  ds_read_b64_tr_b16 a[210:211], v246 offset:6144
  v_lshlrev_b32 v68, 16, v131
  v_mfma_f32_16x16x32_bf16 v[52:55], a[180:183], a[92:95], v[52:55]
  ds_read_b64_tr_b16 a[212:213], v246 offset:10240
  v_and_b32 v69, 0xffff0000, v131
  v_mfma_f32_16x16x32_bf16 v[52:55], a[176:179], a[84:87], v[52:55]
  s_waitcnt lgkmcnt(11)
  buffer_load_dwordx4 a[228:231], v137, s[36:39], s51 offen offset:3072 sc1
  s_add_u32 s70, s83, 10
  v_mfma_f32_16x16x32_bf16 v[60:63], a[184:187], a[84:87], v[60:63]
  s_and_b32 s70, s70, 3
  s_mul_i32 s70, s70, 14
  s_lshl_b32 s50, s70, 16
  v_mfma_f32_16x16x32_bf16 v[60:63], a[188:191], a[92:95], v[60:63]
  s_add_u32 s50, s50, s84
  s_add_u32 m0, s73, 131072
  ds_read_b64_tr_b16 a[214:215], v246 offset:14336
  v_mfma_f32_16x16x32_bf16 v[56:59], a[188:191], a[88:91], v[56:59]
  ds_read_b64_tr_b16 a[176:177], v247 offset:2048
  ds_read_b64_tr_b16 a[178:179], v247 offset:6144
  v_mfma_f32_16x16x32_bf16 v[56:59], a[184:187], a[80:83], v[56:59]
  s_waitcnt lgkmcnt(10)
  ds_read_b64_tr_b16 a[180:181], v247 offset:10240
  buffer_load_dwordx4 v133, s[24:27], s50 offen offset:0 lds
  v_mfma_f32_16x16x32_bf16 v[144:147], a[192:195], a[80:83], v[144:147]
  s_lshl_b32 s51, s70, 11
  ds_read_b64_tr_b16 a[182:183], v247 offset:14336
  ds_read_b64_tr_b16 a[184:185], v244 offset:16384
  v_mfma_f32_16x16x32_bf16 v[144:147], a[196:199], a[88:91], v[144:147]
  ds_read_b64_tr_b16 a[186:187], v244 offset:20480
  v_accvgpr_read_b32 v131, a235
  v_mfma_f32_16x16x32_bf16 v[148:151], a[196:199], a[92:95], v[148:151]
  buffer_load_dwordx4 a[0:3], v137, s[36:39], s51 offen offset:0 sc1
  ds_read_b64_tr_b16 a[188:189], v244 offset:24576
  v_mfma_f32_16x16x32_bf16 v[148:151], a[192:195], a[84:87], v[148:151]
  s_waitcnt lgkmcnt(11)
  ds_read_b64_tr_b16 a[190:191], v244 offset:28672
  v_lshlrev_b32 v70, 16, v131
  v_mfma_f32_16x16x32_bf16 v[156:159], a[200:203], a[84:87], v[156:159]
  ds_read_b64_tr_b16 a[192:193], v245 offset:16384
  v_and_b32 v71, 0xffff0000, v131
  v_mfma_f32_16x16x32_bf16 v[156:159], a[204:207], a[92:95], v[156:159]
  ds_read_b64_tr_b16 a[194:195], v245 offset:20480
  v_accvgpr_read_b32 v131, a236
  v_mfma_f32_16x16x32_bf16 v[152:155], a[204:207], a[88:91], v[152:155]
  buffer_load_dwordx4 v134, s[24:27], s50 offen offset:1024 lds
  ds_read_b64_tr_b16 a[196:197], v245 offset:24576
  v_mfma_f32_16x16x32_bf16 v[152:155], a[200:203], a[80:83], v[152:155]
  s_waitcnt lgkmcnt(11)
  ds_read_b64_tr_b16 a[198:199], v245 offset:28672
  v_lshlrev_b32 v72, 16, v131
  v_mfma_f32_16x16x32_bf16 v[160:163], a[208:211], a[80:83], v[160:163]
  ds_read_b64_tr_b16 a[200:201], v246 offset:16384
  v_and_b32 v73, 0xffff0000, v131
  v_mfma_f32_16x16x32_bf16 v[160:163], a[212:215], a[88:91], v[160:163]
  ds_read_b64_tr_b16 a[202:203], v246 offset:20480
  v_accvgpr_read_b32 v131, a237
  v_mfma_f32_16x16x32_bf16 v[164:167], a[212:215], a[92:95], v[164:167]
  buffer_load_dword v139, v138, s[36:39], s91 offen sc1
  ds_read_b64_tr_b16 a[204:205], v246 offset:24576
  v_mfma_f32_16x16x32_bf16 v[164:167], a[208:211], a[84:87], v[164:167]
  s_waitcnt lgkmcnt(11)
  ds_read_b64_tr_b16 a[206:207], v246 offset:28672
  v_lshlrev_b32 v74, 16, v131
  v_mfma_f32_16x16x32_bf16 v[172:175], a[176:179], a[84:87], v[172:175]
  ds_read_b64_tr_b16 a[208:209], v247 offset:16384
  v_and_b32 v75, 0xffff0000, v131
  v_mfma_f32_16x16x32_bf16 v[172:175], a[180:183], a[92:95], v[172:175]
  buffer_load_dwordx4 a[4:7], v137, s[36:39], s51 offen offset:1024 sc1
  ds_read_b64_tr_b16 a[210:211], v247 offset:20480
  v_mfma_f32_16x16x32_bf16 v[168:171], a[180:183], a[88:91], v[168:171]
  ds_read_b64_tr_b16 a[212:213], v247 offset:24576
  v_accvgpr_read_b32 v131, a238
  v_mfma_f32_16x16x32_bf16 v[168:171], a[176:179], a[80:83], v[168:171]
  s_waitcnt vmcnt(21) lgkmcnt(11)
  ds_read_b64_tr_b16 a[214:215], v247 offset:28672
  v_lshlrev_b32 v76, 16, v131
  v_mfma_f32_16x16x32_bf16 v[32:35], a[184:187], a[96:99], v[32:35]
  buffer_load_dwordx4 v135, s[24:27], s50 offen offset:2048 lds
  s_add_u32 s51, s51, 12288
  v_mfma_f32_16x16x32_bf16 v[32:35], a[188:191], a[104:107], v[32:35]
  ds_read_b64_tr_b16 a[176:177], v244 offset:18432
  ds_read_b64_tr_b16 a[178:179], v244 offset:22528
  v_mfma_f32_16x16x32_bf16 v[36:39], a[188:191], a[108:111], v[36:39]
  ds_read_b64_tr_b16 a[180:181], v244 offset:26624
  v_and_b32 v77, 0xffff0000, v131
  v_mfma_f32_16x16x32_bf16 v[36:39], a[184:187], a[100:103], v[36:39]
  s_waitcnt lgkmcnt(11)
  buffer_load_dwordx4 a[8:11], v137, s[36:39], s51 offen offset:2048 sc1
  ds_read_b64_tr_b16 a[182:183], v244 offset:30720
  v_mfma_f32_16x16x32_bf16 v[44:47], a[192:195], a[100:103], v[44:47]
  ds_read_b64_tr_b16 a[184:185], v245 offset:18432
  v_accvgpr_read_b32 v131, a239
  v_mfma_f32_16x16x32_bf16 v[44:47], a[196:199], a[108:111], v[44:47]
  ds_read_b64_tr_b16 a[186:187], v245 offset:22528
  v_lshlrev_b32 v78, 16, v131
  v_mfma_f32_16x16x32_bf16 v[40:43], a[196:199], a[104:107], v[40:43]
  buffer_load_dwordx4 v136, s[24:27], s50 offen offset:3072 lds
  ds_read_b64_tr_b16 a[188:189], v245 offset:26624
  v_mfma_f32_16x16x32_bf16 v[40:43], a[192:195], a[96:99], v[40:43]
  s_waitcnt vmcnt(17) lgkmcnt(11)
  s_barrier
  ds_read_b64_tr_b16 a[190:191], v245 offset:30720
  v_mfma_f32_16x16x32_bf16 v[48:51], a[200:203], a[96:99], v[48:51]
  ds_read_b64_tr_b16 a[192:193], v246 offset:18432
  v_and_b32 v79, 0xffff0000, v131
  v_mfma_f32_16x16x32_bf16 v[48:51], a[204:207], a[104:107], v[48:51]
  buffer_load_dwordx4 a[12:15], v137, s[36:39], s51 offen offset:3072 sc1
  s_add_u32 s74, s83, 11
  v_mfma_f32_16x16x32_bf16 v[52:55], a[204:207], a[108:111], v[52:55]
  s_and_b32 s74, s74, 3
  s_mul_i32 s74, s74, 14
  s_lshl_b32 s50, s74, 16
  v_mfma_f32_16x16x32_bf16 v[52:55], a[200:203], a[100:103], v[52:55]
  s_waitcnt lgkmcnt(9)
  s_add_u32 s50, s50, s84
  s_add_u32 m0, s73, 0
  v_mfma_f32_16x16x32_bf16 v[60:63], a[208:211], a[100:103], v[60:63]
  ds_read_b64_tr_b16 a[194:195], v246 offset:22528
  ds_read_b64_tr_b16 a[196:197], v246 offset:26624
  v_mfma_f32_16x16x32_bf16 v[60:63], a[212:215], a[108:111], v[60:63]
  ds_read_b64_tr_b16 a[198:199], v246 offset:30720
  ds_read_b64_tr_b16 a[200:201], v247 offset:18432
  v_mfma_f32_16x16x32_bf16 v[56:59], a[212:215], a[104:107], v[56:59]
  buffer_load_dwordx4 v133, s[24:27], s50 offen offset:0 lds
  s_lshl_b32 s51, s74, 11
  v_mfma_f32_16x16x32_bf16 v[56:59], a[208:211], a[96:99], v[56:59]
  s_waitcnt lgkmcnt(9)
  ds_read_b64_tr_b16 a[202:203], v247 offset:22528
  ds_read_b64_tr_b16 a[204:205], v247 offset:26624
  v_mfma_f32_16x16x32_bf16 v[144:147], a[176:179], a[96:99], v[144:147]
  ds_read_b64_tr_b16 a[206:207], v247 offset:30720
  ds_read_b64_tr_b16 a[208:209], v244 offset:32768
  v_mfma_f32_16x16x32_bf16 v[144:147], a[180:183], a[104:107], v[144:147]
  buffer_load_dwordx4 a[16:19], v137, s[36:39], s51 offen offset:0 sc1
  ds_read_b64_tr_b16 a[210:211], v244 offset:36864
  v_mfma_f32_16x16x32_bf16 v[148:151], a[180:183], a[108:111], v[148:151]
  ds_read_b64_tr_b16 a[212:213], v244 offset:40960
  v_accvgpr_read_b32 v131, a240
  v_mfma_f32_16x16x32_bf16 v[148:151], a[176:179], a[100:103], v[148:151]
  s_waitcnt lgkmcnt(11)
  ds_read_b64_tr_b16 a[214:215], v244 offset:45056
  v_lshlrev_b32 v80, 16, v131
  v_mfma_f32_16x16x32_bf16 v[156:159], a[184:187], a[100:103], v[156:159]
  ds_read_b64_tr_b16 a[176:177], v245 offset:32768
  v_and_b32 v81, 0xffff0000, v131
  v_mfma_f32_16x16x32_bf16 v[156:159], a[188:191], a[108:111], v[156:159]
  buffer_load_dwordx4 v134, s[24:27], s50 offen offset:1024 lds
  ds_read_b64_tr_b16 a[178:179], v245 offset:36864
  v_mfma_f32_16x16x32_bf16 v[152:155], a[188:191], a[104:107], v[152:155]
  ds_read_b64_tr_b16 a[180:181], v245 offset:40960
  v_accvgpr_read_b32 v131, a241
  v_mfma_f32_16x16x32_bf16 v[152:155], a[184:187], a[96:99], v[152:155]
  s_waitcnt lgkmcnt(11)
  ds_read_b64_tr_b16 a[182:183], v245 offset:45056
  v_lshlrev_b32 v82, 16, v131
  v_mfma_f32_16x16x32_bf16 v[160:163], a[192:195], a[96:99], v[160:163]
  buffer_load_dwordx4 a[20:23], v137, s[36:39], s51 offen offset:1024 sc1
  ds_read_b64_tr_b16 a[184:185], v246 offset:32768
  v_mfma_f32_16x16x32_bf16 v[160:163], a[196:199], a[104:107], v[160:163]
  ds_read_b64_tr_b16 a[186:187], v246 offset:36864
  v_and_b32 v83, 0xffff0000, v131
  v_mfma_f32_16x16x32_bf16 v[164:167], a[196:199], a[108:111], v[164:167]
  ds_read_b64_tr_b16 a[188:189], v246 offset:40960
  v_accvgpr_read_b32 v131, a242
  v_mfma_f32_16x16x32_bf16 v[164:167], a[192:195], a[100:103], v[164:167]
  s_waitcnt lgkmcnt(11)
  ds_read_b64_tr_b16 a[190:191], v246 offset:45056
  v_lshlrev_b32 v84, 16, v131
  v_mfma_f32_16x16x32_bf16 v[172:175], a[200:203], a[100:103], v[172:175]
  buffer_load_dwordx4 v135, s[24:27], s50 offen offset:2048 lds
  s_add_u32 s51, s51, 12288
  v_mfma_f32_16x16x32_bf16 v[172:175], a[204:207], a[108:111], v[172:175]
  ds_read_b64_tr_b16 a[192:193], v247 offset:32768
  ds_read_b64_tr_b16 a[194:195], v247 offset:36864
  v_mfma_f32_16x16x32_bf16 v[168:171], a[204:207], a[104:107], v[168:171]
  ds_read_b64_tr_b16 a[196:197], v247 offset:40960
  v_and_b32 v85, 0xffff0000, v131
  v_mfma_f32_16x16x32_bf16 v[168:171], a[200:203], a[96:99], v[168:171]
  s_waitcnt vmcnt(22) lgkmcnt(11)
  ds_read_b64_tr_b16 a[198:199], v247 offset:45056
  v_accvgpr_read_b32 v131, a243
  v_mfma_f32_16x16x32_bf16 v[32:35], a[208:211], a[112:115], v[32:35]
  buffer_load_dwordx4 a[24:27], v137, s[36:39], s51 offen offset:2048 sc1
  ds_read_b64_tr_b16 a[200:201], v244 offset:34816
  v_mfma_f32_16x16x32_bf16 v[32:35], a[212:215], a[120:123], v[32:35]
  ds_read_b64_tr_b16 a[202:203], v244 offset:38912
  v_lshlrev_b32 v86, 16, v131
  v_mfma_f32_16x16x32_bf16 v[36:39], a[212:215], a[124:127], v[36:39]
  ds_read_b64_tr_b16 a[204:205], v244 offset:43008
  v_and_b32 v87, 0xffff0000, v131
  v_mfma_f32_16x16x32_bf16 v[36:39], a[208:211], a[116:119], v[36:39]
  s_waitcnt lgkmcnt(11)
  ds_read_b64_tr_b16 a[206:207], v244 offset:47104
  v_accvgpr_read_b32 v131, a244
  v_mfma_f32_16x16x32_bf16 v[44:47], a[176:179], a[116:119], v[44:47]
  buffer_load_dwordx4 v136, s[24:27], s50 offen offset:3072 lds
  ds_read_b64_tr_b16 a[208:209], v245 offset:34816
  v_mfma_f32_16x16x32_bf16 v[44:47], a[180:183], a[124:127], v[44:47]
  ds_read_b64_tr_b16 a[210:211], v245 offset:38912
  v_lshlrev_b32 v88, 16, v131
  v_mfma_f32_16x16x32_bf16 v[40:43], a[180:183], a[120:123], v[40:43]
  ds_read_b64_tr_b16 a[212:213], v245 offset:43008
  v_and_b32 v89, 0xffff0000, v131
  v_mfma_f32_16x16x32_bf16 v[40:43], a[176:179], a[112:115], v[40:43]
  s_waitcnt vmcnt(17) lgkmcnt(11)
  s_barrier
  ds_read_b64_tr_b16 a[214:215], v245 offset:47104
  v_mfma_f32_16x16x32_bf16 v[48:51], a[184:187], a[112:115], v[48:51]
  buffer_load_dwordx4 a[28:31], v137, s[36:39], s51 offen offset:3072 sc1
  s_mov_b32 s75, 1
  v_mfma_f32_16x16x32_bf16 v[48:51], a[188:191], a[120:123], v[48:51]
  s_lshl_b32 s50, s75, 16
  s_add_u32 m0, s73, 16384
  ds_read_b64_tr_b16 a[176:177], v246 offset:34816
  v_mfma_f32_16x16x32_bf16 v[52:55], a[188:191], a[124:127], v[52:55]
  ds_read_b64_tr_b16 a[178:179], v246 offset:38912
  ds_read_b64_tr_b16 a[180:181], v246 offset:43008
  v_mfma_f32_16x16x32_bf16 v[52:55], a[184:187], a[116:119], v[52:55]
  s_waitcnt lgkmcnt(11)
  buffer_load_dwordx4 v133, s[24:27], s50 offen offset:0 lds
  ds_read_b64_tr_b16 a[182:183], v246 offset:47104
  v_mfma_f32_16x16x32_bf16 v[60:63], a[192:195], a[116:119], v[60:63]
  s_waitcnt vmcnt(14)
  v_cmp_ne_u32 vcc, 1, v139
  s_nop 4
  s_cbranch_vccnz CK7s
CK7x:
  v_mfma_f32_16x16x32_bf16 v[60:63], a[196:199], a[124:127], v[60:63]
  s_lshl_b32 s51, s75, 11
  ds_read_b64_tr_b16 a[184:185], v247 offset:34816
  ds_read_b64_tr_b16 a[186:187], v247 offset:38912
  v_mfma_f32_16x16x32_bf16 v[56:59], a[196:199], a[120:123], v[56:59]
  ds_read_b64_tr_b16 a[188:189], v247 offset:43008
  v_accvgpr_read_b32 v131, a245
  v_mfma_f32_16x16x32_bf16 v[56:59], a[192:195], a[112:115], v[56:59]
  s_waitcnt lgkmcnt(11)
  buffer_load_dwordx4 a[32:35], v137, s[36:39], s51 offen offset:0 sc1
  ds_read_b64_tr_b16 a[190:191], v247 offset:47104
  v_mfma_f32_16x16x32_bf16 v[144:147], a[200:203], a[112:115], v[144:147]
  ds_read_b64_tr_b16 a[192:193], v244 offset:49152
  v_lshlrev_b32 v90, 16, v131
  v_mfma_f32_16x16x32_bf16 v[144:147], a[204:207], a[120:123], v[144:147]
  ds_read_b64_tr_b16 a[194:195], v244 offset:53248
  v_and_b32 v91, 0xffff0000, v131
  v_mfma_f32_16x16x32_bf16 v[148:151], a[204:207], a[124:127], v[148:151]
  ds_read_b64_tr_b16 a[196:197], v244 offset:57344
  v_accvgpr_read_b32 v131, a246
  v_mfma_f32_16x16x32_bf16 v[148:151], a[200:203], a[116:119], v[148:151]
  s_waitcnt lgkmcnt(11)
  buffer_load_dwordx4 v134, s[24:27], s50 offen offset:1024 lds
  ds_read_b64_tr_b16 a[198:199], v244 offset:61440
  v_mfma_f32_16x16x32_bf16 v[156:159], a[208:211], a[116:119], v[156:159]
  ds_read_b64_tr_b16 a[200:201], v245 offset:49152
  v_lshlrev_b32 v92, 16, v131
  v_mfma_f32_16x16x32_bf16 v[156:159], a[212:215], a[124:127], v[156:159]
  ds_read_b64_tr_b16 a[202:203], v245 offset:53248
  v_and_b32 v93, 0xffff0000, v131
  v_mfma_f32_16x16x32_bf16 v[152:155], a[212:215], a[120:123], v[152:155]
  ds_read_b64_tr_b16 a[204:205], v245 offset:57344
  v_accvgpr_read_b32 v131, a247
  v_mfma_f32_16x16x32_bf16 v[152:155], a[208:211], a[112:115], v[152:155]
  s_waitcnt lgkmcnt(11)
  buffer_load_dwordx4 a[36:39], v137, s[36:39], s51 offen offset:1024 sc1
  ds_read_b64_tr_b16 a[206:207], v245 offset:61440
  v_mfma_f32_16x16x32_bf16 v[160:163], a[176:179], a[112:115], v[160:163]
  ds_read_b64_tr_b16 a[208:209], v246 offset:49152
  v_lshlrev_b32 v94, 16, v131
  v_mfma_f32_16x16x32_bf16 v[160:163], a[180:183], a[120:123], v[160:163]
  ds_read_b64_tr_b16 a[210:211], v246 offset:53248
  v_and_b32 v95, 0xffff0000, v131
  v_mfma_f32_16x16x32_bf16 v[164:167], a[180:183], a[124:127], v[164:167]
  s_add_u32 s49, s72, 32768
  ds_read_b64_tr_b16 a[212:213], v246 offset:57344
  s_lshl_b32 s67, s2, 5
  v_mfma_f32_16x16x32_bf16 v[164:167], a[176:179], a[116:119], v[164:167]
  s_waitcnt lgkmcnt(11)
  buffer_load_dwordx4 v135, s[24:27], s50 offen offset:2048 lds
  ds_read_b64_tr_b16 a[214:215], v246 offset:61440
  v_mfma_f32_16x16x32_bf16 v[172:175], a[184:187], a[116:119], v[172:175]
  s_add_u32 s67, s67, s44
  ds_read_b64_tr_b16 a[176:177], v247 offset:49152
  s_lshl2_add_u32 s67, s67, 5472256
  v_mfma_f32_16x16x32_bf16 v[172:175], a[188:191], a[124:127], v[172:175]
  s_xor_b32 s68, s67, 128
  ds_read_b64_tr_b16 a[178:179], v247 offset:53248
  v_mov_b32 v132, 0
  v_mfma_f32_16x16x32_bf16 v[168:171], a[188:191], a[120:123], v[168:171]
  ds_read_b64_tr_b16 a[180:181], v247 offset:57344
  v_mfma_f32_16x16x32_bf16 v[168:171], a[184:187], a[112:115], v[168:171]
  s_waitcnt vmcnt(22) lgkmcnt(11)
  buffer_load_dwordx4 a[40:43], v137, s[36:39], s51 offen offset:2048 sc1
  ds_read_b64_tr_b16 a[182:183], v247 offset:61440
  v_mfma_f32_16x16x32_bf16 v[32:35], a[192:195], a[216:219], v[32:35]
  ds_read_b64_tr_b16 a[184:185], v244 offset:51200
  v_mfma_f32_16x16x32_bf16 v[32:35], a[196:199], a[224:227], v[32:35]
  ds_read_b64_tr_b16 a[186:187], v244 offset:55296
  v_mfma_f32_16x16x32_bf16 v[36:39], a[196:199], a[228:231], v[36:39]
  buffer_load_dwordx4 v136, s[24:27], s50 offen offset:3072 lds
  ds_read_b64_tr_b16 a[188:189], v244 offset:59392
  v_mfma_f32_16x16x32_bf16 v[36:39], a[192:195], a[220:223], v[36:39]
  s_waitcnt lgkmcnt(11)
  ds_read_b64_tr_b16 a[190:191], v244 offset:63488
  v_mfma_f32_16x16x32_bf16 v[44:47], a[200:203], a[220:223], v[44:47]
  ds_read_b64_tr_b16 a[192:193], v245 offset:51200
  v_mfma_f32_16x16x32_bf16 v[44:47], a[204:207], a[228:231], v[44:47]
  ds_read_b64_tr_b16 a[194:195], v245 offset:55296
  v_mfma_f32_16x16x32_bf16 v[40:43], a[204:207], a[224:227], v[40:43]
  buffer_load_dwordx4 a[44:47], v137, s[36:39], s51 offen offset:3072 sc1
  s_cmp_eq_u32 s83, 1
  v_mfma_f32_16x16x32_bf16 v[40:43], a[200:203], a[216:219], v[40:43]
  s_waitcnt vmcnt(17) lgkmcnt(10)
  s_barrier
  s_cselect_b32 s76, 19, 5
  v_mfma_f32_16x16x32_bf16 v[48:51], a[208:211], a[216:219], v[48:51]
  s_lshl_b32 s50, s76, 16
  s_add_u32 m0, s73, 32768
  ds_read_b64_tr_b16 a[196:197], v245 offset:59392
  v_mfma_f32_16x16x32_bf16 v[48:51], a[212:215], a[224:227], v[48:51]
  ds_read_b64_tr_b16 a[198:199], v245 offset:63488
  ds_read_b64_tr_b16 a[200:201], v246 offset:51200
  v_mfma_f32_16x16x32_bf16 v[52:55], a[212:215], a[228:231], v[52:55]
  ds_read_b64_tr_b16 a[202:203], v246 offset:55296
  buffer_load_dwordx4 v133, s[24:27], s50 offen offset:0 lds
  v_mfma_f32_16x16x32_bf16 v[52:55], a[208:211], a[220:223], v[52:55]
  s_waitcnt lgkmcnt(10)
  s_lshl_b32 s51, s76, 11
  ds_read_b64_tr_b16 a[204:205], v246 offset:59392
  v_mfma_f32_16x16x32_bf16 v[60:63], a[176:179], a[220:223], v[60:63]
  ds_read_b64_tr_b16 a[206:207], v246 offset:63488
  ds_read_b64_tr_b16 a[208:209], v247 offset:51200
  v_mfma_f32_16x16x32_bf16 v[60:63], a[180:183], a[228:231], v[60:63]
  ds_read_b64_tr_b16 a[210:211], v247 offset:55296
  v_mfma_f32_16x16x32_bf16 v[56:59], a[180:183], a[224:227], v[56:59]
  buffer_load_dwordx4 a[48:51], v137, s[36:39], s51 offen offset:0 sc1
  ds_read_b64_tr_b16 a[212:213], v247 offset:59392
  v_mfma_f32_16x16x32_bf16 v[56:59], a[176:179], a[216:219], v[56:59]
  s_waitcnt lgkmcnt(11)
  ds_read_b64_tr_b16 a[214:215], v247 offset:63488
  v_mfma_f32_16x16x32_bf16 v[144:147], a[184:187], a[216:219], v[144:147]
  ds_read_b64_tr_b16 a[176:177], v248 offset:0
  v_mfma_f32_16x16x32_bf16 v[144:147], a[188:191], a[224:227], v[144:147]
  ds_read_b64_tr_b16 a[178:179], v248 offset:4096
  v_mfma_f32_16x16x32_bf16 v[148:151], a[188:191], a[228:231], v[148:151]
  buffer_load_dwordx4 v134, s[24:27], s50 offen offset:1024 lds
  ds_read_b64_tr_b16 a[180:181], v248 offset:8192
  v_mfma_f32_16x16x32_bf16 v[148:151], a[184:187], a[220:223], v[148:151]
  s_waitcnt lgkmcnt(11)
  ds_read_b64_tr_b16 a[182:183], v248 offset:12288
  v_mfma_f32_16x16x32_bf16 v[156:159], a[192:195], a[220:223], v[156:159]
  ds_read_b64_tr_b16 a[184:185], v249 offset:0
  v_mfma_f32_16x16x32_bf16 v[156:159], a[196:199], a[228:231], v[156:159]
  buffer_load_dwordx4 a[52:55], v137, s[36:39], s51 offen offset:1024 sc1
  ds_read_b64_tr_b16 a[186:187], v249 offset:4096
  v_mfma_f32_16x16x32_bf16 v[152:155], a[196:199], a[224:227], v[152:155]
  ds_read_b64_tr_b16 a[188:189], v249 offset:8192
  v_mfma_f32_16x16x32_bf16 v[152:155], a[192:195], a[216:219], v[152:155]
  s_waitcnt lgkmcnt(11)
  ds_read_b64_tr_b16 a[190:191], v249 offset:12288
  v_mfma_f32_16x16x32_bf16 v[160:163], a[200:203], a[216:219], v[160:163]
  ds_read_b64_tr_b16 a[192:193], v250 offset:0
  v_mfma_f32_16x16x32_bf16 v[160:163], a[204:207], a[224:227], v[160:163]
  buffer_load_dwordx4 v135, s[24:27], s50 offen offset:2048 lds
  ds_read_b64_tr_b16 a[194:195], v250 offset:4096
  v_mfma_f32_16x16x32_bf16 v[164:167], a[204:207], a[228:231], v[164:167]
  ds_read_b64_tr_b16 a[196:197], v250 offset:8192
  v_mfma_f32_16x16x32_bf16 v[164:167], a[200:203], a[220:223], v[164:167]
  s_waitcnt lgkmcnt(11)
  ds_read_b64_tr_b16 a[198:199], v250 offset:12288
  v_mfma_f32_16x16x32_bf16 v[172:175], a[208:211], a[220:223], v[172:175]
  ds_read_b64_tr_b16 a[200:201], v251 offset:0
  v_mfma_f32_16x16x32_bf16 v[172:175], a[212:215], a[228:231], v[172:175]
  buffer_load_dwordx4 a[56:59], v137, s[36:39], s51 offen offset:2048 sc1
  ds_read_b64_tr_b16 a[202:203], v251 offset:4096
  v_mfma_f32_16x16x32_bf16 v[168:171], a[212:215], a[224:227], v[168:171]
  ds_read_b64_tr_b16 a[204:205], v251 offset:8192
  v_mfma_f32_16x16x32_bf16 v[168:171], a[208:211], a[216:219], v[168:171]
  s_waitcnt vmcnt(22) lgkmcnt(11)
  ds_read_b64_tr_b16 a[206:207], v251 offset:12288
  v_mfma_f32_16x16x32_bf16 v[32:35], a[176:179], a[0:3], v[32:35]
  ds_read_b64_tr_b16 a[208:209], v248 offset:2048
  v_mfma_f32_16x16x32_bf16 v[32:35], a[180:183], a[8:11], v[32:35]
  buffer_load_dwordx4 v136, s[24:27], s50 offen offset:3072 lds
  ds_read_b64_tr_b16 a[210:211], v248 offset:6144
  v_mfma_f32_16x16x32_bf16 v[36:39], a[180:183], a[12:15], v[36:39]
  ds_read_b64_tr_b16 a[212:213], v248 offset:10240
  v_mfma_f32_16x16x32_bf16 v[36:39], a[176:179], a[4:7], v[36:39]
  s_waitcnt lgkmcnt(11)
  ds_read_b64_tr_b16 a[214:215], v248 offset:14336
  v_mfma_f32_16x16x32_bf16 v[44:47], a[184:187], a[4:7], v[44:47]
  ds_read_b64_tr_b16 a[176:177], v249 offset:2048
  v_mfma_f32_16x16x32_bf16 v[44:47], a[188:191], a[12:15], v[44:47]
  buffer_load_dwordx4 a[60:63], v137, s[36:39], s51 offen offset:3072 sc1
  s_cmp_eq_u32 s83, 2
  v_mfma_f32_16x16x32_bf16 v[40:43], a[188:191], a[8:11], v[40:43]
  s_cselect_b32 s77, 22, 8
  s_lshl_b32 s50, s77, 16
  s_add_u32 m0, s73, 49152
  v_mfma_f32_16x16x32_bf16 v[40:43], a[184:187], a[0:3], v[40:43]
  s_waitcnt vmcnt(17) lgkmcnt(9)
  s_barrier
  ds_read_b64_tr_b16 a[178:179], v249 offset:6144
  v_mfma_f32_16x16x32_bf16 v[48:51], a[192:195], a[0:3], v[48:51]
  ds_read_b64_tr_b16 a[180:181], v249 offset:10240
  ds_read_b64_tr_b16 a[182:183], v249 offset:14336
  v_mfma_f32_16x16x32_bf16 v[48:51], a[196:199], a[8:11], v[48:51]
  buffer_load_dwordx4 v133, s[24:27], s50 offen offset:0 lds
  s_lshl_b32 s51, s77, 11
  v_mfma_f32_16x16x32_bf16 v[52:55], a[196:199], a[12:15], v[52:55]
  ds_read_b64_tr_b16 a[184:185], v250 offset:2048
  ds_read_b64_tr_b16 a[186:187], v250 offset:6144
  v_mfma_f32_16x16x32_bf16 v[52:55], a[192:195], a[4:7], v[52:55]
  s_waitcnt lgkmcnt(10)
  ds_read_b64_tr_b16 a[188:189], v250 offset:10240
  ds_read_b64_tr_b16 a[190:191], v250 offset:14336
  v_mfma_f32_16x16x32_bf16 v[60:63], a[200:203], a[4:7], v[60:63]
  buffer_load_dwordx4 a[64:67], v137, s[36:39], s51 offen offset:0 sc1
  ds_read_b64_tr_b16 a[192:193], v251 offset:2048
  v_mfma_f32_16x16x32_bf16 v[60:63], a[204:207], a[12:15], v[60:63]
  ds_read_b64_tr_b16 a[194:195], v251 offset:6144
  v_mfma_f32_16x16x32_bf16 v[56:59], a[204:207], a[8:11], v[56:59]
  ds_read_b64_tr_b16 a[196:197], v251 offset:10240
  v_mfma_f32_16x16x32_bf16 v[56:59], a[200:203], a[0:3], v[56:59]
  s_waitcnt lgkmcnt(11)
  ds_read_b64_tr_b16 a[198:199], v251 offset:14336
  v_mfma_f32_16x16x32_bf16 v[144:147], a[208:211], a[0:3], v[144:147]
  buffer_load_dwordx4 v134, s[24:27], s50 offen offset:1024 lds
  ds_read_b64_tr_b16 a[200:201], v240 offset:0
  v_mfma_f32_16x16x32_bf16 v[144:147], a[212:215], a[8:11], v[144:147]
  ds_read_b64_tr_b16 a[202:203], v240 offset:4096
  v_mfma_f32_16x16x32_bf16 v[148:151], a[212:215], a[12:15], v[148:151]
  ds_read_b64_tr_b16 a[204:205], v240 offset:8192
  v_mfma_f32_16x16x32_bf16 v[148:151], a[208:211], a[4:7], v[148:151]
  s_waitcnt lgkmcnt(11)
  ds_read_b64_tr_b16 a[206:207], v240 offset:12288
  v_mfma_f32_16x16x32_bf16 v[156:159], a[176:179], a[4:7], v[156:159]
  buffer_load_dwordx4 a[68:71], v137, s[36:39], s51 offen offset:1024 sc1
  ds_read_b64_tr_b16 a[208:209], v241 offset:0
  v_mfma_f32_16x16x32_bf16 v[156:159], a[180:183], a[12:15], v[156:159]
  ds_read_b64_tr_b16 a[210:211], v241 offset:4096
  v_mfma_f32_16x16x32_bf16 v[152:155], a[180:183], a[8:11], v[152:155]
  ds_read_b64_tr_b16 a[212:213], v241 offset:8192
  v_mfma_f32_16x16x32_bf16 v[152:155], a[176:179], a[0:3], v[152:155]
  s_waitcnt lgkmcnt(11)
  ds_read_b64_tr_b16 a[214:215], v241 offset:12288
  v_mfma_f32_16x16x32_bf16 v[160:163], a[184:187], a[0:3], v[160:163]
  buffer_load_dwordx4 v135, s[24:27], s50 offen offset:2048 lds
  ds_read_b64_tr_b16 a[176:177], v242 offset:0
  v_mfma_f32_16x16x32_bf16 v[160:163], a[188:191], a[8:11], v[160:163]
  ds_read_b64_tr_b16 a[178:179], v242 offset:4096
  v_mfma_f32_16x16x32_bf16 v[164:167], a[188:191], a[12:15], v[164:167]
  ds_read_b64_tr_b16 a[180:181], v242 offset:8192
  v_mfma_f32_16x16x32_bf16 v[164:167], a[184:187], a[4:7], v[164:167]
  s_waitcnt lgkmcnt(11)
  buffer_load_dwordx4 a[72:75], v137, s[36:39], s51 offen offset:2048 sc1
  ds_read_b64_tr_b16 a[182:183], v242 offset:12288
  v_mfma_f32_16x16x32_bf16 v[172:175], a[192:195], a[4:7], v[172:175]
  ds_read_b64_tr_b16 a[184:185], v243 offset:0
  v_mfma_f32_16x16x32_bf16 v[172:175], a[196:199], a[12:15], v[172:175]
  ds_read_b64_tr_b16 a[186:187], v243 offset:4096
  v_mfma_f32_16x16x32_bf16 v[168:171], a[196:199], a[8:11], v[168:171]
  ds_read_b64_tr_b16 a[188:189], v243 offset:8192
  v_mfma_f32_16x16x32_bf16 v[168:171], a[192:195], a[0:3], v[168:171]
  s_waitcnt vmcnt(22) lgkmcnt(11)
  buffer_load_dwordx4 v136, s[24:27], s50 offen offset:3072 lds
  ds_read_b64_tr_b16 a[190:191], v243 offset:12288
  v_mfma_f32_16x16x32_bf16 v[32:35], a[200:203], a[16:19], v[32:35]
  ds_read_b64_tr_b16 a[192:193], v240 offset:2048
  v_mfma_f32_16x16x32_bf16 v[32:35], a[204:207], a[24:27], v[32:35]
  ds_read_b64_tr_b16 a[194:195], v240 offset:6144
  v_mfma_f32_16x16x32_bf16 v[36:39], a[204:207], a[28:31], v[36:39]
  ds_read_b64_tr_b16 a[196:197], v240 offset:10240
  v_mfma_f32_16x16x32_bf16 v[36:39], a[200:203], a[20:23], v[36:39]
  s_waitcnt lgkmcnt(11)
  buffer_load_dwordx4 a[76:79], v137, s[36:39], s51 offen offset:3072 sc1
  s_cmp_eq_u32 s83, 3
  v_mfma_f32_16x16x32_bf16 v[44:47], a[208:211], a[20:23], v[44:47]
  s_cselect_b32 s78, 26, 12
  s_lshl_b32 s50, s78, 16
  s_add_u32 m0, s73, 65536
  v_mfma_f32_16x16x32_bf16 v[44:47], a[212:215], a[28:31], v[44:47]
  ds_read_b64_tr_b16 a[198:199], v240 offset:14336
  ds_read_b64_tr_b16 a[200:201], v241 offset:2048
  v_mfma_f32_16x16x32_bf16 v[40:43], a[212:215], a[24:27], v[40:43]
  ds_read_b64_tr_b16 a[202:203], v241 offset:6144
  ds_read_b64_tr_b16 a[204:205], v241 offset:10240
  v_mfma_f32_16x16x32_bf16 v[40:43], a[208:211], a[16:19], v[40:43]
  s_waitcnt vmcnt(17) lgkmcnt(11)
  s_barrier
  buffer_load_dwordx4 v133, s[24:27], s50 offen offset:0 lds
  v_mfma_f32_16x16x32_bf16 v[48:51], a[176:179], a[16:19], v[48:51]
  s_lshl_b32 s51, s78, 11
  ds_read_b64_tr_b16 a[206:207], v241 offset:14336
  ds_read_b64_tr_b16 a[208:209], v242 offset:2048
  v_mfma_f32_16x16x32_bf16 v[48:51], a[180:183], a[24:27], v[48:51]
  ds_read_b64_tr_b16 a[210:211], v242 offset:6144
  v_mfma_f32_16x16x32_bf16 v[52:55], a[180:183], a[28:31], v[52:55]
  ds_read_b64_tr_b16 a[212:213], v242 offset:10240
  v_mfma_f32_16x16x32_bf16 v[52:55], a[176:179], a[20:23], v[52:55]
  s_waitcnt lgkmcnt(11)
  buffer_load_dwordx4 a[80:83], v137, s[36:39], s51 offen offset:0 sc1
  ds_read_b64_tr_b16 a[214:215], v242 offset:14336
  v_mfma_f32_16x16x32_bf16 v[60:63], a[184:187], a[20:23], v[60:63]
  ds_read_b64_tr_b16 a[176:177], v243 offset:2048
  v_mfma_f32_16x16x32_bf16 v[60:63], a[188:191], a[28:31], v[60:63]
  ds_read_b64_tr_b16 a[178:179], v243 offset:6144
  v_mfma_f32_16x16x32_bf16 v[56:59], a[188:191], a[24:27], v[56:59]
  buffer_load_dwordx4 v134, s[24:27], s50 offen offset:1024 lds
  ds_read_b64_tr_b16 a[180:181], v243 offset:10240
  v_mfma_f32_16x16x32_bf16 v[56:59], a[184:187], a[16:19], v[56:59]
  s_waitcnt lgkmcnt(11)
  ds_read_b64_tr_b16 a[182:183], v243 offset:14336
  v_mfma_f32_16x16x32_bf16 v[144:147], a[192:195], a[16:19], v[144:147]
  ds_read_b64_tr_b16 a[184:185], v240 offset:16384
  v_mfma_f32_16x16x32_bf16 v[144:147], a[196:199], a[24:27], v[144:147]
  ds_read_b64_tr_b16 a[186:187], v240 offset:20480
  v_mfma_f32_16x16x32_bf16 v[148:151], a[196:199], a[28:31], v[148:151]
  buffer_load_dwordx4 a[84:87], v137, s[36:39], s51 offen offset:1024 sc1
  ds_read_b64_tr_b16 a[188:189], v240 offset:24576
  v_mfma_f32_16x16x32_bf16 v[148:151], a[192:195], a[20:23], v[148:151]
  s_waitcnt lgkmcnt(11)
  ds_read_b64_tr_b16 a[190:191], v240 offset:28672
  v_mfma_f32_16x16x32_bf16 v[156:159], a[200:203], a[20:23], v[156:159]
  ds_read_b64_tr_b16 a[192:193], v241 offset:16384
  v_mfma_f32_16x16x32_bf16 v[156:159], a[204:207], a[28:31], v[156:159]
  ds_read_b64_tr_b16 a[194:195], v241 offset:20480
  v_mfma_f32_16x16x32_bf16 v[152:155], a[204:207], a[24:27], v[152:155]
  buffer_load_dwordx4 v135, s[24:27], s50 offen offset:2048 lds
  ds_read_b64_tr_b16 a[196:197], v241 offset:24576
  v_mfma_f32_16x16x32_bf16 v[152:155], a[200:203], a[16:19], v[152:155]
  s_waitcnt lgkmcnt(11)
  ds_read_b64_tr_b16 a[198:199], v241 offset:28672
  v_mfma_f32_16x16x32_bf16 v[160:163], a[208:211], a[16:19], v[160:163]
  ds_read_b64_tr_b16 a[200:201], v242 offset:16384
  v_mfma_f32_16x16x32_bf16 v[160:163], a[212:215], a[24:27], v[160:163]
  ds_read_b64_tr_b16 a[202:203], v242 offset:20480
  v_mfma_f32_16x16x32_bf16 v[164:167], a[212:215], a[28:31], v[164:167]
  buffer_load_dwordx4 a[88:91], v137, s[36:39], s51 offen offset:2048 sc1
  ds_read_b64_tr_b16 a[204:205], v242 offset:24576
  v_mfma_f32_16x16x32_bf16 v[164:167], a[208:211], a[20:23], v[164:167]
  s_waitcnt lgkmcnt(11)
  ds_read_b64_tr_b16 a[206:207], v242 offset:28672
  v_mfma_f32_16x16x32_bf16 v[172:175], a[176:179], a[20:23], v[172:175]
  ds_read_b64_tr_b16 a[208:209], v243 offset:16384
  v_mfma_f32_16x16x32_bf16 v[172:175], a[180:183], a[28:31], v[172:175]
Hb0_3:
  s_cbranch_execz Rb
  ds_read_b64_tr_b16 a[210:211], v243 offset:20480
  v_mfma_f32_16x16x32_bf16 v[168:171], a[180:183], a[24:27], v[168:171]
  buffer_load_dwordx4 v136, s[24:27], s50 offen offset:3072 lds
  ds_read_b64_tr_b16 a[212:213], v243 offset:24576
  v_mfma_f32_16x16x32_bf16 v[168:171], a[176:179], a[16:19], v[168:171]
  s_waitcnt vmcnt(23) lgkmcnt(11)
  ds_read_b64_tr_b16 a[214:215], v243 offset:28672
  v_mfma_f32_16x16x32_bf16 v[32:35], a[184:187], a[32:35], v[32:35]
  ds_read_b64_tr_b16 a[176:177], v240 offset:18432
  v_mfma_f32_16x16x32_bf16 v[32:35], a[188:191], a[40:43], v[32:35]
  buffer_load_dwordx4 a[92:95], v137, s[36:39], s51 offen offset:3072 sc1
  s_cmp_eq_u32 s83, 0
  v_mfma_f32_16x16x32_bf16 v[36:39], a[188:191], a[44:47], v[36:39]
  s_cselect_b32 s79, 29, 15
  s_lshl_b32 s50, s79, 16
  s_add_u32 m0, s73, 81920
  v_mfma_f32_16x16x32_bf16 v[36:39], a[184:187], a[36:39], v[36:39]
  s_waitcnt lgkmcnt(9)
  ds_read_b64_tr_b16 a[178:179], v240 offset:22528
  ds_read_b64_tr_b16 a[180:181], v240 offset:26624
  v_mfma_f32_16x16x32_bf16 v[44:47], a[192:195], a[36:39], v[44:47]
  ds_read_b64_tr_b16 a[182:183], v240 offset:30720
  ds_read_b64_tr_b16 a[184:185], v241 offset:18432
  v_mfma_f32_16x16x32_bf16 v[44:47], a[196:199], a[44:47], v[44:47]
  buffer_load_dwordx4 v133, s[24:27], s50 offen offset:0 lds
  s_lshl_b32 s51, s79, 11
  v_mfma_f32_16x16x32_bf16 v[40:43], a[196:199], a[40:43], v[40:43]
  ds_read_b64_tr_b16 a[186:187], v241 offset:22528
  ds_read_b64_tr_b16 a[188:189], v241 offset:26624
  v_mfma_f32_16x16x32_bf16 v[40:43], a[192:195], a[32:35], v[40:43]
  s_waitcnt vmcnt(18) lgkmcnt(11)
  s_barrier
  ds_read_b64_tr_b16 a[190:191], v241 offset:30720
  v_mfma_f32_16x16x32_bf16 v[48:51], a[200:203], a[32:35], v[48:51]
  ds_read_b64_tr_b16 a[192:193], v242 offset:18432
  v_mfma_f32_16x16x32_bf16 v[48:51], a[204:207], a[40:43], v[48:51]
  buffer_load_dwordx4 a[96:99], v137, s[36:39], s51 offen offset:0 sc1
  ds_read_b64_tr_b16 a[194:195], v242 offset:22528
  v_mfma_f32_16x16x32_bf16 v[52:55], a[204:207], a[44:47], v[52:55]
  ds_read_b64_tr_b16 a[196:197], v242 offset:26624
  v_mfma_f32_16x16x32_bf16 v[52:55], a[200:203], a[36:39], v[52:55]
  s_waitcnt lgkmcnt(11)
  ds_read_b64_tr_b16 a[198:199], v242 offset:30720
  v_mfma_f32_16x16x32_bf16 v[60:63], a[208:211], a[36:39], v[60:63]
  ds_read_b64_tr_b16 a[200:201], v243 offset:18432
  v_mfma_f32_16x16x32_bf16 v[60:63], a[212:215], a[44:47], v[60:63]
  buffer_load_dwordx4 v134, s[24:27], s50 offen offset:1024 lds
  ds_read_b64_tr_b16 a[202:203], v243 offset:22528
  v_mfma_f32_16x16x32_bf16 v[56:59], a[212:215], a[40:43], v[56:59]
  ds_read_b64_tr_b16 a[204:205], v243 offset:26624
  v_mfma_f32_16x16x32_bf16 v[56:59], a[208:211], a[32:35], v[56:59]
  s_waitcnt lgkmcnt(11)
  ds_read_b64_tr_b16 a[206:207], v243 offset:30720
  v_mfma_f32_16x16x32_bf16 v[144:147], a[176:179], a[32:35], v[144:147]
  ds_read_b64_tr_b16 a[208:209], v240 offset:32768
  v_mfma_f32_16x16x32_bf16 v[144:147], a[180:183], a[40:43], v[144:147]
  buffer_load_dwordx4 a[100:103], v137, s[36:39], s51 offen offset:1024 sc1
  ds_read_b64_tr_b16 a[210:211], v240 offset:36864
  v_mfma_f32_16x16x32_bf16 v[148:151], a[180:183], a[44:47], v[148:151]
  ds_read_b64_tr_b16 a[212:213], v240 offset:40960
  v_mfma_f32_16x16x32_bf16 v[148:151], a[176:179], a[36:39], v[148:151]
  s_waitcnt lgkmcnt(11)
  ds_read_b64_tr_b16 a[214:215], v240 offset:45056
  v_mfma_f32_16x16x32_bf16 v[156:159], a[184:187], a[36:39], v[156:159]
  buffer_load_dwordx4 v135, s[24:27], s50 offen offset:2048 lds
  ds_read_b64_tr_b16 a[176:177], v241 offset:32768
  v_mfma_f32_16x16x32_bf16 v[156:159], a[188:191], a[44:47], v[156:159]
  ds_read_b64_tr_b16 a[178:179], v241 offset:36864
  v_mfma_f32_16x16x32_bf16 v[152:155], a[188:191], a[40:43], v[152:155]
  ds_read_b64_tr_b16 a[180:181], v241 offset:40960
  v_mfma_f32_16x16x32_bf16 v[152:155], a[184:187], a[32:35], v[152:155]
  s_waitcnt lgkmcnt(11)
  ds_read_b64_tr_b16 a[182:183], v241 offset:45056
  v_mfma_f32_16x16x32_bf16 v[160:163], a[192:195], a[32:35], v[160:163]
  buffer_load_dwordx4 a[104:107], v137, s[36:39], s51 offen offset:2048 sc1
  ds_read_b64_tr_b16 a[184:185], v242 offset:32768
  v_mfma_f32_16x16x32_bf16 v[160:163], a[196:199], a[40:43], v[160:163]
  ds_read_b64_tr_b16 a[186:187], v242 offset:36864
  v_mfma_f32_16x16x32_bf16 v[164:167], a[196:199], a[44:47], v[164:167]
  ds_read_b64_tr_b16 a[188:189], v242 offset:40960
  v_mfma_f32_16x16x32_bf16 v[164:167], a[192:195], a[36:39], v[164:167]
  s_waitcnt lgkmcnt(11)
  ds_read_b64_tr_b16 a[190:191], v242 offset:45056
  v_mfma_f32_16x16x32_bf16 v[172:175], a[200:203], a[36:39], v[172:175]
  buffer_load_dwordx4 v136, s[24:27], s50 offen offset:3072 lds
  ds_read_b64_tr_b16 a[192:193], v243 offset:32768
  v_mfma_f32_16x16x32_bf16 v[172:175], a[204:207], a[44:47], v[172:175]
  ds_read_b64_tr_b16 a[194:195], v243 offset:36864
  v_mfma_f32_16x16x32_bf16 v[168:171], a[204:207], a[40:43], v[168:171]
  ds_read_b64_tr_b16 a[196:197], v243 offset:40960
  v_mfma_f32_16x16x32_bf16 v[168:171], a[200:203], a[32:35], v[168:171]
  s_waitcnt vmcnt(23) lgkmcnt(11)
  ds_read_b64_tr_b16 a[198:199], v243 offset:45056
  v_mfma_f32_16x16x32_bf16 v[32:35], a[208:211], a[48:51], v[32:35]
  buffer_load_dwordx4 a[108:111], v137, s[36:39], s51 offen offset:3072 sc1
  s_cmp_eq_u32 s83, 1
  v_mfma_f32_16x16x32_bf16 v[32:35], a[212:215], a[56:59], v[32:35]
  s_cselect_b32 s80, 33, 19
  s_lshl_b32 s50, s80, 16
  s_add_u32 m0, s73, 98304
  v_mfma_f32_16x16x32_bf16 v[36:39], a[212:215], a[60:63], v[36:39]
  ds_read_b64_tr_b16 a[200:201], v240 offset:34816
  ds_read_b64_tr_b16 a[202:203], v240 offset:38912
  v_mfma_f32_16x16x32_bf16 v[36:39], a[208:211], a[52:55], v[36:39]
  s_waitcnt lgkmcnt(10)
  ds_read_b64_tr_b16 a[204:205], v240 offset:43008
  ds_read_b64_tr_b16 a[206:207], v240 offset:47104
  v_mfma_f32_16x16x32_bf16 v[44:47], a[176:179], a[52:55], v[44:47]
  buffer_load_dwordx4 v133, s[24:27], s50 offen offset:0 lds
  s_lshl_b32 s51, s80, 11
  v_mfma_f32_16x16x32_bf16 v[44:47], a[180:183], a[60:63], v[44:47]
  ds_read_b64_tr_b16 a[208:209], v241 offset:34816
  ds_read_b64_tr_b16 a[210:211], v241 offset:38912
  v_mfma_f32_16x16x32_bf16 v[40:43], a[180:183], a[56:59], v[40:43]
  ds_read_b64_tr_b16 a[212:213], v241 offset:43008
  v_mfma_f32_16x16x32_bf16 v[40:43], a[176:179], a[48:51], v[40:43]
  s_waitcnt vmcnt(18) lgkmcnt(11)
  s_barrier
  ds_read_b64_tr_b16 a[214:215], v241 offset:47104
  v_mfma_f32_16x16x32_bf16 v[48:51], a[184:187], a[48:51], v[48:51]
  buffer_load_dwordx4 a[112:115], v137, s[36:39], s51 offen offset:0 sc1
  ds_read_b64_tr_b16 a[176:177], v242 offset:34816
  v_mfma_f32_16x16x32_bf16 v[48:51], a[188:191], a[56:59], v[48:51]
  ds_read_b64_tr_b16 a[178:179], v242 offset:38912
  v_mfma_f32_16x16x32_bf16 v[52:55], a[188:191], a[60:63], v[52:55]
  ds_read_b64_tr_b16 a[180:181], v242 offset:43008
  v_mfma_f32_16x16x32_bf16 v[52:55], a[184:187], a[52:55], v[52:55]
  s_waitcnt lgkmcnt(11)
  buffer_load_dwordx4 v134, s[24:27], s50 offen offset:1024 lds
  ds_read_b64_tr_b16 a[182:183], v242 offset:47104
  v_mfma_f32_16x16x32_bf16 v[60:63], a[192:195], a[52:55], v[60:63]
  ds_read_b64_tr_b16 a[184:185], v243 offset:34816
  v_mfma_f32_16x16x32_bf16 v[60:63], a[196:199], a[60:63], v[60:63]
  ds_read_b64_tr_b16 a[186:187], v243 offset:38912
  v_mfma_f32_16x16x32_bf16 v[56:59], a[196:199], a[56:59], v[56:59]
  ds_read_b64_tr_b16 a[188:189], v243 offset:43008
  v_mfma_f32_16x16x32_bf16 v[56:59], a[192:195], a[48:51], v[56:59]
  s_waitcnt lgkmcnt(11)
  buffer_load_dwordx4 a[116:119], v137, s[36:39], s51 offen offset:1024 sc1
  ds_read_b64_tr_b16 a[190:191], v243 offset:47104
  v_mfma_f32_16x16x32_bf16 v[144:147], a[200:203], a[48:51], v[144:147]
  ds_read_b64_tr_b16 a[192:193], v240 offset:49152
  v_mfma_f32_16x16x32_bf16 v[144:147], a[204:207], a[56:59], v[144:147]
  ds_read_b64_tr_b16 a[194:195], v240 offset:53248
  v_mfma_f32_16x16x32_bf16 v[148:151], a[204:207], a[60:63], v[148:151]
  ds_read_b64_tr_b16 a[196:197], v240 offset:57344
  v_mfma_f32_16x16x32_bf16 v[148:151], a[200:203], a[52:55], v[148:151]
  s_waitcnt lgkmcnt(11)
  buffer_load_dwordx4 v135, s[24:27], s50 offen offset:2048 lds
  ds_read_b64_tr_b16 a[198:199], v240 offset:61440
  v_mfma_f32_16x16x32_bf16 v[156:159], a[208:211], a[52:55], v[156:159]
  ds_read_b64_tr_b16 a[200:201], v241 offset:49152
  v_mfma_f32_16x16x32_bf16 v[156:159], a[212:215], a[60:63], v[156:159]
  ds_read_b64_tr_b16 a[202:203], v241 offset:53248
  v_mfma_f32_16x16x32_bf16 v[152:155], a[212:215], a[56:59], v[152:155]
  ds_read_b64_tr_b16 a[204:205], v241 offset:57344
  v_mfma_f32_16x16x32_bf16 v[152:155], a[208:211], a[48:51], v[152:155]
  s_waitcnt lgkmcnt(11)
  buffer_load_dwordx4 a[120:123], v137, s[36:39], s51 offen offset:2048 sc1
  ds_read_b64_tr_b16 a[206:207], v241 offset:61440
  v_mfma_f32_16x16x32_bf16 v[160:163], a[176:179], a[48:51], v[160:163]
  ds_read_b64_tr_b16 a[208:209], v242 offset:49152
  v_mfma_f32_16x16x32_bf16 v[160:163], a[180:183], a[56:59], v[160:163]
  ds_read_b64_tr_b16 a[210:211], v242 offset:53248
  v_mfma_f32_16x16x32_bf16 v[164:167], a[180:183], a[60:63], v[164:167]
  ds_read_b64_tr_b16 a[212:213], v242 offset:57344
  v_mfma_f32_16x16x32_bf16 v[164:167], a[176:179], a[52:55], v[164:167]
  s_waitcnt lgkmcnt(11)
  buffer_load_dwordx4 v136, s[24:27], s50 offen offset:3072 lds
  ds_read_b64_tr_b16 a[214:215], v242 offset:61440
  v_mfma_f32_16x16x32_bf16 v[172:175], a[184:187], a[52:55], v[172:175]
  ds_read_b64_tr_b16 a[176:177], v243 offset:49152
  v_mfma_f32_16x16x32_bf16 v[172:175], a[188:191], a[60:63], v[172:175]
  ds_read_b64_tr_b16 a[178:179], v243 offset:53248
  v_mfma_f32_16x16x32_bf16 v[168:171], a[188:191], a[56:59], v[168:171]
  buffer_load_dwordx4 a[124:127], v137, s[36:39], s51 offen offset:3072 sc1
  s_cmp_eq_u32 s83, 2
  v_mfma_f32_16x16x32_bf16 v[168:171], a[184:187], a[48:51], v[168:171]
  s_waitcnt vmcnt(24) lgkmcnt(10)
  s_cselect_b32 s81, 36, 22
  s_lshl_b32 s50, s81, 16
  v_mfma_f32_16x16x32_bf16 v[32:35], a[192:195], a[64:67], v[32:35]
  s_add_u32 m0, s73, 114688
  ds_read_b64_tr_b16 a[180:181], v243 offset:57344
  ds_read_b64_tr_b16 a[182:183], v243 offset:61440
  v_mfma_f32_16x16x32_bf16 v[32:35], a[196:199], a[72:75], v[32:35]
  ds_read_b64_tr_b16 a[184:185], v240 offset:51200
  ds_read_b64_tr_b16 a[186:187], v240 offset:55296
  v_mfma_f32_16x16x32_bf16 v[36:39], a[196:199], a[76:79], v[36:39]
  buffer_load_dwordx4 v133, s[24:27], s50 offen offset:0 lds
  s_lshl_b32 s51, s81, 11
  v_mfma_f32_16x16x32_bf16 v[36:39], a[192:195], a[68:71], v[36:39]
  s_waitcnt lgkmcnt(10)
  ds_read_b64_tr_b16 a[188:189], v240 offset:59392
  ds_read_b64_tr_b16 a[190:191], v240 offset:63488
  v_mfma_f32_16x16x32_bf16 v[44:47], a[200:203], a[68:71], v[44:47]
  ds_read_b64_tr_b16 a[192:193], v241 offset:51200
  v_mfma_f32_16x16x32_bf16 v[44:47], a[204:207], a[76:79], v[44:47]
  ds_read_b64_tr_b16 a[194:195], v241 offset:55296
  v_mfma_f32_16x16x32_bf16 v[40:43], a[204:207], a[72:75], v[40:43]
  buffer_load_dwordx4 a[216:219], v137, s[36:39], s51 offen offset:0 sc1
  ds_read_b64_tr_b16 a[196:197], v241 offset:59392
  v_mfma_f32_16x16x32_bf16 v[40:43], a[200:203], a[64:67], v[40:43]
  s_waitcnt vmcnt(19) lgkmcnt(11)
  s_barrier
  ds_read_b64_tr_b16 a[198:199], v241 offset:63488
  v_mfma_f32_16x16x32_bf16 v[48:51], a[208:211], a[64:67], v[48:51]
  ds_read_b64_tr_b16 a[200:201], v242 offset:51200
  v_mfma_f32_16x16x32_bf16 v[48:51], a[212:215], a[72:75], v[48:51]
  ds_read_b64_tr_b16 a[202:203], v242 offset:55296
  v_mfma_f32_16x16x32_bf16 v[52:55], a[212:215], a[76:79], v[52:55]
  buffer_load_dwordx4 v134, s[24:27], s50 offen offset:1024 lds
  ds_read_b64_tr_b16 a[204:205], v242 offset:59392
  v_mfma_f32_16x16x32_bf16 v[52:55], a[208:211], a[68:71], v[52:55]
  s_waitcnt lgkmcnt(11)
  ds_read_b64_tr_b16 a[206:207], v242 offset:63488
  v_mfma_f32_16x16x32_bf16 v[60:63], a[176:179], a[68:71], v[60:63]
  ds_read_b64_tr_b16 a[208:209], v243 offset:51200
  v_mfma_f32_16x16x32_bf16 v[60:63], a[180:183], a[76:79], v[60:63]
  ds_read_b64_tr_b16 a[210:211], v243 offset:55296
  v_mfma_f32_16x16x32_bf16 v[56:59], a[180:183], a[72:75], v[56:59]
  buffer_load_dwordx4 a[220:223], v137, s[36:39], s51 offen offset:1024 sc1
  ds_read_b64_tr_b16 a[212:213], v243 offset:59392
  v_mfma_f32_16x16x32_bf16 v[56:59], a[176:179], a[64:67], v[56:59]
  s_waitcnt lgkmcnt(11)
  ds_read_b64_tr_b16 a[214:215], v243 offset:63488
  v_mfma_f32_16x16x32_bf16 v[144:147], a[184:187], a[64:67], v[144:147]
  ds_read_b64_tr_b16 a[176:177], v244 offset:0
  v_mfma_f32_16x16x32_bf16 v[144:147], a[188:191], a[72:75], v[144:147]
  buffer_load_dwordx4 v135, s[24:27], s50 offen offset:2048 lds
  ds_read_b64_tr_b16 a[178:179], v244 offset:4096
  v_mfma_f32_16x16x32_bf16 v[148:151], a[188:191], a[76:79], v[148:151]
  ds_read_b64_tr_b16 a[180:181], v244 offset:8192
  v_mfma_f32_16x16x32_bf16 v[148:151], a[184:187], a[68:71], v[148:151]
  s_waitcnt lgkmcnt(11)
  ds_read_b64_tr_b16 a[182:183], v244 offset:12288
  v_mfma_f32_16x16x32_bf16 v[156:159], a[192:195], a[68:71], v[156:159]
  ds_read_b64_tr_b16 a[184:185], v245 offset:0
  v_mfma_f32_16x16x32_bf16 v[156:159], a[196:199], a[76:79], v[156:159]
  buffer_load_dwordx4 a[224:227], v137, s[36:39], s51 offen offset:2048 sc1
  ds_read_b64_tr_b16 a[186:187], v245 offset:4096
  v_mfma_f32_16x16x32_bf16 v[152:155], a[196:199], a[72:75], v[152:155]
  ds_read_b64_tr_b16 a[188:189], v245 offset:8192
  v_mfma_f32_16x16x32_bf16 v[152:155], a[192:195], a[64:67], v[152:155]
  s_waitcnt lgkmcnt(11)
  ds_read_b64_tr_b16 a[190:191], v245 offset:12288
  v_mfma_f32_16x16x32_bf16 v[160:163], a[200:203], a[64:67], v[160:163]
  ds_read_b64_tr_b16 a[192:193], v246 offset:0
  v_mfma_f32_16x16x32_bf16 v[160:163], a[204:207], a[72:75], v[160:163]
  buffer_load_dwordx4 v136, s[24:27], s50 offen offset:3072 lds
  ds_read_b64_tr_b16 a[194:195], v246 offset:4096
  v_mfma_f32_16x16x32_bf16 v[164:167], a[204:207], a[76:79], v[164:167]
  ds_read_b64_tr_b16 a[196:197], v246 offset:8192
  v_mfma_f32_16x16x32_bf16 v[164:167], a[200:203], a[68:71], v[164:167]
  s_waitcnt lgkmcnt(11)
  ds_read_b64_tr_b16 a[198:199], v246 offset:12288
  v_mfma_f32_16x16x32_bf16 v[172:175], a[208:211], a[68:71], v[172:175]
  ds_read_b64_tr_b16 a[200:201], v247 offset:0
  v_mfma_f32_16x16x32_bf16 v[172:175], a[212:215], a[76:79], v[172:175]
  buffer_load_dwordx4 a[228:231], v137, s[36:39], s51 offen offset:3072 sc1
  s_cmp_eq_u32 s83, 3
  v_mfma_f32_16x16x32_bf16 v[168:171], a[212:215], a[72:75], v[168:171]
  s_cselect_b32 s82, 40, 26
  s_lshl_b32 s50, s82, 16
  s_add_u32 m0, s73, 131072
  v_mfma_f32_16x16x32_bf16 v[168:171], a[208:211], a[64:67], v[168:171]
  s_waitcnt vmcnt(24) lgkmcnt(9)
  ds_read_b64_tr_b16 a[202:203], v247 offset:4096
  ds_read_b64_tr_b16 a[204:205], v247 offset:8192
  v_mfma_f32_16x16x32_bf16 v[32:35], a[176:179], a[80:83], v[32:35]
  ds_read_b64_tr_b16 a[206:207], v247 offset:12288
  ds_read_b64_tr_b16 a[208:209], v244 offset:2048
  v_mfma_f32_16x16x32_bf16 v[32:35], a[180:183], a[88:91], v[32:35]
  buffer_load_dwordx4 v133, s[24:27], s50 offen offset:0 lds
  s_lshl_b32 s51, s82, 11
  v_mfma_f32_16x16x32_bf16 v[36:39], a[180:183], a[92:95], v[36:39]
  ds_read_b64_tr_b16 a[210:211], v244 offset:6144
  ds_read_b64_tr_b16 a[212:213], v244 offset:10240
  v_mfma_f32_16x16x32_bf16 v[36:39], a[176:179], a[84:87], v[36:39]
  s_waitcnt lgkmcnt(11)
  ds_read_b64_tr_b16 a[214:215], v244 offset:14336
  v_mfma_f32_16x16x32_bf16 v[44:47], a[184:187], a[84:87], v[44:47]
  buffer_load_dwordx4 a[0:3], v137, s[36:39], s51 offen offset:0 sc1
  ds_read_b64_tr_b16 a[176:177], v245 offset:2048
  v_mfma_f32_16x16x32_bf16 v[44:47], a[188:191], a[92:95], v[44:47]
  ds_read_b64_tr_b16 a[178:179], v245 offset:6144
  v_mfma_f32_16x16x32_bf16 v[40:43], a[188:191], a[88:91], v[40:43]
  ds_read_b64_tr_b16 a[180:181], v245 offset:10240
  v_mfma_f32_16x16x32_bf16 v[40:43], a[184:187], a[80:83], v[40:43]
  s_waitcnt vmcnt(19) lgkmcnt(11)
  s_barrier
  ds_read_b64_tr_b16 a[182:183], v245 offset:14336
  v_mfma_f32_16x16x32_bf16 v[48:51], a[192:195], a[80:83], v[48:51]
  buffer_load_dwordx4 v134, s[24:27], s50 offen offset:1024 lds
  ds_read_b64_tr_b16 a[184:185], v246 offset:2048
  v_mfma_f32_16x16x32_bf16 v[48:51], a[196:199], a[88:91], v[48:51]
  ds_read_b64_tr_b16 a[186:187], v246 offset:6144
  v_mfma_f32_16x16x32_bf16 v[52:55], a[196:199], a[92:95], v[52:55]
  ds_read_b64_tr_b16 a[188:189], v246 offset:10240
  v_mfma_f32_16x16x32_bf16 v[52:55], a[192:195], a[84:87], v[52:55]
  s_waitcnt lgkmcnt(11)
  ds_read_b64_tr_b16 a[190:191], v246 offset:14336
  v_mfma_f32_16x16x32_bf16 v[60:63], a[200:203], a[84:87], v[60:63]
  buffer_load_dwordx4 a[4:7], v137, s[36:39], s51 offen offset:1024 sc1
  ds_read_b64_tr_b16 a[192:193], v247 offset:2048
  v_mfma_f32_16x16x32_bf16 v[60:63], a[204:207], a[92:95], v[60:63]
  ds_read_b64_tr_b16 a[194:195], v247 offset:6144
  v_mfma_f32_16x16x32_bf16 v[56:59], a[204:207], a[88:91], v[56:59]
  ds_read_b64_tr_b16 a[196:197], v247 offset:10240
  v_mfma_f32_16x16x32_bf16 v[56:59], a[200:203], a[80:83], v[56:59]
  s_waitcnt lgkmcnt(11)
  ds_read_b64_tr_b16 a[198:199], v247 offset:14336
  v_mfma_f32_16x16x32_bf16 v[144:147], a[208:211], a[80:83], v[144:147]
  buffer_load_dwordx4 v135, s[24:27], s50 offen offset:2048 lds
  ds_read_b64_tr_b16 a[200:201], v244 offset:16384
  v_mfma_f32_16x16x32_bf16 v[144:147], a[212:215], a[88:91], v[144:147]
  ds_read_b64_tr_b16 a[202:203], v244 offset:20480
  v_mfma_f32_16x16x32_bf16 v[148:151], a[212:215], a[92:95], v[148:151]
  ds_read_b64_tr_b16 a[204:205], v244 offset:24576
  v_mfma_f32_16x16x32_bf16 v[148:151], a[208:211], a[84:87], v[148:151]
  s_waitcnt lgkmcnt(11)
  ds_read_b64_tr_b16 a[206:207], v244 offset:28672
  v_mfma_f32_16x16x32_bf16 v[156:159], a[176:179], a[84:87], v[156:159]
  buffer_load_dwordx4 a[8:11], v137, s[36:39], s51 offen offset:2048 sc1
  ds_read_b64_tr_b16 a[208:209], v245 offset:16384
  v_mfma_f32_16x16x32_bf16 v[156:159], a[180:183], a[92:95], v[156:159]
  ds_read_b64_tr_b16 a[210:211], v245 offset:20480
  v_mfma_f32_16x16x32_bf16 v[152:155], a[180:183], a[88:91], v[152:155]
  ds_read_b64_tr_b16 a[212:213], v245 offset:24576
  v_mfma_f32_16x16x32_bf16 v[152:155], a[176:179], a[80:83], v[152:155]
  s_waitcnt lgkmcnt(11)
  buffer_load_dwordx4 v136, s[24:27], s50 offen offset:3072 lds
  ds_read_b64_tr_b16 a[214:215], v245 offset:28672
  v_mfma_f32_16x16x32_bf16 v[160:163], a[184:187], a[80:83], v[160:163]
  ds_read_b64_tr_b16 a[176:177], v246 offset:16384
  v_mfma_f32_16x16x32_bf16 v[160:163], a[188:191], a[88:91], v[160:163]
  ds_read_b64_tr_b16 a[178:179], v246 offset:20480
  v_mfma_f32_16x16x32_bf16 v[164:167], a[188:191], a[92:95], v[164:167]
  ds_read_b64_tr_b16 a[180:181], v246 offset:24576
  v_mfma_f32_16x16x32_bf16 v[164:167], a[184:187], a[84:87], v[164:167]
  s_waitcnt lgkmcnt(11)
  buffer_load_dwordx4 a[12:15], v137, s[36:39], s51 offen offset:3072 sc1
  s_cmp_eq_u32 s83, 0
  v_mfma_f32_16x16x32_bf16 v[172:175], a[192:195], a[84:87], v[172:175]
  s_cselect_b32 s70, 43, 29
  s_lshl_b32 s50, s70, 16
  s_add_u32 m0, s73, 0
  v_mfma_f32_16x16x32_bf16 v[172:175], a[196:199], a[92:95], v[172:175]
  ds_read_b64_tr_b16 a[182:183], v246 offset:28672
  ds_read_b64_tr_b16 a[184:185], v247 offset:16384
  v_mfma_f32_16x16x32_bf16 v[168:171], a[196:199], a[88:91], v[168:171]
  ds_read_b64_tr_b16 a[186:187], v247 offset:20480
  ds_read_b64_tr_b16 a[188:189], v247 offset:24576
  v_mfma_f32_16x16x32_bf16 v[168:171], a[192:195], a[80:83], v[168:171]
  s_waitcnt vmcnt(24) lgkmcnt(11)
  buffer_load_dwordx4 v133, s[24:27], s50 offen offset:0 lds
  s_lshl_b32 s51, s70, 11
  v_mfma_f32_16x16x32_bf16 v[32:35], a[200:203], a[96:99], v[32:35]
  ds_read_b64_tr_b16 a[190:191], v247 offset:28672
  ds_read_b64_tr_b16 a[192:193], v244 offset:18432
  v_mfma_f32_16x16x32_bf16 v[32:35], a[204:207], a[104:107], v[32:35]
  ds_read_b64_tr_b16 a[194:195], v244 offset:22528
  v_mfma_f32_16x16x32_bf16 v[36:39], a[204:207], a[108:111], v[36:39]
  ds_read_b64_tr_b16 a[196:197], v244 offset:26624
  v_mfma_f32_16x16x32_bf16 v[36:39], a[200:203], a[100:103], v[36:39]
  s_waitcnt lgkmcnt(11)
  buffer_load_dwordx4 a[16:19], v137, s[36:39], s51 offen offset:0 sc1
  ds_read_b64_tr_b16 a[198:199], v244 offset:30720
  v_mfma_f32_16x16x32_bf16 v[44:47], a[208:211], a[100:103], v[44:47]
  ds_read_b64_tr_b16 a[200:201], v245 offset:18432
  v_mfma_f32_16x16x32_bf16 v[44:47], a[212:215], a[108:111], v[44:47]
  ds_read_b64_tr_b16 a[202:203], v245 offset:22528
  v_mfma_f32_16x16x32_bf16 v[40:43], a[212:215], a[104:107], v[40:43]
  ds_read_b64_tr_b16 a[204:205], v245 offset:26624
  v_mfma_f32_16x16x32_bf16 v[40:43], a[208:211], a[96:99], v[40:43]
  s_waitcnt vmcnt(19) lgkmcnt(11)
  s_barrier
  buffer_load_dwordx4 v134, s[24:27], s50 offen offset:1024 lds
  v_mfma_f32_16x16x32_bf16 v[48:51], a[176:179], a[96:99], v[48:51]
  ds_read_b64_tr_b16 a[206:207], v245 offset:30720
  ds_read_b64_tr_b16 a[208:209], v246 offset:18432
  v_mfma_f32_16x16x32_bf16 v[48:51], a[180:183], a[104:107], v[48:51]
  ds_read_b64_tr_b16 a[210:211], v246 offset:22528
  v_mfma_f32_16x16x32_bf16 v[52:55], a[180:183], a[108:111], v[52:55]
  buffer_load_dwordx4 a[20:23], v137, s[36:39], s51 offen offset:1024 sc1
  ds_read_b64_tr_b16 a[212:213], v246 offset:26624
  v_mfma_f32_16x16x32_bf16 v[52:55], a[176:179], a[100:103], v[52:55]
  s_waitcnt lgkmcnt(11)
  ds_read_b64_tr_b16 a[214:215], v246 offset:30720
  v_mfma_f32_16x16x32_bf16 v[60:63], a[184:187], a[100:103], v[60:63]
  ds_read_b64_tr_b16 a[176:177], v247 offset:18432
  v_mfma_f32_16x16x32_bf16 v[60:63], a[188:191], a[108:111], v[60:63]
  ds_read_b64_tr_b16 a[178:179], v247 offset:22528
  v_mfma_f32_16x16x32_bf16 v[56:59], a[188:191], a[104:107], v[56:59]
  buffer_load_dwordx4 v135, s[24:27], s50 offen offset:2048 lds
  ds_read_b64_tr_b16 a[180:181], v247 offset:26624
  v_mfma_f32_16x16x32_bf16 v[56:59], a[184:187], a[96:99], v[56:59]
  s_waitcnt lgkmcnt(11)
  ds_read_b64_tr_b16 a[182:183], v247 offset:30720
  v_mfma_f32_16x16x32_bf16 v[144:147], a[192:195], a[96:99], v[144:147]
  ds_read_b64_tr_b16 a[184:185], v244 offset:32768
  v_mfma_f32_16x16x32_bf16 v[144:147], a[196:199], a[104:107], v[144:147]
  ds_read_b64_tr_b16 a[186:187], v244 offset:36864
  v_mfma_f32_16x16x32_bf16 v[148:151], a[196:199], a[108:111], v[148:151]
  buffer_load_dwordx4 a[24:27], v137, s[36:39], s51 offen offset:2048 sc1
  ds_read_b64_tr_b16 a[188:189], v244 offset:40960
  v_mfma_f32_16x16x32_bf16 v[148:151], a[192:195], a[100:103], v[148:151]
  s_waitcnt lgkmcnt(11)
  ds_read_b64_tr_b16 a[190:191], v244 offset:45056
  v_mfma_f32_16x16x32_bf16 v[156:159], a[200:203], a[100:103], v[156:159]
  ds_read_b64_tr_b16 a[192:193], v245 offset:32768
  v_mfma_f32_16x16x32_bf16 v[156:159], a[204:207], a[108:111], v[156:159]
  ds_read_b64_tr_b16 a[194:195], v245 offset:36864
  v_mfma_f32_16x16x32_bf16 v[152:155], a[204:207], a[104:107], v[152:155]
  buffer_load_dwordx4 v136, s[24:27], s50 offen offset:3072 lds
  ds_read_b64_tr_b16 a[196:197], v245 offset:40960
  v_mfma_f32_16x16x32_bf16 v[152:155], a[200:203], a[96:99], v[152:155]
  s_waitcnt lgkmcnt(11)
  ds_read_b64_tr_b16 a[198:199], v245 offset:45056
  v_mfma_f32_16x16x32_bf16 v[160:163], a[208:211], a[96:99], v[160:163]
  ds_read_b64_tr_b16 a[200:201], v246 offset:32768
  v_mfma_f32_16x16x32_bf16 v[160:163], a[212:215], a[104:107], v[160:163]
  ds_read_b64_tr_b16 a[202:203], v246 offset:36864
  v_mfma_f32_16x16x32_bf16 v[164:167], a[212:215], a[108:111], v[164:167]
  buffer_load_dwordx4 a[28:31], v137, s[36:39], s51 offen offset:3072 sc1
  s_cmp_eq_u32 s83, 1
  v_mfma_f32_16x16x32_bf16 v[164:167], a[208:211], a[100:103], v[164:167]
  s_waitcnt lgkmcnt(10)
  s_cselect_b32 s74, 47, 33
  s_lshl_b32 s51, s74, 11
  v_mfma_f32_16x16x32_bf16 v[172:175], a[176:179], a[100:103], v[172:175]
  ds_read_b64_tr_b16 a[204:205], v246 offset:40960
  ds_read_b64_tr_b16 a[206:207], v246 offset:45056
  v_mfma_f32_16x16x32_bf16 v[172:175], a[180:183], a[108:111], v[172:175]
  ds_read_b64_tr_b16 a[208:209], v247 offset:32768
  buffer_load_dwordx4 a[32:35], v137, s[36:39], s51 offen offset:0 sc1
  v_mfma_f32_16x16x32_bf16 v[168:171], a[180:183], a[104:107], v[168:171]
  ds_read_b64_tr_b16 a[210:211], v247 offset:36864
  ds_read_b64_tr_b16 a[212:213], v247 offset:40960
  v_mfma_f32_16x16x32_bf16 v[168:171], a[176:179], a[96:99], v[168:171]
  s_waitcnt vmcnt(25) lgkmcnt(11)
  ds_read_b64_tr_b16 a[214:215], v247 offset:45056
  v_mfma_f32_16x16x32_bf16 v[32:35], a[184:187], a[112:115], v[32:35]
  ds_read_b64_tr_b16 a[176:177], v244 offset:34816
  v_mfma_f32_16x16x32_bf16 v[32:35], a[188:191], a[120:123], v[32:35]
  buffer_load_dwordx4 a[36:39], v137, s[36:39], s51 offen offset:1024 sc1
  s_lshl_b32 s50, s74, 16
  v_mfma_f32_16x16x32_bf16 v[36:39], a[188:191], a[124:127], v[36:39]
  s_add_u32 m0, s73, 16384
  ds_read_b64_tr_b16 a[178:179], v244 offset:38912
  ds_read_b64_tr_b16 a[180:181], v244 offset:43008
  v_mfma_f32_16x16x32_bf16 v[36:39], a[184:187], a[116:119], v[36:39]
  s_waitcnt lgkmcnt(11)
  ds_read_b64_tr_b16 a[182:183], v244 offset:47104
  v_mfma_f32_16x16x32_bf16 v[44:47], a[192:195], a[116:119], v[44:47]
  ds_read_b64_tr_b16 a[184:185], v245 offset:34816
  v_mfma_f32_16x16x32_bf16 v[44:47], a[196:199], a[124:127], v[44:47]
  buffer_load_dwordx4 v135, s[24:27], s50 offen offset:2048 lds
  ds_read_b64_tr_b16 a[186:187], v245 offset:38912
  v_mfma_f32_16x16x32_bf16 v[40:43], a[196:199], a[120:123], v[40:43]
  ds_read_b64_tr_b16 a[188:189], v245 offset:43008
  v_mfma_f32_16x16x32_bf16 v[40:43], a[192:195], a[112:115], v[40:43]
  s_waitcnt vmcnt(20) lgkmcnt(11)
  s_barrier
  ds_read_b64_tr_b16 a[190:191], v245 offset:47104
  v_mfma_f32_16x16x32_bf16 v[48:51], a[200:203], a[112:115], v[48:51]
  ds_read_b64_tr_b16 a[192:193], v246 offset:34816
  v_mfma_f32_16x16x32_bf16 v[48:51], a[204:207], a[120:123], v[48:51]
  buffer_load_dwordx4 a[40:43], v137, s[36:39], s51 offen offset:2048 sc1
  ds_read_b64_tr_b16 a[194:195], v246 offset:38912
  v_mfma_f32_16x16x32_bf16 v[52:55], a[204:207], a[124:127], v[52:55]
  ds_read_b64_tr_b16 a[196:197], v246 offset:43008
  v_mfma_f32_16x16x32_bf16 v[52:55], a[200:203], a[116:119], v[52:55]
  s_waitcnt lgkmcnt(11)
  ds_read_b64_tr_b16 a[198:199], v246 offset:47104
  v_mfma_f32_16x16x32_bf16 v[60:63], a[208:211], a[116:119], v[60:63]
  ds_read_b64_tr_b16 a[200:201], v247 offset:34816
  v_mfma_f32_16x16x32_bf16 v[60:63], a[212:215], a[124:127], v[60:63]
  buffer_load_dwordx4 v136, s[24:27], s50 offen offset:3072 lds
  ds_read_b64_tr_b16 a[202:203], v247 offset:38912
  v_mfma_f32_16x16x32_bf16 v[56:59], a[212:215], a[120:123], v[56:59]
  ds_read_b64_tr_b16 a[204:205], v247 offset:43008
  v_mfma_f32_16x16x32_bf16 v[56:59], a[208:211], a[112:115], v[56:59]
  s_waitcnt lgkmcnt(11)
  ds_read_b64_tr_b16 a[206:207], v247 offset:47104
  v_mfma_f32_16x16x32_bf16 v[144:147], a[176:179], a[112:115], v[144:147]
  ds_read_b64_tr_b16 a[208:209], v244 offset:49152
  v_mfma_f32_16x16x32_bf16 v[144:147], a[180:183], a[120:123], v[144:147]
  buffer_load_dwordx4 a[44:47], v137, s[36:39], s51 offen offset:3072 sc1
  s_cmp_eq_u32 s83, 2
  v_mfma_f32_16x16x32_bf16 v[148:151], a[180:183], a[124:127], v[148:151]
  s_cselect_b32 s75, 50, 36
  s_lshl_b32 s51, s75, 11
  ds_read_b64_tr_b16 a[210:211], v244 offset:53248
  v_mfma_f32_16x16x32_bf16 v[148:151], a[176:179], a[116:119], v[148:151]
  s_waitcnt lgkmcnt(10)
  ds_read_b64_tr_b16 a[212:213], v244 offset:57344
  ds_read_b64_tr_b16 a[214:215], v244 offset:61440
  v_mfma_f32_16x16x32_bf16 v[156:159], a[184:187], a[116:119], v[156:159]
  buffer_load_dwordx4 a[48:51], v137, s[36:39], s51 offen offset:0 sc1
  ds_read_b64_tr_b16 a[176:177], v245 offset:49152
  v_mfma_f32_16x16x32_bf16 v[156:159], a[188:191], a[124:127], v[156:159]
  ds_read_b64_tr_b16 a[178:179], v245 offset:53248
  v_mfma_f32_16x16x32_bf16 v[152:155], a[188:191], a[120:123], v[152:155]
  ds_read_b64_tr_b16 a[180:181], v245 offset:57344
  v_mfma_f32_16x16x32_bf16 v[152:155], a[184:187], a[112:115], v[152:155]
  s_waitcnt lgkmcnt(11)
  ds_read_b64_tr_b16 a[182:183], v245 offset:61440
  v_mfma_f32_16x16x32_bf16 v[160:163], a[192:195], a[112:115], v[160:163]
  buffer_load_dwordx4 a[52:55], v137, s[36:39], s51 offen offset:1024 sc1
  s_lshl_b32 s50, s75, 16
  v_mfma_f32_16x16x32_bf16 v[160:163], a[196:199], a[120:123], v[160:163]
  s_add_u32 m0, s73, 32768
  ds_read_b64_tr_b16 a[184:185], v246 offset:49152
  ds_read_b64_tr_b16 a[186:187], v246 offset:53248
  v_mfma_f32_16x16x32_bf16 v[164:167], a[196:199], a[124:127], v[164:167]
  ds_read_b64_tr_b16 a[188:189], v246 offset:57344
  v_mfma_f32_16x16x32_bf16 v[164:167], a[192:195], a[116:119], v[164:167]
  s_waitcnt lgkmcnt(11)
  ds_read_b64_tr_b16 a[190:191], v246 offset:61440
  v_mfma_f32_16x16x32_bf16 v[172:175], a[200:203], a[116:119], v[172:175]
  buffer_load_dwordx4 v135, s[24:27], s50 offen offset:2048 lds
  ds_read_b64_tr_b16 a[192:193], v247 offset:49152
  v_mfma_f32_16x16x32_bf16 v[172:175], a[204:207], a[124:127], v[172:175]
  ds_read_b64_tr_b16 a[194:195], v247 offset:53248
  v_mfma_f32_16x16x32_bf16 v[168:171], a[204:207], a[120:123], v[168:171]
  ds_read_b64_tr_b16 a[196:197], v247 offset:57344
  v_mfma_f32_16x16x32_bf16 v[168:171], a[200:203], a[112:115], v[168:171]
  s_waitcnt vmcnt(25) lgkmcnt(11)
  ds_read_b64_tr_b16 a[198:199], v247 offset:61440
  v_mfma_f32_16x16x32_bf16 v[32:35], a[208:211], a[216:219], v[32:35]
  buffer_load_dwordx4 a[56:59], v137, s[36:39], s51 offen offset:2048 sc1
  ds_read_b64_tr_b16 a[200:201], v244 offset:51200
  v_mfma_f32_16x16x32_bf16 v[32:35], a[212:215], a[224:227], v[32:35]
  ds_read_b64_tr_b16 a[202:203], v244 offset:55296
  v_mfma_f32_16x16x32_bf16 v[36:39], a[212:215], a[228:231], v[36:39]
  ds_read_b64_tr_b16 a[204:205], v244 offset:59392
  v_mfma_f32_16x16x32_bf16 v[36:39], a[208:211], a[220:223], v[36:39]
  s_waitcnt lgkmcnt(11)
  ds_read_b64_tr_b16 a[206:207], v244 offset:63488
  v_mfma_f32_16x16x32_bf16 v[44:47], a[176:179], a[220:223], v[44:47]
  buffer_load_dwordx4 v136, s[24:27], s50 offen offset:3072 lds
  ds_read_b64_tr_b16 a[208:209], v245 offset:51200
  v_mfma_f32_16x16x32_bf16 v[44:47], a[180:183], a[228:231], v[44:47]
  ds_read_b64_tr_b16 a[210:211], v245 offset:55296
  v_mfma_f32_16x16x32_bf16 v[40:43], a[180:183], a[224:227], v[40:43]
  ds_read_b64_tr_b16 a[212:213], v245 offset:59392
  v_mfma_f32_16x16x32_bf16 v[40:43], a[176:179], a[216:219], v[40:43]
  s_waitcnt vmcnt(20) lgkmcnt(11)
  s_barrier
  buffer_load_dwordx4 a[60:63], v137, s[36:39], s51 offen offset:3072 sc1
  v_mfma_f32_16x16x32_bf16 v[48:51], a[184:187], a[216:219], v[48:51]
  s_cmp_eq_u32 s83, 3
  s_cselect_b32 s76, 54, 40
  s_lshl_b32 s51, s76, 11
  v_mfma_f32_16x16x32_bf16 v[48:51], a[188:191], a[224:227], v[48:51]
Hb1_3:
  s_cbranch_execz Rb
  ds_read_b64_tr_b16 a[214:215], v245 offset:63488
  ds_read_b64_tr_b16 a[176:177], v246 offset:51200
  v_mfma_f32_16x16x32_bf16 v[52:55], a[188:191], a[228:231], v[52:55]
  ds_read_b64_tr_b16 a[178:179], v246 offset:55296
  ds_read_b64_tr_b16 a[180:181], v246 offset:59392
  v_mfma_f32_16x16x32_bf16 v[52:55], a[184:187], a[220:223], v[52:55]
  s_waitcnt lgkmcnt(11)
  buffer_load_dwordx4 a[64:67], v137, s[36:39], s51 offen offset:0 sc1
  ds_read_b64_tr_b16 a[182:183], v246 offset:63488
  v_mfma_f32_16x16x32_bf16 v[60:63], a[192:195], a[220:223], v[60:63]
  ds_read_b64_tr_b16 a[184:185], v247 offset:51200
  v_mfma_f32_16x16x32_bf16 v[60:63], a[196:199], a[228:231], v[60:63]
  ds_read_b64_tr_b16 a[186:187], v247 offset:55296
  v_mfma_f32_16x16x32_bf16 v[56:59], a[196:199], a[224:227], v[56:59]
  ds_read_b64_tr_b16 a[188:189], v247 offset:59392
  v_mfma_f32_16x16x32_bf16 v[56:59], a[192:195], a[216:219], v[56:59]
  s_waitcnt lgkmcnt(11)
  buffer_load_dwordx4 a[68:71], v137, s[36:39], s51 offen offset:1024 sc1
  s_lshl_b32 s50, s76, 16
  v_mfma_f32_16x16x32_bf16 v[144:147], a[200:203], a[216:219], v[144:147]
  s_add_u32 m0, s73, 49152
  ds_read_b64_tr_b16 a[190:191], v247 offset:63488
  ds_read_b64_tr_b16 a[192:193], v248 offset:0
  v_mfma_f32_16x16x32_bf16 v[144:147], a[204:207], a[224:227], v[144:147]
  ds_read_b64_tr_b16 a[194:195], v248 offset:4096
  v_mfma_f32_16x16x32_bf16 v[148:151], a[204:207], a[228:231], v[148:151]
  ds_read_b64_tr_b16 a[196:197], v248 offset:8192
  v_mfma_f32_16x16x32_bf16 v[148:151], a[200:203], a[220:223], v[148:151]
  s_waitcnt lgkmcnt(11)
  buffer_load_dwordx4 v135, s[24:27], s50 offen offset:2048 lds
  ds_read_b64_tr_b16 a[198:199], v248 offset:12288
  v_mfma_f32_16x16x32_bf16 v[156:159], a[208:211], a[220:223], v[156:159]
  ds_read_b64_tr_b16 a[200:201], v249 offset:0
  v_mfma_f32_16x16x32_bf16 v[156:159], a[212:215], a[228:231], v[156:159]
  ds_read_b64_tr_b16 a[202:203], v249 offset:4096
  v_mfma_f32_16x16x32_bf16 v[152:155], a[212:215], a[224:227], v[152:155]
  ds_read_b64_tr_b16 a[204:205], v249 offset:8192
  v_mfma_f32_16x16x32_bf16 v[152:155], a[208:211], a[216:219], v[152:155]
  s_waitcnt lgkmcnt(11)
  buffer_load_dwordx4 a[72:75], v137, s[36:39], s51 offen offset:2048 sc1
  ds_read_b64_tr_b16 a[206:207], v249 offset:12288
  v_mfma_f32_16x16x32_bf16 v[160:163], a[176:179], a[216:219], v[160:163]
  ds_read_b64_tr_b16 a[208:209], v250 offset:0
  v_mfma_f32_16x16x32_bf16 v[160:163], a[180:183], a[224:227], v[160:163]
  ds_read_b64_tr_b16 a[210:211], v250 offset:4096
  v_mfma_f32_16x16x32_bf16 v[164:167], a[180:183], a[228:231], v[164:167]
  buffer_load_dwordx4 v136, s[24:27], s50 offen offset:3072 lds
  ds_read_b64_tr_b16 a[212:213], v250 offset:8192
  v_mfma_f32_16x16x32_bf16 v[164:167], a[176:179], a[220:223], v[164:167]
  s_waitcnt lgkmcnt(11)
  ds_read_b64_tr_b16 a[214:215], v250 offset:12288
  v_mfma_f32_16x16x32_bf16 v[172:175], a[184:187], a[220:223], v[172:175]
  ds_read_b64_tr_b16 a[176:177], v251 offset:0
  v_mfma_f32_16x16x32_bf16 v[172:175], a[188:191], a[228:231], v[172:175]
  ds_read_b64_tr_b16 a[178:179], v251 offset:4096
  v_mfma_f32_16x16x32_bf16 v[168:171], a[188:191], a[224:227], v[168:171]
  buffer_load_dwordx4 a[76:79], v137, s[36:39], s51 offen offset:3072 sc1
  s_cmp_eq_u32 s83, 0
  v_mfma_f32_16x16x32_bf16 v[168:171], a[184:187], a[216:219], v[168:171]
  s_waitcnt vmcnt(26) lgkmcnt(10)
  s_cselect_b32 s77, 15, 43
  s_lshl_b32 s51, s77, 11
  v_mfma_f32_16x16x32_bf16 v[32:35], a[192:195], a[0:3], v[32:35]
  ds_read_b64_tr_b16 a[180:181], v251 offset:8192
  ds_read_b64_tr_b16 a[182:183], v251 offset:12288
  v_mfma_f32_16x16x32_bf16 v[32:35], a[196:199], a[8:11], v[32:35]
  ds_read_b64_tr_b16 a[184:185], v248 offset:2048
  ds_read_b64_tr_b16 a[186:187], v248 offset:6144
  v_mfma_f32_16x16x32_bf16 v[36:39], a[196:199], a[12:15], v[36:39]
  buffer_load_dwordx4 a[80:83], v137, s[36:39], s51 offen offset:0 sc1
  ds_read_b64_tr_b16 a[188:189], v248 offset:10240
  v_mfma_f32_16x16x32_bf16 v[36:39], a[192:195], a[4:7], v[36:39]
  s_waitcnt lgkmcnt(11)
  ds_read_b64_tr_b16 a[190:191], v248 offset:14336
  v_mfma_f32_16x16x32_bf16 v[44:47], a[200:203], a[4:7], v[44:47]
  ds_read_b64_tr_b16 a[192:193], v249 offset:2048
  v_mfma_f32_16x16x32_bf16 v[44:47], a[204:207], a[12:15], v[44:47]
  ds_read_b64_tr_b16 a[194:195], v249 offset:6144
  v_mfma_f32_16x16x32_bf16 v[40:43], a[204:207], a[8:11], v[40:43]
  buffer_load_dwordx4 a[84:87], v137, s[36:39], s51 offen offset:1024 sc1
  s_lshl_b32 s50, s77, 16
  v_mfma_f32_16x16x32_bf16 v[40:43], a[200:203], a[0:3], v[40:43]
  s_waitcnt vmcnt(21) lgkmcnt(10)
  s_barrier
  s_add_u32 m0, s73, 65536
  v_mfma_f32_16x16x32_bf16 v[48:51], a[208:211], a[0:3], v[48:51]
  ds_read_b64_tr_b16 a[196:197], v249 offset:10240
  ds_read_b64_tr_b16 a[198:199], v249 offset:14336
  v_mfma_f32_16x16x32_bf16 v[48:51], a[212:215], a[8:11], v[48:51]
  ds_read_b64_tr_b16 a[200:201], v250 offset:2048
  ds_read_b64_tr_b16 a[202:203], v250 offset:6144
  v_mfma_f32_16x16x32_bf16 v[52:55], a[212:215], a[12:15], v[52:55]
  buffer_load_dwordx4 v135, s[24:27], s50 offen offset:2048 lds
  ds_read_b64_tr_b16 a[204:205], v250 offset:10240
  v_mfma_f32_16x16x32_bf16 v[52:55], a[208:211], a[4:7], v[52:55]
  s_waitcnt lgkmcnt(11)
  ds_read_b64_tr_b16 a[206:207], v250 offset:14336
  v_mfma_f32_16x16x32_bf16 v[60:63], a[176:179], a[4:7], v[60:63]
  ds_read_b64_tr_b16 a[208:209], v251 offset:2048
  v_mfma_f32_16x16x32_bf16 v[60:63], a[180:183], a[12:15], v[60:63]
  buffer_load_dwordx4 a[88:91], v137, s[36:39], s51 offen offset:2048 sc1
  ds_read_b64_tr_b16 a[210:211], v251 offset:6144
  v_mfma_f32_16x16x32_bf16 v[56:59], a[180:183], a[8:11], v[56:59]
  ds_read_b64_tr_b16 a[212:213], v251 offset:10240
  v_mfma_f32_16x16x32_bf16 v[56:59], a[176:179], a[0:3], v[56:59]
  s_waitcnt lgkmcnt(11)
  ds_read_b64_tr_b16 a[214:215], v251 offset:14336
  v_mfma_f32_16x16x32_bf16 v[144:147], a[184:187], a[0:3], v[144:147]
  ds_read_b64_tr_b16 a[176:177], v240 offset:0
  v_mfma_f32_16x16x32_bf16 v[144:147], a[188:191], a[8:11], v[144:147]
  buffer_load_dwordx4 v136, s[24:27], s50 offen offset:3072 lds
  ds_read_b64_tr_b16 a[178:179], v240 offset:4096
  v_mfma_f32_16x16x32_bf16 v[148:151], a[188:191], a[12:15], v[148:151]
  ds_read_b64_tr_b16 a[180:181], v240 offset:8192
  v_mfma_f32_16x16x32_bf16 v[148:151], a[184:187], a[4:7], v[148:151]
  s_waitcnt lgkmcnt(11)
  ds_read_b64_tr_b16 a[182:183], v240 offset:12288
  v_mfma_f32_16x16x32_bf16 v[156:159], a[192:195], a[4:7], v[156:159]
  ds_read_b64_tr_b16 a[184:185], v241 offset:0
  v_mfma_f32_16x16x32_bf16 v[156:159], a[196:199], a[12:15], v[156:159]
  buffer_load_dwordx4 a[92:95], v137, s[36:39], s51 offen offset:3072 sc1
  s_cmp_eq_u32 s83, 1
  v_mfma_f32_16x16x32_bf16 v[152:155], a[196:199], a[8:11], v[152:155]
  s_cselect_b32 s78, 5, 47
  s_lshl_b32 s51, s78, 11
  ds_read_b64_tr_b16 a[186:187], v241 offset:4096
  v_mfma_f32_16x16x32_bf16 v[152:155], a[192:195], a[0:3], v[152:155]
  s_waitcnt lgkmcnt(10)
  ds_read_b64_tr_b16 a[188:189], v241 offset:8192
  ds_read_b64_tr_b16 a[190:191], v241 offset:12288
  v_mfma_f32_16x16x32_bf16 v[160:163], a[200:203], a[0:3], v[160:163]
  ds_read_b64_tr_b16 a[192:193], v242 offset:0
  v_mfma_f32_16x16x32_bf16 v[160:163], a[204:207], a[8:11], v[160:163]
  buffer_load_dwordx4 a[96:99], v137, s[36:39], s51 offen offset:0 sc1
  ds_read_b64_tr_b16 a[194:195], v242 offset:4096
  v_mfma_f32_16x16x32_bf16 v[164:167], a[204:207], a[12:15], v[164:167]
  ds_read_b64_tr_b16 a[196:197], v242 offset:8192
  v_mfma_f32_16x16x32_bf16 v[164:167], a[200:203], a[4:7], v[164:167]
  s_waitcnt lgkmcnt(11)
  ds_read_b64_tr_b16 a[198:199], v242 offset:12288
  v_mfma_f32_16x16x32_bf16 v[172:175], a[208:211], a[4:7], v[172:175]
  ds_read_b64_tr_b16 a[200:201], v243 offset:0
  v_mfma_f32_16x16x32_bf16 v[172:175], a[212:215], a[12:15], v[172:175]
  buffer_load_dwordx4 a[100:103], v137, s[36:39], s51 offen offset:1024 sc1
  s_lshl_b32 s50, s78, 16
  v_mfma_f32_16x16x32_bf16 v[168:171], a[212:215], a[8:11], v[168:171]
  s_add_u32 m0, s73, 81920
  ds_read_b64_tr_b16 a[202:203], v243 offset:4096
  ds_read_b64_tr_b16 a[204:205], v243 offset:8192
  v_mfma_f32_16x16x32_bf16 v[168:171], a[208:211], a[0:3], v[168:171]
  s_waitcnt vmcnt(26) lgkmcnt(11)
  ds_read_b64_tr_b16 a[206:207], v243 offset:12288
  v_mfma_f32_16x16x32_bf16 v[32:35], a[176:179], a[16:19], v[32:35]
  buffer_load_dwordx4 v135, s[24:27], s50 offen offset:2048 lds
  ds_read_b64_tr_b16 a[208:209], v240 offset:2048
  v_mfma_f32_16x16x32_bf16 v[32:35], a[180:183], a[24:27], v[32:35]
  ds_read_b64_tr_b16 a[210:211], v240 offset:6144
  v_mfma_f32_16x16x32_bf16 v[36:39], a[180:183], a[28:31], v[36:39]
  ds_read_b64_tr_b16 a[212:213], v240 offset:10240
  v_mfma_f32_16x16x32_bf16 v[36:39], a[176:179], a[20:23], v[36:39]
  s_waitcnt lgkmcnt(11)
  ds_read_b64_tr_b16 a[214:215], v240 offset:14336
  v_mfma_f32_16x16x32_bf16 v[44:47], a[184:187], a[20:23], v[44:47]
  buffer_load_dwordx4 a[104:107], v137, s[36:39], s51 offen offset:2048 sc1
  ds_read_b64_tr_b16 a[176:177], v241 offset:2048
  v_mfma_f32_16x16x32_bf16 v[44:47], a[188:191], a[28:31], v[44:47]
  ds_read_b64_tr_b16 a[178:179], v241 offset:6144
  v_mfma_f32_16x16x32_bf16 v[40:43], a[188:191], a[24:27], v[40:43]
  ds_read_b64_tr_b16 a[180:181], v241 offset:10240
  v_mfma_f32_16x16x32_bf16 v[40:43], a[184:187], a[16:19], v[40:43]
  s_waitcnt vmcnt(23) lgkmcnt(11)
  s_barrier
  ds_read_b64_tr_b16 a[182:183], v241 offset:14336
  v_mfma_f32_16x16x32_bf16 v[48:51], a[192:195], a[16:19], v[48:51]
  buffer_load_dwordx4 v136, s[24:27], s50 offen offset:3072 lds
  ds_read_b64_tr_b16 a[184:185], v242 offset:2048
  v_mfma_f32_16x16x32_bf16 v[48:51], a[196:199], a[24:27], v[48:51]
  ds_read_b64_tr_b16 a[186:187], v242 offset:6144
  v_mfma_f32_16x16x32_bf16 v[52:55], a[196:199], a[28:31], v[52:55]
  ds_read_b64_tr_b16 a[188:189], v242 offset:10240
  v_mfma_f32_16x16x32_bf16 v[52:55], a[192:195], a[20:23], v[52:55]
  s_waitcnt lgkmcnt(11)
  ds_read_b64_tr_b16 a[190:191], v242 offset:14336
  v_mfma_f32_16x16x32_bf16 v[60:63], a[200:203], a[20:23], v[60:63]
  buffer_load_dwordx4 a[108:111], v137, s[36:39], s51 offen offset:3072 sc1
  s_cmp_eq_u32 s83, 2
  v_mfma_f32_16x16x32_bf16 v[60:63], a[204:207], a[28:31], v[60:63]
  s_cselect_b32 s79, 8, 50
  s_lshl_b32 s51, s79, 11
  ds_read_b64_tr_b16 a[192:193], v243 offset:2048
  v_mfma_f32_16x16x32_bf16 v[56:59], a[204:207], a[24:27], v[56:59]
  ds_read_b64_tr_b16 a[194:195], v243 offset:6144
  ds_read_b64_tr_b16 a[196:197], v243 offset:10240
  v_mfma_f32_16x16x32_bf16 v[56:59], a[200:203], a[16:19], v[56:59]
  s_waitcnt lgkmcnt(11)
  ds_read_b64_tr_b16 a[198:199], v243 offset:14336
  v_mfma_f32_16x16x32_bf16 v[144:147], a[208:211], a[16:19], v[144:147]
  buffer_load_dwordx4 a[112:115], v137, s[36:39], s51 offen offset:0 sc1
  ds_read_b64_tr_b16 a[200:201], v240 offset:18432
  v_mfma_f32_16x16x32_bf16 v[144:147], a[212:215], a[24:27], v[144:147]
  ds_read_b64_tr_b16 a[202:203], v240 offset:22528
  v_mfma_f32_16x16x32_bf16 v[148:151], a[212:215], a[28:31], v[148:151]
  ds_read_b64_tr_b16 a[204:205], v240 offset:26624
  v_mfma_f32_16x16x32_bf16 v[148:151], a[208:211], a[20:23], v[148:151]
  s_waitcnt lgkmcnt(11)
  buffer_load_dwordx4 a[116:119], v137, s[36:39], s51 offen offset:1024 sc1
  s_lshl_b32 s50, s79, 16
  v_mfma_f32_16x16x32_bf16 v[156:159], a[176:179], a[20:23], v[156:159]
  s_add_u32 m0, s73, 98304
  ds_read_b64_tr_b16 a[206:207], v240 offset:30720
  ds_read_b64_tr_b16 a[208:209], v241 offset:18432
  v_mfma_f32_16x16x32_bf16 v[156:159], a[180:183], a[28:31], v[156:159]
  ds_read_b64_tr_b16 a[210:211], v241 offset:22528
  v_mfma_f32_16x16x32_bf16 v[152:155], a[180:183], a[24:27], v[152:155]
  ds_read_b64_tr_b16 a[212:213], v241 offset:26624
  v_mfma_f32_16x16x32_bf16 v[152:155], a[176:179], a[16:19], v[152:155]
  s_waitcnt vmcnt(21) lgkmcnt(11)
  s_barrier
  buffer_load_dwordx4 v135, s[24:27], s50 offen offset:2048 lds
  v_mfma_f32_16x16x32_bf16 v[160:163], a[184:187], a[16:19], v[160:163]
  ds_read_b64_tr_b16 a[214:215], v241 offset:30720
  ds_read_b64_tr_b16 a[176:177], v242 offset:18432
  v_mfma_f32_16x16x32_bf16 v[160:163], a[188:191], a[24:27], v[160:163]
  ds_read_b64_tr_b16 a[178:179], v242 offset:22528
  v_mfma_f32_16x16x32_bf16 v[164:167], a[188:191], a[28:31], v[164:167]
  ds_read_b64_tr_b16 a[180:181], v242 offset:26624
  v_mfma_f32_16x16x32_bf16 v[164:167], a[184:187], a[20:23], v[164:167]
  s_waitcnt lgkmcnt(11)
  buffer_load_dwordx4 a[120:123], v137, s[36:39], s51 offen offset:2048 sc1
  ds_read_b64_tr_b16 a[182:183], v242 offset:30720
  v_mfma_f32_16x16x32_bf16 v[172:175], a[192:195], a[20:23], v[172:175]
  ds_read_b64_tr_b16 a[184:185], v243 offset:18432
  v_mfma_f32_16x16x32_bf16 v[172:175], a[196:199], a[28:31], v[172:175]
  ds_read_b64_tr_b16 a[186:187], v243 offset:22528
  v_mfma_f32_16x16x32_bf16 v[168:171], a[196:199], a[24:27], v[168:171]
  ds_read_b64_tr_b16 a[188:189], v243 offset:26624
  v_mfma_f32_16x16x32_bf16 v[168:171], a[192:195], a[16:19], v[168:171]
  s_waitcnt vmcnt(28) lgkmcnt(11)
  buffer_load_dwordx4 v136, s[24:27], s50 offen offset:3072 lds
  ds_read_b64_tr_b16 a[190:191], v243 offset:30720
  v_mfma_f32_16x16x32_bf16 v[144:147], a[200:203], a[32:35], v[144:147]
  ds_read_b64_tr_b16 a[192:193], v240 offset:34816
  v_mfma_f32_16x16x32_bf16 v[144:147], a[204:207], a[40:43], v[144:147]
  ds_read_b64_tr_b16 a[194:195], v240 offset:38912
  v_mfma_f32_16x16x32_bf16 v[148:151], a[204:207], a[44:47], v[148:151]
  ds_read_b64_tr_b16 a[196:197], v240 offset:43008
  v_mfma_f32_16x16x32_bf16 v[148:151], a[200:203], a[36:39], v[148:151]
  s_waitcnt lgkmcnt(11)
  buffer_load_dwordx4 a[124:127], v137, s[36:39], s51 offen offset:3072 sc1
  s_cmp_eq_u32 s83, 3
  v_mfma_f32_16x16x32_bf16 v[156:159], a[208:211], a[36:39], v[156:159]
  s_cselect_b32 s80, 12, 54
  s_lshl_b32 s51, s80, 11
  ds_read_b64_tr_b16 a[198:199], v240 offset:47104
  v_mfma_f32_16x16x32_bf16 v[156:159], a[212:215], a[44:47], v[156:159]
  ds_read_b64_tr_b16 a[200:201], v241 offset:34816
  ds_read_b64_tr_b16 a[202:203], v241 offset:38912
  v_mfma_f32_16x16x32_bf16 v[152:155], a[212:215], a[40:43], v[152:155]
  buffer_load_dwordx4 a[216:219], v137, s[36:39], s51 offen offset:0 sc1
  ds_read_b64_tr_b16 a[204:205], v241 offset:43008
  v_mfma_f32_16x16x32_bf16 v[152:155], a[208:211], a[32:35], v[152:155]
  s_waitcnt vmcnt(20) lgkmcnt(11)
  s_barrier
  ds_read_b64_tr_b16 a[206:207], v241 offset:47104
  v_mfma_f32_16x16x32_bf16 v[160:163], a[176:179], a[32:35], v[160:163]
  ds_read_b64_tr_b16 a[208:209], v242 offset:34816
  v_mfma_f32_16x16x32_bf16 v[160:163], a[180:183], a[40:43], v[160:163]
  ds_read_b64_tr_b16 a[210:211], v242 offset:38912
  v_mfma_f32_16x16x32_bf16 v[164:167], a[180:183], a[44:47], v[164:167]
  buffer_load_dwordx4 a[220:223], v137, s[36:39], s51 offen offset:1024 sc1
  s_lshl_b32 s50, s80, 16
  v_mfma_f32_16x16x32_bf16 v[164:167], a[176:179], a[36:39], v[164:167]
  s_waitcnt lgkmcnt(10)
  s_add_u32 m0, s73, 114688
  ds_read_b64_tr_b16 a[212:213], v242 offset:43008
  v_mfma_f32_16x16x32_bf16 v[172:175], a[184:187], a[36:39], v[172:175]
  ds_read_b64_tr_b16 a[214:215], v242 offset:47104
  ds_read_b64_tr_b16 a[176:177], v243 offset:34816
  v_mfma_f32_16x16x32_bf16 v[172:175], a[188:191], a[44:47], v[172:175]
  ds_read_b64_tr_b16 a[178:179], v243 offset:38912
  v_mfma_f32_16x16x32_bf16 v[168:171], a[188:191], a[40:43], v[168:171]
  buffer_load_dwordx4 v135, s[24:27], s50 offen offset:2048 lds
  ds_read_b64_tr_b16 a[180:181], v243 offset:43008
  v_mfma_f32_16x16x32_bf16 v[168:171], a[184:187], a[32:35], v[168:171]
  s_waitcnt vmcnt(27) lgkmcnt(11)
  ds_read_b64_tr_b16 a[182:183], v243 offset:47104
  v_mfma_f32_16x16x32_bf16 v[144:147], a[192:195], a[48:51], v[144:147]
  ds_read_b64_tr_b16 a[184:185], v240 offset:51200
  v_mfma_f32_16x16x32_bf16 v[144:147], a[196:199], a[56:59], v[144:147]
  ds_read_b64_tr_b16 a[186:187], v240 offset:55296
  v_mfma_f32_16x16x32_bf16 v[148:151], a[196:199], a[60:63], v[148:151]
  buffer_load_dwordx4 a[224:227], v137, s[36:39], s51 offen offset:2048 sc1
  ds_read_b64_tr_b16 a[188:189], v240 offset:59392
  v_mfma_f32_16x16x32_bf16 v[148:151], a[192:195], a[52:55], v[148:151]
  s_waitcnt lgkmcnt(11)
  ds_read_b64_tr_b16 a[190:191], v240 offset:63488
  v_mfma_f32_16x16x32_bf16 v[156:159], a[200:203], a[52:55], v[156:159]
  ds_read_b64_tr_b16 a[192:193], v241 offset:51200
  v_mfma_f32_16x16x32_bf16 v[156:159], a[204:207], a[60:63], v[156:159]
  ds_read_b64_tr_b16 a[194:195], v241 offset:55296
  v_mfma_f32_16x16x32_bf16 v[152:155], a[204:207], a[56:59], v[152:155]
  buffer_load_dwordx4 v136, s[24:27], s50 offen offset:3072 lds
  ds_read_b64_tr_b16 a[196:197], v241 offset:59392
  v_mfma_f32_16x16x32_bf16 v[152:155], a[200:203], a[48:51], v[152:155]
  s_waitcnt vmcnt(18) lgkmcnt(11)
  s_barrier
  ds_read_b64_tr_b16 a[198:199], v241 offset:63488
  v_mfma_f32_16x16x32_bf16 v[160:163], a[208:211], a[48:51], v[160:163]
  ds_read_b64_tr_b16 a[200:201], v242 offset:51200
  v_mfma_f32_16x16x32_bf16 v[160:163], a[212:215], a[56:59], v[160:163]
  ds_read_b64_tr_b16 a[202:203], v242 offset:55296
  v_mfma_f32_16x16x32_bf16 v[164:167], a[212:215], a[60:63], v[164:167]
  buffer_load_dwordx4 a[228:231], v137, s[36:39], s51 offen offset:3072 sc1
  s_lshl_b32 s50, s74, 16
  v_mfma_f32_16x16x32_bf16 v[164:167], a[208:211], a[52:55], v[164:167]
  s_waitcnt lgkmcnt(10)
  s_add_u32 m0, s73, 16384
  ds_read_b64_tr_b16 a[204:205], v242 offset:59392
  v_mfma_f32_16x16x32_bf16 v[172:175], a[176:179], a[52:55], v[172:175]
  ds_read_b64_tr_b16 a[206:207], v242 offset:63488
  ds_read_b64_tr_b16 a[208:209], v243 offset:51200
  v_mfma_f32_16x16x32_bf16 v[172:175], a[180:183], a[60:63], v[172:175]
  ds_read_b64_tr_b16 a[210:211], v243 offset:55296
  v_mfma_f32_16x16x32_bf16 v[168:171], a[180:183], a[56:59], v[168:171]
  buffer_load_dwordx4 v133, s[24:27], s50 offen offset:0 lds
  ds_read_b64_tr_b16 a[212:213], v243 offset:59392
  v_mfma_f32_16x16x32_bf16 v[168:171], a[176:179], a[48:51], v[168:171]
  s_waitcnt vmcnt(25) lgkmcnt(11)
  ds_read_b64_tr_b16 a[214:215], v243 offset:63488
  v_mfma_f32_16x16x32_bf16 v[144:147], a[184:187], a[64:67], v[144:147]
  ds_read_b64_tr_b16 a[176:177], v244 offset:2048
  v_mfma_f32_16x16x32_bf16 v[144:147], a[188:191], a[72:75], v[144:147]
  ds_read_b64_tr_b16 a[178:179], v244 offset:6144
  v_mfma_f32_16x16x32_bf16 v[148:151], a[188:191], a[76:79], v[148:151]
  buffer_load_dwordx4 v134, s[24:27], s50 offen offset:1024 lds
  s_lshl_b32 s50, s75, 16
  v_mfma_f32_16x16x32_bf16 v[148:151], a[184:187], a[68:71], v[148:151]
  s_waitcnt lgkmcnt(10)
  s_add_u32 m0, s73, 32768
  ds_read_b64_tr_b16 a[180:181], v244 offset:10240
  v_mfma_f32_16x16x32_bf16 v[156:159], a[192:195], a[68:71], v[156:159]
  ds_read_b64_tr_b16 a[182:183], v244 offset:14336
  ds_read_b64_tr_b16 a[184:185], v245 offset:2048
  v_mfma_f32_16x16x32_bf16 v[156:159], a[196:199], a[76:79], v[156:159]
  ds_read_b64_tr_b16 a[186:187], v245 offset:6144
  v_mfma_f32_16x16x32_bf16 v[152:155], a[196:199], a[72:75], v[152:155]
  buffer_load_dwordx4 v133, s[24:27], s50 offen offset:0 lds
  ds_read_b64_tr_b16 a[188:189], v245 offset:10240
  v_mfma_f32_16x16x32_bf16 v[152:155], a[192:195], a[64:67], v[152:155]
  s_waitcnt vmcnt(16) lgkmcnt(11)
  s_barrier
  ds_read_b64_tr_b16 a[190:191], v245 offset:14336
  v_mfma_f32_16x16x32_bf16 v[160:163], a[200:203], a[64:67], v[160:163]
  ds_read_b64_tr_b16 a[192:193], v246 offset:2048
  v_mfma_f32_16x16x32_bf16 v[160:163], a[204:207], a[72:75], v[160:163]
  ds_read_b64_tr_b16 a[194:195], v246 offset:6144
  v_mfma_f32_16x16x32_bf16 v[164:167], a[204:207], a[76:79], v[164:167]
  buffer_load_dwordx4 v134, s[24:27], s50 offen offset:1024 lds
  s_lshl_b32 s50, s76, 16
  v_mfma_f32_16x16x32_bf16 v[164:167], a[200:203], a[68:71], v[164:167]
  s_waitcnt lgkmcnt(10)
  s_add_u32 m0, s73, 49152
  ds_read_b64_tr_b16 a[196:197], v246 offset:10240
  v_mfma_f32_16x16x32_bf16 v[172:175], a[208:211], a[68:71], v[172:175]
  ds_read_b64_tr_b16 a[198:199], v246 offset:14336
  ds_read_b64_tr_b16 a[200:201], v247 offset:2048
  v_mfma_f32_16x16x32_bf16 v[172:175], a[212:215], a[76:79], v[172:175]
  ds_read_b64_tr_b16 a[202:203], v247 offset:6144
  v_mfma_f32_16x16x32_bf16 v[168:171], a[212:215], a[72:75], v[168:171]
  buffer_load_dwordx4 v133, s[24:27], s50 offen offset:0 lds
  ds_read_b64_tr_b16 a[204:205], v247 offset:10240
  v_mfma_f32_16x16x32_bf16 v[168:171], a[208:211], a[64:67], v[168:171]
  s_waitcnt vmcnt(23) lgkmcnt(11)
  ds_read_b64_tr_b16 a[206:207], v247 offset:14336
  v_mfma_f32_16x16x32_bf16 v[144:147], a[176:179], a[80:83], v[144:147]
  ds_read_b64_tr_b16 a[208:209], v244 offset:18432
  v_mfma_f32_16x16x32_bf16 v[144:147], a[180:183], a[88:91], v[144:147]
  ds_read_b64_tr_b16 a[210:211], v244 offset:22528
  v_mfma_f32_16x16x32_bf16 v[148:151], a[180:183], a[92:95], v[148:151]
  buffer_load_dwordx4 v134, s[24:27], s50 offen offset:1024 lds
  s_lshl_b32 s50, s77, 16
  v_mfma_f32_16x16x32_bf16 v[148:151], a[176:179], a[84:87], v[148:151]
  s_waitcnt lgkmcnt(10)
  s_add_u32 m0, s73, 65536
  ds_read_b64_tr_b16 a[212:213], v244 offset:26624
  v_mfma_f32_16x16x32_bf16 v[156:159], a[184:187], a[84:87], v[156:159]
  ds_read_b64_tr_b16 a[214:215], v244 offset:30720
  ds_read_b64_tr_b16 a[176:177], v245 offset:18432
  v_mfma_f32_16x16x32_bf16 v[156:159], a[188:191], a[92:95], v[156:159]
  ds_read_b64_tr_b16 a[178:179], v245 offset:22528
  v_mfma_f32_16x16x32_bf16 v[152:155], a[188:191], a[88:91], v[152:155]
  buffer_load_dwordx4 v133, s[24:27], s50 offen offset:0 lds
  ds_read_b64_tr_b16 a[180:181], v245 offset:26624
  v_mfma_f32_16x16x32_bf16 v[152:155], a[184:187], a[80:83], v[152:155]
  s_waitcnt vmcnt(14) lgkmcnt(11)
  s_barrier
  ds_read_b64_tr_b16 a[182:183], v245 offset:30720
  v_mfma_f32_16x16x32_bf16 v[160:163], a[192:195], a[80:83], v[160:163]
  ds_read_b64_tr_b16 a[184:185], v246 offset:18432
  v_mfma_f32_16x16x32_bf16 v[160:163], a[196:199], a[88:91], v[160:163]
  ds_read_b64_tr_b16 a[186:187], v246 offset:22528
  v_mfma_f32_16x16x32_bf16 v[164:167], a[196:199], a[92:95], v[164:167]
  buffer_load_dwordx4 v134, s[24:27], s50 offen offset:1024 lds
  s_lshl_b32 s50, s78, 16
  v_mfma_f32_16x16x32_bf16 v[164:167], a[192:195], a[84:87], v[164:167]
  s_waitcnt lgkmcnt(10)
  s_add_u32 m0, s73, 81920
  ds_read_b64_tr_b16 a[188:189], v246 offset:26624
  v_mfma_f32_16x16x32_bf16 v[172:175], a[200:203], a[84:87], v[172:175]
  ds_read_b64_tr_b16 a[190:191], v246 offset:30720
  ds_read_b64_tr_b16 a[192:193], v247 offset:18432
  v_mfma_f32_16x16x32_bf16 v[172:175], a[204:207], a[92:95], v[172:175]
  ds_read_b64_tr_b16 a[194:195], v247 offset:22528
  v_mfma_f32_16x16x32_bf16 v[168:171], a[204:207], a[88:91], v[168:171]
  buffer_load_dwordx4 v133, s[24:27], s50 offen offset:0 lds
  ds_read_b64_tr_b16 a[196:197], v247 offset:26624
  v_mfma_f32_16x16x32_bf16 v[168:171], a[200:203], a[80:83], v[168:171]
  s_waitcnt vmcnt(21) lgkmcnt(11)
  ds_read_b64_tr_b16 a[198:199], v247 offset:30720
  v_mfma_f32_16x16x32_bf16 v[144:147], a[208:211], a[96:99], v[144:147]
  ds_read_b64_tr_b16 a[200:201], v244 offset:34816
  v_mfma_f32_16x16x32_bf16 v[144:147], a[212:215], a[104:107], v[144:147]
  ds_read_b64_tr_b16 a[202:203], v244 offset:38912
  v_mfma_f32_16x16x32_bf16 v[148:151], a[212:215], a[108:111], v[148:151]
  buffer_load_dwordx4 v134, s[24:27], s50 offen offset:1024 lds
  s_lshl_b32 s50, s79, 16
  v_mfma_f32_16x16x32_bf16 v[148:151], a[208:211], a[100:103], v[148:151]
  s_waitcnt lgkmcnt(10)
  s_add_u32 m0, s73, 98304
  ds_read_b64_tr_b16 a[204:205], v244 offset:43008
  v_mfma_f32_16x16x32_bf16 v[156:159], a[176:179], a[100:103], v[156:159]
  ds_read_b64_tr_b16 a[206:207], v244 offset:47104
  ds_read_b64_tr_b16 a[208:209], v245 offset:34816
  v_mfma_f32_16x16x32_bf16 v[156:159], a[180:183], a[108:111], v[156:159]
  ds_read_b64_tr_b16 a[210:211], v245 offset:38912
  v_mfma_f32_16x16x32_bf16 v[152:155], a[180:183], a[104:107], v[152:155]
  buffer_load_dwordx4 v133, s[24:27], s50 offen offset:0 lds
  ds_read_b64_tr_b16 a[212:213], v245 offset:43008
  v_mfma_f32_16x16x32_bf16 v[152:155], a[176:179], a[96:99], v[152:155]
  s_waitcnt vmcnt(12) lgkmcnt(11)
  s_barrier
  ds_read_b64_tr_b16 a[214:215], v245 offset:47104
  v_mfma_f32_16x16x32_bf16 v[160:163], a[184:187], a[96:99], v[160:163]
  ds_read_b64_tr_b16 a[176:177], v246 offset:34816
  v_mfma_f32_16x16x32_bf16 v[160:163], a[188:191], a[104:107], v[160:163]
  ds_read_b64_tr_b16 a[178:179], v246 offset:38912
  v_mfma_f32_16x16x32_bf16 v[164:167], a[188:191], a[108:111], v[164:167]
  buffer_load_dwordx4 v134, s[24:27], s50 offen offset:1024 lds
  s_lshl_b32 s50, s80, 16
  v_mfma_f32_16x16x32_bf16 v[164:167], a[184:187], a[100:103], v[164:167]
  s_waitcnt lgkmcnt(10)
  s_add_u32 m0, s73, 114688
  ds_read_b64_tr_b16 a[180:181], v246 offset:43008
  v_mfma_f32_16x16x32_bf16 v[172:175], a[192:195], a[100:103], v[172:175]
  ds_read_b64_tr_b16 a[182:183], v246 offset:47104
  ds_read_b64_tr_b16 a[184:185], v247 offset:34816
  v_mfma_f32_16x16x32_bf16 v[172:175], a[196:199], a[108:111], v[172:175]
  ds_read_b64_tr_b16 a[186:187], v247 offset:38912
  v_mfma_f32_16x16x32_bf16 v[168:171], a[196:199], a[104:107], v[168:171]
  buffer_load_dwordx4 v133, s[24:27], s50 offen offset:0 lds
  ds_read_b64_tr_b16 a[188:189], v247 offset:43008
  v_mfma_f32_16x16x32_bf16 v[168:171], a[192:195], a[96:99], v[168:171]
  s_waitcnt vmcnt(19) lgkmcnt(11)
  ds_read_b64_tr_b16 a[190:191], v247 offset:47104
  v_mfma_f32_16x16x32_bf16 v[144:147], a[200:203], a[112:115], v[144:147]
  ds_read_b64_tr_b16 a[192:193], v244 offset:51200
  v_mfma_f32_16x16x32_bf16 v[144:147], a[204:207], a[120:123], v[144:147]
  ds_read_b64_tr_b16 a[194:195], v244 offset:55296
  v_mfma_f32_16x16x32_bf16 v[148:151], a[204:207], a[124:127], v[148:151]
  buffer_load_dwordx4 v134, s[24:27], s50 offen offset:1024 lds
  ds_read_b64_tr_b16 a[196:197], v244 offset:59392
  v_mfma_f32_16x16x32_bf16 v[148:151], a[200:203], a[116:119], v[148:151]
  s_waitcnt lgkmcnt(11)
  ds_read_b64_tr_b16 a[198:199], v244 offset:63488
  v_mfma_f32_16x16x32_bf16 v[156:159], a[208:211], a[116:119], v[156:159]
  ds_read_b64_tr_b16 a[200:201], v245 offset:51200
  v_mfma_f32_16x16x32_bf16 v[156:159], a[212:215], a[124:127], v[156:159]
  ds_read_b64_tr_b16 a[202:203], v245 offset:55296
  v_mfma_f32_16x16x32_bf16 v[152:155], a[212:215], a[120:123], v[152:155]
  ds_read_b64_tr_b16 a[204:205], v245 offset:59392
  v_mfma_f32_16x16x32_bf16 v[152:155], a[208:211], a[112:115], v[152:155]
  s_waitcnt vmcnt(12) lgkmcnt(11)
  s_barrier
  ds_read_b64_tr_b16 a[206:207], v245 offset:63488
  v_mfma_f32_16x16x32_bf16 v[160:163], a[176:179], a[112:115], v[160:163]
  ds_read_b64_tr_b16 a[208:209], v246 offset:51200
  v_mfma_f32_16x16x32_bf16 v[160:163], a[180:183], a[120:123], v[160:163]
  ds_read_b64_tr_b16 a[210:211], v246 offset:55296
  v_mfma_f32_16x16x32_bf16 v[164:167], a[180:183], a[124:127], v[164:167]
  ds_read_b64_tr_b16 a[212:213], v246 offset:59392
  v_mfma_f32_16x16x32_bf16 v[164:167], a[176:179], a[116:119], v[164:167]
  s_waitcnt lgkmcnt(11)
  ds_read_b64_tr_b16 a[214:215], v246 offset:63488
  v_mfma_f32_16x16x32_bf16 v[172:175], a[184:187], a[116:119], v[172:175]
  ds_read_b64_tr_b16 a[176:177], v247 offset:51200
  v_mfma_f32_16x16x32_bf16 v[172:175], a[188:191], a[124:127], v[172:175]
  ds_read_b64_tr_b16 a[178:179], v247 offset:55296
  v_mfma_f32_16x16x32_bf16 v[168:171], a[188:191], a[120:123], v[168:171]
  ds_read_b64_tr_b16 a[180:181], v247 offset:59392
  v_mfma_f32_16x16x32_bf16 v[168:171], a[184:187], a[112:115], v[168:171]
  s_waitcnt vmcnt(14) lgkmcnt(11)
  ds_read_b64_tr_b16 a[182:183], v247 offset:63488
  v_mfma_f32_16x16x32_bf16 v[144:147], a[192:195], a[216:219], v[144:147]
  ds_read_b64_tr_b16 a[184:185], v240 offset:16384
  v_mfma_f32_16x16x32_bf16 v[144:147], a[196:199], a[224:227], v[144:147]
  ds_read_b64_tr_b16 a[186:187], v240 offset:20480
  v_mfma_f32_16x16x32_bf16 v[148:151], a[196:199], a[228:231], v[148:151]
  ds_read_b64_tr_b16 a[188:189], v240 offset:24576
  v_mfma_f32_16x16x32_bf16 v[148:151], a[192:195], a[220:223], v[148:151]
  s_waitcnt lgkmcnt(11)
  ds_read_b64_tr_b16 a[190:191], v240 offset:28672
  v_mfma_f32_16x16x32_bf16 v[156:159], a[200:203], a[220:223], v[156:159]
  ds_read_b64_tr_b16 a[192:193], v241 offset:16384
  v_mfma_f32_16x16x32_bf16 v[156:159], a[204:207], a[228:231], v[156:159]
  ds_read_b64_tr_b16 a[194:195], v241 offset:20480
  v_mfma_f32_16x16x32_bf16 v[152:155], a[204:207], a[224:227], v[152:155]
  ds_read_b64_tr_b16 a[196:197], v241 offset:24576
  v_mfma_f32_16x16x32_bf16 v[152:155], a[200:203], a[216:219], v[152:155]
  s_waitcnt vmcnt(10) lgkmcnt(11)
  s_barrier
  ds_read_b64_tr_b16 a[198:199], v241 offset:28672
  v_mfma_f32_16x16x32_bf16 v[160:163], a[208:211], a[216:219], v[160:163]
  ds_read_b64_tr_b16 a[200:201], v242 offset:16384
  buffer_store_dwordx4 v[144:147], v0, s[36:39], s60 offen offset:0 sc1
  v_mfma_f32_16x16x32_bf16 v[160:163], a[212:215], a[224:227], v[160:163]
  buffer_store_dwordx4 v[148:151], v0, s[36:39], s60 offen offset:1024 sc1
  ds_read_b64_tr_b16 a[202:203], v242 offset:20480
  v_mfma_f32_16x16x32_bf16 v[164:167], a[212:215], a[228:231], v[164:167]
  ds_read_b64_tr_b16 a[204:205], v242 offset:24576
  v_mfma_f32_16x16x32_bf16 v[164:167], a[208:211], a[220:223], v[164:167]
  s_waitcnt lgkmcnt(11)
  ds_read_b64_tr_b16 a[206:207], v242 offset:28672
  v_mfma_f32_16x16x32_bf16 v[172:175], a[176:179], a[220:223], v[172:175]
  ds_read_b64_tr_b16 a[208:209], v243 offset:16384
  buffer_store_dwordx4 v[152:155], v0, s[36:39], s60 offen offset:2048 sc1
  v_mfma_f32_16x16x32_bf16 v[172:175], a[180:183], a[228:231], v[172:175]
  buffer_store_dwordx4 v[156:159], v0, s[36:39], s60 offen offset:3072 sc1
  ds_read_b64_tr_b16 a[210:211], v243 offset:20480
  v_mfma_f32_16x16x32_bf16 v[168:171], a[180:183], a[224:227], v[168:171]
  ds_read_b64_tr_b16 a[212:213], v243 offset:24576
  v_mfma_f32_16x16x32_bf16 v[168:171], a[176:179], a[216:219], v[168:171]
  s_waitcnt lgkmcnt(11)
  ds_read_b64_tr_b16 a[214:215], v243 offset:28672
  v_mfma_f32_16x16x32_bf16 v[32:35], a[184:187], a[32:35], v[32:35]
  ds_read_b64_tr_b16 a[176:177], v240 offset:32768
  buffer_store_dwordx4 v[160:163], v0, s[36:39], s61 offen offset:0 sc1
  v_mfma_f32_16x16x32_bf16 v[32:35], a[188:191], a[40:43], v[32:35]
  buffer_store_dwordx4 v[164:167], v0, s[36:39], s61 offen offset:1024 sc1
  ds_read_b64_tr_b16 a[178:179], v240 offset:36864
  v_mfma_f32_16x16x32_bf16 v[36:39], a[188:191], a[44:47], v[36:39]
  ds_read_b64_tr_b16 a[180:181], v240 offset:40960
  v_mfma_f32_16x16x32_bf16 v[36:39], a[184:187], a[36:39], v[36:39]
  s_waitcnt lgkmcnt(11)
  ds_read_b64_tr_b16 a[182:183], v240 offset:45056
  v_mfma_f32_16x16x32_bf16 v[44:47], a[192:195], a[36:39], v[44:47]
Hb2_3:
  s_cbranch_execz Rb
  ds_read_b64_tr_b16 a[184:185], v241 offset:32768
  buffer_store_dwordx4 v[168:171], v0, s[36:39], s61 offen offset:2048 sc1
  v_mfma_f32_16x16x32_bf16 v[44:47], a[196:199], a[44:47], v[44:47]
  buffer_store_dwordx4 v[172:175], v0, s[36:39], s61 offen offset:3072 sc1
  ds_read_b64_tr_b16 a[186:187], v241 offset:36864
  v_mfma_f32_16x16x32_bf16 v[40:43], a[196:199], a[40:43], v[40:43]
  ds_read_b64_tr_b16 a[188:189], v241 offset:40960
  v_mfma_f32_16x16x32_bf16 v[40:43], a[192:195], a[32:35], v[40:43]
  s_waitcnt vmcnt(16) lgkmcnt(11)
  s_barrier
  ds_read_b64_tr_b16 a[190:191], v241 offset:45056
  v_mfma_f32_16x16x32_bf16 v[48:51], a[200:203], a[32:35], v[48:51]
  ds_read_b64_tr_b16 a[192:193], v242 offset:32768
  v_mfma_f32_16x16x32_bf16 v[48:51], a[204:207], a[40:43], v[48:51]
  ds_read_b64_tr_b16 a[194:195], v242 offset:36864
  v_mfma_f32_16x16x32_bf16 v[52:55], a[204:207], a[44:47], v[52:55]
  ds_read_b64_tr_b16 a[196:197], v242 offset:40960
  v_mfma_f32_16x16x32_bf16 v[52:55], a[200:203], a[36:39], v[52:55]
  s_waitcnt lgkmcnt(11)
  ds_read_b64_tr_b16 a[198:199], v242 offset:45056
  v_mfma_f32_16x16x32_bf16 v[60:63], a[208:211], a[36:39], v[60:63]
  ds_read_b64_tr_b16 a[200:201], v243 offset:32768
  v_mfma_f32_16x16x32_bf16 v[60:63], a[212:215], a[44:47], v[60:63]
  ds_read_b64_tr_b16 a[202:203], v243 offset:36864
  v_mfma_f32_16x16x32_bf16 v[56:59], a[212:215], a[40:43], v[56:59]
  ds_read_b64_tr_b16 a[204:205], v243 offset:40960
  v_mfma_f32_16x16x32_bf16 v[56:59], a[208:211], a[32:35], v[56:59]
  s_waitcnt lgkmcnt(11)
  ds_read_b64_tr_b16 a[206:207], v243 offset:45056
  v_mfma_f32_16x16x32_bf16 v[32:35], a[176:179], a[48:51], v[32:35]
  ds_read_b64_tr_b16 a[208:209], v240 offset:49152
  v_mfma_f32_16x16x32_bf16 v[32:35], a[180:183], a[56:59], v[32:35]
  ds_read_b64_tr_b16 a[210:211], v240 offset:53248
  v_mfma_f32_16x16x32_bf16 v[36:39], a[180:183], a[60:63], v[36:39]
  ds_read_b64_tr_b16 a[212:213], v240 offset:57344
  v_mfma_f32_16x16x32_bf16 v[36:39], a[176:179], a[52:55], v[36:39]
  s_waitcnt lgkmcnt(11)
  ds_read_b64_tr_b16 a[214:215], v240 offset:61440
  v_mfma_f32_16x16x32_bf16 v[44:47], a[184:187], a[52:55], v[44:47]
  ds_read_b64_tr_b16 a[176:177], v241 offset:49152
  v_mfma_f32_16x16x32_bf16 v[44:47], a[188:191], a[60:63], v[44:47]
  ds_read_b64_tr_b16 a[178:179], v241 offset:53248
  v_mfma_f32_16x16x32_bf16 v[40:43], a[188:191], a[56:59], v[40:43]
  ds_read_b64_tr_b16 a[180:181], v241 offset:57344
  v_mfma_f32_16x16x32_bf16 v[40:43], a[184:187], a[48:51], v[40:43]
  s_waitcnt vmcnt(14) lgkmcnt(11)
  s_barrier
  ds_read_b64_tr_b16 a[182:183], v241 offset:61440
  v_mfma_f32_16x16x32_bf16 v[48:51], a[192:195], a[48:51], v[48:51]
  ds_read_b64_tr_b16 a[184:185], v242 offset:49152
  v_mfma_f32_16x16x32_bf16 v[48:51], a[196:199], a[56:59], v[48:51]
  ds_read_b64_tr_b16 a[186:187], v242 offset:53248
  v_mfma_f32_16x16x32_bf16 v[52:55], a[196:199], a[60:63], v[52:55]
  ds_read_b64_tr_b16 a[188:189], v242 offset:57344
  v_mfma_f32_16x16x32_bf16 v[52:55], a[192:195], a[52:55], v[52:55]
  s_waitcnt lgkmcnt(11)
  ds_read_b64_tr_b16 a[190:191], v242 offset:61440
  v_mfma_f32_16x16x32_bf16 v[60:63], a[200:203], a[52:55], v[60:63]
  ds_read_b64_tr_b16 a[192:193], v243 offset:49152
  v_mfma_f32_16x16x32_bf16 v[60:63], a[204:207], a[60:63], v[60:63]
  ds_read_b64_tr_b16 a[194:195], v243 offset:53248
  v_mfma_f32_16x16x32_bf16 v[56:59], a[204:207], a[56:59], v[56:59]
  ds_read_b64_tr_b16 a[196:197], v243 offset:57344
  v_mfma_f32_16x16x32_bf16 v[56:59], a[200:203], a[48:51], v[56:59]
  s_waitcnt lgkmcnt(11)
  ds_read_b64_tr_b16 a[198:199], v243 offset:61440
  v_mfma_f32_16x16x32_bf16 v[32:35], a[208:211], a[64:67], v[32:35]
  ds_read_b64_tr_b16 a[200:201], v244 offset:0
  v_mfma_f32_16x16x32_bf16 v[32:35], a[212:215], a[72:75], v[32:35]
  ds_read_b64_tr_b16 a[202:203], v244 offset:4096
  v_mfma_f32_16x16x32_bf16 v[36:39], a[212:215], a[76:79], v[36:39]
  ds_read_b64_tr_b16 a[204:205], v244 offset:8192
  v_mfma_f32_16x16x32_bf16 v[36:39], a[208:211], a[68:71], v[36:39]
  s_waitcnt lgkmcnt(11)
  ds_read_b64_tr_b16 a[206:207], v244 offset:12288
  v_mfma_f32_16x16x32_bf16 v[44:47], a[176:179], a[68:71], v[44:47]
  ds_read_b64_tr_b16 a[208:209], v245 offset:0
  v_mfma_f32_16x16x32_bf16 v[44:47], a[180:183], a[76:79], v[44:47]
  ds_read_b64_tr_b16 a[210:211], v245 offset:4096
  v_mfma_f32_16x16x32_bf16 v[40:43], a[180:183], a[72:75], v[40:43]
  ds_read_b64_tr_b16 a[212:213], v245 offset:8192
  v_mfma_f32_16x16x32_bf16 v[40:43], a[176:179], a[64:67], v[40:43]
  s_waitcnt vmcnt(12) lgkmcnt(11)
  s_barrier
  ds_read_b64_tr_b16 a[214:215], v245 offset:12288
  v_mfma_f32_16x16x32_bf16 v[48:51], a[184:187], a[64:67], v[48:51]
  ds_read_b64_tr_b16 a[176:177], v246 offset:0
  v_mfma_f32_16x16x32_bf16 v[48:51], a[188:191], a[72:75], v[48:51]
  ds_read_b64_tr_b16 a[178:179], v246 offset:4096
  v_mfma_f32_16x16x32_bf16 v[52:55], a[188:191], a[76:79], v[52:55]
  ds_read_b64_tr_b16 a[180:181], v246 offset:8192
  v_mfma_f32_16x16x32_bf16 v[52:55], a[184:187], a[68:71], v[52:55]
  s_waitcnt lgkmcnt(11)
  ds_read_b64_tr_b16 a[182:183], v246 offset:12288
  v_mfma_f32_16x16x32_bf16 v[60:63], a[192:195], a[68:71], v[60:63]
  ds_read_b64_tr_b16 a[184:185], v247 offset:0
  v_mfma_f32_16x16x32_bf16 v[60:63], a[196:199], a[76:79], v[60:63]
  ds_read_b64_tr_b16 a[186:187], v247 offset:4096
  v_mfma_f32_16x16x32_bf16 v[56:59], a[196:199], a[72:75], v[56:59]
  ds_read_b64_tr_b16 a[188:189], v247 offset:8192
  v_mfma_f32_16x16x32_bf16 v[56:59], a[192:195], a[64:67], v[56:59]
  s_waitcnt lgkmcnt(11)
  ds_read_b64_tr_b16 a[190:191], v247 offset:12288
  v_mfma_f32_16x16x32_bf16 v[32:35], a[200:203], a[80:83], v[32:35]
  s_waitcnt vmcnt(0)
  ds_read_b64_tr_b16 a[192:193], v244 offset:16384
  s_mov_b64 exec, 1
  buffer_store_dword v254, v0, s[36:39], s67 offen sc1
  s_mov_b64 exec, -1
  v_mfma_f32_16x16x32_bf16 v[32:35], a[204:207], a[88:91], v[32:35]
  ds_read_b64_tr_b16 a[194:195], v244 offset:20480
  v_mfma_f32_16x16x32_bf16 v[36:39], a[204:207], a[92:95], v[36:39]
  ds_read_b64_tr_b16 a[196:197], v244 offset:24576
  v_mfma_f32_16x16x32_bf16 v[36:39], a[200:203], a[84:87], v[36:39]
  s_waitcnt lgkmcnt(11)
  ds_read_b64_tr_b16 a[198:199], v244 offset:28672
  v_mfma_f32_16x16x32_bf16 v[44:47], a[208:211], a[84:87], v[44:47]
  ds_read_b64_tr_b16 a[200:201], v245 offset:16384
  buffer_load_dword v139, v132, s[36:39], s68 offen sc1
  v_mfma_f32_16x16x32_bf16 v[44:47], a[212:215], a[92:95], v[44:47]
  ds_read_b64_tr_b16 a[202:203], v245 offset:20480
  v_mfma_f32_16x16x32_bf16 v[40:43], a[212:215], a[88:91], v[40:43]
  ds_read_b64_tr_b16 a[204:205], v245 offset:24576
  v_mfma_f32_16x16x32_bf16 v[40:43], a[208:211], a[80:83], v[40:43]
  s_waitcnt vmcnt(12) lgkmcnt(11)
  s_barrier
  ds_read_b64_tr_b16 a[206:207], v245 offset:28672
  v_mfma_f32_16x16x32_bf16 v[48:51], a[176:179], a[80:83], v[48:51]
  ds_read_b64_tr_b16 a[208:209], v246 offset:16384
  v_mfma_f32_16x16x32_bf16 v[48:51], a[180:183], a[88:91], v[48:51]
  ds_read_b64_tr_b16 a[210:211], v246 offset:20480
  v_mfma_f32_16x16x32_bf16 v[52:55], a[180:183], a[92:95], v[52:55]
  ds_read_b64_tr_b16 a[212:213], v246 offset:24576
  v_mfma_f32_16x16x32_bf16 v[52:55], a[176:179], a[84:87], v[52:55]
  s_waitcnt lgkmcnt(11)
  ds_read_b64_tr_b16 a[214:215], v246 offset:28672
  v_mfma_f32_16x16x32_bf16 v[60:63], a[184:187], a[84:87], v[60:63]
  ds_read_b64_tr_b16 a[176:177], v247 offset:16384
  v_mfma_f32_16x16x32_bf16 v[60:63], a[188:191], a[92:95], v[60:63]
  ds_read_b64_tr_b16 a[178:179], v247 offset:20480
  v_mfma_f32_16x16x32_bf16 v[56:59], a[188:191], a[88:91], v[56:59]
  ds_read_b64_tr_b16 a[180:181], v247 offset:24576
  v_mfma_f32_16x16x32_bf16 v[56:59], a[184:187], a[80:83], v[56:59]
  s_waitcnt lgkmcnt(11)
  ds_read_b64_tr_b16 a[182:183], v247 offset:28672
  v_mfma_f32_16x16x32_bf16 v[32:35], a[192:195], a[96:99], v[32:35]
  ds_read_b64_tr_b16 a[184:185], v244 offset:32768
  v_mfma_f32_16x16x32_bf16 v[32:35], a[196:199], a[104:107], v[32:35]
  ds_read_b64_tr_b16 a[186:187], v244 offset:36864
  v_mfma_f32_16x16x32_bf16 v[36:39], a[196:199], a[108:111], v[36:39]
  ds_read_b64_tr_b16 a[188:189], v244 offset:40960
  v_mfma_f32_16x16x32_bf16 v[36:39], a[192:195], a[100:103], v[36:39]
  s_waitcnt lgkmcnt(11)
  ds_read_b64_tr_b16 a[190:191], v244 offset:45056
  v_mfma_f32_16x16x32_bf16 v[44:47], a[200:203], a[100:103], v[44:47]
  ds_read_b64_tr_b16 a[192:193], v245 offset:32768
  v_mfma_f32_16x16x32_bf16 v[44:47], a[204:207], a[108:111], v[44:47]
  ds_read_b64_tr_b16 a[194:195], v245 offset:36864
  v_mfma_f32_16x16x32_bf16 v[40:43], a[204:207], a[104:107], v[40:43]
  ds_read_b64_tr_b16 a[196:197], v245 offset:40960
  v_mfma_f32_16x16x32_bf16 v[40:43], a[200:203], a[96:99], v[40:43]
  s_waitcnt vmcnt(10) lgkmcnt(11)
  s_barrier
  ds_read_b64_tr_b16 a[198:199], v245 offset:45056
  v_mfma_f32_16x16x32_bf16 v[48:51], a[208:211], a[96:99], v[48:51]
  ds_read_b64_tr_b16 a[200:201], v246 offset:32768
  v_mfma_f32_16x16x32_bf16 v[48:51], a[212:215], a[104:107], v[48:51]
  ds_read_b64_tr_b16 a[202:203], v246 offset:36864
  v_mfma_f32_16x16x32_bf16 v[52:55], a[212:215], a[108:111], v[52:55]
  ds_read_b64_tr_b16 a[204:205], v246 offset:40960
  v_mfma_f32_16x16x32_bf16 v[52:55], a[208:211], a[100:103], v[52:55]
  s_waitcnt lgkmcnt(11)
  ds_read_b64_tr_b16 a[206:207], v246 offset:45056
  v_mfma_f32_16x16x32_bf16 v[60:63], a[176:179], a[100:103], v[60:63]
  ds_read_b64_tr_b16 a[208:209], v247 offset:32768
  v_mfma_f32_16x16x32_bf16 v[60:63], a[180:183], a[108:111], v[60:63]
  ds_read_b64_tr_b16 a[210:211], v247 offset:36864
  v_mfma_f32_16x16x32_bf16 v[56:59], a[180:183], a[104:107], v[56:59]
  s_waitcnt vmcnt(0)
  ds_read_b64_tr_b16 a[212:213], v247 offset:40960
  v_readfirstlane_b32 s69, v139
  v_mfma_f32_16x16x32_bf16 v[56:59], a[176:179], a[96:99], v[56:59]
  s_waitcnt lgkmcnt(11)
  ds_read_b64_tr_b16 a[214:215], v247 offset:45056
  s_nop 0
  v_mfma_f32_16x16x32_bf16 v[32:35], a[184:187], a[112:115], v[32:35]
  s_cmp_eq_u32 s69, 1
  ds_read_b64_tr_b16 a[176:177], v244 offset:49152
  s_cselect_b32 s85, s62, 1073741824
  v_mfma_f32_16x16x32_bf16 v[32:35], a[188:191], a[120:123], v[32:35]
  s_cselect_b32 s90, s63, 1073741824
  ds_read_b64_tr_b16 a[178:179], v244 offset:53248
  buffer_load_dwordx4 v[96:99], v0, s[36:39], s85 offen offset:0 sc1
  v_mfma_f32_16x16x32_bf16 v[36:39], a[188:191], a[124:127], v[36:39]
  ds_read_b64_tr_b16 a[180:181], v244 offset:57344
  v_mfma_f32_16x16x32_bf16 v[36:39], a[184:187], a[116:119], v[36:39]
  s_waitcnt lgkmcnt(11)
  ds_read_b64_tr_b16 a[182:183], v244 offset:61440
  v_mfma_f32_16x16x32_bf16 v[44:47], a[192:195], a[116:119], v[44:47]
  ds_read_b64_tr_b16 a[184:185], v245 offset:49152
  buffer_load_dwordx4 v[100:103], v0, s[36:39], s85 offen offset:1024 sc1
  v_mfma_f32_16x16x32_bf16 v[44:47], a[196:199], a[124:127], v[44:47]
  ds_read_b64_tr_b16 a[186:187], v245 offset:53248
  v_mfma_f32_16x16x32_bf16 v[40:43], a[196:199], a[120:123], v[40:43]
  ds_read_b64_tr_b16 a[188:189], v245 offset:57344
  v_mfma_f32_16x16x32_bf16 v[40:43], a[192:195], a[112:115], v[40:43]
  s_waitcnt lgkmcnt(11)
  buffer_load_dwordx4 v[104:107], v0, s[36:39], s85 offen offset:2048 sc1
  ds_read_b64_tr_b16 a[190:191], v245 offset:61440
  v_mfma_f32_16x16x32_bf16 v[48:51], a[200:203], a[112:115], v[48:51]
  ds_read_b64_tr_b16 a[192:193], v246 offset:49152
  v_mfma_f32_16x16x32_bf16 v[48:51], a[204:207], a[120:123], v[48:51]
  buffer_load_dwordx4 v[108:111], v0, s[36:39], s85 offen offset:3072 sc1
  ds_read_b64_tr_b16 a[194:195], v246 offset:53248
  v_mfma_f32_16x16x32_bf16 v[52:55], a[204:207], a[124:127], v[52:55]
  ds_read_b64_tr_b16 a[196:197], v246 offset:57344
  v_mfma_f32_16x16x32_bf16 v[52:55], a[200:203], a[116:119], v[52:55]
  s_waitcnt lgkmcnt(11)
  buffer_load_dwordx4 v[112:115], v0, s[36:39], s90 offen offset:0 sc1
  ds_read_b64_tr_b16 a[198:199], v246 offset:61440
  v_mfma_f32_16x16x32_bf16 v[60:63], a[208:211], a[116:119], v[60:63]
  ds_read_b64_tr_b16 a[200:201], v247 offset:49152
  v_mfma_f32_16x16x32_bf16 v[60:63], a[212:215], a[124:127], v[60:63]
  buffer_load_dwordx4 v[116:119], v0, s[36:39], s90 offen offset:1024 sc1
  ds_read_b64_tr_b16 a[202:203], v247 offset:53248
  v_mfma_f32_16x16x32_bf16 v[56:59], a[212:215], a[120:123], v[56:59]
  ds_read_b64_tr_b16 a[204:205], v247 offset:57344
  v_mfma_f32_16x16x32_bf16 v[56:59], a[208:211], a[112:115], v[56:59]
  s_waitcnt lgkmcnt(11)
  buffer_load_dwordx4 v[120:123], v0, s[36:39], s90 offen offset:2048 sc1
  ds_read_b64_tr_b16 a[206:207], v247 offset:61440
  v_mfma_f32_16x16x32_bf16 v[32:35], a[176:179], a[216:219], v[32:35]
  v_mfma_f32_16x16x32_bf16 v[32:35], a[180:183], a[224:227], v[32:35]
  buffer_load_dwordx4 v[124:127], v0, s[36:39], s90 offen offset:3072 sc1
  v_mfma_f32_16x16x32_bf16 v[36:39], a[180:183], a[228:231], v[36:39]
  v_mfma_f32_16x16x32_bf16 v[36:39], a[176:179], a[220:223], v[36:39]
  s_waitcnt lgkmcnt(8)
  v_mfma_f32_16x16x32_bf16 v[44:47], a[184:187], a[220:223], v[44:47]
  v_mfma_f32_16x16x32_bf16 v[44:47], a[188:191], a[228:231], v[44:47]
  v_mfma_f32_16x16x32_bf16 v[40:43], a[188:191], a[224:227], v[40:43]
  v_mfma_f32_16x16x32_bf16 v[40:43], a[184:187], a[216:219], v[40:43]
  s_waitcnt lgkmcnt(4)
  v_mfma_f32_16x16x32_bf16 v[48:51], a[192:195], a[216:219], v[48:51]
  v_mfma_f32_16x16x32_bf16 v[48:51], a[196:199], a[224:227], v[48:51]
  v_mfma_f32_16x16x32_bf16 v[52:55], a[196:199], a[228:231], v[52:55]
  v_mfma_f32_16x16x32_bf16 v[52:55], a[192:195], a[220:223], v[52:55]
  s_waitcnt lgkmcnt(0)
  v_mfma_f32_16x16x32_bf16 v[60:63], a[200:203], a[220:223], v[60:63]
  v_mfma_f32_16x16x32_bf16 v[60:63], a[204:207], a[228:231], v[60:63]
  v_mfma_f32_16x16x32_bf16 v[56:59], a[204:207], a[224:227], v[56:59]
  v_mfma_f32_16x16x32_bf16 v[56:59], a[200:203], a[216:219], v[56:59]
  s_cmp_eq_u32 s69, 1
  s_cbranch_scc0 CKXs
CKXx:
  v_pk_fma_f32 v[64:65], v[176:177], v[32:33], v[64:65]
  v_pk_fma_f32 v[66:67], v[178:179], v[34:35], v[66:67]
  v_pk_fma_f32 v[80:81], v[176:177], v[36:37], v[80:81]
  v_pk_fma_f32 v[82:83], v[178:179], v[38:39], v[82:83]
  v_pk_fma_f32 v[68:69], v[180:181], v[40:41], v[68:69]
  v_pk_fma_f32 v[70:71], v[182:183], v[42:43], v[70:71]
  v_pk_fma_f32 v[84:85], v[180:181], v[44:45], v[84:85]
  v_pk_fma_f32 v[86:87], v[182:183], v[46:47], v[86:87]
  v_pk_fma_f32 v[72:73], v[184:185], v[48:49], v[72:73]
  v_pk_fma_f32 v[74:75], v[186:187], v[50:51], v[74:75]
  v_pk_fma_f32 v[88:89], v[184:185], v[52:53], v[88:89]
  v_pk_fma_f32 v[90:91], v[186:187], v[54:55], v[90:91]
  v_pk_fma_f32 v[76:77], v[188:189], v[56:57], v[76:77]
  v_pk_fma_f32 v[78:79], v[190:191], v[58:59], v[78:79]
  v_pk_fma_f32 v[92:93], v[188:189], v[60:61], v[92:93]
  v_pk_fma_f32 v[94:95], v[190:191], v[62:63], v[94:95]
  s_waitcnt vmcnt(7)
  v_pk_fma_f32 v[64:65], v[176:177], v[96:97], v[64:65]
  v_pk_fma_f32 v[66:67], v[178:179], v[98:99], v[66:67]
  v_cvt_pk_bf16_f32 v192, v64, v65
  v_cvt_pk_bf16_f32 v193, v66, v67
  ds_write_b64 v140, v[192:193] offset:0
  s_waitcnt vmcnt(6)
  v_pk_fma_f32 v[80:81], v[176:177], v[100:101], v[80:81]
  v_pk_fma_f32 v[82:83], v[178:179], v[102:103], v[82:83]
  v_cvt_pk_bf16_f32 v200, v80, v81
  v_cvt_pk_bf16_f32 v201, v82, v83
  ds_write_b64 v140, v[200:201] offset:2048
  s_waitcnt vmcnt(5)
  v_pk_fma_f32 v[68:69], v[180:181], v[104:105], v[68:69]
  v_pk_fma_f32 v[70:71], v[182:183], v[106:107], v[70:71]
  v_cvt_pk_bf16_f32 v194, v68, v69
  v_cvt_pk_bf16_f32 v195, v70, v71
  ds_write_b64 v141, v[194:195] offset:0
  s_waitcnt vmcnt(4)
  v_pk_fma_f32 v[84:85], v[180:181], v[108:109], v[84:85]
  v_pk_fma_f32 v[86:87], v[182:183], v[110:111], v[86:87]
  v_cvt_pk_bf16_f32 v202, v84, v85
  v_cvt_pk_bf16_f32 v203, v86, v87
  ds_write_b64 v141, v[202:203] offset:2048
  s_waitcnt vmcnt(3)
  v_pk_fma_f32 v[72:73], v[184:185], v[112:113], v[72:73]
  v_pk_fma_f32 v[74:75], v[186:187], v[114:115], v[74:75]
  v_cvt_pk_bf16_f32 v196, v72, v73
  v_cvt_pk_bf16_f32 v197, v74, v75
  ds_write_b64 v142, v[196:197] offset:0
  s_waitcnt vmcnt(2)
  v_pk_fma_f32 v[88:89], v[184:185], v[116:117], v[88:89]
  v_pk_fma_f32 v[90:91], v[186:187], v[118:119], v[90:91]
  v_cvt_pk_bf16_f32 v204, v88, v89
  v_cvt_pk_bf16_f32 v205, v90, v91
  ds_write_b64 v142, v[204:205] offset:2048
  s_waitcnt vmcnt(1)
  v_pk_fma_f32 v[76:77], v[188:189], v[120:121], v[76:77]
  v_pk_fma_f32 v[78:79], v[190:191], v[122:123], v[78:79]
  v_cvt_pk_bf16_f32 v198, v76, v77
  v_cvt_pk_bf16_f32 v199, v78, v79
  ds_write_b64 v143, v[198:199] offset:0
  s_waitcnt vmcnt(0)
  v_pk_fma_f32 v[92:93], v[188:189], v[124:125], v[92:93]
  v_pk_fma_f32 v[94:95], v[190:191], v[126:127], v[94:95]
  v_cvt_pk_bf16_f32 v206, v92, v93
  v_cvt_pk_bf16_f32 v207, v94, v95
  ds_write_b64 v143, v[206:207] offset:2048
  ds_read_b128 v[64:67], v255 offset:0
  ds_read_b128 v[68:71], v255 offset:1024
  ds_read_b128 v[72:75], v255 offset:2048
  ds_read_b128 v[76:79], v255 offset:3072
  s_waitcnt lgkmcnt(3)
  buffer_store_dwordx4 v[64:67], v252, s[32:35], s72 offen
  s_waitcnt lgkmcnt(2)
  buffer_store_dwordx4 v[68:71], v253, s[32:35], s72 offen
  s_waitcnt lgkmcnt(1)
  buffer_store_dwordx4 v[72:75], v252, s[32:35], s49 offen
  s_waitcnt lgkmcnt(0)
  buffer_store_dwordx4 v[76:79], v253, s[32:35], s49 offen
X_k3_main_kernel:
  s_endpgm
CK3s:
  s_mov_b32 s46, 30000
CK3:
  s_mov_b32 s49, 0
  buffer_load_dwordx4 v[156:159], v248, s[36:39], s49 offen sc1
  s_mov_b32 s49, 24576
  buffer_load_dwordx4 v[160:163], v248, s[36:39], s49 offen sc1
  s_mov_b32 s49, 49152
  buffer_load_dwordx4 v[164:167], v248, s[36:39], s49 offen sc1
  s_mov_b32 s49, 73728
  buffer_load_dwordx4 v[168:171], v248, s[36:39], s49 offen sc1
  s_sub_u32 s46, s46, 1
  s_waitcnt vmcnt(0)
  v_max_u32 v15, v156, v157
  v_max3_u32 v15, v15, v158, v159
  v_max3_u32 v15, v15, v160, v161
  v_max3_u32 v15, v15, v162, v163
  v_max3_u32 v15, v15, v164, v165
  v_max3_u32 v15, v15, v166, v167
  v_max3_u32 v15, v15, v168, v169
  v_max3_u32 v15, v15, v170, v171
  s_cmp_eq_u32 s46, 0
  s_cbranch_scc1 CK3x
  v_cmp_eq_u32 vcc, -1, v15
  s_nop 4
  s_cbranch_vccnz CK3
  s_branch CK3x
CK5s:
  s_mov_b32 s46, 30000
CK5:
  buffer_load_dwordx4 a[208:211], v25, s[36:39], s68 offen offset:0 sc1
  buffer_load_dwordx4 a[212:215], v25, s[36:39], s68 offen offset:2048 sc1
  buffer_load_dwordx4 a[216:219], v25, s[36:39], s67 offen offset:0 sc1
  buffer_load_dwordx4 a[220:223], v25, s[36:39], s67 offen offset:2048 sc1
  s_sub_u32 s46, s46, 1
  s_waitcnt vmcnt(0)
  v_accvgpr_read_b32 v26, a208
  v_accvgpr_read_b32 v27, a209
  v_accvgpr_read_b32 v28, a210
  v_accvgpr_read_b32 v29, a211
  v_max_u32 v31, v26, v27
  v_max3_u32 v31, v31, v28, v29
  v_accvgpr_read_b32 v22, a212
  v_accvgpr_read_b32 v23, a213
  v_max3_u32 v31, v31, v22, v23
  v_add_f32 v26, v26, v22
  v_add_f32 v27, v27, v23
  v_accvgpr_read_b32 v22, a214
  v_accvgpr_read_b32 v23, a215
  v_max3_u32 v31, v31, v22, v23
  v_add_f32 v28, v28, v22
  v_add_f32 v29, v29, v23
  v_accvgpr_read_b32 v22, a216
  v_accvgpr_read_b32 v23, a217
  v_max3_u32 v31, v31, v22, v23
  v_add_f32 v26, v26, v22
  v_add_f32 v27, v27, v23
  v_accvgpr_read_b32 v22, a218
  v_accvgpr_read_b32 v23, a219
  v_max3_u32 v31, v31, v22, v23
  v_add_f32 v28, v28, v22
  v_add_f32 v29, v29, v23
  v_accvgpr_read_b32 v22, a220
  v_accvgpr_read_b32 v23, a221
  v_max3_u32 v31, v31, v22, v23
  v_add_f32 v26, v26, v22
  v_add_f32 v27, v27, v23
  v_accvgpr_read_b32 v22, a222
  v_accvgpr_read_b32 v23, a223
  v_max3_u32 v31, v31, v22, v23
  v_add_f32 v28, v28, v22
  v_add_f32 v29, v29, v23
  s_cmp_eq_u32 s46, 0
  s_cbranch_scc1 CK5x
  v_cmp_eq_u32 vcc, -1, v31
  s_nop 4
  s_cbranch_vccnz CK5
  s_branch CK5x
CK6s:
  s_mov_b32 s46, 60000
CK6:
  buffer_load_dword v139, v138, s[36:39], s91 offen sc1
  s_sub_u32 s46, s46, 1
  s_cmp_eq_u32 s46, 0
  s_waitcnt vmcnt(0)
  s_cbranch_scc1 CK6x
  v_cmp_ne_u32 vcc, 1, v139
  s_nop 4
  s_cbranch_vccnz CK6
  s_branch CK6x
CK7s:
  s_mov_b32 s46, 60000
CK7:
  buffer_load_dword v139, v138, s[36:39], s91 offen sc1
  s_sub_u32 s46, s46, 1
  s_cmp_eq_u32 s46, 0
  s_waitcnt vmcnt(0)
  s_cbranch_scc1 CK7x
  v_cmp_ne_u32 vcc, 1, v139
  s_nop 4
  s_cbranch_vccnz CK7
  s_branch CK7x
CKXs:
  s_mov_b32 s46, 60000
CKX:
  buffer_load_dword v139, v132, s[36:39], s68 offen sc1
  s_sub_u32 s46, s46, 1
  s_cmp_eq_u32 s46, 0
  s_waitcnt vmcnt(0)
  s_cbranch_scc1 CKXy
  v_cmp_ne_u32 vcc, 1, v139
  s_nop 4
  s_cbranch_vccnz CKX
CKXy:
  buffer_load_dwordx4 v[96:99], v0, s[36:39], s62 offen offset:0 sc1
  buffer_load_dwordx4 v[100:103], v0, s[36:39], s62 offen offset:1024 sc1
  buffer_load_dwordx4 v[104:107], v0, s[36:39], s62 offen offset:2048 sc1
  buffer_load_dwordx4 v[108:111], v0, s[36:39], s62 offen offset:3072 sc1
  buffer_load_dwordx4 v[112:115], v0, s[36:39], s63 offen offset:0 sc1
  buffer_load_dwordx4 v[116:119], v0, s[36:39], s63 offen offset:1024 sc1
  buffer_load_dwordx4 v[120:123], v0, s[36:39], s63 offen offset:2048 sc1
  buffer_load_dwordx4 v[124:127], v0, s[36:39], s63 offen offset:3072 sc1
  s_branch CKXx
code_end:
.fill 2048, 4, 0xBF800000
.section .rodata,"a"
.p2align 6
.amdhsa_kernel k1_mod_kernel
  .amdhsa_next_free_vgpr 77
  .amdhsa_next_free_sgpr 48
  .amdhsa_accum_offset 80
  .amdhsa_group_segment_fixed_size 0
  .amdhsa_kernarg_size 96
  .amdhsa_user_sgpr_count 2
  .amdhsa_user_sgpr_kernarg_segment_ptr 1
  .amdhsa_system_sgpr_workgroup_id_x 1
  .amdhsa_float_denorm_mode_32 3
.end_amdhsa_kernel
.p2align 6
.amdhsa_kernel k3_main_kernel
  .amdhsa_next_free_vgpr 512
  .amdhsa_next_free_sgpr 102
  .amdhsa_accum_offset 256
  .amdhsa_group_segment_fixed_size 0
  .amdhsa_kernarg_size 96
  .amdhsa_user_sgpr_count 2
  .amdhsa_user_sgpr_kernarg_segment_ptr 1
  .amdhsa_system_sgpr_workgroup_id_x 1
  .amdhsa_float_denorm_mode_32 3
.end_amdhsa_kernel
```

```asm
; @launch kernel=k1_mod_kernel grid=(256,1,1) block=(256,1,1) lds=1024
; @launch kernel=k3_main_kernel grid=(256,1,1) block=(256,1,1) lds=163840
.amdgcn_target "amdgcn-amd-amdhsa--gfx950"
.text
.globl k1_mod_kernel
.type k1_mod_kernel,@function
.p2align 8
k1_mod_kernel:
  s_cmp_ge_u32 s2, 256
  s_cbranch_scc1 X_k1_mod_kernel
  s_load_dwordx2 s[4:5], s[0:1], 64
  s_load_dwordx2 s[8:9], s[0:1], 56
  s_load_dwordx2 s[12:13], s[0:1], 88
  s_load_dwordx2 s[16:17], s[0:1], 0
  s_load_dwordx2 s[20:21], s[0:1], 8
  s_load_dwordx2 s[24:25], s[0:1], 88
  s_load_dwordx2 s[32:33], s[0:1], 88
  v_lshrrev_b32 v11, 6, v0
  v_and_b32 v10, 63, v0
  v_readfirstlane_b32 s36, v11
  s_mov_b32 s37, s2
  s_mov_b32 s6, 12582912
  s_mov_b32 s7, 0x20000
  s_mov_b32 s10, 2048
  s_mov_b32 s11, 0x20000
  s_mov_b32 s14, 98304
  s_mov_b32 s15, 0x20000
  s_mov_b32 s18, 4194304
  s_mov_b32 s19, 0x20000
  s_mov_b32 s22, 6291456
  s_mov_b32 s23, 0x20000
  s_mov_b32 s26, 262144
  s_mov_b32 s27, 0x20000
  s_mov_b32 s34, 1048576
  s_mov_b32 s35, 0x20000
  s_waitcnt lgkmcnt(0)
  s_add_u32 s24, s24, 5242880
  s_addc_u32 s25, s25, 0
  s_cmp_lg_u32 s36, 2
  s_cbranch_scc1 F_zk1_mod_kernel
  s_lshl_b32 s28, s2, 7
  s_lshr_b32 s29, s2, 2
  s_lshl_b32 s29, s29, 7
  v_lshrrev_b32 v8, 3, v10
  v_mov_b32 v4, s28
  v_mov_b32 v5, s29
  v_cmp_eq_u32 vcc, 2, v8
  v_and_b32 v9, 7, v10
  v_lshlrev_b32 v8, 15, v8
  v_cndmask_b32 v4, v4, v5, vcc
  v_lshl_add_u32 v8, v9, 4, v8
  v_add_u32 v8, v8, v4
  v_mov_b32 v4, 0
  v_mov_b32 v5, 0
  v_mov_b32 v6, 0
  v_mov_b32 v7, 0
  buffer_store_dwordx4 v[4:7], v8, s[24:27], 0 offen
  s_nop 1
F_zk1_mod_kernel:
  s_cmp_lg_u32 s36, 1
  s_cbranch_scc1 F_sent
  v_mov_b32 v4, -1
  v_mov_b32 v5, -1
  v_mov_b32 v6, -1
  v_mov_b32 v7, -1
  v_lshlrev_b32 v8, 4, v10
  v_lshlrev_b32 v9, 2, v10
  s_lshl_b32 s28, s2, 11
  s_add_u32 s28, s28, 524288
  buffer_store_dwordx4 v[4:7], v8, s[32:35], s28 offen
  buffer_store_dwordx4 v[4:7], v8, s[32:35], s28 offen offset:1024
  s_and_b32 s28, s2, 3
  s_mul_i32 s28, s28, 24576
  s_lshr_b32 s29, s2, 2
  s_lshl_b32 s29, s29, 8
  s_add_u32 s28, s28, s29
  s_add_u32 s28, s28, 8192
  buffer_store_dword v4, v9, s[32:35], s28 offen
  s_nop 1
F_sent:
  s_cmp_ge_u32 s2, 128
  s_cbranch_scc1 T_k1_mod_kernel
  s_lshr_b32 s40, s37, 2
  s_add_u32 s40, s40, 0
  s_and_b32 s41, s37, 3
  s_lshl_b32 s38, s41, 8
  s_lshl_b32 s39, s36, 6
  s_add_u32 s38, s38, s39
  v_and_b32 v12, 0x38, v10
  v_add_u32 v12, s38, v12
  v_lshlrev_b32 v13, 1, v12
  v_mul_u32_u24 v16, 12288, v12
  v_and_b32 v14, 7, v10
  v_lshl_add_u32 v16, v14, 4, v16
  s_lshl_b32 s39, s40, 7
  buffer_load_dwordx4 v[20:23], v13, s[8:11], 0 offen
  buffer_load_dwordx4 v[32:35], v16, s[4:7], s39 offen nt
  s_add_u32 s39, s39, 12288
  buffer_load_dwordx4 v[36:39], v16, s[4:7], s39 offen nt
  s_add_u32 s39, s39, 12288
  buffer_load_dwordx4 v[40:43], v16, s[4:7], s39 offen nt
  s_add_u32 s39, s39, 12288
  buffer_load_dwordx4 v[44:47], v16, s[4:7], s39 offen nt
  s_add_u32 s39, s39, 12288
  buffer_load_dwordx4 v[48:51], v16, s[4:7], s39 offen nt
  s_add_u32 s39, s39, 12288
  buffer_load_dwordx4 v[52:55], v16, s[4:7], s39 offen nt
  s_add_u32 s39, s39, 12288
  buffer_load_dwordx4 v[56:59], v16, s[4:7], s39 offen nt
  s_add_u32 s39, s39, 12288
  buffer_load_dwordx4 v[60:63], v16, s[4:7], s39 offen nt
  s_lshr_b32 s44, s37, 3
  s_lshl_b32 s44, s44, 13
  s_cmp_lg_u32 s36, 3
  s_cbranch_scc1 TC1_k1_mod_kernel
  s_cmp_ge_u32 s44, code_end-k3_main_kernel
  s_cbranch_scc1 TC1_k1_mod_kernel
  s_getpc_b64 s[42:43]
TC1_k1_mod_kernelp:
  s_add_u32 s44, s44, k3_main_kernel-TC1_k1_mod_kernelp
  s_ashr_i32 vcc_hi, s44, 31
  s_add_u32 s42, s42, s44
  s_addc_u32 s43, s43, vcc_hi
  v_lshlrev_b32 v74, 7, v10
  v_mov_b32 v75, s43
  v_add_co_u32 v74, vcc, s42, v74
  s_nop 1
  v_addc_co_u32 v75, vcc, 0, v75, vcc
  global_load_dword v76, v[74:75], off
TC1_k1_mod_kernel:
  v_lshlrev_b32 v74, 7, v10
  s_lshl_b32 s42, s37, 1
  s_add_u32 s42, s42, s36
  s_lshl_b32 s42, s42, 13
  s_cmp_lt_u32 s36, 2
  s_cselect_b32 s42, s42, 0x40000000
  buffer_load_dword v76, v74, s[16:19], s42 offen
  v_lshlrev_b32 v74, 7, v10
  s_mul_i32 s42, s36, 256
  s_add_u32 s42, s42, s37
  s_lshl_b32 s42, s42, 13
  s_add_u32 s43, s42, 0
  s_cmp_lt_u32 s43, 2095104
  s_cselect_b32 s43, s43, 0x40000000
  buffer_load_dword v76, v74, s[20:23], s43 offen
  s_waitcnt vmcnt(10)
  v_lshlrev_b32 v24, 16, v20
  v_and_b32 v25, 0xffff0000, v20
  v_lshlrev_b32 v26, 16, v21
  v_and_b32 v27, 0xffff0000, v21
  v_lshlrev_b32 v28, 16, v22
  v_and_b32 v29, 0xffff0000, v22
  v_lshlrev_b32 v30, 16, v23
  v_and_b32 v31, 0xffff0000, v23
  v_mul_f32 v64, 0xbfb8aa3b, v24
  v_mul_f32 v65, 0xbfb8aa3b, v25
  v_mul_f32 v66, 0xbfb8aa3b, v26
  v_mul_f32 v67, 0xbfb8aa3b, v27
  v_mul_f32 v68, 0xbfb8aa3b, v28
  v_mul_f32 v69, 0xbfb8aa3b, v29
  v_mul_f32 v70, 0xbfb8aa3b, v30
  v_mul_f32 v71, 0xbfb8aa3b, v31
  v_exp_f32 v64, v64
  v_exp_f32 v65, v65
  v_exp_f32 v66, v66
  v_exp_f32 v67, v67
  v_exp_f32 v68, v68
  v_exp_f32 v69, v69
  v_exp_f32 v70, v70
  v_exp_f32 v71, v71
  v_add_f32 v64, 1.0, v64
  v_add_f32 v65, 1.0, v65
  v_add_f32 v66, 1.0, v66
  v_add_f32 v67, 1.0, v67
  v_add_f32 v68, 1.0, v68
  v_add_f32 v69, 1.0, v69
  v_add_f32 v70, 1.0, v70
  v_add_f32 v71, 1.0, v71
  v_rcp_f32 v64, v64
  v_rcp_f32 v65, v65
  v_rcp_f32 v66, v66
  v_rcp_f32 v67, v67
  v_rcp_f32 v68, v68
  v_rcp_f32 v69, v69
  v_rcp_f32 v70, v70
  v_rcp_f32 v71, v71
  v_mul_f32 v24, v24, v64
  v_mul_f32 v25, v25, v65
  v_mul_f32 v26, v26, v66
  v_mul_f32 v27, v27, v67
  v_mul_f32 v28, v28, v68
  v_mul_f32 v29, v29, v69
  v_mul_f32 v30, v30, v70
  v_mul_f32 v31, v31, v71
  v_cvt_pk_bf16_f32 v72, v24, v25
  v_lshlrev_b32 v24, 16, v72
  v_and_b32 v25, 0xffff0000, v72
  v_cvt_pk_bf16_f32 v72, v26, v27
  v_lshlrev_b32 v26, 16, v72
  v_and_b32 v27, 0xffff0000, v72
  v_cvt_pk_bf16_f32 v72, v28, v29
  v_lshlrev_b32 v28, 16, v72
  v_and_b32 v29, 0xffff0000, v72
  v_cvt_pk_bf16_f32 v72, v30, v31
  v_lshlrev_b32 v30, 16, v72
  v_and_b32 v31, 0xffff0000, v72
  v_and_b32 v12, 7, v10
  v_lshlrev_b32 v12, 5, v12
  v_lshrrev_b32 v13, 4, v10
  v_lshl_add_u32 v12, v13, 3, v12
  s_lshl_b32 s38, s36, 8
  v_add_u32 v12, s38, v12
  v_lshlrev_b32 v13, 2, v10
  s_mul_i32 s38, s41, 24576
  s_lshl_b32 s39, s40, 8
  s_add_u32 s38, s38, s39
  s_waitcnt vmcnt(9)
  v_lshlrev_b32 v72, 16, v32
  v_and_b32 v73, 0xffff0000, v32
  v_mul_f32 v64, v24, v72
  v_mul_f32 v65, v24, v73
  v_lshlrev_b32 v72, 16, v33
  v_and_b32 v73, 0xffff0000, v33
  v_mul_f32 v66, v24, v72
  v_mul_f32 v67, v24, v73
  v_lshlrev_b32 v72, 16, v34
  v_and_b32 v73, 0xffff0000, v34
  v_mul_f32 v68, v24, v72
  v_mul_f32 v69, v24, v73
  v_lshlrev_b32 v72, 16, v35
  v_and_b32 v73, 0xffff0000, v35
  v_mul_f32 v70, v24, v72
  v_mul_f32 v71, v24, v73
  s_waitcnt vmcnt(8)
  v_lshlrev_b32 v72, 16, v36
  v_and_b32 v73, 0xffff0000, v36
  v_fmac_f32 v64, v25, v72
  v_fmac_f32 v65, v25, v73
  v_lshlrev_b32 v72, 16, v37
  v_and_b32 v73, 0xffff0000, v37
  v_fmac_f32 v66, v25, v72
  v_fmac_f32 v67, v25, v73
  v_lshlrev_b32 v72, 16, v38
  v_and_b32 v73, 0xffff0000, v38
  v_fmac_f32 v68, v25, v72
  v_fmac_f32 v69, v25, v73
  v_lshlrev_b32 v72, 16, v39
  v_and_b32 v73, 0xffff0000, v39
  v_fmac_f32 v70, v25, v72
  v_fmac_f32 v71, v25, v73
  s_waitcnt vmcnt(7)
  v_lshlrev_b32 v72, 16, v40
  v_and_b32 v73, 0xffff0000, v40
  v_fmac_f32 v64, v26, v72
  v_fmac_f32 v65, v26, v73
  v_lshlrev_b32 v72, 16, v41
  v_and_b32 v73, 0xffff0000, v41
  v_fmac_f32 v66, v26, v72
  v_fmac_f32 v67, v26, v73
  v_lshlrev_b32 v72, 16, v42
  v_and_b32 v73, 0xffff0000, v42
  v_fmac_f32 v68, v26, v72
  v_fmac_f32 v69, v26, v73
  v_lshlrev_b32 v72, 16, v43
  v_and_b32 v73, 0xffff0000, v43
  v_fmac_f32 v70, v26, v72
  v_fmac_f32 v71, v26, v73
  s_waitcnt vmcnt(6)
  v_lshlrev_b32 v72, 16, v44
  v_and_b32 v73, 0xffff0000, v44
  v_fmac_f32 v64, v27, v72
  v_fmac_f32 v65, v27, v73
  v_lshlrev_b32 v72, 16, v45
  v_and_b32 v73, 0xffff0000, v45
  v_fmac_f32 v66, v27, v72
  v_fmac_f32 v67, v27, v73
  v_lshlrev_b32 v72, 16, v46
  v_and_b32 v73, 0xffff0000, v46
  v_fmac_f32 v68, v27, v72
  v_fmac_f32 v69, v27, v73
  v_lshlrev_b32 v72, 16, v47
  v_and_b32 v73, 0xffff0000, v47
  v_fmac_f32 v70, v27, v72
  v_fmac_f32 v71, v27, v73
  s_waitcnt vmcnt(5)
  v_lshlrev_b32 v72, 16, v48
  v_and_b32 v73, 0xffff0000, v48
  v_fmac_f32 v64, v28, v72
  v_fmac_f32 v65, v28, v73
  v_lshlrev_b32 v72, 16, v49
  v_and_b32 v73, 0xffff0000, v49
  v_fmac_f32 v66, v28, v72
  v_fmac_f32 v67, v28, v73
  v_lshlrev_b32 v72, 16, v50
  v_and_b32 v73, 0xffff0000, v50
  v_fmac_f32 v68, v28, v72
  v_fmac_f32 v69, v28, v73
  v_lshlrev_b32 v72, 16, v51
  v_and_b32 v73, 0xffff0000, v51
  v_fmac_f32 v70, v28, v72
  v_fmac_f32 v71, v28, v73
  s_waitcnt vmcnt(4)
  v_lshlrev_b32 v72, 16, v52
  v_and_b32 v73, 0xffff0000, v52
  v_fmac_f32 v64, v29, v72
  v_fmac_f32 v65, v29, v73
  v_lshlrev_b32 v72, 16, v53
  v_and_b32 v73, 0xffff0000, v53
  v_fmac_f32 v66, v29, v72
  v_fmac_f32 v67, v29, v73
  v_lshlrev_b32 v72, 16, v54
  v_and_b32 v73, 0xffff0000, v54
  v_fmac_f32 v68, v29, v72
  v_fmac_f32 v69, v29, v73
  v_lshlrev_b32 v72, 16, v55
  v_and_b32 v73, 0xffff0000, v55
  v_fmac_f32 v70, v29, v72
  v_fmac_f32 v71, v29, v73
  s_waitcnt vmcnt(3)
  v_lshlrev_b32 v72, 16, v56
  v_and_b32 v73, 0xffff0000, v56
  v_fmac_f32 v64, v30, v72
  v_fmac_f32 v65, v30, v73
  v_lshlrev_b32 v72, 16, v57
  v_and_b32 v73, 0xffff0000, v57
  v_fmac_f32 v66, v30, v72
  v_fmac_f32 v67, v30, v73
  v_lshlrev_b32 v72, 16, v58
  v_and_b32 v73, 0xffff0000, v58
  v_fmac_f32 v68, v30, v72
  v_fmac_f32 v69, v30, v73
  v_lshlrev_b32 v72, 16, v59
  v_and_b32 v73, 0xffff0000, v59
  v_fmac_f32 v70, v30, v72
  v_fmac_f32 v71, v30, v73
  s_waitcnt vmcnt(2)
  v_lshlrev_b32 v72, 16, v60
  v_and_b32 v73, 0xffff0000, v60
  v_fmac_f32 v64, v31, v72
  v_fmac_f32 v65, v31, v73
  v_lshlrev_b32 v72, 16, v61
  v_and_b32 v73, 0xffff0000, v61
  v_fmac_f32 v66, v31, v72
  v_fmac_f32 v67, v31, v73
  v_lshlrev_b32 v72, 16, v62
  v_and_b32 v73, 0xffff0000, v62
  v_fmac_f32 v68, v31, v72
  v_fmac_f32 v69, v31, v73
  v_lshlrev_b32 v72, 16, v63
  v_and_b32 v73, 0xffff0000, v63
  v_fmac_f32 v70, v31, v72
  v_fmac_f32 v71, v31, v73
  s_nop 1
  v_permlane32_swap_b32 v64, v68
  v_permlane32_swap_b32 v65, v69
  v_permlane32_swap_b32 v66, v70
  v_permlane32_swap_b32 v67, v71
  s_nop 0
  v_add_f32 v64, v64, v68
  v_add_f32 v65, v65, v69
  v_add_f32 v66, v66, v70
  v_add_f32 v67, v67, v71
  s_nop 1
  v_permlane16_swap_b32 v64, v66
  v_permlane16_swap_b32 v65, v67
  s_nop 0
  v_add_f32 v64, v64, v66
  v_add_f32 v65, v65, v67
  s_nop 1
  v_add_f32_dpp v64, v64, v64 row_ror:8 row_mask:0xf bank_mask:0xf
  v_add_f32_dpp v65, v65, v65 row_ror:8 row_mask:0xf bank_mask:0xf
  ds_write_b64 v12, v[64:65]
  s_waitcnt lgkmcnt(0)
  s_barrier
  s_cmp_lg_u32 s36, 0
  s_cbranch_scc1 E_k1_mod_kernel
  ds_read_b32 v64, v13 offset:0
  ds_read_b32 v65, v13 offset:256
  ds_read_b32 v66, v13 offset:512
  ds_read_b32 v67, v13 offset:768
  s_waitcnt lgkmcnt(0)
  v_add_f32 v64, v64, v65
  v_add_f32 v66, v66, v67
  v_add_f32 v64, v64, v66
  buffer_store_dword v64, v13, s[12:15], s38 offen
  s_branch E_k1_mod_kernel
T_k1_mod_kernel:
  s_lshr_b32 s44, s37, 3
  s_lshl_b32 s44, s44, 13
  s_cmp_lg_u32 s36, 3
  s_cbranch_scc1 TC2_k1_mod_kernel
  s_cmp_ge_u32 s44, code_end-k3_main_kernel
  s_cbranch_scc1 TC2_k1_mod_kernel
  s_getpc_b64 s[42:43]
TC2_k1_mod_kernelp:
  s_add_u32 s44, s44, k3_main_kernel-TC2_k1_mod_kernelp
  s_ashr_i32 vcc_hi, s44, 31
  s_add_u32 s42, s42, s44
  s_addc_u32 s43, s43, vcc_hi
  v_lshlrev_b32 v74, 7, v10
  v_mov_b32 v75, s43
  v_add_co_u32 v74, vcc, s42, v74
  s_nop 1
  v_addc_co_u32 v75, vcc, 0, v75, vcc
  global_load_dword v76, v[74:75], off
TC2_k1_mod_kernel:
  v_lshlrev_b32 v74, 7, v10
  s_lshl_b32 s42, s37, 1
  s_add_u32 s42, s42, s36
  s_lshl_b32 s42, s42, 13
  s_cmp_lt_u32 s36, 2
  s_cselect_b32 s42, s42, 0x40000000
  buffer_load_dword v76, v74, s[16:19], s42 offen
  v_lshlrev_b32 v74, 7, v10
  s_mul_i32 s42, s36, 256
  s_add_u32 s42, s42, s37
  s_lshl_b32 s42, s42, 13
  s_add_u32 s43, s42, 0
  s_cmp_lt_u32 s43, 2095104
  s_cselect_b32 s43, s43, 0x40000000
  buffer_load_dword v76, v74, s[20:23], s43 offen
  s_sub_u32 s37, s37, 128
  s_waitcnt vmcnt(0)
  v_lshlrev_b32 v74, 7, v10
  s_mul_i32 s42, s36, 128
  s_add_u32 s42, s42, s37
  s_lshl_b32 s42, s42, 13
  s_add_u32 s43, s42, 0
  s_cmp_lt_u32 s43, 4196352
  s_cselect_b32 s43, s43, 0x40000000
  s_add_u32 s43, s43, 2095104
  buffer_load_dword v76, v74, s[20:23], s43 offen
  s_add_u32 s43, s42, 4194304
  s_cmp_lt_u32 s43, 4196352
  s_cselect_b32 s43, s43, 0x40000000
  s_add_u32 s43, s43, 2095104
  buffer_load_dword v76, v74, s[20:23], s43 offen
E_k1_mod_kernel:
X_k1_mod_kernel:
  s_endpgm
.globl k3_main_kernel
.type k3_main_kernel,@function
.p2align 12
.p2align 8
k3_main_kernel:
  s_cmp_ge_u32 s2, 256
  s_cbranch_scc1 X_k3_main_kernel
  s_load_dwordx2 s[4:5], s[0:1], 0
  s_load_dwordx2 s[36:37], s[0:1], 88
  s_load_dwordx2 s[8:9], s[0:1], 8
  s_load_dwordx2 s[28:29], s[0:1], 64
  s_load_dwordx2 s[40:41], s[0:1], 56
  s_load_dwordx2 s[12:13], s[0:1], 16
  s_load_dwordx2 s[16:17], s[0:1], 32
  s_load_dwordx2 s[20:21], s[0:1], 40
  s_load_dwordx2 s[24:25], s[0:1], 48
  s_load_dwordx2 s[32:33], s[0:1], 72
  v_lshrrev_b32 v1, 6, v0
  v_and_b32 v10, 63, v0
  v_readfirstlane_b32 s44, v1
  v_lshlrev_b32 v0, 4, v10
  s_mov_b32 s6, 4194304
  s_mov_b32 s7, 0x20000
  s_mov_b32 s38, 50331648
  s_mov_b32 s39, 0x20000
  s_mov_b32 s10, 6291456
  s_mov_b32 s11, 0x20000
  s_mov_b32 s30, 12582912
  s_mov_b32 s31, 0x20000
  s_mov_b32 s42, 2048
  s_mov_b32 s43, 0x20000
  s_mov_b32 s14, 2097152
  s_mov_b32 s15, 0x20000
  s_mov_b32 s18, 7340032
  s_mov_b32 s19, 0x20000
  s_mov_b32 s22, 7340032
  s_mov_b32 s23, 0x20000
  s_mov_b32 s26, 7340032
  s_mov_b32 s27, 0x20000
  s_mov_b32 s34, 4194304
  s_mov_b32 s35, 0x20000
  v_and_b32 v12, 7, v10
  v_lshrrev_b32 v13, 3, v10
  v_lshlrev_b32 v132, 11, v12
  v_lshl_add_u32 v132, v13, 4, v132
  s_lshl_b32 s48, s2, 14
  s_lshl_b32 s49, s44, 9
  s_add_u32 s48, s48, s49
  s_lshl_b32 s49, s44, 10
  s_waitcnt lgkmcnt(0)
  buffer_load_dwordx4 v[20:23], v132, s[4:7], s48 offen offset:0
  buffer_load_dwordx4 v[24:27], v132, s[4:7], s48 offen offset:128
  buffer_load_dwordx4 v[28:31], v132, s[4:7], s48 offen offset:256
  buffer_load_dwordx4 v[32:35], v132, s[4:7], s48 offen offset:384
  buffer_load_dwordx4 v[100:103], v0, s[36:39], s49 offen
  s_add_u32 s49, s49, 4096
  buffer_load_dwordx4 v[68:71], v0, s[36:39], s49 offen
  s_add_u32 s49, s49, 20480
  buffer_load_dwordx4 v[104:107], v0, s[36:39], s49 offen
  s_add_u32 s49, s49, 4096
  buffer_load_dwordx4 v[72:75], v0, s[36:39], s49 offen
  s_add_u32 s49, s49, 20480
  buffer_load_dwordx4 v[108:111], v0, s[36:39], s49 offen
  s_add_u32 s49, s49, 4096
  buffer_load_dwordx4 v[76:79], v0, s[36:39], s49 offen
  s_add_u32 s49, s49, 20480
  buffer_load_dwordx4 v[112:115], v0, s[36:39], s49 offen
  s_add_u32 s49, s49, 4096
  buffer_load_dwordx4 v[80:83], v0, s[36:39], s49 offen
  s_mul_i32 s48, s2, 7168
  s_lshl_b32 s49, s2, 13
  s_mov_b32 s55, 0x20000
  s_mov_b32 s54, 1146880
  s_cmp_eq_u32 s44, 1
  s_cselect_b64 s[52:53], s[16:17], s[20:21]
  s_cmp_eq_u32 s44, 0
  s_cselect_b64 s[52:53], s[12:13], s[52:53]
  s_cselect_b32 s54, s14, s54
  s_cselect_b32 s48, s49, s48
  s_lshr_b32 s49, s2, 3
  s_mul_i32 s50, s49, 43
  s_lshr_b32 s50, s50, 7
  s_mul_i32 s50, s50, 387072
  s_lshl_b32 s46, s49, 11
  s_add_u32 s50, s50, s46
  s_and_b32 s46, s2, 2
  s_lshl_b32 s46, s46, 9
  s_add_u32 s50, s50, s46
  s_and_b32 s46, s49, 1
  s_lshl_b32 s46, s46, 10
  s_lshr_b32 s49, s49, 1
  s_lshl_b32 s49, s49, 17
  s_add_u32 s49, s49, s46
  s_bitcmp1_b32 s2, 0
  s_cselect_b32 s49, 1073741824, s50
  s_cselect_b64 vcc, s[12:13], s[8:9]
  s_cselect_b32 s50, s14, s10
  s_cselect_b32 s47, 16, 48
  s_add_u32 s49, s49, 384
  s_cmp_eq_u32 s44, 3
  s_cselect_b64 s[52:53], vcc, s[52:53]
  s_cselect_b32 s54, s50, s54
  s_cselect_b32 s46, s49, s48
  s_cselect_b32 s49, s47, 1
  s_lshl_b32 s49, s49, 3
  v_mul_u32_u24 v19, s49, v0
  buffer_load_dword a252, v19, s[52:55], s46 offen
  s_getpc_b64 s[92:93]
PC0:
  s_lshl_b32 s48, s44, 10
  s_sub_u32 s48, s48, PC0-k3_main_kernel
  s_ashr_i32 s49, s48, 31
  s_add_u32 s92, s92, s48
  s_addc_u32 s93, s93, s49
  s_and_b32 s48, s2, 7
  s_lshr_b32 s49, s2, 3
  s_and_b32 s56, s48, 3
  s_lshl_b32 s56, s56, 2
  s_and_b32 s51, s49, 3
  s_add_u32 s56, s56, s51
  s_lshr_b32 s51, s48, 2
  s_lshl_b32 s51, s51, 3
  s_lshr_b32 s49, s49, 2
  s_add_u32 s51, s51, s49
  s_add_u32 s57, s51, s56
  s_and_b32 s57, s57, 3
  s_lshr_b32 s58, s44, 1
  s_and_b32 s59, s44, 1
  s_mul_i32 s62, s44, 3072
  s_lshl_b32 s63, s44, 11
  s_lshl_b32 s64, s44, 8
  v_bfe_u32 v14, v10, 4, 2
  v_bfe_u32 v15, v10, 1, 2
  v_xor_b32 v14, v14, v15
  v_lshlrev_b32 v14, 5, v14
  v_and_b32 v15, 1, v10
  v_lshl_add_u32 v150, v15, 4, v14
  s_lshl_b32 s48, s56, 7
  s_mul_i32 s49, s44, 49152
  s_add_u32 s48, s48, s49
  v_mul_u32_u24 v14, 6144, v13
  v_add3_u32 v139, v14, v150, s48
  v_add_u32 v140, 1024, v139
  v_add_u32 v141, 2048, v139
  v_bfe_u32 v14, v10, 3, 2
  v_lshlrev_b32 v14, 5, v14
  v_and_b32 v15, 3, v10
  v_lshl_add_u32 v151, v15, 3, v14
  v_bfe_u32 v14, v10, 2, 3
  v_lshrrev_b32 v15, 5, v10
  v_mul_u32_u24 v15, 24, v15
  v_add_lshl_u32 v14, v14, v15, 7
  s_lshl_b32 s48, s59, 1
  s_add_u32 s48, s48, s58
  s_lshl_b32 s48, s48, 5
  v_xor_b32 v15, s48, v151
  v_add_u32 v133, v14, v15
  v_xor_b32 v134, 32, v133
  v_add_u32 v135, 64512, v133
  v_add_u32 v136, 64512, v134
  v_add_u32 v137, 129024, v133
  v_add_u32 v138, 129024, v134
  s_lshl_b32 s48, s51, 2
  s_add_u32 s49, s48, s44
  s_lshl_b32 s49, s49, 16
  s_add_u32 s49, s49, 1048576
  v_add_u32 v142, s49, v0
  s_max_u32 s48, s48, 1
  s_lshl_b32 s48, s48, 16
  s_add_u32 s48, s48, 984064
  s_add_u32 s48, s48, s64
  v_lshl_add_u32 v143, v10, 2, s48
  s_lshl_b32 s48, s58, 12
  v_add_u32 v147, 0, v0
  v_add_u32 v144, s48, v147
  v_add_u32 v148, 64512, v0
  v_add_u32 v145, s48, v148
  v_add_u32 v149, 129024, v0
  v_add_u32 v146, s48, v149
  s_lshl_b32 s48, s51, 4
  s_sub_u32 s48, s48, 2
  v_min_u32 v152, 17, v10
  v_add_u32 v152, s48, v152
  v_max_i32 v152, 0, v152
  v_lshlrev_b32 v152, 7, v152
  s_add_u32 s48, s63, 150528
  v_add_u32 v14, s48, v0
  v_lshl_add_u32 v15, v13, 5, s48
  v_lshlrev_b32 v17, 5, v12
  v_add_u32 v17, 158720, v17
  s_lshl_b32 s48, s44, 3
  v_add_u32 v16, s48, v17
  v_bfe_u32 v18, v10, 3, 1
  v_lshlrev_b32 v132, 9, v18
  v_bfe_u32 v18, v10, 4, 1
  v_lshl_add_u32 v132, v18, 8, v132
  v_lshrrev_b32 v18, 5, v10
  v_lshl_add_u32 v132, v18, 11, v132
  v_lshl_add_u32 v132, v12, 4, v132
  s_lshr_b32 s50, s2, 2
  s_lshl_b32 s50, s50, 16
  s_bfe_u32 s48, s2, 0x10001
  s_lshl_b32 s48, s48, 10
  s_add_u32 s50, s50, s48
  s_and_b32 s48, s2, 1
  s_lshl_b32 s48, s48, 7
  s_add_u32 s50, s50, s48
  s_lshl_b32 s48, s44, 14
  s_add_u32 s50, s50, s48
  s_add_u32 s50, s50, 1048576
  s_lshl_b32 s45, s2, 7
  s_add_u32 s45, s45, 5242880
  s_cmp_eq_u32 s44, 0
  s_cselect_b32 s45, s45, 1073741824
  s_branch AL
.p2align 12
AL:
  s_waitcnt vmcnt(12)
  v_lshlrev_b32 v36, 16, v20
  v_and_b32 v37, 0xffff0000, v20
  v_lshlrev_b32 v38, 16, v21
  v_and_b32 v39, 0xffff0000, v21
  v_lshlrev_b32 v40, 16, v22
  v_and_b32 v41, 0xffff0000, v22
  v_lshlrev_b32 v42, 16, v23
  v_and_b32 v43, 0xffff0000, v23
  s_waitcnt vmcnt(11)
  v_lshlrev_b32 v44, 16, v24
  v_and_b32 v45, 0xffff0000, v24
  v_lshlrev_b32 v46, 16, v25
  v_and_b32 v47, 0xffff0000, v25
  v_lshlrev_b32 v48, 16, v26
  v_and_b32 v49, 0xffff0000, v26
  v_lshlrev_b32 v50, 16, v27
  v_and_b32 v51, 0xffff0000, v27
  s_waitcnt vmcnt(10)
  v_lshlrev_b32 v52, 16, v28
  v_and_b32 v53, 0xffff0000, v28
  v_lshlrev_b32 v54, 16, v29
  v_and_b32 v55, 0xffff0000, v29
  v_lshlrev_b32 v56, 16, v30
  v_and_b32 v57, 0xffff0000, v30
  v_lshlrev_b32 v58, 16, v31
  v_and_b32 v59, 0xffff0000, v31
  s_waitcnt vmcnt(9)
  v_lshlrev_b32 v60, 16, v32
  v_and_b32 v61, 0xffff0000, v32
  v_lshlrev_b32 v62, 16, v33
  v_and_b32 v63, 0xffff0000, v33
  v_lshlrev_b32 v64, 16, v34
  v_and_b32 v65, 0xffff0000, v34
  v_lshlrev_b32 v66, 16, v35
  v_and_b32 v67, 0xffff0000, v35
  v_add_f32 v20, v36, v37
  v_mul_f32 v21, v36, v36
  v_add_f32 v22, v38, v39
  v_mul_f32 v23, v37, v37
  v_fmac_f32 v21, v38, v38
  v_fmac_f32 v23, v39, v39
  v_fmac_f32 v21, v40, v40
  v_add_f32 v20, v20, v40
  v_fmac_f32 v23, v41, v41
  v_add_f32 v22, v22, v41
  v_fmac_f32 v21, v42, v42
  v_add_f32 v20, v20, v42
  v_fmac_f32 v23, v43, v43
  v_add_f32 v22, v22, v43
  v_fmac_f32 v21, v44, v44
  v_add_f32 v20, v20, v44
  v_fmac_f32 v23, v45, v45
  v_add_f32 v22, v22, v45
  v_fmac_f32 v21, v46, v46
  v_add_f32 v20, v20, v46
  v_fmac_f32 v23, v47, v47
  v_add_f32 v22, v22, v47
  v_fmac_f32 v21, v48, v48
  v_add_f32 v20, v20, v48
  v_fmac_f32 v23, v49, v49
  v_add_f32 v22, v22, v49
  v_fmac_f32 v21, v50, v50
  v_add_f32 v20, v20, v50
  v_fmac_f32 v23, v51, v51
  v_add_f32 v22, v22, v51
  v_fmac_f32 v21, v52, v52
  v_add_f32 v20, v20, v52
  v_fmac_f32 v23, v53, v53
  v_add_f32 v22, v22, v53
  v_fmac_f32 v21, v54, v54
  v_add_f32 v20, v20, v54
  v_fmac_f32 v23, v55, v55
  v_add_f32 v22, v22, v55
  v_fmac_f32 v21, v56, v56
  v_add_f32 v20, v20, v56
  v_fmac_f32 v23, v57, v57
  v_add_f32 v22, v22, v57
  v_fmac_f32 v21, v58, v58
  v_add_f32 v20, v20, v58
  v_fmac_f32 v23, v59, v59
  v_add_f32 v22, v22, v59
  v_fmac_f32 v21, v60, v60
  v_add_f32 v20, v20, v60
  v_fmac_f32 v23, v61, v61
  v_add_f32 v22, v22, v61
  v_fmac_f32 v21, v62, v62
  v_add_f32 v20, v20, v62
  v_fmac_f32 v23, v63, v63
  v_add_f32 v22, v22, v63
  v_fmac_f32 v21, v64, v64
  v_add_f32 v20, v20, v64
  v_fmac_f32 v23, v65, v65
  v_add_f32 v22, v22, v65
  v_fmac_f32 v21, v66, v66
  v_add_f32 v20, v20, v66
  v_fmac_f32 v23, v67, v67
  v_add_f32 v22, v22, v67
  v_add_f32 v20, v20, v22
  v_add_f32 v21, v21, v23
  s_nop 0
  v_add_f32_dpp v18, v20, v20 row_ror:8 row_mask:0xf bank_mask:0xf
  v_add_f32_dpp v19, v21, v21 row_ror:8 row_mask:0xf bank_mask:0xf
  v_mov_b32 v20, v18
  v_mov_b32 v21, v19
  s_nop 0
  v_permlane16_swap_b32 v18, v20
  v_permlane16_swap_b32 v19, v21
  v_add_f32 v18, v18, v20
  v_add_f32 v19, v19, v21
  v_mov_b32 v20, v18
  v_mov_b32 v21, v19
  s_nop 0
  v_permlane32_swap_b32 v18, v20
  v_permlane32_swap_b32 v19, v21
  v_add_f32 v18, v18, v20
  v_add_f32 v19, v19, v21
  ds_write_b64 v16, v[18:19]
  s_waitcnt vmcnt(1)
  v_add_f32 v68, v68, v76
  v_add_f32 v100, v100, v108
  v_add_f32 v69, v69, v77
  v_add_f32 v101, v101, v109
  v_add_f32 v70, v70, v78
  v_add_f32 v102, v102, v110
  v_add_f32 v71, v71, v79
  v_add_f32 v103, v103, v111
  v_add_f32 v72, v72, v80
  v_add_f32 v104, v104, v112
  v_add_f32 v73, v73, v81
  v_add_f32 v105, v105, v113
  v_add_f32 v74, v74, v82
  v_add_f32 v106, v106, v114
  v_add_f32 v75, v75, v83
  v_add_f32 v107, v107, v115
  v_add_f32 v68, v68, v72
  v_add_f32 v100, v100, v104
  v_add_f32 v69, v69, v73
  v_add_f32 v101, v101, v105
  v_add_f32 v70, v70, v74
  v_add_f32 v102, v102, v106
  v_add_f32 v71, v71, v75
  v_add_f32 v103, v103, v107
  v_cvt_pk_bf16_f32 v20, v68, v69
  v_lshlrev_b32 v68, 16, v20
  v_and_b32 v69, 0xffff0000, v20
  v_cvt_pk_bf16_f32 v20, v70, v71
  v_lshlrev_b32 v70, 16, v20
  v_and_b32 v71, 0xffff0000, v20
  v_cvt_pk_bf16_f32 v20, v100, v101
  v_lshlrev_b32 v100, 16, v20
  v_and_b32 v101, 0xffff0000, v20
  v_cvt_pk_bf16_f32 v20, v102, v103
  v_lshlrev_b32 v102, 16, v20
  v_and_b32 v103, 0xffff0000, v20
  v_add_f32 v68, 1.0, v68
  v_add_f32 v69, 1.0, v69
  v_add_f32 v70, 1.0, v70
  v_add_f32 v71, 1.0, v71
  v_cvt_pk_bf16_f32 v20, v68, v69
  v_lshlrev_b32 v68, 16, v20
  v_and_b32 v69, 0xffff0000, v20
  v_cvt_pk_bf16_f32 v20, v70, v71
  v_lshlrev_b32 v70, 16, v20
  v_and_b32 v71, 0xffff0000, v20
  ds_write_b128 v14, v[68:71]
  ds_write_b128 v14, v[100:103] offset:1024
  s_waitcnt lgkmcnt(0)
  s_barrier
  ds_read_b128 v[20:23], v17 offset:0
  ds_read_b128 v[24:27], v17 offset:16
  ds_read_b128 v[68:71], v15 offset:0
  ds_read_b128 v[100:103], v15 offset:1024
  ds_read_b128 v[72:75], v15 offset:16
  ds_read_b128 v[104:107], v15 offset:1040
  ds_read_b128 v[76:79], v15 offset:256
  ds_read_b128 v[108:111], v15 offset:1280
  ds_read_b128 v[80:83], v15 offset:272
  ds_read_b128 v[112:115], v15 offset:1296
  ds_read_b128 v[84:87], v15 offset:512
  ds_read_b128 v[116:119], v15 offset:1536
  ds_read_b128 v[88:91], v15 offset:528
  ds_read_b128 v[120:123], v15 offset:1552
  s_waitcnt lgkmcnt(12)
  v_add_f32 v20, v20, v24
  v_add_f32 v21, v21, v25
  v_add_f32 v22, v22, v26
  v_add_f32 v23, v23, v27
  v_add_f32 v20, v20, v22
  v_add_f32 v21, v21, v23
  ds_read_b128 v[92:95], v15 offset:768
  ds_read_b128 v[124:127], v15 offset:1792
  ds_read_b128 v[96:99], v15 offset:784
  ds_read_b128 v[128:131], v15 offset:1808
  v_mul_f32 v18, 0x3a800000, v20
  v_mul_f32 v19, 0x3a800000, v21
  v_fma_f32 v19, -v18, v18, v19
  v_max_f32 v19, 0, v19
  v_cvt_pk_bf16_f32 v19, v19, v19
  v_lshlrev_b32 v19, 16, v19
  v_add_f32 v19, 0x3727c5ac, v19
  v_cvt_pk_bf16_f32 v19, v19, v19
  v_lshlrev_b32 v19, 16, v19
  v_sqrt_f32 v19, v19
  v_cvt_pk_bf16_f32 v18, v18, v18
  v_lshlrev_b32 v18, 16, v18
  v_cvt_pk_bf16_f32 v19, v19, v19
  v_lshlrev_b32 v19, 16, v19
  v_rcp_f32 v19, v19
  s_nop 0
  v_mul_f32 v18, v18, v19
  v_fma_f32 v36, v36, v19, -v18
  v_fma_f32 v37, v37, v19, -v18
  v_fma_f32 v38, v38, v19, -v18
  v_fma_f32 v39, v39, v19, -v18
  v_fma_f32 v40, v40, v19, -v18
  v_fma_f32 v41, v41, v19, -v18
  v_fma_f32 v42, v42, v19, -v18
  v_fma_f32 v43, v43, v19, -v18
  s_waitcnt lgkmcnt(12)
  v_fma_f32 v36, v36, v68, v100
  v_fma_f32 v37, v37, v69, v101
  v_fma_f32 v38, v38, v70, v102
  v_fma_f32 v39, v39, v71, v103
  v_fma_f32 v40, v40, v72, v104
  v_fma_f32 v41, v41, v73, v105
  v_fma_f32 v42, v42, v74, v106
  v_fma_f32 v43, v43, v75, v107
  v_cvt_pk_bf16_f32 v20, v36, v37
  v_cvt_pk_bf16_f32 v21, v38, v39
  v_cvt_pk_bf16_f32 v22, v40, v41
  v_cvt_pk_bf16_f32 v23, v42, v43
  s_nop 1
  v_permlane16_swap_b32 v20, v22
  v_permlane16_swap_b32 v21, v23
  buffer_store_dwordx4 v[20:23], v132, s[36:39], s50 offen sc1
  s_add_u32 s50, s50, 4096
  v_fma_f32 v44, v44, v19, -v18
  v_fma_f32 v45, v45, v19, -v18
  v_fma_f32 v46, v46, v19, -v18
  v_fma_f32 v47, v47, v19, -v18
  v_fma_f32 v48, v48, v19, -v18
  v_fma_f32 v49, v49, v19, -v18
  v_fma_f32 v50, v50, v19, -v18
  v_fma_f32 v51, v51, v19, -v18
  s_waitcnt lgkmcnt(8)
  v_fma_f32 v44, v44, v76, v108
  v_fma_f32 v45, v45, v77, v109
  v_fma_f32 v46, v46, v78, v110
  v_fma_f32 v47, v47, v79, v111
  v_fma_f32 v48, v48, v80, v112
  v_fma_f32 v49, v49, v81, v113
  v_fma_f32 v50, v50, v82, v114
  v_fma_f32 v51, v51, v83, v115
  v_cvt_pk_bf16_f32 v24, v44, v45
  v_cvt_pk_bf16_f32 v25, v46, v47
  v_cvt_pk_bf16_f32 v26, v48, v49
  v_cvt_pk_bf16_f32 v27, v50, v51
  s_nop 1
  v_permlane16_swap_b32 v24, v26
  v_permlane16_swap_b32 v25, v27
  buffer_store_dwordx4 v[24:27], v132, s[36:39], s50 offen sc1
  s_add_u32 s50, s50, 4096
  v_fma_f32 v52, v52, v19, -v18
  v_fma_f32 v53, v53, v19, -v18
  v_fma_f32 v54, v54, v19, -v18
  v_fma_f32 v55, v55, v19, -v18
  v_fma_f32 v56, v56, v19, -v18
  v_fma_f32 v57, v57, v19, -v18
  v_fma_f32 v58, v58, v19, -v18
  v_fma_f32 v59, v59, v19, -v18
  s_waitcnt lgkmcnt(4)
  v_fma_f32 v52, v52, v84, v116
  v_fma_f32 v53, v53, v85, v117
  v_fma_f32 v54, v54, v86, v118
  v_fma_f32 v55, v55, v87, v119
  v_fma_f32 v56, v56, v88, v120
  v_fma_f32 v57, v57, v89, v121
  v_fma_f32 v58, v58, v90, v122
  v_fma_f32 v59, v59, v91, v123
  v_cvt_pk_bf16_f32 v28, v52, v53
  v_cvt_pk_bf16_f32 v29, v54, v55
  v_cvt_pk_bf16_f32 v30, v56, v57
  v_cvt_pk_bf16_f32 v31, v58, v59
  s_nop 1
  v_permlane16_swap_b32 v28, v30
  v_permlane16_swap_b32 v29, v31
  buffer_store_dwordx4 v[28:31], v132, s[36:39], s50 offen sc1
  s_add_u32 s50, s50, 4096
  v_fma_f32 v60, v60, v19, -v18
  v_fma_f32 v61, v61, v19, -v18
  v_fma_f32 v62, v62, v19, -v18
  v_fma_f32 v63, v63, v19, -v18
  v_fma_f32 v64, v64, v19, -v18
  v_fma_f32 v65, v65, v19, -v18
  v_fma_f32 v66, v66, v19, -v18
  v_fma_f32 v67, v67, v19, -v18
  s_waitcnt lgkmcnt(0)
  v_fma_f32 v60, v60, v92, v124
  v_fma_f32 v61, v61, v93, v125
  v_fma_f32 v62, v62, v94, v126
  v_fma_f32 v63, v63, v95, v127
  v_fma_f32 v64, v64, v96, v128
  v_fma_f32 v65, v65, v97, v129
  v_fma_f32 v66, v66, v98, v130
  v_fma_f32 v67, v67, v99, v131
  v_cvt_pk_bf16_f32 v32, v60, v61
  v_cvt_pk_bf16_f32 v33, v62, v63
  v_cvt_pk_bf16_f32 v34, v64, v65
  v_cvt_pk_bf16_f32 v35, v66, v67
  s_nop 1
  v_permlane16_swap_b32 v32, v34
  v_permlane16_swap_b32 v33, v35
  buffer_store_dwordx4 v[32:35], v132, s[36:39], s50 offen sc1
  v_mov_b32 v12, 1
  s_waitcnt vmcnt(0) lgkmcnt(0)
  s_barrier
  s_mov_b64 exec, 1
  buffer_store_dword v12, v0, s[36:39], s45 offen sc1
  s_mov_b64 exec, -1
  s_mov_b32 s65, 0
  s_mul_i32 s60, s65, 196608
  s_add_u32 m0, s62, 64512
  s_nop 0
  buffer_load_dwordx4 v139, s[8:11], s60 offen offset:0 lds
  buffer_load_dwordx4 v140, s[8:11], s60 offen offset:1024 lds
  buffer_load_dwordx4 v141, s[8:11], s60 offen offset:2048 lds
  s_mov_b32 s66, 1
  s_mul_i32 s60, s66, 196608
  s_add_u32 m0, s62, 86016
  s_nop 0
  buffer_load_dwordx4 v139, s[8:11], s60 offen offset:0 lds
  buffer_load_dwordx4 v140, s[8:11], s60 offen offset:1024 lds
  buffer_load_dwordx4 v141, s[8:11], s60 offen offset:2048 lds
  s_mov_b32 s67, 2
  s_mul_i32 s60, s67, 196608
  s_add_u32 m0, s62, 107520
  s_nop 0
  buffer_load_dwordx4 v139, s[8:11], s60 offen offset:0 lds
  buffer_load_dwordx4 v140, s[8:11], s60 offen offset:1024 lds
  buffer_load_dwordx4 v141, s[8:11], s60 offen offset:2048 lds
  s_mov_b32 s68, 3
  s_mul_i32 s60, s68, 196608
  s_add_u32 m0, s62, 129024
  s_nop 0
  buffer_load_dwordx4 v139, s[8:11], s60 offen offset:0 lds
  buffer_load_dwordx4 v140, s[8:11], s60 offen offset:1024 lds
  buffer_load_dwordx4 v141, s[8:11], s60 offen offset:2048 lds
  s_mov_b32 s69, 4
  s_mul_i32 s60, s69, 196608
  s_add_u32 m0, s62, 0
  s_nop 0
  buffer_load_dwordx4 v139, s[8:11], s60 offen offset:0 lds
  buffer_load_dwordx4 v140, s[8:11], s60 offen offset:1024 lds
  buffer_load_dwordx4 v141, s[8:11], s60 offen offset:2048 lds
  s_mov_b64 exec, 0
  s_cmp_eq_u32 s44, 1
  s_cbranch_scc1 Ha0
  s_cmp_eq_u32 s44, 2
  s_cbranch_scc1 Ha1
  s_cmp_eq_u32 s44, 3
  s_cbranch_scc1 Ha2
Ra:
  s_mov_b64 exec, -1
  s_cmp_lg_u32 s44, 0
  s_cbranch_scc1 SM1x
  s_mov_b32 s46, 60000
  s_mov_b32 s47, 5242880
SM1:
  buffer_load_dword v12, v152, s[36:39], s47 offen sc1
  s_sub_u32 s46, s46, 1
  s_cmp_eq_u32 s46, 0
  s_waitcnt vmcnt(0)
  s_cbranch_scc1 SM1x
  v_cmp_ne_u32 vcc, 1, v12
  s_nop 4
  s_cbranch_vccnz SM1
SM1x:
  s_barrier
  s_lshl_b32 s61, s65, 11
  s_add_u32 m0, s63, 76800
  s_nop 0
  buffer_load_dwordx4 v142, s[36:39], s61 offen offset:0 sc1 lds
  buffer_load_dwordx4 v142, s[36:39], s61 offen offset:1024 sc1 lds
  s_add_u32 m0, s64, 84992
  s_nop 0
  buffer_load_dword v143, s[36:39], s61 offen sc1 lds
  s_lshl_b32 s61, s66, 11
  s_add_u32 m0, s63, 98304
  s_nop 0
  buffer_load_dwordx4 v142, s[36:39], s61 offen offset:0 sc1 lds
  buffer_load_dwordx4 v142, s[36:39], s61 offen offset:1024 sc1 lds
  s_add_u32 m0, s64, 106496
  s_nop 0
  buffer_load_dword v143, s[36:39], s61 offen sc1 lds
  s_lshl_b32 s61, s67, 11
  s_add_u32 m0, s63, 119808
  s_nop 0
  buffer_load_dwordx4 v142, s[36:39], s61 offen offset:0 sc1 lds
  buffer_load_dwordx4 v142, s[36:39], s61 offen offset:1024 sc1 lds
  s_add_u32 m0, s64, 128000
  s_nop 0
  buffer_load_dword v143, s[36:39], s61 offen sc1 lds
  s_lshl_b32 s61, s68, 11
  s_add_u32 m0, s63, 141312
  s_nop 0
  buffer_load_dwordx4 v142, s[36:39], s61 offen offset:0 sc1 lds
  buffer_load_dwordx4 v142, s[36:39], s61 offen offset:1024 sc1 lds
  s_add_u32 m0, s64, 149504
  s_nop 0
  buffer_load_dword v143, s[36:39], s61 offen sc1 lds
  s_waitcnt vmcnt(9)
  s_barrier
  ds_read_b64_tr_b16 a[40:41], v135 offset:1024
  ds_read_b64_tr_b16 a[42:43], v135 offset:7168
  ds_read_b64_tr_b16 a[44:45], v136 offset:1024
  ds_read_b64_tr_b16 a[46:47], v136 offset:7168
  ds_read_b64_tr_b16 a[48:49], v135 offset:2048
  ds_read_b64_tr_b16 a[50:51], v135 offset:8192
  ds_read_b64_tr_b16 a[52:53], v136 offset:2048
  ds_read_b64_tr_b16 a[54:55], v136 offset:8192
  ds_read_b128 a[0:3], v145 offset:12288
  ds_read_b128 a[4:7], v145 offset:13312
  ds_read_b128 a[8:11], v145 offset:14336
  ds_read_b128 a[12:15], v145 offset:15360
  ds_read_b128 a[16:19], v148 offset:20480
  s_waitcnt lgkmcnt(0)
  v_mfma_f32_16x16x32_bf16 v[20:23], a[40:43], a[0:3], 0
  s_waitcnt vmcnt(6)
  s_barrier
  s_lshl_b32 s61, s69, 11
  v_mfma_f32_16x16x32_bf16 v[24:27], a[40:43], a[4:7], 0
  s_add_u32 m0, s63, 12288
  ds_read_b64_tr_b16 a[56:57], v135 offset:0
  v_mfma_f32_16x16x32_bf16 v[28:31], a[40:43], a[8:11], 0
  buffer_load_dwordx4 v142, s[36:39], s61 offen offset:0 sc1 lds
  v_mfma_f32_16x16x32_bf16 v[32:35], a[40:43], a[12:15], 0
  ds_read_b64_tr_b16 a[58:59], v135 offset:6144
  v_mfma_f32_16x16x32_bf16 v[116:119], a[40:43], a[16:19], 0
  ds_read_b64_tr_b16 a[60:61], v136 offset:0
  v_mfma_f32_16x16x32_bf16 v[48:51], a[44:47], a[12:15], 0
  v_mfma_f32_16x16x32_bf16 v[44:47], a[44:47], a[8:11], 0
  buffer_load_dwordx4 v142, s[36:39], s61 offen offset:1024 sc1 lds
  s_add_u32 m0, s64, 20480
  v_mfma_f32_16x16x32_bf16 v[40:43], a[44:47], a[4:7], 0
  ds_read_b64_tr_b16 a[62:63], v136 offset:6144
  v_mfma_f32_16x16x32_bf16 v[36:39], a[44:47], a[0:3], 0
  s_waitcnt lgkmcnt(9)
  ds_read_b64_tr_b16 a[64:65], v135 offset:22528
  v_mfma_f32_16x16x32_bf16 v[52:55], a[0:3], a[48:51], 0
  ds_read_b128 a[20:23], v145 offset:33792
  v_mfma_f32_16x16x32_bf16 v[56:59], a[4:7], a[48:51], 0
  buffer_load_dword v143, s[36:39], s61 offen sc1 lds
  s_mov_b32 s70, 5
  v_mfma_f32_16x16x32_bf16 v[60:63], a[8:11], a[48:51], 0
  s_mul_i32 s60, s70, 196608
  s_add_u32 m0, s62, 21504
  ds_read_b64_tr_b16 a[66:67], v135 offset:28672
  v_mfma_f32_16x16x32_bf16 v[64:67], a[12:15], a[48:51], 0
  ds_read_b128 a[24:27], v145 offset:34816
  v_mfma_f32_16x16x32_bf16 v[120:123], a[16:19], a[48:51], 0
  ds_read_b64_tr_b16 a[68:69], v136 offset:22528
  v_mfma_f32_16x16x32_bf16 v[80:83], a[12:15], a[52:55], 0
  buffer_load_dwordx4 v139, s[8:11], s60 offen offset:0 lds
  v_mfma_f32_16x16x32_bf16 v[76:79], a[8:11], a[52:55], 0
  ds_read_b128 a[28:31], v145 offset:35840
  v_mfma_f32_16x16x32_bf16 v[72:75], a[4:7], a[52:55], 0
  ds_read_b64_tr_b16 a[70:71], v136 offset:28672
  v_mfma_f32_16x16x32_bf16 v[68:71], a[0:3], a[52:55], 0
  s_waitcnt lgkmcnt(7)
  ds_read_b128 a[32:35], v145 offset:36864
  v_mfma_f32_16x16x32_bf16 v[84:87], a[56:59], a[0:3], 0
  buffer_load_dwordx4 v140, s[8:11], s60 offen offset:1024 lds
  v_mfma_f32_16x16x32_bf16 v[88:91], a[56:59], a[4:7], 0
  ds_read_b128 a[36:39], v148 offset:41984
  v_mfma_f32_16x16x32_bf16 v[92:95], a[56:59], a[8:11], 0
  ds_read_b64_tr_b16 a[40:41], v135 offset:23552
  v_mfma_f32_16x16x32_bf16 v[96:99], a[56:59], a[12:15], 0
  ds_read_b64_tr_b16 a[42:43], v135 offset:29696
  v_mfma_f32_16x16x32_bf16 v[112:115], a[60:63], a[12:15], 0
  buffer_load_dwordx4 v141, s[8:11], s60 offen offset:2048 lds
  s_lshl_b32 s61, s70, 11
  v_mfma_f32_16x16x32_bf16 v[108:111], a[60:63], a[8:11], 0
  s_add_u32 m0, s63, 33792
  ds_read_b64_tr_b16 a[44:45], v136 offset:23552
  v_mfma_f32_16x16x32_bf16 v[104:107], a[60:63], a[4:7], 0
  ds_read_b64_tr_b16 a[46:47], v136 offset:29696
  v_mfma_f32_16x16x32_bf16 v[100:103], a[60:63], a[0:3], 0
  s_waitcnt vmcnt(9) lgkmcnt(4)
  s_barrier
  v_mfma_f32_16x16x32_bf16 v[20:23], a[64:67], a[20:23], v[20:23]
  buffer_load_dwordx4 v142, s[36:39], s61 offen offset:0 sc1 lds
  v_mfma_f32_16x16x32_bf16 v[24:27], a[64:67], a[24:27], v[24:27]
  ds_read_b64_tr_b16 a[48:49], v135 offset:21504
  v_mfma_f32_16x16x32_bf16 v[28:31], a[64:67], a[28:31], v[28:31]
  ds_read_b64_tr_b16 a[50:51], v135 offset:27648
  v_mfma_f32_16x16x32_bf16 v[32:35], a[64:67], a[32:35], v[32:35]
  v_mfma_f32_16x16x32_bf16 v[116:119], a[64:67], a[36:39], v[116:119]
  buffer_load_dwordx4 v142, s[36:39], s61 offen offset:1024 sc1 lds
  s_add_u32 m0, s64, 41984
  v_mfma_f32_16x16x32_bf16 v[48:51], a[68:71], a[32:35], v[48:51]
  ds_read_b64_tr_b16 a[52:53], v136 offset:21504
  v_mfma_f32_16x16x32_bf16 v[44:47], a[68:71], a[28:31], v[44:47]
  ds_read_b64_tr_b16 a[54:55], v136 offset:27648
  v_mfma_f32_16x16x32_bf16 v[40:43], a[68:71], a[24:27], v[40:43]
  v_mfma_f32_16x16x32_bf16 v[36:39], a[68:71], a[20:23], v[36:39]
  s_waitcnt lgkmcnt(4)
  buffer_load_dword v143, s[36:39], s61 offen sc1 lds
  s_mov_b32 s65, 6
  v_mfma_f32_16x16x32_bf16 v[52:55], a[20:23], a[40:43], v[52:55]
  s_mul_i32 s60, s65, 196608
  s_add_u32 m0, s62, 43008
  ds_read_b64_tr_b16 a[56:57], v135 offset:44032
  v_mfma_f32_16x16x32_bf16 v[56:59], a[24:27], a[40:43], v[56:59]
  ds_read_b128 a[0:3], v145 offset:55296
  v_mfma_f32_16x16x32_bf16 v[60:63], a[28:31], a[40:43], v[60:63]
  ds_read_b64_tr_b16 a[58:59], v135 offset:50176
  v_mfma_f32_16x16x32_bf16 v[64:67], a[32:35], a[40:43], v[64:67]
  buffer_load_dwordx4 v139, s[8:11], s60 offen offset:0 lds
  v_mfma_f32_16x16x32_bf16 v[120:123], a[36:39], a[40:43], v[120:123]
  ds_read_b128 a[4:7], v145 offset:56320
  v_mfma_f32_16x16x32_bf16 v[80:83], a[32:35], a[44:47], v[80:83]
  ds_read_b64_tr_b16 a[60:61], v136 offset:44032
  v_mfma_f32_16x16x32_bf16 v[76:79], a[28:31], a[44:47], v[76:79]
  ds_read_b128 a[8:11], v145 offset:57344
  v_mfma_f32_16x16x32_bf16 v[72:75], a[24:27], a[44:47], v[72:75]
  buffer_load_dwordx4 v140, s[8:11], s60 offen offset:1024 lds
  v_mfma_f32_16x16x32_bf16 v[68:71], a[20:23], a[44:47], v[68:71]
  s_waitcnt lgkmcnt(6)
  ds_read_b64_tr_b16 a[62:63], v136 offset:50176
  v_mfma_f32_16x16x32_bf16 v[84:87], a[48:51], a[20:23], v[84:87]
  ds_read_b128 a[12:15], v145 offset:58368
  v_mfma_f32_16x16x32_bf16 v[88:91], a[48:51], a[24:27], v[88:91]
  ds_read_b128 a[16:19], v148 offset:63488
  v_mfma_f32_16x16x32_bf16 v[92:95], a[48:51], a[28:31], v[92:95]
  buffer_load_dwordx4 v141, s[8:11], s60 offen offset:2048 lds
  s_lshl_b32 s61, s65, 11
  v_mfma_f32_16x16x32_bf16 v[96:99], a[48:51], a[32:35], v[96:99]
  s_add_u32 m0, s63, 55296
  ds_read_b64_tr_b16 a[64:65], v135 offset:45056
  v_mfma_f32_16x16x32_bf16 v[112:115], a[52:55], a[32:35], v[112:115]
  ds_read_b64_tr_b16 a[66:67], v135 offset:51200
  v_mfma_f32_16x16x32_bf16 v[108:111], a[52:55], a[28:31], v[108:111]
  ds_read_b64_tr_b16 a[68:69], v136 offset:45056
  v_mfma_f32_16x16x32_bf16 v[104:107], a[52:55], a[24:27], v[104:107]
  buffer_load_dwordx4 v142, s[36:39], s61 offen offset:0 sc1 lds
  v_mfma_f32_16x16x32_bf16 v[100:103], a[52:55], a[20:23], v[100:103]
  s_waitcnt vmcnt(13) lgkmcnt(3)
  s_barrier
  ds_read_b64_tr_b16 a[70:71], v136 offset:51200
  v_mfma_f32_16x16x32_bf16 v[20:23], a[56:59], a[0:3], v[20:23]
  ds_read_b64_tr_b16 a[40:41], v135 offset:43008
  v_mfma_f32_16x16x32_bf16 v[24:27], a[56:59], a[4:7], v[24:27]
  v_mfma_f32_16x16x32_bf16 v[28:31], a[56:59], a[8:11], v[28:31]
  buffer_load_dwordx4 v142, s[36:39], s61 offen offset:1024 sc1 lds
  s_add_u32 m0, s64, 63488
  v_mfma_f32_16x16x32_bf16 v[32:35], a[56:59], a[12:15], v[32:35]
  ds_read_b64_tr_b16 a[42:43], v135 offset:49152
  v_mfma_f32_16x16x32_bf16 v[116:119], a[56:59], a[16:19], v[116:119]
  ds_read_b64_tr_b16 a[44:45], v136 offset:43008
  v_mfma_f32_16x16x32_bf16 v[48:51], a[60:63], a[12:15], v[48:51]
  v_mfma_f32_16x16x32_bf16 v[44:47], a[60:63], a[8:11], v[44:47]
  buffer_load_dword v143, s[36:39], s61 offen sc1 lds
  s_mov_b32 s66, 7
  v_mfma_f32_16x16x32_bf16 v[40:43], a[60:63], a[4:7], v[40:43]
  s_mul_i32 s60, s66, 196608
  s_add_u32 m0, s62, 64512
  ds_read_b64_tr_b16 a[46:47], v136 offset:49152
  v_mfma_f32_16x16x32_bf16 v[36:39], a[60:63], a[0:3], v[36:39]
  s_waitcnt lgkmcnt(4)
  ds_read_b64_tr_b16 a[48:49], v137 offset:1024
  v_mfma_f32_16x16x32_bf16 v[52:55], a[0:3], a[64:67], v[52:55]
  ds_read_b128 a[20:23], v146 offset:12288
  v_mfma_f32_16x16x32_bf16 v[56:59], a[4:7], a[64:67], v[56:59]
  buffer_load_dwordx4 v139, s[8:11], s60 offen offset:0 lds
  v_mfma_f32_16x16x32_bf16 v[60:63], a[8:11], a[64:67], v[60:63]
  ds_read_b64_tr_b16 a[50:51], v137 offset:7168
  v_mfma_f32_16x16x32_bf16 v[64:67], a[12:15], a[64:67], v[64:67]
  ds_read_b128 a[24:27], v146 offset:13312
  v_mfma_f32_16x16x32_bf16 v[120:123], a[16:19], a[64:67], v[120:123]
  ds_read_b64_tr_b16 a[52:53], v138 offset:1024
  v_mfma_f32_16x16x32_bf16 v[80:83], a[12:15], a[68:71], v[80:83]
  buffer_load_dwordx4 v140, s[8:11], s60 offen offset:1024 lds
  v_mfma_f32_16x16x32_bf16 v[76:79], a[8:11], a[68:71], v[76:79]
  ds_read_b128 a[28:31], v146 offset:14336
  v_mfma_f32_16x16x32_bf16 v[72:75], a[4:7], a[68:71], v[72:75]
  ds_read_b64_tr_b16 a[54:55], v138 offset:7168
  v_mfma_f32_16x16x32_bf16 v[68:71], a[0:3], a[68:71], v[68:71]
  s_waitcnt lgkmcnt(7)
  ds_read_b128 a[32:35], v146 offset:15360
  v_mfma_f32_16x16x32_bf16 v[84:87], a[40:43], a[0:3], v[84:87]
  buffer_load_dwordx4 v141, s[8:11], s60 offen offset:2048 lds
  s_lshl_b32 s61, s66, 11
  v_mfma_f32_16x16x32_bf16 v[88:91], a[40:43], a[4:7], v[88:91]
  s_add_u32 m0, s63, 76800
  ds_read_b128 a[36:39], v149 offset:20480
  v_mfma_f32_16x16x32_bf16 v[92:95], a[40:43], a[8:11], v[92:95]
  ds_read_b64_tr_b16 a[56:57], v137 offset:2048
  v_mfma_f32_16x16x32_bf16 v[96:99], a[40:43], a[12:15], v[96:99]
  ds_read_b64_tr_b16 a[58:59], v137 offset:8192
  v_mfma_f32_16x16x32_bf16 v[112:115], a[44:47], a[12:15], v[112:115]
  buffer_load_dwordx4 v142, s[36:39], s61 offen offset:0 sc1 lds
  v_mfma_f32_16x16x32_bf16 v[108:111], a[44:47], a[8:11], v[108:111]
  ds_read_b64_tr_b16 a[60:61], v138 offset:2048
  v_mfma_f32_16x16x32_bf16 v[104:107], a[44:47], a[4:7], v[104:107]
  ds_read_b64_tr_b16 a[62:63], v138 offset:8192
  v_mfma_f32_16x16x32_bf16 v[100:103], a[44:47], a[0:3], v[100:103]
  s_waitcnt vmcnt(16) lgkmcnt(4)
  s_barrier
  v_mfma_f32_16x16x32_bf16 v[20:23], a[48:51], a[20:23], v[20:23]
  buffer_load_dwordx4 v142, s[36:39], s61 offen offset:1024 sc1 lds
  s_add_u32 m0, s64, 84992
  v_mfma_f32_16x16x32_bf16 v[24:27], a[48:51], a[24:27], v[24:27]
  ds_read_b64_tr_b16 a[64:65], v137 offset:0
  v_mfma_f32_16x16x32_bf16 v[28:31], a[48:51], a[28:31], v[28:31]
  ds_read_b64_tr_b16 a[66:67], v137 offset:6144
  v_mfma_f32_16x16x32_bf16 v[32:35], a[48:51], a[32:35], v[32:35]
  v_mfma_f32_16x16x32_bf16 v[116:119], a[48:51], a[36:39], v[116:119]
  buffer_load_dword v143, s[36:39], s61 offen sc1 lds
  s_mov_b32 s67, 8
  v_mfma_f32_16x16x32_bf16 v[48:51], a[52:55], a[32:35], v[48:51]
  s_mul_i32 s60, s67, 196608
  s_add_u32 m0, s62, 86016
  ds_read_b64_tr_b16 a[68:69], v138 offset:0
  v_mfma_f32_16x16x32_bf16 v[44:47], a[52:55], a[28:31], v[44:47]
  ds_read_b64_tr_b16 a[70:71], v138 offset:6144
  v_mfma_f32_16x16x32_bf16 v[40:43], a[52:55], a[24:27], v[40:43]
  v_mfma_f32_16x16x32_bf16 v[36:39], a[52:55], a[20:23], v[36:39]
  s_waitcnt lgkmcnt(4)
  buffer_load_dwordx4 v139, s[8:11], s60 offen offset:0 lds
  v_mfma_f32_16x16x32_bf16 v[52:55], a[20:23], a[56:59], v[52:55]
  ds_read_b64_tr_b16 a[40:41], v133 offset:1024
  v_mfma_f32_16x16x32_bf16 v[56:59], a[24:27], a[56:59], v[56:59]
  ds_read_b128 a[0:3], v144 offset:12288
  v_mfma_f32_16x16x32_bf16 v[60:63], a[28:31], a[56:59], v[60:63]
Ha0:
  s_cbranch_execz Ha0_1
  ds_read_b64_tr_b16 a[42:43], v133 offset:7168
  v_mfma_f32_16x16x32_bf16 v[64:67], a[32:35], a[56:59], v[64:67]
  buffer_load_dwordx4 v140, s[8:11], s60 offen offset:1024 lds
  v_mfma_f32_16x16x32_bf16 v[120:123], a[36:39], a[56:59], v[120:123]
  ds_read_b128 a[4:7], v144 offset:13312
  v_mfma_f32_16x16x32_bf16 v[80:83], a[32:35], a[60:63], v[80:83]
  ds_read_b64_tr_b16 a[44:45], v134 offset:1024
  v_mfma_f32_16x16x32_bf16 v[76:79], a[28:31], a[60:63], v[76:79]
  ds_read_b128 a[8:11], v144 offset:14336
  v_mfma_f32_16x16x32_bf16 v[72:75], a[24:27], a[60:63], v[72:75]
  buffer_load_dwordx4 v141, s[8:11], s60 offen offset:2048 lds
  s_lshl_b32 s61, s67, 11
  v_mfma_f32_16x16x32_bf16 v[68:71], a[20:23], a[60:63], v[68:71]
  s_waitcnt lgkmcnt(6)
  s_add_u32 m0, s63, 98304
  ds_read_b64_tr_b16 a[46:47], v134 offset:7168
  v_mfma_f32_16x16x32_bf16 v[84:87], a[64:67], a[20:23], v[84:87]
  ds_read_b128 a[12:15], v144 offset:15360
  v_mfma_f32_16x16x32_bf16 v[88:91], a[64:67], a[24:27], v[88:91]
  ds_read_b128 a[16:19], v147 offset:20480
  v_mfma_f32_16x16x32_bf16 v[92:95], a[64:67], a[28:31], v[92:95]
  buffer_load_dwordx4 v142, s[36:39], s61 offen offset:0 sc1 lds
  v_mfma_f32_16x16x32_bf16 v[96:99], a[64:67], a[32:35], v[96:99]
  ds_read_b64_tr_b16 a[48:49], v133 offset:2048
  v_mfma_f32_16x16x32_bf16 v[112:115], a[68:71], a[32:35], v[112:115]
  s_and_b32 s48, s2, 3
  ds_read_b64_tr_b16 a[50:51], v133 offset:8192
  s_lshl_b32 s48, s48, 8
  v_mfma_f32_16x16x32_bf16 v[108:111], a[68:71], a[28:31], v[108:111]
  s_lshl_b32 s49, s44, 6
  ds_read_b64_tr_b16 a[52:53], v134 offset:2048
  s_add_u32 s48, s48, s49
  v_mfma_f32_16x16x32_bf16 v[104:107], a[68:71], a[24:27], v[104:107]
  buffer_load_dwordx4 v142, s[36:39], s61 offen offset:1024 sc1 lds
  s_add_u32 m0, s64, 106496
  v_mfma_f32_16x16x32_bf16 v[100:103], a[68:71], a[20:23], v[100:103]
  s_waitcnt vmcnt(17) lgkmcnt(3)
  s_barrier
  ds_read_b64_tr_b16 a[54:55], v134 offset:8192
  v_mfma_f32_16x16x32_bf16 v[20:23], a[40:43], a[0:3], v[20:23]
  ds_read_b64_tr_b16 a[56:57], v133 offset:0
  v_mfma_f32_16x16x32_bf16 v[24:27], a[40:43], a[4:7], v[24:27]
  v_mfma_f32_16x16x32_bf16 v[28:31], a[40:43], a[8:11], v[28:31]
  buffer_load_dword v143, s[36:39], s61 offen sc1 lds
  s_mov_b32 s68, 9
  v_mfma_f32_16x16x32_bf16 v[32:35], a[40:43], a[12:15], v[32:35]
  s_mul_i32 s60, s68, 196608
  s_add_u32 m0, s62, 107520
  ds_read_b64_tr_b16 a[58:59], v133 offset:6144
  v_mfma_f32_16x16x32_bf16 v[116:119], a[40:43], a[16:19], v[116:119]
  ds_read_b64_tr_b16 a[60:61], v134 offset:0
  v_and_b32 v196, 0x38, v10
  v_mfma_f32_16x16x32_bf16 v[48:51], a[44:47], a[12:15], v[48:51]
  v_add_u32 v196, s48, v196
  v_lshlrev_b32 v12, 1, v196
  v_mfma_f32_16x16x32_bf16 v[44:47], a[44:47], a[8:11], v[44:47]
  buffer_load_dwordx4 v139, s[8:11], s60 offen offset:0 lds
  v_mfma_f32_16x16x32_bf16 v[40:43], a[44:47], a[4:7], v[40:43]
  ds_read_b64_tr_b16 a[62:63], v134 offset:6144
  v_mfma_f32_16x16x32_bf16 v[36:39], a[44:47], a[0:3], v[36:39]
  s_waitcnt lgkmcnt(4)
  ds_read_b64_tr_b16 a[64:65], v133 offset:22528
  v_mfma_f32_16x16x32_bf16 v[52:55], a[0:3], a[48:51], v[52:55]
  ds_read_b128 a[20:23], v144 offset:33792
  v_mfma_f32_16x16x32_bf16 v[56:59], a[4:7], a[48:51], v[56:59]
  buffer_load_dwordx4 v140, s[8:11], s60 offen offset:1024 lds
  v_mfma_f32_16x16x32_bf16 v[60:63], a[8:11], a[48:51], v[60:63]
  ds_read_b64_tr_b16 a[66:67], v133 offset:28672
  v_mfma_f32_16x16x32_bf16 v[64:67], a[12:15], a[48:51], v[64:67]
  ds_read_b128 a[24:27], v144 offset:34816
  v_mfma_f32_16x16x32_bf16 v[120:123], a[16:19], a[48:51], v[120:123]
  buffer_load_dwordx4 v[208:211], v12, s[40:43], 0 offen
  v_mul_u32_u24 v196, 12288, v196
  v_mfma_f32_16x16x32_bf16 v[80:83], a[12:15], a[52:55], v[80:83]
  ds_read_b64_tr_b16 a[68:69], v134 offset:22528
  v_and_b32 v12, 7, v10
  v_mfma_f32_16x16x32_bf16 v[76:79], a[8:11], a[52:55], v[76:79]
  ds_read_b128 a[28:31], v144 offset:35840
  v_lshl_add_u32 v196, v12, 4, v196
  v_mfma_f32_16x16x32_bf16 v[72:75], a[4:7], a[52:55], v[72:75]
  ds_read_b64_tr_b16 a[70:71], v134 offset:28672
  v_lshlrev_b32 v12, 5, v12
  v_mfma_f32_16x16x32_bf16 v[68:71], a[0:3], a[52:55], v[68:71]
  s_waitcnt lgkmcnt(7)
  buffer_load_dwordx4 v141, s[8:11], s60 offen offset:2048 lds
  s_lshl_b32 s61, s68, 11
  v_mfma_f32_16x16x32_bf16 v[84:87], a[56:59], a[0:3], v[84:87]
  s_add_u32 m0, s63, 119808
  ds_read_b128 a[32:35], v144 offset:36864
  v_lshrrev_b32 v13, 4, v10
  v_mfma_f32_16x16x32_bf16 v[88:91], a[56:59], a[4:7], v[88:91]
  ds_read_b128 a[36:39], v147 offset:41984
  v_lshl_add_u32 v12, v13, 3, v12
  v_mfma_f32_16x16x32_bf16 v[92:95], a[56:59], a[8:11], v[92:95]
  s_add_u32 s48, s64, 162816
  ds_read_b64_tr_b16 a[40:41], v133 offset:23552
  v_add_u32 v197, s48, v12
  v_mfma_f32_16x16x32_bf16 v[96:99], a[56:59], a[12:15], v[96:99]
  buffer_load_dwordx4 v142, s[36:39], s61 offen offset:0 sc1 lds
  v_lshlrev_b32 v198, 2, v10
  v_mfma_f32_16x16x32_bf16 v[112:115], a[60:63], a[12:15], v[112:115]
  ds_read_b64_tr_b16 a[42:43], v133 offset:29696
  v_mfma_f32_16x16x32_bf16 v[108:111], a[60:63], a[8:11], v[108:111]
  s_lshr_b32 s48, s2, 2
  ds_read_b64_tr_b16 a[44:45], v134 offset:23552
  s_and_b32 s49, s2, 3
  v_mfma_f32_16x16x32_bf16 v[104:107], a[60:63], a[4:7], v[104:107]
  s_lshl_b32 s52, s48, 7
  ds_read_b64_tr_b16 a[46:47], v134 offset:29696
  v_mfma_f32_16x16x32_bf16 v[100:103], a[60:63], a[0:3], v[100:103]
  s_waitcnt vmcnt(17) lgkmcnt(4)
  s_barrier
  buffer_load_dwordx4 v142, s[36:39], s61 offen offset:1024 sc1 lds
  v_mfma_f32_16x16x32_bf16 v[20:23], a[64:67], a[20:23], v[20:23]
  s_add_u32 m0, s64, 128000
  ds_read_b64_tr_b16 a[48:49], v133 offset:21504
  v_mfma_f32_16x16x32_bf16 v[24:27], a[64:67], a[24:27], v[24:27]
  v_mfma_f32_16x16x32_bf16 v[28:31], a[64:67], a[28:31], v[28:31]
  s_mul_i32 s53, s49, 24576
  ds_read_b64_tr_b16 a[50:51], v133 offset:27648
  s_lshl1_add_u32 s53, s52, s53
  v_mfma_f32_16x16x32_bf16 v[32:35], a[64:67], a[32:35], v[32:35]
  s_add_u32 s53, s53, 8192
  buffer_load_dword v143, s[36:39], s61 offen sc1 lds
  s_mov_b32 s69, 10
  v_mfma_f32_16x16x32_bf16 v[116:119], a[64:67], a[36:39], v[116:119]
  s_mul_i32 s60, s69, 196608
  s_add_u32 m0, s62, 129024
  ds_read_b64_tr_b16 a[52:53], v134 offset:21504
  v_mfma_f32_16x16x32_bf16 v[48:51], a[68:71], a[32:35], v[48:51]
  s_add_u32 s52, s52, 4096
  v_mfma_f32_16x16x32_bf16 v[44:47], a[68:71], a[28:31], v[44:47]
  ds_read_b64_tr_b16 a[54:55], v134 offset:27648
  v_mfma_f32_16x16x32_bf16 v[40:43], a[68:71], a[24:27], v[40:43]
  buffer_load_dwordx4 v139, s[8:11], s60 offen offset:0 lds
  v_mfma_f32_16x16x32_bf16 v[36:39], a[68:71], a[20:23], v[36:39]
  s_waitcnt lgkmcnt(4)
  ds_read_b64_tr_b16 a[56:57], v133 offset:44032
  s_lshr_b32 s49, s2, 3
  v_mfma_f32_16x16x32_bf16 v[52:55], a[20:23], a[40:43], v[52:55]
  s_and_b32 s71, s49, 7
  ds_read_b128 a[0:3], v144 offset:55296
  s_and_b32 s48, s2, 1
  v_mfma_f32_16x16x32_bf16 v[56:59], a[24:27], a[40:43], v[56:59]
  s_lshl1_add_u32 s55, s71, s48
  ds_read_b64_tr_b16 a[58:59], v133 offset:50176
  v_mfma_f32_16x16x32_bf16 v[60:63], a[28:31], a[40:43], v[60:63]
  buffer_load_dwordx4 v140, s[8:11], s60 offen offset:1024 lds
  v_mfma_f32_16x16x32_bf16 v[64:67], a[32:35], a[40:43], v[64:67]
  ds_read_b128 a[4:7], v144 offset:56320
  v_mfma_f32_16x16x32_bf16 v[120:123], a[36:39], a[40:43], v[120:123]
  ds_read_b64_tr_b16 a[60:61], v134 offset:44032
  v_mfma_f32_16x16x32_bf16 v[80:83], a[32:35], a[44:47], v[80:83]
  s_and_b32 s79, s71, 0
  ds_read_b128 a[8:11], v144 offset:57344
  s_lshl_b32 s79, s79, 3
  v_mfma_f32_16x16x32_bf16 v[76:79], a[28:31], a[44:47], v[76:79]
  buffer_load_dwordx4 v141, s[8:11], s60 offen offset:2048 lds
  s_lshl_b32 s61, s69, 11
  v_mfma_f32_16x16x32_bf16 v[72:75], a[24:27], a[44:47], v[72:75]
  s_add_u32 m0, s63, 141312
  ds_read_b64_tr_b16 a[62:63], v134 offset:50176
  v_mfma_f32_16x16x32_bf16 v[68:71], a[20:23], a[44:47], v[68:71]
  s_waitcnt lgkmcnt(7)
  ds_read_b128 a[12:15], v144 offset:58368
  v_mfma_f32_16x16x32_bf16 v[84:87], a[48:51], a[20:23], v[84:87]
  s_bfe_u32 s54, s2, 0x20001
  ds_read_b128 a[16:19], v147 offset:63488
  s_lshr_b32 s49, s2, 6
  v_mfma_f32_16x16x32_bf16 v[88:91], a[48:51], a[24:27], v[88:91]
  s_lshl2_add_u32 s54, s54, s49
  buffer_load_dwordx4 v142, s[36:39], s61 offen offset:0 sc1 lds
  s_lshl_b32 s73, s44, 12
  v_mfma_f32_16x16x32_bf16 v[92:95], a[48:51], a[28:31], v[92:95]
  ds_read_b64_tr_b16 a[64:65], v133 offset:45056
  v_mfma_f32_16x16x32_bf16 v[96:99], a[48:51], a[32:35], v[96:99]
  ds_read_b64_tr_b16 a[66:67], v133 offset:51200
  v_mfma_f32_16x16x32_bf16 v[112:115], a[52:55], a[32:35], v[112:115]
  ds_read_b64_tr_b16 a[68:69], v134 offset:45056
  v_mfma_f32_16x16x32_bf16 v[108:111], a[52:55], a[28:31], v[108:111]
  buffer_load_dwordx4 v142, s[36:39], s61 offen offset:1024 sc1 lds
  s_add_u32 m0, s64, 149504
  v_mfma_f32_16x16x32_bf16 v[104:107], a[52:55], a[24:27], v[104:107]
  s_lshl_b32 s48, s55, 7
  ds_read_b64_tr_b16 a[70:71], v134 offset:51200
  s_lshl_b32 s49, s44, 16
  v_mfma_f32_16x16x32_bf16 v[100:103], a[52:55], a[20:23], v[100:103]
  s_waitcnt vmcnt(18) lgkmcnt(4)
  s_barrier
  s_add_u32 s48, s48, s49
  v_mfma_f32_16x16x32_bf16 v[20:23], a[56:59], a[0:3], v[20:23]
  ds_read_b64_tr_b16 a[40:41], v133 offset:43008
  v_lshrrev_b32 v12, 3, v10
  v_mfma_f32_16x16x32_bf16 v[24:27], a[56:59], a[4:7], v[24:27]
  buffer_load_dword v143, s[36:39], s61 offen sc1 lds
  s_mov_b32 s70, 11
  v_mfma_f32_16x16x32_bf16 v[28:31], a[56:59], a[8:11], v[28:31]
  s_mul_i32 s60, s70, 196608
  s_add_u32 m0, s62, 0
  ds_read_b64_tr_b16 a[42:43], v133 offset:49152
  v_mfma_f32_16x16x32_bf16 v[32:35], a[56:59], a[12:15], v[32:35]
  v_lshlrev_b32 v12, 11, v12
  v_add3_u32 v216, v12, v150, s48
  v_mfma_f32_16x16x32_bf16 v[116:119], a[56:59], a[16:19], v[116:119]
  ds_read_b64_tr_b16 a[44:45], v134 offset:43008
  v_mfma_f32_16x16x32_bf16 v[48:51], a[60:63], a[12:15], v[48:51]
  buffer_load_dwordx4 v139, s[8:11], s60 offen offset:0 lds
  v_mfma_f32_16x16x32_bf16 v[44:47], a[60:63], a[8:11], v[44:47]
  ds_read_b64_tr_b16 a[46:47], v134 offset:49152
  v_mfma_f32_16x16x32_bf16 v[40:43], a[60:63], a[4:7], v[40:43]
  v_mfma_f32_16x16x32_bf16 v[36:39], a[60:63], a[0:3], v[36:39]
  s_waitcnt lgkmcnt(4)
  ds_read_b64_tr_b16 a[48:49], v135 offset:1024
  v_add_u32 v217, 15360, v216
  v_mfma_f32_16x16x32_bf16 v[52:55], a[0:3], a[64:67], v[52:55]
  buffer_load_dwordx4 v140, s[8:11], s60 offen offset:1024 lds
  v_add_u32 v218, 30720, v216
  v_mfma_f32_16x16x32_bf16 v[56:59], a[4:7], a[64:67], v[56:59]
  ds_read_b128 a[20:23], v145 offset:12288
  v_mfma_f32_16x16x32_bf16 v[60:63], a[8:11], a[64:67], v[60:63]
  ds_read_b64_tr_b16 a[50:51], v135 offset:7168
  v_add_u32 v219, 46080, v216
  v_mfma_f32_16x16x32_bf16 v[64:67], a[12:15], a[64:67], v[64:67]
  s_lshl_b32 s72, s54, 18
  ds_read_b128 a[24:27], v145 offset:13312
  s_add_u32 s72, s72, s48
  v_mfma_f32_16x16x32_bf16 v[120:123], a[16:19], a[64:67], v[120:123]
  buffer_load_dwordx4 v141, s[8:11], s60 offen offset:2048 lds
  s_lshl_b32 s61, s70, 11
  v_mfma_f32_16x16x32_bf16 v[80:83], a[12:15], a[68:71], v[80:83]
  s_add_u32 m0, s63, 12288
  ds_read_b64_tr_b16 a[52:53], v136 offset:1024
  v_mfma_f32_16x16x32_bf16 v[76:79], a[8:11], a[68:71], v[76:79]
  ds_read_b128 a[28:31], v145 offset:14336
  v_and_b32 v13, 7, v10
  v_mfma_f32_16x16x32_bf16 v[72:75], a[4:7], a[68:71], v[72:75]
  ds_read_b64_tr_b16 a[54:55], v136 offset:7168
  v_lshrrev_b32 v14, 4, v10
  v_mfma_f32_16x16x32_bf16 v[68:71], a[0:3], a[68:71], v[68:71]
  s_waitcnt lgkmcnt(7)
  buffer_load_dwordx4 v142, s[36:39], s61 offen offset:0 sc1 lds
  v_xor_b32 v13, v13, v14
  v_mfma_f32_16x16x32_bf16 v[84:87], a[40:43], a[0:3], v[84:87]
  ds_read_b128 a[32:35], v145 offset:15360
  v_lshl_add_u32 v220, v13, 4, v12
  v_mfma_f32_16x16x32_bf16 v[88:91], a[40:43], a[4:7], v[88:91]
  ds_read_b128 a[36:39], v148 offset:20480
  v_xor_b32 v221, 64, v220
  v_mfma_f32_16x16x32_bf16 v[92:95], a[40:43], a[8:11], v[92:95]
  ds_read_b64_tr_b16 a[56:57], v135 offset:2048
  v_add_u32 v221, 15360, v221
  v_mfma_f32_16x16x32_bf16 v[96:99], a[40:43], a[12:15], v[96:99]
  buffer_load_dwordx4 v142, s[36:39], s61 offen offset:1024 sc1 lds
  s_add_u32 m0, s64, 20480
  v_mfma_f32_16x16x32_bf16 v[112:115], a[44:47], a[12:15], v[112:115]
  ds_read_b64_tr_b16 a[58:59], v135 offset:8192
  v_mfma_f32_16x16x32_bf16 v[108:111], a[44:47], a[8:11], v[108:111]
  ds_read_b64_tr_b16 a[60:61], v136 offset:2048
  v_mfma_f32_16x16x32_bf16 v[104:107], a[44:47], a[4:7], v[104:107]
  ds_read_b64_tr_b16 a[62:63], v136 offset:8192
  v_mfma_f32_16x16x32_bf16 v[100:103], a[44:47], a[0:3], v[100:103]
  s_waitcnt vmcnt(18) lgkmcnt(4)
  s_barrier
  buffer_load_dword v143, s[36:39], s61 offen sc1 lds
  v_mfma_f32_16x16x32_bf16 v[20:23], a[48:51], a[20:23], v[20:23]
  s_mov_b32 s65, 12
  s_mul_i32 s60, s65, 196608
  s_add_u32 m0, s62, 21504
  v_mfma_f32_16x16x32_bf16 v[24:27], a[48:51], a[24:27], v[24:27]
  s_lshl_b32 s48, s44, 10
  ds_read_b64_tr_b16 a[64:65], v135 offset:0
  s_add_u32 s48, s48, 147456
  v_mfma_f32_16x16x32_bf16 v[28:31], a[48:51], a[28:31], v[28:31]
  ds_read_b64_tr_b16 a[66:67], v135 offset:6144
  v_add_u32 v246, s48, v0
  v_mfma_f32_16x16x32_bf16 v[32:35], a[48:51], a[32:35], v[32:35]
  buffer_load_dwordx4 v139, s[8:11], s60 offen offset:0 lds
  v_lshl_add_u32 v244, v14, 4, s48
  v_mfma_f32_16x16x32_bf16 v[116:119], a[48:51], a[36:39], v[116:119]
  ds_read_b64_tr_b16 a[68:69], v136 offset:0
  v_and_b32 v12, 1, v10
  v_mfma_f32_16x16x32_bf16 v[48:51], a[52:55], a[32:35], v[48:51]
  v_lshlrev_b32 v12, 8, v12
  v_sub_u32 v245, v244, v12
  v_mfma_f32_16x16x32_bf16 v[44:47], a[52:55], a[28:31], v[44:47]
  ds_read_b64_tr_b16 a[70:71], v136 offset:6144
  v_mfma_f32_16x16x32_bf16 v[40:43], a[52:55], a[24:27], v[40:43]
  buffer_load_dwordx4 v140, s[8:11], s60 offen offset:1024 lds
  v_mfma_f32_16x16x32_bf16 v[36:39], a[52:55], a[20:23], v[36:39]
  s_waitcnt lgkmcnt(4)
  ds_read_b64_tr_b16 a[40:41], v135 offset:22528
  v_mfma_f32_16x16x32_bf16 v[52:55], a[20:23], a[56:59], v[52:55]
  ds_read_b128 a[0:3], v145 offset:33792
  v_mfma_f32_16x16x32_bf16 v[56:59], a[24:27], a[56:59], v[56:59]
  s_lshl_b32 s48, s55, 7
  ds_read_b64_tr_b16 a[42:43], v135 offset:28672
  v_and_b32 v13, 0xf0, v0
  v_mfma_f32_16x16x32_bf16 v[60:63], a[28:31], a[56:59], v[60:63]
  buffer_load_dwordx4 v141, s[8:11], s60 offen offset:2048 lds
  s_lshl_b32 s61, s65, 11
  v_mfma_f32_16x16x32_bf16 v[64:67], a[32:35], a[56:59], v[64:67]
  s_add_u32 m0, s63, 33792
  ds_read_b128 a[4:7], v145 offset:34816
  v_lshl_add_u32 v13, v14, 12, v13
  v_mfma_f32_16x16x32_bf16 v[120:123], a[36:39], a[56:59], v[120:123]
  s_lshl1_add_u32 s48, s48, 8192
  ds_read_b64_tr_b16 a[44:45], v136 offset:22528
  v_add_u32 v248, s48, v13
  v_mfma_f32_16x16x32_bf16 v[80:83], a[32:35], a[60:63], v[80:83]
  ds_read_b128 a[8:11], v145 offset:35840
  v_mfma_f32_16x16x32_bf16 v[76:79], a[28:31], a[60:63], v[76:79]
  buffer_load_dwordx4 v142, s[36:39], s61 offen offset:0 sc1 lds
  v_mfma_f32_16x16x32_bf16 v[72:75], a[24:27], a[60:63], v[72:75]
  ds_read_b64_tr_b16 a[46:47], v136 offset:28672
  v_mfma_f32_16x16x32_bf16 v[68:71], a[20:23], a[60:63], v[68:71]
  s_waitcnt lgkmcnt(7)
  ds_read_b128 a[12:15], v145 offset:36864
  v_mfma_f32_16x16x32_bf16 v[84:87], a[64:67], a[20:23], v[84:87]
  ds_read_b128 a[16:19], v148 offset:41984
  v_lshrrev_b32 v12, 2, v10
  v_mfma_f32_16x16x32_bf16 v[88:91], a[64:67], a[24:27], v[88:91]
  buffer_load_dwordx4 v142, s[36:39], s61 offen offset:1024 sc1 lds
  s_add_u32 m0, s64, 41984
  v_mfma_f32_16x16x32_bf16 v[92:95], a[64:67], a[28:31], v[92:95]
  ds_read_b64_tr_b16 a[48:49], v135 offset:23552
  v_lshl_add_u32 v231, v12, 7, v151
  v_mfma_f32_16x16x32_bf16 v[96:99], a[64:67], a[32:35], v[96:99]
  ds_read_b64_tr_b16 a[50:51], v135 offset:29696
  v_xor_b32 v232, 32, v231
  v_mfma_f32_16x16x32_bf16 v[112:115], a[68:71], a[32:35], v[112:115]
  ds_read_b64_tr_b16 a[52:53], v136 offset:23552
  v_mfma_f32_16x16x32_bf16 v[108:111], a[68:71], a[28:31], v[108:111]
  buffer_load_dword v143, s[36:39], s61 offen sc1 lds
  s_mov_b32 s66, 13
  v_mfma_f32_16x16x32_bf16 v[104:107], a[68:71], a[24:27], v[104:107]
  s_mul_i32 s60, s66, 196608
  s_add_u32 m0, s62, 43008
  ds_read_b64_tr_b16 a[54:55], v136 offset:29696
  v_mfma_f32_16x16x32_bf16 v[100:103], a[68:71], a[20:23], v[100:103]
  s_waitcnt vmcnt(18) lgkmcnt(4)
  s_barrier
  v_xor_b32 v233, 64, v231
  v_mfma_f32_16x16x32_bf16 v[20:23], a[40:43], a[0:3], v[20:23]
  ds_read_b64_tr_b16 a[56:57], v135 offset:21504
  v_xor_b32 v234, 96, v231
  v_mfma_f32_16x16x32_bf16 v[24:27], a[40:43], a[4:7], v[24:27]
  buffer_load_dwordx4 v139, s[8:11], s60 offen offset:0 lds
  v_xor_b32 v235, 65536, v231
  v_mfma_f32_16x16x32_bf16 v[28:31], a[40:43], a[8:11], v[28:31]
  ds_read_b64_tr_b16 a[58:59], v135 offset:27648
  v_xor_b32 v236, 65568, v231
  v_mfma_f32_16x16x32_bf16 v[32:35], a[40:43], a[12:15], v[32:35]
  v_xor_b32 v237, 65600, v231
  v_mfma_f32_16x16x32_bf16 v[116:119], a[40:43], a[16:19], v[116:119]
  ds_read_b64_tr_b16 a[60:61], v136 offset:21504
  v_mfma_f32_16x16x32_bf16 v[48:51], a[44:47], a[12:15], v[48:51]
  buffer_load_dwordx4 v140, s[8:11], s60 offen offset:1024 lds
  v_xor_b32 v238, 65632, v231
  v_mfma_f32_16x16x32_bf16 v[44:47], a[44:47], a[8:11], v[44:47]
  ds_read_b64_tr_b16 a[62:63], v136 offset:27648
  v_mfma_f32_16x16x32_bf16 v[40:43], a[44:47], a[4:7], v[40:43]
  s_add_u32 s48, s73, 131072
  v_and_b32 v12, 15, v10
  v_lshrrev_b32 v14, 1, v12
  v_mfma_f32_16x16x32_bf16 v[36:39], a[44:47], a[0:3], v[36:39]
  s_waitcnt lgkmcnt(4)
  ds_read_b64_tr_b16 a[64:65], v135 offset:44032
  v_lshrrev_b32 v13, 5, v10
  v_mfma_f32_16x16x32_bf16 v[52:55], a[0:3], a[48:51], v[52:55]
  buffer_load_dwordx4 v141, s[8:11], s60 offen offset:2048 lds
  s_lshl_b32 s61, s66, 11
  v_mfma_f32_16x16x32_bf16 v[56:59], a[4:7], a[48:51], v[56:59]
  s_add_u32 m0, s63, 55296
  ds_read_b128 a[20:23], v145 offset:55296
  v_xor_b32 v14, v14, v13
  v_mfma_f32_16x16x32_bf16 v[60:63], a[8:11], a[48:51], v[60:63]
  ds_read_b64_tr_b16 a[66:67], v135 offset:50176
  v_lshlrev_b32 v14, 4, v14
  v_mfma_f32_16x16x32_bf16 v[64:67], a[12:15], a[48:51], v[64:67]
  ds_read_b128 a[24:27], v145 offset:56320
  v_lshl_add_u32 v14, v12, 7, v14
  v_mfma_f32_16x16x32_bf16 v[120:123], a[16:19], a[48:51], v[120:123]
  buffer_load_dwordx4 v142, s[36:39], s61 offen offset:0 sc1 lds
  v_bfe_u32 v13, v10, 4, 1
  v_mfma_f32_16x16x32_bf16 v[80:83], a[12:15], a[52:55], v[80:83]
  ds_read_b64_tr_b16 a[68:69], v136 offset:44032
  v_lshl_add_u32 v14, v13, 3, v14
  v_mfma_f32_16x16x32_bf16 v[76:79], a[8:11], a[52:55], v[76:79]
  ds_read_b128 a[28:31], v145 offset:57344
  v_add_u32 v239, s48, v14
  v_mfma_f32_16x16x32_bf16 v[72:75], a[4:7], a[52:55], v[72:75]
  ds_read_b64_tr_b16 a[70:71], v136 offset:50176
  v_xor_b32 v240, 32, v239
  v_mfma_f32_16x16x32_bf16 v[68:71], a[0:3], a[52:55], v[68:71]
  s_waitcnt lgkmcnt(7)
  buffer_load_dwordx4 v142, s[36:39], s61 offen offset:1024 sc1 lds
  s_add_u32 m0, s64, 63488
  v_mfma_f32_16x16x32_bf16 v[84:87], a[56:59], a[0:3], v[84:87]
  ds_read_b128 a[32:35], v145 offset:58368
  v_xor_b32 v241, 64, v239
  v_mfma_f32_16x16x32_bf16 v[88:91], a[56:59], a[4:7], v[88:91]
  ds_read_b128 a[36:39], v148 offset:63488
  v_xor_b32 v242, 96, v239
  v_mfma_f32_16x16x32_bf16 v[92:95], a[56:59], a[8:11], v[92:95]
  ds_read_b64_tr_b16 a[40:41], v135 offset:45056
  v_mfma_f32_16x16x32_bf16 v[96:99], a[56:59], a[12:15], v[96:99]
  buffer_load_dword v143, s[36:39], s61 offen sc1 lds
  s_mov_b32 s67, 14
  v_mfma_f32_16x16x32_bf16 v[112:115], a[60:63], a[12:15], v[112:115]
  s_mul_i32 s60, s67, 196608
  s_add_u32 m0, s62, 64512
  ds_read_b64_tr_b16 a[42:43], v135 offset:51200
  v_mfma_f32_16x16x32_bf16 v[108:111], a[60:63], a[8:11], v[108:111]
  ds_read_b64_tr_b16 a[44:45], v136 offset:45056
  v_mfma_f32_16x16x32_bf16 v[104:107], a[60:63], a[4:7], v[104:107]
  ds_read_b64_tr_b16 a[46:47], v136 offset:51200
  v_mfma_f32_16x16x32_bf16 v[100:103], a[60:63], a[0:3], v[100:103]
  s_waitcnt vmcnt(18) lgkmcnt(4)
  s_barrier
  buffer_load_dwordx4 v139, s[8:11], s60 offen offset:0 lds
  v_mfma_f32_16x16x32_bf16 v[20:23], a[64:67], a[20:23], v[20:23]
  ds_read_b64_tr_b16 a[48:49], v135 offset:43008
  v_mfma_f32_16x16x32_bf16 v[24:27], a[64:67], a[24:27], v[24:27]
  s_lshl2_add_u32 s48, s54, s44
  s_lshl_b32 s49, s48, 16
  s_add_u32 s49, s49, 7340032
  v_mfma_f32_16x16x32_bf16 v[28:31], a[64:67], a[28:31], v[28:31]
  ds_read_b64_tr_b16 a[50:51], v135 offset:49152
  v_add_u32 v243, s49, v0
  v_mfma_f32_16x16x32_bf16 v[32:35], a[64:67], a[32:35], v[32:35]
  buffer_load_dwordx4 v140, s[8:11], s60 offen offset:1024 lds
  v_mfma_f32_16x16x32_bf16 v[116:119], a[64:67], a[36:39], v[116:119]
  ds_read_b64_tr_b16 a[52:53], v136 offset:43008
  v_mfma_f32_16x16x32_bf16 v[48:51], a[68:71], a[32:35], v[48:51]
  v_mfma_f32_16x16x32_bf16 v[44:47], a[68:71], a[28:31], v[44:47]
  ds_read_b64_tr_b16 a[54:55], v136 offset:49152
  v_mfma_f32_16x16x32_bf16 v[40:43], a[68:71], a[24:27], v[40:43]
  buffer_load_dwordx4 v141, s[8:11], s60 offen offset:2048 lds
  s_lshl_b32 s61, s67, 11
  v_mfma_f32_16x16x32_bf16 v[36:39], a[68:71], a[20:23], v[36:39]
  s_waitcnt lgkmcnt(4)
  s_add_u32 m0, s63, 76800
  ds_read_b64_tr_b16 a[56:57], v137 offset:1024
  v_mfma_f32_16x16x32_bf16 v[52:55], a[20:23], a[40:43], v[52:55]
  s_lshl4_add_u32 s77, s48, s55
  ds_read_b128 a[0:3], v146 offset:12288
  s_lshl_b32 s77, s77, 8
  v_mfma_f32_16x16x32_bf16 v[56:59], a[24:27], a[40:43], v[56:59]
  s_add_u32 s77, s77, 262144
  ds_read_b64_tr_b16 a[58:59], v137 offset:7168
  v_mfma_f32_16x16x32_bf16 v[60:63], a[28:31], a[40:43], v[60:63]
  buffer_load_dwordx4 v142, s[36:39], s61 offen offset:0 sc1 lds
  v_mfma_f32_16x16x32_bf16 v[64:67], a[32:35], a[40:43], v[64:67]
  ds_read_b128 a[4:7], v146 offset:13312
  v_mfma_f32_16x16x32_bf16 v[120:123], a[36:39], a[40:43], v[120:123]
  s_lshr_b32 s76, s48, 1
  ds_read_b64_tr_b16 a[60:61], v138 offset:1024
  s_lshl4_add_u32 s76, s76, s55
  v_mfma_f32_16x16x32_bf16 v[80:83], a[32:35], a[44:47], v[80:83]
  s_and_b32 s49, s48, 1
  ds_read_b128 a[8:11], v146 offset:14336
  s_lshl2_add_u32 s76, s76, s49
  v_mfma_f32_16x16x32_bf16 v[76:79], a[28:31], a[44:47], v[76:79]
  s_lshl_b32 s76, s76, 11
  buffer_load_dwordx4 v142, s[36:39], s61 offen offset:1024 sc1 lds
  s_add_u32 m0, s64, 84992
  v_mfma_f32_16x16x32_bf16 v[72:75], a[24:27], a[44:47], v[72:75]
  s_add_u32 s76, s76, 36700160
  ds_read_b64_tr_b16 a[62:63], v138 offset:7168
  v_mfma_f32_16x16x32_bf16 v[68:71], a[20:23], a[44:47], v[68:71]
  s_waitcnt lgkmcnt(7)
  ds_read_b128 a[12:15], v146 offset:15360
  v_mfma_f32_16x16x32_bf16 v[84:87], a[48:51], a[20:23], v[84:87]
  ds_read_b128 a[16:19], v149 offset:20480
  v_mfma_f32_16x16x32_bf16 v[88:91], a[48:51], a[24:27], v[88:91]
  buffer_load_dword v143, s[36:39], s61 offen sc1 lds
  s_mov_b32 s68, 15
  v_mfma_f32_16x16x32_bf16 v[92:95], a[48:51], a[28:31], v[92:95]
  s_mul_i32 s60, s68, 196608
  s_add_u32 m0, s62, 86016
  ds_read_b64_tr_b16 a[64:65], v137 offset:2048
  v_mfma_f32_16x16x32_bf16 v[96:99], a[48:51], a[32:35], v[96:99]
  ds_read_b64_tr_b16 a[66:67], v137 offset:8192
  v_mfma_f32_16x16x32_bf16 v[112:115], a[52:55], a[32:35], v[112:115]
  s_lshl1_add_u32 s78, s48, s55
  ds_read_b64_tr_b16 a[68:69], v138 offset:2048
  s_lshl_b32 s78, s78, 11
  v_mfma_f32_16x16x32_bf16 v[108:111], a[52:55], a[28:31], v[108:111]
  s_add_u32 s78, s78, 5767168
  buffer_load_dwordx4 v139, s[8:11], s60 offen offset:0 lds
  s_and_b32 s48, s48, 7
  v_mfma_f32_16x16x32_bf16 v[104:107], a[52:55], a[24:27], v[104:107]
  s_cselect_b32 s78, 1073741824, s78
  ds_read_b64_tr_b16 a[70:71], v138 offset:8192
  v_mfma_f32_16x16x32_bf16 v[100:103], a[52:55], a[20:23], v[100:103]
  s_waitcnt vmcnt(19) lgkmcnt(4)
  s_barrier
  v_mfma_f32_16x16x32_bf16 v[20:23], a[56:59], a[0:3], v[20:23]
  ds_read_b64_tr_b16 a[40:41], v137 offset:0
  v_mfma_f32_16x16x32_bf16 v[24:27], a[56:59], a[4:7], v[24:27]
  buffer_load_dwordx4 v140, s[8:11], s60 offen offset:1024 lds
  v_mfma_f32_16x16x32_bf16 v[28:31], a[56:59], a[8:11], v[28:31]
  ds_read_b64_tr_b16 a[42:43], v137 offset:6144
  v_mfma_f32_16x16x32_bf16 v[32:35], a[56:59], a[12:15], v[32:35]
  v_mfma_f32_16x16x32_bf16 v[116:119], a[56:59], a[16:19], v[116:119]
  s_and_b32 s48, s54, 7
  ds_read_b64_tr_b16 a[44:45], v138 offset:0
  s_lshl_b32 s48, s48, 5
  v_mfma_f32_16x16x32_bf16 v[48:51], a[60:63], a[12:15], v[48:51]
  s_lshr_b32 s49, s54, 3
  buffer_load_dwordx4 v141, s[8:11], s60 offen offset:2048 lds
  s_lshl_b32 s61, s68, 11
  v_mfma_f32_16x16x32_bf16 v[44:47], a[60:63], a[8:11], v[44:47]
  s_add_u32 m0, s63, 98304
  ds_read_b64_tr_b16 a[46:47], v138 offset:6144
  s_lshl2_add_u32 s48, s49, s48
  v_mfma_f32_16x16x32_bf16 v[40:43], a[60:63], a[4:7], v[40:43]
  v_mfma_f32_16x16x32_bf16 v[36:39], a[60:63], a[0:3], v[36:39]
  s_waitcnt lgkmcnt(4)
  ds_read_b64_tr_b16 a[48:49], v133 offset:1024
  v_mfma_f32_16x16x32_bf16 v[52:55], a[0:3], a[64:67], v[52:55]
  buffer_load_dwordx4 v142, s[36:39], s61 offen offset:0 sc1 lds
  v_mfma_f32_16x16x32_bf16 v[56:59], a[4:7], a[64:67], v[56:59]
  ds_read_b128 a[20:23], v144 offset:12288
  v_mfma_f32_16x16x32_bf16 v[60:63], a[8:11], a[64:67], v[60:63]
  ds_read_b64_tr_b16 a[50:51], v133 offset:7168
  v_and_b32 v12, 3, v10
  v_mfma_f32_16x16x32_bf16 v[64:67], a[12:15], a[64:67], v[64:67]
  ds_read_b128 a[24:27], v144 offset:13312
  v_bfe_u32 v13, v10, 2, 2
  v_mfma_f32_16x16x32_bf16 v[120:123], a[16:19], a[64:67], v[120:123]
  buffer_load_dwordx4 v142, s[36:39], s61 offen offset:1024 sc1 lds
  s_add_u32 m0, s64, 106496
  v_mfma_f32_16x16x32_bf16 v[80:83], a[12:15], a[68:71], v[80:83]
  ds_read_b64_tr_b16 a[52:53], v134 offset:1024
  v_lshl_add_u32 v12, v13, 3, v12
  v_mfma_f32_16x16x32_bf16 v[76:79], a[8:11], a[68:71], v[76:79]
  ds_read_b128 a[28:31], v144 offset:14336
  v_add_lshl_u32 v249, v12, s48, 7
  v_mfma_f32_16x16x32_bf16 v[72:75], a[4:7], a[68:71], v[72:75]
  ds_read_b64_tr_b16 a[54:55], v134 offset:7168
  v_mfma_f32_16x16x32_bf16 v[68:71], a[0:3], a[68:71], v[68:71]
  s_waitcnt lgkmcnt(7)
  buffer_load_dword v143, s[36:39], s61 offen sc1 lds
  s_mov_b32 s69, 16
  v_mfma_f32_16x16x32_bf16 v[84:87], a[40:43], a[0:3], v[84:87]
  s_mul_i32 s60, s69, 196608
  s_add_u32 m0, s62, 107520
  ds_read_b128 a[32:35], v144 offset:15360
  v_mfma_f32_16x16x32_bf16 v[88:91], a[40:43], a[4:7], v[88:91]
  s_waitcnt vmcnt(40)
  ds_read_b128 a[36:39], v147 offset:20480
  v_lshlrev_b32 v188, 16, v208
  v_mfma_f32_16x16x32_bf16 v[92:95], a[40:43], a[8:11], v[92:95]
  ds_read_b64_tr_b16 a[56:57], v133 offset:2048
  v_and_b32 v189, 0xffff0000, v208
  v_mfma_f32_16x16x32_bf16 v[96:99], a[40:43], a[12:15], v[96:99]
  buffer_load_dwordx4 v139, s[8:11], s60 offen offset:0 lds
  v_mfma_f32_16x16x32_bf16 v[112:115], a[44:47], a[12:15], v[112:115]
  ds_read_b64_tr_b16 a[58:59], v133 offset:8192
  v_lshlrev_b32 v190, 16, v209
  v_mfma_f32_16x16x32_bf16 v[108:111], a[44:47], a[8:11], v[108:111]
  ds_read_b64_tr_b16 a[60:61], v134 offset:2048
  v_mfma_f32_16x16x32_bf16 v[104:107], a[44:47], a[4:7], v[104:107]
  ds_read_b64_tr_b16 a[62:63], v134 offset:8192
  v_and_b32 v191, 0xffff0000, v209
  v_mfma_f32_16x16x32_bf16 v[100:103], a[44:47], a[0:3], v[100:103]
  s_waitcnt vmcnt(19) lgkmcnt(4)
  s_barrier
  buffer_load_dwordx4 v140, s[8:11], s60 offen offset:1024 lds
  v_mfma_f32_16x16x32_bf16 v[20:23], a[48:51], a[20:23], v[20:23]
  ds_read_b64_tr_b16 a[64:65], v133 offset:0
  v_lshlrev_b32 v192, 16, v210
  v_mfma_f32_16x16x32_bf16 v[24:27], a[48:51], a[24:27], v[24:27]
Ha1:
  s_cbranch_execz Ha1_1
  v_and_b32 v193, 0xffff0000, v210
  v_mfma_f32_16x16x32_bf16 v[28:31], a[48:51], a[28:31], v[28:31]
  ds_read_b64_tr_b16 a[66:67], v133 offset:6144
  v_lshlrev_b32 v194, 16, v211
  v_mfma_f32_16x16x32_bf16 v[32:35], a[48:51], a[32:35], v[32:35]
  buffer_load_dwordx4 v141, s[8:11], s60 offen offset:2048 lds
  s_lshl_b32 s61, s69, 11
  v_mfma_f32_16x16x32_bf16 v[116:119], a[48:51], a[36:39], v[116:119]
  s_add_u32 m0, s63, 119808
  ds_read_b64_tr_b16 a[68:69], v134 offset:0
  v_and_b32 v195, 0xffff0000, v211
  v_mfma_f32_16x16x32_bf16 v[48:51], a[52:55], a[32:35], v[48:51]
  v_mfma_f32_16x16x32_bf16 v[44:47], a[52:55], a[28:31], v[44:47]
  ds_read_b64_tr_b16 a[70:71], v134 offset:6144
  v_mul_f32 v200, 0xbfb8aa3b, v188
  v_mfma_f32_16x16x32_bf16 v[40:43], a[52:55], a[24:27], v[40:43]
  buffer_load_dwordx4 v142, s[36:39], s61 offen offset:0 sc1 lds
  v_mul_f32 v201, 0xbfb8aa3b, v189
  v_mfma_f32_16x16x32_bf16 v[36:39], a[52:55], a[20:23], v[36:39]
  s_waitcnt lgkmcnt(4)
  ds_read_b64_tr_b16 a[40:41], v133 offset:22528
  v_mfma_f32_16x16x32_bf16 v[52:55], a[20:23], a[56:59], v[52:55]
  ds_read_b128 a[0:3], v144 offset:33792
  v_mul_f32 v202, 0xbfb8aa3b, v190
  v_mfma_f32_16x16x32_bf16 v[56:59], a[24:27], a[56:59], v[56:59]
  ds_read_b64_tr_b16 a[42:43], v133 offset:28672
  v_mul_f32 v203, 0xbfb8aa3b, v191
  v_mfma_f32_16x16x32_bf16 v[60:63], a[28:31], a[56:59], v[60:63]
  buffer_load_dwordx4 v142, s[36:39], s61 offen offset:1024 sc1 lds
  s_add_u32 m0, s64, 128000
  v_mfma_f32_16x16x32_bf16 v[64:67], a[32:35], a[56:59], v[64:67]
  ds_read_b128 a[4:7], v144 offset:34816
  v_mul_f32 v204, 0xbfb8aa3b, v192
  v_mfma_f32_16x16x32_bf16 v[120:123], a[36:39], a[56:59], v[120:123]
  ds_read_b64_tr_b16 a[44:45], v134 offset:22528
  v_mfma_f32_16x16x32_bf16 v[80:83], a[32:35], a[60:63], v[80:83]
  ds_read_b128 a[8:11], v144 offset:35840
  v_mul_f32 v205, 0xbfb8aa3b, v193
  v_mfma_f32_16x16x32_bf16 v[76:79], a[28:31], a[60:63], v[76:79]
  buffer_load_dword v143, s[36:39], s61 offen sc1 lds
  s_mov_b32 s70, 17
  v_mfma_f32_16x16x32_bf16 v[72:75], a[24:27], a[60:63], v[72:75]
  s_mul_i32 s60, s70, 196608
  s_add_u32 m0, s62, 129024
  ds_read_b64_tr_b16 a[46:47], v134 offset:28672
  v_mfma_f32_16x16x32_bf16 v[68:71], a[20:23], a[60:63], v[68:71]
  s_waitcnt lgkmcnt(7)
  ds_read_b128 a[12:15], v144 offset:36864
  v_mul_f32 v206, 0xbfb8aa3b, v194
  v_mfma_f32_16x16x32_bf16 v[84:87], a[64:67], a[20:23], v[84:87]
  ds_read_b128 a[16:19], v147 offset:41984
  v_mul_f32 v207, 0xbfb8aa3b, v195
  v_mfma_f32_16x16x32_bf16 v[88:91], a[64:67], a[24:27], v[88:91]
  buffer_load_dwordx4 v139, s[8:11], s60 offen offset:0 lds
  v_mfma_f32_16x16x32_bf16 v[92:95], a[64:67], a[28:31], v[92:95]
  ds_read_b64_tr_b16 a[48:49], v133 offset:23552
  v_mfma_f32_16x16x32_bf16 v[96:99], a[64:67], a[32:35], v[96:99]
  ds_read_b64_tr_b16 a[50:51], v133 offset:29696
  v_mfma_f32_16x16x32_bf16 v[112:115], a[68:71], a[32:35], v[112:115]
  ds_read_b64_tr_b16 a[52:53], v134 offset:23552
  v_mfma_f32_16x16x32_bf16 v[108:111], a[68:71], a[28:31], v[108:111]
  buffer_load_dwordx4 v140, s[8:11], s60 offen offset:1024 lds
  v_mfma_f32_16x16x32_bf16 v[104:107], a[68:71], a[24:27], v[104:107]
  ds_read_b64_tr_b16 a[54:55], v134 offset:29696
  v_mfma_f32_16x16x32_bf16 v[100:103], a[68:71], a[20:23], v[100:103]
  s_waitcnt vmcnt(20) lgkmcnt(4)
  s_barrier
  v_mfma_f32_16x16x32_bf16 v[20:23], a[40:43], a[0:3], v[20:23]
  ds_read_b64_tr_b16 a[56:57], v133 offset:21504
  v_mfma_f32_16x16x32_bf16 v[24:27], a[40:43], a[4:7], v[24:27]
  buffer_load_dwordx4 v141, s[8:11], s60 offen offset:2048 lds
  s_lshl_b32 s61, s70, 11
  v_mfma_f32_16x16x32_bf16 v[28:31], a[40:43], a[8:11], v[28:31]
  s_add_u32 m0, s63, 141312
  ds_read_b64_tr_b16 a[58:59], v133 offset:27648
  v_mfma_f32_16x16x32_bf16 v[32:35], a[40:43], a[12:15], v[32:35]
  v_exp_f32 v200, v200
  v_mfma_f32_16x16x32_bf16 v[116:119], a[40:43], a[16:19], v[116:119]
  ds_read_b64_tr_b16 a[60:61], v134 offset:21504
  v_mfma_f32_16x16x32_bf16 v[48:51], a[44:47], a[12:15], v[48:51]
  buffer_load_dwordx4 v142, s[36:39], s61 offen offset:0 sc1 lds
  v_mfma_f32_16x16x32_bf16 v[44:47], a[44:47], a[8:11], v[44:47]
  ds_read_b64_tr_b16 a[62:63], v134 offset:27648
  v_mfma_f32_16x16x32_bf16 v[40:43], a[44:47], a[4:7], v[40:43]
  v_exp_f32 v201, v201
  v_mfma_f32_16x16x32_bf16 v[36:39], a[44:47], a[0:3], v[36:39]
  s_waitcnt lgkmcnt(4)
  ds_read_b64_tr_b16 a[64:65], v133 offset:44032
  v_mfma_f32_16x16x32_bf16 v[52:55], a[0:3], a[48:51], v[52:55]
  buffer_load_dwordx4 v142, s[36:39], s61 offen offset:1024 sc1 lds
  s_add_u32 m0, s64, 149504
  v_mfma_f32_16x16x32_bf16 v[56:59], a[4:7], a[48:51], v[56:59]
  ds_read_b128 a[20:23], v144 offset:55296
  v_mfma_f32_16x16x32_bf16 v[60:63], a[8:11], a[48:51], v[60:63]
  ds_read_b64_tr_b16 a[66:67], v133 offset:50176
  v_mfma_f32_16x16x32_bf16 v[64:67], a[12:15], a[48:51], v[64:67]
  ds_read_b128 a[24:27], v144 offset:56320
  v_mfma_f32_16x16x32_bf16 v[120:123], a[16:19], a[48:51], v[120:123]
  buffer_load_dword v143, s[36:39], s61 offen sc1 lds
  s_mov_b32 s65, 18
  v_mfma_f32_16x16x32_bf16 v[80:83], a[12:15], a[52:55], v[80:83]
  s_mul_i32 s60, s65, 196608
  s_add_u32 m0, s62, 0
  ds_read_b64_tr_b16 a[68:69], v134 offset:44032
  v_mfma_f32_16x16x32_bf16 v[76:79], a[8:11], a[52:55], v[76:79]
  ds_read_b128 a[28:31], v144 offset:57344
  v_mfma_f32_16x16x32_bf16 v[72:75], a[4:7], a[52:55], v[72:75]
  ds_read_b64_tr_b16 a[70:71], v134 offset:50176
  v_mfma_f32_16x16x32_bf16 v[68:71], a[0:3], a[52:55], v[68:71]
  s_waitcnt lgkmcnt(7)
  buffer_load_dwordx4 v139, s[8:11], s60 offen offset:0 lds
  v_mfma_f32_16x16x32_bf16 v[84:87], a[56:59], a[0:3], v[84:87]
  ds_read_b128 a[32:35], v144 offset:58368
  v_mfma_f32_16x16x32_bf16 v[88:91], a[56:59], a[4:7], v[88:91]
  ds_read_b128 a[36:39], v147 offset:63488
  v_mfma_f32_16x16x32_bf16 v[92:95], a[56:59], a[8:11], v[92:95]
  ds_read_b64_tr_b16 a[40:41], v133 offset:45056
  v_mfma_f32_16x16x32_bf16 v[96:99], a[56:59], a[12:15], v[96:99]
  buffer_load_dwordx4 v140, s[8:11], s60 offen offset:1024 lds
  v_mfma_f32_16x16x32_bf16 v[112:115], a[60:63], a[12:15], v[112:115]
  ds_read_b64_tr_b16 a[42:43], v133 offset:51200
  v_mfma_f32_16x16x32_bf16 v[108:111], a[60:63], a[8:11], v[108:111]
  ds_read_b64_tr_b16 a[44:45], v134 offset:45056
  v_mfma_f32_16x16x32_bf16 v[104:107], a[60:63], a[4:7], v[104:107]
  ds_read_b64_tr_b16 a[46:47], v134 offset:51200
  v_mfma_f32_16x16x32_bf16 v[100:103], a[60:63], a[0:3], v[100:103]
  s_waitcnt vmcnt(20) lgkmcnt(4)
  s_barrier
  buffer_load_dwordx4 v141, s[8:11], s60 offen offset:2048 lds
  v_mfma_f32_16x16x32_bf16 v[20:23], a[64:67], a[20:23], v[20:23]
  s_lshl_b32 s61, s65, 11
  s_add_u32 m0, s63, 12288
  ds_read_b64_tr_b16 a[48:49], v133 offset:43008
  v_mfma_f32_16x16x32_bf16 v[24:27], a[64:67], a[24:27], v[24:27]
  v_exp_f32 v202, v202
  v_mfma_f32_16x16x32_bf16 v[28:31], a[64:67], a[28:31], v[28:31]
  ds_read_b64_tr_b16 a[50:51], v133 offset:49152
  v_mfma_f32_16x16x32_bf16 v[32:35], a[64:67], a[32:35], v[32:35]
  buffer_load_dwordx4 v142, s[36:39], s61 offen offset:0 sc1 lds
  v_mfma_f32_16x16x32_bf16 v[116:119], a[64:67], a[36:39], v[116:119]
  ds_read_b64_tr_b16 a[52:53], v134 offset:43008
  v_mfma_f32_16x16x32_bf16 v[48:51], a[68:71], a[32:35], v[48:51]
  v_exp_f32 v203, v203
  v_mfma_f32_16x16x32_bf16 v[44:47], a[68:71], a[28:31], v[44:47]
  ds_read_b64_tr_b16 a[54:55], v134 offset:49152
  v_mfma_f32_16x16x32_bf16 v[40:43], a[68:71], a[24:27], v[40:43]
  buffer_load_dwordx4 v142, s[36:39], s61 offen offset:1024 sc1 lds
  s_add_u32 m0, s64, 20480
  v_mfma_f32_16x16x32_bf16 v[36:39], a[68:71], a[20:23], v[36:39]
  s_waitcnt lgkmcnt(4)
  ds_read_b64_tr_b16 a[56:57], v135 offset:1024
  v_mfma_f32_16x16x32_bf16 v[52:55], a[20:23], a[40:43], v[52:55]
  ds_read_b128 a[0:3], v145 offset:12288
  v_mfma_f32_16x16x32_bf16 v[56:59], a[24:27], a[40:43], v[56:59]
  ds_read_b64_tr_b16 a[58:59], v135 offset:7168
  v_mfma_f32_16x16x32_bf16 v[60:63], a[28:31], a[40:43], v[60:63]
  buffer_load_dword v143, s[36:39], s61 offen sc1 lds
  s_mov_b32 s66, 19
  v_mfma_f32_16x16x32_bf16 v[64:67], a[32:35], a[40:43], v[64:67]
  s_mul_i32 s60, s66, 196608
  s_add_u32 m0, s62, 21504
  ds_read_b128 a[4:7], v145 offset:13312
  v_mfma_f32_16x16x32_bf16 v[120:123], a[36:39], a[40:43], v[120:123]
  ds_read_b64_tr_b16 a[60:61], v136 offset:1024
  v_mfma_f32_16x16x32_bf16 v[80:83], a[32:35], a[44:47], v[80:83]
  ds_read_b128 a[8:11], v145 offset:14336
  v_mfma_f32_16x16x32_bf16 v[76:79], a[28:31], a[44:47], v[76:79]
  buffer_load_dwordx4 v139, s[8:11], s60 offen offset:0 lds
  v_mfma_f32_16x16x32_bf16 v[72:75], a[24:27], a[44:47], v[72:75]
  ds_read_b64_tr_b16 a[62:63], v136 offset:7168
  v_mfma_f32_16x16x32_bf16 v[68:71], a[20:23], a[44:47], v[68:71]
  s_waitcnt lgkmcnt(7)
  ds_read_b128 a[12:15], v145 offset:15360
  v_mfma_f32_16x16x32_bf16 v[84:87], a[48:51], a[20:23], v[84:87]
  ds_read_b128 a[16:19], v148 offset:20480
  v_mfma_f32_16x16x32_bf16 v[88:91], a[48:51], a[24:27], v[88:91]
  buffer_load_dwordx4 v140, s[8:11], s60 offen offset:1024 lds
  v_mfma_f32_16x16x32_bf16 v[92:95], a[48:51], a[28:31], v[92:95]
  ds_read_b64_tr_b16 a[64:65], v135 offset:2048
  v_mfma_f32_16x16x32_bf16 v[96:99], a[48:51], a[32:35], v[96:99]
  ds_read_b64_tr_b16 a[66:67], v135 offset:8192
  v_mfma_f32_16x16x32_bf16 v[112:115], a[52:55], a[32:35], v[112:115]
  ds_read_b64_tr_b16 a[68:69], v136 offset:2048
  v_mfma_f32_16x16x32_bf16 v[108:111], a[52:55], a[28:31], v[108:111]
  buffer_load_dwordx4 v141, s[8:11], s60 offen offset:2048 lds
  s_lshl_b32 s61, s66, 11
  v_mfma_f32_16x16x32_bf16 v[104:107], a[52:55], a[24:27], v[104:107]
  s_add_u32 m0, s63, 33792
  ds_read_b64_tr_b16 a[70:71], v136 offset:8192
  v_mfma_f32_16x16x32_bf16 v[100:103], a[52:55], a[20:23], v[100:103]
  s_waitcnt vmcnt(21) lgkmcnt(4)
  s_barrier
  v_mfma_f32_16x16x32_bf16 v[20:23], a[56:59], a[0:3], v[20:23]
  ds_read_b64_tr_b16 a[40:41], v135 offset:0
  v_mfma_f32_16x16x32_bf16 v[24:27], a[56:59], a[4:7], v[24:27]
  buffer_load_dwordx4 v142, s[36:39], s61 offen offset:0 sc1 lds
  v_mfma_f32_16x16x32_bf16 v[28:31], a[56:59], a[8:11], v[28:31]
  ds_read_b64_tr_b16 a[42:43], v135 offset:6144
  v_mfma_f32_16x16x32_bf16 v[32:35], a[56:59], a[12:15], v[32:35]
  v_exp_f32 v204, v204
  v_mfma_f32_16x16x32_bf16 v[116:119], a[56:59], a[16:19], v[116:119]
  ds_read_b64_tr_b16 a[44:45], v136 offset:0
  v_mfma_f32_16x16x32_bf16 v[48:51], a[60:63], a[12:15], v[48:51]
  buffer_load_dwordx4 v142, s[36:39], s61 offen offset:1024 sc1 lds
  s_add_u32 m0, s64, 41984
  v_mfma_f32_16x16x32_bf16 v[44:47], a[60:63], a[8:11], v[44:47]
  ds_read_b64_tr_b16 a[46:47], v136 offset:6144
  v_mfma_f32_16x16x32_bf16 v[40:43], a[60:63], a[4:7], v[40:43]
  v_exp_f32 v205, v205
  v_mfma_f32_16x16x32_bf16 v[36:39], a[60:63], a[0:3], v[36:39]
  s_waitcnt lgkmcnt(4)
  ds_read_b64_tr_b16 a[48:49], v135 offset:22528
  v_mfma_f32_16x16x32_bf16 v[52:55], a[0:3], a[64:67], v[52:55]
  buffer_load_dword v143, s[36:39], s61 offen sc1 lds
  s_mov_b32 s67, 20
  v_mfma_f32_16x16x32_bf16 v[56:59], a[4:7], a[64:67], v[56:59]
  s_mul_i32 s60, s67, 196608
  s_add_u32 m0, s62, 43008
  ds_read_b128 a[20:23], v145 offset:33792
  v_mfma_f32_16x16x32_bf16 v[60:63], a[8:11], a[64:67], v[60:63]
  ds_read_b64_tr_b16 a[50:51], v135 offset:28672
  v_mfma_f32_16x16x32_bf16 v[64:67], a[12:15], a[64:67], v[64:67]
  ds_read_b128 a[24:27], v145 offset:34816
  v_mfma_f32_16x16x32_bf16 v[120:123], a[16:19], a[64:67], v[120:123]
  buffer_load_dwordx4 v139, s[8:11], s60 offen offset:0 lds
  v_mfma_f32_16x16x32_bf16 v[80:83], a[12:15], a[68:71], v[80:83]
  ds_read_b64_tr_b16 a[52:53], v136 offset:22528
  v_mfma_f32_16x16x32_bf16 v[76:79], a[8:11], a[68:71], v[76:79]
  ds_read_b128 a[28:31], v145 offset:35840
  v_mfma_f32_16x16x32_bf16 v[72:75], a[4:7], a[68:71], v[72:75]
  ds_read_b64_tr_b16 a[54:55], v136 offset:28672
  v_mfma_f32_16x16x32_bf16 v[68:71], a[0:3], a[68:71], v[68:71]
  s_waitcnt lgkmcnt(7)
  buffer_load_dwordx4 v140, s[8:11], s60 offen offset:1024 lds
  v_mfma_f32_16x16x32_bf16 v[84:87], a[40:43], a[0:3], v[84:87]
  ds_read_b128 a[32:35], v145 offset:36864
  v_mfma_f32_16x16x32_bf16 v[88:91], a[40:43], a[4:7], v[88:91]
  ds_read_b128 a[36:39], v148 offset:41984
  v_mfma_f32_16x16x32_bf16 v[92:95], a[40:43], a[8:11], v[92:95]
  ds_read_b64_tr_b16 a[56:57], v135 offset:23552
  v_mfma_f32_16x16x32_bf16 v[96:99], a[40:43], a[12:15], v[96:99]
  buffer_load_dwordx4 v141, s[8:11], s60 offen offset:2048 lds
  s_lshl_b32 s61, s67, 11
  v_mfma_f32_16x16x32_bf16 v[112:115], a[44:47], a[12:15], v[112:115]
  s_add_u32 m0, s63, 55296
  ds_read_b64_tr_b16 a[58:59], v135 offset:29696
  v_mfma_f32_16x16x32_bf16 v[108:111], a[44:47], a[8:11], v[108:111]
  ds_read_b64_tr_b16 a[60:61], v136 offset:23552
  v_mfma_f32_16x16x32_bf16 v[104:107], a[44:47], a[4:7], v[104:107]
  ds_read_b64_tr_b16 a[62:63], v136 offset:29696
  v_mfma_f32_16x16x32_bf16 v[100:103], a[44:47], a[0:3], v[100:103]
  s_waitcnt vmcnt(21) lgkmcnt(4)
  s_barrier
  buffer_load_dwordx4 v142, s[36:39], s61 offen offset:0 sc1 lds
  v_mfma_f32_16x16x32_bf16 v[20:23], a[48:51], a[20:23], v[20:23]
  ds_read_b64_tr_b16 a[64:65], v135 offset:21504
  v_mfma_f32_16x16x32_bf16 v[24:27], a[48:51], a[24:27], v[24:27]
  v_exp_f32 v206, v206
  v_mfma_f32_16x16x32_bf16 v[28:31], a[48:51], a[28:31], v[28:31]
  ds_read_b64_tr_b16 a[66:67], v135 offset:27648
  v_mfma_f32_16x16x32_bf16 v[32:35], a[48:51], a[32:35], v[32:35]
  buffer_load_dwordx4 v142, s[36:39], s61 offen offset:1024 sc1 lds
  s_add_u32 m0, s64, 63488
  v_mfma_f32_16x16x32_bf16 v[116:119], a[48:51], a[36:39], v[116:119]
  ds_read_b64_tr_b16 a[68:69], v136 offset:21504
  v_mfma_f32_16x16x32_bf16 v[48:51], a[52:55], a[32:35], v[48:51]
  v_exp_f32 v207, v207
  v_mfma_f32_16x16x32_bf16 v[44:47], a[52:55], a[28:31], v[44:47]
  ds_read_b64_tr_b16 a[70:71], v136 offset:27648
  v_add_f32 v200, 1.0, v200
  v_mfma_f32_16x16x32_bf16 v[40:43], a[52:55], a[24:27], v[40:43]
  buffer_load_dword v143, s[36:39], s61 offen sc1 lds
  s_mov_b32 s68, 21
  v_mfma_f32_16x16x32_bf16 v[36:39], a[52:55], a[20:23], v[36:39]
  s_waitcnt lgkmcnt(4)
  s_mul_i32 s60, s68, 196608
  s_add_u32 m0, s62, 64512
  v_mfma_f32_16x16x32_bf16 v[52:55], a[20:23], a[56:59], v[52:55]
  ds_read_b64_tr_b16 a[40:41], v135 offset:44032
  v_add_f32 v201, 1.0, v201
  v_mfma_f32_16x16x32_bf16 v[56:59], a[24:27], a[56:59], v[56:59]
  ds_read_b128 a[0:3], v145 offset:55296
  v_add_f32 v202, 1.0, v202
  v_mfma_f32_16x16x32_bf16 v[60:63], a[28:31], a[56:59], v[60:63]
  buffer_load_dwordx4 v139, s[8:11], s60 offen offset:0 lds
  v_add_f32 v203, 1.0, v203
  v_mfma_f32_16x16x32_bf16 v[64:67], a[32:35], a[56:59], v[64:67]
  ds_read_b64_tr_b16 a[42:43], v135 offset:50176
  v_add_f32 v204, 1.0, v204
  v_mfma_f32_16x16x32_bf16 v[120:123], a[36:39], a[56:59], v[120:123]
  ds_read_b128 a[4:7], v145 offset:56320
  v_add_f32 v205, 1.0, v205
  v_mfma_f32_16x16x32_bf16 v[80:83], a[32:35], a[60:63], v[80:83]
  ds_read_b64_tr_b16 a[44:45], v136 offset:44032
  v_add_f32 v206, 1.0, v206
  v_mfma_f32_16x16x32_bf16 v[76:79], a[28:31], a[60:63], v[76:79]
  buffer_load_dwordx4 v140, s[8:11], s60 offen offset:1024 lds
  v_add_f32 v207, 1.0, v207
  v_mfma_f32_16x16x32_bf16 v[72:75], a[24:27], a[60:63], v[72:75]
  ds_read_b128 a[8:11], v145 offset:57344
  v_mfma_f32_16x16x32_bf16 v[68:71], a[20:23], a[60:63], v[68:71]
  s_waitcnt lgkmcnt(6)
  ds_read_b64_tr_b16 a[46:47], v136 offset:50176
  v_mfma_f32_16x16x32_bf16 v[84:87], a[64:67], a[20:23], v[84:87]
  ds_read_b128 a[12:15], v145 offset:58368
  v_mfma_f32_16x16x32_bf16 v[88:91], a[64:67], a[24:27], v[88:91]
  buffer_load_dwordx4 v141, s[8:11], s60 offen offset:2048 lds
  s_lshl_b32 s61, s68, 11
  v_mfma_f32_16x16x32_bf16 v[92:95], a[64:67], a[28:31], v[92:95]
  s_add_u32 m0, s63, 76800
  ds_read_b128 a[16:19], v148 offset:63488
  v_mfma_f32_16x16x32_bf16 v[96:99], a[64:67], a[32:35], v[96:99]
  ds_read_b64_tr_b16 a[48:49], v135 offset:45056
  v_mfma_f32_16x16x32_bf16 v[112:115], a[68:71], a[32:35], v[112:115]
  ds_read_b64_tr_b16 a[50:51], v135 offset:51200
  v_mfma_f32_16x16x32_bf16 v[108:111], a[68:71], a[28:31], v[108:111]
  buffer_load_dwordx4 v142, s[36:39], s61 offen offset:0 sc1 lds
  v_mfma_f32_16x16x32_bf16 v[104:107], a[68:71], a[24:27], v[104:107]
  ds_read_b64_tr_b16 a[52:53], v136 offset:45056
  v_mfma_f32_16x16x32_bf16 v[100:103], a[68:71], a[20:23], v[100:103]
  s_waitcnt vmcnt(22) lgkmcnt(3)
  s_barrier
  ds_read_b64_tr_b16 a[54:55], v136 offset:51200
  v_mfma_f32_16x16x32_bf16 v[20:23], a[40:43], a[0:3], v[20:23]
  ds_read_b64_tr_b16 a[56:57], v135 offset:43008
  v_mfma_f32_16x16x32_bf16 v[24:27], a[40:43], a[4:7], v[24:27]
  buffer_load_dwordx4 v142, s[36:39], s61 offen offset:1024 sc1 lds
  s_add_u32 m0, s64, 84992
  v_mfma_f32_16x16x32_bf16 v[28:31], a[40:43], a[8:11], v[28:31]
  ds_read_b64_tr_b16 a[58:59], v135 offset:49152
  v_mfma_f32_16x16x32_bf16 v[32:35], a[40:43], a[12:15], v[32:35]
  v_rcp_f32 v200, v200
  v_mfma_f32_16x16x32_bf16 v[116:119], a[40:43], a[16:19], v[116:119]
  ds_read_b64_tr_b16 a[60:61], v136 offset:43008
  v_mfma_f32_16x16x32_bf16 v[48:51], a[44:47], a[12:15], v[48:51]
  buffer_load_dword v143, s[36:39], s61 offen sc1 lds
  s_mov_b32 s69, 22
  v_mfma_f32_16x16x32_bf16 v[44:47], a[44:47], a[8:11], v[44:47]
  s_mul_i32 s60, s69, 196608
  s_add_u32 m0, s62, 86016
  ds_read_b64_tr_b16 a[62:63], v136 offset:49152
  v_mfma_f32_16x16x32_bf16 v[40:43], a[44:47], a[4:7], v[40:43]
  v_rcp_f32 v201, v201
  v_mfma_f32_16x16x32_bf16 v[36:39], a[44:47], a[0:3], v[36:39]
  s_waitcnt lgkmcnt(4)
  ds_read_b64_tr_b16 a[64:65], v137 offset:1024
  v_mfma_f32_16x16x32_bf16 v[52:55], a[0:3], a[48:51], v[52:55]
  buffer_load_dwordx4 v139, s[8:11], s60 offen offset:0 lds
  v_mfma_f32_16x16x32_bf16 v[56:59], a[4:7], a[48:51], v[56:59]
  ds_read_b128 a[20:23], v146 offset:12288
  v_mfma_f32_16x16x32_bf16 v[60:63], a[8:11], a[48:51], v[60:63]
  ds_read_b64_tr_b16 a[66:67], v137 offset:7168
  v_mfma_f32_16x16x32_bf16 v[64:67], a[12:15], a[48:51], v[64:67]
  ds_read_b128 a[24:27], v146 offset:13312
  v_mfma_f32_16x16x32_bf16 v[120:123], a[16:19], a[48:51], v[120:123]
  buffer_load_dwordx4 v140, s[8:11], s60 offen offset:1024 lds
  v_mfma_f32_16x16x32_bf16 v[80:83], a[12:15], a[52:55], v[80:83]
  ds_read_b64_tr_b16 a[68:69], v138 offset:1024
  v_mfma_f32_16x16x32_bf16 v[76:79], a[8:11], a[52:55], v[76:79]
  ds_read_b128 a[28:31], v146 offset:14336
  v_mfma_f32_16x16x32_bf16 v[72:75], a[4:7], a[52:55], v[72:75]
  ds_read_b64_tr_b16 a[70:71], v138 offset:7168
  v_mfma_f32_16x16x32_bf16 v[68:71], a[0:3], a[52:55], v[68:71]
  s_waitcnt lgkmcnt(7)
  buffer_load_dwordx4 v141, s[8:11], s60 offen offset:2048 lds
  s_lshl_b32 s61, s69, 11
  v_mfma_f32_16x16x32_bf16 v[84:87], a[56:59], a[0:3], v[84:87]
  s_add_u32 m0, s63, 98304
  ds_read_b128 a[32:35], v146 offset:15360
  v_mfma_f32_16x16x32_bf16 v[88:91], a[56:59], a[4:7], v[88:91]
  ds_read_b128 a[36:39], v149 offset:20480
  v_mfma_f32_16x16x32_bf16 v[92:95], a[56:59], a[8:11], v[92:95]
  ds_read_b64_tr_b16 a[40:41], v137 offset:2048
  v_mfma_f32_16x16x32_bf16 v[96:99], a[56:59], a[12:15], v[96:99]
  buffer_load_dwordx4 v142, s[36:39], s61 offen offset:0 sc1 lds
  v_mfma_f32_16x16x32_bf16 v[112:115], a[60:63], a[12:15], v[112:115]
  ds_read_b64_tr_b16 a[42:43], v137 offset:8192
  v_mfma_f32_16x16x32_bf16 v[108:111], a[60:63], a[8:11], v[108:111]
  ds_read_b64_tr_b16 a[44:45], v138 offset:2048
  v_mfma_f32_16x16x32_bf16 v[104:107], a[60:63], a[4:7], v[104:107]
  ds_read_b64_tr_b16 a[46:47], v138 offset:8192
  v_mfma_f32_16x16x32_bf16 v[100:103], a[60:63], a[0:3], v[100:103]
  s_waitcnt vmcnt(22) lgkmcnt(4)
  s_barrier
  buffer_load_dwordx4 v142, s[36:39], s61 offen offset:1024 sc1 lds
  v_mfma_f32_16x16x32_bf16 v[20:23], a[64:67], a[20:23], v[20:23]
  s_add_u32 m0, s64, 106496
  ds_read_b64_tr_b16 a[48:49], v137 offset:0
  v_mfma_f32_16x16x32_bf16 v[24:27], a[64:67], a[24:27], v[24:27]
  v_rcp_f32 v202, v202
  v_mfma_f32_16x16x32_bf16 v[28:31], a[64:67], a[28:31], v[28:31]
  ds_read_b64_tr_b16 a[50:51], v137 offset:6144
  v_mfma_f32_16x16x32_bf16 v[32:35], a[64:67], a[32:35], v[32:35]
  buffer_load_dword v143, s[36:39], s61 offen sc1 lds
  s_mov_b32 s70, 23
  v_mfma_f32_16x16x32_bf16 v[116:119], a[64:67], a[36:39], v[116:119]
  s_mul_i32 s60, s70, 196608
  s_add_u32 m0, s62, 107520
  ds_read_b64_tr_b16 a[52:53], v138 offset:0
  v_mfma_f32_16x16x32_bf16 v[48:51], a[68:71], a[32:35], v[48:51]
  v_rcp_f32 v203, v203
  v_mfma_f32_16x16x32_bf16 v[44:47], a[68:71], a[28:31], v[44:47]
  ds_read_b64_tr_b16 a[54:55], v138 offset:6144
  v_mfma_f32_16x16x32_bf16 v[40:43], a[68:71], a[24:27], v[40:43]
  buffer_load_dwordx4 v139, s[8:11], s60 offen offset:0 lds
  v_mfma_f32_16x16x32_bf16 v[36:39], a[68:71], a[20:23], v[36:39]
  s_waitcnt lgkmcnt(4)
  ds_read_b64_tr_b16 a[56:57], v133 offset:1024
  v_mfma_f32_16x16x32_bf16 v[52:55], a[20:23], a[40:43], v[52:55]
  ds_read_b128 a[0:3], v144 offset:12288
  v_mfma_f32_16x16x32_bf16 v[56:59], a[24:27], a[40:43], v[56:59]
  ds_read_b64_tr_b16 a[58:59], v133 offset:7168
  v_mfma_f32_16x16x32_bf16 v[60:63], a[28:31], a[40:43], v[60:63]
  buffer_load_dwordx4 v140, s[8:11], s60 offen offset:1024 lds
  v_mfma_f32_16x16x32_bf16 v[64:67], a[32:35], a[40:43], v[64:67]
  ds_read_b128 a[4:7], v144 offset:13312
  v_mfma_f32_16x16x32_bf16 v[120:123], a[36:39], a[40:43], v[120:123]
  ds_read_b64_tr_b16 a[60:61], v134 offset:1024
  v_mfma_f32_16x16x32_bf16 v[80:83], a[32:35], a[44:47], v[80:83]
  ds_read_b128 a[8:11], v144 offset:14336
  v_mfma_f32_16x16x32_bf16 v[76:79], a[28:31], a[44:47], v[76:79]
  buffer_load_dwordx4 v141, s[8:11], s60 offen offset:2048 lds
  s_lshl_b32 s61, s70, 11
  v_mfma_f32_16x16x32_bf16 v[72:75], a[24:27], a[44:47], v[72:75]
  s_add_u32 m0, s63, 119808
  ds_read_b64_tr_b16 a[62:63], v134 offset:7168
  v_mfma_f32_16x16x32_bf16 v[68:71], a[20:23], a[44:47], v[68:71]
  s_waitcnt lgkmcnt(7)
  ds_read_b128 a[12:15], v144 offset:15360
  v_mfma_f32_16x16x32_bf16 v[84:87], a[48:51], a[20:23], v[84:87]
  ds_read_b128 a[16:19], v147 offset:20480
  v_mfma_f32_16x16x32_bf16 v[88:91], a[48:51], a[24:27], v[88:91]
  buffer_load_dwordx4 v142, s[36:39], s61 offen offset:0 sc1 lds
  v_mfma_f32_16x16x32_bf16 v[92:95], a[48:51], a[28:31], v[92:95]
  ds_read_b64_tr_b16 a[64:65], v133 offset:2048
  v_mfma_f32_16x16x32_bf16 v[96:99], a[48:51], a[32:35], v[96:99]
  ds_read_b64_tr_b16 a[66:67], v133 offset:8192
  v_mfma_f32_16x16x32_bf16 v[112:115], a[52:55], a[32:35], v[112:115]
  ds_read_b64_tr_b16 a[68:69], v134 offset:2048
  v_mfma_f32_16x16x32_bf16 v[108:111], a[52:55], a[28:31], v[108:111]
  buffer_load_dwordx4 v142, s[36:39], s61 offen offset:1024 sc1 lds
  s_add_u32 m0, s64, 128000
  v_mfma_f32_16x16x32_bf16 v[104:107], a[52:55], a[24:27], v[104:107]
  ds_read_b64_tr_b16 a[70:71], v134 offset:8192
  v_mfma_f32_16x16x32_bf16 v[100:103], a[52:55], a[20:23], v[100:103]
  s_waitcnt vmcnt(23) lgkmcnt(4)
  s_barrier
  v_mfma_f32_16x16x32_bf16 v[20:23], a[56:59], a[0:3], v[20:23]
  ds_read_b64_tr_b16 a[40:41], v133 offset:0
  v_mfma_f32_16x16x32_bf16 v[24:27], a[56:59], a[4:7], v[24:27]
  buffer_load_dword v143, s[36:39], s61 offen sc1 lds
  s_mov_b32 s65, 24
  v_mfma_f32_16x16x32_bf16 v[28:31], a[56:59], a[8:11], v[28:31]
  s_mul_i32 s60, s65, 196608
  s_add_u32 m0, s62, 129024
  ds_read_b64_tr_b16 a[42:43], v133 offset:6144
  v_mfma_f32_16x16x32_bf16 v[32:35], a[56:59], a[12:15], v[32:35]
  v_rcp_f32 v204, v204
  v_mfma_f32_16x16x32_bf16 v[116:119], a[56:59], a[16:19], v[116:119]
  ds_read_b64_tr_b16 a[44:45], v134 offset:0
  v_mfma_f32_16x16x32_bf16 v[48:51], a[60:63], a[12:15], v[48:51]
  buffer_load_dwordx4 v139, s[8:11], s60 offen offset:0 lds
  v_mfma_f32_16x16x32_bf16 v[44:47], a[60:63], a[8:11], v[44:47]
  ds_read_b64_tr_b16 a[46:47], v134 offset:6144
  v_mfma_f32_16x16x32_bf16 v[40:43], a[60:63], a[4:7], v[40:43]
  v_rcp_f32 v205, v205
  v_mfma_f32_16x16x32_bf16 v[36:39], a[60:63], a[0:3], v[36:39]
  s_waitcnt lgkmcnt(4)
  ds_read_b64_tr_b16 a[48:49], v133 offset:22528
  v_mfma_f32_16x16x32_bf16 v[52:55], a[0:3], a[64:67], v[52:55]
  buffer_load_dwordx4 v140, s[8:11], s60 offen offset:1024 lds
  v_mfma_f32_16x16x32_bf16 v[56:59], a[4:7], a[64:67], v[56:59]
  ds_read_b128 a[20:23], v144 offset:33792
  v_mfma_f32_16x16x32_bf16 v[60:63], a[8:11], a[64:67], v[60:63]
  ds_read_b64_tr_b16 a[50:51], v133 offset:28672
  v_mfma_f32_16x16x32_bf16 v[64:67], a[12:15], a[64:67], v[64:67]
  ds_read_b128 a[24:27], v144 offset:34816
  v_mfma_f32_16x16x32_bf16 v[120:123], a[16:19], a[64:67], v[120:123]
  buffer_load_dwordx4 v141, s[8:11], s60 offen offset:2048 lds
  s_lshl_b32 s61, s65, 11
  v_mfma_f32_16x16x32_bf16 v[80:83], a[12:15], a[68:71], v[80:83]
  s_add_u32 m0, s63, 141312
  ds_read_b64_tr_b16 a[52:53], v134 offset:22528
  v_mfma_f32_16x16x32_bf16 v[76:79], a[8:11], a[68:71], v[76:79]
  ds_read_b128 a[28:31], v144 offset:35840
  v_mfma_f32_16x16x32_bf16 v[72:75], a[4:7], a[68:71], v[72:75]
  ds_read_b64_tr_b16 a[54:55], v134 offset:28672
  v_mfma_f32_16x16x32_bf16 v[68:71], a[0:3], a[68:71], v[68:71]
  s_waitcnt lgkmcnt(7)
  buffer_load_dwordx4 v142, s[36:39], s61 offen offset:0 sc1 lds
  v_mfma_f32_16x16x32_bf16 v[84:87], a[40:43], a[0:3], v[84:87]
  ds_read_b128 a[32:35], v144 offset:36864
  v_mfma_f32_16x16x32_bf16 v[88:91], a[40:43], a[4:7], v[88:91]
  ds_read_b128 a[36:39], v147 offset:41984
  v_mfma_f32_16x16x32_bf16 v[92:95], a[40:43], a[8:11], v[92:95]
  ds_read_b64_tr_b16 a[56:57], v133 offset:23552
  v_mfma_f32_16x16x32_bf16 v[96:99], a[40:43], a[12:15], v[96:99]
  buffer_load_dwordx4 v142, s[36:39], s61 offen offset:1024 sc1 lds
  s_add_u32 m0, s64, 149504
  v_mfma_f32_16x16x32_bf16 v[112:115], a[44:47], a[12:15], v[112:115]
  ds_read_b64_tr_b16 a[58:59], v133 offset:29696
  v_mfma_f32_16x16x32_bf16 v[108:111], a[44:47], a[8:11], v[108:111]
  ds_read_b64_tr_b16 a[60:61], v134 offset:23552
  v_mfma_f32_16x16x32_bf16 v[104:107], a[44:47], a[4:7], v[104:107]
  ds_read_b64_tr_b16 a[62:63], v134 offset:29696
  v_mfma_f32_16x16x32_bf16 v[100:103], a[44:47], a[0:3], v[100:103]
  s_waitcnt vmcnt(23) lgkmcnt(4)
  s_barrier
  buffer_load_dword v143, s[36:39], s61 offen sc1 lds
  v_mfma_f32_16x16x32_bf16 v[20:23], a[48:51], a[20:23], v[20:23]
  s_mov_b32 s66, 25
  s_mul_i32 s60, s66, 196608
  s_add_u32 m0, s62, 0
  v_mfma_f32_16x16x32_bf16 v[24:27], a[48:51], a[24:27], v[24:27]
  ds_read_b64_tr_b16 a[64:65], v133 offset:21504
  v_mfma_f32_16x16x32_bf16 v[28:31], a[48:51], a[28:31], v[28:31]
  ds_read_b64_tr_b16 a[66:67], v133 offset:27648
  v_mfma_f32_16x16x32_bf16 v[32:35], a[48:51], a[32:35], v[32:35]
  buffer_load_dwordx4 v139, s[8:11], s60 offen offset:0 lds
  v_mfma_f32_16x16x32_bf16 v[116:119], a[48:51], a[36:39], v[116:119]
  ds_read_b64_tr_b16 a[68:69], v134 offset:21504
  v_mfma_f32_16x16x32_bf16 v[48:51], a[52:55], a[32:35], v[48:51]
  v_rcp_f32 v206, v206
  v_mfma_f32_16x16x32_bf16 v[44:47], a[52:55], a[28:31], v[44:47]
  ds_read_b64_tr_b16 a[70:71], v134 offset:27648
  v_mfma_f32_16x16x32_bf16 v[40:43], a[52:55], a[24:27], v[40:43]
  buffer_load_dwordx4 v140, s[8:11], s60 offen offset:1024 lds
  v_mfma_f32_16x16x32_bf16 v[36:39], a[52:55], a[20:23], v[36:39]
  s_waitcnt lgkmcnt(4)
  ds_read_b64_tr_b16 a[40:41], v133 offset:44032
  v_mfma_f32_16x16x32_bf16 v[52:55], a[20:23], a[56:59], v[52:55]
  ds_read_b128 a[0:3], v144 offset:55296
  v_mfma_f32_16x16x32_bf16 v[56:59], a[24:27], a[56:59], v[56:59]
  ds_read_b64_tr_b16 a[42:43], v133 offset:50176
  v_mfma_f32_16x16x32_bf16 v[60:63], a[28:31], a[56:59], v[60:63]
  buffer_load_dwordx4 v141, s[8:11], s60 offen offset:2048 lds
  s_lshl_b32 s61, s66, 11
  v_mfma_f32_16x16x32_bf16 v[64:67], a[32:35], a[56:59], v[64:67]
  s_add_u32 m0, s63, 12288
  ds_read_b128 a[4:7], v144 offset:56320
  v_mfma_f32_16x16x32_bf16 v[120:123], a[36:39], a[56:59], v[120:123]
  ds_read_b64_tr_b16 a[44:45], v134 offset:44032
  v_mfma_f32_16x16x32_bf16 v[80:83], a[32:35], a[60:63], v[80:83]
  ds_read_b128 a[8:11], v144 offset:57344
  v_mfma_f32_16x16x32_bf16 v[76:79], a[28:31], a[60:63], v[76:79]
  buffer_load_dwordx4 v142, s[36:39], s61 offen offset:0 sc1 lds
  v_mfma_f32_16x16x32_bf16 v[72:75], a[24:27], a[60:63], v[72:75]
  ds_read_b64_tr_b16 a[46:47], v134 offset:50176
  v_mfma_f32_16x16x32_bf16 v[68:71], a[20:23], a[60:63], v[68:71]
  s_waitcnt lgkmcnt(7)
  ds_read_b128 a[12:15], v144 offset:58368
  v_mfma_f32_16x16x32_bf16 v[84:87], a[64:67], a[20:23], v[84:87]
Ha2:
  s_cbranch_execz Ha2_1
  ds_read_b128 a[16:19], v147 offset:63488
  v_mfma_f32_16x16x32_bf16 v[88:91], a[64:67], a[24:27], v[88:91]
  ds_read_b64_tr_b16 a[48:49], v133 offset:45056
  v_mfma_f32_16x16x32_bf16 v[92:95], a[64:67], a[28:31], v[92:95]
  buffer_load_dwordx4 v142, s[36:39], s61 offen offset:1024 sc1 lds
  s_add_u32 m0, s64, 20480
  v_mfma_f32_16x16x32_bf16 v[96:99], a[64:67], a[32:35], v[96:99]
  ds_read_b64_tr_b16 a[50:51], v133 offset:51200
  v_mfma_f32_16x16x32_bf16 v[112:115], a[68:71], a[32:35], v[112:115]
  ds_read_b64_tr_b16 a[52:53], v134 offset:45056
  v_mfma_f32_16x16x32_bf16 v[108:111], a[68:71], a[28:31], v[108:111]
  v_rcp_f32 v207, v207
  v_mfma_f32_16x16x32_bf16 v[104:107], a[68:71], a[24:27], v[104:107]
  buffer_load_dword v143, s[36:39], s61 offen sc1 lds
  s_mov_b32 s67, 26
  v_mfma_f32_16x16x32_bf16 v[100:103], a[68:71], a[20:23], v[100:103]
  s_waitcnt vmcnt(24) lgkmcnt(3)
  s_barrier
  s_mul_i32 s60, s67, 196608
  v_mfma_f32_16x16x32_bf16 v[20:23], a[40:43], a[0:3], v[20:23]
  s_add_u32 m0, s62, 21504
  ds_read_b64_tr_b16 a[54:55], v134 offset:51200
  v_mul_f32 v188, v188, v200
  v_mfma_f32_16x16x32_bf16 v[24:27], a[40:43], a[4:7], v[24:27]
  ds_read_b64_tr_b16 a[56:57], v133 offset:43008
  v_mul_f32 v189, v189, v201
  v_mfma_f32_16x16x32_bf16 v[28:31], a[40:43], a[8:11], v[28:31]
  buffer_load_dwordx4 v139, s[8:11], s60 offen offset:0 lds
  v_mul_f32 v190, v190, v202
  v_mfma_f32_16x16x32_bf16 v[32:35], a[40:43], a[12:15], v[32:35]
  ds_read_b64_tr_b16 a[58:59], v133 offset:49152
  v_mul_f32 v191, v191, v203
  v_mfma_f32_16x16x32_bf16 v[116:119], a[40:43], a[16:19], v[116:119]
  ds_read_b64_tr_b16 a[60:61], v134 offset:43008
  v_mul_f32 v192, v192, v204
  v_mfma_f32_16x16x32_bf16 v[48:51], a[44:47], a[12:15], v[48:51]
  v_mul_f32 v193, v193, v205
  v_mul_f32 v194, v194, v206
  v_mfma_f32_16x16x32_bf16 v[44:47], a[44:47], a[8:11], v[44:47]
  buffer_load_dwordx4 v140, s[8:11], s60 offen offset:1024 lds
  v_mul_f32 v195, v195, v207
  v_mfma_f32_16x16x32_bf16 v[40:43], a[44:47], a[4:7], v[40:43]
  ds_read_b64_tr_b16 a[62:63], v134 offset:49152
  v_cvt_pk_bf16_f32 v212, v188, v189
  v_mfma_f32_16x16x32_bf16 v[36:39], a[44:47], a[0:3], v[36:39]
  s_waitcnt lgkmcnt(4)
  ds_read_b64_tr_b16 a[64:65], v135 offset:1024
  v_lshlrev_b32 v188, 16, v212
  v_mfma_f32_16x16x32_bf16 v[52:55], a[0:3], a[48:51], v[52:55]
  ds_read_b128 a[20:23], v145 offset:12288
  v_and_b32 v189, 0xffff0000, v212
  v_mfma_f32_16x16x32_bf16 v[56:59], a[4:7], a[48:51], v[56:59]
  buffer_load_dwordx4 v141, s[8:11], s60 offen offset:2048 lds
  v_cvt_pk_bf16_f32 v212, v190, v191
  v_mfma_f32_16x16x32_bf16 v[60:63], a[8:11], a[48:51], v[60:63]
  s_lshl_b32 s61, s67, 11
  ds_read_b64_tr_b16 a[66:67], v135 offset:7168
  s_add_u32 m0, s63, 33792
  v_mfma_f32_16x16x32_bf16 v[64:67], a[12:15], a[48:51], v[64:67]
  ds_read_b128 a[24:27], v145 offset:13312
  v_lshlrev_b32 v190, 16, v212
  v_mfma_f32_16x16x32_bf16 v[120:123], a[16:19], a[48:51], v[120:123]
  ds_read_b64_tr_b16 a[68:69], v136 offset:1024
  v_and_b32 v191, 0xffff0000, v212
  v_mfma_f32_16x16x32_bf16 v[80:83], a[12:15], a[52:55], v[80:83]
  ds_read_b128 a[28:31], v145 offset:14336
  v_cvt_pk_bf16_f32 v212, v192, v193
  v_mfma_f32_16x16x32_bf16 v[76:79], a[8:11], a[52:55], v[76:79]
  buffer_load_dwordx4 v142, s[36:39], s61 offen offset:0 sc1 lds
  v_lshlrev_b32 v192, 16, v212
  v_mfma_f32_16x16x32_bf16 v[72:75], a[4:7], a[52:55], v[72:75]
  ds_read_b64_tr_b16 a[70:71], v136 offset:7168
  v_and_b32 v193, 0xffff0000, v212
  v_mfma_f32_16x16x32_bf16 v[68:71], a[0:3], a[52:55], v[68:71]
  s_waitcnt lgkmcnt(7)
  ds_read_b128 a[32:35], v145 offset:15360
  v_cvt_pk_bf16_f32 v212, v194, v195
  v_mfma_f32_16x16x32_bf16 v[84:87], a[56:59], a[0:3], v[84:87]
  ds_read_b128 a[36:39], v148 offset:20480
  v_lshlrev_b32 v194, 16, v212
  v_mfma_f32_16x16x32_bf16 v[88:91], a[56:59], a[4:7], v[88:91]
  ds_read_b64_tr_b16 a[40:41], v135 offset:2048
  v_and_b32 v195, 0xffff0000, v212
  v_mfma_f32_16x16x32_bf16 v[92:95], a[56:59], a[8:11], v[92:95]
  s_lshl_b32 s48, s58, 3
  buffer_load_dwordx4 v142, s[36:39], s61 offen offset:1024 sc1 lds
  s_add_u32 m0, s64, 41984
  v_mfma_f32_16x16x32_bf16 v[96:99], a[56:59], a[12:15], v[96:99]
  s_add_u32 s48, s48, 150528
  ds_read_b64_tr_b16 a[42:43], v135 offset:8192
  v_add_u32 v12, s48, v0
  v_mfma_f32_16x16x32_bf16 v[112:115], a[60:63], a[12:15], v[112:115]
  ds_read_b64_tr_b16 a[44:45], v136 offset:2048
  v_add_u32 v222, s63, v12
  v_mfma_f32_16x16x32_bf16 v[108:111], a[60:63], a[8:11], v[108:111]
  v_xor_b32 v223, 8, v222
  s_lshl_b32 s48, s59, 11
  v_mfma_f32_16x16x32_bf16 v[104:107], a[60:63], a[4:7], v[104:107]
  s_add_u32 s48, s48, 8192
  buffer_load_dword v143, s[36:39], s61 offen sc1 lds
  s_mov_b32 s68, 27
  v_mfma_f32_16x16x32_bf16 v[100:103], a[60:63], a[0:3], v[100:103]
  s_waitcnt vmcnt(24) lgkmcnt(3)
  s_barrier
  s_mul_i32 s60, s68, 196608
  v_mfma_f32_16x16x32_bf16 v[20:23], a[64:67], a[20:23], v[20:23]
  s_add_u32 m0, s62, 43008
  ds_read_b64_tr_b16 a[46:47], v136 offset:8192
  v_add_u32 v224, s48, v12
  v_mfma_f32_16x16x32_bf16 v[24:27], a[64:67], a[24:27], v[24:27]
  s_lshl_b32 s48, s58, 13
  ds_read_b64_tr_b16 a[48:49], v135 offset:0
  v_subrev_u32 v225, s48, v224
  v_mfma_f32_16x16x32_bf16 v[28:31], a[64:67], a[28:31], v[28:31]
  buffer_load_dwordx4 v139, s[8:11], s60 offen offset:0 lds
  v_xor_b32 v226, 8, v225
  v_mfma_f32_16x16x32_bf16 v[32:35], a[64:67], a[32:35], v[32:35]
  s_mov_b32 s80, 0xaaaaaaaa
  ds_read_b64_tr_b16 a[50:51], v135 offset:6144
  s_mov_b32 s81, 0xaaaaaaaa
  v_mfma_f32_16x16x32_bf16 v[116:119], a[64:67], a[36:39], v[116:119]
  s_mov_b32 s82, 0x000f0000
  ds_read_b64_tr_b16 a[52:53], v136 offset:0
  s_mov_b32 s83, 0x0fff00ff
  v_mfma_f32_16x16x32_bf16 v[48:51], a[68:71], a[32:35], v[48:51]
  s_mov_b32 s84, 0x003f0003
  s_mov_b32 s85, 0x3fff03ff
  v_mov_b32 v12, 0xffff
  v_mfma_f32_16x16x32_bf16 v[44:47], a[68:71], a[28:31], v[44:47]
  buffer_load_dwordx4 v140, s[8:11], s60 offen offset:1024 lds
  v_mov_b32 v13, 0xffff0000
  v_mfma_f32_16x16x32_bf16 v[40:43], a[68:71], a[24:27], v[40:43]
  ds_read_b64_tr_b16 a[54:55], v136 offset:6144
  v_cndmask_b32 v12, v12, v13, s[80:81]
  v_mfma_f32_16x16x32_bf16 v[36:39], a[68:71], a[20:23], v[36:39]
  s_waitcnt lgkmcnt(4)
  ds_read_b64_tr_b16 a[56:57], v135 offset:22528
  v_cndmask_b32 v227, 0, v12, s[82:83]
  v_mfma_f32_16x16x32_bf16 v[52:55], a[20:23], a[40:43], v[52:55]
  ds_read_b128 a[0:3], v145 offset:33792
  v_cndmask_b32 v228, 0, v12, s[84:85]
  v_mfma_f32_16x16x32_bf16 v[56:59], a[24:27], a[40:43], v[56:59]
  buffer_load_dwordx4 v141, s[8:11], s60 offen offset:2048 lds
  v_xor_b32 v229, v227, v12
  v_mfma_f32_16x16x32_bf16 v[60:63], a[28:31], a[40:43], v[60:63]
  s_lshl_b32 s61, s68, 11
  ds_read_b64_tr_b16 a[58:59], v135 offset:28672
  s_add_u32 m0, s63, 55296
  v_mfma_f32_16x16x32_bf16 v[64:67], a[32:35], a[40:43], v[64:67]
  ds_read_b128 a[4:7], v145 offset:34816
  v_xor_b32 v230, v228, v12
  v_mfma_f32_16x16x32_bf16 v[120:123], a[36:39], a[40:43], v[120:123]
  s_lshl1_add_u32 s48, s51, s58
  ds_read_b64_tr_b16 a[60:61], v136 offset:22528
  s_lshl_b32 s74, s48, 17
  v_mfma_f32_16x16x32_bf16 v[80:83], a[32:35], a[44:47], v[80:83]
  s_lshl1_add_u32 s48, s56, s59
  ds_read_b128 a[8:11], v145 offset:35840
  s_lshl_b32 s48, s48, 11
  v_mfma_f32_16x16x32_bf16 v[76:79], a[28:31], a[44:47], v[76:79]
  s_add_u32 s74, s74, s48
  buffer_load_dwordx4 v142, s[36:39], s61 offen offset:0 sc1 lds
  s_add_u32 s74, s74, 7340032
  v_mfma_f32_16x16x32_bf16 v[72:75], a[24:27], a[44:47], v[72:75]
  s_add_u32 s75, s74, 65536
  ds_read_b64_tr_b16 a[62:63], v136 offset:28672
  s_or_b32 s51, s51, s58
  v_mfma_f32_16x16x32_bf16 v[68:71], a[20:23], a[44:47], v[68:71]
  s_waitcnt lgkmcnt(7)
  ds_read_b128 a[12:15], v145 offset:36864
  s_lshl_b32 s45, s2, 7
  v_mfma_f32_16x16x32_bf16 v[84:87], a[48:51], a[20:23], v[84:87]
  s_add_u32 s45, s45, 5275648
  ds_read_b128 a[16:19], v148 offset:41984
  s_cmp_eq_u32 s44, 0
  v_mfma_f32_16x16x32_bf16 v[88:91], a[48:51], a[24:27], v[88:91]
  s_cselect_b32 s45, s45, 1073741824
  ds_read_b64_tr_b16 a[64:65], v135 offset:23552
  s_lshr_b32 s49, s2, 3
  v_mfma_f32_16x16x32_bf16 v[92:95], a[48:51], a[28:31], v[92:95]
  s_and_b32 s59, s49, 3
  buffer_load_dwordx4 v142, s[36:39], s61 offen offset:1024 sc1 lds
  s_add_u32 m0, s64, 63488
  v_mfma_f32_16x16x32_bf16 v[96:99], a[48:51], a[32:35], v[96:99]
  s_lshr_b32 s56, s49, 2
  ds_read_b64_tr_b16 a[66:67], v135 offset:29696
  s_lshl1_add_u32 s49, s59, s56
  v_mfma_f32_16x16x32_bf16 v[112:115], a[52:55], a[32:35], v[112:115]
  s_and_b32 s49, s49, 7
  ds_read_b64_tr_b16 a[68:69], v136 offset:23552
  s_and_b32 s48, s2, 7
  v_mfma_f32_16x16x32_bf16 v[108:111], a[52:55], a[28:31], v[108:111]
  s_lshl2_add_u32 s59, s48, s59
  s_mov_b32 s86, 0xc0653421
  s_mov_b32 s87, 0xfedba987
  v_mfma_f32_16x16x32_bf16 v[104:107], a[52:55], a[24:27], v[104:107]
  s_cmp_eq_u32 s49, 1
  buffer_load_dword v143, s[36:39], s61 offen sc1 lds
  s_mov_b32 s69, 28
  v_mfma_f32_16x16x32_bf16 v[100:103], a[52:55], a[20:23], v[100:103]
  s_waitcnt vmcnt(24) lgkmcnt(3)
  s_barrier
  s_mul_i32 s60, s69, 196608
  v_mfma_f32_16x16x32_bf16 v[20:23], a[56:59], a[0:3], v[20:23]
  s_cselect_b32 s86, 0xd1643520, s86
  ds_read_b64_tr_b16 a[70:71], v136 offset:29696
  s_cselect_b32 s87, 0xfecba897, s87
  v_mfma_f32_16x16x32_bf16 v[24:27], a[56:59], a[4:7], v[24:27]
  s_add_u32 m0, s62, 64512
  ds_read_b64_tr_b16 a[40:41], v135 offset:21504
  s_cmp_eq_u32 s49, 2
  v_mfma_f32_16x16x32_bf16 v[28:31], a[56:59], a[8:11], v[28:31]
  s_cselect_b32 s86, 0x72546310, s86
  buffer_load_dwordx4 v139, s[8:11], s60 offen offset:0 lds
  s_cselect_b32 s87, 0xfdcb98ae, s87
  v_mfma_f32_16x16x32_bf16 v[32:35], a[56:59], a[12:15], v[32:35]
  s_cmp_eq_u32 s49, 3
  ds_read_b64_tr_b16 a[42:43], v135 offset:27648
  s_cselect_b32 s86, 0x63547210, s86
  v_mfma_f32_16x16x32_bf16 v[116:119], a[56:59], a[16:19], v[116:119]
  s_cselect_b32 s87, 0xfedca9b8, s87
  ds_read_b64_tr_b16 a[44:45], v136 offset:21504
  s_cmp_eq_u32 s49, 4
  v_mfma_f32_16x16x32_bf16 v[48:51], a[60:63], a[12:15], v[48:51]
  s_cselect_b32 s86, 0x64583210, s86
  s_cselect_b32 s87, 0xfedba9c7, s87
  s_cmp_eq_u32 s49, 5
  v_mfma_f32_16x16x32_bf16 v[44:47], a[60:63], a[8:11], v[44:47]
  s_cselect_b32 s86, 0x65493210, s86
  buffer_load_dwordx4 v140, s[8:11], s60 offen offset:1024 lds
  s_cselect_b32 s87, 0xfecba8d7, s87
  v_mfma_f32_16x16x32_bf16 v[40:43], a[60:63], a[4:7], v[40:43]
  s_cmp_eq_u32 s49, 6
  ds_read_b64_tr_b16 a[46:47], v136 offset:27648
  s_cselect_b32 s86, 0x56a43210, s86
  v_mfma_f32_16x16x32_bf16 v[36:39], a[60:63], a[0:3], v[36:39]
  s_waitcnt lgkmcnt(4)
  ds_read_b64_tr_b16 a[48:49], v135 offset:44032
  s_cselect_b32 s87, 0xfdcb98e7, s87
  v_mfma_f32_16x16x32_bf16 v[52:55], a[0:3], a[64:67], v[52:55]
  s_cmp_eq_u32 s49, 7
  ds_read_b128 a[20:23], v145 offset:55296
  s_cselect_b32 s86, 0x57b43210, s86
  v_mfma_f32_16x16x32_bf16 v[56:59], a[4:7], a[64:67], v[56:59]
  s_cselect_b32 s87, 0xedca98f6, s87
  buffer_load_dwordx4 v141, s[8:11], s60 offen offset:2048 lds
  s_mul_i32 s88, s44, 7168
  v_mfma_f32_16x16x32_bf16 v[60:63], a[8:11], a[64:67], v[60:63]
  s_lshl_b32 s61, s69, 11
  ds_read_b64_tr_b16 a[50:51], v135 offset:50176
  s_add_u32 m0, s63, 76800
  v_mfma_f32_16x16x32_bf16 v[64:67], a[12:15], a[64:67], v[64:67]
  s_lshl2_add_u32 s89, s56, s44
  ds_read_b128 a[24:27], v145 offset:56320
  s_lshl_b32 s89, s89, 17
  v_mfma_f32_16x16x32_bf16 v[120:123], a[16:19], a[64:67], v[120:123]
  s_add_u32 s89, s89, 36700160
  ds_read_b64_tr_b16 a[52:53], v136 offset:44032
  s_cmp_ge_u32 s44, 2
  v_mfma_f32_16x16x32_bf16 v[80:83], a[12:15], a[68:71], v[80:83]
  s_cselect_b64 s[16:17], s[20:21], s[16:17]
  ds_read_b128 a[28:31], v145 offset:57344
  v_lshrrev_b32 v12, 2, v10
  v_mfma_f32_16x16x32_bf16 v[76:79], a[8:11], a[68:71], v[76:79]
  buffer_load_dwordx4 v142, s[36:39], s61 offen offset:0 sc1 lds
  v_mul_u32_u24 v12, 224, v12
  v_mfma_f32_16x16x32_bf16 v[72:75], a[4:7], a[68:71], v[72:75]
  ds_read_b64_tr_b16 a[54:55], v136 offset:50176
  v_and_b32 v13, 3, v10
  v_mfma_f32_16x16x32_bf16 v[68:71], a[0:3], a[68:71], v[68:71]
  s_waitcnt lgkmcnt(7)
  ds_read_b128 a[32:35], v145 offset:58368
  v_lshl_add_u32 v1, v13, 3, v12
  v_mfma_f32_16x16x32_bf16 v[84:87], a[40:43], a[0:3], v[84:87]
  ds_read_b128 a[36:39], v148 offset:63488
  v_add_u32 v2, 57344, v1
  v_mfma_f32_16x16x32_bf16 v[88:91], a[40:43], a[4:7], v[88:91]
  s_mul_i32 s48, s59, 224
  ds_read_b64_tr_b16 a[56:57], v135 offset:45056
  s_and_b32 s49, s44, 1
  v_mfma_f32_16x16x32_bf16 v[92:95], a[40:43], a[8:11], v[92:95]
  s_mul_i32 s49, s49, 229376
  buffer_load_dwordx4 v142, s[36:39], s61 offen offset:1024 sc1 lds
  s_add_u32 m0, s64, 84992
  v_mfma_f32_16x16x32_bf16 v[96:99], a[40:43], a[12:15], v[96:99]
  s_add_u32 s48, s48, s49
  ds_read_b64_tr_b16 a[58:59], v135 offset:51200
  s_and_b32 s49, s59, 1
  v_mfma_f32_16x16x32_bf16 v[112:115], a[44:47], a[12:15], v[112:115]
  s_lshl_b32 s49, s49, 1
  ds_read_b64_tr_b16 a[60:61], v136 offset:45056
  v_add_u32 v12, 0, v10
  v_mfma_f32_16x16x32_bf16 v[108:111], a[44:47], a[8:11], v[108:111]
  v_mul_u32_u24 v13, 4682, v12
  v_lshrrev_b32 v13, 16, v13
  v_mfma_f32_16x16x32_bf16 v[104:107], a[44:47], a[4:7], v[104:107]
  buffer_load_dword v143, s[36:39], s61 offen sc1 lds
  s_mov_b32 s70, 29
  v_mfma_f32_16x16x32_bf16 v[100:103], a[44:47], a[0:3], v[100:103]
  s_waitcnt vmcnt(24) lgkmcnt(3)
  s_barrier
  s_mul_i32 s60, s70, 196608
  v_mfma_f32_16x16x32_bf16 v[20:23], a[48:51], a[20:23], v[20:23]
  s_add_u32 m0, s62, 86016
  ds_read_b64_tr_b16 a[62:63], v136 offset:51200
  v_mul_i32_i24 v14, -14, v13
  v_mfma_f32_16x16x32_bf16 v[24:27], a[48:51], a[24:27], v[24:27]
  ds_read_b64_tr_b16 a[64:65], v135 offset:43008
  v_add3_u32 v12, v12, v14, s49
  v_mfma_f32_16x16x32_bf16 v[28:31], a[48:51], a[28:31], v[28:31]
  buffer_load_dwordx4 v139, s[8:11], s60 offen offset:0 lds
  v_add_u32 v14, -14, v12
  v_mfma_f32_16x16x32_bf16 v[32:35], a[48:51], a[32:35], v[32:35]
  ds_read_b64_tr_b16 a[66:67], v135 offset:49152
  v_min_u32 v12, v12, v14
  v_mfma_f32_16x16x32_bf16 v[116:119], a[48:51], a[36:39], v[116:119]
  ds_read_b64_tr_b16 a[68:69], v136 offset:43008
  v_mul_u32_u24 v13, 7168, v13
  v_mfma_f32_16x16x32_bf16 v[48:51], a[52:55], a[32:35], v[48:51]
  v_lshl_add_u32 v12, v12, 4, v13
  v_add_u32 v3, s48, v12
  v_mfma_f32_16x16x32_bf16 v[44:47], a[52:55], a[28:31], v[44:47]
  s_sub_u32 s48, s48, 1024
  buffer_load_dwordx4 v140, s[8:11], s60 offen offset:1024 lds
  v_add_u32 v12, 64, v10
  v_mfma_f32_16x16x32_bf16 v[40:43], a[52:55], a[24:27], v[40:43]
  ds_read_b64_tr_b16 a[70:71], v136 offset:49152
  v_mul_u32_u24 v13, 4682, v12
  v_mfma_f32_16x16x32_bf16 v[36:39], a[52:55], a[20:23], v[36:39]
  s_waitcnt lgkmcnt(4)
  ds_read_b64_tr_b16 a[40:41], v137 offset:1024
  v_lshrrev_b32 v13, 16, v13
  v_mfma_f32_16x16x32_bf16 v[52:55], a[20:23], a[56:59], v[52:55]
  ds_read_b128 a[0:3], v146 offset:12288
  v_mul_i32_i24 v14, -14, v13
  v_mfma_f32_16x16x32_bf16 v[56:59], a[24:27], a[56:59], v[56:59]
  buffer_load_dwordx4 v141, s[8:11], s60 offen offset:2048 lds
  v_add3_u32 v12, v12, v14, s49
  v_mfma_f32_16x16x32_bf16 v[60:63], a[28:31], a[56:59], v[60:63]
  s_lshl_b32 s61, s70, 11
  ds_read_b64_tr_b16 a[42:43], v137 offset:7168
  s_add_u32 m0, s63, 98304
  v_mfma_f32_16x16x32_bf16 v[64:67], a[32:35], a[56:59], v[64:67]
  ds_read_b128 a[4:7], v146 offset:13312
  v_add_u32 v14, -14, v12
  v_mfma_f32_16x16x32_bf16 v[120:123], a[36:39], a[56:59], v[120:123]
  ds_read_b64_tr_b16 a[44:45], v138 offset:1024
  v_min_u32 v12, v12, v14
  v_mfma_f32_16x16x32_bf16 v[80:83], a[32:35], a[60:63], v[80:83]
  ds_read_b128 a[8:11], v146 offset:14336
  v_mul_u32_u24 v13, 7168, v13
  v_mfma_f32_16x16x32_bf16 v[76:79], a[28:31], a[60:63], v[76:79]
  buffer_load_dwordx4 v142, s[36:39], s61 offen offset:0 sc1 lds
  v_lshl_add_u32 v12, v12, 4, v13
  v_mfma_f32_16x16x32_bf16 v[72:75], a[24:27], a[60:63], v[72:75]
  ds_read_b64_tr_b16 a[46:47], v138 offset:7168
  v_add_u32 v4, s48, v12
  v_mfma_f32_16x16x32_bf16 v[68:71], a[20:23], a[60:63], v[68:71]
  s_waitcnt lgkmcnt(7)
  ds_read_b128 a[12:15], v146 offset:15360
  s_sub_u32 s48, s48, 1024
  v_mfma_f32_16x16x32_bf16 v[84:87], a[64:67], a[20:23], v[84:87]
  ds_read_b128 a[16:19], v149 offset:20480
  v_add_u32 v12, 128, v10
  v_mfma_f32_16x16x32_bf16 v[88:91], a[64:67], a[24:27], v[88:91]
  ds_read_b64_tr_b16 a[48:49], v137 offset:2048
  v_mul_u32_u24 v13, 4682, v12
  v_mfma_f32_16x16x32_bf16 v[92:95], a[64:67], a[28:31], v[92:95]
  buffer_load_dwordx4 v142, s[36:39], s61 offen offset:1024 sc1 lds
  s_add_u32 m0, s64, 106496
  v_mfma_f32_16x16x32_bf16 v[96:99], a[64:67], a[32:35], v[96:99]
  ds_read_b64_tr_b16 a[50:51], v137 offset:8192
  v_lshrrev_b32 v13, 16, v13
  v_mfma_f32_16x16x32_bf16 v[112:115], a[68:71], a[32:35], v[112:115]
  ds_read_b64_tr_b16 a[52:53], v138 offset:2048
  v_mul_i32_i24 v14, -14, v13
  v_mfma_f32_16x16x32_bf16 v[108:111], a[68:71], a[28:31], v[108:111]
  v_add3_u32 v12, v12, v14, s49
  v_add_u32 v14, -14, v12
  v_mfma_f32_16x16x32_bf16 v[104:107], a[68:71], a[24:27], v[104:107]
  buffer_load_dword v143, s[36:39], s61 offen sc1 lds
  s_mov_b32 s65, 30
  v_mfma_f32_16x16x32_bf16 v[100:103], a[68:71], a[20:23], v[100:103]
  s_waitcnt vmcnt(24) lgkmcnt(3)
  s_barrier
  s_mul_i32 s60, s65, 196608
  v_mfma_f32_16x16x32_bf16 v[20:23], a[40:43], a[0:3], v[20:23]
  s_add_u32 m0, s62, 107520
  ds_read_b64_tr_b16 a[54:55], v138 offset:8192
  v_min_u32 v12, v12, v14
  v_mfma_f32_16x16x32_bf16 v[24:27], a[40:43], a[4:7], v[24:27]
  ds_read_b64_tr_b16 a[56:57], v137 offset:0
  v_mul_u32_u24 v13, 7168, v13
  v_mfma_f32_16x16x32_bf16 v[28:31], a[40:43], a[8:11], v[28:31]
  buffer_load_dwordx4 v139, s[8:11], s60 offen offset:0 lds
  v_lshl_add_u32 v12, v12, 4, v13
  v_mfma_f32_16x16x32_bf16 v[32:35], a[40:43], a[12:15], v[32:35]
  ds_read_b64_tr_b16 a[58:59], v137 offset:6144
  v_add_u32 v5, s48, v12
  v_mfma_f32_16x16x32_bf16 v[116:119], a[40:43], a[16:19], v[116:119]
  s_sub_u32 s48, s48, 1024
  ds_read_b64_tr_b16 a[60:61], v138 offset:0
  v_add_u32 v12, 192, v10
  v_mfma_f32_16x16x32_bf16 v[48:51], a[44:47], a[12:15], v[48:51]
  v_mul_u32_u24 v13, 4682, v12
  v_lshrrev_b32 v13, 16, v13
  v_mfma_f32_16x16x32_bf16 v[44:47], a[44:47], a[8:11], v[44:47]
  buffer_load_dwordx4 v140, s[8:11], s60 offen offset:1024 lds
  v_mul_i32_i24 v14, -14, v13
  v_mfma_f32_16x16x32_bf16 v[40:43], a[44:47], a[4:7], v[40:43]
  ds_read_b64_tr_b16 a[62:63], v138 offset:6144
  v_add3_u32 v12, v12, v14, s49
  v_mfma_f32_16x16x32_bf16 v[36:39], a[44:47], a[0:3], v[36:39]
  s_waitcnt lgkmcnt(4)
  ds_read_b64_tr_b16 a[64:65], v133 offset:1024
  v_add_u32 v14, -14, v12
  v_mfma_f32_16x16x32_bf16 v[52:55], a[0:3], a[48:51], v[52:55]
  ds_read_b128 a[20:23], v144 offset:12288
  v_min_u32 v12, v12, v14
  v_mfma_f32_16x16x32_bf16 v[56:59], a[4:7], a[48:51], v[56:59]
  buffer_load_dwordx4 v141, s[8:11], s60 offen offset:2048 lds
  v_mul_u32_u24 v13, 7168, v13
  v_mfma_f32_16x16x32_bf16 v[60:63], a[8:11], a[48:51], v[60:63]
  s_lshl_b32 s61, s65, 11
  ds_read_b64_tr_b16 a[66:67], v133 offset:7168
  s_add_u32 m0, s63, 119808
  v_mfma_f32_16x16x32_bf16 v[64:67], a[12:15], a[48:51], v[64:67]
  ds_read_b128 a[24:27], v144 offset:13312
  v_lshl_add_u32 v12, v12, 4, v13
  v_mfma_f32_16x16x32_bf16 v[120:123], a[16:19], a[48:51], v[120:123]
  ds_read_b64_tr_b16 a[68:69], v134 offset:1024
  v_add_u32 v6, s48, v12
  v_mfma_f32_16x16x32_bf16 v[80:83], a[12:15], a[52:55], v[80:83]
  s_sub_u32 s48, s48, -3072
  ds_read_b128 a[28:31], v144 offset:14336
  v_add_u32 v12, 256, v10
  v_mfma_f32_16x16x32_bf16 v[76:79], a[8:11], a[52:55], v[76:79]
  buffer_load_dwordx4 v142, s[36:39], s61 offen offset:0 sc1 lds
  v_mul_u32_u24 v13, 4682, v12
  v_mfma_f32_16x16x32_bf16 v[72:75], a[4:7], a[52:55], v[72:75]
  ds_read_b64_tr_b16 a[70:71], v134 offset:7168
  v_lshrrev_b32 v13, 16, v13
  v_mfma_f32_16x16x32_bf16 v[68:71], a[0:3], a[52:55], v[68:71]
  s_waitcnt lgkmcnt(7)
  ds_read_b128 a[32:35], v144 offset:15360
  v_mul_i32_i24 v14, -14, v13
  v_mfma_f32_16x16x32_bf16 v[84:87], a[56:59], a[0:3], v[84:87]
  ds_read_b128 a[36:39], v147 offset:20480
  v_add3_u32 v12, v12, v14, s49
  v_mfma_f32_16x16x32_bf16 v[88:91], a[56:59], a[4:7], v[88:91]
  ds_read_b64_tr_b16 a[40:41], v133 offset:2048
  v_add_u32 v14, -14, v12
  v_mfma_f32_16x16x32_bf16 v[92:95], a[56:59], a[8:11], v[92:95]
  buffer_load_dwordx4 v142, s[36:39], s61 offen offset:1024 sc1 lds
  s_add_u32 m0, s64, 128000
  v_mfma_f32_16x16x32_bf16 v[96:99], a[56:59], a[12:15], v[96:99]
  ds_read_b64_tr_b16 a[42:43], v133 offset:8192
  v_min_u32 v12, v12, v14
  v_mfma_f32_16x16x32_bf16 v[112:115], a[60:63], a[12:15], v[112:115]
  ds_read_b64_tr_b16 a[44:45], v134 offset:2048
  v_mul_u32_u24 v13, 7168, v13
  v_mfma_f32_16x16x32_bf16 v[108:111], a[60:63], a[8:11], v[108:111]
  v_lshl_add_u32 v12, v12, 4, v13
  v_add_u32 v7, s48, v12
  v_mfma_f32_16x16x32_bf16 v[104:107], a[60:63], a[4:7], v[104:107]
  s_sub_u32 s48, s48, 1024
  buffer_load_dword v143, s[36:39], s61 offen sc1 lds
  s_mov_b32 s66, 31
  v_mfma_f32_16x16x32_bf16 v[100:103], a[60:63], a[0:3], v[100:103]
  s_waitcnt vmcnt(24) lgkmcnt(3)
  s_barrier
  s_mul_i32 s60, s66, 196608
  v_mfma_f32_16x16x32_bf16 v[20:23], a[64:67], a[20:23], v[20:23]
  s_add_u32 m0, s62, 129024
  ds_read_b64_tr_b16 a[46:47], v134 offset:8192
  v_add_u32 v12, 320, v10
  v_mfma_f32_16x16x32_bf16 v[24:27], a[64:67], a[24:27], v[24:27]
  ds_read_b64_tr_b16 a[48:49], v133 offset:0
  v_mul_u32_u24 v13, 4682, v12
  v_mfma_f32_16x16x32_bf16 v[28:31], a[64:67], a[28:31], v[28:31]
  buffer_load_dwordx4 v139, s[8:11], s60 offen offset:0 lds
  v_lshrrev_b32 v13, 16, v13
  v_mfma_f32_16x16x32_bf16 v[32:35], a[64:67], a[32:35], v[32:35]
  ds_read_b64_tr_b16 a[50:51], v133 offset:6144
  v_mul_i32_i24 v14, -14, v13
  v_mfma_f32_16x16x32_bf16 v[116:119], a[64:67], a[36:39], v[116:119]
  ds_read_b64_tr_b16 a[52:53], v134 offset:0
  v_add3_u32 v12, v12, v14, s49
  v_mfma_f32_16x16x32_bf16 v[48:51], a[68:71], a[32:35], v[48:51]
  v_add_u32 v14, -14, v12
  v_min_u32 v12, v12, v14
  v_mfma_f32_16x16x32_bf16 v[44:47], a[68:71], a[28:31], v[44:47]
  buffer_load_dwordx4 v140, s[8:11], s60 offen offset:1024 lds
  v_mul_u32_u24 v13, 7168, v13
  v_mfma_f32_16x16x32_bf16 v[40:43], a[68:71], a[24:27], v[40:43]
  ds_read_b64_tr_b16 a[54:55], v134 offset:6144
  v_lshl_add_u32 v12, v12, 4, v13
  v_mfma_f32_16x16x32_bf16 v[36:39], a[68:71], a[20:23], v[36:39]
  s_waitcnt lgkmcnt(4)
  ds_read_b64_tr_b16 a[56:57], v133 offset:22528
  v_add_u32 v8, s48, v12
  v_mfma_f32_16x16x32_bf16 v[52:55], a[20:23], a[40:43], v[52:55]
  s_sub_u32 s48, s48, 1024
  ds_read_b128 a[0:3], v144 offset:33792
  v_add_u32 v12, 384, v10
  v_mfma_f32_16x16x32_bf16 v[56:59], a[24:27], a[40:43], v[56:59]
  buffer_load_dwordx4 v141, s[8:11], s60 offen offset:2048 lds
  v_mul_u32_u24 v13, 4682, v12
  v_mfma_f32_16x16x32_bf16 v[60:63], a[28:31], a[40:43], v[60:63]
  s_lshl_b32 s61, s66, 11
  ds_read_b64_tr_b16 a[58:59], v133 offset:28672
  s_add_u32 m0, s63, 141312
  v_mfma_f32_16x16x32_bf16 v[64:67], a[32:35], a[40:43], v[64:67]
  ds_read_b128 a[4:7], v144 offset:34816
  v_lshrrev_b32 v13, 16, v13
  v_mfma_f32_16x16x32_bf16 v[120:123], a[36:39], a[40:43], v[120:123]
  ds_read_b64_tr_b16 a[60:61], v134 offset:22528
  v_mul_i32_i24 v14, -14, v13
  v_mfma_f32_16x16x32_bf16 v[80:83], a[32:35], a[44:47], v[80:83]
  ds_read_b128 a[8:11], v144 offset:35840
  v_add3_u32 v12, v12, v14, s49
  v_mfma_f32_16x16x32_bf16 v[76:79], a[28:31], a[44:47], v[76:79]
  buffer_load_dwordx4 v142, s[36:39], s61 offen offset:0 sc1 lds
  v_add_u32 v14, -14, v12
  v_mfma_f32_16x16x32_bf16 v[72:75], a[24:27], a[44:47], v[72:75]
  ds_read_b64_tr_b16 a[62:63], v134 offset:28672
  v_min_u32 v12, v12, v14
  v_mfma_f32_16x16x32_bf16 v[68:71], a[20:23], a[44:47], v[68:71]
  s_waitcnt lgkmcnt(7)
  ds_read_b128 a[12:15], v144 offset:36864
  v_mul_u32_u24 v13, 7168, v13
  v_mfma_f32_16x16x32_bf16 v[84:87], a[48:51], a[20:23], v[84:87]
  ds_read_b128 a[16:19], v147 offset:41984
  v_lshl_add_u32 v12, v12, 4, v13
  v_mfma_f32_16x16x32_bf16 v[88:91], a[48:51], a[24:27], v[88:91]
  ds_read_b64_tr_b16 a[64:65], v133 offset:23552
  v_add_u32 v9, s48, v12
  v_mfma_f32_16x16x32_bf16 v[92:95], a[48:51], a[28:31], v[92:95]
  s_sub_u32 s48, s48, 1024
  buffer_load_dwordx4 v142, s[36:39], s61 offen offset:1024 sc1 lds
  s_add_u32 m0, s64, 149504
  v_mfma_f32_16x16x32_bf16 v[96:99], a[48:51], a[32:35], v[96:99]
  s_and_b32 s48, s56, 1
  ds_read_b64_tr_b16 a[66:67], v133 offset:29696
  s_lshl_b32 s48, s48, 7
  v_mfma_f32_16x16x32_bf16 v[112:115], a[52:55], a[32:35], v[112:115]
  s_and_b32 s49, s56, 6
  ds_read_b64_tr_b16 a[68:69], v134 offset:23552
  s_add_u32 s48, s48, s49
  v_mfma_f32_16x16x32_bf16 v[108:111], a[52:55], a[28:31], v[108:111]
  v_bfe_u32 v12, v10, 1, 4
  v_and_b32 v13, 1, v10
  v_mfma_f32_16x16x32_bf16 v[104:107], a[52:55], a[24:27], v[104:107]
  buffer_load_dword v143, s[36:39], s61 offen sc1 lds
  s_nop 0
  v_mfma_f32_16x16x32_bf16 v[100:103], a[52:55], a[20:23], v[100:103]
  s_waitcnt vmcnt(24) lgkmcnt(3)
  s_barrier
  s_add_u32 s50, s79, 0
  v_mfma_f32_16x16x32_bf16 v[20:23], a[56:59], a[0:3], v[20:23]
  s_and_b32 s50, s50, 7
  s_lshl_b32 s50, s50, 18
  s_add_u32 m0, s73, 0
  v_mfma_f32_16x16x32_bf16 v[24:27], a[56:59], a[4:7], v[24:27]
  ds_read_b64_tr_b16 a[70:71], v134 offset:29696
  v_lshl_add_u32 v12, v12, 3, v13
  v_mfma_f32_16x16x32_bf16 v[28:31], a[56:59], a[8:11], v[28:31]
  ds_read_b64_tr_b16 a[40:41], v133 offset:21504
  v_add_lshl_u32 v250, v12, s48, 7
  v_mfma_f32_16x16x32_bf16 v[32:35], a[56:59], a[12:15], v[32:35]
  buffer_load_dwordx4 v216, s[12:15], s50 offen offset:0 lds
  v_mfma_f32_16x16x32_bf16 v[116:119], a[56:59], a[16:19], v[116:119]
  ds_read_b64_tr_b16 a[42:43], v133 offset:27648
  v_mfma_f32_16x16x32_bf16 v[48:51], a[60:63], a[12:15], v[48:51]
  ds_read_b64_tr_b16 a[44:45], v134 offset:21504
  v_mfma_f32_16x16x32_bf16 v[44:47], a[60:63], a[8:11], v[44:47]
  ds_read_b64_tr_b16 a[46:47], v134 offset:27648
  v_mfma_f32_16x16x32_bf16 v[40:43], a[60:63], a[4:7], v[40:43]
  buffer_load_dwordx4 v217, s[12:15], s50 offen offset:1024 lds
  v_mfma_f32_16x16x32_bf16 v[36:39], a[60:63], a[0:3], v[36:39]
  s_waitcnt lgkmcnt(4)
  ds_read_b64_tr_b16 a[48:49], v133 offset:44032
  v_mfma_f32_16x16x32_bf16 v[52:55], a[0:3], a[64:67], v[52:55]
Ha0_1:
  s_cbranch_execz Ra
  ds_read_b128 a[20:23], v144 offset:55296
  v_mfma_f32_16x16x32_bf16 v[56:59], a[4:7], a[64:67], v[56:59]
  ds_read_b64_tr_b16 a[50:51], v133 offset:50176
  v_mfma_f32_16x16x32_bf16 v[60:63], a[8:11], a[64:67], v[60:63]
  buffer_load_dwordx4 v218, s[12:15], s50 offen offset:2048 lds
  v_mfma_f32_16x16x32_bf16 v[64:67], a[12:15], a[64:67], v[64:67]
  ds_read_b128 a[24:27], v144 offset:56320
  v_mfma_f32_16x16x32_bf16 v[120:123], a[16:19], a[64:67], v[120:123]
  ds_read_b64_tr_b16 a[52:53], v134 offset:44032
  v_mfma_f32_16x16x32_bf16 v[80:83], a[12:15], a[68:71], v[80:83]
  ds_read_b128 a[28:31], v144 offset:57344
  v_mfma_f32_16x16x32_bf16 v[76:79], a[8:11], a[68:71], v[76:79]
  buffer_load_dwordx4 v219, s[12:15], s50 offen offset:3072 lds
  v_mfma_f32_16x16x32_bf16 v[72:75], a[4:7], a[68:71], v[72:75]
  ds_read_b64_tr_b16 a[54:55], v134 offset:50176
  v_mfma_f32_16x16x32_bf16 v[68:71], a[0:3], a[68:71], v[68:71]
  s_waitcnt lgkmcnt(7)
  ds_read_b128 a[32:35], v144 offset:58368
  v_mfma_f32_16x16x32_bf16 v[84:87], a[40:43], a[0:3], v[84:87]
  ds_read_b128 a[36:39], v147 offset:63488
  v_mfma_f32_16x16x32_bf16 v[88:91], a[40:43], a[4:7], v[88:91]
  buffer_load_dwordx4 v[156:159], v196, s[28:31], s52 offen nt
  s_add_u32 s52, s52, 12288
  v_mfma_f32_16x16x32_bf16 v[92:95], a[40:43], a[8:11], v[92:95]
  ds_read_b64_tr_b16 a[56:57], v133 offset:45056
  v_mfma_f32_16x16x32_bf16 v[96:99], a[40:43], a[12:15], v[96:99]
  ds_read_b64_tr_b16 a[58:59], v133 offset:51200
  v_mfma_f32_16x16x32_bf16 v[112:115], a[44:47], a[12:15], v[112:115]
  ds_read_b64_tr_b16 a[60:61], v134 offset:45056
  v_mfma_f32_16x16x32_bf16 v[108:111], a[44:47], a[8:11], v[108:111]
  buffer_load_dwordx4 v[160:163], v196, s[28:31], s52 offen nt
  s_add_u32 s52, s52, 12288
  v_mfma_f32_16x16x32_bf16 v[104:107], a[44:47], a[4:7], v[104:107]
  ds_read_b64_tr_b16 a[62:63], v134 offset:51200
  v_mfma_f32_16x16x32_bf16 v[100:103], a[44:47], a[0:3], v[100:103]
  s_waitcnt vmcnt(24) lgkmcnt(4)
  s_barrier
  v_mfma_f32_16x16x32_bf16 v[20:23], a[48:51], a[20:23], v[20:23]
  ds_read_b64_tr_b16 a[64:65], v133 offset:43008
  v_mfma_f32_16x16x32_bf16 v[24:27], a[48:51], a[24:27], v[24:27]
  buffer_load_dwordx4 v[164:167], v196, s[28:31], s52 offen nt
  s_add_u32 s52, s52, 12288
  v_mfma_f32_16x16x32_bf16 v[28:31], a[48:51], a[28:31], v[28:31]
  ds_read_b64_tr_b16 a[66:67], v133 offset:49152
  v_mfma_f32_16x16x32_bf16 v[32:35], a[48:51], a[32:35], v[32:35]
  v_mfma_f32_16x16x32_bf16 v[116:119], a[48:51], a[36:39], v[116:119]
  ds_read_b64_tr_b16 a[68:69], v134 offset:43008
  v_mfma_f32_16x16x32_bf16 v[48:51], a[52:55], a[32:35], v[48:51]
  buffer_load_dwordx4 v[168:171], v196, s[28:31], s52 offen nt
  s_add_u32 s52, s52, 12288
  v_mfma_f32_16x16x32_bf16 v[44:47], a[52:55], a[28:31], v[44:47]
  ds_read_b64_tr_b16 a[70:71], v134 offset:49152
  v_mfma_f32_16x16x32_bf16 v[40:43], a[52:55], a[24:27], v[40:43]
  v_mfma_f32_16x16x32_bf16 v[36:39], a[52:55], a[20:23], v[36:39]
  s_waitcnt lgkmcnt(4)
  ds_read_b64_tr_b16 a[40:41], v135 offset:1024
  v_mfma_f32_16x16x32_bf16 v[52:55], a[20:23], a[56:59], v[52:55]
  buffer_load_dwordx4 v[172:175], v196, s[28:31], s52 offen nt
  s_add_u32 s52, s52, 12288
  v_mfma_f32_16x16x32_bf16 v[56:59], a[24:27], a[56:59], v[56:59]
  ds_read_b128 a[0:3], v145 offset:12288
  v_mfma_f32_16x16x32_bf16 v[60:63], a[28:31], a[56:59], v[60:63]
  ds_read_b64_tr_b16 a[42:43], v135 offset:7168
  v_mfma_f32_16x16x32_bf16 v[64:67], a[32:35], a[56:59], v[64:67]
  ds_read_b128 a[4:7], v145 offset:13312
  v_mfma_f32_16x16x32_bf16 v[120:123], a[36:39], a[56:59], v[120:123]
  buffer_load_dwordx4 v[176:179], v196, s[28:31], s52 offen nt
  s_add_u32 s52, s52, 12288
  v_mfma_f32_16x16x32_bf16 v[80:83], a[32:35], a[60:63], v[80:83]
  ds_read_b64_tr_b16 a[44:45], v136 offset:1024
  v_mfma_f32_16x16x32_bf16 v[76:79], a[28:31], a[60:63], v[76:79]
  ds_read_b128 a[8:11], v145 offset:14336
  v_mfma_f32_16x16x32_bf16 v[72:75], a[24:27], a[60:63], v[72:75]
  ds_read_b64_tr_b16 a[46:47], v136 offset:7168
  v_mfma_f32_16x16x32_bf16 v[68:71], a[20:23], a[60:63], v[68:71]
  s_waitcnt lgkmcnt(7)
  buffer_load_dwordx4 v[180:183], v196, s[28:31], s52 offen nt
  s_add_u32 s52, s52, 12288
  v_mfma_f32_16x16x32_bf16 v[84:87], a[64:67], a[20:23], v[84:87]
  ds_read_b128 a[12:15], v145 offset:15360
  v_mfma_f32_16x16x32_bf16 v[88:91], a[64:67], a[24:27], v[88:91]
  ds_read_b128 a[16:19], v148 offset:20480
  v_mfma_f32_16x16x32_bf16 v[92:95], a[64:67], a[28:31], v[92:95]
  ds_read_b64_tr_b16 a[48:49], v135 offset:2048
  v_mfma_f32_16x16x32_bf16 v[96:99], a[64:67], a[32:35], v[96:99]
  buffer_load_dwordx4 v[184:187], v196, s[28:31], s52 offen nt
  v_mfma_f32_16x16x32_bf16 v[112:115], a[68:71], a[32:35], v[112:115]
  ds_read_b64_tr_b16 a[50:51], v135 offset:8192
  v_mfma_f32_16x16x32_bf16 v[108:111], a[68:71], a[28:31], v[108:111]
  ds_read_b64_tr_b16 a[52:53], v136 offset:2048
  v_mfma_f32_16x16x32_bf16 v[104:107], a[68:71], a[24:27], v[104:107]
  ds_read_b64_tr_b16 a[54:55], v136 offset:8192
  v_mfma_f32_16x16x32_bf16 v[100:103], a[68:71], a[20:23], v[100:103]
  s_waitcnt vmcnt(24) lgkmcnt(4)
  s_barrier
  v_mfma_f32_16x16x32_bf16 v[20:23], a[40:43], a[0:3], v[20:23]
  ds_read_b64_tr_b16 a[56:57], v135 offset:0
  v_mfma_f32_16x16x32_bf16 v[24:27], a[40:43], a[4:7], v[24:27]
  v_mfma_f32_16x16x32_bf16 v[28:31], a[40:43], a[8:11], v[28:31]
  ds_read_b64_tr_b16 a[58:59], v135 offset:6144
  v_mfma_f32_16x16x32_bf16 v[32:35], a[40:43], a[12:15], v[32:35]
  v_mfma_f32_16x16x32_bf16 v[116:119], a[40:43], a[16:19], v[116:119]
  ds_read_b64_tr_b16 a[60:61], v136 offset:0
  v_mfma_f32_16x16x32_bf16 v[48:51], a[44:47], a[12:15], v[48:51]
  v_mfma_f32_16x16x32_bf16 v[44:47], a[44:47], a[8:11], v[44:47]
  ds_read_b64_tr_b16 a[62:63], v136 offset:6144
  v_mfma_f32_16x16x32_bf16 v[40:43], a[44:47], a[4:7], v[40:43]
  v_mfma_f32_16x16x32_bf16 v[36:39], a[44:47], a[0:3], v[36:39]
  s_waitcnt lgkmcnt(4)
  ds_read_b64_tr_b16 a[64:65], v135 offset:22528
  v_mfma_f32_16x16x32_bf16 v[52:55], a[0:3], a[48:51], v[52:55]
  ds_read_b128 a[20:23], v145 offset:33792
  v_mfma_f32_16x16x32_bf16 v[56:59], a[4:7], a[48:51], v[56:59]
  ds_read_b64_tr_b16 a[66:67], v135 offset:28672
  v_mfma_f32_16x16x32_bf16 v[60:63], a[8:11], a[48:51], v[60:63]
  ds_read_b128 a[24:27], v145 offset:34816
  v_mfma_f32_16x16x32_bf16 v[64:67], a[12:15], a[48:51], v[64:67]
  v_mfma_f32_16x16x32_bf16 v[120:123], a[16:19], a[48:51], v[120:123]
  ds_read_b64_tr_b16 a[68:69], v136 offset:22528
  v_mfma_f32_16x16x32_bf16 v[80:83], a[12:15], a[52:55], v[80:83]
  ds_read_b128 a[28:31], v145 offset:35840
  v_mfma_f32_16x16x32_bf16 v[76:79], a[8:11], a[52:55], v[76:79]
  ds_read_b64_tr_b16 a[70:71], v136 offset:28672
  v_mfma_f32_16x16x32_bf16 v[72:75], a[4:7], a[52:55], v[72:75]
  ds_read_b128 a[32:35], v145 offset:36864
  v_mfma_f32_16x16x32_bf16 v[68:71], a[0:3], a[52:55], v[68:71]
  s_waitcnt lgkmcnt(8)
  ds_read_b128 a[36:39], v148 offset:41984
  v_mfma_f32_16x16x32_bf16 v[84:87], a[56:59], a[0:3], v[84:87]
  ds_read_b64_tr_b16 a[40:41], v135 offset:23552
  v_mfma_f32_16x16x32_bf16 v[88:91], a[56:59], a[4:7], v[88:91]
  ds_read_b64_tr_b16 a[42:43], v135 offset:29696
  v_mfma_f32_16x16x32_bf16 v[92:95], a[56:59], a[8:11], v[92:95]
  v_mfma_f32_16x16x32_bf16 v[96:99], a[56:59], a[12:15], v[96:99]
  v_mfma_f32_16x16x32_bf16 v[112:115], a[60:63], a[12:15], v[112:115]
  ds_read_b64_tr_b16 a[44:45], v136 offset:23552
  v_mfma_f32_16x16x32_bf16 v[108:111], a[60:63], a[8:11], v[108:111]
  v_mfma_f32_16x16x32_bf16 v[104:107], a[60:63], a[4:7], v[104:107]
  ds_read_b64_tr_b16 a[46:47], v136 offset:29696
  v_mfma_f32_16x16x32_bf16 v[100:103], a[60:63], a[0:3], v[100:103]
  s_waitcnt vmcnt(18) lgkmcnt(4)
  s_barrier
  v_mfma_f32_16x16x32_bf16 v[20:23], a[64:67], a[20:23], v[20:23]
  ds_read_b64_tr_b16 a[48:49], v135 offset:21504
  v_mfma_f32_16x16x32_bf16 v[24:27], a[64:67], a[24:27], v[24:27]
  v_mfma_f32_16x16x32_bf16 v[28:31], a[64:67], a[28:31], v[28:31]
  ds_read_b64_tr_b16 a[50:51], v135 offset:27648
  v_mfma_f32_16x16x32_bf16 v[32:35], a[64:67], a[32:35], v[32:35]
  v_mfma_f32_16x16x32_bf16 v[116:119], a[64:67], a[36:39], v[116:119]
  ds_read_b64_tr_b16 a[52:53], v136 offset:21504
  v_mfma_f32_16x16x32_bf16 v[48:51], a[68:71], a[32:35], v[48:51]
  v_mfma_f32_16x16x32_bf16 v[44:47], a[68:71], a[28:31], v[44:47]
  ds_read_b64_tr_b16 a[54:55], v136 offset:27648
  v_mfma_f32_16x16x32_bf16 v[40:43], a[68:71], a[24:27], v[40:43]
  v_mfma_f32_16x16x32_bf16 v[36:39], a[68:71], a[20:23], v[36:39]
  s_waitcnt lgkmcnt(4)
  ds_read_b64_tr_b16 a[56:57], v135 offset:44032
  v_mfma_f32_16x16x32_bf16 v[52:55], a[20:23], a[40:43], v[52:55]
  ds_read_b128 a[0:3], v145 offset:55296
  v_mfma_f32_16x16x32_bf16 v[56:59], a[24:27], a[40:43], v[56:59]
  ds_read_b64_tr_b16 a[58:59], v135 offset:50176
  v_mfma_f32_16x16x32_bf16 v[60:63], a[28:31], a[40:43], v[60:63]
  ds_read_b128 a[4:7], v145 offset:56320
  v_mfma_f32_16x16x32_bf16 v[64:67], a[32:35], a[40:43], v[64:67]
  v_mfma_f32_16x16x32_bf16 v[120:123], a[36:39], a[40:43], v[120:123]
  ds_read_b64_tr_b16 a[60:61], v136 offset:44032
  v_mfma_f32_16x16x32_bf16 v[80:83], a[32:35], a[44:47], v[80:83]
  ds_read_b128 a[8:11], v145 offset:57344
  v_mfma_f32_16x16x32_bf16 v[76:79], a[28:31], a[44:47], v[76:79]
  ds_read_b64_tr_b16 a[62:63], v136 offset:50176
  v_mfma_f32_16x16x32_bf16 v[72:75], a[24:27], a[44:47], v[72:75]
  ds_read_b128 a[12:15], v145 offset:58368
  v_mfma_f32_16x16x32_bf16 v[68:71], a[20:23], a[44:47], v[68:71]
  s_waitcnt lgkmcnt(8)
  ds_read_b128 a[16:19], v148 offset:63488
  v_mfma_f32_16x16x32_bf16 v[84:87], a[48:51], a[20:23], v[84:87]
  ds_read_b64_tr_b16 a[64:65], v135 offset:45056
  v_mfma_f32_16x16x32_bf16 v[88:91], a[48:51], a[24:27], v[88:91]
  ds_read_b64_tr_b16 a[66:67], v135 offset:51200
  v_mfma_f32_16x16x32_bf16 v[92:95], a[48:51], a[28:31], v[92:95]
  v_mfma_f32_16x16x32_bf16 v[96:99], a[48:51], a[32:35], v[96:99]
  v_mfma_f32_16x16x32_bf16 v[112:115], a[52:55], a[32:35], v[112:115]
  ds_read_b64_tr_b16 a[68:69], v136 offset:45056
  v_mfma_f32_16x16x32_bf16 v[108:111], a[52:55], a[28:31], v[108:111]
  v_mfma_f32_16x16x32_bf16 v[104:107], a[52:55], a[24:27], v[104:107]
  ds_read_b64_tr_b16 a[70:71], v136 offset:51200
  v_mfma_f32_16x16x32_bf16 v[100:103], a[52:55], a[20:23], v[100:103]
  s_waitcnt vmcnt(12) lgkmcnt(4)
  s_barrier
  v_mfma_f32_16x16x32_bf16 v[20:23], a[56:59], a[0:3], v[20:23]
  ds_read_b64_tr_b16 a[40:41], v135 offset:43008
  v_mfma_f32_16x16x32_bf16 v[24:27], a[56:59], a[4:7], v[24:27]
  s_add_u32 s50, s79, 1
  s_and_b32 s50, s50, 7
  s_lshl_b32 s50, s50, 18
  v_mfma_f32_16x16x32_bf16 v[28:31], a[56:59], a[8:11], v[28:31]
  s_add_u32 m0, s73, 16384
  ds_read_b64_tr_b16 a[42:43], v135 offset:49152
  v_mfma_f32_16x16x32_bf16 v[32:35], a[56:59], a[12:15], v[32:35]
  v_mfma_f32_16x16x32_bf16 v[116:119], a[56:59], a[16:19], v[116:119]
  ds_read_b64_tr_b16 a[44:45], v136 offset:43008
  v_mfma_f32_16x16x32_bf16 v[48:51], a[60:63], a[12:15], v[48:51]
  buffer_load_dwordx4 v216, s[12:15], s50 offen offset:0 lds
  v_mfma_f32_16x16x32_bf16 v[44:47], a[60:63], a[8:11], v[44:47]
  ds_read_b64_tr_b16 a[46:47], v136 offset:49152
  v_mfma_f32_16x16x32_bf16 v[40:43], a[60:63], a[4:7], v[40:43]
  v_mfma_f32_16x16x32_bf16 v[36:39], a[60:63], a[0:3], v[36:39]
  s_waitcnt lgkmcnt(4)
  ds_read_b64_tr_b16 a[48:49], v137 offset:1024
  v_mfma_f32_16x16x32_bf16 v[52:55], a[0:3], a[64:67], v[52:55]
  buffer_load_dwordx4 v217, s[12:15], s50 offen offset:1024 lds
  v_mfma_f32_16x16x32_bf16 v[56:59], a[4:7], a[64:67], v[56:59]
  ds_read_b128 a[20:23], v146 offset:12288
  v_mfma_f32_16x16x32_bf16 v[60:63], a[8:11], a[64:67], v[60:63]
  ds_read_b64_tr_b16 a[50:51], v137 offset:7168
  v_mfma_f32_16x16x32_bf16 v[64:67], a[12:15], a[64:67], v[64:67]
  ds_read_b128 a[24:27], v146 offset:13312
  v_mfma_f32_16x16x32_bf16 v[120:123], a[16:19], a[64:67], v[120:123]
  buffer_load_dwordx4 v218, s[12:15], s50 offen offset:2048 lds
  v_mfma_f32_16x16x32_bf16 v[80:83], a[12:15], a[68:71], v[80:83]
  ds_read_b64_tr_b16 a[52:53], v138 offset:1024
  v_mfma_f32_16x16x32_bf16 v[76:79], a[8:11], a[68:71], v[76:79]
  ds_read_b128 a[28:31], v146 offset:14336
  v_mfma_f32_16x16x32_bf16 v[72:75], a[4:7], a[68:71], v[72:75]
  ds_read_b64_tr_b16 a[54:55], v138 offset:7168
  v_mfma_f32_16x16x32_bf16 v[68:71], a[0:3], a[68:71], v[68:71]
  s_waitcnt lgkmcnt(7)
  ds_read_b128 a[32:35], v146 offset:15360
  v_mfma_f32_16x16x32_bf16 v[84:87], a[40:43], a[0:3], v[84:87]
  buffer_load_dwordx4 v219, s[12:15], s50 offen offset:3072 lds
  s_add_u32 s50, s79, 2
  v_mfma_f32_16x16x32_bf16 v[88:91], a[40:43], a[4:7], v[88:91]
  s_and_b32 s50, s50, 7
  s_lshl_b32 s50, s50, 18
  s_add_u32 m0, s73, 32768
  v_mfma_f32_16x16x32_bf16 v[92:95], a[40:43], a[8:11], v[92:95]
  ds_read_b128 a[36:39], v149 offset:20480
  v_mfma_f32_16x16x32_bf16 v[96:99], a[40:43], a[12:15], v[96:99]
  ds_read_b64_tr_b16 a[56:57], v137 offset:2048
  v_mfma_f32_16x16x32_bf16 v[112:115], a[44:47], a[12:15], v[112:115]
  ds_read_b64_tr_b16 a[58:59], v137 offset:8192
  v_mfma_f32_16x16x32_bf16 v[108:111], a[44:47], a[8:11], v[108:111]
  buffer_load_dwordx4 v216, s[12:15], s50 offen offset:0 lds
  v_mfma_f32_16x16x32_bf16 v[104:107], a[44:47], a[4:7], v[104:107]
  ds_read_b64_tr_b16 a[60:61], v138 offset:2048
  v_mfma_f32_16x16x32_bf16 v[100:103], a[44:47], a[0:3], v[100:103]
  s_waitcnt lgkmcnt(3)
  ds_read_b64_tr_b16 a[62:63], v138 offset:8192
  v_mfma_f32_16x16x32_bf16 v[20:23], a[48:51], a[20:23], v[20:23]
  ds_read_b64_tr_b16 a[64:65], v137 offset:0
  v_mfma_f32_16x16x32_bf16 v[24:27], a[48:51], a[24:27], v[24:27]
  buffer_load_dwordx4 v217, s[12:15], s50 offen offset:1024 lds
  v_mfma_f32_16x16x32_bf16 v[28:31], a[48:51], a[28:31], v[28:31]
  ds_read_b64_tr_b16 a[66:67], v137 offset:6144
  v_mfma_f32_16x16x32_bf16 v[32:35], a[48:51], a[32:35], v[32:35]
  v_mfma_f32_16x16x32_bf16 v[116:119], a[48:51], a[36:39], v[116:119]
  ds_read_b64_tr_b16 a[68:69], v138 offset:0
  v_mfma_f32_16x16x32_bf16 v[48:51], a[52:55], a[32:35], v[48:51]
  buffer_load_dwordx4 v218, s[12:15], s50 offen offset:2048 lds
  v_mfma_f32_16x16x32_bf16 v[44:47], a[52:55], a[28:31], v[44:47]
  ds_read_b64_tr_b16 a[70:71], v138 offset:6144
  v_mfma_f32_16x16x32_bf16 v[40:43], a[52:55], a[24:27], v[40:43]
  v_mfma_f32_16x16x32_bf16 v[36:39], a[52:55], a[20:23], v[36:39]
  s_waitcnt lgkmcnt(4)
  v_mfma_f32_16x16x32_bf16 v[52:55], a[20:23], a[56:59], v[52:55]
  buffer_load_dwordx4 v219, s[12:15], s50 offen offset:3072 lds
  v_cvt_pk_bf16_f32 v116, v116, v117
  v_mfma_f32_16x16x32_bf16 v[56:59], a[24:27], a[56:59], v[56:59]
  v_cvt_pk_bf16_f32 v117, v118, v119
  v_cvt_pk_bf16_f32 v32, v32, v33
  v_mfma_f32_16x16x32_bf16 v[60:63], a[28:31], a[56:59], v[60:63]
  v_cvt_pk_bf16_f32 v33, v34, v35
  v_cvt_pk_bf16_f32 v34, v48, v49
  v_mfma_f32_16x16x32_bf16 v[64:67], a[32:35], a[56:59], v[64:67]
  v_cvt_pk_bf16_f32 v35, v50, v51
  v_mfma_f32_16x16x32_bf16 v[120:123], a[36:39], a[56:59], v[120:123]
  ds_write_b64 v224, v[116:117]
  v_mfma_f32_16x16x32_bf16 v[80:83], a[32:35], a[60:63], v[80:83]
  ds_write_b64 v222, v[32:33]
  v_mfma_f32_16x16x32_bf16 v[76:79], a[28:31], a[60:63], v[76:79]
  ds_write_b64 v223, v[34:35]
  v_cvt_pk_bf16_f32 v55, v54, v55
  v_mfma_f32_16x16x32_bf16 v[72:75], a[24:27], a[60:63], v[72:75]
  v_cvt_pk_bf16_f32 v54, v52, v53
  v_cvt_pk_bf16_f32 v56, v56, v57
  v_mfma_f32_16x16x32_bf16 v[68:71], a[20:23], a[60:63], v[68:71]
  s_waitcnt lgkmcnt(3)
  v_cvt_pk_bf16_f32 v57, v58, v59
  v_cvt_pk_bf16_f32 v58, v60, v61
  v_mfma_f32_16x16x32_bf16 v[84:87], a[64:67], a[20:23], v[84:87]
  v_cvt_pk_bf16_f32 v59, v62, v63
  v_cvt_pk_bf16_f32 v60, v64, v65
  v_mfma_f32_16x16x32_bf16 v[88:91], a[64:67], a[24:27], v[88:91]
  v_cvt_pk_bf16_f32 v61, v66, v67
  v_cvt_pk_bf16_f32 v120, v120, v121
  v_mfma_f32_16x16x32_bf16 v[92:95], a[64:67], a[28:31], v[92:95]
  v_cvt_pk_bf16_f32 v121, v122, v123
  v_mfma_f32_16x16x32_bf16 v[96:99], a[64:67], a[32:35], v[96:99]
  ds_write_b64 v222, v[60:61] offset:1024
  v_mfma_f32_16x16x32_bf16 v[112:115], a[68:71], a[32:35], v[112:115]
  ds_write_b64 v224, v[120:121] offset:1024
  v_cvt_pk_bf16_f32 v71, v70, v71
  v_mfma_f32_16x16x32_bf16 v[108:111], a[68:71], a[28:31], v[108:111]
  v_cvt_pk_bf16_f32 v70, v68, v69
  v_cvt_pk_bf16_f32 v72, v72, v73
  v_mfma_f32_16x16x32_bf16 v[104:107], a[68:71], a[24:27], v[104:107]
  v_cvt_pk_bf16_f32 v73, v74, v75
  v_cvt_pk_bf16_f32 v74, v76, v77
  v_mfma_f32_16x16x32_bf16 v[100:103], a[68:71], a[20:23], v[100:103]
  v_cvt_pk_bf16_f32 v75, v78, v79
  v_cvt_pk_bf16_f32 v76, v80, v81
  v_cvt_pk_bf16_f32 v77, v82, v83
  ds_write_b64 v223, v[76:77] offset:1024
  v_cvt_pk_bf16_f32 v28, v28, v29
  v_cvt_pk_bf16_f32 v29, v30, v31
  v_cvt_pk_bf16_f32 v30, v44, v45
  v_cvt_pk_bf16_f32 v31, v46, v47
  v_cvt_pk_bf16_f32 v24, v24, v25
  v_cvt_pk_bf16_f32 v25, v26, v27
  v_cvt_pk_bf16_f32 v26, v40, v41
  v_cvt_pk_bf16_f32 v27, v42, v43
  v_cvt_pk_bf16_f32 v20, v20, v21
  v_cvt_pk_bf16_f32 v21, v22, v23
  v_cvt_pk_bf16_f32 v22, v36, v37
  v_cvt_pk_bf16_f32 v23, v38, v39
  s_waitcnt lgkmcnt(0)
  s_barrier
  ds_read_b64 v[124:125], v225
  ds_read_b64 v[126:127], v226
  ds_read_b64 v[52:53], v225 offset:1024
  ds_read_b64 v[68:69], v226 offset:1024
  s_cmp_eq_u32 s51, 0
  s_cselect_b64 s[66:67], s[82:83], 0
  s_cselect_b64 s[68:69], s[84:85], 0
  v_cvt_pk_bf16_f32 v96, v96, v97
  v_cvt_pk_bf16_f32 v97, v98, v99
  v_cvt_pk_bf16_f32 v98, v112, v113
  v_cvt_pk_bf16_f32 v99, v114, v115
  v_cvt_pk_bf16_f32 v92, v92, v93
  v_cvt_pk_bf16_f32 v93, v94, v95
  v_cvt_pk_bf16_f32 v94, v108, v109
  s_add_u32 s50, s79, 3
  s_and_b32 s50, s50, 7
  s_lshl_b32 s50, s50, 18
  s_add_u32 m0, s73, 49152
  s_nop 0
  buffer_load_dwordx4 v216, s[12:15], s50 offen offset:0 lds
  v_cvt_pk_bf16_f32 v95, v110, v111
  v_cvt_pk_bf16_f32 v88, v88, v89
  v_cvt_pk_bf16_f32 v89, v90, v91
  v_cvt_pk_bf16_f32 v90, v104, v105
  v_cvt_pk_bf16_f32 v91, v106, v107
  v_cvt_pk_bf16_f32 v84, v84, v85
  v_cvt_pk_bf16_f32 v85, v86, v87
  v_cvt_pk_bf16_f32 v86, v100, v101
  v_cvt_pk_bf16_f32 v87, v102, v103
  v_mov_b32 v12, 0xce6e6b28
  buffer_load_dwordx4 v217, s[12:15], s50 offen offset:1024 lds
  v_mfma_f32_16x16x32_bf16 v[112:115], v[32:35], v[96:99], 0
  v_mfma_f32_16x16x32_bf16 v[48:51], v[28:31], v[96:99], 0
  v_mfma_f32_16x16x32_bf16 v[108:111], v[28:31], v[92:95], 0
  v_mfma_f32_16x16x32_bf16 v[44:47], v[24:27], v[92:95], 0
  v_mfma_f32_16x16x32_bf16 v[104:107], v[24:27], v[88:91], 0
  v_mfma_f32_16x16x32_bf16 v[40:43], v[20:23], v[88:91], 0
  s_waitcnt lgkmcnt(2)
  v_mfma_f32_16x16x32_bf16 v[100:103], v[20:23], v[84:87], 0
  v_mfma_f32_16x16x32_bf16 v[36:39], v[124:127], v[84:87], 0
  s_nop 1
  v_cndmask_b32 v214, v112, v113, s[80:81]
  buffer_load_dwordx4 v218, s[12:15], s50 offen offset:2048 lds
  v_cndmask_b32 v215, v114, v115, s[80:81]
  v_cndmask_b32 v212, v48, v49, s[80:81]
  v_cndmask_b32 v213, v50, v51, s[80:81]
  v_cndmask_b32 v210, v108, v109, s[80:81]
  v_cndmask_b32 v211, v110, v111, s[80:81]
  v_cndmask_b32 v208, v44, v45, s[80:81]
  v_cndmask_b32 v209, v46, v47, s[80:81]
  v_cndmask_b32 v206, v104, v105, s[80:81]
  v_cndmask_b32 v207, v106, v107, s[80:81]
  v_cndmask_b32 v204, v40, v41, s[80:81]
  buffer_load_dwordx4 v219, s[12:15], s50 offen offset:3072 lds
  v_cndmask_b32 v205, v42, v43, s[80:81]
  v_cndmask_b32 v202, v100, v101, s[80:81]
  v_cndmask_b32 v203, v102, v103, s[80:81]
  v_cndmask_b32 v200, v36, v37, s[80:81]
  v_cndmask_b32 v201, v38, v39, s[80:81]
  v_cndmask_b32 v212, v214, v212, s[82:83]
  v_cndmask_b32 v213, v215, v213, s[84:85]
  v_cndmask_b32 v208, v210, v208, s[82:83]
  v_cndmask_b32 v209, v211, v209, s[84:85]
  v_cndmask_b32 v204, v206, v204, s[82:83]
  s_add_u32 s50, s79, 4
  s_and_b32 s50, s50, 7
  s_lshl_b32 s50, s50, 18
  s_add_u32 m0, s73, 65536
  s_nop 0
  buffer_load_dwordx4 v216, s[12:15], s50 offen offset:0 lds
  v_cndmask_b32 v205, v207, v205, s[84:85]
  v_cndmask_b32 v200, v202, v200, s[82:83]
  v_cndmask_b32 v201, v203, v201, s[84:85]
  v_mul_f32 v212, 0x3e8293ee, v212
  v_mul_f32 v213, 0x3e8293ee, v213
  v_mul_f32 v208, 0x3e8293ee, v208
  v_mul_f32 v209, 0x3e8293ee, v209
  v_mul_f32 v204, 0x3e8293ee, v204
  v_mul_f32 v205, 0x3e8293ee, v205
  v_mul_f32 v200, 0x3e8293ee, v200
  buffer_load_dwordx4 v217, s[12:15], s50 offen offset:1024 lds
  v_mul_f32 v201, 0x3e8293ee, v201
  v_cndmask_b32 v200, v200, v12, s[66:67]
  v_cndmask_b32 v201, v201, v12, s[68:69]
  v_max_f32 v214, v212, v213
  v_max_f32 v210, v208, v209
  v_max_f32 v206, v204, v205
  v_max_f32 v202, v200, v201
  v_mov_b32 v215, v214
  v_mov_b32 v211, v210
  v_mov_b32 v207, v206
  buffer_load_dwordx4 v218, s[12:15], s50 offen offset:2048 lds
  v_mov_b32 v203, v202
  v_permlane16_swap_b32 v214, v215
  v_permlane16_swap_b32 v210, v211
  v_permlane16_swap_b32 v206, v207
  v_permlane16_swap_b32 v202, v203
  v_max_f32 v214, v214, v215
  v_max_f32 v210, v210, v211
  v_max_f32 v206, v206, v207
  v_max_f32 v202, v202, v203
  v_mov_b32 v215, v214
  buffer_load_dwordx4 v219, s[12:15], s50 offen offset:3072 lds
  v_mov_b32 v211, v210
  v_mov_b32 v207, v206
  v_mov_b32 v203, v202
  v_permlane32_swap_b32 v214, v215
  v_permlane32_swap_b32 v210, v211
  v_permlane32_swap_b32 v206, v207
  v_permlane32_swap_b32 v202, v203
  v_max_f32 v214, v214, v215
  v_max_f32 v210, v210, v211
  v_max_f32 v206, v206, v207
  v_max_f32 v202, v202, v203
  v_sub_f32 v212, v212, v214
  v_sub_f32 v213, v213, v214
  v_sub_f32 v208, v208, v210
  v_sub_f32 v209, v209, v210
  v_sub_f32 v204, v204, v206
  v_sub_f32 v205, v205, v206
  v_sub_f32 v200, v200, v202
  v_sub_f32 v201, v201, v202
  v_exp_f32 v212, v212
  v_exp_f32 v213, v213
  v_exp_f32 v208, v208
  v_exp_f32 v209, v209
  v_exp_f32 v204, v204
  v_exp_f32 v205, v205
  v_exp_f32 v200, v200
  v_exp_f32 v201, v201
  v_add_f32 v214, v212, v213
  v_add_f32 v210, v208, v209
  v_add_f32 v206, v204, v205
  v_add_f32 v202, v200, v201
  v_mov_b32 v215, v214
  v_mov_b32 v211, v210
  v_mov_b32 v207, v206
  v_mov_b32 v203, v202
  v_permlane16_swap_b32 v214, v215
  v_permlane16_swap_b32 v210, v211
  v_permlane16_swap_b32 v206, v207
  v_permlane16_swap_b32 v202, v203
  v_add_f32 v214, v214, v215
  v_add_f32 v210, v210, v211
  v_add_f32 v206, v206, v207
  v_add_f32 v202, v202, v203
  v_mov_b32 v215, v214
  v_mov_b32 v211, v210
  v_mov_b32 v207, v206
  v_mov_b32 v203, v202
  v_permlane32_swap_b32 v214, v215
  v_permlane32_swap_b32 v210, v211
  v_permlane32_swap_b32 v206, v207
  v_permlane32_swap_b32 v202, v203
  v_add_f32 v214, v214, v215
  v_add_f32 v210, v210, v211
  v_add_f32 v206, v206, v207
  v_add_f32 v202, v202, v203
  v_rcp_f32 v214, v214
  v_rcp_f32 v210, v210
  v_rcp_f32 v206, v206
  v_rcp_f32 v202, v202
  v_mul_f32 v212, v212, v214
  v_mul_f32 v213, v213, v214
  v_mul_f32 v208, v208, v210
  v_mul_f32 v209, v209, v210
  v_mul_f32 v204, v204, v206
  v_mul_f32 v205, v205, v206
  v_mul_f32 v200, v200, v202
  v_mul_f32 v201, v201, v202
  v_cvt_pk_bf16_f32 v212, v212, v212
  v_cvt_pk_bf16_f32 v213, v213, v213
  v_cvt_pk_bf16_f32 v208, v208, v208
  v_cvt_pk_bf16_f32 v209, v209, v209
  v_cvt_pk_bf16_f32 v204, v204, v204
  v_cvt_pk_bf16_f32 v205, v205, v205
  v_cvt_pk_bf16_f32 v200, v200, v200
  v_cvt_pk_bf16_f32 v201, v201, v201
  v_and_b32 v48, v227, v212
  v_and_b32 v49, v228, v213
  v_and_b32 v50, v229, v212
  v_and_b32 v51, v230, v213
  v_and_b32 v44, v227, v208
  v_and_b32 v45, v228, v209
  v_and_b32 v46, v229, v208
  v_and_b32 v47, v230, v209
  v_and_b32 v40, v227, v204
  v_and_b32 v41, v228, v205
  v_and_b32 v42, v229, v204
  v_and_b32 v43, v230, v205
  v_and_b32 v36, v227, v200
  v_and_b32 v37, v228, v201
  v_and_b32 v38, v229, v200
  v_and_b32 v39, v230, v201
  s_waitcnt lgkmcnt(0)
  v_mfma_f32_16x16x32_bf16 v[32:35], v[58:61], v[48:51], 0
  v_mfma_f32_16x16x32_bf16 v[96:99], v[74:77], v[48:51], 0
  v_mfma_f32_16x16x32_bf16 v[28:31], v[56:59], v[44:47], 0
  v_mfma_f32_16x16x32_bf16 v[92:95], v[72:75], v[44:47], 0
  v_mfma_f32_16x16x32_bf16 v[24:27], v[54:57], v[40:43], 0
  v_mfma_f32_16x16x32_bf16 v[88:91], v[70:73], v[40:43], 0
  v_mfma_f32_16x16x32_bf16 v[20:23], v[52:55], v[36:39], 0
  v_mfma_f32_16x16x32_bf16 v[84:87], v[68:71], v[36:39], 0
  s_cmp_eq_u32 s58, 1
  s_cselect_b64 vcc, -1, 0
  v_cvt_pk_bf16_f32 v112, v32, v33
  v_cvt_pk_bf16_f32 v113, v34, v35
  v_cvt_pk_bf16_f32 v114, v96, v97
  v_cvt_pk_bf16_f32 v115, v98, v99
  v_cndmask_b32 v212, v112, v114, vcc
  v_cndmask_b32 v213, v113, v115, vcc
  v_cndmask_b32 v214, v114, v112, vcc
  v_cndmask_b32 v215, v115, v113, vcc
  buffer_store_dwordx4 v[212:215], v0, s[36:39], s75 offen offset:1024 sc1
  v_cvt_pk_bf16_f32 v108, v28, v29
  v_cvt_pk_bf16_f32 v109, v30, v31
  v_cvt_pk_bf16_f32 v110, v92, v93
  v_cvt_pk_bf16_f32 v111, v94, v95
  v_cndmask_b32 v208, v108, v110, vcc
  v_cndmask_b32 v209, v109, v111, vcc
  v_cndmask_b32 v210, v110, v108, vcc
  v_cndmask_b32 v211, v111, v109, vcc
  buffer_store_dwordx4 v[208:211], v0, s[36:39], s75 offen offset:0 sc1
  v_cvt_pk_bf16_f32 v104, v24, v25
  v_cvt_pk_bf16_f32 v105, v26, v27
  v_cvt_pk_bf16_f32 v106, v88, v89
  v_cvt_pk_bf16_f32 v107, v90, v91
  v_cndmask_b32 v204, v104, v106, vcc
  v_cndmask_b32 v205, v105, v107, vcc
  v_cndmask_b32 v206, v106, v104, vcc
  v_cndmask_b32 v207, v107, v105, vcc
  buffer_store_dwordx4 v[204:207], v0, s[36:39], s74 offen offset:1024 sc1
  v_cvt_pk_bf16_f32 v100, v20, v21
  v_cvt_pk_bf16_f32 v101, v22, v23
  v_cvt_pk_bf16_f32 v102, v84, v85
  v_cvt_pk_bf16_f32 v103, v86, v87
  v_cndmask_b32 v200, v100, v102, vcc
  v_cndmask_b32 v201, v101, v103, vcc
  v_cndmask_b32 v202, v102, v100, vcc
  v_cndmask_b32 v203, v103, v101, vcc
  buffer_store_dwordx4 v[200:203], v0, s[36:39], s74 offen offset:0 sc1
  v_mov_b32 v12, 1
  s_waitcnt vmcnt(0) lgkmcnt(0)
  s_barrier
  s_mov_b64 exec, 1
  buffer_store_dword v12, v0, s[36:39], s45 offen sc1
  s_mov_b64 exec, -1
  v_lshlrev_b32 v28, 16, v156
  v_lshrrev_b32 v14, 2, v10
  v_min_u32 v14, (X_k3_main_kernel-G3S)/4096, v14
  v_and_b32 v15, 3, v10
  v_lshlrev_b32 v15, 7, v15
  v_lshl_add_u32 v14, v14, 12, v15
  s_lshl_b32 s94, s44, 10
  s_sub_u32 s94, AL-k3_main_kernel+((G3S-AL+4095)/4096)*4096, s94
  s_add_u32 s94, s92, s94
  s_addc_u32 s95, s93, 0
  global_load_dword a252, v14, s[94:95]
  v_and_b32 v29, 0xffff0000, v156
  v_lshlrev_b32 v30, 16, v157
  v_and_b32 v31, 0xffff0000, v157
  v_mul_f32 v20, v188, v28
  v_mul_f32 v21, v188, v29
  v_mul_f32 v22, v188, v30
  s_add_u32 s50, s79, 5
  s_and_b32 s50, s50, 7
  s_lshl_b32 s50, s50, 18
  s_add_u32 m0, s73, 81920
  s_nop 0
  buffer_load_dwordx4 v216, s[12:15], s50 offen offset:0 lds
  v_mul_f32 v23, v188, v31
  v_lshlrev_b32 v28, 16, v158
  v_and_b32 v29, 0xffff0000, v158
  v_lshlrev_b32 v30, 16, v159
  v_and_b32 v31, 0xffff0000, v159
  v_mul_f32 v24, v188, v28
  buffer_load_dwordx4 v217, s[12:15], s50 offen offset:1024 lds
  v_mul_f32 v25, v188, v29
  v_mul_f32 v26, v188, v30
  v_mul_f32 v27, v188, v31
  v_lshlrev_b32 v28, 16, v160
  v_and_b32 v29, 0xffff0000, v160
  v_lshlrev_b32 v30, 16, v161
Ha1_1:
  s_cbranch_execz Ra
  buffer_load_dwordx4 v218, s[12:15], s50 offen offset:2048 lds
  v_and_b32 v31, 0xffff0000, v161
  v_fmac_f32 v20, v189, v28
  v_fmac_f32 v21, v189, v29
  v_fmac_f32 v22, v189, v30
  v_fmac_f32 v23, v189, v31
  v_lshlrev_b32 v28, 16, v162
  buffer_load_dwordx4 v219, s[12:15], s50 offen offset:3072 lds
  v_and_b32 v29, 0xffff0000, v162
  v_lshlrev_b32 v30, 16, v163
  v_and_b32 v31, 0xffff0000, v163
  v_fmac_f32 v24, v189, v28
  v_fmac_f32 v25, v189, v29
  v_fmac_f32 v26, v189, v30
  s_add_u32 s50, s79, 6
  s_and_b32 s50, s50, 7
  s_lshl_b32 s50, s50, 18
  s_add_u32 m0, s73, 98304
  s_nop 0
  buffer_load_dwordx4 v216, s[12:15], s50 offen offset:0 lds
  v_fmac_f32 v27, v189, v31
  v_lshlrev_b32 v28, 16, v164
  v_and_b32 v29, 0xffff0000, v164
  v_lshlrev_b32 v30, 16, v165
  v_and_b32 v31, 0xffff0000, v165
  v_fmac_f32 v20, v190, v28
  buffer_load_dwordx4 v217, s[12:15], s50 offen offset:1024 lds
  v_fmac_f32 v21, v190, v29
  v_fmac_f32 v22, v190, v30
  v_fmac_f32 v23, v190, v31
  v_lshlrev_b32 v28, 16, v166
  v_and_b32 v29, 0xffff0000, v166
  v_lshlrev_b32 v30, 16, v167
  buffer_load_dwordx4 v218, s[12:15], s50 offen offset:2048 lds
  v_and_b32 v31, 0xffff0000, v167
  v_fmac_f32 v24, v190, v28
  v_fmac_f32 v25, v190, v29
  v_fmac_f32 v26, v190, v30
  v_fmac_f32 v27, v190, v31
  v_lshlrev_b32 v28, 16, v168
  buffer_load_dwordx4 v219, s[12:15], s50 offen offset:3072 lds
  v_and_b32 v29, 0xffff0000, v168
  v_lshlrev_b32 v30, 16, v169
  v_and_b32 v31, 0xffff0000, v169
  v_fmac_f32 v20, v191, v28
  v_fmac_f32 v21, v191, v29
  v_fmac_f32 v22, v191, v30
  s_add_u32 s50, s79, 7
  s_and_b32 s50, s50, 7
  s_lshl_b32 s50, s50, 18
  s_add_u32 m0, s73, 114688
  s_nop 0
  buffer_load_dwordx4 v216, s[12:15], s50 offen offset:0 lds
  v_fmac_f32 v23, v191, v31
  v_lshlrev_b32 v28, 16, v170
  v_and_b32 v29, 0xffff0000, v170
  v_lshlrev_b32 v30, 16, v171
  v_and_b32 v31, 0xffff0000, v171
  v_fmac_f32 v24, v191, v28
  buffer_load_dwordx4 v217, s[12:15], s50 offen offset:1024 lds
  v_fmac_f32 v25, v191, v29
  v_fmac_f32 v26, v191, v30
  v_fmac_f32 v27, v191, v31
  v_lshlrev_b32 v28, 16, v172
  v_and_b32 v29, 0xffff0000, v172
  v_lshlrev_b32 v30, 16, v173
  buffer_load_dwordx4 v218, s[12:15], s50 offen offset:2048 lds
  v_and_b32 v31, 0xffff0000, v173
  v_fmac_f32 v20, v192, v28
  v_fmac_f32 v21, v192, v29
  v_fmac_f32 v22, v192, v30
  v_fmac_f32 v23, v192, v31
  v_lshlrev_b32 v28, 16, v174
  buffer_load_dwordx4 v219, s[12:15], s50 offen offset:3072 lds
  v_and_b32 v29, 0xffff0000, v174
  v_lshlrev_b32 v30, 16, v175
  v_and_b32 v31, 0xffff0000, v175
  v_fmac_f32 v24, v192, v28
  v_fmac_f32 v25, v192, v29
  v_fmac_f32 v26, v192, v30
  s_add_u32 m0, s73, 131072
  s_nop 0
  buffer_load_dwordx4 v220, s[4:7], s72 offen offset:0 lds
  v_fmac_f32 v27, v192, v31
  v_lshlrev_b32 v28, 16, v176
  v_and_b32 v29, 0xffff0000, v176
  v_lshlrev_b32 v30, 16, v177
  v_and_b32 v31, 0xffff0000, v177
  v_fmac_f32 v20, v193, v28
  buffer_load_dwordx4 v221, s[4:7], s72 offen offset:1024 lds
  v_fmac_f32 v21, v193, v29
  v_fmac_f32 v22, v193, v30
  v_fmac_f32 v23, v193, v31
  v_lshlrev_b32 v28, 16, v178
  v_and_b32 v29, 0xffff0000, v178
  v_lshlrev_b32 v30, 16, v179
  s_add_u32 m0, s73, 133120
  s_add_u32 s48, s72, 32768
  buffer_load_dwordx4 v220, s[4:7], s48 offen offset:0 lds
  v_and_b32 v31, 0xffff0000, v179
  v_fmac_f32 v24, v193, v28
  v_fmac_f32 v25, v193, v29
  v_fmac_f32 v26, v193, v30
  v_fmac_f32 v27, v193, v31
  v_lshlrev_b32 v28, 16, v180
  buffer_load_dwordx4 v221, s[4:7], s48 offen offset:1024 lds
  v_and_b32 v29, 0xffff0000, v180
  v_lshlrev_b32 v30, 16, v181
  v_and_b32 v31, 0xffff0000, v181
  v_fmac_f32 v20, v194, v28
  v_fmac_f32 v21, v194, v29
  v_fmac_f32 v22, v194, v30
  v_fmac_f32 v23, v194, v31
  v_lshlrev_b32 v28, 16, v182
  v_and_b32 v29, 0xffff0000, v182
  v_lshlrev_b32 v30, 16, v183
  v_and_b32 v31, 0xffff0000, v183
  v_fmac_f32 v24, v194, v28
  v_fmac_f32 v25, v194, v29
  v_fmac_f32 v26, v194, v30
  v_fmac_f32 v27, v194, v31
  v_lshlrev_b32 v28, 16, v184
  v_and_b32 v29, 0xffff0000, v184
  v_lshlrev_b32 v30, 16, v185
  v_and_b32 v31, 0xffff0000, v185
  v_fmac_f32 v20, v195, v28
  v_fmac_f32 v21, v195, v29
  v_fmac_f32 v22, v195, v30
  v_fmac_f32 v23, v195, v31
  v_lshlrev_b32 v28, 16, v186
  v_and_b32 v29, 0xffff0000, v186
  v_lshlrev_b32 v30, 16, v187
  v_and_b32 v31, 0xffff0000, v187
  v_fmac_f32 v24, v195, v28
  v_fmac_f32 v25, v195, v29
  v_fmac_f32 v26, v195, v30
  v_fmac_f32 v27, v195, v31
  s_nop 0
  v_permlane32_swap_b32 v20, v24
  v_permlane32_swap_b32 v21, v25
  v_permlane32_swap_b32 v22, v26
  v_permlane32_swap_b32 v23, v27
  v_add_f32 v20, v20, v24
  v_add_f32 v21, v21, v25
  v_add_f32 v22, v22, v26
  v_add_f32 v23, v23, v27
  s_nop 0
  v_permlane16_swap_b32 v20, v22
  v_permlane16_swap_b32 v21, v23
  v_add_f32 v20, v20, v22
  v_add_f32 v21, v21, v23
  v_add_u32 v196, 162816, v198
  v_add_f32_dpp v20, v20, v20 row_ror:8 row_mask:0xf bank_mask:0xf
  v_add_f32_dpp v21, v21, v21 row_ror:8 row_mask:0xf bank_mask:0xf
  ds_write_b64 v197, v[20:21]
  s_lshl_b32 s45, s2, 7
  s_add_u32 s45, s45, 5341184
  s_cmp_eq_u32 s44, 0
  s_cselect_b32 s45, s45, 1073741824
  s_waitcnt lgkmcnt(0)
  s_barrier
  ds_read_b32 v200, v196 offset:0
  ds_read_b32 v201, v196 offset:256
  ds_read_b32 v202, v196 offset:512
  ds_read_b32 v203, v196 offset:768
  s_cmp_eq_u32 s44, 1
  s_cselect_b32 s48, s53, 1073741824
  s_waitcnt lgkmcnt(0)
  v_add_f32 v200, v200, v201
  v_add_f32 v202, v202, v203
  v_add_f32 v200, v200, v202
  buffer_store_dword v200, v198, s[36:39], s48 offen sc1
  ds_read_b64_tr_b16 a[80:81], v231 offset:0
  ds_read_b64_tr_b16 a[82:83], v231 offset:2048
  ds_read_b64_tr_b16 a[84:85], v231 offset:4096
  ds_read_b64_tr_b16 a[86:87], v231 offset:6144
  ds_read_b64_tr_b16 a[88:89], v232 offset:0
  ds_read_b64_tr_b16 a[90:91], v232 offset:2048
  ds_read_b64_tr_b16 a[92:93], v232 offset:4096
  ds_read_b64_tr_b16 a[94:95], v232 offset:6144
  ds_read_b64_tr_b16 a[96:97], v233 offset:0
  ds_read_b64_tr_b16 a[98:99], v233 offset:2048
  ds_read_b64_tr_b16 a[100:101], v233 offset:4096
  ds_read_b64_tr_b16 a[102:103], v233 offset:6144
  ds_read_b64_tr_b16 a[104:105], v234 offset:0
  ds_read_b64_tr_b16 a[106:107], v234 offset:2048
  ds_read_b64_tr_b16 a[108:109], v234 offset:4096
  ds_read_b64_tr_b16 a[110:111], v234 offset:6144
  ds_read_b64_tr_b16 a[112:113], v231 offset:8192
  ds_read_b64_tr_b16 a[114:115], v231 offset:10240
  ds_read_b64_tr_b16 a[116:117], v231 offset:12288
  ds_read_b64_tr_b16 a[118:119], v231 offset:14336
  ds_read_b64_tr_b16 a[120:121], v232 offset:8192
  ds_read_b64_tr_b16 a[122:123], v232 offset:10240
  ds_read_b64_tr_b16 a[124:125], v232 offset:12288
  ds_read_b64_tr_b16 a[126:127], v232 offset:14336
  ds_read_b64_tr_b16 a[128:129], v233 offset:8192
  ds_read_b64_tr_b16 a[130:131], v233 offset:10240
  ds_read_b64_tr_b16 a[132:133], v233 offset:12288
  ds_read_b64_tr_b16 a[134:135], v233 offset:14336
  ds_read_b64_tr_b16 a[136:137], v234 offset:8192
  ds_read_b64_tr_b16 a[138:139], v234 offset:10240
  ds_read_b64_tr_b16 a[140:141], v234 offset:12288
  ds_read_b64_tr_b16 a[142:143], v234 offset:14336
  s_cmp_lg_u32 s44, 0
  s_cbranch_scc1 SM2x
  s_mov_b32 s46, 60000
  s_mov_b32 s47, 5275648
SM2:
  buffer_load_dword v13, v249, s[36:39], s47 offen sc1
  s_sub_u32 s46, s46, 1
  s_cmp_eq_u32 s46, 0
  s_waitcnt vmcnt(0)
  s_cbranch_scc1 SM2x
  v_cmp_ne_u32 vcc, 1, v13
  s_nop 4
  s_cbranch_vccnz SM2
SM2x:
  s_waitcnt vmcnt(1)
  s_barrier
  s_lshl_b32 s50, s79, 13
  buffer_load_dwordx4 a[0:3], v243, s[36:39], s50 offen offset:0 sc1
  buffer_load_dwordx4 a[8:11], v243, s[36:39], s50 offen offset:2048 sc1
  buffer_load_dwordx4 a[4:7], v243, s[36:39], s50 offen offset:1024 sc1
  buffer_load_dwordx4 a[12:15], v243, s[36:39], s50 offen offset:3072 sc1
  s_add_u32 s50, s50, 4096
  s_and_b32 s50, s50, 0xffff
  buffer_load_dwordx4 a[16:19], v243, s[36:39], s50 offen offset:0 sc1
  buffer_load_dwordx4 a[20:23], v243, s[36:39], s50 offen offset:1024 sc1
  buffer_load_dwordx4 a[24:27], v243, s[36:39], s50 offen offset:2048 sc1
  buffer_load_dwordx4 a[28:31], v243, s[36:39], s50 offen offset:3072 sc1
  ds_read_b64_tr_b16 a[144:145], v231 offset:16384
  ds_read_b64_tr_b16 a[146:147], v231 offset:18432
  ds_read_b64_tr_b16 a[148:149], v231 offset:20480
  ds_read_b64_tr_b16 a[150:151], v231 offset:22528
  ds_read_b64_tr_b16 a[152:153], v232 offset:16384
  ds_read_b64_tr_b16 a[154:155], v232 offset:18432
  ds_read_b64_tr_b16 a[156:157], v232 offset:20480
  ds_read_b64_tr_b16 a[158:159], v232 offset:22528
  ds_read_b64_tr_b16 a[160:161], v233 offset:16384
  ds_read_b64_tr_b16 a[162:163], v233 offset:18432
  ds_read_b64_tr_b16 a[164:165], v233 offset:20480
  ds_read_b64_tr_b16 a[166:167], v233 offset:22528
  ds_read_b64_tr_b16 a[168:169], v234 offset:16384
  ds_read_b64_tr_b16 a[170:171], v234 offset:18432
  ds_read_b64_tr_b16 a[172:173], v234 offset:20480
  ds_read_b64_tr_b16 a[174:175], v234 offset:22528
  ds_read_b64_tr_b16 a[176:177], v231 offset:24576
  ds_read_b64_tr_b16 a[178:179], v231 offset:26624
  ds_read_b64_tr_b16 a[180:181], v231 offset:28672
  ds_read_b64_tr_b16 a[182:183], v231 offset:30720
  ds_read_b64_tr_b16 a[184:185], v232 offset:24576
  ds_read_b64_tr_b16 a[186:187], v232 offset:26624
  ds_read_b64_tr_b16 a[188:189], v232 offset:28672
  ds_read_b64_tr_b16 a[190:191], v232 offset:30720
  ds_read_b64_tr_b16 a[192:193], v233 offset:24576
  ds_read_b64_tr_b16 a[194:195], v233 offset:26624
  ds_read_b64_tr_b16 a[196:197], v233 offset:28672
  ds_read_b64_tr_b16 a[198:199], v233 offset:30720
  ds_read_b64_tr_b16 a[200:201], v234 offset:24576
  ds_read_b64_tr_b16 a[202:203], v234 offset:26624
  ds_read_b64_tr_b16 a[204:205], v234 offset:28672
  ds_read_b64_tr_b16 a[206:207], v234 offset:30720
  ds_read_b64_tr_b16 a[208:209], v231 offset:32768
  ds_read_b64_tr_b16 a[210:211], v231 offset:34816
  ds_read_b64_tr_b16 a[212:213], v231 offset:36864
  ds_read_b64_tr_b16 a[214:215], v231 offset:38912
  ds_read_b64_tr_b16 a[216:217], v232 offset:32768
  ds_read_b64_tr_b16 a[218:219], v232 offset:34816
  ds_read_b64_tr_b16 a[220:221], v232 offset:36864
  ds_read_b64_tr_b16 a[222:223], v232 offset:38912
  ds_read_b64 v[116:117], v239 offset:0
  ds_read_b64 v[118:119], v240 offset:0
  ds_read_b64 v[120:121], v241 offset:0
  ds_read_b64 v[122:123], v242 offset:0
  ds_read_b64 v[124:125], v239 offset:2048
  ds_read_b64 v[126:127], v240 offset:2048
  ds_read_b64 v[128:129], v241 offset:2048
  ds_read_b64 v[130:131], v242 offset:2048
  v_lshrrev_b32 v13, 4, v10
  v_cmp_eq_u32 vcc, 2, v13
  s_add_u32 s51, s76, 4096
  s_nop 0
  v_cndmask_b32 v13, 0, 1.0, vcc
  s_waitcnt lgkmcnt(0)
  v_lshlrev_b32 v52, 16, v116
  v_and_b32 v53, 0xffff0000, v116
  v_lshlrev_b32 v54, 16, v117
  v_and_b32 v55, 0xffff0000, v117
  v_lshlrev_b32 v56, 16, v118
  v_and_b32 v57, 0xffff0000, v118
  v_lshlrev_b32 v58, 16, v119
  v_and_b32 v59, 0xffff0000, v119
  v_lshlrev_b32 v60, 16, v120
  v_and_b32 v61, 0xffff0000, v120
  v_lshlrev_b32 v62, 16, v121
  v_and_b32 v63, 0xffff0000, v121
  v_lshlrev_b32 v64, 16, v122
  v_and_b32 v65, 0xffff0000, v122
  v_lshlrev_b32 v66, 16, v123
  v_and_b32 v67, 0xffff0000, v123
  v_lshlrev_b32 v68, 16, v124
  v_and_b32 v69, 0xffff0000, v124
  v_lshlrev_b32 v70, 16, v125
  v_and_b32 v71, 0xffff0000, v125
  v_lshlrev_b32 v72, 16, v126
  v_and_b32 v73, 0xffff0000, v126
  v_lshlrev_b32 v74, 16, v127
  v_and_b32 v75, 0xffff0000, v127
  v_lshlrev_b32 v76, 16, v128
  v_and_b32 v77, 0xffff0000, v128
  v_lshlrev_b32 v78, 16, v129
  v_and_b32 v79, 0xffff0000, v129
  v_lshlrev_b32 v80, 16, v130
  v_and_b32 v81, 0xffff0000, v130
  v_lshlrev_b32 v82, 16, v131
  v_and_b32 v83, 0xffff0000, v131
  s_waitcnt vmcnt(7) lgkmcnt(15)
  v_mfma_f32_16x16x32_bf16 v[20:23], a[80:83], a[0:3], 0
  s_waitcnt vmcnt(6)
  s_add_u32 s50, s50, 4096
  s_and_b32 s50, s50, 0xffff
  v_mfma_f32_16x16x32_bf16 v[20:23], a[84:87], a[8:11], v[20:23]
  s_waitcnt vmcnt(4)
  buffer_load_dwordx4 a[32:35], v243, s[36:39], s50 offen offset:0 sc1
  v_mfma_f32_16x16x32_bf16 v[24:27], a[84:87], a[12:15], 0
  s_waitcnt vmcnt(6)
  buffer_load_dwordx4 a[36:39], v243, s[36:39], s50 offen offset:1024 sc1
  v_mfma_f32_16x16x32_bf16 v[24:27], a[80:83], a[4:7], v[24:27]
  s_waitcnt lgkmcnt(15)
  ds_read_b64_tr_b16 a[80:81], v233 offset:32768
  ds_read_b64_tr_b16 a[82:83], v233 offset:34816
  v_mfma_f32_16x16x32_bf16 v[32:35], a[88:91], a[4:7], 0
  ds_read_b64_tr_b16 a[84:85], v233 offset:36864
  ds_read_b64_tr_b16 a[86:87], v233 offset:38912
  v_mfma_f32_16x16x32_bf16 v[32:35], a[92:95], a[12:15], v[32:35]
  buffer_load_dwordx4 a[40:43], v243, s[36:39], s50 offen offset:2048 sc1
  v_mfma_f32_16x16x32_bf16 v[28:31], a[92:95], a[8:11], 0
  buffer_load_dwordx4 a[44:47], v243, s[36:39], s50 offen offset:3072 sc1
  v_mfma_f32_16x16x32_bf16 v[28:31], a[88:91], a[0:3], v[28:31]
  s_waitcnt lgkmcnt(15)
  s_add_u32 s50, s50, 4096
  s_and_b32 s50, s50, 0xffff
  v_mfma_f32_16x16x32_bf16 v[36:39], a[96:99], a[0:3], 0
  ds_read_b64_tr_b16 a[88:89], v234 offset:32768
  ds_read_b64_tr_b16 a[90:91], v234 offset:34816
  v_mfma_f32_16x16x32_bf16 v[36:39], a[100:103], a[8:11], v[36:39]
  ds_read_b64_tr_b16 a[92:93], v234 offset:36864
  buffer_load_dwordx4 a[48:51], v243, s[36:39], s50 offen offset:0 sc1
  v_mfma_f32_16x16x32_bf16 v[40:43], a[100:103], a[12:15], 0
  ds_read_b64_tr_b16 a[94:95], v234 offset:38912
  buffer_load_dwordx4 a[52:55], v243, s[36:39], s50 offen offset:1024 sc1
  v_mfma_f32_16x16x32_bf16 v[40:43], a[96:99], a[4:7], v[40:43]
  s_waitcnt lgkmcnt(15)
  ds_read_b64_tr_b16 a[96:97], v231 offset:40960
  ds_read_b64_tr_b16 a[98:99], v231 offset:43008
  v_mfma_f32_16x16x32_bf16 v[48:51], a[104:107], a[4:7], 0
  s_mov_b32 s49, 0
  buffer_load_dwordx4 a[56:59], v243, s[36:39], s50 offen offset:2048 sc1
  ds_read_b64_tr_b16 a[100:101], v231 offset:45056
  v_mfma_f32_16x16x32_bf16 v[48:51], a[108:111], a[12:15], v[48:51]
  buffer_load_dwordx4 v[156:159], v248, s[36:39], s49 offen sc1
  s_mov_b32 s49, 24576
  v_mfma_f32_16x16x32_bf16 v[44:47], a[108:111], a[8:11], 0
  buffer_load_dwordx4 v[160:163], v248, s[36:39], s49 offen sc1
  s_mov_b32 s49, 49152
  v_mfma_f32_16x16x32_bf16 v[44:47], a[104:107], a[0:3], v[44:47]
  s_waitcnt vmcnt(9) lgkmcnt(15)
  buffer_load_dwordx4 v[164:167], v248, s[36:39], s49 offen sc1
  s_mov_b32 s49, 73728
  v_mfma_f32_16x16x32_bf16 v[20:23], a[112:115], a[16:19], v[20:23]
  buffer_load_dwordx4 v[168:171], v248, s[36:39], s49 offen sc1
  buffer_load_dwordx4 a[60:63], v243, s[36:39], s50 offen offset:3072 sc1
  v_mfma_f32_16x16x32_bf16 v[20:23], a[116:119], a[24:27], v[20:23]
  s_add_u32 s50, s50, 4096
  ds_read_b64_tr_b16 a[102:103], v231 offset:47104
  s_and_b32 s50, s50, 0xffff
  v_mfma_f32_16x16x32_bf16 v[24:27], a[116:119], a[28:31], v[24:27]
  ds_read_b64_tr_b16 a[104:105], v232 offset:40960
  buffer_load_dwordx4 a[64:67], v243, s[36:39], s50 offen offset:0 sc1
  v_mfma_f32_16x16x32_bf16 v[24:27], a[112:115], a[20:23], v[24:27]
  s_waitcnt lgkmcnt(15)
  ds_read_b64_tr_b16 a[106:107], v232 offset:43008
  ds_read_b64_tr_b16 a[108:109], v232 offset:45056
  v_mfma_f32_16x16x32_bf16 v[32:35], a[120:123], a[20:23], v[32:35]
  buffer_load_dwordx4 a[68:71], v243, s[36:39], s50 offen offset:1024 sc1
  ds_read_b64_tr_b16 a[110:111], v232 offset:47104
  v_mfma_f32_16x16x32_bf16 v[32:35], a[124:127], a[28:31], v[32:35]
  buffer_load_dwordx4 a[72:75], v243, s[36:39], s50 offen offset:2048 sc1
  ds_read_b64_tr_b16 a[112:113], v233 offset:40960
  v_mfma_f32_16x16x32_bf16 v[28:31], a[124:127], a[24:27], v[28:31]
  ds_read_b64_tr_b16 a[114:115], v233 offset:43008
  buffer_load_dwordx4 a[76:79], v243, s[36:39], s50 offen offset:3072 sc1
  v_mfma_f32_16x16x32_bf16 v[28:31], a[120:123], a[16:19], v[28:31]
  s_waitcnt lgkmcnt(15)
  s_add_u32 s50, s50, 4096
  s_and_b32 s50, s50, 0xffff
  v_mfma_f32_16x16x32_bf16 v[36:39], a[128:131], a[16:19], v[36:39]
  ds_read_b64_tr_b16 a[116:117], v233 offset:45056
  buffer_load_dwordx4 a[0:3], v243, s[36:39], s50 offen offset:0 sc1
  v_mfma_f32_16x16x32_bf16 v[36:39], a[132:135], a[24:27], v[36:39]
  ds_read_b64_tr_b16 a[118:119], v233 offset:47104
  ds_read_b64_tr_b16 a[120:121], v234 offset:40960
  v_mfma_f32_16x16x32_bf16 v[40:43], a[132:135], a[28:31], v[40:43]
  buffer_load_dwordx4 a[4:7], v243, s[36:39], s50 offen offset:1024 sc1
  ds_read_b64_tr_b16 a[122:123], v234 offset:43008
  v_mfma_f32_16x16x32_bf16 v[40:43], a[128:131], a[20:23], v[40:43]
  s_waitcnt lgkmcnt(15)
  v_mfma_f32_16x16x32_bf16 v[48:51], a[136:139], a[20:23], v[48:51]
  buffer_load_dwordx4 a[8:11], v243, s[36:39], s50 offen offset:2048 sc1
  ds_read_b64_tr_b16 a[124:125], v234 offset:45056
  v_mfma_f32_16x16x32_bf16 v[48:51], a[140:143], a[28:31], v[48:51]
  ds_read_b64_tr_b16 a[126:127], v234 offset:47104
  v_mfma_f32_16x16x32_bf16 v[44:47], a[140:143], a[24:27], v[44:47]
  buffer_load_dwordx4 a[12:15], v243, s[36:39], s50 offen offset:3072 sc1
  ds_read_b64_tr_b16 a[128:129], v231 offset:49152
  v_mfma_f32_16x16x32_bf16 v[44:47], a[136:139], a[16:19], v[44:47]
  s_waitcnt vmcnt(16) lgkmcnt(15)
  v_mfma_f32_16x16x32_bf16 v[20:23], a[144:147], a[32:35], v[20:23]
  s_add_u32 s50, s50, 4096
  s_and_b32 s50, s50, 0xffff
  ds_read_b64_tr_b16 a[130:131], v231 offset:51200
  v_mfma_f32_16x16x32_bf16 v[20:23], a[148:151], a[40:43], v[20:23]
  buffer_load_dwordx4 a[16:19], v243, s[36:39], s50 offen offset:0 sc1
  ds_read_b64_tr_b16 a[132:133], v231 offset:53248
  v_mfma_f32_16x16x32_bf16 v[24:27], a[148:151], a[44:47], v[24:27]
  ds_read_b64_tr_b16 a[134:135], v231 offset:55296
  v_mfma_f32_16x16x32_bf16 v[24:27], a[144:147], a[36:39], v[24:27]
  s_waitcnt lgkmcnt(15)
  ds_read_b64_tr_b16 a[136:137], v232 offset:49152
  v_mfma_f32_16x16x32_bf16 v[32:35], a[152:155], a[36:39], v[32:35]
  v_mfma_f32_16x16x32_bf16 v[32:35], a[156:159], a[44:47], v[32:35]
  buffer_load_dwordx4 a[20:23], v243, s[36:39], s50 offen offset:1024 sc1
  ds_read_b64_tr_b16 a[138:139], v232 offset:51200
  v_mfma_f32_16x16x32_bf16 v[28:31], a[156:159], a[40:43], v[28:31]
  ds_read_b64_tr_b16 a[140:141], v232 offset:53248
  v_mfma_f32_16x16x32_bf16 v[28:31], a[152:155], a[32:35], v[28:31]
  s_waitcnt lgkmcnt(15)
  ds_read_b64_tr_b16 a[142:143], v232 offset:55296
  v_mfma_f32_16x16x32_bf16 v[36:39], a[160:163], a[32:35], v[36:39]
  v_mfma_f32_16x16x32_bf16 v[36:39], a[164:167], a[40:43], v[36:39]
  buffer_load_dwordx4 a[24:27], v243, s[36:39], s50 offen offset:2048 sc1
  ds_read_b64_tr_b16 a[144:145], v233 offset:49152
  v_mfma_f32_16x16x32_bf16 v[40:43], a[164:167], a[44:47], v[40:43]
  ds_read_b64_tr_b16 a[146:147], v233 offset:51200
  v_mfma_f32_16x16x32_bf16 v[40:43], a[160:163], a[36:39], v[40:43]
  s_waitcnt lgkmcnt(15)
  ds_read_b64_tr_b16 a[148:149], v233 offset:53248
  v_mfma_f32_16x16x32_bf16 v[48:51], a[168:171], a[36:39], v[48:51]
  ds_read_b64_tr_b16 a[150:151], v233 offset:55296
  v_mfma_f32_16x16x32_bf16 v[48:51], a[172:175], a[44:47], v[48:51]
  buffer_load_dwordx4 a[28:31], v243, s[36:39], s50 offen offset:3072 sc1
  v_mfma_f32_16x16x32_bf16 v[44:47], a[172:175], a[40:43], v[44:47]
  ds_read_b64_tr_b16 a[152:153], v234 offset:49152
  v_mfma_f32_16x16x32_bf16 v[44:47], a[168:171], a[32:35], v[44:47]
  s_waitcnt vmcnt(12) lgkmcnt(15)
  ds_read_b64_tr_b16 a[154:155], v234 offset:51200
  v_mfma_f32_16x16x32_bf16 v[20:23], a[176:179], a[48:51], v[20:23]
  s_add_u32 s50, s50, 4096
  s_and_b32 s50, s50, 0xffff
  ds_read_b64_tr_b16 a[156:157], v234 offset:53248
  v_mfma_f32_16x16x32_bf16 v[20:23], a[180:183], a[56:59], v[20:23]
  buffer_load_dwordx4 a[32:35], v243, s[36:39], s50 offen offset:0 sc1
  v_mfma_f32_16x16x32_bf16 v[24:27], a[180:183], a[60:63], v[24:27]
  ds_read_b64_tr_b16 a[158:159], v234 offset:55296
  v_mfma_f32_16x16x32_bf16 v[24:27], a[176:179], a[52:55], v[24:27]
  s_waitcnt lgkmcnt(15)
  ds_read_b64_tr_b16 a[160:161], v231 offset:57344
  v_mfma_f32_16x16x32_bf16 v[32:35], a[184:187], a[52:55], v[32:35]
  ds_read_b64_tr_b16 a[162:163], v231 offset:59392
  v_mfma_f32_16x16x32_bf16 v[32:35], a[188:191], a[60:63], v[32:35]
  buffer_load_dwordx4 a[36:39], v243, s[36:39], s50 offen offset:1024 sc1
  ds_read_b64_tr_b16 a[164:165], v231 offset:61440
  v_mfma_f32_16x16x32_bf16 v[28:31], a[188:191], a[56:59], v[28:31]
  v_mfma_f32_16x16x32_bf16 v[28:31], a[184:187], a[48:51], v[28:31]
  s_waitcnt lgkmcnt(15)
  ds_read_b64_tr_b16 a[166:167], v231 offset:63488
  v_mfma_f32_16x16x32_bf16 v[36:39], a[192:195], a[48:51], v[36:39]
  ds_read_b64_tr_b16 a[168:169], v232 offset:57344
  v_mfma_f32_16x16x32_bf16 v[36:39], a[196:199], a[56:59], v[36:39]
  buffer_load_dwordx4 a[40:43], v243, s[36:39], s50 offen offset:2048 sc1
  ds_read_b64_tr_b16 a[170:171], v232 offset:59392
  v_mfma_f32_16x16x32_bf16 v[40:43], a[196:199], a[60:63], v[40:43]
  v_mfma_f32_16x16x32_bf16 v[40:43], a[192:195], a[52:55], v[40:43]
  s_waitcnt lgkmcnt(15)
  ds_read_b64_tr_b16 a[172:173], v232 offset:61440
  v_mfma_f32_16x16x32_bf16 v[48:51], a[200:203], a[52:55], v[48:51]
  ds_read_b64_tr_b16 a[174:175], v232 offset:63488
  v_mfma_f32_16x16x32_bf16 v[48:51], a[204:207], a[60:63], v[48:51]
  buffer_load_dwordx4 a[44:47], v243, s[36:39], s50 offen offset:3072 sc1
  ds_read_b64_tr_b16 a[176:177], v233 offset:57344
  v_mfma_f32_16x16x32_bf16 v[44:47], a[204:207], a[56:59], v[44:47]
  ds_read_b64_tr_b16 a[178:179], v233 offset:59392
  v_mfma_f32_16x16x32_bf16 v[44:47], a[200:203], a[48:51], v[44:47]
  s_waitcnt vmcnt(12) lgkmcnt(15)
  v_mfma_f32_16x16x32_bf16 v[20:23], a[208:211], a[64:67], v[20:23]
  s_add_u32 s50, s50, 4096
  s_and_b32 s50, s50, 0xffff
  ds_read_b64_tr_b16 a[180:181], v233 offset:61440
  v_mfma_f32_16x16x32_bf16 v[20:23], a[212:215], a[72:75], v[20:23]
  buffer_load_dwordx4 a[48:51], v243, s[36:39], s50 offen offset:0 sc1
  ds_read_b64_tr_b16 a[182:183], v233 offset:63488
  v_mfma_f32_16x16x32_bf16 v[24:27], a[212:215], a[76:79], v[24:27]
  ds_read_b64_tr_b16 a[184:185], v234 offset:57344
  v_mfma_f32_16x16x32_bf16 v[24:27], a[208:211], a[68:71], v[24:27]
  s_waitcnt lgkmcnt(15)
  ds_read_b64_tr_b16 a[186:187], v234 offset:59392
  v_mfma_f32_16x16x32_bf16 v[32:35], a[216:219], a[68:71], v[32:35]
  v_mfma_f32_16x16x32_bf16 v[32:35], a[220:223], a[76:79], v[32:35]
  buffer_load_dwordx4 a[52:55], v243, s[36:39], s50 offen offset:1024 sc1
  ds_read_b64_tr_b16 a[188:189], v234 offset:61440
  v_mfma_f32_16x16x32_bf16 v[28:31], a[220:223], a[72:75], v[28:31]
  ds_read_b64_tr_b16 a[190:191], v234 offset:63488
  v_mfma_f32_16x16x32_bf16 v[28:31], a[216:219], a[64:67], v[28:31]
  s_waitcnt lgkmcnt(15)
  ds_read_b64_tr_b16 a[192:193], v235 offset:0
  v_mfma_f32_16x16x32_bf16 v[36:39], a[80:83], a[64:67], v[36:39]
  v_mfma_f32_16x16x32_bf16 v[36:39], a[84:87], a[72:75], v[36:39]
  buffer_load_dwordx4 a[56:59], v243, s[36:39], s50 offen offset:2048 sc1
  ds_read_b64_tr_b16 a[194:195], v235 offset:2048
  v_mfma_f32_16x16x32_bf16 v[40:43], a[84:87], a[76:79], v[40:43]
  ds_read_b64_tr_b16 a[196:197], v235 offset:4096
  v_mfma_f32_16x16x32_bf16 v[40:43], a[80:83], a[68:71], v[40:43]
  s_waitcnt lgkmcnt(15)
  ds_read_b64_tr_b16 a[198:199], v235 offset:6144
  v_mfma_f32_16x16x32_bf16 v[48:51], a[88:91], a[68:71], v[48:51]
  ds_read_b64_tr_b16 a[200:201], v236 offset:0
  v_mfma_f32_16x16x32_bf16 v[48:51], a[92:95], a[76:79], v[48:51]
  buffer_load_dwordx4 a[60:63], v243, s[36:39], s50 offen offset:3072 sc1
  v_mfma_f32_16x16x32_bf16 v[44:47], a[92:95], a[72:75], v[44:47]
  ds_read_b64_tr_b16 a[202:203], v236 offset:2048
  v_mfma_f32_16x16x32_bf16 v[44:47], a[88:91], a[64:67], v[44:47]
  s_waitcnt vmcnt(12) lgkmcnt(15)
  ds_read_b64_tr_b16 a[204:205], v236 offset:4096
  v_mfma_f32_16x16x32_bf16 v[20:23], a[96:99], a[0:3], v[20:23]
  s_add_u32 s50, s50, 4096
  s_and_b32 s50, s50, 0xffff
  ds_read_b64_tr_b16 a[206:207], v236 offset:6144
  v_mfma_f32_16x16x32_bf16 v[20:23], a[100:103], a[8:11], v[20:23]
  buffer_load_dwordx4 a[64:67], v243, s[36:39], s50 offen offset:0 sc1
  v_mfma_f32_16x16x32_bf16 v[24:27], a[100:103], a[12:15], v[24:27]
  ds_read_b64_tr_b16 a[208:209], v237 offset:0
  v_mfma_f32_16x16x32_bf16 v[24:27], a[96:99], a[4:7], v[24:27]
  s_waitcnt lgkmcnt(15)
  ds_read_b64_tr_b16 a[210:211], v237 offset:2048
  v_mfma_f32_16x16x32_bf16 v[32:35], a[104:107], a[4:7], v[32:35]
  ds_read_b64_tr_b16 a[212:213], v237 offset:4096
  v_mfma_f32_16x16x32_bf16 v[32:35], a[108:111], a[12:15], v[32:35]
  buffer_load_dwordx4 a[68:71], v243, s[36:39], s50 offen offset:1024 sc1
  ds_read_b64_tr_b16 a[214:215], v237 offset:6144
  v_mfma_f32_16x16x32_bf16 v[28:31], a[108:111], a[8:11], v[28:31]
  v_mfma_f32_16x16x32_bf16 v[28:31], a[104:107], a[0:3], v[28:31]
  s_waitcnt lgkmcnt(15)
  ds_read_b64_tr_b16 a[216:217], v238 offset:0
  v_mfma_f32_16x16x32_bf16 v[36:39], a[112:115], a[0:3], v[36:39]
  s_waitcnt vmcnt(23)
  ds_read_b64_tr_b16 a[218:219], v238 offset:2048
  v_max_u32 v15, v156, v157
  v_mfma_f32_16x16x32_bf16 v[36:39], a[116:119], a[8:11], v[36:39]
  buffer_load_dwordx4 a[72:75], v243, s[36:39], s50 offen offset:2048 sc1
  ds_read_b64_tr_b16 a[220:221], v238 offset:4096
  v_mfma_f32_16x16x32_bf16 v[40:43], a[116:119], a[12:15], v[40:43]
  v_max3_u32 v15, v15, v158, v159
  v_max3_u32 v15, v15, v160, v161
  v_mfma_f32_16x16x32_bf16 v[40:43], a[112:115], a[4:7], v[40:43]
  s_waitcnt lgkmcnt(15)
  ds_read_b64_tr_b16 a[222:223], v238 offset:6144
  v_max3_u32 v15, v15, v162, v163
  v_mfma_f32_16x16x32_bf16 v[48:51], a[120:123], a[4:7], v[48:51]
  ds_read_b64_tr_b16 a[80:81], v235 offset:8192
  v_max3_u32 v15, v15, v164, v165
  v_mfma_f32_16x16x32_bf16 v[48:51], a[124:127], a[12:15], v[48:51]
  buffer_load_dwordx4 a[76:79], v243, s[36:39], s50 offen offset:3072 sc1
  ds_read_b64_tr_b16 a[82:83], v235 offset:10240
  v_mfma_f32_16x16x32_bf16 v[44:47], a[124:127], a[8:11], v[44:47]
  ds_read_b64_tr_b16 a[84:85], v235 offset:12288
  v_max3_u32 v15, v15, v166, v167
  v_mfma_f32_16x16x32_bf16 v[44:47], a[120:123], a[0:3], v[44:47]
  s_waitcnt vmcnt(12) lgkmcnt(15)
  v_max3_u32 v15, v15, v168, v169
  v_max3_u32 v15, v15, v170, v171
  v_mfma_f32_16x16x32_bf16 v[20:23], a[128:131], a[16:19], v[20:23]
  s_add_u32 s50, s50, 4096
  s_and_b32 s50, s50, 0xffff
  ds_read_b64_tr_b16 a[86:87], v235 offset:14336
  v_mfma_f32_16x16x32_bf16 v[20:23], a[132:135], a[24:27], v[20:23]
  buffer_load_dwordx4 a[0:3], v243, s[36:39], s50 offen offset:0 sc1
  ds_read_b64_tr_b16 a[88:89], v236 offset:8192
  v_mfma_f32_16x16x32_bf16 v[24:27], a[132:135], a[28:31], v[24:27]
  ds_read_b64_tr_b16 a[90:91], v236 offset:10240
  v_mfma_f32_16x16x32_bf16 v[24:27], a[128:131], a[20:23], v[24:27]
  s_waitcnt lgkmcnt(15)
  v_cmp_eq_u32 vcc, -1, v15
  s_nop 4
  s_cbranch_vccnz CK3s
CK3x:
  v_mfma_f32_16x16x32_bf16 v[32:35], a[136:139], a[20:23], v[32:35]
  ds_read_b64_tr_b16 a[92:93], v236 offset:12288
  v_add_f32 v156, v156, v164
  v_mfma_f32_16x16x32_bf16 v[32:35], a[140:143], a[28:31], v[32:35]
  buffer_load_dwordx4 a[4:7], v243, s[36:39], s50 offen offset:1024 sc1
  ds_read_b64_tr_b16 a[94:95], v236 offset:14336
  v_mfma_f32_16x16x32_bf16 v[28:31], a[140:143], a[24:27], v[28:31]
Ha2_1:
  s_cbranch_execz Ra
  ds_read_b64_tr_b16 a[96:97], v237 offset:8192
  v_add_f32 v157, v157, v165
  v_mfma_f32_16x16x32_bf16 v[28:31], a[136:139], a[16:19], v[28:31]
  s_waitcnt lgkmcnt(15)
  ds_read_b64_tr_b16 a[98:99], v237 offset:10240
  v_add_f32 v158, v158, v166
  v_mfma_f32_16x16x32_bf16 v[36:39], a[144:147], a[16:19], v[36:39]
  v_add_f32 v159, v159, v167
  v_add_f32 v160, v160, v168
  v_mfma_f32_16x16x32_bf16 v[36:39], a[148:151], a[24:27], v[36:39]
  buffer_load_dwordx4 a[8:11], v243, s[36:39], s50 offen offset:2048 sc1
  ds_read_b64_tr_b16 a[100:101], v237 offset:12288
  v_mfma_f32_16x16x32_bf16 v[40:43], a[148:151], a[28:31], v[40:43]
  ds_read_b64_tr_b16 a[102:103], v237 offset:14336
  v_add_f32 v161, v161, v169
  v_mfma_f32_16x16x32_bf16 v[40:43], a[144:147], a[20:23], v[40:43]
  s_waitcnt lgkmcnt(15)
  ds_read_b64_tr_b16 a[104:105], v238 offset:8192
  v_add_f32 v162, v162, v170
  v_mfma_f32_16x16x32_bf16 v[48:51], a[152:155], a[20:23], v[48:51]
  v_add_f32 v163, v163, v171
  v_add_f32 v156, v156, v160
  v_mfma_f32_16x16x32_bf16 v[48:51], a[156:159], a[28:31], v[48:51]
  buffer_load_dwordx4 a[12:15], v243, s[36:39], s50 offen offset:3072 sc1
  ds_read_b64_tr_b16 a[106:107], v238 offset:10240
  v_mfma_f32_16x16x32_bf16 v[44:47], a[156:159], a[24:27], v[44:47]
  ds_read_b64_tr_b16 a[108:109], v238 offset:12288
  v_add_f32 v157, v157, v161
  v_mfma_f32_16x16x32_bf16 v[44:47], a[152:155], a[16:19], v[44:47]
  s_waitcnt vmcnt(12) lgkmcnt(15)
  ds_read_b64_tr_b16 a[110:111], v238 offset:14336
  v_add_f32 v158, v158, v162
  v_mfma_f32_16x16x32_bf16 v[20:23], a[160:163], a[32:35], v[20:23]
  s_add_u32 s50, s50, 4096
  s_and_b32 s50, s50, 0xffff
  ds_read_b64_tr_b16 a[112:113], v235 offset:16384
  v_mfma_f32_16x16x32_bf16 v[20:23], a[164:167], a[40:43], v[20:23]
  buffer_load_dwordx4 a[16:19], v243, s[36:39], s50 offen offset:0 sc1
  v_add_f32 v159, v159, v163
  v_mfma_f32_16x16x32_bf16 v[24:27], a[164:167], a[44:47], v[24:27]
  ds_read_b64_tr_b16 a[114:115], v235 offset:18432
  v_cvt_pk_bf16_f32 v160, v156, v157
  v_mfma_f32_16x16x32_bf16 v[24:27], a[160:163], a[36:39], v[24:27]
  s_waitcnt lgkmcnt(15)
  ds_read_b64_tr_b16 a[116:117], v235 offset:20480
  v_lshlrev_b32 v156, 16, v160
  v_mfma_f32_16x16x32_bf16 v[32:35], a[168:171], a[36:39], v[32:35]
  ds_read_b64_tr_b16 a[118:119], v235 offset:22528
  v_and_b32 v157, 0xffff0000, v160
  v_mfma_f32_16x16x32_bf16 v[32:35], a[172:175], a[44:47], v[32:35]
  buffer_load_dwordx4 a[20:23], v243, s[36:39], s50 offen offset:1024 sc1
  v_cvt_pk_bf16_f32 v161, v158, v159
  v_mfma_f32_16x16x32_bf16 v[28:31], a[172:175], a[40:43], v[28:31]
  ds_read_b64_tr_b16 a[120:121], v236 offset:16384
  v_lshlrev_b32 v158, 16, v161
  v_mfma_f32_16x16x32_bf16 v[28:31], a[168:171], a[32:35], v[28:31]
  s_waitcnt lgkmcnt(15)
  ds_read_b64_tr_b16 a[122:123], v236 offset:18432
  v_and_b32 v159, 0xffff0000, v161
  v_mfma_f32_16x16x32_bf16 v[36:39], a[176:179], a[32:35], v[36:39]
  ds_read_b64_tr_b16 a[124:125], v236 offset:20480
  v_add_f32 v156, v13, v156
  v_mfma_f32_16x16x32_bf16 v[36:39], a[180:183], a[40:43], v[36:39]
  buffer_load_dwordx4 a[24:27], v243, s[36:39], s50 offen offset:2048 sc1
  ds_read_b64_tr_b16 a[126:127], v236 offset:22528
  v_mfma_f32_16x16x32_bf16 v[40:43], a[180:183], a[44:47], v[40:43]
  v_add_f32 v157, v13, v157
  v_add_f32 v158, v13, v158
  v_mfma_f32_16x16x32_bf16 v[40:43], a[176:179], a[36:39], v[40:43]
  s_waitcnt lgkmcnt(15)
  ds_read_b64_tr_b16 a[128:129], v237 offset:16384
  v_add_f32 v159, v13, v159
  v_mfma_f32_16x16x32_bf16 v[48:51], a[184:187], a[36:39], v[48:51]
  ds_read_b64_tr_b16 a[130:131], v237 offset:18432
  v_cvt_pk_bf16_f32 v160, v156, v157
  v_mfma_f32_16x16x32_bf16 v[48:51], a[188:191], a[44:47], v[48:51]
  buffer_load_dwordx4 a[28:31], v243, s[36:39], s50 offen offset:3072 sc1
  ds_read_b64_tr_b16 a[132:133], v237 offset:20480
  v_mfma_f32_16x16x32_bf16 v[44:47], a[188:191], a[40:43], v[44:47]
  ds_read_b64_tr_b16 a[134:135], v237 offset:22528
  v_lshlrev_b32 v156, 16, v160
  v_mfma_f32_16x16x32_bf16 v[44:47], a[184:187], a[32:35], v[44:47]
  s_waitcnt vmcnt(12) lgkmcnt(15)
  v_and_b32 v157, 0xffff0000, v160
  v_cvt_pk_bf16_f32 v161, v158, v159
  v_mfma_f32_16x16x32_bf16 v[20:23], a[192:195], a[48:51], v[20:23]
  s_add_u32 s50, s50, 4096
  s_and_b32 s50, s50, 0xffff
  ds_read_b64_tr_b16 a[136:137], v238 offset:16384
  v_mfma_f32_16x16x32_bf16 v[20:23], a[196:199], a[56:59], v[20:23]
  buffer_load_dwordx4 a[32:35], v243, s[36:39], s50 offen offset:0 sc1
  ds_read_b64_tr_b16 a[138:139], v238 offset:18432
  v_mfma_f32_16x16x32_bf16 v[24:27], a[196:199], a[60:63], v[24:27]
  ds_read_b64_tr_b16 a[140:141], v238 offset:20480
  v_lshlrev_b32 v158, 16, v161
  v_mfma_f32_16x16x32_bf16 v[24:27], a[192:195], a[52:55], v[24:27]
  s_waitcnt lgkmcnt(15)
  v_and_b32 v159, 0xffff0000, v161
  v_mfma_f32_16x16x32_bf16 v[32:35], a[200:203], a[52:55], v[32:35]
  ds_write_b128 v246, v[156:159]
  ds_read_b128 v[84:87], v244 offset:0
  v_mfma_f32_16x16x32_bf16 v[32:35], a[204:207], a[60:63], v[32:35]
  ds_read_b128 v[100:103], v244 offset:512
  ds_read_b128 v[88:91], v244 offset:64
  v_mfma_f32_16x16x32_bf16 v[28:31], a[204:207], a[56:59], v[28:31]
  ds_read_b128 v[104:107], v244 offset:576
  ds_read_b128 v[92:95], v244 offset:128
  v_mfma_f32_16x16x32_bf16 v[28:31], a[200:203], a[48:51], v[28:31]
  s_waitcnt lgkmcnt(15)
  ds_read_b128 v[108:111], v244 offset:640
  ds_read_b128 v[96:99], v244 offset:192
  v_mfma_f32_16x16x32_bf16 v[36:39], a[208:211], a[48:51], v[36:39]
  ds_read_b128 v[112:115], v244 offset:704
  ds_read_b128 v[116:119], v245 offset:512
  v_mfma_f32_16x16x32_bf16 v[36:39], a[212:215], a[56:59], v[36:39]
  ds_read_b128 v[120:123], v245 offset:576
  ds_read_b128 v[124:127], v245 offset:640
  v_mfma_f32_16x16x32_bf16 v[40:43], a[212:215], a[60:63], v[40:43]
  ds_read_b128 v[128:131], v245 offset:704
  ds_read_b64_tr_b16 a[142:143], v238 offset:22528
  v_mfma_f32_16x16x32_bf16 v[40:43], a[208:211], a[52:55], v[40:43]
  s_waitcnt lgkmcnt(15)
  buffer_load_dwordx4 a[36:39], v243, s[36:39], s50 offen offset:1024 sc1
  ds_read_b64_tr_b16 a[144:145], v235 offset:24576
  v_mfma_f32_16x16x32_bf16 v[48:51], a[216:219], a[52:55], v[48:51]
  ds_read_b64_tr_b16 a[146:147], v235 offset:26624
  ds_read_b64_tr_b16 a[148:149], v235 offset:28672
  v_mfma_f32_16x16x32_bf16 v[48:51], a[220:223], a[60:63], v[48:51]
  buffer_load_dwordx4 a[40:43], v243, s[36:39], s50 offen offset:2048 sc1
  ds_read_b64_tr_b16 a[150:151], v235 offset:30720
  v_mfma_f32_16x16x32_bf16 v[44:47], a[220:223], a[56:59], v[44:47]
  ds_read_b64_tr_b16 a[152:153], v236 offset:24576
  ds_read_b64_tr_b16 a[154:155], v236 offset:26624
  v_mfma_f32_16x16x32_bf16 v[44:47], a[216:219], a[48:51], v[44:47]
  s_waitcnt vmcnt(11) lgkmcnt(15)
  buffer_load_dwordx4 a[44:47], v243, s[36:39], s50 offen offset:3072 sc1
  ds_read_b64_tr_b16 a[156:157], v236 offset:28672
  v_mfma_f32_16x16x32_bf16 v[20:23], a[80:83], a[64:67], v[20:23]
  s_add_u32 s50, s50, 4096
  ds_read_b64_tr_b16 a[158:159], v236 offset:30720
  ds_read_b64_tr_b16 a[160:161], v237 offset:24576
  v_mfma_f32_16x16x32_bf16 v[20:23], a[84:87], a[72:75], v[20:23]
  s_and_b32 s50, s50, 0xffff
  ds_read_b64_tr_b16 a[162:163], v237 offset:26624
  buffer_load_dwordx4 a[48:51], v243, s[36:39], s50 offen offset:0 sc1
  v_mfma_f32_16x16x32_bf16 v[24:27], a[84:87], a[76:79], v[24:27]
  ds_read_b64_tr_b16 a[164:165], v237 offset:28672
  v_accvgpr_write_b32 a248, v156
  v_mfma_f32_16x16x32_bf16 v[24:27], a[80:83], a[68:71], v[24:27]
  s_waitcnt lgkmcnt(15)
  ds_read_b64_tr_b16 a[166:167], v237 offset:30720
  v_accvgpr_write_b32 a249, v157
  v_mfma_f32_16x16x32_bf16 v[32:35], a[88:91], a[68:71], v[32:35]
  ds_read_b64_tr_b16 a[168:169], v238 offset:24576
  v_accvgpr_write_b32 a250, v158
  v_mfma_f32_16x16x32_bf16 v[32:35], a[92:95], a[76:79], v[32:35]
  buffer_load_dwordx4 a[52:55], v243, s[36:39], s50 offen offset:1024 sc1
  v_accvgpr_write_b32 a251, v159
  v_mfma_f32_16x16x32_bf16 v[28:31], a[92:95], a[72:75], v[28:31]
  s_waitcnt lgkmcnt(14)
  ds_read_b64_tr_b16 a[170:171], v238 offset:26624
  v_cvt_pk_bf16_f32 v148, v116, v117
  v_mfma_f32_16x16x32_bf16 v[28:31], a[88:91], a[64:67], v[28:31]
  s_waitcnt lgkmcnt(15)
  ds_read_b64_tr_b16 a[172:173], v238 offset:28672
  v_cvt_pk_bf16_f32 v149, v118, v119
  v_mfma_f32_16x16x32_bf16 v[36:39], a[96:99], a[64:67], v[36:39]
  ds_read_b64_tr_b16 a[174:175], v238 offset:30720
  v_cvt_pk_bf16_f32 v150, v120, v121
  v_mfma_f32_16x16x32_bf16 v[36:39], a[100:103], a[72:75], v[36:39]
  buffer_load_dwordx4 a[56:59], v243, s[36:39], s50 offen offset:2048 sc1
  ds_read_b64_tr_b16 a[176:177], v235 offset:32768
  v_mfma_f32_16x16x32_bf16 v[40:43], a[100:103], a[76:79], v[40:43]
  v_cvt_pk_bf16_f32 v151, v122, v123
  v_cvt_pk_bf16_f32 v152, v124, v125
  v_mfma_f32_16x16x32_bf16 v[40:43], a[96:99], a[68:71], v[40:43]
  s_waitcnt lgkmcnt(15)
  ds_read_b64_tr_b16 a[178:179], v235 offset:34816
  v_cvt_pk_bf16_f32 v153, v126, v127
  v_mfma_f32_16x16x32_bf16 v[48:51], a[104:107], a[68:71], v[48:51]
  ds_read_b64_tr_b16 a[180:181], v235 offset:36864
  v_cvt_pk_bf16_f32 v154, v128, v129
  v_mfma_f32_16x16x32_bf16 v[48:51], a[108:111], a[76:79], v[48:51]
  buffer_load_dwordx4 a[60:63], v243, s[36:39], s50 offen offset:3072 sc1
  ds_read_b64_tr_b16 a[182:183], v235 offset:38912
  v_mfma_f32_16x16x32_bf16 v[44:47], a[108:111], a[72:75], v[44:47]
  v_cvt_pk_bf16_f32 v155, v130, v131
  v_mfma_f32_16x16x32_bf16 v[44:47], a[104:107], a[64:67], v[44:47]
  s_waitcnt vmcnt(12) lgkmcnt(15)
  buffer_store_dwordx4 v[148:151], v0, s[36:39], s78 offen offset:0 sc1
  buffer_store_dwordx4 v[152:155], v0, s[36:39], s78 offen offset:1024 sc1
  v_mfma_f32_16x16x32_bf16 v[20:23], a[112:115], a[0:3], v[20:23]
  s_add_u32 s50, s50, 4096
  ds_read_b64_tr_b16 a[184:185], v236 offset:32768
  s_and_b32 s50, s50, 0xffff
  v_mfma_f32_16x16x32_bf16 v[20:23], a[116:119], a[8:11], v[20:23]
  ds_read_b64_tr_b16 a[186:187], v236 offset:34816
  buffer_load_dwordx4 a[64:67], v243, s[36:39], s50 offen offset:0 sc1
  v_mfma_f32_16x16x32_bf16 v[24:27], a[116:119], a[12:15], v[24:27]
  ds_read_b64_tr_b16 a[188:189], v236 offset:36864
  ds_read_b64_tr_b16 a[190:191], v236 offset:38912
  v_mfma_f32_16x16x32_bf16 v[24:27], a[112:115], a[4:7], v[24:27]
  s_waitcnt lgkmcnt(15)
  v_mfma_f32_16x16x32_bf16 v[32:35], a[120:123], a[4:7], v[32:35]
  ds_read_b64_tr_b16 a[192:193], v237 offset:32768
  v_mfma_f32_16x16x32_bf16 v[32:35], a[124:127], a[12:15], v[32:35]
  buffer_load_dwordx4 a[68:71], v243, s[36:39], s50 offen offset:1024 sc1
  ds_read_b64_tr_b16 a[194:195], v237 offset:34816
  v_mfma_f32_16x16x32_bf16 v[28:31], a[124:127], a[8:11], v[28:31]
  ds_read_b64_tr_b16 a[196:197], v237 offset:36864
  v_mfma_f32_16x16x32_bf16 v[28:31], a[120:123], a[0:3], v[28:31]
  s_waitcnt lgkmcnt(15)
  v_mfma_f32_16x16x32_bf16 v[36:39], a[128:131], a[0:3], v[36:39]
  ds_read_b64_tr_b16 a[198:199], v237 offset:38912
  v_mfma_f32_16x16x32_bf16 v[36:39], a[132:135], a[8:11], v[36:39]
  buffer_load_dwordx4 a[72:75], v243, s[36:39], s50 offen offset:2048 sc1
  ds_read_b64_tr_b16 a[200:201], v238 offset:32768
  v_mfma_f32_16x16x32_bf16 v[40:43], a[132:135], a[12:15], v[40:43]
  ds_read_b64_tr_b16 a[202:203], v238 offset:34816
  v_mfma_f32_16x16x32_bf16 v[40:43], a[128:131], a[4:7], v[40:43]
  s_waitcnt lgkmcnt(15)
  ds_read_b64_tr_b16 a[204:205], v238 offset:36864
  v_mfma_f32_16x16x32_bf16 v[48:51], a[136:139], a[4:7], v[48:51]
  v_mfma_f32_16x16x32_bf16 v[48:51], a[140:143], a[12:15], v[48:51]
  buffer_load_dwordx4 a[76:79], v243, s[36:39], s50 offen offset:3072 sc1
  ds_read_b64_tr_b16 a[206:207], v238 offset:38912
  v_mfma_f32_16x16x32_bf16 v[44:47], a[140:143], a[8:11], v[44:47]
  ds_read_b64_tr_b16 a[208:209], v235 offset:40960
  v_mfma_f32_16x16x32_bf16 v[44:47], a[136:139], a[0:3], v[44:47]
  s_waitcnt vmcnt(14) lgkmcnt(15)
  ds_read_b64_tr_b16 a[210:211], v235 offset:43008
  v_mfma_f32_16x16x32_bf16 v[20:23], a[144:147], a[16:19], v[20:23]
  s_add_u32 s50, s50, 4096
  s_and_b32 s50, s50, 0xffff
  v_mfma_f32_16x16x32_bf16 v[20:23], a[148:151], a[24:27], v[20:23]
  buffer_load_dwordx4 a[0:3], v243, s[36:39], s50 offen offset:0 sc1
  ds_read_b64_tr_b16 a[212:213], v235 offset:45056
  v_mfma_f32_16x16x32_bf16 v[24:27], a[148:151], a[28:31], v[24:27]
  ds_read_b64_tr_b16 a[214:215], v235 offset:47104
  v_mfma_f32_16x16x32_bf16 v[24:27], a[144:147], a[20:23], v[24:27]
  s_waitcnt lgkmcnt(15)
  ds_read_b64_tr_b16 a[216:217], v236 offset:40960
  v_mfma_f32_16x16x32_bf16 v[32:35], a[152:155], a[20:23], v[32:35]
  ds_read_b64_tr_b16 a[218:219], v236 offset:43008
  v_mfma_f32_16x16x32_bf16 v[32:35], a[156:159], a[28:31], v[32:35]
  buffer_load_dwordx4 a[4:7], v243, s[36:39], s50 offen offset:1024 sc1
  v_mfma_f32_16x16x32_bf16 v[28:31], a[156:159], a[24:27], v[28:31]
  ds_read_b64_tr_b16 a[220:221], v236 offset:45056
  v_mfma_f32_16x16x32_bf16 v[28:31], a[152:155], a[16:19], v[28:31]
  s_waitcnt lgkmcnt(15)
  ds_read_b64_tr_b16 a[222:223], v236 offset:47104
  v_mfma_f32_16x16x32_bf16 v[36:39], a[160:163], a[16:19], v[36:39]
  ds_read_b64_tr_b16 a[80:81], v237 offset:40960
  v_mfma_f32_16x16x32_bf16 v[36:39], a[164:167], a[24:27], v[36:39]
  buffer_load_dwordx4 a[8:11], v243, s[36:39], s50 offen offset:2048 sc1
  ds_read_b64_tr_b16 a[82:83], v237 offset:43008
  v_mfma_f32_16x16x32_bf16 v[40:43], a[164:167], a[28:31], v[40:43]
  v_mfma_f32_16x16x32_bf16 v[40:43], a[160:163], a[20:23], v[40:43]
  s_waitcnt lgkmcnt(15)
  ds_read_b64_tr_b16 a[84:85], v237 offset:45056
  v_mfma_f32_16x16x32_bf16 v[48:51], a[168:171], a[20:23], v[48:51]
  ds_read_b64_tr_b16 a[86:87], v237 offset:47104
  v_mfma_f32_16x16x32_bf16 v[48:51], a[172:175], a[28:31], v[48:51]
  buffer_load_dwordx4 a[12:15], v243, s[36:39], s50 offen offset:3072 sc1
  ds_read_b64_tr_b16 a[88:89], v238 offset:40960
  v_mfma_f32_16x16x32_bf16 v[44:47], a[172:175], a[24:27], v[44:47]
  v_mfma_f32_16x16x32_bf16 v[44:47], a[168:171], a[16:19], v[44:47]
  s_waitcnt vmcnt(14) lgkmcnt(15)
  ds_read_b64_tr_b16 a[90:91], v238 offset:43008
  v_mfma_f32_16x16x32_bf16 v[20:23], a[176:179], a[32:35], v[20:23]
  ds_read_b64_tr_b16 a[92:93], v238 offset:45056
  v_mfma_f32_16x16x32_bf16 v[20:23], a[180:183], a[40:43], v[20:23]
  ds_read_b64_tr_b16 a[94:95], v238 offset:47104
  v_mfma_f32_16x16x32_bf16 v[24:27], a[180:183], a[44:47], v[24:27]
  ds_read_b64_tr_b16 a[96:97], v235 offset:49152
  v_mfma_f32_16x16x32_bf16 v[24:27], a[176:179], a[36:39], v[24:27]
  s_waitcnt lgkmcnt(15)
  v_mfma_f32_16x16x32_bf16 v[32:35], a[184:187], a[36:39], v[32:35]
  ds_read_b64_tr_b16 a[98:99], v235 offset:51200
  v_mfma_f32_16x16x32_bf16 v[32:35], a[188:191], a[44:47], v[32:35]
  ds_read_b64_tr_b16 a[100:101], v235 offset:53248
  v_mfma_f32_16x16x32_bf16 v[28:31], a[188:191], a[40:43], v[28:31]
  ds_read_b64_tr_b16 a[102:103], v235 offset:55296
  v_mfma_f32_16x16x32_bf16 v[28:31], a[184:187], a[32:35], v[28:31]
  s_waitcnt lgkmcnt(15)
  v_mfma_f32_16x16x32_bf16 v[36:39], a[192:195], a[32:35], v[36:39]
  ds_read_b64_tr_b16 a[104:105], v236 offset:49152
  v_mfma_f32_16x16x32_bf16 v[36:39], a[196:199], a[40:43], v[36:39]
  ds_read_b64_tr_b16 a[106:107], v236 offset:51200
  v_mfma_f32_16x16x32_bf16 v[40:43], a[196:199], a[44:47], v[40:43]
  ds_read_b64_tr_b16 a[108:109], v236 offset:53248
  v_mfma_f32_16x16x32_bf16 v[40:43], a[192:195], a[36:39], v[40:43]
  s_waitcnt lgkmcnt(15)
  ds_read_b64_tr_b16 a[110:111], v236 offset:55296
  v_mfma_f32_16x16x32_bf16 v[48:51], a[200:203], a[36:39], v[48:51]
  v_mfma_f32_16x16x32_bf16 v[48:51], a[204:207], a[44:47], v[48:51]
  ds_read_b64_tr_b16 a[112:113], v237 offset:49152
  v_mfma_f32_16x16x32_bf16 v[44:47], a[204:207], a[40:43], v[44:47]
  ds_read_b64_tr_b16 a[114:115], v237 offset:51200
  v_mfma_f32_16x16x32_bf16 v[44:47], a[200:203], a[32:35], v[44:47]
  s_waitcnt vmcnt(10) lgkmcnt(15)
  ds_read_b64_tr_b16 a[116:117], v237 offset:53248
  v_mfma_f32_16x16x32_bf16 v[20:23], a[208:211], a[48:51], v[20:23]
  v_mfma_f32_16x16x32_bf16 v[20:23], a[212:215], a[56:59], v[20:23]
  ds_read_b64_tr_b16 a[118:119], v237 offset:55296
  v_mfma_f32_16x16x32_bf16 v[24:27], a[212:215], a[60:63], v[24:27]
  ds_read_b64_tr_b16 a[120:121], v238 offset:49152
  v_mfma_f32_16x16x32_bf16 v[24:27], a[208:211], a[52:55], v[24:27]
  s_waitcnt lgkmcnt(15)
  ds_read_b64_tr_b16 a[122:123], v238 offset:51200
  v_mfma_f32_16x16x32_bf16 v[32:35], a[216:219], a[52:55], v[32:35]
  ds_read_b64_tr_b16 a[124:125], v238 offset:53248
  v_mfma_f32_16x16x32_bf16 v[32:35], a[220:223], a[60:63], v[32:35]
  v_mfma_f32_16x16x32_bf16 v[28:31], a[220:223], a[56:59], v[28:31]
  ds_read_b64_tr_b16 a[126:127], v238 offset:55296
  v_mfma_f32_16x16x32_bf16 v[28:31], a[216:219], a[48:51], v[28:31]
  s_waitcnt lgkmcnt(15)
  ds_read_b64_tr_b16 a[128:129], v235 offset:57344
  v_mfma_f32_16x16x32_bf16 v[36:39], a[80:83], a[48:51], v[36:39]
  ds_read_b64_tr_b16 a[130:131], v235 offset:59392
  v_mfma_f32_16x16x32_bf16 v[36:39], a[84:87], a[56:59], v[36:39]
  v_mfma_f32_16x16x32_bf16 v[40:43], a[84:87], a[60:63], v[40:43]
  ds_read_b64_tr_b16 a[132:133], v235 offset:61440
  v_mfma_f32_16x16x32_bf16 v[40:43], a[80:83], a[52:55], v[40:43]
  s_waitcnt lgkmcnt(15)
  ds_read_b64_tr_b16 a[134:135], v235 offset:63488
  v_mfma_f32_16x16x32_bf16 v[48:51], a[88:91], a[52:55], v[48:51]
  ds_read_b64_tr_b16 a[136:137], v236 offset:57344
  v_mfma_f32_16x16x32_bf16 v[48:51], a[92:95], a[60:63], v[48:51]
  ds_read_b64_tr_b16 a[138:139], v236 offset:59392
  v_mfma_f32_16x16x32_bf16 v[44:47], a[92:95], a[56:59], v[44:47]
  v_mfma_f32_16x16x32_bf16 v[44:47], a[88:91], a[48:51], v[44:47]
  s_waitcnt vmcnt(4) lgkmcnt(15)
  ds_read_b64_tr_b16 a[140:141], v236 offset:61440
  v_mfma_f32_16x16x32_bf16 v[20:23], a[96:99], a[64:67], v[20:23]
  ds_read_b64_tr_b16 a[142:143], v236 offset:63488
  v_mfma_f32_16x16x32_bf16 v[20:23], a[100:103], a[72:75], v[20:23]
  ds_read_b64_tr_b16 a[144:145], v237 offset:57344
  v_mfma_f32_16x16x32_bf16 v[24:27], a[100:103], a[76:79], v[24:27]
  v_mfma_f32_16x16x32_bf16 v[24:27], a[96:99], a[68:71], v[24:27]
  s_waitcnt lgkmcnt(15)
  ds_read_b64_tr_b16 a[146:147], v237 offset:59392
  v_mfma_f32_16x16x32_bf16 v[32:35], a[104:107], a[68:71], v[32:35]
  ds_read_b64_tr_b16 a[148:149], v237 offset:61440
  v_mfma_f32_16x16x32_bf16 v[32:35], a[108:111], a[76:79], v[32:35]
  ds_read_b64_tr_b16 a[150:151], v237 offset:63488
  v_mfma_f32_16x16x32_bf16 v[28:31], a[108:111], a[72:75], v[28:31]
  ds_read_b64_tr_b16 a[152:153], v238 offset:57344
  v_mfma_f32_16x16x32_bf16 v[28:31], a[104:107], a[64:67], v[28:31]
  s_waitcnt lgkmcnt(15)
  v_mfma_f32_16x16x32_bf16 v[36:39], a[112:115], a[64:67], v[36:39]
  ds_read_b64_tr_b16 a[154:155], v238 offset:59392
  v_mfma_f32_16x16x32_bf16 v[36:39], a[116:119], a[72:75], v[36:39]
  ds_read_b64_tr_b16 a[156:157], v238 offset:61440
  v_mfma_f32_16x16x32_bf16 v[40:43], a[116:119], a[76:79], v[40:43]
  ds_read_b64_tr_b16 a[158:159], v238 offset:63488
  v_mfma_f32_16x16x32_bf16 v[40:43], a[112:115], a[68:71], v[40:43]
  s_waitcnt lgkmcnt(15)
  v_mfma_f32_16x16x32_bf16 v[48:51], a[120:123], a[68:71], v[48:51]
  v_mfma_f32_16x16x32_bf16 v[48:51], a[124:127], a[76:79], v[48:51]
  v_mfma_f32_16x16x32_bf16 v[44:47], a[124:127], a[72:75], v[44:47]
  v_mfma_f32_16x16x32_bf16 v[44:47], a[120:123], a[64:67], v[44:47]
  s_waitcnt vmcnt(0) lgkmcnt(12)
  v_mfma_f32_16x16x32_bf16 v[20:23], a[128:131], a[0:3], v[20:23]
  v_mfma_f32_16x16x32_bf16 v[20:23], a[132:135], a[8:11], v[20:23]
  v_mfma_f32_16x16x32_bf16 v[24:27], a[132:135], a[12:15], v[24:27]
  v_mfma_f32_16x16x32_bf16 v[24:27], a[128:131], a[4:7], v[24:27]
  s_waitcnt lgkmcnt(8)
  v_mfma_f32_16x16x32_bf16 v[32:35], a[136:139], a[4:7], v[32:35]
  v_mfma_f32_16x16x32_bf16 v[32:35], a[140:143], a[12:15], v[32:35]
  v_mfma_f32_16x16x32_bf16 v[28:31], a[140:143], a[8:11], v[28:31]
  v_mfma_f32_16x16x32_bf16 v[28:31], a[136:139], a[0:3], v[28:31]
  s_waitcnt lgkmcnt(4)
  v_mfma_f32_16x16x32_bf16 v[36:39], a[144:147], a[0:3], v[36:39]
  v_mfma_f32_16x16x32_bf16 v[36:39], a[148:151], a[8:11], v[36:39]
  v_mfma_f32_16x16x32_bf16 v[40:43], a[148:151], a[12:15], v[40:43]
  v_mfma_f32_16x16x32_bf16 v[40:43], a[144:147], a[4:7], v[40:43]
  s_waitcnt lgkmcnt(0)
  v_mfma_f32_16x16x32_bf16 v[48:51], a[152:155], a[4:7], v[48:51]
  v_mfma_f32_16x16x32_bf16 v[48:51], a[156:159], a[12:15], v[48:51]
  v_mfma_f32_16x16x32_bf16 v[44:47], a[156:159], a[8:11], v[44:47]
  v_mfma_f32_16x16x32_bf16 v[44:47], a[152:155], a[0:3], v[44:47]
  s_waitcnt lgkmcnt(0)
  s_nop 2
  v_fmac_f32 v52, v84, v20
  v_fmac_f32 v53, v85, v21
  v_fmac_f32 v54, v86, v22
  v_fmac_f32 v55, v87, v23
  v_mul_f32 v20, v52, v100
  v_mul_f32 v21, v53, v101
  v_mul_f32 v22, v54, v102
  v_mul_f32 v23, v55, v103
  v_cvt_pk_bf16_f32 v132, v20, v21
  v_cvt_pk_bf16_f32 v133, v22, v23
  v_fmac_f32 v56, v88, v28
  v_fmac_f32 v57, v89, v29
  v_fmac_f32 v58, v90, v30
  v_fmac_f32 v59, v91, v31
  v_mul_f32 v28, v56, v104
  v_mul_f32 v29, v57, v105
  v_mul_f32 v30, v58, v106
  v_mul_f32 v31, v59, v107
  v_cvt_pk_bf16_f32 v134, v28, v29
  v_cvt_pk_bf16_f32 v135, v30, v31
  buffer_store_dwordx4 v[132:135], v0, s[36:39], s76 offen offset:0 sc1
  v_fmac_f32 v60, v92, v36
  v_fmac_f32 v61, v93, v37
  v_fmac_f32 v62, v94, v38
  v_fmac_f32 v63, v95, v39
  v_mul_f32 v36, v60, v108
  v_mul_f32 v37, v61, v109
  v_mul_f32 v38, v62, v110
  v_mul_f32 v39, v63, v111
  v_cvt_pk_bf16_f32 v136, v36, v37
  v_cvt_pk_bf16_f32 v137, v38, v39
  v_fmac_f32 v64, v96, v44
  v_fmac_f32 v65, v97, v45
  v_fmac_f32 v66, v98, v46
  v_fmac_f32 v67, v99, v47
  v_mul_f32 v44, v64, v112
  v_mul_f32 v45, v65, v113
  v_mul_f32 v46, v66, v114
  v_mul_f32 v47, v67, v115
  v_cvt_pk_bf16_f32 v138, v44, v45
  v_cvt_pk_bf16_f32 v139, v46, v47
  buffer_store_dwordx4 v[136:139], v0, s[36:39], s51 offen offset:0 sc1
  v_fmac_f32 v68, v84, v24
  v_fmac_f32 v69, v85, v25
  v_fmac_f32 v70, v86, v26
  v_fmac_f32 v71, v87, v27
  v_mul_f32 v24, v68, v100
  v_mul_f32 v25, v69, v101
  v_mul_f32 v26, v70, v102
  v_mul_f32 v27, v71, v103
  v_cvt_pk_bf16_f32 v140, v24, v25
  v_cvt_pk_bf16_f32 v141, v26, v27
  v_fmac_f32 v72, v88, v32
  v_fmac_f32 v73, v89, v33
  v_fmac_f32 v74, v90, v34
  v_fmac_f32 v75, v91, v35
  v_mul_f32 v32, v72, v104
  v_mul_f32 v33, v73, v105
  v_mul_f32 v34, v74, v106
  v_mul_f32 v35, v75, v107
  v_cvt_pk_bf16_f32 v142, v32, v33
  v_cvt_pk_bf16_f32 v143, v34, v35
  buffer_store_dwordx4 v[140:143], v0, s[36:39], s76 offen offset:1024 sc1
  v_fmac_f32 v76, v92, v40
  v_fmac_f32 v77, v93, v41
  v_fmac_f32 v78, v94, v42
  v_fmac_f32 v79, v95, v43
  v_mul_f32 v40, v76, v108
  v_mul_f32 v41, v77, v109
  v_mul_f32 v42, v78, v110
  v_mul_f32 v43, v79, v111
  v_cvt_pk_bf16_f32 v144, v40, v41
  v_cvt_pk_bf16_f32 v145, v42, v43
  v_fmac_f32 v80, v96, v48
  v_fmac_f32 v81, v97, v49
  v_fmac_f32 v82, v98, v50
  v_fmac_f32 v83, v99, v51
  v_mul_f32 v48, v80, v112
  v_mul_f32 v49, v81, v113
  v_mul_f32 v50, v82, v114
  v_mul_f32 v51, v83, v115
  v_cvt_pk_bf16_f32 v146, v48, v49
  v_cvt_pk_bf16_f32 v147, v50, v51
  buffer_store_dwordx4 v[144:147], v0, s[36:39], s51 offen offset:1024 sc1
  v_add_f32 v20, v52, v53
  v_mul_f32 v21, v52, v52
  v_add_f32 v24, v54, v55
  v_mul_f32 v25, v53, v53
  v_fmac_f32 v21, v54, v54
  v_fmac_f32 v25, v55, v55
  v_fmac_f32 v21, v56, v56
  v_add_f32 v20, v20, v56
  v_fmac_f32 v25, v57, v57
  v_add_f32 v24, v24, v57
  v_fmac_f32 v21, v58, v58
  v_add_f32 v20, v20, v58
  v_fmac_f32 v25, v59, v59
  v_add_f32 v24, v24, v59
  v_fmac_f32 v21, v60, v60
  v_add_f32 v20, v20, v60
  v_fmac_f32 v25, v61, v61
  v_add_f32 v24, v24, v61
  v_fmac_f32 v21, v62, v62
  v_add_f32 v20, v20, v62
  v_fmac_f32 v25, v63, v63
  v_add_f32 v24, v24, v63
  v_fmac_f32 v21, v64, v64
  v_add_f32 v20, v20, v64
  v_fmac_f32 v25, v65, v65
  v_add_f32 v24, v24, v65
  v_fmac_f32 v21, v66, v66
  v_add_f32 v20, v20, v66
  v_fmac_f32 v25, v67, v67
  v_add_f32 v24, v24, v67
  v_add_f32 v22, v68, v69
  v_mul_f32 v23, v68, v68
  v_add_f32 v26, v70, v71
  v_mul_f32 v27, v69, v69
  v_fmac_f32 v23, v70, v70
  v_fmac_f32 v27, v71, v71
  v_fmac_f32 v23, v72, v72
  v_add_f32 v22, v22, v72
  v_fmac_f32 v27, v73, v73
  v_add_f32 v26, v26, v73
  v_fmac_f32 v23, v74, v74
  v_add_f32 v22, v22, v74
  v_fmac_f32 v27, v75, v75
  v_add_f32 v26, v26, v75
  v_fmac_f32 v23, v76, v76
  v_add_f32 v22, v22, v76
  v_fmac_f32 v27, v77, v77
  v_add_f32 v26, v26, v77
  v_fmac_f32 v23, v78, v78
  v_add_f32 v22, v22, v78
  v_fmac_f32 v27, v79, v79
  v_add_f32 v26, v26, v79
  v_fmac_f32 v23, v80, v80
  v_add_f32 v22, v22, v80
  v_fmac_f32 v27, v81, v81
  v_add_f32 v26, v26, v81
  v_fmac_f32 v23, v82, v82
  v_add_f32 v22, v22, v82
  v_fmac_f32 v27, v83, v83
  v_add_f32 v26, v26, v83
  v_add_f32 v20, v20, v24
  v_add_f32 v21, v21, v25
  v_add_f32 v22, v22, v26
  v_add_f32 v23, v23, v27
  v_mov_b32 v24, v20
  v_mov_b32 v25, v21
  v_mov_b32 v26, v22
  v_mov_b32 v27, v23
  v_permlane16_swap_b32 v20, v24
  v_permlane16_swap_b32 v21, v25
  v_permlane16_swap_b32 v22, v26
  v_permlane16_swap_b32 v23, v27
  v_add_f32 v20, v20, v24
  v_add_f32 v21, v21, v25
  v_add_f32 v22, v22, v26
  v_add_f32 v23, v23, v27
  v_mov_b32 v24, v20
  v_mov_b32 v25, v21
  v_mov_b32 v26, v22
  v_mov_b32 v27, v23
  v_permlane32_swap_b32 v20, v24
  v_permlane32_swap_b32 v21, v25
  v_permlane32_swap_b32 v22, v26
  v_permlane32_swap_b32 v23, v27
  v_add_f32 v20, v20, v24
  v_add_f32 v21, v21, v25
  v_add_f32 v22, v22, v26
  v_add_f32 v23, v23, v27
  s_mov_b64 exec, 0xffff
  buffer_store_dwordx4 v[20:23], v0, s[36:39], s77 offen sc1
  s_mov_b64 exec, -1
  v_cvt_pk_bf16_f32 v116, v52, v53
  v_cvt_pk_bf16_f32 v117, v54, v55
  v_cvt_pk_bf16_f32 v118, v56, v57
  v_cvt_pk_bf16_f32 v119, v58, v59
  v_cvt_pk_bf16_f32 v120, v60, v61
  v_cvt_pk_bf16_f32 v121, v62, v63
  v_cvt_pk_bf16_f32 v122, v64, v65
  v_cvt_pk_bf16_f32 v123, v66, v67
  v_cvt_pk_bf16_f32 v124, v68, v69
  v_cvt_pk_bf16_f32 v125, v70, v71
  v_cvt_pk_bf16_f32 v126, v72, v73
  v_cvt_pk_bf16_f32 v127, v74, v75
  v_cvt_pk_bf16_f32 v128, v76, v77
  v_cvt_pk_bf16_f32 v129, v78, v79
  v_cvt_pk_bf16_f32 v130, v80, v81
  v_cvt_pk_bf16_f32 v131, v82, v83
  v_accvgpr_write_b32 a232, v116
  v_accvgpr_write_b32 a233, v117
  v_accvgpr_write_b32 a234, v118
  v_accvgpr_write_b32 a235, v119
  v_accvgpr_write_b32 a236, v120
  v_accvgpr_write_b32 a237, v121
  v_accvgpr_write_b32 a238, v122
  v_accvgpr_write_b32 a239, v123
  v_accvgpr_write_b32 a240, v124
  v_accvgpr_write_b32 a241, v125
  v_accvgpr_write_b32 a242, v126
  v_accvgpr_write_b32 a243, v127
  v_accvgpr_write_b32 a244, v128
  v_accvgpr_write_b32 a245, v129
  v_accvgpr_write_b32 a246, v130
  v_accvgpr_write_b32 a247, v131
  v_mov_b32 v12, 1
  s_waitcnt vmcnt(0) lgkmcnt(0)
  s_barrier
  s_mov_b64 exec, 1
  buffer_store_dword v12, v0, s[36:39], s45 offen sc1
  s_mov_b64 exec, -1
  s_bfe_u32 s52, s86, 0x40000
  s_mul_i32 s52, s52, 458752
  s_add_u32 m0, s88, 0
  s_nop 0
  buffer_load_dwordx4 v3, s[16:19], s52 offen offset:0 lds
  buffer_load_dwordx4 v4, s[16:19], s52 offen offset:1024 lds
  buffer_load_dwordx4 v5, s[16:19], s52 offen offset:2048 lds
  buffer_load_dwordx4 v6, s[16:19], s52 offen offset:3072 lds
  s_add_u32 m0, s88, 4096
  s_nop 0
  buffer_load_dwordx4 v7, s[16:19], s52 offen offset:0 lds
  buffer_load_dwordx4 v8, s[16:19], s52 offen offset:1024 lds
  buffer_load_dwordx4 v9, s[16:19], s52 offen offset:2048 lds
  s_bfe_u32 s52, s86, 0x40004
  s_mul_i32 s52, s52, 458752
  s_add_u32 m0, s88, 28672
  s_nop 0
  buffer_load_dwordx4 v3, s[16:19], s52 offen offset:0 lds
  buffer_load_dwordx4 v4, s[16:19], s52 offen offset:1024 lds
  buffer_load_dwordx4 v5, s[16:19], s52 offen offset:2048 lds
  buffer_load_dwordx4 v6, s[16:19], s52 offen offset:3072 lds
  s_add_u32 m0, s88, 32768
  s_nop 0
  buffer_load_dwordx4 v7, s[16:19], s52 offen offset:0 lds
  buffer_load_dwordx4 v8, s[16:19], s52 offen offset:1024 lds
  buffer_load_dwordx4 v9, s[16:19], s52 offen offset:2048 lds
  s_bfe_u32 s53, s86, 0x40000
  s_lshl_b32 s53, s53, 13
  s_add_u32 s53, s53, s89
  s_mov_b64 exec, 0
  s_cmp_eq_u32 s44, 1
  s_cbranch_scc1 Hb0
  s_cmp_eq_u32 s44, 2
  s_cbranch_scc1 Hb1
  s_cmp_eq_u32 s44, 3
  s_cbranch_scc1 Hb2
Rb:
  s_mov_b64 exec, -1
G3S:
Hb0:
  s_cbranch_execz Hb0_1
  s_cmp_lg_u32 s44, 0
  s_cbranch_scc1 SM4x
  s_mov_b32 s46, 60000
  s_mov_b32 s47, 5341184
SM4:
  buffer_load_dword v13, v250, s[36:39], s47 offen sc1
  s_sub_u32 s46, s46, 1
  s_cmp_eq_u32 s46, 0
  s_waitcnt vmcnt(0)
  s_cbranch_scc1 SM4x
  v_cmp_ne_u32 vcc, 1, v13
  s_nop 4
  s_cbranch_vccnz SM4
SM4x:
  s_waitcnt vmcnt(7)
  s_barrier
  buffer_load_dwordx4 a[0:3], v0, s[36:39], s53 offen offset:0 sc1
  buffer_load_dwordx4 a[4:7], v0, s[36:39], s53 offen offset:1024 sc1
  buffer_load_dwordx4 a[8:11], v0, s[36:39], s53 offen offset:2048 sc1
  buffer_load_dwordx4 a[12:15], v0, s[36:39], s53 offen offset:3072 sc1
  s_add_u32 s53, s53, 4096
  buffer_load_dwordx4 a[16:19], v0, s[36:39], s53 offen offset:0 sc1
  buffer_load_dwordx4 a[20:23], v0, s[36:39], s53 offen offset:1024 sc1
  buffer_load_dwordx4 a[24:27], v0, s[36:39], s53 offen offset:2048 sc1
  buffer_load_dwordx4 a[28:31], v0, s[36:39], s53 offen offset:3072 sc1
  ds_read_b64_tr_b16 a[128:129], v1 offset:0
  ds_read_b64_tr_b16 a[130:131], v1 offset:3584
  ds_read_b64_tr_b16 a[132:133], v1 offset:7168
  ds_read_b64_tr_b16 a[134:135], v1 offset:10752
  ds_read_b64_tr_b16 a[136:137], v1 offset:32
  ds_read_b64_tr_b16 a[138:139], v1 offset:3616
  ds_read_b64_tr_b16 a[140:141], v1 offset:7200
  ds_read_b64_tr_b16 a[142:143], v1 offset:10784
  ds_read_b64_tr_b16 a[144:145], v1 offset:64
  ds_read_b64_tr_b16 a[146:147], v1 offset:3648
  ds_read_b64_tr_b16 a[148:149], v1 offset:7232
  ds_read_b64_tr_b16 a[150:151], v1 offset:10816
  ds_read_b64_tr_b16 a[152:153], v1 offset:96
  ds_read_b64_tr_b16 a[154:155], v1 offset:3680
  ds_read_b64_tr_b16 a[156:157], v1 offset:7264
  ds_read_b64_tr_b16 a[158:159], v1 offset:10848
  s_waitcnt vmcnt(7) lgkmcnt(8)
  v_mfma_f32_16x16x32_bf16 v[32:35], a[128:131], a[0:3], 0
  s_waitcnt vmcnt(3)
  s_bfe_u32 s53, s86, 0x40004
  s_lshl_b32 s53, s53, 13
  v_mfma_f32_16x16x32_bf16 v[32:35], a[132:135], a[16:19], v[32:35]
  s_waitcnt vmcnt(2)
  s_add_u32 s53, s53, s89
  buffer_load_dwordx4 a[32:35], v0, s[36:39], s53 offen offset:0 sc1
  v_mfma_f32_16x16x32_bf16 v[36:39], a[132:135], a[20:23], 0
  s_waitcnt vmcnt(7)
  ds_read_b64_tr_b16 a[160:161], v1 offset:128
  v_mfma_f32_16x16x32_bf16 v[36:39], a[128:131], a[4:7], v[36:39]
  s_waitcnt vmcnt(6)
  ds_read_b64_tr_b16 a[162:163], v1 offset:3712
  v_mfma_f32_16x16x32_bf16 v[40:43], a[128:131], a[8:11], 0
  s_waitcnt vmcnt(2)
  ds_read_b64_tr_b16 a[164:165], v1 offset:7296
  v_mfma_f32_16x16x32_bf16 v[40:43], a[132:135], a[24:27], v[40:43]
  s_waitcnt vmcnt(1)
  v_mfma_f32_16x16x32_bf16 v[44:47], a[132:135], a[28:31], 0
  s_waitcnt vmcnt(5)
  buffer_load_dwordx4 a[36:39], v0, s[36:39], s53 offen offset:1024 sc1
  v_mfma_f32_16x16x32_bf16 v[44:47], a[128:131], a[12:15], v[44:47]
  ds_read_b64_tr_b16 a[166:167], v1 offset:10880
  v_mfma_f32_16x16x32_bf16 v[60:63], a[136:139], a[12:15], 0
  ds_read_b64_tr_b16 a[168:169], v1 offset:160
  v_mfma_f32_16x16x32_bf16 v[60:63], a[140:143], a[28:31], v[60:63]
  v_mfma_f32_16x16x32_bf16 v[56:59], a[140:143], a[24:27], 0
  ds_read_b64_tr_b16 a[170:171], v1 offset:3744
  v_mfma_f32_16x16x32_bf16 v[56:59], a[136:139], a[8:11], v[56:59]
  buffer_load_dwordx4 a[40:43], v0, s[36:39], s53 offen offset:2048 sc1
  v_mfma_f32_16x16x32_bf16 v[52:55], a[136:139], a[4:7], 0
  ds_read_b64_tr_b16 a[172:173], v1 offset:7328
  v_mfma_f32_16x16x32_bf16 v[52:55], a[140:143], a[20:23], v[52:55]
  v_mfma_f32_16x16x32_bf16 v[48:51], a[140:143], a[16:19], 0
  ds_read_b64_tr_b16 a[174:175], v1 offset:10912
  v_mfma_f32_16x16x32_bf16 v[48:51], a[136:139], a[0:3], v[48:51]
  s_waitcnt lgkmcnt(8)
  v_mfma_f32_16x16x32_bf16 v[64:67], a[144:147], a[0:3], 0
  buffer_load_dwordx4 a[44:47], v0, s[36:39], s53 offen offset:3072 sc1
  s_bfe_u32 s52, s86, 0x40008
  v_mfma_f32_16x16x32_bf16 v[64:67], a[148:151], a[16:19], v[64:67]
  s_mul_i32 s52, s52, 458752
  s_add_u32 m0, s88, 57344
  ds_read_b64_tr_b16 a[128:129], v1 offset:192
  v_mfma_f32_16x16x32_bf16 v[68:71], a[148:151], a[20:23], 0
  ds_read_b64_tr_b16 a[130:131], v1 offset:3776
  v_mfma_f32_16x16x32_bf16 v[68:71], a[144:147], a[4:7], v[68:71]
  v_mfma_f32_16x16x32_bf16 v[72:75], a[144:147], a[8:11], 0
  ds_read_b64_tr_b16 a[132:133], v1 offset:7360
  v_mfma_f32_16x16x32_bf16 v[72:75], a[148:151], a[24:27], v[72:75]
  buffer_load_dwordx4 v3, s[16:19], s52 offen offset:0 lds
  s_add_u32 s53, s53, 4096
  v_mfma_f32_16x16x32_bf16 v[76:79], a[148:151], a[28:31], 0
  ds_read_b64_tr_b16 a[134:135], v1 offset:10944
  v_mfma_f32_16x16x32_bf16 v[76:79], a[144:147], a[12:15], v[76:79]
  v_mfma_f32_16x16x32_bf16 v[92:95], a[152:155], a[12:15], 0
  ds_read_b64_tr_b16 a[136:137], v1 offset:14336
  v_mfma_f32_16x16x32_bf16 v[92:95], a[156:159], a[28:31], v[92:95]
  v_mfma_f32_16x16x32_bf16 v[88:91], a[156:159], a[24:27], 0
  buffer_load_dwordx4 a[48:51], v0, s[36:39], s53 offen offset:0 sc1
  v_mfma_f32_16x16x32_bf16 v[88:91], a[152:155], a[8:11], v[88:91]
  ds_read_b64_tr_b16 a[138:139], v1 offset:17920
  v_mfma_f32_16x16x32_bf16 v[84:87], a[152:155], a[4:7], 0
  ds_read_b64_tr_b16 a[140:141], v1 offset:21504
  v_mfma_f32_16x16x32_bf16 v[84:87], a[156:159], a[20:23], v[84:87]
  v_mfma_f32_16x16x32_bf16 v[80:83], a[156:159], a[16:19], 0
  ds_read_b64_tr_b16 a[142:143], v1 offset:25088
  v_mfma_f32_16x16x32_bf16 v[80:83], a[152:155], a[0:3], v[80:83]
  s_waitcnt lgkmcnt(8)
  buffer_load_dwordx4 v4, s[16:19], s52 offen offset:1024 lds
  v_mfma_f32_16x16x32_bf16 v[96:99], a[160:163], a[0:3], 0
  ds_read_b64_tr_b16 a[144:145], v1 offset:14368
  v_mfma_f32_16x16x32_bf16 v[96:99], a[164:167], a[16:19], v[96:99]
  v_mfma_f32_16x16x32_bf16 v[100:103], a[164:167], a[20:23], 0
  ds_read_b64_tr_b16 a[146:147], v1 offset:17952
  v_mfma_f32_16x16x32_bf16 v[100:103], a[160:163], a[4:7], v[100:103]
  v_mfma_f32_16x16x32_bf16 v[104:107], a[160:163], a[8:11], 0
  buffer_load_dwordx4 a[52:55], v0, s[36:39], s53 offen offset:1024 sc1
  v_mfma_f32_16x16x32_bf16 v[104:107], a[164:167], a[24:27], v[104:107]
  ds_read_b64_tr_b16 a[148:149], v1 offset:21536
  v_mfma_f32_16x16x32_bf16 v[108:111], a[164:167], a[28:31], 0
  ds_read_b64_tr_b16 a[150:151], v1 offset:25120
  v_mfma_f32_16x16x32_bf16 v[108:111], a[160:163], a[12:15], v[108:111]
  v_mfma_f32_16x16x32_bf16 v[124:127], a[168:171], a[12:15], 0
  s_bfe_u32 s57, s86, 0x40018
  s_lshl4_add_u32 s57, s56, s57
  s_lshl_b32 s57, s57, 11
  v_mfma_f32_16x16x32_bf16 v[124:127], a[172:175], a[28:31], v[124:127]
  s_add_u32 s57, s57, 5767168
  buffer_load_dwordx4 v5, s[16:19], s52 offen offset:2048 lds
  s_lshr_b32 s67, s44, 1
  v_mfma_f32_16x16x32_bf16 v[120:123], a[172:175], a[24:27], 0
  s_mul_i32 s67, s67, 14336
  ds_read_b64_tr_b16 a[152:153], v1 offset:14400
  s_and_b32 s68, s44, 1
  v_mfma_f32_16x16x32_bf16 v[120:123], a[168:171], a[8:11], v[120:123]
  s_lshl_b32 s68, s68, 7
  ds_read_b64_tr_b16 a[154:155], v1 offset:17984
  s_add_u32 s67, s67, s68
  v_mfma_f32_16x16x32_bf16 v[116:119], a[168:171], a[4:7], 0
  ds_read_b64_tr_b16 a[156:157], v1 offset:21568
  v_add_u32 v31, s67, v1
  v_mfma_f32_16x16x32_bf16 v[116:119], a[172:175], a[20:23], v[116:119]
  s_lshl_b32 s60, s2, 15
  s_lshl1_add_u32 s60, s73, s60
  s_xor_b32 s62, s60, 32768
  v_mfma_f32_16x16x32_bf16 v[112:115], a[172:175], a[16:19], 0
  s_add_u32 s60, s60, 41943040
  buffer_load_dwordx4 a[56:59], v0, s[36:39], s53 offen offset:2048 sc1
  s_add_u32 s61, s60, 4096
  v_mfma_f32_16x16x32_bf16 v[112:115], a[168:171], a[0:3], v[112:115]
  s_waitcnt lgkmcnt(7)
  ds_read_b64_tr_b16 a[158:159], v1 offset:25152
  s_add_u32 s62, s62, 41943040
  v_mfma_f32_16x16x32_bf16 v[128:131], a[128:131], a[0:3], 0
  s_add_u32 s63, s62, 4096
  ds_read_b64_tr_b16 a[160:161], v1 offset:14432
  v_mfma_f32_16x16x32_bf16 v[128:131], a[132:135], a[16:19], v[128:131]
  v_mfma_f32_16x16x32_bf16 v[132:135], a[132:135], a[20:23], 0
  ds_read_b64_tr_b16 a[162:163], v1 offset:18016
  v_mfma_f32_16x16x32_bf16 v[132:135], a[128:131], a[4:7], v[132:135]
  buffer_load_dwordx4 v6, s[16:19], s52 offen offset:3072 lds
  v_mfma_f32_16x16x32_bf16 v[136:139], a[128:131], a[8:11], 0
  ds_read_b64_tr_b16 a[164:165], v1 offset:21600
  v_mfma_f32_16x16x32_bf16 v[136:139], a[132:135], a[24:27], v[136:139]
  v_mfma_f32_16x16x32_bf16 v[140:143], a[132:135], a[28:31], 0
  ds_read_b64_tr_b16 a[166:167], v1 offset:25184
  v_mfma_f32_16x16x32_bf16 v[140:143], a[128:131], a[12:15], v[140:143]
  v_mfma_f32_16x16x32_bf16 v[156:159], a[136:139], a[12:15], 0
  buffer_load_dwordx4 a[60:63], v0, s[36:39], s53 offen offset:3072 sc1
  s_add_u32 m0, s88, 61440
  v_mfma_f32_16x16x32_bf16 v[156:159], a[140:143], a[28:31], v[156:159]
  ds_read_b64_tr_b16 a[168:169], v1 offset:14464
  v_mfma_f32_16x16x32_bf16 v[152:155], a[140:143], a[24:27], 0
  ds_read_b64_tr_b16 a[170:171], v1 offset:18048
  v_mfma_f32_16x16x32_bf16 v[152:155], a[136:139], a[8:11], v[152:155]
  v_mfma_f32_16x16x32_bf16 v[148:151], a[136:139], a[4:7], 0
  ds_read_b64_tr_b16 a[172:173], v1 offset:21632
  v_mfma_f32_16x16x32_bf16 v[148:151], a[140:143], a[20:23], v[148:151]
  buffer_load_dwordx4 v7, s[16:19], s52 offen offset:0 lds
  s_bfe_u32 s53, s86, 0x40008
  v_mfma_f32_16x16x32_bf16 v[144:147], a[140:143], a[16:19], 0
  s_lshl_b32 s53, s53, 13
  s_add_u32 s53, s53, s89
  ds_read_b64_tr_b16 a[174:175], v1 offset:25216
  v_mfma_f32_16x16x32_bf16 v[144:147], a[136:139], a[0:3], v[144:147]
  s_waitcnt lgkmcnt(8)
  v_mfma_f32_16x16x32_bf16 v[160:163], a[144:147], a[0:3], 0
  ds_read_b64_tr_b16 a[128:129], v1 offset:14496
  v_mfma_f32_16x16x32_bf16 v[160:163], a[148:151], a[16:19], v[160:163]
  v_mfma_f32_16x16x32_bf16 v[164:167], a[148:151], a[20:23], 0
  buffer_load_dwordx4 a[64:67], v0, s[36:39], s53 offen offset:0 sc1
  v_mfma_f32_16x16x32_bf16 v[164:167], a[144:147], a[4:7], v[164:167]
  ds_read_b64_tr_b16 a[130:131], v1 offset:18080
  v_mfma_f32_16x16x32_bf16 v[168:171], a[144:147], a[8:11], 0
  ds_read_b64_tr_b16 a[132:133], v1 offset:21664
  v_mfma_f32_16x16x32_bf16 v[168:171], a[148:151], a[24:27], v[168:171]
  v_mfma_f32_16x16x32_bf16 v[172:175], a[148:151], a[28:31], 0
  ds_read_b64_tr_b16 a[134:135], v1 offset:25248
  v_mfma_f32_16x16x32_bf16 v[172:175], a[144:147], a[12:15], v[172:175]
  s_waitcnt vmcnt(22)
  s_barrier
  buffer_load_dwordx4 v8, s[16:19], s52 offen offset:1024 lds
  v_mfma_f32_16x16x32_bf16 v[188:191], a[152:155], a[12:15], 0
  ds_read_b64_tr_b16 a[136:137], v1 offset:14528
  v_mfma_f32_16x16x32_bf16 v[188:191], a[156:159], a[28:31], v[188:191]
  v_mfma_f32_16x16x32_bf16 v[184:187], a[156:159], a[24:27], 0
  ds_read_b64_tr_b16 a[138:139], v1 offset:18112
  v_mfma_f32_16x16x32_bf16 v[184:187], a[152:155], a[8:11], v[184:187]
  v_mfma_f32_16x16x32_bf16 v[180:183], a[152:155], a[4:7], 0
  buffer_load_dwordx4 a[68:71], v0, s[36:39], s53 offen offset:1024 sc1
  v_mfma_f32_16x16x32_bf16 v[180:183], a[156:159], a[20:23], v[180:183]
  ds_read_b64_tr_b16 a[140:141], v1 offset:21696
  v_mfma_f32_16x16x32_bf16 v[176:179], a[156:159], a[16:19], 0
  ds_read_b64_tr_b16 a[142:143], v1 offset:25280
  v_mfma_f32_16x16x32_bf16 v[176:179], a[152:155], a[0:3], v[176:179]
  s_waitcnt lgkmcnt(8)
  v_mfma_f32_16x16x32_bf16 v[192:195], a[160:163], a[0:3], 0
  ds_read_b64_tr_b16 a[144:145], v1 offset:28672
  v_mfma_f32_16x16x32_bf16 v[192:195], a[164:167], a[16:19], v[192:195]
  v_mfma_f32_16x16x32_bf16 v[196:199], a[164:167], a[20:23], 0
  ds_read_b64_tr_b16 a[146:147], v1 offset:32256
  v_mfma_f32_16x16x32_bf16 v[196:199], a[160:163], a[4:7], v[196:199]
  v_mfma_f32_16x16x32_bf16 v[200:203], a[160:163], a[8:11], 0
  ds_read_b64_tr_b16 a[148:149], v1 offset:35840
  v_mfma_f32_16x16x32_bf16 v[200:203], a[164:167], a[24:27], v[200:203]
  v_mfma_f32_16x16x32_bf16 v[204:207], a[164:167], a[28:31], 0
  buffer_load_dwordx4 v9, s[16:19], s52 offen offset:2048 lds
  v_mfma_f32_16x16x32_bf16 v[204:207], a[160:163], a[12:15], v[204:207]
  ds_read_b64_tr_b16 a[150:151], v1 offset:39424
  v_mfma_f32_16x16x32_bf16 v[220:223], a[168:171], a[12:15], 0
  ds_read_b64_tr_b16 a[152:153], v1 offset:28704
  v_mfma_f32_16x16x32_bf16 v[220:223], a[172:175], a[28:31], v[220:223]
  v_mfma_f32_16x16x32_bf16 v[216:219], a[172:175], a[24:27], 0
  ds_read_b64_tr_b16 a[154:155], v1 offset:32288
  v_mfma_f32_16x16x32_bf16 v[216:219], a[168:171], a[8:11], v[216:219]
  buffer_load_dwordx4 a[72:75], v0, s[36:39], s53 offen offset:2048 sc1
  v_mfma_f32_16x16x32_bf16 v[212:215], a[168:171], a[4:7], 0
  ds_read_b64_tr_b16 a[156:157], v1 offset:35872
  v_mfma_f32_16x16x32_bf16 v[212:215], a[172:175], a[20:23], v[212:215]
  v_mfma_f32_16x16x32_bf16 v[208:211], a[172:175], a[16:19], 0
  ds_read_b64_tr_b16 a[158:159], v1 offset:39456
  v_mfma_f32_16x16x32_bf16 v[208:211], a[168:171], a[0:3], v[208:211]
  s_waitcnt lgkmcnt(8)
  v_mfma_f32_16x16x32_bf16 v[224:227], a[128:131], a[0:3], 0
  ds_read_b64_tr_b16 a[160:161], v1 offset:28736
  v_mfma_f32_16x16x32_bf16 v[224:227], a[132:135], a[16:19], v[224:227]
  v_mfma_f32_16x16x32_bf16 v[228:231], a[132:135], a[20:23], 0
  ds_read_b64_tr_b16 a[162:163], v1 offset:32320
  v_mfma_f32_16x16x32_bf16 v[228:231], a[128:131], a[4:7], v[228:231]
  v_mfma_f32_16x16x32_bf16 v[232:235], a[128:131], a[8:11], 0
  ds_read_b64_tr_b16 a[164:165], v1 offset:35904
  v_mfma_f32_16x16x32_bf16 v[232:235], a[132:135], a[24:27], v[232:235]
  buffer_load_dwordx4 a[76:79], v0, s[36:39], s53 offen offset:3072 sc1
  v_mfma_f32_16x16x32_bf16 v[236:239], a[132:135], a[28:31], 0
  ds_read_b64_tr_b16 a[166:167], v1 offset:39488
  v_mfma_f32_16x16x32_bf16 v[236:239], a[128:131], a[12:15], v[236:239]
  v_mfma_f32_16x16x32_bf16 v[252:255], a[136:139], a[12:15], 0
  ds_read_b64_tr_b16 a[168:169], v1 offset:28768
  v_mfma_f32_16x16x32_bf16 v[252:255], a[140:143], a[28:31], v[252:255]
  s_bfe_u32 s52, s86, 0x4000c
  s_mul_i32 s52, s52, 458752
  s_add_u32 m0, s88, 86016
  v_mfma_f32_16x16x32_bf16 v[248:251], a[140:143], a[24:27], 0
  ds_read_b64_tr_b16 a[170:171], v1 offset:32352
  v_mfma_f32_16x16x32_bf16 v[248:251], a[136:139], a[8:11], v[248:251]
  v_mfma_f32_16x16x32_bf16 v[244:247], a[136:139], a[4:7], 0
  ds_read_b64_tr_b16 a[172:173], v1 offset:35936
  v_mfma_f32_16x16x32_bf16 v[244:247], a[140:143], a[20:23], v[244:247]
  buffer_load_dwordx4 v3, s[16:19], s52 offen offset:0 lds
  v_mfma_f32_16x16x32_bf16 v[240:243], a[140:143], a[16:19], 0
  ds_read_b64_tr_b16 a[174:175], v1 offset:39520
  v_mfma_f32_16x16x32_bf16 v[240:243], a[136:139], a[0:3], v[240:243]
  s_waitcnt vmcnt(8) lgkmcnt(8)
  v_mfma_f32_16x16x32_bf16 v[32:35], a[144:147], a[32:35], v[32:35]
  s_add_u32 s53, s53, 4096
  ds_read_b64_tr_b16 a[128:129], v1 offset:28800
  v_mfma_f32_16x16x32_bf16 v[32:35], a[148:151], a[48:51], v[32:35]
  v_mfma_f32_16x16x32_bf16 v[36:39], a[148:151], a[52:55], v[36:39]
  ds_read_b64_tr_b16 a[130:131], v1 offset:32384
  v_mfma_f32_16x16x32_bf16 v[36:39], a[144:147], a[36:39], v[36:39]
  v_mfma_f32_16x16x32_bf16 v[40:43], a[144:147], a[40:43], v[40:43]
  buffer_load_dwordx4 a[80:83], v0, s[36:39], s53 offen offset:0 sc1
  v_mfma_f32_16x16x32_bf16 v[40:43], a[148:151], a[56:59], v[40:43]
  ds_read_b64_tr_b16 a[132:133], v1 offset:35968
  v_mfma_f32_16x16x32_bf16 v[44:47], a[148:151], a[60:63], v[44:47]
  ds_read_b64_tr_b16 a[134:135], v1 offset:39552
  v_mfma_f32_16x16x32_bf16 v[44:47], a[144:147], a[44:47], v[44:47]
  v_mfma_f32_16x16x32_bf16 v[60:63], a[152:155], a[44:47], v[60:63]
  ds_read_b64_tr_b16 a[136:137], v1 offset:28832
  v_mfma_f32_16x16x32_bf16 v[60:63], a[156:159], a[60:63], v[60:63]
  v_mfma_f32_16x16x32_bf16 v[56:59], a[156:159], a[56:59], v[56:59]
  ds_read_b64_tr_b16 a[138:139], v1 offset:32416
  v_mfma_f32_16x16x32_bf16 v[56:59], a[152:155], a[40:43], v[56:59]
  buffer_load_dwordx4 v4, s[16:19], s52 offen offset:1024 lds
  v_mfma_f32_16x16x32_bf16 v[52:55], a[152:155], a[36:39], v[52:55]
  ds_read_b64_tr_b16 a[140:141], v1 offset:36000
  v_mfma_f32_16x16x32_bf16 v[52:55], a[156:159], a[52:55], v[52:55]
  v_mfma_f32_16x16x32_bf16 v[48:51], a[156:159], a[48:51], v[48:51]
  ds_read_b64_tr_b16 a[142:143], v1 offset:39584
  v_mfma_f32_16x16x32_bf16 v[48:51], a[152:155], a[32:35], v[48:51]
  s_waitcnt lgkmcnt(8)
  v_mfma_f32_16x16x32_bf16 v[64:67], a[160:163], a[32:35], v[64:67]
  ds_read_b64_tr_b16 a[144:145], v1 offset:28864
  v_mfma_f32_16x16x32_bf16 v[64:67], a[164:167], a[48:51], v[64:67]
  v_mfma_f32_16x16x32_bf16 v[68:71], a[164:167], a[52:55], v[68:71]
  ds_read_b64_tr_b16 a[146:147], v1 offset:32448
  v_mfma_f32_16x16x32_bf16 v[68:71], a[160:163], a[36:39], v[68:71]
  buffer_load_dwordx4 a[84:87], v0, s[36:39], s53 offen offset:1024 sc1
  v_mfma_f32_16x16x32_bf16 v[72:75], a[160:163], a[40:43], v[72:75]
  ds_read_b64_tr_b16 a[148:149], v1 offset:36032
  v_mfma_f32_16x16x32_bf16 v[72:75], a[164:167], a[56:59], v[72:75]
  v_mfma_f32_16x16x32_bf16 v[76:79], a[164:167], a[60:63], v[76:79]
  ds_read_b64_tr_b16 a[150:151], v1 offset:39616
  v_mfma_f32_16x16x32_bf16 v[76:79], a[160:163], a[44:47], v[76:79]
  v_mfma_f32_16x16x32_bf16 v[92:95], a[168:171], a[44:47], v[92:95]
  ds_read_b64_tr_b16 a[152:153], v1 offset:43008
  v_mfma_f32_16x16x32_bf16 v[92:95], a[172:175], a[60:63], v[92:95]
  v_mfma_f32_16x16x32_bf16 v[88:91], a[172:175], a[56:59], v[88:91]
  buffer_load_dwordx4 v5, s[16:19], s52 offen offset:2048 lds
  v_mfma_f32_16x16x32_bf16 v[88:91], a[168:171], a[40:43], v[88:91]
  ds_read_b64_tr_b16 a[154:155], v1 offset:46592
  v_mfma_f32_16x16x32_bf16 v[84:87], a[168:171], a[36:39], v[84:87]
  ds_read_b64_tr_b16 a[156:157], v1 offset:50176
  v_mfma_f32_16x16x32_bf16 v[84:87], a[172:175], a[52:55], v[84:87]
  v_mfma_f32_16x16x32_bf16 v[80:83], a[172:175], a[48:51], v[80:83]
  ds_read_b64_tr_b16 a[158:159], v1 offset:53760
  v_mfma_f32_16x16x32_bf16 v[80:83], a[168:171], a[32:35], v[80:83]
  s_waitcnt lgkmcnt(8)
  v_mfma_f32_16x16x32_bf16 v[96:99], a[128:131], a[32:35], v[96:99]
  ds_read_b64_tr_b16 a[160:161], v1 offset:43040
  v_mfma_f32_16x16x32_bf16 v[96:99], a[132:135], a[48:51], v[96:99]
  v_mfma_f32_16x16x32_bf16 v[100:103], a[132:135], a[52:55], v[100:103]
  buffer_load_dwordx4 a[88:91], v0, s[36:39], s53 offen offset:2048 sc1
  v_mfma_f32_16x16x32_bf16 v[100:103], a[128:131], a[36:39], v[100:103]
  ds_read_b64_tr_b16 a[162:163], v1 offset:46624
  v_mfma_f32_16x16x32_bf16 v[104:107], a[128:131], a[40:43], v[104:107]
  ds_read_b64_tr_b16 a[164:165], v1 offset:50208
  v_mfma_f32_16x16x32_bf16 v[104:107], a[132:135], a[56:59], v[104:107]
  v_mfma_f32_16x16x32_bf16 v[108:111], a[132:135], a[60:63], v[108:111]
  ds_read_b64_tr_b16 a[166:167], v1 offset:53792
  v_mfma_f32_16x16x32_bf16 v[108:111], a[128:131], a[44:47], v[108:111]
  v_mfma_f32_16x16x32_bf16 v[124:127], a[136:139], a[44:47], v[124:127]
  ds_read_b64_tr_b16 a[168:169], v1 offset:43072
  v_mfma_f32_16x16x32_bf16 v[124:127], a[140:143], a[60:63], v[124:127]
  buffer_load_dwordx4 v6, s[16:19], s52 offen offset:3072 lds
  v_mfma_f32_16x16x32_bf16 v[120:123], a[140:143], a[56:59], v[120:123]
  ds_read_b64_tr_b16 a[170:171], v1 offset:46656
  v_mfma_f32_16x16x32_bf16 v[120:123], a[136:139], a[40:43], v[120:123]
  v_mfma_f32_16x16x32_bf16 v[116:119], a[136:139], a[36:39], v[116:119]
  ds_read_b64_tr_b16 a[172:173], v1 offset:50240
  v_mfma_f32_16x16x32_bf16 v[116:119], a[140:143], a[52:55], v[116:119]
  v_mfma_f32_16x16x32_bf16 v[112:115], a[140:143], a[48:51], v[112:115]
  ds_read_b64_tr_b16 a[174:175], v1 offset:53824
  v_mfma_f32_16x16x32_bf16 v[112:115], a[136:139], a[32:35], v[112:115]
  s_waitcnt lgkmcnt(8)
  v_mfma_f32_16x16x32_bf16 v[128:131], a[144:147], a[32:35], v[128:131]
  ds_read_b64_tr_b16 a[128:129], v1 offset:43104
  v_mfma_f32_16x16x32_bf16 v[128:131], a[148:151], a[48:51], v[128:131]
  buffer_load_dwordx4 a[92:95], v0, s[36:39], s53 offen offset:3072 sc1
  v_mfma_f32_16x16x32_bf16 v[132:135], a[148:151], a[52:55], v[132:135]
  ds_read_b64_tr_b16 a[130:131], v1 offset:46688
  v_mfma_f32_16x16x32_bf16 v[132:135], a[144:147], a[36:39], v[132:135]
  v_mfma_f32_16x16x32_bf16 v[136:139], a[144:147], a[40:43], v[136:139]
  s_add_u32 m0, s88, 90112
  ds_read_b64_tr_b16 a[132:133], v1 offset:50272
  v_mfma_f32_16x16x32_bf16 v[136:139], a[148:151], a[56:59], v[136:139]
  v_mfma_f32_16x16x32_bf16 v[140:143], a[148:151], a[60:63], v[140:143]
  ds_read_b64_tr_b16 a[134:135], v1 offset:53856
  v_mfma_f32_16x16x32_bf16 v[140:143], a[144:147], a[44:47], v[140:143]
  v_mfma_f32_16x16x32_bf16 v[156:159], a[152:155], a[44:47], v[156:159]
  buffer_load_dwordx4 v7, s[16:19], s52 offen offset:0 lds
  s_bfe_u32 s53, s86, 0x4000c
  v_mfma_f32_16x16x32_bf16 v[156:159], a[156:159], a[60:63], v[156:159]
  s_lshl_b32 s53, s53, 13
  s_add_u32 s53, s53, s89
  ds_read_b64_tr_b16 a[136:137], v1 offset:43136
  v_mfma_f32_16x16x32_bf16 v[152:155], a[156:159], a[56:59], v[152:155]
  ds_read_b64_tr_b16 a[138:139], v1 offset:46720
  v_mfma_f32_16x16x32_bf16 v[152:155], a[152:155], a[40:43], v[152:155]
  v_mfma_f32_16x16x32_bf16 v[148:151], a[152:155], a[36:39], v[148:151]
  ds_read_b64_tr_b16 a[140:141], v1 offset:50304
  v_mfma_f32_16x16x32_bf16 v[148:151], a[156:159], a[52:55], v[148:151]
  buffer_load_dwordx4 a[96:99], v0, s[36:39], s53 offen offset:0 sc1
  v_mfma_f32_16x16x32_bf16 v[144:147], a[156:159], a[48:51], v[144:147]
  ds_read_b64_tr_b16 a[142:143], v1 offset:53888
  v_mfma_f32_16x16x32_bf16 v[144:147], a[152:155], a[32:35], v[144:147]
  s_waitcnt lgkmcnt(8)
  v_mfma_f32_16x16x32_bf16 v[160:163], a[160:163], a[32:35], v[160:163]
  ds_read_b64_tr_b16 a[144:145], v1 offset:43168
  v_mfma_f32_16x16x32_bf16 v[160:163], a[164:167], a[48:51], v[160:163]
  v_mfma_f32_16x16x32_bf16 v[164:167], a[164:167], a[52:55], v[164:167]
  ds_read_b64_tr_b16 a[146:147], v1 offset:46752
  v_mfma_f32_16x16x32_bf16 v[164:167], a[160:163], a[36:39], v[164:167]
  v_mfma_f32_16x16x32_bf16 v[168:171], a[160:163], a[40:43], v[168:171]
  ds_read_b64_tr_b16 a[148:149], v1 offset:50336
  v_mfma_f32_16x16x32_bf16 v[168:171], a[164:167], a[56:59], v[168:171]
  v_mfma_f32_16x16x32_bf16 v[172:175], a[164:167], a[60:63], v[172:175]
  ds_read_b64_tr_b16 a[150:151], v1 offset:53920
  v_mfma_f32_16x16x32_bf16 v[172:175], a[160:163], a[44:47], v[172:175]
  s_waitcnt vmcnt(12)
  s_barrier
  buffer_load_dwordx4 v8, s[16:19], s52 offen offset:1024 lds
  v_mfma_f32_16x16x32_bf16 v[188:191], a[168:171], a[44:47], v[188:191]
  ds_read_b64_tr_b16 a[152:153], v1 offset:43200
  v_mfma_f32_16x16x32_bf16 v[188:191], a[172:175], a[60:63], v[188:191]
  v_mfma_f32_16x16x32_bf16 v[184:187], a[172:175], a[56:59], v[184:187]
  ds_read_b64_tr_b16 a[154:155], v1 offset:46784
  v_mfma_f32_16x16x32_bf16 v[184:187], a[168:171], a[40:43], v[184:187]
  v_mfma_f32_16x16x32_bf16 v[180:183], a[168:171], a[36:39], v[180:183]
  buffer_load_dwordx4 a[100:103], v0, s[36:39], s53 offen offset:1024 sc1
  v_mfma_f32_16x16x32_bf16 v[180:183], a[172:175], a[52:55], v[180:183]
  ds_read_b64_tr_b16 a[156:157], v1 offset:50368
  v_mfma_f32_16x16x32_bf16 v[176:179], a[172:175], a[48:51], v[176:179]
  ds_read_b64_tr_b16 a[158:159], v1 offset:53952
  v_mfma_f32_16x16x32_bf16 v[176:179], a[168:171], a[32:35], v[176:179]
  s_waitcnt lgkmcnt(8)
  v_mfma_f32_16x16x32_bf16 v[192:195], a[128:131], a[32:35], v[192:195]
  ds_read_b64_tr_b16 a[160:161], v2 offset:0
  v_mfma_f32_16x16x32_bf16 v[192:195], a[132:135], a[48:51], v[192:195]
  v_mfma_f32_16x16x32_bf16 v[196:199], a[132:135], a[52:55], v[196:199]
  ds_read_b64_tr_b16 a[162:163], v2 offset:3584
  v_mfma_f32_16x16x32_bf16 v[196:199], a[128:131], a[36:39], v[196:199]
  v_mfma_f32_16x16x32_bf16 v[200:203], a[128:131], a[40:43], v[200:203]
  ds_read_b64_tr_b16 a[164:165], v2 offset:7168
  v_mfma_f32_16x16x32_bf16 v[200:203], a[132:135], a[56:59], v[200:203]
  v_mfma_f32_16x16x32_bf16 v[204:207], a[132:135], a[60:63], v[204:207]
  buffer_load_dwordx4 v9, s[16:19], s52 offen offset:2048 lds
  v_mfma_f32_16x16x32_bf16 v[204:207], a[128:131], a[44:47], v[204:207]
  ds_read_b64_tr_b16 a[166:167], v2 offset:10752
  v_mfma_f32_16x16x32_bf16 v[220:223], a[136:139], a[44:47], v[220:223]
  ds_read_b64_tr_b16 a[168:169], v2 offset:32
  v_mfma_f32_16x16x32_bf16 v[220:223], a[140:143], a[60:63], v[220:223]
  v_mfma_f32_16x16x32_bf16 v[216:219], a[140:143], a[56:59], v[216:219]
  ds_read_b64_tr_b16 a[170:171], v2 offset:3616
  v_mfma_f32_16x16x32_bf16 v[216:219], a[136:139], a[40:43], v[216:219]
  buffer_load_dwordx4 a[104:107], v0, s[36:39], s53 offen offset:2048 sc1
  v_mfma_f32_16x16x32_bf16 v[212:215], a[136:139], a[36:39], v[212:215]
  ds_read_b64_tr_b16 a[172:173], v2 offset:7200
  v_mfma_f32_16x16x32_bf16 v[212:215], a[140:143], a[52:55], v[212:215]
  v_mfma_f32_16x16x32_bf16 v[208:211], a[140:143], a[48:51], v[208:211]
  ds_read_b64_tr_b16 a[174:175], v2 offset:10784
  v_mfma_f32_16x16x32_bf16 v[208:211], a[136:139], a[32:35], v[208:211]
  s_waitcnt lgkmcnt(8)
  v_mfma_f32_16x16x32_bf16 v[224:227], a[144:147], a[32:35], v[224:227]
  ds_read_b64_tr_b16 a[128:129], v2 offset:64
  v_mfma_f32_16x16x32_bf16 v[224:227], a[148:151], a[48:51], v[224:227]
  v_mfma_f32_16x16x32_bf16 v[228:231], a[148:151], a[52:55], v[228:231]
  ds_read_b64_tr_b16 a[130:131], v2 offset:3648
  v_mfma_f32_16x16x32_bf16 v[228:231], a[144:147], a[36:39], v[228:231]
  v_mfma_f32_16x16x32_bf16 v[232:235], a[144:147], a[40:43], v[232:235]
  ds_read_b64_tr_b16 a[132:133], v2 offset:7232
  v_mfma_f32_16x16x32_bf16 v[232:235], a[148:151], a[56:59], v[232:235]
  buffer_load_dwordx4 a[108:111], v0, s[36:39], s53 offen offset:3072 sc1
  v_mfma_f32_16x16x32_bf16 v[236:239], a[148:151], a[60:63], v[236:239]
  ds_read_b64_tr_b16 a[134:135], v2 offset:10816
  v_mfma_f32_16x16x32_bf16 v[236:239], a[144:147], a[44:47], v[236:239]
  v_mfma_f32_16x16x32_bf16 v[252:255], a[152:155], a[44:47], v[252:255]
  ds_read_b64_tr_b16 a[136:137], v2 offset:96
  v_mfma_f32_16x16x32_bf16 v[252:255], a[156:159], a[60:63], v[252:255]
  s_bfe_u32 s52, s86, 0x40010
  s_mul_i32 s52, s52, 458752
  s_add_u32 m0, s88, 0
  v_mfma_f32_16x16x32_bf16 v[248:251], a[156:159], a[56:59], v[248:251]
  ds_read_b64_tr_b16 a[138:139], v2 offset:3680
  v_mfma_f32_16x16x32_bf16 v[248:251], a[152:155], a[40:43], v[248:251]
  v_mfma_f32_16x16x32_bf16 v[244:247], a[152:155], a[36:39], v[244:247]
  ds_read_b64_tr_b16 a[140:141], v2 offset:7264
  v_mfma_f32_16x16x32_bf16 v[244:247], a[156:159], a[52:55], v[244:247]
  buffer_load_dwordx4 v3, s[16:19], s52 offen offset:0 lds
  v_mfma_f32_16x16x32_bf16 v[240:243], a[156:159], a[48:51], v[240:243]
  ds_read_b64_tr_b16 a[142:143], v2 offset:10848
  v_mfma_f32_16x16x32_bf16 v[240:243], a[152:155], a[32:35], v[240:243]
  s_waitcnt vmcnt(8) lgkmcnt(8)
  v_mfma_f32_16x16x32_bf16 v[32:35], a[160:163], a[64:67], v[32:35]
  s_add_u32 s53, s53, 4096
  ds_read_b64_tr_b16 a[144:145], v2 offset:128
  v_mfma_f32_16x16x32_bf16 v[32:35], a[164:167], a[80:83], v[32:35]
  v_mfma_f32_16x16x32_bf16 v[36:39], a[164:167], a[84:87], v[36:39]
  ds_read_b64_tr_b16 a[146:147], v2 offset:3712
  v_mfma_f32_16x16x32_bf16 v[36:39], a[160:163], a[68:71], v[36:39]
  v_mfma_f32_16x16x32_bf16 v[40:43], a[160:163], a[72:75], v[40:43]
  buffer_load_dwordx4 a[112:115], v0, s[36:39], s53 offen offset:0 sc1
  v_mfma_f32_16x16x32_bf16 v[40:43], a[164:167], a[88:91], v[40:43]
  ds_read_b64_tr_b16 a[148:149], v2 offset:7296
  v_mfma_f32_16x16x32_bf16 v[44:47], a[164:167], a[92:95], v[44:47]
  ds_read_b64_tr_b16 a[150:151], v2 offset:10880
  v_mfma_f32_16x16x32_bf16 v[44:47], a[160:163], a[76:79], v[44:47]
  v_mfma_f32_16x16x32_bf16 v[60:63], a[168:171], a[76:79], v[60:63]
  ds_read_b64_tr_b16 a[152:153], v2 offset:160
  v_mfma_f32_16x16x32_bf16 v[60:63], a[172:175], a[92:95], v[60:63]
  v_mfma_f32_16x16x32_bf16 v[56:59], a[172:175], a[88:91], v[56:59]
  ds_read_b64_tr_b16 a[154:155], v2 offset:3744
  v_mfma_f32_16x16x32_bf16 v[56:59], a[168:171], a[72:75], v[56:59]
  buffer_load_dwordx4 v4, s[16:19], s52 offen offset:1024 lds
  v_mfma_f32_16x16x32_bf16 v[52:55], a[168:171], a[68:71], v[52:55]
  ds_read_b64_tr_b16 a[156:157], v2 offset:7328
  v_mfma_f32_16x16x32_bf16 v[52:55], a[172:175], a[84:87], v[52:55]
  v_mfma_f32_16x16x32_bf16 v[48:51], a[172:175], a[80:83], v[48:51]
  ds_read_b64_tr_b16 a[158:159], v2 offset:10912
  v_mfma_f32_16x16x32_bf16 v[48:51], a[168:171], a[64:67], v[48:51]
  s_waitcnt lgkmcnt(8)
  v_mfma_f32_16x16x32_bf16 v[64:67], a[128:131], a[64:67], v[64:67]
  ds_read_b64_tr_b16 a[160:161], v2 offset:192
  v_mfma_f32_16x16x32_bf16 v[64:67], a[132:135], a[80:83], v[64:67]
  v_mfma_f32_16x16x32_bf16 v[68:71], a[132:135], a[84:87], v[68:71]
  ds_read_b64_tr_b16 a[162:163], v2 offset:3776
  v_mfma_f32_16x16x32_bf16 v[68:71], a[128:131], a[68:71], v[68:71]
  buffer_load_dwordx4 a[116:119], v0, s[36:39], s53 offen offset:1024 sc1
  v_mfma_f32_16x16x32_bf16 v[72:75], a[128:131], a[72:75], v[72:75]
  ds_read_b64_tr_b16 a[164:165], v2 offset:7360
  v_mfma_f32_16x16x32_bf16 v[72:75], a[132:135], a[88:91], v[72:75]
  v_mfma_f32_16x16x32_bf16 v[76:79], a[132:135], a[92:95], v[76:79]
  ds_read_b64_tr_b16 a[166:167], v2 offset:10944
  v_mfma_f32_16x16x32_bf16 v[76:79], a[128:131], a[76:79], v[76:79]
  v_mfma_f32_16x16x32_bf16 v[92:95], a[136:139], a[76:79], v[92:95]
  ds_read_b64_tr_b16 a[168:169], v2 offset:14336
  v_mfma_f32_16x16x32_bf16 v[92:95], a[140:143], a[92:95], v[92:95]
  v_mfma_f32_16x16x32_bf16 v[88:91], a[140:143], a[88:91], v[88:91]
  buffer_load_dwordx4 v5, s[16:19], s52 offen offset:2048 lds
  v_mfma_f32_16x16x32_bf16 v[88:91], a[136:139], a[72:75], v[88:91]
  ds_read_b64_tr_b16 a[170:171], v2 offset:17920
  v_mfma_f32_16x16x32_bf16 v[84:87], a[136:139], a[68:71], v[84:87]
  ds_read_b64_tr_b16 a[172:173], v2 offset:21504
  v_mfma_f32_16x16x32_bf16 v[84:87], a[140:143], a[84:87], v[84:87]
  v_mfma_f32_16x16x32_bf16 v[80:83], a[140:143], a[80:83], v[80:83]
  ds_read_b64_tr_b16 a[174:175], v2 offset:25088
  v_mfma_f32_16x16x32_bf16 v[80:83], a[136:139], a[64:67], v[80:83]
  s_waitcnt lgkmcnt(8)
  v_mfma_f32_16x16x32_bf16 v[96:99], a[144:147], a[64:67], v[96:99]
  ds_read_b64_tr_b16 a[128:129], v2 offset:14368
  v_mfma_f32_16x16x32_bf16 v[96:99], a[148:151], a[80:83], v[96:99]
Hb1:
  s_cbranch_execz Hb1_1
  v_mfma_f32_16x16x32_bf16 v[100:103], a[148:151], a[84:87], v[100:103]
  buffer_load_dwordx4 a[120:123], v0, s[36:39], s53 offen offset:2048 sc1
  v_mfma_f32_16x16x32_bf16 v[100:103], a[144:147], a[68:71], v[100:103]
  ds_read_b64_tr_b16 a[130:131], v2 offset:17952
  v_mfma_f32_16x16x32_bf16 v[104:107], a[144:147], a[72:75], v[104:107]
  ds_read_b64_tr_b16 a[132:133], v2 offset:21536
  v_mfma_f32_16x16x32_bf16 v[104:107], a[148:151], a[88:91], v[104:107]
  v_mfma_f32_16x16x32_bf16 v[108:111], a[148:151], a[92:95], v[108:111]
  ds_read_b64_tr_b16 a[134:135], v2 offset:25120
  v_mfma_f32_16x16x32_bf16 v[108:111], a[144:147], a[76:79], v[108:111]
  v_mfma_f32_16x16x32_bf16 v[124:127], a[152:155], a[76:79], v[124:127]
  ds_read_b64_tr_b16 a[136:137], v2 offset:14400
  v_mfma_f32_16x16x32_bf16 v[124:127], a[156:159], a[92:95], v[124:127]
  buffer_load_dwordx4 v6, s[16:19], s52 offen offset:3072 lds
  v_mfma_f32_16x16x32_bf16 v[120:123], a[156:159], a[88:91], v[120:123]
  ds_read_b64_tr_b16 a[138:139], v2 offset:17984
  v_mfma_f32_16x16x32_bf16 v[120:123], a[152:155], a[72:75], v[120:123]
  v_mfma_f32_16x16x32_bf16 v[116:119], a[152:155], a[68:71], v[116:119]
  ds_read_b64_tr_b16 a[140:141], v2 offset:21568
  v_mfma_f32_16x16x32_bf16 v[116:119], a[156:159], a[84:87], v[116:119]
  v_mfma_f32_16x16x32_bf16 v[112:115], a[156:159], a[80:83], v[112:115]
  ds_read_b64_tr_b16 a[142:143], v2 offset:25152
  v_mfma_f32_16x16x32_bf16 v[112:115], a[152:155], a[64:67], v[112:115]
  s_waitcnt lgkmcnt(8)
  v_mfma_f32_16x16x32_bf16 v[128:131], a[160:163], a[64:67], v[128:131]
  ds_read_b64_tr_b16 a[144:145], v2 offset:14432
  v_mfma_f32_16x16x32_bf16 v[128:131], a[164:167], a[80:83], v[128:131]
  buffer_load_dwordx4 a[124:127], v0, s[36:39], s53 offen offset:3072 sc1
  v_mfma_f32_16x16x32_bf16 v[132:135], a[164:167], a[84:87], v[132:135]
  ds_read_b64_tr_b16 a[146:147], v2 offset:18016
  v_mfma_f32_16x16x32_bf16 v[132:135], a[160:163], a[68:71], v[132:135]
  v_mfma_f32_16x16x32_bf16 v[136:139], a[160:163], a[72:75], v[136:139]
  s_add_u32 m0, s88, 4096
  ds_read_b64_tr_b16 a[148:149], v2 offset:21600
  v_mfma_f32_16x16x32_bf16 v[136:139], a[164:167], a[88:91], v[136:139]
  v_mfma_f32_16x16x32_bf16 v[140:143], a[164:167], a[92:95], v[140:143]
  ds_read_b64_tr_b16 a[150:151], v2 offset:25184
  v_mfma_f32_16x16x32_bf16 v[140:143], a[160:163], a[76:79], v[140:143]
  v_mfma_f32_16x16x32_bf16 v[156:159], a[168:171], a[76:79], v[156:159]
  buffer_load_dwordx4 v7, s[16:19], s52 offen offset:0 lds
  s_bfe_u32 s53, s86, 0x40010
  v_mfma_f32_16x16x32_bf16 v[156:159], a[172:175], a[92:95], v[156:159]
  s_lshl_b32 s53, s53, 13
  s_add_u32 s53, s53, s89
  ds_read_b64_tr_b16 a[152:153], v2 offset:14464
  v_mfma_f32_16x16x32_bf16 v[152:155], a[172:175], a[88:91], v[152:155]
  ds_read_b64_tr_b16 a[154:155], v2 offset:18048
  v_mfma_f32_16x16x32_bf16 v[152:155], a[168:171], a[72:75], v[152:155]
  v_mfma_f32_16x16x32_bf16 v[148:151], a[168:171], a[68:71], v[148:151]
  ds_read_b64_tr_b16 a[156:157], v2 offset:21632
  v_mfma_f32_16x16x32_bf16 v[148:151], a[172:175], a[84:87], v[148:151]
  buffer_load_dwordx4 a[0:3], v0, s[36:39], s53 offen offset:0 sc1
  v_mfma_f32_16x16x32_bf16 v[144:147], a[172:175], a[80:83], v[144:147]
  ds_read_b64_tr_b16 a[158:159], v2 offset:25216
  v_mfma_f32_16x16x32_bf16 v[144:147], a[168:171], a[64:67], v[144:147]
  s_waitcnt lgkmcnt(8)
  v_mfma_f32_16x16x32_bf16 v[160:163], a[128:131], a[64:67], v[160:163]
  ds_read_b64_tr_b16 a[160:161], v2 offset:14496
  v_mfma_f32_16x16x32_bf16 v[160:163], a[132:135], a[80:83], v[160:163]
  v_mfma_f32_16x16x32_bf16 v[164:167], a[132:135], a[84:87], v[164:167]
  ds_read_b64_tr_b16 a[162:163], v2 offset:18080
  v_mfma_f32_16x16x32_bf16 v[164:167], a[128:131], a[68:71], v[164:167]
  v_mfma_f32_16x16x32_bf16 v[168:171], a[128:131], a[72:75], v[168:171]
  ds_read_b64_tr_b16 a[164:165], v2 offset:21664
  v_mfma_f32_16x16x32_bf16 v[168:171], a[132:135], a[88:91], v[168:171]
  v_mfma_f32_16x16x32_bf16 v[172:175], a[132:135], a[92:95], v[172:175]
  ds_read_b64_tr_b16 a[166:167], v2 offset:25248
  v_mfma_f32_16x16x32_bf16 v[172:175], a[128:131], a[76:79], v[172:175]
  s_waitcnt vmcnt(12)
  s_barrier
  buffer_load_dwordx4 v8, s[16:19], s52 offen offset:1024 lds
  v_mfma_f32_16x16x32_bf16 v[188:191], a[136:139], a[76:79], v[188:191]
  ds_read_b64_tr_b16 a[168:169], v2 offset:14528
  v_mfma_f32_16x16x32_bf16 v[188:191], a[140:143], a[92:95], v[188:191]
  v_mfma_f32_16x16x32_bf16 v[184:187], a[140:143], a[88:91], v[184:187]
  ds_read_b64_tr_b16 a[170:171], v2 offset:18112
  v_mfma_f32_16x16x32_bf16 v[184:187], a[136:139], a[72:75], v[184:187]
  v_mfma_f32_16x16x32_bf16 v[180:183], a[136:139], a[68:71], v[180:183]
  buffer_load_dwordx4 a[4:7], v0, s[36:39], s53 offen offset:1024 sc1
  v_mfma_f32_16x16x32_bf16 v[180:183], a[140:143], a[84:87], v[180:183]
  ds_read_b64_tr_b16 a[172:173], v2 offset:21696
  v_mfma_f32_16x16x32_bf16 v[176:179], a[140:143], a[80:83], v[176:179]
  ds_read_b64_tr_b16 a[174:175], v2 offset:25280
  v_mfma_f32_16x16x32_bf16 v[176:179], a[136:139], a[64:67], v[176:179]
  s_waitcnt lgkmcnt(8)
  v_mfma_f32_16x16x32_bf16 v[192:195], a[144:147], a[64:67], v[192:195]
  ds_read_b64_tr_b16 a[128:129], v2 offset:28672
  v_mfma_f32_16x16x32_bf16 v[192:195], a[148:151], a[80:83], v[192:195]
  v_mfma_f32_16x16x32_bf16 v[196:199], a[148:151], a[84:87], v[196:199]
  ds_read_b64_tr_b16 a[130:131], v2 offset:32256
  v_mfma_f32_16x16x32_bf16 v[196:199], a[144:147], a[68:71], v[196:199]
  v_mfma_f32_16x16x32_bf16 v[200:203], a[144:147], a[72:75], v[200:203]
  ds_read_b64_tr_b16 a[132:133], v2 offset:35840
  v_mfma_f32_16x16x32_bf16 v[200:203], a[148:151], a[88:91], v[200:203]
  v_mfma_f32_16x16x32_bf16 v[204:207], a[148:151], a[92:95], v[204:207]
  buffer_load_dwordx4 v9, s[16:19], s52 offen offset:2048 lds
  v_mfma_f32_16x16x32_bf16 v[204:207], a[144:147], a[76:79], v[204:207]
  ds_read_b64_tr_b16 a[134:135], v2 offset:39424
  v_mfma_f32_16x16x32_bf16 v[220:223], a[152:155], a[76:79], v[220:223]
  ds_read_b64_tr_b16 a[136:137], v2 offset:28704
  v_mfma_f32_16x16x32_bf16 v[220:223], a[156:159], a[92:95], v[220:223]
  v_mfma_f32_16x16x32_bf16 v[216:219], a[156:159], a[88:91], v[216:219]
  ds_read_b64_tr_b16 a[138:139], v2 offset:32288
  v_mfma_f32_16x16x32_bf16 v[216:219], a[152:155], a[72:75], v[216:219]
  buffer_load_dwordx4 a[8:11], v0, s[36:39], s53 offen offset:2048 sc1
  v_mfma_f32_16x16x32_bf16 v[212:215], a[152:155], a[68:71], v[212:215]
  ds_read_b64_tr_b16 a[140:141], v2 offset:35872
  v_mfma_f32_16x16x32_bf16 v[212:215], a[156:159], a[84:87], v[212:215]
  v_mfma_f32_16x16x32_bf16 v[208:211], a[156:159], a[80:83], v[208:211]
  ds_read_b64_tr_b16 a[142:143], v2 offset:39456
  v_mfma_f32_16x16x32_bf16 v[208:211], a[152:155], a[64:67], v[208:211]
  s_waitcnt lgkmcnt(8)
  v_mfma_f32_16x16x32_bf16 v[224:227], a[160:163], a[64:67], v[224:227]
  ds_read_b64_tr_b16 a[144:145], v2 offset:28736
  v_mfma_f32_16x16x32_bf16 v[224:227], a[164:167], a[80:83], v[224:227]
  v_mfma_f32_16x16x32_bf16 v[228:231], a[164:167], a[84:87], v[228:231]
  ds_read_b64_tr_b16 a[146:147], v2 offset:32320
  v_mfma_f32_16x16x32_bf16 v[228:231], a[160:163], a[68:71], v[228:231]
  v_mfma_f32_16x16x32_bf16 v[232:235], a[160:163], a[72:75], v[232:235]
  ds_read_b64_tr_b16 a[148:149], v2 offset:35904
  v_mfma_f32_16x16x32_bf16 v[232:235], a[164:167], a[88:91], v[232:235]
  buffer_load_dwordx4 a[12:15], v0, s[36:39], s53 offen offset:3072 sc1
  v_mfma_f32_16x16x32_bf16 v[236:239], a[164:167], a[92:95], v[236:239]
  ds_read_b64_tr_b16 a[150:151], v2 offset:39488
  v_mfma_f32_16x16x32_bf16 v[236:239], a[160:163], a[76:79], v[236:239]
  v_mfma_f32_16x16x32_bf16 v[252:255], a[168:171], a[76:79], v[252:255]
  ds_read_b64_tr_b16 a[152:153], v2 offset:28768
  v_mfma_f32_16x16x32_bf16 v[252:255], a[172:175], a[92:95], v[252:255]
  s_bfe_u32 s52, s86, 0x40014
  s_mul_i32 s52, s52, 458752
  s_add_u32 m0, s88, 28672
  v_mfma_f32_16x16x32_bf16 v[248:251], a[172:175], a[88:91], v[248:251]
  ds_read_b64_tr_b16 a[154:155], v2 offset:32352
  v_mfma_f32_16x16x32_bf16 v[248:251], a[168:171], a[72:75], v[248:251]
  v_mfma_f32_16x16x32_bf16 v[244:247], a[168:171], a[68:71], v[244:247]
  ds_read_b64_tr_b16 a[156:157], v2 offset:35936
  v_mfma_f32_16x16x32_bf16 v[244:247], a[172:175], a[84:87], v[244:247]
  buffer_load_dwordx4 v3, s[16:19], s52 offen offset:0 lds
  v_mfma_f32_16x16x32_bf16 v[240:243], a[172:175], a[80:83], v[240:243]
  ds_read_b64_tr_b16 a[158:159], v2 offset:39520
  v_mfma_f32_16x16x32_bf16 v[240:243], a[168:171], a[64:67], v[240:243]
  s_waitcnt vmcnt(8) lgkmcnt(8)
  v_mfma_f32_16x16x32_bf16 v[32:35], a[128:131], a[96:99], v[32:35]
  s_add_u32 s53, s53, 4096
  ds_read_b64_tr_b16 a[160:161], v2 offset:28800
  v_mfma_f32_16x16x32_bf16 v[32:35], a[132:135], a[112:115], v[32:35]
  v_mfma_f32_16x16x32_bf16 v[36:39], a[132:135], a[116:119], v[36:39]
  ds_read_b64_tr_b16 a[162:163], v2 offset:32384
  v_mfma_f32_16x16x32_bf16 v[36:39], a[128:131], a[100:103], v[36:39]
  v_mfma_f32_16x16x32_bf16 v[40:43], a[128:131], a[104:107], v[40:43]
  buffer_load_dwordx4 a[16:19], v0, s[36:39], s53 offen offset:0 sc1
  v_mfma_f32_16x16x32_bf16 v[40:43], a[132:135], a[120:123], v[40:43]
  ds_read_b64_tr_b16 a[164:165], v2 offset:35968
  v_mfma_f32_16x16x32_bf16 v[44:47], a[132:135], a[124:127], v[44:47]
  ds_read_b64_tr_b16 a[166:167], v2 offset:39552
  v_mfma_f32_16x16x32_bf16 v[44:47], a[128:131], a[108:111], v[44:47]
  v_mfma_f32_16x16x32_bf16 v[60:63], a[136:139], a[108:111], v[60:63]
  ds_read_b64_tr_b16 a[168:169], v2 offset:28832
  v_mfma_f32_16x16x32_bf16 v[60:63], a[140:143], a[124:127], v[60:63]
  v_mfma_f32_16x16x32_bf16 v[56:59], a[140:143], a[120:123], v[56:59]
  ds_read_b64_tr_b16 a[170:171], v2 offset:32416
  v_mfma_f32_16x16x32_bf16 v[56:59], a[136:139], a[104:107], v[56:59]
  buffer_load_dwordx4 v4, s[16:19], s52 offen offset:1024 lds
  v_mfma_f32_16x16x32_bf16 v[52:55], a[136:139], a[100:103], v[52:55]
  ds_read_b64_tr_b16 a[172:173], v2 offset:36000
  v_mfma_f32_16x16x32_bf16 v[52:55], a[140:143], a[116:119], v[52:55]
  v_mfma_f32_16x16x32_bf16 v[48:51], a[140:143], a[112:115], v[48:51]
  ds_read_b64_tr_b16 a[174:175], v2 offset:39584
  v_mfma_f32_16x16x32_bf16 v[48:51], a[136:139], a[96:99], v[48:51]
  s_waitcnt lgkmcnt(8)
  v_mfma_f32_16x16x32_bf16 v[64:67], a[144:147], a[96:99], v[64:67]
  ds_read_b64_tr_b16 a[128:129], v2 offset:28864
  v_mfma_f32_16x16x32_bf16 v[64:67], a[148:151], a[112:115], v[64:67]
  v_mfma_f32_16x16x32_bf16 v[68:71], a[148:151], a[116:119], v[68:71]
  ds_read_b64_tr_b16 a[130:131], v2 offset:32448
  v_mfma_f32_16x16x32_bf16 v[68:71], a[144:147], a[100:103], v[68:71]
  buffer_load_dwordx4 a[20:23], v0, s[36:39], s53 offen offset:1024 sc1
  v_mfma_f32_16x16x32_bf16 v[72:75], a[144:147], a[104:107], v[72:75]
  ds_read_b64_tr_b16 a[132:133], v2 offset:36032
  v_mfma_f32_16x16x32_bf16 v[72:75], a[148:151], a[120:123], v[72:75]
  v_mfma_f32_16x16x32_bf16 v[76:79], a[148:151], a[124:127], v[76:79]
  ds_read_b64_tr_b16 a[134:135], v2 offset:39616
  v_mfma_f32_16x16x32_bf16 v[76:79], a[144:147], a[108:111], v[76:79]
  v_mfma_f32_16x16x32_bf16 v[92:95], a[152:155], a[108:111], v[92:95]
  ds_read_b64_tr_b16 a[136:137], v2 offset:43008
  v_mfma_f32_16x16x32_bf16 v[92:95], a[156:159], a[124:127], v[92:95]
  v_mfma_f32_16x16x32_bf16 v[88:91], a[156:159], a[120:123], v[88:91]
  buffer_load_dwordx4 v5, s[16:19], s52 offen offset:2048 lds
  v_mfma_f32_16x16x32_bf16 v[88:91], a[152:155], a[104:107], v[88:91]
  ds_read_b64_tr_b16 a[138:139], v2 offset:46592
  v_mfma_f32_16x16x32_bf16 v[84:87], a[152:155], a[100:103], v[84:87]
  ds_read_b64_tr_b16 a[140:141], v2 offset:50176
  v_mfma_f32_16x16x32_bf16 v[84:87], a[156:159], a[116:119], v[84:87]
  v_mfma_f32_16x16x32_bf16 v[80:83], a[156:159], a[112:115], v[80:83]
  ds_read_b64_tr_b16 a[142:143], v2 offset:53760
  v_mfma_f32_16x16x32_bf16 v[80:83], a[152:155], a[96:99], v[80:83]
  s_waitcnt lgkmcnt(8)
  v_mfma_f32_16x16x32_bf16 v[96:99], a[160:163], a[96:99], v[96:99]
  ds_read_b64_tr_b16 a[144:145], v2 offset:43040
  v_mfma_f32_16x16x32_bf16 v[96:99], a[164:167], a[112:115], v[96:99]
  v_mfma_f32_16x16x32_bf16 v[100:103], a[164:167], a[116:119], v[100:103]
  buffer_load_dwordx4 a[24:27], v0, s[36:39], s53 offen offset:2048 sc1
  v_mfma_f32_16x16x32_bf16 v[100:103], a[160:163], a[100:103], v[100:103]
  ds_read_b64_tr_b16 a[146:147], v2 offset:46624
  v_mfma_f32_16x16x32_bf16 v[104:107], a[160:163], a[104:107], v[104:107]
  ds_read_b64_tr_b16 a[148:149], v2 offset:50208
  v_mfma_f32_16x16x32_bf16 v[104:107], a[164:167], a[120:123], v[104:107]
  v_mfma_f32_16x16x32_bf16 v[108:111], a[164:167], a[124:127], v[108:111]
  ds_read_b64_tr_b16 a[150:151], v2 offset:53792
  v_mfma_f32_16x16x32_bf16 v[108:111], a[160:163], a[108:111], v[108:111]
  v_mfma_f32_16x16x32_bf16 v[124:127], a[168:171], a[108:111], v[124:127]
  ds_read_b64_tr_b16 a[152:153], v2 offset:43072
  v_mfma_f32_16x16x32_bf16 v[124:127], a[172:175], a[124:127], v[124:127]
  buffer_load_dwordx4 v6, s[16:19], s52 offen offset:3072 lds
  v_mfma_f32_16x16x32_bf16 v[120:123], a[172:175], a[120:123], v[120:123]
  ds_read_b64_tr_b16 a[154:155], v2 offset:46656
  v_mfma_f32_16x16x32_bf16 v[120:123], a[168:171], a[104:107], v[120:123]
  v_mfma_f32_16x16x32_bf16 v[116:119], a[168:171], a[100:103], v[116:119]
  ds_read_b64_tr_b16 a[156:157], v2 offset:50240
  v_mfma_f32_16x16x32_bf16 v[116:119], a[172:175], a[116:119], v[116:119]
  v_mfma_f32_16x16x32_bf16 v[112:115], a[172:175], a[112:115], v[112:115]
  ds_read_b64_tr_b16 a[158:159], v2 offset:53824
  v_mfma_f32_16x16x32_bf16 v[112:115], a[168:171], a[96:99], v[112:115]
  s_waitcnt lgkmcnt(8)
  v_mfma_f32_16x16x32_bf16 v[128:131], a[128:131], a[96:99], v[128:131]
  ds_read_b64_tr_b16 a[160:161], v2 offset:43104
  v_mfma_f32_16x16x32_bf16 v[128:131], a[132:135], a[112:115], v[128:131]
  buffer_load_dwordx4 a[28:31], v0, s[36:39], s53 offen offset:3072 sc1
  v_mfma_f32_16x16x32_bf16 v[132:135], a[132:135], a[116:119], v[132:135]
  ds_read_b64_tr_b16 a[162:163], v2 offset:46688
  v_mfma_f32_16x16x32_bf16 v[132:135], a[128:131], a[100:103], v[132:135]
  v_mfma_f32_16x16x32_bf16 v[136:139], a[128:131], a[104:107], v[136:139]
  s_add_u32 m0, s88, 32768
  ds_read_b64_tr_b16 a[164:165], v2 offset:50272
  v_mfma_f32_16x16x32_bf16 v[136:139], a[132:135], a[120:123], v[136:139]
  v_mfma_f32_16x16x32_bf16 v[140:143], a[132:135], a[124:127], v[140:143]
  ds_read_b64_tr_b16 a[166:167], v2 offset:53856
  v_mfma_f32_16x16x32_bf16 v[140:143], a[128:131], a[108:111], v[140:143]
  v_mfma_f32_16x16x32_bf16 v[156:159], a[136:139], a[108:111], v[156:159]
  buffer_load_dwordx4 v7, s[16:19], s52 offen offset:0 lds
  s_bfe_u32 s53, s86, 0x40014
  v_mfma_f32_16x16x32_bf16 v[156:159], a[140:143], a[124:127], v[156:159]
  s_lshl_b32 s53, s53, 13
  s_add_u32 s53, s53, s89
  ds_read_b64_tr_b16 a[168:169], v2 offset:43136
  v_mfma_f32_16x16x32_bf16 v[152:155], a[140:143], a[120:123], v[152:155]
  ds_read_b64_tr_b16 a[170:171], v2 offset:46720
  v_mfma_f32_16x16x32_bf16 v[152:155], a[136:139], a[104:107], v[152:155]
  v_mfma_f32_16x16x32_bf16 v[148:151], a[136:139], a[100:103], v[148:151]
  ds_read_b64_tr_b16 a[172:173], v2 offset:50304
  v_mfma_f32_16x16x32_bf16 v[148:151], a[140:143], a[116:119], v[148:151]
  buffer_load_dwordx4 a[32:35], v0, s[36:39], s53 offen offset:0 sc1
  v_mfma_f32_16x16x32_bf16 v[144:147], a[140:143], a[112:115], v[144:147]
  ds_read_b64_tr_b16 a[174:175], v2 offset:53888
  v_mfma_f32_16x16x32_bf16 v[144:147], a[136:139], a[96:99], v[144:147]
  s_waitcnt lgkmcnt(8)
  v_mfma_f32_16x16x32_bf16 v[160:163], a[144:147], a[96:99], v[160:163]
  ds_read_b64_tr_b16 a[128:129], v2 offset:43168
  v_mfma_f32_16x16x32_bf16 v[160:163], a[148:151], a[112:115], v[160:163]
  v_mfma_f32_16x16x32_bf16 v[164:167], a[148:151], a[116:119], v[164:167]
  ds_read_b64_tr_b16 a[130:131], v2 offset:46752
  v_mfma_f32_16x16x32_bf16 v[164:167], a[144:147], a[100:103], v[164:167]
  v_mfma_f32_16x16x32_bf16 v[168:171], a[144:147], a[104:107], v[168:171]
  ds_read_b64_tr_b16 a[132:133], v2 offset:50336
  v_mfma_f32_16x16x32_bf16 v[168:171], a[148:151], a[120:123], v[168:171]
  v_mfma_f32_16x16x32_bf16 v[172:175], a[148:151], a[124:127], v[172:175]
  ds_read_b64_tr_b16 a[134:135], v2 offset:53920
  v_mfma_f32_16x16x32_bf16 v[172:175], a[144:147], a[108:111], v[172:175]
  s_waitcnt vmcnt(12)
  s_barrier
  buffer_load_dwordx4 v8, s[16:19], s52 offen offset:1024 lds
  v_mfma_f32_16x16x32_bf16 v[188:191], a[152:155], a[108:111], v[188:191]
  ds_read_b64_tr_b16 a[136:137], v2 offset:43200
  v_mfma_f32_16x16x32_bf16 v[188:191], a[156:159], a[124:127], v[188:191]
  v_mfma_f32_16x16x32_bf16 v[184:187], a[156:159], a[120:123], v[184:187]
  ds_read_b64_tr_b16 a[138:139], v2 offset:46784
  v_mfma_f32_16x16x32_bf16 v[184:187], a[152:155], a[104:107], v[184:187]
  v_mfma_f32_16x16x32_bf16 v[180:183], a[152:155], a[100:103], v[180:183]
  buffer_load_dwordx4 a[36:39], v0, s[36:39], s53 offen offset:1024 sc1
  v_mfma_f32_16x16x32_bf16 v[180:183], a[156:159], a[116:119], v[180:183]
  ds_read_b64_tr_b16 a[140:141], v2 offset:50368
  v_mfma_f32_16x16x32_bf16 v[176:179], a[156:159], a[112:115], v[176:179]
  ds_read_b64_tr_b16 a[142:143], v2 offset:53952
  v_mfma_f32_16x16x32_bf16 v[176:179], a[152:155], a[96:99], v[176:179]
  s_waitcnt lgkmcnt(8)
  v_mfma_f32_16x16x32_bf16 v[192:195], a[160:163], a[96:99], v[192:195]
  ds_read_b64_tr_b16 a[144:145], v1 offset:0
  v_mfma_f32_16x16x32_bf16 v[192:195], a[164:167], a[112:115], v[192:195]
  v_mfma_f32_16x16x32_bf16 v[196:199], a[164:167], a[116:119], v[196:199]
  ds_read_b64_tr_b16 a[146:147], v1 offset:3584
  v_mfma_f32_16x16x32_bf16 v[196:199], a[160:163], a[100:103], v[196:199]
  v_mfma_f32_16x16x32_bf16 v[200:203], a[160:163], a[104:107], v[200:203]
  ds_read_b64_tr_b16 a[148:149], v1 offset:7168
  v_mfma_f32_16x16x32_bf16 v[200:203], a[164:167], a[120:123], v[200:203]
  v_mfma_f32_16x16x32_bf16 v[204:207], a[164:167], a[124:127], v[204:207]
  buffer_load_dwordx4 v9, s[16:19], s52 offen offset:2048 lds
  v_mfma_f32_16x16x32_bf16 v[204:207], a[160:163], a[108:111], v[204:207]
  ds_read_b64_tr_b16 a[150:151], v1 offset:10752
  v_mfma_f32_16x16x32_bf16 v[220:223], a[168:171], a[108:111], v[220:223]
  ds_read_b64_tr_b16 a[152:153], v1 offset:32
  v_mfma_f32_16x16x32_bf16 v[220:223], a[172:175], a[124:127], v[220:223]
  v_mfma_f32_16x16x32_bf16 v[216:219], a[172:175], a[120:123], v[216:219]
  ds_read_b64_tr_b16 a[154:155], v1 offset:3616
  v_mfma_f32_16x16x32_bf16 v[216:219], a[168:171], a[104:107], v[216:219]
  buffer_load_dwordx4 a[40:43], v0, s[36:39], s53 offen offset:2048 sc1
  v_mfma_f32_16x16x32_bf16 v[212:215], a[168:171], a[100:103], v[212:215]
  ds_read_b64_tr_b16 a[156:157], v1 offset:7200
  v_mfma_f32_16x16x32_bf16 v[212:215], a[172:175], a[116:119], v[212:215]
  v_mfma_f32_16x16x32_bf16 v[208:211], a[172:175], a[112:115], v[208:211]
  ds_read_b64_tr_b16 a[158:159], v1 offset:10784
  v_mfma_f32_16x16x32_bf16 v[208:211], a[168:171], a[96:99], v[208:211]
  s_waitcnt lgkmcnt(8)
  v_mfma_f32_16x16x32_bf16 v[224:227], a[128:131], a[96:99], v[224:227]
  ds_read_b64_tr_b16 a[160:161], v1 offset:64
  v_mfma_f32_16x16x32_bf16 v[224:227], a[132:135], a[112:115], v[224:227]
  v_mfma_f32_16x16x32_bf16 v[228:231], a[132:135], a[116:119], v[228:231]
  ds_read_b64_tr_b16 a[162:163], v1 offset:3648
  v_mfma_f32_16x16x32_bf16 v[228:231], a[128:131], a[100:103], v[228:231]
  v_mfma_f32_16x16x32_bf16 v[232:235], a[128:131], a[104:107], v[232:235]
  ds_read_b64_tr_b16 a[164:165], v1 offset:7232
  v_mfma_f32_16x16x32_bf16 v[232:235], a[132:135], a[120:123], v[232:235]
  buffer_load_dwordx4 a[44:47], v0, s[36:39], s53 offen offset:3072 sc1
  v_mfma_f32_16x16x32_bf16 v[236:239], a[132:135], a[124:127], v[236:239]
  ds_read_b64_tr_b16 a[166:167], v1 offset:10816
  v_mfma_f32_16x16x32_bf16 v[236:239], a[128:131], a[108:111], v[236:239]
  v_mfma_f32_16x16x32_bf16 v[252:255], a[136:139], a[108:111], v[252:255]
  ds_read_b64_tr_b16 a[168:169], v1 offset:96
  v_mfma_f32_16x16x32_bf16 v[252:255], a[140:143], a[124:127], v[252:255]
  s_bfe_u32 s52, s86, 0x40018
  s_mul_i32 s52, s52, 458752
  s_add_u32 m0, s88, 57344
  v_mfma_f32_16x16x32_bf16 v[248:251], a[140:143], a[120:123], v[248:251]
  ds_read_b64_tr_b16 a[170:171], v1 offset:3680
  v_mfma_f32_16x16x32_bf16 v[248:251], a[136:139], a[104:107], v[248:251]
  v_mfma_f32_16x16x32_bf16 v[244:247], a[136:139], a[100:103], v[244:247]
  ds_read_b64_tr_b16 a[172:173], v1 offset:7264
  v_mfma_f32_16x16x32_bf16 v[244:247], a[140:143], a[116:119], v[244:247]
  buffer_load_dwordx4 v3, s[16:19], s52 offen offset:0 lds
  v_mfma_f32_16x16x32_bf16 v[240:243], a[140:143], a[112:115], v[240:243]
  ds_read_b64_tr_b16 a[174:175], v1 offset:10848
  v_mfma_f32_16x16x32_bf16 v[240:243], a[136:139], a[96:99], v[240:243]
  s_waitcnt vmcnt(8) lgkmcnt(8)
  v_mfma_f32_16x16x32_bf16 v[32:35], a[144:147], a[0:3], v[32:35]
  s_add_u32 s53, s53, 4096
  ds_read_b64_tr_b16 a[128:129], v1 offset:128
  v_mfma_f32_16x16x32_bf16 v[32:35], a[148:151], a[16:19], v[32:35]
  v_mfma_f32_16x16x32_bf16 v[36:39], a[148:151], a[20:23], v[36:39]
  ds_read_b64_tr_b16 a[130:131], v1 offset:3712
  v_mfma_f32_16x16x32_bf16 v[36:39], a[144:147], a[4:7], v[36:39]
  v_mfma_f32_16x16x32_bf16 v[40:43], a[144:147], a[8:11], v[40:43]
  buffer_load_dwordx4 a[48:51], v0, s[36:39], s53 offen offset:0 sc1
  v_mfma_f32_16x16x32_bf16 v[40:43], a[148:151], a[24:27], v[40:43]
  ds_read_b64_tr_b16 a[132:133], v1 offset:7296
  v_mfma_f32_16x16x32_bf16 v[44:47], a[148:151], a[28:31], v[44:47]
  ds_read_b64_tr_b16 a[134:135], v1 offset:10880
  v_mfma_f32_16x16x32_bf16 v[44:47], a[144:147], a[12:15], v[44:47]
  v_mfma_f32_16x16x32_bf16 v[60:63], a[152:155], a[12:15], v[60:63]
  ds_read_b64_tr_b16 a[136:137], v1 offset:160
  v_mfma_f32_16x16x32_bf16 v[60:63], a[156:159], a[28:31], v[60:63]
  v_mfma_f32_16x16x32_bf16 v[56:59], a[156:159], a[24:27], v[56:59]
  ds_read_b64_tr_b16 a[138:139], v1 offset:3744
  v_mfma_f32_16x16x32_bf16 v[56:59], a[152:155], a[8:11], v[56:59]
  buffer_load_dwordx4 v4, s[16:19], s52 offen offset:1024 lds
  v_mfma_f32_16x16x32_bf16 v[52:55], a[152:155], a[4:7], v[52:55]
  ds_read_b64_tr_b16 a[140:141], v1 offset:7328
  v_mfma_f32_16x16x32_bf16 v[52:55], a[156:159], a[20:23], v[52:55]
  v_mfma_f32_16x16x32_bf16 v[48:51], a[156:159], a[16:19], v[48:51]
  ds_read_b64_tr_b16 a[142:143], v1 offset:10912
  v_mfma_f32_16x16x32_bf16 v[48:51], a[152:155], a[0:3], v[48:51]
  s_waitcnt lgkmcnt(8)
  v_mfma_f32_16x16x32_bf16 v[64:67], a[160:163], a[0:3], v[64:67]
  ds_read_b64_tr_b16 a[144:145], v1 offset:192
  v_mfma_f32_16x16x32_bf16 v[64:67], a[164:167], a[16:19], v[64:67]
  v_mfma_f32_16x16x32_bf16 v[68:71], a[164:167], a[20:23], v[68:71]
  ds_read_b64_tr_b16 a[146:147], v1 offset:3776
  v_mfma_f32_16x16x32_bf16 v[68:71], a[160:163], a[4:7], v[68:71]
  buffer_load_dwordx4 a[52:55], v0, s[36:39], s53 offen offset:1024 sc1
  v_mfma_f32_16x16x32_bf16 v[72:75], a[160:163], a[8:11], v[72:75]
  ds_read_b64_tr_b16 a[148:149], v1 offset:7360
  v_mfma_f32_16x16x32_bf16 v[72:75], a[164:167], a[24:27], v[72:75]
  v_mfma_f32_16x16x32_bf16 v[76:79], a[164:167], a[28:31], v[76:79]
  ds_read_b64_tr_b16 a[150:151], v1 offset:10944
  v_mfma_f32_16x16x32_bf16 v[76:79], a[160:163], a[12:15], v[76:79]
  v_mfma_f32_16x16x32_bf16 v[92:95], a[168:171], a[12:15], v[92:95]
  ds_read_b64_tr_b16 a[152:153], v1 offset:14336
  v_mfma_f32_16x16x32_bf16 v[92:95], a[172:175], a[28:31], v[92:95]
  v_mfma_f32_16x16x32_bf16 v[88:91], a[172:175], a[24:27], v[88:91]
  buffer_load_dwordx4 v5, s[16:19], s52 offen offset:2048 lds
  v_mfma_f32_16x16x32_bf16 v[88:91], a[168:171], a[8:11], v[88:91]
  ds_read_b64_tr_b16 a[154:155], v1 offset:17920
  v_mfma_f32_16x16x32_bf16 v[84:87], a[168:171], a[4:7], v[84:87]
  ds_read_b64_tr_b16 a[156:157], v1 offset:21504
  v_mfma_f32_16x16x32_bf16 v[84:87], a[172:175], a[20:23], v[84:87]
  v_mfma_f32_16x16x32_bf16 v[80:83], a[172:175], a[16:19], v[80:83]
  ds_read_b64_tr_b16 a[158:159], v1 offset:25088
  v_mfma_f32_16x16x32_bf16 v[80:83], a[168:171], a[0:3], v[80:83]
  s_waitcnt lgkmcnt(8)
  v_mfma_f32_16x16x32_bf16 v[96:99], a[128:131], a[0:3], v[96:99]
  ds_read_b64_tr_b16 a[160:161], v1 offset:14368
  v_mfma_f32_16x16x32_bf16 v[96:99], a[132:135], a[16:19], v[96:99]
  v_mfma_f32_16x16x32_bf16 v[100:103], a[132:135], a[20:23], v[100:103]
  buffer_load_dwordx4 a[56:59], v0, s[36:39], s53 offen offset:2048 sc1
  v_mfma_f32_16x16x32_bf16 v[100:103], a[128:131], a[4:7], v[100:103]
  ds_read_b64_tr_b16 a[162:163], v1 offset:17952
  v_mfma_f32_16x16x32_bf16 v[104:107], a[128:131], a[8:11], v[104:107]
  ds_read_b64_tr_b16 a[164:165], v1 offset:21536
  v_mfma_f32_16x16x32_bf16 v[104:107], a[132:135], a[24:27], v[104:107]
  v_mfma_f32_16x16x32_bf16 v[108:111], a[132:135], a[28:31], v[108:111]
  ds_read_b64_tr_b16 a[166:167], v1 offset:25120
  v_mfma_f32_16x16x32_bf16 v[108:111], a[128:131], a[12:15], v[108:111]
  v_mfma_f32_16x16x32_bf16 v[124:127], a[136:139], a[12:15], v[124:127]
  ds_read_b64_tr_b16 a[168:169], v1 offset:14400
  v_mfma_f32_16x16x32_bf16 v[124:127], a[140:143], a[28:31], v[124:127]
  buffer_load_dwordx4 v6, s[16:19], s52 offen offset:3072 lds
  v_mfma_f32_16x16x32_bf16 v[120:123], a[140:143], a[24:27], v[120:123]
  ds_read_b64_tr_b16 a[170:171], v1 offset:17984
  v_mfma_f32_16x16x32_bf16 v[120:123], a[136:139], a[8:11], v[120:123]
  v_mfma_f32_16x16x32_bf16 v[116:119], a[136:139], a[4:7], v[116:119]
  ds_read_b64_tr_b16 a[172:173], v1 offset:21568
  v_mfma_f32_16x16x32_bf16 v[116:119], a[140:143], a[20:23], v[116:119]
  v_mfma_f32_16x16x32_bf16 v[112:115], a[140:143], a[16:19], v[112:115]
  ds_read_b64_tr_b16 a[174:175], v1 offset:25152
  v_mfma_f32_16x16x32_bf16 v[112:115], a[136:139], a[0:3], v[112:115]
  s_waitcnt lgkmcnt(8)
  v_mfma_f32_16x16x32_bf16 v[128:131], a[144:147], a[0:3], v[128:131]
  ds_read_b64_tr_b16 a[128:129], v1 offset:14432
  v_mfma_f32_16x16x32_bf16 v[128:131], a[148:151], a[16:19], v[128:131]
  buffer_load_dwordx4 a[60:63], v0, s[36:39], s53 offen offset:3072 sc1
  v_mfma_f32_16x16x32_bf16 v[132:135], a[148:151], a[20:23], v[132:135]
  ds_read_b64_tr_b16 a[130:131], v1 offset:18016
  v_mfma_f32_16x16x32_bf16 v[132:135], a[144:147], a[4:7], v[132:135]
  v_mfma_f32_16x16x32_bf16 v[136:139], a[144:147], a[8:11], v[136:139]
  s_add_u32 m0, s88, 61440
  ds_read_b64_tr_b16 a[132:133], v1 offset:21600
  v_mfma_f32_16x16x32_bf16 v[136:139], a[148:151], a[24:27], v[136:139]
  v_mfma_f32_16x16x32_bf16 v[140:143], a[148:151], a[28:31], v[140:143]
  ds_read_b64_tr_b16 a[134:135], v1 offset:25184
  v_mfma_f32_16x16x32_bf16 v[140:143], a[144:147], a[12:15], v[140:143]
  v_mfma_f32_16x16x32_bf16 v[156:159], a[152:155], a[12:15], v[156:159]
  buffer_load_dwordx4 v7, s[16:19], s52 offen offset:0 lds
  s_bfe_u32 s53, s86, 0x40018
  v_mfma_f32_16x16x32_bf16 v[156:159], a[156:159], a[28:31], v[156:159]
  s_lshl_b32 s53, s53, 13
  s_add_u32 s53, s53, s89
  ds_read_b64_tr_b16 a[136:137], v1 offset:14464
  v_mfma_f32_16x16x32_bf16 v[152:155], a[156:159], a[24:27], v[152:155]
  ds_read_b64_tr_b16 a[138:139], v1 offset:18048
  v_mfma_f32_16x16x32_bf16 v[152:155], a[152:155], a[8:11], v[152:155]
  v_mfma_f32_16x16x32_bf16 v[148:151], a[152:155], a[4:7], v[148:151]
  ds_read_b64_tr_b16 a[140:141], v1 offset:21632
  v_mfma_f32_16x16x32_bf16 v[148:151], a[156:159], a[20:23], v[148:151]
  buffer_load_dwordx4 a[64:67], v0, s[36:39], s53 offen offset:0 sc1
  v_mfma_f32_16x16x32_bf16 v[144:147], a[156:159], a[16:19], v[144:147]
  ds_read_b64_tr_b16 a[142:143], v1 offset:25216
  v_mfma_f32_16x16x32_bf16 v[144:147], a[152:155], a[0:3], v[144:147]
  s_waitcnt lgkmcnt(8)
  v_mfma_f32_16x16x32_bf16 v[160:163], a[160:163], a[0:3], v[160:163]
  ds_read_b64_tr_b16 a[144:145], v1 offset:14496
  v_mfma_f32_16x16x32_bf16 v[160:163], a[164:167], a[16:19], v[160:163]
  v_mfma_f32_16x16x32_bf16 v[164:167], a[164:167], a[20:23], v[164:167]
  ds_read_b64_tr_b16 a[146:147], v1 offset:18080
  v_mfma_f32_16x16x32_bf16 v[164:167], a[160:163], a[4:7], v[164:167]
  v_mfma_f32_16x16x32_bf16 v[168:171], a[160:163], a[8:11], v[168:171]
  ds_read_b64_tr_b16 a[148:149], v1 offset:21664
  v_mfma_f32_16x16x32_bf16 v[168:171], a[164:167], a[24:27], v[168:171]
  v_mfma_f32_16x16x32_bf16 v[172:175], a[164:167], a[28:31], v[172:175]
  ds_read_b64_tr_b16 a[150:151], v1 offset:25248
  v_mfma_f32_16x16x32_bf16 v[172:175], a[160:163], a[12:15], v[172:175]
  s_waitcnt vmcnt(12)
  s_barrier
  buffer_load_dwordx4 v8, s[16:19], s52 offen offset:1024 lds
  v_mfma_f32_16x16x32_bf16 v[188:191], a[168:171], a[12:15], v[188:191]
  ds_read_b64_tr_b16 a[152:153], v1 offset:14528
  v_mfma_f32_16x16x32_bf16 v[188:191], a[172:175], a[28:31], v[188:191]
  v_mfma_f32_16x16x32_bf16 v[184:187], a[172:175], a[24:27], v[184:187]
  ds_read_b64_tr_b16 a[154:155], v1 offset:18112
  v_mfma_f32_16x16x32_bf16 v[184:187], a[168:171], a[8:11], v[184:187]
  v_mfma_f32_16x16x32_bf16 v[180:183], a[168:171], a[4:7], v[180:183]
  buffer_load_dwordx4 a[68:71], v0, s[36:39], s53 offen offset:1024 sc1
  v_mfma_f32_16x16x32_bf16 v[180:183], a[172:175], a[20:23], v[180:183]
  ds_read_b64_tr_b16 a[156:157], v1 offset:21696
  v_mfma_f32_16x16x32_bf16 v[176:179], a[172:175], a[16:19], v[176:179]
  ds_read_b64_tr_b16 a[158:159], v1 offset:25280
  v_mfma_f32_16x16x32_bf16 v[176:179], a[168:171], a[0:3], v[176:179]
  s_waitcnt lgkmcnt(8)
  v_mfma_f32_16x16x32_bf16 v[192:195], a[128:131], a[0:3], v[192:195]
  ds_read_b64_tr_b16 a[160:161], v1 offset:28672
  v_mfma_f32_16x16x32_bf16 v[192:195], a[132:135], a[16:19], v[192:195]
  v_mfma_f32_16x16x32_bf16 v[196:199], a[132:135], a[20:23], v[196:199]
  ds_read_b64_tr_b16 a[162:163], v1 offset:32256
  v_mfma_f32_16x16x32_bf16 v[196:199], a[128:131], a[4:7], v[196:199]
  v_mfma_f32_16x16x32_bf16 v[200:203], a[128:131], a[8:11], v[200:203]
  ds_read_b64_tr_b16 a[164:165], v1 offset:35840
  v_mfma_f32_16x16x32_bf16 v[200:203], a[132:135], a[24:27], v[200:203]
  v_mfma_f32_16x16x32_bf16 v[204:207], a[132:135], a[28:31], v[204:207]
  buffer_load_dwordx4 v9, s[16:19], s52 offen offset:2048 lds
  v_mfma_f32_16x16x32_bf16 v[204:207], a[128:131], a[12:15], v[204:207]
  ds_read_b64_tr_b16 a[166:167], v1 offset:39424
  v_mfma_f32_16x16x32_bf16 v[220:223], a[136:139], a[12:15], v[220:223]
  ds_read_b64_tr_b16 a[168:169], v1 offset:28704
  v_mfma_f32_16x16x32_bf16 v[220:223], a[140:143], a[28:31], v[220:223]
  v_mfma_f32_16x16x32_bf16 v[216:219], a[140:143], a[24:27], v[216:219]
  ds_read_b64_tr_b16 a[170:171], v1 offset:32288
  v_mfma_f32_16x16x32_bf16 v[216:219], a[136:139], a[8:11], v[216:219]
  buffer_load_dwordx4 a[72:75], v0, s[36:39], s53 offen offset:2048 sc1
  v_mfma_f32_16x16x32_bf16 v[212:215], a[136:139], a[4:7], v[212:215]
  ds_read_b64_tr_b16 a[172:173], v1 offset:35872
  v_mfma_f32_16x16x32_bf16 v[212:215], a[140:143], a[20:23], v[212:215]
  v_mfma_f32_16x16x32_bf16 v[208:211], a[140:143], a[16:19], v[208:211]
  ds_read_b64_tr_b16 a[174:175], v1 offset:39456
  v_mfma_f32_16x16x32_bf16 v[208:211], a[136:139], a[0:3], v[208:211]
  s_waitcnt lgkmcnt(8)
  v_mfma_f32_16x16x32_bf16 v[224:227], a[144:147], a[0:3], v[224:227]
  ds_read_b64_tr_b16 a[128:129], v1 offset:28736
  v_mfma_f32_16x16x32_bf16 v[224:227], a[148:151], a[16:19], v[224:227]
  v_mfma_f32_16x16x32_bf16 v[228:231], a[148:151], a[20:23], v[228:231]
  ds_read_b64_tr_b16 a[130:131], v1 offset:32320
  v_mfma_f32_16x16x32_bf16 v[228:231], a[144:147], a[4:7], v[228:231]
  v_mfma_f32_16x16x32_bf16 v[232:235], a[144:147], a[8:11], v[232:235]
  ds_read_b64_tr_b16 a[132:133], v1 offset:35904
  v_mfma_f32_16x16x32_bf16 v[232:235], a[148:151], a[24:27], v[232:235]
  buffer_load_dwordx4 a[76:79], v0, s[36:39], s53 offen offset:3072 sc1
  v_mfma_f32_16x16x32_bf16 v[236:239], a[148:151], a[28:31], v[236:239]
  ds_read_b64_tr_b16 a[134:135], v1 offset:39488
  v_mfma_f32_16x16x32_bf16 v[236:239], a[144:147], a[12:15], v[236:239]
Hb2:
  s_cbranch_execz Hb2_1
  v_mfma_f32_16x16x32_bf16 v[252:255], a[152:155], a[12:15], v[252:255]
  ds_read_b64_tr_b16 a[136:137], v1 offset:28768
  v_mfma_f32_16x16x32_bf16 v[252:255], a[156:159], a[28:31], v[252:255]
  s_bfe_u32 s52, s86, 0x4001c
  s_mul_i32 s52, s52, 458752
  s_add_u32 m0, s88, 86016
  v_mfma_f32_16x16x32_bf16 v[248:251], a[156:159], a[24:27], v[248:251]
  buffer_load_dwordx4 a[208:211], v0, s[36:39], s57 offen offset:0 sc1
  v_add_u32 v31, 57344, v31
  v_mfma_f32_16x16x32_bf16 v[248:251], a[152:155], a[8:11], v[248:251]
  ds_read_b64_tr_b16 a[138:139], v1 offset:32352
  v_mfma_f32_16x16x32_bf16 v[244:247], a[152:155], a[4:7], v[244:247]
  ds_read_b64_tr_b16 a[140:141], v1 offset:35936
  v_mfma_f32_16x16x32_bf16 v[244:247], a[156:159], a[20:23], v[244:247]
  v_mfma_f32_16x16x32_bf16 v[240:243], a[156:159], a[16:19], v[240:243]
  ds_read_b64_tr_b16 a[142:143], v1 offset:39520
  v_mfma_f32_16x16x32_bf16 v[240:243], a[152:155], a[0:3], v[240:243]
  s_waitcnt vmcnt(8) lgkmcnt(8)
  buffer_load_dwordx4 a[212:215], v0, s[36:39], s57 offen offset:1024 sc1
  v_mfma_f32_16x16x32_bf16 v[32:35], a[160:163], a[32:35], v[32:35]
  ds_read_b64_tr_b16 a[144:145], v1 offset:28800
  v_mfma_f32_16x16x32_bf16 v[32:35], a[164:167], a[48:51], v[32:35]
  v_mfma_f32_16x16x32_bf16 v[36:39], a[164:167], a[52:55], v[36:39]
  ds_read_b64_tr_b16 a[146:147], v1 offset:32384
  v_mfma_f32_16x16x32_bf16 v[36:39], a[160:163], a[36:39], v[36:39]
  v_mfma_f32_16x16x32_bf16 v[40:43], a[160:163], a[40:43], v[40:43]
  buffer_load_dwordx4 v3, s[16:19], s52 offen offset:0 lds
  s_add_u32 s53, s53, 4096
  v_mfma_f32_16x16x32_bf16 v[40:43], a[164:167], a[56:59], v[40:43]
  ds_read_b64_tr_b16 a[148:149], v1 offset:35968
  v_mfma_f32_16x16x32_bf16 v[44:47], a[164:167], a[60:63], v[44:47]
  ds_read_b64_tr_b16 a[150:151], v1 offset:39552
  v_mfma_f32_16x16x32_bf16 v[44:47], a[160:163], a[44:47], v[44:47]
  v_mfma_f32_16x16x32_bf16 v[60:63], a[168:171], a[44:47], v[60:63]
  ds_read_b64_tr_b16 a[152:153], v1 offset:28832
  v_mfma_f32_16x16x32_bf16 v[60:63], a[172:175], a[60:63], v[60:63]
  buffer_load_dwordx4 a[80:83], v0, s[36:39], s53 offen offset:0 sc1
  v_mfma_f32_16x16x32_bf16 v[56:59], a[172:175], a[56:59], v[56:59]
  ds_read_b64_tr_b16 a[154:155], v1 offset:32416
  v_mfma_f32_16x16x32_bf16 v[56:59], a[168:171], a[40:43], v[56:59]
  v_mfma_f32_16x16x32_bf16 v[52:55], a[168:171], a[36:39], v[52:55]
  ds_read_b64_tr_b16 a[156:157], v1 offset:36000
  v_mfma_f32_16x16x32_bf16 v[52:55], a[172:175], a[52:55], v[52:55]
  v_mfma_f32_16x16x32_bf16 v[48:51], a[172:175], a[48:51], v[48:51]
  buffer_load_dwordx4 v4, s[16:19], s52 offen offset:1024 lds
  v_mfma_f32_16x16x32_bf16 v[48:51], a[168:171], a[32:35], v[48:51]
  s_waitcnt lgkmcnt(7)
  ds_read_b64_tr_b16 a[158:159], v1 offset:39584
  v_mfma_f32_16x16x32_bf16 v[64:67], a[128:131], a[32:35], v[64:67]
  ds_read_b64_tr_b16 a[160:161], v1 offset:28864
  v_mfma_f32_16x16x32_bf16 v[64:67], a[132:135], a[48:51], v[64:67]
  v_mfma_f32_16x16x32_bf16 v[68:71], a[132:135], a[52:55], v[68:71]
  ds_read_b64_tr_b16 a[162:163], v1 offset:32448
  v_mfma_f32_16x16x32_bf16 v[68:71], a[128:131], a[36:39], v[68:71]
  buffer_load_dwordx4 a[84:87], v0, s[36:39], s53 offen offset:1024 sc1
  v_mfma_f32_16x16x32_bf16 v[72:75], a[128:131], a[40:43], v[72:75]
  ds_read_b64_tr_b16 a[164:165], v1 offset:36032
  v_mfma_f32_16x16x32_bf16 v[72:75], a[132:135], a[56:59], v[72:75]
  v_mfma_f32_16x16x32_bf16 v[76:79], a[132:135], a[60:63], v[76:79]
  ds_read_b64_tr_b16 a[166:167], v1 offset:39616
  v_mfma_f32_16x16x32_bf16 v[76:79], a[128:131], a[44:47], v[76:79]
  v_mfma_f32_16x16x32_bf16 v[92:95], a[136:139], a[44:47], v[92:95]
  ds_read_b64_tr_b16 a[168:169], v1 offset:43008
  v_mfma_f32_16x16x32_bf16 v[92:95], a[140:143], a[60:63], v[92:95]
  v_mfma_f32_16x16x32_bf16 v[88:91], a[140:143], a[56:59], v[88:91]
  buffer_load_dwordx4 v5, s[16:19], s52 offen offset:2048 lds
  v_mfma_f32_16x16x32_bf16 v[88:91], a[136:139], a[40:43], v[88:91]
  ds_read_b64_tr_b16 a[170:171], v1 offset:46592
  v_mfma_f32_16x16x32_bf16 v[84:87], a[136:139], a[36:39], v[84:87]
  ds_read_b64_tr_b16 a[172:173], v1 offset:50176
  v_mfma_f32_16x16x32_bf16 v[84:87], a[140:143], a[52:55], v[84:87]
  v_mfma_f32_16x16x32_bf16 v[80:83], a[140:143], a[48:51], v[80:83]
  ds_read_b64_tr_b16 a[174:175], v1 offset:53760
  v_mfma_f32_16x16x32_bf16 v[80:83], a[136:139], a[32:35], v[80:83]
  s_waitcnt lgkmcnt(8)
  v_mfma_f32_16x16x32_bf16 v[96:99], a[144:147], a[32:35], v[96:99]
  ds_read_b64_tr_b16 a[128:129], v1 offset:43040
  v_mfma_f32_16x16x32_bf16 v[96:99], a[148:151], a[48:51], v[96:99]
  v_mfma_f32_16x16x32_bf16 v[100:103], a[148:151], a[52:55], v[100:103]
  buffer_load_dwordx4 a[88:91], v0, s[36:39], s53 offen offset:2048 sc1
  v_mfma_f32_16x16x32_bf16 v[100:103], a[144:147], a[36:39], v[100:103]
  ds_read_b64_tr_b16 a[130:131], v1 offset:46624
  v_mfma_f32_16x16x32_bf16 v[104:107], a[144:147], a[40:43], v[104:107]
  ds_read_b64_tr_b16 a[132:133], v1 offset:50208
  v_mfma_f32_16x16x32_bf16 v[104:107], a[148:151], a[56:59], v[104:107]
  v_mfma_f32_16x16x32_bf16 v[108:111], a[148:151], a[60:63], v[108:111]
  ds_read_b64_tr_b16 a[134:135], v1 offset:53792
  v_mfma_f32_16x16x32_bf16 v[108:111], a[144:147], a[44:47], v[108:111]
  v_mfma_f32_16x16x32_bf16 v[124:127], a[152:155], a[44:47], v[124:127]
  ds_read_b64_tr_b16 a[136:137], v1 offset:43072
  v_mfma_f32_16x16x32_bf16 v[124:127], a[156:159], a[60:63], v[124:127]
  buffer_load_dwordx4 v6, s[16:19], s52 offen offset:3072 lds
  v_mfma_f32_16x16x32_bf16 v[120:123], a[156:159], a[56:59], v[120:123]
  ds_read_b64_tr_b16 a[138:139], v1 offset:46656
  v_mfma_f32_16x16x32_bf16 v[120:123], a[152:155], a[40:43], v[120:123]
  v_mfma_f32_16x16x32_bf16 v[116:119], a[152:155], a[36:39], v[116:119]
  ds_read_b64_tr_b16 a[140:141], v1 offset:50240
  v_mfma_f32_16x16x32_bf16 v[116:119], a[156:159], a[52:55], v[116:119]
  v_mfma_f32_16x16x32_bf16 v[112:115], a[156:159], a[48:51], v[112:115]
  ds_read_b64_tr_b16 a[142:143], v1 offset:53824
  v_mfma_f32_16x16x32_bf16 v[112:115], a[152:155], a[32:35], v[112:115]
  s_waitcnt lgkmcnt(8)
  v_mfma_f32_16x16x32_bf16 v[128:131], a[160:163], a[32:35], v[128:131]
  ds_read_b64_tr_b16 a[144:145], v1 offset:43104
  v_mfma_f32_16x16x32_bf16 v[128:131], a[164:167], a[48:51], v[128:131]
  buffer_load_dwordx4 a[92:95], v0, s[36:39], s53 offen offset:3072 sc1
  v_mfma_f32_16x16x32_bf16 v[132:135], a[164:167], a[52:55], v[132:135]
  ds_read_b64_tr_b16 a[146:147], v1 offset:46688
  v_mfma_f32_16x16x32_bf16 v[132:135], a[160:163], a[36:39], v[132:135]
  v_mfma_f32_16x16x32_bf16 v[136:139], a[160:163], a[40:43], v[136:139]
  s_add_u32 m0, s88, 90112
  ds_read_b64_tr_b16 a[148:149], v1 offset:50272
  v_mfma_f32_16x16x32_bf16 v[136:139], a[164:167], a[56:59], v[136:139]
  v_mfma_f32_16x16x32_bf16 v[140:143], a[164:167], a[60:63], v[140:143]
  ds_read_b64_tr_b16 a[150:151], v1 offset:53856
  v_mfma_f32_16x16x32_bf16 v[140:143], a[160:163], a[44:47], v[140:143]
  v_mfma_f32_16x16x32_bf16 v[156:159], a[168:171], a[44:47], v[156:159]
  buffer_load_dwordx4 v7, s[16:19], s52 offen offset:0 lds
  s_bfe_u32 s53, s86, 0x4001c
  v_mfma_f32_16x16x32_bf16 v[156:159], a[172:175], a[60:63], v[156:159]
  s_lshl_b32 s53, s53, 13
  s_add_u32 s53, s53, s89
  ds_read_b64_tr_b16 a[152:153], v1 offset:43136
  v_mfma_f32_16x16x32_bf16 v[152:155], a[172:175], a[56:59], v[152:155]
  ds_read_b64_tr_b16 a[154:155], v1 offset:46720
  v_mfma_f32_16x16x32_bf16 v[152:155], a[168:171], a[40:43], v[152:155]
  v_mfma_f32_16x16x32_bf16 v[148:151], a[168:171], a[36:39], v[148:151]
  ds_read_b64_tr_b16 a[156:157], v1 offset:50304
  v_mfma_f32_16x16x32_bf16 v[148:151], a[172:175], a[52:55], v[148:151]
  buffer_load_dwordx4 a[96:99], v0, s[36:39], s53 offen offset:0 sc1
  v_mfma_f32_16x16x32_bf16 v[144:147], a[172:175], a[48:51], v[144:147]
  ds_read_b64_tr_b16 a[158:159], v1 offset:53888
  v_mfma_f32_16x16x32_bf16 v[144:147], a[168:171], a[32:35], v[144:147]
  s_waitcnt lgkmcnt(8)
  v_mfma_f32_16x16x32_bf16 v[160:163], a[128:131], a[32:35], v[160:163]
  ds_read_b64_tr_b16 a[160:161], v1 offset:43168
  v_mfma_f32_16x16x32_bf16 v[160:163], a[132:135], a[48:51], v[160:163]
  v_mfma_f32_16x16x32_bf16 v[164:167], a[132:135], a[52:55], v[164:167]
  ds_read_b64_tr_b16 a[162:163], v1 offset:46752
  v_mfma_f32_16x16x32_bf16 v[164:167], a[128:131], a[36:39], v[164:167]
  v_mfma_f32_16x16x32_bf16 v[168:171], a[128:131], a[40:43], v[168:171]
  ds_read_b64_tr_b16 a[164:165], v1 offset:50336
  v_mfma_f32_16x16x32_bf16 v[168:171], a[132:135], a[56:59], v[168:171]
  v_mfma_f32_16x16x32_bf16 v[172:175], a[132:135], a[60:63], v[172:175]
  ds_read_b64_tr_b16 a[166:167], v1 offset:53920
  v_mfma_f32_16x16x32_bf16 v[172:175], a[128:131], a[44:47], v[172:175]
  s_waitcnt vmcnt(14)
  s_barrier
  buffer_load_dwordx4 v8, s[16:19], s52 offen offset:1024 lds
  v_mfma_f32_16x16x32_bf16 v[188:191], a[136:139], a[44:47], v[188:191]
  ds_read_b64_tr_b16 a[168:169], v1 offset:43200
  v_mfma_f32_16x16x32_bf16 v[188:191], a[140:143], a[60:63], v[188:191]
  v_mfma_f32_16x16x32_bf16 v[184:187], a[140:143], a[56:59], v[184:187]
  ds_read_b64_tr_b16 a[170:171], v1 offset:46784
  v_mfma_f32_16x16x32_bf16 v[184:187], a[136:139], a[40:43], v[184:187]
  v_mfma_f32_16x16x32_bf16 v[180:183], a[136:139], a[36:39], v[180:183]
  buffer_load_dwordx4 a[100:103], v0, s[36:39], s53 offen offset:1024 sc1
  v_mfma_f32_16x16x32_bf16 v[180:183], a[140:143], a[52:55], v[180:183]
  ds_read_b64_tr_b16 a[172:173], v1 offset:50368
  v_mfma_f32_16x16x32_bf16 v[176:179], a[140:143], a[48:51], v[176:179]
  ds_read_b64_tr_b16 a[174:175], v1 offset:53952
  v_mfma_f32_16x16x32_bf16 v[176:179], a[136:139], a[32:35], v[176:179]
  s_waitcnt lgkmcnt(8)
  v_mfma_f32_16x16x32_bf16 v[192:195], a[144:147], a[32:35], v[192:195]
  ds_read_b64_tr_b16 a[128:129], v2 offset:0
  v_mfma_f32_16x16x32_bf16 v[192:195], a[148:151], a[48:51], v[192:195]
  v_mfma_f32_16x16x32_bf16 v[196:199], a[148:151], a[52:55], v[196:199]
  ds_read_b64_tr_b16 a[130:131], v2 offset:3584
  v_mfma_f32_16x16x32_bf16 v[196:199], a[144:147], a[36:39], v[196:199]
  v_mfma_f32_16x16x32_bf16 v[200:203], a[144:147], a[40:43], v[200:203]
  ds_read_b64_tr_b16 a[132:133], v2 offset:7168
  v_mfma_f32_16x16x32_bf16 v[200:203], a[148:151], a[56:59], v[200:203]
  ds_read_b64_tr_b16 a[176:177], v31 offset:0
  v_mfma_f32_16x16x32_bf16 v[204:207], a[148:151], a[60:63], v[204:207]
  buffer_load_dwordx4 v9, s[16:19], s52 offen offset:2048 lds
  v_mfma_f32_16x16x32_bf16 v[204:207], a[144:147], a[44:47], v[204:207]
  ds_read_b64_tr_b16 a[134:135], v2 offset:10752
  v_mfma_f32_16x16x32_bf16 v[220:223], a[152:155], a[44:47], v[220:223]
  ds_read_b64_tr_b16 a[136:137], v2 offset:32
  v_mfma_f32_16x16x32_bf16 v[220:223], a[156:159], a[60:63], v[220:223]
  ds_read_b64_tr_b16 a[178:179], v31 offset:3584
  v_mfma_f32_16x16x32_bf16 v[216:219], a[156:159], a[56:59], v[216:219]
  ds_read_b64_tr_b16 a[138:139], v2 offset:3616
  v_mfma_f32_16x16x32_bf16 v[216:219], a[152:155], a[40:43], v[216:219]
  buffer_load_dwordx4 a[104:107], v0, s[36:39], s53 offen offset:2048 sc1
  v_mfma_f32_16x16x32_bf16 v[212:215], a[152:155], a[36:39], v[212:215]
  ds_read_b64_tr_b16 a[140:141], v2 offset:7200
  v_mfma_f32_16x16x32_bf16 v[212:215], a[156:159], a[52:55], v[212:215]
  ds_read_b64_tr_b16 a[180:181], v31 offset:7168
  v_mfma_f32_16x16x32_bf16 v[208:211], a[156:159], a[48:51], v[208:211]
  ds_read_b64_tr_b16 a[142:143], v2 offset:10784
  v_mfma_f32_16x16x32_bf16 v[208:211], a[152:155], a[32:35], v[208:211]
  s_waitcnt lgkmcnt(11)
  ds_read_b64_tr_b16 a[182:183], v31 offset:10752
  v_mfma_f32_16x16x32_bf16 v[224:227], a[160:163], a[32:35], v[224:227]
  ds_read_b64_tr_b16 a[144:145], v2 offset:64
  v_mfma_f32_16x16x32_bf16 v[224:227], a[164:167], a[48:51], v[224:227]
  ds_read_b64_tr_b16 a[184:185], v31 offset:32
  v_mfma_f32_16x16x32_bf16 v[228:231], a[164:167], a[52:55], v[228:231]
  ds_read_b64_tr_b16 a[146:147], v2 offset:3648
  v_mfma_f32_16x16x32_bf16 v[228:231], a[160:163], a[36:39], v[228:231]
  ds_read_b64_tr_b16 a[186:187], v31 offset:3616
  v_mfma_f32_16x16x32_bf16 v[232:235], a[160:163], a[40:43], v[232:235]
  ds_read_b64_tr_b16 a[148:149], v2 offset:7232
  v_mfma_f32_16x16x32_bf16 v[232:235], a[164:167], a[56:59], v[232:235]
  buffer_load_dwordx4 a[108:111], v0, s[36:39], s53 offen offset:3072 sc1
  v_mfma_f32_16x16x32_bf16 v[236:239], a[164:167], a[60:63], v[236:239]
  ds_read_b64_tr_b16 a[150:151], v2 offset:10816
  v_mfma_f32_16x16x32_bf16 v[236:239], a[160:163], a[44:47], v[236:239]
  ds_read_b64_tr_b16 a[188:189], v31 offset:7200
  v_mfma_f32_16x16x32_bf16 v[252:255], a[168:171], a[44:47], v[252:255]
  ds_read_b64_tr_b16 a[152:153], v2 offset:96
  v_mfma_f32_16x16x32_bf16 v[252:255], a[172:175], a[60:63], v[252:255]
  s_bfe_u32 s52, s87, 0x40000
  s_mul_i32 s52, s52, 458752
  s_add_u32 m0, s88, 0
  v_mfma_f32_16x16x32_bf16 v[248:251], a[172:175], a[56:59], v[248:251]
  ds_read_b64_tr_b16 a[154:155], v2 offset:3680
  v_mfma_f32_16x16x32_bf16 v[248:251], a[168:171], a[40:43], v[248:251]
  ds_read_b64_tr_b16 a[190:191], v31 offset:10784
  v_mfma_f32_16x16x32_bf16 v[244:247], a[168:171], a[36:39], v[244:247]
  ds_read_b64_tr_b16 a[156:157], v2 offset:7264
  v_mfma_f32_16x16x32_bf16 v[244:247], a[172:175], a[52:55], v[244:247]
  buffer_load_dwordx4 v3, s[16:19], s52 offen offset:0 lds
  v_mfma_f32_16x16x32_bf16 v[240:243], a[172:175], a[48:51], v[240:243]
  ds_read_b64_tr_b16 a[158:159], v2 offset:10848
  v_mfma_f32_16x16x32_bf16 v[240:243], a[168:171], a[32:35], v[240:243]
  s_waitcnt vmcnt(8) lgkmcnt(13)
  ds_read_b64_tr_b16 a[192:193], v31 offset:64
  v_mfma_f32_16x16x32_bf16 v[32:35], a[128:131], a[64:67], v[32:35]
  s_add_u32 s53, s53, 4096
  ds_read_b64_tr_b16 a[194:195], v31 offset:3648
  v_mfma_f32_16x16x32_bf16 v[32:35], a[132:135], a[80:83], v[32:35]
  ds_read_b64_tr_b16 a[196:197], v31 offset:7232
  v_mfma_f32_16x16x32_bf16 v[36:39], a[132:135], a[84:87], v[36:39]
  ds_read_b64_tr_b16 a[198:199], v31 offset:10816
  v_mfma_f32_16x16x32_bf16 v[36:39], a[128:131], a[68:71], v[36:39]
  ds_read_b64_tr_b16 a[200:201], v31 offset:96
  v_mfma_f32_16x16x32_bf16 v[40:43], a[128:131], a[72:75], v[40:43]
  buffer_load_dwordx4 a[112:115], v0, s[36:39], s53 offen offset:0 sc1
  v_mfma_f32_16x16x32_bf16 v[40:43], a[132:135], a[88:91], v[40:43]
  ds_read_b64_tr_b16 a[202:203], v31 offset:3680
  v_mfma_f32_16x16x32_bf16 v[44:47], a[132:135], a[92:95], v[44:47]
  ds_read_b64_tr_b16 a[204:205], v31 offset:7264
  v_mfma_f32_16x16x32_bf16 v[44:47], a[128:131], a[76:79], v[44:47]
  ds_read_b64_tr_b16 a[206:207], v31 offset:10848
  v_mfma_f32_16x16x32_bf16 v[60:63], a[136:139], a[76:79], v[60:63]
  ds_read_b64_tr_b16 a[160:161], v2 offset:128
  v_mfma_f32_16x16x32_bf16 v[60:63], a[140:143], a[92:95], v[60:63]
  v_mfma_f32_16x16x32_bf16 v[56:59], a[140:143], a[88:91], v[56:59]
  ds_read_b64_tr_b16 a[162:163], v2 offset:3712
  v_mfma_f32_16x16x32_bf16 v[56:59], a[136:139], a[72:75], v[56:59]
  buffer_load_dwordx4 v4, s[16:19], s52 offen offset:1024 lds
  v_mfma_f32_16x16x32_bf16 v[52:55], a[136:139], a[68:71], v[52:55]
  ds_read_b64_tr_b16 a[164:165], v2 offset:7296
  v_mfma_f32_16x16x32_bf16 v[52:55], a[140:143], a[84:87], v[52:55]
  v_mfma_f32_16x16x32_bf16 v[48:51], a[140:143], a[80:83], v[48:51]
  ds_read_b64_tr_b16 a[166:167], v2 offset:10880
  v_mfma_f32_16x16x32_bf16 v[48:51], a[136:139], a[64:67], v[48:51]
  s_waitcnt lgkmcnt(12)
  v_mfma_f32_16x16x32_bf16 v[64:67], a[144:147], a[64:67], v[64:67]
  ds_read_b64_tr_b16 a[168:169], v2 offset:160
  v_mfma_f32_16x16x32_bf16 v[64:67], a[148:151], a[80:83], v[64:67]
  v_mfma_f32_16x16x32_bf16 v[68:71], a[148:151], a[84:87], v[68:71]
  ds_read_b64_tr_b16 a[170:171], v2 offset:3744
  v_mfma_f32_16x16x32_bf16 v[68:71], a[144:147], a[68:71], v[68:71]
  buffer_load_dwordx4 a[116:119], v0, s[36:39], s53 offen offset:1024 sc1
  v_mfma_f32_16x16x32_bf16 v[72:75], a[144:147], a[72:75], v[72:75]
  ds_read_b64_tr_b16 a[172:173], v2 offset:7328
  v_mfma_f32_16x16x32_bf16 v[72:75], a[148:151], a[88:91], v[72:75]
  v_mfma_f32_16x16x32_bf16 v[76:79], a[148:151], a[92:95], v[76:79]
  ds_read_b64_tr_b16 a[174:175], v2 offset:10912
  v_mfma_f32_16x16x32_bf16 v[76:79], a[144:147], a[76:79], v[76:79]
  v_mfma_f32_16x16x32_bf16 v[92:95], a[152:155], a[76:79], v[92:95]
  ds_read_b64_tr_b16 a[128:129], v2 offset:192
  v_mfma_f32_16x16x32_bf16 v[92:95], a[156:159], a[92:95], v[92:95]
  v_mfma_f32_16x16x32_bf16 v[88:91], a[156:159], a[88:91], v[88:91]
  buffer_load_dwordx4 v5, s[16:19], s52 offen offset:2048 lds
  v_mfma_f32_16x16x32_bf16 v[88:91], a[152:155], a[72:75], v[88:91]
  ds_read_b64_tr_b16 a[130:131], v2 offset:3776
  v_mfma_f32_16x16x32_bf16 v[84:87], a[152:155], a[68:71], v[84:87]
  ds_read_b64_tr_b16 a[132:133], v2 offset:7360
  v_mfma_f32_16x16x32_bf16 v[84:87], a[156:159], a[84:87], v[84:87]
  v_mfma_f32_16x16x32_bf16 v[80:83], a[156:159], a[80:83], v[80:83]
  ds_read_b64_tr_b16 a[134:135], v2 offset:10944
  v_mfma_f32_16x16x32_bf16 v[80:83], a[152:155], a[64:67], v[80:83]
  s_waitcnt vmcnt(20) lgkmcnt(12)
  v_mfma_f32_16x16x32_bf16 a[216:219], a[176:179], a[208:211], 0
  ds_read_b64_tr_b16 a[136:137], v2 offset:14336
  v_mfma_f32_16x16x32_bf16 a[216:219], a[180:183], a[212:215], a[216:219]
  v_mfma_f32_16x16x32_bf16 a[220:223], a[184:187], a[208:211], 0
  buffer_load_dwordx4 a[120:123], v0, s[36:39], s53 offen offset:2048 sc1
  v_mfma_f32_16x16x32_bf16 a[220:223], a[188:191], a[212:215], a[220:223]
  ds_read_b64_tr_b16 a[138:139], v2 offset:17920
  v_mfma_f32_16x16x32_bf16 a[224:227], a[192:195], a[208:211], 0
  ds_read_b64_tr_b16 a[140:141], v2 offset:21504
  v_mfma_f32_16x16x32_bf16 a[224:227], a[196:199], a[212:215], a[224:227]
  v_mfma_f32_16x16x32_bf16 a[228:231], a[200:203], a[208:211], 0
  ds_read_b64_tr_b16 a[142:143], v2 offset:25088
  v_mfma_f32_16x16x32_bf16 a[228:231], a[204:207], a[212:215], a[228:231]
  s_waitcnt lgkmcnt(8)
  v_mfma_f32_16x16x32_bf16 v[96:99], a[160:163], a[64:67], v[96:99]
  ds_read_b64_tr_b16 a[144:145], v2 offset:14368
  v_mfma_f32_16x16x32_bf16 v[96:99], a[164:167], a[80:83], v[96:99]
  buffer_load_dwordx4 v6, s[16:19], s52 offen offset:3072 lds
  v_mfma_f32_16x16x32_bf16 v[100:103], a[164:167], a[84:87], v[100:103]
  s_lshl2_add_u32 s67, s56, s44
  ds_read_b64_tr_b16 a[146:147], v2 offset:17952
  s_lshl_b32 s67, s67, 13
  v_mfma_f32_16x16x32_bf16 v[100:103], a[160:163], a[68:71], v[100:103]
  s_add_u32 s67, s67, 262144
  s_add_u32 s68, s67, 4096
  v_mfma_f32_16x16x32_bf16 v[104:107], a[160:163], a[72:75], v[104:107]
  ds_read_b64_tr_b16 a[148:149], v2 offset:21536
  v_mfma_f32_16x16x32_bf16 v[104:107], a[164:167], a[88:91], v[104:107]
  v_mfma_f32_16x16x32_bf16 v[108:111], a[164:167], a[92:95], v[108:111]
  ds_read_b64_tr_b16 a[150:151], v2 offset:25120
  v_mfma_f32_16x16x32_bf16 v[108:111], a[160:163], a[76:79], v[108:111]
  buffer_load_dwordx4 a[176:179], v0, s[36:39], s67 offen offset:0 sc1
  v_mfma_f32_16x16x32_bf16 v[124:127], a[168:171], a[76:79], v[124:127]
  ds_read_b64_tr_b16 a[152:153], v2 offset:14400
  v_mfma_f32_16x16x32_bf16 v[124:127], a[172:175], a[92:95], v[124:127]
  v_mfma_f32_16x16x32_bf16 v[120:123], a[172:175], a[88:91], v[120:123]
  ds_read_b64_tr_b16 a[154:155], v2 offset:17984
  v_mfma_f32_16x16x32_bf16 v[120:123], a[168:171], a[72:75], v[120:123]
  v_mfma_f32_16x16x32_bf16 v[116:119], a[168:171], a[68:71], v[116:119]
  buffer_load_dwordx4 a[124:127], v0, s[36:39], s53 offen offset:3072 sc1
  s_add_u32 m0, s88, 4096
  v_mfma_f32_16x16x32_bf16 v[116:119], a[172:175], a[84:87], v[116:119]
  ds_read_b64_tr_b16 a[156:157], v2 offset:21568
  v_mfma_f32_16x16x32_bf16 v[112:115], a[172:175], a[80:83], v[112:115]
  ds_read_b64_tr_b16 a[158:159], v2 offset:25152
  v_mfma_f32_16x16x32_bf16 v[112:115], a[168:171], a[64:67], v[112:115]
  s_waitcnt lgkmcnt(8)
  v_mfma_f32_16x16x32_bf16 v[128:131], a[128:131], a[64:67], v[128:131]
  ds_read_b64_tr_b16 a[160:161], v2 offset:14432
  v_mfma_f32_16x16x32_bf16 v[128:131], a[132:135], a[80:83], v[128:131]
  buffer_load_dwordx4 v7, s[16:19], s52 offen offset:0 lds
  s_bfe_u32 s53, s87, 0x40000
  v_mfma_f32_16x16x32_bf16 v[132:135], a[132:135], a[84:87], v[132:135]
  s_lshl_b32 s53, s53, 13
  s_add_u32 s53, s53, s89
  ds_read_b64_tr_b16 a[162:163], v2 offset:18016
  v_mfma_f32_16x16x32_bf16 v[132:135], a[128:131], a[68:71], v[132:135]
  v_mfma_f32_16x16x32_bf16 v[136:139], a[128:131], a[72:75], v[136:139]
  ds_read_b64_tr_b16 a[164:165], v2 offset:21600
  v_mfma_f32_16x16x32_bf16 v[136:139], a[132:135], a[88:91], v[136:139]
  v_mfma_f32_16x16x32_bf16 v[140:143], a[132:135], a[92:95], v[140:143]
  buffer_load_dwordx4 a[0:3], v0, s[36:39], s53 offen offset:0 sc1
  v_mfma_f32_16x16x32_bf16 v[140:143], a[128:131], a[76:79], v[140:143]
  ds_read_b64_tr_b16 a[166:167], v2 offset:25184
  v_mfma_f32_16x16x32_bf16 v[156:159], a[136:139], a[76:79], v[156:159]
  ds_read_b64_tr_b16 a[168:169], v2 offset:14464
  v_mfma_f32_16x16x32_bf16 v[156:159], a[140:143], a[92:95], v[156:159]
  v_mfma_f32_16x16x32_bf16 v[152:155], a[140:143], a[88:91], v[152:155]
  ds_read_b64_tr_b16 a[170:171], v2 offset:18048
  v_mfma_f32_16x16x32_bf16 v[152:155], a[136:139], a[72:75], v[152:155]
  buffer_load_dwordx4 a[180:183], v0, s[36:39], s67 offen offset:1024 sc1
  v_mfma_f32_16x16x32_bf16 v[148:151], a[136:139], a[68:71], v[148:151]
  ds_read_b64_tr_b16 a[172:173], v2 offset:21632
  v_mfma_f32_16x16x32_bf16 v[148:151], a[140:143], a[84:87], v[148:151]
  v_mfma_f32_16x16x32_bf16 v[144:147], a[140:143], a[80:83], v[144:147]
  ds_read_b64_tr_b16 a[174:175], v2 offset:25216
  v_mfma_f32_16x16x32_bf16 v[144:147], a[136:139], a[64:67], v[144:147]
  s_waitcnt lgkmcnt(8)
  v_mfma_f32_16x16x32_bf16 v[160:163], a[144:147], a[64:67], v[160:163]
  buffer_load_dwordx4 v8, s[16:19], s52 offen offset:1024 lds
  v_mfma_f32_16x16x32_bf16 v[160:163], a[148:151], a[80:83], v[160:163]
  ds_read_b64_tr_b16 a[128:129], v2 offset:14496
  v_mfma_f32_16x16x32_bf16 v[164:167], a[148:151], a[84:87], v[164:167]
  ds_read_b64_tr_b16 a[130:131], v2 offset:18080
  v_mfma_f32_16x16x32_bf16 v[164:167], a[144:147], a[68:71], v[164:167]
  v_mfma_f32_16x16x32_bf16 v[168:171], a[144:147], a[72:75], v[168:171]
  ds_read_b64_tr_b16 a[132:133], v2 offset:21664
  v_mfma_f32_16x16x32_bf16 v[168:171], a[148:151], a[88:91], v[168:171]
  buffer_load_dwordx4 a[4:7], v0, s[36:39], s53 offen offset:1024 sc1
  v_mfma_f32_16x16x32_bf16 v[172:175], a[148:151], a[92:95], v[172:175]
  ds_read_b64_tr_b16 a[134:135], v2 offset:25248
  v_mfma_f32_16x16x32_bf16 v[172:175], a[144:147], a[76:79], v[172:175]
  s_waitcnt vmcnt(16)
  s_barrier
  v_mfma_f32_16x16x32_bf16 v[188:191], a[152:155], a[76:79], v[188:191]
  ds_read_b64_tr_b16 a[136:137], v2 offset:14528
  v_mfma_f32_16x16x32_bf16 v[188:191], a[156:159], a[92:95], v[188:191]
  v_mfma_f32_16x16x32_bf16 v[184:187], a[156:159], a[88:91], v[184:187]
  ds_read_b64_tr_b16 a[138:139], v2 offset:18112
  v_mfma_f32_16x16x32_bf16 v[184:187], a[152:155], a[72:75], v[184:187]
  buffer_load_dwordx4 a[184:187], v0, s[36:39], s67 offen offset:2048 sc1
  v_mfma_f32_16x16x32_bf16 v[180:183], a[152:155], a[68:71], v[180:183]
  ds_read_b64_tr_b16 a[140:141], v2 offset:21696
  v_mfma_f32_16x16x32_bf16 v[180:183], a[156:159], a[84:87], v[180:183]
  v_mfma_f32_16x16x32_bf16 v[176:179], a[156:159], a[80:83], v[176:179]
  ds_read_b64_tr_b16 a[142:143], v2 offset:25280
  v_mfma_f32_16x16x32_bf16 v[176:179], a[152:155], a[64:67], v[176:179]
  s_waitcnt lgkmcnt(8)
  v_mfma_f32_16x16x32_bf16 v[192:195], a[160:163], a[64:67], v[192:195]
  buffer_load_dwordx4 v9, s[16:19], s52 offen offset:2048 lds
  v_mfma_f32_16x16x32_bf16 v[192:195], a[164:167], a[80:83], v[192:195]
  ds_read_b64_tr_b16 a[144:145], v2 offset:28672
  v_mfma_f32_16x16x32_bf16 v[196:199], a[164:167], a[84:87], v[196:199]
  ds_read_b64_tr_b16 a[146:147], v2 offset:32256
  v_mfma_f32_16x16x32_bf16 v[196:199], a[160:163], a[68:71], v[196:199]
  v_mfma_f32_16x16x32_bf16 v[200:203], a[160:163], a[72:75], v[200:203]
  ds_read_b64_tr_b16 a[148:149], v2 offset:35840
  v_mfma_f32_16x16x32_bf16 v[200:203], a[164:167], a[88:91], v[200:203]
  buffer_load_dwordx4 a[8:11], v0, s[36:39], s53 offen offset:2048 sc1
  v_mfma_f32_16x16x32_bf16 v[204:207], a[164:167], a[92:95], v[204:207]
  ds_read_b64_tr_b16 a[150:151], v2 offset:39424
  v_mfma_f32_16x16x32_bf16 v[204:207], a[160:163], a[76:79], v[204:207]
  v_mfma_f32_16x16x32_bf16 v[220:223], a[168:171], a[76:79], v[220:223]
  ds_read_b64_tr_b16 a[152:153], v2 offset:28704
  v_mfma_f32_16x16x32_bf16 v[220:223], a[172:175], a[92:95], v[220:223]
  buffer_load_dwordx4 a[188:191], v0, s[36:39], s67 offen offset:3072 sc1
  v_mfma_f32_16x16x32_bf16 v[216:219], a[172:175], a[88:91], v[216:219]
  ds_read_b64_tr_b16 a[154:155], v2 offset:32288
  v_mfma_f32_16x16x32_bf16 v[216:219], a[168:171], a[72:75], v[216:219]
  v_mfma_f32_16x16x32_bf16 v[212:215], a[168:171], a[68:71], v[212:215]
  ds_read_b64_tr_b16 a[156:157], v2 offset:35872
  v_mfma_f32_16x16x32_bf16 v[212:215], a[172:175], a[84:87], v[212:215]
  v_mfma_f32_16x16x32_bf16 v[208:211], a[172:175], a[80:83], v[208:211]
  buffer_load_dwordx4 a[12:15], v0, s[36:39], s53 offen offset:3072 sc1
  v_mfma_f32_16x16x32_bf16 v[208:211], a[168:171], a[64:67], v[208:211]
  s_waitcnt lgkmcnt(7)
  ds_read_b64_tr_b16 a[158:159], v2 offset:39456
  v_mfma_f32_16x16x32_bf16 v[224:227], a[128:131], a[64:67], v[224:227]
  ds_read_b64_tr_b16 a[160:161], v2 offset:28736
  v_mfma_f32_16x16x32_bf16 v[224:227], a[132:135], a[80:83], v[224:227]
  s_bfe_u32 s52, s87, 0x40004
  s_mul_i32 s52, s52, 458752
  s_add_u32 m0, s88, 28672
  v_mfma_f32_16x16x32_bf16 v[228:231], a[132:135], a[84:87], v[228:231]
  buffer_load_dwordx4 a[192:195], v0, s[36:39], s68 offen offset:0 sc1
  v_mfma_f32_16x16x32_bf16 v[228:231], a[128:131], a[68:71], v[228:231]
  ds_read_b64_tr_b16 a[162:163], v2 offset:32320
  v_mfma_f32_16x16x32_bf16 v[232:235], a[128:131], a[72:75], v[232:235]
  ds_read_b64_tr_b16 a[164:165], v2 offset:35904
  v_mfma_f32_16x16x32_bf16 v[232:235], a[132:135], a[88:91], v[232:235]
  v_mfma_f32_16x16x32_bf16 v[236:239], a[132:135], a[92:95], v[236:239]
  ds_read_b64_tr_b16 a[166:167], v2 offset:39488
  v_mfma_f32_16x16x32_bf16 v[236:239], a[128:131], a[76:79], v[236:239]
  buffer_load_dwordx4 v3, s[16:19], s52 offen offset:0 lds
  v_mfma_f32_16x16x32_bf16 v[252:255], a[136:139], a[76:79], v[252:255]
  ds_read_b64_tr_b16 a[168:169], v2 offset:28768
  v_mfma_f32_16x16x32_bf16 v[252:255], a[140:143], a[92:95], v[252:255]
  v_mfma_f32_16x16x32_bf16 v[248:251], a[140:143], a[88:91], v[248:251]
  ds_read_b64_tr_b16 a[170:171], v2 offset:32352
  v_mfma_f32_16x16x32_bf16 v[248:251], a[136:139], a[72:75], v[248:251]
  buffer_load_dwordx4 a[196:199], v0, s[36:39], s68 offen offset:1024 sc1
  v_mfma_f32_16x16x32_bf16 v[244:247], a[136:139], a[68:71], v[244:247]
  ds_read_b64_tr_b16 a[172:173], v2 offset:35936
  v_mfma_f32_16x16x32_bf16 v[244:247], a[140:143], a[84:87], v[244:247]
  v_mfma_f32_16x16x32_bf16 v[240:243], a[140:143], a[80:83], v[240:243]
  ds_read_b64_tr_b16 a[174:175], v2 offset:39520
  v_mfma_f32_16x16x32_bf16 v[240:243], a[136:139], a[64:67], v[240:243]
  s_waitcnt vmcnt(13) lgkmcnt(8)
  v_mfma_f32_16x16x32_bf16 v[32:35], a[144:147], a[96:99], v[32:35]
  s_add_u32 s53, s53, 4096
  ds_read_b64_tr_b16 a[128:129], v2 offset:28800
  v_mfma_f32_16x16x32_bf16 v[32:35], a[148:151], a[112:115], v[32:35]
  buffer_load_dwordx4 a[200:203], v0, s[36:39], s68 offen offset:2048 sc1
  v_mfma_f32_16x16x32_bf16 v[36:39], a[148:151], a[116:119], v[36:39]
  ds_read_b64_tr_b16 a[130:131], v2 offset:32384
  v_mfma_f32_16x16x32_bf16 v[36:39], a[144:147], a[100:103], v[36:39]
  v_mfma_f32_16x16x32_bf16 v[40:43], a[144:147], a[104:107], v[40:43]
  ds_read_b64_tr_b16 a[132:133], v2 offset:35968
  v_mfma_f32_16x16x32_bf16 v[40:43], a[148:151], a[120:123], v[40:43]
  v_mfma_f32_16x16x32_bf16 v[44:47], a[148:151], a[124:127], v[44:47]
  buffer_load_dwordx4 a[16:19], v0, s[36:39], s53 offen offset:0 sc1
  v_mfma_f32_16x16x32_bf16 v[44:47], a[144:147], a[108:111], v[44:47]
  ds_read_b64_tr_b16 a[134:135], v2 offset:39552
  v_mfma_f32_16x16x32_bf16 v[60:63], a[152:155], a[108:111], v[60:63]
  ds_read_b64_tr_b16 a[136:137], v2 offset:28832
  v_mfma_f32_16x16x32_bf16 v[60:63], a[156:159], a[124:127], v[60:63]
  v_mfma_f32_16x16x32_bf16 v[56:59], a[156:159], a[120:123], v[56:59]
  ds_read_b64_tr_b16 a[138:139], v2 offset:32416
  v_mfma_f32_16x16x32_bf16 v[56:59], a[152:155], a[104:107], v[56:59]
  buffer_load_dwordx4 v4, s[16:19], s52 offen offset:1024 lds
  v_mfma_f32_16x16x32_bf16 v[52:55], a[152:155], a[100:103], v[52:55]
  ds_read_b64_tr_b16 a[140:141], v2 offset:36000
  v_mfma_f32_16x16x32_bf16 v[52:55], a[156:159], a[116:119], v[52:55]
  buffer_load_dwordx4 a[204:207], v0, s[36:39], s68 offen offset:3072 sc1
  v_mfma_f32_16x16x32_bf16 v[48:51], a[156:159], a[112:115], v[48:51]
  ds_read_b64_tr_b16 a[142:143], v2 offset:39584
  v_mfma_f32_16x16x32_bf16 v[48:51], a[152:155], a[96:99], v[48:51]
  s_waitcnt lgkmcnt(8)
  v_mfma_f32_16x16x32_bf16 v[64:67], a[160:163], a[96:99], v[64:67]
  ds_read_b64_tr_b16 a[144:145], v2 offset:28864
  v_mfma_f32_16x16x32_bf16 v[64:67], a[164:167], a[112:115], v[64:67]
  v_mfma_f32_16x16x32_bf16 v[68:71], a[164:167], a[116:119], v[68:71]
  ds_read_b64_tr_b16 a[146:147], v2 offset:32448
  v_mfma_f32_16x16x32_bf16 v[68:71], a[160:163], a[100:103], v[68:71]
  buffer_load_dwordx4 a[20:23], v0, s[36:39], s53 offen offset:1024 sc1
  v_mfma_f32_16x16x32_bf16 v[72:75], a[160:163], a[104:107], v[72:75]
  ds_read_b64_tr_b16 a[148:149], v2 offset:36032
  v_mfma_f32_16x16x32_bf16 v[72:75], a[164:167], a[120:123], v[72:75]
  v_mfma_f32_16x16x32_bf16 v[76:79], a[164:167], a[124:127], v[76:79]
  ds_read_b64_tr_b16 a[150:151], v2 offset:39616
  v_mfma_f32_16x16x32_bf16 v[76:79], a[160:163], a[108:111], v[76:79]
  v_mfma_f32_16x16x32_bf16 v[92:95], a[168:171], a[108:111], v[92:95]
  ds_read_b64_tr_b16 a[152:153], v2 offset:43008
  v_mfma_f32_16x16x32_bf16 v[92:95], a[172:175], a[124:127], v[92:95]
  v_mfma_f32_16x16x32_bf16 v[88:91], a[172:175], a[120:123], v[88:91]
  buffer_load_dwordx4 v5, s[16:19], s52 offen offset:2048 lds
  v_mfma_f32_16x16x32_bf16 v[88:91], a[168:171], a[104:107], v[88:91]
  ds_read_b64_tr_b16 a[154:155], v2 offset:46592
  v_mfma_f32_16x16x32_bf16 v[84:87], a[168:171], a[100:103], v[84:87]
  ds_read_b64_tr_b16 a[156:157], v2 offset:50176
  v_mfma_f32_16x16x32_bf16 v[84:87], a[172:175], a[116:119], v[84:87]
  v_mfma_f32_16x16x32_bf16 v[80:83], a[172:175], a[112:115], v[80:83]
  ds_read_b64_tr_b16 a[158:159], v2 offset:53760
  v_mfma_f32_16x16x32_bf16 v[80:83], a[168:171], a[96:99], v[80:83]
  s_waitcnt lgkmcnt(8)
  v_mfma_f32_16x16x32_bf16 v[96:99], a[128:131], a[96:99], v[96:99]
  ds_read_b64_tr_b16 a[160:161], v2 offset:43040
  v_mfma_f32_16x16x32_bf16 v[96:99], a[132:135], a[112:115], v[96:99]
  v_mfma_f32_16x16x32_bf16 v[100:103], a[132:135], a[116:119], v[100:103]
  buffer_load_dwordx4 a[24:27], v0, s[36:39], s53 offen offset:2048 sc1
  v_mfma_f32_16x16x32_bf16 v[100:103], a[128:131], a[100:103], v[100:103]
  ds_read_b64_tr_b16 a[162:163], v2 offset:46624
  v_mfma_f32_16x16x32_bf16 v[104:107], a[128:131], a[104:107], v[104:107]
  ds_read_b64_tr_b16 a[164:165], v2 offset:50208
  v_mfma_f32_16x16x32_bf16 v[104:107], a[132:135], a[120:123], v[104:107]
  v_mfma_f32_16x16x32_bf16 v[108:111], a[132:135], a[124:127], v[108:111]
  ds_read_b64_tr_b16 a[166:167], v2 offset:53792
  v_mfma_f32_16x16x32_bf16 v[108:111], a[128:131], a[108:111], v[108:111]
  v_mfma_f32_16x16x32_bf16 v[124:127], a[136:139], a[108:111], v[124:127]
Hb0_1:
  s_cbranch_execz Hb0_2
  ds_read_b64_tr_b16 a[168:169], v2 offset:43072
  v_mfma_f32_16x16x32_bf16 v[124:127], a[140:143], a[124:127], v[124:127]
  buffer_load_dwordx4 v6, s[16:19], s52 offen offset:3072 lds
  v_mfma_f32_16x16x32_bf16 v[120:123], a[140:143], a[120:123], v[120:123]
  ds_read_b64_tr_b16 a[170:171], v2 offset:46656
  v_mfma_f32_16x16x32_bf16 v[120:123], a[136:139], a[104:107], v[120:123]
  v_mfma_f32_16x16x32_bf16 v[116:119], a[136:139], a[100:103], v[116:119]
  ds_read_b64_tr_b16 a[172:173], v2 offset:50240
  v_mfma_f32_16x16x32_bf16 v[116:119], a[140:143], a[116:119], v[116:119]
  v_mfma_f32_16x16x32_bf16 v[112:115], a[140:143], a[112:115], v[112:115]
  ds_read_b64_tr_b16 a[174:175], v2 offset:53824
  v_mfma_f32_16x16x32_bf16 v[112:115], a[136:139], a[96:99], v[112:115]
  s_waitcnt lgkmcnt(8)
  v_mfma_f32_16x16x32_bf16 v[128:131], a[144:147], a[96:99], v[128:131]
  ds_read_b64_tr_b16 a[128:129], v2 offset:43104
  v_mfma_f32_16x16x32_bf16 v[128:131], a[148:151], a[112:115], v[128:131]
  buffer_load_dwordx4 a[28:31], v0, s[36:39], s53 offen offset:3072 sc1
  v_mfma_f32_16x16x32_bf16 v[132:135], a[148:151], a[116:119], v[132:135]
  ds_read_b64_tr_b16 a[130:131], v2 offset:46688
  v_mfma_f32_16x16x32_bf16 v[132:135], a[144:147], a[100:103], v[132:135]
  v_mfma_f32_16x16x32_bf16 v[136:139], a[144:147], a[104:107], v[136:139]
  s_add_u32 m0, s88, 32768
  ds_read_b64_tr_b16 a[132:133], v2 offset:50272
  v_mfma_f32_16x16x32_bf16 v[136:139], a[148:151], a[120:123], v[136:139]
  v_mfma_f32_16x16x32_bf16 v[140:143], a[148:151], a[124:127], v[140:143]
  ds_read_b64_tr_b16 a[134:135], v2 offset:53856
  v_mfma_f32_16x16x32_bf16 v[140:143], a[144:147], a[108:111], v[140:143]
  v_mfma_f32_16x16x32_bf16 v[156:159], a[152:155], a[108:111], v[156:159]
  buffer_load_dwordx4 v7, s[16:19], s52 offen offset:0 lds
  s_bfe_u32 s53, s87, 0x40004
  v_mfma_f32_16x16x32_bf16 v[156:159], a[156:159], a[124:127], v[156:159]
  s_lshl_b32 s53, s53, 13
  s_add_u32 s53, s53, s89
  ds_read_b64_tr_b16 a[136:137], v2 offset:43136
  v_mfma_f32_16x16x32_bf16 v[152:155], a[156:159], a[120:123], v[152:155]
  ds_read_b64_tr_b16 a[138:139], v2 offset:46720
  v_mfma_f32_16x16x32_bf16 v[152:155], a[152:155], a[104:107], v[152:155]
  v_mfma_f32_16x16x32_bf16 v[148:151], a[152:155], a[100:103], v[148:151]
  ds_read_b64_tr_b16 a[140:141], v2 offset:50304
  v_mfma_f32_16x16x32_bf16 v[148:151], a[156:159], a[116:119], v[148:151]
  buffer_load_dwordx4 a[32:35], v0, s[36:39], s53 offen offset:0 sc1
  v_mfma_f32_16x16x32_bf16 v[144:147], a[156:159], a[112:115], v[144:147]
  ds_read_b64_tr_b16 a[142:143], v2 offset:53888
  v_mfma_f32_16x16x32_bf16 v[144:147], a[152:155], a[96:99], v[144:147]
  s_waitcnt lgkmcnt(8)
  v_mfma_f32_16x16x32_bf16 v[160:163], a[160:163], a[96:99], v[160:163]
  s_waitcnt vmcnt(7)
  ds_read_b64_tr_b16 a[144:145], v2 offset:43168
  v_accvgpr_read_b32 v22, a176
  v_mfma_f32_16x16x32_bf16 v[160:163], a[164:167], a[112:115], v[160:163]
  v_accvgpr_read_b32 v23, a177
  v_accvgpr_read_b32 v24, a178
  v_mfma_f32_16x16x32_bf16 v[164:167], a[164:167], a[116:119], v[164:167]
  ds_read_b64_tr_b16 a[146:147], v2 offset:46752
  v_accvgpr_read_b32 v25, a179
  v_mfma_f32_16x16x32_bf16 v[164:167], a[160:163], a[100:103], v[164:167]
  v_accvgpr_read_b32 v26, a180
  v_accvgpr_read_b32 v27, a181
  v_mfma_f32_16x16x32_bf16 v[168:171], a[160:163], a[104:107], v[168:171]
  ds_read_b64_tr_b16 a[148:149], v2 offset:50336
  v_accvgpr_read_b32 v28, a182
  v_mfma_f32_16x16x32_bf16 v[168:171], a[164:167], a[120:123], v[168:171]
  v_accvgpr_read_b32 v29, a183
  v_add_f32 v22, v22, v26
  v_mfma_f32_16x16x32_bf16 v[172:175], a[164:167], a[124:127], v[172:175]
  ds_read_b64_tr_b16 a[150:151], v2 offset:53920
  v_add_f32 v23, v23, v27
  v_mfma_f32_16x16x32_bf16 v[172:175], a[160:163], a[108:111], v[172:175]
  s_waitcnt vmcnt(17)
  s_barrier
  buffer_load_dwordx4 v8, s[16:19], s52 offen offset:1024 lds
  v_add_f32 v24, v24, v28
  v_mfma_f32_16x16x32_bf16 v[188:191], a[168:171], a[108:111], v[188:191]
  ds_read_b64_tr_b16 a[152:153], v2 offset:43200
  v_add_f32 v25, v25, v29
  v_mfma_f32_16x16x32_bf16 v[188:191], a[172:175], a[124:127], v[188:191]
  v_accvgpr_read_b32 v26, a184
  v_accvgpr_read_b32 v27, a185
  v_mfma_f32_16x16x32_bf16 v[184:187], a[172:175], a[120:123], v[184:187]
  ds_read_b64_tr_b16 a[154:155], v2 offset:46784
  v_accvgpr_read_b32 v28, a186
  v_mfma_f32_16x16x32_bf16 v[184:187], a[168:171], a[104:107], v[184:187]
  v_accvgpr_read_b32 v29, a187
  v_add_f32 v22, v22, v26
  v_mfma_f32_16x16x32_bf16 v[180:183], a[168:171], a[100:103], v[180:183]
  buffer_load_dwordx4 a[36:39], v0, s[36:39], s53 offen offset:1024 sc1
  v_add_f32 v23, v23, v27
  v_mfma_f32_16x16x32_bf16 v[180:183], a[172:175], a[116:119], v[180:183]
  ds_read_b64_tr_b16 a[156:157], v2 offset:50368
  v_add_f32 v24, v24, v28
  v_mfma_f32_16x16x32_bf16 v[176:179], a[172:175], a[112:115], v[176:179]
  ds_read_b64_tr_b16 a[158:159], v2 offset:53952
  v_add_f32 v25, v25, v29
  v_mfma_f32_16x16x32_bf16 v[176:179], a[168:171], a[96:99], v[176:179]
  s_waitcnt lgkmcnt(8)
  v_accvgpr_read_b32 v26, a188
  v_accvgpr_read_b32 v27, a189
  v_mfma_f32_16x16x32_bf16 v[192:195], a[128:131], a[96:99], v[192:195]
  ds_read_b64_tr_b16 a[160:161], v1 offset:0
  v_accvgpr_read_b32 v28, a190
  v_mfma_f32_16x16x32_bf16 v[192:195], a[132:135], a[112:115], v[192:195]
  v_accvgpr_read_b32 v29, a191
  v_add_f32 v22, v22, v26
  v_mfma_f32_16x16x32_bf16 v[196:199], a[132:135], a[116:119], v[196:199]
  ds_read_b64_tr_b16 a[162:163], v1 offset:3584
  v_add_f32 v23, v23, v27
  v_mfma_f32_16x16x32_bf16 v[196:199], a[128:131], a[100:103], v[196:199]
  v_add_f32 v24, v24, v28
  v_add_f32 v25, v25, v29
  v_mfma_f32_16x16x32_bf16 v[200:203], a[128:131], a[104:107], v[200:203]
  ds_read_b64_tr_b16 a[164:165], v1 offset:7168
  v_mov_b32 v26, v22
  v_mfma_f32_16x16x32_bf16 v[200:203], a[132:135], a[120:123], v[200:203]
  v_mov_b32 v27, v23
  v_mov_b32 v28, v24
  v_mfma_f32_16x16x32_bf16 v[204:207], a[132:135], a[124:127], v[204:207]
  buffer_load_dwordx4 v9, s[16:19], s52 offen offset:2048 lds
  v_mov_b32 v29, v25
  v_mfma_f32_16x16x32_bf16 v[204:207], a[128:131], a[108:111], v[204:207]
  ds_read_b64_tr_b16 a[166:167], v1 offset:10752
  v_permlane16_swap_b32 v22, v26
  v_mfma_f32_16x16x32_bf16 v[220:223], a[136:139], a[108:111], v[220:223]
  ds_read_b64_tr_b16 a[168:169], v1 offset:32
  v_permlane16_swap_b32 v23, v27
  v_mfma_f32_16x16x32_bf16 v[220:223], a[140:143], a[124:127], v[220:223]
  v_permlane16_swap_b32 v24, v28
  v_permlane16_swap_b32 v25, v29
  v_mfma_f32_16x16x32_bf16 v[216:219], a[140:143], a[120:123], v[216:219]
  s_add_u32 s57, s57, 16384
  ds_read_b64_tr_b16 a[170:171], v1 offset:3616
  v_add_f32 v22, v22, v26
  v_mfma_f32_16x16x32_bf16 v[216:219], a[136:139], a[104:107], v[216:219]
  buffer_load_dwordx4 a[40:43], v0, s[36:39], s53 offen offset:2048 sc1
  v_add_f32 v23, v23, v27
  v_mfma_f32_16x16x32_bf16 v[212:215], a[136:139], a[100:103], v[212:215]
  ds_read_b64_tr_b16 a[172:173], v1 offset:7200
  v_add_f32 v24, v24, v28
  v_mfma_f32_16x16x32_bf16 v[212:215], a[140:143], a[116:119], v[212:215]
  v_add_f32 v25, v25, v29
  v_mov_b32 v26, v22
  v_mfma_f32_16x16x32_bf16 v[208:211], a[140:143], a[112:115], v[208:211]
  ds_read_b64_tr_b16 a[174:175], v1 offset:10784
  v_mov_b32 v27, v23
  v_mfma_f32_16x16x32_bf16 v[208:211], a[136:139], a[96:99], v[208:211]
  s_waitcnt lgkmcnt(8)
  v_mov_b32 v28, v24
  v_mov_b32 v29, v25
  v_mfma_f32_16x16x32_bf16 v[224:227], a[144:147], a[96:99], v[224:227]
  buffer_load_dwordx4 a[208:211], v0, s[36:39], s57 offen offset:0 sc1
  v_permlane32_swap_b32 v22, v26
  v_mfma_f32_16x16x32_bf16 v[224:227], a[148:151], a[112:115], v[224:227]
  ds_read_b64_tr_b16 a[128:129], v1 offset:64
  v_permlane32_swap_b32 v23, v27
  v_mfma_f32_16x16x32_bf16 v[228:231], a[148:151], a[116:119], v[228:231]
  ds_read_b64_tr_b16 a[130:131], v1 offset:3648
  v_permlane32_swap_b32 v24, v28
  v_mfma_f32_16x16x32_bf16 v[228:231], a[144:147], a[100:103], v[228:231]
  v_permlane32_swap_b32 v25, v29
  v_add_f32 v22, v22, v26
  v_mfma_f32_16x16x32_bf16 v[232:235], a[144:147], a[104:107], v[232:235]
  ds_read_b64_tr_b16 a[132:133], v1 offset:7232
  v_add_f32 v23, v23, v27
  v_mfma_f32_16x16x32_bf16 v[232:235], a[148:151], a[120:123], v[232:235]
  buffer_load_dwordx4 a[212:215], v0, s[36:39], s57 offen offset:1024 sc1
  v_add_f32 v24, v24, v28
  v_mfma_f32_16x16x32_bf16 v[236:239], a[148:151], a[124:127], v[236:239]
  ds_read_b64_tr_b16 a[134:135], v1 offset:10816
  v_add_f32 v25, v25, v29
  v_mfma_f32_16x16x32_bf16 v[236:239], a[144:147], a[108:111], v[236:239]
  v_mul_f32 v22, 0x3a800000, v22
  v_mul_f32 v23, 0x3a800000, v23
  v_mfma_f32_16x16x32_bf16 v[252:255], a[152:155], a[108:111], v[252:255]
  ds_read_b64_tr_b16 a[136:137], v1 offset:96
  v_fma_f32 v23, -v22, v22, v23
  v_mfma_f32_16x16x32_bf16 v[252:255], a[156:159], a[124:127], v[252:255]
  v_max_f32 v23, 0, v23
  v_cvt_pk_bf16_f32 v23, v23, v23
  v_mfma_f32_16x16x32_bf16 v[248:251], a[156:159], a[120:123], v[248:251]
  buffer_load_dwordx4 a[44:47], v0, s[36:39], s53 offen offset:3072 sc1
  s_bfe_u32 s52, s87, 0x40008
  v_mfma_f32_16x16x32_bf16 v[248:251], a[152:155], a[104:107], v[248:251]
  s_mul_i32 s52, s52, 458752
  s_add_u32 m0, s88, 57344
  ds_read_b64_tr_b16 a[138:139], v1 offset:3680
  v_mfma_f32_16x16x32_bf16 v[244:247], a[152:155], a[100:103], v[244:247]
  ds_read_b64_tr_b16 a[140:141], v1 offset:7264
  v_lshlrev_b32 v23, 16, v23
  v_mfma_f32_16x16x32_bf16 v[244:247], a[156:159], a[116:119], v[244:247]
  v_add_f32 v23, 0x3727c5ac, v23
  v_cvt_pk_bf16_f32 v23, v23, v23
  v_mfma_f32_16x16x32_bf16 v[240:243], a[156:159], a[112:115], v[240:243]
  ds_read_b64_tr_b16 a[142:143], v1 offset:10848
  v_lshlrev_b32 v23, 16, v23
  v_mfma_f32_16x16x32_bf16 v[240:243], a[152:155], a[96:99], v[240:243]
  s_waitcnt vmcnt(9) lgkmcnt(8)
  buffer_load_dwordx4 v3, s[16:19], s52 offen offset:0 lds
  v_mfma_f32_16x16x32_bf16 v[32:35], a[160:163], a[0:3], v[32:35]
  s_add_u32 s53, s53, 4096
  ds_read_b64_tr_b16 a[144:145], v1 offset:128
  v_mfma_f32_16x16x32_bf16 v[32:35], a[164:167], a[16:19], v[32:35]
  s_barrier
  v_sqrt_f32 v23, v23
  v_mfma_f32_16x16x32_bf16 v[36:39], a[164:167], a[20:23], v[36:39]
  s_nop 0
  ds_read_b64_tr_b16 a[146:147], v1 offset:3712
  v_cvt_pk_bf16_f32 v12, -v22, v23
  v_mfma_f32_16x16x32_bf16 v[36:39], a[160:163], a[4:7], v[36:39]
  v_and_b32 v23, 0xffff0000, v12
  v_mfma_f32_16x16x32_bf16 v[40:43], a[160:163], a[8:11], v[40:43]
  buffer_load_dwordx4 a[48:51], v0, s[36:39], s53 offen offset:0 sc1
  v_mfma_f32_16x16x32_bf16 v[40:43], a[164:167], a[24:27], v[40:43]
  ds_read_b64_tr_b16 a[148:149], v1 offset:7296
  v_mfma_f32_16x16x32_bf16 v[44:47], a[164:167], a[28:31], v[44:47]
  ds_read_b64_tr_b16 a[150:151], v1 offset:10880
  v_mfma_f32_16x16x32_bf16 v[44:47], a[160:163], a[12:15], v[44:47]
  v_rcp_f32 v10, v23
  v_mfma_f32_16x16x32_bf16 v[60:63], a[168:171], a[12:15], v[60:63]
  ds_read_b64_tr_b16 a[152:153], v1 offset:160
  v_mul_f32 v11, v23, v23
  v_mfma_f32_16x16x32_bf16 v[60:63], a[172:175], a[28:31], v[60:63]
  v_mul_f32 v10, 0xbfb8aa3b, v10
  v_mul_f32 v24, 0x3a800000, v24
  v_mfma_f32_16x16x32_bf16 v[56:59], a[172:175], a[24:27], v[56:59]
  ds_read_b64_tr_b16 a[154:155], v1 offset:3744
  v_mul_f32 v25, 0x3a800000, v25
  v_mfma_f32_16x16x32_bf16 v[56:59], a[168:171], a[8:11], v[56:59]
  buffer_load_dwordx4 v4, s[16:19], s52 offen offset:1024 lds
  v_fma_f32 v25, -v24, v24, v25
  v_mfma_f32_16x16x32_bf16 v[52:55], a[168:171], a[4:7], v[52:55]
  ds_read_b64_tr_b16 a[156:157], v1 offset:7328
  v_max_f32 v25, 0, v25
  v_mfma_f32_16x16x32_bf16 v[52:55], a[172:175], a[20:23], v[52:55]
  v_cvt_pk_bf16_f32 v25, v25, v25
  v_lshlrev_b32 v25, 16, v25
  v_mfma_f32_16x16x32_bf16 v[48:51], a[172:175], a[16:19], v[48:51]
  ds_read_b64_tr_b16 a[158:159], v1 offset:10912
  v_add_f32 v25, 0x3727c5ac, v25
  v_mfma_f32_16x16x32_bf16 v[48:51], a[168:171], a[0:3], v[48:51]
  s_waitcnt lgkmcnt(8)
  v_cvt_pk_bf16_f32 v25, v25, v25
  v_lshlrev_b32 v25, 16, v25
  v_mfma_f32_16x16x32_bf16 v[64:67], a[128:131], a[0:3], v[64:67]
  ds_read_b64_tr_b16 a[160:161], v1 offset:192
  v_mfma_f32_16x16x32_bf16 v[64:67], a[132:135], a[16:19], v[64:67]
  v_sqrt_f32 v25, v25
  v_mfma_f32_16x16x32_bf16 v[68:71], a[132:135], a[20:23], v[68:71]
  s_nop 0
  ds_read_b64_tr_b16 a[162:163], v1 offset:3776
  v_cvt_pk_bf16_f32 v15, -v24, v25
  v_mfma_f32_16x16x32_bf16 v[68:71], a[128:131], a[4:7], v[68:71]
  buffer_load_dwordx4 a[52:55], v0, s[36:39], s53 offen offset:1024 sc1
  v_and_b32 v25, 0xffff0000, v15
  v_mfma_f32_16x16x32_bf16 v[72:75], a[128:131], a[8:11], v[72:75]
  ds_read_b64_tr_b16 a[164:165], v1 offset:7360
  v_mfma_f32_16x16x32_bf16 v[72:75], a[132:135], a[24:27], v[72:75]
  v_rcp_f32 v13, v25
  v_mfma_f32_16x16x32_bf16 v[76:79], a[132:135], a[28:31], v[76:79]
  ds_read_b64_tr_b16 a[166:167], v1 offset:10944
  v_mul_f32 v14, v25, v25
  v_mfma_f32_16x16x32_bf16 v[76:79], a[128:131], a[12:15], v[76:79]
  v_mul_f32 v13, 0xbfb8aa3b, v13
  v_accvgpr_read_b32 v22, a192
  v_mfma_f32_16x16x32_bf16 v[92:95], a[136:139], a[12:15], v[92:95]
  ds_read_b64_tr_b16 a[168:169], v1 offset:14336
  v_accvgpr_read_b32 v23, a193
  v_mfma_f32_16x16x32_bf16 v[92:95], a[140:143], a[28:31], v[92:95]
  v_accvgpr_read_b32 v24, a194
  v_accvgpr_read_b32 v25, a195
  v_mfma_f32_16x16x32_bf16 v[88:91], a[140:143], a[24:27], v[88:91]
  buffer_load_dwordx4 v5, s[16:19], s52 offen offset:2048 lds
  v_accvgpr_read_b32 v26, a196
  v_mfma_f32_16x16x32_bf16 v[88:91], a[136:139], a[8:11], v[88:91]
  ds_read_b64_tr_b16 a[170:171], v1 offset:17920
  v_accvgpr_read_b32 v27, a197
  v_mfma_f32_16x16x32_bf16 v[84:87], a[136:139], a[4:7], v[84:87]
  ds_read_b64_tr_b16 a[172:173], v1 offset:21504
  v_accvgpr_read_b32 v28, a198
  v_mfma_f32_16x16x32_bf16 v[84:87], a[140:143], a[20:23], v[84:87]
  v_accvgpr_read_b32 v29, a199
  v_add_f32 v22, v22, v26
  v_mfma_f32_16x16x32_bf16 v[80:83], a[140:143], a[16:19], v[80:83]
  ds_read_b64_tr_b16 a[174:175], v1 offset:25088
  v_add_f32 v23, v23, v27
  v_mfma_f32_16x16x32_bf16 v[80:83], a[136:139], a[0:3], v[80:83]
  s_waitcnt lgkmcnt(8)
  v_add_f32 v24, v24, v28
  v_add_f32 v25, v25, v29
  v_mfma_f32_16x16x32_bf16 v[96:99], a[144:147], a[0:3], v[96:99]
  ds_read_b64_tr_b16 a[128:129], v1 offset:14368
  v_accvgpr_read_b32 v26, a200
  v_mfma_f32_16x16x32_bf16 v[96:99], a[148:151], a[16:19], v[96:99]
  v_accvgpr_read_b32 v27, a201
  v_accvgpr_read_b32 v28, a202
  v_mfma_f32_16x16x32_bf16 v[100:103], a[148:151], a[20:23], v[100:103]
  buffer_load_dwordx4 a[56:59], v0, s[36:39], s53 offen offset:2048 sc1
  v_accvgpr_read_b32 v29, a203
  v_mfma_f32_16x16x32_bf16 v[100:103], a[144:147], a[4:7], v[100:103]
  ds_read_b64_tr_b16 a[130:131], v1 offset:17952
  v_add_f32 v22, v22, v26
  v_mfma_f32_16x16x32_bf16 v[104:107], a[144:147], a[8:11], v[104:107]
  ds_read_b64_tr_b16 a[132:133], v1 offset:21536
  v_add_f32 v23, v23, v27
  v_mfma_f32_16x16x32_bf16 v[104:107], a[148:151], a[24:27], v[104:107]
  v_add_f32 v24, v24, v28
  v_add_f32 v25, v25, v29
  v_mfma_f32_16x16x32_bf16 v[108:111], a[148:151], a[28:31], v[108:111]
  ds_read_b64_tr_b16 a[134:135], v1 offset:25120
  v_accvgpr_read_b32 v26, a204
  v_mfma_f32_16x16x32_bf16 v[108:111], a[144:147], a[12:15], v[108:111]
  v_accvgpr_read_b32 v27, a205
  v_accvgpr_read_b32 v28, a206
  v_mfma_f32_16x16x32_bf16 v[124:127], a[152:155], a[12:15], v[124:127]
  ds_read_b64_tr_b16 a[136:137], v1 offset:14400
  v_accvgpr_read_b32 v29, a207
  v_mfma_f32_16x16x32_bf16 v[124:127], a[156:159], a[28:31], v[124:127]
  buffer_load_dwordx4 v6, s[16:19], s52 offen offset:3072 lds
  v_add_f32 v22, v22, v26
  v_mfma_f32_16x16x32_bf16 v[120:123], a[156:159], a[24:27], v[120:123]
  ds_read_b64_tr_b16 a[138:139], v1 offset:17984
  v_add_f32 v23, v23, v27
  v_mfma_f32_16x16x32_bf16 v[120:123], a[152:155], a[8:11], v[120:123]
  v_add_f32 v24, v24, v28
  v_add_f32 v25, v25, v29
  v_mfma_f32_16x16x32_bf16 v[116:119], a[152:155], a[4:7], v[116:119]
  ds_read_b64_tr_b16 a[140:141], v1 offset:21568
  v_mov_b32 v26, v22
  v_mfma_f32_16x16x32_bf16 v[116:119], a[156:159], a[20:23], v[116:119]
  v_mov_b32 v27, v23
  v_mov_b32 v28, v24
  v_mfma_f32_16x16x32_bf16 v[112:115], a[156:159], a[16:19], v[112:115]
  ds_read_b64_tr_b16 a[142:143], v1 offset:25152
  v_mov_b32 v29, v25
  v_mfma_f32_16x16x32_bf16 v[112:115], a[152:155], a[0:3], v[112:115]
  s_waitcnt lgkmcnt(8)
  v_permlane16_swap_b32 v22, v26
  v_permlane16_swap_b32 v23, v27
  v_mfma_f32_16x16x32_bf16 v[128:131], a[160:163], a[0:3], v[128:131]
  ds_read_b64_tr_b16 a[144:145], v1 offset:14432
  v_permlane16_swap_b32 v24, v28
  v_mfma_f32_16x16x32_bf16 v[128:131], a[164:167], a[16:19], v[128:131]
  buffer_load_dwordx4 a[60:63], v0, s[36:39], s53 offen offset:3072 sc1
  v_permlane16_swap_b32 v25, v29
  v_mfma_f32_16x16x32_bf16 v[132:135], a[164:167], a[20:23], v[132:135]
  s_add_u32 m0, s88, 61440
  ds_read_b64_tr_b16 a[146:147], v1 offset:18016
  v_add_f32 v22, v22, v26
  v_mfma_f32_16x16x32_bf16 v[132:135], a[160:163], a[4:7], v[132:135]
  v_add_f32 v23, v23, v27
  v_add_f32 v24, v24, v28
  v_mfma_f32_16x16x32_bf16 v[136:139], a[160:163], a[8:11], v[136:139]
  ds_read_b64_tr_b16 a[148:149], v1 offset:21600
  v_add_f32 v25, v25, v29
  v_mfma_f32_16x16x32_bf16 v[136:139], a[164:167], a[24:27], v[136:139]
  v_mov_b32 v26, v22
  v_mov_b32 v27, v23
  v_mfma_f32_16x16x32_bf16 v[140:143], a[164:167], a[28:31], v[140:143]
  buffer_load_dwordx4 v7, s[16:19], s52 offen offset:0 lds
  s_bfe_u32 s53, s87, 0x40008
  v_mfma_f32_16x16x32_bf16 v[140:143], a[160:163], a[12:15], v[140:143]
  s_lshl_b32 s53, s53, 13
  s_add_u32 s53, s53, s89
  ds_read_b64_tr_b16 a[150:151], v1 offset:25184
  v_mfma_f32_16x16x32_bf16 v[156:159], a[168:171], a[12:15], v[156:159]
  ds_read_b64_tr_b16 a[152:153], v1 offset:14464
  v_mov_b32 v28, v24
  v_mfma_f32_16x16x32_bf16 v[156:159], a[172:175], a[28:31], v[156:159]
  v_mov_b32 v29, v25
  v_permlane32_swap_b32 v22, v26
  v_mfma_f32_16x16x32_bf16 v[152:155], a[172:175], a[24:27], v[152:155]
  ds_read_b64_tr_b16 a[154:155], v1 offset:18048
  v_permlane32_swap_b32 v23, v27
  v_mfma_f32_16x16x32_bf16 v[152:155], a[168:171], a[8:11], v[152:155]
  buffer_load_dwordx4 a[64:67], v0, s[36:39], s53 offen offset:0 sc1
  v_permlane32_swap_b32 v24, v28
  v_mfma_f32_16x16x32_bf16 v[148:151], a[168:171], a[4:7], v[148:151]
  ds_read_b64_tr_b16 a[156:157], v1 offset:21632
  v_permlane32_swap_b32 v25, v29
  v_mfma_f32_16x16x32_bf16 v[148:151], a[172:175], a[20:23], v[148:151]
  v_add_f32 v22, v22, v26
  v_add_f32 v23, v23, v27
  v_mfma_f32_16x16x32_bf16 v[144:147], a[172:175], a[16:19], v[144:147]
  ds_read_b64_tr_b16 a[158:159], v1 offset:25216
  v_add_f32 v24, v24, v28
  v_mfma_f32_16x16x32_bf16 v[144:147], a[168:171], a[0:3], v[144:147]
  s_waitcnt lgkmcnt(8)
  v_add_f32 v25, v25, v29
  v_mul_f32 v22, 0x3a800000, v22
  v_mfma_f32_16x16x32_bf16 v[160:163], a[128:131], a[0:3], v[160:163]
  ds_read_b64_tr_b16 a[160:161], v1 offset:14496
  v_mul_f32 v23, 0x3a800000, v23
  v_mfma_f32_16x16x32_bf16 v[160:163], a[132:135], a[16:19], v[160:163]
  v_fma_f32 v23, -v22, v22, v23
  v_max_f32 v23, 0, v23
  v_mfma_f32_16x16x32_bf16 v[164:167], a[132:135], a[20:23], v[164:167]
  buffer_load_dwordx4 v8, s[16:19], s52 offen offset:1024 lds
  v_cvt_pk_bf16_f32 v23, v23, v23
  v_mfma_f32_16x16x32_bf16 v[164:167], a[128:131], a[4:7], v[164:167]
  ds_read_b64_tr_b16 a[162:163], v1 offset:18080
  v_lshlrev_b32 v23, 16, v23
  v_mfma_f32_16x16x32_bf16 v[168:171], a[128:131], a[8:11], v[168:171]
  ds_read_b64_tr_b16 a[164:165], v1 offset:21664
  v_add_f32 v23, 0x3727c5ac, v23
  v_mfma_f32_16x16x32_bf16 v[168:171], a[132:135], a[24:27], v[168:171]
  v_cvt_pk_bf16_f32 v23, v23, v23
  v_lshlrev_b32 v23, 16, v23
  v_mfma_f32_16x16x32_bf16 v[172:175], a[132:135], a[28:31], v[172:175]
  ds_read_b64_tr_b16 a[166:167], v1 offset:25248
  v_mfma_f32_16x16x32_bf16 v[172:175], a[128:131], a[12:15], v[172:175]
  s_waitcnt vmcnt(15)
  s_barrier
  buffer_load_dwordx4 a[68:71], v0, s[36:39], s53 offen offset:1024 sc1
  v_mfma_f32_16x16x32_bf16 v[188:191], a[136:139], a[12:15], v[188:191]
  ds_read_b64_tr_b16 a[168:169], v1 offset:14528
  v_mfma_f32_16x16x32_bf16 v[188:191], a[140:143], a[28:31], v[188:191]
  v_sqrt_f32 v23, v23
  v_mfma_f32_16x16x32_bf16 v[184:187], a[140:143], a[24:27], v[184:187]
  s_nop 0
  ds_read_b64_tr_b16 a[170:171], v1 offset:18112
  v_cvt_pk_bf16_f32 v18, -v22, v23
  v_mfma_f32_16x16x32_bf16 v[184:187], a[136:139], a[8:11], v[184:187]
  v_and_b32 v23, 0xffff0000, v18
  v_mfma_f32_16x16x32_bf16 v[180:183], a[136:139], a[4:7], v[180:183]
  ds_read_b64_tr_b16 a[172:173], v1 offset:21696
  v_mfma_f32_16x16x32_bf16 v[180:183], a[140:143], a[20:23], v[180:183]
  v_rcp_f32 v16, v23
  v_mfma_f32_16x16x32_bf16 v[176:179], a[140:143], a[16:19], v[176:179]
  buffer_load_dwordx4 v9, s[16:19], s52 offen offset:2048 lds
  v_mul_f32 v17, v23, v23
  v_mfma_f32_16x16x32_bf16 v[176:179], a[136:139], a[0:3], v[176:179]
  s_waitcnt lgkmcnt(7)
  ds_read_b64_tr_b16 a[174:175], v1 offset:25280
  v_mul_f32 v16, 0xbfb8aa3b, v16
  v_mfma_f32_16x16x32_bf16 v[192:195], a[144:147], a[0:3], v[192:195]
  ds_read_b64_tr_b16 a[128:129], v1 offset:28672
  v_mul_f32 v24, 0x3a800000, v24
  v_mfma_f32_16x16x32_bf16 v[192:195], a[148:151], a[16:19], v[192:195]
  v_mul_f32 v25, 0x3a800000, v25
  v_fma_f32 v25, -v24, v24, v25
  v_mfma_f32_16x16x32_bf16 v[196:199], a[148:151], a[20:23], v[196:199]
  ds_read_b64_tr_b16 a[130:131], v1 offset:32256
  v_max_f32 v25, 0, v25
  v_mfma_f32_16x16x32_bf16 v[196:199], a[144:147], a[4:7], v[196:199]
  v_cvt_pk_bf16_f32 v25, v25, v25
  v_lshlrev_b32 v25, 16, v25
  v_mfma_f32_16x16x32_bf16 v[200:203], a[144:147], a[8:11], v[200:203]
  ds_read_b64_tr_b16 a[132:133], v1 offset:35840
  v_add_f32 v25, 0x3727c5ac, v25
  v_mfma_f32_16x16x32_bf16 v[200:203], a[148:151], a[24:27], v[200:203]
  v_cvt_pk_bf16_f32 v25, v25, v25
  v_lshlrev_b32 v25, 16, v25
  v_mfma_f32_16x16x32_bf16 v[204:207], a[148:151], a[28:31], v[204:207]
  buffer_load_dwordx4 a[72:75], v0, s[36:39], s53 offen offset:2048 sc1
  v_mfma_f32_16x16x32_bf16 v[204:207], a[144:147], a[12:15], v[204:207]
  ds_read_b64_tr_b16 a[134:135], v1 offset:39424
  v_mfma_f32_16x16x32_bf16 v[220:223], a[152:155], a[12:15], v[220:223]
  ds_read_b64_tr_b16 a[136:137], v1 offset:28704
  v_mfma_f32_16x16x32_bf16 v[220:223], a[156:159], a[28:31], v[220:223]
  v_sqrt_f32 v25, v25
  v_mfma_f32_16x16x32_bf16 v[216:219], a[156:159], a[24:27], v[216:219]
  s_nop 0
  ds_read_b64_tr_b16 a[138:139], v1 offset:32288
  v_cvt_pk_bf16_f32 v21, -v24, v25
  v_mfma_f32_16x16x32_bf16 v[216:219], a[152:155], a[8:11], v[216:219]
  v_and_b32 v25, 0xffff0000, v21
  v_mfma_f32_16x16x32_bf16 v[212:215], a[152:155], a[4:7], v[212:215]
  s_bfe_u32 s52, s87, 0x4000c
  s_mul_i32 s52, s52, 458752
  s_add_u32 m0, s88, 86016
  v_mfma_f32_16x16x32_bf16 v[212:215], a[156:159], a[20:23], v[212:215]
  ds_read_b64_tr_b16 a[140:141], v1 offset:35872
  v_mfma_f32_16x16x32_bf16 v[208:211], a[156:159], a[16:19], v[208:211]
  ds_read_b64_tr_b16 a[142:143], v1 offset:39456
  v_mfma_f32_16x16x32_bf16 v[208:211], a[152:155], a[0:3], v[208:211]
  s_waitcnt lgkmcnt(8)
  v_rcp_f32 v19, v25
  v_mfma_f32_16x16x32_bf16 v[224:227], a[160:163], a[0:3], v[224:227]
  buffer_load_dwordx4 v3, s[16:19], s52 offen offset:0 lds
  v_mul_f32 v20, v25, v25
  v_mfma_f32_16x16x32_bf16 v[224:227], a[164:167], a[16:19], v[224:227]
  v_mul_f32 v19, 0xbfb8aa3b, v19
  v_add_u32 v31, -28672, v31
  v_mfma_f32_16x16x32_bf16 v[228:231], a[164:167], a[20:23], v[228:231]
  ds_read_b64_tr_b16 a[176:177], v31 offset:0
  v_mfma_f32_16x16x32_bf16 v[228:231], a[160:163], a[4:7], v[228:231]
  ds_read_b64_tr_b16 a[178:179], v31 offset:3584
  v_mfma_f32_16x16x32_bf16 v[232:235], a[160:163], a[8:11], v[232:235]
  ds_read_b64_tr_b16 a[180:181], v31 offset:7168
  v_mfma_f32_16x16x32_bf16 v[232:235], a[164:167], a[24:27], v[232:235]
  buffer_load_dwordx4 a[76:79], v0, s[36:39], s53 offen offset:3072 sc1
  v_mfma_f32_16x16x32_bf16 v[236:239], a[164:167], a[28:31], v[236:239]
  ds_read_b64_tr_b16 a[182:183], v31 offset:10752
  v_mfma_f32_16x16x32_bf16 v[236:239], a[160:163], a[12:15], v[236:239]
  ds_read_b64_tr_b16 a[184:185], v31 offset:32
  v_mfma_f32_16x16x32_bf16 v[252:255], a[168:171], a[12:15], v[252:255]
  ds_read_b64_tr_b16 a[144:145], v1 offset:28736
  v_mfma_f32_16x16x32_bf16 v[252:255], a[172:175], a[28:31], v[252:255]
  ds_read_b64_tr_b16 a[186:187], v31 offset:3616
  v_mfma_f32_16x16x32_bf16 v[248:251], a[172:175], a[24:27], v[248:251]
  ds_read_b64_tr_b16 a[146:147], v1 offset:32320
  v_mfma_f32_16x16x32_bf16 v[248:251], a[168:171], a[8:11], v[248:251]
  ds_read_b64_tr_b16 a[188:189], v31 offset:7200
  v_mfma_f32_16x16x32_bf16 v[244:247], a[168:171], a[4:7], v[244:247]
  buffer_load_dwordx4 v4, s[16:19], s52 offen offset:1024 lds
  v_mfma_f32_16x16x32_bf16 v[244:247], a[172:175], a[20:23], v[244:247]
  ds_read_b64_tr_b16 a[148:149], v1 offset:35904
  v_mfma_f32_16x16x32_bf16 v[240:243], a[172:175], a[16:19], v[240:243]
  s_add_u32 s53, s53, 4096
  ds_read_b64_tr_b16 a[150:151], v1 offset:39488
  v_mfma_f32_16x16x32_bf16 v[240:243], a[168:171], a[0:3], v[240:243]
  s_waitcnt vmcnt(9) lgkmcnt(11)
  ds_read_b64_tr_b16 a[190:191], v31 offset:10784
  v_mfma_f32_16x16x32_bf16 v[32:35], a[128:131], a[32:35], v[32:35]
  ds_read_b64_tr_b16 a[152:153], v1 offset:28768
  v_mfma_f32_16x16x32_bf16 v[32:35], a[132:135], a[48:51], v[32:35]
  s_barrier
  ds_read_b64_tr_b16 a[192:193], v31 offset:64
  v_mfma_f32_16x16x32_bf16 v[36:39], a[132:135], a[52:55], v[36:39]
  buffer_load_dwordx4 a[80:83], v0, s[36:39], s53 offen offset:0 sc1
  v_mfma_f32_16x16x32_bf16 v[36:39], a[128:131], a[36:39], v[36:39]
  ds_read_b64_tr_b16 a[154:155], v1 offset:32352
  v_mfma_f32_16x16x32_bf16 v[40:43], a[128:131], a[40:43], v[40:43]
  ds_read_b64_tr_b16 a[156:157], v1 offset:35936
  v_mfma_f32_16x16x32_bf16 v[40:43], a[132:135], a[56:59], v[40:43]
  ds_read_b64_tr_b16 a[194:195], v31 offset:3648
  v_mfma_f32_16x16x32_bf16 v[44:47], a[132:135], a[60:63], v[44:47]
  ds_read_b64_tr_b16 a[196:197], v31 offset:7232
  ds_read_b64_tr_b16 a[198:199], v31 offset:10816
  ds_read_b64_tr_b16 a[200:201], v31 offset:96
  ds_read_b64_tr_b16 a[202:203], v31 offset:3680
  ds_read_b64_tr_b16 a[204:205], v31 offset:7264
  ds_read_b64_tr_b16 a[206:207], v31 offset:10848
  v_mfma_f32_16x16x32_bf16 v[44:47], a[128:131], a[44:47], v[44:47]
  ds_read_b64_tr_b16 a[158:159], v1 offset:39520
  v_lshrrev_b32 v22, 4, v0
  v_mfma_f32_16x16x32_bf16 v[60:63], a[136:139], a[44:47], v[60:63]
  buffer_load_dwordx4 v5, s[16:19], s52 offen offset:2048 lds
  v_and_b32 v23, 14, v22
  v_mfma_f32_16x16x32_bf16 v[60:63], a[140:143], a[60:63], v[60:63]
  ds_read_b64_tr_b16 a[160:161], v1 offset:28800
  v_lshlrev_b32 v23, 27, v23
  v_mfma_f32_16x16x32_bf16 v[56:59], a[140:143], a[56:59], v[56:59]
  ds_read_b64_tr_b16 a[162:163], v1 offset:32384
  v_and_b32 v24, 1, v22
  v_mfma_f32_16x16x32_bf16 v[56:59], a[136:139], a[40:43], v[56:59]
  v_lshl_add_u32 v23, v24, 9, v23
  v_and_b32 v22, 0x30, v22
  v_mfma_f32_16x16x32_bf16 v[52:55], a[136:139], a[36:39], v[52:55]
  ds_read_b64_tr_b16 a[164:165], v1 offset:35968
  v_add_u32 v22, v22, v23
  v_mfma_f32_16x16x32_bf16 v[52:55], a[140:143], a[52:55], v[52:55]
  s_lshl3_add_u32 s67, s59, s56
  buffer_load_dwordx4 a[84:87], v0, s[36:39], s53 offen offset:1024 sc1
  s_lshr_b32 s68, s44, 1
  v_mfma_f32_16x16x32_bf16 v[48:51], a[140:143], a[48:51], v[48:51]
  s_lshl1_add_u32 s67, s67, s68
  ds_read_b64_tr_b16 a[166:167], v1 offset:39552
  s_and_b32 s68, s44, 1
  v_mfma_f32_16x16x32_bf16 v[48:51], a[136:139], a[32:35], v[48:51]
  s_waitcnt vmcnt(21) lgkmcnt(5)
  s_lshl2_add_u32 s67, s67, s68
  s_lshl_b32 s67, s67, 8
  v_mfma_f32_16x16x32_bf16 a[216:219], a[176:179], a[208:211], a[216:219]
  s_add_u32 s67, s67, 524288
  ds_read_b64_tr_b16 a[168:169], v1 offset:28832
  v_mfma_f32_16x16x32_bf16 a[216:219], a[180:183], a[212:215], a[216:219]
  v_mfma_f32_16x16x32_bf16 a[220:223], a[184:187], a[208:211], a[220:223]
  ds_read_b64_tr_b16 a[170:171], v1 offset:32416
  v_mfma_f32_16x16x32_bf16 a[220:223], a[188:191], a[212:215], a[220:223]
  v_mfma_f32_16x16x32_bf16 a[224:227], a[192:195], a[208:211], a[224:227]
  buffer_load_dwordx4 v6, s[16:19], s52 offen offset:3072 lds
  v_mfma_f32_16x16x32_bf16 a[224:227], a[196:199], a[212:215], a[224:227]
  ds_read_b64_tr_b16 a[172:173], v1 offset:36000
  v_mfma_f32_16x16x32_bf16 a[228:231], a[200:203], a[208:211], a[228:231]
  ds_read_b64_tr_b16 a[174:175], v1 offset:39584
  v_mfma_f32_16x16x32_bf16 a[228:231], a[204:207], a[212:215], a[228:231]
  s_waitcnt lgkmcnt(8)
  v_mfma_f32_16x16x32_bf16 v[64:67], a[144:147], a[32:35], v[64:67]
  ds_read_b64_tr_b16 a[128:129], v1 offset:28864
  v_mfma_f32_16x16x32_bf16 v[64:67], a[148:151], a[48:51], v[64:67]
  buffer_load_dwordx4 a[88:91], v0, s[36:39], s53 offen offset:2048 sc1
  v_mfma_f32_16x16x32_bf16 v[68:71], a[148:151], a[52:55], v[68:71]
Hb1_1:
  s_cbranch_execz Hb1_2
  ds_read_b64_tr_b16 a[130:131], v1 offset:32448
  v_mfma_f32_16x16x32_bf16 v[68:71], a[144:147], a[36:39], v[68:71]
  s_add_u32 m0, s88, 90112
  v_mfma_f32_16x16x32_bf16 v[72:75], a[144:147], a[40:43], v[72:75]
  ds_read_b64_tr_b16 a[132:133], v1 offset:36032
  v_mfma_f32_16x16x32_bf16 v[72:75], a[148:151], a[56:59], v[72:75]
  v_mfma_f32_16x16x32_bf16 v[76:79], a[148:151], a[60:63], v[76:79]
  ds_read_b64_tr_b16 a[134:135], v1 offset:39616
  v_mfma_f32_16x16x32_bf16 v[76:79], a[144:147], a[44:47], v[76:79]
  buffer_load_dwordx4 v7, s[16:19], s52 offen offset:0 lds
  v_mfma_f32_16x16x32_bf16 v[92:95], a[152:155], a[44:47], v[92:95]
  ds_read_b64_tr_b16 a[136:137], v1 offset:43008
  v_mfma_f32_16x16x32_bf16 v[92:95], a[156:159], a[60:63], v[92:95]
  v_mfma_f32_16x16x32_bf16 v[88:91], a[156:159], a[56:59], v[88:91]
  ds_read_b64_tr_b16 a[138:139], v1 offset:46592
  v_mfma_f32_16x16x32_bf16 v[88:91], a[152:155], a[40:43], v[88:91]
  v_mfma_f32_16x16x32_bf16 v[84:87], a[152:155], a[36:39], v[84:87]
  buffer_load_dwordx4 a[92:95], v0, s[36:39], s53 offen offset:3072 sc1
  s_bfe_u32 s53, s87, 0x4000c
  v_mfma_f32_16x16x32_bf16 v[84:87], a[156:159], a[52:55], v[84:87]
  s_lshl_b32 s53, s53, 13
  s_add_u32 s53, s53, s89
  ds_read_b64_tr_b16 a[140:141], v1 offset:50176
  v_mfma_f32_16x16x32_bf16 v[80:83], a[156:159], a[48:51], v[80:83]
  ds_read_b64_tr_b16 a[142:143], v1 offset:53760
  v_mfma_f32_16x16x32_bf16 v[80:83], a[152:155], a[32:35], v[80:83]
  s_waitcnt lgkmcnt(8)
  v_mfma_f32_16x16x32_bf16 v[96:99], a[160:163], a[32:35], v[96:99]
  ds_read_b64_tr_b16 a[144:145], v1 offset:43040
  v_mfma_f32_16x16x32_bf16 v[96:99], a[164:167], a[48:51], v[96:99]
  buffer_load_dwordx4 a[96:99], v0, s[36:39], s53 offen offset:0 sc1
  v_mfma_f32_16x16x32_bf16 v[100:103], a[164:167], a[52:55], v[100:103]
  buffer_store_dwordx4 a[216:219], v22, s[36:39], s67 offen offset:0 sc1
  v_mfma_f32_16x16x32_bf16 v[100:103], a[160:163], a[36:39], v[100:103]
  ds_read_b64_tr_b16 a[146:147], v1 offset:46624
  v_mfma_f32_16x16x32_bf16 v[104:107], a[160:163], a[40:43], v[104:107]
  ds_read_b64_tr_b16 a[148:149], v1 offset:50208
  v_mfma_f32_16x16x32_bf16 v[104:107], a[164:167], a[56:59], v[104:107]
  v_mfma_f32_16x16x32_bf16 v[108:111], a[164:167], a[60:63], v[108:111]
  buffer_store_dwordx4 a[220:223], v22, s[36:39], s67 offen offset:64 sc1
  v_mfma_f32_16x16x32_bf16 v[108:111], a[160:163], a[44:47], v[108:111]
  ds_read_b64_tr_b16 a[150:151], v1 offset:53792
  v_mfma_f32_16x16x32_bf16 v[124:127], a[168:171], a[44:47], v[124:127]
  ds_read_b64_tr_b16 a[152:153], v1 offset:43072
  v_mfma_f32_16x16x32_bf16 v[124:127], a[172:175], a[60:63], v[124:127]
  v_mfma_f32_16x16x32_bf16 v[120:123], a[172:175], a[56:59], v[120:123]
  buffer_store_dwordx4 a[224:227], v22, s[36:39], s67 offen offset:128 sc1
  v_mfma_f32_16x16x32_bf16 v[120:123], a[168:171], a[40:43], v[120:123]
  ds_read_b64_tr_b16 a[154:155], v1 offset:46656
  v_mfma_f32_16x16x32_bf16 v[116:119], a[168:171], a[36:39], v[116:119]
  ds_read_b64_tr_b16 a[156:157], v1 offset:50240
  v_mfma_f32_16x16x32_bf16 v[116:119], a[172:175], a[52:55], v[116:119]
  v_mfma_f32_16x16x32_bf16 v[112:115], a[172:175], a[48:51], v[112:115]
  buffer_store_dwordx4 a[228:231], v22, s[36:39], s67 offen offset:192 sc1
  s_lshl_b32 s68, s59, 14
  v_mfma_f32_16x16x32_bf16 v[112:115], a[168:171], a[32:35], v[112:115]
  s_waitcnt lgkmcnt(7)
  ds_read_b64_tr_b16 a[158:159], v1 offset:53824
  s_lshl_b32 s69, s44, 9
  v_mfma_f32_16x16x32_bf16 v[128:131], a[128:131], a[32:35], v[128:131]
  s_add_u32 s68, s68, s69
  ds_read_b64_tr_b16 a[160:161], v1 offset:43104
  s_add_u32 s68, s68, 524288
  v_mfma_f32_16x16x32_bf16 v[128:131], a[132:135], a[48:51], v[128:131]
  s_lshr_b32 s69, s44, 1
  s_lshl_b32 s69, s69, 8
  s_and_b32 s64, s44, 1
  v_mfma_f32_16x16x32_bf16 v[132:135], a[132:135], a[52:55], v[132:135]
  s_add_u32 s69, s69, s64
  ds_read_b64_tr_b16 a[162:163], v1 offset:46688
  s_lshl3_add_u32 s69, s69, 159744
  v_mfma_f32_16x16x32_bf16 v[132:135], a[128:131], a[36:39], v[132:135]
  buffer_load_dwordx4 v8, s[16:19], s52 offen offset:1024 lds
  v_and_b32 v24, 0x1f0, v0
  v_mfma_f32_16x16x32_bf16 v[136:139], a[128:131], a[40:43], v[136:139]
  ds_read_b64_tr_b16 a[164:165], v1 offset:50272
  v_min_u32 v24, 432, v24
  v_mfma_f32_16x16x32_bf16 v[136:139], a[132:135], a[56:59], v[136:139]
  v_and_b32 v26, 0x200, v0
  v_lshl_add_u32 v25, v26, 4, v24
  v_mfma_f32_16x16x32_bf16 v[140:143], a[132:135], a[60:63], v[140:143]
  ds_read_b64_tr_b16 a[166:167], v1 offset:53856
  v_lshrrev_b32 v26, 4, v26
  v_mfma_f32_16x16x32_bf16 v[140:143], a[128:131], a[44:47], v[140:143]
  v_lshl_add_u32 v24, v24, 2, v26
  v_add_u32 v24, s69, v24
  v_mfma_f32_16x16x32_bf16 v[156:159], a[136:139], a[44:47], v[156:159]
  s_lshl2_add_u32 s64, s56, s44
  buffer_load_dwordx4 a[100:103], v0, s[36:39], s53 offen offset:1024 sc1
  s_lshl_b32 s64, s64, 19
  v_mfma_f32_16x16x32_bf16 v[156:159], a[140:143], a[60:63], v[156:159]
  s_mul_i32 s65, s59, 7
  ds_read_b64_tr_b16 a[168:169], v1 offset:43136
  s_and_b32 s69, s59, 1
  v_mfma_f32_16x16x32_bf16 v[152:155], a[140:143], a[56:59], v[152:155]
  s_add_u32 s65, s65, s69
  ds_read_b64_tr_b16 a[170:171], v1 offset:46720
  s_lshl_b32 s65, s65, 10
  v_mfma_f32_16x16x32_bf16 v[152:155], a[136:139], a[40:43], v[152:155]
  s_add_u32 s64, s64, s65
  s_add_u32 s66, s64, 19922944
  s_mul_i32 s69, s69, 8184
  v_mfma_f32_16x16x32_bf16 v[148:151], a[136:139], a[36:39], v[148:151]
  s_sub_u32 s64, s66, s69
  ds_read_b64_tr_b16 a[172:173], v1 offset:50304
  s_add_u32 s64, s64, 6144
  v_mfma_f32_16x16x32_bf16 v[148:151], a[140:143], a[52:55], v[148:151]
  s_add_u32 s65, s64, 262144
  buffer_load_dwordx4 v9, s[16:19], s52 offen offset:2048 lds
  s_lshl_b32 s45, s2, 7
  v_mfma_f32_16x16x32_bf16 v[144:147], a[140:143], a[48:51], v[144:147]
  s_add_u32 s45, s45, 5406720
  ds_read_b64_tr_b16 a[174:175], v1 offset:53888
  s_cmp_eq_u32 s44, 0
  v_mfma_f32_16x16x32_bf16 v[144:147], a[136:139], a[32:35], v[144:147]
  s_waitcnt lgkmcnt(8)
  s_cselect_b32 s45, s45, 1073741824
  s_add_u32 s67, s68, 4096
  v_mfma_f32_16x16x32_bf16 v[160:163], a[144:147], a[32:35], v[160:163]
  ds_read_b64_tr_b16 a[128:129], v1 offset:43168
  v_mfma_f32_16x16x32_bf16 v[160:163], a[148:151], a[48:51], v[160:163]
  v_mfma_f32_16x16x32_bf16 v[164:167], a[148:151], a[52:55], v[164:167]
  buffer_load_dwordx4 a[104:107], v0, s[36:39], s53 offen offset:2048 sc1
  v_mfma_f32_16x16x32_bf16 v[164:167], a[144:147], a[36:39], v[164:167]
  ds_read_b64_tr_b16 a[130:131], v1 offset:46752
  v_mfma_f32_16x16x32_bf16 v[168:171], a[144:147], a[40:43], v[168:171]
  ds_read_b64_tr_b16 a[132:133], v1 offset:50336
  v_mfma_f32_16x16x32_bf16 v[168:171], a[148:151], a[56:59], v[168:171]
  v_mfma_f32_16x16x32_bf16 v[172:175], a[148:151], a[60:63], v[172:175]
  ds_read_b64_tr_b16 a[134:135], v1 offset:53920
  v_mfma_f32_16x16x32_bf16 v[172:175], a[144:147], a[44:47], v[172:175]
  s_waitcnt vmcnt(20)
  s_barrier
  buffer_load_dwordx4 a[108:111], v0, s[36:39], s53 offen offset:3072 sc1
  s_bfe_u32 s52, s87, 0x40010
  v_mfma_f32_16x16x32_bf16 v[188:191], a[152:155], a[44:47], v[188:191]
  s_mul_i32 s52, s52, 458752
  s_add_u32 m0, s88, 0
  ds_read_b64_tr_b16 a[136:137], v1 offset:43200
  v_mfma_f32_16x16x32_bf16 v[188:191], a[156:159], a[60:63], v[188:191]
  v_mfma_f32_16x16x32_bf16 v[184:187], a[156:159], a[56:59], v[184:187]
  ds_read_b64_tr_b16 a[138:139], v1 offset:46784
  v_mfma_f32_16x16x32_bf16 v[184:187], a[152:155], a[40:43], v[184:187]
  v_mfma_f32_16x16x32_bf16 v[180:183], a[152:155], a[36:39], v[180:183]
  buffer_load_dwordx4 v3, s[16:19], s52 offen offset:0 lds
  s_add_u32 s53, s53, 4096
  v_mfma_f32_16x16x32_bf16 v[180:183], a[156:159], a[52:55], v[180:183]
  ds_read_b64_tr_b16 a[140:141], v1 offset:50368
  v_mfma_f32_16x16x32_bf16 v[176:179], a[156:159], a[48:51], v[176:179]
  ds_read_b64_tr_b16 a[142:143], v1 offset:53952
  v_mfma_f32_16x16x32_bf16 v[176:179], a[152:155], a[32:35], v[176:179]
  s_waitcnt lgkmcnt(8)
  v_mfma_f32_16x16x32_bf16 v[192:195], a[160:163], a[32:35], v[192:195]
  ds_read_b64_tr_b16 a[144:145], v2 offset:0
  v_mfma_f32_16x16x32_bf16 v[192:195], a[164:167], a[48:51], v[192:195]
  buffer_load_dwordx4 a[112:115], v0, s[36:39], s53 offen offset:0 sc1
  v_mfma_f32_16x16x32_bf16 v[196:199], a[164:167], a[52:55], v[196:199]
  ds_read_b64_tr_b16 a[146:147], v2 offset:3584
  v_mfma_f32_16x16x32_bf16 v[196:199], a[160:163], a[36:39], v[196:199]
  v_mfma_f32_16x16x32_bf16 v[200:203], a[160:163], a[40:43], v[200:203]
  ds_read_b64_tr_b16 a[148:149], v2 offset:7168
  v_mfma_f32_16x16x32_bf16 v[200:203], a[164:167], a[56:59], v[200:203]
  v_mfma_f32_16x16x32_bf16 v[204:207], a[164:167], a[60:63], v[204:207]
  buffer_load_dwordx4 v4, s[16:19], s52 offen offset:1024 lds
  v_mfma_f32_16x16x32_bf16 v[204:207], a[160:163], a[44:47], v[204:207]
  ds_read_b64_tr_b16 a[150:151], v2 offset:10752
  v_mfma_f32_16x16x32_bf16 v[220:223], a[168:171], a[44:47], v[220:223]
  ds_read_b64_tr_b16 a[152:153], v2 offset:32
  v_mfma_f32_16x16x32_bf16 v[220:223], a[172:175], a[60:63], v[220:223]
  v_mfma_f32_16x16x32_bf16 v[216:219], a[172:175], a[56:59], v[216:219]
  ds_read_b64_tr_b16 a[154:155], v2 offset:3616
  v_mfma_f32_16x16x32_bf16 v[216:219], a[168:171], a[40:43], v[216:219]
  buffer_load_dwordx4 a[116:119], v0, s[36:39], s53 offen offset:1024 sc1
  v_mfma_f32_16x16x32_bf16 v[212:215], a[168:171], a[36:39], v[212:215]
  ds_read_b64_tr_b16 a[156:157], v2 offset:7200
  v_mfma_f32_16x16x32_bf16 v[212:215], a[172:175], a[52:55], v[212:215]
  v_mfma_f32_16x16x32_bf16 v[208:211], a[172:175], a[48:51], v[208:211]
  ds_read_b64_tr_b16 a[158:159], v2 offset:10784
  v_mfma_f32_16x16x32_bf16 v[208:211], a[168:171], a[32:35], v[208:211]
  s_waitcnt lgkmcnt(8)
  v_mfma_f32_16x16x32_bf16 v[224:227], a[128:131], a[32:35], v[224:227]
  buffer_load_dwordx4 a[120:123], v0, s[36:39], s53 offen offset:2048 sc1
  v_mfma_f32_16x16x32_bf16 v[224:227], a[132:135], a[48:51], v[224:227]
  ds_read_b64_tr_b16 a[160:161], v2 offset:64
  v_mfma_f32_16x16x32_bf16 v[228:231], a[132:135], a[52:55], v[228:231]
  ds_read_b64_tr_b16 a[162:163], v2 offset:3648
  v_mfma_f32_16x16x32_bf16 v[228:231], a[128:131], a[36:39], v[228:231]
  v_mfma_f32_16x16x32_bf16 v[232:235], a[128:131], a[40:43], v[232:235]
  ds_read_b64_tr_b16 a[164:165], v2 offset:7232
  v_mfma_f32_16x16x32_bf16 v[232:235], a[132:135], a[56:59], v[232:235]
  buffer_load_dwordx4 v5, s[16:19], s52 offen offset:2048 lds
  v_mfma_f32_16x16x32_bf16 v[236:239], a[132:135], a[60:63], v[236:239]
  ds_read_b64_tr_b16 a[166:167], v2 offset:10816
  v_mfma_f32_16x16x32_bf16 v[236:239], a[128:131], a[44:47], v[236:239]
  v_mfma_f32_16x16x32_bf16 v[252:255], a[136:139], a[44:47], v[252:255]
  ds_read_b64_tr_b16 a[168:169], v2 offset:96
  v_mfma_f32_16x16x32_bf16 v[252:255], a[140:143], a[60:63], v[252:255]
  v_mfma_f32_16x16x32_bf16 v[248:251], a[140:143], a[56:59], v[248:251]
  buffer_load_dwordx4 a[124:127], v0, s[36:39], s53 offen offset:3072 sc1
  v_mfma_f32_16x16x32_bf16 v[248:251], a[136:139], a[40:43], v[248:251]
  ds_read_b64_tr_b16 a[170:171], v2 offset:3680
  v_mfma_f32_16x16x32_bf16 v[244:247], a[136:139], a[36:39], v[244:247]
  ds_read_b64_tr_b16 a[172:173], v2 offset:7264
  v_mfma_f32_16x16x32_bf16 v[244:247], a[140:143], a[52:55], v[244:247]
  v_mfma_f32_16x16x32_bf16 v[240:243], a[140:143], a[48:51], v[240:243]
  ds_read_b64_tr_b16 a[174:175], v2 offset:10848
  v_mfma_f32_16x16x32_bf16 v[240:243], a[136:139], a[32:35], v[240:243]
  s_waitcnt vmcnt(17) lgkmcnt(8)
  buffer_load_dwordx4 v6, s[16:19], s52 offen offset:3072 lds
  s_bfe_u32 s53, s87, 0x40010
  v_mfma_f32_16x16x32_bf16 v[32:35], a[144:147], a[64:67], v[32:35]
  s_lshl_b32 s53, s53, 13
  s_add_u32 s53, s53, s89
  ds_read_b64_tr_b16 a[128:129], v2 offset:128
  v_mfma_f32_16x16x32_bf16 v[32:35], a[148:151], a[80:83], v[32:35]
  s_barrier
  v_mfma_f32_16x16x32_bf16 v[36:39], a[148:151], a[84:87], v[36:39]
  ds_read_b64_tr_b16 a[130:131], v2 offset:3712
  v_mfma_f32_16x16x32_bf16 v[36:39], a[144:147], a[68:71], v[36:39]
  v_mfma_f32_16x16x32_bf16 v[40:43], a[144:147], a[72:75], v[40:43]
  buffer_load_dwordx4 a[0:3], v0, s[36:39], s53 offen offset:0 sc1
  v_mfma_f32_16x16x32_bf16 v[40:43], a[148:151], a[88:91], v[40:43]
  s_add_u32 m0, s88, 4096
  ds_read_b64_tr_b16 a[132:133], v2 offset:7296
  v_mfma_f32_16x16x32_bf16 v[44:47], a[148:151], a[92:95], v[44:47]
  ds_read_b64_tr_b16 a[134:135], v2 offset:10880
  v_mfma_f32_16x16x32_bf16 v[44:47], a[144:147], a[76:79], v[44:47]
  v_mfma_f32_16x16x32_bf16 v[60:63], a[152:155], a[76:79], v[60:63]
  ds_read_b64_tr_b16 a[136:137], v2 offset:160
  v_mfma_f32_16x16x32_bf16 v[60:63], a[156:159], a[92:95], v[60:63]
  buffer_load_dwordx4 v7, s[16:19], s52 offen offset:0 lds
  v_mfma_f32_16x16x32_bf16 v[56:59], a[156:159], a[88:91], v[56:59]
  ds_read_b64_tr_b16 a[138:139], v2 offset:3744
  v_mfma_f32_16x16x32_bf16 v[56:59], a[152:155], a[72:75], v[56:59]
  v_mfma_f32_16x16x32_bf16 v[52:55], a[152:155], a[68:71], v[52:55]
  ds_read_b64_tr_b16 a[140:141], v2 offset:7328
  v_mfma_f32_16x16x32_bf16 v[52:55], a[156:159], a[84:87], v[52:55]
  v_mfma_f32_16x16x32_bf16 v[48:51], a[156:159], a[80:83], v[48:51]
  buffer_load_dwordx4 a[4:7], v0, s[36:39], s53 offen offset:1024 sc1
  v_mfma_f32_16x16x32_bf16 v[48:51], a[152:155], a[64:67], v[48:51]
  s_waitcnt lgkmcnt(7)
  ds_read_b64_tr_b16 a[142:143], v2 offset:10912
  v_mfma_f32_16x16x32_bf16 v[64:67], a[160:163], a[64:67], v[64:67]
  ds_read_b64_tr_b16 a[144:145], v2 offset:192
  v_mfma_f32_16x16x32_bf16 v[64:67], a[164:167], a[80:83], v[64:67]
  v_mfma_f32_16x16x32_bf16 v[68:71], a[164:167], a[84:87], v[68:71]
  ds_read_b64_tr_b16 a[146:147], v2 offset:3776
  v_mfma_f32_16x16x32_bf16 v[68:71], a[160:163], a[68:71], v[68:71]
  v_mfma_f32_16x16x32_bf16 v[72:75], a[160:163], a[72:75], v[72:75]
  buffer_load_dwordx4 a[8:11], v0, s[36:39], s53 offen offset:2048 sc1
  v_mfma_f32_16x16x32_bf16 v[72:75], a[164:167], a[88:91], v[72:75]
  ds_read_b64_tr_b16 a[148:149], v2 offset:7360
  v_mfma_f32_16x16x32_bf16 v[76:79], a[164:167], a[92:95], v[76:79]
  ds_read_b64_tr_b16 a[150:151], v2 offset:10944
  v_mfma_f32_16x16x32_bf16 v[76:79], a[160:163], a[76:79], v[76:79]
  v_mfma_f32_16x16x32_bf16 v[92:95], a[168:171], a[76:79], v[92:95]
  ds_read_b64_tr_b16 a[152:153], v2 offset:14336
  v_mfma_f32_16x16x32_bf16 v[92:95], a[172:175], a[92:95], v[92:95]
  buffer_load_dwordx4 v8, s[16:19], s52 offen offset:1024 lds
  v_mfma_f32_16x16x32_bf16 v[88:91], a[172:175], a[88:91], v[88:91]
  ds_read_b64_tr_b16 a[154:155], v2 offset:17920
  v_mfma_f32_16x16x32_bf16 v[88:91], a[168:171], a[72:75], v[88:91]
  v_mfma_f32_16x16x32_bf16 v[84:87], a[168:171], a[68:71], v[84:87]
  ds_read_b64_tr_b16 a[156:157], v2 offset:21504
  v_mfma_f32_16x16x32_bf16 v[84:87], a[172:175], a[84:87], v[84:87]
  v_mfma_f32_16x16x32_bf16 v[80:83], a[172:175], a[80:83], v[80:83]
  buffer_load_dwordx4 a[12:15], v0, s[36:39], s53 offen offset:3072 sc1
  v_mfma_f32_16x16x32_bf16 v[80:83], a[168:171], a[64:67], v[80:83]
  s_waitcnt lgkmcnt(7)
  ds_read_b64_tr_b16 a[158:159], v2 offset:25088
  v_mfma_f32_16x16x32_bf16 v[96:99], a[128:131], a[64:67], v[96:99]
  ds_read_b64_tr_b16 a[160:161], v2 offset:14368
  v_mfma_f32_16x16x32_bf16 v[96:99], a[132:135], a[80:83], v[96:99]
  v_mfma_f32_16x16x32_bf16 v[100:103], a[132:135], a[84:87], v[100:103]
  ds_read_b64_tr_b16 a[162:163], v2 offset:17952
  v_mfma_f32_16x16x32_bf16 v[100:103], a[128:131], a[68:71], v[100:103]
  buffer_load_dwordx4 v9, s[16:19], s52 offen offset:2048 lds
  v_mfma_f32_16x16x32_bf16 v[104:107], a[128:131], a[72:75], v[104:107]
  s_add_u32 s53, s53, 4096
  ds_read_b64_tr_b16 a[164:165], v2 offset:21536
  v_mfma_f32_16x16x32_bf16 v[104:107], a[132:135], a[88:91], v[104:107]
  v_mfma_f32_16x16x32_bf16 v[108:111], a[132:135], a[92:95], v[108:111]
  ds_read_b64_tr_b16 a[166:167], v2 offset:25120
  v_mfma_f32_16x16x32_bf16 v[108:111], a[128:131], a[76:79], v[108:111]
  v_mfma_f32_16x16x32_bf16 v[124:127], a[136:139], a[76:79], v[124:127]
  buffer_load_dwordx4 a[16:19], v0, s[36:39], s53 offen offset:0 sc1
  v_mfma_f32_16x16x32_bf16 v[124:127], a[140:143], a[92:95], v[124:127]
  ds_read_b64_tr_b16 a[168:169], v2 offset:14400
  v_mfma_f32_16x16x32_bf16 v[120:123], a[140:143], a[88:91], v[120:123]
  ds_read_b64_tr_b16 a[170:171], v2 offset:17984
  v_mfma_f32_16x16x32_bf16 v[120:123], a[136:139], a[72:75], v[120:123]
  v_mfma_f32_16x16x32_bf16 v[116:119], a[136:139], a[68:71], v[116:119]
  ds_read_b64_tr_b16 a[172:173], v2 offset:21568
  v_mfma_f32_16x16x32_bf16 v[116:119], a[140:143], a[84:87], v[116:119]
  v_mfma_f32_16x16x32_bf16 v[112:115], a[140:143], a[80:83], v[112:115]
  ds_read_b64_tr_b16 a[174:175], v2 offset:25152
  v_mfma_f32_16x16x32_bf16 v[112:115], a[136:139], a[64:67], v[112:115]
  s_waitcnt lgkmcnt(8)
  v_mfma_f32_16x16x32_bf16 v[128:131], a[144:147], a[64:67], v[128:131]
  ds_read_b64_tr_b16 a[128:129], v2 offset:14432
  v_mfma_f32_16x16x32_bf16 v[128:131], a[148:151], a[80:83], v[128:131]
  v_mfma_f32_16x16x32_bf16 v[132:135], a[148:151], a[84:87], v[132:135]
  buffer_load_dwordx4 a[20:23], v0, s[36:39], s53 offen offset:1024 sc1
  s_bfe_u32 s52, s87, 0x40014
  v_mfma_f32_16x16x32_bf16 v[132:135], a[144:147], a[68:71], v[132:135]
  s_mul_i32 s52, s52, 458752
  s_add_u32 m0, s88, 28672
  ds_read_b64_tr_b16 a[130:131], v2 offset:18016
  v_mfma_f32_16x16x32_bf16 v[136:139], a[144:147], a[72:75], v[136:139]
  ds_read_b64_tr_b16 a[132:133], v2 offset:21600
  v_mfma_f32_16x16x32_bf16 v[136:139], a[148:151], a[88:91], v[136:139]
  v_mfma_f32_16x16x32_bf16 v[140:143], a[148:151], a[92:95], v[140:143]
  ds_read_b64_tr_b16 a[134:135], v2 offset:25184
  v_mfma_f32_16x16x32_bf16 v[140:143], a[144:147], a[76:79], v[140:143]
  buffer_load_dwordx4 v3, s[16:19], s52 offen offset:0 lds
  v_mfma_f32_16x16x32_bf16 v[156:159], a[152:155], a[76:79], v[156:159]
  ds_read_b64_tr_b16 a[136:137], v2 offset:14464
  v_mfma_f32_16x16x32_bf16 v[156:159], a[156:159], a[92:95], v[156:159]
  v_mfma_f32_16x16x32_bf16 v[152:155], a[156:159], a[88:91], v[152:155]
  ds_read_b64_tr_b16 a[138:139], v2 offset:18048
  v_mfma_f32_16x16x32_bf16 v[152:155], a[152:155], a[72:75], v[152:155]
  v_mfma_f32_16x16x32_bf16 v[148:151], a[152:155], a[68:71], v[148:151]
  buffer_load_dwordx4 a[24:27], v0, s[36:39], s53 offen offset:2048 sc1
  v_mfma_f32_16x16x32_bf16 v[148:151], a[156:159], a[84:87], v[148:151]
  ds_read_b64_tr_b16 a[140:141], v2 offset:21632
  v_mfma_f32_16x16x32_bf16 v[144:147], a[156:159], a[80:83], v[144:147]
  ds_read_b64_tr_b16 a[142:143], v2 offset:25216
  v_mfma_f32_16x16x32_bf16 v[144:147], a[152:155], a[64:67], v[144:147]
  s_waitcnt lgkmcnt(8)
  v_mfma_f32_16x16x32_bf16 v[160:163], a[160:163], a[64:67], v[160:163]
  ds_read_b64_tr_b16 a[144:145], v2 offset:14496
  v_mfma_f32_16x16x32_bf16 v[160:163], a[164:167], a[80:83], v[160:163]
  buffer_load_dwordx4 v4, s[16:19], s52 offen offset:1024 lds
  v_mfma_f32_16x16x32_bf16 v[164:167], a[164:167], a[84:87], v[164:167]
  ds_read_b64_tr_b16 a[146:147], v2 offset:18080
  v_mfma_f32_16x16x32_bf16 v[164:167], a[160:163], a[68:71], v[164:167]
  v_mfma_f32_16x16x32_bf16 v[168:171], a[160:163], a[72:75], v[168:171]
  ds_read_b64_tr_b16 a[148:149], v2 offset:21664
  v_mfma_f32_16x16x32_bf16 v[168:171], a[164:167], a[88:91], v[168:171]
  v_mfma_f32_16x16x32_bf16 v[172:175], a[164:167], a[92:95], v[172:175]
  buffer_load_dwordx4 a[28:31], v0, s[36:39], s53 offen offset:3072 sc1
  v_mfma_f32_16x16x32_bf16 v[172:175], a[160:163], a[76:79], v[172:175]
  s_waitcnt vmcnt(23)
  s_barrier
  ds_read_b64_tr_b16 a[150:151], v2 offset:25248
  v_mfma_f32_16x16x32_bf16 v[188:191], a[168:171], a[76:79], v[188:191]
  ds_read_b64_tr_b16 a[152:153], v2 offset:14528
  v_mfma_f32_16x16x32_bf16 v[188:191], a[172:175], a[92:95], v[188:191]
  v_mfma_f32_16x16x32_bf16 v[184:187], a[172:175], a[88:91], v[184:187]
  ds_read_b64_tr_b16 a[154:155], v2 offset:18112
  v_mfma_f32_16x16x32_bf16 v[184:187], a[168:171], a[72:75], v[184:187]
  buffer_load_dwordx4 v5, s[16:19], s52 offen offset:2048 lds
  s_bfe_u32 s53, s87, 0x40014
  v_mfma_f32_16x16x32_bf16 v[180:183], a[168:171], a[68:71], v[180:183]
  s_lshl_b32 s53, s53, 13
  s_add_u32 s53, s53, s89
  ds_read_b64_tr_b16 a[156:157], v2 offset:21696
  v_mfma_f32_16x16x32_bf16 v[180:183], a[172:175], a[84:87], v[180:183]
  v_mfma_f32_16x16x32_bf16 v[176:179], a[172:175], a[80:83], v[176:179]
  ds_read_b64_tr_b16 a[158:159], v2 offset:25280
  v_mfma_f32_16x16x32_bf16 v[176:179], a[168:171], a[64:67], v[176:179]
  s_waitcnt lgkmcnt(8)
  v_mfma_f32_16x16x32_bf16 v[192:195], a[128:131], a[64:67], v[192:195]
  buffer_load_dwordx4 a[32:35], v0, s[36:39], s53 offen offset:0 sc1
  v_mfma_f32_16x16x32_bf16 v[192:195], a[132:135], a[80:83], v[192:195]
  ds_read_b64_tr_b16 a[160:161], v2 offset:28672
  v_mfma_f32_16x16x32_bf16 v[196:199], a[132:135], a[84:87], v[196:199]
  ds_read_b64_tr_b16 a[162:163], v2 offset:32256
  v_mfma_f32_16x16x32_bf16 v[196:199], a[128:131], a[68:71], v[196:199]
  v_mfma_f32_16x16x32_bf16 v[200:203], a[128:131], a[72:75], v[200:203]
  ds_read_b64_tr_b16 a[164:165], v2 offset:35840
  v_mfma_f32_16x16x32_bf16 v[200:203], a[132:135], a[88:91], v[200:203]
  buffer_load_dwordx4 a[36:39], v0, s[36:39], s53 offen offset:1024 sc1
  v_mfma_f32_16x16x32_bf16 v[204:207], a[132:135], a[92:95], v[204:207]
  ds_read_b64_tr_b16 a[166:167], v2 offset:39424
  v_mfma_f32_16x16x32_bf16 v[204:207], a[128:131], a[76:79], v[204:207]
  v_mfma_f32_16x16x32_bf16 v[220:223], a[136:139], a[76:79], v[220:223]
  ds_read_b64_tr_b16 a[168:169], v2 offset:28704
  v_mfma_f32_16x16x32_bf16 v[220:223], a[140:143], a[92:95], v[220:223]
  v_mfma_f32_16x16x32_bf16 v[216:219], a[140:143], a[88:91], v[216:219]
  buffer_load_dwordx4 v6, s[16:19], s52 offen offset:3072 lds
  v_mfma_f32_16x16x32_bf16 v[216:219], a[136:139], a[72:75], v[216:219]
  ds_read_b64_tr_b16 a[170:171], v2 offset:32288
  v_mfma_f32_16x16x32_bf16 v[212:215], a[136:139], a[68:71], v[212:215]
  ds_read_b64_tr_b16 a[172:173], v2 offset:35872
  v_mfma_f32_16x16x32_bf16 v[212:215], a[140:143], a[84:87], v[212:215]
  v_mfma_f32_16x16x32_bf16 v[208:211], a[140:143], a[80:83], v[208:211]
  ds_read_b64_tr_b16 a[174:175], v2 offset:39456
  v_mfma_f32_16x16x32_bf16 v[208:211], a[136:139], a[64:67], v[208:211]
  s_waitcnt lgkmcnt(8)
  buffer_load_dwordx4 a[40:43], v0, s[36:39], s53 offen offset:2048 sc1
  s_add_u32 m0, s88, 32768
  v_mfma_f32_16x16x32_bf16 v[224:227], a[144:147], a[64:67], v[224:227]
  ds_read_b64_tr_b16 a[128:129], v2 offset:28736
  v_mfma_f32_16x16x32_bf16 v[224:227], a[148:151], a[80:83], v[224:227]
  v_mfma_f32_16x16x32_bf16 v[228:231], a[148:151], a[84:87], v[228:231]
  ds_read_b64_tr_b16 a[130:131], v2 offset:32320
  v_mfma_f32_16x16x32_bf16 v[228:231], a[144:147], a[68:71], v[228:231]
  v_mfma_f32_16x16x32_bf16 v[232:235], a[144:147], a[72:75], v[232:235]
  buffer_load_dwordx4 v7, s[16:19], s52 offen offset:0 lds
  v_mfma_f32_16x16x32_bf16 v[232:235], a[148:151], a[88:91], v[232:235]
  ds_read_b64_tr_b16 a[132:133], v2 offset:35904
  v_mfma_f32_16x16x32_bf16 v[236:239], a[148:151], a[92:95], v[236:239]
  ds_read_b64_tr_b16 a[134:135], v2 offset:39488
  v_mfma_f32_16x16x32_bf16 v[236:239], a[144:147], a[76:79], v[236:239]
  v_mfma_f32_16x16x32_bf16 v[252:255], a[152:155], a[76:79], v[252:255]
  ds_read_b64_tr_b16 a[136:137], v2 offset:28768
  v_mfma_f32_16x16x32_bf16 v[252:255], a[156:159], a[92:95], v[252:255]
  buffer_load_dwordx4 a[44:47], v0, s[36:39], s53 offen offset:3072 sc1
  v_mfma_f32_16x16x32_bf16 v[248:251], a[156:159], a[88:91], v[248:251]
  ds_read_b64_tr_b16 a[138:139], v2 offset:32352
  v_mfma_f32_16x16x32_bf16 v[248:251], a[152:155], a[72:75], v[248:251]
  v_mfma_f32_16x16x32_bf16 v[244:247], a[152:155], a[68:71], v[244:247]
  ds_read_b64_tr_b16 a[140:141], v2 offset:35936
  v_mfma_f32_16x16x32_bf16 v[244:247], a[156:159], a[84:87], v[244:247]
  v_mfma_f32_16x16x32_bf16 v[240:243], a[156:159], a[80:83], v[240:243]
  ds_read_b64_tr_b16 a[142:143], v2 offset:39520
  v_mfma_f32_16x16x32_bf16 v[240:243], a[152:155], a[64:67], v[240:243]
  s_waitcnt vmcnt(21) lgkmcnt(8)
  buffer_load_dwordx4 v8, s[16:19], s52 offen offset:1024 lds
  s_add_u32 s53, s53, 4096
  v_mfma_f32_16x16x32_bf16 v[32:35], a[160:163], a[96:99], v[32:35]
  ds_read_b64_tr_b16 a[144:145], v2 offset:28800
  v_mfma_f32_16x16x32_bf16 v[32:35], a[164:167], a[112:115], v[32:35]
  s_barrier
  v_mfma_f32_16x16x32_bf16 v[36:39], a[164:167], a[116:119], v[36:39]
  ds_read_b64_tr_b16 a[146:147], v2 offset:32384
  v_mfma_f32_16x16x32_bf16 v[36:39], a[160:163], a[100:103], v[36:39]
  v_mfma_f32_16x16x32_bf16 v[40:43], a[160:163], a[104:107], v[40:43]
  buffer_load_dwordx4 a[48:51], v0, s[36:39], s53 offen offset:0 sc1
  v_mfma_f32_16x16x32_bf16 v[40:43], a[164:167], a[120:123], v[40:43]
  ds_read_b64_tr_b16 a[148:149], v2 offset:35968
  v_mfma_f32_16x16x32_bf16 v[44:47], a[164:167], a[124:127], v[44:47]
  ds_read_b64_tr_b16 a[150:151], v2 offset:39552
  v_mfma_f32_16x16x32_bf16 v[44:47], a[160:163], a[108:111], v[44:47]
  v_mfma_f32_16x16x32_bf16 v[60:63], a[168:171], a[108:111], v[60:63]
  ds_read_b64_tr_b16 a[152:153], v2 offset:28832
  v_mfma_f32_16x16x32_bf16 v[60:63], a[172:175], a[124:127], v[60:63]
  v_mfma_f32_16x16x32_bf16 v[56:59], a[172:175], a[120:123], v[56:59]
  ds_read_b64_tr_b16 a[154:155], v2 offset:32416
  v_mfma_f32_16x16x32_bf16 v[56:59], a[168:171], a[104:107], v[56:59]
  buffer_load_dwordx4 v9, s[16:19], s52 offen offset:2048 lds
  v_mfma_f32_16x16x32_bf16 v[52:55], a[168:171], a[100:103], v[52:55]
  ds_read_b64_tr_b16 a[156:157], v2 offset:36000
  v_mfma_f32_16x16x32_bf16 v[52:55], a[172:175], a[116:119], v[52:55]
  v_mfma_f32_16x16x32_bf16 v[48:51], a[172:175], a[112:115], v[48:51]
  ds_read_b64_tr_b16 a[158:159], v2 offset:39584
  v_mfma_f32_16x16x32_bf16 v[48:51], a[168:171], a[96:99], v[48:51]
  s_waitcnt lgkmcnt(8)
  v_mfma_f32_16x16x32_bf16 v[64:67], a[128:131], a[96:99], v[64:67]
  buffer_load_dwordx4 a[52:55], v0, s[36:39], s53 offen offset:1024 sc1
  v_mfma_f32_16x16x32_bf16 v[64:67], a[132:135], a[112:115], v[64:67]
  ds_read_b64_tr_b16 a[160:161], v2 offset:28864
  v_mfma_f32_16x16x32_bf16 v[68:71], a[132:135], a[116:119], v[68:71]
  ds_read_b64_tr_b16 a[162:163], v2 offset:32448
  v_mfma_f32_16x16x32_bf16 v[68:71], a[128:131], a[100:103], v[68:71]
  v_mfma_f32_16x16x32_bf16 v[72:75], a[128:131], a[104:107], v[72:75]
  ds_read_b64_tr_b16 a[164:165], v2 offset:36032
  v_mfma_f32_16x16x32_bf16 v[72:75], a[132:135], a[120:123], v[72:75]
  v_mfma_f32_16x16x32_bf16 v[76:79], a[132:135], a[124:127], v[76:79]
  buffer_load_dwordx4 a[56:59], v0, s[36:39], s53 offen offset:2048 sc1
  v_mfma_f32_16x16x32_bf16 v[76:79], a[128:131], a[108:111], v[76:79]
  ds_read_b64_tr_b16 a[166:167], v2 offset:39616
  v_mfma_f32_16x16x32_bf16 v[92:95], a[136:139], a[108:111], v[92:95]
  s_bfe_u32 s52, s87, 0x40018
  s_mul_i32 s52, s52, 458752
  s_add_u32 m0, s88, 57344
  v_mfma_f32_16x16x32_bf16 v[92:95], a[140:143], a[124:127], v[92:95]
  ds_read_b64_tr_b16 a[168:169], v2 offset:43008
  v_mfma_f32_16x16x32_bf16 v[88:91], a[140:143], a[120:123], v[88:91]
  ds_read_b64_tr_b16 a[170:171], v2 offset:46592
  v_mfma_f32_16x16x32_bf16 v[88:91], a[136:139], a[104:107], v[88:91]
  v_mfma_f32_16x16x32_bf16 v[84:87], a[136:139], a[100:103], v[84:87]
  buffer_load_dwordx4 v3, s[16:19], s52 offen offset:0 lds
  v_mfma_f32_16x16x32_bf16 v[84:87], a[140:143], a[116:119], v[84:87]
  ds_read_b64_tr_b16 a[172:173], v2 offset:50176
  v_mfma_f32_16x16x32_bf16 v[80:83], a[140:143], a[112:115], v[80:83]
  ds_read_b64_tr_b16 a[174:175], v2 offset:53760
  v_mfma_f32_16x16x32_bf16 v[80:83], a[136:139], a[96:99], v[80:83]
  s_waitcnt lgkmcnt(8)
  v_mfma_f32_16x16x32_bf16 v[96:99], a[144:147], a[96:99], v[96:99]
  ds_read_b64_tr_b16 a[128:129], v2 offset:43040
  v_mfma_f32_16x16x32_bf16 v[96:99], a[148:151], a[112:115], v[96:99]
  buffer_load_dwordx4 a[60:63], v0, s[36:39], s53 offen offset:3072 sc1
  s_bfe_u32 s53, s87, 0x40018
  v_mfma_f32_16x16x32_bf16 v[100:103], a[148:151], a[116:119], v[100:103]
  s_lshl_b32 s53, s53, 13
  s_add_u32 s53, s53, s89
  ds_read_b64_tr_b16 a[130:131], v2 offset:46624
  v_mfma_f32_16x16x32_bf16 v[100:103], a[144:147], a[100:103], v[100:103]
  v_mfma_f32_16x16x32_bf16 v[104:107], a[144:147], a[104:107], v[104:107]
  buffer_load_dwordx4 a[208:211], v25, s[36:39], s68 offen offset:0 sc1
  v_mfma_f32_16x16x32_bf16 v[104:107], a[148:151], a[120:123], v[104:107]
  ds_read_b64_tr_b16 a[132:133], v2 offset:50208
  v_mfma_f32_16x16x32_bf16 v[108:111], a[148:151], a[124:127], v[108:111]
  ds_read_b64_tr_b16 a[134:135], v2 offset:53792
  v_mfma_f32_16x16x32_bf16 v[108:111], a[144:147], a[108:111], v[108:111]
  v_mfma_f32_16x16x32_bf16 v[124:127], a[152:155], a[108:111], v[124:127]
  ds_read_b64_tr_b16 a[136:137], v2 offset:43072
  v_mfma_f32_16x16x32_bf16 v[124:127], a[156:159], a[124:127], v[124:127]
  buffer_load_dwordx4 a[212:215], v25, s[36:39], s68 offen offset:2048 sc1
  v_mfma_f32_16x16x32_bf16 v[120:123], a[156:159], a[120:123], v[120:123]
  ds_read_b64_tr_b16 a[138:139], v2 offset:46656
  v_mfma_f32_16x16x32_bf16 v[120:123], a[152:155], a[104:107], v[120:123]
  v_mfma_f32_16x16x32_bf16 v[116:119], a[152:155], a[100:103], v[116:119]
  ds_read_b64_tr_b16 a[140:141], v2 offset:50240
  v_mfma_f32_16x16x32_bf16 v[116:119], a[156:159], a[116:119], v[116:119]
  v_mfma_f32_16x16x32_bf16 v[112:115], a[156:159], a[112:115], v[112:115]
  buffer_load_dwordx4 a[216:219], v25, s[36:39], s67 offen offset:0 sc1
  v_mfma_f32_16x16x32_bf16 v[112:115], a[152:155], a[96:99], v[112:115]
  s_waitcnt lgkmcnt(7)
  ds_read_b64_tr_b16 a[142:143], v2 offset:53824
  v_mfma_f32_16x16x32_bf16 v[128:131], a[160:163], a[96:99], v[128:131]
  ds_read_b64_tr_b16 a[144:145], v2 offset:43104
  v_mfma_f32_16x16x32_bf16 v[128:131], a[164:167], a[112:115], v[128:131]
  v_mfma_f32_16x16x32_bf16 v[132:135], a[164:167], a[116:119], v[132:135]
  ds_read_b64_tr_b16 a[146:147], v2 offset:46688
  v_mfma_f32_16x16x32_bf16 v[132:135], a[160:163], a[100:103], v[132:135]
  buffer_load_dwordx4 a[220:223], v25, s[36:39], s67 offen offset:2048 sc1
  v_mfma_f32_16x16x32_bf16 v[136:139], a[160:163], a[104:107], v[136:139]
  ds_read_b64_tr_b16 a[148:149], v2 offset:50272
  v_mfma_f32_16x16x32_bf16 v[136:139], a[164:167], a[120:123], v[136:139]
  v_mfma_f32_16x16x32_bf16 v[140:143], a[164:167], a[124:127], v[140:143]
  ds_read_b64_tr_b16 a[150:151], v2 offset:53856
  v_mfma_f32_16x16x32_bf16 v[140:143], a[160:163], a[108:111], v[140:143]
  v_mfma_f32_16x16x32_bf16 v[156:159], a[168:171], a[108:111], v[156:159]
  buffer_load_dwordx4 a[64:67], v0, s[36:39], s53 offen offset:0 sc1
  v_mfma_f32_16x16x32_bf16 v[156:159], a[172:175], a[124:127], v[156:159]
  ds_read_b64_tr_b16 a[152:153], v2 offset:43136
  v_mfma_f32_16x16x32_bf16 v[152:155], a[172:175], a[120:123], v[152:155]
  ds_read_b64_tr_b16 a[154:155], v2 offset:46720
  v_mfma_f32_16x16x32_bf16 v[152:155], a[168:171], a[104:107], v[152:155]
  v_mfma_f32_16x16x32_bf16 v[148:151], a[168:171], a[100:103], v[148:151]
  ds_read_b64_tr_b16 a[156:157], v2 offset:50304
  v_mfma_f32_16x16x32_bf16 v[148:151], a[172:175], a[116:119], v[148:151]
  buffer_load_dwordx4 v4, s[16:19], s52 offen offset:1024 lds
  v_mfma_f32_16x16x32_bf16 v[144:147], a[172:175], a[112:115], v[144:147]
Hb2_1:
  s_cbranch_execz Hb2_2
  ds_read_b64_tr_b16 a[158:159], v2 offset:53888
  v_mfma_f32_16x16x32_bf16 v[144:147], a[168:171], a[96:99], v[144:147]
  s_waitcnt lgkmcnt(8)
  v_mfma_f32_16x16x32_bf16 v[160:163], a[128:131], a[96:99], v[160:163]
  ds_read_b64_tr_b16 a[160:161], v2 offset:43168
  v_mfma_f32_16x16x32_bf16 v[160:163], a[132:135], a[112:115], v[160:163]
  v_mfma_f32_16x16x32_bf16 v[164:167], a[132:135], a[116:119], v[164:167]
  buffer_load_dwordx4 a[68:71], v0, s[36:39], s53 offen offset:1024 sc1
  v_mfma_f32_16x16x32_bf16 v[164:167], a[128:131], a[100:103], v[164:167]
  ds_read_b64_tr_b16 a[162:163], v2 offset:46752
  v_mfma_f32_16x16x32_bf16 v[168:171], a[128:131], a[104:107], v[168:171]
  ds_read_b64_tr_b16 a[164:165], v2 offset:50336
  v_mfma_f32_16x16x32_bf16 v[168:171], a[132:135], a[120:123], v[168:171]
  v_mfma_f32_16x16x32_bf16 v[172:175], a[132:135], a[124:127], v[172:175]
  ds_read_b64_tr_b16 a[166:167], v2 offset:53920
  v_mfma_f32_16x16x32_bf16 v[172:175], a[128:131], a[108:111], v[172:175]
  s_waitcnt vmcnt(27)
  s_barrier
  buffer_load_dwordx4 v5, s[16:19], s52 offen offset:2048 lds
  v_mfma_f32_16x16x32_bf16 v[188:191], a[136:139], a[108:111], v[188:191]
  ds_read_b64_tr_b16 a[168:169], v2 offset:43200
  v_mfma_f32_16x16x32_bf16 v[188:191], a[140:143], a[124:127], v[188:191]
  v_mfma_f32_16x16x32_bf16 v[184:187], a[140:143], a[120:123], v[184:187]
  ds_read_b64_tr_b16 a[170:171], v2 offset:46784
  v_mfma_f32_16x16x32_bf16 v[184:187], a[136:139], a[104:107], v[184:187]
  v_mfma_f32_16x16x32_bf16 v[180:183], a[136:139], a[100:103], v[180:183]
  buffer_load_dwordx4 a[72:75], v0, s[36:39], s53 offen offset:2048 sc1
  v_mfma_f32_16x16x32_bf16 v[180:183], a[140:143], a[116:119], v[180:183]
  ds_read_b64_tr_b16 a[172:173], v2 offset:50368
  v_mfma_f32_16x16x32_bf16 v[176:179], a[140:143], a[112:115], v[176:179]
  ds_read_b64_tr_b16 a[174:175], v2 offset:53952
  v_mfma_f32_16x16x32_bf16 v[176:179], a[136:139], a[96:99], v[176:179]
  s_waitcnt lgkmcnt(8)
  v_mfma_f32_16x16x32_bf16 v[192:195], a[144:147], a[96:99], v[192:195]
  ds_read_b64_tr_b16 a[128:129], v1 offset:0
  v_mfma_f32_16x16x32_bf16 v[192:195], a[148:151], a[112:115], v[192:195]
  buffer_load_dwordx4 v6, s[16:19], s52 offen offset:3072 lds
  v_mfma_f32_16x16x32_bf16 v[196:199], a[148:151], a[116:119], v[196:199]
  ds_read_b64_tr_b16 a[130:131], v1 offset:3584
  v_mfma_f32_16x16x32_bf16 v[196:199], a[144:147], a[100:103], v[196:199]
  v_mfma_f32_16x16x32_bf16 v[200:203], a[144:147], a[104:107], v[200:203]
  ds_read_b64_tr_b16 a[132:133], v1 offset:7168
  v_mfma_f32_16x16x32_bf16 v[200:203], a[148:151], a[120:123], v[200:203]
  v_mfma_f32_16x16x32_bf16 v[204:207], a[148:151], a[124:127], v[204:207]
  buffer_load_dwordx4 a[76:79], v0, s[36:39], s53 offen offset:3072 sc1
  s_add_u32 m0, s88, 61440
  v_mfma_f32_16x16x32_bf16 v[204:207], a[144:147], a[108:111], v[204:207]
  ds_read_b64_tr_b16 a[134:135], v1 offset:10752
  v_mfma_f32_16x16x32_bf16 v[220:223], a[152:155], a[108:111], v[220:223]
  ds_read_b64_tr_b16 a[136:137], v1 offset:32
  v_mfma_f32_16x16x32_bf16 v[220:223], a[156:159], a[124:127], v[220:223]
  v_mfma_f32_16x16x32_bf16 v[216:219], a[156:159], a[120:123], v[216:219]
  ds_read_b64_tr_b16 a[138:139], v1 offset:3616
  v_mfma_f32_16x16x32_bf16 v[216:219], a[152:155], a[104:107], v[216:219]
  buffer_load_dwordx4 v7, s[16:19], s52 offen offset:0 lds
  s_add_u32 s53, s53, 4096
  v_mfma_f32_16x16x32_bf16 v[212:215], a[152:155], a[100:103], v[212:215]
  ds_read_b64_tr_b16 a[140:141], v1 offset:7200
  v_mfma_f32_16x16x32_bf16 v[212:215], a[156:159], a[116:119], v[212:215]
  v_mfma_f32_16x16x32_bf16 v[208:211], a[156:159], a[112:115], v[208:211]
  ds_read_b64_tr_b16 a[142:143], v1 offset:10784
  v_mfma_f32_16x16x32_bf16 v[208:211], a[152:155], a[96:99], v[208:211]
  s_waitcnt lgkmcnt(8)
  v_mfma_f32_16x16x32_bf16 v[224:227], a[160:163], a[96:99], v[224:227]
  buffer_load_dwordx4 a[80:83], v0, s[36:39], s53 offen offset:0 sc1
  v_mfma_f32_16x16x32_bf16 v[224:227], a[164:167], a[112:115], v[224:227]
  ds_read_b64_tr_b16 a[144:145], v1 offset:64
  v_mfma_f32_16x16x32_bf16 v[228:231], a[164:167], a[116:119], v[228:231]
  ds_read_b64_tr_b16 a[146:147], v1 offset:3648
  v_mfma_f32_16x16x32_bf16 v[228:231], a[160:163], a[100:103], v[228:231]
  v_mfma_f32_16x16x32_bf16 v[232:235], a[160:163], a[104:107], v[232:235]
  ds_read_b64_tr_b16 a[148:149], v1 offset:7232
  v_mfma_f32_16x16x32_bf16 v[232:235], a[164:167], a[120:123], v[232:235]
  buffer_load_dwordx4 a[84:87], v0, s[36:39], s53 offen offset:1024 sc1
  v_mfma_f32_16x16x32_bf16 v[236:239], a[164:167], a[124:127], v[236:239]
  ds_read_b64_tr_b16 a[150:151], v1 offset:10816
  v_mfma_f32_16x16x32_bf16 v[236:239], a[160:163], a[108:111], v[236:239]
  v_mfma_f32_16x16x32_bf16 v[252:255], a[168:171], a[108:111], v[252:255]
  ds_read_b64_tr_b16 a[152:153], v1 offset:96
  v_mfma_f32_16x16x32_bf16 v[252:255], a[172:175], a[124:127], v[252:255]
  v_mfma_f32_16x16x32_bf16 v[248:251], a[172:175], a[120:123], v[248:251]
  buffer_load_dwordx4 v8, s[16:19], s52 offen offset:1024 lds
  v_mfma_f32_16x16x32_bf16 v[248:251], a[168:171], a[104:107], v[248:251]
  ds_read_b64_tr_b16 a[154:155], v1 offset:3680
  v_mfma_f32_16x16x32_bf16 v[244:247], a[168:171], a[100:103], v[244:247]
  ds_read_b64_tr_b16 a[156:157], v1 offset:7264
  v_mfma_f32_16x16x32_bf16 v[244:247], a[172:175], a[116:119], v[244:247]
  v_mfma_f32_16x16x32_bf16 v[240:243], a[172:175], a[112:115], v[240:243]
  ds_read_b64_tr_b16 a[158:159], v1 offset:10848
  v_mfma_f32_16x16x32_bf16 v[240:243], a[168:171], a[96:99], v[240:243]
  s_waitcnt vmcnt(29) lgkmcnt(8)
  buffer_load_dwordx4 a[88:91], v0, s[36:39], s53 offen offset:2048 sc1
  v_mfma_f32_16x16x32_bf16 v[32:35], a[128:131], a[0:3], v[32:35]
  ds_read_b64_tr_b16 a[160:161], v1 offset:128
  v_mfma_f32_16x16x32_bf16 v[32:35], a[132:135], a[16:19], v[32:35]
  s_waitcnt vmcnt(20)
  s_barrier
  v_mfma_f32_16x16x32_bf16 v[36:39], a[132:135], a[20:23], v[36:39]
  ds_read_b64_tr_b16 a[162:163], v1 offset:3712
  v_mfma_f32_16x16x32_bf16 v[36:39], a[128:131], a[4:7], v[36:39]
  v_mfma_f32_16x16x32_bf16 v[40:43], a[128:131], a[8:11], v[40:43]
  buffer_load_dwordx4 v9, s[16:19], s52 offen offset:2048 lds
  v_mfma_f32_16x16x32_bf16 v[40:43], a[132:135], a[24:27], v[40:43]
  ds_read_b64_tr_b16 a[164:165], v1 offset:7296
  v_mfma_f32_16x16x32_bf16 v[44:47], a[132:135], a[28:31], v[44:47]
  ds_read_b64_tr_b16 a[166:167], v1 offset:10880
  v_mfma_f32_16x16x32_bf16 v[44:47], a[128:131], a[12:15], v[44:47]
  v_mfma_f32_16x16x32_bf16 v[60:63], a[136:139], a[12:15], v[60:63]
  ds_read_b64_tr_b16 a[168:169], v1 offset:160
  v_mfma_f32_16x16x32_bf16 v[60:63], a[140:143], a[28:31], v[60:63]
  buffer_load_dwordx4 a[92:95], v0, s[36:39], s53 offen offset:3072 sc1
  s_bfe_u32 s53, s87, 0x4001c
  v_mfma_f32_16x16x32_bf16 v[56:59], a[140:143], a[24:27], v[56:59]
  s_lshl_b32 s53, s53, 13
  s_add_u32 s53, s53, s89
  ds_read_b64_tr_b16 a[170:171], v1 offset:3744
  v_mfma_f32_16x16x32_bf16 v[56:59], a[136:139], a[8:11], v[56:59]
  v_mfma_f32_16x16x32_bf16 v[52:55], a[136:139], a[4:7], v[52:55]
  ds_read_b64_tr_b16 a[172:173], v1 offset:7328
  v_mfma_f32_16x16x32_bf16 v[52:55], a[140:143], a[20:23], v[52:55]
  s_waitcnt vmcnt(14)
  v_accvgpr_read_b32 v26, a208
  v_accvgpr_read_b32 v27, a209
  v_mfma_f32_16x16x32_bf16 v[48:51], a[140:143], a[16:19], v[48:51]
  buffer_load_dwordx4 a[96:99], v0, s[36:39], s53 offen offset:0 sc1
  s_bfe_u32 s52, s87, 0x4001c
  v_mfma_f32_16x16x32_bf16 v[48:51], a[136:139], a[0:3], v[48:51]
  s_waitcnt lgkmcnt(7)
  s_mul_i32 s52, s52, 458752
  s_add_u32 m0, s88, 86016
  v_mfma_f32_16x16x32_bf16 v[64:67], a[144:147], a[0:3], v[64:67]
  ds_read_b64_tr_b16 a[174:175], v1 offset:10912
  v_accvgpr_read_b32 v28, a210
  v_mfma_f32_16x16x32_bf16 v[64:67], a[148:151], a[16:19], v[64:67]
  ds_read_b64_tr_b16 a[128:129], v1 offset:192
  v_accvgpr_read_b32 v29, a211
  v_mfma_f32_16x16x32_bf16 v[68:71], a[148:151], a[20:23], v[68:71]
  ds_read_b64_tr_b16 a[130:131], v1 offset:3776
  v_max_u32 v31, v26, v27
  v_mfma_f32_16x16x32_bf16 v[68:71], a[144:147], a[4:7], v[68:71]
  buffer_load_dwordx4 v3, s[16:19], s52 offen offset:0 lds
  v_max3_u32 v31, v31, v28, v29
  v_mfma_f32_16x16x32_bf16 v[72:75], a[144:147], a[8:11], v[72:75]
  ds_read_b64_tr_b16 a[132:133], v1 offset:7360
  v_accvgpr_read_b32 v22, a212
  v_mfma_f32_16x16x32_bf16 v[72:75], a[148:151], a[24:27], v[72:75]
  v_accvgpr_read_b32 v23, a213
  v_max3_u32 v31, v31, v22, v23
  v_mfma_f32_16x16x32_bf16 v[76:79], a[148:151], a[28:31], v[76:79]
  ds_read_b64_tr_b16 a[134:135], v1 offset:10944
  v_add_f32 v26, v26, v22
  v_mfma_f32_16x16x32_bf16 v[76:79], a[144:147], a[12:15], v[76:79]
  v_add_f32 v27, v27, v23
  v_accvgpr_read_b32 v22, a214
  v_mfma_f32_16x16x32_bf16 v[92:95], a[152:155], a[12:15], v[92:95]
  buffer_load_dwordx4 a[100:103], v0, s[36:39], s53 offen offset:1024 sc1
  v_accvgpr_read_b32 v23, a215
  v_mfma_f32_16x16x32_bf16 v[92:95], a[156:159], a[28:31], v[92:95]
  ds_read_b64_tr_b16 a[136:137], v1 offset:14336
  v_max3_u32 v31, v31, v22, v23
  v_mfma_f32_16x16x32_bf16 v[88:91], a[156:159], a[24:27], v[88:91]
  ds_read_b64_tr_b16 a[138:139], v1 offset:17920
  v_add_f32 v28, v28, v22
  v_mfma_f32_16x16x32_bf16 v[88:91], a[152:155], a[8:11], v[88:91]
  v_add_f32 v29, v29, v23
  v_accvgpr_read_b32 v22, a216
  v_mfma_f32_16x16x32_bf16 v[84:87], a[152:155], a[4:7], v[84:87]
  ds_read_b64_tr_b16 a[140:141], v1 offset:21504
  v_accvgpr_read_b32 v23, a217
  v_mfma_f32_16x16x32_bf16 v[84:87], a[156:159], a[20:23], v[84:87]
  buffer_load_dwordx4 v4, s[16:19], s52 offen offset:1024 lds
  v_max3_u32 v31, v31, v22, v23
  v_mfma_f32_16x16x32_bf16 v[80:83], a[156:159], a[16:19], v[80:83]
  ds_read_b64_tr_b16 a[142:143], v1 offset:25088
  v_add_f32 v26, v26, v22
  v_mfma_f32_16x16x32_bf16 v[80:83], a[152:155], a[0:3], v[80:83]
  s_waitcnt lgkmcnt(8)
  v_add_f32 v27, v27, v23
  v_accvgpr_read_b32 v22, a218
  v_mfma_f32_16x16x32_bf16 v[96:99], a[160:163], a[0:3], v[96:99]
  ds_read_b64_tr_b16 a[144:145], v1 offset:14368
  v_accvgpr_read_b32 v23, a219
  v_mfma_f32_16x16x32_bf16 v[96:99], a[164:167], a[16:19], v[96:99]
  v_max3_u32 v31, v31, v22, v23
  v_add_f32 v28, v28, v22
  v_mfma_f32_16x16x32_bf16 v[100:103], a[164:167], a[20:23], v[100:103]
  buffer_load_dwordx4 a[104:107], v0, s[36:39], s53 offen offset:2048 sc1
  v_add_f32 v29, v29, v23
  v_mfma_f32_16x16x32_bf16 v[100:103], a[160:163], a[4:7], v[100:103]
  ds_read_b64_tr_b16 a[146:147], v1 offset:17952
  v_accvgpr_read_b32 v22, a220
  v_mfma_f32_16x16x32_bf16 v[104:107], a[160:163], a[8:11], v[104:107]
  ds_read_b64_tr_b16 a[148:149], v1 offset:21536
  v_accvgpr_read_b32 v23, a221
  v_mfma_f32_16x16x32_bf16 v[104:107], a[164:167], a[24:27], v[104:107]
  v_max3_u32 v31, v31, v22, v23
  v_add_f32 v26, v26, v22
  v_mfma_f32_16x16x32_bf16 v[108:111], a[164:167], a[28:31], v[108:111]
  ds_read_b64_tr_b16 a[150:151], v1 offset:25120
  v_add_f32 v27, v27, v23
  v_mfma_f32_16x16x32_bf16 v[108:111], a[160:163], a[12:15], v[108:111]
  buffer_load_dwordx4 v5, s[16:19], s52 offen offset:2048 lds
  v_accvgpr_read_b32 v22, a222
  v_mfma_f32_16x16x32_bf16 v[124:127], a[168:171], a[12:15], v[124:127]
  ds_read_b64_tr_b16 a[152:153], v1 offset:14400
  v_accvgpr_read_b32 v23, a223
  v_mfma_f32_16x16x32_bf16 v[124:127], a[172:175], a[28:31], v[124:127]
  v_max3_u32 v31, v31, v22, v23
  v_add_f32 v28, v28, v22
  v_mfma_f32_16x16x32_bf16 v[120:123], a[172:175], a[24:27], v[120:123]
  ds_read_b64_tr_b16 a[154:155], v1 offset:17984
  v_add_f32 v29, v29, v23
  v_mfma_f32_16x16x32_bf16 v[120:123], a[168:171], a[8:11], v[120:123]
  v_cmp_eq_u32 vcc, -1, v31
  s_nop 4
  s_cbranch_vccnz CK5s
CK5x:
  v_mfma_f32_16x16x32_bf16 v[116:119], a[168:171], a[4:7], v[116:119]
  s_nop 0
  buffer_load_dwordx4 a[108:111], v0, s[36:39], s53 offen offset:3072 sc1
  v_permlane32_swap_b32 v26, v28
  v_mfma_f32_16x16x32_bf16 v[116:119], a[172:175], a[20:23], v[116:119]
  ds_read_b64_tr_b16 a[156:157], v1 offset:21568
  v_permlane32_swap_b32 v27, v29
  v_mfma_f32_16x16x32_bf16 v[112:115], a[172:175], a[16:19], v[112:115]
  ds_read_b64_tr_b16 a[158:159], v1 offset:25152
  v_add_f32 v26, v26, v28
  v_mfma_f32_16x16x32_bf16 v[112:115], a[168:171], a[0:3], v[112:115]
  s_waitcnt lgkmcnt(8)
  v_add_f32 v27, v27, v29
  v_cvt_pk_bf16_f32 v25, v26, v26
  v_mfma_f32_16x16x32_bf16 v[128:131], a[128:131], a[0:3], v[128:131]
  ds_read_b64_tr_b16 a[160:161], v1 offset:14432
  v_lshlrev_b32 v25, 16, v25
  v_mfma_f32_16x16x32_bf16 v[128:131], a[132:135], a[16:19], v[128:131]
  buffer_load_dwordx4 v6, s[16:19], s52 offen offset:3072 lds
  s_add_u32 s53, s53, 4096
  v_mfma_f32_16x16x32_bf16 v[132:135], a[132:135], a[20:23], v[132:135]
  ds_read_b64_tr_b16 a[162:163], v1 offset:18016
  v_sub_f32 v30, v26, v25
  v_mfma_f32_16x16x32_bf16 v[132:135], a[128:131], a[4:7], v[132:135]
  v_cvt_pk_bf16_f32 v22, v26, v30
  v_and_b32 v25, 0xffff0000, v22
  v_mfma_f32_16x16x32_bf16 v[136:139], a[128:131], a[8:11], v[136:139]
  ds_read_b64_tr_b16 a[164:165], v1 offset:21600
  v_sub_f32 v30, v30, v25
  v_mfma_f32_16x16x32_bf16 v[136:139], a[132:135], a[24:27], v[136:139]
  v_cvt_pk_bf16_f32 v23, v30, 0
  v_mfma_f32_16x16x32_bf16 v[140:143], a[132:135], a[28:31], v[140:143]
  buffer_load_dwordx4 a[112:115], v0, s[36:39], s53 offen offset:0 sc1
  s_add_u32 m0, s88, 90112
  v_mfma_f32_16x16x32_bf16 v[140:143], a[128:131], a[12:15], v[140:143]
  ds_read_b64_tr_b16 a[166:167], v1 offset:25184
  v_mfma_f32_16x16x32_bf16 v[156:159], a[136:139], a[12:15], v[156:159]
  ds_read_b64_tr_b16 a[168:169], v1 offset:14464
  v_mfma_f32_16x16x32_bf16 v[156:159], a[140:143], a[28:31], v[156:159]
  ds_write_b64 v24, v[22:23] offset:0
  v_cvt_pk_bf16_f32 v25, v27, v27
  v_mfma_f32_16x16x32_bf16 v[152:155], a[140:143], a[24:27], v[152:155]
  ds_read_b64_tr_b16 a[170:171], v1 offset:18048
  v_lshlrev_b32 v25, 16, v25
  v_mfma_f32_16x16x32_bf16 v[152:155], a[136:139], a[8:11], v[152:155]
  buffer_load_dwordx4 v7, s[16:19], s52 offen offset:0 lds
  v_sub_f32 v30, v27, v25
  v_mfma_f32_16x16x32_bf16 v[148:151], a[136:139], a[4:7], v[148:151]
  ds_read_b64_tr_b16 a[172:173], v1 offset:21632
  v_cvt_pk_bf16_f32 v28, v27, v30
  v_mfma_f32_16x16x32_bf16 v[148:151], a[140:143], a[20:23], v[148:151]
  v_and_b32 v25, 0xffff0000, v28
  v_sub_f32 v30, v30, v25
  v_mfma_f32_16x16x32_bf16 v[144:147], a[140:143], a[16:19], v[144:147]
  ds_read_b64_tr_b16 a[174:175], v1 offset:25216
  v_cvt_pk_bf16_f32 v29, v30, 0
  v_mfma_f32_16x16x32_bf16 v[144:147], a[136:139], a[0:3], v[144:147]
  s_waitcnt lgkmcnt(9)
  ds_write_b64 v24, v[28:29] offset:16
  s_waitcnt lgkmcnt(0)
  v_mfma_f32_16x16x32_bf16 v[160:163], a[144:147], a[0:3], v[160:163]
  buffer_load_dwordx4 a[116:119], v0, s[36:39], s53 offen offset:1024 sc1
  v_mfma_f32_16x16x32_bf16 v[160:163], a[148:151], a[16:19], v[160:163]
  s_lshl_b32 s58, s44, 8
  ds_read_b64_tr_b16 a[128:129], v1 offset:14496
  s_add_u32 s58, s58, s2
  v_mfma_f32_16x16x32_bf16 v[164:167], a[148:151], a[20:23], v[164:167]
  s_mul_i32 s58, s58, 7168
  ds_read_b64_tr_b16 a[130:131], v1 offset:18080
  v_mfma_f32_16x16x32_bf16 v[164:167], a[144:147], a[4:7], v[164:167]
  v_mfma_f32_16x16x32_bf16 v[168:171], a[144:147], a[8:11], v[168:171]
  ds_read_b64_tr_b16 a[132:133], v1 offset:21664
  v_mfma_f32_16x16x32_bf16 v[168:171], a[148:151], a[24:27], v[168:171]
  buffer_load_dwordx4 v8, s[16:19], s52 offen offset:1024 lds
  v_mfma_f32_16x16x32_bf16 v[172:175], a[148:151], a[28:31], v[172:175]
  ds_read_b64_tr_b16 a[134:135], v1 offset:25248
  v_mfma_f32_16x16x32_bf16 v[172:175], a[144:147], a[12:15], v[172:175]
  v_mfma_f32_16x16x32_bf16 v[188:191], a[152:155], a[12:15], v[188:191]
  ds_read_b64_tr_b16 a[136:137], v1 offset:14528
  v_mfma_f32_16x16x32_bf16 v[188:191], a[156:159], a[28:31], v[188:191]
  v_mfma_f32_16x16x32_bf16 v[184:187], a[156:159], a[24:27], v[184:187]
  buffer_load_dwordx4 a[120:123], v0, s[36:39], s53 offen offset:2048 sc1
  v_mfma_f32_16x16x32_bf16 v[184:187], a[152:155], a[8:11], v[184:187]
  ds_read_b64_tr_b16 a[138:139], v1 offset:18112
  v_mfma_f32_16x16x32_bf16 v[180:183], a[152:155], a[4:7], v[180:183]
  ds_read_b64_tr_b16 a[140:141], v1 offset:21696
  v_mfma_f32_16x16x32_bf16 v[180:183], a[156:159], a[20:23], v[180:183]
  v_mfma_f32_16x16x32_bf16 v[176:179], a[156:159], a[16:19], v[176:179]
  ds_read_b64_tr_b16 a[142:143], v1 offset:25280
  v_mfma_f32_16x16x32_bf16 v[176:179], a[152:155], a[0:3], v[176:179]
  s_waitcnt lgkmcnt(9)
  buffer_load_dwordx4 v9, s[16:19], s52 offen offset:2048 lds
  v_mfma_f32_16x16x32_bf16 v[192:195], a[160:163], a[0:3], v[192:195]
  ds_read_b64_tr_b16 a[144:145], v1 offset:28864
  v_mfma_f32_16x16x32_bf16 v[192:195], a[164:167], a[16:19], v[192:195]
  v_mfma_f32_16x16x32_bf16 v[196:199], a[164:167], a[20:23], v[196:199]
  ds_read_b64_tr_b16 a[146:147], v1 offset:32448
  v_mfma_f32_16x16x32_bf16 v[196:199], a[160:163], a[4:7], v[196:199]
  v_mfma_f32_16x16x32_bf16 v[200:203], a[160:163], a[8:11], v[200:203]
  buffer_load_dwordx4 a[124:127], v0, s[36:39], s53 offen offset:3072 sc1
  v_mfma_f32_16x16x32_bf16 v[200:203], a[164:167], a[24:27], v[200:203]
  ds_read_b64_tr_b16 a[148:149], v1 offset:36032
  v_mfma_f32_16x16x32_bf16 v[204:207], a[164:167], a[28:31], v[204:207]
  ds_read_b64_tr_b16 a[150:151], v1 offset:39616
  v_mfma_f32_16x16x32_bf16 v[204:207], a[160:163], a[12:15], v[204:207]
  s_waitcnt vmcnt(16)
  s_barrier
  v_mfma_f32_16x16x32_bf16 v[220:223], a[168:171], a[12:15], v[220:223]
  ds_read_b64_tr_b16 a[152:153], v1 offset:43200
  v_mfma_f32_16x16x32_bf16 v[220:223], a[172:175], a[28:31], v[220:223]
  v_mfma_f32_16x16x32_bf16 v[216:219], a[172:175], a[24:27], v[216:219]
  ds_read_b64_tr_b16 a[154:155], v1 offset:46784
  v_mfma_f32_16x16x32_bf16 v[216:219], a[168:171], a[8:11], v[216:219]
  v_mfma_f32_16x16x32_bf16 v[212:215], a[168:171], a[4:7], v[212:215]
  ds_read_b64_tr_b16 a[156:157], v1 offset:50368
  v_mfma_f32_16x16x32_bf16 v[212:215], a[172:175], a[20:23], v[212:215]
  v_mfma_f32_16x16x32_bf16 v[208:211], a[172:175], a[16:19], v[208:211]
  ds_read_b64_tr_b16 a[158:159], v1 offset:53952
  v_mfma_f32_16x16x32_bf16 v[208:211], a[168:171], a[0:3], v[208:211]
  s_waitcnt lgkmcnt(8)
  v_mfma_f32_16x16x32_bf16 v[224:227], a[128:131], a[0:3], v[224:227]
  ds_read_b64_tr_b16 a[160:161], v2 offset:192
  v_mfma_f32_16x16x32_bf16 v[224:227], a[132:135], a[16:19], v[224:227]
  v_mfma_f32_16x16x32_bf16 v[228:231], a[132:135], a[20:23], v[228:231]
  ds_read_b64_tr_b16 a[162:163], v2 offset:3776
  v_mfma_f32_16x16x32_bf16 v[228:231], a[128:131], a[4:7], v[228:231]
  v_mfma_f32_16x16x32_bf16 v[232:235], a[128:131], a[8:11], v[232:235]
  ds_read_b64_tr_b16 a[164:165], v2 offset:7360
  v_mfma_f32_16x16x32_bf16 v[232:235], a[132:135], a[24:27], v[232:235]
  v_mfma_f32_16x16x32_bf16 v[236:239], a[132:135], a[28:31], v[236:239]
  ds_read_b64_tr_b16 a[166:167], v2 offset:10944
  v_mfma_f32_16x16x32_bf16 v[236:239], a[128:131], a[12:15], v[236:239]
  v_mfma_f32_16x16x32_bf16 v[252:255], a[136:139], a[12:15], v[252:255]
  ds_read_b64_tr_b16 a[168:169], v2 offset:14528
  v_mfma_f32_16x16x32_bf16 v[252:255], a[140:143], a[28:31], v[252:255]
  v_mfma_f32_16x16x32_bf16 v[248:251], a[140:143], a[24:27], v[248:251]
  ds_read_b64_tr_b16 a[170:171], v2 offset:18112
  v_mfma_f32_16x16x32_bf16 v[248:251], a[136:139], a[8:11], v[248:251]
  v_mfma_f32_16x16x32_bf16 v[244:247], a[136:139], a[4:7], v[244:247]
  ds_read_b64_tr_b16 a[172:173], v2 offset:21696
  v_mfma_f32_16x16x32_bf16 v[244:247], a[140:143], a[20:23], v[244:247]
  v_mfma_f32_16x16x32_bf16 v[240:243], a[140:143], a[16:19], v[240:243]
  ds_read_b64_tr_b16 a[174:175], v2 offset:25280
  v_mfma_f32_16x16x32_bf16 v[240:243], a[136:139], a[0:3], v[240:243]
  s_waitcnt vmcnt(1) lgkmcnt(8)
  s_barrier
  v_mfma_f32_16x16x32_bf16 v[128:131], a[144:147], a[32:35], v[128:131]
  v_and_b32 v31, 0xf0, v0
  v_add_u32 v31, 159744, v31
  v_mfma_f32_16x16x32_bf16 v[128:131], a[148:151], a[48:51], v[128:131]
  s_barrier
  v_cmp_gt_u32 vcc, 0x100, v0
  s_mov_b32 s67, 0x01000100
  v_mfma_f32_16x16x32_bf16 v[132:135], a[148:151], a[52:55], v[132:135]
  s_mov_b32 s68, 0x03020302
  v_cndmask_b32 v12, 0, v12, vcc
  v_perm_b32 v22, v12, v12, s67
  v_mfma_f32_16x16x32_bf16 v[132:135], a[144:147], a[36:39], v[132:135]
  v_min_u32 v3, 880, v0
  v_lshlrev_b32 v3, 3, v3
  v_mfma_f32_16x16x32_bf16 v[136:139], a[144:147], a[40:43], v[136:139]
  buffer_load_dword a252, v3, s[24:27], s58 offen
  v_and_b32 v23, 0xffff, v12
  v_mfma_f32_16x16x32_bf16 v[136:139], a[148:151], a[56:59], v[136:139]
  v_perm_b32 v24, v12, v12, s68
  v_lshrrev_b32 v25, 16, v12
  v_mfma_f32_16x16x32_bf16 v[140:143], a[148:151], a[60:63], v[140:143]
  v_accvgpr_write_b32 a0, v22
  v_accvgpr_write_b32 a1, v23
  v_mfma_f32_16x16x32_bf16 v[140:143], a[144:147], a[44:47], v[140:143]
  v_accvgpr_write_b32 a2, v24
  v_accvgpr_write_b32 a3, v25
  v_mfma_f32_16x16x32_bf16 v[252:255], a[152:155], a[44:47], v[252:255]
  ds_read_b64_tr_b16 a[128:129], v2 offset:28864
  v_cndmask_b32 v15, 0, v15, vcc
  v_mfma_f32_16x16x32_bf16 v[252:255], a[156:159], a[60:63], v[252:255]
  v_perm_b32 v26, v15, v15, s67
  v_and_b32 v27, 0xffff, v15
  v_mfma_f32_16x16x32_bf16 v[248:251], a[156:159], a[56:59], v[248:251]
  ds_read_b64_tr_b16 a[130:131], v2 offset:32448
  v_perm_b32 v28, v15, v15, s68
  v_mfma_f32_16x16x32_bf16 v[248:251], a[152:155], a[40:43], v[248:251]
  v_lshrrev_b32 v29, 16, v15
  v_accvgpr_write_b32 a4, v26
  v_mfma_f32_16x16x32_bf16 v[244:247], a[152:155], a[36:39], v[244:247]
  ds_read_b64_tr_b16 a[132:133], v2 offset:36032
  v_accvgpr_write_b32 a5, v27
  v_mfma_f32_16x16x32_bf16 v[244:247], a[156:159], a[52:55], v[244:247]
  ds_read_b128 a[16:19], v31 offset:1536
  v_accvgpr_write_b32 a6, v28
  v_mfma_f32_16x16x32_bf16 v[240:243], a[156:159], a[48:51], v[240:243]
  ds_read_b128 a[20:23], v31 offset:3584
  v_accvgpr_write_b32 a7, v29
  v_mfma_f32_16x16x32_bf16 v[240:243], a[152:155], a[32:35], v[240:243]
  s_waitcnt vmcnt(16) lgkmcnt(5)
  ds_read_b64_tr_b16 a[134:135], v2 offset:39616
  v_cndmask_b32 v18, 0, v18, vcc
  v_mfma_f32_16x16x32_bf16 v[128:131], a[160:163], a[64:67], v[128:131]
  ds_read_b64_tr_b16 a[136:137], v2 offset:43200
  v_perm_b32 v22, v18, v18, s67
  v_mfma_f32_16x16x32_bf16 v[128:131], a[164:167], a[80:83], v[128:131]
  v_and_b32 v23, 0xffff, v18
  v_perm_b32 v24, v18, v18, s68
  v_mfma_f32_16x16x32_bf16 v[132:135], a[164:167], a[84:87], v[132:135]
  ds_read_b64_tr_b16 a[138:139], v2 offset:46784
  v_lshrrev_b32 v25, 16, v18
  v_mfma_f32_16x16x32_bf16 v[132:135], a[160:163], a[68:71], v[132:135]
  v_accvgpr_write_b32 a8, v22
  v_accvgpr_write_b32 a9, v23
  v_mfma_f32_16x16x32_bf16 v[136:139], a[160:163], a[72:75], v[136:139]
  ds_read_b64_tr_b16 a[140:141], v2 offset:50368
  v_accvgpr_write_b32 a10, v24
  v_mfma_f32_16x16x32_bf16 v[136:139], a[164:167], a[88:91], v[136:139]
  v_accvgpr_write_b32 a11, v25
  v_cndmask_b32 v21, 0, v21, vcc
  v_mfma_f32_16x16x32_bf16 v[140:143], a[164:167], a[92:95], v[140:143]
  ds_read_b64_tr_b16 a[142:143], v2 offset:53952
  v_perm_b32 v26, v21, v21, s67
  v_mfma_f32_16x16x32_bf16 v[140:143], a[160:163], a[76:79], v[140:143]
  v_and_b32 v27, 0xffff, v21
  v_perm_b32 v28, v21, v21, s68
  v_mfma_f32_16x16x32_bf16 v[252:255], a[168:171], a[76:79], v[252:255]
  ds_read_b64_tr_b16 a[144:145], v1 offset:28672
  v_lshrrev_b32 v29, 16, v21
  v_mfma_f32_16x16x32_bf16 v[252:255], a[172:175], a[92:95], v[252:255]
  v_accvgpr_write_b32 a12, v26
  v_accvgpr_write_b32 a13, v27
  v_mfma_f32_16x16x32_bf16 v[248:251], a[172:175], a[88:91], v[248:251]
  ds_read_b64_tr_b16 a[146:147], v1 offset:32256
  v_accvgpr_write_b32 a14, v28
  v_mfma_f32_16x16x32_bf16 v[248:251], a[168:171], a[72:75], v[248:251]
  v_accvgpr_write_b32 a15, v29
  v_mfma_f32_16x16x32_bf16 v[244:247], a[168:171], a[68:71], v[244:247]
  ds_read_b64_tr_b16 a[148:149], v1 offset:35840
  v_mfma_f32_16x16x32_bf16 v[244:247], a[172:175], a[84:87], v[244:247]
  v_mfma_f32_16x16x32_bf16 v[240:243], a[172:175], a[80:83], v[240:243]
  ds_read_b64_tr_b16 a[150:151], v1 offset:39424
  v_mfma_f32_16x16x32_bf16 v[240:243], a[168:171], a[64:67], v[240:243]
  s_waitcnt lgkmcnt(9)
  v_mfma_f32_16x16x32_bf16 v[128:131], a[16:19], a[0:3], v[128:131]
  v_mfma_f32_16x16x32_bf16 v[132:135], a[16:19], a[4:7], v[132:135]
  v_mfma_f32_16x16x32_bf16 v[136:139], a[16:19], a[8:11], v[136:139]
  v_mfma_f32_16x16x32_bf16 v[140:143], a[16:19], a[12:15], v[140:143]
  v_mfma_f32_16x16x32_bf16 v[240:243], a[20:23], a[0:3], v[240:243]
  v_mfma_f32_16x16x32_bf16 v[244:247], a[20:23], a[4:7], v[244:247]
  v_mfma_f32_16x16x32_bf16 v[248:251], a[20:23], a[8:11], v[248:251]
  v_mfma_f32_16x16x32_bf16 v[252:255], a[20:23], a[12:15], v[252:255]
  s_waitcnt vmcnt(1) lgkmcnt(4)
  v_mfma_f32_16x16x32_bf16 v[128:131], a[128:131], a[96:99], v[128:131]
  ds_read_b128 a[24:27], v31 offset:0
  v_mfma_f32_16x16x32_bf16 v[128:131], a[132:135], a[112:115], v[128:131]
  ds_read_b64_tr_b16 a[152:153], v1 offset:43008
  v_mfma_f32_16x16x32_bf16 v[132:135], a[132:135], a[116:119], v[132:135]
  ds_read_b128 a[28:31], v31 offset:2048
  v_mfma_f32_16x16x32_bf16 v[132:135], a[128:131], a[100:103], v[132:135]
  ds_read_b64_tr_b16 a[154:155], v1 offset:46592
  v_mfma_f32_16x16x32_bf16 v[136:139], a[128:131], a[104:107], v[136:139]
  ds_read_b64_tr_b16 a[156:157], v1 offset:50176
  v_mfma_f32_16x16x32_bf16 v[136:139], a[132:135], a[120:123], v[136:139]
  v_mfma_f32_16x16x32_bf16 v[140:143], a[132:135], a[124:127], v[140:143]
  ds_read_b64_tr_b16 a[158:159], v1 offset:53760
  v_mfma_f32_16x16x32_bf16 v[140:143], a[128:131], a[108:111], v[140:143]
  v_mfma_f32_16x16x32_bf16 v[252:255], a[136:139], a[108:111], v[252:255]
  ds_read_b64_tr_b16 a[160:161], v2 offset:0
  v_mul_f32 v22, v10, v128
  v_mul_f32 v23, v10, v129
  v_mul_f32 v24, v10, v130
  v_mfma_f32_16x16x32_bf16 v[252:255], a[140:143], a[124:127], v[252:255]
  v_mul_f32 v25, v10, v131
  v_exp_f32 v22, v22
  v_mul_f32 v26, v13, v132
  v_mfma_f32_16x16x32_bf16 v[248:251], a[140:143], a[120:123], v[248:251]
  ds_read_b64_tr_b16 a[162:163], v2 offset:3584
  v_exp_f32 v23, v23
  v_mul_f32 v27, v13, v133
  v_mfma_f32_16x16x32_bf16 v[248:251], a[136:139], a[104:107], v[248:251]
  v_exp_f32 v24, v24
  v_mul_f32 v28, v13, v134
  v_mfma_f32_16x16x32_bf16 v[244:247], a[136:139], a[100:103], v[244:247]
  ds_read_b64_tr_b16 a[164:165], v2 offset:7168
  v_exp_f32 v25, v25
  v_mul_f32 v29, v13, v135
  v_mfma_f32_16x16x32_bf16 v[244:247], a[140:143], a[116:119], v[244:247]
  v_exp_f32 v26, v26
  v_fma_f32 v22, v22, v11, v11
  v_mfma_f32_16x16x32_bf16 v[240:243], a[140:143], a[112:115], v[240:243]
  ds_read_b64_tr_b16 a[166:167], v2 offset:10752
  v_exp_f32 v27, v27
  v_fma_f32 v23, v23, v11, v11
  v_mfma_f32_16x16x32_bf16 v[240:243], a[136:139], a[96:99], v[240:243]
  s_waitcnt lgkmcnt(4)
  v_exp_f32 v28, v28
  v_fma_f32 v24, v24, v11, v11
  v_mfma_f32_16x16x32_bf16 v[32:35], a[144:147], a[32:35], v[32:35]
  ds_read_b64_tr_b16 a[168:169], v2 offset:14336
  v_exp_f32 v29, v29
  v_fma_f32 v25, v25, v11, v11
  v_mfma_f32_16x16x32_bf16 v[32:35], a[148:151], a[48:51], v[32:35]
  v_rcp_f32 v22, v22
  v_fma_f32 v26, v26, v14, v14
  v_mfma_f32_16x16x32_bf16 v[36:39], a[148:151], a[52:55], v[36:39]
  ds_read_b64_tr_b16 a[170:171], v2 offset:17920
  v_rcp_f32 v23, v23
  v_fma_f32 v27, v27, v14, v14
  v_mfma_f32_16x16x32_bf16 v[36:39], a[144:147], a[36:39], v[36:39]
  v_rcp_f32 v24, v24
  v_fma_f32 v28, v28, v14, v14
  v_mfma_f32_16x16x32_bf16 v[40:43], a[144:147], a[40:43], v[40:43]
  ds_read_b64_tr_b16 a[172:173], v2 offset:21504
  v_rcp_f32 v25, v25
  v_fma_f32 v29, v29, v14, v14
  v_mfma_f32_16x16x32_bf16 v[40:43], a[148:151], a[56:59], v[40:43]
  v_rcp_f32 v26, v26
  v_mul_f32 v240, v128, v240
  v_mfma_f32_16x16x32_bf16 v[44:47], a[148:151], a[60:63], v[44:47]
  ds_read_b64_tr_b16 a[174:175], v2 offset:25088
  v_rcp_f32 v27, v27
  v_mul_f32 v241, v129, v241
  v_mfma_f32_16x16x32_bf16 v[44:47], a[144:147], a[44:47], v[44:47]
  s_waitcnt lgkmcnt(11)
  v_rcp_f32 v28, v28
  v_mul_f32 v242, v130, v242
  v_mfma_f32_16x16x32_bf16 v[32:35], a[24:27], a[0:3], v[32:35]
  ds_read_b64_tr_b16 a[128:129], v2 offset:28672
  v_rcp_f32 v29, v29
  v_mul_f32 v243, v131, v243
  v_mfma_f32_16x16x32_bf16 v[36:39], a[24:27], a[4:7], v[36:39]
  v_mul_f32 v240, v240, v22
  v_mul_f32 v241, v241, v23
  v_mul_f32 v242, v242, v24
  v_mul_f32 v243, v243, v25
  v_mfma_f32_16x16x32_bf16 v[40:43], a[24:27], a[8:11], v[40:43]
  ds_read_b64_tr_b16 a[130:131], v2 offset:32256
  v_mul_f32 v22, v16, v136
  v_mul_f32 v23, v16, v137
  v_mul_f32 v24, v16, v138
  v_mfma_f32_16x16x32_bf16 v[44:47], a[24:27], a[12:15], v[44:47]
  v_mul_f32 v25, v16, v139
  v_exp_f32 v22, v22
  v_mul_f32 v244, v132, v244
  v_mfma_f32_16x16x32_bf16 v[144:147], a[28:31], a[0:3], v[144:147]
  ds_read_b64_tr_b16 a[132:133], v2 offset:35840
  v_exp_f32 v23, v23
  v_mul_f32 v245, v133, v245
  v_mfma_f32_16x16x32_bf16 v[148:151], a[28:31], a[4:7], v[148:151]
  v_exp_f32 v24, v24
  v_mul_f32 v246, v134, v246
  v_mfma_f32_16x16x32_bf16 v[152:155], a[28:31], a[8:11], v[152:155]
  ds_read_b64_tr_b16 a[134:135], v2 offset:39424
  v_exp_f32 v25, v25
  v_mul_f32 v247, v135, v247
  v_mfma_f32_16x16x32_bf16 v[156:159], a[28:31], a[12:15], v[156:159]
Hb0_2:
  s_cbranch_execz Hb0_3
  v_mul_f32 v244, v244, v26
  v_mul_f32 v245, v245, v27
  v_mul_f32 v246, v246, v28
  v_mul_f32 v247, v247, v29
  v_mfma_f32_16x16x32_bf16 v[156:159], a[152:155], a[44:47], v[156:159]
  ds_read_b64_tr_b16 a[136:137], v2 offset:43008
  v_cvt_pk_bf16_f32 v128, v240, v241
  v_cvt_pk_bf16_f32 v129, v242, v243
  v_mfma_f32_16x16x32_bf16 v[156:159], a[156:159], a[60:63], v[156:159]
  buffer_store_dwordx2 v[128:129], v0, s[36:39], s64 offen offset:0 sc1
  v_mul_f32 v26, v19, v140
  v_mul_f32 v27, v19, v141
  v_mul_f32 v28, v19, v142
  v_mfma_f32_16x16x32_bf16 v[152:155], a[156:159], a[56:59], v[152:155]
  ds_read_b64_tr_b16 a[138:139], v2 offset:46592
  v_mul_f32 v29, v19, v143
  v_exp_f32 v26, v26
  v_mfma_f32_16x16x32_bf16 v[152:155], a[152:155], a[40:43], v[152:155]
  v_fma_f32 v22, v22, v17, v17
  v_exp_f32 v27, v27
  v_fma_f32 v23, v23, v17, v17
  v_mfma_f32_16x16x32_bf16 v[148:151], a[152:155], a[36:39], v[148:151]
  ds_read_b64_tr_b16 a[140:141], v2 offset:50176
  v_exp_f32 v28, v28
  v_fma_f32 v24, v24, v17, v17
  v_mfma_f32_16x16x32_bf16 v[148:151], a[156:159], a[52:55], v[148:151]
  v_exp_f32 v29, v29
  v_fma_f32 v25, v25, v17, v17
  v_cvt_pk_bf16_f32 v132, v244, v245
  v_mfma_f32_16x16x32_bf16 v[144:147], a[156:159], a[48:51], v[144:147]
  ds_read_b64_tr_b16 a[142:143], v2 offset:53760
  v_cvt_pk_bf16_f32 v133, v246, v247
  v_mfma_f32_16x16x32_bf16 v[144:147], a[152:155], a[32:35], v[144:147]
  s_waitcnt lgkmcnt(8)
  buffer_store_dwordx2 v[132:133], v0, s[36:39], s64 offen offset:1024 sc1
  v_rcp_f32 v22, v22
  v_fma_f32 v26, v26, v20, v20
  v_mfma_f32_16x16x32_bf16 v[32:35], a[160:163], a[64:67], v[32:35]
  ds_read_b64_tr_b16 a[144:145], v1 offset:28704
  v_rcp_f32 v23, v23
  v_fma_f32 v27, v27, v20, v20
  v_mfma_f32_16x16x32_bf16 v[32:35], a[164:167], a[80:83], v[32:35]
  v_rcp_f32 v24, v24
  v_fma_f32 v28, v28, v20, v20
  v_mfma_f32_16x16x32_bf16 v[36:39], a[164:167], a[84:87], v[36:39]
  ds_read_b64_tr_b16 a[146:147], v1 offset:32288
  v_rcp_f32 v25, v25
  v_fma_f32 v29, v29, v20, v20
  v_mfma_f32_16x16x32_bf16 v[36:39], a[160:163], a[68:71], v[36:39]
  v_rcp_f32 v26, v26
  v_mul_f32 v248, v136, v248
  v_mfma_f32_16x16x32_bf16 v[40:43], a[160:163], a[72:75], v[40:43]
  ds_read_b64_tr_b16 a[148:149], v1 offset:35872
  v_rcp_f32 v27, v27
  v_mul_f32 v249, v137, v249
  v_mfma_f32_16x16x32_bf16 v[40:43], a[164:167], a[88:91], v[40:43]
  v_rcp_f32 v28, v28
  v_mul_f32 v250, v138, v250
  v_mfma_f32_16x16x32_bf16 v[44:47], a[164:167], a[92:95], v[44:47]
  ds_read_b64_tr_b16 a[150:151], v1 offset:39456
  v_rcp_f32 v29, v29
  v_mul_f32 v251, v139, v251
  v_mfma_f32_16x16x32_bf16 v[44:47], a[160:163], a[76:79], v[44:47]
  v_mul_f32 v248, v248, v22
  v_mul_f32 v249, v249, v23
  v_mul_f32 v250, v250, v24
  v_mul_f32 v251, v251, v25
  v_mfma_f32_16x16x32_bf16 v[156:159], a[168:171], a[76:79], v[156:159]
  v_mul_f32 v252, v140, v252
  v_mul_f32 v253, v141, v253
  v_mul_f32 v254, v142, v254
  v_mul_f32 v255, v143, v255
  v_mfma_f32_16x16x32_bf16 v[156:159], a[172:175], a[92:95], v[156:159]
  v_cvt_pk_bf16_f32 v136, v248, v249
  v_cvt_pk_bf16_f32 v137, v250, v251
  v_mfma_f32_16x16x32_bf16 v[152:155], a[172:175], a[88:91], v[152:155]
  buffer_store_dwordx2 v[136:137], v0, s[36:39], s65 offen offset:0 sc1
  v_mul_f32 v252, v252, v26
  v_mul_f32 v253, v253, v27
  v_mul_f32 v254, v254, v28
  v_mfma_f32_16x16x32_bf16 v[152:155], a[168:171], a[72:75], v[152:155]
  v_mul_f32 v255, v255, v29
  v_cvt_pk_bf16_f32 v140, v252, v253
  v_cvt_pk_bf16_f32 v141, v254, v255
  v_mfma_f32_16x16x32_bf16 v[148:151], a[168:171], a[68:71], v[148:151]
  buffer_store_dwordx2 v[140:141], v0, s[36:39], s65 offen offset:1024 sc1
  s_mov_b32 s64, s66
  s_add_u32 s65, s66, 262144
  v_mfma_f32_16x16x32_bf16 v[148:151], a[172:175], a[84:87], v[148:151]
  v_lshrrev_b32 v128, 4, v0
  s_add_u32 s83, s54, s71
  s_and_b32 s83, s83, 3
  s_and_b32 s90, s2, 1
  v_mfma_f32_16x16x32_bf16 v[144:147], a[172:175], a[80:83], v[144:147]
  s_lshl_b32 s85, s55, 7
  s_lshl3_add_u32 s85, s73, s85
  s_mul_i32 s84, s90, 3670016
  s_add_u32 s85, s85, s84
  s_lshr_b32 s84, s44, 1
  v_mfma_f32_16x16x32_bf16 v[144:147], a[168:171], a[64:67], v[144:147]
  s_waitcnt lgkmcnt(4)
  s_mul_i32 s84, s84, 393216
  v_bfe_u32 v129, v128, 4, 2
  v_bfe_u32 v130, v128, 1, 2
  v_xor_b32 v129, v129, v130
  v_mfma_f32_16x16x32_bf16 v[32:35], a[128:131], a[96:99], v[32:35]
  ds_read_b128 a[16:19], v31 offset:256
  v_lshlrev_b32 v129, 5, v129
  v_and_b32 v130, 1, v128
  v_lshl_add_u32 v129, v130, 4, v129
  v_mfma_f32_16x16x32_bf16 v[32:35], a[132:135], a[112:115], v[32:35]
  ds_read_b64_tr_b16 a[152:153], v1 offset:43040
  v_lshrrev_b32 v130, 3, v128
  v_lshlrev_b32 v130, 11, v130
  s_sub_u32 s24, s24, 2048
  v_mfma_f32_16x16x32_bf16 v[36:39], a[132:135], a[116:119], v[36:39]
  s_subb_u32 s25, s25, 0
  s_mov_b32 s26, 7342080
  ds_read_b128 a[20:23], v31 offset:2304
  v_add3_u32 v129, v129, v130, s85
  v_add_u32 v133, 2048, v129
  v_mfma_f32_16x16x32_bf16 v[36:39], a[128:131], a[100:103], v[36:39]
  ds_read_b64_tr_b16 a[154:155], v1 offset:46624
  v_add_u32 v134, 17408, v129
  v_xor_b32 v135, 128, v129
  v_add_u32 v136, 15360, v135
  v_mfma_f32_16x16x32_bf16 v[40:43], a[128:131], a[104:107], v[40:43]
  ds_read_b64_tr_b16 a[156:157], v1 offset:50208
  v_and_b32 v129, 7, v128
  v_lshrrev_b32 v131, 4, v128
  v_xor_b32 v129, v129, v131
  v_mfma_f32_16x16x32_bf16 v[40:43], a[132:135], a[120:123], v[40:43]
  v_lshl_add_u32 v252, v129, 4, v130
  v_xor_b32 v253, 64, v252
  v_add_u32 v253, 16384, v253
  s_lshl2_add_u32 s85, s54, s44
  v_mfma_f32_16x16x32_bf16 v[44:47], a[132:135], a[124:127], v[44:47]
  s_lshl_b32 s85, s85, 18
  s_mul_i32 s91, s90, 114688
  s_add_u32 s85, s85, s91
  s_add_u32 s85, s85, 19922944
  ds_read_b64_tr_b16 a[158:159], v1 offset:53792
  v_mfma_f32_16x16x32_bf16 v[44:47], a[128:131], a[108:111], v[44:47]
  v_add_u32 v137, s85, v0
  v_bfe_u32 v129, v128, 3, 2
  v_lshlrev_b32 v129, 5, v129
  v_and_b32 v130, 3, v128
  v_mfma_f32_16x16x32_bf16 v[156:159], a[136:139], a[108:111], v[156:159]
  ds_read_b64_tr_b16 a[160:161], v2 offset:32
  v_lshl_add_u32 v129, v130, 3, v129
  v_lshrrev_b32 v130, 2, v128
  v_lshl_add_u32 v240, v130, 7, v129
  v_mfma_f32_16x16x32_bf16 v[156:159], a[140:143], a[124:127], v[156:159]
  v_xor_b32 v241, 32, v240
  v_xor_b32 v242, 64, v240
  v_xor_b32 v243, 96, v240
  v_xor_b32 v244, 65536, v240
  v_mfma_f32_16x16x32_bf16 v[152:155], a[140:143], a[120:123], v[152:155]
  ds_read_b64_tr_b16 a[162:163], v2 offset:3616
  v_xor_b32 v245, 65568, v240
  v_xor_b32 v246, 65600, v240
  v_xor_b32 v247, 65632, v240
  v_mfma_f32_16x16x32_bf16 v[152:155], a[136:139], a[104:107], v[152:155]
  v_xor_b32 v248, 131072, v240
  v_xor_b32 v249, 131104, v240
  v_xor_b32 v250, 131136, v240
  v_xor_b32 v251, 131168, v240
  v_mfma_f32_16x16x32_bf16 v[148:151], a[136:139], a[100:103], v[148:151]
  s_lshr_b32 s85, s54, 1
  s_lshl_b32 s85, s85, 5
  s_lshl2_add_u32 s85, s90, s85
  ds_read_b64_tr_b16 a[164:165], v2 offset:7200
  v_and_b32 v129, 3, v128
  v_mfma_f32_16x16x32_bf16 v[148:151], a[140:143], a[116:119], v[148:151]
  v_bfe_u32 v130, v128, 2, 2
  v_lshl_add_u32 v129, v129, 3, v130
  v_add_lshl_u32 v138, v129, s85, 7
  v_mov_b32 v254, 1
  v_mfma_f32_16x16x32_bf16 v[144:147], a[140:143], a[112:115], v[144:147]
  s_mov_b32 s91, 5406720
  ds_read_b64_tr_b16 a[166:167], v2 offset:10784
  v_mul_f32 v22, v10, v32
  v_mul_f32 v23, v10, v33
  v_mul_f32 v24, v10, v34
  v_mfma_f32_16x16x32_bf16 v[144:147], a[136:139], a[96:99], v[144:147]
  s_waitcnt lgkmcnt(4)
  v_mul_f32 v25, v10, v35
  v_exp_f32 v22, v22
  v_mul_f32 v26, v13, v36
  v_mfma_f32_16x16x32_bf16 v[48:51], a[144:147], a[32:35], v[48:51]
  ds_read_b64_tr_b16 a[168:169], v2 offset:14368
  v_exp_f32 v23, v23
  v_mul_f32 v27, v13, v37
  v_mfma_f32_16x16x32_bf16 v[48:51], a[148:151], a[48:51], v[48:51]
  v_exp_f32 v24, v24
  v_mul_f32 v28, v13, v38
  v_mfma_f32_16x16x32_bf16 v[52:55], a[148:151], a[52:55], v[52:55]
  ds_read_b64_tr_b16 a[170:171], v2 offset:17952
  v_exp_f32 v25, v25
  v_mul_f32 v29, v13, v39
  v_mfma_f32_16x16x32_bf16 v[52:55], a[144:147], a[36:39], v[52:55]
  v_exp_f32 v26, v26
  v_fma_f32 v22, v22, v11, v11
  v_mfma_f32_16x16x32_bf16 v[56:59], a[144:147], a[40:43], v[56:59]
  ds_read_b64_tr_b16 a[172:173], v2 offset:21536
  v_exp_f32 v27, v27
  v_fma_f32 v23, v23, v11, v11
  v_mfma_f32_16x16x32_bf16 v[56:59], a[148:151], a[56:59], v[56:59]
  v_exp_f32 v28, v28
  v_fma_f32 v24, v24, v11, v11
  v_mfma_f32_16x16x32_bf16 v[60:63], a[148:151], a[60:63], v[60:63]
  ds_read_b64_tr_b16 a[174:175], v2 offset:25120
  v_exp_f32 v29, v29
  v_fma_f32 v25, v25, v11, v11
  v_mfma_f32_16x16x32_bf16 v[60:63], a[144:147], a[44:47], v[60:63]
  s_waitcnt lgkmcnt(11)
  v_rcp_f32 v22, v22
  v_fma_f32 v26, v26, v14, v14
  v_mfma_f32_16x16x32_bf16 v[48:51], a[16:19], a[0:3], v[48:51]
  ds_read_b64_tr_b16 a[128:129], v2 offset:28704
  v_rcp_f32 v23, v23
  v_fma_f32 v27, v27, v14, v14
  v_mfma_f32_16x16x32_bf16 v[52:55], a[16:19], a[4:7], v[52:55]
  v_rcp_f32 v24, v24
  v_fma_f32 v28, v28, v14, v14
  v_mfma_f32_16x16x32_bf16 v[56:59], a[16:19], a[8:11], v[56:59]
  ds_read_b64_tr_b16 a[130:131], v2 offset:32288
  v_rcp_f32 v25, v25
  v_fma_f32 v29, v29, v14, v14
  v_mfma_f32_16x16x32_bf16 v[60:63], a[16:19], a[12:15], v[60:63]
  v_rcp_f32 v26, v26
  v_mul_f32 v144, v32, v144
  v_mfma_f32_16x16x32_bf16 v[160:163], a[20:23], a[0:3], v[160:163]
  ds_read_b64_tr_b16 a[132:133], v2 offset:35872
  v_rcp_f32 v27, v27
  v_mul_f32 v145, v33, v145
  v_mfma_f32_16x16x32_bf16 v[164:167], a[20:23], a[4:7], v[164:167]
  v_rcp_f32 v28, v28
  v_mul_f32 v146, v34, v146
  v_mfma_f32_16x16x32_bf16 v[168:171], a[20:23], a[8:11], v[168:171]
  ds_read_b64_tr_b16 a[134:135], v2 offset:39456
  v_rcp_f32 v29, v29
  v_mul_f32 v147, v35, v147
  v_mfma_f32_16x16x32_bf16 v[172:175], a[20:23], a[12:15], v[172:175]
  v_mul_f32 v144, v144, v22
  v_mul_f32 v145, v145, v23
  v_mul_f32 v146, v146, v24
  v_mul_f32 v147, v147, v25
  v_mfma_f32_16x16x32_bf16 v[172:175], a[152:155], a[44:47], v[172:175]
  ds_read_b64_tr_b16 a[136:137], v2 offset:43040
  v_mul_f32 v22, v16, v40
  v_mul_f32 v23, v16, v41
  v_mul_f32 v24, v16, v42
  v_mul_f32 v25, v16, v43
  v_mfma_f32_16x16x32_bf16 v[172:175], a[156:159], a[60:63], v[172:175]
  v_exp_f32 v22, v22
  v_mul_f32 v148, v36, v148
  v_mfma_f32_16x16x32_bf16 v[168:171], a[156:159], a[56:59], v[168:171]
  ds_read_b64_tr_b16 a[138:139], v2 offset:46624
  v_exp_f32 v23, v23
  v_mul_f32 v149, v37, v149
  v_mfma_f32_16x16x32_bf16 v[168:171], a[152:155], a[40:43], v[168:171]
  v_exp_f32 v24, v24
  v_mul_f32 v150, v38, v150
  v_mfma_f32_16x16x32_bf16 v[164:167], a[152:155], a[36:39], v[164:167]
  ds_read_b64_tr_b16 a[140:141], v2 offset:50208
  v_exp_f32 v25, v25
  v_mul_f32 v151, v39, v151
  v_mfma_f32_16x16x32_bf16 v[164:167], a[156:159], a[52:55], v[164:167]
  v_mul_f32 v148, v148, v26
  v_mul_f32 v149, v149, v27
  v_mul_f32 v150, v150, v28
  v_mul_f32 v151, v151, v29
  v_mfma_f32_16x16x32_bf16 v[160:163], a[156:159], a[48:51], v[160:163]
  ds_read_b64_tr_b16 a[142:143], v2 offset:53792
  v_cvt_pk_bf16_f32 v32, v144, v145
  v_cvt_pk_bf16_f32 v33, v146, v147
  v_mul_f32 v26, v19, v44
  v_mfma_f32_16x16x32_bf16 v[160:163], a[152:155], a[32:35], v[160:163]
  s_waitcnt lgkmcnt(8)
  v_mul_f32 v27, v19, v45
  v_mul_f32 v28, v19, v46
  v_mul_f32 v29, v19, v47
  v_mfma_f32_16x16x32_bf16 v[48:51], a[160:163], a[64:67], v[48:51]
  ds_read_b64_tr_b16 a[144:145], v1 offset:28736
  v_exp_f32 v26, v26
  v_fma_f32 v22, v22, v17, v17
  v_mfma_f32_16x16x32_bf16 v[48:51], a[164:167], a[80:83], v[48:51]
  v_exp_f32 v27, v27
  v_fma_f32 v23, v23, v17, v17
  v_mfma_f32_16x16x32_bf16 v[52:55], a[164:167], a[84:87], v[52:55]
  s_mov_b32 s70, 3
  s_lshl_b32 s50, s70, 16
  s_add_u32 m0, s73, 114688
  ds_read_b64_tr_b16 a[146:147], v1 offset:32320
  v_mfma_f32_16x16x32_bf16 v[52:55], a[160:163], a[68:71], v[52:55]
  v_exp_f32 v28, v28
  v_fma_f32 v24, v24, v17, v17
  v_mfma_f32_16x16x32_bf16 v[56:59], a[160:163], a[72:75], v[56:59]
  ds_read_b64_tr_b16 a[148:149], v1 offset:35904
  v_exp_f32 v29, v29
  v_fma_f32 v25, v25, v17, v17
  v_mfma_f32_16x16x32_bf16 v[56:59], a[164:167], a[88:91], v[56:59]
  v_cvt_pk_bf16_f32 v36, v148, v149
  v_cvt_pk_bf16_f32 v37, v150, v151
  v_rcp_f32 v22, v22
  v_mfma_f32_16x16x32_bf16 v[60:63], a[164:167], a[92:95], v[60:63]
  buffer_load_dwordx4 v133, s[24:27], s50 offen offset:0 lds
  v_fma_f32 v26, v26, v20, v20
  v_rcp_f32 v23, v23
  v_mfma_f32_16x16x32_bf16 v[60:63], a[160:163], a[76:79], v[60:63]
  ds_read_b64_tr_b16 a[150:151], v1 offset:39488
  v_fma_f32 v27, v27, v20, v20
  v_rcp_f32 v24, v24
  v_mfma_f32_16x16x32_bf16 v[172:175], a[168:171], a[76:79], v[172:175]
  v_fma_f32 v28, v28, v20, v20
  v_rcp_f32 v25, v25
  v_fma_f32 v29, v29, v20, v20
  v_mfma_f32_16x16x32_bf16 v[172:175], a[172:175], a[92:95], v[172:175]
  v_rcp_f32 v26, v26
  v_mul_f32 v152, v40, v152
  v_mfma_f32_16x16x32_bf16 v[168:171], a[172:175], a[88:91], v[168:171]
  v_rcp_f32 v27, v27
  v_mul_f32 v153, v41, v153
  v_mfma_f32_16x16x32_bf16 v[168:171], a[168:171], a[72:75], v[168:171]
  buffer_load_dwordx4 v134, s[24:27], s50 offen offset:1024 lds
  v_rcp_f32 v28, v28
  v_mul_f32 v154, v42, v154
  v_mfma_f32_16x16x32_bf16 v[164:167], a[168:171], a[68:71], v[164:167]
  v_rcp_f32 v29, v29
  v_mul_f32 v155, v43, v155
  v_mul_f32 v152, v152, v22
  v_mfma_f32_16x16x32_bf16 v[164:167], a[172:175], a[84:87], v[164:167]
  v_mul_f32 v153, v153, v23
  v_mul_f32 v154, v154, v24
  v_mul_f32 v155, v155, v25
  v_mul_f32 v156, v44, v156
  v_mfma_f32_16x16x32_bf16 v[160:163], a[172:175], a[80:83], v[160:163]
  v_mul_f32 v157, v45, v157
  v_mul_f32 v158, v46, v158
  v_mul_f32 v159, v47, v159
  v_cvt_pk_bf16_f32 v40, v152, v153
  v_mfma_f32_16x16x32_bf16 v[160:163], a[168:171], a[64:67], v[160:163]
  s_waitcnt lgkmcnt(4)
  v_cvt_pk_bf16_f32 v41, v154, v155
  v_mul_f32 v156, v156, v26
  v_mul_f32 v157, v157, v27
  v_mul_f32 v158, v158, v28
  v_mfma_f32_16x16x32_bf16 v[48:51], a[128:131], a[96:99], v[48:51]
  ds_read_b128 a[24:27], v31 offset:512
  v_mul_f32 v159, v159, v29
  v_cvt_pk_bf16_f32 v44, v156, v157
  v_cvt_pk_bf16_f32 v45, v158, v159
  v_mfma_f32_16x16x32_bf16 v[48:51], a[132:135], a[112:115], v[48:51]
  buffer_load_dwordx4 v135, s[24:27], s50 offen offset:2048 lds
  v_mfma_f32_16x16x32_bf16 v[52:55], a[132:135], a[116:119], v[52:55]
  ds_read_b64_tr_b16 a[152:153], v1 offset:43072
  v_mfma_f32_16x16x32_bf16 v[52:55], a[128:131], a[100:103], v[52:55]
  ds_read_b128 a[28:31], v31 offset:2560
  v_mfma_f32_16x16x32_bf16 v[56:59], a[128:131], a[104:107], v[56:59]
  ds_read_b64_tr_b16 a[154:155], v1 offset:46656
  v_mfma_f32_16x16x32_bf16 v[56:59], a[132:135], a[120:123], v[56:59]
  ds_read_b64_tr_b16 a[156:157], v1 offset:50240
  v_mfma_f32_16x16x32_bf16 v[60:63], a[132:135], a[124:127], v[60:63]
  buffer_load_dwordx4 v136, s[24:27], s50 offen offset:3072 lds
  s_cmp_eq_u32 s83, 1
  s_cselect_b32 s74, 38, 10
  s_lshl_b32 s50, s74, 16
  v_mfma_f32_16x16x32_bf16 v[60:63], a[128:131], a[108:111], v[60:63]
  s_add_u32 m0, s73, 131072
  ds_read_b64_tr_b16 a[158:159], v1 offset:53824
  v_mfma_f32_16x16x32_bf16 v[172:175], a[136:139], a[108:111], v[172:175]
  ds_read_b64_tr_b16 a[160:161], v2 offset:64
  v_mul_f32 v22, v10, v48
  v_mul_f32 v23, v10, v49
  v_mul_f32 v24, v10, v50
  v_mfma_f32_16x16x32_bf16 v[172:175], a[140:143], a[124:127], v[172:175]
  v_mul_f32 v25, v10, v51
  v_exp_f32 v22, v22
  v_mul_f32 v26, v13, v52
  v_mfma_f32_16x16x32_bf16 v[168:171], a[140:143], a[120:123], v[168:171]
  buffer_load_dwordx4 v133, s[24:27], s50 offen offset:0 lds
  v_exp_f32 v23, v23
  v_mul_f32 v27, v13, v53
  v_mfma_f32_16x16x32_bf16 v[168:171], a[136:139], a[104:107], v[168:171]
  ds_read_b64_tr_b16 a[162:163], v2 offset:3648
  v_exp_f32 v24, v24
  v_mul_f32 v28, v13, v54
  v_mfma_f32_16x16x32_bf16 v[164:167], a[136:139], a[100:103], v[164:167]
  ds_read_b64_tr_b16 a[164:165], v2 offset:7232
  v_exp_f32 v25, v25
  v_mul_f32 v29, v13, v55
  v_mfma_f32_16x16x32_bf16 v[164:167], a[140:143], a[116:119], v[164:167]
  v_exp_f32 v26, v26
  v_fma_f32 v22, v22, v11, v11
  v_mfma_f32_16x16x32_bf16 v[160:163], a[140:143], a[112:115], v[160:163]
  ds_read_b64_tr_b16 a[166:167], v2 offset:10816
  v_exp_f32 v27, v27
  v_fma_f32 v23, v23, v11, v11
  v_mfma_f32_16x16x32_bf16 v[160:163], a[136:139], a[96:99], v[160:163]
  s_waitcnt lgkmcnt(4)
  buffer_load_dwordx4 v134, s[24:27], s50 offen offset:1024 lds
  v_exp_f32 v28, v28
  v_fma_f32 v24, v24, v11, v11
  v_mfma_f32_16x16x32_bf16 v[64:67], a[144:147], a[32:35], v[64:67]
  ds_read_b64_tr_b16 a[168:169], v2 offset:14400
  v_exp_f32 v29, v29
  v_fma_f32 v25, v25, v11, v11
  v_mfma_f32_16x16x32_bf16 v[64:67], a[148:151], a[48:51], v[64:67]
  v_rcp_f32 v22, v22
  v_fma_f32 v26, v26, v14, v14
  v_mfma_f32_16x16x32_bf16 v[68:71], a[148:151], a[52:55], v[68:71]
  ds_read_b64_tr_b16 a[170:171], v2 offset:17984
  v_rcp_f32 v23, v23
  v_fma_f32 v27, v27, v14, v14
  v_mfma_f32_16x16x32_bf16 v[68:71], a[144:147], a[36:39], v[68:71]
  v_rcp_f32 v24, v24
  v_fma_f32 v28, v28, v14, v14
  v_mfma_f32_16x16x32_bf16 v[72:75], a[144:147], a[40:43], v[72:75]
  buffer_load_dwordx4 v135, s[24:27], s50 offen offset:2048 lds
  v_rcp_f32 v25, v25
  v_fma_f32 v29, v29, v14, v14
  v_mfma_f32_16x16x32_bf16 v[72:75], a[148:151], a[56:59], v[72:75]
  ds_read_b64_tr_b16 a[172:173], v2 offset:21568
  v_rcp_f32 v26, v26
  v_mul_f32 v160, v48, v160
  v_mfma_f32_16x16x32_bf16 v[76:79], a[148:151], a[60:63], v[76:79]
  ds_read_b64_tr_b16 a[174:175], v2 offset:25152
  v_rcp_f32 v27, v27
  v_mul_f32 v161, v49, v161
  v_mfma_f32_16x16x32_bf16 v[76:79], a[144:147], a[44:47], v[76:79]
  s_waitcnt lgkmcnt(11)
  v_rcp_f32 v28, v28
  v_mul_f32 v162, v50, v162
  v_mfma_f32_16x16x32_bf16 v[64:67], a[24:27], a[0:3], v[64:67]
  ds_read_b64_tr_b16 a[128:129], v2 offset:28736
  v_rcp_f32 v29, v29
  v_mul_f32 v163, v51, v163
  v_mfma_f32_16x16x32_bf16 v[68:71], a[24:27], a[4:7], v[68:71]
  buffer_load_dwordx4 v136, s[24:27], s50 offen offset:3072 lds
  v_mul_f32 v160, v160, v22
  v_mul_f32 v161, v161, v23
  v_mul_f32 v162, v162, v24
  v_mfma_f32_16x16x32_bf16 v[72:75], a[24:27], a[8:11], v[72:75]
  s_cmp_eq_u32 s83, 2
  s_cselect_b32 s75, 45, 17
  s_lshl_b32 s50, s75, 16
  s_add_u32 m0, s73, 0
  ds_read_b64_tr_b16 a[130:131], v2 offset:32320
  v_mfma_f32_16x16x32_bf16 v[76:79], a[24:27], a[12:15], v[76:79]
  v_mul_f32 v163, v163, v25
  v_mul_f32 v22, v16, v56
  v_mul_f32 v23, v16, v57
  v_mul_f32 v24, v16, v58
  v_mfma_f32_16x16x32_bf16 v[176:179], a[28:31], a[0:3], v[176:179]
  ds_read_b64_tr_b16 a[132:133], v2 offset:35904
  v_mul_f32 v25, v16, v59
  v_exp_f32 v22, v22
  v_mfma_f32_16x16x32_bf16 v[180:183], a[28:31], a[4:7], v[180:183]
  v_mul_f32 v164, v52, v164
  v_exp_f32 v23, v23
  v_mul_f32 v165, v53, v165
  v_mfma_f32_16x16x32_bf16 v[184:187], a[28:31], a[8:11], v[184:187]
  buffer_load_dwordx4 v133, s[24:27], s50 offen offset:0 lds
  v_exp_f32 v24, v24
  v_mul_f32 v166, v54, v166
  v_mfma_f32_16x16x32_bf16 v[188:191], a[28:31], a[12:15], v[188:191]
  ds_read_b64_tr_b16 a[134:135], v2 offset:39488
  v_exp_f32 v25, v25
  v_mul_f32 v167, v55, v167
  v_mfma_f32_16x16x32_bf16 v[188:191], a[152:155], a[44:47], v[188:191]
  ds_read_b64_tr_b16 a[136:137], v2 offset:43072
  v_mul_f32 v164, v164, v26
  v_mul_f32 v165, v165, v27
  v_mul_f32 v166, v166, v28
  v_mfma_f32_16x16x32_bf16 v[188:191], a[156:159], a[60:63], v[188:191]
  v_mul_f32 v167, v167, v29
  v_cvt_pk_bf16_f32 v34, v160, v161
  v_cvt_pk_bf16_f32 v35, v162, v163
  v_mfma_f32_16x16x32_bf16 v[184:187], a[156:159], a[56:59], v[184:187]
  ds_read_b64_tr_b16 a[138:139], v2 offset:46656
  v_mfma_f32_16x16x32_bf16 v[184:187], a[152:155], a[40:43], v[184:187]
  buffer_load_dwordx4 v134, s[24:27], s50 offen offset:1024 lds
  v_mfma_f32_16x16x32_bf16 v[180:183], a[152:155], a[36:39], v[180:183]
  ds_read_b64_tr_b16 a[140:141], v2 offset:50240
  v_mfma_f32_16x16x32_bf16 v[180:183], a[156:159], a[52:55], v[180:183]
  buffer_store_dwordx4 v[32:35], v0, s[36:39], s64 offen offset:0 sc1
  v_mul_f32 v26, v19, v60
  v_mul_f32 v27, v19, v61
  v_mul_f32 v28, v19, v62
  v_mfma_f32_16x16x32_bf16 v[176:179], a[156:159], a[48:51], v[176:179]
  ds_read_b64_tr_b16 a[142:143], v2 offset:53824
  v_mul_f32 v29, v19, v63
  v_exp_f32 v26, v26
  v_mfma_f32_16x16x32_bf16 v[176:179], a[152:155], a[32:35], v[176:179]
  s_waitcnt lgkmcnt(8)
  v_fma_f32 v22, v22, v17, v17
  v_exp_f32 v27, v27
  v_fma_f32 v23, v23, v17, v17
  v_mfma_f32_16x16x32_bf16 v[64:67], a[160:163], a[64:67], v[64:67]
  buffer_load_dwordx4 v135, s[24:27], s50 offen offset:2048 lds
  v_exp_f32 v28, v28
  v_fma_f32 v24, v24, v17, v17
  v_mfma_f32_16x16x32_bf16 v[64:67], a[164:167], a[80:83], v[64:67]
  ds_read_b64_tr_b16 a[144:145], v1 offset:28768
  v_exp_f32 v29, v29
  v_fma_f32 v25, v25, v17, v17
  v_mfma_f32_16x16x32_bf16 v[68:71], a[164:167], a[84:87], v[68:71]
  ds_read_b64_tr_b16 a[146:147], v1 offset:32352
  v_cvt_pk_bf16_f32 v38, v164, v165
  v_cvt_pk_bf16_f32 v39, v166, v167
  v_mfma_f32_16x16x32_bf16 v[68:71], a[160:163], a[68:71], v[68:71]
  buffer_store_dwordx4 v[36:39], v0, s[36:39], s64 offen offset:1024 sc1
  v_rcp_f32 v22, v22
  v_fma_f32 v26, v26, v20, v20
  v_mfma_f32_16x16x32_bf16 v[72:75], a[160:163], a[72:75], v[72:75]
  ds_read_b64_tr_b16 a[148:149], v1 offset:35936
  v_rcp_f32 v23, v23
  v_fma_f32 v27, v27, v20, v20
  v_mfma_f32_16x16x32_bf16 v[72:75], a[164:167], a[88:91], v[72:75]
  buffer_load_dwordx4 v136, s[24:27], s50 offen offset:3072 lds
  v_rcp_f32 v24, v24
  v_fma_f32 v28, v28, v20, v20
  v_mfma_f32_16x16x32_bf16 v[76:79], a[164:167], a[92:95], v[76:79]
  ds_read_b64_tr_b16 a[150:151], v1 offset:39520
  v_rcp_f32 v25, v25
  v_fma_f32 v29, v29, v20, v20
  v_mfma_f32_16x16x32_bf16 v[76:79], a[160:163], a[76:79], v[76:79]
  v_rcp_f32 v26, v26
  v_mul_f32 v168, v56, v168
  v_mfma_f32_16x16x32_bf16 v[188:191], a[168:171], a[76:79], v[188:191]
  v_rcp_f32 v27, v27
  v_mul_f32 v169, v57, v169
  v_mfma_f32_16x16x32_bf16 v[188:191], a[172:175], a[92:95], v[188:191]
  v_rcp_f32 v28, v28
  v_mul_f32 v170, v58, v170
  v_mfma_f32_16x16x32_bf16 v[184:187], a[172:175], a[88:91], v[184:187]
  v_rcp_f32 v29, v29
  v_mul_f32 v171, v59, v171
  v_mul_f32 v168, v168, v22
  v_mfma_f32_16x16x32_bf16 v[184:187], a[168:171], a[72:75], v[184:187]
  v_mul_f32 v169, v169, v23
  v_mul_f32 v170, v170, v24
  v_mul_f32 v171, v171, v25
  v_mul_f32 v172, v60, v172
  v_mfma_f32_16x16x32_bf16 v[180:183], a[168:171], a[68:71], v[180:183]
  v_mul_f32 v173, v61, v173
  v_mul_f32 v174, v62, v174
  v_mul_f32 v175, v63, v175
  v_cvt_pk_bf16_f32 v42, v168, v169
  v_mfma_f32_16x16x32_bf16 v[180:183], a[172:175], a[84:87], v[180:183]
  v_cvt_pk_bf16_f32 v43, v170, v171
  v_mfma_f32_16x16x32_bf16 v[176:179], a[172:175], a[80:83], v[176:179]
  buffer_store_dwordx4 v[40:43], v0, s[36:39], s65 offen offset:0 sc1
  v_mul_f32 v172, v172, v26
  v_mul_f32 v173, v173, v27
  v_mul_f32 v174, v174, v28
  v_mfma_f32_16x16x32_bf16 v[176:179], a[168:171], a[64:67], v[176:179]
  s_waitcnt lgkmcnt(4)
  v_mul_f32 v175, v175, v29
  v_cvt_pk_bf16_f32 v46, v172, v173
  v_cvt_pk_bf16_f32 v47, v174, v175
  v_mfma_f32_16x16x32_bf16 v[64:67], a[128:131], a[96:99], v[64:67]
  ds_read_b128 a[16:19], v31 offset:768
  v_mfma_f32_16x16x32_bf16 v[64:67], a[132:135], a[112:115], v[64:67]
  ds_read_b64_tr_b16 a[152:153], v1 offset:43104
  v_mfma_f32_16x16x32_bf16 v[68:71], a[132:135], a[116:119], v[68:71]
  ds_read_b128 a[20:23], v31 offset:2816
  v_mfma_f32_16x16x32_bf16 v[68:71], a[128:131], a[100:103], v[68:71]
  ds_read_b64_tr_b16 a[154:155], v1 offset:46688
  v_mfma_f32_16x16x32_bf16 v[72:75], a[128:131], a[104:107], v[72:75]
  ds_read_b64_tr_b16 a[156:157], v1 offset:50272
  v_mfma_f32_16x16x32_bf16 v[72:75], a[132:135], a[120:123], v[72:75]
  buffer_store_dwordx4 v[44:47], v0, s[36:39], s65 offen offset:1024 sc1
  s_add_u32 s64, s64, 2048
  s_add_u32 s65, s65, 2048
  v_mfma_f32_16x16x32_bf16 v[76:79], a[132:135], a[124:127], v[76:79]
  ds_read_b64_tr_b16 a[158:159], v1 offset:53856
  v_mfma_f32_16x16x32_bf16 v[76:79], a[128:131], a[108:111], v[76:79]
  v_mfma_f32_16x16x32_bf16 v[188:191], a[136:139], a[108:111], v[188:191]
  ds_read_b64_tr_b16 a[160:161], v2 offset:96
  v_mul_f32 v22, v10, v64
  v_mul_f32 v23, v10, v65
  v_mul_f32 v24, v10, v66
  v_mfma_f32_16x16x32_bf16 v[188:191], a[140:143], a[124:127], v[188:191]
  v_mul_f32 v25, v10, v67
  v_exp_f32 v22, v22
  v_mul_f32 v26, v13, v68
  v_mfma_f32_16x16x32_bf16 v[184:187], a[140:143], a[120:123], v[184:187]
  ds_read_b64_tr_b16 a[162:163], v2 offset:3680
  v_exp_f32 v23, v23
  v_mul_f32 v27, v13, v69
  v_mfma_f32_16x16x32_bf16 v[184:187], a[136:139], a[104:107], v[184:187]
  v_exp_f32 v24, v24
  v_mul_f32 v28, v13, v70
  v_mfma_f32_16x16x32_bf16 v[180:183], a[136:139], a[100:103], v[180:183]
  ds_read_b64_tr_b16 a[164:165], v2 offset:7264
  v_exp_f32 v25, v25
  v_mul_f32 v29, v13, v71
  v_mfma_f32_16x16x32_bf16 v[180:183], a[140:143], a[116:119], v[180:183]
  v_exp_f32 v26, v26
  v_fma_f32 v22, v22, v11, v11
  v_mfma_f32_16x16x32_bf16 v[176:179], a[140:143], a[112:115], v[176:179]
  ds_read_b64_tr_b16 a[166:167], v2 offset:10848
  v_exp_f32 v27, v27
  v_fma_f32 v23, v23, v11, v11
  v_mfma_f32_16x16x32_bf16 v[176:179], a[136:139], a[96:99], v[176:179]
  s_waitcnt lgkmcnt(4)
  v_exp_f32 v28, v28
  v_fma_f32 v24, v24, v11, v11
  v_mfma_f32_16x16x32_bf16 v[80:83], a[144:147], a[32:35], v[80:83]
  ds_read_b64_tr_b16 a[168:169], v2 offset:14432
  v_exp_f32 v29, v29
  v_fma_f32 v25, v25, v11, v11
  v_mfma_f32_16x16x32_bf16 v[80:83], a[148:151], a[48:51], v[80:83]
  v_rcp_f32 v22, v22
  v_fma_f32 v26, v26, v14, v14
  v_mfma_f32_16x16x32_bf16 v[84:87], a[148:151], a[52:55], v[84:87]
  ds_read_b64_tr_b16 a[170:171], v2 offset:18016
  v_rcp_f32 v23, v23
  v_fma_f32 v27, v27, v14, v14
  v_mfma_f32_16x16x32_bf16 v[84:87], a[144:147], a[36:39], v[84:87]
  v_rcp_f32 v24, v24
  v_fma_f32 v28, v28, v14, v14
  v_mfma_f32_16x16x32_bf16 v[88:91], a[144:147], a[40:43], v[88:91]
  ds_read_b64_tr_b16 a[172:173], v2 offset:21600
  v_rcp_f32 v25, v25
  v_fma_f32 v29, v29, v14, v14
  v_mfma_f32_16x16x32_bf16 v[88:91], a[148:151], a[56:59], v[88:91]
  v_rcp_f32 v26, v26
  v_mul_f32 v176, v64, v176
  v_mfma_f32_16x16x32_bf16 v[92:95], a[148:151], a[60:63], v[92:95]
  ds_read_b64_tr_b16 a[174:175], v2 offset:25184
  v_rcp_f32 v27, v27
  v_mul_f32 v177, v65, v177
  v_mfma_f32_16x16x32_bf16 v[92:95], a[144:147], a[44:47], v[92:95]
  s_waitcnt lgkmcnt(11)
  v_rcp_f32 v28, v28
  v_mul_f32 v178, v66, v178
  v_mfma_f32_16x16x32_bf16 v[80:83], a[16:19], a[0:3], v[80:83]
  ds_read_b64_tr_b16 a[128:129], v2 offset:28768
  v_rcp_f32 v29, v29
  v_mul_f32 v179, v67, v179
  v_mfma_f32_16x16x32_bf16 v[84:87], a[16:19], a[4:7], v[84:87]
  v_mul_f32 v176, v176, v22
  v_mul_f32 v177, v177, v23
  v_mul_f32 v178, v178, v24
  v_mul_f32 v179, v179, v25
  v_mfma_f32_16x16x32_bf16 v[88:91], a[16:19], a[8:11], v[88:91]
  ds_read_b64_tr_b16 a[130:131], v2 offset:32352
  v_mul_f32 v22, v16, v72
  v_mul_f32 v23, v16, v73
  v_mul_f32 v24, v16, v74
  v_mfma_f32_16x16x32_bf16 v[92:95], a[16:19], a[12:15], v[92:95]
Hb1_2:
  s_cbranch_execz Hb1_3
  v_mul_f32 v25, v16, v75
  v_exp_f32 v22, v22
  v_mul_f32 v180, v68, v180
  v_mfma_f32_16x16x32_bf16 v[192:195], a[20:23], a[0:3], v[192:195]
  ds_read_b64_tr_b16 a[132:133], v2 offset:35936
  v_exp_f32 v23, v23
  v_mul_f32 v181, v69, v181
  v_mfma_f32_16x16x32_bf16 v[196:199], a[20:23], a[4:7], v[196:199]
  v_exp_f32 v24, v24
  v_mul_f32 v182, v70, v182
  v_mfma_f32_16x16x32_bf16 v[200:203], a[20:23], a[8:11], v[200:203]
  ds_read_b64_tr_b16 a[134:135], v2 offset:39520
  v_exp_f32 v25, v25
  v_mul_f32 v183, v71, v183
  v_mfma_f32_16x16x32_bf16 v[204:207], a[20:23], a[12:15], v[204:207]
  v_mul_f32 v180, v180, v26
  v_mul_f32 v181, v181, v27
  v_mul_f32 v182, v182, v28
  v_mul_f32 v183, v183, v29
  v_mfma_f32_16x16x32_bf16 v[204:207], a[152:155], a[44:47], v[204:207]
  ds_read_b64_tr_b16 a[136:137], v2 offset:43104
  v_cvt_pk_bf16_f32 v64, v176, v177
  v_cvt_pk_bf16_f32 v65, v178, v179
  v_mul_f32 v26, v19, v76
  v_mfma_f32_16x16x32_bf16 v[204:207], a[156:159], a[60:63], v[204:207]
  v_mul_f32 v27, v19, v77
  v_mul_f32 v28, v19, v78
  v_mul_f32 v29, v19, v79
  v_mfma_f32_16x16x32_bf16 v[200:203], a[156:159], a[56:59], v[200:203]
  ds_read_b64_tr_b16 a[138:139], v2 offset:46688
  v_exp_f32 v26, v26
  v_fma_f32 v22, v22, v17, v17
  v_mfma_f32_16x16x32_bf16 v[200:203], a[152:155], a[40:43], v[200:203]
  v_exp_f32 v27, v27
  v_fma_f32 v23, v23, v17, v17
  v_mfma_f32_16x16x32_bf16 v[196:199], a[152:155], a[36:39], v[196:199]
  ds_read_b64_tr_b16 a[140:141], v2 offset:50272
  v_exp_f32 v28, v28
  v_fma_f32 v24, v24, v17, v17
  v_mfma_f32_16x16x32_bf16 v[196:199], a[156:159], a[52:55], v[196:199]
  v_exp_f32 v29, v29
  v_fma_f32 v25, v25, v17, v17
  v_cvt_pk_bf16_f32 v68, v180, v181
  v_mfma_f32_16x16x32_bf16 v[192:195], a[156:159], a[48:51], v[192:195]
  ds_read_b64_tr_b16 a[142:143], v2 offset:53856
  v_cvt_pk_bf16_f32 v69, v182, v183
  v_rcp_f32 v22, v22
  v_mfma_f32_16x16x32_bf16 v[192:195], a[152:155], a[32:35], v[192:195]
  s_waitcnt lgkmcnt(8)
  v_fma_f32 v26, v26, v20, v20
  v_rcp_f32 v23, v23
  v_fma_f32 v27, v27, v20, v20
  v_mfma_f32_16x16x32_bf16 v[80:83], a[160:163], a[64:67], v[80:83]
  ds_read_b64_tr_b16 a[144:145], v1 offset:28800
  v_rcp_f32 v24, v24
  v_fma_f32 v28, v28, v20, v20
  v_mfma_f32_16x16x32_bf16 v[80:83], a[164:167], a[80:83], v[80:83]
  v_rcp_f32 v25, v25
  v_fma_f32 v29, v29, v20, v20
  v_mfma_f32_16x16x32_bf16 v[84:87], a[164:167], a[84:87], v[84:87]
  ds_read_b64_tr_b16 a[146:147], v1 offset:32384
  v_rcp_f32 v26, v26
  v_mul_f32 v184, v72, v184
  v_mfma_f32_16x16x32_bf16 v[84:87], a[160:163], a[68:71], v[84:87]
  v_rcp_f32 v27, v27
  v_mul_f32 v185, v73, v185
  v_mfma_f32_16x16x32_bf16 v[88:91], a[160:163], a[72:75], v[88:91]
  ds_read_b64_tr_b16 a[148:149], v1 offset:35968
  v_rcp_f32 v28, v28
  v_mul_f32 v186, v74, v186
  v_mfma_f32_16x16x32_bf16 v[88:91], a[164:167], a[88:91], v[88:91]
  v_rcp_f32 v29, v29
  v_mul_f32 v187, v75, v187
  v_mul_f32 v184, v184, v22
  v_mfma_f32_16x16x32_bf16 v[92:95], a[164:167], a[92:95], v[92:95]
  ds_read_b64_tr_b16 a[150:151], v1 offset:39552
  v_mul_f32 v185, v185, v23
  v_mul_f32 v186, v186, v24
  v_mul_f32 v187, v187, v25
  v_mfma_f32_16x16x32_bf16 v[92:95], a[160:163], a[76:79], v[92:95]
  s_waitcnt vmcnt(0)
  s_barrier
  v_mul_f32 v188, v76, v188
  v_mul_f32 v189, v77, v189
  v_mul_f32 v190, v78, v190
  v_mfma_f32_16x16x32_bf16 v[204:207], a[168:171], a[76:79], v[204:207]
  s_mov_b64 exec, 1
  buffer_store_dword v254, v0, s[36:39], s45 offen sc1
  s_mov_b64 exec, -1
  s_lshl_b32 s45, s2, 7
  v_mfma_f32_16x16x32_bf16 v[204:207], a[172:175], a[92:95], v[204:207]
  s_add_u32 s45, s45, 5439488
  s_cmp_eq_u32 s44, 0
  s_cselect_b32 s45, s45, 1073741824
  v_mul_f32 v191, v79, v191
  v_cvt_pk_bf16_f32 v72, v184, v185
  v_mfma_f32_16x16x32_bf16 v[200:203], a[172:175], a[88:91], v[200:203]
  v_cvt_pk_bf16_f32 v73, v186, v187
  v_mul_f32 v188, v188, v26
  v_mul_f32 v189, v189, v27
  v_mul_f32 v190, v190, v28
  v_mfma_f32_16x16x32_bf16 v[200:203], a[168:171], a[72:75], v[200:203]
  v_mul_f32 v191, v191, v29
  v_cvt_pk_bf16_f32 v76, v188, v189
  v_cvt_pk_bf16_f32 v77, v190, v191
  v_mfma_f32_16x16x32_bf16 v[196:199], a[168:171], a[68:71], v[196:199]
  v_mfma_f32_16x16x32_bf16 v[196:199], a[172:175], a[84:87], v[196:199]
  v_mfma_f32_16x16x32_bf16 v[192:195], a[172:175], a[80:83], v[192:195]
  v_mfma_f32_16x16x32_bf16 v[192:195], a[168:171], a[64:67], v[192:195]
  s_waitcnt lgkmcnt(4)
  v_mfma_f32_16x16x32_bf16 v[80:83], a[128:131], a[96:99], v[80:83]
  ds_read_b128 a[24:27], v31 offset:1024
  v_mfma_f32_16x16x32_bf16 v[80:83], a[132:135], a[112:115], v[80:83]
  ds_read_b64_tr_b16 a[152:153], v1 offset:43136
  v_mfma_f32_16x16x32_bf16 v[84:87], a[132:135], a[116:119], v[84:87]
  ds_read_b128 a[28:31], v31 offset:3072
  v_mfma_f32_16x16x32_bf16 v[84:87], a[128:131], a[100:103], v[84:87]
  ds_read_b64_tr_b16 a[154:155], v1 offset:46720
  v_mfma_f32_16x16x32_bf16 v[88:91], a[128:131], a[104:107], v[88:91]
  ds_read_b64_tr_b16 a[156:157], v1 offset:50304
  v_mfma_f32_16x16x32_bf16 v[88:91], a[132:135], a[120:123], v[88:91]
  v_mfma_f32_16x16x32_bf16 v[92:95], a[132:135], a[124:127], v[92:95]
  ds_read_b64_tr_b16 a[158:159], v1 offset:53888
  v_mfma_f32_16x16x32_bf16 v[92:95], a[128:131], a[108:111], v[92:95]
  v_mfma_f32_16x16x32_bf16 v[204:207], a[136:139], a[108:111], v[204:207]
  ds_read_b64_tr_b16 a[160:161], v2 offset:128
  v_mul_f32 v22, v10, v80
  v_mul_f32 v23, v10, v81
  v_mul_f32 v24, v10, v82
  v_mfma_f32_16x16x32_bf16 v[204:207], a[140:143], a[124:127], v[204:207]
  v_mul_f32 v25, v10, v83
  v_exp_f32 v22, v22
  v_mul_f32 v26, v13, v84
  v_mfma_f32_16x16x32_bf16 v[200:203], a[140:143], a[120:123], v[200:203]
  ds_read_b64_tr_b16 a[162:163], v2 offset:3712
  v_exp_f32 v23, v23
  v_mul_f32 v27, v13, v85
  v_mfma_f32_16x16x32_bf16 v[200:203], a[136:139], a[104:107], v[200:203]
  v_exp_f32 v24, v24
  v_mul_f32 v28, v13, v86
  v_mfma_f32_16x16x32_bf16 v[196:199], a[136:139], a[100:103], v[196:199]
  ds_read_b64_tr_b16 a[164:165], v2 offset:7296
  v_exp_f32 v25, v25
  v_mul_f32 v29, v13, v87
  v_mfma_f32_16x16x32_bf16 v[196:199], a[140:143], a[116:119], v[196:199]
  v_exp_f32 v26, v26
  v_fma_f32 v22, v22, v11, v11
  v_mfma_f32_16x16x32_bf16 v[192:195], a[140:143], a[112:115], v[192:195]
  ds_read_b64_tr_b16 a[166:167], v2 offset:10880
  v_exp_f32 v27, v27
  v_fma_f32 v23, v23, v11, v11
  v_mfma_f32_16x16x32_bf16 v[192:195], a[136:139], a[96:99], v[192:195]
  s_waitcnt lgkmcnt(4)
  v_exp_f32 v28, v28
  v_fma_f32 v24, v24, v11, v11
  v_mfma_f32_16x16x32_bf16 v[96:99], a[144:147], a[32:35], v[96:99]
  ds_read_b64_tr_b16 a[168:169], v2 offset:14464
  v_exp_f32 v29, v29
  v_fma_f32 v25, v25, v11, v11
  v_mfma_f32_16x16x32_bf16 v[96:99], a[148:151], a[48:51], v[96:99]
  v_rcp_f32 v22, v22
  v_fma_f32 v26, v26, v14, v14
  v_mfma_f32_16x16x32_bf16 v[100:103], a[148:151], a[52:55], v[100:103]
  ds_read_b64_tr_b16 a[170:171], v2 offset:18048
  v_rcp_f32 v23, v23
  v_fma_f32 v27, v27, v14, v14
  v_mfma_f32_16x16x32_bf16 v[100:103], a[144:147], a[36:39], v[100:103]
  v_rcp_f32 v24, v24
  v_fma_f32 v28, v28, v14, v14
  v_mfma_f32_16x16x32_bf16 v[104:107], a[144:147], a[40:43], v[104:107]
  ds_read_b64_tr_b16 a[172:173], v2 offset:21632
  v_rcp_f32 v25, v25
  v_fma_f32 v29, v29, v14, v14
  v_mfma_f32_16x16x32_bf16 v[104:107], a[148:151], a[56:59], v[104:107]
  v_rcp_f32 v26, v26
  v_mul_f32 v192, v80, v192
  v_mfma_f32_16x16x32_bf16 v[108:111], a[148:151], a[60:63], v[108:111]
  ds_read_b64_tr_b16 a[174:175], v2 offset:25216
  v_rcp_f32 v27, v27
  v_mul_f32 v193, v81, v193
  v_mfma_f32_16x16x32_bf16 v[108:111], a[144:147], a[44:47], v[108:111]
  s_waitcnt lgkmcnt(11)
  v_rcp_f32 v28, v28
  v_mul_f32 v194, v82, v194
  v_mfma_f32_16x16x32_bf16 v[96:99], a[24:27], a[0:3], v[96:99]
  ds_read_b64_tr_b16 a[128:129], v2 offset:28800
  v_rcp_f32 v29, v29
  v_mul_f32 v195, v83, v195
  v_mfma_f32_16x16x32_bf16 v[100:103], a[24:27], a[4:7], v[100:103]
  v_mul_f32 v192, v192, v22
  v_mul_f32 v193, v193, v23
  v_mul_f32 v194, v194, v24
  v_mul_f32 v195, v195, v25
  v_mfma_f32_16x16x32_bf16 v[104:107], a[24:27], a[8:11], v[104:107]
  ds_read_b64_tr_b16 a[130:131], v2 offset:32384
  v_mul_f32 v22, v16, v88
  v_mul_f32 v23, v16, v89
  v_mul_f32 v24, v16, v90
  v_mfma_f32_16x16x32_bf16 v[108:111], a[24:27], a[12:15], v[108:111]
  v_mul_f32 v25, v16, v91
  v_exp_f32 v22, v22
  v_mul_f32 v196, v84, v196
  v_mfma_f32_16x16x32_bf16 v[208:211], a[28:31], a[0:3], v[208:211]
  ds_read_b64_tr_b16 a[132:133], v2 offset:35968
  v_exp_f32 v23, v23
  v_mul_f32 v197, v85, v197
  v_mfma_f32_16x16x32_bf16 v[212:215], a[28:31], a[4:7], v[212:215]
  v_exp_f32 v24, v24
  v_mul_f32 v198, v86, v198
  v_mfma_f32_16x16x32_bf16 v[216:219], a[28:31], a[8:11], v[216:219]
  ds_read_b64_tr_b16 a[134:135], v2 offset:39552
  v_exp_f32 v25, v25
  v_mul_f32 v199, v87, v199
  v_mfma_f32_16x16x32_bf16 v[220:223], a[28:31], a[12:15], v[220:223]
  v_mul_f32 v196, v196, v26
  v_mul_f32 v197, v197, v27
  v_mul_f32 v198, v198, v28
  v_mul_f32 v199, v199, v29
  v_mfma_f32_16x16x32_bf16 v[220:223], a[152:155], a[44:47], v[220:223]
  ds_read_b64_tr_b16 a[136:137], v2 offset:43136
  v_cvt_pk_bf16_f32 v66, v192, v193
  v_cvt_pk_bf16_f32 v67, v194, v195
  v_mfma_f32_16x16x32_bf16 v[220:223], a[156:159], a[60:63], v[220:223]
  buffer_store_dwordx4 v[64:67], v0, s[36:39], s64 offen offset:0 sc1
  v_mul_f32 v26, v19, v92
  v_mul_f32 v27, v19, v93
  v_mul_f32 v28, v19, v94
  v_mfma_f32_16x16x32_bf16 v[216:219], a[156:159], a[56:59], v[216:219]
  ds_read_b64_tr_b16 a[138:139], v2 offset:46720
  v_mul_f32 v29, v19, v95
  v_exp_f32 v26, v26
  v_mfma_f32_16x16x32_bf16 v[216:219], a[152:155], a[40:43], v[216:219]
  v_fma_f32 v22, v22, v17, v17
  v_exp_f32 v27, v27
  v_fma_f32 v23, v23, v17, v17
  v_mfma_f32_16x16x32_bf16 v[212:215], a[152:155], a[36:39], v[212:215]
  ds_read_b64_tr_b16 a[140:141], v2 offset:50304
  v_exp_f32 v28, v28
  v_fma_f32 v24, v24, v17, v17
  v_mfma_f32_16x16x32_bf16 v[212:215], a[156:159], a[52:55], v[212:215]
  v_exp_f32 v29, v29
  v_fma_f32 v25, v25, v17, v17
  v_cvt_pk_bf16_f32 v70, v196, v197
  v_mfma_f32_16x16x32_bf16 v[208:211], a[156:159], a[48:51], v[208:211]
  ds_read_b64_tr_b16 a[142:143], v2 offset:53888
  v_cvt_pk_bf16_f32 v71, v198, v199
  v_mfma_f32_16x16x32_bf16 v[208:211], a[152:155], a[32:35], v[208:211]
  s_waitcnt lgkmcnt(8)
  buffer_store_dwordx4 v[68:71], v0, s[36:39], s64 offen offset:1024 sc1
  v_rcp_f32 v22, v22
  v_fma_f32 v26, v26, v20, v20
  v_mfma_f32_16x16x32_bf16 v[96:99], a[160:163], a[64:67], v[96:99]
  ds_read_b64_tr_b16 a[144:145], v1 offset:28832
  v_rcp_f32 v23, v23
  v_fma_f32 v27, v27, v20, v20
  v_mfma_f32_16x16x32_bf16 v[96:99], a[164:167], a[80:83], v[96:99]
  v_rcp_f32 v24, v24
  v_fma_f32 v28, v28, v20, v20
  v_mfma_f32_16x16x32_bf16 v[100:103], a[164:167], a[84:87], v[100:103]
  ds_read_b64_tr_b16 a[146:147], v1 offset:32416
  v_rcp_f32 v25, v25
  v_fma_f32 v29, v29, v20, v20
  v_mfma_f32_16x16x32_bf16 v[100:103], a[160:163], a[68:71], v[100:103]
  v_rcp_f32 v26, v26
  v_mul_f32 v200, v88, v200
  v_mfma_f32_16x16x32_bf16 v[104:107], a[160:163], a[72:75], v[104:107]
  ds_read_b64_tr_b16 a[148:149], v1 offset:36000
  v_rcp_f32 v27, v27
  v_mul_f32 v201, v89, v201
  v_mfma_f32_16x16x32_bf16 v[104:107], a[164:167], a[88:91], v[104:107]
  v_rcp_f32 v28, v28
  v_mul_f32 v202, v90, v202
  v_mfma_f32_16x16x32_bf16 v[108:111], a[164:167], a[92:95], v[108:111]
  ds_read_b64_tr_b16 a[150:151], v1 offset:39584
  v_rcp_f32 v29, v29
  v_mul_f32 v203, v91, v203
  v_mfma_f32_16x16x32_bf16 v[108:111], a[160:163], a[76:79], v[108:111]
  v_mul_f32 v200, v200, v22
  v_mul_f32 v201, v201, v23
  v_mul_f32 v202, v202, v24
  v_mul_f32 v203, v203, v25
  v_mfma_f32_16x16x32_bf16 v[220:223], a[168:171], a[76:79], v[220:223]
  v_mul_f32 v204, v92, v204
  v_mul_f32 v205, v93, v205
  v_mul_f32 v206, v94, v206
  v_mul_f32 v207, v95, v207
  v_mfma_f32_16x16x32_bf16 v[220:223], a[172:175], a[92:95], v[220:223]
  v_cvt_pk_bf16_f32 v74, v200, v201
  v_cvt_pk_bf16_f32 v75, v202, v203
  v_mfma_f32_16x16x32_bf16 v[216:219], a[172:175], a[88:91], v[216:219]
  buffer_store_dwordx4 v[72:75], v0, s[36:39], s65 offen offset:0 sc1
  v_mul_f32 v204, v204, v26
  v_mul_f32 v205, v205, v27
  v_mul_f32 v206, v206, v28
  v_mfma_f32_16x16x32_bf16 v[216:219], a[168:171], a[72:75], v[216:219]
  v_mul_f32 v207, v207, v29
  v_cvt_pk_bf16_f32 v78, v204, v205
  v_cvt_pk_bf16_f32 v79, v206, v207
  v_mfma_f32_16x16x32_bf16 v[212:215], a[168:171], a[68:71], v[212:215]
  buffer_store_dwordx4 v[76:79], v0, s[36:39], s65 offen offset:1024 sc1
  s_add_u32 s64, s64, 2048
  s_add_u32 s65, s65, 2048
  v_mfma_f32_16x16x32_bf16 v[212:215], a[172:175], a[84:87], v[212:215]
  v_mfma_f32_16x16x32_bf16 v[208:211], a[172:175], a[80:83], v[208:211]
  v_mfma_f32_16x16x32_bf16 v[208:211], a[168:171], a[64:67], v[208:211]
  s_waitcnt lgkmcnt(4)
  v_mfma_f32_16x16x32_bf16 v[96:99], a[128:131], a[96:99], v[96:99]
  ds_read_b128 a[16:19], v31 offset:1280
  v_mfma_f32_16x16x32_bf16 v[96:99], a[132:135], a[112:115], v[96:99]
  ds_read_b64_tr_b16 a[152:153], v1 offset:43168
  v_mfma_f32_16x16x32_bf16 v[100:103], a[132:135], a[116:119], v[100:103]
  ds_read_b128 a[20:23], v31 offset:3328
  v_mfma_f32_16x16x32_bf16 v[100:103], a[128:131], a[100:103], v[100:103]
  ds_read_b64_tr_b16 a[154:155], v1 offset:46752
  v_mfma_f32_16x16x32_bf16 v[104:107], a[128:131], a[104:107], v[104:107]
  ds_read_b64_tr_b16 a[156:157], v1 offset:50336
  v_mfma_f32_16x16x32_bf16 v[104:107], a[132:135], a[120:123], v[104:107]
  v_mfma_f32_16x16x32_bf16 v[108:111], a[132:135], a[124:127], v[108:111]
  ds_read_b64_tr_b16 a[158:159], v1 offset:53920
  v_mfma_f32_16x16x32_bf16 v[108:111], a[128:131], a[108:111], v[108:111]
  v_mfma_f32_16x16x32_bf16 v[220:223], a[136:139], a[108:111], v[220:223]
  ds_read_b64_tr_b16 a[160:161], v2 offset:160
  v_mul_f32 v22, v10, v96
  v_mul_f32 v23, v10, v97
  v_mul_f32 v24, v10, v98
  v_mul_f32 v25, v10, v99
  v_mfma_f32_16x16x32_bf16 v[220:223], a[140:143], a[124:127], v[220:223]
  v_exp_f32 v22, v22
  v_mul_f32 v26, v13, v100
  v_mfma_f32_16x16x32_bf16 v[216:219], a[140:143], a[120:123], v[216:219]
  buffer_load_dword v139, v138, s[36:39], s91 offen sc1
  v_exp_f32 v23, v23
  v_mul_f32 v27, v13, v101
  v_mfma_f32_16x16x32_bf16 v[216:219], a[136:139], a[104:107], v[216:219]
  ds_read_b64_tr_b16 a[162:163], v2 offset:3744
  v_exp_f32 v24, v24
  v_mul_f32 v28, v13, v102
  v_mfma_f32_16x16x32_bf16 v[212:215], a[136:139], a[100:103], v[212:215]
  ds_read_b64_tr_b16 a[164:165], v2 offset:7328
  v_exp_f32 v25, v25
  v_mul_f32 v29, v13, v103
  v_mfma_f32_16x16x32_bf16 v[212:215], a[140:143], a[116:119], v[212:215]
  v_exp_f32 v26, v26
  v_fma_f32 v22, v22, v11, v11
  v_mfma_f32_16x16x32_bf16 v[208:211], a[140:143], a[112:115], v[208:211]
  ds_read_b64_tr_b16 a[166:167], v2 offset:10912
  v_exp_f32 v27, v27
  v_fma_f32 v23, v23, v11, v11
  v_mfma_f32_16x16x32_bf16 v[208:211], a[136:139], a[96:99], v[208:211]
  s_waitcnt lgkmcnt(4)
  v_exp_f32 v28, v28
  v_fma_f32 v24, v24, v11, v11
  v_mfma_f32_16x16x32_bf16 v[112:115], a[144:147], a[32:35], v[112:115]
  ds_read_b64_tr_b16 a[168:169], v2 offset:14496
  v_exp_f32 v29, v29
  v_fma_f32 v25, v25, v11, v11
  v_mfma_f32_16x16x32_bf16 v[112:115], a[148:151], a[48:51], v[112:115]
  v_rcp_f32 v22, v22
  v_fma_f32 v26, v26, v14, v14
  v_mfma_f32_16x16x32_bf16 v[116:119], a[148:151], a[52:55], v[116:119]
  ds_read_b64_tr_b16 a[170:171], v2 offset:18080
  v_rcp_f32 v23, v23
  v_fma_f32 v27, v27, v14, v14
  v_mfma_f32_16x16x32_bf16 v[116:119], a[144:147], a[36:39], v[116:119]
  v_rcp_f32 v24, v24
  v_fma_f32 v28, v28, v14, v14
  v_mfma_f32_16x16x32_bf16 v[120:123], a[144:147], a[40:43], v[120:123]
  ds_read_b64_tr_b16 a[172:173], v2 offset:21664
  v_rcp_f32 v25, v25
  v_fma_f32 v29, v29, v14, v14
  v_mfma_f32_16x16x32_bf16 v[120:123], a[148:151], a[56:59], v[120:123]
  v_rcp_f32 v26, v26
  v_mul_f32 v208, v96, v208
  v_mfma_f32_16x16x32_bf16 v[124:127], a[148:151], a[60:63], v[124:127]
  ds_read_b64_tr_b16 a[174:175], v2 offset:25248
  v_rcp_f32 v27, v27
  v_mul_f32 v209, v97, v209
  v_mfma_f32_16x16x32_bf16 v[124:127], a[144:147], a[44:47], v[124:127]
  s_waitcnt lgkmcnt(11)
  v_rcp_f32 v28, v28
  v_mul_f32 v210, v98, v210
  v_mfma_f32_16x16x32_bf16 v[112:115], a[16:19], a[0:3], v[112:115]
  ds_read_b64_tr_b16 a[128:129], v2 offset:28832
  v_rcp_f32 v29, v29
  v_mul_f32 v211, v99, v211
  v_mfma_f32_16x16x32_bf16 v[116:119], a[16:19], a[4:7], v[116:119]
  v_mul_f32 v208, v208, v22
  v_mul_f32 v209, v209, v23
  v_mul_f32 v210, v210, v24
  v_mul_f32 v211, v211, v25
  v_mfma_f32_16x16x32_bf16 v[120:123], a[16:19], a[8:11], v[120:123]
  ds_read_b64_tr_b16 a[130:131], v2 offset:32416
  v_mul_f32 v22, v16, v104
  v_mul_f32 v23, v16, v105
  v_mul_f32 v24, v16, v106
  v_mfma_f32_16x16x32_bf16 v[124:127], a[16:19], a[12:15], v[124:127]
  v_mul_f32 v25, v16, v107
  v_exp_f32 v22, v22
  v_mul_f32 v212, v100, v212
  v_mfma_f32_16x16x32_bf16 v[224:227], a[20:23], a[0:3], v[224:227]
  ds_read_b64_tr_b16 a[132:133], v2 offset:36000
  v_exp_f32 v23, v23
  v_mul_f32 v213, v101, v213
  v_mfma_f32_16x16x32_bf16 v[228:231], a[20:23], a[4:7], v[228:231]
  v_exp_f32 v24, v24
  v_mul_f32 v214, v102, v214
  v_mfma_f32_16x16x32_bf16 v[232:235], a[20:23], a[8:11], v[232:235]
  ds_read_b64_tr_b16 a[134:135], v2 offset:39584
  v_exp_f32 v25, v25
  v_mul_f32 v215, v103, v215
  v_mfma_f32_16x16x32_bf16 v[236:239], a[20:23], a[12:15], v[236:239]
  v_mul_f32 v212, v212, v26
  v_mul_f32 v213, v213, v27
  v_mul_f32 v214, v214, v28
  v_mul_f32 v215, v215, v29
  v_mfma_f32_16x16x32_bf16 v[236:239], a[152:155], a[44:47], v[236:239]
  ds_read_b64_tr_b16 a[136:137], v2 offset:43168
  v_cvt_pk_bf16_f32 v96, v208, v209
  v_cvt_pk_bf16_f32 v97, v210, v211
  v_mul_f32 v26, v19, v108
  v_mfma_f32_16x16x32_bf16 v[236:239], a[156:159], a[60:63], v[236:239]
  v_mul_f32 v27, v19, v109
  v_mul_f32 v28, v19, v110
  v_mul_f32 v29, v19, v111
  v_mfma_f32_16x16x32_bf16 v[232:235], a[156:159], a[56:59], v[232:235]
  ds_read_b64_tr_b16 a[138:139], v2 offset:46752
  v_exp_f32 v26, v26
  v_fma_f32 v22, v22, v17, v17
  v_mfma_f32_16x16x32_bf16 v[232:235], a[152:155], a[40:43], v[232:235]
  v_exp_f32 v27, v27
  v_fma_f32 v23, v23, v17, v17
  v_mfma_f32_16x16x32_bf16 v[228:231], a[152:155], a[36:39], v[228:231]
  ds_read_b64_tr_b16 a[140:141], v2 offset:50336
  v_exp_f32 v28, v28
  v_fma_f32 v24, v24, v17, v17
  v_mfma_f32_16x16x32_bf16 v[228:231], a[156:159], a[52:55], v[228:231]
  v_exp_f32 v29, v29
  v_fma_f32 v25, v25, v17, v17
  v_cvt_pk_bf16_f32 v100, v212, v213
  v_mfma_f32_16x16x32_bf16 v[224:227], a[156:159], a[48:51], v[224:227]
  s_waitcnt vmcnt(0)
  v_cmp_ne_u32 vcc, 1, v139
  s_nop 4
  s_cbranch_vccnz CK6s
CK6x:
  v_mfma_f32_16x16x32_bf16 v[224:227], a[152:155], a[32:35], v[224:227]
  s_waitcnt lgkmcnt(7)
  s_lshl_b32 s51, s70, 11
  s_mov_b32 s91, 5439488
  ds_read_b64_tr_b16 a[142:143], v2 offset:53920
  v_cvt_pk_bf16_f32 v101, v214, v215
  v_mfma_f32_16x16x32_bf16 v[112:115], a[160:163], a[64:67], v[112:115]
  buffer_load_dwordx4 a[216:219], v137, s[36:39], s51 offen offset:0 sc1
  v_rcp_f32 v22, v22
  v_fma_f32 v26, v26, v20, v20
  v_mfma_f32_16x16x32_bf16 v[112:115], a[164:167], a[80:83], v[112:115]
  v_rcp_f32 v23, v23
  v_fma_f32 v27, v27, v20, v20
  v_mfma_f32_16x16x32_bf16 v[116:119], a[164:167], a[84:87], v[116:119]
  buffer_load_dwordx4 a[220:223], v137, s[36:39], s51 offen offset:1024 sc1
  v_rcp_f32 v24, v24
  v_fma_f32 v28, v28, v20, v20
  v_mfma_f32_16x16x32_bf16 v[116:119], a[160:163], a[68:71], v[116:119]
  v_rcp_f32 v25, v25
  v_fma_f32 v29, v29, v20, v20
  v_mfma_f32_16x16x32_bf16 v[120:123], a[160:163], a[72:75], v[120:123]
  buffer_load_dwordx4 a[224:227], v137, s[36:39], s51 offen offset:2048 sc1
  v_rcp_f32 v26, v26
  v_mul_f32 v216, v104, v216
  v_mfma_f32_16x16x32_bf16 v[120:123], a[164:167], a[88:91], v[120:123]
  v_rcp_f32 v27, v27
  v_mul_f32 v217, v105, v217
  v_mfma_f32_16x16x32_bf16 v[124:127], a[164:167], a[92:95], v[124:127]
  buffer_load_dwordx4 a[228:231], v137, s[36:39], s51 offen offset:3072 sc1
  s_lshl_b32 s51, s74, 11
  v_rcp_f32 v28, v28
  v_mfma_f32_16x16x32_bf16 v[124:127], a[160:163], a[76:79], v[124:127]
  s_waitcnt vmcnt(22)
  s_barrier
  v_mul_f32 v218, v106, v218
  v_rcp_f32 v29, v29
  v_mfma_f32_16x16x32_bf16 v[236:239], a[168:171], a[76:79], v[236:239]
  buffer_load_dwordx4 a[0:3], v137, s[36:39], s51 offen offset:0 sc1
  v_mul_f32 v219, v107, v219
  v_mul_f32 v216, v216, v22
  v_mul_f32 v217, v217, v23
  v_mfma_f32_16x16x32_bf16 v[236:239], a[172:175], a[92:95], v[236:239]
  v_mul_f32 v218, v218, v24
  v_mul_f32 v219, v219, v25
  v_mul_f32 v220, v108, v220
  v_mul_f32 v221, v109, v221
  v_mfma_f32_16x16x32_bf16 v[232:235], a[172:175], a[88:91], v[232:235]
  buffer_load_dwordx4 a[4:7], v137, s[36:39], s51 offen offset:1024 sc1
  v_mul_f32 v222, v110, v222
  v_mul_f32 v223, v111, v223
  v_cvt_pk_bf16_f32 v104, v216, v217
  v_mfma_f32_16x16x32_bf16 v[232:235], a[168:171], a[72:75], v[232:235]
  v_cvt_pk_bf16_f32 v105, v218, v219
  v_mul_f32 v220, v220, v26
  v_mul_f32 v221, v221, v27
  v_mul_f32 v222, v222, v28
  v_mfma_f32_16x16x32_bf16 v[228:231], a[168:171], a[68:71], v[228:231]
  buffer_load_dwordx4 a[8:11], v137, s[36:39], s51 offen offset:2048 sc1
  v_mul_f32 v223, v223, v29
  v_cvt_pk_bf16_f32 v108, v220, v221
  v_cvt_pk_bf16_f32 v109, v222, v223
  v_mfma_f32_16x16x32_bf16 v[228:231], a[172:175], a[84:87], v[228:231]
  v_mfma_f32_16x16x32_bf16 v[224:227], a[172:175], a[80:83], v[224:227]
  buffer_load_dwordx4 a[12:15], v137, s[36:39], s51 offen offset:3072 sc1
  s_lshl_b32 s51, s75, 11
  v_mfma_f32_16x16x32_bf16 v[224:227], a[168:171], a[64:67], v[224:227]
  s_waitcnt lgkmcnt(0)
  v_mfma_f32_16x16x32_bf16 v[112:115], a[128:131], a[96:99], v[112:115]
  s_barrier
  buffer_load_dwordx4 a[16:19], v137, s[36:39], s51 offen offset:0 sc1
  ds_read_b64_tr_b16 a[176:177], v244 offset:49152
  v_mfma_f32_16x16x32_bf16 v[112:115], a[132:135], a[112:115], v[112:115]
  ds_read_b64_tr_b16 a[178:179], v244 offset:53248
  v_mfma_f32_16x16x32_bf16 v[116:119], a[132:135], a[116:119], v[116:119]
  buffer_load_dwordx4 a[20:23], v137, s[36:39], s51 offen offset:1024 sc1
  ds_read_b64_tr_b16 a[180:181], v244 offset:57344
  v_mfma_f32_16x16x32_bf16 v[116:119], a[128:131], a[100:103], v[116:119]
  ds_read_b64_tr_b16 a[182:183], v244 offset:61440
  v_mfma_f32_16x16x32_bf16 v[120:123], a[128:131], a[104:107], v[120:123]
  buffer_load_dwordx4 a[24:27], v137, s[36:39], s51 offen offset:2048 sc1
  ds_read_b64_tr_b16 a[184:185], v245 offset:49152
  v_mfma_f32_16x16x32_bf16 v[120:123], a[132:135], a[120:123], v[120:123]
  ds_read_b64_tr_b16 a[186:187], v245 offset:53248
  v_mfma_f32_16x16x32_bf16 v[124:127], a[132:135], a[124:127], v[124:127]
  buffer_load_dwordx4 a[28:31], v137, s[36:39], s51 offen offset:3072 sc1
  s_cmp_eq_u32 s83, 3
  s_cselect_b32 s76, 52, 24
  s_lshl_b32 s50, s76, 16
  v_mfma_f32_16x16x32_bf16 v[124:127], a[128:131], a[108:111], v[124:127]
  s_add_u32 m0, s73, 16384
  ds_read_b64_tr_b16 a[188:189], v245 offset:57344
  ds_read_b64_tr_b16 a[190:191], v245 offset:61440
  v_mfma_f32_16x16x32_bf16 v[236:239], a[136:139], a[108:111], v[236:239]
  ds_read_b64_tr_b16 a[192:193], v246 offset:49152
  v_mul_f32 v22, v10, v112
  v_mul_f32 v23, v10, v113
  v_mul_f32 v24, v10, v114
  v_mfma_f32_16x16x32_bf16 v[236:239], a[140:143], a[124:127], v[236:239]
  ds_read_b64_tr_b16 a[194:195], v246 offset:53248
  v_mul_f32 v25, v10, v115
  v_exp_f32 v22, v22
  v_mfma_f32_16x16x32_bf16 v[232:235], a[140:143], a[120:123], v[232:235]
  buffer_load_dwordx4 v133, s[24:27], s50 offen offset:0 lds
  ds_read_b64_tr_b16 a[196:197], v246 offset:57344
  v_mul_f32 v26, v13, v116
  v_mfma_f32_16x16x32_bf16 v[232:235], a[136:139], a[104:107], v[232:235]
  ds_read_b64_tr_b16 a[198:199], v246 offset:61440
  v_exp_f32 v23, v23
  v_mul_f32 v27, v13, v117
  v_mfma_f32_16x16x32_bf16 v[228:231], a[136:139], a[100:103], v[228:231]
  s_lshl_b32 s51, s76, 11
  ds_read_b64_tr_b16 a[200:201], v247 offset:49152
  v_exp_f32 v24, v24
  v_mul_f32 v28, v13, v118
  v_mfma_f32_16x16x32_bf16 v[228:231], a[140:143], a[116:119], v[228:231]
  ds_read_b64_tr_b16 a[202:203], v247 offset:53248
  v_exp_f32 v25, v25
  v_mul_f32 v29, v13, v119
  v_mfma_f32_16x16x32_bf16 v[224:227], a[140:143], a[112:115], v[224:227]
  ds_read_b64_tr_b16 a[204:205], v247 offset:57344
  v_exp_f32 v26, v26
  v_fma_f32 v22, v22, v11, v11
  v_mfma_f32_16x16x32_bf16 v[224:227], a[136:139], a[96:99], v[224:227]
  s_waitcnt vmcnt(9) lgkmcnt(11)
  ds_read_b64_tr_b16 a[206:207], v247 offset:61440
  v_exp_f32 v27, v27
  v_fma_f32 v23, v23, v11, v11
  v_mfma_f32_16x16x32_bf16 v[32:35], a[176:179], a[216:219], 0
  buffer_load_dwordx4 a[32:35], v137, s[36:39], s51 offen offset:0 sc1
  ds_read_b64_tr_b16 a[208:209], v244 offset:51200
  v_exp_f32 v28, v28
  v_mfma_f32_16x16x32_bf16 v[32:35], a[180:183], a[224:227], v[32:35]
  ds_read_b64_tr_b16 a[210:211], v244 offset:55296
  v_fma_f32 v24, v24, v11, v11
  v_exp_f32 v29, v29
  v_mfma_f32_16x16x32_bf16 v[36:39], a[180:183], a[228:231], 0
  buffer_load_dwordx4 v134, s[24:27], s50 offen offset:1024 lds
  ds_read_b64_tr_b16 a[212:213], v244 offset:59392
  v_fma_f32 v25, v25, v11, v11
  v_mfma_f32_16x16x32_bf16 v[36:39], a[176:179], a[220:223], v[36:39]
  s_waitcnt lgkmcnt(11)
  ds_read_b64_tr_b16 a[214:215], v244 offset:63488
  v_rcp_f32 v22, v22
  v_fma_f32 v26, v26, v14, v14
  v_mfma_f32_16x16x32_bf16 v[44:47], a[184:187], a[220:223], 0
  ds_read_b64_tr_b16 a[176:177], v245 offset:51200
  v_rcp_f32 v23, v23
  v_fma_f32 v27, v27, v14, v14
  v_mfma_f32_16x16x32_bf16 v[44:47], a[188:191], a[228:231], v[44:47]
  buffer_load_dwordx4 a[36:39], v137, s[36:39], s51 offen offset:1024 sc1
  ds_read_b64_tr_b16 a[178:179], v245 offset:55296
  v_rcp_f32 v24, v24
  v_mfma_f32_16x16x32_bf16 v[40:43], a[188:191], a[224:227], 0
  ds_read_b64_tr_b16 a[180:181], v245 offset:59392
  v_fma_f32 v28, v28, v14, v14
  v_rcp_f32 v25, v25
  v_mfma_f32_16x16x32_bf16 v[40:43], a[184:187], a[216:219], v[40:43]
  s_waitcnt vmcnt(30) lgkmcnt(11)
  s_barrier
  ds_read_b64_tr_b16 a[182:183], v245 offset:63488
  v_fma_f32 v29, v29, v14, v14
  v_mfma_f32_16x16x32_bf16 v[48:51], a[192:195], a[216:219], 0
  ds_read_b64_tr_b16 a[184:185], v246 offset:51200
  v_rcp_f32 v26, v26
  v_mul_f32 v224, v112, v224
  v_mfma_f32_16x16x32_bf16 v[48:51], a[196:199], a[224:227], v[48:51]
  buffer_load_dwordx4 v135, s[24:27], s50 offen offset:2048 lds
  ds_read_b64_tr_b16 a[186:187], v246 offset:55296
  v_rcp_f32 v27, v27
  v_mfma_f32_16x16x32_bf16 v[52:55], a[196:199], a[228:231], 0
  ds_read_b64_tr_b16 a[188:189], v246 offset:59392
  v_mul_f32 v225, v113, v225
  v_rcp_f32 v28, v28
  v_mfma_f32_16x16x32_bf16 v[52:55], a[192:195], a[220:223], v[52:55]
  s_waitcnt lgkmcnt(11)
  ds_read_b64_tr_b16 a[190:191], v246 offset:63488
  v_mul_f32 v226, v114, v226
  v_rcp_f32 v29, v29
  v_mfma_f32_16x16x32_bf16 v[60:63], a[200:203], a[220:223], 0
  ds_read_b64_tr_b16 a[192:193], v247 offset:51200
  v_mul_f32 v227, v115, v227
  v_mul_f32 v224, v224, v22
  v_mul_f32 v225, v225, v23
  v_mfma_f32_16x16x32_bf16 v[60:63], a[204:207], a[228:231], v[60:63]
  buffer_load_dwordx4 a[40:43], v137, s[36:39], s51 offen offset:2048 sc1
  ds_read_b64_tr_b16 a[194:195], v247 offset:55296
  v_mul_f32 v226, v226, v24
  v_mul_f32 v227, v227, v25
  v_mfma_f32_16x16x32_bf16 v[56:59], a[204:207], a[224:227], 0
  ds_read_b64_tr_b16 a[196:197], v247 offset:59392
  v_mul_f32 v22, v16, v120
  v_mul_f32 v23, v16, v121
  v_mul_f32 v24, v16, v122
  v_mfma_f32_16x16x32_bf16 v[56:59], a[200:203], a[216:219], v[56:59]
  s_waitcnt lgkmcnt(11)
  ds_read_b64_tr_b16 a[198:199], v247 offset:63488
  v_mul_f32 v25, v16, v123
  v_exp_f32 v22, v22
  v_mfma_f32_16x16x32_bf16 v[144:147], a[208:211], a[216:219], 0
  buffer_load_dwordx4 v136, s[24:27], s50 offen offset:3072 lds
  ds_read_b64_tr_b16 a[200:201], v248 offset:0
  v_mul_f32 v228, v116, v228
  v_mfma_f32_16x16x32_bf16 v[144:147], a[212:215], a[224:227], v[144:147]
  ds_read_b64_tr_b16 a[202:203], v248 offset:4096
  v_exp_f32 v23, v23
  v_mul_f32 v229, v117, v229
  v_mfma_f32_16x16x32_bf16 v[148:151], a[212:215], a[228:231], 0
Hb2_2:
  s_cbranch_execz Hb2_3
  ds_read_b64_tr_b16 a[204:205], v248 offset:8192
  v_exp_f32 v24, v24
  v_mul_f32 v230, v118, v230
  v_mfma_f32_16x16x32_bf16 v[148:151], a[208:211], a[220:223], v[148:151]
  s_waitcnt lgkmcnt(11)
  ds_read_b64_tr_b16 a[206:207], v248 offset:12288
  v_exp_f32 v25, v25
  v_mul_f32 v231, v119, v231
  v_mfma_f32_16x16x32_bf16 v[156:159], a[176:179], a[220:223], 0
  buffer_load_dwordx4 a[44:47], v137, s[36:39], s51 offen offset:3072 sc1
  s_mov_b32 s77, 31
  s_lshl_b32 s50, s77, 16
  s_add_u32 m0, s73, 32768
  v_mfma_f32_16x16x32_bf16 v[156:159], a[180:183], a[228:231], v[156:159]
  ds_read_b64_tr_b16 a[208:209], v249 offset:0
  ds_read_b64_tr_b16 a[210:211], v249 offset:4096
  v_mul_f32 v228, v228, v26
  v_mul_f32 v229, v229, v27
  v_mfma_f32_16x16x32_bf16 v[152:155], a[180:183], a[224:227], 0
  ds_read_b64_tr_b16 a[212:213], v249 offset:8192
  v_mul_f32 v230, v230, v28
  v_mul_f32 v231, v231, v29
  v_cvt_pk_bf16_f32 v98, v224, v225
  v_mfma_f32_16x16x32_bf16 v[152:155], a[176:179], a[216:219], v[152:155]
  s_waitcnt lgkmcnt(11)
  ds_read_b64_tr_b16 a[214:215], v249 offset:12288
  v_cvt_pk_bf16_f32 v99, v226, v227
  v_mfma_f32_16x16x32_bf16 v[160:163], a[184:187], a[216:219], 0
  buffer_load_dwordx4 v133, s[24:27], s50 offen offset:0 lds
  s_lshl_b32 s51, s77, 11
  ds_read_b64_tr_b16 a[176:177], v250 offset:0
  v_mfma_f32_16x16x32_bf16 v[160:163], a[188:191], a[224:227], v[160:163]
  ds_read_b64_tr_b16 a[178:179], v250 offset:4096
  v_mfma_f32_16x16x32_bf16 v[164:167], a[188:191], a[228:231], 0
  ds_read_b64_tr_b16 a[180:181], v250 offset:8192
  buffer_store_dwordx4 v[96:99], v0, s[36:39], s64 offen offset:0 sc1
  v_mul_f32 v26, v19, v124
  v_mul_f32 v27, v19, v125
  v_mfma_f32_16x16x32_bf16 v[164:167], a[184:187], a[220:223], v[164:167]
  s_waitcnt lgkmcnt(11)
  ds_read_b64_tr_b16 a[182:183], v250 offset:12288
  v_mul_f32 v28, v19, v126
  v_mul_f32 v29, v19, v127
  v_mfma_f32_16x16x32_bf16 v[172:175], a[192:195], a[220:223], 0
  buffer_load_dwordx4 a[48:51], v137, s[36:39], s51 offen offset:0 sc1
  ds_read_b64_tr_b16 a[184:185], v251 offset:0
  v_exp_f32 v26, v26
  v_mfma_f32_16x16x32_bf16 v[172:175], a[196:199], a[228:231], v[172:175]
  ds_read_b64_tr_b16 a[186:187], v251 offset:4096
  v_fma_f32 v22, v22, v17, v17
  v_exp_f32 v27, v27
  v_mfma_f32_16x16x32_bf16 v[168:171], a[196:199], a[224:227], 0
  ds_read_b64_tr_b16 a[188:189], v251 offset:8192
  v_fma_f32 v23, v23, v17, v17
  v_exp_f32 v28, v28
  v_mfma_f32_16x16x32_bf16 v[168:171], a[192:195], a[216:219], v[168:171]
  s_waitcnt vmcnt(15) lgkmcnt(11)
  ds_read_b64_tr_b16 a[190:191], v251 offset:12288
  v_fma_f32 v24, v24, v17, v17
  v_exp_f32 v29, v29
  v_mfma_f32_16x16x32_bf16 v[32:35], a[200:203], a[0:3], v[32:35]
  buffer_load_dwordx4 v134, s[24:27], s50 offen offset:1024 lds
  ds_read_b64_tr_b16 a[192:193], v248 offset:2048
  v_fma_f32 v25, v25, v17, v17
  v_cvt_pk_bf16_f32 v102, v228, v229
  v_mfma_f32_16x16x32_bf16 v[32:35], a[204:207], a[8:11], v[32:35]
  ds_read_b64_tr_b16 a[194:195], v248 offset:6144
  v_cvt_pk_bf16_f32 v103, v230, v231
  v_mfma_f32_16x16x32_bf16 v[36:39], a[204:207], a[12:15], v[36:39]
  ds_read_b64_tr_b16 a[196:197], v248 offset:10240
  buffer_store_dwordx4 v[100:103], v0, s[36:39], s64 offen offset:1024 sc1
  v_rcp_f32 v22, v22
  v_mfma_f32_16x16x32_bf16 v[36:39], a[200:203], a[4:7], v[36:39]
  s_waitcnt lgkmcnt(11)
  ds_read_b64_tr_b16 a[198:199], v248 offset:14336
  v_fma_f32 v26, v26, v20, v20
  v_rcp_f32 v23, v23
  v_mfma_f32_16x16x32_bf16 v[44:47], a[208:211], a[4:7], v[44:47]
  buffer_load_dwordx4 a[52:55], v137, s[36:39], s51 offen offset:1024 sc1
  ds_read_b64_tr_b16 a[200:201], v249 offset:2048
  v_fma_f32 v27, v27, v20, v20
  v_mfma_f32_16x16x32_bf16 v[44:47], a[212:215], a[12:15], v[44:47]
  ds_read_b64_tr_b16 a[202:203], v249 offset:6144
  v_rcp_f32 v24, v24
  v_fma_f32 v28, v28, v20, v20
  v_mfma_f32_16x16x32_bf16 v[40:43], a[212:215], a[8:11], v[40:43]
  ds_read_b64_tr_b16 a[204:205], v249 offset:10240
  v_rcp_f32 v25, v25
  v_fma_f32 v29, v29, v20, v20
  v_mfma_f32_16x16x32_bf16 v[40:43], a[208:211], a[0:3], v[40:43]
  s_waitcnt vmcnt(34) lgkmcnt(11)
  s_barrier
  buffer_load_dwordx4 v135, s[24:27], s50 offen offset:2048 lds
  ds_read_b64_tr_b16 a[206:207], v249 offset:14336
  v_mfma_f32_16x16x32_bf16 v[48:51], a[176:179], a[0:3], v[48:51]
  ds_read_b64_tr_b16 a[208:209], v250 offset:2048
  v_rcp_f32 v26, v26
  v_mul_f32 v232, v120, v232
  v_mfma_f32_16x16x32_bf16 v[48:51], a[180:183], a[8:11], v[48:51]
  ds_read_b64_tr_b16 a[210:211], v250 offset:6144
  v_rcp_f32 v27, v27
  v_mul_f32 v233, v121, v233
  v_mfma_f32_16x16x32_bf16 v[52:55], a[180:183], a[12:15], v[52:55]
  ds_read_b64_tr_b16 a[212:213], v250 offset:10240
  v_rcp_f32 v28, v28
  v_mul_f32 v234, v122, v234
  v_mfma_f32_16x16x32_bf16 v[52:55], a[176:179], a[4:7], v[52:55]
  s_waitcnt lgkmcnt(11)
  buffer_load_dwordx4 a[56:59], v137, s[36:39], s51 offen offset:2048 sc1
  ds_read_b64_tr_b16 a[214:215], v250 offset:14336
  v_rcp_f32 v29, v29
  v_mfma_f32_16x16x32_bf16 v[60:63], a[184:187], a[4:7], v[60:63]
  ds_read_b64_tr_b16 a[176:177], v251 offset:2048
  v_mul_f32 v235, v123, v235
  v_mul_f32 v232, v232, v22
  v_mul_f32 v233, v233, v23
  v_mfma_f32_16x16x32_bf16 v[60:63], a[188:191], a[12:15], v[60:63]
  ds_read_b64_tr_b16 a[178:179], v251 offset:6144
  v_mul_f32 v234, v234, v24
  v_mul_f32 v235, v235, v25
  v_mul_f32 v236, v124, v236
  v_mfma_f32_16x16x32_bf16 v[56:59], a[188:191], a[8:11], v[56:59]
  ds_read_b64_tr_b16 a[180:181], v251 offset:10240
  v_mul_f32 v237, v125, v237
  v_mul_f32 v238, v126, v238
  v_mul_f32 v239, v127, v239
  v_mfma_f32_16x16x32_bf16 v[56:59], a[184:187], a[0:3], v[56:59]
  s_waitcnt lgkmcnt(11)
  buffer_load_dwordx4 v136, s[24:27], s50 offen offset:3072 lds
  ds_read_b64_tr_b16 a[182:183], v251 offset:14336
  v_cvt_pk_bf16_f32 v106, v232, v233
  v_cvt_pk_bf16_f32 v107, v234, v235
  v_mfma_f32_16x16x32_bf16 v[144:147], a[192:195], a[0:3], v[144:147]
  ds_read_b64_tr_b16 a[184:185], v240 offset:0
  v_mfma_f32_16x16x32_bf16 v[144:147], a[196:199], a[8:11], v[144:147]
  ds_read_b64_tr_b16 a[186:187], v240 offset:4096
  buffer_store_dwordx4 v[104:107], v0, s[36:39], s65 offen offset:0 sc1
  v_mul_f32 v236, v236, v26
  v_mul_f32 v237, v237, v27
  v_mfma_f32_16x16x32_bf16 v[148:151], a[196:199], a[12:15], v[148:151]
  ds_read_b64_tr_b16 a[188:189], v240 offset:8192
  v_mul_f32 v238, v238, v28
  v_mul_f32 v239, v239, v29
  v_cvt_pk_bf16_f32 v110, v236, v237
  v_mfma_f32_16x16x32_bf16 v[148:151], a[192:195], a[4:7], v[148:151]
  s_waitcnt lgkmcnt(11)
  buffer_load_dwordx4 a[60:63], v137, s[36:39], s51 offen offset:3072 sc1
  s_cmp_eq_u32 s83, 1
  s_cselect_b32 s78, 10, 38
  s_lshl_b32 s50, s78, 16
  v_mfma_f32_16x16x32_bf16 v[156:159], a[200:203], a[4:7], v[156:159]
  s_add_u32 m0, s73, 49152
  ds_read_b64_tr_b16 a[190:191], v240 offset:12288
  ds_read_b64_tr_b16 a[192:193], v241 offset:0
  v_cvt_pk_bf16_f32 v111, v238, v239
  v_mfma_f32_16x16x32_bf16 v[156:159], a[204:207], a[12:15], v[156:159]
  ds_read_b64_tr_b16 a[194:195], v241 offset:4096
  buffer_store_dwordx4 v[108:111], v0, s[36:39], s65 offen offset:1024 sc1
  v_mfma_f32_16x16x32_bf16 v[152:155], a[204:207], a[8:11], v[152:155]
  ds_read_b64_tr_b16 a[196:197], v241 offset:8192
  v_mfma_f32_16x16x32_bf16 v[152:155], a[200:203], a[0:3], v[152:155]
  s_waitcnt lgkmcnt(11)
  buffer_load_dwordx4 v133, s[24:27], s50 offen offset:0 lds
  s_lshl_b32 s51, s78, 11
  ds_read_b64_tr_b16 a[198:199], v241 offset:12288
  v_mfma_f32_16x16x32_bf16 v[160:163], a[208:211], a[0:3], v[160:163]
  ds_read_b64_tr_b16 a[200:201], v242 offset:0
  v_mfma_f32_16x16x32_bf16 v[160:163], a[212:215], a[8:11], v[160:163]
  ds_read_b64_tr_b16 a[202:203], v242 offset:4096
  v_mfma_f32_16x16x32_bf16 v[164:167], a[212:215], a[12:15], v[164:167]
  buffer_load_dwordx4 a[64:67], v137, s[36:39], s51 offen offset:0 sc1
  ds_read_b64_tr_b16 a[204:205], v242 offset:8192
  v_mfma_f32_16x16x32_bf16 v[164:167], a[208:211], a[4:7], v[164:167]
  s_waitcnt lgkmcnt(11)
  ds_read_b64_tr_b16 a[206:207], v242 offset:12288
  v_mfma_f32_16x16x32_bf16 v[172:175], a[176:179], a[4:7], v[172:175]
  ds_read_b64_tr_b16 a[208:209], v243 offset:0
  v_mfma_f32_16x16x32_bf16 v[172:175], a[180:183], a[12:15], v[172:175]
  ds_read_b64_tr_b16 a[210:211], v243 offset:4096
  v_mfma_f32_16x16x32_bf16 v[168:171], a[180:183], a[8:11], v[168:171]
  buffer_load_dwordx4 v134, s[24:27], s50 offen offset:1024 lds
  ds_read_b64_tr_b16 a[212:213], v243 offset:8192
  v_mfma_f32_16x16x32_bf16 v[168:171], a[176:179], a[0:3], v[168:171]
  s_waitcnt vmcnt(23) lgkmcnt(11)
  ds_read_b64_tr_b16 a[214:215], v243 offset:12288
  v_mfma_f32_16x16x32_bf16 v[32:35], a[184:187], a[16:19], v[32:35]
  ds_read_b64_tr_b16 a[176:177], v240 offset:2048
  v_mfma_f32_16x16x32_bf16 v[32:35], a[188:191], a[24:27], v[32:35]
  ds_read_b64_tr_b16 a[178:179], v240 offset:6144
  v_mfma_f32_16x16x32_bf16 v[36:39], a[188:191], a[28:31], v[36:39]
  buffer_load_dwordx4 a[68:71], v137, s[36:39], s51 offen offset:1024 sc1
  ds_read_b64_tr_b16 a[180:181], v240 offset:10240
  v_mfma_f32_16x16x32_bf16 v[36:39], a[184:187], a[20:23], v[36:39]
  s_waitcnt lgkmcnt(11)
  ds_read_b64_tr_b16 a[182:183], v240 offset:14336
  v_mfma_f32_16x16x32_bf16 v[44:47], a[192:195], a[20:23], v[44:47]
  ds_read_b64_tr_b16 a[184:185], v241 offset:2048
  v_mfma_f32_16x16x32_bf16 v[44:47], a[196:199], a[28:31], v[44:47]
  ds_read_b64_tr_b16 a[186:187], v241 offset:6144
  v_mfma_f32_16x16x32_bf16 v[40:43], a[196:199], a[24:27], v[40:43]
  buffer_load_dwordx4 v135, s[24:27], s50 offen offset:2048 lds
  ds_read_b64_tr_b16 a[188:189], v241 offset:10240
  v_mfma_f32_16x16x32_bf16 v[40:43], a[192:195], a[16:19], v[40:43]
  s_waitcnt vmcnt(18) lgkmcnt(11)
  s_barrier
  ds_read_b64_tr_b16 a[190:191], v241 offset:14336
  v_mfma_f32_16x16x32_bf16 v[48:51], a[200:203], a[16:19], v[48:51]
  ds_read_b64_tr_b16 a[192:193], v242 offset:2048
  v_mfma_f32_16x16x32_bf16 v[48:51], a[204:207], a[24:27], v[48:51]
  buffer_load_dwordx4 a[72:75], v137, s[36:39], s51 offen offset:2048 sc1
  ds_read_b64_tr_b16 a[194:195], v242 offset:6144
  v_mfma_f32_16x16x32_bf16 v[52:55], a[204:207], a[28:31], v[52:55]
  ds_read_b64_tr_b16 a[196:197], v242 offset:10240
  v_mfma_f32_16x16x32_bf16 v[52:55], a[200:203], a[20:23], v[52:55]
  s_waitcnt lgkmcnt(11)
  ds_read_b64_tr_b16 a[198:199], v242 offset:14336
  v_mfma_f32_16x16x32_bf16 v[60:63], a[208:211], a[20:23], v[60:63]
  ds_read_b64_tr_b16 a[200:201], v243 offset:2048
  v_mfma_f32_16x16x32_bf16 v[60:63], a[212:215], a[28:31], v[60:63]
  buffer_load_dwordx4 v136, s[24:27], s50 offen offset:3072 lds
  ds_read_b64_tr_b16 a[202:203], v243 offset:6144
  v_mfma_f32_16x16x32_bf16 v[56:59], a[212:215], a[24:27], v[56:59]
  ds_read_b64_tr_b16 a[204:205], v243 offset:10240
  v_mfma_f32_16x16x32_bf16 v[56:59], a[208:211], a[16:19], v[56:59]
  s_waitcnt lgkmcnt(11)
  ds_read_b64_tr_b16 a[206:207], v243 offset:14336
  v_mfma_f32_16x16x32_bf16 v[144:147], a[176:179], a[16:19], v[144:147]
  ds_read_b64_tr_b16 a[208:209], v240 offset:16384
  v_mfma_f32_16x16x32_bf16 v[144:147], a[180:183], a[24:27], v[144:147]
  buffer_load_dwordx4 a[76:79], v137, s[36:39], s51 offen offset:3072 sc1
  s_cmp_eq_u32 s83, 2
  v_mfma_f32_16x16x32_bf16 v[148:151], a[180:183], a[28:31], v[148:151]
  s_cselect_b32 s79, 17, 45
  s_lshl_b32 s50, s79, 16
  s_add_u32 m0, s73, 65536
  v_mfma_f32_16x16x32_bf16 v[148:151], a[176:179], a[20:23], v[148:151]
  s_waitcnt lgkmcnt(9)
  ds_read_b64_tr_b16 a[210:211], v240 offset:20480
  ds_read_b64_tr_b16 a[212:213], v240 offset:24576
  v_mfma_f32_16x16x32_bf16 v[156:159], a[184:187], a[20:23], v[156:159]
  ds_read_b64_tr_b16 a[214:215], v240 offset:28672
  ds_read_b64_tr_b16 a[176:177], v241 offset:16384
  v_mfma_f32_16x16x32_bf16 v[156:159], a[188:191], a[28:31], v[156:159]
  buffer_load_dwordx4 v133, s[24:27], s50 offen offset:0 lds
  s_lshl_b32 s51, s79, 11
  v_mfma_f32_16x16x32_bf16 v[152:155], a[188:191], a[24:27], v[152:155]
  ds_read_b64_tr_b16 a[178:179], v241 offset:20480
  ds_read_b64_tr_b16 a[180:181], v241 offset:24576
  v_mfma_f32_16x16x32_bf16 v[152:155], a[184:187], a[16:19], v[152:155]
  s_waitcnt lgkmcnt(11)
  ds_read_b64_tr_b16 a[182:183], v241 offset:28672
  v_mfma_f32_16x16x32_bf16 v[160:163], a[192:195], a[16:19], v[160:163]
  ds_read_b64_tr_b16 a[184:185], v242 offset:16384
  v_mfma_f32_16x16x32_bf16 v[160:163], a[196:199], a[24:27], v[160:163]
  buffer_load_dwordx4 a[80:83], v137, s[36:39], s51 offen offset:0 sc1
  ds_read_b64_tr_b16 a[186:187], v242 offset:20480
  v_mfma_f32_16x16x32_bf16 v[164:167], a[196:199], a[28:31], v[164:167]
  ds_read_b64_tr_b16 a[188:189], v242 offset:24576
  v_mfma_f32_16x16x32_bf16 v[164:167], a[192:195], a[20:23], v[164:167]
  s_waitcnt lgkmcnt(11)
  ds_read_b64_tr_b16 a[190:191], v242 offset:28672
  v_mfma_f32_16x16x32_bf16 v[172:175], a[200:203], a[20:23], v[172:175]
  buffer_load_dwordx4 v134, s[24:27], s50 offen offset:1024 lds
  ds_read_b64_tr_b16 a[192:193], v243 offset:16384
  v_mfma_f32_16x16x32_bf16 v[172:175], a[204:207], a[28:31], v[172:175]
  ds_read_b64_tr_b16 a[194:195], v243 offset:20480
  v_mfma_f32_16x16x32_bf16 v[168:171], a[204:207], a[24:27], v[168:171]
  ds_read_b64_tr_b16 a[196:197], v243 offset:24576
  v_mfma_f32_16x16x32_bf16 v[168:171], a[200:203], a[16:19], v[168:171]
  s_waitcnt vmcnt(23) lgkmcnt(11)
  ds_read_b64_tr_b16 a[198:199], v243 offset:28672
  v_mfma_f32_16x16x32_bf16 v[32:35], a[208:211], a[32:35], v[32:35]
  buffer_load_dwordx4 a[84:87], v137, s[36:39], s51 offen offset:1024 sc1
  ds_read_b64_tr_b16 a[200:201], v240 offset:18432
  v_mfma_f32_16x16x32_bf16 v[32:35], a[212:215], a[40:43], v[32:35]
  ds_read_b64_tr_b16 a[202:203], v240 offset:22528
  v_mfma_f32_16x16x32_bf16 v[36:39], a[212:215], a[44:47], v[36:39]
  ds_read_b64_tr_b16 a[204:205], v240 offset:26624
  v_mfma_f32_16x16x32_bf16 v[36:39], a[208:211], a[36:39], v[36:39]
  s_waitcnt lgkmcnt(11)
  ds_read_b64_tr_b16 a[206:207], v240 offset:30720
  v_mfma_f32_16x16x32_bf16 v[44:47], a[176:179], a[36:39], v[44:47]
  buffer_load_dwordx4 v135, s[24:27], s50 offen offset:2048 lds
  ds_read_b64_tr_b16 a[208:209], v241 offset:18432
  v_mfma_f32_16x16x32_bf16 v[44:47], a[180:183], a[44:47], v[44:47]
  ds_read_b64_tr_b16 a[210:211], v241 offset:22528
  v_mfma_f32_16x16x32_bf16 v[40:43], a[180:183], a[40:43], v[40:43]
  s_waitcnt vmcnt(13)
  ds_read_b64_tr_b16 a[212:213], v241 offset:26624
  v_mfma_f32_16x16x32_bf16 v[40:43], a[176:179], a[32:35], v[40:43]
  s_waitcnt vmcnt(16) lgkmcnt(11)
  s_barrier
  ds_read_b64_tr_b16 a[214:215], v241 offset:30720
  v_mfma_f32_16x16x32_bf16 v[48:51], a[184:187], a[32:35], v[48:51]
  s_mov_b64 exec, 1
  buffer_store_dword v254, v0, s[36:39], s45 offen sc1
  s_mov_b64 exec, -1
  v_mfma_f32_16x16x32_bf16 v[48:51], a[188:191], a[40:43], v[48:51]
  buffer_load_dwordx4 a[88:91], v137, s[36:39], s51 offen offset:2048 sc1
  ds_read_b64_tr_b16 a[176:177], v242 offset:18432
  v_mfma_f32_16x16x32_bf16 v[52:55], a[188:191], a[44:47], v[52:55]
  ds_read_b64_tr_b16 a[178:179], v242 offset:22528
  ds_read_b64_tr_b16 a[180:181], v242 offset:26624
  v_mfma_f32_16x16x32_bf16 v[52:55], a[184:187], a[36:39], v[52:55]
  s_waitcnt lgkmcnt(11)
  ds_read_b64_tr_b16 a[182:183], v242 offset:30720
  v_mfma_f32_16x16x32_bf16 v[60:63], a[192:195], a[36:39], v[60:63]
  buffer_load_dwordx4 v136, s[24:27], s50 offen offset:3072 lds
  ds_read_b64_tr_b16 a[184:185], v243 offset:18432
  v_mfma_f32_16x16x32_bf16 v[60:63], a[196:199], a[44:47], v[60:63]
  ds_read_b64_tr_b16 a[186:187], v243 offset:22528
  v_mfma_f32_16x16x32_bf16 v[56:59], a[196:199], a[40:43], v[56:59]
  ds_read_b64_tr_b16 a[188:189], v243 offset:26624
  v_mfma_f32_16x16x32_bf16 v[56:59], a[192:195], a[32:35], v[56:59]
  s_waitcnt lgkmcnt(11)
  buffer_load_dwordx4 a[92:95], v137, s[36:39], s51 offen offset:3072 sc1
  s_cmp_eq_u32 s83, 3
  v_mfma_f32_16x16x32_bf16 v[144:147], a[200:203], a[32:35], v[144:147]
  s_cselect_b32 s80, 24, 52
  s_lshl_b32 s50, s80, 16
  s_add_u32 m0, s73, 81920
  v_mfma_f32_16x16x32_bf16 v[144:147], a[204:207], a[40:43], v[144:147]
  ds_read_b64_tr_b16 a[190:191], v243 offset:30720
  ds_read_b64_tr_b16 a[192:193], v240 offset:32768
  v_mfma_f32_16x16x32_bf16 v[148:151], a[204:207], a[44:47], v[148:151]
  ds_read_b64_tr_b16 a[194:195], v240 offset:36864
  ds_read_b64_tr_b16 a[196:197], v240 offset:40960
  v_mfma_f32_16x16x32_bf16 v[148:151], a[200:203], a[36:39], v[148:151]
  s_waitcnt lgkmcnt(11)
  buffer_load_dwordx4 v133, s[24:27], s50 offen offset:0 lds
  s_lshl_b32 s51, s80, 11
  v_mfma_f32_16x16x32_bf16 v[156:159], a[208:211], a[36:39], v[156:159]
  ds_read_b64_tr_b16 a[198:199], v240 offset:45056
  ds_read_b64_tr_b16 a[200:201], v241 offset:32768
  v_mfma_f32_16x16x32_bf16 v[156:159], a[212:215], a[44:47], v[156:159]
  ds_read_b64_tr_b16 a[202:203], v241 offset:36864
  v_mfma_f32_16x16x32_bf16 v[152:155], a[212:215], a[40:43], v[152:155]
  ds_read_b64_tr_b16 a[204:205], v241 offset:40960
  v_mfma_f32_16x16x32_bf16 v[152:155], a[208:211], a[32:35], v[152:155]
  s_waitcnt lgkmcnt(11)
  buffer_load_dwordx4 a[96:99], v137, s[36:39], s51 offen offset:0 sc1
  ds_read_b64_tr_b16 a[206:207], v241 offset:45056
  v_mfma_f32_16x16x32_bf16 v[160:163], a[176:179], a[32:35], v[160:163]
  ds_read_b64_tr_b16 a[208:209], v242 offset:32768
  v_mfma_f32_16x16x32_bf16 v[160:163], a[180:183], a[40:43], v[160:163]
  ds_read_b64_tr_b16 a[210:211], v242 offset:36864
  v_mfma_f32_16x16x32_bf16 v[164:167], a[180:183], a[44:47], v[164:167]
  ds_read_b64_tr_b16 a[212:213], v242 offset:40960
  v_mfma_f32_16x16x32_bf16 v[164:167], a[176:179], a[36:39], v[164:167]
  s_waitcnt lgkmcnt(11)
  buffer_load_dwordx4 v134, s[24:27], s50 offen offset:1024 lds
  ds_read_b64_tr_b16 a[214:215], v242 offset:45056
  v_mfma_f32_16x16x32_bf16 v[172:175], a[184:187], a[36:39], v[172:175]
  ds_read_b64_tr_b16 a[176:177], v243 offset:32768
  v_mfma_f32_16x16x32_bf16 v[172:175], a[188:191], a[44:47], v[172:175]
  ds_read_b64_tr_b16 a[178:179], v243 offset:36864
  v_mfma_f32_16x16x32_bf16 v[168:171], a[188:191], a[40:43], v[168:171]
  ds_read_b64_tr_b16 a[180:181], v243 offset:40960
  v_mfma_f32_16x16x32_bf16 v[168:171], a[184:187], a[32:35], v[168:171]
  s_waitcnt vmcnt(21) lgkmcnt(11)
  buffer_load_dwordx4 a[100:103], v137, s[36:39], s51 offen offset:1024 sc1
  ds_read_b64_tr_b16 a[182:183], v243 offset:45056
  v_mfma_f32_16x16x32_bf16 v[32:35], a[192:195], a[48:51], v[32:35]
  ds_read_b64_tr_b16 a[184:185], v240 offset:34816
  v_mfma_f32_16x16x32_bf16 v[32:35], a[196:199], a[56:59], v[32:35]
  ds_read_b64_tr_b16 a[186:187], v240 offset:38912
  v_mfma_f32_16x16x32_bf16 v[36:39], a[196:199], a[60:63], v[36:39]
  buffer_load_dwordx4 v135, s[24:27], s50 offen offset:2048 lds
  ds_read_b64_tr_b16 a[188:189], v240 offset:43008
  v_mfma_f32_16x16x32_bf16 v[36:39], a[192:195], a[52:55], v[36:39]
  s_waitcnt lgkmcnt(11)
  ds_read_b64_tr_b16 a[190:191], v240 offset:47104
  v_mfma_f32_16x16x32_bf16 v[44:47], a[200:203], a[52:55], v[44:47]
  ds_read_b64_tr_b16 a[192:193], v241 offset:34816
  v_mfma_f32_16x16x32_bf16 v[44:47], a[204:207], a[60:63], v[44:47]
  ds_read_b64_tr_b16 a[194:195], v241 offset:38912
  v_mfma_f32_16x16x32_bf16 v[40:43], a[204:207], a[56:59], v[40:43]
  buffer_load_dwordx4 a[104:107], v137, s[36:39], s51 offen offset:2048 sc1
  ds_read_b64_tr_b16 a[196:197], v241 offset:43008
  v_mfma_f32_16x16x32_bf16 v[40:43], a[200:203], a[48:51], v[40:43]
  s_waitcnt vmcnt(16) lgkmcnt(11)
  s_barrier
  ds_read_b64_tr_b16 a[198:199], v241 offset:47104
  v_mfma_f32_16x16x32_bf16 v[48:51], a[208:211], a[48:51], v[48:51]
  ds_read_b64_tr_b16 a[200:201], v242 offset:34816
  v_mfma_f32_16x16x32_bf16 v[48:51], a[212:215], a[56:59], v[48:51]
  ds_read_b64_tr_b16 a[202:203], v242 offset:38912
  v_mfma_f32_16x16x32_bf16 v[52:55], a[212:215], a[60:63], v[52:55]
  buffer_load_dwordx4 v136, s[24:27], s50 offen offset:3072 lds
  ds_read_b64_tr_b16 a[204:205], v242 offset:43008
  v_mfma_f32_16x16x32_bf16 v[52:55], a[208:211], a[52:55], v[52:55]
  s_waitcnt lgkmcnt(11)
  ds_read_b64_tr_b16 a[206:207], v242 offset:47104
  v_mfma_f32_16x16x32_bf16 v[60:63], a[176:179], a[52:55], v[60:63]
  ds_read_b64_tr_b16 a[208:209], v243 offset:34816
  v_mfma_f32_16x16x32_bf16 v[60:63], a[180:183], a[60:63], v[60:63]
  ds_read_b64_tr_b16 a[210:211], v243 offset:38912
  v_mfma_f32_16x16x32_bf16 v[56:59], a[180:183], a[56:59], v[56:59]
  buffer_load_dwordx4 a[108:111], v137, s[36:39], s51 offen offset:3072 sc1
  s_add_u32 s81, s83, 8
  v_mfma_f32_16x16x32_bf16 v[56:59], a[176:179], a[48:51], v[56:59]
  s_waitcnt lgkmcnt(10)
  s_and_b32 s81, s81, 3
  s_mul_i32 s81, s81, 14
  v_mfma_f32_16x16x32_bf16 v[144:147], a[184:187], a[48:51], v[144:147]
  s_lshl_b32 s50, s81, 16
  s_add_u32 s50, s50, s84
  s_add_u32 m0, s73, 98304
  v_mfma_f32_16x16x32_bf16 v[144:147], a[188:191], a[56:59], v[144:147]
  ds_read_b64_tr_b16 a[212:213], v243 offset:43008
  ds_read_b64_tr_b16 a[214:215], v243 offset:47104
  v_mfma_f32_16x16x32_bf16 v[148:151], a[188:191], a[60:63], v[148:151]
  ds_read_b64_tr_b16 a[176:177], v240 offset:49152
  ds_read_b64_tr_b16 a[178:179], v240 offset:53248
  v_mfma_f32_16x16x32_bf16 v[148:151], a[184:187], a[52:55], v[148:151]
  s_waitcnt lgkmcnt(10)
  buffer_load_dwordx4 v133, s[24:27], s50 offen offset:0 lds
  s_lshl_b32 s51, s81, 11
  v_mfma_f32_16x16x32_bf16 v[156:159], a[192:195], a[52:55], v[156:159]
  ds_read_b64_tr_b16 a[180:181], v240 offset:57344
  ds_read_b64_tr_b16 a[182:183], v240 offset:61440
  v_mfma_f32_16x16x32_bf16 v[156:159], a[196:199], a[60:63], v[156:159]
  ds_read_b64_tr_b16 a[184:185], v241 offset:49152
  ds_read_b64_tr_b16 a[186:187], v241 offset:53248
  v_mfma_f32_16x16x32_bf16 v[152:155], a[196:199], a[56:59], v[152:155]
  s_add_u32 s67, s73, 16384
  buffer_load_dwordx4 a[112:115], v137, s[36:39], s51 offen offset:0 sc1
  ds_read_b64_tr_b16 a[188:189], v241 offset:57344
  v_mfma_f32_16x16x32_bf16 v[152:155], a[192:195], a[48:51], v[152:155]
  s_waitcnt lgkmcnt(11)
  ds_read_b64_tr_b16 a[190:191], v241 offset:61440
  v_and_b32 v129, 15, v128
  v_mfma_f32_16x16x32_bf16 v[160:163], a[200:203], a[48:51], v[160:163]
  ds_read_b64_tr_b16 a[192:193], v242 offset:49152
  v_lshrrev_b32 v131, 1, v129
  v_mfma_f32_16x16x32_bf16 v[160:163], a[204:207], a[56:59], v[160:163]
  buffer_load_dwordx4 v134, s[24:27], s50 offen offset:1024 lds
  ds_read_b64_tr_b16 a[194:195], v242 offset:53248
  v_mfma_f32_16x16x32_bf16 v[164:167], a[204:207], a[60:63], v[164:167]
  ds_read_b64_tr_b16 a[196:197], v242 offset:57344
  v_lshrrev_b32 v130, 5, v128
  v_mfma_f32_16x16x32_bf16 v[164:167], a[200:203], a[52:55], v[164:167]
  s_waitcnt lgkmcnt(11)
  ds_read_b64_tr_b16 a[198:199], v242 offset:61440
  v_xor_b32 v131, v131, v130
  v_mfma_f32_16x16x32_bf16 v[172:175], a[208:211], a[52:55], v[172:175]
  ds_read_b64_tr_b16 a[200:201], v243 offset:49152
  v_lshlrev_b32 v131, 4, v131
  v_mfma_f32_16x16x32_bf16 v[172:175], a[212:215], a[60:63], v[172:175]
  buffer_load_dwordx4 a[116:119], v137, s[36:39], s51 offen offset:1024 sc1
  ds_read_b64_tr_b16 a[202:203], v243 offset:53248
  v_mfma_f32_16x16x32_bf16 v[168:171], a[212:215], a[56:59], v[168:171]
  ds_read_b64_tr_b16 a[204:205], v243 offset:57344
  v_lshl_add_u32 v131, v129, 7, v131
  v_mfma_f32_16x16x32_bf16 v[168:171], a[208:211], a[48:51], v[168:171]
  s_waitcnt vmcnt(21) lgkmcnt(11)
  ds_read_b64_tr_b16 a[206:207], v243 offset:61440
  v_bfe_u32 v130, v128, 4, 1
  v_mfma_f32_16x16x32_bf16 v[32:35], a[176:179], a[64:67], v[32:35]
  ds_read_b64_tr_b16 a[208:209], v240 offset:51200
  v_lshl_add_u32 v131, v130, 3, v131
  v_mfma_f32_16x16x32_bf16 v[32:35], a[180:183], a[72:75], v[32:35]
  buffer_load_dwordx4 v135, s[24:27], s50 offen offset:2048 lds
  s_add_u32 s51, s51, 12288
  v_mfma_f32_16x16x32_bf16 v[36:39], a[180:183], a[76:79], v[36:39]
  ds_read_b64_tr_b16 a[210:211], v240 offset:55296
  ds_read_b64_tr_b16 a[212:213], v240 offset:59392
  v_mfma_f32_16x16x32_bf16 v[36:39], a[176:179], a[68:71], v[36:39]
  s_waitcnt lgkmcnt(11)
  ds_read_b64_tr_b16 a[214:215], v240 offset:63488
  v_add_u32 v140, s67, v131
  v_mfma_f32_16x16x32_bf16 v[44:47], a[184:187], a[68:71], v[44:47]
  ds_read_b64_tr_b16 a[176:177], v241 offset:51200
  v_xor_b32 v141, 32, v140
  v_mfma_f32_16x16x32_bf16 v[44:47], a[188:191], a[76:79], v[44:47]
  buffer_load_dwordx4 a[120:123], v137, s[36:39], s51 offen offset:2048 sc1
  ds_read_b64_tr_b16 a[178:179], v241 offset:55296
  v_mfma_f32_16x16x32_bf16 v[40:43], a[188:191], a[72:75], v[40:43]
  ds_read_b64_tr_b16 a[180:181], v241 offset:59392
  v_xor_b32 v142, 64, v140
  v_mfma_f32_16x16x32_bf16 v[40:43], a[184:187], a[64:67], v[40:43]
  s_waitcnt vmcnt(15) lgkmcnt(11)
  s_barrier
  ds_read_b64_tr_b16 a[182:183], v241 offset:63488
  v_mfma_f32_16x16x32_bf16 v[48:51], a[192:195], a[64:67], v[48:51]
  ds_read_b64_tr_b16 a[184:185], v242 offset:51200
  v_xor_b32 v143, 96, v140
  v_mfma_f32_16x16x32_bf16 v[48:51], a[196:199], a[72:75], v[48:51]
  buffer_load_dwordx4 v136, s[24:27], s50 offen offset:3072 lds
  ds_read_b64_tr_b16 a[186:187], v242 offset:55296
  v_mfma_f32_16x16x32_bf16 v[52:55], a[196:199], a[76:79], v[52:55]
  ds_read_b64_tr_b16 a[188:189], v242 offset:59392
  v_add_u32 v255, s67, v0
  v_mfma_f32_16x16x32_bf16 v[52:55], a[192:195], a[68:71], v[52:55]
  s_waitcnt lgkmcnt(11)
  ds_read_b64_tr_b16 a[190:191], v242 offset:63488
  s_lshl_b32 s67, s44, 10
  v_mfma_f32_16x16x32_bf16 v[60:63], a[200:203], a[68:71], v[60:63]
  s_add_u32 s67, s67, 151552
  buffer_load_dwordx4 a[124:127], v137, s[36:39], s51 offen offset:3072 sc1
  s_add_u32 s82, s83, 9
  v_mfma_f32_16x16x32_bf16 v[60:63], a[204:207], a[76:79], v[60:63]
  s_and_b32 s82, s82, 3
  s_mul_i32 s82, s82, 14
  s_lshl_b32 s50, s82, 16
  v_mfma_f32_16x16x32_bf16 v[56:59], a[204:207], a[72:75], v[56:59]
  s_add_u32 s50, s50, s84
  s_add_u32 m0, s73, 114688
  ds_read_b64_tr_b16 a[192:193], v243 offset:51200
  v_mfma_f32_16x16x32_bf16 v[56:59], a[200:203], a[64:67], v[56:59]
  s_waitcnt lgkmcnt(9)
  ds_read_b64_tr_b16 a[194:195], v243 offset:55296
  ds_read_b64_tr_b16 a[196:197], v243 offset:59392
  v_mfma_f32_16x16x32_bf16 v[144:147], a[208:211], a[64:67], v[144:147]
  ds_read_b64_tr_b16 a[198:199], v243 offset:63488
  buffer_load_dwordx4 v133, s[24:27], s50 offen offset:0 lds
  v_mfma_f32_16x16x32_bf16 v[144:147], a[212:215], a[72:75], v[144:147]
  s_lshl_b32 s51, s82, 11
  ds_read_b64_tr_b16 a[200:201], v244 offset:0
  ds_read_b64_tr_b16 a[202:203], v244 offset:4096
  v_mfma_f32_16x16x32_bf16 v[148:151], a[212:215], a[76:79], v[148:151]
  ds_read_b64_tr_b16 a[204:205], v244 offset:8192
  v_add_u32 v129, s67, v0
  v_mfma_f32_16x16x32_bf16 v[148:151], a[208:211], a[68:71], v[148:151]
  s_waitcnt lgkmcnt(11)
  ds_read_b64_tr_b16 a[206:207], v244 offset:12288
  v_lshrrev_b32 v130, 4, v128
  v_mfma_f32_16x16x32_bf16 v[156:159], a[176:179], a[68:71], v[156:159]
  buffer_load_dwordx4 a[216:219], v137, s[36:39], s51 offen offset:0 sc1
  ds_read_b64_tr_b16 a[208:209], v245 offset:0
  v_mfma_f32_16x16x32_bf16 v[156:159], a[180:183], a[76:79], v[156:159]
  ds_read_b64_tr_b16 a[210:211], v245 offset:4096
  v_lshl_add_u32 v130, v130, 4, s67
  v_mfma_f32_16x16x32_bf16 v[152:155], a[180:183], a[72:75], v[152:155]
  ds_read_b64_tr_b16 a[212:213], v245 offset:8192
  ds_write_b128 v129, a[248:251]
  v_mfma_f32_16x16x32_bf16 v[152:155], a[176:179], a[64:67], v[152:155]
  s_waitcnt lgkmcnt(12)
  ds_read_b64_tr_b16 a[214:215], v245 offset:12288
  ds_read_b128 v[176:179], v130 offset:768
  v_mfma_f32_16x16x32_bf16 v[160:163], a[184:187], a[64:67], v[160:163]
  buffer_load_dwordx4 v134, s[24:27], s50 offen offset:1024 lds
  ds_read_b64_tr_b16 a[176:177], v246 offset:0
  v_mfma_f32_16x16x32_bf16 v[160:163], a[188:191], a[72:75], v[160:163]
  ds_read_b64_tr_b16 a[178:179], v246 offset:4096
  ds_read_b128 v[180:183], v130 offset:832
  v_mfma_f32_16x16x32_bf16 v[164:167], a[188:191], a[76:79], v[164:167]
  ds_read_b64_tr_b16 a[180:181], v246 offset:8192
  ds_read_b128 v[184:187], v130 offset:896
  v_mfma_f32_16x16x32_bf16 v[164:167], a[184:187], a[68:71], v[164:167]
  s_waitcnt lgkmcnt(15)
  ds_read_b64_tr_b16 a[182:183], v246 offset:12288
  ds_read_b128 v[188:191], v130 offset:960
  v_mfma_f32_16x16x32_bf16 v[172:175], a[192:195], a[68:71], v[172:175]
  buffer_load_dwordx4 a[220:223], v137, s[36:39], s51 offen offset:1024 sc1
  ds_read_b64_tr_b16 a[184:185], v247 offset:0
  v_mfma_f32_16x16x32_bf16 v[172:175], a[196:199], a[76:79], v[172:175]
  ds_read_b64_tr_b16 a[186:187], v247 offset:4096
  v_accvgpr_read_b32 v131, a232
  v_mfma_f32_16x16x32_bf16 v[168:171], a[196:199], a[72:75], v[168:171]
  ds_read_b64_tr_b16 a[188:189], v247 offset:8192
  v_lshlrev_b32 v64, 16, v131
  v_mfma_f32_16x16x32_bf16 v[168:171], a[192:195], a[64:67], v[168:171]
  s_waitcnt vmcnt(20) lgkmcnt(15)
  buffer_load_dwordx4 v135, s[24:27], s50 offen offset:2048 lds
  s_add_u32 s51, s51, 12288
  v_mfma_f32_16x16x32_bf16 v[32:35], a[200:203], a[80:83], v[32:35]
  ds_read_b64_tr_b16 a[190:191], v247 offset:12288
  ds_read_b64_tr_b16 a[192:193], v244 offset:2048
  v_mfma_f32_16x16x32_bf16 v[32:35], a[204:207], a[88:91], v[32:35]
  ds_read_b64_tr_b16 a[194:195], v244 offset:6144
  v_and_b32 v65, 0xffff0000, v131
  v_mfma_f32_16x16x32_bf16 v[36:39], a[204:207], a[92:95], v[36:39]
  ds_read_b64_tr_b16 a[196:197], v244 offset:10240
  v_accvgpr_read_b32 v131, a233
  v_mfma_f32_16x16x32_bf16 v[36:39], a[200:203], a[84:87], v[36:39]
  s_waitcnt lgkmcnt(15)
  buffer_load_dwordx4 a[224:227], v137, s[36:39], s51 offen offset:2048 sc1
  ds_read_b64_tr_b16 a[198:199], v244 offset:14336
  v_mfma_f32_16x16x32_bf16 v[44:47], a[208:211], a[84:87], v[44:47]
Hb0_3:
  s_cbranch_execz Hb0_4
  ds_read_b64_tr_b16 a[200:201], v245 offset:2048
  v_lshlrev_b32 v66, 16, v131
  v_mfma_f32_16x16x32_bf16 v[44:47], a[212:215], a[92:95], v[44:47]
  ds_read_b64_tr_b16 a[202:203], v245 offset:6144
  v_and_b32 v67, 0xffff0000, v131
  v_mfma_f32_16x16x32_bf16 v[40:43], a[212:215], a[88:91], v[40:43]
  ds_read_b64_tr_b16 a[204:205], v245 offset:10240
  v_accvgpr_read_b32 v131, a234
  v_mfma_f32_16x16x32_bf16 v[40:43], a[208:211], a[80:83], v[40:43]
  s_waitcnt vmcnt(15) lgkmcnt(12)
  s_barrier
  buffer_load_dwordx4 v136, s[24:27], s50 offen offset:3072 lds
  v_mfma_f32_16x16x32_bf16 v[48:51], a[176:179], a[80:83], v[48:51]
  ds_read_b64_tr_b16 a[206:207], v245 offset:14336
  ds_read_b64_tr_b16 a[208:209], v246 offset:2048
  v_mfma_f32_16x16x32_bf16 v[48:51], a[180:183], a[88:91], v[48:51]
  ds_read_b64_tr_b16 a[210:211], v246 offset:6144
  v_lshlrev_b32 v68, 16, v131
  v_mfma_f32_16x16x32_bf16 v[52:55], a[180:183], a[92:95], v[52:55]
  ds_read_b64_tr_b16 a[212:213], v246 offset:10240
  v_and_b32 v69, 0xffff0000, v131
  v_mfma_f32_16x16x32_bf16 v[52:55], a[176:179], a[84:87], v[52:55]
  s_waitcnt lgkmcnt(11)
  buffer_load_dwordx4 a[228:231], v137, s[36:39], s51 offen offset:3072 sc1
  s_add_u32 s70, s83, 10
  v_mfma_f32_16x16x32_bf16 v[60:63], a[184:187], a[84:87], v[60:63]
  s_and_b32 s70, s70, 3
  s_mul_i32 s70, s70, 14
  s_lshl_b32 s50, s70, 16
  v_mfma_f32_16x16x32_bf16 v[60:63], a[188:191], a[92:95], v[60:63]
  s_add_u32 s50, s50, s84
  s_add_u32 m0, s73, 131072
  ds_read_b64_tr_b16 a[214:215], v246 offset:14336
  v_mfma_f32_16x16x32_bf16 v[56:59], a[188:191], a[88:91], v[56:59]
  ds_read_b64_tr_b16 a[176:177], v247 offset:2048
  ds_read_b64_tr_b16 a[178:179], v247 offset:6144
  v_mfma_f32_16x16x32_bf16 v[56:59], a[184:187], a[80:83], v[56:59]
  s_waitcnt lgkmcnt(10)
  ds_read_b64_tr_b16 a[180:181], v247 offset:10240
  buffer_load_dwordx4 v133, s[24:27], s50 offen offset:0 lds
  v_mfma_f32_16x16x32_bf16 v[144:147], a[192:195], a[80:83], v[144:147]
  s_lshl_b32 s51, s70, 11
  ds_read_b64_tr_b16 a[182:183], v247 offset:14336
  ds_read_b64_tr_b16 a[184:185], v244 offset:16384
  v_mfma_f32_16x16x32_bf16 v[144:147], a[196:199], a[88:91], v[144:147]
  ds_read_b64_tr_b16 a[186:187], v244 offset:20480
  v_accvgpr_read_b32 v131, a235
  v_mfma_f32_16x16x32_bf16 v[148:151], a[196:199], a[92:95], v[148:151]
  buffer_load_dwordx4 a[0:3], v137, s[36:39], s51 offen offset:0 sc1
  ds_read_b64_tr_b16 a[188:189], v244 offset:24576
  v_mfma_f32_16x16x32_bf16 v[148:151], a[192:195], a[84:87], v[148:151]
  s_waitcnt lgkmcnt(11)
  ds_read_b64_tr_b16 a[190:191], v244 offset:28672
  v_lshlrev_b32 v70, 16, v131
  v_mfma_f32_16x16x32_bf16 v[156:159], a[200:203], a[84:87], v[156:159]
  ds_read_b64_tr_b16 a[192:193], v245 offset:16384
  v_and_b32 v71, 0xffff0000, v131
  v_mfma_f32_16x16x32_bf16 v[156:159], a[204:207], a[92:95], v[156:159]
  ds_read_b64_tr_b16 a[194:195], v245 offset:20480
  v_accvgpr_read_b32 v131, a236
  v_mfma_f32_16x16x32_bf16 v[152:155], a[204:207], a[88:91], v[152:155]
  buffer_load_dwordx4 v134, s[24:27], s50 offen offset:1024 lds
  ds_read_b64_tr_b16 a[196:197], v245 offset:24576
  v_mfma_f32_16x16x32_bf16 v[152:155], a[200:203], a[80:83], v[152:155]
  s_waitcnt lgkmcnt(11)
  ds_read_b64_tr_b16 a[198:199], v245 offset:28672
  v_lshlrev_b32 v72, 16, v131
  v_mfma_f32_16x16x32_bf16 v[160:163], a[208:211], a[80:83], v[160:163]
  ds_read_b64_tr_b16 a[200:201], v246 offset:16384
  v_and_b32 v73, 0xffff0000, v131
  v_mfma_f32_16x16x32_bf16 v[160:163], a[212:215], a[88:91], v[160:163]
  ds_read_b64_tr_b16 a[202:203], v246 offset:20480
  v_accvgpr_read_b32 v131, a237
  v_mfma_f32_16x16x32_bf16 v[164:167], a[212:215], a[92:95], v[164:167]
  buffer_load_dword v139, v138, s[36:39], s91 offen sc1
  ds_read_b64_tr_b16 a[204:205], v246 offset:24576
  v_mfma_f32_16x16x32_bf16 v[164:167], a[208:211], a[84:87], v[164:167]
  s_waitcnt lgkmcnt(11)
  ds_read_b64_tr_b16 a[206:207], v246 offset:28672
  v_lshlrev_b32 v74, 16, v131
  v_mfma_f32_16x16x32_bf16 v[172:175], a[176:179], a[84:87], v[172:175]
  ds_read_b64_tr_b16 a[208:209], v247 offset:16384
  v_and_b32 v75, 0xffff0000, v131
  v_mfma_f32_16x16x32_bf16 v[172:175], a[180:183], a[92:95], v[172:175]
  buffer_load_dwordx4 a[4:7], v137, s[36:39], s51 offen offset:1024 sc1
  ds_read_b64_tr_b16 a[210:211], v247 offset:20480
  v_mfma_f32_16x16x32_bf16 v[168:171], a[180:183], a[88:91], v[168:171]
  ds_read_b64_tr_b16 a[212:213], v247 offset:24576
  v_accvgpr_read_b32 v131, a238
  v_mfma_f32_16x16x32_bf16 v[168:171], a[176:179], a[80:83], v[168:171]
  s_waitcnt vmcnt(21) lgkmcnt(11)
  ds_read_b64_tr_b16 a[214:215], v247 offset:28672
  v_lshlrev_b32 v76, 16, v131
  v_mfma_f32_16x16x32_bf16 v[32:35], a[184:187], a[96:99], v[32:35]
  buffer_load_dwordx4 v135, s[24:27], s50 offen offset:2048 lds
  s_add_u32 s51, s51, 12288
  v_mfma_f32_16x16x32_bf16 v[32:35], a[188:191], a[104:107], v[32:35]
  ds_read_b64_tr_b16 a[176:177], v244 offset:18432
  ds_read_b64_tr_b16 a[178:179], v244 offset:22528
  v_mfma_f32_16x16x32_bf16 v[36:39], a[188:191], a[108:111], v[36:39]
  ds_read_b64_tr_b16 a[180:181], v244 offset:26624
  v_and_b32 v77, 0xffff0000, v131
  v_mfma_f32_16x16x32_bf16 v[36:39], a[184:187], a[100:103], v[36:39]
  s_waitcnt lgkmcnt(11)
  buffer_load_dwordx4 a[8:11], v137, s[36:39], s51 offen offset:2048 sc1
  ds_read_b64_tr_b16 a[182:183], v244 offset:30720
  v_mfma_f32_16x16x32_bf16 v[44:47], a[192:195], a[100:103], v[44:47]
  ds_read_b64_tr_b16 a[184:185], v245 offset:18432
  v_accvgpr_read_b32 v131, a239
  v_mfma_f32_16x16x32_bf16 v[44:47], a[196:199], a[108:111], v[44:47]
  ds_read_b64_tr_b16 a[186:187], v245 offset:22528
  v_lshlrev_b32 v78, 16, v131
  v_mfma_f32_16x16x32_bf16 v[40:43], a[196:199], a[104:107], v[40:43]
  buffer_load_dwordx4 v136, s[24:27], s50 offen offset:3072 lds
  ds_read_b64_tr_b16 a[188:189], v245 offset:26624
  v_mfma_f32_16x16x32_bf16 v[40:43], a[192:195], a[96:99], v[40:43]
  s_waitcnt vmcnt(17) lgkmcnt(11)
  s_barrier
  ds_read_b64_tr_b16 a[190:191], v245 offset:30720
  v_mfma_f32_16x16x32_bf16 v[48:51], a[200:203], a[96:99], v[48:51]
  ds_read_b64_tr_b16 a[192:193], v246 offset:18432
  v_and_b32 v79, 0xffff0000, v131
  v_mfma_f32_16x16x32_bf16 v[48:51], a[204:207], a[104:107], v[48:51]
  buffer_load_dwordx4 a[12:15], v137, s[36:39], s51 offen offset:3072 sc1
  s_add_u32 s74, s83, 11
  v_mfma_f32_16x16x32_bf16 v[52:55], a[204:207], a[108:111], v[52:55]
  s_and_b32 s74, s74, 3
  s_mul_i32 s74, s74, 14
  s_lshl_b32 s50, s74, 16
  v_mfma_f32_16x16x32_bf16 v[52:55], a[200:203], a[100:103], v[52:55]
  s_waitcnt lgkmcnt(9)
  s_add_u32 s50, s50, s84
  s_add_u32 m0, s73, 0
  v_mfma_f32_16x16x32_bf16 v[60:63], a[208:211], a[100:103], v[60:63]
  ds_read_b64_tr_b16 a[194:195], v246 offset:22528
  ds_read_b64_tr_b16 a[196:197], v246 offset:26624
  v_mfma_f32_16x16x32_bf16 v[60:63], a[212:215], a[108:111], v[60:63]
  ds_read_b64_tr_b16 a[198:199], v246 offset:30720
  ds_read_b64_tr_b16 a[200:201], v247 offset:18432
  v_mfma_f32_16x16x32_bf16 v[56:59], a[212:215], a[104:107], v[56:59]
  buffer_load_dwordx4 v133, s[24:27], s50 offen offset:0 lds
  s_lshl_b32 s51, s74, 11
  v_mfma_f32_16x16x32_bf16 v[56:59], a[208:211], a[96:99], v[56:59]
  s_waitcnt lgkmcnt(9)
  ds_read_b64_tr_b16 a[202:203], v247 offset:22528
  ds_read_b64_tr_b16 a[204:205], v247 offset:26624
  v_mfma_f32_16x16x32_bf16 v[144:147], a[176:179], a[96:99], v[144:147]
  ds_read_b64_tr_b16 a[206:207], v247 offset:30720
  ds_read_b64_tr_b16 a[208:209], v244 offset:32768
  v_mfma_f32_16x16x32_bf16 v[144:147], a[180:183], a[104:107], v[144:147]
  buffer_load_dwordx4 a[16:19], v137, s[36:39], s51 offen offset:0 sc1
  ds_read_b64_tr_b16 a[210:211], v244 offset:36864
  v_mfma_f32_16x16x32_bf16 v[148:151], a[180:183], a[108:111], v[148:151]
  ds_read_b64_tr_b16 a[212:213], v244 offset:40960
  v_accvgpr_read_b32 v131, a240
  v_mfma_f32_16x16x32_bf16 v[148:151], a[176:179], a[100:103], v[148:151]
  s_waitcnt lgkmcnt(11)
  ds_read_b64_tr_b16 a[214:215], v244 offset:45056
  v_lshlrev_b32 v80, 16, v131
  v_mfma_f32_16x16x32_bf16 v[156:159], a[184:187], a[100:103], v[156:159]
  ds_read_b64_tr_b16 a[176:177], v245 offset:32768
  v_and_b32 v81, 0xffff0000, v131
  v_mfma_f32_16x16x32_bf16 v[156:159], a[188:191], a[108:111], v[156:159]
  buffer_load_dwordx4 v134, s[24:27], s50 offen offset:1024 lds
  ds_read_b64_tr_b16 a[178:179], v245 offset:36864
  v_mfma_f32_16x16x32_bf16 v[152:155], a[188:191], a[104:107], v[152:155]
  ds_read_b64_tr_b16 a[180:181], v245 offset:40960
  v_accvgpr_read_b32 v131, a241
  v_mfma_f32_16x16x32_bf16 v[152:155], a[184:187], a[96:99], v[152:155]
  s_waitcnt lgkmcnt(11)
  ds_read_b64_tr_b16 a[182:183], v245 offset:45056
  v_lshlrev_b32 v82, 16, v131
  v_mfma_f32_16x16x32_bf16 v[160:163], a[192:195], a[96:99], v[160:163]
  buffer_load_dwordx4 a[20:23], v137, s[36:39], s51 offen offset:1024 sc1
  ds_read_b64_tr_b16 a[184:185], v246 offset:32768
  v_mfma_f32_16x16x32_bf16 v[160:163], a[196:199], a[104:107], v[160:163]
  ds_read_b64_tr_b16 a[186:187], v246 offset:36864
  v_and_b32 v83, 0xffff0000, v131
  v_mfma_f32_16x16x32_bf16 v[164:167], a[196:199], a[108:111], v[164:167]
  ds_read_b64_tr_b16 a[188:189], v246 offset:40960
  v_accvgpr_read_b32 v131, a242
  v_mfma_f32_16x16x32_bf16 v[164:167], a[192:195], a[100:103], v[164:167]
  s_waitcnt lgkmcnt(11)
  ds_read_b64_tr_b16 a[190:191], v246 offset:45056
  v_lshlrev_b32 v84, 16, v131
  v_mfma_f32_16x16x32_bf16 v[172:175], a[200:203], a[100:103], v[172:175]
  buffer_load_dwordx4 v135, s[24:27], s50 offen offset:2048 lds
  s_add_u32 s51, s51, 12288
  v_mfma_f32_16x16x32_bf16 v[172:175], a[204:207], a[108:111], v[172:175]
  ds_read_b64_tr_b16 a[192:193], v247 offset:32768
  ds_read_b64_tr_b16 a[194:195], v247 offset:36864
  v_mfma_f32_16x16x32_bf16 v[168:171], a[204:207], a[104:107], v[168:171]
  ds_read_b64_tr_b16 a[196:197], v247 offset:40960
  v_and_b32 v85, 0xffff0000, v131
  v_mfma_f32_16x16x32_bf16 v[168:171], a[200:203], a[96:99], v[168:171]
  s_waitcnt vmcnt(22) lgkmcnt(11)
  ds_read_b64_tr_b16 a[198:199], v247 offset:45056
  v_accvgpr_read_b32 v131, a243
  v_mfma_f32_16x16x32_bf16 v[32:35], a[208:211], a[112:115], v[32:35]
  buffer_load_dwordx4 a[24:27], v137, s[36:39], s51 offen offset:2048 sc1
  ds_read_b64_tr_b16 a[200:201], v244 offset:34816
  v_mfma_f32_16x16x32_bf16 v[32:35], a[212:215], a[120:123], v[32:35]
  ds_read_b64_tr_b16 a[202:203], v244 offset:38912
  v_lshlrev_b32 v86, 16, v131
  v_mfma_f32_16x16x32_bf16 v[36:39], a[212:215], a[124:127], v[36:39]
  ds_read_b64_tr_b16 a[204:205], v244 offset:43008
  v_and_b32 v87, 0xffff0000, v131
  v_mfma_f32_16x16x32_bf16 v[36:39], a[208:211], a[116:119], v[36:39]
  s_waitcnt lgkmcnt(11)
  ds_read_b64_tr_b16 a[206:207], v244 offset:47104
  v_accvgpr_read_b32 v131, a244
  v_mfma_f32_16x16x32_bf16 v[44:47], a[176:179], a[116:119], v[44:47]
  buffer_load_dwordx4 v136, s[24:27], s50 offen offset:3072 lds
  ds_read_b64_tr_b16 a[208:209], v245 offset:34816
  v_mfma_f32_16x16x32_bf16 v[44:47], a[180:183], a[124:127], v[44:47]
  ds_read_b64_tr_b16 a[210:211], v245 offset:38912
  v_lshlrev_b32 v88, 16, v131
  v_mfma_f32_16x16x32_bf16 v[40:43], a[180:183], a[120:123], v[40:43]
  ds_read_b64_tr_b16 a[212:213], v245 offset:43008
  v_and_b32 v89, 0xffff0000, v131
  v_mfma_f32_16x16x32_bf16 v[40:43], a[176:179], a[112:115], v[40:43]
  s_waitcnt vmcnt(17) lgkmcnt(11)
  s_barrier
  ds_read_b64_tr_b16 a[214:215], v245 offset:47104
  v_mfma_f32_16x16x32_bf16 v[48:51], a[184:187], a[112:115], v[48:51]
  buffer_load_dwordx4 a[28:31], v137, s[36:39], s51 offen offset:3072 sc1
  s_mov_b32 s75, 1
  v_mfma_f32_16x16x32_bf16 v[48:51], a[188:191], a[120:123], v[48:51]
  s_lshl_b32 s50, s75, 16
  s_add_u32 m0, s73, 16384
  ds_read_b64_tr_b16 a[176:177], v246 offset:34816
  v_mfma_f32_16x16x32_bf16 v[52:55], a[188:191], a[124:127], v[52:55]
  ds_read_b64_tr_b16 a[178:179], v246 offset:38912
  ds_read_b64_tr_b16 a[180:181], v246 offset:43008
  v_mfma_f32_16x16x32_bf16 v[52:55], a[184:187], a[116:119], v[52:55]
  s_waitcnt lgkmcnt(11)
  buffer_load_dwordx4 v133, s[24:27], s50 offen offset:0 lds
  ds_read_b64_tr_b16 a[182:183], v246 offset:47104
  v_mfma_f32_16x16x32_bf16 v[60:63], a[192:195], a[116:119], v[60:63]
  s_waitcnt vmcnt(14)
  v_cmp_ne_u32 vcc, 1, v139
  s_nop 4
  s_cbranch_vccnz CK7s
CK7x:
  v_mfma_f32_16x16x32_bf16 v[60:63], a[196:199], a[124:127], v[60:63]
  s_lshl_b32 s51, s75, 11
  ds_read_b64_tr_b16 a[184:185], v247 offset:34816
  ds_read_b64_tr_b16 a[186:187], v247 offset:38912
  v_mfma_f32_16x16x32_bf16 v[56:59], a[196:199], a[120:123], v[56:59]
  ds_read_b64_tr_b16 a[188:189], v247 offset:43008
  v_accvgpr_read_b32 v131, a245
  v_mfma_f32_16x16x32_bf16 v[56:59], a[192:195], a[112:115], v[56:59]
  s_waitcnt lgkmcnt(11)
  buffer_load_dwordx4 a[32:35], v137, s[36:39], s51 offen offset:0 sc1
  ds_read_b64_tr_b16 a[190:191], v247 offset:47104
  v_mfma_f32_16x16x32_bf16 v[144:147], a[200:203], a[112:115], v[144:147]
  ds_read_b64_tr_b16 a[192:193], v244 offset:49152
  v_lshlrev_b32 v90, 16, v131
  v_mfma_f32_16x16x32_bf16 v[144:147], a[204:207], a[120:123], v[144:147]
  ds_read_b64_tr_b16 a[194:195], v244 offset:53248
  v_and_b32 v91, 0xffff0000, v131
  v_mfma_f32_16x16x32_bf16 v[148:151], a[204:207], a[124:127], v[148:151]
  ds_read_b64_tr_b16 a[196:197], v244 offset:57344
  v_accvgpr_read_b32 v131, a246
  v_mfma_f32_16x16x32_bf16 v[148:151], a[200:203], a[116:119], v[148:151]
  s_waitcnt lgkmcnt(11)
  buffer_load_dwordx4 v134, s[24:27], s50 offen offset:1024 lds
  ds_read_b64_tr_b16 a[198:199], v244 offset:61440
  v_mfma_f32_16x16x32_bf16 v[156:159], a[208:211], a[116:119], v[156:159]
  ds_read_b64_tr_b16 a[200:201], v245 offset:49152
  v_lshlrev_b32 v92, 16, v131
  v_mfma_f32_16x16x32_bf16 v[156:159], a[212:215], a[124:127], v[156:159]
  ds_read_b64_tr_b16 a[202:203], v245 offset:53248
  v_and_b32 v93, 0xffff0000, v131
  v_mfma_f32_16x16x32_bf16 v[152:155], a[212:215], a[120:123], v[152:155]
  ds_read_b64_tr_b16 a[204:205], v245 offset:57344
  v_accvgpr_read_b32 v131, a247
  v_mfma_f32_16x16x32_bf16 v[152:155], a[208:211], a[112:115], v[152:155]
  s_waitcnt lgkmcnt(11)
  buffer_load_dwordx4 a[36:39], v137, s[36:39], s51 offen offset:1024 sc1
  ds_read_b64_tr_b16 a[206:207], v245 offset:61440
  v_mfma_f32_16x16x32_bf16 v[160:163], a[176:179], a[112:115], v[160:163]
  ds_read_b64_tr_b16 a[208:209], v246 offset:49152
  v_lshlrev_b32 v94, 16, v131
  v_mfma_f32_16x16x32_bf16 v[160:163], a[180:183], a[120:123], v[160:163]
  ds_read_b64_tr_b16 a[210:211], v246 offset:53248
  v_and_b32 v95, 0xffff0000, v131
  v_mfma_f32_16x16x32_bf16 v[164:167], a[180:183], a[124:127], v[164:167]
  s_add_u32 s49, s72, 32768
  ds_read_b64_tr_b16 a[212:213], v246 offset:57344
  s_lshl_b32 s67, s2, 5
  v_mfma_f32_16x16x32_bf16 v[164:167], a[176:179], a[116:119], v[164:167]
  s_waitcnt lgkmcnt(11)
  buffer_load_dwordx4 v135, s[24:27], s50 offen offset:2048 lds
  ds_read_b64_tr_b16 a[214:215], v246 offset:61440
  v_mfma_f32_16x16x32_bf16 v[172:175], a[184:187], a[116:119], v[172:175]
  s_add_u32 s67, s67, s44
  ds_read_b64_tr_b16 a[176:177], v247 offset:49152
  s_lshl2_add_u32 s67, s67, 5472256
  v_mfma_f32_16x16x32_bf16 v[172:175], a[188:191], a[124:127], v[172:175]
  s_xor_b32 s68, s67, 128
  ds_read_b64_tr_b16 a[178:179], v247 offset:53248
  v_mov_b32 v132, 0
  v_mfma_f32_16x16x32_bf16 v[168:171], a[188:191], a[120:123], v[168:171]
  ds_read_b64_tr_b16 a[180:181], v247 offset:57344
  v_mfma_f32_16x16x32_bf16 v[168:171], a[184:187], a[112:115], v[168:171]
  s_waitcnt vmcnt(22) lgkmcnt(11)
  buffer_load_dwordx4 a[40:43], v137, s[36:39], s51 offen offset:2048 sc1
  ds_read_b64_tr_b16 a[182:183], v247 offset:61440
  v_mfma_f32_16x16x32_bf16 v[32:35], a[192:195], a[216:219], v[32:35]
  ds_read_b64_tr_b16 a[184:185], v244 offset:51200
  v_mfma_f32_16x16x32_bf16 v[32:35], a[196:199], a[224:227], v[32:35]
  ds_read_b64_tr_b16 a[186:187], v244 offset:55296
  v_mfma_f32_16x16x32_bf16 v[36:39], a[196:199], a[228:231], v[36:39]
  buffer_load_dwordx4 v136, s[24:27], s50 offen offset:3072 lds
  ds_read_b64_tr_b16 a[188:189], v244 offset:59392
  v_mfma_f32_16x16x32_bf16 v[36:39], a[192:195], a[220:223], v[36:39]
  s_waitcnt lgkmcnt(11)
  ds_read_b64_tr_b16 a[190:191], v244 offset:63488
  v_mfma_f32_16x16x32_bf16 v[44:47], a[200:203], a[220:223], v[44:47]
  ds_read_b64_tr_b16 a[192:193], v245 offset:51200
  v_mfma_f32_16x16x32_bf16 v[44:47], a[204:207], a[228:231], v[44:47]
  ds_read_b64_tr_b16 a[194:195], v245 offset:55296
  v_mfma_f32_16x16x32_bf16 v[40:43], a[204:207], a[224:227], v[40:43]
  buffer_load_dwordx4 a[44:47], v137, s[36:39], s51 offen offset:3072 sc1
  s_cmp_eq_u32 s83, 1
  v_mfma_f32_16x16x32_bf16 v[40:43], a[200:203], a[216:219], v[40:43]
  s_waitcnt vmcnt(17) lgkmcnt(10)
  s_barrier
  s_cselect_b32 s76, 19, 5
  v_mfma_f32_16x16x32_bf16 v[48:51], a[208:211], a[216:219], v[48:51]
  s_lshl_b32 s50, s76, 16
  s_add_u32 m0, s73, 32768
  ds_read_b64_tr_b16 a[196:197], v245 offset:59392
  v_mfma_f32_16x16x32_bf16 v[48:51], a[212:215], a[224:227], v[48:51]
  ds_read_b64_tr_b16 a[198:199], v245 offset:63488
  ds_read_b64_tr_b16 a[200:201], v246 offset:51200
  v_mfma_f32_16x16x32_bf16 v[52:55], a[212:215], a[228:231], v[52:55]
  ds_read_b64_tr_b16 a[202:203], v246 offset:55296
  buffer_load_dwordx4 v133, s[24:27], s50 offen offset:0 lds
  v_mfma_f32_16x16x32_bf16 v[52:55], a[208:211], a[220:223], v[52:55]
  s_waitcnt lgkmcnt(10)
  s_lshl_b32 s51, s76, 11
  ds_read_b64_tr_b16 a[204:205], v246 offset:59392
  v_mfma_f32_16x16x32_bf16 v[60:63], a[176:179], a[220:223], v[60:63]
  ds_read_b64_tr_b16 a[206:207], v246 offset:63488
  ds_read_b64_tr_b16 a[208:209], v247 offset:51200
  v_mfma_f32_16x16x32_bf16 v[60:63], a[180:183], a[228:231], v[60:63]
  ds_read_b64_tr_b16 a[210:211], v247 offset:55296
  v_mfma_f32_16x16x32_bf16 v[56:59], a[180:183], a[224:227], v[56:59]
  buffer_load_dwordx4 a[48:51], v137, s[36:39], s51 offen offset:0 sc1
  ds_read_b64_tr_b16 a[212:213], v247 offset:59392
  v_mfma_f32_16x16x32_bf16 v[56:59], a[176:179], a[216:219], v[56:59]
  s_waitcnt lgkmcnt(11)
  ds_read_b64_tr_b16 a[214:215], v247 offset:63488
  v_mfma_f32_16x16x32_bf16 v[144:147], a[184:187], a[216:219], v[144:147]
  ds_read_b64_tr_b16 a[176:177], v248 offset:0
  v_mfma_f32_16x16x32_bf16 v[144:147], a[188:191], a[224:227], v[144:147]
  ds_read_b64_tr_b16 a[178:179], v248 offset:4096
  v_mfma_f32_16x16x32_bf16 v[148:151], a[188:191], a[228:231], v[148:151]
  buffer_load_dwordx4 v134, s[24:27], s50 offen offset:1024 lds
  ds_read_b64_tr_b16 a[180:181], v248 offset:8192
  v_mfma_f32_16x16x32_bf16 v[148:151], a[184:187], a[220:223], v[148:151]
  s_waitcnt lgkmcnt(11)
  ds_read_b64_tr_b16 a[182:183], v248 offset:12288
  v_mfma_f32_16x16x32_bf16 v[156:159], a[192:195], a[220:223], v[156:159]
  ds_read_b64_tr_b16 a[184:185], v249 offset:0
  v_mfma_f32_16x16x32_bf16 v[156:159], a[196:199], a[228:231], v[156:159]
  buffer_load_dwordx4 a[52:55], v137, s[36:39], s51 offen offset:1024 sc1
  ds_read_b64_tr_b16 a[186:187], v249 offset:4096
  v_mfma_f32_16x16x32_bf16 v[152:155], a[196:199], a[224:227], v[152:155]
  ds_read_b64_tr_b16 a[188:189], v249 offset:8192
  v_mfma_f32_16x16x32_bf16 v[152:155], a[192:195], a[216:219], v[152:155]
  s_waitcnt lgkmcnt(11)
  ds_read_b64_tr_b16 a[190:191], v249 offset:12288
  v_mfma_f32_16x16x32_bf16 v[160:163], a[200:203], a[216:219], v[160:163]
  ds_read_b64_tr_b16 a[192:193], v250 offset:0
  v_mfma_f32_16x16x32_bf16 v[160:163], a[204:207], a[224:227], v[160:163]
  buffer_load_dwordx4 v135, s[24:27], s50 offen offset:2048 lds
  ds_read_b64_tr_b16 a[194:195], v250 offset:4096
  v_mfma_f32_16x16x32_bf16 v[164:167], a[204:207], a[228:231], v[164:167]
  ds_read_b64_tr_b16 a[196:197], v250 offset:8192
  v_mfma_f32_16x16x32_bf16 v[164:167], a[200:203], a[220:223], v[164:167]
  s_waitcnt lgkmcnt(11)
  ds_read_b64_tr_b16 a[198:199], v250 offset:12288
  v_mfma_f32_16x16x32_bf16 v[172:175], a[208:211], a[220:223], v[172:175]
  ds_read_b64_tr_b16 a[200:201], v251 offset:0
  v_mfma_f32_16x16x32_bf16 v[172:175], a[212:215], a[228:231], v[172:175]
  buffer_load_dwordx4 a[56:59], v137, s[36:39], s51 offen offset:2048 sc1
  ds_read_b64_tr_b16 a[202:203], v251 offset:4096
  v_mfma_f32_16x16x32_bf16 v[168:171], a[212:215], a[224:227], v[168:171]
  ds_read_b64_tr_b16 a[204:205], v251 offset:8192
  v_mfma_f32_16x16x32_bf16 v[168:171], a[208:211], a[216:219], v[168:171]
  s_waitcnt vmcnt(22) lgkmcnt(11)
  ds_read_b64_tr_b16 a[206:207], v251 offset:12288
  v_mfma_f32_16x16x32_bf16 v[32:35], a[176:179], a[0:3], v[32:35]
  ds_read_b64_tr_b16 a[208:209], v248 offset:2048
  v_mfma_f32_16x16x32_bf16 v[32:35], a[180:183], a[8:11], v[32:35]
  buffer_load_dwordx4 v136, s[24:27], s50 offen offset:3072 lds
  ds_read_b64_tr_b16 a[210:211], v248 offset:6144
  v_mfma_f32_16x16x32_bf16 v[36:39], a[180:183], a[12:15], v[36:39]
  ds_read_b64_tr_b16 a[212:213], v248 offset:10240
  v_mfma_f32_16x16x32_bf16 v[36:39], a[176:179], a[4:7], v[36:39]
  s_waitcnt lgkmcnt(11)
  ds_read_b64_tr_b16 a[214:215], v248 offset:14336
  v_mfma_f32_16x16x32_bf16 v[44:47], a[184:187], a[4:7], v[44:47]
  ds_read_b64_tr_b16 a[176:177], v249 offset:2048
  v_mfma_f32_16x16x32_bf16 v[44:47], a[188:191], a[12:15], v[44:47]
  buffer_load_dwordx4 a[60:63], v137, s[36:39], s51 offen offset:3072 sc1
  s_cmp_eq_u32 s83, 2
  v_mfma_f32_16x16x32_bf16 v[40:43], a[188:191], a[8:11], v[40:43]
  s_cselect_b32 s77, 22, 8
  s_lshl_b32 s50, s77, 16
  s_add_u32 m0, s73, 49152
  v_mfma_f32_16x16x32_bf16 v[40:43], a[184:187], a[0:3], v[40:43]
  s_waitcnt vmcnt(17) lgkmcnt(9)
  s_barrier
  ds_read_b64_tr_b16 a[178:179], v249 offset:6144
  v_mfma_f32_16x16x32_bf16 v[48:51], a[192:195], a[0:3], v[48:51]
  ds_read_b64_tr_b16 a[180:181], v249 offset:10240
  ds_read_b64_tr_b16 a[182:183], v249 offset:14336
  v_mfma_f32_16x16x32_bf16 v[48:51], a[196:199], a[8:11], v[48:51]
  buffer_load_dwordx4 v133, s[24:27], s50 offen offset:0 lds
  s_lshl_b32 s51, s77, 11
  v_mfma_f32_16x16x32_bf16 v[52:55], a[196:199], a[12:15], v[52:55]
  ds_read_b64_tr_b16 a[184:185], v250 offset:2048
  ds_read_b64_tr_b16 a[186:187], v250 offset:6144
  v_mfma_f32_16x16x32_bf16 v[52:55], a[192:195], a[4:7], v[52:55]
  s_waitcnt lgkmcnt(10)
  ds_read_b64_tr_b16 a[188:189], v250 offset:10240
  ds_read_b64_tr_b16 a[190:191], v250 offset:14336
  v_mfma_f32_16x16x32_bf16 v[60:63], a[200:203], a[4:7], v[60:63]
  buffer_load_dwordx4 a[64:67], v137, s[36:39], s51 offen offset:0 sc1
  ds_read_b64_tr_b16 a[192:193], v251 offset:2048
  v_mfma_f32_16x16x32_bf16 v[60:63], a[204:207], a[12:15], v[60:63]
  ds_read_b64_tr_b16 a[194:195], v251 offset:6144
  v_mfma_f32_16x16x32_bf16 v[56:59], a[204:207], a[8:11], v[56:59]
  ds_read_b64_tr_b16 a[196:197], v251 offset:10240
  v_mfma_f32_16x16x32_bf16 v[56:59], a[200:203], a[0:3], v[56:59]
  s_waitcnt lgkmcnt(11)
  ds_read_b64_tr_b16 a[198:199], v251 offset:14336
  v_mfma_f32_16x16x32_bf16 v[144:147], a[208:211], a[0:3], v[144:147]
  buffer_load_dwordx4 v134, s[24:27], s50 offen offset:1024 lds
  ds_read_b64_tr_b16 a[200:201], v240 offset:0
  v_mfma_f32_16x16x32_bf16 v[144:147], a[212:215], a[8:11], v[144:147]
  ds_read_b64_tr_b16 a[202:203], v240 offset:4096
  v_mfma_f32_16x16x32_bf16 v[148:151], a[212:215], a[12:15], v[148:151]
  ds_read_b64_tr_b16 a[204:205], v240 offset:8192
  v_mfma_f32_16x16x32_bf16 v[148:151], a[208:211], a[4:7], v[148:151]
  s_waitcnt lgkmcnt(11)
  ds_read_b64_tr_b16 a[206:207], v240 offset:12288
  v_mfma_f32_16x16x32_bf16 v[156:159], a[176:179], a[4:7], v[156:159]
  buffer_load_dwordx4 a[68:71], v137, s[36:39], s51 offen offset:1024 sc1
  ds_read_b64_tr_b16 a[208:209], v241 offset:0
  v_mfma_f32_16x16x32_bf16 v[156:159], a[180:183], a[12:15], v[156:159]
  ds_read_b64_tr_b16 a[210:211], v241 offset:4096
  v_mfma_f32_16x16x32_bf16 v[152:155], a[180:183], a[8:11], v[152:155]
  ds_read_b64_tr_b16 a[212:213], v241 offset:8192
  v_mfma_f32_16x16x32_bf16 v[152:155], a[176:179], a[0:3], v[152:155]
  s_waitcnt lgkmcnt(11)
  ds_read_b64_tr_b16 a[214:215], v241 offset:12288
  v_mfma_f32_16x16x32_bf16 v[160:163], a[184:187], a[0:3], v[160:163]
  buffer_load_dwordx4 v135, s[24:27], s50 offen offset:2048 lds
  ds_read_b64_tr_b16 a[176:177], v242 offset:0
  v_mfma_f32_16x16x32_bf16 v[160:163], a[188:191], a[8:11], v[160:163]
  ds_read_b64_tr_b16 a[178:179], v242 offset:4096
  v_mfma_f32_16x16x32_bf16 v[164:167], a[188:191], a[12:15], v[164:167]
  ds_read_b64_tr_b16 a[180:181], v242 offset:8192
  v_mfma_f32_16x16x32_bf16 v[164:167], a[184:187], a[4:7], v[164:167]
  s_waitcnt lgkmcnt(11)
  buffer_load_dwordx4 a[72:75], v137, s[36:39], s51 offen offset:2048 sc1
  ds_read_b64_tr_b16 a[182:183], v242 offset:12288
  v_mfma_f32_16x16x32_bf16 v[172:175], a[192:195], a[4:7], v[172:175]
  ds_read_b64_tr_b16 a[184:185], v243 offset:0
  v_mfma_f32_16x16x32_bf16 v[172:175], a[196:199], a[12:15], v[172:175]
  ds_read_b64_tr_b16 a[186:187], v243 offset:4096
  v_mfma_f32_16x16x32_bf16 v[168:171], a[196:199], a[8:11], v[168:171]
  ds_read_b64_tr_b16 a[188:189], v243 offset:8192
  v_mfma_f32_16x16x32_bf16 v[168:171], a[192:195], a[0:3], v[168:171]
  s_waitcnt vmcnt(22) lgkmcnt(11)
  buffer_load_dwordx4 v136, s[24:27], s50 offen offset:3072 lds
  ds_read_b64_tr_b16 a[190:191], v243 offset:12288
  v_mfma_f32_16x16x32_bf16 v[32:35], a[200:203], a[16:19], v[32:35]
  ds_read_b64_tr_b16 a[192:193], v240 offset:2048
  v_mfma_f32_16x16x32_bf16 v[32:35], a[204:207], a[24:27], v[32:35]
  ds_read_b64_tr_b16 a[194:195], v240 offset:6144
  v_mfma_f32_16x16x32_bf16 v[36:39], a[204:207], a[28:31], v[36:39]
  ds_read_b64_tr_b16 a[196:197], v240 offset:10240
  v_mfma_f32_16x16x32_bf16 v[36:39], a[200:203], a[20:23], v[36:39]
  s_waitcnt lgkmcnt(11)
  buffer_load_dwordx4 a[76:79], v137, s[36:39], s51 offen offset:3072 sc1
  s_cmp_eq_u32 s83, 3
  v_mfma_f32_16x16x32_bf16 v[44:47], a[208:211], a[20:23], v[44:47]
  s_cselect_b32 s78, 26, 12
  s_lshl_b32 s50, s78, 16
  s_add_u32 m0, s73, 65536
  v_mfma_f32_16x16x32_bf16 v[44:47], a[212:215], a[28:31], v[44:47]
  ds_read_b64_tr_b16 a[198:199], v240 offset:14336
  ds_read_b64_tr_b16 a[200:201], v241 offset:2048
  v_mfma_f32_16x16x32_bf16 v[40:43], a[212:215], a[24:27], v[40:43]
  ds_read_b64_tr_b16 a[202:203], v241 offset:6144
  ds_read_b64_tr_b16 a[204:205], v241 offset:10240
  v_mfma_f32_16x16x32_bf16 v[40:43], a[208:211], a[16:19], v[40:43]
  s_waitcnt vmcnt(17) lgkmcnt(11)
  s_barrier
  buffer_load_dwordx4 v133, s[24:27], s50 offen offset:0 lds
  v_mfma_f32_16x16x32_bf16 v[48:51], a[176:179], a[16:19], v[48:51]
  s_lshl_b32 s51, s78, 11
  ds_read_b64_tr_b16 a[206:207], v241 offset:14336
  ds_read_b64_tr_b16 a[208:209], v242 offset:2048
  v_mfma_f32_16x16x32_bf16 v[48:51], a[180:183], a[24:27], v[48:51]
  ds_read_b64_tr_b16 a[210:211], v242 offset:6144
  v_mfma_f32_16x16x32_bf16 v[52:55], a[180:183], a[28:31], v[52:55]
  ds_read_b64_tr_b16 a[212:213], v242 offset:10240
  v_mfma_f32_16x16x32_bf16 v[52:55], a[176:179], a[20:23], v[52:55]
  s_waitcnt lgkmcnt(11)
  buffer_load_dwordx4 a[80:83], v137, s[36:39], s51 offen offset:0 sc1
  ds_read_b64_tr_b16 a[214:215], v242 offset:14336
  v_mfma_f32_16x16x32_bf16 v[60:63], a[184:187], a[20:23], v[60:63]
  ds_read_b64_tr_b16 a[176:177], v243 offset:2048
  v_mfma_f32_16x16x32_bf16 v[60:63], a[188:191], a[28:31], v[60:63]
  ds_read_b64_tr_b16 a[178:179], v243 offset:6144
  v_mfma_f32_16x16x32_bf16 v[56:59], a[188:191], a[24:27], v[56:59]
  buffer_load_dwordx4 v134, s[24:27], s50 offen offset:1024 lds
  ds_read_b64_tr_b16 a[180:181], v243 offset:10240
  v_mfma_f32_16x16x32_bf16 v[56:59], a[184:187], a[16:19], v[56:59]
  s_waitcnt lgkmcnt(11)
  ds_read_b64_tr_b16 a[182:183], v243 offset:14336
  v_mfma_f32_16x16x32_bf16 v[144:147], a[192:195], a[16:19], v[144:147]
  ds_read_b64_tr_b16 a[184:185], v240 offset:16384
  v_mfma_f32_16x16x32_bf16 v[144:147], a[196:199], a[24:27], v[144:147]
  ds_read_b64_tr_b16 a[186:187], v240 offset:20480
  v_mfma_f32_16x16x32_bf16 v[148:151], a[196:199], a[28:31], v[148:151]
  buffer_load_dwordx4 a[84:87], v137, s[36:39], s51 offen offset:1024 sc1
  ds_read_b64_tr_b16 a[188:189], v240 offset:24576
  v_mfma_f32_16x16x32_bf16 v[148:151], a[192:195], a[20:23], v[148:151]
  s_waitcnt lgkmcnt(11)
  ds_read_b64_tr_b16 a[190:191], v240 offset:28672
  v_mfma_f32_16x16x32_bf16 v[156:159], a[200:203], a[20:23], v[156:159]
  ds_read_b64_tr_b16 a[192:193], v241 offset:16384
  v_mfma_f32_16x16x32_bf16 v[156:159], a[204:207], a[28:31], v[156:159]
  ds_read_b64_tr_b16 a[194:195], v241 offset:20480
  v_mfma_f32_16x16x32_bf16 v[152:155], a[204:207], a[24:27], v[152:155]
  buffer_load_dwordx4 v135, s[24:27], s50 offen offset:2048 lds
  ds_read_b64_tr_b16 a[196:197], v241 offset:24576
  v_mfma_f32_16x16x32_bf16 v[152:155], a[200:203], a[16:19], v[152:155]
  s_waitcnt lgkmcnt(11)
  ds_read_b64_tr_b16 a[198:199], v241 offset:28672
  v_mfma_f32_16x16x32_bf16 v[160:163], a[208:211], a[16:19], v[160:163]
  ds_read_b64_tr_b16 a[200:201], v242 offset:16384
  v_mfma_f32_16x16x32_bf16 v[160:163], a[212:215], a[24:27], v[160:163]
  ds_read_b64_tr_b16 a[202:203], v242 offset:20480
  v_mfma_f32_16x16x32_bf16 v[164:167], a[212:215], a[28:31], v[164:167]
  buffer_load_dwordx4 a[88:91], v137, s[36:39], s51 offen offset:2048 sc1
  ds_read_b64_tr_b16 a[204:205], v242 offset:24576
  v_mfma_f32_16x16x32_bf16 v[164:167], a[208:211], a[20:23], v[164:167]
  s_waitcnt lgkmcnt(11)
  ds_read_b64_tr_b16 a[206:207], v242 offset:28672
  v_mfma_f32_16x16x32_bf16 v[172:175], a[176:179], a[20:23], v[172:175]
  ds_read_b64_tr_b16 a[208:209], v243 offset:16384
  v_mfma_f32_16x16x32_bf16 v[172:175], a[180:183], a[28:31], v[172:175]
Hb1_3:
  s_cbranch_execz Rb
  ds_read_b64_tr_b16 a[210:211], v243 offset:20480
  v_mfma_f32_16x16x32_bf16 v[168:171], a[180:183], a[24:27], v[168:171]
  buffer_load_dwordx4 v136, s[24:27], s50 offen offset:3072 lds
  ds_read_b64_tr_b16 a[212:213], v243 offset:24576
  v_mfma_f32_16x16x32_bf16 v[168:171], a[176:179], a[16:19], v[168:171]
  s_waitcnt vmcnt(23) lgkmcnt(11)
  ds_read_b64_tr_b16 a[214:215], v243 offset:28672
  v_mfma_f32_16x16x32_bf16 v[32:35], a[184:187], a[32:35], v[32:35]
  ds_read_b64_tr_b16 a[176:177], v240 offset:18432
  v_mfma_f32_16x16x32_bf16 v[32:35], a[188:191], a[40:43], v[32:35]
  buffer_load_dwordx4 a[92:95], v137, s[36:39], s51 offen offset:3072 sc1
  s_cmp_eq_u32 s83, 0
  v_mfma_f32_16x16x32_bf16 v[36:39], a[188:191], a[44:47], v[36:39]
  s_cselect_b32 s79, 29, 15
  s_lshl_b32 s50, s79, 16
  s_add_u32 m0, s73, 81920
  v_mfma_f32_16x16x32_bf16 v[36:39], a[184:187], a[36:39], v[36:39]
  s_waitcnt lgkmcnt(9)
  ds_read_b64_tr_b16 a[178:179], v240 offset:22528
  ds_read_b64_tr_b16 a[180:181], v240 offset:26624
  v_mfma_f32_16x16x32_bf16 v[44:47], a[192:195], a[36:39], v[44:47]
  ds_read_b64_tr_b16 a[182:183], v240 offset:30720
  ds_read_b64_tr_b16 a[184:185], v241 offset:18432
  v_mfma_f32_16x16x32_bf16 v[44:47], a[196:199], a[44:47], v[44:47]
  buffer_load_dwordx4 v133, s[24:27], s50 offen offset:0 lds
  s_lshl_b32 s51, s79, 11
  v_mfma_f32_16x16x32_bf16 v[40:43], a[196:199], a[40:43], v[40:43]
  ds_read_b64_tr_b16 a[186:187], v241 offset:22528
  ds_read_b64_tr_b16 a[188:189], v241 offset:26624
  v_mfma_f32_16x16x32_bf16 v[40:43], a[192:195], a[32:35], v[40:43]
  s_waitcnt vmcnt(18) lgkmcnt(11)
  s_barrier
  ds_read_b64_tr_b16 a[190:191], v241 offset:30720
  v_mfma_f32_16x16x32_bf16 v[48:51], a[200:203], a[32:35], v[48:51]
  ds_read_b64_tr_b16 a[192:193], v242 offset:18432
  v_mfma_f32_16x16x32_bf16 v[48:51], a[204:207], a[40:43], v[48:51]
  buffer_load_dwordx4 a[96:99], v137, s[36:39], s51 offen offset:0 sc1
  ds_read_b64_tr_b16 a[194:195], v242 offset:22528
  v_mfma_f32_16x16x32_bf16 v[52:55], a[204:207], a[44:47], v[52:55]
  ds_read_b64_tr_b16 a[196:197], v242 offset:26624
  v_mfma_f32_16x16x32_bf16 v[52:55], a[200:203], a[36:39], v[52:55]
  s_waitcnt lgkmcnt(11)
  ds_read_b64_tr_b16 a[198:199], v242 offset:30720
  v_mfma_f32_16x16x32_bf16 v[60:63], a[208:211], a[36:39], v[60:63]
  ds_read_b64_tr_b16 a[200:201], v243 offset:18432
  v_mfma_f32_16x16x32_bf16 v[60:63], a[212:215], a[44:47], v[60:63]
  buffer_load_dwordx4 v134, s[24:27], s50 offen offset:1024 lds
  ds_read_b64_tr_b16 a[202:203], v243 offset:22528
  v_mfma_f32_16x16x32_bf16 v[56:59], a[212:215], a[40:43], v[56:59]
  ds_read_b64_tr_b16 a[204:205], v243 offset:26624
  v_mfma_f32_16x16x32_bf16 v[56:59], a[208:211], a[32:35], v[56:59]
  s_waitcnt lgkmcnt(11)
  ds_read_b64_tr_b16 a[206:207], v243 offset:30720
  v_mfma_f32_16x16x32_bf16 v[144:147], a[176:179], a[32:35], v[144:147]
  ds_read_b64_tr_b16 a[208:209], v240 offset:32768
  v_mfma_f32_16x16x32_bf16 v[144:147], a[180:183], a[40:43], v[144:147]
  buffer_load_dwordx4 a[100:103], v137, s[36:39], s51 offen offset:1024 sc1
  ds_read_b64_tr_b16 a[210:211], v240 offset:36864
  v_mfma_f32_16x16x32_bf16 v[148:151], a[180:183], a[44:47], v[148:151]
  ds_read_b64_tr_b16 a[212:213], v240 offset:40960
  v_mfma_f32_16x16x32_bf16 v[148:151], a[176:179], a[36:39], v[148:151]
  s_waitcnt lgkmcnt(11)
  ds_read_b64_tr_b16 a[214:215], v240 offset:45056
  v_mfma_f32_16x16x32_bf16 v[156:159], a[184:187], a[36:39], v[156:159]
  buffer_load_dwordx4 v135, s[24:27], s50 offen offset:2048 lds
  ds_read_b64_tr_b16 a[176:177], v241 offset:32768
  v_mfma_f32_16x16x32_bf16 v[156:159], a[188:191], a[44:47], v[156:159]
  ds_read_b64_tr_b16 a[178:179], v241 offset:36864
  v_mfma_f32_16x16x32_bf16 v[152:155], a[188:191], a[40:43], v[152:155]
  ds_read_b64_tr_b16 a[180:181], v241 offset:40960
  v_mfma_f32_16x16x32_bf16 v[152:155], a[184:187], a[32:35], v[152:155]
  s_waitcnt lgkmcnt(11)
  ds_read_b64_tr_b16 a[182:183], v241 offset:45056
  v_mfma_f32_16x16x32_bf16 v[160:163], a[192:195], a[32:35], v[160:163]
  buffer_load_dwordx4 a[104:107], v137, s[36:39], s51 offen offset:2048 sc1
  ds_read_b64_tr_b16 a[184:185], v242 offset:32768
  v_mfma_f32_16x16x32_bf16 v[160:163], a[196:199], a[40:43], v[160:163]
  ds_read_b64_tr_b16 a[186:187], v242 offset:36864
  v_mfma_f32_16x16x32_bf16 v[164:167], a[196:199], a[44:47], v[164:167]
  ds_read_b64_tr_b16 a[188:189], v242 offset:40960
  v_mfma_f32_16x16x32_bf16 v[164:167], a[192:195], a[36:39], v[164:167]
  s_waitcnt lgkmcnt(11)
  ds_read_b64_tr_b16 a[190:191], v242 offset:45056
  v_mfma_f32_16x16x32_bf16 v[172:175], a[200:203], a[36:39], v[172:175]
  buffer_load_dwordx4 v136, s[24:27], s50 offen offset:3072 lds
  ds_read_b64_tr_b16 a[192:193], v243 offset:32768
  v_mfma_f32_16x16x32_bf16 v[172:175], a[204:207], a[44:47], v[172:175]
  ds_read_b64_tr_b16 a[194:195], v243 offset:36864
  v_mfma_f32_16x16x32_bf16 v[168:171], a[204:207], a[40:43], v[168:171]
  ds_read_b64_tr_b16 a[196:197], v243 offset:40960
  v_mfma_f32_16x16x32_bf16 v[168:171], a[200:203], a[32:35], v[168:171]
  s_waitcnt vmcnt(23) lgkmcnt(11)
  ds_read_b64_tr_b16 a[198:199], v243 offset:45056
  v_mfma_f32_16x16x32_bf16 v[32:35], a[208:211], a[48:51], v[32:35]
  buffer_load_dwordx4 a[108:111], v137, s[36:39], s51 offen offset:3072 sc1
  s_cmp_eq_u32 s83, 1
  v_mfma_f32_16x16x32_bf16 v[32:35], a[212:215], a[56:59], v[32:35]
  s_cselect_b32 s80, 33, 19
  s_lshl_b32 s50, s80, 16
  s_add_u32 m0, s73, 98304
  v_mfma_f32_16x16x32_bf16 v[36:39], a[212:215], a[60:63], v[36:39]
  ds_read_b64_tr_b16 a[200:201], v240 offset:34816
  ds_read_b64_tr_b16 a[202:203], v240 offset:38912
  v_mfma_f32_16x16x32_bf16 v[36:39], a[208:211], a[52:55], v[36:39]
  s_waitcnt lgkmcnt(10)
  ds_read_b64_tr_b16 a[204:205], v240 offset:43008
  ds_read_b64_tr_b16 a[206:207], v240 offset:47104
  v_mfma_f32_16x16x32_bf16 v[44:47], a[176:179], a[52:55], v[44:47]
  buffer_load_dwordx4 v133, s[24:27], s50 offen offset:0 lds
  s_lshl_b32 s51, s80, 11
  v_mfma_f32_16x16x32_bf16 v[44:47], a[180:183], a[60:63], v[44:47]
  ds_read_b64_tr_b16 a[208:209], v241 offset:34816
  ds_read_b64_tr_b16 a[210:211], v241 offset:38912
  v_mfma_f32_16x16x32_bf16 v[40:43], a[180:183], a[56:59], v[40:43]
  ds_read_b64_tr_b16 a[212:213], v241 offset:43008
  v_mfma_f32_16x16x32_bf16 v[40:43], a[176:179], a[48:51], v[40:43]
  s_waitcnt vmcnt(18) lgkmcnt(11)
  s_barrier
  ds_read_b64_tr_b16 a[214:215], v241 offset:47104
  v_mfma_f32_16x16x32_bf16 v[48:51], a[184:187], a[48:51], v[48:51]
  buffer_load_dwordx4 a[112:115], v137, s[36:39], s51 offen offset:0 sc1
  ds_read_b64_tr_b16 a[176:177], v242 offset:34816
  v_mfma_f32_16x16x32_bf16 v[48:51], a[188:191], a[56:59], v[48:51]
  ds_read_b64_tr_b16 a[178:179], v242 offset:38912
  v_mfma_f32_16x16x32_bf16 v[52:55], a[188:191], a[60:63], v[52:55]
  ds_read_b64_tr_b16 a[180:181], v242 offset:43008
  v_mfma_f32_16x16x32_bf16 v[52:55], a[184:187], a[52:55], v[52:55]
  s_waitcnt lgkmcnt(11)
  buffer_load_dwordx4 v134, s[24:27], s50 offen offset:1024 lds
  ds_read_b64_tr_b16 a[182:183], v242 offset:47104
  v_mfma_f32_16x16x32_bf16 v[60:63], a[192:195], a[52:55], v[60:63]
  ds_read_b64_tr_b16 a[184:185], v243 offset:34816
  v_mfma_f32_16x16x32_bf16 v[60:63], a[196:199], a[60:63], v[60:63]
  ds_read_b64_tr_b16 a[186:187], v243 offset:38912
  v_mfma_f32_16x16x32_bf16 v[56:59], a[196:199], a[56:59], v[56:59]
  ds_read_b64_tr_b16 a[188:189], v243 offset:43008
  v_mfma_f32_16x16x32_bf16 v[56:59], a[192:195], a[48:51], v[56:59]
  s_waitcnt lgkmcnt(11)
  buffer_load_dwordx4 a[116:119], v137, s[36:39], s51 offen offset:1024 sc1
  ds_read_b64_tr_b16 a[190:191], v243 offset:47104
  v_mfma_f32_16x16x32_bf16 v[144:147], a[200:203], a[48:51], v[144:147]
  ds_read_b64_tr_b16 a[192:193], v240 offset:49152
  v_mfma_f32_16x16x32_bf16 v[144:147], a[204:207], a[56:59], v[144:147]
  ds_read_b64_tr_b16 a[194:195], v240 offset:53248
  v_mfma_f32_16x16x32_bf16 v[148:151], a[204:207], a[60:63], v[148:151]
  ds_read_b64_tr_b16 a[196:197], v240 offset:57344
  v_mfma_f32_16x16x32_bf16 v[148:151], a[200:203], a[52:55], v[148:151]
  s_waitcnt lgkmcnt(11)
  buffer_load_dwordx4 v135, s[24:27], s50 offen offset:2048 lds
  ds_read_b64_tr_b16 a[198:199], v240 offset:61440
  v_mfma_f32_16x16x32_bf16 v[156:159], a[208:211], a[52:55], v[156:159]
  ds_read_b64_tr_b16 a[200:201], v241 offset:49152
  v_mfma_f32_16x16x32_bf16 v[156:159], a[212:215], a[60:63], v[156:159]
  ds_read_b64_tr_b16 a[202:203], v241 offset:53248
  v_mfma_f32_16x16x32_bf16 v[152:155], a[212:215], a[56:59], v[152:155]
  ds_read_b64_tr_b16 a[204:205], v241 offset:57344
  v_mfma_f32_16x16x32_bf16 v[152:155], a[208:211], a[48:51], v[152:155]
  s_waitcnt lgkmcnt(11)
  buffer_load_dwordx4 a[120:123], v137, s[36:39], s51 offen offset:2048 sc1
  ds_read_b64_tr_b16 a[206:207], v241 offset:61440
  v_mfma_f32_16x16x32_bf16 v[160:163], a[176:179], a[48:51], v[160:163]
  ds_read_b64_tr_b16 a[208:209], v242 offset:49152
  v_mfma_f32_16x16x32_bf16 v[160:163], a[180:183], a[56:59], v[160:163]
  ds_read_b64_tr_b16 a[210:211], v242 offset:53248
  v_mfma_f32_16x16x32_bf16 v[164:167], a[180:183], a[60:63], v[164:167]
  ds_read_b64_tr_b16 a[212:213], v242 offset:57344
  v_mfma_f32_16x16x32_bf16 v[164:167], a[176:179], a[52:55], v[164:167]
  s_waitcnt lgkmcnt(11)
  buffer_load_dwordx4 v136, s[24:27], s50 offen offset:3072 lds
  ds_read_b64_tr_b16 a[214:215], v242 offset:61440
  v_mfma_f32_16x16x32_bf16 v[172:175], a[184:187], a[52:55], v[172:175]
  ds_read_b64_tr_b16 a[176:177], v243 offset:49152
  v_mfma_f32_16x16x32_bf16 v[172:175], a[188:191], a[60:63], v[172:175]
  ds_read_b64_tr_b16 a[178:179], v243 offset:53248
  v_mfma_f32_16x16x32_bf16 v[168:171], a[188:191], a[56:59], v[168:171]
  buffer_load_dwordx4 a[124:127], v137, s[36:39], s51 offen offset:3072 sc1
  s_cmp_eq_u32 s83, 2
  v_mfma_f32_16x16x32_bf16 v[168:171], a[184:187], a[48:51], v[168:171]
  s_waitcnt vmcnt(24) lgkmcnt(10)
  s_cselect_b32 s81, 36, 22
  s_lshl_b32 s50, s81, 16
  v_mfma_f32_16x16x32_bf16 v[32:35], a[192:195], a[64:67], v[32:35]
  s_add_u32 m0, s73, 114688
  ds_read_b64_tr_b16 a[180:181], v243 offset:57344
  ds_read_b64_tr_b16 a[182:183], v243 offset:61440
  v_mfma_f32_16x16x32_bf16 v[32:35], a[196:199], a[72:75], v[32:35]
  ds_read_b64_tr_b16 a[184:185], v240 offset:51200
  ds_read_b64_tr_b16 a[186:187], v240 offset:55296
  v_mfma_f32_16x16x32_bf16 v[36:39], a[196:199], a[76:79], v[36:39]
  buffer_load_dwordx4 v133, s[24:27], s50 offen offset:0 lds
  s_lshl_b32 s51, s81, 11
  v_mfma_f32_16x16x32_bf16 v[36:39], a[192:195], a[68:71], v[36:39]
  s_waitcnt lgkmcnt(10)
  ds_read_b64_tr_b16 a[188:189], v240 offset:59392
  ds_read_b64_tr_b16 a[190:191], v240 offset:63488
  v_mfma_f32_16x16x32_bf16 v[44:47], a[200:203], a[68:71], v[44:47]
  ds_read_b64_tr_b16 a[192:193], v241 offset:51200
  v_mfma_f32_16x16x32_bf16 v[44:47], a[204:207], a[76:79], v[44:47]
  ds_read_b64_tr_b16 a[194:195], v241 offset:55296
  v_mfma_f32_16x16x32_bf16 v[40:43], a[204:207], a[72:75], v[40:43]
  buffer_load_dwordx4 a[216:219], v137, s[36:39], s51 offen offset:0 sc1
  ds_read_b64_tr_b16 a[196:197], v241 offset:59392
  v_mfma_f32_16x16x32_bf16 v[40:43], a[200:203], a[64:67], v[40:43]
  s_waitcnt vmcnt(19) lgkmcnt(11)
  s_barrier
  ds_read_b64_tr_b16 a[198:199], v241 offset:63488
  v_mfma_f32_16x16x32_bf16 v[48:51], a[208:211], a[64:67], v[48:51]
  ds_read_b64_tr_b16 a[200:201], v242 offset:51200
  v_mfma_f32_16x16x32_bf16 v[48:51], a[212:215], a[72:75], v[48:51]
  ds_read_b64_tr_b16 a[202:203], v242 offset:55296
  v_mfma_f32_16x16x32_bf16 v[52:55], a[212:215], a[76:79], v[52:55]
  buffer_load_dwordx4 v134, s[24:27], s50 offen offset:1024 lds
  ds_read_b64_tr_b16 a[204:205], v242 offset:59392
  v_mfma_f32_16x16x32_bf16 v[52:55], a[208:211], a[68:71], v[52:55]
  s_waitcnt lgkmcnt(11)
  ds_read_b64_tr_b16 a[206:207], v242 offset:63488
  v_mfma_f32_16x16x32_bf16 v[60:63], a[176:179], a[68:71], v[60:63]
  ds_read_b64_tr_b16 a[208:209], v243 offset:51200
  v_mfma_f32_16x16x32_bf16 v[60:63], a[180:183], a[76:79], v[60:63]
  ds_read_b64_tr_b16 a[210:211], v243 offset:55296
  v_mfma_f32_16x16x32_bf16 v[56:59], a[180:183], a[72:75], v[56:59]
  buffer_load_dwordx4 a[220:223], v137, s[36:39], s51 offen offset:1024 sc1
  ds_read_b64_tr_b16 a[212:213], v243 offset:59392
  v_mfma_f32_16x16x32_bf16 v[56:59], a[176:179], a[64:67], v[56:59]
  s_waitcnt lgkmcnt(11)
  ds_read_b64_tr_b16 a[214:215], v243 offset:63488
  v_mfma_f32_16x16x32_bf16 v[144:147], a[184:187], a[64:67], v[144:147]
  ds_read_b64_tr_b16 a[176:177], v244 offset:0
  v_mfma_f32_16x16x32_bf16 v[144:147], a[188:191], a[72:75], v[144:147]
  buffer_load_dwordx4 v135, s[24:27], s50 offen offset:2048 lds
  ds_read_b64_tr_b16 a[178:179], v244 offset:4096
  v_mfma_f32_16x16x32_bf16 v[148:151], a[188:191], a[76:79], v[148:151]
  ds_read_b64_tr_b16 a[180:181], v244 offset:8192
  v_mfma_f32_16x16x32_bf16 v[148:151], a[184:187], a[68:71], v[148:151]
  s_waitcnt lgkmcnt(11)
  ds_read_b64_tr_b16 a[182:183], v244 offset:12288
  v_mfma_f32_16x16x32_bf16 v[156:159], a[192:195], a[68:71], v[156:159]
  ds_read_b64_tr_b16 a[184:185], v245 offset:0
  v_mfma_f32_16x16x32_bf16 v[156:159], a[196:199], a[76:79], v[156:159]
  buffer_load_dwordx4 a[224:227], v137, s[36:39], s51 offen offset:2048 sc1
  ds_read_b64_tr_b16 a[186:187], v245 offset:4096
  v_mfma_f32_16x16x32_bf16 v[152:155], a[196:199], a[72:75], v[152:155]
  ds_read_b64_tr_b16 a[188:189], v245 offset:8192
  v_mfma_f32_16x16x32_bf16 v[152:155], a[192:195], a[64:67], v[152:155]
  s_waitcnt lgkmcnt(11)
  ds_read_b64_tr_b16 a[190:191], v245 offset:12288
  v_mfma_f32_16x16x32_bf16 v[160:163], a[200:203], a[64:67], v[160:163]
  ds_read_b64_tr_b16 a[192:193], v246 offset:0
  v_mfma_f32_16x16x32_bf16 v[160:163], a[204:207], a[72:75], v[160:163]
  buffer_load_dwordx4 v136, s[24:27], s50 offen offset:3072 lds
  ds_read_b64_tr_b16 a[194:195], v246 offset:4096
  v_mfma_f32_16x16x32_bf16 v[164:167], a[204:207], a[76:79], v[164:167]
  ds_read_b64_tr_b16 a[196:197], v246 offset:8192
  v_mfma_f32_16x16x32_bf16 v[164:167], a[200:203], a[68:71], v[164:167]
  s_waitcnt lgkmcnt(11)
  ds_read_b64_tr_b16 a[198:199], v246 offset:12288
  v_mfma_f32_16x16x32_bf16 v[172:175], a[208:211], a[68:71], v[172:175]
  ds_read_b64_tr_b16 a[200:201], v247 offset:0
  v_mfma_f32_16x16x32_bf16 v[172:175], a[212:215], a[76:79], v[172:175]
  buffer_load_dwordx4 a[228:231], v137, s[36:39], s51 offen offset:3072 sc1
  s_cmp_eq_u32 s83, 3
  v_mfma_f32_16x16x32_bf16 v[168:171], a[212:215], a[72:75], v[168:171]
  s_cselect_b32 s82, 40, 26
  s_lshl_b32 s50, s82, 16
  s_add_u32 m0, s73, 131072
  v_mfma_f32_16x16x32_bf16 v[168:171], a[208:211], a[64:67], v[168:171]
  s_waitcnt vmcnt(24) lgkmcnt(9)
  ds_read_b64_tr_b16 a[202:203], v247 offset:4096
  ds_read_b64_tr_b16 a[204:205], v247 offset:8192
  v_mfma_f32_16x16x32_bf16 v[32:35], a[176:179], a[80:83], v[32:35]
  ds_read_b64_tr_b16 a[206:207], v247 offset:12288
  ds_read_b64_tr_b16 a[208:209], v244 offset:2048
  v_mfma_f32_16x16x32_bf16 v[32:35], a[180:183], a[88:91], v[32:35]
  buffer_load_dwordx4 v133, s[24:27], s50 offen offset:0 lds
  s_lshl_b32 s51, s82, 11
  v_mfma_f32_16x16x32_bf16 v[36:39], a[180:183], a[92:95], v[36:39]
  ds_read_b64_tr_b16 a[210:211], v244 offset:6144
  ds_read_b64_tr_b16 a[212:213], v244 offset:10240
  v_mfma_f32_16x16x32_bf16 v[36:39], a[176:179], a[84:87], v[36:39]
  s_waitcnt lgkmcnt(11)
  ds_read_b64_tr_b16 a[214:215], v244 offset:14336
  v_mfma_f32_16x16x32_bf16 v[44:47], a[184:187], a[84:87], v[44:47]
  buffer_load_dwordx4 a[0:3], v137, s[36:39], s51 offen offset:0 sc1
  ds_read_b64_tr_b16 a[176:177], v245 offset:2048
  v_mfma_f32_16x16x32_bf16 v[44:47], a[188:191], a[92:95], v[44:47]
  ds_read_b64_tr_b16 a[178:179], v245 offset:6144
  v_mfma_f32_16x16x32_bf16 v[40:43], a[188:191], a[88:91], v[40:43]
  ds_read_b64_tr_b16 a[180:181], v245 offset:10240
  v_mfma_f32_16x16x32_bf16 v[40:43], a[184:187], a[80:83], v[40:43]
  s_waitcnt vmcnt(19) lgkmcnt(11)
  s_barrier
  ds_read_b64_tr_b16 a[182:183], v245 offset:14336
  v_mfma_f32_16x16x32_bf16 v[48:51], a[192:195], a[80:83], v[48:51]
  buffer_load_dwordx4 v134, s[24:27], s50 offen offset:1024 lds
  ds_read_b64_tr_b16 a[184:185], v246 offset:2048
  v_mfma_f32_16x16x32_bf16 v[48:51], a[196:199], a[88:91], v[48:51]
  ds_read_b64_tr_b16 a[186:187], v246 offset:6144
  v_mfma_f32_16x16x32_bf16 v[52:55], a[196:199], a[92:95], v[52:55]
  ds_read_b64_tr_b16 a[188:189], v246 offset:10240
  v_mfma_f32_16x16x32_bf16 v[52:55], a[192:195], a[84:87], v[52:55]
  s_waitcnt lgkmcnt(11)
  ds_read_b64_tr_b16 a[190:191], v246 offset:14336
  v_mfma_f32_16x16x32_bf16 v[60:63], a[200:203], a[84:87], v[60:63]
  buffer_load_dwordx4 a[4:7], v137, s[36:39], s51 offen offset:1024 sc1
  ds_read_b64_tr_b16 a[192:193], v247 offset:2048
  v_mfma_f32_16x16x32_bf16 v[60:63], a[204:207], a[92:95], v[60:63]
  ds_read_b64_tr_b16 a[194:195], v247 offset:6144
  v_mfma_f32_16x16x32_bf16 v[56:59], a[204:207], a[88:91], v[56:59]
  ds_read_b64_tr_b16 a[196:197], v247 offset:10240
  v_mfma_f32_16x16x32_bf16 v[56:59], a[200:203], a[80:83], v[56:59]
  s_waitcnt lgkmcnt(11)
  ds_read_b64_tr_b16 a[198:199], v247 offset:14336
  v_mfma_f32_16x16x32_bf16 v[144:147], a[208:211], a[80:83], v[144:147]
  buffer_load_dwordx4 v135, s[24:27], s50 offen offset:2048 lds
  ds_read_b64_tr_b16 a[200:201], v244 offset:16384
  v_mfma_f32_16x16x32_bf16 v[144:147], a[212:215], a[88:91], v[144:147]
  ds_read_b64_tr_b16 a[202:203], v244 offset:20480
  v_mfma_f32_16x16x32_bf16 v[148:151], a[212:215], a[92:95], v[148:151]
  ds_read_b64_tr_b16 a[204:205], v244 offset:24576
  v_mfma_f32_16x16x32_bf16 v[148:151], a[208:211], a[84:87], v[148:151]
  s_waitcnt lgkmcnt(11)
  ds_read_b64_tr_b16 a[206:207], v244 offset:28672
  v_mfma_f32_16x16x32_bf16 v[156:159], a[176:179], a[84:87], v[156:159]
  buffer_load_dwordx4 a[8:11], v137, s[36:39], s51 offen offset:2048 sc1
  ds_read_b64_tr_b16 a[208:209], v245 offset:16384
  v_mfma_f32_16x16x32_bf16 v[156:159], a[180:183], a[92:95], v[156:159]
  ds_read_b64_tr_b16 a[210:211], v245 offset:20480
  v_mfma_f32_16x16x32_bf16 v[152:155], a[180:183], a[88:91], v[152:155]
  ds_read_b64_tr_b16 a[212:213], v245 offset:24576
  v_mfma_f32_16x16x32_bf16 v[152:155], a[176:179], a[80:83], v[152:155]
  s_waitcnt lgkmcnt(11)
  buffer_load_dwordx4 v136, s[24:27], s50 offen offset:3072 lds
  ds_read_b64_tr_b16 a[214:215], v245 offset:28672
  v_mfma_f32_16x16x32_bf16 v[160:163], a[184:187], a[80:83], v[160:163]
  ds_read_b64_tr_b16 a[176:177], v246 offset:16384
  v_mfma_f32_16x16x32_bf16 v[160:163], a[188:191], a[88:91], v[160:163]
  ds_read_b64_tr_b16 a[178:179], v246 offset:20480
  v_mfma_f32_16x16x32_bf16 v[164:167], a[188:191], a[92:95], v[164:167]
  ds_read_b64_tr_b16 a[180:181], v246 offset:24576
  v_mfma_f32_16x16x32_bf16 v[164:167], a[184:187], a[84:87], v[164:167]
  s_waitcnt lgkmcnt(11)
  buffer_load_dwordx4 a[12:15], v137, s[36:39], s51 offen offset:3072 sc1
  s_cmp_eq_u32 s83, 0
  v_mfma_f32_16x16x32_bf16 v[172:175], a[192:195], a[84:87], v[172:175]
  s_cselect_b32 s70, 43, 29
  s_lshl_b32 s50, s70, 16
  s_add_u32 m0, s73, 0
  v_mfma_f32_16x16x32_bf16 v[172:175], a[196:199], a[92:95], v[172:175]
  ds_read_b64_tr_b16 a[182:183], v246 offset:28672
  ds_read_b64_tr_b16 a[184:185], v247 offset:16384
  v_mfma_f32_16x16x32_bf16 v[168:171], a[196:199], a[88:91], v[168:171]
  ds_read_b64_tr_b16 a[186:187], v247 offset:20480
  ds_read_b64_tr_b16 a[188:189], v247 offset:24576
  v_mfma_f32_16x16x32_bf16 v[168:171], a[192:195], a[80:83], v[168:171]
  s_waitcnt vmcnt(24) lgkmcnt(11)
  buffer_load_dwordx4 v133, s[24:27], s50 offen offset:0 lds
  s_lshl_b32 s51, s70, 11
  v_mfma_f32_16x16x32_bf16 v[32:35], a[200:203], a[96:99], v[32:35]
  ds_read_b64_tr_b16 a[190:191], v247 offset:28672
  ds_read_b64_tr_b16 a[192:193], v244 offset:18432
  v_mfma_f32_16x16x32_bf16 v[32:35], a[204:207], a[104:107], v[32:35]
  ds_read_b64_tr_b16 a[194:195], v244 offset:22528
  v_mfma_f32_16x16x32_bf16 v[36:39], a[204:207], a[108:111], v[36:39]
  ds_read_b64_tr_b16 a[196:197], v244 offset:26624
  v_mfma_f32_16x16x32_bf16 v[36:39], a[200:203], a[100:103], v[36:39]
  s_waitcnt lgkmcnt(11)
  buffer_load_dwordx4 a[16:19], v137, s[36:39], s51 offen offset:0 sc1
  ds_read_b64_tr_b16 a[198:199], v244 offset:30720
  v_mfma_f32_16x16x32_bf16 v[44:47], a[208:211], a[100:103], v[44:47]
  ds_read_b64_tr_b16 a[200:201], v245 offset:18432
  v_mfma_f32_16x16x32_bf16 v[44:47], a[212:215], a[108:111], v[44:47]
  ds_read_b64_tr_b16 a[202:203], v245 offset:22528
  v_mfma_f32_16x16x32_bf16 v[40:43], a[212:215], a[104:107], v[40:43]
  ds_read_b64_tr_b16 a[204:205], v245 offset:26624
  v_mfma_f32_16x16x32_bf16 v[40:43], a[208:211], a[96:99], v[40:43]
  s_waitcnt vmcnt(19) lgkmcnt(11)
  s_barrier
  buffer_load_dwordx4 v134, s[24:27], s50 offen offset:1024 lds
  v_mfma_f32_16x16x32_bf16 v[48:51], a[176:179], a[96:99], v[48:51]
  ds_read_b64_tr_b16 a[206:207], v245 offset:30720
  ds_read_b64_tr_b16 a[208:209], v246 offset:18432
  v_mfma_f32_16x16x32_bf16 v[48:51], a[180:183], a[104:107], v[48:51]
  ds_read_b64_tr_b16 a[210:211], v246 offset:22528
  v_mfma_f32_16x16x32_bf16 v[52:55], a[180:183], a[108:111], v[52:55]
  buffer_load_dwordx4 a[20:23], v137, s[36:39], s51 offen offset:1024 sc1
  ds_read_b64_tr_b16 a[212:213], v246 offset:26624
  v_mfma_f32_16x16x32_bf16 v[52:55], a[176:179], a[100:103], v[52:55]
  s_waitcnt lgkmcnt(11)
  ds_read_b64_tr_b16 a[214:215], v246 offset:30720
  v_mfma_f32_16x16x32_bf16 v[60:63], a[184:187], a[100:103], v[60:63]
  ds_read_b64_tr_b16 a[176:177], v247 offset:18432
  v_mfma_f32_16x16x32_bf16 v[60:63], a[188:191], a[108:111], v[60:63]
  ds_read_b64_tr_b16 a[178:179], v247 offset:22528
  v_mfma_f32_16x16x32_bf16 v[56:59], a[188:191], a[104:107], v[56:59]
  buffer_load_dwordx4 v135, s[24:27], s50 offen offset:2048 lds
  ds_read_b64_tr_b16 a[180:181], v247 offset:26624
  v_mfma_f32_16x16x32_bf16 v[56:59], a[184:187], a[96:99], v[56:59]
  s_waitcnt lgkmcnt(11)
  ds_read_b64_tr_b16 a[182:183], v247 offset:30720
  v_mfma_f32_16x16x32_bf16 v[144:147], a[192:195], a[96:99], v[144:147]
  ds_read_b64_tr_b16 a[184:185], v244 offset:32768
  v_mfma_f32_16x16x32_bf16 v[144:147], a[196:199], a[104:107], v[144:147]
  ds_read_b64_tr_b16 a[186:187], v244 offset:36864
  v_mfma_f32_16x16x32_bf16 v[148:151], a[196:199], a[108:111], v[148:151]
  buffer_load_dwordx4 a[24:27], v137, s[36:39], s51 offen offset:2048 sc1
  ds_read_b64_tr_b16 a[188:189], v244 offset:40960
  v_mfma_f32_16x16x32_bf16 v[148:151], a[192:195], a[100:103], v[148:151]
  s_waitcnt lgkmcnt(11)
  ds_read_b64_tr_b16 a[190:191], v244 offset:45056
  v_mfma_f32_16x16x32_bf16 v[156:159], a[200:203], a[100:103], v[156:159]
  ds_read_b64_tr_b16 a[192:193], v245 offset:32768
  v_mfma_f32_16x16x32_bf16 v[156:159], a[204:207], a[108:111], v[156:159]
  ds_read_b64_tr_b16 a[194:195], v245 offset:36864
  v_mfma_f32_16x16x32_bf16 v[152:155], a[204:207], a[104:107], v[152:155]
  buffer_load_dwordx4 v136, s[24:27], s50 offen offset:3072 lds
  ds_read_b64_tr_b16 a[196:197], v245 offset:40960
  v_mfma_f32_16x16x32_bf16 v[152:155], a[200:203], a[96:99], v[152:155]
  s_waitcnt lgkmcnt(11)
  ds_read_b64_tr_b16 a[198:199], v245 offset:45056
  v_mfma_f32_16x16x32_bf16 v[160:163], a[208:211], a[96:99], v[160:163]
  ds_read_b64_tr_b16 a[200:201], v246 offset:32768
  v_mfma_f32_16x16x32_bf16 v[160:163], a[212:215], a[104:107], v[160:163]
  ds_read_b64_tr_b16 a[202:203], v246 offset:36864
  v_mfma_f32_16x16x32_bf16 v[164:167], a[212:215], a[108:111], v[164:167]
  buffer_load_dwordx4 a[28:31], v137, s[36:39], s51 offen offset:3072 sc1
  s_cmp_eq_u32 s83, 1
  v_mfma_f32_16x16x32_bf16 v[164:167], a[208:211], a[100:103], v[164:167]
  s_waitcnt lgkmcnt(10)
  s_cselect_b32 s74, 47, 33
  s_lshl_b32 s51, s74, 11
  v_mfma_f32_16x16x32_bf16 v[172:175], a[176:179], a[100:103], v[172:175]
  ds_read_b64_tr_b16 a[204:205], v246 offset:40960
  ds_read_b64_tr_b16 a[206:207], v246 offset:45056
  v_mfma_f32_16x16x32_bf16 v[172:175], a[180:183], a[108:111], v[172:175]
  ds_read_b64_tr_b16 a[208:209], v247 offset:32768
  buffer_load_dwordx4 a[32:35], v137, s[36:39], s51 offen offset:0 sc1
  v_mfma_f32_16x16x32_bf16 v[168:171], a[180:183], a[104:107], v[168:171]
  ds_read_b64_tr_b16 a[210:211], v247 offset:36864
  ds_read_b64_tr_b16 a[212:213], v247 offset:40960
  v_mfma_f32_16x16x32_bf16 v[168:171], a[176:179], a[96:99], v[168:171]
  s_waitcnt vmcnt(25) lgkmcnt(11)
  ds_read_b64_tr_b16 a[214:215], v247 offset:45056
  v_mfma_f32_16x16x32_bf16 v[32:35], a[184:187], a[112:115], v[32:35]
  ds_read_b64_tr_b16 a[176:177], v244 offset:34816
  v_mfma_f32_16x16x32_bf16 v[32:35], a[188:191], a[120:123], v[32:35]
  buffer_load_dwordx4 a[36:39], v137, s[36:39], s51 offen offset:1024 sc1
  s_lshl_b32 s50, s74, 16
  v_mfma_f32_16x16x32_bf16 v[36:39], a[188:191], a[124:127], v[36:39]
  s_add_u32 m0, s73, 16384
  ds_read_b64_tr_b16 a[178:179], v244 offset:38912
  ds_read_b64_tr_b16 a[180:181], v244 offset:43008
  v_mfma_f32_16x16x32_bf16 v[36:39], a[184:187], a[116:119], v[36:39]
  s_waitcnt lgkmcnt(11)
  ds_read_b64_tr_b16 a[182:183], v244 offset:47104
  v_mfma_f32_16x16x32_bf16 v[44:47], a[192:195], a[116:119], v[44:47]
  ds_read_b64_tr_b16 a[184:185], v245 offset:34816
  v_mfma_f32_16x16x32_bf16 v[44:47], a[196:199], a[124:127], v[44:47]
  buffer_load_dwordx4 v135, s[24:27], s50 offen offset:2048 lds
  ds_read_b64_tr_b16 a[186:187], v245 offset:38912
  v_mfma_f32_16x16x32_bf16 v[40:43], a[196:199], a[120:123], v[40:43]
  ds_read_b64_tr_b16 a[188:189], v245 offset:43008
  v_mfma_f32_16x16x32_bf16 v[40:43], a[192:195], a[112:115], v[40:43]
  s_waitcnt vmcnt(20) lgkmcnt(11)
  s_barrier
  ds_read_b64_tr_b16 a[190:191], v245 offset:47104
  v_mfma_f32_16x16x32_bf16 v[48:51], a[200:203], a[112:115], v[48:51]
  ds_read_b64_tr_b16 a[192:193], v246 offset:34816
  v_mfma_f32_16x16x32_bf16 v[48:51], a[204:207], a[120:123], v[48:51]
  buffer_load_dwordx4 a[40:43], v137, s[36:39], s51 offen offset:2048 sc1
  ds_read_b64_tr_b16 a[194:195], v246 offset:38912
  v_mfma_f32_16x16x32_bf16 v[52:55], a[204:207], a[124:127], v[52:55]
  ds_read_b64_tr_b16 a[196:197], v246 offset:43008
  v_mfma_f32_16x16x32_bf16 v[52:55], a[200:203], a[116:119], v[52:55]
  s_waitcnt lgkmcnt(11)
  ds_read_b64_tr_b16 a[198:199], v246 offset:47104
  v_mfma_f32_16x16x32_bf16 v[60:63], a[208:211], a[116:119], v[60:63]
  ds_read_b64_tr_b16 a[200:201], v247 offset:34816
  v_mfma_f32_16x16x32_bf16 v[60:63], a[212:215], a[124:127], v[60:63]
  buffer_load_dwordx4 v136, s[24:27], s50 offen offset:3072 lds
  ds_read_b64_tr_b16 a[202:203], v247 offset:38912
  v_mfma_f32_16x16x32_bf16 v[56:59], a[212:215], a[120:123], v[56:59]
  ds_read_b64_tr_b16 a[204:205], v247 offset:43008
  v_mfma_f32_16x16x32_bf16 v[56:59], a[208:211], a[112:115], v[56:59]
  s_waitcnt lgkmcnt(11)
  ds_read_b64_tr_b16 a[206:207], v247 offset:47104
  v_mfma_f32_16x16x32_bf16 v[144:147], a[176:179], a[112:115], v[144:147]
  ds_read_b64_tr_b16 a[208:209], v244 offset:49152
  v_mfma_f32_16x16x32_bf16 v[144:147], a[180:183], a[120:123], v[144:147]
  buffer_load_dwordx4 a[44:47], v137, s[36:39], s51 offen offset:3072 sc1
  s_cmp_eq_u32 s83, 2
  v_mfma_f32_16x16x32_bf16 v[148:151], a[180:183], a[124:127], v[148:151]
  s_cselect_b32 s75, 50, 36
  s_lshl_b32 s51, s75, 11
  ds_read_b64_tr_b16 a[210:211], v244 offset:53248
  v_mfma_f32_16x16x32_bf16 v[148:151], a[176:179], a[116:119], v[148:151]
  s_waitcnt lgkmcnt(10)
  ds_read_b64_tr_b16 a[212:213], v244 offset:57344
  ds_read_b64_tr_b16 a[214:215], v244 offset:61440
  v_mfma_f32_16x16x32_bf16 v[156:159], a[184:187], a[116:119], v[156:159]
  buffer_load_dwordx4 a[48:51], v137, s[36:39], s51 offen offset:0 sc1
  ds_read_b64_tr_b16 a[176:177], v245 offset:49152
  v_mfma_f32_16x16x32_bf16 v[156:159], a[188:191], a[124:127], v[156:159]
  ds_read_b64_tr_b16 a[178:179], v245 offset:53248
  v_mfma_f32_16x16x32_bf16 v[152:155], a[188:191], a[120:123], v[152:155]
  ds_read_b64_tr_b16 a[180:181], v245 offset:57344
  v_mfma_f32_16x16x32_bf16 v[152:155], a[184:187], a[112:115], v[152:155]
  s_waitcnt lgkmcnt(11)
  ds_read_b64_tr_b16 a[182:183], v245 offset:61440
  v_mfma_f32_16x16x32_bf16 v[160:163], a[192:195], a[112:115], v[160:163]
  buffer_load_dwordx4 a[52:55], v137, s[36:39], s51 offen offset:1024 sc1
  s_lshl_b32 s50, s75, 16
  v_mfma_f32_16x16x32_bf16 v[160:163], a[196:199], a[120:123], v[160:163]
  s_add_u32 m0, s73, 32768
  ds_read_b64_tr_b16 a[184:185], v246 offset:49152
  ds_read_b64_tr_b16 a[186:187], v246 offset:53248
  v_mfma_f32_16x16x32_bf16 v[164:167], a[196:199], a[124:127], v[164:167]
  ds_read_b64_tr_b16 a[188:189], v246 offset:57344
  v_mfma_f32_16x16x32_bf16 v[164:167], a[192:195], a[116:119], v[164:167]
  s_waitcnt lgkmcnt(11)
  ds_read_b64_tr_b16 a[190:191], v246 offset:61440
  v_mfma_f32_16x16x32_bf16 v[172:175], a[200:203], a[116:119], v[172:175]
  buffer_load_dwordx4 v135, s[24:27], s50 offen offset:2048 lds
  ds_read_b64_tr_b16 a[192:193], v247 offset:49152
  v_mfma_f32_16x16x32_bf16 v[172:175], a[204:207], a[124:127], v[172:175]
  ds_read_b64_tr_b16 a[194:195], v247 offset:53248
  v_mfma_f32_16x16x32_bf16 v[168:171], a[204:207], a[120:123], v[168:171]
  ds_read_b64_tr_b16 a[196:197], v247 offset:57344
  v_mfma_f32_16x16x32_bf16 v[168:171], a[200:203], a[112:115], v[168:171]
  s_waitcnt vmcnt(25) lgkmcnt(11)
  ds_read_b64_tr_b16 a[198:199], v247 offset:61440
  v_mfma_f32_16x16x32_bf16 v[32:35], a[208:211], a[216:219], v[32:35]
  buffer_load_dwordx4 a[56:59], v137, s[36:39], s51 offen offset:2048 sc1
  ds_read_b64_tr_b16 a[200:201], v244 offset:51200
  v_mfma_f32_16x16x32_bf16 v[32:35], a[212:215], a[224:227], v[32:35]
  ds_read_b64_tr_b16 a[202:203], v244 offset:55296
  v_mfma_f32_16x16x32_bf16 v[36:39], a[212:215], a[228:231], v[36:39]
  ds_read_b64_tr_b16 a[204:205], v244 offset:59392
  v_mfma_f32_16x16x32_bf16 v[36:39], a[208:211], a[220:223], v[36:39]
  s_waitcnt lgkmcnt(11)
  ds_read_b64_tr_b16 a[206:207], v244 offset:63488
  v_mfma_f32_16x16x32_bf16 v[44:47], a[176:179], a[220:223], v[44:47]
  buffer_load_dwordx4 v136, s[24:27], s50 offen offset:3072 lds
  ds_read_b64_tr_b16 a[208:209], v245 offset:51200
  v_mfma_f32_16x16x32_bf16 v[44:47], a[180:183], a[228:231], v[44:47]
  ds_read_b64_tr_b16 a[210:211], v245 offset:55296
  v_mfma_f32_16x16x32_bf16 v[40:43], a[180:183], a[224:227], v[40:43]
  ds_read_b64_tr_b16 a[212:213], v245 offset:59392
  v_mfma_f32_16x16x32_bf16 v[40:43], a[176:179], a[216:219], v[40:43]
  s_waitcnt vmcnt(20) lgkmcnt(11)
  s_barrier
  buffer_load_dwordx4 a[60:63], v137, s[36:39], s51 offen offset:3072 sc1
  v_mfma_f32_16x16x32_bf16 v[48:51], a[184:187], a[216:219], v[48:51]
  s_cmp_eq_u32 s83, 3
  s_cselect_b32 s76, 54, 40
  s_lshl_b32 s51, s76, 11
  v_mfma_f32_16x16x32_bf16 v[48:51], a[188:191], a[224:227], v[48:51]
Hb2_3:
  s_cbranch_execz Rb
  ds_read_b64_tr_b16 a[214:215], v245 offset:63488
  ds_read_b64_tr_b16 a[176:177], v246 offset:51200
  v_mfma_f32_16x16x32_bf16 v[52:55], a[188:191], a[228:231], v[52:55]
  ds_read_b64_tr_b16 a[178:179], v246 offset:55296
  ds_read_b64_tr_b16 a[180:181], v246 offset:59392
  v_mfma_f32_16x16x32_bf16 v[52:55], a[184:187], a[220:223], v[52:55]
  s_waitcnt lgkmcnt(11)
  buffer_load_dwordx4 a[64:67], v137, s[36:39], s51 offen offset:0 sc1
  ds_read_b64_tr_b16 a[182:183], v246 offset:63488
  v_mfma_f32_16x16x32_bf16 v[60:63], a[192:195], a[220:223], v[60:63]
  ds_read_b64_tr_b16 a[184:185], v247 offset:51200
  v_mfma_f32_16x16x32_bf16 v[60:63], a[196:199], a[228:231], v[60:63]
  ds_read_b64_tr_b16 a[186:187], v247 offset:55296
  v_mfma_f32_16x16x32_bf16 v[56:59], a[196:199], a[224:227], v[56:59]
  ds_read_b64_tr_b16 a[188:189], v247 offset:59392
  v_mfma_f32_16x16x32_bf16 v[56:59], a[192:195], a[216:219], v[56:59]
  s_waitcnt lgkmcnt(11)
  buffer_load_dwordx4 a[68:71], v137, s[36:39], s51 offen offset:1024 sc1
  s_lshl_b32 s50, s76, 16
  v_mfma_f32_16x16x32_bf16 v[144:147], a[200:203], a[216:219], v[144:147]
  s_add_u32 m0, s73, 49152
  ds_read_b64_tr_b16 a[190:191], v247 offset:63488
  ds_read_b64_tr_b16 a[192:193], v248 offset:0
  v_mfma_f32_16x16x32_bf16 v[144:147], a[204:207], a[224:227], v[144:147]
  ds_read_b64_tr_b16 a[194:195], v248 offset:4096
  v_mfma_f32_16x16x32_bf16 v[148:151], a[204:207], a[228:231], v[148:151]
  ds_read_b64_tr_b16 a[196:197], v248 offset:8192
  v_mfma_f32_16x16x32_bf16 v[148:151], a[200:203], a[220:223], v[148:151]
  s_waitcnt lgkmcnt(11)
  buffer_load_dwordx4 v135, s[24:27], s50 offen offset:2048 lds
  ds_read_b64_tr_b16 a[198:199], v248 offset:12288
  v_mfma_f32_16x16x32_bf16 v[156:159], a[208:211], a[220:223], v[156:159]
  ds_read_b64_tr_b16 a[200:201], v249 offset:0
  v_mfma_f32_16x16x32_bf16 v[156:159], a[212:215], a[228:231], v[156:159]
  ds_read_b64_tr_b16 a[202:203], v249 offset:4096
  v_mfma_f32_16x16x32_bf16 v[152:155], a[212:215], a[224:227], v[152:155]
  ds_read_b64_tr_b16 a[204:205], v249 offset:8192
  v_mfma_f32_16x16x32_bf16 v[152:155], a[208:211], a[216:219], v[152:155]
  s_waitcnt lgkmcnt(11)
  buffer_load_dwordx4 a[72:75], v137, s[36:39], s51 offen offset:2048 sc1
  ds_read_b64_tr_b16 a[206:207], v249 offset:12288
  v_mfma_f32_16x16x32_bf16 v[160:163], a[176:179], a[216:219], v[160:163]
  ds_read_b64_tr_b16 a[208:209], v250 offset:0
  v_mfma_f32_16x16x32_bf16 v[160:163], a[180:183], a[224:227], v[160:163]
  ds_read_b64_tr_b16 a[210:211], v250 offset:4096
  v_mfma_f32_16x16x32_bf16 v[164:167], a[180:183], a[228:231], v[164:167]
  buffer_load_dwordx4 v136, s[24:27], s50 offen offset:3072 lds
  ds_read_b64_tr_b16 a[212:213], v250 offset:8192
  v_mfma_f32_16x16x32_bf16 v[164:167], a[176:179], a[220:223], v[164:167]
  s_waitcnt lgkmcnt(11)
  ds_read_b64_tr_b16 a[214:215], v250 offset:12288
  v_mfma_f32_16x16x32_bf16 v[172:175], a[184:187], a[220:223], v[172:175]
  ds_read_b64_tr_b16 a[176:177], v251 offset:0
  v_mfma_f32_16x16x32_bf16 v[172:175], a[188:191], a[228:231], v[172:175]
  ds_read_b64_tr_b16 a[178:179], v251 offset:4096
  v_mfma_f32_16x16x32_bf16 v[168:171], a[188:191], a[224:227], v[168:171]
  buffer_load_dwordx4 a[76:79], v137, s[36:39], s51 offen offset:3072 sc1
  s_cmp_eq_u32 s83, 0
  v_mfma_f32_16x16x32_bf16 v[168:171], a[184:187], a[216:219], v[168:171]
  s_waitcnt vmcnt(26) lgkmcnt(10)
  s_cselect_b32 s77, 15, 43
  s_lshl_b32 s51, s77, 11
  v_mfma_f32_16x16x32_bf16 v[32:35], a[192:195], a[0:3], v[32:35]
  ds_read_b64_tr_b16 a[180:181], v251 offset:8192
  ds_read_b64_tr_b16 a[182:183], v251 offset:12288
  v_mfma_f32_16x16x32_bf16 v[32:35], a[196:199], a[8:11], v[32:35]
  ds_read_b64_tr_b16 a[184:185], v248 offset:2048
  ds_read_b64_tr_b16 a[186:187], v248 offset:6144
  v_mfma_f32_16x16x32_bf16 v[36:39], a[196:199], a[12:15], v[36:39]
  buffer_load_dwordx4 a[80:83], v137, s[36:39], s51 offen offset:0 sc1
  ds_read_b64_tr_b16 a[188:189], v248 offset:10240
  v_mfma_f32_16x16x32_bf16 v[36:39], a[192:195], a[4:7], v[36:39]
  s_waitcnt lgkmcnt(11)
  ds_read_b64_tr_b16 a[190:191], v248 offset:14336
  v_mfma_f32_16x16x32_bf16 v[44:47], a[200:203], a[4:7], v[44:47]
  ds_read_b64_tr_b16 a[192:193], v249 offset:2048
  v_mfma_f32_16x16x32_bf16 v[44:47], a[204:207], a[12:15], v[44:47]
  ds_read_b64_tr_b16 a[194:195], v249 offset:6144
  v_mfma_f32_16x16x32_bf16 v[40:43], a[204:207], a[8:11], v[40:43]
  buffer_load_dwordx4 a[84:87], v137, s[36:39], s51 offen offset:1024 sc1
  s_lshl_b32 s50, s77, 16
  v_mfma_f32_16x16x32_bf16 v[40:43], a[200:203], a[0:3], v[40:43]
  s_waitcnt vmcnt(21) lgkmcnt(10)
  s_barrier
  s_add_u32 m0, s73, 65536
  v_mfma_f32_16x16x32_bf16 v[48:51], a[208:211], a[0:3], v[48:51]
  ds_read_b64_tr_b16 a[196:197], v249 offset:10240
  ds_read_b64_tr_b16 a[198:199], v249 offset:14336
  v_mfma_f32_16x16x32_bf16 v[48:51], a[212:215], a[8:11], v[48:51]
  ds_read_b64_tr_b16 a[200:201], v250 offset:2048
  ds_read_b64_tr_b16 a[202:203], v250 offset:6144
  v_mfma_f32_16x16x32_bf16 v[52:55], a[212:215], a[12:15], v[52:55]
  buffer_load_dwordx4 v135, s[24:27], s50 offen offset:2048 lds
  ds_read_b64_tr_b16 a[204:205], v250 offset:10240
  v_mfma_f32_16x16x32_bf16 v[52:55], a[208:211], a[4:7], v[52:55]
  s_waitcnt lgkmcnt(11)
  ds_read_b64_tr_b16 a[206:207], v250 offset:14336
  v_mfma_f32_16x16x32_bf16 v[60:63], a[176:179], a[4:7], v[60:63]
  ds_read_b64_tr_b16 a[208:209], v251 offset:2048
  v_mfma_f32_16x16x32_bf16 v[60:63], a[180:183], a[12:15], v[60:63]
  buffer_load_dwordx4 a[88:91], v137, s[36:39], s51 offen offset:2048 sc1
  ds_read_b64_tr_b16 a[210:211], v251 offset:6144
  v_mfma_f32_16x16x32_bf16 v[56:59], a[180:183], a[8:11], v[56:59]
  ds_read_b64_tr_b16 a[212:213], v251 offset:10240
  v_mfma_f32_16x16x32_bf16 v[56:59], a[176:179], a[0:3], v[56:59]
  s_waitcnt lgkmcnt(11)
  ds_read_b64_tr_b16 a[214:215], v251 offset:14336
  v_mfma_f32_16x16x32_bf16 v[144:147], a[184:187], a[0:3], v[144:147]
  ds_read_b64_tr_b16 a[176:177], v240 offset:0
  v_mfma_f32_16x16x32_bf16 v[144:147], a[188:191], a[8:11], v[144:147]
  buffer_load_dwordx4 v136, s[24:27], s50 offen offset:3072 lds
  ds_read_b64_tr_b16 a[178:179], v240 offset:4096
  v_mfma_f32_16x16x32_bf16 v[148:151], a[188:191], a[12:15], v[148:151]
  ds_read_b64_tr_b16 a[180:181], v240 offset:8192
  v_mfma_f32_16x16x32_bf16 v[148:151], a[184:187], a[4:7], v[148:151]
  s_waitcnt lgkmcnt(11)
  ds_read_b64_tr_b16 a[182:183], v240 offset:12288
  v_mfma_f32_16x16x32_bf16 v[156:159], a[192:195], a[4:7], v[156:159]
  ds_read_b64_tr_b16 a[184:185], v241 offset:0
  v_mfma_f32_16x16x32_bf16 v[156:159], a[196:199], a[12:15], v[156:159]
  buffer_load_dwordx4 a[92:95], v137, s[36:39], s51 offen offset:3072 sc1
  s_cmp_eq_u32 s83, 1
  v_mfma_f32_16x16x32_bf16 v[152:155], a[196:199], a[8:11], v[152:155]
  s_cselect_b32 s78, 5, 47
  s_lshl_b32 s51, s78, 11
  ds_read_b64_tr_b16 a[186:187], v241 offset:4096
  v_mfma_f32_16x16x32_bf16 v[152:155], a[192:195], a[0:3], v[152:155]
  s_waitcnt lgkmcnt(10)
  ds_read_b64_tr_b16 a[188:189], v241 offset:8192
  ds_read_b64_tr_b16 a[190:191], v241 offset:12288
  v_mfma_f32_16x16x32_bf16 v[160:163], a[200:203], a[0:3], v[160:163]
  ds_read_b64_tr_b16 a[192:193], v242 offset:0
  v_mfma_f32_16x16x32_bf16 v[160:163], a[204:207], a[8:11], v[160:163]
  buffer_load_dwordx4 a[96:99], v137, s[36:39], s51 offen offset:0 sc1
  ds_read_b64_tr_b16 a[194:195], v242 offset:4096
  v_mfma_f32_16x16x32_bf16 v[164:167], a[204:207], a[12:15], v[164:167]
  ds_read_b64_tr_b16 a[196:197], v242 offset:8192
  v_mfma_f32_16x16x32_bf16 v[164:167], a[200:203], a[4:7], v[164:167]
  s_waitcnt lgkmcnt(11)
  ds_read_b64_tr_b16 a[198:199], v242 offset:12288
  v_mfma_f32_16x16x32_bf16 v[172:175], a[208:211], a[4:7], v[172:175]
  ds_read_b64_tr_b16 a[200:201], v243 offset:0
  v_mfma_f32_16x16x32_bf16 v[172:175], a[212:215], a[12:15], v[172:175]
  buffer_load_dwordx4 a[100:103], v137, s[36:39], s51 offen offset:1024 sc1
  s_lshl_b32 s50, s78, 16
  v_mfma_f32_16x16x32_bf16 v[168:171], a[212:215], a[8:11], v[168:171]
  s_add_u32 m0, s73, 81920
  ds_read_b64_tr_b16 a[202:203], v243 offset:4096
  ds_read_b64_tr_b16 a[204:205], v243 offset:8192
  v_mfma_f32_16x16x32_bf16 v[168:171], a[208:211], a[0:3], v[168:171]
  s_waitcnt vmcnt(26) lgkmcnt(11)
  ds_read_b64_tr_b16 a[206:207], v243 offset:12288
  v_mfma_f32_16x16x32_bf16 v[32:35], a[176:179], a[16:19], v[32:35]
  buffer_load_dwordx4 v135, s[24:27], s50 offen offset:2048 lds
  ds_read_b64_tr_b16 a[208:209], v240 offset:2048
  v_mfma_f32_16x16x32_bf16 v[32:35], a[180:183], a[24:27], v[32:35]
  ds_read_b64_tr_b16 a[210:211], v240 offset:6144
  v_mfma_f32_16x16x32_bf16 v[36:39], a[180:183], a[28:31], v[36:39]
  ds_read_b64_tr_b16 a[212:213], v240 offset:10240
  v_mfma_f32_16x16x32_bf16 v[36:39], a[176:179], a[20:23], v[36:39]
  s_waitcnt lgkmcnt(11)
  ds_read_b64_tr_b16 a[214:215], v240 offset:14336
  v_mfma_f32_16x16x32_bf16 v[44:47], a[184:187], a[20:23], v[44:47]
  buffer_load_dwordx4 a[104:107], v137, s[36:39], s51 offen offset:2048 sc1
  ds_read_b64_tr_b16 a[176:177], v241 offset:2048
  v_mfma_f32_16x16x32_bf16 v[44:47], a[188:191], a[28:31], v[44:47]
  ds_read_b64_tr_b16 a[178:179], v241 offset:6144
  v_mfma_f32_16x16x32_bf16 v[40:43], a[188:191], a[24:27], v[40:43]
  ds_read_b64_tr_b16 a[180:181], v241 offset:10240
  v_mfma_f32_16x16x32_bf16 v[40:43], a[184:187], a[16:19], v[40:43]
  s_waitcnt vmcnt(23) lgkmcnt(11)
  s_barrier
  ds_read_b64_tr_b16 a[182:183], v241 offset:14336
  v_mfma_f32_16x16x32_bf16 v[48:51], a[192:195], a[16:19], v[48:51]
  buffer_load_dwordx4 v136, s[24:27], s50 offen offset:3072 lds
  ds_read_b64_tr_b16 a[184:185], v242 offset:2048
  v_mfma_f32_16x16x32_bf16 v[48:51], a[196:199], a[24:27], v[48:51]
  ds_read_b64_tr_b16 a[186:187], v242 offset:6144
  v_mfma_f32_16x16x32_bf16 v[52:55], a[196:199], a[28:31], v[52:55]
  ds_read_b64_tr_b16 a[188:189], v242 offset:10240
  v_mfma_f32_16x16x32_bf16 v[52:55], a[192:195], a[20:23], v[52:55]
  s_waitcnt lgkmcnt(11)
  ds_read_b64_tr_b16 a[190:191], v242 offset:14336
  v_mfma_f32_16x16x32_bf16 v[60:63], a[200:203], a[20:23], v[60:63]
  buffer_load_dwordx4 a[108:111], v137, s[36:39], s51 offen offset:3072 sc1
  s_cmp_eq_u32 s83, 2
  v_mfma_f32_16x16x32_bf16 v[60:63], a[204:207], a[28:31], v[60:63]
  s_cselect_b32 s79, 8, 50
  s_lshl_b32 s51, s79, 11
  ds_read_b64_tr_b16 a[192:193], v243 offset:2048
  v_mfma_f32_16x16x32_bf16 v[56:59], a[204:207], a[24:27], v[56:59]
  ds_read_b64_tr_b16 a[194:195], v243 offset:6144
  ds_read_b64_tr_b16 a[196:197], v243 offset:10240
  v_mfma_f32_16x16x32_bf16 v[56:59], a[200:203], a[16:19], v[56:59]
  s_waitcnt lgkmcnt(11)
  ds_read_b64_tr_b16 a[198:199], v243 offset:14336
  v_mfma_f32_16x16x32_bf16 v[144:147], a[208:211], a[16:19], v[144:147]
  buffer_load_dwordx4 a[112:115], v137, s[36:39], s51 offen offset:0 sc1
  ds_read_b64_tr_b16 a[200:201], v240 offset:18432
  v_mfma_f32_16x16x32_bf16 v[144:147], a[212:215], a[24:27], v[144:147]
  ds_read_b64_tr_b16 a[202:203], v240 offset:22528
  v_mfma_f32_16x16x32_bf16 v[148:151], a[212:215], a[28:31], v[148:151]
  ds_read_b64_tr_b16 a[204:205], v240 offset:26624
  v_mfma_f32_16x16x32_bf16 v[148:151], a[208:211], a[20:23], v[148:151]
  s_waitcnt lgkmcnt(11)
  buffer_load_dwordx4 a[116:119], v137, s[36:39], s51 offen offset:1024 sc1
  s_lshl_b32 s50, s79, 16
  v_mfma_f32_16x16x32_bf16 v[156:159], a[176:179], a[20:23], v[156:159]
  s_add_u32 m0, s73, 98304
  ds_read_b64_tr_b16 a[206:207], v240 offset:30720
  ds_read_b64_tr_b16 a[208:209], v241 offset:18432
  v_mfma_f32_16x16x32_bf16 v[156:159], a[180:183], a[28:31], v[156:159]
  ds_read_b64_tr_b16 a[210:211], v241 offset:22528
  v_mfma_f32_16x16x32_bf16 v[152:155], a[180:183], a[24:27], v[152:155]
  ds_read_b64_tr_b16 a[212:213], v241 offset:26624
  v_mfma_f32_16x16x32_bf16 v[152:155], a[176:179], a[16:19], v[152:155]
  s_waitcnt vmcnt(21) lgkmcnt(11)
  s_barrier
  buffer_load_dwordx4 v135, s[24:27], s50 offen offset:2048 lds
  v_mfma_f32_16x16x32_bf16 v[160:163], a[184:187], a[16:19], v[160:163]
  ds_read_b64_tr_b16 a[214:215], v241 offset:30720
  ds_read_b64_tr_b16 a[176:177], v242 offset:18432
  v_mfma_f32_16x16x32_bf16 v[160:163], a[188:191], a[24:27], v[160:163]
  ds_read_b64_tr_b16 a[178:179], v242 offset:22528
  v_mfma_f32_16x16x32_bf16 v[164:167], a[188:191], a[28:31], v[164:167]
  ds_read_b64_tr_b16 a[180:181], v242 offset:26624
  v_mfma_f32_16x16x32_bf16 v[164:167], a[184:187], a[20:23], v[164:167]
  s_waitcnt lgkmcnt(11)
  buffer_load_dwordx4 a[120:123], v137, s[36:39], s51 offen offset:2048 sc1
  ds_read_b64_tr_b16 a[182:183], v242 offset:30720
  v_mfma_f32_16x16x32_bf16 v[172:175], a[192:195], a[20:23], v[172:175]
  ds_read_b64_tr_b16 a[184:185], v243 offset:18432
  v_mfma_f32_16x16x32_bf16 v[172:175], a[196:199], a[28:31], v[172:175]
  ds_read_b64_tr_b16 a[186:187], v243 offset:22528
  v_mfma_f32_16x16x32_bf16 v[168:171], a[196:199], a[24:27], v[168:171]
  ds_read_b64_tr_b16 a[188:189], v243 offset:26624
  v_mfma_f32_16x16x32_bf16 v[168:171], a[192:195], a[16:19], v[168:171]
  s_waitcnt vmcnt(28) lgkmcnt(11)
  buffer_load_dwordx4 v136, s[24:27], s50 offen offset:3072 lds
  ds_read_b64_tr_b16 a[190:191], v243 offset:30720
  v_mfma_f32_16x16x32_bf16 v[144:147], a[200:203], a[32:35], v[144:147]
  ds_read_b64_tr_b16 a[192:193], v240 offset:34816
  v_mfma_f32_16x16x32_bf16 v[144:147], a[204:207], a[40:43], v[144:147]
  ds_read_b64_tr_b16 a[194:195], v240 offset:38912
  v_mfma_f32_16x16x32_bf16 v[148:151], a[204:207], a[44:47], v[148:151]
  ds_read_b64_tr_b16 a[196:197], v240 offset:43008
  v_mfma_f32_16x16x32_bf16 v[148:151], a[200:203], a[36:39], v[148:151]
  s_waitcnt lgkmcnt(11)
  buffer_load_dwordx4 a[124:127], v137, s[36:39], s51 offen offset:3072 sc1
  s_cmp_eq_u32 s83, 3
  v_mfma_f32_16x16x32_bf16 v[156:159], a[208:211], a[36:39], v[156:159]
  s_cselect_b32 s80, 12, 54
  s_lshl_b32 s51, s80, 11
  ds_read_b64_tr_b16 a[198:199], v240 offset:47104
  v_mfma_f32_16x16x32_bf16 v[156:159], a[212:215], a[44:47], v[156:159]
  ds_read_b64_tr_b16 a[200:201], v241 offset:34816
  ds_read_b64_tr_b16 a[202:203], v241 offset:38912
  v_mfma_f32_16x16x32_bf16 v[152:155], a[212:215], a[40:43], v[152:155]
  buffer_load_dwordx4 a[216:219], v137, s[36:39], s51 offen offset:0 sc1
  ds_read_b64_tr_b16 a[204:205], v241 offset:43008
  v_mfma_f32_16x16x32_bf16 v[152:155], a[208:211], a[32:35], v[152:155]
  s_waitcnt vmcnt(20) lgkmcnt(11)
  s_barrier
  ds_read_b64_tr_b16 a[206:207], v241 offset:47104
  v_mfma_f32_16x16x32_bf16 v[160:163], a[176:179], a[32:35], v[160:163]
  ds_read_b64_tr_b16 a[208:209], v242 offset:34816
  v_mfma_f32_16x16x32_bf16 v[160:163], a[180:183], a[40:43], v[160:163]
  ds_read_b64_tr_b16 a[210:211], v242 offset:38912
  v_mfma_f32_16x16x32_bf16 v[164:167], a[180:183], a[44:47], v[164:167]
  buffer_load_dwordx4 a[220:223], v137, s[36:39], s51 offen offset:1024 sc1
  s_lshl_b32 s50, s80, 16
  v_mfma_f32_16x16x32_bf16 v[164:167], a[176:179], a[36:39], v[164:167]
  s_waitcnt lgkmcnt(10)
  s_add_u32 m0, s73, 114688
  ds_read_b64_tr_b16 a[212:213], v242 offset:43008
  v_mfma_f32_16x16x32_bf16 v[172:175], a[184:187], a[36:39], v[172:175]
  ds_read_b64_tr_b16 a[214:215], v242 offset:47104
  ds_read_b64_tr_b16 a[176:177], v243 offset:34816
  v_mfma_f32_16x16x32_bf16 v[172:175], a[188:191], a[44:47], v[172:175]
  ds_read_b64_tr_b16 a[178:179], v243 offset:38912
  v_mfma_f32_16x16x32_bf16 v[168:171], a[188:191], a[40:43], v[168:171]
  buffer_load_dwordx4 v135, s[24:27], s50 offen offset:2048 lds
  ds_read_b64_tr_b16 a[180:181], v243 offset:43008
  v_mfma_f32_16x16x32_bf16 v[168:171], a[184:187], a[32:35], v[168:171]
  s_waitcnt vmcnt(27) lgkmcnt(11)
  ds_read_b64_tr_b16 a[182:183], v243 offset:47104
  v_mfma_f32_16x16x32_bf16 v[144:147], a[192:195], a[48:51], v[144:147]
  ds_read_b64_tr_b16 a[184:185], v240 offset:51200
  v_mfma_f32_16x16x32_bf16 v[144:147], a[196:199], a[56:59], v[144:147]
  ds_read_b64_tr_b16 a[186:187], v240 offset:55296
  v_mfma_f32_16x16x32_bf16 v[148:151], a[196:199], a[60:63], v[148:151]
  buffer_load_dwordx4 a[224:227], v137, s[36:39], s51 offen offset:2048 sc1
  ds_read_b64_tr_b16 a[188:189], v240 offset:59392
  v_mfma_f32_16x16x32_bf16 v[148:151], a[192:195], a[52:55], v[148:151]
  s_waitcnt lgkmcnt(11)
  ds_read_b64_tr_b16 a[190:191], v240 offset:63488
  v_mfma_f32_16x16x32_bf16 v[156:159], a[200:203], a[52:55], v[156:159]
  ds_read_b64_tr_b16 a[192:193], v241 offset:51200
  v_mfma_f32_16x16x32_bf16 v[156:159], a[204:207], a[60:63], v[156:159]
  ds_read_b64_tr_b16 a[194:195], v241 offset:55296
  v_mfma_f32_16x16x32_bf16 v[152:155], a[204:207], a[56:59], v[152:155]
  buffer_load_dwordx4 v136, s[24:27], s50 offen offset:3072 lds
  ds_read_b64_tr_b16 a[196:197], v241 offset:59392
  v_mfma_f32_16x16x32_bf16 v[152:155], a[200:203], a[48:51], v[152:155]
  s_waitcnt vmcnt(18) lgkmcnt(11)
  s_barrier
  ds_read_b64_tr_b16 a[198:199], v241 offset:63488
  v_mfma_f32_16x16x32_bf16 v[160:163], a[208:211], a[48:51], v[160:163]
  ds_read_b64_tr_b16 a[200:201], v242 offset:51200
  v_mfma_f32_16x16x32_bf16 v[160:163], a[212:215], a[56:59], v[160:163]
  ds_read_b64_tr_b16 a[202:203], v242 offset:55296
  v_mfma_f32_16x16x32_bf16 v[164:167], a[212:215], a[60:63], v[164:167]
  buffer_load_dwordx4 a[228:231], v137, s[36:39], s51 offen offset:3072 sc1
  s_lshl_b32 s50, s74, 16
  v_mfma_f32_16x16x32_bf16 v[164:167], a[208:211], a[52:55], v[164:167]
  s_waitcnt lgkmcnt(10)
  s_add_u32 m0, s73, 16384
  ds_read_b64_tr_b16 a[204:205], v242 offset:59392
  v_mfma_f32_16x16x32_bf16 v[172:175], a[176:179], a[52:55], v[172:175]
  ds_read_b64_tr_b16 a[206:207], v242 offset:63488
  ds_read_b64_tr_b16 a[208:209], v243 offset:51200
  v_mfma_f32_16x16x32_bf16 v[172:175], a[180:183], a[60:63], v[172:175]
  ds_read_b64_tr_b16 a[210:211], v243 offset:55296
  v_mfma_f32_16x16x32_bf16 v[168:171], a[180:183], a[56:59], v[168:171]
  buffer_load_dwordx4 v133, s[24:27], s50 offen offset:0 lds
  ds_read_b64_tr_b16 a[212:213], v243 offset:59392
  v_mfma_f32_16x16x32_bf16 v[168:171], a[176:179], a[48:51], v[168:171]
  s_waitcnt vmcnt(25) lgkmcnt(11)
  ds_read_b64_tr_b16 a[214:215], v243 offset:63488
  v_mfma_f32_16x16x32_bf16 v[144:147], a[184:187], a[64:67], v[144:147]
  ds_read_b64_tr_b16 a[176:177], v244 offset:2048
  v_mfma_f32_16x16x32_bf16 v[144:147], a[188:191], a[72:75], v[144:147]
  ds_read_b64_tr_b16 a[178:179], v244 offset:6144
  v_mfma_f32_16x16x32_bf16 v[148:151], a[188:191], a[76:79], v[148:151]
  buffer_load_dwordx4 v134, s[24:27], s50 offen offset:1024 lds
  s_lshl_b32 s50, s75, 16
  v_mfma_f32_16x16x32_bf16 v[148:151], a[184:187], a[68:71], v[148:151]
  s_waitcnt lgkmcnt(10)
  s_add_u32 m0, s73, 32768
  ds_read_b64_tr_b16 a[180:181], v244 offset:10240
  v_mfma_f32_16x16x32_bf16 v[156:159], a[192:195], a[68:71], v[156:159]
  ds_read_b64_tr_b16 a[182:183], v244 offset:14336
  ds_read_b64_tr_b16 a[184:185], v245 offset:2048
  v_mfma_f32_16x16x32_bf16 v[156:159], a[196:199], a[76:79], v[156:159]
  ds_read_b64_tr_b16 a[186:187], v245 offset:6144
  v_mfma_f32_16x16x32_bf16 v[152:155], a[196:199], a[72:75], v[152:155]
  buffer_load_dwordx4 v133, s[24:27], s50 offen offset:0 lds
  ds_read_b64_tr_b16 a[188:189], v245 offset:10240
  v_mfma_f32_16x16x32_bf16 v[152:155], a[192:195], a[64:67], v[152:155]
  s_waitcnt vmcnt(16) lgkmcnt(11)
  s_barrier
  ds_read_b64_tr_b16 a[190:191], v245 offset:14336
  v_mfma_f32_16x16x32_bf16 v[160:163], a[200:203], a[64:67], v[160:163]
  ds_read_b64_tr_b16 a[192:193], v246 offset:2048
  v_mfma_f32_16x16x32_bf16 v[160:163], a[204:207], a[72:75], v[160:163]
  ds_read_b64_tr_b16 a[194:195], v246 offset:6144
  v_mfma_f32_16x16x32_bf16 v[164:167], a[204:207], a[76:79], v[164:167]
  buffer_load_dwordx4 v134, s[24:27], s50 offen offset:1024 lds
  s_lshl_b32 s50, s76, 16
  v_mfma_f32_16x16x32_bf16 v[164:167], a[200:203], a[68:71], v[164:167]
  s_waitcnt lgkmcnt(10)
  s_add_u32 m0, s73, 49152
  ds_read_b64_tr_b16 a[196:197], v246 offset:10240
  v_mfma_f32_16x16x32_bf16 v[172:175], a[208:211], a[68:71], v[172:175]
  ds_read_b64_tr_b16 a[198:199], v246 offset:14336
  ds_read_b64_tr_b16 a[200:201], v247 offset:2048
  v_mfma_f32_16x16x32_bf16 v[172:175], a[212:215], a[76:79], v[172:175]
  ds_read_b64_tr_b16 a[202:203], v247 offset:6144
  v_mfma_f32_16x16x32_bf16 v[168:171], a[212:215], a[72:75], v[168:171]
  buffer_load_dwordx4 v133, s[24:27], s50 offen offset:0 lds
  ds_read_b64_tr_b16 a[204:205], v247 offset:10240
  v_mfma_f32_16x16x32_bf16 v[168:171], a[208:211], a[64:67], v[168:171]
  s_waitcnt vmcnt(23) lgkmcnt(11)
  ds_read_b64_tr_b16 a[206:207], v247 offset:14336
  v_mfma_f32_16x16x32_bf16 v[144:147], a[176:179], a[80:83], v[144:147]
  ds_read_b64_tr_b16 a[208:209], v244 offset:18432
  v_mfma_f32_16x16x32_bf16 v[144:147], a[180:183], a[88:91], v[144:147]
  ds_read_b64_tr_b16 a[210:211], v244 offset:22528
  v_mfma_f32_16x16x32_bf16 v[148:151], a[180:183], a[92:95], v[148:151]
  buffer_load_dwordx4 v134, s[24:27], s50 offen offset:1024 lds
  s_lshl_b32 s50, s77, 16
  v_mfma_f32_16x16x32_bf16 v[148:151], a[176:179], a[84:87], v[148:151]
  s_waitcnt lgkmcnt(10)
  s_add_u32 m0, s73, 65536
  ds_read_b64_tr_b16 a[212:213], v244 offset:26624
  v_mfma_f32_16x16x32_bf16 v[156:159], a[184:187], a[84:87], v[156:159]
  ds_read_b64_tr_b16 a[214:215], v244 offset:30720
  ds_read_b64_tr_b16 a[176:177], v245 offset:18432
  v_mfma_f32_16x16x32_bf16 v[156:159], a[188:191], a[92:95], v[156:159]
  ds_read_b64_tr_b16 a[178:179], v245 offset:22528
  v_mfma_f32_16x16x32_bf16 v[152:155], a[188:191], a[88:91], v[152:155]
  buffer_load_dwordx4 v133, s[24:27], s50 offen offset:0 lds
  ds_read_b64_tr_b16 a[180:181], v245 offset:26624
  v_mfma_f32_16x16x32_bf16 v[152:155], a[184:187], a[80:83], v[152:155]
  s_waitcnt vmcnt(14) lgkmcnt(11)
  s_barrier
  ds_read_b64_tr_b16 a[182:183], v245 offset:30720
  v_mfma_f32_16x16x32_bf16 v[160:163], a[192:195], a[80:83], v[160:163]
  ds_read_b64_tr_b16 a[184:185], v246 offset:18432
  v_mfma_f32_16x16x32_bf16 v[160:163], a[196:199], a[88:91], v[160:163]
  ds_read_b64_tr_b16 a[186:187], v246 offset:22528
  v_mfma_f32_16x16x32_bf16 v[164:167], a[196:199], a[92:95], v[164:167]
  buffer_load_dwordx4 v134, s[24:27], s50 offen offset:1024 lds
  s_lshl_b32 s50, s78, 16
  v_mfma_f32_16x16x32_bf16 v[164:167], a[192:195], a[84:87], v[164:167]
  s_waitcnt lgkmcnt(10)
  s_add_u32 m0, s73, 81920
  ds_read_b64_tr_b16 a[188:189], v246 offset:26624
  v_mfma_f32_16x16x32_bf16 v[172:175], a[200:203], a[84:87], v[172:175]
  ds_read_b64_tr_b16 a[190:191], v246 offset:30720
  ds_read_b64_tr_b16 a[192:193], v247 offset:18432
  v_mfma_f32_16x16x32_bf16 v[172:175], a[204:207], a[92:95], v[172:175]
  ds_read_b64_tr_b16 a[194:195], v247 offset:22528
  v_mfma_f32_16x16x32_bf16 v[168:171], a[204:207], a[88:91], v[168:171]
  buffer_load_dwordx4 v133, s[24:27], s50 offen offset:0 lds
  ds_read_b64_tr_b16 a[196:197], v247 offset:26624
  v_mfma_f32_16x16x32_bf16 v[168:171], a[200:203], a[80:83], v[168:171]
  s_waitcnt vmcnt(21) lgkmcnt(11)
  ds_read_b64_tr_b16 a[198:199], v247 offset:30720
  v_mfma_f32_16x16x32_bf16 v[144:147], a[208:211], a[96:99], v[144:147]
  ds_read_b64_tr_b16 a[200:201], v244 offset:34816
  v_mfma_f32_16x16x32_bf16 v[144:147], a[212:215], a[104:107], v[144:147]
  ds_read_b64_tr_b16 a[202:203], v244 offset:38912
  v_mfma_f32_16x16x32_bf16 v[148:151], a[212:215], a[108:111], v[148:151]
  buffer_load_dwordx4 v134, s[24:27], s50 offen offset:1024 lds
  s_lshl_b32 s50, s79, 16
  v_mfma_f32_16x16x32_bf16 v[148:151], a[208:211], a[100:103], v[148:151]
  s_waitcnt lgkmcnt(10)
  s_add_u32 m0, s73, 98304
  ds_read_b64_tr_b16 a[204:205], v244 offset:43008
  v_mfma_f32_16x16x32_bf16 v[156:159], a[176:179], a[100:103], v[156:159]
  ds_read_b64_tr_b16 a[206:207], v244 offset:47104
  ds_read_b64_tr_b16 a[208:209], v245 offset:34816
  v_mfma_f32_16x16x32_bf16 v[156:159], a[180:183], a[108:111], v[156:159]
  ds_read_b64_tr_b16 a[210:211], v245 offset:38912
  v_mfma_f32_16x16x32_bf16 v[152:155], a[180:183], a[104:107], v[152:155]
  buffer_load_dwordx4 v133, s[24:27], s50 offen offset:0 lds
  ds_read_b64_tr_b16 a[212:213], v245 offset:43008
  v_mfma_f32_16x16x32_bf16 v[152:155], a[176:179], a[96:99], v[152:155]
  s_waitcnt vmcnt(12) lgkmcnt(11)
  s_barrier
  ds_read_b64_tr_b16 a[214:215], v245 offset:47104
  v_mfma_f32_16x16x32_bf16 v[160:163], a[184:187], a[96:99], v[160:163]
  ds_read_b64_tr_b16 a[176:177], v246 offset:34816
  v_mfma_f32_16x16x32_bf16 v[160:163], a[188:191], a[104:107], v[160:163]
  ds_read_b64_tr_b16 a[178:179], v246 offset:38912
  v_mfma_f32_16x16x32_bf16 v[164:167], a[188:191], a[108:111], v[164:167]
  buffer_load_dwordx4 v134, s[24:27], s50 offen offset:1024 lds
  s_lshl_b32 s50, s80, 16
  v_mfma_f32_16x16x32_bf16 v[164:167], a[184:187], a[100:103], v[164:167]
  s_waitcnt lgkmcnt(10)
  s_add_u32 m0, s73, 114688
  ds_read_b64_tr_b16 a[180:181], v246 offset:43008
  v_mfma_f32_16x16x32_bf16 v[172:175], a[192:195], a[100:103], v[172:175]
  ds_read_b64_tr_b16 a[182:183], v246 offset:47104
  ds_read_b64_tr_b16 a[184:185], v247 offset:34816
  v_mfma_f32_16x16x32_bf16 v[172:175], a[196:199], a[108:111], v[172:175]
  ds_read_b64_tr_b16 a[186:187], v247 offset:38912
  v_mfma_f32_16x16x32_bf16 v[168:171], a[196:199], a[104:107], v[168:171]
  buffer_load_dwordx4 v133, s[24:27], s50 offen offset:0 lds
  ds_read_b64_tr_b16 a[188:189], v247 offset:43008
  v_mfma_f32_16x16x32_bf16 v[168:171], a[192:195], a[96:99], v[168:171]
  s_waitcnt vmcnt(19) lgkmcnt(11)
  ds_read_b64_tr_b16 a[190:191], v247 offset:47104
  v_mfma_f32_16x16x32_bf16 v[144:147], a[200:203], a[112:115], v[144:147]
  ds_read_b64_tr_b16 a[192:193], v244 offset:51200
  v_mfma_f32_16x16x32_bf16 v[144:147], a[204:207], a[120:123], v[144:147]
  ds_read_b64_tr_b16 a[194:195], v244 offset:55296
  v_mfma_f32_16x16x32_bf16 v[148:151], a[204:207], a[124:127], v[148:151]
  buffer_load_dwordx4 v134, s[24:27], s50 offen offset:1024 lds
  ds_read_b64_tr_b16 a[196:197], v244 offset:59392
  v_mfma_f32_16x16x32_bf16 v[148:151], a[200:203], a[116:119], v[148:151]
  s_waitcnt lgkmcnt(11)
  ds_read_b64_tr_b16 a[198:199], v244 offset:63488
  v_mfma_f32_16x16x32_bf16 v[156:159], a[208:211], a[116:119], v[156:159]
  ds_read_b64_tr_b16 a[200:201], v245 offset:51200
  v_mfma_f32_16x16x32_bf16 v[156:159], a[212:215], a[124:127], v[156:159]
  ds_read_b64_tr_b16 a[202:203], v245 offset:55296
  v_mfma_f32_16x16x32_bf16 v[152:155], a[212:215], a[120:123], v[152:155]
  ds_read_b64_tr_b16 a[204:205], v245 offset:59392
  v_mfma_f32_16x16x32_bf16 v[152:155], a[208:211], a[112:115], v[152:155]
  s_waitcnt vmcnt(12) lgkmcnt(11)
  s_barrier
  ds_read_b64_tr_b16 a[206:207], v245 offset:63488
  v_mfma_f32_16x16x32_bf16 v[160:163], a[176:179], a[112:115], v[160:163]
  ds_read_b64_tr_b16 a[208:209], v246 offset:51200
  v_mfma_f32_16x16x32_bf16 v[160:163], a[180:183], a[120:123], v[160:163]
  ds_read_b64_tr_b16 a[210:211], v246 offset:55296
  v_mfma_f32_16x16x32_bf16 v[164:167], a[180:183], a[124:127], v[164:167]
  ds_read_b64_tr_b16 a[212:213], v246 offset:59392
  v_mfma_f32_16x16x32_bf16 v[164:167], a[176:179], a[116:119], v[164:167]
  s_waitcnt lgkmcnt(11)
  ds_read_b64_tr_b16 a[214:215], v246 offset:63488
  v_mfma_f32_16x16x32_bf16 v[172:175], a[184:187], a[116:119], v[172:175]
  ds_read_b64_tr_b16 a[176:177], v247 offset:51200
  v_mfma_f32_16x16x32_bf16 v[172:175], a[188:191], a[124:127], v[172:175]
  ds_read_b64_tr_b16 a[178:179], v247 offset:55296
  v_mfma_f32_16x16x32_bf16 v[168:171], a[188:191], a[120:123], v[168:171]
  ds_read_b64_tr_b16 a[180:181], v247 offset:59392
  v_mfma_f32_16x16x32_bf16 v[168:171], a[184:187], a[112:115], v[168:171]
  s_waitcnt vmcnt(14) lgkmcnt(11)
  ds_read_b64_tr_b16 a[182:183], v247 offset:63488
  v_mfma_f32_16x16x32_bf16 v[144:147], a[192:195], a[216:219], v[144:147]
  ds_read_b64_tr_b16 a[184:185], v240 offset:16384
  v_mfma_f32_16x16x32_bf16 v[144:147], a[196:199], a[224:227], v[144:147]
  ds_read_b64_tr_b16 a[186:187], v240 offset:20480
  v_mfma_f32_16x16x32_bf16 v[148:151], a[196:199], a[228:231], v[148:151]
  ds_read_b64_tr_b16 a[188:189], v240 offset:24576
  v_mfma_f32_16x16x32_bf16 v[148:151], a[192:195], a[220:223], v[148:151]
  s_waitcnt lgkmcnt(11)
  ds_read_b64_tr_b16 a[190:191], v240 offset:28672
  v_mfma_f32_16x16x32_bf16 v[156:159], a[200:203], a[220:223], v[156:159]
  ds_read_b64_tr_b16 a[192:193], v241 offset:16384
  v_mfma_f32_16x16x32_bf16 v[156:159], a[204:207], a[228:231], v[156:159]
  ds_read_b64_tr_b16 a[194:195], v241 offset:20480
  v_mfma_f32_16x16x32_bf16 v[152:155], a[204:207], a[224:227], v[152:155]
  ds_read_b64_tr_b16 a[196:197], v241 offset:24576
  v_mfma_f32_16x16x32_bf16 v[152:155], a[200:203], a[216:219], v[152:155]
  s_waitcnt vmcnt(10) lgkmcnt(11)
  s_barrier
  ds_read_b64_tr_b16 a[198:199], v241 offset:28672
  v_mfma_f32_16x16x32_bf16 v[160:163], a[208:211], a[216:219], v[160:163]
  ds_read_b64_tr_b16 a[200:201], v242 offset:16384
  buffer_store_dwordx4 v[144:147], v0, s[36:39], s60 offen offset:0 sc1
  v_mfma_f32_16x16x32_bf16 v[160:163], a[212:215], a[224:227], v[160:163]
  buffer_store_dwordx4 v[148:151], v0, s[36:39], s60 offen offset:1024 sc1
  ds_read_b64_tr_b16 a[202:203], v242 offset:20480
  v_mfma_f32_16x16x32_bf16 v[164:167], a[212:215], a[228:231], v[164:167]
  ds_read_b64_tr_b16 a[204:205], v242 offset:24576
  v_mfma_f32_16x16x32_bf16 v[164:167], a[208:211], a[220:223], v[164:167]
  s_waitcnt lgkmcnt(11)
  ds_read_b64_tr_b16 a[206:207], v242 offset:28672
  v_mfma_f32_16x16x32_bf16 v[172:175], a[176:179], a[220:223], v[172:175]
  ds_read_b64_tr_b16 a[208:209], v243 offset:16384
  buffer_store_dwordx4 v[152:155], v0, s[36:39], s60 offen offset:2048 sc1
  v_mfma_f32_16x16x32_bf16 v[172:175], a[180:183], a[228:231], v[172:175]
  buffer_store_dwordx4 v[156:159], v0, s[36:39], s60 offen offset:3072 sc1
  ds_read_b64_tr_b16 a[210:211], v243 offset:20480
  v_mfma_f32_16x16x32_bf16 v[168:171], a[180:183], a[224:227], v[168:171]
  ds_read_b64_tr_b16 a[212:213], v243 offset:24576
  v_mfma_f32_16x16x32_bf16 v[168:171], a[176:179], a[216:219], v[168:171]
  s_waitcnt lgkmcnt(11)
  ds_read_b64_tr_b16 a[214:215], v243 offset:28672
  v_mfma_f32_16x16x32_bf16 v[32:35], a[184:187], a[32:35], v[32:35]
  ds_read_b64_tr_b16 a[176:177], v240 offset:32768
  buffer_store_dwordx4 v[160:163], v0, s[36:39], s61 offen offset:0 sc1
  v_mfma_f32_16x16x32_bf16 v[32:35], a[188:191], a[40:43], v[32:35]
  buffer_store_dwordx4 v[164:167], v0, s[36:39], s61 offen offset:1024 sc1
  ds_read_b64_tr_b16 a[178:179], v240 offset:36864
  v_mfma_f32_16x16x32_bf16 v[36:39], a[188:191], a[44:47], v[36:39]
  ds_read_b64_tr_b16 a[180:181], v240 offset:40960
  v_mfma_f32_16x16x32_bf16 v[36:39], a[184:187], a[36:39], v[36:39]
  s_waitcnt lgkmcnt(11)
  ds_read_b64_tr_b16 a[182:183], v240 offset:45056
  v_mfma_f32_16x16x32_bf16 v[44:47], a[192:195], a[36:39], v[44:47]
Hb0_4:
  s_cbranch_execz Rb
  ds_read_b64_tr_b16 a[184:185], v241 offset:32768
  buffer_store_dwordx4 v[168:171], v0, s[36:39], s61 offen offset:2048 sc1
  v_mfma_f32_16x16x32_bf16 v[44:47], a[196:199], a[44:47], v[44:47]
  buffer_store_dwordx4 v[172:175], v0, s[36:39], s61 offen offset:3072 sc1
  ds_read_b64_tr_b16 a[186:187], v241 offset:36864
  v_mfma_f32_16x16x32_bf16 v[40:43], a[196:199], a[40:43], v[40:43]
  ds_read_b64_tr_b16 a[188:189], v241 offset:40960
  v_mfma_f32_16x16x32_bf16 v[40:43], a[192:195], a[32:35], v[40:43]
  s_waitcnt vmcnt(16) lgkmcnt(11)
  s_barrier
  ds_read_b64_tr_b16 a[190:191], v241 offset:45056
  v_mfma_f32_16x16x32_bf16 v[48:51], a[200:203], a[32:35], v[48:51]
  ds_read_b64_tr_b16 a[192:193], v242 offset:32768
  v_mfma_f32_16x16x32_bf16 v[48:51], a[204:207], a[40:43], v[48:51]
  ds_read_b64_tr_b16 a[194:195], v242 offset:36864
  v_mfma_f32_16x16x32_bf16 v[52:55], a[204:207], a[44:47], v[52:55]
  ds_read_b64_tr_b16 a[196:197], v242 offset:40960
  v_mfma_f32_16x16x32_bf16 v[52:55], a[200:203], a[36:39], v[52:55]
  s_waitcnt lgkmcnt(11)
  ds_read_b64_tr_b16 a[198:199], v242 offset:45056
  v_mfma_f32_16x16x32_bf16 v[60:63], a[208:211], a[36:39], v[60:63]
  ds_read_b64_tr_b16 a[200:201], v243 offset:32768
  v_mfma_f32_16x16x32_bf16 v[60:63], a[212:215], a[44:47], v[60:63]
  ds_read_b64_tr_b16 a[202:203], v243 offset:36864
  v_mfma_f32_16x16x32_bf16 v[56:59], a[212:215], a[40:43], v[56:59]
  ds_read_b64_tr_b16 a[204:205], v243 offset:40960
  v_mfma_f32_16x16x32_bf16 v[56:59], a[208:211], a[32:35], v[56:59]
  s_waitcnt lgkmcnt(11)
  ds_read_b64_tr_b16 a[206:207], v243 offset:45056
  v_mfma_f32_16x16x32_bf16 v[32:35], a[176:179], a[48:51], v[32:35]
  ds_read_b64_tr_b16 a[208:209], v240 offset:49152
  v_mfma_f32_16x16x32_bf16 v[32:35], a[180:183], a[56:59], v[32:35]
  ds_read_b64_tr_b16 a[210:211], v240 offset:53248
  v_mfma_f32_16x16x32_bf16 v[36:39], a[180:183], a[60:63], v[36:39]
  ds_read_b64_tr_b16 a[212:213], v240 offset:57344
  v_mfma_f32_16x16x32_bf16 v[36:39], a[176:179], a[52:55], v[36:39]
  s_waitcnt lgkmcnt(11)
  ds_read_b64_tr_b16 a[214:215], v240 offset:61440
  v_mfma_f32_16x16x32_bf16 v[44:47], a[184:187], a[52:55], v[44:47]
  ds_read_b64_tr_b16 a[176:177], v241 offset:49152
  v_mfma_f32_16x16x32_bf16 v[44:47], a[188:191], a[60:63], v[44:47]
  ds_read_b64_tr_b16 a[178:179], v241 offset:53248
  v_mfma_f32_16x16x32_bf16 v[40:43], a[188:191], a[56:59], v[40:43]
  ds_read_b64_tr_b16 a[180:181], v241 offset:57344
  v_mfma_f32_16x16x32_bf16 v[40:43], a[184:187], a[48:51], v[40:43]
  s_waitcnt vmcnt(14) lgkmcnt(11)
  s_barrier
  ds_read_b64_tr_b16 a[182:183], v241 offset:61440
  v_mfma_f32_16x16x32_bf16 v[48:51], a[192:195], a[48:51], v[48:51]
  ds_read_b64_tr_b16 a[184:185], v242 offset:49152
  v_mfma_f32_16x16x32_bf16 v[48:51], a[196:199], a[56:59], v[48:51]
  ds_read_b64_tr_b16 a[186:187], v242 offset:53248
  v_mfma_f32_16x16x32_bf16 v[52:55], a[196:199], a[60:63], v[52:55]
  ds_read_b64_tr_b16 a[188:189], v242 offset:57344
  v_mfma_f32_16x16x32_bf16 v[52:55], a[192:195], a[52:55], v[52:55]
  s_waitcnt lgkmcnt(11)
  ds_read_b64_tr_b16 a[190:191], v242 offset:61440
  v_mfma_f32_16x16x32_bf16 v[60:63], a[200:203], a[52:55], v[60:63]
  ds_read_b64_tr_b16 a[192:193], v243 offset:49152
  v_mfma_f32_16x16x32_bf16 v[60:63], a[204:207], a[60:63], v[60:63]
  ds_read_b64_tr_b16 a[194:195], v243 offset:53248
  v_mfma_f32_16x16x32_bf16 v[56:59], a[204:207], a[56:59], v[56:59]
  ds_read_b64_tr_b16 a[196:197], v243 offset:57344
  v_mfma_f32_16x16x32_bf16 v[56:59], a[200:203], a[48:51], v[56:59]
  s_waitcnt lgkmcnt(11)
  ds_read_b64_tr_b16 a[198:199], v243 offset:61440
  v_mfma_f32_16x16x32_bf16 v[32:35], a[208:211], a[64:67], v[32:35]
  ds_read_b64_tr_b16 a[200:201], v244 offset:0
  v_mfma_f32_16x16x32_bf16 v[32:35], a[212:215], a[72:75], v[32:35]
  ds_read_b64_tr_b16 a[202:203], v244 offset:4096
  v_mfma_f32_16x16x32_bf16 v[36:39], a[212:215], a[76:79], v[36:39]
  ds_read_b64_tr_b16 a[204:205], v244 offset:8192
  v_mfma_f32_16x16x32_bf16 v[36:39], a[208:211], a[68:71], v[36:39]
  s_waitcnt lgkmcnt(11)
  ds_read_b64_tr_b16 a[206:207], v244 offset:12288
  v_mfma_f32_16x16x32_bf16 v[44:47], a[176:179], a[68:71], v[44:47]
  ds_read_b64_tr_b16 a[208:209], v245 offset:0
  v_mfma_f32_16x16x32_bf16 v[44:47], a[180:183], a[76:79], v[44:47]
  ds_read_b64_tr_b16 a[210:211], v245 offset:4096
  v_mfma_f32_16x16x32_bf16 v[40:43], a[180:183], a[72:75], v[40:43]
  ds_read_b64_tr_b16 a[212:213], v245 offset:8192
  v_mfma_f32_16x16x32_bf16 v[40:43], a[176:179], a[64:67], v[40:43]
  s_waitcnt vmcnt(12) lgkmcnt(11)
  s_barrier
  ds_read_b64_tr_b16 a[214:215], v245 offset:12288
  v_mfma_f32_16x16x32_bf16 v[48:51], a[184:187], a[64:67], v[48:51]
  ds_read_b64_tr_b16 a[176:177], v246 offset:0
  v_mfma_f32_16x16x32_bf16 v[48:51], a[188:191], a[72:75], v[48:51]
  ds_read_b64_tr_b16 a[178:179], v246 offset:4096
  v_mfma_f32_16x16x32_bf16 v[52:55], a[188:191], a[76:79], v[52:55]
  ds_read_b64_tr_b16 a[180:181], v246 offset:8192
  v_mfma_f32_16x16x32_bf16 v[52:55], a[184:187], a[68:71], v[52:55]
  s_waitcnt lgkmcnt(11)
  ds_read_b64_tr_b16 a[182:183], v246 offset:12288
  v_mfma_f32_16x16x32_bf16 v[60:63], a[192:195], a[68:71], v[60:63]
  ds_read_b64_tr_b16 a[184:185], v247 offset:0
  v_mfma_f32_16x16x32_bf16 v[60:63], a[196:199], a[76:79], v[60:63]
  ds_read_b64_tr_b16 a[186:187], v247 offset:4096
  v_mfma_f32_16x16x32_bf16 v[56:59], a[196:199], a[72:75], v[56:59]
  ds_read_b64_tr_b16 a[188:189], v247 offset:8192
  v_mfma_f32_16x16x32_bf16 v[56:59], a[192:195], a[64:67], v[56:59]
  s_waitcnt lgkmcnt(11)
  ds_read_b64_tr_b16 a[190:191], v247 offset:12288
  v_mfma_f32_16x16x32_bf16 v[32:35], a[200:203], a[80:83], v[32:35]
  s_waitcnt vmcnt(0)
  ds_read_b64_tr_b16 a[192:193], v244 offset:16384
  s_mov_b64 exec, 1
  buffer_store_dword v254, v0, s[36:39], s67 offen sc1
  s_mov_b64 exec, -1
  v_mfma_f32_16x16x32_bf16 v[32:35], a[204:207], a[88:91], v[32:35]
  ds_read_b64_tr_b16 a[194:195], v244 offset:20480
  v_mfma_f32_16x16x32_bf16 v[36:39], a[204:207], a[92:95], v[36:39]
  ds_read_b64_tr_b16 a[196:197], v244 offset:24576
  v_mfma_f32_16x16x32_bf16 v[36:39], a[200:203], a[84:87], v[36:39]
  s_waitcnt lgkmcnt(11)
  ds_read_b64_tr_b16 a[198:199], v244 offset:28672
  v_mfma_f32_16x16x32_bf16 v[44:47], a[208:211], a[84:87], v[44:47]
  ds_read_b64_tr_b16 a[200:201], v245 offset:16384
  buffer_load_dword v139, v132, s[36:39], s68 offen sc1
  v_mfma_f32_16x16x32_bf16 v[44:47], a[212:215], a[92:95], v[44:47]
  ds_read_b64_tr_b16 a[202:203], v245 offset:20480
  v_mfma_f32_16x16x32_bf16 v[40:43], a[212:215], a[88:91], v[40:43]
  ds_read_b64_tr_b16 a[204:205], v245 offset:24576
  v_mfma_f32_16x16x32_bf16 v[40:43], a[208:211], a[80:83], v[40:43]
  s_waitcnt vmcnt(12) lgkmcnt(11)
  s_barrier
  ds_read_b64_tr_b16 a[206:207], v245 offset:28672
  v_mfma_f32_16x16x32_bf16 v[48:51], a[176:179], a[80:83], v[48:51]
  ds_read_b64_tr_b16 a[208:209], v246 offset:16384
  v_mfma_f32_16x16x32_bf16 v[48:51], a[180:183], a[88:91], v[48:51]
  ds_read_b64_tr_b16 a[210:211], v246 offset:20480
  v_mfma_f32_16x16x32_bf16 v[52:55], a[180:183], a[92:95], v[52:55]
  ds_read_b64_tr_b16 a[212:213], v246 offset:24576
  v_mfma_f32_16x16x32_bf16 v[52:55], a[176:179], a[84:87], v[52:55]
  s_waitcnt lgkmcnt(11)
  ds_read_b64_tr_b16 a[214:215], v246 offset:28672
  v_mfma_f32_16x16x32_bf16 v[60:63], a[184:187], a[84:87], v[60:63]
  ds_read_b64_tr_b16 a[176:177], v247 offset:16384
  v_mfma_f32_16x16x32_bf16 v[60:63], a[188:191], a[92:95], v[60:63]
  ds_read_b64_tr_b16 a[178:179], v247 offset:20480
  v_mfma_f32_16x16x32_bf16 v[56:59], a[188:191], a[88:91], v[56:59]
  ds_read_b64_tr_b16 a[180:181], v247 offset:24576
  v_mfma_f32_16x16x32_bf16 v[56:59], a[184:187], a[80:83], v[56:59]
  s_waitcnt lgkmcnt(11)
  ds_read_b64_tr_b16 a[182:183], v247 offset:28672
  v_mfma_f32_16x16x32_bf16 v[32:35], a[192:195], a[96:99], v[32:35]
  ds_read_b64_tr_b16 a[184:185], v244 offset:32768
  v_mfma_f32_16x16x32_bf16 v[32:35], a[196:199], a[104:107], v[32:35]
  ds_read_b64_tr_b16 a[186:187], v244 offset:36864
  v_mfma_f32_16x16x32_bf16 v[36:39], a[196:199], a[108:111], v[36:39]
  ds_read_b64_tr_b16 a[188:189], v244 offset:40960
  v_mfma_f32_16x16x32_bf16 v[36:39], a[192:195], a[100:103], v[36:39]
  s_waitcnt lgkmcnt(11)
  ds_read_b64_tr_b16 a[190:191], v244 offset:45056
  v_mfma_f32_16x16x32_bf16 v[44:47], a[200:203], a[100:103], v[44:47]
  ds_read_b64_tr_b16 a[192:193], v245 offset:32768
  v_mfma_f32_16x16x32_bf16 v[44:47], a[204:207], a[108:111], v[44:47]
  ds_read_b64_tr_b16 a[194:195], v245 offset:36864
  v_mfma_f32_16x16x32_bf16 v[40:43], a[204:207], a[104:107], v[40:43]
  ds_read_b64_tr_b16 a[196:197], v245 offset:40960
  v_mfma_f32_16x16x32_bf16 v[40:43], a[200:203], a[96:99], v[40:43]
  s_waitcnt vmcnt(10) lgkmcnt(11)
  s_barrier
  ds_read_b64_tr_b16 a[198:199], v245 offset:45056
  v_mfma_f32_16x16x32_bf16 v[48:51], a[208:211], a[96:99], v[48:51]
  ds_read_b64_tr_b16 a[200:201], v246 offset:32768
  v_mfma_f32_16x16x32_bf16 v[48:51], a[212:215], a[104:107], v[48:51]
  ds_read_b64_tr_b16 a[202:203], v246 offset:36864
  v_mfma_f32_16x16x32_bf16 v[52:55], a[212:215], a[108:111], v[52:55]
  ds_read_b64_tr_b16 a[204:205], v246 offset:40960
  v_mfma_f32_16x16x32_bf16 v[52:55], a[208:211], a[100:103], v[52:55]
  s_waitcnt lgkmcnt(11)
  ds_read_b64_tr_b16 a[206:207], v246 offset:45056
  v_mfma_f32_16x16x32_bf16 v[60:63], a[176:179], a[100:103], v[60:63]
  ds_read_b64_tr_b16 a[208:209], v247 offset:32768
  v_mfma_f32_16x16x32_bf16 v[60:63], a[180:183], a[108:111], v[60:63]
  ds_read_b64_tr_b16 a[210:211], v247 offset:36864
  v_mfma_f32_16x16x32_bf16 v[56:59], a[180:183], a[104:107], v[56:59]
  s_waitcnt vmcnt(0)
  ds_read_b64_tr_b16 a[212:213], v247 offset:40960
  v_readfirstlane_b32 s69, v139
  v_mfma_f32_16x16x32_bf16 v[56:59], a[176:179], a[96:99], v[56:59]
  s_waitcnt lgkmcnt(11)
  ds_read_b64_tr_b16 a[214:215], v247 offset:45056
  s_nop 0
  v_mfma_f32_16x16x32_bf16 v[32:35], a[184:187], a[112:115], v[32:35]
  s_cmp_eq_u32 s69, 1
  ds_read_b64_tr_b16 a[176:177], v244 offset:49152
  s_cselect_b32 s85, s62, 1073741824
  v_mfma_f32_16x16x32_bf16 v[32:35], a[188:191], a[120:123], v[32:35]
  s_cselect_b32 s90, s63, 1073741824
  ds_read_b64_tr_b16 a[178:179], v244 offset:53248
  buffer_load_dwordx4 v[96:99], v0, s[36:39], s85 offen offset:0 sc1
  v_mfma_f32_16x16x32_bf16 v[36:39], a[188:191], a[124:127], v[36:39]
  ds_read_b64_tr_b16 a[180:181], v244 offset:57344
  v_mfma_f32_16x16x32_bf16 v[36:39], a[184:187], a[116:119], v[36:39]
  s_waitcnt lgkmcnt(11)
  ds_read_b64_tr_b16 a[182:183], v244 offset:61440
  v_mfma_f32_16x16x32_bf16 v[44:47], a[192:195], a[116:119], v[44:47]
  ds_read_b64_tr_b16 a[184:185], v245 offset:49152
  buffer_load_dwordx4 v[100:103], v0, s[36:39], s85 offen offset:1024 sc1
  v_mfma_f32_16x16x32_bf16 v[44:47], a[196:199], a[124:127], v[44:47]
  ds_read_b64_tr_b16 a[186:187], v245 offset:53248
  v_mfma_f32_16x16x32_bf16 v[40:43], a[196:199], a[120:123], v[40:43]
  ds_read_b64_tr_b16 a[188:189], v245 offset:57344
  v_mfma_f32_16x16x32_bf16 v[40:43], a[192:195], a[112:115], v[40:43]
  s_waitcnt lgkmcnt(11)
  buffer_load_dwordx4 v[104:107], v0, s[36:39], s85 offen offset:2048 sc1
  ds_read_b64_tr_b16 a[190:191], v245 offset:61440
  v_mfma_f32_16x16x32_bf16 v[48:51], a[200:203], a[112:115], v[48:51]
  ds_read_b64_tr_b16 a[192:193], v246 offset:49152
  v_mfma_f32_16x16x32_bf16 v[48:51], a[204:207], a[120:123], v[48:51]
  buffer_load_dwordx4 v[108:111], v0, s[36:39], s85 offen offset:3072 sc1
  ds_read_b64_tr_b16 a[194:195], v246 offset:53248
  v_mfma_f32_16x16x32_bf16 v[52:55], a[204:207], a[124:127], v[52:55]
  ds_read_b64_tr_b16 a[196:197], v246 offset:57344
  v_mfma_f32_16x16x32_bf16 v[52:55], a[200:203], a[116:119], v[52:55]
  s_waitcnt lgkmcnt(11)
  buffer_load_dwordx4 v[112:115], v0, s[36:39], s90 offen offset:0 sc1
  ds_read_b64_tr_b16 a[198:199], v246 offset:61440
  v_mfma_f32_16x16x32_bf16 v[60:63], a[208:211], a[116:119], v[60:63]
  ds_read_b64_tr_b16 a[200:201], v247 offset:49152
  v_mfma_f32_16x16x32_bf16 v[60:63], a[212:215], a[124:127], v[60:63]
  buffer_load_dwordx4 v[116:119], v0, s[36:39], s90 offen offset:1024 sc1
  ds_read_b64_tr_b16 a[202:203], v247 offset:53248
  v_mfma_f32_16x16x32_bf16 v[56:59], a[212:215], a[120:123], v[56:59]
  ds_read_b64_tr_b16 a[204:205], v247 offset:57344
  v_mfma_f32_16x16x32_bf16 v[56:59], a[208:211], a[112:115], v[56:59]
  s_waitcnt lgkmcnt(11)
  buffer_load_dwordx4 v[120:123], v0, s[36:39], s90 offen offset:2048 sc1
  ds_read_b64_tr_b16 a[206:207], v247 offset:61440
  v_mfma_f32_16x16x32_bf16 v[32:35], a[176:179], a[216:219], v[32:35]
  v_mfma_f32_16x16x32_bf16 v[32:35], a[180:183], a[224:227], v[32:35]
  buffer_load_dwordx4 v[124:127], v0, s[36:39], s90 offen offset:3072 sc1
  v_mfma_f32_16x16x32_bf16 v[36:39], a[180:183], a[228:231], v[36:39]
  v_mfma_f32_16x16x32_bf16 v[36:39], a[176:179], a[220:223], v[36:39]
  s_waitcnt lgkmcnt(8)
  v_mfma_f32_16x16x32_bf16 v[44:47], a[184:187], a[220:223], v[44:47]
  v_mfma_f32_16x16x32_bf16 v[44:47], a[188:191], a[228:231], v[44:47]
  v_mfma_f32_16x16x32_bf16 v[40:43], a[188:191], a[224:227], v[40:43]
  v_mfma_f32_16x16x32_bf16 v[40:43], a[184:187], a[216:219], v[40:43]
  s_waitcnt lgkmcnt(4)
  v_mfma_f32_16x16x32_bf16 v[48:51], a[192:195], a[216:219], v[48:51]
  v_mfma_f32_16x16x32_bf16 v[48:51], a[196:199], a[224:227], v[48:51]
  v_mfma_f32_16x16x32_bf16 v[52:55], a[196:199], a[228:231], v[52:55]
  v_mfma_f32_16x16x32_bf16 v[52:55], a[192:195], a[220:223], v[52:55]
  s_waitcnt lgkmcnt(0)
  v_mfma_f32_16x16x32_bf16 v[60:63], a[200:203], a[220:223], v[60:63]
  v_mfma_f32_16x16x32_bf16 v[60:63], a[204:207], a[228:231], v[60:63]
  v_mfma_f32_16x16x32_bf16 v[56:59], a[204:207], a[224:227], v[56:59]
  v_mfma_f32_16x16x32_bf16 v[56:59], a[200:203], a[216:219], v[56:59]
  s_cmp_eq_u32 s69, 1
  s_cbranch_scc0 CKXs
CKXx:
  v_pk_fma_f32 v[64:65], v[176:177], v[32:33], v[64:65]
  v_pk_fma_f32 v[66:67], v[178:179], v[34:35], v[66:67]
  v_pk_fma_f32 v[80:81], v[176:177], v[36:37], v[80:81]
  v_pk_fma_f32 v[82:83], v[178:179], v[38:39], v[82:83]
  v_pk_fma_f32 v[68:69], v[180:181], v[40:41], v[68:69]
  v_pk_fma_f32 v[70:71], v[182:183], v[42:43], v[70:71]
  v_pk_fma_f32 v[84:85], v[180:181], v[44:45], v[84:85]
  v_pk_fma_f32 v[86:87], v[182:183], v[46:47], v[86:87]
  v_pk_fma_f32 v[72:73], v[184:185], v[48:49], v[72:73]
  v_pk_fma_f32 v[74:75], v[186:187], v[50:51], v[74:75]
  v_pk_fma_f32 v[88:89], v[184:185], v[52:53], v[88:89]
  v_pk_fma_f32 v[90:91], v[186:187], v[54:55], v[90:91]
  v_pk_fma_f32 v[76:77], v[188:189], v[56:57], v[76:77]
  v_pk_fma_f32 v[78:79], v[190:191], v[58:59], v[78:79]
  v_pk_fma_f32 v[92:93], v[188:189], v[60:61], v[92:93]
  v_pk_fma_f32 v[94:95], v[190:191], v[62:63], v[94:95]
  s_waitcnt vmcnt(7)
  v_pk_fma_f32 v[64:65], v[176:177], v[96:97], v[64:65]
  v_pk_fma_f32 v[66:67], v[178:179], v[98:99], v[66:67]
  v_cvt_pk_bf16_f32 v192, v64, v65
  v_cvt_pk_bf16_f32 v193, v66, v67
  ds_write_b64 v140, v[192:193] offset:0
  s_waitcnt vmcnt(6)
  v_pk_fma_f32 v[80:81], v[176:177], v[100:101], v[80:81]
  v_pk_fma_f32 v[82:83], v[178:179], v[102:103], v[82:83]
  v_cvt_pk_bf16_f32 v200, v80, v81
  v_cvt_pk_bf16_f32 v201, v82, v83
  ds_write_b64 v140, v[200:201] offset:2048
  s_waitcnt vmcnt(5)
  v_pk_fma_f32 v[68:69], v[180:181], v[104:105], v[68:69]
  v_pk_fma_f32 v[70:71], v[182:183], v[106:107], v[70:71]
  v_cvt_pk_bf16_f32 v194, v68, v69
  v_cvt_pk_bf16_f32 v195, v70, v71
  ds_write_b64 v141, v[194:195] offset:0
  s_waitcnt vmcnt(4)
  v_pk_fma_f32 v[84:85], v[180:181], v[108:109], v[84:85]
  v_pk_fma_f32 v[86:87], v[182:183], v[110:111], v[86:87]
  v_cvt_pk_bf16_f32 v202, v84, v85
  v_cvt_pk_bf16_f32 v203, v86, v87
  ds_write_b64 v141, v[202:203] offset:2048
  s_waitcnt vmcnt(3)
  v_pk_fma_f32 v[72:73], v[184:185], v[112:113], v[72:73]
  v_pk_fma_f32 v[74:75], v[186:187], v[114:115], v[74:75]
  v_cvt_pk_bf16_f32 v196, v72, v73
  v_cvt_pk_bf16_f32 v197, v74, v75
  ds_write_b64 v142, v[196:197] offset:0
  s_waitcnt vmcnt(2)
  v_pk_fma_f32 v[88:89], v[184:185], v[116:117], v[88:89]
  v_pk_fma_f32 v[90:91], v[186:187], v[118:119], v[90:91]
  v_cvt_pk_bf16_f32 v204, v88, v89
  v_cvt_pk_bf16_f32 v205, v90, v91
  ds_write_b64 v142, v[204:205] offset:2048
  s_waitcnt vmcnt(1)
  v_pk_fma_f32 v[76:77], v[188:189], v[120:121], v[76:77]
  v_pk_fma_f32 v[78:79], v[190:191], v[122:123], v[78:79]
  v_cvt_pk_bf16_f32 v198, v76, v77
  v_cvt_pk_bf16_f32 v199, v78, v79
  ds_write_b64 v143, v[198:199] offset:0
  s_waitcnt vmcnt(0)
  v_pk_fma_f32 v[92:93], v[188:189], v[124:125], v[92:93]
  v_pk_fma_f32 v[94:95], v[190:191], v[126:127], v[94:95]
  v_cvt_pk_bf16_f32 v206, v92, v93
  v_cvt_pk_bf16_f32 v207, v94, v95
  ds_write_b64 v143, v[206:207] offset:2048
  ds_read_b128 v[64:67], v255 offset:0
  ds_read_b128 v[68:71], v255 offset:1024
  ds_read_b128 v[72:75], v255 offset:2048
  ds_read_b128 v[76:79], v255 offset:3072
  s_waitcnt lgkmcnt(3)
  buffer_store_dwordx4 v[64:67], v252, s[32:35], s72 offen
  s_waitcnt lgkmcnt(2)
  buffer_store_dwordx4 v[68:71], v253, s[32:35], s72 offen
  s_waitcnt lgkmcnt(1)
  buffer_store_dwordx4 v[72:75], v252, s[32:35], s49 offen
  s_waitcnt lgkmcnt(0)
  buffer_store_dwordx4 v[76:79], v253, s[32:35], s49 offen
X_k3_main_kernel:
  s_endpgm
CK3s:
  s_mov_b32 s46, 30000
CK3:
  s_mov_b32 s49, 0
  buffer_load_dwordx4 v[156:159], v248, s[36:39], s49 offen sc1
  s_mov_b32 s49, 24576
  buffer_load_dwordx4 v[160:163], v248, s[36:39], s49 offen sc1
  s_mov_b32 s49, 49152
  buffer_load_dwordx4 v[164:167], v248, s[36:39], s49 offen sc1
  s_mov_b32 s49, 73728
  buffer_load_dwordx4 v[168:171], v248, s[36:39], s49 offen sc1
  s_sub_u32 s46, s46, 1
  s_waitcnt vmcnt(0)
  v_max_u32 v15, v156, v157
  v_max3_u32 v15, v15, v158, v159
  v_max3_u32 v15, v15, v160, v161
  v_max3_u32 v15, v15, v162, v163
  v_max3_u32 v15, v15, v164, v165
  v_max3_u32 v15, v15, v166, v167
  v_max3_u32 v15, v15, v168, v169
  v_max3_u32 v15, v15, v170, v171
  s_cmp_eq_u32 s46, 0
  s_cbranch_scc1 CK3x
  v_cmp_eq_u32 vcc, -1, v15
  s_nop 4
  s_cbranch_vccnz CK3
  s_branch CK3x
CK5s:
  s_mov_b32 s46, 30000
CK5:
  buffer_load_dwordx4 a[208:211], v25, s[36:39], s68 offen offset:0 sc1
  buffer_load_dwordx4 a[212:215], v25, s[36:39], s68 offen offset:2048 sc1
  buffer_load_dwordx4 a[216:219], v25, s[36:39], s67 offen offset:0 sc1
  buffer_load_dwordx4 a[220:223], v25, s[36:39], s67 offen offset:2048 sc1
  s_sub_u32 s46, s46, 1
  s_waitcnt vmcnt(0)
  v_accvgpr_read_b32 v26, a208
  v_accvgpr_read_b32 v27, a209
  v_accvgpr_read_b32 v28, a210
  v_accvgpr_read_b32 v29, a211
  v_max_u32 v31, v26, v27
  v_max3_u32 v31, v31, v28, v29
  v_accvgpr_read_b32 v22, a212
  v_accvgpr_read_b32 v23, a213
  v_max3_u32 v31, v31, v22, v23
  v_add_f32 v26, v26, v22
  v_add_f32 v27, v27, v23
  v_accvgpr_read_b32 v22, a214
  v_accvgpr_read_b32 v23, a215
  v_max3_u32 v31, v31, v22, v23
  v_add_f32 v28, v28, v22
  v_add_f32 v29, v29, v23
  v_accvgpr_read_b32 v22, a216
  v_accvgpr_read_b32 v23, a217
  v_max3_u32 v31, v31, v22, v23
  v_add_f32 v26, v26, v22
  v_add_f32 v27, v27, v23
  v_accvgpr_read_b32 v22, a218
  v_accvgpr_read_b32 v23, a219
  v_max3_u32 v31, v31, v22, v23
  v_add_f32 v28, v28, v22
  v_add_f32 v29, v29, v23
  v_accvgpr_read_b32 v22, a220
  v_accvgpr_read_b32 v23, a221
  v_max3_u32 v31, v31, v22, v23
  v_add_f32 v26, v26, v22
  v_add_f32 v27, v27, v23
  v_accvgpr_read_b32 v22, a222
  v_accvgpr_read_b32 v23, a223
  v_max3_u32 v31, v31, v22, v23
  v_add_f32 v28, v28, v22
  v_add_f32 v29, v29, v23
  s_cmp_eq_u32 s46, 0
  s_cbranch_scc1 CK5x
  v_cmp_eq_u32 vcc, -1, v31
  s_nop 4
  s_cbranch_vccnz CK5
  s_branch CK5x
CK6s:
  s_mov_b32 s46, 60000
CK6:
  buffer_load_dword v139, v138, s[36:39], s91 offen sc1
  s_sub_u32 s46, s46, 1
  s_cmp_eq_u32 s46, 0
  s_waitcnt vmcnt(0)
  s_cbranch_scc1 CK6x
  v_cmp_ne_u32 vcc, 1, v139
  s_nop 4
  s_cbranch_vccnz CK6
  s_branch CK6x
CK7s:
  s_mov_b32 s46, 60000
CK7:
  buffer_load_dword v139, v138, s[36:39], s91 offen sc1
  s_sub_u32 s46, s46, 1
  s_cmp_eq_u32 s46, 0
  s_waitcnt vmcnt(0)
  s_cbranch_scc1 CK7x
  v_cmp_ne_u32 vcc, 1, v139
  s_nop 4
  s_cbranch_vccnz CK7
  s_branch CK7x
CKXs:
  s_mov_b32 s46, 60000
CKX:
  buffer_load_dword v139, v132, s[36:39], s68 offen sc1
  s_sub_u32 s46, s46, 1
  s_cmp_eq_u32 s46, 0
  s_waitcnt vmcnt(0)
  s_cbranch_scc1 CKXy
  v_cmp_ne_u32 vcc, 1, v139
  s_nop 4
  s_cbranch_vccnz CKX
CKXy:
  buffer_load_dwordx4 v[96:99], v0, s[36:39], s62 offen offset:0 sc1
  buffer_load_dwordx4 v[100:103], v0, s[36:39], s62 offen offset:1024 sc1
  buffer_load_dwordx4 v[104:107], v0, s[36:39], s62 offen offset:2048 sc1
  buffer_load_dwordx4 v[108:111], v0, s[36:39], s62 offen offset:3072 sc1
  buffer_load_dwordx4 v[112:115], v0, s[36:39], s63 offen offset:0 sc1
  buffer_load_dwordx4 v[116:119], v0, s[36:39], s63 offen offset:1024 sc1
  buffer_load_dwordx4 v[120:123], v0, s[36:39], s63 offen offset:2048 sc1
  buffer_load_dwordx4 v[124:127], v0, s[36:39], s63 offen offset:3072 sc1
  s_branch CKXx
code_end:
.fill 2048, 4, 0xBF800000
.section .rodata,"a"
.p2align 6
.amdhsa_kernel k1_mod_kernel
  .amdhsa_next_free_vgpr 77
  .amdhsa_next_free_sgpr 48
  .amdhsa_accum_offset 80
  .amdhsa_group_segment_fixed_size 0
  .amdhsa_kernarg_size 96
  .amdhsa_user_sgpr_count 2
  .amdhsa_user_sgpr_kernarg_segment_ptr 1
  .amdhsa_system_sgpr_workgroup_id_x 1
  .amdhsa_float_denorm_mode_32 3
.end_amdhsa_kernel
.p2align 6
.amdhsa_kernel k3_main_kernel
  .amdhsa_next_free_vgpr 512
  .amdhsa_next_free_sgpr 102
  .amdhsa_accum_offset 256
  .amdhsa_group_segment_fixed_size 0
  .amdhsa_kernarg_size 96
  .amdhsa_user_sgpr_count 2
  .amdhsa_user_sgpr_kernarg_segment_ptr 1
  .amdhsa_system_sgpr_workgroup_id_x 1
  .amdhsa_float_denorm_mode_32 3
.end_amdhsa_kernel
```

```asm
; @launch grid=(256,1,1) block=(256,1,1) lds=163840
.amdgcn_target "amdgcn-amd-amdhsa--gfx950"
.text
.globl adaLN_cond__sliding_local_dilated__swiglu_ffn__prompt_kernel
.type adaLN_cond__sliding_local_dilated__swiglu_ffn__prompt_kernel,@function
.p2align 12
.p2align 8
adaLN_cond__sliding_local_dilated__swiglu_ffn__prompt_kernel:
  s_cmp_ge_u32 s2, 256
  s_cbranch_scc1 XEND
  s_load_dwordx2 s[36:37], s[0:1], 88
  s_load_dwordx2 s[40:41], s[0:1], 56
  s_load_dwordx2 s[28:29], s[0:1], 64
  s_load_dwordx2 s[4:5], s[0:1], 0
  s_load_dwordx2 s[8:9], s[0:1], 8
  s_load_dwordx2 s[12:13], s[0:1], 16
  s_load_dwordx2 s[16:17], s[0:1], 32
  s_load_dwordx2 s[20:21], s[0:1], 40
  s_load_dwordx2 s[24:25], s[0:1], 48
  s_load_dwordx2 s[32:33], s[0:1], 72
  v_lshrrev_b32 v1, 6, v0
  v_and_b32 v10, 63, v0
  v_readfirstlane_b32 s44, v1
  v_lshlrev_b32 v0, 4, v10
  s_mov_b32 s38, 50331648
  s_mov_b32 s39, 0x20000
  s_mov_b32 s42, 2048
  s_mov_b32 s43, 0x20000
  s_mov_b32 s30, 12582912
  s_mov_b32 s31, 0x20000
  s_mov_b32 s6, 4194304
  s_mov_b32 s7, 0x20000
  s_mov_b32 s10, 6291456
  s_mov_b32 s11, 0x20000
  s_mov_b32 s14, 2097152
  s_mov_b32 s15, 0x20000
  s_mov_b32 s18, 7340032
  s_mov_b32 s19, 0x20000
  s_mov_b32 s22, 7340032
  s_mov_b32 s23, 0x20000
  s_mov_b32 s26, 7340032
  s_mov_b32 s27, 0x20000
  s_mov_b32 s34, 4194304
  s_mov_b32 s35, 0x20000
  s_and_b32 s48, s2, 3
  s_lshl2_add_u32 s48, s48, s44
  s_lshl_b32 s48, s48, 6
  v_and_b32 v176, 0x38, v10
  v_add_u32 v176, s48, v176
  v_lshlrev_b32 v177, 1, v176
  v_mul_u32_u24 v176, 12288, v176
  v_and_b32 v12, 7, v10
  v_lshl_add_u32 v176, v12, 4, v176
  v_mov_b32 v178, 0
  s_bfe_u32 s51, s2, 0x40003
  s_and_b32 s49, s2, 4
  s_lshl2_add_u32 s51, s49, s51
  s_and_b32 s49, s2, 128
  s_lshl2_add_u32 s51, s51, s49
  s_lshl_b32 s51, s51, 5
  s_mov_b32 s49, s51
  s_mov_b32 s50, 5505024
  v_lshrrev_b32 v13, 3, v10
  v_lshlrev_b32 v132, 11, v12
  v_lshl_add_u32 v132, v13, 4, v132
  s_and_b32 s48, s2, 127
  s_lshl_b32 s48, s48, 6
  s_add_u32 s48, s48, s44
  s_lshl_b32 s48, s48, 9
  s_cmp_lt_u32 s2, 128
  s_waitcnt lgkmcnt(0)
  buffer_load_dwordx4 v[188:191], v177, s[40:43], 0 offen
  s_cbranch_scc0 F_x
  buffer_load_dwordx4 v[136:139], v176, s[28:31], s49 offen nt
  s_add_u32 s49, s49, 12288
  buffer_load_dwordx4 v[140:143], v176, s[28:31], s49 offen nt
  s_add_u32 s49, s49, 12288
  buffer_load_dwordx4 v[144:147], v176, s[28:31], s49 offen nt
  s_add_u32 s49, s49, 12288
  buffer_load_dwordx4 v[148:151], v176, s[28:31], s49 offen nt
  s_add_u32 s49, s49, 12288
  buffer_load_dwordx4 v[152:155], v176, s[28:31], s49 offen nt
  s_add_u32 s49, s49, 12288
  buffer_load_dwordx4 v[156:159], v176, s[28:31], s49 offen nt
  s_add_u32 s49, s49, 12288
  buffer_load_dwordx4 v[160:163], v176, s[28:31], s49 offen nt
  s_add_u32 s49, s49, 12288
  buffer_load_dwordx4 v[164:167], v176, s[28:31], s49 offen nt
F_x:
  buffer_load_dword v195, v178, s[36:39], s50 offen sc1
  s_mov_b32 s50, s48
  s_getpc_b64 s[92:93]
PC0:
  s_sub_u32 s92, s92, PC0-adaLN_cond__sliding_local_dilated__swiglu_ffn__prompt_kernel
  s_subb_u32 s93, s93, 0
  s_cmp_lt_u32 s2, 128
  s_cbranch_scc1 F_ct
  s_bfe_u32 s48, s2, 0x30004
  s_and_b32 s49, s2, 3
  s_lshl3_add_u32 s48, s49, s48
  s_mul_i32 s48, s48, 393216
  s_and_b32 s49, s2, 4
  s_lshl_b32 s49, s49, 9
  s_add_u32 s48, s48, s49
  s_and_b32 s49, s2, 8
  s_lshl_b32 s49, s49, 7
  s_add_u32 s48, s48, s49
  s_cmp_lt_u32 s44, 1
  s_cselect_b32 s48, s48, 1073741824
  v_and_b32 v19, 31, v10
  v_mul_u32_u24 v19, 12288, v19
  buffer_load_dword a252, v19, s[28:31], s48 offen offset:384
  s_bfe_u32 s48, s2, 0x40003
  s_cmp_lt_u32 s48, (code_end-adaLN_cond__sliding_local_dilated__swiglu_ffn__prompt_kernel)/8192+1
  s_cselect_b32 s49, 3, 4
  s_lshl_b32 s48, s48, 13
  v_lshl_add_u32 v19, v0, 3, s48
  s_cmp_eq_u32 s44, s49
  s_cselect_b32 s49, -1, 0
  v_and_b32 v19, s49, v19
  global_load_dword a252, v19, s[92:93]
  s_bfe_u32 s48, s2, 0x20003
  s_mul_i32 s48, s48, 24576
  s_lshr_b32 s49, s2, 5
  s_lshl3_add_u32 s49, s44, s49
  s_cmp_eq_u32 s49, 15
  s_cselect_b32 s48, s48, 1073741824
  v_lshlrev_b32 v19, 3, v0
  buffer_load_dword a252, v19, s[36:39], s48 offen sc1
F_ct:
  s_and_b32 s48, s2, 7
  s_lshr_b32 s49, s2, 3
  s_and_b32 s58, s48, 3
  s_lshl_b32 s58, s58, 2
  s_and_b32 s57, s49, 3
  s_add_u32 s58, s58, s57
  s_lshr_b32 s57, s48, 2
  s_lshl_b32 s57, s57, 3
  s_lshr_b32 s49, s49, 2
  s_add_u32 s57, s57, s49
  s_lshr_b32 s59, s44, 1
  s_and_b32 s60, s44, 1
  s_mul_i32 s63, s44, 3072
  s_lshl_b32 s64, s44, 11
  s_lshl_b32 s65, s44, 8
  v_bfe_u32 v14, v10, 4, 2
  v_bfe_u32 v15, v10, 1, 2
  v_xor_b32 v14, v14, v15
  v_lshlrev_b32 v14, 5, v14
  v_and_b32 v15, 1, v10
  v_lshl_add_u32 v213, v15, 4, v14
  s_lshl_b32 s48, s58, 7
  s_mul_i32 s49, s44, 49152
  s_add_u32 s48, s48, s49
  v_mul_u32_u24 v14, 6144, v13
  v_add3_u32 v202, v14, v213, s48
  v_add_u32 v203, 1024, v202
  v_add_u32 v204, 2048, v202
  v_bfe_u32 v14, v10, 3, 2
  v_lshlrev_b32 v14, 5, v14
  v_and_b32 v15, 3, v10
  v_lshl_add_u32 v214, v15, 3, v14
  v_bfe_u32 v14, v10, 2, 3
  v_lshrrev_b32 v15, 5, v10
  v_mul_u32_u24 v15, 24, v15
  v_add_lshl_u32 v14, v14, v15, 7
  s_lshl_b32 s48, s60, 1
  s_add_u32 s48, s48, s59
  s_lshl_b32 s48, s48, 5
  v_xor_b32 v15, s48, v214
  v_add_u32 v196, v14, v15
  v_xor_b32 v197, 32, v196
  v_add_u32 v198, 64512, v196
  v_add_u32 v199, 64512, v197
  v_add_u32 v200, 129024, v196
  v_add_u32 v201, 129024, v197
  s_lshl_b32 s48, s57, 2
  s_add_u32 s49, s48, s44
  s_lshl_b32 s49, s49, 16
  s_add_u32 s49, s49, 1048576
  v_add_u32 v205, s49, v0
  s_max_u32 s48, s48, 1
  s_lshl_b32 s48, s48, 16
  s_add_u32 s48, s48, 984064
  s_add_u32 s48, s48, s65
  v_lshl_add_u32 v206, v10, 2, s48
  s_lshl_b32 s48, s59, 12
  v_add_u32 v210, 0, v0
  v_add_u32 v207, s48, v210
  v_add_u32 v211, 64512, v0
  v_add_u32 v208, s48, v211
  v_add_u32 v212, 129024, v0
  v_add_u32 v209, s48, v212
  s_lshl3_add_u32 s48, s57, 127
  v_min_u32 v215, 8, v10
  v_add_u32 v215, s48, v215
  v_max_u32 v215, 0x80, v215
  v_lshlrev_b32 v215, 7, v215
  v_lshlrev_b32 v18, 5, v12
  v_lshrrev_b32 v19, 4, v10
  v_lshl_add_u32 v18, v19, 3, v18
  s_add_u32 s48, s65, 162816
  v_add_u32 v177, s48, v18
  v_lshlrev_b32 v178, 2, v10
  s_and_b32 s49, s2, 3
  s_mul_i32 s56, s49, 24576
  s_lshl1_add_u32 s56, s51, s56
  s_add_u32 s51, s51, 4096
  s_cmp_lt_u32 s2, 128
  s_cbranch_scc1 F_cw
  s_waitcnt vmcnt(4)
F_cw:
  s_waitcnt vmcnt(9)
  v_lshlrev_b32 v168, 16, v188
  v_and_b32 v169, 0xffff0000, v188
  v_lshlrev_b32 v170, 16, v189
  v_and_b32 v171, 0xffff0000, v189
  v_lshlrev_b32 v172, 16, v190
  v_and_b32 v173, 0xffff0000, v190
  v_lshlrev_b32 v174, 16, v191
  v_and_b32 v175, 0xffff0000, v191
  v_mul_f32 v180, 0xbfb8aa3b, v168
  v_mul_f32 v181, 0xbfb8aa3b, v169
  v_mul_f32 v182, 0xbfb8aa3b, v170
  v_mul_f32 v183, 0xbfb8aa3b, v171
  v_mul_f32 v184, 0xbfb8aa3b, v172
  v_mul_f32 v185, 0xbfb8aa3b, v173
  v_mul_f32 v186, 0xbfb8aa3b, v174
  v_mul_f32 v187, 0xbfb8aa3b, v175
  v_exp_f32 v180, v180
  v_exp_f32 v181, v181
  v_exp_f32 v182, v182
  v_exp_f32 v183, v183
  v_exp_f32 v184, v184
  v_exp_f32 v185, v185
  v_exp_f32 v186, v186
  v_exp_f32 v187, v187
  v_add_f32 v180, 1.0, v180
  v_add_f32 v181, 1.0, v181
  v_add_f32 v182, 1.0, v182
  v_add_f32 v183, 1.0, v183
  v_add_f32 v184, 1.0, v184
  v_add_f32 v185, 1.0, v185
  v_add_f32 v186, 1.0, v186
  v_add_f32 v187, 1.0, v187
  v_rcp_f32 v180, v180
  v_rcp_f32 v181, v181
  v_rcp_f32 v182, v182
  v_rcp_f32 v183, v183
  v_rcp_f32 v184, v184
  v_rcp_f32 v185, v185
  v_rcp_f32 v186, v186
  v_rcp_f32 v187, v187
  v_mul_f32 v168, v168, v180
  v_mul_f32 v169, v169, v181
  v_mul_f32 v170, v170, v182
  v_mul_f32 v171, v171, v183
  v_mul_f32 v172, v172, v184
  v_mul_f32 v173, v173, v185
  v_mul_f32 v174, v174, v186
  v_mul_f32 v175, v175, v187
  v_cvt_pk_bf16_f32 v192, v168, v169
  v_lshlrev_b32 v168, 16, v192
  v_and_b32 v169, 0xffff0000, v192
  v_cvt_pk_bf16_f32 v192, v170, v171
  v_lshlrev_b32 v170, 16, v192
  v_and_b32 v171, 0xffff0000, v192
  v_cvt_pk_bf16_f32 v192, v172, v173
  v_lshlrev_b32 v172, 16, v192
  v_and_b32 v173, 0xffff0000, v192
  v_cvt_pk_bf16_f32 v192, v174, v175
  v_lshlrev_b32 v174, 16, v192
  v_and_b32 v175, 0xffff0000, v192
  s_cmp_lt_u32 s2, 128
  s_cbranch_scc1 F_xl1
  buffer_load_dwordx4 v[136:139], v132, s[4:7], s50 offen offset:0
  buffer_load_dwordx4 v[140:143], v132, s[4:7], s50 offen offset:128
  buffer_load_dwordx4 v[144:147], v132, s[4:7], s50 offen offset:256
  buffer_load_dwordx4 v[148:151], v132, s[4:7], s50 offen offset:384
  s_add_u32 s50, s50, 16384
  buffer_load_dwordx4 v[152:155], v132, s[4:7], s50 offen offset:0
  buffer_load_dwordx4 v[156:159], v132, s[4:7], s50 offen offset:128
  buffer_load_dwordx4 v[160:163], v132, s[4:7], s50 offen offset:256
  buffer_load_dwordx4 v[164:167], v132, s[4:7], s50 offen offset:384
F_xl1:
  s_cmp_lt_u32 s2, 128
  s_cbranch_scc0 AL
  s_waitcnt vmcnt(8)
  v_lshlrev_b32 v188, 16, v136
  v_and_b32 v189, 0xffff0000, v136
  v_lshlrev_b32 v190, 16, v137
  v_and_b32 v191, 0xffff0000, v137
  v_pk_mul_f32 v[180:181], v[188:189], v[168:169] op_sel_hi:[1,0]
  v_pk_mul_f32 v[182:183], v[190:191], v[168:169] op_sel_hi:[1,0]
  v_lshlrev_b32 v188, 16, v138
  v_and_b32 v189, 0xffff0000, v138
  v_lshlrev_b32 v190, 16, v139
  v_and_b32 v191, 0xffff0000, v139
  v_pk_mul_f32 v[184:185], v[188:189], v[168:169] op_sel_hi:[1,0]
  v_pk_mul_f32 v[186:187], v[190:191], v[168:169] op_sel_hi:[1,0]
  s_waitcnt vmcnt(7)
  v_lshlrev_b32 v188, 16, v140
  v_and_b32 v189, 0xffff0000, v140
  v_lshlrev_b32 v190, 16, v141
  v_and_b32 v191, 0xffff0000, v141
  v_pk_fma_f32 v[180:181], v[188:189], v[168:169], v[180:181] op_sel:[0,1,0] op_sel_hi:[1,1,1]
  v_pk_fma_f32 v[182:183], v[190:191], v[168:169], v[182:183] op_sel:[0,1,0] op_sel_hi:[1,1,1]
  v_lshlrev_b32 v188, 16, v142
  v_and_b32 v189, 0xffff0000, v142
  v_lshlrev_b32 v190, 16, v143
  v_and_b32 v191, 0xffff0000, v143
  v_pk_fma_f32 v[184:185], v[188:189], v[168:169], v[184:185] op_sel:[0,1,0] op_sel_hi:[1,1,1]
  v_pk_fma_f32 v[186:187], v[190:191], v[168:169], v[186:187] op_sel:[0,1,0] op_sel_hi:[1,1,1]
  s_waitcnt vmcnt(6)
  v_lshlrev_b32 v188, 16, v144
  v_and_b32 v189, 0xffff0000, v144
  v_lshlrev_b32 v190, 16, v145
  v_and_b32 v191, 0xffff0000, v145
  v_pk_fma_f32 v[180:181], v[188:189], v[170:171], v[180:181] op_sel:[0,0,0] op_sel_hi:[1,0,1]
  v_pk_fma_f32 v[182:183], v[190:191], v[170:171], v[182:183] op_sel:[0,0,0] op_sel_hi:[1,0,1]
  v_lshlrev_b32 v188, 16, v146
  v_and_b32 v189, 0xffff0000, v146
  v_lshlrev_b32 v190, 16, v147
  v_and_b32 v191, 0xffff0000, v147
  v_pk_fma_f32 v[184:185], v[188:189], v[170:171], v[184:185] op_sel:[0,0,0] op_sel_hi:[1,0,1]
  v_pk_fma_f32 v[186:187], v[190:191], v[170:171], v[186:187] op_sel:[0,0,0] op_sel_hi:[1,0,1]
  s_waitcnt vmcnt(5)
  v_lshlrev_b32 v188, 16, v148
  v_and_b32 v189, 0xffff0000, v148
  v_lshlrev_b32 v190, 16, v149
  v_and_b32 v191, 0xffff0000, v149
  v_pk_fma_f32 v[180:181], v[188:189], v[170:171], v[180:181] op_sel:[0,1,0] op_sel_hi:[1,1,1]
  v_pk_fma_f32 v[182:183], v[190:191], v[170:171], v[182:183] op_sel:[0,1,0] op_sel_hi:[1,1,1]
  v_lshlrev_b32 v188, 16, v150
  v_and_b32 v189, 0xffff0000, v150
  v_lshlrev_b32 v190, 16, v151
  v_and_b32 v191, 0xffff0000, v151
  v_pk_fma_f32 v[184:185], v[188:189], v[170:171], v[184:185] op_sel:[0,1,0] op_sel_hi:[1,1,1]
  v_pk_fma_f32 v[186:187], v[190:191], v[170:171], v[186:187] op_sel:[0,1,0] op_sel_hi:[1,1,1]
  s_waitcnt vmcnt(4)
  v_lshlrev_b32 v188, 16, v152
  v_and_b32 v189, 0xffff0000, v152
  v_lshlrev_b32 v190, 16, v153
  v_and_b32 v191, 0xffff0000, v153
  v_pk_fma_f32 v[180:181], v[188:189], v[172:173], v[180:181] op_sel:[0,0,0] op_sel_hi:[1,0,1]
  v_pk_fma_f32 v[182:183], v[190:191], v[172:173], v[182:183] op_sel:[0,0,0] op_sel_hi:[1,0,1]
  v_lshlrev_b32 v188, 16, v154
  v_and_b32 v189, 0xffff0000, v154
  v_lshlrev_b32 v190, 16, v155
  v_and_b32 v191, 0xffff0000, v155
  v_pk_fma_f32 v[184:185], v[188:189], v[172:173], v[184:185] op_sel:[0,0,0] op_sel_hi:[1,0,1]
  v_pk_fma_f32 v[186:187], v[190:191], v[172:173], v[186:187] op_sel:[0,0,0] op_sel_hi:[1,0,1]
  s_waitcnt vmcnt(3)
  v_lshlrev_b32 v188, 16, v156
  v_and_b32 v189, 0xffff0000, v156
  v_lshlrev_b32 v190, 16, v157
  v_and_b32 v191, 0xffff0000, v157
  v_pk_fma_f32 v[180:181], v[188:189], v[172:173], v[180:181] op_sel:[0,1,0] op_sel_hi:[1,1,1]
  v_pk_fma_f32 v[182:183], v[190:191], v[172:173], v[182:183] op_sel:[0,1,0] op_sel_hi:[1,1,1]
  v_lshlrev_b32 v188, 16, v158
  v_and_b32 v189, 0xffff0000, v158
  v_lshlrev_b32 v190, 16, v159
  v_and_b32 v191, 0xffff0000, v159
  v_pk_fma_f32 v[184:185], v[188:189], v[172:173], v[184:185] op_sel:[0,1,0] op_sel_hi:[1,1,1]
  v_pk_fma_f32 v[186:187], v[190:191], v[172:173], v[186:187] op_sel:[0,1,0] op_sel_hi:[1,1,1]
  s_waitcnt vmcnt(2)
  v_lshlrev_b32 v188, 16, v160
  v_and_b32 v189, 0xffff0000, v160
  v_lshlrev_b32 v190, 16, v161
  v_and_b32 v191, 0xffff0000, v161
  v_pk_fma_f32 v[180:181], v[188:189], v[174:175], v[180:181] op_sel:[0,0,0] op_sel_hi:[1,0,1]
  v_pk_fma_f32 v[182:183], v[190:191], v[174:175], v[182:183] op_sel:[0,0,0] op_sel_hi:[1,0,1]
  v_lshlrev_b32 v188, 16, v162
  v_and_b32 v189, 0xffff0000, v162
  v_lshlrev_b32 v190, 16, v163
  v_and_b32 v191, 0xffff0000, v163
  v_pk_fma_f32 v[184:185], v[188:189], v[174:175], v[184:185] op_sel:[0,0,0] op_sel_hi:[1,0,1]
  v_pk_fma_f32 v[186:187], v[190:191], v[174:175], v[186:187] op_sel:[0,0,0] op_sel_hi:[1,0,1]
  s_waitcnt vmcnt(1)
  v_lshlrev_b32 v188, 16, v164
  v_and_b32 v189, 0xffff0000, v164
  v_lshlrev_b32 v190, 16, v165
  v_and_b32 v191, 0xffff0000, v165
  v_pk_fma_f32 v[180:181], v[188:189], v[174:175], v[180:181] op_sel:[0,1,0] op_sel_hi:[1,1,1]
  v_pk_fma_f32 v[182:183], v[190:191], v[174:175], v[182:183] op_sel:[0,1,0] op_sel_hi:[1,1,1]
  v_lshlrev_b32 v188, 16, v166
  v_and_b32 v189, 0xffff0000, v166
  v_lshlrev_b32 v190, 16, v167
  v_and_b32 v191, 0xffff0000, v167
  v_pk_fma_f32 v[184:185], v[188:189], v[174:175], v[184:185] op_sel:[0,1,0] op_sel_hi:[1,1,1]
  v_pk_fma_f32 v[186:187], v[190:191], v[174:175], v[186:187] op_sel:[0,1,0] op_sel_hi:[1,1,1]
  s_nop 0
  v_permlane32_swap_b32 v180, v184
  v_permlane32_swap_b32 v181, v185
  v_permlane32_swap_b32 v182, v186
  v_permlane32_swap_b32 v183, v187
  v_add_f32 v180, v180, v184
  v_add_f32 v181, v181, v185
  v_add_f32 v182, v182, v186
  v_add_f32 v183, v183, v187
  s_nop 0
  v_permlane16_swap_b32 v180, v182
  v_permlane16_swap_b32 v181, v183
  v_add_f32 v180, v180, v182
  v_add_f32 v181, v181, v183
  v_add_u32 v188, 162816, v178
  v_add_f32_dpp v180, v180, v180 row_ror:8 row_mask:0xf bank_mask:0xf
  v_add_f32_dpp v181, v181, v181 row_ror:8 row_mask:0xf bank_mask:0xf
  ds_write_b64 v177, v[180:181]
  v_and_b32 v184, 3, v10
  v_lshlrev_b32 v184, 3, v184
  s_cmp_eq_u32 s44, 0
  s_cselect_b32 s48, s56, 1073741824
  s_waitcnt lgkmcnt(0)
  s_barrier
  ds_read_b32 v180, v188 offset:0
  ds_read_b32 v181, v188 offset:256
  ds_read_b32 v182, v188 offset:512
  ds_read_b32 v183, v188 offset:768
  s_waitcnt vmcnt(0)
  v_readfirstlane_b32 s3, v195
  s_lshl_b32 s45, s2, 7
  s_add_u32 s45, s45, 5242880
  s_cmp_eq_u32 s44, 0
  s_cselect_b32 s45, s45, 1073741824
  s_mul_i32 s3, s3, 0x9e3779b1
  s_add_u32 s3, s3, 0x7f4a7c15
  s_and_b32 s70, s2, 7
  s_bfe_u32 s49, s2, 0x20003
  s_lshl2_add_u32 s70, s70, s49
  s_lshr_b32 s49, s2, 5
  s_lshl3_add_u32 s70, s70, s49
  s_lshl1_add_u32 s70, s70, s44
  s_lshl_b32 s70, s70, 10
  s_add_u32 s70, s70, 524288
  s_add_u32 s56, s56, 8192
  s_cmp_lt_u32 s44, 2
  s_cselect_b32 s70, s70, 1073741824
  s_cmp_eq_u32 s44, 2
  s_cselect_b32 s71, s56, 1073741824
  v_bfe_u32 v184, s3, v184, 8
  v_mov_b32 v185, 0xffffff00
  s_waitcnt lgkmcnt(0)
  v_add_f32 v180, v180, v181
  v_add_f32 v182, v182, v183
  v_add_f32 v180, v180, v182
  v_add_u32 v180, 0x80, v180
  v_and_or_b32 v180, v180, v185, v184
  buffer_store_dword v180, v178, s[36:39], s48 offen sc1
  v_mov_b32 v184, -1
  v_mov_b32 v185, -1
  v_mov_b32 v186, -1
  v_mov_b32 v187, -1
  buffer_store_dwordx4 v[184:187], v0, s[36:39], s70 offen sc1
  buffer_store_dword v184, v178, s[36:39], s71 offen sc1
  s_lshl_b32 s48, s44, 7
  s_add_u32 s48, s48, s2
  s_lshl_b32 s48, s48, 13
  v_lshlrev_b32 v14, 3, v0
  s_mov_b32 s50, s48
  buffer_load_dword a252, v14, s[8:11], s50 offen
  s_mov_b32 s55, 0x20000
  s_sub_u32 s49, s48, 2097152
  s_add_u32 s48, s48, 4194304
  s_cmp_ge_u32 s44, 2
  s_cselect_b64 s[52:53], s[12:13], s[8:9]
  s_cselect_b32 s54, s14, s10
  s_cselect_b32 s48, s49, s48
  v_mov_b32 v12, s3
  s_waitcnt vmcnt(1)
  s_barrier
  s_mov_b64 exec, 1
  buffer_store_dword v12, v0, s[36:39], s45 offen sc1
  s_mov_b64 exec, -1
  s_waitcnt vmcnt(1)
  s_lshr_b32 s49, s2, 3
  s_mul_i32 s49, s49, 393216
  s_add_u32 s49, s49, s64
  s_and_b32 s50, s2, 2
  s_lshl_b32 s50, s50, 9
  s_add_u32 s49, s49, s50
  s_and_b32 s50, s2, 1
  s_lshl2_add_u32 s50, s50, s44
  s_cmp_lt_u32 s50, 3
  s_cselect_b32 s49, s49, 1073741824
  v_mul_u32_u24 v15, 6144, v10
  buffer_load_dword a252, v15, s[8:11], s49 offen offset:384
  buffer_load_dword a252, v14, s[52:55], s48 offen
  s_branch J2
.p2align 12
AL:
  s_waitcnt vmcnt(8)
  v_readfirstlane_b32 s3, v195
  s_lshl_b32 s45, s2, 7
  s_add_u32 s45, s45, 5242880
  s_cmp_eq_u32 s44, 0
  s_cselect_b32 s45, s45, 1073741824
  s_mul_i32 s3, s3, 0x9e3779b1
  s_add_u32 s3, s3, 0x7f4a7c15
  s_and_b32 s70, s2, 7
  s_bfe_u32 s49, s2, 0x20003
  s_lshl2_add_u32 s70, s70, s49
  s_lshr_b32 s49, s2, 5
  s_lshl3_add_u32 s70, s70, s49
  s_lshl1_add_u32 s70, s70, s44
  s_lshl_b32 s70, s70, 10
  s_add_u32 s70, s70, 524288
  s_add_u32 s56, s56, 8192
  s_cmp_lt_u32 s44, 2
  s_cselect_b32 s70, s70, 1073741824
  s_cmp_eq_u32 s44, 2
  s_cselect_b32 s71, s56, 1073741824
  s_add_u32 s48, s64, 150528
  v_add_u32 v14, s48, v0
  v_lshl_add_u32 v15, v13, 5, s48
  v_lshlrev_b32 v17, 6, v12
  v_add_u32 v17, 158720, v17
  s_lshl_b32 s48, s44, 4
  v_add_u32 v16, s48, v17
  v_bfe_u32 v18, v10, 3, 1
  v_lshlrev_b32 v132, 9, v18
  v_bfe_u32 v18, v10, 4, 1
  v_lshl_add_u32 v132, v18, 8, v132
  v_lshrrev_b32 v18, 5, v10
  v_lshl_add_u32 v132, v18, 11, v132
  v_lshl_add_u32 v132, v12, 4, v132
  s_bfe_u32 s50, s2, 0x60001
  s_lshl2_add_u32 s50, s50, s44
  s_lshl_b32 s50, s50, 4
  s_and_b32 s48, s2, 1
  s_add_u32 s50, s50, s48
  s_lshl_b32 s50, s50, 10
  s_add_u32 s50, s50, 1048576
  s_bfe_u32 s66, s3, 0x80000
  s_bfe_u32 s67, s3, 0x80008
  s_bfe_u32 s68, s3, 0x80010
  s_bfe_u32 s69, s3, 0x80018
  s_waitcnt vmcnt(7)
  v_lshlrev_b32 v20, 16, v136
  v_and_b32 v21, 0xffff0000, v136
  v_lshlrev_b32 v22, 16, v137
  v_and_b32 v23, 0xffff0000, v137
  v_lshlrev_b32 v24, 16, v138
  v_and_b32 v25, 0xffff0000, v138
  v_lshlrev_b32 v26, 16, v139
  v_and_b32 v27, 0xffff0000, v139
  v_pk_mul_f32 v[126:127], v[20:21], v[20:21]
  v_pk_mul_f32 v[130:131], v[22:23], v[22:23]
  v_pk_fma_f32 v[126:127], v[24:25], v[24:25], v[126:127]
  v_pk_add_f32 v[124:125], v[24:25], v[20:21]
  v_pk_fma_f32 v[130:131], v[26:27], v[26:27], v[130:131]
  v_pk_add_f32 v[128:129], v[26:27], v[22:23]
  s_waitcnt vmcnt(6)
  v_lshlrev_b32 v28, 16, v140
  v_and_b32 v29, 0xffff0000, v140
  v_lshlrev_b32 v30, 16, v141
  v_and_b32 v31, 0xffff0000, v141
  v_lshlrev_b32 v32, 16, v142
  v_and_b32 v33, 0xffff0000, v142
  v_lshlrev_b32 v34, 16, v143
  v_and_b32 v35, 0xffff0000, v143
  v_pk_fma_f32 v[126:127], v[28:29], v[28:29], v[126:127]
  v_pk_add_f32 v[124:125], v[28:29], v[124:125]
  v_pk_fma_f32 v[130:131], v[30:31], v[30:31], v[130:131]
  v_pk_add_f32 v[128:129], v[30:31], v[128:129]
  v_pk_fma_f32 v[126:127], v[32:33], v[32:33], v[126:127]
  v_pk_add_f32 v[124:125], v[32:33], v[124:125]
  v_pk_fma_f32 v[130:131], v[34:35], v[34:35], v[130:131]
  v_pk_add_f32 v[128:129], v[34:35], v[128:129]
  s_waitcnt vmcnt(5)
  v_lshlrev_b32 v36, 16, v144
  v_and_b32 v37, 0xffff0000, v144
  v_lshlrev_b32 v38, 16, v145
  v_and_b32 v39, 0xffff0000, v145
  v_lshlrev_b32 v40, 16, v146
  v_and_b32 v41, 0xffff0000, v146
  v_lshlrev_b32 v42, 16, v147
  v_and_b32 v43, 0xffff0000, v147
  v_pk_fma_f32 v[126:127], v[36:37], v[36:37], v[126:127]
  v_pk_add_f32 v[124:125], v[36:37], v[124:125]
  v_pk_fma_f32 v[130:131], v[38:39], v[38:39], v[130:131]
  v_pk_add_f32 v[128:129], v[38:39], v[128:129]
  v_pk_fma_f32 v[126:127], v[40:41], v[40:41], v[126:127]
  v_pk_add_f32 v[124:125], v[40:41], v[124:125]
  v_pk_fma_f32 v[130:131], v[42:43], v[42:43], v[130:131]
  v_pk_add_f32 v[128:129], v[42:43], v[128:129]
  s_waitcnt vmcnt(4)
  v_lshlrev_b32 v44, 16, v148
  v_and_b32 v45, 0xffff0000, v148
  v_lshlrev_b32 v46, 16, v149
  v_and_b32 v47, 0xffff0000, v149
  v_lshlrev_b32 v48, 16, v150
  v_and_b32 v49, 0xffff0000, v150
  v_lshlrev_b32 v50, 16, v151
  v_and_b32 v51, 0xffff0000, v151
  v_pk_fma_f32 v[126:127], v[44:45], v[44:45], v[126:127]
  v_pk_add_f32 v[124:125], v[44:45], v[124:125]
  v_pk_fma_f32 v[130:131], v[46:47], v[46:47], v[130:131]
  v_pk_add_f32 v[128:129], v[46:47], v[128:129]
  v_pk_fma_f32 v[126:127], v[48:49], v[48:49], v[126:127]
  v_pk_add_f32 v[124:125], v[48:49], v[124:125]
  v_pk_fma_f32 v[130:131], v[50:51], v[50:51], v[130:131]
  v_pk_add_f32 v[128:129], v[50:51], v[128:129]
  v_pk_add_f32 v[124:125], v[124:125], v[128:129]
  v_pk_add_f32 v[126:127], v[126:127], v[130:131]
  v_add_f32 v180, v124, v125
  v_add_f32 v181, v126, v127
  s_waitcnt vmcnt(3)
  v_lshlrev_b32 v52, 16, v152
  v_and_b32 v53, 0xffff0000, v152
  v_lshlrev_b32 v54, 16, v153
  v_and_b32 v55, 0xffff0000, v153
  v_lshlrev_b32 v56, 16, v154
  v_and_b32 v57, 0xffff0000, v154
  v_lshlrev_b32 v58, 16, v155
  v_and_b32 v59, 0xffff0000, v155
  v_pk_mul_f32 v[126:127], v[52:53], v[52:53]
  v_pk_mul_f32 v[130:131], v[54:55], v[54:55]
  v_pk_fma_f32 v[126:127], v[56:57], v[56:57], v[126:127]
  v_pk_add_f32 v[124:125], v[56:57], v[52:53]
  v_pk_fma_f32 v[130:131], v[58:59], v[58:59], v[130:131]
  v_pk_add_f32 v[128:129], v[58:59], v[54:55]
  s_waitcnt vmcnt(2)
  v_lshlrev_b32 v60, 16, v156
  v_and_b32 v61, 0xffff0000, v156
  v_lshlrev_b32 v62, 16, v157
  v_and_b32 v63, 0xffff0000, v157
  v_lshlrev_b32 v64, 16, v158
  v_and_b32 v65, 0xffff0000, v158
  v_lshlrev_b32 v66, 16, v159
  v_and_b32 v67, 0xffff0000, v159
  v_pk_fma_f32 v[126:127], v[60:61], v[60:61], v[126:127]
  v_pk_add_f32 v[124:125], v[60:61], v[124:125]
  v_pk_fma_f32 v[130:131], v[62:63], v[62:63], v[130:131]
  v_pk_add_f32 v[128:129], v[62:63], v[128:129]
  v_pk_fma_f32 v[126:127], v[64:65], v[64:65], v[126:127]
  v_pk_add_f32 v[124:125], v[64:65], v[124:125]
  v_pk_fma_f32 v[130:131], v[66:67], v[66:67], v[130:131]
  v_pk_add_f32 v[128:129], v[66:67], v[128:129]
  s_waitcnt vmcnt(1)
  v_lshlrev_b32 v68, 16, v160
  v_and_b32 v69, 0xffff0000, v160
  v_lshlrev_b32 v70, 16, v161
  v_and_b32 v71, 0xffff0000, v161
  v_lshlrev_b32 v72, 16, v162
  v_and_b32 v73, 0xffff0000, v162
  v_lshlrev_b32 v74, 16, v163
  v_and_b32 v75, 0xffff0000, v163
  v_pk_fma_f32 v[126:127], v[68:69], v[68:69], v[126:127]
  v_pk_add_f32 v[124:125], v[68:69], v[124:125]
  v_pk_fma_f32 v[130:131], v[70:71], v[70:71], v[130:131]
  v_pk_add_f32 v[128:129], v[70:71], v[128:129]
  v_pk_fma_f32 v[126:127], v[72:73], v[72:73], v[126:127]
  v_pk_add_f32 v[124:125], v[72:73], v[124:125]
  v_pk_fma_f32 v[130:131], v[74:75], v[74:75], v[130:131]
  v_pk_add_f32 v[128:129], v[74:75], v[128:129]
  s_waitcnt vmcnt(0)
  v_lshlrev_b32 v76, 16, v164
  v_and_b32 v77, 0xffff0000, v164
  v_lshlrev_b32 v78, 16, v165
  v_and_b32 v79, 0xffff0000, v165
  v_lshlrev_b32 v80, 16, v166
  v_and_b32 v81, 0xffff0000, v166
  v_lshlrev_b32 v82, 16, v167
  v_and_b32 v83, 0xffff0000, v167
  v_pk_fma_f32 v[126:127], v[76:77], v[76:77], v[126:127]
  v_pk_add_f32 v[124:125], v[76:77], v[124:125]
  v_pk_fma_f32 v[130:131], v[78:79], v[78:79], v[130:131]
  v_pk_add_f32 v[128:129], v[78:79], v[128:129]
  v_pk_fma_f32 v[126:127], v[80:81], v[80:81], v[126:127]
  v_pk_add_f32 v[124:125], v[80:81], v[124:125]
  v_pk_fma_f32 v[130:131], v[82:83], v[82:83], v[130:131]
  v_pk_add_f32 v[128:129], v[82:83], v[128:129]
  v_pk_add_f32 v[124:125], v[124:125], v[128:129]
  v_pk_add_f32 v[126:127], v[126:127], v[130:131]
  v_add_f32 v182, v124, v125
  v_add_f32 v183, v126, v127
  s_nop 0
  v_add_f32_dpp v188, v180, v180 row_ror:8 row_mask:0xf bank_mask:0xf
  v_add_f32_dpp v189, v181, v181 row_ror:8 row_mask:0xf bank_mask:0xf
  v_add_f32_dpp v190, v182, v182 row_ror:8 row_mask:0xf bank_mask:0xf
  v_add_f32_dpp v191, v183, v183 row_ror:8 row_mask:0xf bank_mask:0xf
  v_mov_b32 v180, v188
  v_mov_b32 v181, v189
  v_mov_b32 v182, v190
  v_mov_b32 v183, v191
  v_permlane16_swap_b32 v188, v180
  v_permlane16_swap_b32 v189, v181
  v_permlane16_swap_b32 v190, v182
  v_permlane16_swap_b32 v191, v183
  v_pk_add_f32 v[188:189], v[188:189], v[180:181]
  v_pk_add_f32 v[190:191], v[190:191], v[182:183]
  v_mov_b32 v180, v188
  v_mov_b32 v181, v189
  v_mov_b32 v182, v190
  v_mov_b32 v183, v191
  v_permlane32_swap_b32 v188, v180
  v_permlane32_swap_b32 v189, v181
  v_permlane32_swap_b32 v190, v182
  v_permlane32_swap_b32 v191, v183
  v_pk_add_f32 v[188:189], v[188:189], v[180:181]
  v_pk_add_f32 v[190:191], v[190:191], v[182:183]
  ds_write_b128 v16, v[188:191]
  s_waitcnt lgkmcnt(0)
  s_barrier
  ds_read_b128 v[136:139], v17 offset:0
  ds_read_b128 v[140:143], v17 offset:16
  ds_read_b128 v[144:147], v17 offset:32
  ds_read_b128 v[148:151], v17 offset:48
  s_lshl_b32 s49, s44, 10
  buffer_load_dwordx4 v[220:223], v0, s[36:39], s49 offen sc1
  s_add_u32 s49, s49, 4096
  buffer_load_dwordx4 v[84:87], v0, s[36:39], s49 offen sc1
  s_add_u32 s49, s49, 20480
  buffer_load_dwordx4 v[224:227], v0, s[36:39], s49 offen sc1
  s_add_u32 s49, s49, 4096
  buffer_load_dwordx4 v[88:91], v0, s[36:39], s49 offen sc1
  s_add_u32 s49, s49, 20480
  buffer_load_dwordx4 v[228:231], v0, s[36:39], s49 offen sc1
  s_add_u32 s49, s49, 4096
  buffer_load_dwordx4 v[92:95], v0, s[36:39], s49 offen sc1
  s_add_u32 s49, s49, 20480
  buffer_load_dwordx4 v[232:235], v0, s[36:39], s49 offen sc1
  s_add_u32 s49, s49, 4096
  buffer_load_dwordx4 v[96:99], v0, s[36:39], s49 offen sc1
  s_waitcnt lgkmcnt(0)
  v_pk_add_f32 v[136:137], v[136:137], v[144:145]
  v_pk_add_f32 v[138:139], v[138:139], v[146:147]
  v_pk_add_f32 v[140:141], v[140:141], v[148:149]
  v_pk_add_f32 v[142:143], v[142:143], v[150:151]
  v_pk_add_f32 v[136:137], v[136:137], v[140:141]
  v_pk_add_f32 v[138:139], v[138:139], v[142:143]
  v_mul_f32 v188, 0x3a800000, v136
  v_mul_f32 v189, 0x3a800000, v137
  v_mul_f32 v190, 0x3a800000, v138
  v_mul_f32 v191, 0x3a800000, v139
  v_fma_f32 v189, -v188, v188, v189
  v_fma_f32 v191, -v190, v190, v191
  v_max_f32 v189, 0, v189
  v_max_f32 v191, 0, v191
  v_cvt_pk_bf16_f32 v189, v189, v189
  v_cvt_pk_bf16_f32 v191, v191, v191
  v_lshlrev_b32 v189, 16, v189
  v_lshlrev_b32 v191, 16, v191
  v_add_f32 v189, 0x3727c5ac, v189
  v_add_f32 v191, 0x3727c5ac, v191
  v_cvt_pk_bf16_f32 v189, v189, v189
  v_cvt_pk_bf16_f32 v191, v191, v191
  v_lshlrev_b32 v189, 16, v189
  v_lshlrev_b32 v191, 16, v191
  v_sqrt_f32 v189, v189
  v_sqrt_f32 v191, v191
  v_cvt_pk_bf16_f32 v188, v188, v188
  v_cvt_pk_bf16_f32 v190, v190, v190
  v_lshlrev_b32 v188, 16, v188
  v_lshlrev_b32 v190, 16, v190
  v_cvt_pk_bf16_f32 v189, v189, v189
  v_cvt_pk_bf16_f32 v191, v191, v191
  v_lshlrev_b32 v189, 16, v189
  v_lshlrev_b32 v191, 16, v191
  v_rcp_f32 v189, v189
  v_rcp_f32 v191, v191
  v_mul_f32 v188, -v188, v189
  v_mul_f32 v190, -v190, v191
  v_pk_fma_f32 v[20:21], v[20:21], v[188:189], v[188:189] op_sel:[0,1,0] op_sel_hi:[1,1,0]
  v_pk_fma_f32 v[22:23], v[22:23], v[188:189], v[188:189] op_sel:[0,1,0] op_sel_hi:[1,1,0]
  v_pk_fma_f32 v[24:25], v[24:25], v[188:189], v[188:189] op_sel:[0,1,0] op_sel_hi:[1,1,0]
  v_pk_fma_f32 v[26:27], v[26:27], v[188:189], v[188:189] op_sel:[0,1,0] op_sel_hi:[1,1,0]
  v_pk_fma_f32 v[28:29], v[28:29], v[188:189], v[188:189] op_sel:[0,1,0] op_sel_hi:[1,1,0]
  v_pk_fma_f32 v[30:31], v[30:31], v[188:189], v[188:189] op_sel:[0,1,0] op_sel_hi:[1,1,0]
  v_pk_fma_f32 v[32:33], v[32:33], v[188:189], v[188:189] op_sel:[0,1,0] op_sel_hi:[1,1,0]
  v_pk_fma_f32 v[34:35], v[34:35], v[188:189], v[188:189] op_sel:[0,1,0] op_sel_hi:[1,1,0]
  v_pk_fma_f32 v[36:37], v[36:37], v[188:189], v[188:189] op_sel:[0,1,0] op_sel_hi:[1,1,0]
  v_pk_fma_f32 v[38:39], v[38:39], v[188:189], v[188:189] op_sel:[0,1,0] op_sel_hi:[1,1,0]
  v_pk_fma_f32 v[40:41], v[40:41], v[188:189], v[188:189] op_sel:[0,1,0] op_sel_hi:[1,1,0]
  v_pk_fma_f32 v[42:43], v[42:43], v[188:189], v[188:189] op_sel:[0,1,0] op_sel_hi:[1,1,0]
  v_pk_fma_f32 v[44:45], v[44:45], v[188:189], v[188:189] op_sel:[0,1,0] op_sel_hi:[1,1,0]
  v_pk_fma_f32 v[46:47], v[46:47], v[188:189], v[188:189] op_sel:[0,1,0] op_sel_hi:[1,1,0]
  v_pk_fma_f32 v[48:49], v[48:49], v[188:189], v[188:189] op_sel:[0,1,0] op_sel_hi:[1,1,0]
  v_pk_fma_f32 v[50:51], v[50:51], v[188:189], v[188:189] op_sel:[0,1,0] op_sel_hi:[1,1,0]
  v_pk_fma_f32 v[52:53], v[52:53], v[190:191], v[190:191] op_sel:[0,1,0] op_sel_hi:[1,1,0]
  v_pk_fma_f32 v[54:55], v[54:55], v[190:191], v[190:191] op_sel:[0,1,0] op_sel_hi:[1,1,0]
  v_pk_fma_f32 v[56:57], v[56:57], v[190:191], v[190:191] op_sel:[0,1,0] op_sel_hi:[1,1,0]
  v_pk_fma_f32 v[58:59], v[58:59], v[190:191], v[190:191] op_sel:[0,1,0] op_sel_hi:[1,1,0]
  v_pk_fma_f32 v[60:61], v[60:61], v[190:191], v[190:191] op_sel:[0,1,0] op_sel_hi:[1,1,0]
  v_pk_fma_f32 v[62:63], v[62:63], v[190:191], v[190:191] op_sel:[0,1,0] op_sel_hi:[1,1,0]
  v_pk_fma_f32 v[64:65], v[64:65], v[190:191], v[190:191] op_sel:[0,1,0] op_sel_hi:[1,1,0]
  v_pk_fma_f32 v[66:67], v[66:67], v[190:191], v[190:191] op_sel:[0,1,0] op_sel_hi:[1,1,0]
  v_pk_fma_f32 v[68:69], v[68:69], v[190:191], v[190:191] op_sel:[0,1,0] op_sel_hi:[1,1,0]
  v_pk_fma_f32 v[70:71], v[70:71], v[190:191], v[190:191] op_sel:[0,1,0] op_sel_hi:[1,1,0]
  v_pk_fma_f32 v[72:73], v[72:73], v[190:191], v[190:191] op_sel:[0,1,0] op_sel_hi:[1,1,0]
  v_pk_fma_f32 v[74:75], v[74:75], v[190:191], v[190:191] op_sel:[0,1,0] op_sel_hi:[1,1,0]
  v_pk_fma_f32 v[76:77], v[76:77], v[190:191], v[190:191] op_sel:[0,1,0] op_sel_hi:[1,1,0]
  v_pk_fma_f32 v[78:79], v[78:79], v[190:191], v[190:191] op_sel:[0,1,0] op_sel_hi:[1,1,0]
  v_pk_fma_f32 v[80:81], v[80:81], v[190:191], v[190:191] op_sel:[0,1,0] op_sel_hi:[1,1,0]
  v_pk_fma_f32 v[82:83], v[82:83], v[190:191], v[190:191] op_sel:[0,1,0] op_sel_hi:[1,1,0]
  s_mov_b32 s46, 30000
  s_branch PLC
PLP:
  s_lshl_b32 s49, s44, 10
  buffer_load_dwordx4 v[220:223], v0, s[36:39], s49 offen sc1
  s_add_u32 s49, s49, 4096
  buffer_load_dwordx4 v[84:87], v0, s[36:39], s49 offen sc1
  s_add_u32 s49, s49, 20480
  buffer_load_dwordx4 v[224:227], v0, s[36:39], s49 offen sc1
  s_add_u32 s49, s49, 4096
  buffer_load_dwordx4 v[88:91], v0, s[36:39], s49 offen sc1
  s_add_u32 s49, s49, 20480
  buffer_load_dwordx4 v[228:231], v0, s[36:39], s49 offen sc1
  s_add_u32 s49, s49, 4096
  buffer_load_dwordx4 v[92:95], v0, s[36:39], s49 offen sc1
  s_add_u32 s49, s49, 20480
  buffer_load_dwordx4 v[232:235], v0, s[36:39], s49 offen sc1
  s_add_u32 s49, s49, 4096
  buffer_load_dwordx4 v[96:99], v0, s[36:39], s49 offen sc1
PLC:
  s_waitcnt vmcnt(7)
  v_xor_b32 v220, s66, v220
  v_xor_b32 v221, s67, v221
  v_xor_b32 v222, s68, v222
  v_xor_b32 v223, s69, v223
  v_or3_b32 v184, 0, v220, v221
  v_or3_b32 v184, v184, v222, v223
  s_waitcnt vmcnt(6)
  v_xor_b32 v84, s66, v84
  v_xor_b32 v85, s67, v85
  v_xor_b32 v86, s68, v86
  v_xor_b32 v87, s69, v87
  v_or3_b32 v184, v184, v84, v85
  v_or3_b32 v184, v184, v86, v87
  s_waitcnt vmcnt(5)
  v_xor_b32 v224, s66, v224
  v_xor_b32 v225, s67, v225
  v_xor_b32 v226, s68, v226
  v_xor_b32 v227, s69, v227
  v_or3_b32 v184, v184, v224, v225
  v_or3_b32 v184, v184, v226, v227
  s_waitcnt vmcnt(4)
  v_xor_b32 v88, s66, v88
  v_xor_b32 v89, s67, v89
  v_xor_b32 v90, s68, v90
  v_xor_b32 v91, s69, v91
  v_or3_b32 v184, v184, v88, v89
  v_or3_b32 v184, v184, v90, v91
  s_waitcnt vmcnt(3)
  v_xor_b32 v228, s66, v228
  v_xor_b32 v229, s67, v229
  v_xor_b32 v230, s68, v230
  v_xor_b32 v231, s69, v231
  v_or3_b32 v184, v184, v228, v229
  v_or3_b32 v184, v184, v230, v231
  s_waitcnt vmcnt(2)
  v_xor_b32 v92, s66, v92
  v_xor_b32 v93, s67, v93
  v_xor_b32 v94, s68, v94
  v_xor_b32 v95, s69, v95
  v_or3_b32 v184, v184, v92, v93
  v_or3_b32 v184, v184, v94, v95
  s_waitcnt vmcnt(1)
  v_xor_b32 v232, s66, v232
  v_xor_b32 v233, s67, v233
  v_xor_b32 v234, s68, v234
  v_xor_b32 v235, s69, v235
  v_or3_b32 v184, v184, v232, v233
  v_or3_b32 v184, v184, v234, v235
  s_waitcnt vmcnt(0)
  v_xor_b32 v96, s66, v96
  v_xor_b32 v97, s67, v97
  v_xor_b32 v98, s68, v98
  v_xor_b32 v99, s69, v99
  v_or3_b32 v184, v184, v96, v97
  v_or3_b32 v184, v184, v98, v99
  v_and_b32 v184, 0xff, v184
  v_cmp_ne_u32 vcc, 0, v184
  s_sub_u32 s46, s46, 1
  s_cmp_eq_u32 s46, 0
  s_cbranch_scc1 PLX
  s_nop 1
  s_cbranch_vccnz PLP
PLX:
  v_mov_b32 v180, -1
  v_mov_b32 v181, -1
  v_mov_b32 v182, -1
  v_mov_b32 v183, -1
  buffer_store_dwordx4 v[180:183], v0, s[36:39], s70 offen sc1
  buffer_store_dword v180, v178, s[36:39], s71 offen sc1
  v_pk_add_f32 v[84:85], v[84:85], v[92:93]
  v_pk_add_f32 v[220:221], v[220:221], v[228:229]
  v_pk_add_f32 v[86:87], v[86:87], v[94:95]
  v_pk_add_f32 v[222:223], v[222:223], v[230:231]
  v_pk_add_f32 v[88:89], v[88:89], v[96:97]
  v_pk_add_f32 v[224:225], v[224:225], v[232:233]
  v_pk_add_f32 v[90:91], v[90:91], v[98:99]
  v_pk_add_f32 v[226:227], v[226:227], v[234:235]
  v_pk_add_f32 v[84:85], v[84:85], v[88:89]
  v_pk_add_f32 v[220:221], v[220:221], v[224:225]
  v_pk_add_f32 v[86:87], v[86:87], v[90:91]
  v_pk_add_f32 v[222:223], v[222:223], v[226:227]
  v_cvt_pk_bf16_f32 v184, v220, v221
  v_lshlrev_b32 v220, 16, v184
  v_and_b32 v221, 0xffff0000, v184
  v_cvt_pk_bf16_f32 v184, v222, v223
  v_lshlrev_b32 v222, 16, v184
  v_and_b32 v223, 0xffff0000, v184
  ds_write_b128 v14, v[220:223] offset:1024
  v_cvt_pk_bf16_f32 v184, v84, v85
  v_lshlrev_b32 v84, 16, v184
  v_and_b32 v85, 0xffff0000, v184
  v_pk_add_f32 v[84:85], v[84:85], 1.0 op_sel_hi:[1,0]
  v_cvt_pk_bf16_f32 v184, v84, v85
  v_lshlrev_b32 v84, 16, v184
  v_and_b32 v85, 0xffff0000, v184
  v_cvt_pk_bf16_f32 v184, v86, v87
  v_lshlrev_b32 v86, 16, v184
  v_and_b32 v87, 0xffff0000, v184
  v_pk_add_f32 v[86:87], v[86:87], 1.0 op_sel_hi:[1,0]
  v_cvt_pk_bf16_f32 v184, v86, v87
  v_lshlrev_b32 v86, 16, v184
  v_and_b32 v87, 0xffff0000, v184
  ds_write_b128 v14, v[84:87]
  ds_read_b128 v[220:223], v15 offset:1024
  ds_read_b128 v[84:87], v15 offset:0
  ds_read_b128 v[224:227], v15 offset:1040
  ds_read_b128 v[88:91], v15 offset:16
  ds_read_b128 v[228:231], v15 offset:1280
  ds_read_b128 v[92:95], v15 offset:256
  ds_read_b128 v[232:235], v15 offset:1296
  ds_read_b128 v[96:99], v15 offset:272
  ds_read_b128 v[236:239], v15 offset:1536
  ds_read_b128 v[100:103], v15 offset:512
  ds_read_b128 v[240:243], v15 offset:1552
  ds_read_b128 v[104:107], v15 offset:528
  ds_read_b128 v[244:247], v15 offset:1792
  ds_read_b128 v[108:111], v15 offset:768
  ds_read_b128 v[248:251], v15 offset:1808
  ds_read_b128 v[112:115], v15 offset:784
  s_waitcnt lgkmcnt(12)
  v_pk_fma_f32 v[20:21], v[20:21], v[84:85], v[220:221]
  v_pk_fma_f32 v[22:23], v[22:23], v[86:87], v[222:223]
  v_pk_fma_f32 v[24:25], v[24:25], v[88:89], v[224:225]
  v_pk_fma_f32 v[26:27], v[26:27], v[90:91], v[226:227]
  v_pk_fma_f32 v[52:53], v[52:53], v[84:85], v[220:221]
  v_pk_fma_f32 v[54:55], v[54:55], v[86:87], v[222:223]
  v_pk_fma_f32 v[56:57], v[56:57], v[88:89], v[224:225]
  v_pk_fma_f32 v[58:59], v[58:59], v[90:91], v[226:227]
  v_cvt_pk_bf16_f32 v136, v20, v21
  v_cvt_pk_bf16_f32 v137, v22, v23
  v_cvt_pk_bf16_f32 v138, v24, v25
  v_cvt_pk_bf16_f32 v139, v26, v27
  v_cvt_pk_bf16_f32 v152, v52, v53
  v_cvt_pk_bf16_f32 v153, v54, v55
  v_cvt_pk_bf16_f32 v154, v56, v57
  v_cvt_pk_bf16_f32 v155, v58, v59
  v_permlane16_swap_b32 v136, v138
  v_permlane16_swap_b32 v137, v139
  v_permlane16_swap_b32 v152, v154
  v_permlane16_swap_b32 v153, v155
  buffer_store_dwordx4 v[136:139], v132, s[36:39], s50 offen offset:0 sc1
  buffer_store_dwordx4 v[152:155], v132, s[36:39], s50 offen offset:128 sc1
  s_add_u32 s50, s50, 4096
  s_waitcnt lgkmcnt(8)
  v_pk_fma_f32 v[28:29], v[28:29], v[92:93], v[228:229]
  v_pk_fma_f32 v[30:31], v[30:31], v[94:95], v[230:231]
  v_pk_fma_f32 v[32:33], v[32:33], v[96:97], v[232:233]
  v_pk_fma_f32 v[34:35], v[34:35], v[98:99], v[234:235]
  v_pk_fma_f32 v[60:61], v[60:61], v[92:93], v[228:229]
  v_pk_fma_f32 v[62:63], v[62:63], v[94:95], v[230:231]
  v_pk_fma_f32 v[64:65], v[64:65], v[96:97], v[232:233]
  v_pk_fma_f32 v[66:67], v[66:67], v[98:99], v[234:235]
  v_cvt_pk_bf16_f32 v140, v28, v29
  v_cvt_pk_bf16_f32 v141, v30, v31
  v_cvt_pk_bf16_f32 v142, v32, v33
  v_cvt_pk_bf16_f32 v143, v34, v35
  v_cvt_pk_bf16_f32 v156, v60, v61
  v_cvt_pk_bf16_f32 v157, v62, v63
  v_cvt_pk_bf16_f32 v158, v64, v65
  v_cvt_pk_bf16_f32 v159, v66, v67
  v_permlane16_swap_b32 v140, v142
  v_permlane16_swap_b32 v141, v143
  v_permlane16_swap_b32 v156, v158
  v_permlane16_swap_b32 v157, v159
  buffer_store_dwordx4 v[140:143], v132, s[36:39], s50 offen offset:0 sc1
  buffer_store_dwordx4 v[156:159], v132, s[36:39], s50 offen offset:128 sc1
  s_add_u32 s50, s50, 4096
  s_waitcnt lgkmcnt(4)
  v_pk_fma_f32 v[36:37], v[36:37], v[100:101], v[236:237]
  v_pk_fma_f32 v[38:39], v[38:39], v[102:103], v[238:239]
  v_pk_fma_f32 v[40:41], v[40:41], v[104:105], v[240:241]
  v_pk_fma_f32 v[42:43], v[42:43], v[106:107], v[242:243]
  v_pk_fma_f32 v[68:69], v[68:69], v[100:101], v[236:237]
  v_pk_fma_f32 v[70:71], v[70:71], v[102:103], v[238:239]
  v_pk_fma_f32 v[72:73], v[72:73], v[104:105], v[240:241]
  v_pk_fma_f32 v[74:75], v[74:75], v[106:107], v[242:243]
  v_cvt_pk_bf16_f32 v144, v36, v37
  v_cvt_pk_bf16_f32 v145, v38, v39
  v_cvt_pk_bf16_f32 v146, v40, v41
  v_cvt_pk_bf16_f32 v147, v42, v43
  v_cvt_pk_bf16_f32 v160, v68, v69
  v_cvt_pk_bf16_f32 v161, v70, v71
  v_cvt_pk_bf16_f32 v162, v72, v73
  v_cvt_pk_bf16_f32 v163, v74, v75
  v_permlane16_swap_b32 v144, v146
  v_permlane16_swap_b32 v145, v147
  v_permlane16_swap_b32 v160, v162
  v_permlane16_swap_b32 v161, v163
  buffer_store_dwordx4 v[144:147], v132, s[36:39], s50 offen offset:0 sc1
  buffer_store_dwordx4 v[160:163], v132, s[36:39], s50 offen offset:128 sc1
  s_add_u32 s50, s50, 4096
  s_waitcnt lgkmcnt(0)
  v_pk_fma_f32 v[44:45], v[44:45], v[108:109], v[244:245]
  v_pk_fma_f32 v[46:47], v[46:47], v[110:111], v[246:247]
  v_pk_fma_f32 v[48:49], v[48:49], v[112:113], v[248:249]
  v_pk_fma_f32 v[50:51], v[50:51], v[114:115], v[250:251]
  v_pk_fma_f32 v[76:77], v[76:77], v[108:109], v[244:245]
  v_pk_fma_f32 v[78:79], v[78:79], v[110:111], v[246:247]
  v_pk_fma_f32 v[80:81], v[80:81], v[112:113], v[248:249]
  v_pk_fma_f32 v[82:83], v[82:83], v[114:115], v[250:251]
  v_cvt_pk_bf16_f32 v148, v44, v45
  v_cvt_pk_bf16_f32 v149, v46, v47
  v_cvt_pk_bf16_f32 v150, v48, v49
  v_cvt_pk_bf16_f32 v151, v50, v51
  v_cvt_pk_bf16_f32 v164, v76, v77
  v_cvt_pk_bf16_f32 v165, v78, v79
  v_cvt_pk_bf16_f32 v166, v80, v81
  v_cvt_pk_bf16_f32 v167, v82, v83
  v_permlane16_swap_b32 v148, v150
  v_permlane16_swap_b32 v149, v151
  v_permlane16_swap_b32 v164, v166
  v_permlane16_swap_b32 v165, v167
  buffer_store_dwordx4 v[148:151], v132, s[36:39], s50 offen offset:0 sc1
  buffer_store_dwordx4 v[164:167], v132, s[36:39], s50 offen offset:128 sc1
  v_mov_b32 v12, s3
  s_waitcnt vmcnt(0) lgkmcnt(0)
  s_barrier
  s_mov_b64 exec, 1
  buffer_store_dword v12, v0, s[36:39], s45 offen sc1
  s_mov_b64 exec, -1
J2:
  s_mov_b32 s61, 0
  s_add_u32 m0, s63, 64512
  s_nop 0
  buffer_load_dwordx4 v202, s[8:11], s61 offen offset:0 lds
  buffer_load_dwordx4 v203, s[8:11], s61 offen offset:1024 lds
  buffer_load_dwordx4 v204, s[8:11], s61 offen offset:2048 lds
  s_mov_b32 s61, 196608
  s_add_u32 m0, s63, 86016
  s_nop 0
  buffer_load_dwordx4 v202, s[8:11], s61 offen offset:0 lds
  buffer_load_dwordx4 v203, s[8:11], s61 offen offset:1024 lds
  buffer_load_dwordx4 v204, s[8:11], s61 offen offset:2048 lds
  s_mov_b32 s61, 393216
  s_add_u32 m0, s63, 107520
  s_nop 0
  buffer_load_dwordx4 v202, s[8:11], s61 offen offset:0 lds
  buffer_load_dwordx4 v203, s[8:11], s61 offen offset:1024 lds
  buffer_load_dwordx4 v204, s[8:11], s61 offen offset:2048 lds
  s_mov_b32 s61, 589824
  s_add_u32 m0, s63, 129024
  s_nop 0
  buffer_load_dwordx4 v202, s[8:11], s61 offen offset:0 lds
  buffer_load_dwordx4 v203, s[8:11], s61 offen offset:1024 lds
  buffer_load_dwordx4 v204, s[8:11], s61 offen offset:2048 lds
  s_mov_b32 s61, 786432
  s_add_u32 m0, s63, 0
  s_nop 0
  buffer_load_dwordx4 v202, s[8:11], s61 offen offset:0 lds
  buffer_load_dwordx4 v203, s[8:11], s61 offen offset:1024 lds
  buffer_load_dwordx4 v204, s[8:11], s61 offen offset:2048 lds
  s_mov_b64 exec, 0
  s_cmp_eq_u32 s44, 1
  s_cbranch_scc1 Ha0
  s_cmp_eq_u32 s44, 2
  s_cbranch_scc1 Ha1
  s_cmp_eq_u32 s44, 3
  s_cbranch_scc1 Ha2
Ra:
  s_mov_b64 exec, -1
  s_cmp_lg_u32 s44, 0
  s_cbranch_scc1 SM2x
  s_mov_b32 s46, 60000
  s_mov_b32 s47, 5242880
SM2:
  buffer_load_dword v12, v215, s[36:39], s47 offen sc1
  s_sub_u32 s46, s46, 1
  s_cmp_eq_u32 s46, 0
  s_waitcnt vmcnt(0)
  s_cbranch_scc1 SM2x
  v_cmp_ne_u32 vcc, s3, v12
  s_nop 4
  s_cbranch_vccnz SM2
SM2x:
  s_barrier
  s_mov_b32 s62, 0
  s_add_u32 m0, s64, 76800
  s_nop 0
  buffer_load_dwordx4 v205, s[36:39], s62 offen offset:0 sc1 lds
  buffer_load_dwordx4 v205, s[36:39], s62 offen offset:1024 sc1 lds
  s_add_u32 m0, s65, 84992
  s_nop 0
  buffer_load_dword v206, s[36:39], s62 offen sc1 lds
  s_mov_b32 s62, 2048
  s_add_u32 m0, s64, 98304
  s_nop 0
  buffer_load_dwordx4 v205, s[36:39], s62 offen offset:0 sc1 lds
  buffer_load_dwordx4 v205, s[36:39], s62 offen offset:1024 sc1 lds
  s_add_u32 m0, s65, 106496
  s_nop 0
  buffer_load_dword v206, s[36:39], s62 offen sc1 lds
  s_mov_b32 s62, 4096
  s_add_u32 m0, s64, 119808
  s_nop 0
  buffer_load_dwordx4 v205, s[36:39], s62 offen offset:0 sc1 lds
  buffer_load_dwordx4 v205, s[36:39], s62 offen offset:1024 sc1 lds
  s_add_u32 m0, s65, 128000
  s_nop 0
  buffer_load_dword v206, s[36:39], s62 offen sc1 lds
  s_mov_b32 s62, 6144
  s_add_u32 m0, s64, 141312
  s_nop 0
  buffer_load_dwordx4 v205, s[36:39], s62 offen offset:0 sc1 lds
  buffer_load_dwordx4 v205, s[36:39], s62 offen offset:1024 sc1 lds
  s_add_u32 m0, s65, 149504
  s_nop 0
  buffer_load_dword v206, s[36:39], s62 offen sc1 lds
  s_waitcnt vmcnt(9)
  s_barrier
  ds_read_b64_tr_b16 a[40:41], v198 offset:1024
Ha0:
  s_cbranch_execz Ha0_1
  ds_read_b64_tr_b16 a[42:43], v198 offset:7168
  ds_read_b64_tr_b16 a[44:45], v199 offset:1024
  ds_read_b64_tr_b16 a[46:47], v199 offset:7168
  ds_read_b64_tr_b16 a[48:49], v198 offset:2048
  ds_read_b64_tr_b16 a[50:51], v198 offset:8192
  ds_read_b64_tr_b16 a[52:53], v199 offset:2048
  ds_read_b64_tr_b16 a[54:55], v199 offset:8192
  ds_read_b128 a[0:3], v208 offset:12288
  ds_read_b128 a[4:7], v208 offset:13312
  ds_read_b128 a[8:11], v208 offset:14336
  ds_read_b128 a[12:15], v208 offset:15360
  ds_read_b128 a[16:19], v211 offset:20480
  s_waitcnt lgkmcnt(0)
  v_mfma_f32_16x16x32_bf16 v[20:23], a[40:43], a[0:3], 0
  s_waitcnt vmcnt(6)
  s_barrier
  s_mov_b32 s62, 8192
  v_mfma_f32_16x16x32_bf16 v[24:27], a[40:43], a[4:7], 0
  s_add_u32 m0, s64, 12288
  ds_read_b64_tr_b16 a[56:57], v198 offset:0
  v_mfma_f32_16x16x32_bf16 v[28:31], a[40:43], a[8:11], 0
  buffer_load_dwordx4 v205, s[36:39], s62 offen offset:0 sc1 lds
  v_mfma_f32_16x16x32_bf16 v[32:35], a[40:43], a[12:15], 0
  ds_read_b64_tr_b16 a[58:59], v198 offset:6144
  v_mfma_f32_16x16x32_bf16 v[116:119], a[40:43], a[16:19], 0
  ds_read_b64_tr_b16 a[60:61], v199 offset:0
  v_mfma_f32_16x16x32_bf16 v[48:51], a[44:47], a[12:15], 0
  v_mfma_f32_16x16x32_bf16 v[44:47], a[44:47], a[8:11], 0
  buffer_load_dwordx4 v205, s[36:39], s62 offen offset:1024 sc1 lds
  s_add_u32 m0, s65, 20480
  v_mfma_f32_16x16x32_bf16 v[40:43], a[44:47], a[4:7], 0
  ds_read_b64_tr_b16 a[62:63], v199 offset:6144
  v_mfma_f32_16x16x32_bf16 v[36:39], a[44:47], a[0:3], 0
  s_waitcnt lgkmcnt(9)
  ds_read_b64_tr_b16 a[64:65], v198 offset:22528
  v_mfma_f32_16x16x32_bf16 v[52:55], a[0:3], a[48:51], 0
  ds_read_b128 a[20:23], v208 offset:33792
  v_mfma_f32_16x16x32_bf16 v[56:59], a[4:7], a[48:51], 0
  buffer_load_dword v206, s[36:39], s62 offen sc1 lds
  s_mov_b32 s61, 983040
  v_mfma_f32_16x16x32_bf16 v[60:63], a[8:11], a[48:51], 0
  s_add_u32 m0, s63, 21504
  ds_read_b64_tr_b16 a[66:67], v198 offset:28672
  v_mfma_f32_16x16x32_bf16 v[64:67], a[12:15], a[48:51], 0
  ds_read_b128 a[24:27], v208 offset:34816
  v_mfma_f32_16x16x32_bf16 v[120:123], a[16:19], a[48:51], 0
  ds_read_b64_tr_b16 a[68:69], v199 offset:22528
  v_mfma_f32_16x16x32_bf16 v[80:83], a[12:15], a[52:55], 0
  buffer_load_dwordx4 v202, s[8:11], s61 offen offset:0 lds
  v_mfma_f32_16x16x32_bf16 v[76:79], a[8:11], a[52:55], 0
  ds_read_b128 a[28:31], v208 offset:35840
  v_mfma_f32_16x16x32_bf16 v[72:75], a[4:7], a[52:55], 0
  ds_read_b64_tr_b16 a[70:71], v199 offset:28672
  v_mfma_f32_16x16x32_bf16 v[68:71], a[0:3], a[52:55], 0
  s_waitcnt lgkmcnt(7)
  ds_read_b128 a[32:35], v208 offset:36864
  v_mfma_f32_16x16x32_bf16 v[84:87], a[56:59], a[0:3], 0
  buffer_load_dwordx4 v203, s[8:11], s61 offen offset:1024 lds
  v_mfma_f32_16x16x32_bf16 v[88:91], a[56:59], a[4:7], 0
  ds_read_b128 a[36:39], v211 offset:41984
  v_mfma_f32_16x16x32_bf16 v[92:95], a[56:59], a[8:11], 0
  ds_read_b64_tr_b16 a[40:41], v198 offset:23552
  v_mfma_f32_16x16x32_bf16 v[96:99], a[56:59], a[12:15], 0
  ds_read_b64_tr_b16 a[42:43], v198 offset:29696
  v_mfma_f32_16x16x32_bf16 v[112:115], a[60:63], a[12:15], 0
  buffer_load_dwordx4 v204, s[8:11], s61 offen offset:2048 lds
  s_mov_b32 s62, 10240
  v_mfma_f32_16x16x32_bf16 v[108:111], a[60:63], a[8:11], 0
  s_add_u32 m0, s64, 33792
  ds_read_b64_tr_b16 a[44:45], v199 offset:23552
  v_mfma_f32_16x16x32_bf16 v[104:107], a[60:63], a[4:7], 0
  ds_read_b64_tr_b16 a[46:47], v199 offset:29696
  v_mfma_f32_16x16x32_bf16 v[100:103], a[60:63], a[0:3], 0
  s_waitcnt vmcnt(9) lgkmcnt(4)
  s_barrier
  v_mfma_f32_16x16x32_bf16 v[20:23], a[64:67], a[20:23], v[20:23]
  buffer_load_dwordx4 v205, s[36:39], s62 offen offset:0 sc1 lds
  v_mfma_f32_16x16x32_bf16 v[24:27], a[64:67], a[24:27], v[24:27]
  ds_read_b64_tr_b16 a[48:49], v198 offset:21504
  v_mfma_f32_16x16x32_bf16 v[28:31], a[64:67], a[28:31], v[28:31]
  ds_read_b64_tr_b16 a[50:51], v198 offset:27648
  v_mfma_f32_16x16x32_bf16 v[32:35], a[64:67], a[32:35], v[32:35]
  v_mfma_f32_16x16x32_bf16 v[116:119], a[64:67], a[36:39], v[116:119]
  buffer_load_dwordx4 v205, s[36:39], s62 offen offset:1024 sc1 lds
  s_add_u32 m0, s65, 41984
  v_mfma_f32_16x16x32_bf16 v[48:51], a[68:71], a[32:35], v[48:51]
  ds_read_b64_tr_b16 a[52:53], v199 offset:21504
  v_mfma_f32_16x16x32_bf16 v[44:47], a[68:71], a[28:31], v[44:47]
  ds_read_b64_tr_b16 a[54:55], v199 offset:27648
  v_mfma_f32_16x16x32_bf16 v[40:43], a[68:71], a[24:27], v[40:43]
  v_mfma_f32_16x16x32_bf16 v[36:39], a[68:71], a[20:23], v[36:39]
  s_waitcnt lgkmcnt(4)
  buffer_load_dword v206, s[36:39], s62 offen sc1 lds
  s_mov_b32 s61, 1179648
  v_mfma_f32_16x16x32_bf16 v[52:55], a[20:23], a[40:43], v[52:55]
  s_add_u32 m0, s63, 43008
  ds_read_b64_tr_b16 a[56:57], v198 offset:44032
  v_mfma_f32_16x16x32_bf16 v[56:59], a[24:27], a[40:43], v[56:59]
  ds_read_b128 a[0:3], v208 offset:55296
  v_mfma_f32_16x16x32_bf16 v[60:63], a[28:31], a[40:43], v[60:63]
  ds_read_b64_tr_b16 a[58:59], v198 offset:50176
  v_mfma_f32_16x16x32_bf16 v[64:67], a[32:35], a[40:43], v[64:67]
  buffer_load_dwordx4 v202, s[8:11], s61 offen offset:0 lds
  v_mfma_f32_16x16x32_bf16 v[120:123], a[36:39], a[40:43], v[120:123]
  ds_read_b128 a[4:7], v208 offset:56320
  v_mfma_f32_16x16x32_bf16 v[80:83], a[32:35], a[44:47], v[80:83]
  ds_read_b64_tr_b16 a[60:61], v199 offset:44032
  v_mfma_f32_16x16x32_bf16 v[76:79], a[28:31], a[44:47], v[76:79]
  ds_read_b128 a[8:11], v208 offset:57344
  v_mfma_f32_16x16x32_bf16 v[72:75], a[24:27], a[44:47], v[72:75]
  buffer_load_dwordx4 v203, s[8:11], s61 offen offset:1024 lds
  v_mfma_f32_16x16x32_bf16 v[68:71], a[20:23], a[44:47], v[68:71]
  s_waitcnt lgkmcnt(6)
  ds_read_b64_tr_b16 a[62:63], v199 offset:50176
  v_mfma_f32_16x16x32_bf16 v[84:87], a[48:51], a[20:23], v[84:87]
  ds_read_b128 a[12:15], v208 offset:58368
  v_mfma_f32_16x16x32_bf16 v[88:91], a[48:51], a[24:27], v[88:91]
  ds_read_b128 a[16:19], v211 offset:63488
  v_mfma_f32_16x16x32_bf16 v[92:95], a[48:51], a[28:31], v[92:95]
  buffer_load_dwordx4 v204, s[8:11], s61 offen offset:2048 lds
  s_mov_b32 s62, 12288
  v_mfma_f32_16x16x32_bf16 v[96:99], a[48:51], a[32:35], v[96:99]
  s_add_u32 m0, s64, 55296
  ds_read_b64_tr_b16 a[64:65], v198 offset:45056
  v_mfma_f32_16x16x32_bf16 v[112:115], a[52:55], a[32:35], v[112:115]
  ds_read_b64_tr_b16 a[66:67], v198 offset:51200
  v_mfma_f32_16x16x32_bf16 v[108:111], a[52:55], a[28:31], v[108:111]
  ds_read_b64_tr_b16 a[68:69], v199 offset:45056
  v_mfma_f32_16x16x32_bf16 v[104:107], a[52:55], a[24:27], v[104:107]
  buffer_load_dwordx4 v205, s[36:39], s62 offen offset:0 sc1 lds
  v_mfma_f32_16x16x32_bf16 v[100:103], a[52:55], a[20:23], v[100:103]
  s_waitcnt vmcnt(13) lgkmcnt(3)
  s_barrier
  ds_read_b64_tr_b16 a[70:71], v199 offset:51200
  v_mfma_f32_16x16x32_bf16 v[20:23], a[56:59], a[0:3], v[20:23]
  ds_read_b64_tr_b16 a[40:41], v198 offset:43008
  v_mfma_f32_16x16x32_bf16 v[24:27], a[56:59], a[4:7], v[24:27]
  v_mfma_f32_16x16x32_bf16 v[28:31], a[56:59], a[8:11], v[28:31]
  buffer_load_dwordx4 v205, s[36:39], s62 offen offset:1024 sc1 lds
  s_add_u32 m0, s65, 63488
  v_mfma_f32_16x16x32_bf16 v[32:35], a[56:59], a[12:15], v[32:35]
  ds_read_b64_tr_b16 a[42:43], v198 offset:49152
  v_mfma_f32_16x16x32_bf16 v[116:119], a[56:59], a[16:19], v[116:119]
  ds_read_b64_tr_b16 a[44:45], v199 offset:43008
  v_mfma_f32_16x16x32_bf16 v[48:51], a[60:63], a[12:15], v[48:51]
  v_mfma_f32_16x16x32_bf16 v[44:47], a[60:63], a[8:11], v[44:47]
  buffer_load_dword v206, s[36:39], s62 offen sc1 lds
  s_mov_b32 s61, 1376256
  v_mfma_f32_16x16x32_bf16 v[40:43], a[60:63], a[4:7], v[40:43]
  s_add_u32 m0, s63, 64512
  ds_read_b64_tr_b16 a[46:47], v199 offset:49152
  v_mfma_f32_16x16x32_bf16 v[36:39], a[60:63], a[0:3], v[36:39]
  s_waitcnt lgkmcnt(4)
  ds_read_b64_tr_b16 a[48:49], v200 offset:1024
  v_mfma_f32_16x16x32_bf16 v[52:55], a[0:3], a[64:67], v[52:55]
  ds_read_b128 a[20:23], v209 offset:12288
  v_mfma_f32_16x16x32_bf16 v[56:59], a[4:7], a[64:67], v[56:59]
  buffer_load_dwordx4 v202, s[8:11], s61 offen offset:0 lds
  v_mfma_f32_16x16x32_bf16 v[60:63], a[8:11], a[64:67], v[60:63]
  ds_read_b64_tr_b16 a[50:51], v200 offset:7168
  v_mfma_f32_16x16x32_bf16 v[64:67], a[12:15], a[64:67], v[64:67]
  ds_read_b128 a[24:27], v209 offset:13312
  v_mfma_f32_16x16x32_bf16 v[120:123], a[16:19], a[64:67], v[120:123]
  ds_read_b64_tr_b16 a[52:53], v201 offset:1024
  v_mfma_f32_16x16x32_bf16 v[80:83], a[12:15], a[68:71], v[80:83]
  buffer_load_dwordx4 v203, s[8:11], s61 offen offset:1024 lds
  v_mfma_f32_16x16x32_bf16 v[76:79], a[8:11], a[68:71], v[76:79]
  ds_read_b128 a[28:31], v209 offset:14336
  v_mfma_f32_16x16x32_bf16 v[72:75], a[4:7], a[68:71], v[72:75]
  ds_read_b64_tr_b16 a[54:55], v201 offset:7168
  v_mfma_f32_16x16x32_bf16 v[68:71], a[0:3], a[68:71], v[68:71]
  s_waitcnt lgkmcnt(7)
  ds_read_b128 a[32:35], v209 offset:15360
  v_mfma_f32_16x16x32_bf16 v[84:87], a[40:43], a[0:3], v[84:87]
  buffer_load_dwordx4 v204, s[8:11], s61 offen offset:2048 lds
  s_mov_b32 s62, 14336
  v_mfma_f32_16x16x32_bf16 v[88:91], a[40:43], a[4:7], v[88:91]
  s_add_u32 m0, s64, 76800
  ds_read_b128 a[36:39], v212 offset:20480
  v_mfma_f32_16x16x32_bf16 v[92:95], a[40:43], a[8:11], v[92:95]
  ds_read_b64_tr_b16 a[56:57], v200 offset:2048
  v_mfma_f32_16x16x32_bf16 v[96:99], a[40:43], a[12:15], v[96:99]
  ds_read_b64_tr_b16 a[58:59], v200 offset:8192
  v_mfma_f32_16x16x32_bf16 v[112:115], a[44:47], a[12:15], v[112:115]
  buffer_load_dwordx4 v205, s[36:39], s62 offen offset:0 sc1 lds
  v_mfma_f32_16x16x32_bf16 v[108:111], a[44:47], a[8:11], v[108:111]
  ds_read_b64_tr_b16 a[60:61], v201 offset:2048
  v_mfma_f32_16x16x32_bf16 v[104:107], a[44:47], a[4:7], v[104:107]
  ds_read_b64_tr_b16 a[62:63], v201 offset:8192
  v_mfma_f32_16x16x32_bf16 v[100:103], a[44:47], a[0:3], v[100:103]
  s_waitcnt vmcnt(16) lgkmcnt(4)
  s_barrier
  v_mfma_f32_16x16x32_bf16 v[20:23], a[48:51], a[20:23], v[20:23]
  buffer_load_dwordx4 v205, s[36:39], s62 offen offset:1024 sc1 lds
  s_add_u32 m0, s65, 84992
  v_mfma_f32_16x16x32_bf16 v[24:27], a[48:51], a[24:27], v[24:27]
  ds_read_b64_tr_b16 a[64:65], v200 offset:0
  v_mfma_f32_16x16x32_bf16 v[28:31], a[48:51], a[28:31], v[28:31]
  ds_read_b64_tr_b16 a[66:67], v200 offset:6144
  v_mfma_f32_16x16x32_bf16 v[32:35], a[48:51], a[32:35], v[32:35]
  v_mfma_f32_16x16x32_bf16 v[116:119], a[48:51], a[36:39], v[116:119]
  buffer_load_dword v206, s[36:39], s62 offen sc1 lds
  s_mov_b32 s61, 1572864
  v_mfma_f32_16x16x32_bf16 v[48:51], a[52:55], a[32:35], v[48:51]
  s_add_u32 m0, s63, 86016
  ds_read_b64_tr_b16 a[68:69], v201 offset:0
  v_mfma_f32_16x16x32_bf16 v[44:47], a[52:55], a[28:31], v[44:47]
  ds_read_b64_tr_b16 a[70:71], v201 offset:6144
  v_mfma_f32_16x16x32_bf16 v[40:43], a[52:55], a[24:27], v[40:43]
  v_mfma_f32_16x16x32_bf16 v[36:39], a[52:55], a[20:23], v[36:39]
  s_waitcnt lgkmcnt(4)
  buffer_load_dwordx4 v202, s[8:11], s61 offen offset:0 lds
  v_mfma_f32_16x16x32_bf16 v[52:55], a[20:23], a[56:59], v[52:55]
  ds_read_b64_tr_b16 a[40:41], v196 offset:1024
  v_mfma_f32_16x16x32_bf16 v[56:59], a[24:27], a[56:59], v[56:59]
  ds_read_b128 a[0:3], v207 offset:12288
  v_mfma_f32_16x16x32_bf16 v[60:63], a[28:31], a[56:59], v[60:63]
  ds_read_b64_tr_b16 a[42:43], v196 offset:7168
  v_mfma_f32_16x16x32_bf16 v[64:67], a[32:35], a[56:59], v[64:67]
  buffer_load_dwordx4 v203, s[8:11], s61 offen offset:1024 lds
  v_mfma_f32_16x16x32_bf16 v[120:123], a[36:39], a[56:59], v[120:123]
  ds_read_b128 a[4:7], v207 offset:13312
  v_mfma_f32_16x16x32_bf16 v[80:83], a[32:35], a[60:63], v[80:83]
  ds_read_b64_tr_b16 a[44:45], v197 offset:1024
  v_mfma_f32_16x16x32_bf16 v[76:79], a[28:31], a[60:63], v[76:79]
  ds_read_b128 a[8:11], v207 offset:14336
  v_mfma_f32_16x16x32_bf16 v[72:75], a[24:27], a[60:63], v[72:75]
  buffer_load_dwordx4 v204, s[8:11], s61 offen offset:2048 lds
  s_mov_b32 s62, 16384
  v_mfma_f32_16x16x32_bf16 v[68:71], a[20:23], a[60:63], v[68:71]
  s_waitcnt lgkmcnt(6)
  s_add_u32 m0, s64, 98304
  ds_read_b64_tr_b16 a[46:47], v197 offset:7168
  v_mfma_f32_16x16x32_bf16 v[84:87], a[64:67], a[20:23], v[84:87]
  ds_read_b128 a[12:15], v207 offset:15360
  v_mfma_f32_16x16x32_bf16 v[88:91], a[64:67], a[24:27], v[88:91]
  ds_read_b128 a[16:19], v210 offset:20480
  v_mfma_f32_16x16x32_bf16 v[92:95], a[64:67], a[28:31], v[92:95]
  buffer_load_dwordx4 v205, s[36:39], s62 offen offset:0 sc1 lds
  v_mfma_f32_16x16x32_bf16 v[96:99], a[64:67], a[32:35], v[96:99]
  ds_read_b64_tr_b16 a[48:49], v196 offset:2048
  v_mfma_f32_16x16x32_bf16 v[112:115], a[68:71], a[32:35], v[112:115]
  s_lshr_b32 s49, s2, 3
  ds_read_b64_tr_b16 a[50:51], v196 offset:8192
  s_and_b32 s54, s49, 7
  v_mfma_f32_16x16x32_bf16 v[108:111], a[68:71], a[28:31], v[108:111]
  s_and_b32 s48, s2, 1
  ds_read_b64_tr_b16 a[52:53], v197 offset:2048
  s_lshl1_add_u32 s53, s54, s48
  v_mfma_f32_16x16x32_bf16 v[104:107], a[68:71], a[24:27], v[104:107]
  buffer_load_dwordx4 v205, s[36:39], s62 offen offset:1024 sc1 lds
  s_add_u32 m0, s65, 106496
  v_mfma_f32_16x16x32_bf16 v[100:103], a[68:71], a[20:23], v[100:103]
  s_waitcnt vmcnt(17) lgkmcnt(3)
  s_barrier
  ds_read_b64_tr_b16 a[54:55], v197 offset:8192
  v_mfma_f32_16x16x32_bf16 v[20:23], a[40:43], a[0:3], v[20:23]
  ds_read_b64_tr_b16 a[56:57], v196 offset:0
  v_mfma_f32_16x16x32_bf16 v[24:27], a[40:43], a[4:7], v[24:27]
  v_mfma_f32_16x16x32_bf16 v[28:31], a[40:43], a[8:11], v[28:31]
  s_and_b32 s76, s54, 0
  buffer_load_dword v206, s[36:39], s62 offen sc1 lds
  s_mov_b32 s61, 1769472
  v_mfma_f32_16x16x32_bf16 v[32:35], a[40:43], a[12:15], v[32:35]
  s_add_u32 m0, s63, 107520
  ds_read_b64_tr_b16 a[58:59], v196 offset:6144
  s_lshl_b32 s76, s76, 3
  v_mfma_f32_16x16x32_bf16 v[116:119], a[40:43], a[16:19], v[116:119]
  ds_read_b64_tr_b16 a[60:61], v197 offset:0
  v_mfma_f32_16x16x32_bf16 v[48:51], a[44:47], a[12:15], v[48:51]
  s_bfe_u32 s52, s2, 0x20001
  s_lshr_b32 s49, s2, 6
  s_lshl2_add_u32 s52, s52, s49
  v_mfma_f32_16x16x32_bf16 v[44:47], a[44:47], a[8:11], v[44:47]
  s_lshl_b32 s70, s44, 12
  buffer_load_dwordx4 v202, s[8:11], s61 offen offset:0 lds
  v_mfma_f32_16x16x32_bf16 v[40:43], a[44:47], a[4:7], v[40:43]
  ds_read_b64_tr_b16 a[62:63], v197 offset:6144
  v_mfma_f32_16x16x32_bf16 v[36:39], a[44:47], a[0:3], v[36:39]
  s_waitcnt lgkmcnt(4)
  ds_read_b64_tr_b16 a[64:65], v196 offset:22528
  v_mfma_f32_16x16x32_bf16 v[52:55], a[0:3], a[48:51], v[52:55]
  ds_read_b128 a[20:23], v207 offset:33792
  v_mfma_f32_16x16x32_bf16 v[56:59], a[4:7], a[48:51], v[56:59]
  buffer_load_dwordx4 v203, s[8:11], s61 offen offset:1024 lds
  v_mfma_f32_16x16x32_bf16 v[60:63], a[8:11], a[48:51], v[60:63]
  ds_read_b64_tr_b16 a[66:67], v196 offset:28672
  v_mfma_f32_16x16x32_bf16 v[64:67], a[12:15], a[48:51], v[64:67]
  s_lshl_b32 s48, s53, 7
  ds_read_b128 a[24:27], v207 offset:34816
  s_lshl_b32 s49, s44, 16
  v_mfma_f32_16x16x32_bf16 v[120:123], a[16:19], a[48:51], v[120:123]
  s_add_u32 s48, s48, s49
  ds_read_b64_tr_b16 a[68:69], v197 offset:22528
  v_lshrrev_b32 v12, 3, v10
  v_mfma_f32_16x16x32_bf16 v[80:83], a[12:15], a[52:55], v[80:83]
  buffer_load_dwordx4 v204, s[8:11], s61 offen offset:2048 lds
  s_mov_b32 s62, 18432
  v_mfma_f32_16x16x32_bf16 v[76:79], a[8:11], a[52:55], v[76:79]
  s_add_u32 m0, s64, 119808
  ds_read_b128 a[28:31], v207 offset:35840
  v_lshlrev_b32 v12, 11, v12
  v_mfma_f32_16x16x32_bf16 v[72:75], a[4:7], a[52:55], v[72:75]
  ds_read_b64_tr_b16 a[70:71], v197 offset:28672
  v_add3_u32 v216, v12, v213, s48
  v_mfma_f32_16x16x32_bf16 v[68:71], a[0:3], a[52:55], v[68:71]
  s_waitcnt lgkmcnt(7)
  ds_read_b128 a[32:35], v207 offset:36864
  v_mfma_f32_16x16x32_bf16 v[84:87], a[56:59], a[0:3], v[84:87]
  buffer_load_dwordx4 v205, s[36:39], s62 offen offset:0 sc1 lds
  v_mfma_f32_16x16x32_bf16 v[88:91], a[56:59], a[4:7], v[88:91]
  ds_read_b128 a[36:39], v210 offset:41984
  v_mfma_f32_16x16x32_bf16 v[92:95], a[56:59], a[8:11], v[92:95]
  ds_read_b64_tr_b16 a[40:41], v196 offset:23552
  v_mfma_f32_16x16x32_bf16 v[96:99], a[56:59], a[12:15], v[96:99]
  ds_read_b64_tr_b16 a[42:43], v196 offset:29696
  v_add_u32 v217, 15360, v216
  v_mfma_f32_16x16x32_bf16 v[112:115], a[60:63], a[12:15], v[112:115]
  buffer_load_dwordx4 v205, s[36:39], s62 offen offset:1024 sc1 lds
  s_add_u32 m0, s65, 128000
  v_mfma_f32_16x16x32_bf16 v[108:111], a[60:63], a[8:11], v[108:111]
  ds_read_b64_tr_b16 a[44:45], v197 offset:23552
  v_add_u32 v218, 30720, v216
  v_mfma_f32_16x16x32_bf16 v[104:107], a[60:63], a[4:7], v[104:107]
  ds_read_b64_tr_b16 a[46:47], v197 offset:29696
  v_add_u32 v219, 46080, v216
  v_mfma_f32_16x16x32_bf16 v[100:103], a[60:63], a[0:3], v[100:103]
  s_waitcnt vmcnt(17) lgkmcnt(4)
  s_barrier
  v_mfma_f32_16x16x32_bf16 v[20:23], a[64:67], a[20:23], v[20:23]
  s_lshl_b32 s55, s52, 18
  buffer_load_dword v206, s[36:39], s62 offen sc1 lds
  s_mov_b32 s61, 1966080
  v_mfma_f32_16x16x32_bf16 v[24:27], a[64:67], a[24:27], v[24:27]
  s_add_u32 m0, s63, 129024
  ds_read_b64_tr_b16 a[48:49], v196 offset:21504
  s_add_u32 s55, s55, s48
  v_mfma_f32_16x16x32_bf16 v[28:31], a[64:67], a[28:31], v[28:31]
  ds_read_b64_tr_b16 a[50:51], v196 offset:27648
  v_mfma_f32_16x16x32_bf16 v[32:35], a[64:67], a[32:35], v[32:35]
  v_and_b32 v13, 7, v10
  v_lshrrev_b32 v14, 4, v10
  v_mfma_f32_16x16x32_bf16 v[116:119], a[64:67], a[36:39], v[116:119]
  buffer_load_dwordx4 v202, s[8:11], s61 offen offset:0 lds
  v_xor_b32 v13, v13, v14
  v_mfma_f32_16x16x32_bf16 v[48:51], a[68:71], a[32:35], v[48:51]
  ds_read_b64_tr_b16 a[52:53], v197 offset:21504
  v_lshl_add_u32 v220, v13, 4, v12
  v_mfma_f32_16x16x32_bf16 v[44:47], a[68:71], a[28:31], v[44:47]
  ds_read_b64_tr_b16 a[54:55], v197 offset:27648
  v_xor_b32 v221, 64, v220
  v_mfma_f32_16x16x32_bf16 v[40:43], a[68:71], a[24:27], v[40:43]
  v_add_u32 v221, 15360, v221
  v_mfma_f32_16x16x32_bf16 v[36:39], a[68:71], a[20:23], v[36:39]
  s_waitcnt lgkmcnt(4)
  buffer_load_dwordx4 v203, s[8:11], s61 offen offset:1024 lds
  v_mfma_f32_16x16x32_bf16 v[52:55], a[20:23], a[40:43], v[52:55]
  ds_read_b64_tr_b16 a[56:57], v196 offset:44032
  v_mfma_f32_16x16x32_bf16 v[56:59], a[24:27], a[40:43], v[56:59]
  ds_read_b128 a[0:3], v207 offset:55296
  v_mfma_f32_16x16x32_bf16 v[60:63], a[28:31], a[40:43], v[60:63]
  ds_read_b64_tr_b16 a[58:59], v196 offset:50176
  v_mfma_f32_16x16x32_bf16 v[64:67], a[32:35], a[40:43], v[64:67]
  buffer_load_dwordx4 v204, s[8:11], s61 offen offset:2048 lds
  s_mov_b32 s62, 20480
  v_mfma_f32_16x16x32_bf16 v[120:123], a[36:39], a[40:43], v[120:123]
  s_add_u32 m0, s64, 141312
  ds_read_b128 a[4:7], v207 offset:56320
  s_lshl_b32 s48, s44, 10
  v_mfma_f32_16x16x32_bf16 v[80:83], a[32:35], a[44:47], v[80:83]
  s_add_u32 s48, s48, 147456
  ds_read_b64_tr_b16 a[60:61], v197 offset:44032
  v_add_u32 v246, s48, v0
  v_mfma_f32_16x16x32_bf16 v[76:79], a[28:31], a[44:47], v[76:79]
  ds_read_b128 a[8:11], v207 offset:57344
  v_lshl_add_u32 v244, v14, 4, s48
  v_mfma_f32_16x16x32_bf16 v[72:75], a[24:27], a[44:47], v[72:75]
  buffer_load_dwordx4 v205, s[36:39], s62 offen offset:0 sc1 lds
  v_and_b32 v12, 1, v10
  v_mfma_f32_16x16x32_bf16 v[68:71], a[20:23], a[44:47], v[68:71]
  s_waitcnt lgkmcnt(6)
  ds_read_b64_tr_b16 a[62:63], v197 offset:50176
  v_lshlrev_b32 v12, 8, v12
  v_mfma_f32_16x16x32_bf16 v[84:87], a[48:51], a[20:23], v[84:87]
  ds_read_b128 a[12:15], v207 offset:58368
  v_sub_u32 v245, v244, v12
  v_mfma_f32_16x16x32_bf16 v[88:91], a[48:51], a[24:27], v[88:91]
  ds_read_b128 a[16:19], v210 offset:63488
  v_mfma_f32_16x16x32_bf16 v[92:95], a[48:51], a[28:31], v[92:95]
  buffer_load_dwordx4 v205, s[36:39], s62 offen offset:1024 sc1 lds
  s_add_u32 m0, s65, 149504
  v_mfma_f32_16x16x32_bf16 v[96:99], a[48:51], a[32:35], v[96:99]
  ds_read_b64_tr_b16 a[64:65], v196 offset:45056
  v_mfma_f32_16x16x32_bf16 v[112:115], a[52:55], a[32:35], v[112:115]
  ds_read_b64_tr_b16 a[66:67], v196 offset:51200
  v_mfma_f32_16x16x32_bf16 v[108:111], a[52:55], a[28:31], v[108:111]
  ds_read_b64_tr_b16 a[68:69], v197 offset:45056
  v_mfma_f32_16x16x32_bf16 v[104:107], a[52:55], a[24:27], v[104:107]
  s_lshl_b32 s48, s53, 7
  buffer_load_dword v206, s[36:39], s62 offen sc1 lds
  s_mov_b32 s61, 2162688
  v_mfma_f32_16x16x32_bf16 v[100:103], a[52:55], a[20:23], v[100:103]
  s_waitcnt vmcnt(18) lgkmcnt(3)
  s_barrier
  s_add_u32 m0, s63, 0
  v_mfma_f32_16x16x32_bf16 v[20:23], a[56:59], a[0:3], v[20:23]
  ds_read_b64_tr_b16 a[70:71], v197 offset:51200
  v_and_b32 v13, 0xf0, v0
  v_mfma_f32_16x16x32_bf16 v[24:27], a[56:59], a[4:7], v[24:27]
  ds_read_b64_tr_b16 a[40:41], v196 offset:43008
  v_lshl_add_u32 v13, v14, 12, v13
  v_mfma_f32_16x16x32_bf16 v[28:31], a[56:59], a[8:11], v[28:31]
  s_lshl1_add_u32 s48, s48, 8192
  buffer_load_dwordx4 v202, s[8:11], s61 offen offset:0 lds
  v_add_u32 v248, s48, v13
  v_mfma_f32_16x16x32_bf16 v[32:35], a[56:59], a[12:15], v[32:35]
  ds_read_b64_tr_b16 a[42:43], v196 offset:49152
  v_mfma_f32_16x16x32_bf16 v[116:119], a[56:59], a[16:19], v[116:119]
  ds_read_b64_tr_b16 a[44:45], v197 offset:43008
  v_mfma_f32_16x16x32_bf16 v[48:51], a[60:63], a[12:15], v[48:51]
  v_mfma_f32_16x16x32_bf16 v[44:47], a[60:63], a[8:11], v[44:47]
  buffer_load_dwordx4 v203, s[8:11], s61 offen offset:1024 lds
  v_lshrrev_b32 v12, 2, v10
  v_mfma_f32_16x16x32_bf16 v[40:43], a[60:63], a[4:7], v[40:43]
  ds_read_b64_tr_b16 a[46:47], v197 offset:49152
  v_lshl_add_u32 v231, v12, 7, v214
  v_mfma_f32_16x16x32_bf16 v[36:39], a[60:63], a[0:3], v[36:39]
  s_waitcnt lgkmcnt(4)
  ds_read_b64_tr_b16 a[48:49], v198 offset:1024
  v_mfma_f32_16x16x32_bf16 v[52:55], a[0:3], a[64:67], v[52:55]
  ds_read_b128 a[20:23], v208 offset:12288
  v_xor_b32 v232, 32, v231
  v_mfma_f32_16x16x32_bf16 v[56:59], a[4:7], a[64:67], v[56:59]
  buffer_load_dwordx4 v204, s[8:11], s61 offen offset:2048 lds
  s_mov_b32 s62, 22528
  v_mfma_f32_16x16x32_bf16 v[60:63], a[8:11], a[64:67], v[60:63]
  s_add_u32 m0, s64, 12288
  ds_read_b64_tr_b16 a[50:51], v198 offset:7168
  v_xor_b32 v233, 64, v231
  v_mfma_f32_16x16x32_bf16 v[64:67], a[12:15], a[64:67], v[64:67]
  ds_read_b128 a[24:27], v208 offset:13312
  v_xor_b32 v234, 96, v231
  v_mfma_f32_16x16x32_bf16 v[120:123], a[16:19], a[64:67], v[120:123]
  ds_read_b64_tr_b16 a[52:53], v199 offset:1024
  v_mfma_f32_16x16x32_bf16 v[80:83], a[12:15], a[68:71], v[80:83]
  buffer_load_dwordx4 v205, s[36:39], s62 offen offset:0 sc1 lds
  v_xor_b32 v235, 65536, v231
  v_mfma_f32_16x16x32_bf16 v[76:79], a[8:11], a[68:71], v[76:79]
  ds_read_b128 a[28:31], v208 offset:14336
  v_xor_b32 v236, 65568, v231
  v_mfma_f32_16x16x32_bf16 v[72:75], a[4:7], a[68:71], v[72:75]
  ds_read_b64_tr_b16 a[54:55], v199 offset:7168
  v_mfma_f32_16x16x32_bf16 v[68:71], a[0:3], a[68:71], v[68:71]
  s_waitcnt lgkmcnt(7)
  ds_read_b128 a[32:35], v208 offset:15360
  v_xor_b32 v237, 65600, v231
  v_mfma_f32_16x16x32_bf16 v[84:87], a[40:43], a[0:3], v[84:87]
  buffer_load_dwordx4 v205, s[36:39], s62 offen offset:1024 sc1 lds
  s_add_u32 m0, s65, 20480
  v_mfma_f32_16x16x32_bf16 v[88:91], a[40:43], a[4:7], v[88:91]
  ds_read_b128 a[36:39], v211 offset:20480
  v_xor_b32 v238, 65632, v231
  v_mfma_f32_16x16x32_bf16 v[92:95], a[40:43], a[8:11], v[92:95]
  s_add_u32 s48, s70, 131072
  ds_read_b64_tr_b16 a[56:57], v198 offset:2048
  v_and_b32 v12, 15, v10
  v_mfma_f32_16x16x32_bf16 v[96:99], a[40:43], a[12:15], v[96:99]
  ds_read_b64_tr_b16 a[58:59], v198 offset:8192
  v_lshrrev_b32 v14, 1, v12
  v_mfma_f32_16x16x32_bf16 v[112:115], a[44:47], a[12:15], v[112:115]
  buffer_load_dword v206, s[36:39], s62 offen sc1 lds
  s_mov_b32 s61, 2359296
  v_mfma_f32_16x16x32_bf16 v[108:111], a[44:47], a[8:11], v[108:111]
  s_add_u32 m0, s63, 21504
  ds_read_b64_tr_b16 a[60:61], v199 offset:2048
  v_lshrrev_b32 v13, 5, v10
  v_mfma_f32_16x16x32_bf16 v[104:107], a[44:47], a[4:7], v[104:107]
  ds_read_b64_tr_b16 a[62:63], v199 offset:8192
  v_xor_b32 v14, v14, v13
  v_mfma_f32_16x16x32_bf16 v[100:103], a[44:47], a[0:3], v[100:103]
  s_waitcnt vmcnt(18) lgkmcnt(4)
  s_barrier
  v_lshlrev_b32 v14, 4, v14
  v_mfma_f32_16x16x32_bf16 v[20:23], a[48:51], a[20:23], v[20:23]
  buffer_load_dwordx4 v202, s[8:11], s61 offen offset:0 lds
  v_lshl_add_u32 v14, v12, 7, v14
  v_mfma_f32_16x16x32_bf16 v[24:27], a[48:51], a[24:27], v[24:27]
  ds_read_b64_tr_b16 a[64:65], v198 offset:0
  v_bfe_u32 v13, v10, 4, 1
  v_mfma_f32_16x16x32_bf16 v[28:31], a[48:51], a[28:31], v[28:31]
  ds_read_b64_tr_b16 a[66:67], v198 offset:6144
  v_lshl_add_u32 v14, v13, 3, v14
  v_mfma_f32_16x16x32_bf16 v[32:35], a[48:51], a[32:35], v[32:35]
  v_add_u32 v239, s48, v14
  v_xor_b32 v240, 32, v239
  v_mfma_f32_16x16x32_bf16 v[116:119], a[48:51], a[36:39], v[116:119]
  buffer_load_dwordx4 v203, s[8:11], s61 offen offset:1024 lds
  v_xor_b32 v241, 64, v239
  v_mfma_f32_16x16x32_bf16 v[48:51], a[52:55], a[32:35], v[48:51]
  ds_read_b64_tr_b16 a[68:69], v199 offset:0
  v_xor_b32 v242, 96, v239
  v_mfma_f32_16x16x32_bf16 v[44:47], a[52:55], a[28:31], v[44:47]
  ds_read_b64_tr_b16 a[70:71], v199 offset:6144
  v_mfma_f32_16x16x32_bf16 v[40:43], a[52:55], a[24:27], v[40:43]
  v_mfma_f32_16x16x32_bf16 v[36:39], a[52:55], a[20:23], v[36:39]
  s_waitcnt lgkmcnt(4)
  buffer_load_dwordx4 v204, s[8:11], s61 offen offset:2048 lds
  s_mov_b32 s62, 24576
  v_mfma_f32_16x16x32_bf16 v[52:55], a[20:23], a[56:59], v[52:55]
  s_add_u32 m0, s64, 33792
  ds_read_b64_tr_b16 a[40:41], v198 offset:22528
  v_mfma_f32_16x16x32_bf16 v[56:59], a[24:27], a[56:59], v[56:59]
  ds_read_b128 a[0:3], v208 offset:33792
  v_mfma_f32_16x16x32_bf16 v[60:63], a[28:31], a[56:59], v[60:63]
  ds_read_b64_tr_b16 a[42:43], v198 offset:28672
  v_mfma_f32_16x16x32_bf16 v[64:67], a[32:35], a[56:59], v[64:67]
  buffer_load_dwordx4 v205, s[36:39], s62 offen offset:0 sc1 lds
  v_mfma_f32_16x16x32_bf16 v[120:123], a[36:39], a[56:59], v[120:123]
  ds_read_b128 a[4:7], v208 offset:34816
  v_mfma_f32_16x16x32_bf16 v[80:83], a[32:35], a[60:63], v[80:83]
  ds_read_b64_tr_b16 a[44:45], v199 offset:22528
  v_mfma_f32_16x16x32_bf16 v[76:79], a[28:31], a[60:63], v[76:79]
  s_lshl2_add_u32 s48, s52, s44
  ds_read_b128 a[8:11], v208 offset:35840
  s_lshl_b32 s49, s48, 16
  v_mfma_f32_16x16x32_bf16 v[72:75], a[24:27], a[60:63], v[72:75]
  s_add_u32 s49, s49, 7340032
  buffer_load_dwordx4 v205, s[36:39], s62 offen offset:1024 sc1 lds
  s_add_u32 m0, s65, 41984
  v_mfma_f32_16x16x32_bf16 v[68:71], a[20:23], a[60:63], v[68:71]
  s_waitcnt lgkmcnt(6)
  ds_read_b64_tr_b16 a[46:47], v199 offset:28672
  v_add_u32 v243, s49, v0
  v_mfma_f32_16x16x32_bf16 v[84:87], a[64:67], a[20:23], v[84:87]
  ds_read_b128 a[12:15], v208 offset:36864
  v_mfma_f32_16x16x32_bf16 v[88:91], a[64:67], a[24:27], v[88:91]
  ds_read_b128 a[16:19], v211 offset:41984
  v_mfma_f32_16x16x32_bf16 v[92:95], a[64:67], a[28:31], v[92:95]
  buffer_load_dword v206, s[36:39], s62 offen sc1 lds
  s_mov_b32 s61, 2555904
  v_mfma_f32_16x16x32_bf16 v[96:99], a[64:67], a[32:35], v[96:99]
  s_add_u32 m0, s63, 43008
  ds_read_b64_tr_b16 a[48:49], v198 offset:23552
  s_lshl4_add_u32 s74, s48, s53
  v_mfma_f32_16x16x32_bf16 v[112:115], a[68:71], a[32:35], v[112:115]
  s_lshl_b32 s74, s74, 8
  ds_read_b64_tr_b16 a[50:51], v198 offset:29696
  s_add_u32 s74, s74, 262144
  v_mfma_f32_16x16x32_bf16 v[108:111], a[68:71], a[28:31], v[108:111]
Ha1:
  s_cbranch_execz Ha1_1
  ds_read_b64_tr_b16 a[52:53], v199 offset:23552
  v_mfma_f32_16x16x32_bf16 v[104:107], a[68:71], a[24:27], v[104:107]
  buffer_load_dwordx4 v202, s[8:11], s61 offen offset:0 lds
  v_mfma_f32_16x16x32_bf16 v[100:103], a[68:71], a[20:23], v[100:103]
  s_waitcnt vmcnt(19) lgkmcnt(3)
  s_barrier
  ds_read_b64_tr_b16 a[54:55], v199 offset:29696
  v_mfma_f32_16x16x32_bf16 v[20:23], a[40:43], a[0:3], v[20:23]
  s_lshr_b32 s73, s48, 1
  ds_read_b64_tr_b16 a[56:57], v198 offset:21504
  s_lshl4_add_u32 s73, s73, s53
  v_mfma_f32_16x16x32_bf16 v[24:27], a[40:43], a[4:7], v[24:27]
  s_and_b32 s49, s48, 1
  s_lshl2_add_u32 s73, s73, s49
  s_lshl_b32 s73, s73, 11
  v_mfma_f32_16x16x32_bf16 v[28:31], a[40:43], a[8:11], v[28:31]
  s_add_u32 s73, s73, 36700160
  buffer_load_dwordx4 v203, s[8:11], s61 offen offset:1024 lds
  v_mfma_f32_16x16x32_bf16 v[32:35], a[40:43], a[12:15], v[32:35]
  ds_read_b64_tr_b16 a[58:59], v198 offset:27648
  v_mfma_f32_16x16x32_bf16 v[116:119], a[40:43], a[16:19], v[116:119]
  ds_read_b64_tr_b16 a[60:61], v199 offset:21504
  v_mfma_f32_16x16x32_bf16 v[48:51], a[44:47], a[12:15], v[48:51]
  v_mfma_f32_16x16x32_bf16 v[44:47], a[44:47], a[8:11], v[44:47]
  buffer_load_dwordx4 v204, s[8:11], s61 offen offset:2048 lds
  s_mov_b32 s62, 26624
  v_mfma_f32_16x16x32_bf16 v[40:43], a[44:47], a[4:7], v[40:43]
  s_add_u32 m0, s64, 55296
  ds_read_b64_tr_b16 a[62:63], v199 offset:27648
  v_mfma_f32_16x16x32_bf16 v[36:39], a[44:47], a[0:3], v[36:39]
  s_waitcnt lgkmcnt(4)
  ds_read_b64_tr_b16 a[64:65], v198 offset:44032
  v_mfma_f32_16x16x32_bf16 v[52:55], a[0:3], a[48:51], v[52:55]
  ds_read_b128 a[20:23], v208 offset:55296
  v_mfma_f32_16x16x32_bf16 v[56:59], a[4:7], a[48:51], v[56:59]
  s_lshl1_add_u32 s75, s48, s53
  buffer_load_dwordx4 v205, s[36:39], s62 offen offset:0 sc1 lds
  s_lshl_b32 s75, s75, 11
  v_mfma_f32_16x16x32_bf16 v[60:63], a[8:11], a[48:51], v[60:63]
  s_add_u32 s75, s75, 5767168
  ds_read_b64_tr_b16 a[66:67], v198 offset:50176
  s_and_b32 s48, s48, 7
  v_mfma_f32_16x16x32_bf16 v[64:67], a[12:15], a[48:51], v[64:67]
  s_cselect_b32 s75, 1073741824, s75
  ds_read_b128 a[24:27], v208 offset:56320
  v_mfma_f32_16x16x32_bf16 v[120:123], a[16:19], a[48:51], v[120:123]
  ds_read_b64_tr_b16 a[68:69], v199 offset:44032
  v_mfma_f32_16x16x32_bf16 v[80:83], a[12:15], a[52:55], v[80:83]
  buffer_load_dwordx4 v205, s[36:39], s62 offen offset:1024 sc1 lds
  s_add_u32 m0, s65, 63488
  v_mfma_f32_16x16x32_bf16 v[76:79], a[8:11], a[52:55], v[76:79]
  ds_read_b128 a[28:31], v208 offset:57344
  v_mfma_f32_16x16x32_bf16 v[72:75], a[4:7], a[52:55], v[72:75]
  ds_read_b64_tr_b16 a[70:71], v199 offset:50176
  v_mfma_f32_16x16x32_bf16 v[68:71], a[0:3], a[52:55], v[68:71]
  s_waitcnt lgkmcnt(7)
  ds_read_b128 a[32:35], v208 offset:58368
  v_mfma_f32_16x16x32_bf16 v[84:87], a[56:59], a[0:3], v[84:87]
  s_and_b32 s48, s52, 7
  buffer_load_dword v206, s[36:39], s62 offen sc1 lds
  s_mov_b32 s61, 2752512
  v_mfma_f32_16x16x32_bf16 v[88:91], a[56:59], a[4:7], v[88:91]
  s_add_u32 m0, s63, 64512
  ds_read_b128 a[36:39], v211 offset:63488
  s_lshl_b32 s48, s48, 5
  v_mfma_f32_16x16x32_bf16 v[92:95], a[56:59], a[8:11], v[92:95]
  s_lshr_b32 s49, s52, 3
  ds_read_b64_tr_b16 a[40:41], v198 offset:45056
  s_lshl2_add_u32 s48, s49, s48
  v_mfma_f32_16x16x32_bf16 v[96:99], a[56:59], a[12:15], v[96:99]
  ds_read_b64_tr_b16 a[42:43], v198 offset:51200
  v_mfma_f32_16x16x32_bf16 v[112:115], a[60:63], a[12:15], v[112:115]
  buffer_load_dwordx4 v202, s[8:11], s61 offen offset:0 lds
  v_mfma_f32_16x16x32_bf16 v[108:111], a[60:63], a[8:11], v[108:111]
  ds_read_b64_tr_b16 a[44:45], v199 offset:45056
  v_mfma_f32_16x16x32_bf16 v[104:107], a[60:63], a[4:7], v[104:107]
  ds_read_b64_tr_b16 a[46:47], v199 offset:51200
  v_and_b32 v12, 3, v10
  v_mfma_f32_16x16x32_bf16 v[100:103], a[60:63], a[0:3], v[100:103]
  s_waitcnt vmcnt(19) lgkmcnt(4)
  s_barrier
  v_bfe_u32 v13, v10, 2, 2
  v_mfma_f32_16x16x32_bf16 v[20:23], a[64:67], a[20:23], v[20:23]
  buffer_load_dwordx4 v203, s[8:11], s61 offen offset:1024 lds
  v_lshl_add_u32 v12, v13, 3, v12
  v_mfma_f32_16x16x32_bf16 v[24:27], a[64:67], a[24:27], v[24:27]
  ds_read_b64_tr_b16 a[48:49], v198 offset:43008
  v_add_lshl_u32 v249, v12, s48, 7
  v_mfma_f32_16x16x32_bf16 v[28:31], a[64:67], a[28:31], v[28:31]
  ds_read_b64_tr_b16 a[50:51], v198 offset:49152
  v_mfma_f32_16x16x32_bf16 v[32:35], a[64:67], a[32:35], v[32:35]
  v_mfma_f32_16x16x32_bf16 v[116:119], a[64:67], a[36:39], v[116:119]
  buffer_load_dwordx4 v204, s[8:11], s61 offen offset:2048 lds
  s_mov_b32 s62, 28672
  v_mfma_f32_16x16x32_bf16 v[48:51], a[68:71], a[32:35], v[48:51]
  s_add_u32 m0, s64, 76800
  ds_read_b64_tr_b16 a[52:53], v199 offset:43008
  v_add_u32 v249, 32768, v249
  v_mfma_f32_16x16x32_bf16 v[44:47], a[68:71], a[28:31], v[44:47]
  ds_read_b64_tr_b16 a[54:55], v199 offset:49152
  v_and_b32 v12, 7, v10
  v_mfma_f32_16x16x32_bf16 v[40:43], a[68:71], a[24:27], v[40:43]
  v_and_b32 v13, 8, v10
  v_lshl_add_u32 v12, v13, 4, v12
  v_mfma_f32_16x16x32_bf16 v[36:39], a[68:71], a[20:23], v[36:39]
  s_waitcnt lgkmcnt(4)
  buffer_load_dwordx4 v205, s[36:39], s62 offen offset:0 sc1 lds
  s_lshl_b32 s48, s53, 3
  v_mfma_f32_16x16x32_bf16 v[52:55], a[20:23], a[40:43], v[52:55]
  ds_read_b64_tr_b16 a[56:57], v200 offset:1024
  v_add_lshl_u32 v12, v12, s48, 7
  v_mfma_f32_16x16x32_bf16 v[56:59], a[24:27], a[40:43], v[56:59]
  ds_read_b128 a[0:3], v209 offset:12288
  v_cmp_gt_u32 vcc, 16, v10
  v_mfma_f32_16x16x32_bf16 v[60:63], a[28:31], a[40:43], v[60:63]
  s_nop 1
  ds_read_b64_tr_b16 a[58:59], v200 offset:7168
  v_cndmask_b32 v249, v12, v249, vcc
  v_mfma_f32_16x16x32_bf16 v[64:67], a[32:35], a[40:43], v[64:67]
  buffer_load_dwordx4 v205, s[36:39], s62 offen offset:1024 sc1 lds
  s_add_u32 m0, s65, 84992
  v_mfma_f32_16x16x32_bf16 v[120:123], a[36:39], a[40:43], v[120:123]
  ds_read_b128 a[4:7], v209 offset:13312
  v_mfma_f32_16x16x32_bf16 v[80:83], a[32:35], a[44:47], v[80:83]
  ds_read_b64_tr_b16 a[60:61], v201 offset:1024
  v_mfma_f32_16x16x32_bf16 v[76:79], a[28:31], a[44:47], v[76:79]
  ds_read_b128 a[8:11], v209 offset:14336
  v_mfma_f32_16x16x32_bf16 v[72:75], a[24:27], a[44:47], v[72:75]
  buffer_load_dword v206, s[36:39], s62 offen sc1 lds
  s_mov_b32 s61, 2949120
  v_mfma_f32_16x16x32_bf16 v[68:71], a[20:23], a[44:47], v[68:71]
  s_waitcnt lgkmcnt(6)
  s_add_u32 m0, s63, 86016
  ds_read_b64_tr_b16 a[62:63], v201 offset:7168
  v_mfma_f32_16x16x32_bf16 v[84:87], a[48:51], a[20:23], v[84:87]
  ds_read_b128 a[12:15], v209 offset:15360
  v_mfma_f32_16x16x32_bf16 v[88:91], a[48:51], a[24:27], v[88:91]
  s_lshl_b32 s48, s59, 3
  ds_read_b128 a[16:19], v212 offset:20480
  s_add_u32 s48, s48, 150528
  v_mfma_f32_16x16x32_bf16 v[92:95], a[48:51], a[28:31], v[92:95]
  buffer_load_dwordx4 v202, s[8:11], s61 offen offset:0 lds
  v_add_u32 v12, s48, v0
  v_mfma_f32_16x16x32_bf16 v[96:99], a[48:51], a[32:35], v[96:99]
  ds_read_b64_tr_b16 a[64:65], v200 offset:2048
  v_add_u32 v222, s64, v12
  v_mfma_f32_16x16x32_bf16 v[112:115], a[52:55], a[32:35], v[112:115]
  ds_read_b64_tr_b16 a[66:67], v200 offset:8192
  v_xor_b32 v223, 8, v222
  v_mfma_f32_16x16x32_bf16 v[108:111], a[52:55], a[28:31], v[108:111]
  ds_read_b64_tr_b16 a[68:69], v201 offset:2048
  v_mfma_f32_16x16x32_bf16 v[104:107], a[52:55], a[24:27], v[104:107]
  buffer_load_dwordx4 v203, s[8:11], s61 offen offset:1024 lds
  v_mfma_f32_16x16x32_bf16 v[100:103], a[52:55], a[20:23], v[100:103]
  s_waitcnt vmcnt(20) lgkmcnt(3)
  s_barrier
  ds_read_b64_tr_b16 a[70:71], v201 offset:8192
  v_mfma_f32_16x16x32_bf16 v[20:23], a[56:59], a[0:3], v[20:23]
  ds_read_b64_tr_b16 a[40:41], v200 offset:0
  v_mfma_f32_16x16x32_bf16 v[24:27], a[56:59], a[4:7], v[24:27]
  s_lshl_b32 s48, s60, 11
  s_add_u32 s48, s48, 8192
  v_add_u32 v224, s48, v12
  v_mfma_f32_16x16x32_bf16 v[28:31], a[56:59], a[8:11], v[28:31]
  s_lshl_b32 s48, s59, 13
  buffer_load_dwordx4 v204, s[8:11], s61 offen offset:2048 lds
  s_mov_b32 s62, 30720
  v_mfma_f32_16x16x32_bf16 v[32:35], a[56:59], a[12:15], v[32:35]
  s_add_u32 m0, s64, 98304
  ds_read_b64_tr_b16 a[42:43], v200 offset:6144
  v_subrev_u32 v225, s48, v224
  v_mfma_f32_16x16x32_bf16 v[116:119], a[56:59], a[16:19], v[116:119]
  ds_read_b64_tr_b16 a[44:45], v201 offset:0
  v_xor_b32 v226, 8, v225
  v_mfma_f32_16x16x32_bf16 v[48:51], a[60:63], a[12:15], v[48:51]
  v_mfma_f32_16x16x32_bf16 v[44:47], a[60:63], a[8:11], v[44:47]
  buffer_load_dwordx4 v205, s[36:39], s62 offen offset:0 sc1 lds
  v_mfma_f32_16x16x32_bf16 v[40:43], a[60:63], a[4:7], v[40:43]
  ds_read_b64_tr_b16 a[46:47], v201 offset:6144
  v_mfma_f32_16x16x32_bf16 v[36:39], a[60:63], a[0:3], v[36:39]
  s_waitcnt lgkmcnt(4)
  ds_read_b64_tr_b16 a[48:49], v196 offset:1024
  v_mfma_f32_16x16x32_bf16 v[52:55], a[0:3], a[64:67], v[52:55]
  ds_read_b128 a[20:23], v207 offset:12288
  v_mfma_f32_16x16x32_bf16 v[56:59], a[4:7], a[64:67], v[56:59]
  buffer_load_dwordx4 v205, s[36:39], s62 offen offset:1024 sc1 lds
  s_add_u32 m0, s65, 106496
  v_mfma_f32_16x16x32_bf16 v[60:63], a[8:11], a[64:67], v[60:63]
  s_mov_b32 s78, 0xaaaaaaaa
  ds_read_b64_tr_b16 a[50:51], v196 offset:7168
  s_mov_b32 s79, 0xaaaaaaaa
  v_mfma_f32_16x16x32_bf16 v[64:67], a[12:15], a[64:67], v[64:67]
  s_mov_b32 s80, 0x000f0000
  ds_read_b128 a[24:27], v207 offset:13312
  s_mov_b32 s81, 0x0fff00ff
  v_mfma_f32_16x16x32_bf16 v[120:123], a[16:19], a[64:67], v[120:123]
  s_mov_b32 s82, 0x003f0003
  ds_read_b64_tr_b16 a[52:53], v197 offset:1024
  s_mov_b32 s83, 0x3fff03ff
  v_mfma_f32_16x16x32_bf16 v[80:83], a[12:15], a[68:71], v[80:83]
  buffer_load_dword v206, s[36:39], s62 offen sc1 lds
  s_mov_b32 s61, 3145728
  v_mfma_f32_16x16x32_bf16 v[76:79], a[8:11], a[68:71], v[76:79]
  s_add_u32 m0, s63, 107520
  ds_read_b128 a[28:31], v207 offset:14336
  v_mfma_f32_16x16x32_bf16 v[72:75], a[4:7], a[68:71], v[72:75]
  ds_read_b64_tr_b16 a[54:55], v197 offset:7168
  v_mfma_f32_16x16x32_bf16 v[68:71], a[0:3], a[68:71], v[68:71]
  s_waitcnt lgkmcnt(7)
  ds_read_b128 a[32:35], v207 offset:15360
  v_mfma_f32_16x16x32_bf16 v[84:87], a[40:43], a[0:3], v[84:87]
  buffer_load_dwordx4 v202, s[8:11], s61 offen offset:0 lds
  v_mfma_f32_16x16x32_bf16 v[88:91], a[40:43], a[4:7], v[88:91]
  ds_read_b128 a[36:39], v210 offset:20480
  v_mfma_f32_16x16x32_bf16 v[92:95], a[40:43], a[8:11], v[92:95]
  ds_read_b64_tr_b16 a[56:57], v196 offset:2048
  v_mov_b32 v12, 0xffff
  v_mfma_f32_16x16x32_bf16 v[96:99], a[40:43], a[12:15], v[96:99]
  ds_read_b64_tr_b16 a[58:59], v196 offset:8192
  v_mov_b32 v13, 0xffff0000
  v_mfma_f32_16x16x32_bf16 v[112:115], a[44:47], a[12:15], v[112:115]
  buffer_load_dwordx4 v203, s[8:11], s61 offen offset:1024 lds
  v_cndmask_b32 v12, v12, v13, s[78:79]
  v_mfma_f32_16x16x32_bf16 v[108:111], a[44:47], a[8:11], v[108:111]
  ds_read_b64_tr_b16 a[60:61], v197 offset:2048
  v_cndmask_b32 v227, 0, v12, s[80:81]
  v_mfma_f32_16x16x32_bf16 v[104:107], a[44:47], a[4:7], v[104:107]
  ds_read_b64_tr_b16 a[62:63], v197 offset:8192
  v_cndmask_b32 v228, 0, v12, s[82:83]
  v_mfma_f32_16x16x32_bf16 v[100:103], a[44:47], a[0:3], v[100:103]
  s_waitcnt vmcnt(20) lgkmcnt(4)
  s_barrier
  v_mfma_f32_16x16x32_bf16 v[20:23], a[48:51], a[20:23], v[20:23]
  buffer_load_dwordx4 v204, s[8:11], s61 offen offset:2048 lds
  s_mov_b32 s62, 32768
  v_mfma_f32_16x16x32_bf16 v[24:27], a[48:51], a[24:27], v[24:27]
  s_add_u32 m0, s64, 119808
  ds_read_b64_tr_b16 a[64:65], v196 offset:0
  v_mfma_f32_16x16x32_bf16 v[28:31], a[48:51], a[28:31], v[28:31]
  ds_read_b64_tr_b16 a[66:67], v196 offset:6144
  v_xor_b32 v229, v227, v12
  v_mfma_f32_16x16x32_bf16 v[32:35], a[48:51], a[32:35], v[32:35]
  v_xor_b32 v230, v228, v12
  v_mfma_f32_16x16x32_bf16 v[116:119], a[48:51], a[36:39], v[116:119]
  buffer_load_dwordx4 v205, s[36:39], s62 offen offset:0 sc1 lds
  v_mfma_f32_16x16x32_bf16 v[48:51], a[52:55], a[32:35], v[48:51]
  ds_read_b64_tr_b16 a[68:69], v197 offset:0
  v_mfma_f32_16x16x32_bf16 v[44:47], a[52:55], a[28:31], v[44:47]
  s_lshl1_add_u32 s48, s57, s59
  ds_read_b64_tr_b16 a[70:71], v197 offset:6144
  s_lshl_b32 s71, s48, 17
  v_mfma_f32_16x16x32_bf16 v[40:43], a[52:55], a[24:27], v[40:43]
  s_lshl1_add_u32 s48, s58, s60
  s_lshl_b32 s48, s48, 11
  v_mfma_f32_16x16x32_bf16 v[36:39], a[52:55], a[20:23], v[36:39]
  s_waitcnt lgkmcnt(4)
  buffer_load_dwordx4 v205, s[36:39], s62 offen offset:1024 sc1 lds
  s_add_u32 m0, s65, 128000
  v_mfma_f32_16x16x32_bf16 v[52:55], a[20:23], a[56:59], v[52:55]
  ds_read_b64_tr_b16 a[40:41], v196 offset:22528
  v_mfma_f32_16x16x32_bf16 v[56:59], a[24:27], a[56:59], v[56:59]
  ds_read_b128 a[0:3], v207 offset:33792
  v_mfma_f32_16x16x32_bf16 v[60:63], a[28:31], a[56:59], v[60:63]
  ds_read_b64_tr_b16 a[42:43], v196 offset:28672
  v_mfma_f32_16x16x32_bf16 v[64:67], a[32:35], a[56:59], v[64:67]
  s_add_u32 s71, s71, s48
  buffer_load_dword v206, s[36:39], s62 offen sc1 lds
  s_mov_b32 s61, 3342336
  v_mfma_f32_16x16x32_bf16 v[120:123], a[36:39], a[56:59], v[120:123]
  s_add_u32 m0, s63, 129024
  ds_read_b128 a[4:7], v207 offset:34816
  s_add_u32 s71, s71, 7340032
  v_mfma_f32_16x16x32_bf16 v[80:83], a[32:35], a[60:63], v[80:83]
  s_add_u32 s72, s71, 65536
  ds_read_b64_tr_b16 a[44:45], v197 offset:22528
  s_or_b32 s57, s57, s59
  v_mfma_f32_16x16x32_bf16 v[76:79], a[28:31], a[60:63], v[76:79]
  ds_read_b128 a[8:11], v207 offset:35840
  v_mfma_f32_16x16x32_bf16 v[72:75], a[24:27], a[60:63], v[72:75]
  buffer_load_dwordx4 v202, s[8:11], s61 offen offset:0 lds
  v_mfma_f32_16x16x32_bf16 v[68:71], a[20:23], a[60:63], v[68:71]
  s_waitcnt lgkmcnt(6)
  ds_read_b64_tr_b16 a[46:47], v197 offset:28672
  v_mfma_f32_16x16x32_bf16 v[84:87], a[64:67], a[20:23], v[84:87]
  s_lshl_b32 s45, s2, 7
  ds_read_b128 a[12:15], v207 offset:36864
  s_add_u32 s45, s45, 5275648
  v_mfma_f32_16x16x32_bf16 v[88:91], a[64:67], a[24:27], v[88:91]
  s_cmp_eq_u32 s44, 0
  ds_read_b128 a[16:19], v210 offset:41984
  s_cselect_b32 s45, s45, 1073741824
  v_mfma_f32_16x16x32_bf16 v[92:95], a[64:67], a[28:31], v[92:95]
  buffer_load_dwordx4 v203, s[8:11], s61 offen offset:1024 lds
  v_mfma_f32_16x16x32_bf16 v[96:99], a[64:67], a[32:35], v[96:99]
  ds_read_b64_tr_b16 a[48:49], v196 offset:23552
  v_mfma_f32_16x16x32_bf16 v[112:115], a[68:71], a[32:35], v[112:115]
  ds_read_b64_tr_b16 a[50:51], v196 offset:29696
  v_mfma_f32_16x16x32_bf16 v[108:111], a[68:71], a[28:31], v[108:111]
  ds_read_b64_tr_b16 a[52:53], v197 offset:23552
  v_mfma_f32_16x16x32_bf16 v[104:107], a[68:71], a[24:27], v[104:107]
  buffer_load_dwordx4 v204, s[8:11], s61 offen offset:2048 lds
  s_mov_b32 s62, 34816
  v_mfma_f32_16x16x32_bf16 v[100:103], a[68:71], a[20:23], v[100:103]
  s_waitcnt vmcnt(21) lgkmcnt(3)
  s_barrier
  s_add_u32 m0, s64, 141312
  v_mfma_f32_16x16x32_bf16 v[20:23], a[40:43], a[0:3], v[20:23]
  s_lshr_b32 s49, s2, 3
  ds_read_b64_tr_b16 a[54:55], v197 offset:29696
  s_and_b32 s60, s49, 3
  v_mfma_f32_16x16x32_bf16 v[24:27], a[40:43], a[4:7], v[24:27]
  s_lshr_b32 s58, s49, 2
  ds_read_b64_tr_b16 a[56:57], v196 offset:21504
  s_lshl1_add_u32 s49, s60, s58
  v_mfma_f32_16x16x32_bf16 v[28:31], a[40:43], a[8:11], v[28:31]
  s_and_b32 s49, s49, 7
  buffer_load_dwordx4 v205, s[36:39], s62 offen offset:0 sc1 lds
  s_and_b32 s48, s2, 7
  v_mfma_f32_16x16x32_bf16 v[32:35], a[40:43], a[12:15], v[32:35]
  s_lshl2_add_u32 s60, s48, s60
  ds_read_b64_tr_b16 a[58:59], v196 offset:27648
  v_mfma_f32_16x16x32_bf16 v[116:119], a[40:43], a[16:19], v[116:119]
  ds_read_b64_tr_b16 a[60:61], v197 offset:21504
  v_mfma_f32_16x16x32_bf16 v[48:51], a[44:47], a[12:15], v[48:51]
  v_mfma_f32_16x16x32_bf16 v[44:47], a[44:47], a[8:11], v[44:47]
  buffer_load_dwordx4 v205, s[36:39], s62 offen offset:1024 sc1 lds
  s_add_u32 m0, s65, 149504
  v_mfma_f32_16x16x32_bf16 v[40:43], a[44:47], a[4:7], v[40:43]
  ds_read_b64_tr_b16 a[62:63], v197 offset:27648
  v_mfma_f32_16x16x32_bf16 v[36:39], a[44:47], a[0:3], v[36:39]
  s_waitcnt lgkmcnt(4)
  ds_read_b64_tr_b16 a[64:65], v196 offset:44032
  v_mfma_f32_16x16x32_bf16 v[52:55], a[0:3], a[48:51], v[52:55]
  ds_read_b128 a[20:23], v207 offset:55296
  v_mfma_f32_16x16x32_bf16 v[56:59], a[4:7], a[48:51], v[56:59]
  s_mov_b32 s84, 0xc0653421
  buffer_load_dword v206, s[36:39], s62 offen sc1 lds
  s_mov_b32 s61, 3538944
  v_mfma_f32_16x16x32_bf16 v[60:63], a[8:11], a[48:51], v[60:63]
  s_add_u32 m0, s63, 0
  ds_read_b64_tr_b16 a[66:67], v196 offset:50176
  s_mov_b32 s85, 0xfedba987
  v_mfma_f32_16x16x32_bf16 v[64:67], a[12:15], a[48:51], v[64:67]
  ds_read_b128 a[24:27], v207 offset:56320
  v_mfma_f32_16x16x32_bf16 v[120:123], a[16:19], a[48:51], v[120:123]
  s_cmp_eq_u32 s49, 1
  ds_read_b64_tr_b16 a[68:69], v197 offset:44032
  s_cselect_b32 s84, 0xd1643520, s84
  v_mfma_f32_16x16x32_bf16 v[80:83], a[12:15], a[52:55], v[80:83]
  s_cselect_b32 s85, 0xfecba897, s85
  buffer_load_dwordx4 v202, s[8:11], s61 offen offset:0 lds
  v_mfma_f32_16x16x32_bf16 v[76:79], a[8:11], a[52:55], v[76:79]
  ds_read_b128 a[28:31], v207 offset:57344
  v_mfma_f32_16x16x32_bf16 v[72:75], a[4:7], a[52:55], v[72:75]
  ds_read_b64_tr_b16 a[70:71], v197 offset:50176
  v_mfma_f32_16x16x32_bf16 v[68:71], a[0:3], a[52:55], v[68:71]
  s_waitcnt lgkmcnt(7)
  ds_read_b128 a[32:35], v207 offset:58368
  v_mfma_f32_16x16x32_bf16 v[84:87], a[56:59], a[0:3], v[84:87]
  s_cmp_eq_u32 s49, 2
  buffer_load_dwordx4 v203, s[8:11], s61 offen offset:1024 lds
  s_cselect_b32 s84, 0x72546310, s84
  v_mfma_f32_16x16x32_bf16 v[88:91], a[56:59], a[4:7], v[88:91]
  s_cselect_b32 s85, 0xfdcb98ae, s85
  ds_read_b128 a[36:39], v210 offset:63488
  v_mfma_f32_16x16x32_bf16 v[92:95], a[56:59], a[8:11], v[92:95]
  ds_read_b64_tr_b16 a[40:41], v196 offset:45056
  v_mfma_f32_16x16x32_bf16 v[96:99], a[56:59], a[12:15], v[96:99]
  ds_read_b64_tr_b16 a[42:43], v196 offset:51200
  v_mfma_f32_16x16x32_bf16 v[112:115], a[60:63], a[12:15], v[112:115]
  buffer_load_dwordx4 v204, s[8:11], s61 offen offset:2048 lds
  s_mov_b32 s62, 36864
  v_mfma_f32_16x16x32_bf16 v[108:111], a[60:63], a[8:11], v[108:111]
  s_add_u32 m0, s64, 12288
  ds_read_b64_tr_b16 a[44:45], v197 offset:45056
  s_cmp_eq_u32 s49, 3
  v_mfma_f32_16x16x32_bf16 v[104:107], a[60:63], a[4:7], v[104:107]
  s_cselect_b32 s84, 0x63547210, s84
  ds_read_b64_tr_b16 a[46:47], v197 offset:51200
  s_cselect_b32 s85, 0xfedca9b8, s85
  v_mfma_f32_16x16x32_bf16 v[100:103], a[60:63], a[0:3], v[100:103]
  s_waitcnt vmcnt(21) lgkmcnt(4)
  s_barrier
  v_mfma_f32_16x16x32_bf16 v[20:23], a[64:67], a[20:23], v[20:23]
  buffer_load_dwordx4 v205, s[36:39], s62 offen offset:0 sc1 lds
  v_mfma_f32_16x16x32_bf16 v[24:27], a[64:67], a[24:27], v[24:27]
  s_cmp_eq_u32 s49, 4
  ds_read_b64_tr_b16 a[48:49], v196 offset:43008
  s_cselect_b32 s84, 0x64583210, s84
  v_mfma_f32_16x16x32_bf16 v[28:31], a[64:67], a[28:31], v[28:31]
  s_cselect_b32 s85, 0xfedba9c7, s85
  ds_read_b64_tr_b16 a[50:51], v196 offset:49152
  v_mfma_f32_16x16x32_bf16 v[32:35], a[64:67], a[32:35], v[32:35]
  v_mfma_f32_16x16x32_bf16 v[116:119], a[64:67], a[36:39], v[116:119]
  buffer_load_dwordx4 v205, s[36:39], s62 offen offset:1024 sc1 lds
  s_add_u32 m0, s65, 20480
  v_mfma_f32_16x16x32_bf16 v[48:51], a[68:71], a[32:35], v[48:51]
  ds_read_b64_tr_b16 a[52:53], v197 offset:43008
  v_mfma_f32_16x16x32_bf16 v[44:47], a[68:71], a[28:31], v[44:47]
  s_cmp_eq_u32 s49, 5
  ds_read_b64_tr_b16 a[54:55], v197 offset:49152
  s_cselect_b32 s84, 0x65493210, s84
  v_mfma_f32_16x16x32_bf16 v[40:43], a[68:71], a[24:27], v[40:43]
  s_cselect_b32 s85, 0xfecba8d7, s85
  v_mfma_f32_16x16x32_bf16 v[36:39], a[68:71], a[20:23], v[36:39]
  s_waitcnt lgkmcnt(4)
  buffer_load_dword v206, s[36:39], s62 offen sc1 lds
  s_mov_b32 s61, 3735552
  v_mfma_f32_16x16x32_bf16 v[52:55], a[20:23], a[40:43], v[52:55]
  s_add_u32 m0, s63, 21504
  ds_read_b64_tr_b16 a[56:57], v198 offset:1024
  v_mfma_f32_16x16x32_bf16 v[56:59], a[24:27], a[40:43], v[56:59]
  ds_read_b128 a[0:3], v208 offset:12288
  v_mfma_f32_16x16x32_bf16 v[60:63], a[28:31], a[40:43], v[60:63]
  s_cmp_eq_u32 s49, 6
  ds_read_b64_tr_b16 a[58:59], v198 offset:7168
  s_cselect_b32 s84, 0x56a43210, s84
  v_mfma_f32_16x16x32_bf16 v[64:67], a[32:35], a[40:43], v[64:67]
  s_cselect_b32 s85, 0xfdcb98e7, s85
  buffer_load_dwordx4 v202, s[8:11], s61 offen offset:0 lds
  v_mfma_f32_16x16x32_bf16 v[120:123], a[36:39], a[40:43], v[120:123]
  ds_read_b128 a[4:7], v208 offset:13312
  v_mfma_f32_16x16x32_bf16 v[80:83], a[32:35], a[44:47], v[80:83]
  ds_read_b64_tr_b16 a[60:61], v199 offset:1024
  v_mfma_f32_16x16x32_bf16 v[76:79], a[28:31], a[44:47], v[76:79]
  ds_read_b128 a[8:11], v208 offset:14336
  v_mfma_f32_16x16x32_bf16 v[72:75], a[24:27], a[44:47], v[72:75]
  s_cmp_eq_u32 s49, 7
  buffer_load_dwordx4 v203, s[8:11], s61 offen offset:1024 lds
  s_cselect_b32 s84, 0x57b43210, s84
  v_mfma_f32_16x16x32_bf16 v[68:71], a[20:23], a[44:47], v[68:71]
  s_waitcnt lgkmcnt(6)
  ds_read_b64_tr_b16 a[62:63], v199 offset:7168
  s_cselect_b32 s85, 0xedca98f6, s85
  v_mfma_f32_16x16x32_bf16 v[84:87], a[48:51], a[20:23], v[84:87]
  ds_read_b128 a[12:15], v208 offset:15360
  v_mfma_f32_16x16x32_bf16 v[88:91], a[48:51], a[24:27], v[88:91]
  ds_read_b128 a[16:19], v211 offset:20480
  v_mfma_f32_16x16x32_bf16 v[92:95], a[48:51], a[28:31], v[92:95]
  buffer_load_dwordx4 v204, s[8:11], s61 offen offset:2048 lds
  s_mov_b32 s62, 38912
  v_mfma_f32_16x16x32_bf16 v[96:99], a[48:51], a[32:35], v[96:99]
  s_add_u32 m0, s64, 33792
  ds_read_b64_tr_b16 a[64:65], v198 offset:2048
  s_mul_i32 s77, s44, 7168
  v_mfma_f32_16x16x32_bf16 v[112:115], a[52:55], a[32:35], v[112:115]
  s_lshl2_add_u32 s86, s58, s44
  ds_read_b64_tr_b16 a[66:67], v198 offset:8192
  s_lshl_b32 s86, s86, 17
  v_mfma_f32_16x16x32_bf16 v[108:111], a[52:55], a[28:31], v[108:111]
  s_add_u32 s86, s86, 36700160
  ds_read_b64_tr_b16 a[68:69], v199 offset:2048
  v_mfma_f32_16x16x32_bf16 v[104:107], a[52:55], a[24:27], v[104:107]
  buffer_load_dwordx4 v205, s[36:39], s62 offen offset:0 sc1 lds
  v_mfma_f32_16x16x32_bf16 v[100:103], a[52:55], a[20:23], v[100:103]
  s_waitcnt vmcnt(22) lgkmcnt(3)
  s_barrier
  ds_read_b64_tr_b16 a[70:71], v199 offset:8192
  v_mfma_f32_16x16x32_bf16 v[20:23], a[56:59], a[0:3], v[20:23]
  ds_read_b64_tr_b16 a[40:41], v198 offset:0
  v_mfma_f32_16x16x32_bf16 v[24:27], a[56:59], a[4:7], v[24:27]
  s_cmp_ge_u32 s44, 2
  s_cselect_b64 s[16:17], s[20:21], s[16:17]
  v_mfma_f32_16x16x32_bf16 v[28:31], a[56:59], a[8:11], v[28:31]
  buffer_load_dwordx4 v205, s[36:39], s62 offen offset:1024 sc1 lds
  s_add_u32 m0, s65, 41984
  v_mfma_f32_16x16x32_bf16 v[32:35], a[56:59], a[12:15], v[32:35]
  ds_read_b64_tr_b16 a[42:43], v198 offset:6144
  v_mfma_f32_16x16x32_bf16 v[116:119], a[56:59], a[16:19], v[116:119]
  ds_read_b64_tr_b16 a[44:45], v199 offset:0
  v_lshrrev_b32 v12, 2, v10
  v_mfma_f32_16x16x32_bf16 v[48:51], a[60:63], a[12:15], v[48:51]
  v_mul_u32_u24 v12, 224, v12
  v_and_b32 v13, 3, v10
  v_mfma_f32_16x16x32_bf16 v[44:47], a[60:63], a[8:11], v[44:47]
  buffer_load_dword v206, s[36:39], s62 offen sc1 lds
  s_mov_b32 s61, 3932160
  v_mfma_f32_16x16x32_bf16 v[40:43], a[60:63], a[4:7], v[40:43]
  s_add_u32 m0, s63, 43008
  ds_read_b64_tr_b16 a[46:47], v199 offset:6144
  v_lshl_add_u32 v1, v13, 3, v12
  v_mfma_f32_16x16x32_bf16 v[36:39], a[60:63], a[0:3], v[36:39]
  s_waitcnt lgkmcnt(4)
  ds_read_b64_tr_b16 a[48:49], v198 offset:22528
  v_add_u32 v2, 57344, v1
  v_mfma_f32_16x16x32_bf16 v[52:55], a[0:3], a[64:67], v[52:55]
  ds_read_b128 a[20:23], v208 offset:33792
  v_mfma_f32_16x16x32_bf16 v[56:59], a[4:7], a[64:67], v[56:59]
  buffer_load_dwordx4 v202, s[8:11], s61 offen offset:0 lds
  v_mfma_f32_16x16x32_bf16 v[60:63], a[8:11], a[64:67], v[60:63]
  ds_read_b64_tr_b16 a[50:51], v198 offset:28672
  v_mfma_f32_16x16x32_bf16 v[64:67], a[12:15], a[64:67], v[64:67]
  s_mul_i32 s48, s60, 224
  ds_read_b128 a[24:27], v208 offset:34816
  s_and_b32 s49, s44, 1
  v_mfma_f32_16x16x32_bf16 v[120:123], a[16:19], a[64:67], v[120:123]
  s_mul_i32 s49, s49, 229376
  ds_read_b64_tr_b16 a[52:53], v199 offset:22528
  s_add_u32 s48, s48, s49
  v_mfma_f32_16x16x32_bf16 v[80:83], a[12:15], a[68:71], v[80:83]
  s_and_b32 s49, s60, 1
  buffer_load_dwordx4 v203, s[8:11], s61 offen offset:1024 lds
  s_lshl_b32 s49, s49, 1
  v_mfma_f32_16x16x32_bf16 v[76:79], a[8:11], a[68:71], v[76:79]
  ds_read_b128 a[28:31], v208 offset:35840
  v_mfma_f32_16x16x32_bf16 v[72:75], a[4:7], a[68:71], v[72:75]
  ds_read_b64_tr_b16 a[54:55], v199 offset:28672
  v_mfma_f32_16x16x32_bf16 v[68:71], a[0:3], a[68:71], v[68:71]
  s_waitcnt lgkmcnt(7)
  ds_read_b128 a[32:35], v208 offset:36864
  v_mfma_f32_16x16x32_bf16 v[84:87], a[40:43], a[0:3], v[84:87]
  buffer_load_dwordx4 v204, s[8:11], s61 offen offset:2048 lds
  s_mov_b32 s62, 40960
  v_mfma_f32_16x16x32_bf16 v[88:91], a[40:43], a[4:7], v[88:91]
  s_add_u32 m0, s64, 55296
  ds_read_b128 a[36:39], v211 offset:41984
  v_mfma_f32_16x16x32_bf16 v[92:95], a[40:43], a[8:11], v[92:95]
  ds_read_b64_tr_b16 a[56:57], v198 offset:23552
  v_mfma_f32_16x16x32_bf16 v[96:99], a[40:43], a[12:15], v[96:99]
  ds_read_b64_tr_b16 a[58:59], v198 offset:29696
  v_mfma_f32_16x16x32_bf16 v[112:115], a[44:47], a[12:15], v[112:115]
  buffer_load_dwordx4 v205, s[36:39], s62 offen offset:0 sc1 lds
  v_add_u32 v12, 0, v10
  v_mfma_f32_16x16x32_bf16 v[108:111], a[44:47], a[8:11], v[108:111]
  ds_read_b64_tr_b16 a[60:61], v199 offset:23552
  v_mul_u32_u24 v13, 4682, v12
  v_mfma_f32_16x16x32_bf16 v[104:107], a[44:47], a[4:7], v[104:107]
  ds_read_b64_tr_b16 a[62:63], v199 offset:29696
  v_lshrrev_b32 v13, 16, v13
  v_mfma_f32_16x16x32_bf16 v[100:103], a[44:47], a[0:3], v[100:103]
  s_waitcnt vmcnt(22) lgkmcnt(4)
  s_barrier
  v_mul_i32_i24 v14, -14, v13
  v_mfma_f32_16x16x32_bf16 v[20:23], a[48:51], a[20:23], v[20:23]
  buffer_load_dwordx4 v205, s[36:39], s62 offen offset:1024 sc1 lds
  s_add_u32 m0, s65, 63488
  v_mfma_f32_16x16x32_bf16 v[24:27], a[48:51], a[24:27], v[24:27]
  ds_read_b64_tr_b16 a[64:65], v198 offset:21504
  v_add3_u32 v12, v12, v14, s49
  v_mfma_f32_16x16x32_bf16 v[28:31], a[48:51], a[28:31], v[28:31]
  ds_read_b64_tr_b16 a[66:67], v198 offset:27648
  v_mfma_f32_16x16x32_bf16 v[32:35], a[48:51], a[32:35], v[32:35]
  v_mfma_f32_16x16x32_bf16 v[116:119], a[48:51], a[36:39], v[116:119]
  buffer_load_dword v206, s[36:39], s62 offen sc1 lds
  s_mov_b32 s61, 4128768
  v_mfma_f32_16x16x32_bf16 v[48:51], a[52:55], a[32:35], v[48:51]
  s_add_u32 m0, s63, 64512
  ds_read_b64_tr_b16 a[68:69], v199 offset:21504
  v_add_u32 v14, -14, v12
  v_mfma_f32_16x16x32_bf16 v[44:47], a[52:55], a[28:31], v[44:47]
  ds_read_b64_tr_b16 a[70:71], v199 offset:27648
  v_min_u32 v12, v12, v14
  v_mfma_f32_16x16x32_bf16 v[40:43], a[52:55], a[24:27], v[40:43]
  v_mul_u32_u24 v13, 7168, v13
  v_lshl_add_u32 v12, v12, 4, v13
  v_mfma_f32_16x16x32_bf16 v[36:39], a[52:55], a[20:23], v[36:39]
  s_waitcnt lgkmcnt(4)
  buffer_load_dwordx4 v202, s[8:11], s61 offen offset:0 lds
  v_add_u32 v3, s48, v12
  v_mfma_f32_16x16x32_bf16 v[52:55], a[20:23], a[56:59], v[52:55]
Ha2:
  s_cbranch_execz Ha2_1
  ds_read_b64_tr_b16 a[40:41], v198 offset:44032
  v_mfma_f32_16x16x32_bf16 v[56:59], a[24:27], a[56:59], v[56:59]
  ds_read_b128 a[0:3], v208 offset:55296
  v_mfma_f32_16x16x32_bf16 v[60:63], a[28:31], a[56:59], v[60:63]
  ds_read_b64_tr_b16 a[42:43], v198 offset:50176
  v_mfma_f32_16x16x32_bf16 v[64:67], a[32:35], a[56:59], v[64:67]
  s_sub_u32 s48, s48, 1024
  buffer_load_dwordx4 v203, s[8:11], s61 offen offset:1024 lds
  v_mfma_f32_16x16x32_bf16 v[120:123], a[36:39], a[56:59], v[120:123]
  ds_read_b128 a[4:7], v208 offset:56320
  v_mfma_f32_16x16x32_bf16 v[80:83], a[32:35], a[60:63], v[80:83]
  ds_read_b64_tr_b16 a[44:45], v199 offset:44032
  v_add_u32 v12, 64, v10
  v_mfma_f32_16x16x32_bf16 v[76:79], a[28:31], a[60:63], v[76:79]
  ds_read_b128 a[8:11], v208 offset:57344
  v_mul_u32_u24 v13, 4682, v12
  v_mfma_f32_16x16x32_bf16 v[72:75], a[24:27], a[60:63], v[72:75]
  buffer_load_dwordx4 v204, s[8:11], s61 offen offset:2048 lds
  s_mov_b32 s62, 43008
  v_mfma_f32_16x16x32_bf16 v[68:71], a[20:23], a[60:63], v[68:71]
  s_waitcnt lgkmcnt(6)
  s_add_u32 m0, s64, 76800
  ds_read_b64_tr_b16 a[46:47], v199 offset:50176
  v_mfma_f32_16x16x32_bf16 v[84:87], a[64:67], a[20:23], v[84:87]
  ds_read_b128 a[12:15], v208 offset:58368
  v_lshrrev_b32 v13, 16, v13
  v_mfma_f32_16x16x32_bf16 v[88:91], a[64:67], a[24:27], v[88:91]
  ds_read_b128 a[16:19], v211 offset:63488
  v_mul_i32_i24 v14, -14, v13
  v_mfma_f32_16x16x32_bf16 v[92:95], a[64:67], a[28:31], v[92:95]
  buffer_load_dwordx4 v205, s[36:39], s62 offen offset:0 sc1 lds
  v_add3_u32 v12, v12, v14, s49
  v_mfma_f32_16x16x32_bf16 v[96:99], a[64:67], a[32:35], v[96:99]
  ds_read_b64_tr_b16 a[48:49], v198 offset:45056
  v_mfma_f32_16x16x32_bf16 v[112:115], a[68:71], a[32:35], v[112:115]
  ds_read_b64_tr_b16 a[50:51], v198 offset:51200
  v_add_u32 v14, -14, v12
  v_mfma_f32_16x16x32_bf16 v[108:111], a[68:71], a[28:31], v[108:111]
  ds_read_b64_tr_b16 a[52:53], v199 offset:45056
  v_min_u32 v12, v12, v14
  v_mfma_f32_16x16x32_bf16 v[104:107], a[68:71], a[24:27], v[104:107]
  buffer_load_dwordx4 v205, s[36:39], s62 offen offset:1024 sc1 lds
  s_add_u32 m0, s65, 84992
  v_mfma_f32_16x16x32_bf16 v[100:103], a[68:71], a[20:23], v[100:103]
  s_waitcnt vmcnt(23) lgkmcnt(3)
  s_barrier
  ds_read_b64_tr_b16 a[54:55], v199 offset:51200
  v_mfma_f32_16x16x32_bf16 v[20:23], a[40:43], a[0:3], v[20:23]
  ds_read_b64_tr_b16 a[56:57], v198 offset:43008
  v_mul_u32_u24 v13, 7168, v13
  v_mfma_f32_16x16x32_bf16 v[24:27], a[40:43], a[4:7], v[24:27]
  v_lshl_add_u32 v12, v12, 4, v13
  v_add_u32 v4, s48, v12
  v_mfma_f32_16x16x32_bf16 v[28:31], a[40:43], a[8:11], v[28:31]
  buffer_load_dword v206, s[36:39], s62 offen sc1 lds
  s_mov_b32 s61, 4325376
  v_mfma_f32_16x16x32_bf16 v[32:35], a[40:43], a[12:15], v[32:35]
  s_add_u32 m0, s63, 86016
  ds_read_b64_tr_b16 a[58:59], v198 offset:49152
  v_mfma_f32_16x16x32_bf16 v[116:119], a[40:43], a[16:19], v[116:119]
  s_sub_u32 s48, s48, 1024
  ds_read_b64_tr_b16 a[60:61], v199 offset:43008
  v_mfma_f32_16x16x32_bf16 v[48:51], a[44:47], a[12:15], v[48:51]
  v_add_u32 v12, 128, v10
  v_mul_u32_u24 v13, 4682, v12
  v_mfma_f32_16x16x32_bf16 v[44:47], a[44:47], a[8:11], v[44:47]
  buffer_load_dwordx4 v202, s[8:11], s61 offen offset:0 lds
  v_lshrrev_b32 v13, 16, v13
  v_mfma_f32_16x16x32_bf16 v[40:43], a[44:47], a[4:7], v[40:43]
  ds_read_b64_tr_b16 a[62:63], v199 offset:49152
  v_mul_i32_i24 v14, -14, v13
  v_mfma_f32_16x16x32_bf16 v[36:39], a[44:47], a[0:3], v[36:39]
  s_waitcnt lgkmcnt(4)
  ds_read_b64_tr_b16 a[64:65], v200 offset:1024
  v_add3_u32 v12, v12, v14, s49
  v_mfma_f32_16x16x32_bf16 v[52:55], a[0:3], a[48:51], v[52:55]
  ds_read_b128 a[20:23], v209 offset:12288
  v_mfma_f32_16x16x32_bf16 v[56:59], a[4:7], a[48:51], v[56:59]
  buffer_load_dwordx4 v203, s[8:11], s61 offen offset:1024 lds
  v_mfma_f32_16x16x32_bf16 v[60:63], a[8:11], a[48:51], v[60:63]
  ds_read_b64_tr_b16 a[66:67], v200 offset:7168
  v_mfma_f32_16x16x32_bf16 v[64:67], a[12:15], a[48:51], v[64:67]
  ds_read_b128 a[24:27], v209 offset:13312
  v_mfma_f32_16x16x32_bf16 v[120:123], a[16:19], a[48:51], v[120:123]
  ds_read_b64_tr_b16 a[68:69], v201 offset:1024
  v_add_u32 v14, -14, v12
  v_mfma_f32_16x16x32_bf16 v[80:83], a[12:15], a[52:55], v[80:83]
  buffer_load_dwordx4 v204, s[8:11], s61 offen offset:2048 lds
  s_mov_b32 s62, 45056
  v_mfma_f32_16x16x32_bf16 v[76:79], a[8:11], a[52:55], v[76:79]
  s_add_u32 m0, s64, 98304
  ds_read_b128 a[28:31], v209 offset:14336
  v_min_u32 v12, v12, v14
  v_mfma_f32_16x16x32_bf16 v[72:75], a[4:7], a[52:55], v[72:75]
  ds_read_b64_tr_b16 a[70:71], v201 offset:7168
  v_mul_u32_u24 v13, 7168, v13
  v_mfma_f32_16x16x32_bf16 v[68:71], a[0:3], a[52:55], v[68:71]
  s_waitcnt lgkmcnt(7)
  ds_read_b128 a[32:35], v209 offset:15360
  v_lshl_add_u32 v12, v12, 4, v13
  v_mfma_f32_16x16x32_bf16 v[84:87], a[56:59], a[0:3], v[84:87]
  buffer_load_dwordx4 v205, s[36:39], s62 offen offset:0 sc1 lds
  v_add_u32 v5, s48, v12
  v_mfma_f32_16x16x32_bf16 v[88:91], a[56:59], a[4:7], v[88:91]
  ds_read_b128 a[36:39], v212 offset:20480
  v_mfma_f32_16x16x32_bf16 v[92:95], a[56:59], a[8:11], v[92:95]
  ds_read_b64_tr_b16 a[40:41], v200 offset:2048
  v_mfma_f32_16x16x32_bf16 v[96:99], a[56:59], a[12:15], v[96:99]
  s_sub_u32 s48, s48, 1024
  ds_read_b64_tr_b16 a[42:43], v200 offset:8192
  v_mfma_f32_16x16x32_bf16 v[112:115], a[60:63], a[12:15], v[112:115]
  buffer_load_dwordx4 v205, s[36:39], s62 offen offset:1024 sc1 lds
  s_add_u32 m0, s65, 106496
  v_mfma_f32_16x16x32_bf16 v[108:111], a[60:63], a[8:11], v[108:111]
  ds_read_b64_tr_b16 a[44:45], v201 offset:2048
  v_add_u32 v12, 192, v10
  v_mfma_f32_16x16x32_bf16 v[104:107], a[60:63], a[4:7], v[104:107]
  ds_read_b64_tr_b16 a[46:47], v201 offset:8192
  v_mul_u32_u24 v13, 4682, v12
  v_mfma_f32_16x16x32_bf16 v[100:103], a[60:63], a[0:3], v[100:103]
  s_waitcnt vmcnt(23) lgkmcnt(4)
  s_barrier
  v_lshrrev_b32 v13, 16, v13
  v_mfma_f32_16x16x32_bf16 v[20:23], a[64:67], a[20:23], v[20:23]
  buffer_load_dword v206, s[36:39], s62 offen sc1 lds
  s_mov_b32 s61, 4521984
  v_mfma_f32_16x16x32_bf16 v[24:27], a[64:67], a[24:27], v[24:27]
  s_add_u32 m0, s63, 107520
  ds_read_b64_tr_b16 a[48:49], v200 offset:0
  v_mul_i32_i24 v14, -14, v13
  v_mfma_f32_16x16x32_bf16 v[28:31], a[64:67], a[28:31], v[28:31]
  ds_read_b64_tr_b16 a[50:51], v200 offset:6144
  v_add3_u32 v12, v12, v14, s49
  v_mfma_f32_16x16x32_bf16 v[32:35], a[64:67], a[32:35], v[32:35]
  v_mfma_f32_16x16x32_bf16 v[116:119], a[64:67], a[36:39], v[116:119]
  buffer_load_dwordx4 v202, s[8:11], s61 offen offset:0 lds
  v_mfma_f32_16x16x32_bf16 v[48:51], a[68:71], a[32:35], v[48:51]
  ds_read_b64_tr_b16 a[52:53], v201 offset:0
  v_add_u32 v14, -14, v12
  v_mfma_f32_16x16x32_bf16 v[44:47], a[68:71], a[28:31], v[44:47]
  ds_read_b64_tr_b16 a[54:55], v201 offset:6144
  v_min_u32 v12, v12, v14
  v_mfma_f32_16x16x32_bf16 v[40:43], a[68:71], a[24:27], v[40:43]
  v_mul_u32_u24 v13, 7168, v13
  v_lshl_add_u32 v12, v12, 4, v13
  v_mfma_f32_16x16x32_bf16 v[36:39], a[68:71], a[20:23], v[36:39]
  s_waitcnt lgkmcnt(4)
  buffer_load_dwordx4 v203, s[8:11], s61 offen offset:1024 lds
  v_add_u32 v6, s48, v12
  v_mfma_f32_16x16x32_bf16 v[52:55], a[20:23], a[40:43], v[52:55]
  ds_read_b64_tr_b16 a[56:57], v196 offset:1024
  v_mfma_f32_16x16x32_bf16 v[56:59], a[24:27], a[40:43], v[56:59]
  ds_read_b128 a[0:3], v207 offset:12288
  v_mfma_f32_16x16x32_bf16 v[60:63], a[28:31], a[40:43], v[60:63]
  ds_read_b64_tr_b16 a[58:59], v196 offset:7168
  v_mfma_f32_16x16x32_bf16 v[64:67], a[32:35], a[40:43], v[64:67]
  buffer_load_dwordx4 v204, s[8:11], s61 offen offset:2048 lds
  s_mov_b32 s62, 47104
  v_mfma_f32_16x16x32_bf16 v[120:123], a[36:39], a[40:43], v[120:123]
  s_add_u32 m0, s64, 119808
  ds_read_b128 a[4:7], v207 offset:13312
  s_sub_u32 s48, s48, -3072
  v_mfma_f32_16x16x32_bf16 v[80:83], a[32:35], a[44:47], v[80:83]
  ds_read_b64_tr_b16 a[60:61], v197 offset:1024
  v_add_u32 v12, 256, v10
  v_mfma_f32_16x16x32_bf16 v[76:79], a[28:31], a[44:47], v[76:79]
  ds_read_b128 a[8:11], v207 offset:14336
  v_mul_u32_u24 v13, 4682, v12
  v_mfma_f32_16x16x32_bf16 v[72:75], a[24:27], a[44:47], v[72:75]
  buffer_load_dwordx4 v205, s[36:39], s62 offen offset:0 sc1 lds
  v_lshrrev_b32 v13, 16, v13
  v_mfma_f32_16x16x32_bf16 v[68:71], a[20:23], a[44:47], v[68:71]
  s_waitcnt lgkmcnt(6)
  ds_read_b64_tr_b16 a[62:63], v197 offset:7168
  v_mul_i32_i24 v14, -14, v13
  v_mfma_f32_16x16x32_bf16 v[84:87], a[48:51], a[20:23], v[84:87]
  ds_read_b128 a[12:15], v207 offset:15360
  v_add3_u32 v12, v12, v14, s49
  v_mfma_f32_16x16x32_bf16 v[88:91], a[48:51], a[24:27], v[88:91]
  ds_read_b128 a[16:19], v210 offset:20480
  v_mfma_f32_16x16x32_bf16 v[92:95], a[48:51], a[28:31], v[92:95]
  ds_read_b64_tr_b16 a[64:65], v196 offset:2048
  v_mfma_f32_16x16x32_bf16 v[96:99], a[48:51], a[32:35], v[96:99]
  buffer_load_dwordx4 v205, s[36:39], s62 offen offset:1024 sc1 lds
  s_add_u32 m0, s65, 128000
  v_mfma_f32_16x16x32_bf16 v[112:115], a[52:55], a[32:35], v[112:115]
  ds_read_b64_tr_b16 a[66:67], v196 offset:8192
  v_add_u32 v14, -14, v12
  v_mfma_f32_16x16x32_bf16 v[108:111], a[52:55], a[28:31], v[108:111]
  ds_read_b64_tr_b16 a[68:69], v197 offset:2048
  v_min_u32 v12, v12, v14
  v_mfma_f32_16x16x32_bf16 v[104:107], a[52:55], a[24:27], v[104:107]
  ds_read_b64_tr_b16 a[70:71], v197 offset:8192
  v_mul_u32_u24 v13, 7168, v13
  v_mfma_f32_16x16x32_bf16 v[100:103], a[52:55], a[20:23], v[100:103]
  s_waitcnt vmcnt(23) lgkmcnt(4)
  s_barrier
  buffer_load_dword v206, s[36:39], s62 offen sc1 lds
  v_mfma_f32_16x16x32_bf16 v[20:23], a[56:59], a[0:3], v[20:23]
  s_mov_b32 s61, 4718592
  s_add_u32 m0, s63, 129024
  ds_read_b64_tr_b16 a[40:41], v196 offset:0
  v_mfma_f32_16x16x32_bf16 v[24:27], a[56:59], a[4:7], v[24:27]
  v_lshl_add_u32 v12, v12, 4, v13
  v_add_u32 v7, s48, v12
  v_mfma_f32_16x16x32_bf16 v[28:31], a[56:59], a[8:11], v[28:31]
  ds_read_b64_tr_b16 a[42:43], v196 offset:6144
  v_mfma_f32_16x16x32_bf16 v[32:35], a[56:59], a[12:15], v[32:35]
  buffer_load_dwordx4 v202, s[8:11], s61 offen offset:0 lds
  v_mfma_f32_16x16x32_bf16 v[116:119], a[56:59], a[16:19], v[116:119]
  s_sub_u32 s48, s48, 1024
  ds_read_b64_tr_b16 a[44:45], v197 offset:0
  v_mfma_f32_16x16x32_bf16 v[48:51], a[60:63], a[12:15], v[48:51]
  v_mfma_f32_16x16x32_bf16 v[44:47], a[60:63], a[8:11], v[44:47]
  ds_read_b64_tr_b16 a[46:47], v197 offset:6144
  v_add_u32 v12, 320, v10
  v_mfma_f32_16x16x32_bf16 v[40:43], a[60:63], a[4:7], v[40:43]
  buffer_load_dwordx4 v203, s[8:11], s61 offen offset:1024 lds
  v_mul_u32_u24 v13, 4682, v12
  v_mfma_f32_16x16x32_bf16 v[36:39], a[60:63], a[0:3], v[36:39]
  s_waitcnt lgkmcnt(4)
  ds_read_b64_tr_b16 a[48:49], v196 offset:22528
  v_lshrrev_b32 v13, 16, v13
  v_mfma_f32_16x16x32_bf16 v[52:55], a[0:3], a[64:67], v[52:55]
  ds_read_b128 a[20:23], v207 offset:33792
  v_mul_i32_i24 v14, -14, v13
  v_mfma_f32_16x16x32_bf16 v[56:59], a[4:7], a[64:67], v[56:59]
  ds_read_b64_tr_b16 a[50:51], v196 offset:28672
  v_add3_u32 v12, v12, v14, s49
  v_mfma_f32_16x16x32_bf16 v[60:63], a[8:11], a[64:67], v[60:63]
  buffer_load_dwordx4 v204, s[8:11], s61 offen offset:2048 lds
  s_mov_b32 s62, 49152
  v_mfma_f32_16x16x32_bf16 v[64:67], a[12:15], a[64:67], v[64:67]
  s_add_u32 m0, s64, 141312
  ds_read_b128 a[24:27], v207 offset:34816
  v_mfma_f32_16x16x32_bf16 v[120:123], a[16:19], a[64:67], v[120:123]
  ds_read_b64_tr_b16 a[52:53], v197 offset:22528
  v_mfma_f32_16x16x32_bf16 v[80:83], a[12:15], a[68:71], v[80:83]
  ds_read_b128 a[28:31], v207 offset:35840
  v_add_u32 v14, -14, v12
  v_mfma_f32_16x16x32_bf16 v[76:79], a[8:11], a[68:71], v[76:79]
  buffer_load_dwordx4 v205, s[36:39], s62 offen offset:0 sc1 lds
  v_min_u32 v12, v12, v14
  v_mfma_f32_16x16x32_bf16 v[72:75], a[4:7], a[68:71], v[72:75]
  ds_read_b64_tr_b16 a[54:55], v197 offset:28672
  v_mul_u32_u24 v13, 7168, v13
  v_mfma_f32_16x16x32_bf16 v[68:71], a[0:3], a[68:71], v[68:71]
  s_waitcnt lgkmcnt(7)
  ds_read_b128 a[32:35], v207 offset:36864
  v_lshl_add_u32 v12, v12, 4, v13
  v_mfma_f32_16x16x32_bf16 v[84:87], a[40:43], a[0:3], v[84:87]
  ds_read_b128 a[36:39], v210 offset:41984
  v_add_u32 v8, s48, v12
  v_mfma_f32_16x16x32_bf16 v[88:91], a[40:43], a[4:7], v[88:91]
  ds_read_b64_tr_b16 a[56:57], v196 offset:23552
  v_mfma_f32_16x16x32_bf16 v[92:95], a[40:43], a[8:11], v[92:95]
  buffer_load_dwordx4 v205, s[36:39], s62 offen offset:1024 sc1 lds
  s_add_u32 m0, s65, 149504
  v_mfma_f32_16x16x32_bf16 v[96:99], a[40:43], a[12:15], v[96:99]
  ds_read_b64_tr_b16 a[58:59], v196 offset:29696
  v_mfma_f32_16x16x32_bf16 v[112:115], a[44:47], a[12:15], v[112:115]
  s_sub_u32 s48, s48, 1024
  ds_read_b64_tr_b16 a[60:61], v197 offset:23552
  v_mfma_f32_16x16x32_bf16 v[108:111], a[44:47], a[8:11], v[108:111]
  v_mfma_f32_16x16x32_bf16 v[104:107], a[44:47], a[4:7], v[104:107]
  buffer_load_dword v206, s[36:39], s62 offen sc1 lds
  s_mov_b32 s61, 4915200
  v_mfma_f32_16x16x32_bf16 v[100:103], a[44:47], a[0:3], v[100:103]
  s_waitcnt vmcnt(24) lgkmcnt(3)
  s_barrier
  s_add_u32 m0, s63, 0
  v_mfma_f32_16x16x32_bf16 v[20:23], a[48:51], a[20:23], v[20:23]
  ds_read_b64_tr_b16 a[62:63], v197 offset:29696
  v_add_u32 v12, 384, v10
  v_mfma_f32_16x16x32_bf16 v[24:27], a[48:51], a[24:27], v[24:27]
  ds_read_b64_tr_b16 a[64:65], v196 offset:21504
  v_mul_u32_u24 v13, 4682, v12
  v_mfma_f32_16x16x32_bf16 v[28:31], a[48:51], a[28:31], v[28:31]
  buffer_load_dwordx4 v202, s[8:11], s61 offen offset:0 lds
  v_lshrrev_b32 v13, 16, v13
  v_mfma_f32_16x16x32_bf16 v[32:35], a[48:51], a[32:35], v[32:35]
  ds_read_b64_tr_b16 a[66:67], v196 offset:27648
  v_mul_i32_i24 v14, -14, v13
  v_mfma_f32_16x16x32_bf16 v[116:119], a[48:51], a[36:39], v[116:119]
  ds_read_b64_tr_b16 a[68:69], v197 offset:21504
  v_add3_u32 v12, v12, v14, s49
  v_mfma_f32_16x16x32_bf16 v[48:51], a[52:55], a[32:35], v[48:51]
  v_mfma_f32_16x16x32_bf16 v[44:47], a[52:55], a[28:31], v[44:47]
  buffer_load_dwordx4 v203, s[8:11], s61 offen offset:1024 lds
  v_add_u32 v14, -14, v12
  v_mfma_f32_16x16x32_bf16 v[40:43], a[52:55], a[24:27], v[40:43]
  ds_read_b64_tr_b16 a[70:71], v197 offset:27648
  v_min_u32 v12, v12, v14
  v_mfma_f32_16x16x32_bf16 v[36:39], a[52:55], a[20:23], v[36:39]
  s_waitcnt lgkmcnt(4)
  ds_read_b64_tr_b16 a[40:41], v196 offset:44032
  v_mul_u32_u24 v13, 7168, v13
  v_mfma_f32_16x16x32_bf16 v[52:55], a[20:23], a[56:59], v[52:55]
  ds_read_b128 a[0:3], v207 offset:55296
  v_lshl_add_u32 v12, v12, 4, v13
  v_mfma_f32_16x16x32_bf16 v[56:59], a[24:27], a[56:59], v[56:59]
  buffer_load_dwordx4 v204, s[8:11], s61 offen offset:2048 lds
  v_add_u32 v9, s48, v12
  v_mfma_f32_16x16x32_bf16 v[60:63], a[28:31], a[56:59], v[60:63]
  s_mov_b32 s62, 51200
  ds_read_b64_tr_b16 a[42:43], v196 offset:50176
  s_add_u32 m0, s64, 12288
  v_mfma_f32_16x16x32_bf16 v[64:67], a[32:35], a[56:59], v[64:67]
  ds_read_b128 a[4:7], v207 offset:56320
  v_mfma_f32_16x16x32_bf16 v[120:123], a[36:39], a[56:59], v[120:123]
  ds_read_b64_tr_b16 a[44:45], v197 offset:44032
  v_mfma_f32_16x16x32_bf16 v[80:83], a[32:35], a[60:63], v[80:83]
  s_sub_u32 s48, s48, 1024
  ds_read_b128 a[8:11], v207 offset:57344
  v_mfma_f32_16x16x32_bf16 v[76:79], a[28:31], a[60:63], v[76:79]
  s_and_b32 s48, s58, 1
  buffer_load_dwordx4 v205, s[36:39], s62 offen offset:0 sc1 lds
  s_lshl_b32 s48, s48, 7
  v_mfma_f32_16x16x32_bf16 v[72:75], a[24:27], a[60:63], v[72:75]
  s_and_b32 s49, s58, 6
  ds_read_b64_tr_b16 a[46:47], v197 offset:50176
  s_add_u32 s48, s48, s49
  v_mfma_f32_16x16x32_bf16 v[68:71], a[20:23], a[60:63], v[68:71]
  s_waitcnt lgkmcnt(7)
  ds_read_b128 a[12:15], v207 offset:58368
  v_mfma_f32_16x16x32_bf16 v[84:87], a[64:67], a[20:23], v[84:87]
  ds_read_b128 a[16:19], v210 offset:63488
  v_mfma_f32_16x16x32_bf16 v[88:91], a[64:67], a[24:27], v[88:91]
  ds_read_b64_tr_b16 a[48:49], v196 offset:45056
  v_mfma_f32_16x16x32_bf16 v[92:95], a[64:67], a[28:31], v[92:95]
  buffer_load_dwordx4 v205, s[36:39], s62 offen offset:1024 sc1 lds
  s_add_u32 m0, s65, 20480
  v_mfma_f32_16x16x32_bf16 v[96:99], a[64:67], a[32:35], v[96:99]
  ds_read_b64_tr_b16 a[50:51], v196 offset:51200
  v_mfma_f32_16x16x32_bf16 v[112:115], a[68:71], a[32:35], v[112:115]
  ds_read_b64_tr_b16 a[52:53], v197 offset:45056
  v_bfe_u32 v12, v10, 1, 4
  v_mfma_f32_16x16x32_bf16 v[108:111], a[68:71], a[28:31], v[108:111]
  v_and_b32 v13, 1, v10
  v_lshl_add_u32 v12, v12, 3, v13
  v_mfma_f32_16x16x32_bf16 v[104:107], a[68:71], a[24:27], v[104:107]
  buffer_load_dword v206, s[36:39], s62 offen sc1 lds
  s_mov_b32 s61, 5111808
  v_mfma_f32_16x16x32_bf16 v[100:103], a[68:71], a[20:23], v[100:103]
  s_waitcnt vmcnt(24) lgkmcnt(3)
  s_barrier
  s_add_u32 m0, s63, 21504
  v_mfma_f32_16x16x32_bf16 v[20:23], a[40:43], a[0:3], v[20:23]
  ds_read_b64_tr_b16 a[54:55], v197 offset:51200
  v_add_lshl_u32 v250, v12, s48, 7
  v_mfma_f32_16x16x32_bf16 v[24:27], a[40:43], a[4:7], v[24:27]
  ds_read_b64_tr_b16 a[56:57], v196 offset:43008
  v_mfma_f32_16x16x32_bf16 v[28:31], a[40:43], a[8:11], v[28:31]
  buffer_load_dwordx4 v202, s[8:11], s61 offen offset:0 lds
  v_add_u32 v250, 98304, v250
  v_mfma_f32_16x16x32_bf16 v[32:35], a[40:43], a[12:15], v[32:35]
  ds_read_b64_tr_b16 a[58:59], v196 offset:49152
  v_and_b32 v12, 7, v10
  v_mfma_f32_16x16x32_bf16 v[116:119], a[40:43], a[16:19], v[116:119]
  ds_read_b64_tr_b16 a[60:61], v197 offset:43008
  v_lshlrev_b32 v12, 5, v12
  v_mfma_f32_16x16x32_bf16 v[48:51], a[44:47], a[12:15], v[48:51]
  s_and_b32 s48, s2, 31
  v_add_lshl_u32 v12, v12, s48, 7
  v_cmp_gt_u32 vcc, 32, v10
  v_mfma_f32_16x16x32_bf16 v[44:47], a[44:47], a[8:11], v[44:47]
  s_nop 1
  buffer_load_dwordx4 v203, s[8:11], s61 offen offset:1024 lds
  v_cndmask_b32 v250, v12, v250, vcc
  v_mfma_f32_16x16x32_bf16 v[40:43], a[44:47], a[4:7], v[40:43]
  ds_read_b64_tr_b16 a[62:63], v197 offset:49152
  v_mfma_f32_16x16x32_bf16 v[36:39], a[44:47], a[0:3], v[36:39]
  s_waitcnt lgkmcnt(4)
  ds_read_b64_tr_b16 a[64:65], v198 offset:1024
  v_mfma_f32_16x16x32_bf16 v[52:55], a[0:3], a[48:51], v[52:55]
  ds_read_b128 a[20:23], v208 offset:12288
  v_mfma_f32_16x16x32_bf16 v[56:59], a[4:7], a[48:51], v[56:59]
  buffer_load_dwordx4 v204, s[8:11], s61 offen offset:2048 lds
  v_mfma_f32_16x16x32_bf16 v[60:63], a[8:11], a[48:51], v[60:63]
  s_mov_b32 s62, 53248
  ds_read_b64_tr_b16 a[66:67], v198 offset:7168
  s_add_u32 m0, s64, 33792
  v_mfma_f32_16x16x32_bf16 v[64:67], a[12:15], a[48:51], v[64:67]
  ds_read_b128 a[24:27], v208 offset:13312
  v_mfma_f32_16x16x32_bf16 v[120:123], a[16:19], a[48:51], v[120:123]
  ds_read_b64_tr_b16 a[68:69], v199 offset:1024
  v_mfma_f32_16x16x32_bf16 v[80:83], a[12:15], a[52:55], v[80:83]
  ds_read_b128 a[28:31], v208 offset:14336
  v_mfma_f32_16x16x32_bf16 v[76:79], a[8:11], a[52:55], v[76:79]
  buffer_load_dwordx4 v205, s[36:39], s62 offen offset:0 sc1 lds
  v_mfma_f32_16x16x32_bf16 v[72:75], a[4:7], a[52:55], v[72:75]
  ds_read_b64_tr_b16 a[70:71], v199 offset:7168
  v_mfma_f32_16x16x32_bf16 v[68:71], a[0:3], a[52:55], v[68:71]
  s_waitcnt lgkmcnt(7)
  ds_read_b128 a[32:35], v208 offset:15360
  v_mfma_f32_16x16x32_bf16 v[84:87], a[56:59], a[0:3], v[84:87]
  ds_read_b128 a[36:39], v211 offset:20480
  v_mfma_f32_16x16x32_bf16 v[88:91], a[56:59], a[4:7], v[88:91]
  ds_read_b64_tr_b16 a[40:41], v198 offset:2048
  v_mfma_f32_16x16x32_bf16 v[92:95], a[56:59], a[8:11], v[92:95]
  buffer_load_dwordx4 v205, s[36:39], s62 offen offset:1024 sc1 lds
  s_add_u32 m0, s65, 41984
  v_mfma_f32_16x16x32_bf16 v[96:99], a[56:59], a[12:15], v[96:99]
  ds_read_b64_tr_b16 a[42:43], v198 offset:8192
  v_mfma_f32_16x16x32_bf16 v[112:115], a[60:63], a[12:15], v[112:115]
  ds_read_b64_tr_b16 a[44:45], v199 offset:2048
  v_mfma_f32_16x16x32_bf16 v[108:111], a[60:63], a[8:11], v[108:111]
  v_mfma_f32_16x16x32_bf16 v[104:107], a[60:63], a[4:7], v[104:107]
  buffer_load_dword v206, s[36:39], s62 offen sc1 lds
  s_mov_b32 s61, 5308416
  v_mfma_f32_16x16x32_bf16 v[100:103], a[60:63], a[0:3], v[100:103]
  s_waitcnt vmcnt(24) lgkmcnt(3)
  s_barrier
  s_add_u32 m0, s63, 43008
  v_mfma_f32_16x16x32_bf16 v[20:23], a[64:67], a[20:23], v[20:23]
  ds_read_b64_tr_b16 a[46:47], v199 offset:8192
  v_mfma_f32_16x16x32_bf16 v[24:27], a[64:67], a[24:27], v[24:27]
  ds_read_b64_tr_b16 a[48:49], v198 offset:0
  v_mfma_f32_16x16x32_bf16 v[28:31], a[64:67], a[28:31], v[28:31]
  buffer_load_dwordx4 v202, s[8:11], s61 offen offset:0 lds
  v_mfma_f32_16x16x32_bf16 v[32:35], a[64:67], a[32:35], v[32:35]
  ds_read_b64_tr_b16 a[50:51], v198 offset:6144
  v_mfma_f32_16x16x32_bf16 v[116:119], a[64:67], a[36:39], v[116:119]
  ds_read_b64_tr_b16 a[52:53], v199 offset:0
  v_mfma_f32_16x16x32_bf16 v[48:51], a[68:71], a[32:35], v[48:51]
  v_mfma_f32_16x16x32_bf16 v[44:47], a[68:71], a[28:31], v[44:47]
  buffer_load_dwordx4 v203, s[8:11], s61 offen offset:1024 lds
  v_mfma_f32_16x16x32_bf16 v[40:43], a[68:71], a[24:27], v[40:43]
  ds_read_b64_tr_b16 a[54:55], v199 offset:6144
  v_mfma_f32_16x16x32_bf16 v[36:39], a[68:71], a[20:23], v[36:39]
  s_waitcnt lgkmcnt(4)
  ds_read_b64_tr_b16 a[56:57], v198 offset:22528
  v_mfma_f32_16x16x32_bf16 v[52:55], a[20:23], a[40:43], v[52:55]
  ds_read_b128 a[0:3], v208 offset:33792
  v_mfma_f32_16x16x32_bf16 v[56:59], a[24:27], a[40:43], v[56:59]
  buffer_load_dwordx4 v204, s[8:11], s61 offen offset:2048 lds
  v_mfma_f32_16x16x32_bf16 v[60:63], a[28:31], a[40:43], v[60:63]
  s_mov_b32 s62, 55296
  ds_read_b64_tr_b16 a[58:59], v198 offset:28672
  s_add_u32 m0, s64, 55296
  v_mfma_f32_16x16x32_bf16 v[64:67], a[32:35], a[40:43], v[64:67]
  ds_read_b128 a[4:7], v208 offset:34816
  v_mfma_f32_16x16x32_bf16 v[120:123], a[36:39], a[40:43], v[120:123]
  ds_read_b64_tr_b16 a[60:61], v199 offset:22528
  v_mfma_f32_16x16x32_bf16 v[80:83], a[32:35], a[44:47], v[80:83]
  ds_read_b128 a[8:11], v208 offset:35840
  v_mfma_f32_16x16x32_bf16 v[76:79], a[28:31], a[44:47], v[76:79]
  buffer_load_dwordx4 v205, s[36:39], s62 offen offset:0 sc1 lds
  v_mfma_f32_16x16x32_bf16 v[72:75], a[24:27], a[44:47], v[72:75]
  ds_read_b64_tr_b16 a[62:63], v199 offset:28672
  v_mfma_f32_16x16x32_bf16 v[68:71], a[20:23], a[44:47], v[68:71]
  s_waitcnt lgkmcnt(7)
  ds_read_b128 a[12:15], v208 offset:36864
  v_mfma_f32_16x16x32_bf16 v[84:87], a[48:51], a[20:23], v[84:87]
  ds_read_b128 a[16:19], v211 offset:41984
  v_mfma_f32_16x16x32_bf16 v[88:91], a[48:51], a[24:27], v[88:91]
  ds_read_b64_tr_b16 a[64:65], v198 offset:23552
  v_mfma_f32_16x16x32_bf16 v[92:95], a[48:51], a[28:31], v[92:95]
  buffer_load_dwordx4 v205, s[36:39], s62 offen offset:1024 sc1 lds
  s_add_u32 m0, s65, 63488
  v_mfma_f32_16x16x32_bf16 v[96:99], a[48:51], a[32:35], v[96:99]
  ds_read_b64_tr_b16 a[66:67], v198 offset:29696
  v_mfma_f32_16x16x32_bf16 v[112:115], a[52:55], a[32:35], v[112:115]
  ds_read_b64_tr_b16 a[68:69], v199 offset:23552
  v_mfma_f32_16x16x32_bf16 v[108:111], a[52:55], a[28:31], v[108:111]
  v_mfma_f32_16x16x32_bf16 v[104:107], a[52:55], a[24:27], v[104:107]
  buffer_load_dword v206, s[36:39], s62 offen sc1 lds
  s_mov_b32 s61, 5505024
  v_mfma_f32_16x16x32_bf16 v[100:103], a[52:55], a[20:23], v[100:103]
  s_waitcnt vmcnt(24) lgkmcnt(3)
  s_barrier
  s_add_u32 m0, s63, 64512
  v_mfma_f32_16x16x32_bf16 v[20:23], a[56:59], a[0:3], v[20:23]
  ds_read_b64_tr_b16 a[70:71], v199 offset:29696
  v_mfma_f32_16x16x32_bf16 v[24:27], a[56:59], a[4:7], v[24:27]
  ds_read_b64_tr_b16 a[40:41], v198 offset:21504
  v_mfma_f32_16x16x32_bf16 v[28:31], a[56:59], a[8:11], v[28:31]
  buffer_load_dwordx4 v202, s[8:11], s61 offen offset:0 lds
  v_mfma_f32_16x16x32_bf16 v[32:35], a[56:59], a[12:15], v[32:35]
  ds_read_b64_tr_b16 a[42:43], v198 offset:27648
  v_mfma_f32_16x16x32_bf16 v[116:119], a[56:59], a[16:19], v[116:119]
  ds_read_b64_tr_b16 a[44:45], v199 offset:21504
  v_mfma_f32_16x16x32_bf16 v[48:51], a[60:63], a[12:15], v[48:51]
  v_mfma_f32_16x16x32_bf16 v[44:47], a[60:63], a[8:11], v[44:47]
  buffer_load_dwordx4 v203, s[8:11], s61 offen offset:1024 lds
  v_mfma_f32_16x16x32_bf16 v[40:43], a[60:63], a[4:7], v[40:43]
  ds_read_b64_tr_b16 a[46:47], v199 offset:27648
  v_mfma_f32_16x16x32_bf16 v[36:39], a[60:63], a[0:3], v[36:39]
  s_waitcnt lgkmcnt(4)
  ds_read_b64_tr_b16 a[48:49], v198 offset:44032
  v_mfma_f32_16x16x32_bf16 v[52:55], a[0:3], a[64:67], v[52:55]
  ds_read_b128 a[20:23], v208 offset:55296
  v_mfma_f32_16x16x32_bf16 v[56:59], a[4:7], a[64:67], v[56:59]
  buffer_load_dwordx4 v204, s[8:11], s61 offen offset:2048 lds
  v_mfma_f32_16x16x32_bf16 v[60:63], a[8:11], a[64:67], v[60:63]
  s_mov_b32 s62, 57344
  ds_read_b64_tr_b16 a[50:51], v198 offset:50176
  s_add_u32 m0, s64, 76800
  v_mfma_f32_16x16x32_bf16 v[64:67], a[12:15], a[64:67], v[64:67]
  ds_read_b128 a[24:27], v208 offset:56320
  v_mfma_f32_16x16x32_bf16 v[120:123], a[16:19], a[64:67], v[120:123]
  ds_read_b64_tr_b16 a[52:53], v199 offset:44032
  v_mfma_f32_16x16x32_bf16 v[80:83], a[12:15], a[68:71], v[80:83]
  ds_read_b128 a[28:31], v208 offset:57344
  v_mfma_f32_16x16x32_bf16 v[76:79], a[8:11], a[68:71], v[76:79]
  buffer_load_dwordx4 v205, s[36:39], s62 offen offset:0 sc1 lds
  v_mfma_f32_16x16x32_bf16 v[72:75], a[4:7], a[68:71], v[72:75]
  ds_read_b64_tr_b16 a[54:55], v199 offset:50176
  v_mfma_f32_16x16x32_bf16 v[68:71], a[0:3], a[68:71], v[68:71]
  s_waitcnt lgkmcnt(7)
  ds_read_b128 a[32:35], v208 offset:58368
  v_mfma_f32_16x16x32_bf16 v[84:87], a[40:43], a[0:3], v[84:87]
  ds_read_b128 a[36:39], v211 offset:63488
  v_mfma_f32_16x16x32_bf16 v[88:91], a[40:43], a[4:7], v[88:91]
  ds_read_b64_tr_b16 a[56:57], v198 offset:45056
  v_mfma_f32_16x16x32_bf16 v[92:95], a[40:43], a[8:11], v[92:95]
  buffer_load_dwordx4 v205, s[36:39], s62 offen offset:1024 sc1 lds
  s_add_u32 m0, s65, 84992
  v_mfma_f32_16x16x32_bf16 v[96:99], a[40:43], a[12:15], v[96:99]
  ds_read_b64_tr_b16 a[58:59], v198 offset:51200
  v_mfma_f32_16x16x32_bf16 v[112:115], a[44:47], a[12:15], v[112:115]
  ds_read_b64_tr_b16 a[60:61], v199 offset:45056
  v_mfma_f32_16x16x32_bf16 v[108:111], a[44:47], a[8:11], v[108:111]
  v_mfma_f32_16x16x32_bf16 v[104:107], a[44:47], a[4:7], v[104:107]
  buffer_load_dword v206, s[36:39], s62 offen sc1 lds
  s_mov_b32 s61, 5701632
  v_mfma_f32_16x16x32_bf16 v[100:103], a[44:47], a[0:3], v[100:103]
  s_waitcnt vmcnt(24) lgkmcnt(3)
  s_barrier
  s_add_u32 m0, s63, 86016
  v_mfma_f32_16x16x32_bf16 v[20:23], a[48:51], a[20:23], v[20:23]
  ds_read_b64_tr_b16 a[62:63], v199 offset:51200
  v_mfma_f32_16x16x32_bf16 v[24:27], a[48:51], a[24:27], v[24:27]
  ds_read_b64_tr_b16 a[64:65], v198 offset:43008
  v_mfma_f32_16x16x32_bf16 v[28:31], a[48:51], a[28:31], v[28:31]
  buffer_load_dwordx4 v202, s[8:11], s61 offen offset:0 lds
  v_mfma_f32_16x16x32_bf16 v[32:35], a[48:51], a[32:35], v[32:35]
  ds_read_b64_tr_b16 a[66:67], v198 offset:49152
  v_mfma_f32_16x16x32_bf16 v[116:119], a[48:51], a[36:39], v[116:119]
  ds_read_b64_tr_b16 a[68:69], v199 offset:43008
  v_mfma_f32_16x16x32_bf16 v[48:51], a[52:55], a[32:35], v[48:51]
  v_mfma_f32_16x16x32_bf16 v[44:47], a[52:55], a[28:31], v[44:47]
  buffer_load_dwordx4 v203, s[8:11], s61 offen offset:1024 lds
  v_mfma_f32_16x16x32_bf16 v[40:43], a[52:55], a[24:27], v[40:43]
  ds_read_b64_tr_b16 a[70:71], v199 offset:49152
  v_mfma_f32_16x16x32_bf16 v[36:39], a[52:55], a[20:23], v[36:39]
  s_waitcnt lgkmcnt(4)
  ds_read_b64_tr_b16 a[40:41], v200 offset:1024
  v_mfma_f32_16x16x32_bf16 v[52:55], a[20:23], a[56:59], v[52:55]
Ha0_1:
  s_cbranch_execz Ha0_2
  ds_read_b128 a[0:3], v209 offset:12288
  v_mfma_f32_16x16x32_bf16 v[56:59], a[24:27], a[56:59], v[56:59]
  buffer_load_dwordx4 v204, s[8:11], s61 offen offset:2048 lds
  v_mfma_f32_16x16x32_bf16 v[60:63], a[28:31], a[56:59], v[60:63]
  s_mov_b32 s62, 59392
  ds_read_b64_tr_b16 a[42:43], v200 offset:7168
  s_add_u32 m0, s64, 98304
  v_mfma_f32_16x16x32_bf16 v[64:67], a[32:35], a[56:59], v[64:67]
  ds_read_b128 a[4:7], v209 offset:13312
  v_mfma_f32_16x16x32_bf16 v[120:123], a[36:39], a[56:59], v[120:123]
  ds_read_b64_tr_b16 a[44:45], v201 offset:1024
  v_mfma_f32_16x16x32_bf16 v[80:83], a[32:35], a[60:63], v[80:83]
  ds_read_b128 a[8:11], v209 offset:14336
  v_mfma_f32_16x16x32_bf16 v[76:79], a[28:31], a[60:63], v[76:79]
  buffer_load_dwordx4 v205, s[36:39], s62 offen offset:0 sc1 lds
  v_mfma_f32_16x16x32_bf16 v[72:75], a[24:27], a[60:63], v[72:75]
  ds_read_b64_tr_b16 a[46:47], v201 offset:7168
  v_mfma_f32_16x16x32_bf16 v[68:71], a[20:23], a[60:63], v[68:71]
  s_waitcnt lgkmcnt(7)
  ds_read_b128 a[12:15], v209 offset:15360
  v_mfma_f32_16x16x32_bf16 v[84:87], a[64:67], a[20:23], v[84:87]
  ds_read_b128 a[16:19], v212 offset:20480
  v_mfma_f32_16x16x32_bf16 v[88:91], a[64:67], a[24:27], v[88:91]
  ds_read_b64_tr_b16 a[48:49], v200 offset:2048
  v_mfma_f32_16x16x32_bf16 v[92:95], a[64:67], a[28:31], v[92:95]
  buffer_load_dwordx4 v205, s[36:39], s62 offen offset:1024 sc1 lds
  s_add_u32 m0, s65, 106496
  v_mfma_f32_16x16x32_bf16 v[96:99], a[64:67], a[32:35], v[96:99]
  ds_read_b64_tr_b16 a[50:51], v200 offset:8192
  v_mfma_f32_16x16x32_bf16 v[112:115], a[68:71], a[32:35], v[112:115]
  ds_read_b64_tr_b16 a[52:53], v201 offset:2048
  v_mfma_f32_16x16x32_bf16 v[108:111], a[68:71], a[28:31], v[108:111]
  v_mfma_f32_16x16x32_bf16 v[104:107], a[68:71], a[24:27], v[104:107]
  buffer_load_dword v206, s[36:39], s62 offen sc1 lds
  s_mov_b32 s61, 5898240
  v_mfma_f32_16x16x32_bf16 v[100:103], a[68:71], a[20:23], v[100:103]
  s_waitcnt vmcnt(24) lgkmcnt(3)
  s_barrier
  s_add_u32 m0, s63, 107520
  v_mfma_f32_16x16x32_bf16 v[20:23], a[40:43], a[0:3], v[20:23]
  ds_read_b64_tr_b16 a[54:55], v201 offset:8192
  v_mfma_f32_16x16x32_bf16 v[24:27], a[40:43], a[4:7], v[24:27]
  ds_read_b64_tr_b16 a[56:57], v200 offset:0
  v_mfma_f32_16x16x32_bf16 v[28:31], a[40:43], a[8:11], v[28:31]
  buffer_load_dwordx4 v202, s[8:11], s61 offen offset:0 lds
  v_mfma_f32_16x16x32_bf16 v[32:35], a[40:43], a[12:15], v[32:35]
  ds_read_b64_tr_b16 a[58:59], v200 offset:6144
  v_mfma_f32_16x16x32_bf16 v[116:119], a[40:43], a[16:19], v[116:119]
  ds_read_b64_tr_b16 a[60:61], v201 offset:0
  v_mfma_f32_16x16x32_bf16 v[48:51], a[44:47], a[12:15], v[48:51]
  v_mfma_f32_16x16x32_bf16 v[44:47], a[44:47], a[8:11], v[44:47]
  buffer_load_dwordx4 v203, s[8:11], s61 offen offset:1024 lds
  v_mfma_f32_16x16x32_bf16 v[40:43], a[44:47], a[4:7], v[40:43]
  ds_read_b64_tr_b16 a[62:63], v201 offset:6144
  v_mfma_f32_16x16x32_bf16 v[36:39], a[44:47], a[0:3], v[36:39]
  s_waitcnt lgkmcnt(4)
  ds_read_b64_tr_b16 a[64:65], v196 offset:1024
  v_mfma_f32_16x16x32_bf16 v[52:55], a[0:3], a[48:51], v[52:55]
  ds_read_b128 a[20:23], v207 offset:12288
  v_mfma_f32_16x16x32_bf16 v[56:59], a[4:7], a[48:51], v[56:59]
  buffer_load_dwordx4 v204, s[8:11], s61 offen offset:2048 lds
  v_mfma_f32_16x16x32_bf16 v[60:63], a[8:11], a[48:51], v[60:63]
  s_mov_b32 s62, 61440
  ds_read_b64_tr_b16 a[66:67], v196 offset:7168
  s_add_u32 m0, s64, 119808
  v_mfma_f32_16x16x32_bf16 v[64:67], a[12:15], a[48:51], v[64:67]
  ds_read_b128 a[24:27], v207 offset:13312
  v_mfma_f32_16x16x32_bf16 v[120:123], a[16:19], a[48:51], v[120:123]
  ds_read_b64_tr_b16 a[68:69], v197 offset:1024
  v_mfma_f32_16x16x32_bf16 v[80:83], a[12:15], a[52:55], v[80:83]
  ds_read_b128 a[28:31], v207 offset:14336
  v_mfma_f32_16x16x32_bf16 v[76:79], a[8:11], a[52:55], v[76:79]
  buffer_load_dwordx4 v205, s[36:39], s62 offen offset:0 sc1 lds
  v_mfma_f32_16x16x32_bf16 v[72:75], a[4:7], a[52:55], v[72:75]
  ds_read_b64_tr_b16 a[70:71], v197 offset:7168
  v_mfma_f32_16x16x32_bf16 v[68:71], a[0:3], a[52:55], v[68:71]
  s_waitcnt lgkmcnt(7)
  ds_read_b128 a[32:35], v207 offset:15360
  v_mfma_f32_16x16x32_bf16 v[84:87], a[56:59], a[0:3], v[84:87]
  ds_read_b128 a[36:39], v210 offset:20480
  v_mfma_f32_16x16x32_bf16 v[88:91], a[56:59], a[4:7], v[88:91]
  ds_read_b64_tr_b16 a[40:41], v196 offset:2048
  v_mfma_f32_16x16x32_bf16 v[92:95], a[56:59], a[8:11], v[92:95]
  buffer_load_dwordx4 v205, s[36:39], s62 offen offset:1024 sc1 lds
  s_add_u32 m0, s65, 128000
  v_mfma_f32_16x16x32_bf16 v[96:99], a[56:59], a[12:15], v[96:99]
  ds_read_b64_tr_b16 a[42:43], v196 offset:8192
  v_mfma_f32_16x16x32_bf16 v[112:115], a[60:63], a[12:15], v[112:115]
  ds_read_b64_tr_b16 a[44:45], v197 offset:2048
  v_mfma_f32_16x16x32_bf16 v[108:111], a[60:63], a[8:11], v[108:111]
  v_mfma_f32_16x16x32_bf16 v[104:107], a[60:63], a[4:7], v[104:107]
  buffer_load_dword v206, s[36:39], s62 offen sc1 lds
  s_mov_b32 s61, 6094848
  v_mfma_f32_16x16x32_bf16 v[100:103], a[60:63], a[0:3], v[100:103]
  s_waitcnt vmcnt(24) lgkmcnt(3)
  s_barrier
  s_add_u32 m0, s63, 129024
  v_mfma_f32_16x16x32_bf16 v[20:23], a[64:67], a[20:23], v[20:23]
  ds_read_b64_tr_b16 a[46:47], v197 offset:8192
  v_mfma_f32_16x16x32_bf16 v[24:27], a[64:67], a[24:27], v[24:27]
  ds_read_b64_tr_b16 a[48:49], v196 offset:0
  v_mfma_f32_16x16x32_bf16 v[28:31], a[64:67], a[28:31], v[28:31]
  buffer_load_dwordx4 v202, s[8:11], s61 offen offset:0 lds
  v_mfma_f32_16x16x32_bf16 v[32:35], a[64:67], a[32:35], v[32:35]
  ds_read_b64_tr_b16 a[50:51], v196 offset:6144
  v_mfma_f32_16x16x32_bf16 v[116:119], a[64:67], a[36:39], v[116:119]
  ds_read_b64_tr_b16 a[52:53], v197 offset:0
  v_mfma_f32_16x16x32_bf16 v[48:51], a[68:71], a[32:35], v[48:51]
  v_mfma_f32_16x16x32_bf16 v[44:47], a[68:71], a[28:31], v[44:47]
  buffer_load_dwordx4 v203, s[8:11], s61 offen offset:1024 lds
  v_mfma_f32_16x16x32_bf16 v[40:43], a[68:71], a[24:27], v[40:43]
  ds_read_b64_tr_b16 a[54:55], v197 offset:6144
  v_mfma_f32_16x16x32_bf16 v[36:39], a[68:71], a[20:23], v[36:39]
  s_waitcnt lgkmcnt(4)
  ds_read_b64_tr_b16 a[56:57], v196 offset:22528
  v_mfma_f32_16x16x32_bf16 v[52:55], a[20:23], a[40:43], v[52:55]
  ds_read_b128 a[0:3], v207 offset:33792
  v_mfma_f32_16x16x32_bf16 v[56:59], a[24:27], a[40:43], v[56:59]
  buffer_load_dwordx4 v204, s[8:11], s61 offen offset:2048 lds
  v_mfma_f32_16x16x32_bf16 v[60:63], a[28:31], a[40:43], v[60:63]
  s_mov_b32 s62, 63488
  ds_read_b64_tr_b16 a[58:59], v196 offset:28672
  s_add_u32 m0, s64, 141312
  v_mfma_f32_16x16x32_bf16 v[64:67], a[32:35], a[40:43], v[64:67]
  ds_read_b128 a[4:7], v207 offset:34816
  v_mfma_f32_16x16x32_bf16 v[120:123], a[36:39], a[40:43], v[120:123]
  ds_read_b64_tr_b16 a[60:61], v197 offset:22528
  v_mfma_f32_16x16x32_bf16 v[80:83], a[32:35], a[44:47], v[80:83]
  ds_read_b128 a[8:11], v207 offset:35840
  v_mfma_f32_16x16x32_bf16 v[76:79], a[28:31], a[44:47], v[76:79]
  buffer_load_dwordx4 v205, s[36:39], s62 offen offset:0 sc1 lds
  v_mfma_f32_16x16x32_bf16 v[72:75], a[24:27], a[44:47], v[72:75]
  ds_read_b64_tr_b16 a[62:63], v197 offset:28672
  v_mfma_f32_16x16x32_bf16 v[68:71], a[20:23], a[44:47], v[68:71]
  s_waitcnt lgkmcnt(7)
  ds_read_b128 a[12:15], v207 offset:36864
  v_mfma_f32_16x16x32_bf16 v[84:87], a[48:51], a[20:23], v[84:87]
  ds_read_b128 a[16:19], v210 offset:41984
  v_mfma_f32_16x16x32_bf16 v[88:91], a[48:51], a[24:27], v[88:91]
  ds_read_b64_tr_b16 a[64:65], v196 offset:23552
  v_mfma_f32_16x16x32_bf16 v[92:95], a[48:51], a[28:31], v[92:95]
  buffer_load_dwordx4 v205, s[36:39], s62 offen offset:1024 sc1 lds
  s_add_u32 m0, s65, 149504
  v_mfma_f32_16x16x32_bf16 v[96:99], a[48:51], a[32:35], v[96:99]
  ds_read_b64_tr_b16 a[66:67], v196 offset:29696
  v_mfma_f32_16x16x32_bf16 v[112:115], a[52:55], a[32:35], v[112:115]
  ds_read_b64_tr_b16 a[68:69], v197 offset:23552
  v_mfma_f32_16x16x32_bf16 v[108:111], a[52:55], a[28:31], v[108:111]
  v_mfma_f32_16x16x32_bf16 v[104:107], a[52:55], a[24:27], v[104:107]
  buffer_load_dword v206, s[36:39], s62 offen sc1 lds
  s_nop 0
  v_mfma_f32_16x16x32_bf16 v[100:103], a[52:55], a[20:23], v[100:103]
  s_waitcnt vmcnt(24) lgkmcnt(3)
  s_barrier
  s_add_u32 s50, s76, 0
  v_mfma_f32_16x16x32_bf16 v[20:23], a[56:59], a[0:3], v[20:23]
  s_and_b32 s50, s50, 7
  s_lshl_b32 s50, s50, 18
  s_add_u32 m0, s70, 0
  v_mfma_f32_16x16x32_bf16 v[24:27], a[56:59], a[4:7], v[24:27]
  ds_read_b64_tr_b16 a[70:71], v197 offset:29696
  v_mfma_f32_16x16x32_bf16 v[28:31], a[56:59], a[8:11], v[28:31]
  ds_read_b64_tr_b16 a[40:41], v196 offset:21504
  v_mfma_f32_16x16x32_bf16 v[32:35], a[56:59], a[12:15], v[32:35]
  buffer_load_dwordx4 v216, s[12:15], s50 offen offset:0 lds
  v_mfma_f32_16x16x32_bf16 v[116:119], a[56:59], a[16:19], v[116:119]
  ds_read_b64_tr_b16 a[42:43], v196 offset:27648
  v_mfma_f32_16x16x32_bf16 v[48:51], a[60:63], a[12:15], v[48:51]
  ds_read_b64_tr_b16 a[44:45], v197 offset:21504
  v_mfma_f32_16x16x32_bf16 v[44:47], a[60:63], a[8:11], v[44:47]
  ds_read_b64_tr_b16 a[46:47], v197 offset:27648
  v_mfma_f32_16x16x32_bf16 v[40:43], a[60:63], a[4:7], v[40:43]
  buffer_load_dwordx4 v217, s[12:15], s50 offen offset:1024 lds
  v_mfma_f32_16x16x32_bf16 v[36:39], a[60:63], a[0:3], v[36:39]
  s_waitcnt lgkmcnt(4)
  ds_read_b64_tr_b16 a[48:49], v196 offset:44032
  v_mfma_f32_16x16x32_bf16 v[52:55], a[0:3], a[64:67], v[52:55]
  ds_read_b128 a[20:23], v207 offset:55296
  v_mfma_f32_16x16x32_bf16 v[56:59], a[4:7], a[64:67], v[56:59]
  ds_read_b64_tr_b16 a[50:51], v196 offset:50176
  v_mfma_f32_16x16x32_bf16 v[60:63], a[8:11], a[64:67], v[60:63]
  buffer_load_dwordx4 v218, s[12:15], s50 offen offset:2048 lds
  v_mfma_f32_16x16x32_bf16 v[64:67], a[12:15], a[64:67], v[64:67]
  ds_read_b128 a[24:27], v207 offset:56320
  v_mfma_f32_16x16x32_bf16 v[120:123], a[16:19], a[64:67], v[120:123]
  ds_read_b64_tr_b16 a[52:53], v197 offset:44032
  v_mfma_f32_16x16x32_bf16 v[80:83], a[12:15], a[68:71], v[80:83]
  ds_read_b128 a[28:31], v207 offset:57344
  v_mfma_f32_16x16x32_bf16 v[76:79], a[8:11], a[68:71], v[76:79]
  buffer_load_dwordx4 v219, s[12:15], s50 offen offset:3072 lds
  s_bfe_u32 s66, s2, 0x30004
  v_mfma_f32_16x16x32_bf16 v[72:75], a[4:7], a[68:71], v[72:75]
  s_and_b32 s67, s2, 3
  s_lshl3_add_u32 s66, s67, s66
  s_lshl2_add_u32 s66, s66, s44
  v_mfma_f32_16x16x32_bf16 v[68:71], a[0:3], a[68:71], v[68:71]
  s_waitcnt lgkmcnt(6)
  s_mul_i32 s66, s66, 98304
  s_and_b32 s67, s51, 0x3800
  v_mfma_f32_16x16x32_bf16 v[84:87], a[40:43], a[0:3], v[84:87]
  s_add_u32 s66, s66, s67
  s_and_b32 s67, s2, 8
  s_lshl_b32 s67, s67, 7
  v_mfma_f32_16x16x32_bf16 v[88:91], a[40:43], a[4:7], v[88:91]
  s_add_u32 s66, s66, s67
  ds_read_b64_tr_b16 a[54:55], v197 offset:50176
  v_and_b32 v215, 7, v10
  v_mfma_f32_16x16x32_bf16 v[92:95], a[40:43], a[8:11], v[92:95]
  ds_read_b128 a[32:35], v207 offset:58368
  v_mul_u32_u24 v215, 12288, v215
  v_mfma_f32_16x16x32_bf16 v[96:99], a[40:43], a[12:15], v[96:99]
  buffer_load_dword a252, v215, s[28:31], s66 offen offset:384
  v_mfma_f32_16x16x32_bf16 v[112:115], a[44:47], a[12:15], v[112:115]
  ds_read_b128 a[36:39], v210 offset:63488
  v_mfma_f32_16x16x32_bf16 v[108:111], a[44:47], a[8:11], v[108:111]
  ds_read_b64_tr_b16 a[56:57], v196 offset:45056
  v_mfma_f32_16x16x32_bf16 v[104:107], a[44:47], a[4:7], v[104:107]
  ds_read_b64_tr_b16 a[58:59], v196 offset:51200
  v_mfma_f32_16x16x32_bf16 v[100:103], a[44:47], a[0:3], v[100:103]
  s_waitcnt vmcnt(23) lgkmcnt(2)
  s_barrier
  buffer_load_dwordx4 v[136:139], v176, s[28:31], s51 offen nt
  v_mfma_f32_16x16x32_bf16 v[20:23], a[48:51], a[20:23], v[20:23]
  s_add_u32 s51, s51, 12288
  ds_read_b64_tr_b16 a[60:61], v197 offset:45056
  v_mfma_f32_16x16x32_bf16 v[24:27], a[48:51], a[24:27], v[24:27]
  ds_read_b64_tr_b16 a[62:63], v197 offset:51200
  v_mfma_f32_16x16x32_bf16 v[28:31], a[48:51], a[28:31], v[28:31]
  ds_read_b64_tr_b16 a[64:65], v196 offset:43008
  v_mfma_f32_16x16x32_bf16 v[32:35], a[48:51], a[32:35], v[32:35]
  buffer_load_dwordx4 v[140:143], v176, s[28:31], s51 offen nt
  s_add_u32 s51, s51, 12288
  v_mfma_f32_16x16x32_bf16 v[116:119], a[48:51], a[36:39], v[116:119]
  ds_read_b64_tr_b16 a[66:67], v196 offset:49152
  v_mfma_f32_16x16x32_bf16 v[48:51], a[52:55], a[32:35], v[48:51]
  ds_read_b64_tr_b16 a[68:69], v197 offset:43008
  v_mfma_f32_16x16x32_bf16 v[44:47], a[52:55], a[28:31], v[44:47]
  ds_read_b64_tr_b16 a[70:71], v197 offset:49152
  v_mfma_f32_16x16x32_bf16 v[40:43], a[52:55], a[24:27], v[40:43]
  buffer_load_dwordx4 v[144:147], v176, s[28:31], s51 offen nt
  s_add_u32 s51, s51, 12288
  v_mfma_f32_16x16x32_bf16 v[36:39], a[52:55], a[20:23], v[36:39]
  s_waitcnt lgkmcnt(4)
  ds_read_b64_tr_b16 a[40:41], v198 offset:1024
  v_mfma_f32_16x16x32_bf16 v[52:55], a[20:23], a[56:59], v[52:55]
  ds_read_b128 a[0:3], v208 offset:12288
  v_mfma_f32_16x16x32_bf16 v[56:59], a[24:27], a[56:59], v[56:59]
  ds_read_b64_tr_b16 a[42:43], v198 offset:7168
  v_mfma_f32_16x16x32_bf16 v[60:63], a[28:31], a[56:59], v[60:63]
  buffer_load_dwordx4 v[148:151], v176, s[28:31], s51 offen nt
  s_add_u32 s51, s51, 12288
  v_mfma_f32_16x16x32_bf16 v[64:67], a[32:35], a[56:59], v[64:67]
  ds_read_b128 a[4:7], v208 offset:13312
  v_mfma_f32_16x16x32_bf16 v[120:123], a[36:39], a[56:59], v[120:123]
  ds_read_b64_tr_b16 a[44:45], v199 offset:1024
  v_mfma_f32_16x16x32_bf16 v[80:83], a[32:35], a[60:63], v[80:83]
  ds_read_b128 a[8:11], v208 offset:14336
  v_mfma_f32_16x16x32_bf16 v[76:79], a[28:31], a[60:63], v[76:79]
  buffer_load_dwordx4 v[152:155], v176, s[28:31], s51 offen nt
  s_add_u32 s51, s51, 12288
  v_mfma_f32_16x16x32_bf16 v[72:75], a[24:27], a[60:63], v[72:75]
  ds_read_b64_tr_b16 a[46:47], v199 offset:7168
  v_mfma_f32_16x16x32_bf16 v[68:71], a[20:23], a[60:63], v[68:71]
  s_waitcnt lgkmcnt(7)
  ds_read_b128 a[12:15], v208 offset:15360
  v_mfma_f32_16x16x32_bf16 v[84:87], a[64:67], a[20:23], v[84:87]
  ds_read_b128 a[16:19], v211 offset:20480
  v_mfma_f32_16x16x32_bf16 v[88:91], a[64:67], a[24:27], v[88:91]
  buffer_load_dwordx4 v[156:159], v176, s[28:31], s51 offen nt
  s_add_u32 s51, s51, 12288
  v_mfma_f32_16x16x32_bf16 v[92:95], a[64:67], a[28:31], v[92:95]
  ds_read_b64_tr_b16 a[48:49], v198 offset:2048
  v_mfma_f32_16x16x32_bf16 v[96:99], a[64:67], a[32:35], v[96:99]
  ds_read_b64_tr_b16 a[50:51], v198 offset:8192
  v_mfma_f32_16x16x32_bf16 v[112:115], a[68:71], a[32:35], v[112:115]
  ds_read_b64_tr_b16 a[52:53], v199 offset:2048
  v_mfma_f32_16x16x32_bf16 v[108:111], a[68:71], a[28:31], v[108:111]
  buffer_load_dwordx4 v[160:163], v176, s[28:31], s51 offen nt
  s_add_u32 s51, s51, 12288
  v_mfma_f32_16x16x32_bf16 v[104:107], a[68:71], a[24:27], v[104:107]
  ds_read_b64_tr_b16 a[54:55], v199 offset:8192
  v_mfma_f32_16x16x32_bf16 v[100:103], a[68:71], a[20:23], v[100:103]
  s_waitcnt vmcnt(24) lgkmcnt(4)
  s_barrier
  v_mfma_f32_16x16x32_bf16 v[20:23], a[40:43], a[0:3], v[20:23]
  ds_read_b64_tr_b16 a[56:57], v198 offset:0
  v_mfma_f32_16x16x32_bf16 v[24:27], a[40:43], a[4:7], v[24:27]
  buffer_load_dwordx4 v[164:167], v176, s[28:31], s51 offen nt
  v_mfma_f32_16x16x32_bf16 v[28:31], a[40:43], a[8:11], v[28:31]
  ds_read_b64_tr_b16 a[58:59], v198 offset:6144
  v_mfma_f32_16x16x32_bf16 v[32:35], a[40:43], a[12:15], v[32:35]
  v_mfma_f32_16x16x32_bf16 v[116:119], a[40:43], a[16:19], v[116:119]
  ds_read_b64_tr_b16 a[60:61], v199 offset:0
  v_mfma_f32_16x16x32_bf16 v[48:51], a[44:47], a[12:15], v[48:51]
  v_mfma_f32_16x16x32_bf16 v[44:47], a[44:47], a[8:11], v[44:47]
  ds_read_b64_tr_b16 a[62:63], v199 offset:6144
  v_mfma_f32_16x16x32_bf16 v[40:43], a[44:47], a[4:7], v[40:43]
  v_mfma_f32_16x16x32_bf16 v[36:39], a[44:47], a[0:3], v[36:39]
  s_waitcnt lgkmcnt(4)
  ds_read_b64_tr_b16 a[64:65], v198 offset:22528
  v_mfma_f32_16x16x32_bf16 v[52:55], a[0:3], a[48:51], v[52:55]
  ds_read_b128 a[20:23], v208 offset:33792
  v_mfma_f32_16x16x32_bf16 v[56:59], a[4:7], a[48:51], v[56:59]
  ds_read_b64_tr_b16 a[66:67], v198 offset:28672
  v_mfma_f32_16x16x32_bf16 v[60:63], a[8:11], a[48:51], v[60:63]
  ds_read_b128 a[24:27], v208 offset:34816
  v_mfma_f32_16x16x32_bf16 v[64:67], a[12:15], a[48:51], v[64:67]
  v_mfma_f32_16x16x32_bf16 v[120:123], a[16:19], a[48:51], v[120:123]
  ds_read_b64_tr_b16 a[68:69], v199 offset:22528
  v_mfma_f32_16x16x32_bf16 v[80:83], a[12:15], a[52:55], v[80:83]
  ds_read_b128 a[28:31], v208 offset:35840
  v_mfma_f32_16x16x32_bf16 v[76:79], a[8:11], a[52:55], v[76:79]
  ds_read_b64_tr_b16 a[70:71], v199 offset:28672
  v_mfma_f32_16x16x32_bf16 v[72:75], a[4:7], a[52:55], v[72:75]
  ds_read_b128 a[32:35], v208 offset:36864
  v_mfma_f32_16x16x32_bf16 v[68:71], a[0:3], a[52:55], v[68:71]
  s_waitcnt lgkmcnt(8)
  ds_read_b128 a[36:39], v211 offset:41984
  v_mfma_f32_16x16x32_bf16 v[84:87], a[56:59], a[0:3], v[84:87]
  ds_read_b64_tr_b16 a[40:41], v198 offset:23552
  v_mfma_f32_16x16x32_bf16 v[88:91], a[56:59], a[4:7], v[88:91]
  ds_read_b64_tr_b16 a[42:43], v198 offset:29696
  v_mfma_f32_16x16x32_bf16 v[92:95], a[56:59], a[8:11], v[92:95]
  v_mfma_f32_16x16x32_bf16 v[96:99], a[56:59], a[12:15], v[96:99]
  v_mfma_f32_16x16x32_bf16 v[112:115], a[60:63], a[12:15], v[112:115]
  ds_read_b64_tr_b16 a[44:45], v199 offset:23552
  v_mfma_f32_16x16x32_bf16 v[108:111], a[60:63], a[8:11], v[108:111]
  v_mfma_f32_16x16x32_bf16 v[104:107], a[60:63], a[4:7], v[104:107]
  ds_read_b64_tr_b16 a[46:47], v199 offset:29696
  v_mfma_f32_16x16x32_bf16 v[100:103], a[60:63], a[0:3], v[100:103]
  s_waitcnt vmcnt(19) lgkmcnt(4)
  s_barrier
  v_mfma_f32_16x16x32_bf16 v[20:23], a[64:67], a[20:23], v[20:23]
  ds_read_b64_tr_b16 a[48:49], v198 offset:21504
  v_mfma_f32_16x16x32_bf16 v[24:27], a[64:67], a[24:27], v[24:27]
  v_mfma_f32_16x16x32_bf16 v[28:31], a[64:67], a[28:31], v[28:31]
  ds_read_b64_tr_b16 a[50:51], v198 offset:27648
  v_mfma_f32_16x16x32_bf16 v[32:35], a[64:67], a[32:35], v[32:35]
  v_mfma_f32_16x16x32_bf16 v[116:119], a[64:67], a[36:39], v[116:119]
  ds_read_b64_tr_b16 a[52:53], v199 offset:21504
  v_mfma_f32_16x16x32_bf16 v[48:51], a[68:71], a[32:35], v[48:51]
  v_mfma_f32_16x16x32_bf16 v[44:47], a[68:71], a[28:31], v[44:47]
  ds_read_b64_tr_b16 a[54:55], v199 offset:27648
  v_mfma_f32_16x16x32_bf16 v[40:43], a[68:71], a[24:27], v[40:43]
  v_mfma_f32_16x16x32_bf16 v[36:39], a[68:71], a[20:23], v[36:39]
  s_waitcnt lgkmcnt(4)
  ds_read_b64_tr_b16 a[56:57], v198 offset:44032
  v_mfma_f32_16x16x32_bf16 v[52:55], a[20:23], a[40:43], v[52:55]
  ds_read_b128 a[0:3], v208 offset:55296
  v_mfma_f32_16x16x32_bf16 v[56:59], a[24:27], a[40:43], v[56:59]
  ds_read_b64_tr_b16 a[58:59], v198 offset:50176
  v_mfma_f32_16x16x32_bf16 v[60:63], a[28:31], a[40:43], v[60:63]
  ds_read_b128 a[4:7], v208 offset:56320
  v_mfma_f32_16x16x32_bf16 v[64:67], a[32:35], a[40:43], v[64:67]
  v_mfma_f32_16x16x32_bf16 v[120:123], a[36:39], a[40:43], v[120:123]
  ds_read_b64_tr_b16 a[60:61], v199 offset:44032
  v_mfma_f32_16x16x32_bf16 v[80:83], a[32:35], a[44:47], v[80:83]
  ds_read_b128 a[8:11], v208 offset:57344
  v_mfma_f32_16x16x32_bf16 v[76:79], a[28:31], a[44:47], v[76:79]
  ds_read_b64_tr_b16 a[62:63], v199 offset:50176
  v_mfma_f32_16x16x32_bf16 v[72:75], a[24:27], a[44:47], v[72:75]
  ds_read_b128 a[12:15], v208 offset:58368
  v_mfma_f32_16x16x32_bf16 v[68:71], a[20:23], a[44:47], v[68:71]
  s_waitcnt lgkmcnt(8)
  ds_read_b128 a[16:19], v211 offset:63488
  v_mfma_f32_16x16x32_bf16 v[84:87], a[48:51], a[20:23], v[84:87]
  ds_read_b64_tr_b16 a[64:65], v198 offset:45056
  v_mfma_f32_16x16x32_bf16 v[88:91], a[48:51], a[24:27], v[88:91]
  ds_read_b64_tr_b16 a[66:67], v198 offset:51200
  v_mfma_f32_16x16x32_bf16 v[92:95], a[48:51], a[28:31], v[92:95]
  v_mfma_f32_16x16x32_bf16 v[96:99], a[48:51], a[32:35], v[96:99]
  v_mfma_f32_16x16x32_bf16 v[112:115], a[52:55], a[32:35], v[112:115]
  ds_read_b64_tr_b16 a[68:69], v199 offset:45056
  v_mfma_f32_16x16x32_bf16 v[108:111], a[52:55], a[28:31], v[108:111]
  v_mfma_f32_16x16x32_bf16 v[104:107], a[52:55], a[24:27], v[104:107]
  ds_read_b64_tr_b16 a[70:71], v199 offset:51200
  v_mfma_f32_16x16x32_bf16 v[100:103], a[52:55], a[20:23], v[100:103]
  s_waitcnt vmcnt(13) lgkmcnt(4)
  s_barrier
  v_mfma_f32_16x16x32_bf16 v[20:23], a[56:59], a[0:3], v[20:23]
  ds_read_b64_tr_b16 a[40:41], v198 offset:43008
  v_mfma_f32_16x16x32_bf16 v[24:27], a[56:59], a[4:7], v[24:27]
  v_mfma_f32_16x16x32_bf16 v[28:31], a[56:59], a[8:11], v[28:31]
  ds_read_b64_tr_b16 a[42:43], v198 offset:49152
  v_mfma_f32_16x16x32_bf16 v[32:35], a[56:59], a[12:15], v[32:35]
  v_mfma_f32_16x16x32_bf16 v[116:119], a[56:59], a[16:19], v[116:119]
  ds_read_b64_tr_b16 a[44:45], v199 offset:43008
  v_mfma_f32_16x16x32_bf16 v[48:51], a[60:63], a[12:15], v[48:51]
  s_add_u32 s50, s76, 1
  s_and_b32 s50, s50, 7
  s_lshl_b32 s50, s50, 18
  v_mfma_f32_16x16x32_bf16 v[44:47], a[60:63], a[8:11], v[44:47]
  s_add_u32 m0, s70, 16384
  ds_read_b64_tr_b16 a[46:47], v199 offset:49152
  v_mfma_f32_16x16x32_bf16 v[40:43], a[60:63], a[4:7], v[40:43]
  v_mfma_f32_16x16x32_bf16 v[36:39], a[60:63], a[0:3], v[36:39]
  s_waitcnt lgkmcnt(4)
  ds_read_b64_tr_b16 a[48:49], v200 offset:1024
  v_mfma_f32_16x16x32_bf16 v[52:55], a[0:3], a[64:67], v[52:55]
  buffer_load_dwordx4 v216, s[12:15], s50 offen offset:0 lds
  v_mfma_f32_16x16x32_bf16 v[56:59], a[4:7], a[64:67], v[56:59]
  ds_read_b128 a[20:23], v209 offset:12288
  v_mfma_f32_16x16x32_bf16 v[60:63], a[8:11], a[64:67], v[60:63]
  ds_read_b64_tr_b16 a[50:51], v200 offset:7168
  v_mfma_f32_16x16x32_bf16 v[64:67], a[12:15], a[64:67], v[64:67]
  ds_read_b128 a[24:27], v209 offset:13312
  v_mfma_f32_16x16x32_bf16 v[120:123], a[16:19], a[64:67], v[120:123]
  buffer_load_dwordx4 v217, s[12:15], s50 offen offset:1024 lds
  v_mfma_f32_16x16x32_bf16 v[80:83], a[12:15], a[68:71], v[80:83]
  ds_read_b64_tr_b16 a[52:53], v201 offset:1024
  v_mfma_f32_16x16x32_bf16 v[76:79], a[8:11], a[68:71], v[76:79]
  ds_read_b128 a[28:31], v209 offset:14336
  v_mfma_f32_16x16x32_bf16 v[72:75], a[4:7], a[68:71], v[72:75]
  ds_read_b64_tr_b16 a[54:55], v201 offset:7168
  v_mfma_f32_16x16x32_bf16 v[68:71], a[0:3], a[68:71], v[68:71]
  s_waitcnt lgkmcnt(7)
  ds_read_b128 a[32:35], v209 offset:15360
  v_mfma_f32_16x16x32_bf16 v[84:87], a[40:43], a[0:3], v[84:87]
  buffer_load_dwordx4 v218, s[12:15], s50 offen offset:2048 lds
  v_mfma_f32_16x16x32_bf16 v[88:91], a[40:43], a[4:7], v[88:91]
  ds_read_b128 a[36:39], v212 offset:20480
  v_mfma_f32_16x16x32_bf16 v[92:95], a[40:43], a[8:11], v[92:95]
  ds_read_b64_tr_b16 a[56:57], v200 offset:2048
  v_mfma_f32_16x16x32_bf16 v[96:99], a[40:43], a[12:15], v[96:99]
  ds_read_b64_tr_b16 a[58:59], v200 offset:8192
  v_mfma_f32_16x16x32_bf16 v[112:115], a[44:47], a[12:15], v[112:115]
  buffer_load_dwordx4 v219, s[12:15], s50 offen offset:3072 lds
  s_add_u32 s50, s76, 2
  v_mfma_f32_16x16x32_bf16 v[108:111], a[44:47], a[8:11], v[108:111]
  s_and_b32 s50, s50, 7
  s_lshl_b32 s50, s50, 18
  s_add_u32 m0, s70, 32768
  v_mfma_f32_16x16x32_bf16 v[104:107], a[44:47], a[4:7], v[104:107]
  ds_read_b64_tr_b16 a[60:61], v201 offset:2048
  v_mfma_f32_16x16x32_bf16 v[100:103], a[44:47], a[0:3], v[100:103]
  s_waitcnt lgkmcnt(3)
  ds_read_b64_tr_b16 a[62:63], v201 offset:8192
  v_mfma_f32_16x16x32_bf16 v[20:23], a[48:51], a[20:23], v[20:23]
  buffer_load_dwordx4 v216, s[12:15], s50 offen offset:0 lds
  v_mfma_f32_16x16x32_bf16 v[24:27], a[48:51], a[24:27], v[24:27]
  ds_read_b64_tr_b16 a[64:65], v200 offset:0
  v_mfma_f32_16x16x32_bf16 v[28:31], a[48:51], a[28:31], v[28:31]
  ds_read_b64_tr_b16 a[66:67], v200 offset:6144
  v_mfma_f32_16x16x32_bf16 v[32:35], a[48:51], a[32:35], v[32:35]
  v_mfma_f32_16x16x32_bf16 v[116:119], a[48:51], a[36:39], v[116:119]
  buffer_load_dwordx4 v217, s[12:15], s50 offen offset:1024 lds
  v_mfma_f32_16x16x32_bf16 v[48:51], a[52:55], a[32:35], v[48:51]
  ds_read_b64_tr_b16 a[68:69], v201 offset:0
  v_mfma_f32_16x16x32_bf16 v[44:47], a[52:55], a[28:31], v[44:47]
  ds_read_b64_tr_b16 a[70:71], v201 offset:6144
  v_mfma_f32_16x16x32_bf16 v[40:43], a[52:55], a[24:27], v[40:43]
  v_mfma_f32_16x16x32_bf16 v[36:39], a[52:55], a[20:23], v[36:39]
  s_waitcnt lgkmcnt(4)
  buffer_load_dwordx4 v218, s[12:15], s50 offen offset:2048 lds
  v_mfma_f32_16x16x32_bf16 v[52:55], a[20:23], a[56:59], v[52:55]
  v_cvt_pk_bf16_f32 v116, v116, v117
  v_cvt_pk_bf16_f32 v117, v118, v119
  v_mfma_f32_16x16x32_bf16 v[56:59], a[24:27], a[56:59], v[56:59]
  v_cvt_pk_bf16_f32 v32, v32, v33
  v_cvt_pk_bf16_f32 v33, v34, v35
  v_mfma_f32_16x16x32_bf16 v[60:63], a[28:31], a[56:59], v[60:63]
  v_cvt_pk_bf16_f32 v34, v48, v49
  v_cvt_pk_bf16_f32 v35, v50, v51
  v_mfma_f32_16x16x32_bf16 v[64:67], a[32:35], a[56:59], v[64:67]
  buffer_load_dwordx4 v219, s[12:15], s50 offen offset:3072 lds
  v_mfma_f32_16x16x32_bf16 v[120:123], a[36:39], a[56:59], v[120:123]
  ds_write_b64 v224, v[116:117]
  v_mfma_f32_16x16x32_bf16 v[80:83], a[32:35], a[60:63], v[80:83]
  ds_write_b64 v222, v[32:33]
  v_mfma_f32_16x16x32_bf16 v[76:79], a[28:31], a[60:63], v[76:79]
  ds_write_b64 v223, v[34:35]
  v_cvt_pk_bf16_f32 v55, v54, v55
  v_mfma_f32_16x16x32_bf16 v[72:75], a[24:27], a[60:63], v[72:75]
  v_cvt_pk_bf16_f32 v54, v52, v53
  v_cvt_pk_bf16_f32 v56, v56, v57
  v_mfma_f32_16x16x32_bf16 v[68:71], a[20:23], a[60:63], v[68:71]
  s_waitcnt lgkmcnt(3)
  v_cvt_pk_bf16_f32 v57, v58, v59
  v_cvt_pk_bf16_f32 v58, v60, v61
  v_mfma_f32_16x16x32_bf16 v[84:87], a[64:67], a[20:23], v[84:87]
  v_cvt_pk_bf16_f32 v59, v62, v63
  v_cvt_pk_bf16_f32 v60, v64, v65
  v_mfma_f32_16x16x32_bf16 v[88:91], a[64:67], a[24:27], v[88:91]
  v_cvt_pk_bf16_f32 v61, v66, v67
  v_cvt_pk_bf16_f32 v120, v120, v121
  v_mfma_f32_16x16x32_bf16 v[92:95], a[64:67], a[28:31], v[92:95]
  v_cvt_pk_bf16_f32 v121, v122, v123
  v_mfma_f32_16x16x32_bf16 v[96:99], a[64:67], a[32:35], v[96:99]
  ds_write_b64 v222, v[60:61] offset:1024
  v_mfma_f32_16x16x32_bf16 v[112:115], a[68:71], a[32:35], v[112:115]
  ds_write_b64 v224, v[120:121] offset:1024
  v_cvt_pk_bf16_f32 v71, v70, v71
  v_mfma_f32_16x16x32_bf16 v[108:111], a[68:71], a[28:31], v[108:111]
  v_cvt_pk_bf16_f32 v70, v68, v69
  v_cvt_pk_bf16_f32 v72, v72, v73
  v_mfma_f32_16x16x32_bf16 v[104:107], a[68:71], a[24:27], v[104:107]
  v_cvt_pk_bf16_f32 v73, v74, v75
  v_cvt_pk_bf16_f32 v74, v76, v77
  v_mfma_f32_16x16x32_bf16 v[100:103], a[68:71], a[20:23], v[100:103]
  v_cvt_pk_bf16_f32 v75, v78, v79
  v_cvt_pk_bf16_f32 v76, v80, v81
  v_cvt_pk_bf16_f32 v77, v82, v83
  ds_write_b64 v223, v[76:77] offset:1024
  v_cvt_pk_bf16_f32 v28, v28, v29
  v_cvt_pk_bf16_f32 v29, v30, v31
  v_cvt_pk_bf16_f32 v30, v44, v45
  v_cvt_pk_bf16_f32 v31, v46, v47
  v_cvt_pk_bf16_f32 v24, v24, v25
  v_cvt_pk_bf16_f32 v25, v26, v27
  v_cvt_pk_bf16_f32 v26, v40, v41
  v_cvt_pk_bf16_f32 v27, v42, v43
  v_cvt_pk_bf16_f32 v20, v20, v21
  v_cvt_pk_bf16_f32 v21, v22, v23
  v_cvt_pk_bf16_f32 v22, v36, v37
  v_cvt_pk_bf16_f32 v23, v38, v39
  s_waitcnt lgkmcnt(0)
  s_barrier
  ds_read_b64 v[124:125], v225
  ds_read_b64 v[126:127], v226
  ds_read_b64 v[52:53], v225 offset:1024
  ds_read_b64 v[68:69], v226 offset:1024
  s_cmp_eq_u32 s57, 0
  s_cselect_b64 s[66:67], s[80:81], 0
  s_cselect_b64 s[68:69], s[82:83], 0
  v_cvt_pk_bf16_f32 v96, v96, v97
  v_cvt_pk_bf16_f32 v97, v98, v99
  v_cvt_pk_bf16_f32 v98, v112, v113
  v_cvt_pk_bf16_f32 v99, v114, v115
  v_cvt_pk_bf16_f32 v92, v92, v93
  v_cvt_pk_bf16_f32 v93, v94, v95
  v_cvt_pk_bf16_f32 v94, v108, v109
  s_add_u32 s50, s76, 3
  s_and_b32 s50, s50, 7
  s_lshl_b32 s50, s50, 18
  s_add_u32 m0, s70, 49152
  s_nop 0
  buffer_load_dwordx4 v216, s[12:15], s50 offen offset:0 lds
  v_cvt_pk_bf16_f32 v95, v110, v111
  v_cvt_pk_bf16_f32 v88, v88, v89
  v_cvt_pk_bf16_f32 v89, v90, v91
  v_cvt_pk_bf16_f32 v90, v104, v105
  v_cvt_pk_bf16_f32 v91, v106, v107
  v_cvt_pk_bf16_f32 v84, v84, v85
  v_cvt_pk_bf16_f32 v85, v86, v87
  v_cvt_pk_bf16_f32 v86, v100, v101
Ha1_1:
  s_cbranch_execz Ra
  v_cvt_pk_bf16_f32 v87, v102, v103
  v_mov_b32 v12, 0xce6e6b28
  buffer_load_dwordx4 v217, s[12:15], s50 offen offset:1024 lds
  v_mfma_f32_16x16x32_bf16 v[112:115], v[32:35], v[96:99], 0
  v_mfma_f32_16x16x32_bf16 v[48:51], v[28:31], v[96:99], 0
  v_mfma_f32_16x16x32_bf16 v[108:111], v[28:31], v[92:95], 0
  v_mfma_f32_16x16x32_bf16 v[44:47], v[24:27], v[92:95], 0
  v_mfma_f32_16x16x32_bf16 v[104:107], v[24:27], v[88:91], 0
  v_mfma_f32_16x16x32_bf16 v[40:43], v[20:23], v[88:91], 0
  s_waitcnt lgkmcnt(2)
  v_mfma_f32_16x16x32_bf16 v[100:103], v[20:23], v[84:87], 0
  v_mfma_f32_16x16x32_bf16 v[36:39], v[124:127], v[84:87], 0
  s_nop 1
  v_cndmask_b32 v194, v112, v113, s[78:79]
  buffer_load_dwordx4 v218, s[12:15], s50 offen offset:2048 lds
  v_cndmask_b32 v195, v114, v115, s[78:79]
  v_cndmask_b32 v192, v48, v49, s[78:79]
  v_cndmask_b32 v193, v50, v51, s[78:79]
  v_cndmask_b32 v190, v108, v109, s[78:79]
  v_cndmask_b32 v191, v110, v111, s[78:79]
  v_cndmask_b32 v188, v44, v45, s[78:79]
  v_cndmask_b32 v189, v46, v47, s[78:79]
  v_cndmask_b32 v186, v104, v105, s[78:79]
  v_cndmask_b32 v187, v106, v107, s[78:79]
  v_cndmask_b32 v184, v40, v41, s[78:79]
  buffer_load_dwordx4 v219, s[12:15], s50 offen offset:3072 lds
  v_cndmask_b32 v185, v42, v43, s[78:79]
  v_cndmask_b32 v182, v100, v101, s[78:79]
  v_cndmask_b32 v183, v102, v103, s[78:79]
  v_cndmask_b32 v180, v36, v37, s[78:79]
  v_cndmask_b32 v181, v38, v39, s[78:79]
  v_cndmask_b32 v192, v194, v192, s[80:81]
  v_cndmask_b32 v193, v195, v193, s[82:83]
  v_cndmask_b32 v188, v190, v188, s[80:81]
  v_cndmask_b32 v189, v191, v189, s[82:83]
  v_cndmask_b32 v184, v186, v184, s[80:81]
  s_add_u32 s50, s76, 4
  s_and_b32 s50, s50, 7
  s_lshl_b32 s50, s50, 18
  s_add_u32 m0, s70, 65536
  s_nop 0
  buffer_load_dwordx4 v216, s[12:15], s50 offen offset:0 lds
  v_cndmask_b32 v185, v187, v185, s[82:83]
  v_cndmask_b32 v180, v182, v180, s[80:81]
  v_cndmask_b32 v181, v183, v181, s[82:83]
  v_mul_f32 v192, 0x3e8293ee, v192
  v_mul_f32 v193, 0x3e8293ee, v193
  v_mul_f32 v188, 0x3e8293ee, v188
  v_mul_f32 v189, 0x3e8293ee, v189
  v_mul_f32 v184, 0x3e8293ee, v184
  v_mul_f32 v185, 0x3e8293ee, v185
  v_mul_f32 v180, 0x3e8293ee, v180
  buffer_load_dwordx4 v217, s[12:15], s50 offen offset:1024 lds
  v_mul_f32 v181, 0x3e8293ee, v181
  v_cndmask_b32 v180, v180, v12, s[66:67]
  v_cndmask_b32 v181, v181, v12, s[68:69]
  v_max_f32 v194, v192, v193
  v_max_f32 v190, v188, v189
  v_max_f32 v186, v184, v185
  v_max_f32 v182, v180, v181
  v_mov_b32 v195, v194
  v_mov_b32 v191, v190
  v_mov_b32 v187, v186
  buffer_load_dwordx4 v218, s[12:15], s50 offen offset:2048 lds
  v_mov_b32 v183, v182
  v_permlane16_swap_b32 v194, v195
  v_permlane16_swap_b32 v190, v191
  v_permlane16_swap_b32 v186, v187
  v_permlane16_swap_b32 v182, v183
  v_max_f32 v194, v194, v195
  v_max_f32 v190, v190, v191
  v_max_f32 v186, v186, v187
  v_max_f32 v182, v182, v183
  v_mov_b32 v195, v194
  buffer_load_dwordx4 v219, s[12:15], s50 offen offset:3072 lds
  v_mov_b32 v191, v190
  v_mov_b32 v187, v186
  v_mov_b32 v183, v182
  v_permlane32_swap_b32 v194, v195
  v_permlane32_swap_b32 v190, v191
  v_permlane32_swap_b32 v186, v187
  v_permlane32_swap_b32 v182, v183
  v_max_f32 v194, v194, v195
  v_max_f32 v190, v190, v191
  v_max_f32 v186, v186, v187
  v_max_f32 v182, v182, v183
  v_sub_f32 v192, v192, v194
  v_sub_f32 v193, v193, v194
  v_sub_f32 v188, v188, v190
  v_sub_f32 v189, v189, v190
  v_sub_f32 v184, v184, v186
  v_sub_f32 v185, v185, v186
  v_sub_f32 v180, v180, v182
  v_sub_f32 v181, v181, v182
  v_exp_f32 v192, v192
  v_exp_f32 v193, v193
  v_exp_f32 v188, v188
  v_exp_f32 v189, v189
  v_exp_f32 v184, v184
  v_exp_f32 v185, v185
  v_exp_f32 v180, v180
  v_exp_f32 v181, v181
  v_add_f32 v194, v192, v193
  v_add_f32 v190, v188, v189
  v_add_f32 v186, v184, v185
  v_add_f32 v182, v180, v181
  v_mov_b32 v195, v194
  v_mov_b32 v191, v190
  v_mov_b32 v187, v186
  v_mov_b32 v183, v182
  v_permlane16_swap_b32 v194, v195
  v_permlane16_swap_b32 v190, v191
  v_permlane16_swap_b32 v186, v187
  v_permlane16_swap_b32 v182, v183
  v_add_f32 v194, v194, v195
  v_add_f32 v190, v190, v191
  v_add_f32 v186, v186, v187
  v_add_f32 v182, v182, v183
  v_mov_b32 v195, v194
  v_mov_b32 v191, v190
  v_mov_b32 v187, v186
  v_mov_b32 v183, v182
  v_permlane32_swap_b32 v194, v195
  v_permlane32_swap_b32 v190, v191
  v_permlane32_swap_b32 v186, v187
  v_permlane32_swap_b32 v182, v183
  v_add_f32 v194, v194, v195
  v_add_f32 v190, v190, v191
  v_add_f32 v186, v186, v187
  v_add_f32 v182, v182, v183
  v_rcp_f32 v194, v194
  v_rcp_f32 v190, v190
  v_rcp_f32 v186, v186
  v_rcp_f32 v182, v182
  v_mul_f32 v192, v192, v194
  v_mul_f32 v193, v193, v194
  v_mul_f32 v188, v188, v190
  v_mul_f32 v189, v189, v190
  v_mul_f32 v184, v184, v186
  v_mul_f32 v185, v185, v186
  v_mul_f32 v180, v180, v182
  v_mul_f32 v181, v181, v182
  v_cvt_pk_bf16_f32 v192, v192, v192
  v_cvt_pk_bf16_f32 v193, v193, v193
  v_cvt_pk_bf16_f32 v188, v188, v188
  v_cvt_pk_bf16_f32 v189, v189, v189
  v_cvt_pk_bf16_f32 v184, v184, v184
  v_cvt_pk_bf16_f32 v185, v185, v185
  v_cvt_pk_bf16_f32 v180, v180, v180
  v_cvt_pk_bf16_f32 v181, v181, v181
  v_and_b32 v48, v227, v192
  v_and_b32 v49, v228, v193
  v_and_b32 v50, v229, v192
  v_and_b32 v51, v230, v193
  v_and_b32 v44, v227, v188
  v_and_b32 v45, v228, v189
  v_and_b32 v46, v229, v188
  v_and_b32 v47, v230, v189
  v_and_b32 v40, v227, v184
  v_and_b32 v41, v228, v185
  v_and_b32 v42, v229, v184
  v_and_b32 v43, v230, v185
  v_and_b32 v36, v227, v180
  v_and_b32 v37, v228, v181
  v_and_b32 v38, v229, v180
  v_and_b32 v39, v230, v181
  s_waitcnt lgkmcnt(0)
  v_mfma_f32_16x16x32_bf16 v[32:35], v[58:61], v[48:51], 0
  v_mfma_f32_16x16x32_bf16 v[96:99], v[74:77], v[48:51], 0
  v_mfma_f32_16x16x32_bf16 v[28:31], v[56:59], v[44:47], 0
  v_mfma_f32_16x16x32_bf16 v[92:95], v[72:75], v[44:47], 0
  v_mfma_f32_16x16x32_bf16 v[24:27], v[54:57], v[40:43], 0
  v_mfma_f32_16x16x32_bf16 v[88:91], v[70:73], v[40:43], 0
  v_mfma_f32_16x16x32_bf16 v[20:23], v[52:55], v[36:39], 0
  v_mfma_f32_16x16x32_bf16 v[84:87], v[68:71], v[36:39], 0
  s_cmp_eq_u32 s59, 1
  s_cselect_b64 vcc, -1, 0
  v_cvt_pk_bf16_f32 v112, v32, v33
  v_cvt_pk_bf16_f32 v113, v34, v35
  v_cvt_pk_bf16_f32 v114, v96, v97
  v_cvt_pk_bf16_f32 v115, v98, v99
  v_cndmask_b32 v192, v112, v114, vcc
  v_cndmask_b32 v193, v113, v115, vcc
  v_cndmask_b32 v194, v114, v112, vcc
  v_cndmask_b32 v195, v115, v113, vcc
  buffer_store_dwordx4 v[192:195], v0, s[36:39], s72 offen offset:1024 sc1
  v_cvt_pk_bf16_f32 v108, v28, v29
  v_cvt_pk_bf16_f32 v109, v30, v31
  v_cvt_pk_bf16_f32 v110, v92, v93
  v_cvt_pk_bf16_f32 v111, v94, v95
  v_cndmask_b32 v188, v108, v110, vcc
  v_cndmask_b32 v189, v109, v111, vcc
  v_cndmask_b32 v190, v110, v108, vcc
  v_cndmask_b32 v191, v111, v109, vcc
  buffer_store_dwordx4 v[188:191], v0, s[36:39], s72 offen offset:0 sc1
  v_cvt_pk_bf16_f32 v104, v24, v25
  v_cvt_pk_bf16_f32 v105, v26, v27
  v_cvt_pk_bf16_f32 v106, v88, v89
  v_cvt_pk_bf16_f32 v107, v90, v91
  v_cndmask_b32 v184, v104, v106, vcc
  v_cndmask_b32 v185, v105, v107, vcc
  v_cndmask_b32 v186, v106, v104, vcc
  v_cndmask_b32 v187, v107, v105, vcc
  buffer_store_dwordx4 v[184:187], v0, s[36:39], s71 offen offset:1024 sc1
  v_cvt_pk_bf16_f32 v100, v20, v21
  v_cvt_pk_bf16_f32 v101, v22, v23
  v_cvt_pk_bf16_f32 v102, v84, v85
  v_cvt_pk_bf16_f32 v103, v86, v87
  v_cndmask_b32 v180, v100, v102, vcc
  v_cndmask_b32 v181, v101, v103, vcc
  v_cndmask_b32 v182, v102, v100, vcc
  v_cndmask_b32 v183, v103, v101, vcc
  buffer_store_dwordx4 v[180:183], v0, s[36:39], s71 offen offset:0 sc1
  v_mov_b32 v12, s3
  s_waitcnt vmcnt(0) lgkmcnt(0)
  s_barrier
  s_mov_b64 exec, 1
  buffer_store_dword v12, v0, s[36:39], s45 offen sc1
  s_mov_b64 exec, -1
  v_lshlrev_b32 v28, 16, v136
  v_lshrrev_b32 v14, 2, v10
  v_min_u32 v14, (XEND-G3S)/4096, v14
  v_and_b32 v15, 3, v10
  v_lshlrev_b32 v15, 7, v15
  v_lshl_add_u32 v14, v14, 12, v15
  s_add_u32 s94, s92, AL-adaLN_cond__sliding_local_dilated__swiglu_ffn__prompt_kernel+((G3S-AL+4095)/4096)*4096
  s_addc_u32 s95, s93, 0
  global_load_dword a252, v14, s[94:95]
  v_and_b32 v29, 0xffff0000, v136
  v_lshlrev_b32 v30, 16, v137
  v_and_b32 v31, 0xffff0000, v137
  v_pk_mul_f32 v[20:21], v[28:29], v[168:169] op_sel_hi:[1,0]
  v_pk_mul_f32 v[22:23], v[30:31], v[168:169] op_sel_hi:[1,0]
  s_add_u32 s50, s76, 5
  s_and_b32 s50, s50, 7
  s_lshl_b32 s50, s50, 18
  s_add_u32 m0, s70, 81920
  s_nop 0
  buffer_load_dwordx4 v216, s[12:15], s50 offen offset:0 lds
  v_lshlrev_b32 v28, 16, v138
  v_and_b32 v29, 0xffff0000, v138
  v_lshlrev_b32 v30, 16, v139
  v_and_b32 v31, 0xffff0000, v139
  v_pk_mul_f32 v[24:25], v[28:29], v[168:169] op_sel_hi:[1,0]
  buffer_load_dwordx4 v217, s[12:15], s50 offen offset:1024 lds
  v_pk_mul_f32 v[26:27], v[30:31], v[168:169] op_sel_hi:[1,0]
  v_lshlrev_b32 v28, 16, v140
  v_and_b32 v29, 0xffff0000, v140
  v_lshlrev_b32 v30, 16, v141
  v_and_b32 v31, 0xffff0000, v141
  buffer_load_dwordx4 v218, s[12:15], s50 offen offset:2048 lds
  v_pk_fma_f32 v[20:21], v[28:29], v[168:169], v[20:21] op_sel:[0,1,0] op_sel_hi:[1,1,1]
  v_pk_fma_f32 v[22:23], v[30:31], v[168:169], v[22:23] op_sel:[0,1,0] op_sel_hi:[1,1,1]
  v_lshlrev_b32 v28, 16, v142
  v_and_b32 v29, 0xffff0000, v142
  v_lshlrev_b32 v30, 16, v143
  buffer_load_dwordx4 v219, s[12:15], s50 offen offset:3072 lds
  v_and_b32 v31, 0xffff0000, v143
  v_pk_fma_f32 v[24:25], v[28:29], v[168:169], v[24:25] op_sel:[0,1,0] op_sel_hi:[1,1,1]
  v_pk_fma_f32 v[26:27], v[30:31], v[168:169], v[26:27] op_sel:[0,1,0] op_sel_hi:[1,1,1]
  v_lshlrev_b32 v28, 16, v144
  v_and_b32 v29, 0xffff0000, v144
  s_add_u32 s50, s76, 6
  s_and_b32 s50, s50, 7
  s_lshl_b32 s50, s50, 18
  s_add_u32 m0, s70, 98304
  s_nop 0
  buffer_load_dwordx4 v216, s[12:15], s50 offen offset:0 lds
  v_lshlrev_b32 v30, 16, v145
  v_and_b32 v31, 0xffff0000, v145
  v_pk_fma_f32 v[20:21], v[28:29], v[170:171], v[20:21] op_sel:[0,0,0] op_sel_hi:[1,0,1]
  v_pk_fma_f32 v[22:23], v[30:31], v[170:171], v[22:23] op_sel:[0,0,0] op_sel_hi:[1,0,1]
  v_lshlrev_b32 v28, 16, v146
  buffer_load_dwordx4 v217, s[12:15], s50 offen offset:1024 lds
  v_and_b32 v29, 0xffff0000, v146
  v_lshlrev_b32 v30, 16, v147
  v_and_b32 v31, 0xffff0000, v147
  v_pk_fma_f32 v[24:25], v[28:29], v[170:171], v[24:25] op_sel:[0,0,0] op_sel_hi:[1,0,1]
  v_pk_fma_f32 v[26:27], v[30:31], v[170:171], v[26:27] op_sel:[0,0,0] op_sel_hi:[1,0,1]
  buffer_load_dwordx4 v218, s[12:15], s50 offen offset:2048 lds
  v_lshlrev_b32 v28, 16, v148
  v_and_b32 v29, 0xffff0000, v148
  v_lshlrev_b32 v30, 16, v149
  v_and_b32 v31, 0xffff0000, v149
  v_pk_fma_f32 v[20:21], v[28:29], v[170:171], v[20:21] op_sel:[0,1,0] op_sel_hi:[1,1,1]
  buffer_load_dwordx4 v219, s[12:15], s50 offen offset:3072 lds
  v_pk_fma_f32 v[22:23], v[30:31], v[170:171], v[22:23] op_sel:[0,1,0] op_sel_hi:[1,1,1]
  v_lshlrev_b32 v28, 16, v150
  v_and_b32 v29, 0xffff0000, v150
  v_lshlrev_b32 v30, 16, v151
  v_and_b32 v31, 0xffff0000, v151
  s_add_u32 s50, s76, 7
  s_and_b32 s50, s50, 7
  s_lshl_b32 s50, s50, 18
  s_add_u32 m0, s70, 114688
  s_nop 0
  buffer_load_dwordx4 v216, s[12:15], s50 offen offset:0 lds
  v_pk_fma_f32 v[24:25], v[28:29], v[170:171], v[24:25] op_sel:[0,1,0] op_sel_hi:[1,1,1]
  v_pk_fma_f32 v[26:27], v[30:31], v[170:171], v[26:27] op_sel:[0,1,0] op_sel_hi:[1,1,1]
  v_lshlrev_b32 v28, 16, v152
  v_and_b32 v29, 0xffff0000, v152
  v_lshlrev_b32 v30, 16, v153
  buffer_load_dwordx4 v217, s[12:15], s50 offen offset:1024 lds
  v_and_b32 v31, 0xffff0000, v153
  v_pk_fma_f32 v[20:21], v[28:29], v[172:173], v[20:21] op_sel:[0,0,0] op_sel_hi:[1,0,1]
  v_pk_fma_f32 v[22:23], v[30:31], v[172:173], v[22:23] op_sel:[0,0,0] op_sel_hi:[1,0,1]
  v_lshlrev_b32 v28, 16, v154
  v_and_b32 v29, 0xffff0000, v154
  buffer_load_dwordx4 v218, s[12:15], s50 offen offset:2048 lds
  v_lshlrev_b32 v30, 16, v155
  v_and_b32 v31, 0xffff0000, v155
  v_pk_fma_f32 v[24:25], v[28:29], v[172:173], v[24:25] op_sel:[0,0,0] op_sel_hi:[1,0,1]
  v_pk_fma_f32 v[26:27], v[30:31], v[172:173], v[26:27] op_sel:[0,0,0] op_sel_hi:[1,0,1]
  v_lshlrev_b32 v28, 16, v156
  buffer_load_dwordx4 v219, s[12:15], s50 offen offset:3072 lds
  v_and_b32 v29, 0xffff0000, v156
  v_lshlrev_b32 v30, 16, v157
  v_and_b32 v31, 0xffff0000, v157
  v_pk_fma_f32 v[20:21], v[28:29], v[172:173], v[20:21] op_sel:[0,1,0] op_sel_hi:[1,1,1]
  v_pk_fma_f32 v[22:23], v[30:31], v[172:173], v[22:23] op_sel:[0,1,0] op_sel_hi:[1,1,1]
  s_add_u32 m0, s70, 131072
  s_nop 0
  buffer_load_dwordx4 v220, s[4:7], s55 offen offset:0 lds
  v_lshlrev_b32 v28, 16, v158
  v_and_b32 v29, 0xffff0000, v158
  v_lshlrev_b32 v30, 16, v159
  v_and_b32 v31, 0xffff0000, v159
  v_pk_fma_f32 v[24:25], v[28:29], v[172:173], v[24:25] op_sel:[0,1,0] op_sel_hi:[1,1,1]
  buffer_load_dwordx4 v221, s[4:7], s55 offen offset:1024 lds
  v_pk_fma_f32 v[26:27], v[30:31], v[172:173], v[26:27] op_sel:[0,1,0] op_sel_hi:[1,1,1]
  v_lshlrev_b32 v28, 16, v160
  v_and_b32 v29, 0xffff0000, v160
  v_lshlrev_b32 v30, 16, v161
  v_and_b32 v31, 0xffff0000, v161
  s_add_u32 m0, s70, 133120
  s_add_u32 s48, s55, 32768
  buffer_load_dwordx4 v220, s[4:7], s48 offen offset:0 lds
  v_pk_fma_f32 v[20:21], v[28:29], v[174:175], v[20:21] op_sel:[0,0,0] op_sel_hi:[1,0,1]
  v_pk_fma_f32 v[22:23], v[30:31], v[174:175], v[22:23] op_sel:[0,0,0] op_sel_hi:[1,0,1]
  v_lshlrev_b32 v28, 16, v162
  v_and_b32 v29, 0xffff0000, v162
  v_lshlrev_b32 v30, 16, v163
  buffer_load_dwordx4 v221, s[4:7], s48 offen offset:1024 lds
  v_and_b32 v31, 0xffff0000, v163
  v_pk_fma_f32 v[24:25], v[28:29], v[174:175], v[24:25] op_sel:[0,0,0] op_sel_hi:[1,0,1]
  v_pk_fma_f32 v[26:27], v[30:31], v[174:175], v[26:27] op_sel:[0,0,0] op_sel_hi:[1,0,1]
  v_lshlrev_b32 v28, 16, v164
  v_and_b32 v29, 0xffff0000, v164
  v_lshlrev_b32 v30, 16, v165
  v_and_b32 v31, 0xffff0000, v165
  v_pk_fma_f32 v[20:21], v[28:29], v[174:175], v[20:21] op_sel:[0,1,0] op_sel_hi:[1,1,1]
  v_pk_fma_f32 v[22:23], v[30:31], v[174:175], v[22:23] op_sel:[0,1,0] op_sel_hi:[1,1,1]
  v_lshlrev_b32 v28, 16, v166
  v_and_b32 v29, 0xffff0000, v166
  v_lshlrev_b32 v30, 16, v167
  v_and_b32 v31, 0xffff0000, v167
  v_pk_fma_f32 v[24:25], v[28:29], v[174:175], v[24:25] op_sel:[0,1,0] op_sel_hi:[1,1,1]
  v_pk_fma_f32 v[26:27], v[30:31], v[174:175], v[26:27] op_sel:[0,1,0] op_sel_hi:[1,1,1]
  s_nop 0
  v_permlane32_swap_b32 v20, v24
  v_permlane32_swap_b32 v21, v25
  v_permlane32_swap_b32 v22, v26
  v_permlane32_swap_b32 v23, v27
  v_add_f32 v20, v20, v24
  v_add_f32 v21, v21, v25
  v_add_f32 v22, v22, v26
  v_add_f32 v23, v23, v27
  s_nop 0
  v_permlane16_swap_b32 v20, v22
  v_permlane16_swap_b32 v21, v23
  v_add_f32 v20, v20, v22
  v_add_f32 v21, v21, v23
  v_add_u32 v28, 162816, v178
  v_add_f32_dpp v20, v20, v20 row_ror:8 row_mask:0xf bank_mask:0xf
  v_add_f32_dpp v21, v21, v21 row_ror:8 row_mask:0xf bank_mask:0xf
  ds_write_b64 v177, v[20:21]
  s_lshl_b32 s45, s2, 7
  s_add_u32 s45, s45, 5341184
  s_cmp_eq_u32 s44, 0
  s_cselect_b32 s45, s45, 1073741824
  s_waitcnt lgkmcnt(0)
  s_barrier
  ds_read_b32 v180, v28 offset:0
  ds_read_b32 v181, v28 offset:256
  ds_read_b32 v182, v28 offset:512
  ds_read_b32 v183, v28 offset:768
  s_cmp_eq_u32 s44, 1
  s_cselect_b32 s48, s56, 1073741824
  s_waitcnt lgkmcnt(0)
  v_add_f32 v180, v180, v181
  v_add_f32 v182, v182, v183
  v_add_f32 v180, v180, v182
  buffer_store_dword v180, v178, s[36:39], s48 offen sc1
  ds_read_b64_tr_b16 a[80:81], v231 offset:0
  ds_read_b64_tr_b16 a[82:83], v231 offset:2048
  ds_read_b64_tr_b16 a[84:85], v231 offset:4096
  ds_read_b64_tr_b16 a[86:87], v231 offset:6144
  ds_read_b64_tr_b16 a[88:89], v232 offset:0
  ds_read_b64_tr_b16 a[90:91], v232 offset:2048
  ds_read_b64_tr_b16 a[92:93], v232 offset:4096
  ds_read_b64_tr_b16 a[94:95], v232 offset:6144
  ds_read_b64_tr_b16 a[96:97], v233 offset:0
  ds_read_b64_tr_b16 a[98:99], v233 offset:2048
  ds_read_b64_tr_b16 a[100:101], v233 offset:4096
  ds_read_b64_tr_b16 a[102:103], v233 offset:6144
  ds_read_b64_tr_b16 a[104:105], v234 offset:0
  ds_read_b64_tr_b16 a[106:107], v234 offset:2048
  ds_read_b64_tr_b16 a[108:109], v234 offset:4096
  ds_read_b64_tr_b16 a[110:111], v234 offset:6144
  ds_read_b64_tr_b16 a[112:113], v231 offset:8192
  ds_read_b64_tr_b16 a[114:115], v231 offset:10240
  ds_read_b64_tr_b16 a[116:117], v231 offset:12288
  ds_read_b64_tr_b16 a[118:119], v231 offset:14336
  ds_read_b64_tr_b16 a[120:121], v232 offset:8192
  ds_read_b64_tr_b16 a[122:123], v232 offset:10240
  ds_read_b64_tr_b16 a[124:125], v232 offset:12288
  ds_read_b64_tr_b16 a[126:127], v232 offset:14336
  ds_read_b64_tr_b16 a[128:129], v233 offset:8192
  ds_read_b64_tr_b16 a[130:131], v233 offset:10240
  ds_read_b64_tr_b16 a[132:133], v233 offset:12288
  ds_read_b64_tr_b16 a[134:135], v233 offset:14336
  ds_read_b64_tr_b16 a[136:137], v234 offset:8192
  ds_read_b64_tr_b16 a[138:139], v234 offset:10240
  ds_read_b64_tr_b16 a[140:141], v234 offset:12288
  ds_read_b64_tr_b16 a[142:143], v234 offset:14336
  s_cmp_lg_u32 s44, 0
  s_cbranch_scc1 SM3x
  s_mov_b32 s46, 60000
  s_mov_b32 s47, 5242880
SM3:
  buffer_load_dword v13, v249, s[36:39], s47 offen sc1
  s_sub_u32 s46, s46, 1
  s_cmp_eq_u32 s46, 0
  s_waitcnt vmcnt(0)
  s_cbranch_scc1 SM3x
  v_cmp_ne_u32 vcc, s3, v13
  s_nop 4
  s_cbranch_vccnz SM3
SM3x:
  s_waitcnt vmcnt(1)
  s_barrier
  s_lshl_b32 s50, s76, 13
  buffer_load_dwordx4 a[0:3], v243, s[36:39], s50 offen offset:0 sc1
  buffer_load_dwordx4 a[8:11], v243, s[36:39], s50 offen offset:2048 sc1
  buffer_load_dwordx4 a[4:7], v243, s[36:39], s50 offen offset:1024 sc1
  buffer_load_dwordx4 a[12:15], v243, s[36:39], s50 offen offset:3072 sc1
  s_add_u32 s50, s50, 4096
  s_and_b32 s50, s50, 0xffff
  buffer_load_dwordx4 a[16:19], v243, s[36:39], s50 offen offset:0 sc1
  buffer_load_dwordx4 a[20:23], v243, s[36:39], s50 offen offset:1024 sc1
  buffer_load_dwordx4 a[24:27], v243, s[36:39], s50 offen offset:2048 sc1
  buffer_load_dwordx4 a[28:31], v243, s[36:39], s50 offen offset:3072 sc1
  ds_read_b64_tr_b16 a[144:145], v231 offset:16384
  ds_read_b64_tr_b16 a[146:147], v231 offset:18432
  ds_read_b64_tr_b16 a[148:149], v231 offset:20480
  ds_read_b64_tr_b16 a[150:151], v231 offset:22528
  ds_read_b64_tr_b16 a[152:153], v232 offset:16384
  ds_read_b64_tr_b16 a[154:155], v232 offset:18432
  ds_read_b64_tr_b16 a[156:157], v232 offset:20480
  ds_read_b64_tr_b16 a[158:159], v232 offset:22528
  ds_read_b64_tr_b16 a[160:161], v233 offset:16384
  ds_read_b64_tr_b16 a[162:163], v233 offset:18432
  ds_read_b64_tr_b16 a[164:165], v233 offset:20480
  ds_read_b64_tr_b16 a[166:167], v233 offset:22528
  ds_read_b64_tr_b16 a[168:169], v234 offset:16384
  ds_read_b64_tr_b16 a[170:171], v234 offset:18432
  ds_read_b64_tr_b16 a[172:173], v234 offset:20480
  ds_read_b64_tr_b16 a[174:175], v234 offset:22528
  ds_read_b64_tr_b16 a[176:177], v231 offset:24576
  ds_read_b64_tr_b16 a[178:179], v231 offset:26624
  ds_read_b64_tr_b16 a[180:181], v231 offset:28672
  ds_read_b64_tr_b16 a[182:183], v231 offset:30720
  ds_read_b64_tr_b16 a[184:185], v232 offset:24576
  ds_read_b64_tr_b16 a[186:187], v232 offset:26624
  ds_read_b64_tr_b16 a[188:189], v232 offset:28672
  ds_read_b64_tr_b16 a[190:191], v232 offset:30720
  ds_read_b64_tr_b16 a[192:193], v233 offset:24576
  ds_read_b64_tr_b16 a[194:195], v233 offset:26624
  ds_read_b64_tr_b16 a[196:197], v233 offset:28672
  ds_read_b64_tr_b16 a[198:199], v233 offset:30720
  ds_read_b64_tr_b16 a[200:201], v234 offset:24576
  ds_read_b64_tr_b16 a[202:203], v234 offset:26624
  ds_read_b64_tr_b16 a[204:205], v234 offset:28672
  ds_read_b64_tr_b16 a[206:207], v234 offset:30720
  ds_read_b64_tr_b16 a[208:209], v231 offset:32768
  ds_read_b64_tr_b16 a[210:211], v231 offset:34816
  ds_read_b64_tr_b16 a[212:213], v231 offset:36864
  ds_read_b64_tr_b16 a[214:215], v231 offset:38912
  ds_read_b64_tr_b16 a[216:217], v232 offset:32768
  ds_read_b64_tr_b16 a[218:219], v232 offset:34816
  ds_read_b64_tr_b16 a[220:221], v232 offset:36864
  ds_read_b64_tr_b16 a[222:223], v232 offset:38912
  ds_read_b64 v[116:117], v239 offset:0
  ds_read_b64 v[118:119], v240 offset:0
  ds_read_b64 v[120:121], v241 offset:0
  ds_read_b64 v[122:123], v242 offset:0
  ds_read_b64 v[124:125], v239 offset:2048
  ds_read_b64 v[126:127], v240 offset:2048
  ds_read_b64 v[128:129], v241 offset:2048
  ds_read_b64 v[130:131], v242 offset:2048
  v_lshrrev_b32 v13, 4, v10
  v_cmp_eq_u32 vcc, 2, v13
  s_add_u32 s51, s73, 4096
  s_nop 0
  v_cndmask_b32 v13, 0, 1.0, vcc
  s_waitcnt lgkmcnt(0)
  v_lshlrev_b32 v52, 16, v116
  v_and_b32 v53, 0xffff0000, v116
  v_lshlrev_b32 v54, 16, v117
  v_and_b32 v55, 0xffff0000, v117
  v_lshlrev_b32 v56, 16, v118
  v_and_b32 v57, 0xffff0000, v118
  v_lshlrev_b32 v58, 16, v119
  v_and_b32 v59, 0xffff0000, v119
  v_lshlrev_b32 v60, 16, v120
  v_and_b32 v61, 0xffff0000, v120
  v_lshlrev_b32 v62, 16, v121
  v_and_b32 v63, 0xffff0000, v121
  v_lshlrev_b32 v64, 16, v122
  v_and_b32 v65, 0xffff0000, v122
  v_lshlrev_b32 v66, 16, v123
  v_and_b32 v67, 0xffff0000, v123
  v_lshlrev_b32 v68, 16, v124
  v_and_b32 v69, 0xffff0000, v124
  v_lshlrev_b32 v70, 16, v125
  v_and_b32 v71, 0xffff0000, v125
  v_lshlrev_b32 v72, 16, v126
  v_and_b32 v73, 0xffff0000, v126
  v_lshlrev_b32 v74, 16, v127
  v_and_b32 v75, 0xffff0000, v127
  v_lshlrev_b32 v76, 16, v128
  v_and_b32 v77, 0xffff0000, v128
  v_lshlrev_b32 v78, 16, v129
  v_and_b32 v79, 0xffff0000, v129
  v_lshlrev_b32 v80, 16, v130
  v_and_b32 v81, 0xffff0000, v130
  v_lshlrev_b32 v82, 16, v131
  v_and_b32 v83, 0xffff0000, v131
  s_waitcnt vmcnt(7) lgkmcnt(15)
  v_mfma_f32_16x16x32_bf16 v[20:23], a[80:83], a[0:3], 0
  s_waitcnt vmcnt(6)
  s_add_u32 s50, s50, 4096
  s_and_b32 s50, s50, 0xffff
  v_mfma_f32_16x16x32_bf16 v[20:23], a[84:87], a[8:11], v[20:23]
  s_waitcnt vmcnt(4)
  buffer_load_dwordx4 a[32:35], v243, s[36:39], s50 offen offset:0 sc1
  v_mfma_f32_16x16x32_bf16 v[24:27], a[84:87], a[12:15], 0
  s_waitcnt vmcnt(6)
  buffer_load_dwordx4 a[36:39], v243, s[36:39], s50 offen offset:1024 sc1
  v_mfma_f32_16x16x32_bf16 v[24:27], a[80:83], a[4:7], v[24:27]
  s_waitcnt lgkmcnt(15)
  ds_read_b64_tr_b16 a[80:81], v233 offset:32768
  ds_read_b64_tr_b16 a[82:83], v233 offset:34816
  v_mfma_f32_16x16x32_bf16 v[32:35], a[88:91], a[4:7], 0
  ds_read_b64_tr_b16 a[84:85], v233 offset:36864
  ds_read_b64_tr_b16 a[86:87], v233 offset:38912
  v_mfma_f32_16x16x32_bf16 v[32:35], a[92:95], a[12:15], v[32:35]
  buffer_load_dwordx4 a[40:43], v243, s[36:39], s50 offen offset:2048 sc1
  v_mfma_f32_16x16x32_bf16 v[28:31], a[92:95], a[8:11], 0
  buffer_load_dwordx4 a[44:47], v243, s[36:39], s50 offen offset:3072 sc1
  v_mfma_f32_16x16x32_bf16 v[28:31], a[88:91], a[0:3], v[28:31]
  s_waitcnt lgkmcnt(15)
  s_add_u32 s50, s50, 4096
  s_and_b32 s50, s50, 0xffff
  v_mfma_f32_16x16x32_bf16 v[36:39], a[96:99], a[0:3], 0
  ds_read_b64_tr_b16 a[88:89], v234 offset:32768
  ds_read_b64_tr_b16 a[90:91], v234 offset:34816
  v_mfma_f32_16x16x32_bf16 v[36:39], a[100:103], a[8:11], v[36:39]
  ds_read_b64_tr_b16 a[92:93], v234 offset:36864
  buffer_load_dwordx4 a[48:51], v243, s[36:39], s50 offen offset:0 sc1
  v_mfma_f32_16x16x32_bf16 v[40:43], a[100:103], a[12:15], 0
  ds_read_b64_tr_b16 a[94:95], v234 offset:38912
  buffer_load_dwordx4 a[52:55], v243, s[36:39], s50 offen offset:1024 sc1
  v_mfma_f32_16x16x32_bf16 v[40:43], a[96:99], a[4:7], v[40:43]
  s_waitcnt lgkmcnt(15)
  ds_read_b64_tr_b16 a[96:97], v231 offset:40960
  ds_read_b64_tr_b16 a[98:99], v231 offset:43008
  v_mfma_f32_16x16x32_bf16 v[48:51], a[104:107], a[4:7], 0
  s_mov_b32 s49, 0
  buffer_load_dwordx4 a[56:59], v243, s[36:39], s50 offen offset:2048 sc1
  ds_read_b64_tr_b16 a[100:101], v231 offset:45056
  v_mfma_f32_16x16x32_bf16 v[48:51], a[108:111], a[12:15], v[48:51]
  buffer_load_dwordx4 v[156:159], v248, s[36:39], s49 offen sc1
  s_mov_b32 s49, 24576
  v_mfma_f32_16x16x32_bf16 v[44:47], a[108:111], a[8:11], 0
  buffer_load_dwordx4 v[160:163], v248, s[36:39], s49 offen sc1
  s_mov_b32 s49, 49152
  v_mfma_f32_16x16x32_bf16 v[44:47], a[104:107], a[0:3], v[44:47]
  s_waitcnt vmcnt(9) lgkmcnt(15)
  buffer_load_dwordx4 v[164:167], v248, s[36:39], s49 offen sc1
  s_mov_b32 s49, 73728
  v_mfma_f32_16x16x32_bf16 v[20:23], a[112:115], a[16:19], v[20:23]
  buffer_load_dwordx4 v[168:171], v248, s[36:39], s49 offen sc1
  buffer_load_dwordx4 a[60:63], v243, s[36:39], s50 offen offset:3072 sc1
  v_mfma_f32_16x16x32_bf16 v[20:23], a[116:119], a[24:27], v[20:23]
  s_add_u32 s50, s50, 4096
  ds_read_b64_tr_b16 a[102:103], v231 offset:47104
  s_and_b32 s50, s50, 0xffff
  v_mfma_f32_16x16x32_bf16 v[24:27], a[116:119], a[28:31], v[24:27]
  ds_read_b64_tr_b16 a[104:105], v232 offset:40960
  buffer_load_dwordx4 a[64:67], v243, s[36:39], s50 offen offset:0 sc1
  v_mfma_f32_16x16x32_bf16 v[24:27], a[112:115], a[20:23], v[24:27]
  s_waitcnt lgkmcnt(15)
  ds_read_b64_tr_b16 a[106:107], v232 offset:43008
  ds_read_b64_tr_b16 a[108:109], v232 offset:45056
  v_mfma_f32_16x16x32_bf16 v[32:35], a[120:123], a[20:23], v[32:35]
  buffer_load_dwordx4 a[68:71], v243, s[36:39], s50 offen offset:1024 sc1
  ds_read_b64_tr_b16 a[110:111], v232 offset:47104
  v_mfma_f32_16x16x32_bf16 v[32:35], a[124:127], a[28:31], v[32:35]
  buffer_load_dwordx4 a[72:75], v243, s[36:39], s50 offen offset:2048 sc1
  ds_read_b64_tr_b16 a[112:113], v233 offset:40960
  v_mfma_f32_16x16x32_bf16 v[28:31], a[124:127], a[24:27], v[28:31]
  ds_read_b64_tr_b16 a[114:115], v233 offset:43008
  buffer_load_dwordx4 a[76:79], v243, s[36:39], s50 offen offset:3072 sc1
  v_mfma_f32_16x16x32_bf16 v[28:31], a[120:123], a[16:19], v[28:31]
  s_waitcnt lgkmcnt(15)
  s_add_u32 s50, s50, 4096
  s_and_b32 s50, s50, 0xffff
  v_mfma_f32_16x16x32_bf16 v[36:39], a[128:131], a[16:19], v[36:39]
  ds_read_b64_tr_b16 a[116:117], v233 offset:45056
  buffer_load_dwordx4 a[0:3], v243, s[36:39], s50 offen offset:0 sc1
  v_mfma_f32_16x16x32_bf16 v[36:39], a[132:135], a[24:27], v[36:39]
  ds_read_b64_tr_b16 a[118:119], v233 offset:47104
  ds_read_b64_tr_b16 a[120:121], v234 offset:40960
  v_mfma_f32_16x16x32_bf16 v[40:43], a[132:135], a[28:31], v[40:43]
  buffer_load_dwordx4 a[4:7], v243, s[36:39], s50 offen offset:1024 sc1
  ds_read_b64_tr_b16 a[122:123], v234 offset:43008
  v_mfma_f32_16x16x32_bf16 v[40:43], a[128:131], a[20:23], v[40:43]
  s_waitcnt lgkmcnt(15)
  v_mfma_f32_16x16x32_bf16 v[48:51], a[136:139], a[20:23], v[48:51]
  buffer_load_dwordx4 a[8:11], v243, s[36:39], s50 offen offset:2048 sc1
  ds_read_b64_tr_b16 a[124:125], v234 offset:45056
  v_mfma_f32_16x16x32_bf16 v[48:51], a[140:143], a[28:31], v[48:51]
Ha2_1:
  s_cbranch_execz Ra
  ds_read_b64_tr_b16 a[126:127], v234 offset:47104
  v_mfma_f32_16x16x32_bf16 v[44:47], a[140:143], a[24:27], v[44:47]
  buffer_load_dwordx4 a[12:15], v243, s[36:39], s50 offen offset:3072 sc1
  ds_read_b64_tr_b16 a[128:129], v231 offset:49152
  v_mfma_f32_16x16x32_bf16 v[44:47], a[136:139], a[16:19], v[44:47]
  s_waitcnt vmcnt(16) lgkmcnt(15)
  v_mfma_f32_16x16x32_bf16 v[20:23], a[144:147], a[32:35], v[20:23]
  s_add_u32 s50, s50, 4096
  s_and_b32 s50, s50, 0xffff
  ds_read_b64_tr_b16 a[130:131], v231 offset:51200
  v_mfma_f32_16x16x32_bf16 v[20:23], a[148:151], a[40:43], v[20:23]
  buffer_load_dwordx4 a[16:19], v243, s[36:39], s50 offen offset:0 sc1
  ds_read_b64_tr_b16 a[132:133], v231 offset:53248
  v_mfma_f32_16x16x32_bf16 v[24:27], a[148:151], a[44:47], v[24:27]
  ds_read_b64_tr_b16 a[134:135], v231 offset:55296
  v_mfma_f32_16x16x32_bf16 v[24:27], a[144:147], a[36:39], v[24:27]
  s_waitcnt lgkmcnt(15)
  ds_read_b64_tr_b16 a[136:137], v232 offset:49152
  v_mfma_f32_16x16x32_bf16 v[32:35], a[152:155], a[36:39], v[32:35]
  v_mfma_f32_16x16x32_bf16 v[32:35], a[156:159], a[44:47], v[32:35]
  buffer_load_dwordx4 a[20:23], v243, s[36:39], s50 offen offset:1024 sc1
  ds_read_b64_tr_b16 a[138:139], v232 offset:51200
  v_mfma_f32_16x16x32_bf16 v[28:31], a[156:159], a[40:43], v[28:31]
  ds_read_b64_tr_b16 a[140:141], v232 offset:53248
  v_mfma_f32_16x16x32_bf16 v[28:31], a[152:155], a[32:35], v[28:31]
  s_waitcnt lgkmcnt(15)
  ds_read_b64_tr_b16 a[142:143], v232 offset:55296
  v_mfma_f32_16x16x32_bf16 v[36:39], a[160:163], a[32:35], v[36:39]
  v_mfma_f32_16x16x32_bf16 v[36:39], a[164:167], a[40:43], v[36:39]
  buffer_load_dwordx4 a[24:27], v243, s[36:39], s50 offen offset:2048 sc1
  ds_read_b64_tr_b16 a[144:145], v233 offset:49152
  v_mfma_f32_16x16x32_bf16 v[40:43], a[164:167], a[44:47], v[40:43]
  ds_read_b64_tr_b16 a[146:147], v233 offset:51200
  v_mfma_f32_16x16x32_bf16 v[40:43], a[160:163], a[36:39], v[40:43]
  s_waitcnt lgkmcnt(15)
  ds_read_b64_tr_b16 a[148:149], v233 offset:53248
  v_mfma_f32_16x16x32_bf16 v[48:51], a[168:171], a[36:39], v[48:51]
  ds_read_b64_tr_b16 a[150:151], v233 offset:55296
  v_mfma_f32_16x16x32_bf16 v[48:51], a[172:175], a[44:47], v[48:51]
  buffer_load_dwordx4 a[28:31], v243, s[36:39], s50 offen offset:3072 sc1
  v_mfma_f32_16x16x32_bf16 v[44:47], a[172:175], a[40:43], v[44:47]
  ds_read_b64_tr_b16 a[152:153], v234 offset:49152
  v_mfma_f32_16x16x32_bf16 v[44:47], a[168:171], a[32:35], v[44:47]
  s_waitcnt vmcnt(12) lgkmcnt(15)
  ds_read_b64_tr_b16 a[154:155], v234 offset:51200
  v_mfma_f32_16x16x32_bf16 v[20:23], a[176:179], a[48:51], v[20:23]
  s_add_u32 s50, s50, 4096
  s_and_b32 s50, s50, 0xffff
  ds_read_b64_tr_b16 a[156:157], v234 offset:53248
  v_mfma_f32_16x16x32_bf16 v[20:23], a[180:183], a[56:59], v[20:23]
  buffer_load_dwordx4 a[32:35], v243, s[36:39], s50 offen offset:0 sc1
  v_mfma_f32_16x16x32_bf16 v[24:27], a[180:183], a[60:63], v[24:27]
  ds_read_b64_tr_b16 a[158:159], v234 offset:55296
  v_mfma_f32_16x16x32_bf16 v[24:27], a[176:179], a[52:55], v[24:27]
  s_waitcnt lgkmcnt(15)
  ds_read_b64_tr_b16 a[160:161], v231 offset:57344
  v_mfma_f32_16x16x32_bf16 v[32:35], a[184:187], a[52:55], v[32:35]
  ds_read_b64_tr_b16 a[162:163], v231 offset:59392
  v_mfma_f32_16x16x32_bf16 v[32:35], a[188:191], a[60:63], v[32:35]
  buffer_load_dwordx4 a[36:39], v243, s[36:39], s50 offen offset:1024 sc1
  ds_read_b64_tr_b16 a[164:165], v231 offset:61440
  v_mfma_f32_16x16x32_bf16 v[28:31], a[188:191], a[56:59], v[28:31]
  v_mfma_f32_16x16x32_bf16 v[28:31], a[184:187], a[48:51], v[28:31]
  s_waitcnt lgkmcnt(15)
  ds_read_b64_tr_b16 a[166:167], v231 offset:63488
  v_mfma_f32_16x16x32_bf16 v[36:39], a[192:195], a[48:51], v[36:39]
  ds_read_b64_tr_b16 a[168:169], v232 offset:57344
  v_mfma_f32_16x16x32_bf16 v[36:39], a[196:199], a[56:59], v[36:39]
  buffer_load_dwordx4 a[40:43], v243, s[36:39], s50 offen offset:2048 sc1
  ds_read_b64_tr_b16 a[170:171], v232 offset:59392
  v_mfma_f32_16x16x32_bf16 v[40:43], a[196:199], a[60:63], v[40:43]
  v_mfma_f32_16x16x32_bf16 v[40:43], a[192:195], a[52:55], v[40:43]
  s_waitcnt lgkmcnt(15)
  ds_read_b64_tr_b16 a[172:173], v232 offset:61440
  v_mfma_f32_16x16x32_bf16 v[48:51], a[200:203], a[52:55], v[48:51]
  ds_read_b64_tr_b16 a[174:175], v232 offset:63488
  v_mfma_f32_16x16x32_bf16 v[48:51], a[204:207], a[60:63], v[48:51]
  buffer_load_dwordx4 a[44:47], v243, s[36:39], s50 offen offset:3072 sc1
  ds_read_b64_tr_b16 a[176:177], v233 offset:57344
  v_mfma_f32_16x16x32_bf16 v[44:47], a[204:207], a[56:59], v[44:47]
  ds_read_b64_tr_b16 a[178:179], v233 offset:59392
  v_mfma_f32_16x16x32_bf16 v[44:47], a[200:203], a[48:51], v[44:47]
  s_waitcnt vmcnt(12) lgkmcnt(15)
  v_mfma_f32_16x16x32_bf16 v[20:23], a[208:211], a[64:67], v[20:23]
  s_add_u32 s50, s50, 4096
  s_and_b32 s50, s50, 0xffff
  ds_read_b64_tr_b16 a[180:181], v233 offset:61440
  v_mfma_f32_16x16x32_bf16 v[20:23], a[212:215], a[72:75], v[20:23]
  buffer_load_dwordx4 a[48:51], v243, s[36:39], s50 offen offset:0 sc1
  ds_read_b64_tr_b16 a[182:183], v233 offset:63488
  v_mfma_f32_16x16x32_bf16 v[24:27], a[212:215], a[76:79], v[24:27]
  ds_read_b64_tr_b16 a[184:185], v234 offset:57344
  v_mfma_f32_16x16x32_bf16 v[24:27], a[208:211], a[68:71], v[24:27]
  s_waitcnt lgkmcnt(15)
  ds_read_b64_tr_b16 a[186:187], v234 offset:59392
  v_mfma_f32_16x16x32_bf16 v[32:35], a[216:219], a[68:71], v[32:35]
  v_mfma_f32_16x16x32_bf16 v[32:35], a[220:223], a[76:79], v[32:35]
  buffer_load_dwordx4 a[52:55], v243, s[36:39], s50 offen offset:1024 sc1
  ds_read_b64_tr_b16 a[188:189], v234 offset:61440
  v_mfma_f32_16x16x32_bf16 v[28:31], a[220:223], a[72:75], v[28:31]
  ds_read_b64_tr_b16 a[190:191], v234 offset:63488
  v_mfma_f32_16x16x32_bf16 v[28:31], a[216:219], a[64:67], v[28:31]
  s_waitcnt lgkmcnt(15)
  ds_read_b64_tr_b16 a[192:193], v235 offset:0
  v_mfma_f32_16x16x32_bf16 v[36:39], a[80:83], a[64:67], v[36:39]
  v_mfma_f32_16x16x32_bf16 v[36:39], a[84:87], a[72:75], v[36:39]
  buffer_load_dwordx4 a[56:59], v243, s[36:39], s50 offen offset:2048 sc1
  ds_read_b64_tr_b16 a[194:195], v235 offset:2048
  v_mfma_f32_16x16x32_bf16 v[40:43], a[84:87], a[76:79], v[40:43]
  ds_read_b64_tr_b16 a[196:197], v235 offset:4096
  v_mfma_f32_16x16x32_bf16 v[40:43], a[80:83], a[68:71], v[40:43]
  s_waitcnt lgkmcnt(15)
  ds_read_b64_tr_b16 a[198:199], v235 offset:6144
  v_mfma_f32_16x16x32_bf16 v[48:51], a[88:91], a[68:71], v[48:51]
  ds_read_b64_tr_b16 a[200:201], v236 offset:0
  v_mfma_f32_16x16x32_bf16 v[48:51], a[92:95], a[76:79], v[48:51]
  buffer_load_dwordx4 a[60:63], v243, s[36:39], s50 offen offset:3072 sc1
  v_mfma_f32_16x16x32_bf16 v[44:47], a[92:95], a[72:75], v[44:47]
  ds_read_b64_tr_b16 a[202:203], v236 offset:2048
  v_mfma_f32_16x16x32_bf16 v[44:47], a[88:91], a[64:67], v[44:47]
  s_waitcnt vmcnt(12) lgkmcnt(15)
  ds_read_b64_tr_b16 a[204:205], v236 offset:4096
  v_mfma_f32_16x16x32_bf16 v[20:23], a[96:99], a[0:3], v[20:23]
  s_add_u32 s50, s50, 4096
  s_and_b32 s50, s50, 0xffff
  ds_read_b64_tr_b16 a[206:207], v236 offset:6144
  v_mfma_f32_16x16x32_bf16 v[20:23], a[100:103], a[8:11], v[20:23]
  buffer_load_dwordx4 a[64:67], v243, s[36:39], s50 offen offset:0 sc1
  v_mfma_f32_16x16x32_bf16 v[24:27], a[100:103], a[12:15], v[24:27]
  ds_read_b64_tr_b16 a[208:209], v237 offset:0
  v_mfma_f32_16x16x32_bf16 v[24:27], a[96:99], a[4:7], v[24:27]
  s_waitcnt lgkmcnt(15)
  ds_read_b64_tr_b16 a[210:211], v237 offset:2048
  v_mfma_f32_16x16x32_bf16 v[32:35], a[104:107], a[4:7], v[32:35]
  ds_read_b64_tr_b16 a[212:213], v237 offset:4096
  v_mfma_f32_16x16x32_bf16 v[32:35], a[108:111], a[12:15], v[32:35]
  buffer_load_dwordx4 a[68:71], v243, s[36:39], s50 offen offset:1024 sc1
  ds_read_b64_tr_b16 a[214:215], v237 offset:6144
  v_mfma_f32_16x16x32_bf16 v[28:31], a[108:111], a[8:11], v[28:31]
  v_mfma_f32_16x16x32_bf16 v[28:31], a[104:107], a[0:3], v[28:31]
  s_waitcnt lgkmcnt(15)
  ds_read_b64_tr_b16 a[216:217], v238 offset:0
  v_mfma_f32_16x16x32_bf16 v[36:39], a[112:115], a[0:3], v[36:39]
  s_waitcnt vmcnt(23)
  ds_read_b64_tr_b16 a[218:219], v238 offset:2048
  v_max_u32 v15, v156, v157
  v_mfma_f32_16x16x32_bf16 v[36:39], a[116:119], a[8:11], v[36:39]
  buffer_load_dwordx4 a[72:75], v243, s[36:39], s50 offen offset:2048 sc1
  ds_read_b64_tr_b16 a[220:221], v238 offset:4096
  v_mfma_f32_16x16x32_bf16 v[40:43], a[116:119], a[12:15], v[40:43]
  v_max3_u32 v15, v15, v158, v159
  v_max3_u32 v15, v15, v160, v161
  v_mfma_f32_16x16x32_bf16 v[40:43], a[112:115], a[4:7], v[40:43]
  s_waitcnt lgkmcnt(15)
  ds_read_b64_tr_b16 a[222:223], v238 offset:6144
  v_max3_u32 v15, v15, v162, v163
  v_mfma_f32_16x16x32_bf16 v[48:51], a[120:123], a[4:7], v[48:51]
  ds_read_b64_tr_b16 a[80:81], v235 offset:8192
  v_max3_u32 v15, v15, v164, v165
  v_mfma_f32_16x16x32_bf16 v[48:51], a[124:127], a[12:15], v[48:51]
  buffer_load_dwordx4 a[76:79], v243, s[36:39], s50 offen offset:3072 sc1
  ds_read_b64_tr_b16 a[82:83], v235 offset:10240
  v_mfma_f32_16x16x32_bf16 v[44:47], a[124:127], a[8:11], v[44:47]
  ds_read_b64_tr_b16 a[84:85], v235 offset:12288
  v_max3_u32 v15, v15, v166, v167
  v_mfma_f32_16x16x32_bf16 v[44:47], a[120:123], a[0:3], v[44:47]
  s_waitcnt vmcnt(12) lgkmcnt(15)
  v_max3_u32 v15, v15, v168, v169
  v_max3_u32 v15, v15, v170, v171
  v_mfma_f32_16x16x32_bf16 v[20:23], a[128:131], a[16:19], v[20:23]
  s_add_u32 s50, s50, 4096
  s_and_b32 s50, s50, 0xffff
  ds_read_b64_tr_b16 a[86:87], v235 offset:14336
  v_mfma_f32_16x16x32_bf16 v[20:23], a[132:135], a[24:27], v[20:23]
  buffer_load_dwordx4 a[0:3], v243, s[36:39], s50 offen offset:0 sc1
  ds_read_b64_tr_b16 a[88:89], v236 offset:8192
  v_mfma_f32_16x16x32_bf16 v[24:27], a[132:135], a[28:31], v[24:27]
  ds_read_b64_tr_b16 a[90:91], v236 offset:10240
  v_mfma_f32_16x16x32_bf16 v[24:27], a[128:131], a[20:23], v[24:27]
  s_waitcnt lgkmcnt(15)
  v_cmp_eq_u32 vcc, -1, v15
  s_nop 4
  s_cbranch_vccnz CK4s
CK4x:
  v_mfma_f32_16x16x32_bf16 v[32:35], a[136:139], a[20:23], v[32:35]
  ds_read_b64_tr_b16 a[92:93], v236 offset:12288
  v_add_f32 v156, v156, v164
  v_mfma_f32_16x16x32_bf16 v[32:35], a[140:143], a[28:31], v[32:35]
  buffer_load_dwordx4 a[4:7], v243, s[36:39], s50 offen offset:1024 sc1
  ds_read_b64_tr_b16 a[94:95], v236 offset:14336
  v_mfma_f32_16x16x32_bf16 v[28:31], a[140:143], a[24:27], v[28:31]
  ds_read_b64_tr_b16 a[96:97], v237 offset:8192
  v_add_f32 v157, v157, v165
  v_mfma_f32_16x16x32_bf16 v[28:31], a[136:139], a[16:19], v[28:31]
  s_waitcnt lgkmcnt(15)
  ds_read_b64_tr_b16 a[98:99], v237 offset:10240
  v_add_f32 v158, v158, v166
  v_mfma_f32_16x16x32_bf16 v[36:39], a[144:147], a[16:19], v[36:39]
  v_add_f32 v159, v159, v167
  v_add_f32 v160, v160, v168
  v_mfma_f32_16x16x32_bf16 v[36:39], a[148:151], a[24:27], v[36:39]
  buffer_load_dwordx4 a[8:11], v243, s[36:39], s50 offen offset:2048 sc1
  ds_read_b64_tr_b16 a[100:101], v237 offset:12288
  v_mfma_f32_16x16x32_bf16 v[40:43], a[148:151], a[28:31], v[40:43]
  ds_read_b64_tr_b16 a[102:103], v237 offset:14336
  v_add_f32 v161, v161, v169
  v_mfma_f32_16x16x32_bf16 v[40:43], a[144:147], a[20:23], v[40:43]
  s_waitcnt lgkmcnt(15)
  ds_read_b64_tr_b16 a[104:105], v238 offset:8192
  v_add_f32 v162, v162, v170
  v_mfma_f32_16x16x32_bf16 v[48:51], a[152:155], a[20:23], v[48:51]
  v_add_f32 v163, v163, v171
  v_add_f32 v156, v156, v160
  v_mfma_f32_16x16x32_bf16 v[48:51], a[156:159], a[28:31], v[48:51]
  buffer_load_dwordx4 a[12:15], v243, s[36:39], s50 offen offset:3072 sc1
  ds_read_b64_tr_b16 a[106:107], v238 offset:10240
  v_mfma_f32_16x16x32_bf16 v[44:47], a[156:159], a[24:27], v[44:47]
  ds_read_b64_tr_b16 a[108:109], v238 offset:12288
  v_add_f32 v157, v157, v161
  v_mfma_f32_16x16x32_bf16 v[44:47], a[152:155], a[16:19], v[44:47]
  s_waitcnt vmcnt(12) lgkmcnt(15)
  ds_read_b64_tr_b16 a[110:111], v238 offset:14336
  v_add_f32 v158, v158, v162
  v_mfma_f32_16x16x32_bf16 v[20:23], a[160:163], a[32:35], v[20:23]
  s_add_u32 s50, s50, 4096
  s_and_b32 s50, s50, 0xffff
  ds_read_b64_tr_b16 a[112:113], v235 offset:16384
  v_mfma_f32_16x16x32_bf16 v[20:23], a[164:167], a[40:43], v[20:23]
  buffer_load_dwordx4 a[16:19], v243, s[36:39], s50 offen offset:0 sc1
  v_add_f32 v159, v159, v163
  v_mfma_f32_16x16x32_bf16 v[24:27], a[164:167], a[44:47], v[24:27]
  ds_read_b64_tr_b16 a[114:115], v235 offset:18432
  v_cvt_pk_bf16_f32 v160, v156, v157
  v_mfma_f32_16x16x32_bf16 v[24:27], a[160:163], a[36:39], v[24:27]
  s_waitcnt lgkmcnt(15)
  ds_read_b64_tr_b16 a[116:117], v235 offset:20480
  v_lshlrev_b32 v156, 16, v160
  v_mfma_f32_16x16x32_bf16 v[32:35], a[168:171], a[36:39], v[32:35]
  ds_read_b64_tr_b16 a[118:119], v235 offset:22528
  v_and_b32 v157, 0xffff0000, v160
  v_mfma_f32_16x16x32_bf16 v[32:35], a[172:175], a[44:47], v[32:35]
  buffer_load_dwordx4 a[20:23], v243, s[36:39], s50 offen offset:1024 sc1
  v_cvt_pk_bf16_f32 v161, v158, v159
  v_mfma_f32_16x16x32_bf16 v[28:31], a[172:175], a[40:43], v[28:31]
  ds_read_b64_tr_b16 a[120:121], v236 offset:16384
  v_lshlrev_b32 v158, 16, v161
  v_mfma_f32_16x16x32_bf16 v[28:31], a[168:171], a[32:35], v[28:31]
  s_waitcnt lgkmcnt(15)
  ds_read_b64_tr_b16 a[122:123], v236 offset:18432
  v_and_b32 v159, 0xffff0000, v161
  v_mfma_f32_16x16x32_bf16 v[36:39], a[176:179], a[32:35], v[36:39]
  ds_read_b64_tr_b16 a[124:125], v236 offset:20480
  v_add_f32 v156, v13, v156
  v_mfma_f32_16x16x32_bf16 v[36:39], a[180:183], a[40:43], v[36:39]
  buffer_load_dwordx4 a[24:27], v243, s[36:39], s50 offen offset:2048 sc1
  ds_read_b64_tr_b16 a[126:127], v236 offset:22528
  v_mfma_f32_16x16x32_bf16 v[40:43], a[180:183], a[44:47], v[40:43]
  v_add_f32 v157, v13, v157
  v_add_f32 v158, v13, v158
  v_mfma_f32_16x16x32_bf16 v[40:43], a[176:179], a[36:39], v[40:43]
  s_waitcnt lgkmcnt(15)
  ds_read_b64_tr_b16 a[128:129], v237 offset:16384
  v_add_f32 v159, v13, v159
  v_mfma_f32_16x16x32_bf16 v[48:51], a[184:187], a[36:39], v[48:51]
  ds_read_b64_tr_b16 a[130:131], v237 offset:18432
  v_cvt_pk_bf16_f32 v160, v156, v157
  v_mfma_f32_16x16x32_bf16 v[48:51], a[188:191], a[44:47], v[48:51]
  buffer_load_dwordx4 a[28:31], v243, s[36:39], s50 offen offset:3072 sc1
  ds_read_b64_tr_b16 a[132:133], v237 offset:20480
  v_mfma_f32_16x16x32_bf16 v[44:47], a[188:191], a[40:43], v[44:47]
  ds_read_b64_tr_b16 a[134:135], v237 offset:22528
  v_lshlrev_b32 v156, 16, v160
  v_mfma_f32_16x16x32_bf16 v[44:47], a[184:187], a[32:35], v[44:47]
  s_waitcnt vmcnt(12) lgkmcnt(15)
  v_and_b32 v157, 0xffff0000, v160
  v_cvt_pk_bf16_f32 v161, v158, v159
  v_mfma_f32_16x16x32_bf16 v[20:23], a[192:195], a[48:51], v[20:23]
  s_add_u32 s50, s50, 4096
  s_and_b32 s50, s50, 0xffff
  ds_read_b64_tr_b16 a[136:137], v238 offset:16384
  v_mfma_f32_16x16x32_bf16 v[20:23], a[196:199], a[56:59], v[20:23]
  buffer_load_dwordx4 a[32:35], v243, s[36:39], s50 offen offset:0 sc1
  ds_read_b64_tr_b16 a[138:139], v238 offset:18432
  v_mfma_f32_16x16x32_bf16 v[24:27], a[196:199], a[60:63], v[24:27]
  ds_read_b64_tr_b16 a[140:141], v238 offset:20480
  v_lshlrev_b32 v158, 16, v161
  v_mfma_f32_16x16x32_bf16 v[24:27], a[192:195], a[52:55], v[24:27]
  s_waitcnt lgkmcnt(15)
  v_and_b32 v159, 0xffff0000, v161
  v_mfma_f32_16x16x32_bf16 v[32:35], a[200:203], a[52:55], v[32:35]
  ds_write_b128 v246, v[156:159]
  ds_read_b128 v[84:87], v244 offset:0
  v_mfma_f32_16x16x32_bf16 v[32:35], a[204:207], a[60:63], v[32:35]
  ds_read_b128 v[100:103], v244 offset:512
  ds_read_b128 v[88:91], v244 offset:64
  v_mfma_f32_16x16x32_bf16 v[28:31], a[204:207], a[56:59], v[28:31]
  ds_read_b128 v[104:107], v244 offset:576
  ds_read_b128 v[92:95], v244 offset:128
  v_mfma_f32_16x16x32_bf16 v[28:31], a[200:203], a[48:51], v[28:31]
  s_waitcnt lgkmcnt(15)
  ds_read_b128 v[108:111], v244 offset:640
  ds_read_b128 v[96:99], v244 offset:192
  v_mfma_f32_16x16x32_bf16 v[36:39], a[208:211], a[48:51], v[36:39]
  ds_read_b128 v[112:115], v244 offset:704
  ds_read_b128 v[116:119], v245 offset:512
  v_mfma_f32_16x16x32_bf16 v[36:39], a[212:215], a[56:59], v[36:39]
  ds_read_b128 v[120:123], v245 offset:576
  ds_read_b128 v[124:127], v245 offset:640
  v_mfma_f32_16x16x32_bf16 v[40:43], a[212:215], a[60:63], v[40:43]
  ds_read_b128 v[128:131], v245 offset:704
  ds_read_b64_tr_b16 a[142:143], v238 offset:22528
  v_mfma_f32_16x16x32_bf16 v[40:43], a[208:211], a[52:55], v[40:43]
  s_waitcnt lgkmcnt(15)
  buffer_load_dwordx4 a[36:39], v243, s[36:39], s50 offen offset:1024 sc1
  ds_read_b64_tr_b16 a[144:145], v235 offset:24576
  v_mfma_f32_16x16x32_bf16 v[48:51], a[216:219], a[52:55], v[48:51]
  ds_read_b64_tr_b16 a[146:147], v235 offset:26624
  ds_read_b64_tr_b16 a[148:149], v235 offset:28672
  v_mfma_f32_16x16x32_bf16 v[48:51], a[220:223], a[60:63], v[48:51]
  buffer_load_dwordx4 a[40:43], v243, s[36:39], s50 offen offset:2048 sc1
  ds_read_b64_tr_b16 a[150:151], v235 offset:30720
  v_mfma_f32_16x16x32_bf16 v[44:47], a[220:223], a[56:59], v[44:47]
  ds_read_b64_tr_b16 a[152:153], v236 offset:24576
  ds_read_b64_tr_b16 a[154:155], v236 offset:26624
  v_mfma_f32_16x16x32_bf16 v[44:47], a[216:219], a[48:51], v[44:47]
  s_waitcnt vmcnt(11) lgkmcnt(15)
  buffer_load_dwordx4 a[44:47], v243, s[36:39], s50 offen offset:3072 sc1
  ds_read_b64_tr_b16 a[156:157], v236 offset:28672
  v_mfma_f32_16x16x32_bf16 v[20:23], a[80:83], a[64:67], v[20:23]
  s_add_u32 s50, s50, 4096
  ds_read_b64_tr_b16 a[158:159], v236 offset:30720
  ds_read_b64_tr_b16 a[160:161], v237 offset:24576
  v_mfma_f32_16x16x32_bf16 v[20:23], a[84:87], a[72:75], v[20:23]
  s_and_b32 s50, s50, 0xffff
  ds_read_b64_tr_b16 a[162:163], v237 offset:26624
  buffer_load_dwordx4 a[48:51], v243, s[36:39], s50 offen offset:0 sc1
  v_mfma_f32_16x16x32_bf16 v[24:27], a[84:87], a[76:79], v[24:27]
  ds_read_b64_tr_b16 a[164:165], v237 offset:28672
  v_accvgpr_write_b32 a248, v156
  v_mfma_f32_16x16x32_bf16 v[24:27], a[80:83], a[68:71], v[24:27]
  s_waitcnt lgkmcnt(15)
  ds_read_b64_tr_b16 a[166:167], v237 offset:30720
  v_accvgpr_write_b32 a249, v157
  v_mfma_f32_16x16x32_bf16 v[32:35], a[88:91], a[68:71], v[32:35]
  ds_read_b64_tr_b16 a[168:169], v238 offset:24576
  v_accvgpr_write_b32 a250, v158
  v_mfma_f32_16x16x32_bf16 v[32:35], a[92:95], a[76:79], v[32:35]
  buffer_load_dwordx4 a[52:55], v243, s[36:39], s50 offen offset:1024 sc1
  v_accvgpr_write_b32 a251, v159
  v_mfma_f32_16x16x32_bf16 v[28:31], a[92:95], a[72:75], v[28:31]
  s_waitcnt lgkmcnt(14)
  ds_read_b64_tr_b16 a[170:171], v238 offset:26624
  v_cvt_pk_bf16_f32 v148, v116, v117
  v_mfma_f32_16x16x32_bf16 v[28:31], a[88:91], a[64:67], v[28:31]
  s_waitcnt lgkmcnt(15)
  ds_read_b64_tr_b16 a[172:173], v238 offset:28672
  v_cvt_pk_bf16_f32 v149, v118, v119
  v_mfma_f32_16x16x32_bf16 v[36:39], a[96:99], a[64:67], v[36:39]
  ds_read_b64_tr_b16 a[174:175], v238 offset:30720
  v_cvt_pk_bf16_f32 v150, v120, v121
  v_mfma_f32_16x16x32_bf16 v[36:39], a[100:103], a[72:75], v[36:39]
  buffer_load_dwordx4 a[56:59], v243, s[36:39], s50 offen offset:2048 sc1
  ds_read_b64_tr_b16 a[176:177], v235 offset:32768
  v_mfma_f32_16x16x32_bf16 v[40:43], a[100:103], a[76:79], v[40:43]
  v_cvt_pk_bf16_f32 v151, v122, v123
  v_cvt_pk_bf16_f32 v152, v124, v125
  v_mfma_f32_16x16x32_bf16 v[40:43], a[96:99], a[68:71], v[40:43]
  s_waitcnt lgkmcnt(15)
  ds_read_b64_tr_b16 a[178:179], v235 offset:34816
  v_cvt_pk_bf16_f32 v153, v126, v127
  v_mfma_f32_16x16x32_bf16 v[48:51], a[104:107], a[68:71], v[48:51]
  ds_read_b64_tr_b16 a[180:181], v235 offset:36864
  v_cvt_pk_bf16_f32 v154, v128, v129
  v_mfma_f32_16x16x32_bf16 v[48:51], a[108:111], a[76:79], v[48:51]
  buffer_load_dwordx4 a[60:63], v243, s[36:39], s50 offen offset:3072 sc1
  ds_read_b64_tr_b16 a[182:183], v235 offset:38912
  v_mfma_f32_16x16x32_bf16 v[44:47], a[108:111], a[72:75], v[44:47]
  v_cvt_pk_bf16_f32 v155, v130, v131
  v_mfma_f32_16x16x32_bf16 v[44:47], a[104:107], a[64:67], v[44:47]
  s_waitcnt vmcnt(12) lgkmcnt(15)
  buffer_store_dwordx4 v[148:151], v0, s[36:39], s75 offen offset:0 sc1
  buffer_store_dwordx4 v[152:155], v0, s[36:39], s75 offen offset:1024 sc1
  v_mfma_f32_16x16x32_bf16 v[20:23], a[112:115], a[0:3], v[20:23]
  s_add_u32 s50, s50, 4096
  ds_read_b64_tr_b16 a[184:185], v236 offset:32768
  s_and_b32 s50, s50, 0xffff
  v_mfma_f32_16x16x32_bf16 v[20:23], a[116:119], a[8:11], v[20:23]
  ds_read_b64_tr_b16 a[186:187], v236 offset:34816
  buffer_load_dwordx4 a[64:67], v243, s[36:39], s50 offen offset:0 sc1
  v_mfma_f32_16x16x32_bf16 v[24:27], a[116:119], a[12:15], v[24:27]
  ds_read_b64_tr_b16 a[188:189], v236 offset:36864
  ds_read_b64_tr_b16 a[190:191], v236 offset:38912
  v_mfma_f32_16x16x32_bf16 v[24:27], a[112:115], a[4:7], v[24:27]
  s_waitcnt lgkmcnt(15)
  v_mfma_f32_16x16x32_bf16 v[32:35], a[120:123], a[4:7], v[32:35]
  ds_read_b64_tr_b16 a[192:193], v237 offset:32768
  v_mfma_f32_16x16x32_bf16 v[32:35], a[124:127], a[12:15], v[32:35]
  buffer_load_dwordx4 a[68:71], v243, s[36:39], s50 offen offset:1024 sc1
  ds_read_b64_tr_b16 a[194:195], v237 offset:34816
  v_mfma_f32_16x16x32_bf16 v[28:31], a[124:127], a[8:11], v[28:31]
  ds_read_b64_tr_b16 a[196:197], v237 offset:36864
  v_mfma_f32_16x16x32_bf16 v[28:31], a[120:123], a[0:3], v[28:31]
  s_waitcnt lgkmcnt(15)
  v_mfma_f32_16x16x32_bf16 v[36:39], a[128:131], a[0:3], v[36:39]
  ds_read_b64_tr_b16 a[198:199], v237 offset:38912
  v_mfma_f32_16x16x32_bf16 v[36:39], a[132:135], a[8:11], v[36:39]
  buffer_load_dwordx4 a[72:75], v243, s[36:39], s50 offen offset:2048 sc1
  ds_read_b64_tr_b16 a[200:201], v238 offset:32768
  v_mfma_f32_16x16x32_bf16 v[40:43], a[132:135], a[12:15], v[40:43]
  ds_read_b64_tr_b16 a[202:203], v238 offset:34816
  v_mfma_f32_16x16x32_bf16 v[40:43], a[128:131], a[4:7], v[40:43]
  s_waitcnt lgkmcnt(15)
  ds_read_b64_tr_b16 a[204:205], v238 offset:36864
  v_mfma_f32_16x16x32_bf16 v[48:51], a[136:139], a[4:7], v[48:51]
  v_mfma_f32_16x16x32_bf16 v[48:51], a[140:143], a[12:15], v[48:51]
  buffer_load_dwordx4 a[76:79], v243, s[36:39], s50 offen offset:3072 sc1
  ds_read_b64_tr_b16 a[206:207], v238 offset:38912
  v_mfma_f32_16x16x32_bf16 v[44:47], a[140:143], a[8:11], v[44:47]
  ds_read_b64_tr_b16 a[208:209], v235 offset:40960
  v_mfma_f32_16x16x32_bf16 v[44:47], a[136:139], a[0:3], v[44:47]
  s_waitcnt vmcnt(14) lgkmcnt(15)
  ds_read_b64_tr_b16 a[210:211], v235 offset:43008
  v_mfma_f32_16x16x32_bf16 v[20:23], a[144:147], a[16:19], v[20:23]
  s_add_u32 s50, s50, 4096
  s_and_b32 s50, s50, 0xffff
  v_mfma_f32_16x16x32_bf16 v[20:23], a[148:151], a[24:27], v[20:23]
  buffer_load_dwordx4 a[0:3], v243, s[36:39], s50 offen offset:0 sc1
  ds_read_b64_tr_b16 a[212:213], v235 offset:45056
  v_mfma_f32_16x16x32_bf16 v[24:27], a[148:151], a[28:31], v[24:27]
  ds_read_b64_tr_b16 a[214:215], v235 offset:47104
  v_mfma_f32_16x16x32_bf16 v[24:27], a[144:147], a[20:23], v[24:27]
  s_waitcnt lgkmcnt(15)
  ds_read_b64_tr_b16 a[216:217], v236 offset:40960
  v_mfma_f32_16x16x32_bf16 v[32:35], a[152:155], a[20:23], v[32:35]
  ds_read_b64_tr_b16 a[218:219], v236 offset:43008
  v_mfma_f32_16x16x32_bf16 v[32:35], a[156:159], a[28:31], v[32:35]
  buffer_load_dwordx4 a[4:7], v243, s[36:39], s50 offen offset:1024 sc1
  v_mfma_f32_16x16x32_bf16 v[28:31], a[156:159], a[24:27], v[28:31]
  ds_read_b64_tr_b16 a[220:221], v236 offset:45056
  v_mfma_f32_16x16x32_bf16 v[28:31], a[152:155], a[16:19], v[28:31]
  s_waitcnt lgkmcnt(15)
  ds_read_b64_tr_b16 a[222:223], v236 offset:47104
  v_mfma_f32_16x16x32_bf16 v[36:39], a[160:163], a[16:19], v[36:39]
  ds_read_b64_tr_b16 a[80:81], v237 offset:40960
  v_mfma_f32_16x16x32_bf16 v[36:39], a[164:167], a[24:27], v[36:39]
  buffer_load_dwordx4 a[8:11], v243, s[36:39], s50 offen offset:2048 sc1
  ds_read_b64_tr_b16 a[82:83], v237 offset:43008
  v_mfma_f32_16x16x32_bf16 v[40:43], a[164:167], a[28:31], v[40:43]
  v_mfma_f32_16x16x32_bf16 v[40:43], a[160:163], a[20:23], v[40:43]
  s_waitcnt lgkmcnt(15)
  ds_read_b64_tr_b16 a[84:85], v237 offset:45056
  v_mfma_f32_16x16x32_bf16 v[48:51], a[168:171], a[20:23], v[48:51]
  ds_read_b64_tr_b16 a[86:87], v237 offset:47104
  v_mfma_f32_16x16x32_bf16 v[48:51], a[172:175], a[28:31], v[48:51]
  buffer_load_dwordx4 a[12:15], v243, s[36:39], s50 offen offset:3072 sc1
  ds_read_b64_tr_b16 a[88:89], v238 offset:40960
  v_mfma_f32_16x16x32_bf16 v[44:47], a[172:175], a[24:27], v[44:47]
  v_mfma_f32_16x16x32_bf16 v[44:47], a[168:171], a[16:19], v[44:47]
  s_waitcnt vmcnt(14) lgkmcnt(15)
  ds_read_b64_tr_b16 a[90:91], v238 offset:43008
  v_mfma_f32_16x16x32_bf16 v[20:23], a[176:179], a[32:35], v[20:23]
  ds_read_b64_tr_b16 a[92:93], v238 offset:45056
  v_mfma_f32_16x16x32_bf16 v[20:23], a[180:183], a[40:43], v[20:23]
  ds_read_b64_tr_b16 a[94:95], v238 offset:47104
  v_mfma_f32_16x16x32_bf16 v[24:27], a[180:183], a[44:47], v[24:27]
  ds_read_b64_tr_b16 a[96:97], v235 offset:49152
  v_mfma_f32_16x16x32_bf16 v[24:27], a[176:179], a[36:39], v[24:27]
  s_waitcnt lgkmcnt(15)
  v_mfma_f32_16x16x32_bf16 v[32:35], a[184:187], a[36:39], v[32:35]
  ds_read_b64_tr_b16 a[98:99], v235 offset:51200
  v_mfma_f32_16x16x32_bf16 v[32:35], a[188:191], a[44:47], v[32:35]
  ds_read_b64_tr_b16 a[100:101], v235 offset:53248
  v_mfma_f32_16x16x32_bf16 v[28:31], a[188:191], a[40:43], v[28:31]
  ds_read_b64_tr_b16 a[102:103], v235 offset:55296
  v_mfma_f32_16x16x32_bf16 v[28:31], a[184:187], a[32:35], v[28:31]
  s_waitcnt lgkmcnt(15)
  v_mfma_f32_16x16x32_bf16 v[36:39], a[192:195], a[32:35], v[36:39]
  ds_read_b64_tr_b16 a[104:105], v236 offset:49152
  v_mfma_f32_16x16x32_bf16 v[36:39], a[196:199], a[40:43], v[36:39]
  ds_read_b64_tr_b16 a[106:107], v236 offset:51200
  v_mfma_f32_16x16x32_bf16 v[40:43], a[196:199], a[44:47], v[40:43]
  ds_read_b64_tr_b16 a[108:109], v236 offset:53248
  v_mfma_f32_16x16x32_bf16 v[40:43], a[192:195], a[36:39], v[40:43]
  s_waitcnt lgkmcnt(15)
  ds_read_b64_tr_b16 a[110:111], v236 offset:55296
  v_mfma_f32_16x16x32_bf16 v[48:51], a[200:203], a[36:39], v[48:51]
  v_mfma_f32_16x16x32_bf16 v[48:51], a[204:207], a[44:47], v[48:51]
  ds_read_b64_tr_b16 a[112:113], v237 offset:49152
  v_mfma_f32_16x16x32_bf16 v[44:47], a[204:207], a[40:43], v[44:47]
  ds_read_b64_tr_b16 a[114:115], v237 offset:51200
  v_mfma_f32_16x16x32_bf16 v[44:47], a[200:203], a[32:35], v[44:47]
  s_waitcnt vmcnt(10) lgkmcnt(15)
  ds_read_b64_tr_b16 a[116:117], v237 offset:53248
  v_mfma_f32_16x16x32_bf16 v[20:23], a[208:211], a[48:51], v[20:23]
  v_mfma_f32_16x16x32_bf16 v[20:23], a[212:215], a[56:59], v[20:23]
  ds_read_b64_tr_b16 a[118:119], v237 offset:55296
  v_mfma_f32_16x16x32_bf16 v[24:27], a[212:215], a[60:63], v[24:27]
  ds_read_b64_tr_b16 a[120:121], v238 offset:49152
  v_mfma_f32_16x16x32_bf16 v[24:27], a[208:211], a[52:55], v[24:27]
  s_waitcnt lgkmcnt(15)
  ds_read_b64_tr_b16 a[122:123], v238 offset:51200
  v_mfma_f32_16x16x32_bf16 v[32:35], a[216:219], a[52:55], v[32:35]
  ds_read_b64_tr_b16 a[124:125], v238 offset:53248
  v_mfma_f32_16x16x32_bf16 v[32:35], a[220:223], a[60:63], v[32:35]
  v_mfma_f32_16x16x32_bf16 v[28:31], a[220:223], a[56:59], v[28:31]
  ds_read_b64_tr_b16 a[126:127], v238 offset:55296
  v_mfma_f32_16x16x32_bf16 v[28:31], a[216:219], a[48:51], v[28:31]
  s_waitcnt lgkmcnt(15)
  ds_read_b64_tr_b16 a[128:129], v235 offset:57344
  v_mfma_f32_16x16x32_bf16 v[36:39], a[80:83], a[48:51], v[36:39]
  ds_read_b64_tr_b16 a[130:131], v235 offset:59392
  v_mfma_f32_16x16x32_bf16 v[36:39], a[84:87], a[56:59], v[36:39]
  v_mfma_f32_16x16x32_bf16 v[40:43], a[84:87], a[60:63], v[40:43]
  ds_read_b64_tr_b16 a[132:133], v235 offset:61440
  v_mfma_f32_16x16x32_bf16 v[40:43], a[80:83], a[52:55], v[40:43]
  s_waitcnt lgkmcnt(15)
  ds_read_b64_tr_b16 a[134:135], v235 offset:63488
  v_mfma_f32_16x16x32_bf16 v[48:51], a[88:91], a[52:55], v[48:51]
  ds_read_b64_tr_b16 a[136:137], v236 offset:57344
  v_mfma_f32_16x16x32_bf16 v[48:51], a[92:95], a[60:63], v[48:51]
  ds_read_b64_tr_b16 a[138:139], v236 offset:59392
  v_mfma_f32_16x16x32_bf16 v[44:47], a[92:95], a[56:59], v[44:47]
  v_mfma_f32_16x16x32_bf16 v[44:47], a[88:91], a[48:51], v[44:47]
  s_waitcnt vmcnt(4) lgkmcnt(15)
  ds_read_b64_tr_b16 a[140:141], v236 offset:61440
  v_mfma_f32_16x16x32_bf16 v[20:23], a[96:99], a[64:67], v[20:23]
  ds_read_b64_tr_b16 a[142:143], v236 offset:63488
  v_mfma_f32_16x16x32_bf16 v[20:23], a[100:103], a[72:75], v[20:23]
  ds_read_b64_tr_b16 a[144:145], v237 offset:57344
  v_mfma_f32_16x16x32_bf16 v[24:27], a[100:103], a[76:79], v[24:27]
  v_mfma_f32_16x16x32_bf16 v[24:27], a[96:99], a[68:71], v[24:27]
  s_waitcnt lgkmcnt(15)
  ds_read_b64_tr_b16 a[146:147], v237 offset:59392
  v_mfma_f32_16x16x32_bf16 v[32:35], a[104:107], a[68:71], v[32:35]
  ds_read_b64_tr_b16 a[148:149], v237 offset:61440
  v_mfma_f32_16x16x32_bf16 v[32:35], a[108:111], a[76:79], v[32:35]
  ds_read_b64_tr_b16 a[150:151], v237 offset:63488
  v_mfma_f32_16x16x32_bf16 v[28:31], a[108:111], a[72:75], v[28:31]
  ds_read_b64_tr_b16 a[152:153], v238 offset:57344
  v_mfma_f32_16x16x32_bf16 v[28:31], a[104:107], a[64:67], v[28:31]
  s_waitcnt lgkmcnt(15)
  v_mfma_f32_16x16x32_bf16 v[36:39], a[112:115], a[64:67], v[36:39]
  ds_read_b64_tr_b16 a[154:155], v238 offset:59392
  v_mfma_f32_16x16x32_bf16 v[36:39], a[116:119], a[72:75], v[36:39]
  ds_read_b64_tr_b16 a[156:157], v238 offset:61440
  v_mfma_f32_16x16x32_bf16 v[40:43], a[116:119], a[76:79], v[40:43]
  ds_read_b64_tr_b16 a[158:159], v238 offset:63488
  v_mfma_f32_16x16x32_bf16 v[40:43], a[112:115], a[68:71], v[40:43]
  s_waitcnt lgkmcnt(15)
  v_mfma_f32_16x16x32_bf16 v[48:51], a[120:123], a[68:71], v[48:51]
  v_mfma_f32_16x16x32_bf16 v[48:51], a[124:127], a[76:79], v[48:51]
Ha0_2:
  s_cbranch_execz Ra
  v_mfma_f32_16x16x32_bf16 v[44:47], a[124:127], a[72:75], v[44:47]
  v_mfma_f32_16x16x32_bf16 v[44:47], a[120:123], a[64:67], v[44:47]
  s_waitcnt vmcnt(0) lgkmcnt(12)
  v_mfma_f32_16x16x32_bf16 v[20:23], a[128:131], a[0:3], v[20:23]
  v_mfma_f32_16x16x32_bf16 v[20:23], a[132:135], a[8:11], v[20:23]
  v_mfma_f32_16x16x32_bf16 v[24:27], a[132:135], a[12:15], v[24:27]
  v_mfma_f32_16x16x32_bf16 v[24:27], a[128:131], a[4:7], v[24:27]
  s_waitcnt lgkmcnt(8)
  v_mfma_f32_16x16x32_bf16 v[32:35], a[136:139], a[4:7], v[32:35]
  v_mfma_f32_16x16x32_bf16 v[32:35], a[140:143], a[12:15], v[32:35]
  v_mfma_f32_16x16x32_bf16 v[28:31], a[140:143], a[8:11], v[28:31]
  v_mfma_f32_16x16x32_bf16 v[28:31], a[136:139], a[0:3], v[28:31]
  s_waitcnt lgkmcnt(4)
  v_mfma_f32_16x16x32_bf16 v[36:39], a[144:147], a[0:3], v[36:39]
  v_mfma_f32_16x16x32_bf16 v[36:39], a[148:151], a[8:11], v[36:39]
  v_mfma_f32_16x16x32_bf16 v[40:43], a[148:151], a[12:15], v[40:43]
  v_mfma_f32_16x16x32_bf16 v[40:43], a[144:147], a[4:7], v[40:43]
  s_waitcnt lgkmcnt(0)
  v_mfma_f32_16x16x32_bf16 v[48:51], a[152:155], a[4:7], v[48:51]
  v_mfma_f32_16x16x32_bf16 v[48:51], a[156:159], a[12:15], v[48:51]
  v_mfma_f32_16x16x32_bf16 v[44:47], a[156:159], a[8:11], v[44:47]
  v_mfma_f32_16x16x32_bf16 v[44:47], a[152:155], a[0:3], v[44:47]
  s_waitcnt lgkmcnt(0)
  s_nop 2
  v_fmac_f32 v52, v84, v20
  v_fmac_f32 v53, v85, v21
  v_fmac_f32 v54, v86, v22
  v_fmac_f32 v55, v87, v23
  v_mul_f32 v20, v52, v100
  v_mul_f32 v21, v53, v101
  v_mul_f32 v22, v54, v102
  v_mul_f32 v23, v55, v103
  v_cvt_pk_bf16_f32 v132, v20, v21
  v_cvt_pk_bf16_f32 v133, v22, v23
  v_fmac_f32 v56, v88, v28
  v_fmac_f32 v57, v89, v29
  v_fmac_f32 v58, v90, v30
  v_fmac_f32 v59, v91, v31
  v_mul_f32 v28, v56, v104
  v_mul_f32 v29, v57, v105
  v_mul_f32 v30, v58, v106
  v_mul_f32 v31, v59, v107
  v_cvt_pk_bf16_f32 v134, v28, v29
  v_cvt_pk_bf16_f32 v135, v30, v31
  buffer_store_dwordx4 v[132:135], v0, s[36:39], s73 offen offset:0 sc1
  v_fmac_f32 v60, v92, v36
  v_fmac_f32 v61, v93, v37
  v_fmac_f32 v62, v94, v38
  v_fmac_f32 v63, v95, v39
  v_mul_f32 v36, v60, v108
  v_mul_f32 v37, v61, v109
  v_mul_f32 v38, v62, v110
  v_mul_f32 v39, v63, v111
  v_cvt_pk_bf16_f32 v136, v36, v37
  v_cvt_pk_bf16_f32 v137, v38, v39
  v_fmac_f32 v64, v96, v44
  v_fmac_f32 v65, v97, v45
  v_fmac_f32 v66, v98, v46
  v_fmac_f32 v67, v99, v47
  v_mul_f32 v44, v64, v112
  v_mul_f32 v45, v65, v113
  v_mul_f32 v46, v66, v114
  v_mul_f32 v47, v67, v115
  v_cvt_pk_bf16_f32 v138, v44, v45
  v_cvt_pk_bf16_f32 v139, v46, v47
  buffer_store_dwordx4 v[136:139], v0, s[36:39], s51 offen offset:0 sc1
  v_fmac_f32 v68, v84, v24
  v_fmac_f32 v69, v85, v25
  v_fmac_f32 v70, v86, v26
  v_fmac_f32 v71, v87, v27
  v_mul_f32 v24, v68, v100
  v_mul_f32 v25, v69, v101
  v_mul_f32 v26, v70, v102
  v_mul_f32 v27, v71, v103
  v_cvt_pk_bf16_f32 v140, v24, v25
  v_cvt_pk_bf16_f32 v141, v26, v27
  v_fmac_f32 v72, v88, v32
  v_fmac_f32 v73, v89, v33
  v_fmac_f32 v74, v90, v34
  v_fmac_f32 v75, v91, v35
  v_mul_f32 v32, v72, v104
  v_mul_f32 v33, v73, v105
  v_mul_f32 v34, v74, v106
  v_mul_f32 v35, v75, v107
  v_cvt_pk_bf16_f32 v142, v32, v33
  v_cvt_pk_bf16_f32 v143, v34, v35
  buffer_store_dwordx4 v[140:143], v0, s[36:39], s73 offen offset:1024 sc1
  v_fmac_f32 v76, v92, v40
  v_fmac_f32 v77, v93, v41
  v_fmac_f32 v78, v94, v42
  v_fmac_f32 v79, v95, v43
  v_mul_f32 v40, v76, v108
  v_mul_f32 v41, v77, v109
  v_mul_f32 v42, v78, v110
  v_mul_f32 v43, v79, v111
  v_cvt_pk_bf16_f32 v144, v40, v41
  v_cvt_pk_bf16_f32 v145, v42, v43
  v_fmac_f32 v80, v96, v48
  v_fmac_f32 v81, v97, v49
  v_fmac_f32 v82, v98, v50
  v_fmac_f32 v83, v99, v51
  v_mul_f32 v48, v80, v112
  v_mul_f32 v49, v81, v113
  v_mul_f32 v50, v82, v114
  v_mul_f32 v51, v83, v115
  v_cvt_pk_bf16_f32 v146, v48, v49
  v_cvt_pk_bf16_f32 v147, v50, v51
  buffer_store_dwordx4 v[144:147], v0, s[36:39], s51 offen offset:1024 sc1
  v_add_f32 v20, v52, v53
  v_mul_f32 v21, v52, v52
  v_add_f32 v24, v54, v55
  v_mul_f32 v25, v53, v53
  v_fmac_f32 v21, v54, v54
  v_fmac_f32 v25, v55, v55
  v_fmac_f32 v21, v56, v56
  v_add_f32 v20, v20, v56
  v_fmac_f32 v25, v57, v57
  v_add_f32 v24, v24, v57
  v_fmac_f32 v21, v58, v58
  v_add_f32 v20, v20, v58
  v_fmac_f32 v25, v59, v59
  v_add_f32 v24, v24, v59
  v_fmac_f32 v21, v60, v60
  v_add_f32 v20, v20, v60
  v_fmac_f32 v25, v61, v61
  v_add_f32 v24, v24, v61
  v_fmac_f32 v21, v62, v62
  v_add_f32 v20, v20, v62
  v_fmac_f32 v25, v63, v63
  v_add_f32 v24, v24, v63
  v_fmac_f32 v21, v64, v64
  v_add_f32 v20, v20, v64
  v_fmac_f32 v25, v65, v65
  v_add_f32 v24, v24, v65
  v_fmac_f32 v21, v66, v66
  v_add_f32 v20, v20, v66
  v_fmac_f32 v25, v67, v67
  v_add_f32 v24, v24, v67
  v_add_f32 v22, v68, v69
  v_mul_f32 v23, v68, v68
  v_add_f32 v26, v70, v71
  v_mul_f32 v27, v69, v69
  v_fmac_f32 v23, v70, v70
  v_fmac_f32 v27, v71, v71
  v_fmac_f32 v23, v72, v72
  v_add_f32 v22, v22, v72
  v_fmac_f32 v27, v73, v73
  v_add_f32 v26, v26, v73
  v_fmac_f32 v23, v74, v74
  v_add_f32 v22, v22, v74
  v_fmac_f32 v27, v75, v75
  v_add_f32 v26, v26, v75
  v_fmac_f32 v23, v76, v76
  v_add_f32 v22, v22, v76
  v_fmac_f32 v27, v77, v77
  v_add_f32 v26, v26, v77
  v_fmac_f32 v23, v78, v78
  v_add_f32 v22, v22, v78
  v_fmac_f32 v27, v79, v79
  v_add_f32 v26, v26, v79
  v_fmac_f32 v23, v80, v80
  v_add_f32 v22, v22, v80
  v_fmac_f32 v27, v81, v81
  v_add_f32 v26, v26, v81
  v_fmac_f32 v23, v82, v82
  v_add_f32 v22, v22, v82
  v_fmac_f32 v27, v83, v83
  v_add_f32 v26, v26, v83
  v_add_f32 v20, v20, v24
  v_add_f32 v21, v21, v25
  v_add_f32 v22, v22, v26
  v_add_f32 v23, v23, v27
  v_mov_b32 v24, v20
  v_mov_b32 v25, v21
  v_mov_b32 v26, v22
  v_mov_b32 v27, v23
  v_permlane16_swap_b32 v20, v24
  v_permlane16_swap_b32 v21, v25
  v_permlane16_swap_b32 v22, v26
  v_permlane16_swap_b32 v23, v27
  v_add_f32 v20, v20, v24
  v_add_f32 v21, v21, v25
  v_add_f32 v22, v22, v26
  v_add_f32 v23, v23, v27
  v_mov_b32 v24, v20
  v_mov_b32 v25, v21
  v_mov_b32 v26, v22
  v_mov_b32 v27, v23
  v_permlane32_swap_b32 v20, v24
  v_permlane32_swap_b32 v21, v25
  v_permlane32_swap_b32 v22, v26
  v_permlane32_swap_b32 v23, v27
  v_add_f32 v20, v20, v24
  v_add_f32 v21, v21, v25
  v_add_f32 v22, v22, v26
  v_add_f32 v23, v23, v27
  s_mov_b64 exec, 0xffff
  buffer_store_dwordx4 v[20:23], v0, s[36:39], s74 offen sc1
  s_mov_b64 exec, -1
  v_cvt_pk_bf16_f32 v116, v52, v53
  v_cvt_pk_bf16_f32 v117, v54, v55
  v_cvt_pk_bf16_f32 v118, v56, v57
  v_cvt_pk_bf16_f32 v119, v58, v59
  v_cvt_pk_bf16_f32 v120, v60, v61
  v_cvt_pk_bf16_f32 v121, v62, v63
  v_cvt_pk_bf16_f32 v122, v64, v65
  v_cvt_pk_bf16_f32 v123, v66, v67
  v_cvt_pk_bf16_f32 v124, v68, v69
  v_cvt_pk_bf16_f32 v125, v70, v71
  v_cvt_pk_bf16_f32 v126, v72, v73
  v_cvt_pk_bf16_f32 v127, v74, v75
  v_cvt_pk_bf16_f32 v128, v76, v77
  v_cvt_pk_bf16_f32 v129, v78, v79
  v_cvt_pk_bf16_f32 v130, v80, v81
  v_cvt_pk_bf16_f32 v131, v82, v83
  v_accvgpr_write_b32 a232, v116
  v_accvgpr_write_b32 a233, v117
  v_accvgpr_write_b32 a234, v118
  v_accvgpr_write_b32 a235, v119
  v_accvgpr_write_b32 a236, v120
  v_accvgpr_write_b32 a237, v121
  v_accvgpr_write_b32 a238, v122
  v_accvgpr_write_b32 a239, v123
  v_accvgpr_write_b32 a240, v124
  v_accvgpr_write_b32 a241, v125
  v_accvgpr_write_b32 a242, v126
  v_accvgpr_write_b32 a243, v127
  v_accvgpr_write_b32 a244, v128
  v_accvgpr_write_b32 a245, v129
  v_accvgpr_write_b32 a246, v130
  v_accvgpr_write_b32 a247, v131
  v_mov_b32 v12, s3
  s_waitcnt vmcnt(0) lgkmcnt(0)
  s_barrier
  s_mov_b64 exec, 1
  buffer_store_dword v12, v0, s[36:39], s45 offen sc1
  s_mov_b64 exec, -1
  s_bfe_u32 s56, s84, 0x40000
  s_mul_i32 s56, s56, 458752
  s_add_u32 m0, s77, 0
  s_nop 0
  buffer_load_dwordx4 v3, s[16:19], s56 offen offset:0 lds
  buffer_load_dwordx4 v4, s[16:19], s56 offen offset:1024 lds
  buffer_load_dwordx4 v5, s[16:19], s56 offen offset:2048 lds
  buffer_load_dwordx4 v6, s[16:19], s56 offen offset:3072 lds
  s_add_u32 m0, s77, 4096
  s_nop 0
  buffer_load_dwordx4 v7, s[16:19], s56 offen offset:0 lds
  buffer_load_dwordx4 v8, s[16:19], s56 offen offset:1024 lds
  buffer_load_dwordx4 v9, s[16:19], s56 offen offset:2048 lds
  s_bfe_u32 s56, s84, 0x40004
  s_mul_i32 s56, s56, 458752
  s_add_u32 m0, s77, 28672
  s_nop 0
  buffer_load_dwordx4 v3, s[16:19], s56 offen offset:0 lds
  buffer_load_dwordx4 v4, s[16:19], s56 offen offset:1024 lds
  buffer_load_dwordx4 v5, s[16:19], s56 offen offset:2048 lds
  buffer_load_dwordx4 v6, s[16:19], s56 offen offset:3072 lds
  s_add_u32 m0, s77, 32768
  s_nop 0
  buffer_load_dwordx4 v7, s[16:19], s56 offen offset:0 lds
  buffer_load_dwordx4 v8, s[16:19], s56 offen offset:1024 lds
  buffer_load_dwordx4 v9, s[16:19], s56 offen offset:2048 lds
  s_bfe_u32 s57, s84, 0x40000
  s_lshl_b32 s57, s57, 13
  s_add_u32 s57, s57, s86
  s_lshl2_add_u32 s48, s2, s44
  s_cmp_eq_u32 s48, 1
  s_cbranch_scc1 CKSs
CKSx:
  s_mov_b64 exec, 0
  s_cmp_eq_u32 s44, 1
  s_cbranch_scc1 Hb0
  s_cmp_eq_u32 s44, 2
  s_cbranch_scc1 Hb1
  s_cmp_eq_u32 s44, 3
  s_cbranch_scc1 Hb2
Rb:
  s_mov_b64 exec, -1
G3S:
  s_cmp_lg_u32 s44, 0
  s_cbranch_scc1 SM5x
  s_mov_b32 s46, 60000
  s_mov_b32 s47, 5242880
SM5:
  buffer_load_dword v13, v250, s[36:39], s47 offen sc1
  s_sub_u32 s46, s46, 1
  s_cmp_eq_u32 s46, 0
  s_waitcnt vmcnt(0)
  s_cbranch_scc1 SM5x
  v_cmp_ne_u32 vcc, s3, v13
  s_nop 4
  s_cbranch_vccnz SM5
SM5x:
  s_waitcnt vmcnt(7)
  s_barrier
  buffer_load_dwordx4 a[0:3], v0, s[36:39], s57 offen offset:0 sc1
  buffer_load_dwordx4 a[4:7], v0, s[36:39], s57 offen offset:1024 sc1
  buffer_load_dwordx4 a[8:11], v0, s[36:39], s57 offen offset:2048 sc1
  buffer_load_dwordx4 a[12:15], v0, s[36:39], s57 offen offset:3072 sc1
  s_add_u32 s57, s57, 4096
  buffer_load_dwordx4 a[16:19], v0, s[36:39], s57 offen offset:0 sc1
  buffer_load_dwordx4 a[20:23], v0, s[36:39], s57 offen offset:1024 sc1
  buffer_load_dwordx4 a[24:27], v0, s[36:39], s57 offen offset:2048 sc1
  buffer_load_dwordx4 a[28:31], v0, s[36:39], s57 offen offset:3072 sc1
  ds_read_b64_tr_b16 a[128:129], v1 offset:0
  ds_read_b64_tr_b16 a[130:131], v1 offset:3584
  ds_read_b64_tr_b16 a[132:133], v1 offset:7168
  ds_read_b64_tr_b16 a[134:135], v1 offset:10752
  ds_read_b64_tr_b16 a[136:137], v1 offset:32
  ds_read_b64_tr_b16 a[138:139], v1 offset:3616
  ds_read_b64_tr_b16 a[140:141], v1 offset:7200
  ds_read_b64_tr_b16 a[142:143], v1 offset:10784
  ds_read_b64_tr_b16 a[144:145], v1 offset:64
  ds_read_b64_tr_b16 a[146:147], v1 offset:3648
  ds_read_b64_tr_b16 a[148:149], v1 offset:7232
  ds_read_b64_tr_b16 a[150:151], v1 offset:10816
  ds_read_b64_tr_b16 a[152:153], v1 offset:96
  ds_read_b64_tr_b16 a[154:155], v1 offset:3680
  ds_read_b64_tr_b16 a[156:157], v1 offset:7264
  ds_read_b64_tr_b16 a[158:159], v1 offset:10848
  s_waitcnt vmcnt(7) lgkmcnt(8)
  v_mfma_f32_16x16x32_bf16 v[32:35], a[128:131], a[0:3], 0
  s_waitcnt vmcnt(3)
  s_bfe_u32 s57, s84, 0x40004
  s_lshl_b32 s57, s57, 13
  v_mfma_f32_16x16x32_bf16 v[32:35], a[132:135], a[16:19], v[32:35]
  s_waitcnt vmcnt(2)
  s_add_u32 s57, s57, s86
  buffer_load_dwordx4 a[32:35], v0, s[36:39], s57 offen offset:0 sc1
  v_mfma_f32_16x16x32_bf16 v[36:39], a[132:135], a[20:23], 0
  s_waitcnt vmcnt(7)
  ds_read_b64_tr_b16 a[160:161], v1 offset:128
  v_mfma_f32_16x16x32_bf16 v[36:39], a[128:131], a[4:7], v[36:39]
  s_waitcnt vmcnt(6)
  ds_read_b64_tr_b16 a[162:163], v1 offset:3712
  v_mfma_f32_16x16x32_bf16 v[40:43], a[128:131], a[8:11], 0
  s_waitcnt vmcnt(2)
  ds_read_b64_tr_b16 a[164:165], v1 offset:7296
  v_mfma_f32_16x16x32_bf16 v[40:43], a[132:135], a[24:27], v[40:43]
  s_waitcnt vmcnt(1)
  v_mfma_f32_16x16x32_bf16 v[44:47], a[132:135], a[28:31], 0
  s_waitcnt vmcnt(5)
  buffer_load_dwordx4 a[36:39], v0, s[36:39], s57 offen offset:1024 sc1
  v_mfma_f32_16x16x32_bf16 v[44:47], a[128:131], a[12:15], v[44:47]
  ds_read_b64_tr_b16 a[166:167], v1 offset:10880
  v_mfma_f32_16x16x32_bf16 v[60:63], a[136:139], a[12:15], 0
  ds_read_b64_tr_b16 a[168:169], v1 offset:160
  v_mfma_f32_16x16x32_bf16 v[60:63], a[140:143], a[28:31], v[60:63]
  v_mfma_f32_16x16x32_bf16 v[56:59], a[140:143], a[24:27], 0
  ds_read_b64_tr_b16 a[170:171], v1 offset:3744
  v_mfma_f32_16x16x32_bf16 v[56:59], a[136:139], a[8:11], v[56:59]
  buffer_load_dwordx4 a[40:43], v0, s[36:39], s57 offen offset:2048 sc1
  v_mfma_f32_16x16x32_bf16 v[52:55], a[136:139], a[4:7], 0
  ds_read_b64_tr_b16 a[172:173], v1 offset:7328
  v_mfma_f32_16x16x32_bf16 v[52:55], a[140:143], a[20:23], v[52:55]
  v_mfma_f32_16x16x32_bf16 v[48:51], a[140:143], a[16:19], 0
  ds_read_b64_tr_b16 a[174:175], v1 offset:10912
  v_mfma_f32_16x16x32_bf16 v[48:51], a[136:139], a[0:3], v[48:51]
  s_waitcnt lgkmcnt(8)
  v_mfma_f32_16x16x32_bf16 v[64:67], a[144:147], a[0:3], 0
  buffer_load_dwordx4 a[44:47], v0, s[36:39], s57 offen offset:3072 sc1
  s_bfe_u32 s56, s84, 0x40008
  v_mfma_f32_16x16x32_bf16 v[64:67], a[148:151], a[16:19], v[64:67]
  s_mul_i32 s56, s56, 458752
  s_add_u32 m0, s77, 57344
  ds_read_b64_tr_b16 a[128:129], v1 offset:192
  v_mfma_f32_16x16x32_bf16 v[68:71], a[148:151], a[20:23], 0
  ds_read_b64_tr_b16 a[130:131], v1 offset:3776
  v_mfma_f32_16x16x32_bf16 v[68:71], a[144:147], a[4:7], v[68:71]
  v_mfma_f32_16x16x32_bf16 v[72:75], a[144:147], a[8:11], 0
  ds_read_b64_tr_b16 a[132:133], v1 offset:7360
  v_mfma_f32_16x16x32_bf16 v[72:75], a[148:151], a[24:27], v[72:75]
  buffer_load_dwordx4 v3, s[16:19], s56 offen offset:0 lds
  s_add_u32 s57, s57, 4096
  v_mfma_f32_16x16x32_bf16 v[76:79], a[148:151], a[28:31], 0
  ds_read_b64_tr_b16 a[134:135], v1 offset:10944
  v_mfma_f32_16x16x32_bf16 v[76:79], a[144:147], a[12:15], v[76:79]
  v_mfma_f32_16x16x32_bf16 v[92:95], a[152:155], a[12:15], 0
  ds_read_b64_tr_b16 a[136:137], v1 offset:14336
  v_mfma_f32_16x16x32_bf16 v[92:95], a[156:159], a[28:31], v[92:95]
  v_mfma_f32_16x16x32_bf16 v[88:91], a[156:159], a[24:27], 0
  buffer_load_dwordx4 a[48:51], v0, s[36:39], s57 offen offset:0 sc1
  v_mfma_f32_16x16x32_bf16 v[88:91], a[152:155], a[8:11], v[88:91]
  ds_read_b64_tr_b16 a[138:139], v1 offset:17920
  v_mfma_f32_16x16x32_bf16 v[84:87], a[152:155], a[4:7], 0
  ds_read_b64_tr_b16 a[140:141], v1 offset:21504
  v_mfma_f32_16x16x32_bf16 v[84:87], a[156:159], a[20:23], v[84:87]
  v_mfma_f32_16x16x32_bf16 v[80:83], a[156:159], a[16:19], 0
  ds_read_b64_tr_b16 a[142:143], v1 offset:25088
  v_mfma_f32_16x16x32_bf16 v[80:83], a[152:155], a[0:3], v[80:83]
  s_waitcnt lgkmcnt(8)
  buffer_load_dwordx4 v4, s[16:19], s56 offen offset:1024 lds
  v_mfma_f32_16x16x32_bf16 v[96:99], a[160:163], a[0:3], 0
  ds_read_b64_tr_b16 a[144:145], v1 offset:14368
  v_mfma_f32_16x16x32_bf16 v[96:99], a[164:167], a[16:19], v[96:99]
  v_mfma_f32_16x16x32_bf16 v[100:103], a[164:167], a[20:23], 0
  ds_read_b64_tr_b16 a[146:147], v1 offset:17952
  v_mfma_f32_16x16x32_bf16 v[100:103], a[160:163], a[4:7], v[100:103]
  v_mfma_f32_16x16x32_bf16 v[104:107], a[160:163], a[8:11], 0
  buffer_load_dwordx4 a[52:55], v0, s[36:39], s57 offen offset:1024 sc1
  v_mfma_f32_16x16x32_bf16 v[104:107], a[164:167], a[24:27], v[104:107]
  ds_read_b64_tr_b16 a[148:149], v1 offset:21536
  v_mfma_f32_16x16x32_bf16 v[108:111], a[164:167], a[28:31], 0
  ds_read_b64_tr_b16 a[150:151], v1 offset:25120
  v_mfma_f32_16x16x32_bf16 v[108:111], a[160:163], a[12:15], v[108:111]
  v_mfma_f32_16x16x32_bf16 v[124:127], a[168:171], a[12:15], 0
  s_bfe_u32 s59, s84, 0x40018
  s_lshl4_add_u32 s59, s58, s59
  s_lshl_b32 s59, s59, 11
  v_mfma_f32_16x16x32_bf16 v[124:127], a[172:175], a[28:31], v[124:127]
  s_add_u32 s59, s59, 5767168
  buffer_load_dwordx4 v5, s[16:19], s56 offen offset:2048 lds
  s_lshr_b32 s78, s44, 1
  v_mfma_f32_16x16x32_bf16 v[120:123], a[172:175], a[24:27], 0
  s_mul_i32 s78, s78, 14336
  ds_read_b64_tr_b16 a[152:153], v1 offset:14400
  s_and_b32 s79, s44, 1
  v_mfma_f32_16x16x32_bf16 v[120:123], a[168:171], a[8:11], v[120:123]
  s_lshl_b32 s79, s79, 7
  ds_read_b64_tr_b16 a[154:155], v1 offset:17984
  s_add_u32 s78, s78, s79
  v_mfma_f32_16x16x32_bf16 v[116:119], a[168:171], a[4:7], 0
  ds_read_b64_tr_b16 a[156:157], v1 offset:21568
  v_add_u32 v31, s78, v1
  v_mfma_f32_16x16x32_bf16 v[116:119], a[172:175], a[20:23], v[116:119]
  s_lshl_b32 s61, s2, 15
  s_lshl1_add_u32 s61, s70, s61
  s_xor_b32 s63, s61, 32768
  v_mfma_f32_16x16x32_bf16 v[112:115], a[172:175], a[16:19], 0
  s_add_u32 s61, s61, 41943040
  buffer_load_dwordx4 a[56:59], v0, s[36:39], s57 offen offset:2048 sc1
  s_add_u32 s62, s61, 4096
  v_mfma_f32_16x16x32_bf16 v[112:115], a[168:171], a[0:3], v[112:115]
  s_waitcnt lgkmcnt(7)
  ds_read_b64_tr_b16 a[158:159], v1 offset:25152
  s_add_u32 s63, s63, 41943040
  v_mfma_f32_16x16x32_bf16 v[128:131], a[128:131], a[0:3], 0
  s_add_u32 s64, s63, 4096
  ds_read_b64_tr_b16 a[160:161], v1 offset:14432
  v_mfma_f32_16x16x32_bf16 v[128:131], a[132:135], a[16:19], v[128:131]
  v_mfma_f32_16x16x32_bf16 v[132:135], a[132:135], a[20:23], 0
  ds_read_b64_tr_b16 a[162:163], v1 offset:18016
  v_mfma_f32_16x16x32_bf16 v[132:135], a[128:131], a[4:7], v[132:135]
  buffer_load_dwordx4 v6, s[16:19], s56 offen offset:3072 lds
  v_mfma_f32_16x16x32_bf16 v[136:139], a[128:131], a[8:11], 0
  ds_read_b64_tr_b16 a[164:165], v1 offset:21600
  v_mfma_f32_16x16x32_bf16 v[136:139], a[132:135], a[24:27], v[136:139]
  v_mfma_f32_16x16x32_bf16 v[140:143], a[132:135], a[28:31], 0
  ds_read_b64_tr_b16 a[166:167], v1 offset:25184
  v_mfma_f32_16x16x32_bf16 v[140:143], a[128:131], a[12:15], v[140:143]
  v_mfma_f32_16x16x32_bf16 v[156:159], a[136:139], a[12:15], 0
  buffer_load_dwordx4 a[60:63], v0, s[36:39], s57 offen offset:3072 sc1
  s_add_u32 m0, s77, 61440
  v_mfma_f32_16x16x32_bf16 v[156:159], a[140:143], a[28:31], v[156:159]
  ds_read_b64_tr_b16 a[168:169], v1 offset:14464
  v_mfma_f32_16x16x32_bf16 v[152:155], a[140:143], a[24:27], 0
  ds_read_b64_tr_b16 a[170:171], v1 offset:18048
  v_mfma_f32_16x16x32_bf16 v[152:155], a[136:139], a[8:11], v[152:155]
  v_mfma_f32_16x16x32_bf16 v[148:151], a[136:139], a[4:7], 0
  ds_read_b64_tr_b16 a[172:173], v1 offset:21632
  v_mfma_f32_16x16x32_bf16 v[148:151], a[140:143], a[20:23], v[148:151]
  buffer_load_dwordx4 v7, s[16:19], s56 offen offset:0 lds
  s_bfe_u32 s57, s84, 0x40008
  v_mfma_f32_16x16x32_bf16 v[144:147], a[140:143], a[16:19], 0
  s_lshl_b32 s57, s57, 13
  s_add_u32 s57, s57, s86
  ds_read_b64_tr_b16 a[174:175], v1 offset:25216
  v_mfma_f32_16x16x32_bf16 v[144:147], a[136:139], a[0:3], v[144:147]
  s_waitcnt lgkmcnt(8)
  v_mfma_f32_16x16x32_bf16 v[160:163], a[144:147], a[0:3], 0
  ds_read_b64_tr_b16 a[128:129], v1 offset:14496
  v_mfma_f32_16x16x32_bf16 v[160:163], a[148:151], a[16:19], v[160:163]
  v_mfma_f32_16x16x32_bf16 v[164:167], a[148:151], a[20:23], 0
  buffer_load_dwordx4 a[64:67], v0, s[36:39], s57 offen offset:0 sc1
  v_mfma_f32_16x16x32_bf16 v[164:167], a[144:147], a[4:7], v[164:167]
  ds_read_b64_tr_b16 a[130:131], v1 offset:18080
  v_mfma_f32_16x16x32_bf16 v[168:171], a[144:147], a[8:11], 0
  ds_read_b64_tr_b16 a[132:133], v1 offset:21664
  v_mfma_f32_16x16x32_bf16 v[168:171], a[148:151], a[24:27], v[168:171]
  v_mfma_f32_16x16x32_bf16 v[172:175], a[148:151], a[28:31], 0
  ds_read_b64_tr_b16 a[134:135], v1 offset:25248
  v_mfma_f32_16x16x32_bf16 v[172:175], a[144:147], a[12:15], v[172:175]
  s_waitcnt vmcnt(22)
  s_barrier
  buffer_load_dwordx4 v8, s[16:19], s56 offen offset:1024 lds
  v_mfma_f32_16x16x32_bf16 v[188:191], a[152:155], a[12:15], 0
  ds_read_b64_tr_b16 a[136:137], v1 offset:14528
  v_mfma_f32_16x16x32_bf16 v[188:191], a[156:159], a[28:31], v[188:191]
  v_mfma_f32_16x16x32_bf16 v[184:187], a[156:159], a[24:27], 0
  ds_read_b64_tr_b16 a[138:139], v1 offset:18112
  v_mfma_f32_16x16x32_bf16 v[184:187], a[152:155], a[8:11], v[184:187]
  v_mfma_f32_16x16x32_bf16 v[180:183], a[152:155], a[4:7], 0
  buffer_load_dwordx4 a[68:71], v0, s[36:39], s57 offen offset:1024 sc1
  v_mfma_f32_16x16x32_bf16 v[180:183], a[156:159], a[20:23], v[180:183]
  ds_read_b64_tr_b16 a[140:141], v1 offset:21696
  v_mfma_f32_16x16x32_bf16 v[176:179], a[156:159], a[16:19], 0
  ds_read_b64_tr_b16 a[142:143], v1 offset:25280
  v_mfma_f32_16x16x32_bf16 v[176:179], a[152:155], a[0:3], v[176:179]
  s_waitcnt lgkmcnt(8)
  v_mfma_f32_16x16x32_bf16 v[192:195], a[160:163], a[0:3], 0
  ds_read_b64_tr_b16 a[144:145], v1 offset:28672
  v_mfma_f32_16x16x32_bf16 v[192:195], a[164:167], a[16:19], v[192:195]
  v_mfma_f32_16x16x32_bf16 v[196:199], a[164:167], a[20:23], 0
  ds_read_b64_tr_b16 a[146:147], v1 offset:32256
  v_mfma_f32_16x16x32_bf16 v[196:199], a[160:163], a[4:7], v[196:199]
  v_mfma_f32_16x16x32_bf16 v[200:203], a[160:163], a[8:11], 0
  ds_read_b64_tr_b16 a[148:149], v1 offset:35840
  v_mfma_f32_16x16x32_bf16 v[200:203], a[164:167], a[24:27], v[200:203]
  v_mfma_f32_16x16x32_bf16 v[204:207], a[164:167], a[28:31], 0
  buffer_load_dwordx4 v9, s[16:19], s56 offen offset:2048 lds
  v_mfma_f32_16x16x32_bf16 v[204:207], a[160:163], a[12:15], v[204:207]
  ds_read_b64_tr_b16 a[150:151], v1 offset:39424
  v_mfma_f32_16x16x32_bf16 v[220:223], a[168:171], a[12:15], 0
  ds_read_b64_tr_b16 a[152:153], v1 offset:28704
  v_mfma_f32_16x16x32_bf16 v[220:223], a[172:175], a[28:31], v[220:223]
  v_mfma_f32_16x16x32_bf16 v[216:219], a[172:175], a[24:27], 0
  ds_read_b64_tr_b16 a[154:155], v1 offset:32288
  v_mfma_f32_16x16x32_bf16 v[216:219], a[168:171], a[8:11], v[216:219]
  buffer_load_dwordx4 a[72:75], v0, s[36:39], s57 offen offset:2048 sc1
  v_mfma_f32_16x16x32_bf16 v[212:215], a[168:171], a[4:7], 0
  ds_read_b64_tr_b16 a[156:157], v1 offset:35872
  v_mfma_f32_16x16x32_bf16 v[212:215], a[172:175], a[20:23], v[212:215]
  v_mfma_f32_16x16x32_bf16 v[208:211], a[172:175], a[16:19], 0
  ds_read_b64_tr_b16 a[158:159], v1 offset:39456
  v_mfma_f32_16x16x32_bf16 v[208:211], a[168:171], a[0:3], v[208:211]
  s_waitcnt lgkmcnt(8)
  v_mfma_f32_16x16x32_bf16 v[224:227], a[128:131], a[0:3], 0
  ds_read_b64_tr_b16 a[160:161], v1 offset:28736
  v_mfma_f32_16x16x32_bf16 v[224:227], a[132:135], a[16:19], v[224:227]
  v_mfma_f32_16x16x32_bf16 v[228:231], a[132:135], a[20:23], 0
  ds_read_b64_tr_b16 a[162:163], v1 offset:32320
  v_mfma_f32_16x16x32_bf16 v[228:231], a[128:131], a[4:7], v[228:231]
  v_mfma_f32_16x16x32_bf16 v[232:235], a[128:131], a[8:11], 0
  ds_read_b64_tr_b16 a[164:165], v1 offset:35904
  v_mfma_f32_16x16x32_bf16 v[232:235], a[132:135], a[24:27], v[232:235]
  buffer_load_dwordx4 a[76:79], v0, s[36:39], s57 offen offset:3072 sc1
  v_mfma_f32_16x16x32_bf16 v[236:239], a[132:135], a[28:31], 0
  ds_read_b64_tr_b16 a[166:167], v1 offset:39488
  v_mfma_f32_16x16x32_bf16 v[236:239], a[128:131], a[12:15], v[236:239]
  v_mfma_f32_16x16x32_bf16 v[252:255], a[136:139], a[12:15], 0
  ds_read_b64_tr_b16 a[168:169], v1 offset:28768
  v_mfma_f32_16x16x32_bf16 v[252:255], a[140:143], a[28:31], v[252:255]
  s_bfe_u32 s56, s84, 0x4000c
  s_mul_i32 s56, s56, 458752
  s_add_u32 m0, s77, 86016
  v_mfma_f32_16x16x32_bf16 v[248:251], a[140:143], a[24:27], 0
  ds_read_b64_tr_b16 a[170:171], v1 offset:32352
  v_mfma_f32_16x16x32_bf16 v[248:251], a[136:139], a[8:11], v[248:251]
  v_mfma_f32_16x16x32_bf16 v[244:247], a[136:139], a[4:7], 0
  ds_read_b64_tr_b16 a[172:173], v1 offset:35936
  v_mfma_f32_16x16x32_bf16 v[244:247], a[140:143], a[20:23], v[244:247]
  buffer_load_dwordx4 v3, s[16:19], s56 offen offset:0 lds
  v_mfma_f32_16x16x32_bf16 v[240:243], a[140:143], a[16:19], 0
  ds_read_b64_tr_b16 a[174:175], v1 offset:39520
  v_mfma_f32_16x16x32_bf16 v[240:243], a[136:139], a[0:3], v[240:243]
  s_waitcnt vmcnt(8) lgkmcnt(8)
  v_mfma_f32_16x16x32_bf16 v[32:35], a[144:147], a[32:35], v[32:35]
  s_add_u32 s57, s57, 4096
  ds_read_b64_tr_b16 a[128:129], v1 offset:28800
  v_mfma_f32_16x16x32_bf16 v[32:35], a[148:151], a[48:51], v[32:35]
  v_mfma_f32_16x16x32_bf16 v[36:39], a[148:151], a[52:55], v[36:39]
  ds_read_b64_tr_b16 a[130:131], v1 offset:32384
  v_mfma_f32_16x16x32_bf16 v[36:39], a[144:147], a[36:39], v[36:39]
  v_mfma_f32_16x16x32_bf16 v[40:43], a[144:147], a[40:43], v[40:43]
  buffer_load_dwordx4 a[80:83], v0, s[36:39], s57 offen offset:0 sc1
  v_mfma_f32_16x16x32_bf16 v[40:43], a[148:151], a[56:59], v[40:43]
  ds_read_b64_tr_b16 a[132:133], v1 offset:35968
  v_mfma_f32_16x16x32_bf16 v[44:47], a[148:151], a[60:63], v[44:47]
  ds_read_b64_tr_b16 a[134:135], v1 offset:39552
  v_mfma_f32_16x16x32_bf16 v[44:47], a[144:147], a[44:47], v[44:47]
  v_mfma_f32_16x16x32_bf16 v[60:63], a[152:155], a[44:47], v[60:63]
  ds_read_b64_tr_b16 a[136:137], v1 offset:28832
  v_mfma_f32_16x16x32_bf16 v[60:63], a[156:159], a[60:63], v[60:63]
  v_mfma_f32_16x16x32_bf16 v[56:59], a[156:159], a[56:59], v[56:59]
  ds_read_b64_tr_b16 a[138:139], v1 offset:32416
  v_mfma_f32_16x16x32_bf16 v[56:59], a[152:155], a[40:43], v[56:59]
  buffer_load_dwordx4 v4, s[16:19], s56 offen offset:1024 lds
  v_mfma_f32_16x16x32_bf16 v[52:55], a[152:155], a[36:39], v[52:55]
  ds_read_b64_tr_b16 a[140:141], v1 offset:36000
  v_mfma_f32_16x16x32_bf16 v[52:55], a[156:159], a[52:55], v[52:55]
  v_mfma_f32_16x16x32_bf16 v[48:51], a[156:159], a[48:51], v[48:51]
  ds_read_b64_tr_b16 a[142:143], v1 offset:39584
  v_mfma_f32_16x16x32_bf16 v[48:51], a[152:155], a[32:35], v[48:51]
  s_waitcnt lgkmcnt(8)
  v_mfma_f32_16x16x32_bf16 v[64:67], a[160:163], a[32:35], v[64:67]
  ds_read_b64_tr_b16 a[144:145], v1 offset:28864
  v_mfma_f32_16x16x32_bf16 v[64:67], a[164:167], a[48:51], v[64:67]
  v_mfma_f32_16x16x32_bf16 v[68:71], a[164:167], a[52:55], v[68:71]
  ds_read_b64_tr_b16 a[146:147], v1 offset:32448
  v_mfma_f32_16x16x32_bf16 v[68:71], a[160:163], a[36:39], v[68:71]
  buffer_load_dwordx4 a[84:87], v0, s[36:39], s57 offen offset:1024 sc1
  v_mfma_f32_16x16x32_bf16 v[72:75], a[160:163], a[40:43], v[72:75]
  ds_read_b64_tr_b16 a[148:149], v1 offset:36032
  v_mfma_f32_16x16x32_bf16 v[72:75], a[164:167], a[56:59], v[72:75]
  v_mfma_f32_16x16x32_bf16 v[76:79], a[164:167], a[60:63], v[76:79]
  ds_read_b64_tr_b16 a[150:151], v1 offset:39616
  v_mfma_f32_16x16x32_bf16 v[76:79], a[160:163], a[44:47], v[76:79]
  v_mfma_f32_16x16x32_bf16 v[92:95], a[168:171], a[44:47], v[92:95]
  ds_read_b64_tr_b16 a[152:153], v1 offset:43008
  v_mfma_f32_16x16x32_bf16 v[92:95], a[172:175], a[60:63], v[92:95]
  v_mfma_f32_16x16x32_bf16 v[88:91], a[172:175], a[56:59], v[88:91]
  buffer_load_dwordx4 v5, s[16:19], s56 offen offset:2048 lds
  v_mfma_f32_16x16x32_bf16 v[88:91], a[168:171], a[40:43], v[88:91]
  ds_read_b64_tr_b16 a[154:155], v1 offset:46592
  v_mfma_f32_16x16x32_bf16 v[84:87], a[168:171], a[36:39], v[84:87]
  ds_read_b64_tr_b16 a[156:157], v1 offset:50176
  v_mfma_f32_16x16x32_bf16 v[84:87], a[172:175], a[52:55], v[84:87]
  v_mfma_f32_16x16x32_bf16 v[80:83], a[172:175], a[48:51], v[80:83]
  ds_read_b64_tr_b16 a[158:159], v1 offset:53760
  v_mfma_f32_16x16x32_bf16 v[80:83], a[168:171], a[32:35], v[80:83]
  s_waitcnt lgkmcnt(8)
  v_mfma_f32_16x16x32_bf16 v[96:99], a[128:131], a[32:35], v[96:99]
  ds_read_b64_tr_b16 a[160:161], v1 offset:43040
  v_mfma_f32_16x16x32_bf16 v[96:99], a[132:135], a[48:51], v[96:99]
  v_mfma_f32_16x16x32_bf16 v[100:103], a[132:135], a[52:55], v[100:103]
  buffer_load_dwordx4 a[88:91], v0, s[36:39], s57 offen offset:2048 sc1
  v_mfma_f32_16x16x32_bf16 v[100:103], a[128:131], a[36:39], v[100:103]
  ds_read_b64_tr_b16 a[162:163], v1 offset:46624
  v_mfma_f32_16x16x32_bf16 v[104:107], a[128:131], a[40:43], v[104:107]
  ds_read_b64_tr_b16 a[164:165], v1 offset:50208
  v_mfma_f32_16x16x32_bf16 v[104:107], a[132:135], a[56:59], v[104:107]
  v_mfma_f32_16x16x32_bf16 v[108:111], a[132:135], a[60:63], v[108:111]
  ds_read_b64_tr_b16 a[166:167], v1 offset:53792
  v_mfma_f32_16x16x32_bf16 v[108:111], a[128:131], a[44:47], v[108:111]
  v_mfma_f32_16x16x32_bf16 v[124:127], a[136:139], a[44:47], v[124:127]
  ds_read_b64_tr_b16 a[168:169], v1 offset:43072
  v_mfma_f32_16x16x32_bf16 v[124:127], a[140:143], a[60:63], v[124:127]
  buffer_load_dwordx4 v6, s[16:19], s56 offen offset:3072 lds
  v_mfma_f32_16x16x32_bf16 v[120:123], a[140:143], a[56:59], v[120:123]
Hb0:
  s_cbranch_execz Hb0_1
  ds_read_b64_tr_b16 a[170:171], v1 offset:46656
  v_mfma_f32_16x16x32_bf16 v[120:123], a[136:139], a[40:43], v[120:123]
  v_mfma_f32_16x16x32_bf16 v[116:119], a[136:139], a[36:39], v[116:119]
  ds_read_b64_tr_b16 a[172:173], v1 offset:50240
  v_mfma_f32_16x16x32_bf16 v[116:119], a[140:143], a[52:55], v[116:119]
  v_mfma_f32_16x16x32_bf16 v[112:115], a[140:143], a[48:51], v[112:115]
  ds_read_b64_tr_b16 a[174:175], v1 offset:53824
  v_mfma_f32_16x16x32_bf16 v[112:115], a[136:139], a[32:35], v[112:115]
  s_waitcnt lgkmcnt(8)
  v_mfma_f32_16x16x32_bf16 v[128:131], a[144:147], a[32:35], v[128:131]
  ds_read_b64_tr_b16 a[128:129], v1 offset:43104
  v_mfma_f32_16x16x32_bf16 v[128:131], a[148:151], a[48:51], v[128:131]
  buffer_load_dwordx4 a[92:95], v0, s[36:39], s57 offen offset:3072 sc1
  v_mfma_f32_16x16x32_bf16 v[132:135], a[148:151], a[52:55], v[132:135]
  ds_read_b64_tr_b16 a[130:131], v1 offset:46688
  v_mfma_f32_16x16x32_bf16 v[132:135], a[144:147], a[36:39], v[132:135]
  v_mfma_f32_16x16x32_bf16 v[136:139], a[144:147], a[40:43], v[136:139]
  s_add_u32 m0, s77, 90112
  ds_read_b64_tr_b16 a[132:133], v1 offset:50272
  v_mfma_f32_16x16x32_bf16 v[136:139], a[148:151], a[56:59], v[136:139]
  v_mfma_f32_16x16x32_bf16 v[140:143], a[148:151], a[60:63], v[140:143]
  ds_read_b64_tr_b16 a[134:135], v1 offset:53856
  v_mfma_f32_16x16x32_bf16 v[140:143], a[144:147], a[44:47], v[140:143]
  v_mfma_f32_16x16x32_bf16 v[156:159], a[152:155], a[44:47], v[156:159]
  buffer_load_dwordx4 v7, s[16:19], s56 offen offset:0 lds
  s_bfe_u32 s57, s84, 0x4000c
  v_mfma_f32_16x16x32_bf16 v[156:159], a[156:159], a[60:63], v[156:159]
  s_lshl_b32 s57, s57, 13
  s_add_u32 s57, s57, s86
  ds_read_b64_tr_b16 a[136:137], v1 offset:43136
  v_mfma_f32_16x16x32_bf16 v[152:155], a[156:159], a[56:59], v[152:155]
  ds_read_b64_tr_b16 a[138:139], v1 offset:46720
  v_mfma_f32_16x16x32_bf16 v[152:155], a[152:155], a[40:43], v[152:155]
  v_mfma_f32_16x16x32_bf16 v[148:151], a[152:155], a[36:39], v[148:151]
  ds_read_b64_tr_b16 a[140:141], v1 offset:50304
  v_mfma_f32_16x16x32_bf16 v[148:151], a[156:159], a[52:55], v[148:151]
  buffer_load_dwordx4 a[96:99], v0, s[36:39], s57 offen offset:0 sc1
  v_mfma_f32_16x16x32_bf16 v[144:147], a[156:159], a[48:51], v[144:147]
  ds_read_b64_tr_b16 a[142:143], v1 offset:53888
  v_mfma_f32_16x16x32_bf16 v[144:147], a[152:155], a[32:35], v[144:147]
  s_waitcnt lgkmcnt(8)
  v_mfma_f32_16x16x32_bf16 v[160:163], a[160:163], a[32:35], v[160:163]
  ds_read_b64_tr_b16 a[144:145], v1 offset:43168
  v_mfma_f32_16x16x32_bf16 v[160:163], a[164:167], a[48:51], v[160:163]
  v_mfma_f32_16x16x32_bf16 v[164:167], a[164:167], a[52:55], v[164:167]
  ds_read_b64_tr_b16 a[146:147], v1 offset:46752
  v_mfma_f32_16x16x32_bf16 v[164:167], a[160:163], a[36:39], v[164:167]
  v_mfma_f32_16x16x32_bf16 v[168:171], a[160:163], a[40:43], v[168:171]
  ds_read_b64_tr_b16 a[148:149], v1 offset:50336
  v_mfma_f32_16x16x32_bf16 v[168:171], a[164:167], a[56:59], v[168:171]
  v_mfma_f32_16x16x32_bf16 v[172:175], a[164:167], a[60:63], v[172:175]
  ds_read_b64_tr_b16 a[150:151], v1 offset:53920
  v_mfma_f32_16x16x32_bf16 v[172:175], a[160:163], a[44:47], v[172:175]
  s_waitcnt vmcnt(12)
  s_barrier
  buffer_load_dwordx4 v8, s[16:19], s56 offen offset:1024 lds
  v_mfma_f32_16x16x32_bf16 v[188:191], a[168:171], a[44:47], v[188:191]
  ds_read_b64_tr_b16 a[152:153], v1 offset:43200
  v_mfma_f32_16x16x32_bf16 v[188:191], a[172:175], a[60:63], v[188:191]
  v_mfma_f32_16x16x32_bf16 v[184:187], a[172:175], a[56:59], v[184:187]
  ds_read_b64_tr_b16 a[154:155], v1 offset:46784
  v_mfma_f32_16x16x32_bf16 v[184:187], a[168:171], a[40:43], v[184:187]
  v_mfma_f32_16x16x32_bf16 v[180:183], a[168:171], a[36:39], v[180:183]
  buffer_load_dwordx4 a[100:103], v0, s[36:39], s57 offen offset:1024 sc1
  v_mfma_f32_16x16x32_bf16 v[180:183], a[172:175], a[52:55], v[180:183]
  ds_read_b64_tr_b16 a[156:157], v1 offset:50368
  v_mfma_f32_16x16x32_bf16 v[176:179], a[172:175], a[48:51], v[176:179]
  ds_read_b64_tr_b16 a[158:159], v1 offset:53952
  v_mfma_f32_16x16x32_bf16 v[176:179], a[168:171], a[32:35], v[176:179]
  s_waitcnt lgkmcnt(8)
  v_mfma_f32_16x16x32_bf16 v[192:195], a[128:131], a[32:35], v[192:195]
  ds_read_b64_tr_b16 a[160:161], v2 offset:0
  v_mfma_f32_16x16x32_bf16 v[192:195], a[132:135], a[48:51], v[192:195]
  v_mfma_f32_16x16x32_bf16 v[196:199], a[132:135], a[52:55], v[196:199]
  ds_read_b64_tr_b16 a[162:163], v2 offset:3584
  v_mfma_f32_16x16x32_bf16 v[196:199], a[128:131], a[36:39], v[196:199]
  v_mfma_f32_16x16x32_bf16 v[200:203], a[128:131], a[40:43], v[200:203]
  ds_read_b64_tr_b16 a[164:165], v2 offset:7168
  v_mfma_f32_16x16x32_bf16 v[200:203], a[132:135], a[56:59], v[200:203]
  v_mfma_f32_16x16x32_bf16 v[204:207], a[132:135], a[60:63], v[204:207]
  buffer_load_dwordx4 v9, s[16:19], s56 offen offset:2048 lds
  v_mfma_f32_16x16x32_bf16 v[204:207], a[128:131], a[44:47], v[204:207]
  ds_read_b64_tr_b16 a[166:167], v2 offset:10752
  v_mfma_f32_16x16x32_bf16 v[220:223], a[136:139], a[44:47], v[220:223]
  ds_read_b64_tr_b16 a[168:169], v2 offset:32
  v_mfma_f32_16x16x32_bf16 v[220:223], a[140:143], a[60:63], v[220:223]
  v_mfma_f32_16x16x32_bf16 v[216:219], a[140:143], a[56:59], v[216:219]
  ds_read_b64_tr_b16 a[170:171], v2 offset:3616
  v_mfma_f32_16x16x32_bf16 v[216:219], a[136:139], a[40:43], v[216:219]
  buffer_load_dwordx4 a[104:107], v0, s[36:39], s57 offen offset:2048 sc1
  v_mfma_f32_16x16x32_bf16 v[212:215], a[136:139], a[36:39], v[212:215]
  ds_read_b64_tr_b16 a[172:173], v2 offset:7200
  v_mfma_f32_16x16x32_bf16 v[212:215], a[140:143], a[52:55], v[212:215]
  v_mfma_f32_16x16x32_bf16 v[208:211], a[140:143], a[48:51], v[208:211]
  ds_read_b64_tr_b16 a[174:175], v2 offset:10784
  v_mfma_f32_16x16x32_bf16 v[208:211], a[136:139], a[32:35], v[208:211]
  s_waitcnt lgkmcnt(8)
  v_mfma_f32_16x16x32_bf16 v[224:227], a[144:147], a[32:35], v[224:227]
  ds_read_b64_tr_b16 a[128:129], v2 offset:64
  v_mfma_f32_16x16x32_bf16 v[224:227], a[148:151], a[48:51], v[224:227]
  v_mfma_f32_16x16x32_bf16 v[228:231], a[148:151], a[52:55], v[228:231]
  ds_read_b64_tr_b16 a[130:131], v2 offset:3648
  v_mfma_f32_16x16x32_bf16 v[228:231], a[144:147], a[36:39], v[228:231]
  v_mfma_f32_16x16x32_bf16 v[232:235], a[144:147], a[40:43], v[232:235]
  ds_read_b64_tr_b16 a[132:133], v2 offset:7232
  v_mfma_f32_16x16x32_bf16 v[232:235], a[148:151], a[56:59], v[232:235]
  buffer_load_dwordx4 a[108:111], v0, s[36:39], s57 offen offset:3072 sc1
  v_mfma_f32_16x16x32_bf16 v[236:239], a[148:151], a[60:63], v[236:239]
  ds_read_b64_tr_b16 a[134:135], v2 offset:10816
  v_mfma_f32_16x16x32_bf16 v[236:239], a[144:147], a[44:47], v[236:239]
  v_mfma_f32_16x16x32_bf16 v[252:255], a[152:155], a[44:47], v[252:255]
  ds_read_b64_tr_b16 a[136:137], v2 offset:96
  v_mfma_f32_16x16x32_bf16 v[252:255], a[156:159], a[60:63], v[252:255]
  s_bfe_u32 s56, s84, 0x40010
  s_mul_i32 s56, s56, 458752
  s_add_u32 m0, s77, 0
  v_mfma_f32_16x16x32_bf16 v[248:251], a[156:159], a[56:59], v[248:251]
  ds_read_b64_tr_b16 a[138:139], v2 offset:3680
  v_mfma_f32_16x16x32_bf16 v[248:251], a[152:155], a[40:43], v[248:251]
  v_mfma_f32_16x16x32_bf16 v[244:247], a[152:155], a[36:39], v[244:247]
  ds_read_b64_tr_b16 a[140:141], v2 offset:7264
  v_mfma_f32_16x16x32_bf16 v[244:247], a[156:159], a[52:55], v[244:247]
  buffer_load_dwordx4 v3, s[16:19], s56 offen offset:0 lds
  v_mfma_f32_16x16x32_bf16 v[240:243], a[156:159], a[48:51], v[240:243]
  ds_read_b64_tr_b16 a[142:143], v2 offset:10848
  v_mfma_f32_16x16x32_bf16 v[240:243], a[152:155], a[32:35], v[240:243]
  s_waitcnt vmcnt(8) lgkmcnt(8)
  v_mfma_f32_16x16x32_bf16 v[32:35], a[160:163], a[64:67], v[32:35]
  s_add_u32 s57, s57, 4096
  ds_read_b64_tr_b16 a[144:145], v2 offset:128
  v_mfma_f32_16x16x32_bf16 v[32:35], a[164:167], a[80:83], v[32:35]
  v_mfma_f32_16x16x32_bf16 v[36:39], a[164:167], a[84:87], v[36:39]
  ds_read_b64_tr_b16 a[146:147], v2 offset:3712
  v_mfma_f32_16x16x32_bf16 v[36:39], a[160:163], a[68:71], v[36:39]
  v_mfma_f32_16x16x32_bf16 v[40:43], a[160:163], a[72:75], v[40:43]
  buffer_load_dwordx4 a[112:115], v0, s[36:39], s57 offen offset:0 sc1
  v_mfma_f32_16x16x32_bf16 v[40:43], a[164:167], a[88:91], v[40:43]
  ds_read_b64_tr_b16 a[148:149], v2 offset:7296
  v_mfma_f32_16x16x32_bf16 v[44:47], a[164:167], a[92:95], v[44:47]
  ds_read_b64_tr_b16 a[150:151], v2 offset:10880
  v_mfma_f32_16x16x32_bf16 v[44:47], a[160:163], a[76:79], v[44:47]
  v_mfma_f32_16x16x32_bf16 v[60:63], a[168:171], a[76:79], v[60:63]
  ds_read_b64_tr_b16 a[152:153], v2 offset:160
  v_mfma_f32_16x16x32_bf16 v[60:63], a[172:175], a[92:95], v[60:63]
  v_mfma_f32_16x16x32_bf16 v[56:59], a[172:175], a[88:91], v[56:59]
  ds_read_b64_tr_b16 a[154:155], v2 offset:3744
  v_mfma_f32_16x16x32_bf16 v[56:59], a[168:171], a[72:75], v[56:59]
  buffer_load_dwordx4 v4, s[16:19], s56 offen offset:1024 lds
  v_mfma_f32_16x16x32_bf16 v[52:55], a[168:171], a[68:71], v[52:55]
  ds_read_b64_tr_b16 a[156:157], v2 offset:7328
  v_mfma_f32_16x16x32_bf16 v[52:55], a[172:175], a[84:87], v[52:55]
  v_mfma_f32_16x16x32_bf16 v[48:51], a[172:175], a[80:83], v[48:51]
  ds_read_b64_tr_b16 a[158:159], v2 offset:10912
  v_mfma_f32_16x16x32_bf16 v[48:51], a[168:171], a[64:67], v[48:51]
  s_waitcnt lgkmcnt(8)
  v_mfma_f32_16x16x32_bf16 v[64:67], a[128:131], a[64:67], v[64:67]
  ds_read_b64_tr_b16 a[160:161], v2 offset:192
  v_mfma_f32_16x16x32_bf16 v[64:67], a[132:135], a[80:83], v[64:67]
  v_mfma_f32_16x16x32_bf16 v[68:71], a[132:135], a[84:87], v[68:71]
  ds_read_b64_tr_b16 a[162:163], v2 offset:3776
  v_mfma_f32_16x16x32_bf16 v[68:71], a[128:131], a[68:71], v[68:71]
  buffer_load_dwordx4 a[116:119], v0, s[36:39], s57 offen offset:1024 sc1
  v_mfma_f32_16x16x32_bf16 v[72:75], a[128:131], a[72:75], v[72:75]
  ds_read_b64_tr_b16 a[164:165], v2 offset:7360
  v_mfma_f32_16x16x32_bf16 v[72:75], a[132:135], a[88:91], v[72:75]
  v_mfma_f32_16x16x32_bf16 v[76:79], a[132:135], a[92:95], v[76:79]
  ds_read_b64_tr_b16 a[166:167], v2 offset:10944
  v_mfma_f32_16x16x32_bf16 v[76:79], a[128:131], a[76:79], v[76:79]
  v_mfma_f32_16x16x32_bf16 v[92:95], a[136:139], a[76:79], v[92:95]
  ds_read_b64_tr_b16 a[168:169], v2 offset:14336
  v_mfma_f32_16x16x32_bf16 v[92:95], a[140:143], a[92:95], v[92:95]
  v_mfma_f32_16x16x32_bf16 v[88:91], a[140:143], a[88:91], v[88:91]
  buffer_load_dwordx4 v5, s[16:19], s56 offen offset:2048 lds
  v_mfma_f32_16x16x32_bf16 v[88:91], a[136:139], a[72:75], v[88:91]
  ds_read_b64_tr_b16 a[170:171], v2 offset:17920
  v_mfma_f32_16x16x32_bf16 v[84:87], a[136:139], a[68:71], v[84:87]
  ds_read_b64_tr_b16 a[172:173], v2 offset:21504
  v_mfma_f32_16x16x32_bf16 v[84:87], a[140:143], a[84:87], v[84:87]
  v_mfma_f32_16x16x32_bf16 v[80:83], a[140:143], a[80:83], v[80:83]
  ds_read_b64_tr_b16 a[174:175], v2 offset:25088
  v_mfma_f32_16x16x32_bf16 v[80:83], a[136:139], a[64:67], v[80:83]
  s_waitcnt lgkmcnt(8)
  v_mfma_f32_16x16x32_bf16 v[96:99], a[144:147], a[64:67], v[96:99]
  ds_read_b64_tr_b16 a[128:129], v2 offset:14368
  v_mfma_f32_16x16x32_bf16 v[96:99], a[148:151], a[80:83], v[96:99]
  v_mfma_f32_16x16x32_bf16 v[100:103], a[148:151], a[84:87], v[100:103]
  buffer_load_dwordx4 a[120:123], v0, s[36:39], s57 offen offset:2048 sc1
  v_mfma_f32_16x16x32_bf16 v[100:103], a[144:147], a[68:71], v[100:103]
  ds_read_b64_tr_b16 a[130:131], v2 offset:17952
  v_mfma_f32_16x16x32_bf16 v[104:107], a[144:147], a[72:75], v[104:107]
  ds_read_b64_tr_b16 a[132:133], v2 offset:21536
  v_mfma_f32_16x16x32_bf16 v[104:107], a[148:151], a[88:91], v[104:107]
  v_mfma_f32_16x16x32_bf16 v[108:111], a[148:151], a[92:95], v[108:111]
  ds_read_b64_tr_b16 a[134:135], v2 offset:25120
  v_mfma_f32_16x16x32_bf16 v[108:111], a[144:147], a[76:79], v[108:111]
  v_mfma_f32_16x16x32_bf16 v[124:127], a[152:155], a[76:79], v[124:127]
  ds_read_b64_tr_b16 a[136:137], v2 offset:14400
  v_mfma_f32_16x16x32_bf16 v[124:127], a[156:159], a[92:95], v[124:127]
  buffer_load_dwordx4 v6, s[16:19], s56 offen offset:3072 lds
  v_mfma_f32_16x16x32_bf16 v[120:123], a[156:159], a[88:91], v[120:123]
  ds_read_b64_tr_b16 a[138:139], v2 offset:17984
  v_mfma_f32_16x16x32_bf16 v[120:123], a[152:155], a[72:75], v[120:123]
  v_mfma_f32_16x16x32_bf16 v[116:119], a[152:155], a[68:71], v[116:119]
  ds_read_b64_tr_b16 a[140:141], v2 offset:21568
  v_mfma_f32_16x16x32_bf16 v[116:119], a[156:159], a[84:87], v[116:119]
  v_mfma_f32_16x16x32_bf16 v[112:115], a[156:159], a[80:83], v[112:115]
  ds_read_b64_tr_b16 a[142:143], v2 offset:25152
  v_mfma_f32_16x16x32_bf16 v[112:115], a[152:155], a[64:67], v[112:115]
  s_waitcnt lgkmcnt(8)
  v_mfma_f32_16x16x32_bf16 v[128:131], a[160:163], a[64:67], v[128:131]
  ds_read_b64_tr_b16 a[144:145], v2 offset:14432
  v_mfma_f32_16x16x32_bf16 v[128:131], a[164:167], a[80:83], v[128:131]
  buffer_load_dwordx4 a[124:127], v0, s[36:39], s57 offen offset:3072 sc1
  v_mfma_f32_16x16x32_bf16 v[132:135], a[164:167], a[84:87], v[132:135]
  ds_read_b64_tr_b16 a[146:147], v2 offset:18016
  v_mfma_f32_16x16x32_bf16 v[132:135], a[160:163], a[68:71], v[132:135]
  v_mfma_f32_16x16x32_bf16 v[136:139], a[160:163], a[72:75], v[136:139]
  s_add_u32 m0, s77, 4096
  ds_read_b64_tr_b16 a[148:149], v2 offset:21600
  v_mfma_f32_16x16x32_bf16 v[136:139], a[164:167], a[88:91], v[136:139]
  v_mfma_f32_16x16x32_bf16 v[140:143], a[164:167], a[92:95], v[140:143]
  ds_read_b64_tr_b16 a[150:151], v2 offset:25184
  v_mfma_f32_16x16x32_bf16 v[140:143], a[160:163], a[76:79], v[140:143]
  v_mfma_f32_16x16x32_bf16 v[156:159], a[168:171], a[76:79], v[156:159]
  buffer_load_dwordx4 v7, s[16:19], s56 offen offset:0 lds
  s_bfe_u32 s57, s84, 0x40010
  v_mfma_f32_16x16x32_bf16 v[156:159], a[172:175], a[92:95], v[156:159]
  s_lshl_b32 s57, s57, 13
  s_add_u32 s57, s57, s86
  ds_read_b64_tr_b16 a[152:153], v2 offset:14464
  v_mfma_f32_16x16x32_bf16 v[152:155], a[172:175], a[88:91], v[152:155]
  ds_read_b64_tr_b16 a[154:155], v2 offset:18048
  v_mfma_f32_16x16x32_bf16 v[152:155], a[168:171], a[72:75], v[152:155]
  v_mfma_f32_16x16x32_bf16 v[148:151], a[168:171], a[68:71], v[148:151]
  ds_read_b64_tr_b16 a[156:157], v2 offset:21632
  v_mfma_f32_16x16x32_bf16 v[148:151], a[172:175], a[84:87], v[148:151]
  buffer_load_dwordx4 a[0:3], v0, s[36:39], s57 offen offset:0 sc1
  v_mfma_f32_16x16x32_bf16 v[144:147], a[172:175], a[80:83], v[144:147]
  ds_read_b64_tr_b16 a[158:159], v2 offset:25216
  v_mfma_f32_16x16x32_bf16 v[144:147], a[168:171], a[64:67], v[144:147]
  s_waitcnt lgkmcnt(8)
  v_mfma_f32_16x16x32_bf16 v[160:163], a[128:131], a[64:67], v[160:163]
  ds_read_b64_tr_b16 a[160:161], v2 offset:14496
  v_mfma_f32_16x16x32_bf16 v[160:163], a[132:135], a[80:83], v[160:163]
  v_mfma_f32_16x16x32_bf16 v[164:167], a[132:135], a[84:87], v[164:167]
  ds_read_b64_tr_b16 a[162:163], v2 offset:18080
  v_mfma_f32_16x16x32_bf16 v[164:167], a[128:131], a[68:71], v[164:167]
  v_mfma_f32_16x16x32_bf16 v[168:171], a[128:131], a[72:75], v[168:171]
  ds_read_b64_tr_b16 a[164:165], v2 offset:21664
  v_mfma_f32_16x16x32_bf16 v[168:171], a[132:135], a[88:91], v[168:171]
  v_mfma_f32_16x16x32_bf16 v[172:175], a[132:135], a[92:95], v[172:175]
  ds_read_b64_tr_b16 a[166:167], v2 offset:25248
  v_mfma_f32_16x16x32_bf16 v[172:175], a[128:131], a[76:79], v[172:175]
  s_waitcnt vmcnt(12)
  s_barrier
  buffer_load_dwordx4 v8, s[16:19], s56 offen offset:1024 lds
  v_mfma_f32_16x16x32_bf16 v[188:191], a[136:139], a[76:79], v[188:191]
  ds_read_b64_tr_b16 a[168:169], v2 offset:14528
  v_mfma_f32_16x16x32_bf16 v[188:191], a[140:143], a[92:95], v[188:191]
  v_mfma_f32_16x16x32_bf16 v[184:187], a[140:143], a[88:91], v[184:187]
  ds_read_b64_tr_b16 a[170:171], v2 offset:18112
  v_mfma_f32_16x16x32_bf16 v[184:187], a[136:139], a[72:75], v[184:187]
  v_mfma_f32_16x16x32_bf16 v[180:183], a[136:139], a[68:71], v[180:183]
  buffer_load_dwordx4 a[4:7], v0, s[36:39], s57 offen offset:1024 sc1
  v_mfma_f32_16x16x32_bf16 v[180:183], a[140:143], a[84:87], v[180:183]
  ds_read_b64_tr_b16 a[172:173], v2 offset:21696
  v_mfma_f32_16x16x32_bf16 v[176:179], a[140:143], a[80:83], v[176:179]
  ds_read_b64_tr_b16 a[174:175], v2 offset:25280
  v_mfma_f32_16x16x32_bf16 v[176:179], a[136:139], a[64:67], v[176:179]
  s_waitcnt lgkmcnt(8)
  v_mfma_f32_16x16x32_bf16 v[192:195], a[144:147], a[64:67], v[192:195]
  ds_read_b64_tr_b16 a[128:129], v2 offset:28672
  v_mfma_f32_16x16x32_bf16 v[192:195], a[148:151], a[80:83], v[192:195]
  v_mfma_f32_16x16x32_bf16 v[196:199], a[148:151], a[84:87], v[196:199]
  ds_read_b64_tr_b16 a[130:131], v2 offset:32256
  v_mfma_f32_16x16x32_bf16 v[196:199], a[144:147], a[68:71], v[196:199]
  v_mfma_f32_16x16x32_bf16 v[200:203], a[144:147], a[72:75], v[200:203]
  ds_read_b64_tr_b16 a[132:133], v2 offset:35840
  v_mfma_f32_16x16x32_bf16 v[200:203], a[148:151], a[88:91], v[200:203]
  v_mfma_f32_16x16x32_bf16 v[204:207], a[148:151], a[92:95], v[204:207]
  buffer_load_dwordx4 v9, s[16:19], s56 offen offset:2048 lds
  v_mfma_f32_16x16x32_bf16 v[204:207], a[144:147], a[76:79], v[204:207]
  ds_read_b64_tr_b16 a[134:135], v2 offset:39424
  v_mfma_f32_16x16x32_bf16 v[220:223], a[152:155], a[76:79], v[220:223]
  ds_read_b64_tr_b16 a[136:137], v2 offset:28704
  v_mfma_f32_16x16x32_bf16 v[220:223], a[156:159], a[92:95], v[220:223]
  v_mfma_f32_16x16x32_bf16 v[216:219], a[156:159], a[88:91], v[216:219]
  ds_read_b64_tr_b16 a[138:139], v2 offset:32288
  v_mfma_f32_16x16x32_bf16 v[216:219], a[152:155], a[72:75], v[216:219]
  buffer_load_dwordx4 a[8:11], v0, s[36:39], s57 offen offset:2048 sc1
  v_mfma_f32_16x16x32_bf16 v[212:215], a[152:155], a[68:71], v[212:215]
  ds_read_b64_tr_b16 a[140:141], v2 offset:35872
  v_mfma_f32_16x16x32_bf16 v[212:215], a[156:159], a[84:87], v[212:215]
  v_mfma_f32_16x16x32_bf16 v[208:211], a[156:159], a[80:83], v[208:211]
  ds_read_b64_tr_b16 a[142:143], v2 offset:39456
  v_mfma_f32_16x16x32_bf16 v[208:211], a[152:155], a[64:67], v[208:211]
  s_waitcnt lgkmcnt(8)
  v_mfma_f32_16x16x32_bf16 v[224:227], a[160:163], a[64:67], v[224:227]
  ds_read_b64_tr_b16 a[144:145], v2 offset:28736
  v_mfma_f32_16x16x32_bf16 v[224:227], a[164:167], a[80:83], v[224:227]
  v_mfma_f32_16x16x32_bf16 v[228:231], a[164:167], a[84:87], v[228:231]
  ds_read_b64_tr_b16 a[146:147], v2 offset:32320
  v_mfma_f32_16x16x32_bf16 v[228:231], a[160:163], a[68:71], v[228:231]
  v_mfma_f32_16x16x32_bf16 v[232:235], a[160:163], a[72:75], v[232:235]
  ds_read_b64_tr_b16 a[148:149], v2 offset:35904
  v_mfma_f32_16x16x32_bf16 v[232:235], a[164:167], a[88:91], v[232:235]
  buffer_load_dwordx4 a[12:15], v0, s[36:39], s57 offen offset:3072 sc1
  v_mfma_f32_16x16x32_bf16 v[236:239], a[164:167], a[92:95], v[236:239]
  ds_read_b64_tr_b16 a[150:151], v2 offset:39488
  v_mfma_f32_16x16x32_bf16 v[236:239], a[160:163], a[76:79], v[236:239]
  v_mfma_f32_16x16x32_bf16 v[252:255], a[168:171], a[76:79], v[252:255]
  ds_read_b64_tr_b16 a[152:153], v2 offset:28768
  v_mfma_f32_16x16x32_bf16 v[252:255], a[172:175], a[92:95], v[252:255]
  s_bfe_u32 s56, s84, 0x40014
  s_mul_i32 s56, s56, 458752
  s_add_u32 m0, s77, 28672
  v_mfma_f32_16x16x32_bf16 v[248:251], a[172:175], a[88:91], v[248:251]
  ds_read_b64_tr_b16 a[154:155], v2 offset:32352
  v_mfma_f32_16x16x32_bf16 v[248:251], a[168:171], a[72:75], v[248:251]
  v_mfma_f32_16x16x32_bf16 v[244:247], a[168:171], a[68:71], v[244:247]
  ds_read_b64_tr_b16 a[156:157], v2 offset:35936
  v_mfma_f32_16x16x32_bf16 v[244:247], a[172:175], a[84:87], v[244:247]
  buffer_load_dwordx4 v3, s[16:19], s56 offen offset:0 lds
  v_mfma_f32_16x16x32_bf16 v[240:243], a[172:175], a[80:83], v[240:243]
  ds_read_b64_tr_b16 a[158:159], v2 offset:39520
  v_mfma_f32_16x16x32_bf16 v[240:243], a[168:171], a[64:67], v[240:243]
  s_waitcnt vmcnt(8) lgkmcnt(8)
  v_mfma_f32_16x16x32_bf16 v[32:35], a[128:131], a[96:99], v[32:35]
  s_add_u32 s57, s57, 4096
  ds_read_b64_tr_b16 a[160:161], v2 offset:28800
  v_mfma_f32_16x16x32_bf16 v[32:35], a[132:135], a[112:115], v[32:35]
  v_mfma_f32_16x16x32_bf16 v[36:39], a[132:135], a[116:119], v[36:39]
  ds_read_b64_tr_b16 a[162:163], v2 offset:32384
  v_mfma_f32_16x16x32_bf16 v[36:39], a[128:131], a[100:103], v[36:39]
  v_mfma_f32_16x16x32_bf16 v[40:43], a[128:131], a[104:107], v[40:43]
  buffer_load_dwordx4 a[16:19], v0, s[36:39], s57 offen offset:0 sc1
  v_mfma_f32_16x16x32_bf16 v[40:43], a[132:135], a[120:123], v[40:43]
  ds_read_b64_tr_b16 a[164:165], v2 offset:35968
  v_mfma_f32_16x16x32_bf16 v[44:47], a[132:135], a[124:127], v[44:47]
  ds_read_b64_tr_b16 a[166:167], v2 offset:39552
  v_mfma_f32_16x16x32_bf16 v[44:47], a[128:131], a[108:111], v[44:47]
  v_mfma_f32_16x16x32_bf16 v[60:63], a[136:139], a[108:111], v[60:63]
  ds_read_b64_tr_b16 a[168:169], v2 offset:28832
  v_mfma_f32_16x16x32_bf16 v[60:63], a[140:143], a[124:127], v[60:63]
  v_mfma_f32_16x16x32_bf16 v[56:59], a[140:143], a[120:123], v[56:59]
  ds_read_b64_tr_b16 a[170:171], v2 offset:32416
  v_mfma_f32_16x16x32_bf16 v[56:59], a[136:139], a[104:107], v[56:59]
  buffer_load_dwordx4 v4, s[16:19], s56 offen offset:1024 lds
  v_mfma_f32_16x16x32_bf16 v[52:55], a[136:139], a[100:103], v[52:55]
  ds_read_b64_tr_b16 a[172:173], v2 offset:36000
  v_mfma_f32_16x16x32_bf16 v[52:55], a[140:143], a[116:119], v[52:55]
  v_mfma_f32_16x16x32_bf16 v[48:51], a[140:143], a[112:115], v[48:51]
  ds_read_b64_tr_b16 a[174:175], v2 offset:39584
  v_mfma_f32_16x16x32_bf16 v[48:51], a[136:139], a[96:99], v[48:51]
  s_waitcnt lgkmcnt(8)
  v_mfma_f32_16x16x32_bf16 v[64:67], a[144:147], a[96:99], v[64:67]
  ds_read_b64_tr_b16 a[128:129], v2 offset:28864
  v_mfma_f32_16x16x32_bf16 v[64:67], a[148:151], a[112:115], v[64:67]
  v_mfma_f32_16x16x32_bf16 v[68:71], a[148:151], a[116:119], v[68:71]
  ds_read_b64_tr_b16 a[130:131], v2 offset:32448
  v_mfma_f32_16x16x32_bf16 v[68:71], a[144:147], a[100:103], v[68:71]
  buffer_load_dwordx4 a[20:23], v0, s[36:39], s57 offen offset:1024 sc1
  v_mfma_f32_16x16x32_bf16 v[72:75], a[144:147], a[104:107], v[72:75]
  ds_read_b64_tr_b16 a[132:133], v2 offset:36032
  v_mfma_f32_16x16x32_bf16 v[72:75], a[148:151], a[120:123], v[72:75]
  v_mfma_f32_16x16x32_bf16 v[76:79], a[148:151], a[124:127], v[76:79]
  ds_read_b64_tr_b16 a[134:135], v2 offset:39616
  v_mfma_f32_16x16x32_bf16 v[76:79], a[144:147], a[108:111], v[76:79]
  v_mfma_f32_16x16x32_bf16 v[92:95], a[152:155], a[108:111], v[92:95]
  ds_read_b64_tr_b16 a[136:137], v2 offset:43008
  v_mfma_f32_16x16x32_bf16 v[92:95], a[156:159], a[124:127], v[92:95]
  v_mfma_f32_16x16x32_bf16 v[88:91], a[156:159], a[120:123], v[88:91]
  buffer_load_dwordx4 v5, s[16:19], s56 offen offset:2048 lds
  v_mfma_f32_16x16x32_bf16 v[88:91], a[152:155], a[104:107], v[88:91]
  ds_read_b64_tr_b16 a[138:139], v2 offset:46592
  v_mfma_f32_16x16x32_bf16 v[84:87], a[152:155], a[100:103], v[84:87]
  ds_read_b64_tr_b16 a[140:141], v2 offset:50176
  v_mfma_f32_16x16x32_bf16 v[84:87], a[156:159], a[116:119], v[84:87]
  v_mfma_f32_16x16x32_bf16 v[80:83], a[156:159], a[112:115], v[80:83]
  ds_read_b64_tr_b16 a[142:143], v2 offset:53760
  v_mfma_f32_16x16x32_bf16 v[80:83], a[152:155], a[96:99], v[80:83]
  s_waitcnt lgkmcnt(8)
  v_mfma_f32_16x16x32_bf16 v[96:99], a[160:163], a[96:99], v[96:99]
  ds_read_b64_tr_b16 a[144:145], v2 offset:43040
  v_mfma_f32_16x16x32_bf16 v[96:99], a[164:167], a[112:115], v[96:99]
  v_mfma_f32_16x16x32_bf16 v[100:103], a[164:167], a[116:119], v[100:103]
  buffer_load_dwordx4 a[24:27], v0, s[36:39], s57 offen offset:2048 sc1
  v_mfma_f32_16x16x32_bf16 v[100:103], a[160:163], a[100:103], v[100:103]
  ds_read_b64_tr_b16 a[146:147], v2 offset:46624
  v_mfma_f32_16x16x32_bf16 v[104:107], a[160:163], a[104:107], v[104:107]
  ds_read_b64_tr_b16 a[148:149], v2 offset:50208
  v_mfma_f32_16x16x32_bf16 v[104:107], a[164:167], a[120:123], v[104:107]
  v_mfma_f32_16x16x32_bf16 v[108:111], a[164:167], a[124:127], v[108:111]
  ds_read_b64_tr_b16 a[150:151], v2 offset:53792
  v_mfma_f32_16x16x32_bf16 v[108:111], a[160:163], a[108:111], v[108:111]
  v_mfma_f32_16x16x32_bf16 v[124:127], a[168:171], a[108:111], v[124:127]
  ds_read_b64_tr_b16 a[152:153], v2 offset:43072
  v_mfma_f32_16x16x32_bf16 v[124:127], a[172:175], a[124:127], v[124:127]
  buffer_load_dwordx4 v6, s[16:19], s56 offen offset:3072 lds
  v_mfma_f32_16x16x32_bf16 v[120:123], a[172:175], a[120:123], v[120:123]
  ds_read_b64_tr_b16 a[154:155], v2 offset:46656
  v_mfma_f32_16x16x32_bf16 v[120:123], a[168:171], a[104:107], v[120:123]
  v_mfma_f32_16x16x32_bf16 v[116:119], a[168:171], a[100:103], v[116:119]
  ds_read_b64_tr_b16 a[156:157], v2 offset:50240
  v_mfma_f32_16x16x32_bf16 v[116:119], a[172:175], a[116:119], v[116:119]
  v_mfma_f32_16x16x32_bf16 v[112:115], a[172:175], a[112:115], v[112:115]
  ds_read_b64_tr_b16 a[158:159], v2 offset:53824
  v_mfma_f32_16x16x32_bf16 v[112:115], a[168:171], a[96:99], v[112:115]
  s_waitcnt lgkmcnt(8)
  v_mfma_f32_16x16x32_bf16 v[128:131], a[128:131], a[96:99], v[128:131]
  ds_read_b64_tr_b16 a[160:161], v2 offset:43104
  v_mfma_f32_16x16x32_bf16 v[128:131], a[132:135], a[112:115], v[128:131]
  buffer_load_dwordx4 a[28:31], v0, s[36:39], s57 offen offset:3072 sc1
  v_mfma_f32_16x16x32_bf16 v[132:135], a[132:135], a[116:119], v[132:135]
  ds_read_b64_tr_b16 a[162:163], v2 offset:46688
  v_mfma_f32_16x16x32_bf16 v[132:135], a[128:131], a[100:103], v[132:135]
  v_mfma_f32_16x16x32_bf16 v[136:139], a[128:131], a[104:107], v[136:139]
  s_add_u32 m0, s77, 32768
  ds_read_b64_tr_b16 a[164:165], v2 offset:50272
  v_mfma_f32_16x16x32_bf16 v[136:139], a[132:135], a[120:123], v[136:139]
  v_mfma_f32_16x16x32_bf16 v[140:143], a[132:135], a[124:127], v[140:143]
  ds_read_b64_tr_b16 a[166:167], v2 offset:53856
  v_mfma_f32_16x16x32_bf16 v[140:143], a[128:131], a[108:111], v[140:143]
  v_mfma_f32_16x16x32_bf16 v[156:159], a[136:139], a[108:111], v[156:159]
  buffer_load_dwordx4 v7, s[16:19], s56 offen offset:0 lds
  s_bfe_u32 s57, s84, 0x40014
  v_mfma_f32_16x16x32_bf16 v[156:159], a[140:143], a[124:127], v[156:159]
  s_lshl_b32 s57, s57, 13
  s_add_u32 s57, s57, s86
  ds_read_b64_tr_b16 a[168:169], v2 offset:43136
  v_mfma_f32_16x16x32_bf16 v[152:155], a[140:143], a[120:123], v[152:155]
  ds_read_b64_tr_b16 a[170:171], v2 offset:46720
  v_mfma_f32_16x16x32_bf16 v[152:155], a[136:139], a[104:107], v[152:155]
  v_mfma_f32_16x16x32_bf16 v[148:151], a[136:139], a[100:103], v[148:151]
  ds_read_b64_tr_b16 a[172:173], v2 offset:50304
  v_mfma_f32_16x16x32_bf16 v[148:151], a[140:143], a[116:119], v[148:151]
  buffer_load_dwordx4 a[32:35], v0, s[36:39], s57 offen offset:0 sc1
  v_mfma_f32_16x16x32_bf16 v[144:147], a[140:143], a[112:115], v[144:147]
  ds_read_b64_tr_b16 a[174:175], v2 offset:53888
  v_mfma_f32_16x16x32_bf16 v[144:147], a[136:139], a[96:99], v[144:147]
  s_waitcnt lgkmcnt(8)
  v_mfma_f32_16x16x32_bf16 v[160:163], a[144:147], a[96:99], v[160:163]
  ds_read_b64_tr_b16 a[128:129], v2 offset:43168
  v_mfma_f32_16x16x32_bf16 v[160:163], a[148:151], a[112:115], v[160:163]
  v_mfma_f32_16x16x32_bf16 v[164:167], a[148:151], a[116:119], v[164:167]
  ds_read_b64_tr_b16 a[130:131], v2 offset:46752
  v_mfma_f32_16x16x32_bf16 v[164:167], a[144:147], a[100:103], v[164:167]
  v_mfma_f32_16x16x32_bf16 v[168:171], a[144:147], a[104:107], v[168:171]
  ds_read_b64_tr_b16 a[132:133], v2 offset:50336
  v_mfma_f32_16x16x32_bf16 v[168:171], a[148:151], a[120:123], v[168:171]
  v_mfma_f32_16x16x32_bf16 v[172:175], a[148:151], a[124:127], v[172:175]
  ds_read_b64_tr_b16 a[134:135], v2 offset:53920
  v_mfma_f32_16x16x32_bf16 v[172:175], a[144:147], a[108:111], v[172:175]
  s_waitcnt vmcnt(12)
  s_barrier
  buffer_load_dwordx4 v8, s[16:19], s56 offen offset:1024 lds
  v_mfma_f32_16x16x32_bf16 v[188:191], a[152:155], a[108:111], v[188:191]
  ds_read_b64_tr_b16 a[136:137], v2 offset:43200
  v_mfma_f32_16x16x32_bf16 v[188:191], a[156:159], a[124:127], v[188:191]
  v_mfma_f32_16x16x32_bf16 v[184:187], a[156:159], a[120:123], v[184:187]
  ds_read_b64_tr_b16 a[138:139], v2 offset:46784
  v_mfma_f32_16x16x32_bf16 v[184:187], a[152:155], a[104:107], v[184:187]
  v_mfma_f32_16x16x32_bf16 v[180:183], a[152:155], a[100:103], v[180:183]
  buffer_load_dwordx4 a[36:39], v0, s[36:39], s57 offen offset:1024 sc1
  v_mfma_f32_16x16x32_bf16 v[180:183], a[156:159], a[116:119], v[180:183]
  ds_read_b64_tr_b16 a[140:141], v2 offset:50368
  v_mfma_f32_16x16x32_bf16 v[176:179], a[156:159], a[112:115], v[176:179]
  ds_read_b64_tr_b16 a[142:143], v2 offset:53952
  v_mfma_f32_16x16x32_bf16 v[176:179], a[152:155], a[96:99], v[176:179]
  s_waitcnt lgkmcnt(8)
  v_mfma_f32_16x16x32_bf16 v[192:195], a[160:163], a[96:99], v[192:195]
  ds_read_b64_tr_b16 a[144:145], v1 offset:0
  v_mfma_f32_16x16x32_bf16 v[192:195], a[164:167], a[112:115], v[192:195]
  v_mfma_f32_16x16x32_bf16 v[196:199], a[164:167], a[116:119], v[196:199]
  ds_read_b64_tr_b16 a[146:147], v1 offset:3584
  v_mfma_f32_16x16x32_bf16 v[196:199], a[160:163], a[100:103], v[196:199]
  v_mfma_f32_16x16x32_bf16 v[200:203], a[160:163], a[104:107], v[200:203]
  ds_read_b64_tr_b16 a[148:149], v1 offset:7168
  v_mfma_f32_16x16x32_bf16 v[200:203], a[164:167], a[120:123], v[200:203]
  v_mfma_f32_16x16x32_bf16 v[204:207], a[164:167], a[124:127], v[204:207]
  buffer_load_dwordx4 v9, s[16:19], s56 offen offset:2048 lds
  v_mfma_f32_16x16x32_bf16 v[204:207], a[160:163], a[108:111], v[204:207]
  ds_read_b64_tr_b16 a[150:151], v1 offset:10752
  v_mfma_f32_16x16x32_bf16 v[220:223], a[168:171], a[108:111], v[220:223]
  ds_read_b64_tr_b16 a[152:153], v1 offset:32
  v_mfma_f32_16x16x32_bf16 v[220:223], a[172:175], a[124:127], v[220:223]
  v_mfma_f32_16x16x32_bf16 v[216:219], a[172:175], a[120:123], v[216:219]
  ds_read_b64_tr_b16 a[154:155], v1 offset:3616
  v_mfma_f32_16x16x32_bf16 v[216:219], a[168:171], a[104:107], v[216:219]
  buffer_load_dwordx4 a[40:43], v0, s[36:39], s57 offen offset:2048 sc1
  v_mfma_f32_16x16x32_bf16 v[212:215], a[168:171], a[100:103], v[212:215]
  ds_read_b64_tr_b16 a[156:157], v1 offset:7200
  v_mfma_f32_16x16x32_bf16 v[212:215], a[172:175], a[116:119], v[212:215]
  v_mfma_f32_16x16x32_bf16 v[208:211], a[172:175], a[112:115], v[208:211]
  ds_read_b64_tr_b16 a[158:159], v1 offset:10784
  v_mfma_f32_16x16x32_bf16 v[208:211], a[168:171], a[96:99], v[208:211]
  s_waitcnt lgkmcnt(8)
  v_mfma_f32_16x16x32_bf16 v[224:227], a[128:131], a[96:99], v[224:227]
  ds_read_b64_tr_b16 a[160:161], v1 offset:64
  v_mfma_f32_16x16x32_bf16 v[224:227], a[132:135], a[112:115], v[224:227]
  v_mfma_f32_16x16x32_bf16 v[228:231], a[132:135], a[116:119], v[228:231]
  ds_read_b64_tr_b16 a[162:163], v1 offset:3648
  v_mfma_f32_16x16x32_bf16 v[228:231], a[128:131], a[100:103], v[228:231]
  v_mfma_f32_16x16x32_bf16 v[232:235], a[128:131], a[104:107], v[232:235]
  ds_read_b64_tr_b16 a[164:165], v1 offset:7232
  v_mfma_f32_16x16x32_bf16 v[232:235], a[132:135], a[120:123], v[232:235]
  buffer_load_dwordx4 a[44:47], v0, s[36:39], s57 offen offset:3072 sc1
  v_mfma_f32_16x16x32_bf16 v[236:239], a[132:135], a[124:127], v[236:239]
  ds_read_b64_tr_b16 a[166:167], v1 offset:10816
  v_mfma_f32_16x16x32_bf16 v[236:239], a[128:131], a[108:111], v[236:239]
  v_mfma_f32_16x16x32_bf16 v[252:255], a[136:139], a[108:111], v[252:255]
  ds_read_b64_tr_b16 a[168:169], v1 offset:96
  v_mfma_f32_16x16x32_bf16 v[252:255], a[140:143], a[124:127], v[252:255]
  s_bfe_u32 s56, s84, 0x40018
  s_mul_i32 s56, s56, 458752
  s_add_u32 m0, s77, 57344
  v_mfma_f32_16x16x32_bf16 v[248:251], a[140:143], a[120:123], v[248:251]
  ds_read_b64_tr_b16 a[170:171], v1 offset:3680
  v_mfma_f32_16x16x32_bf16 v[248:251], a[136:139], a[104:107], v[248:251]
  v_mfma_f32_16x16x32_bf16 v[244:247], a[136:139], a[100:103], v[244:247]
  ds_read_b64_tr_b16 a[172:173], v1 offset:7264
  v_mfma_f32_16x16x32_bf16 v[244:247], a[140:143], a[116:119], v[244:247]
  buffer_load_dwordx4 v3, s[16:19], s56 offen offset:0 lds
  v_mfma_f32_16x16x32_bf16 v[240:243], a[140:143], a[112:115], v[240:243]
  ds_read_b64_tr_b16 a[174:175], v1 offset:10848
  v_mfma_f32_16x16x32_bf16 v[240:243], a[136:139], a[96:99], v[240:243]
  s_waitcnt vmcnt(8) lgkmcnt(8)
  v_mfma_f32_16x16x32_bf16 v[32:35], a[144:147], a[0:3], v[32:35]
  s_add_u32 s57, s57, 4096
  ds_read_b64_tr_b16 a[128:129], v1 offset:128
  v_mfma_f32_16x16x32_bf16 v[32:35], a[148:151], a[16:19], v[32:35]
Hb1:
  s_cbranch_execz Hb1_1
  v_mfma_f32_16x16x32_bf16 v[36:39], a[148:151], a[20:23], v[36:39]
  ds_read_b64_tr_b16 a[130:131], v1 offset:3712
  v_mfma_f32_16x16x32_bf16 v[36:39], a[144:147], a[4:7], v[36:39]
  v_mfma_f32_16x16x32_bf16 v[40:43], a[144:147], a[8:11], v[40:43]
  buffer_load_dwordx4 a[48:51], v0, s[36:39], s57 offen offset:0 sc1
  v_mfma_f32_16x16x32_bf16 v[40:43], a[148:151], a[24:27], v[40:43]
  ds_read_b64_tr_b16 a[132:133], v1 offset:7296
  v_mfma_f32_16x16x32_bf16 v[44:47], a[148:151], a[28:31], v[44:47]
  ds_read_b64_tr_b16 a[134:135], v1 offset:10880
  v_mfma_f32_16x16x32_bf16 v[44:47], a[144:147], a[12:15], v[44:47]
  v_mfma_f32_16x16x32_bf16 v[60:63], a[152:155], a[12:15], v[60:63]
  ds_read_b64_tr_b16 a[136:137], v1 offset:160
  v_mfma_f32_16x16x32_bf16 v[60:63], a[156:159], a[28:31], v[60:63]
  v_mfma_f32_16x16x32_bf16 v[56:59], a[156:159], a[24:27], v[56:59]
  ds_read_b64_tr_b16 a[138:139], v1 offset:3744
  v_mfma_f32_16x16x32_bf16 v[56:59], a[152:155], a[8:11], v[56:59]
  buffer_load_dwordx4 v4, s[16:19], s56 offen offset:1024 lds
  v_mfma_f32_16x16x32_bf16 v[52:55], a[152:155], a[4:7], v[52:55]
  ds_read_b64_tr_b16 a[140:141], v1 offset:7328
  v_mfma_f32_16x16x32_bf16 v[52:55], a[156:159], a[20:23], v[52:55]
  v_mfma_f32_16x16x32_bf16 v[48:51], a[156:159], a[16:19], v[48:51]
  ds_read_b64_tr_b16 a[142:143], v1 offset:10912
  v_mfma_f32_16x16x32_bf16 v[48:51], a[152:155], a[0:3], v[48:51]
  s_waitcnt lgkmcnt(8)
  v_mfma_f32_16x16x32_bf16 v[64:67], a[160:163], a[0:3], v[64:67]
  ds_read_b64_tr_b16 a[144:145], v1 offset:192
  v_mfma_f32_16x16x32_bf16 v[64:67], a[164:167], a[16:19], v[64:67]
  v_mfma_f32_16x16x32_bf16 v[68:71], a[164:167], a[20:23], v[68:71]
  ds_read_b64_tr_b16 a[146:147], v1 offset:3776
  v_mfma_f32_16x16x32_bf16 v[68:71], a[160:163], a[4:7], v[68:71]
  buffer_load_dwordx4 a[52:55], v0, s[36:39], s57 offen offset:1024 sc1
  v_mfma_f32_16x16x32_bf16 v[72:75], a[160:163], a[8:11], v[72:75]
  ds_read_b64_tr_b16 a[148:149], v1 offset:7360
  v_mfma_f32_16x16x32_bf16 v[72:75], a[164:167], a[24:27], v[72:75]
  v_mfma_f32_16x16x32_bf16 v[76:79], a[164:167], a[28:31], v[76:79]
  ds_read_b64_tr_b16 a[150:151], v1 offset:10944
  v_mfma_f32_16x16x32_bf16 v[76:79], a[160:163], a[12:15], v[76:79]
  v_mfma_f32_16x16x32_bf16 v[92:95], a[168:171], a[12:15], v[92:95]
  ds_read_b64_tr_b16 a[152:153], v1 offset:14336
  v_mfma_f32_16x16x32_bf16 v[92:95], a[172:175], a[28:31], v[92:95]
  v_mfma_f32_16x16x32_bf16 v[88:91], a[172:175], a[24:27], v[88:91]
  buffer_load_dwordx4 v5, s[16:19], s56 offen offset:2048 lds
  v_mfma_f32_16x16x32_bf16 v[88:91], a[168:171], a[8:11], v[88:91]
  ds_read_b64_tr_b16 a[154:155], v1 offset:17920
  v_mfma_f32_16x16x32_bf16 v[84:87], a[168:171], a[4:7], v[84:87]
  ds_read_b64_tr_b16 a[156:157], v1 offset:21504
  v_mfma_f32_16x16x32_bf16 v[84:87], a[172:175], a[20:23], v[84:87]
  v_mfma_f32_16x16x32_bf16 v[80:83], a[172:175], a[16:19], v[80:83]
  ds_read_b64_tr_b16 a[158:159], v1 offset:25088
  v_mfma_f32_16x16x32_bf16 v[80:83], a[168:171], a[0:3], v[80:83]
  s_waitcnt lgkmcnt(8)
  v_mfma_f32_16x16x32_bf16 v[96:99], a[128:131], a[0:3], v[96:99]
  ds_read_b64_tr_b16 a[160:161], v1 offset:14368
  v_mfma_f32_16x16x32_bf16 v[96:99], a[132:135], a[16:19], v[96:99]
  v_mfma_f32_16x16x32_bf16 v[100:103], a[132:135], a[20:23], v[100:103]
  buffer_load_dwordx4 a[56:59], v0, s[36:39], s57 offen offset:2048 sc1
  v_mfma_f32_16x16x32_bf16 v[100:103], a[128:131], a[4:7], v[100:103]
  ds_read_b64_tr_b16 a[162:163], v1 offset:17952
  v_mfma_f32_16x16x32_bf16 v[104:107], a[128:131], a[8:11], v[104:107]
  ds_read_b64_tr_b16 a[164:165], v1 offset:21536
  v_mfma_f32_16x16x32_bf16 v[104:107], a[132:135], a[24:27], v[104:107]
  v_mfma_f32_16x16x32_bf16 v[108:111], a[132:135], a[28:31], v[108:111]
  ds_read_b64_tr_b16 a[166:167], v1 offset:25120
  v_mfma_f32_16x16x32_bf16 v[108:111], a[128:131], a[12:15], v[108:111]
  v_mfma_f32_16x16x32_bf16 v[124:127], a[136:139], a[12:15], v[124:127]
  ds_read_b64_tr_b16 a[168:169], v1 offset:14400
  v_mfma_f32_16x16x32_bf16 v[124:127], a[140:143], a[28:31], v[124:127]
  buffer_load_dwordx4 v6, s[16:19], s56 offen offset:3072 lds
  v_mfma_f32_16x16x32_bf16 v[120:123], a[140:143], a[24:27], v[120:123]
  ds_read_b64_tr_b16 a[170:171], v1 offset:17984
  v_mfma_f32_16x16x32_bf16 v[120:123], a[136:139], a[8:11], v[120:123]
  v_mfma_f32_16x16x32_bf16 v[116:119], a[136:139], a[4:7], v[116:119]
  ds_read_b64_tr_b16 a[172:173], v1 offset:21568
  v_mfma_f32_16x16x32_bf16 v[116:119], a[140:143], a[20:23], v[116:119]
  v_mfma_f32_16x16x32_bf16 v[112:115], a[140:143], a[16:19], v[112:115]
  ds_read_b64_tr_b16 a[174:175], v1 offset:25152
  v_mfma_f32_16x16x32_bf16 v[112:115], a[136:139], a[0:3], v[112:115]
  s_waitcnt lgkmcnt(8)
  v_mfma_f32_16x16x32_bf16 v[128:131], a[144:147], a[0:3], v[128:131]
  ds_read_b64_tr_b16 a[128:129], v1 offset:14432
  v_mfma_f32_16x16x32_bf16 v[128:131], a[148:151], a[16:19], v[128:131]
  buffer_load_dwordx4 a[60:63], v0, s[36:39], s57 offen offset:3072 sc1
  v_mfma_f32_16x16x32_bf16 v[132:135], a[148:151], a[20:23], v[132:135]
  ds_read_b64_tr_b16 a[130:131], v1 offset:18016
  v_mfma_f32_16x16x32_bf16 v[132:135], a[144:147], a[4:7], v[132:135]
  v_mfma_f32_16x16x32_bf16 v[136:139], a[144:147], a[8:11], v[136:139]
  s_add_u32 m0, s77, 61440
  ds_read_b64_tr_b16 a[132:133], v1 offset:21600
  v_mfma_f32_16x16x32_bf16 v[136:139], a[148:151], a[24:27], v[136:139]
  v_mfma_f32_16x16x32_bf16 v[140:143], a[148:151], a[28:31], v[140:143]
  ds_read_b64_tr_b16 a[134:135], v1 offset:25184
  v_mfma_f32_16x16x32_bf16 v[140:143], a[144:147], a[12:15], v[140:143]
  v_mfma_f32_16x16x32_bf16 v[156:159], a[152:155], a[12:15], v[156:159]
  buffer_load_dwordx4 v7, s[16:19], s56 offen offset:0 lds
  s_bfe_u32 s57, s84, 0x40018
  v_mfma_f32_16x16x32_bf16 v[156:159], a[156:159], a[28:31], v[156:159]
  s_lshl_b32 s57, s57, 13
  s_add_u32 s57, s57, s86
  ds_read_b64_tr_b16 a[136:137], v1 offset:14464
  v_mfma_f32_16x16x32_bf16 v[152:155], a[156:159], a[24:27], v[152:155]
  ds_read_b64_tr_b16 a[138:139], v1 offset:18048
  v_mfma_f32_16x16x32_bf16 v[152:155], a[152:155], a[8:11], v[152:155]
  v_mfma_f32_16x16x32_bf16 v[148:151], a[152:155], a[4:7], v[148:151]
  ds_read_b64_tr_b16 a[140:141], v1 offset:21632
  v_mfma_f32_16x16x32_bf16 v[148:151], a[156:159], a[20:23], v[148:151]
  buffer_load_dwordx4 a[64:67], v0, s[36:39], s57 offen offset:0 sc1
  v_mfma_f32_16x16x32_bf16 v[144:147], a[156:159], a[16:19], v[144:147]
  ds_read_b64_tr_b16 a[142:143], v1 offset:25216
  v_mfma_f32_16x16x32_bf16 v[144:147], a[152:155], a[0:3], v[144:147]
  s_waitcnt lgkmcnt(8)
  v_mfma_f32_16x16x32_bf16 v[160:163], a[160:163], a[0:3], v[160:163]
  ds_read_b64_tr_b16 a[144:145], v1 offset:14496
  v_mfma_f32_16x16x32_bf16 v[160:163], a[164:167], a[16:19], v[160:163]
  v_mfma_f32_16x16x32_bf16 v[164:167], a[164:167], a[20:23], v[164:167]
  ds_read_b64_tr_b16 a[146:147], v1 offset:18080
  v_mfma_f32_16x16x32_bf16 v[164:167], a[160:163], a[4:7], v[164:167]
  v_mfma_f32_16x16x32_bf16 v[168:171], a[160:163], a[8:11], v[168:171]
  ds_read_b64_tr_b16 a[148:149], v1 offset:21664
  v_mfma_f32_16x16x32_bf16 v[168:171], a[164:167], a[24:27], v[168:171]
  v_mfma_f32_16x16x32_bf16 v[172:175], a[164:167], a[28:31], v[172:175]
  ds_read_b64_tr_b16 a[150:151], v1 offset:25248
  v_mfma_f32_16x16x32_bf16 v[172:175], a[160:163], a[12:15], v[172:175]
  s_waitcnt vmcnt(12)
  s_barrier
  buffer_load_dwordx4 v8, s[16:19], s56 offen offset:1024 lds
  v_mfma_f32_16x16x32_bf16 v[188:191], a[168:171], a[12:15], v[188:191]
  ds_read_b64_tr_b16 a[152:153], v1 offset:14528
  v_mfma_f32_16x16x32_bf16 v[188:191], a[172:175], a[28:31], v[188:191]
  v_mfma_f32_16x16x32_bf16 v[184:187], a[172:175], a[24:27], v[184:187]
  ds_read_b64_tr_b16 a[154:155], v1 offset:18112
  v_mfma_f32_16x16x32_bf16 v[184:187], a[168:171], a[8:11], v[184:187]
  v_mfma_f32_16x16x32_bf16 v[180:183], a[168:171], a[4:7], v[180:183]
  buffer_load_dwordx4 a[68:71], v0, s[36:39], s57 offen offset:1024 sc1
  v_mfma_f32_16x16x32_bf16 v[180:183], a[172:175], a[20:23], v[180:183]
  ds_read_b64_tr_b16 a[156:157], v1 offset:21696
  v_mfma_f32_16x16x32_bf16 v[176:179], a[172:175], a[16:19], v[176:179]
  ds_read_b64_tr_b16 a[158:159], v1 offset:25280
  v_mfma_f32_16x16x32_bf16 v[176:179], a[168:171], a[0:3], v[176:179]
  s_waitcnt lgkmcnt(8)
  v_mfma_f32_16x16x32_bf16 v[192:195], a[128:131], a[0:3], v[192:195]
  ds_read_b64_tr_b16 a[160:161], v1 offset:28672
  v_mfma_f32_16x16x32_bf16 v[192:195], a[132:135], a[16:19], v[192:195]
  v_mfma_f32_16x16x32_bf16 v[196:199], a[132:135], a[20:23], v[196:199]
  ds_read_b64_tr_b16 a[162:163], v1 offset:32256
  v_mfma_f32_16x16x32_bf16 v[196:199], a[128:131], a[4:7], v[196:199]
  v_mfma_f32_16x16x32_bf16 v[200:203], a[128:131], a[8:11], v[200:203]
  ds_read_b64_tr_b16 a[164:165], v1 offset:35840
  v_mfma_f32_16x16x32_bf16 v[200:203], a[132:135], a[24:27], v[200:203]
  v_mfma_f32_16x16x32_bf16 v[204:207], a[132:135], a[28:31], v[204:207]
  buffer_load_dwordx4 v9, s[16:19], s56 offen offset:2048 lds
  v_mfma_f32_16x16x32_bf16 v[204:207], a[128:131], a[12:15], v[204:207]
  ds_read_b64_tr_b16 a[166:167], v1 offset:39424
  v_mfma_f32_16x16x32_bf16 v[220:223], a[136:139], a[12:15], v[220:223]
  ds_read_b64_tr_b16 a[168:169], v1 offset:28704
  v_mfma_f32_16x16x32_bf16 v[220:223], a[140:143], a[28:31], v[220:223]
  v_mfma_f32_16x16x32_bf16 v[216:219], a[140:143], a[24:27], v[216:219]
  ds_read_b64_tr_b16 a[170:171], v1 offset:32288
  v_mfma_f32_16x16x32_bf16 v[216:219], a[136:139], a[8:11], v[216:219]
  buffer_load_dwordx4 a[72:75], v0, s[36:39], s57 offen offset:2048 sc1
  v_mfma_f32_16x16x32_bf16 v[212:215], a[136:139], a[4:7], v[212:215]
  ds_read_b64_tr_b16 a[172:173], v1 offset:35872
  v_mfma_f32_16x16x32_bf16 v[212:215], a[140:143], a[20:23], v[212:215]
  v_mfma_f32_16x16x32_bf16 v[208:211], a[140:143], a[16:19], v[208:211]
  ds_read_b64_tr_b16 a[174:175], v1 offset:39456
  v_mfma_f32_16x16x32_bf16 v[208:211], a[136:139], a[0:3], v[208:211]
  s_waitcnt lgkmcnt(8)
  v_mfma_f32_16x16x32_bf16 v[224:227], a[144:147], a[0:3], v[224:227]
  ds_read_b64_tr_b16 a[128:129], v1 offset:28736
  v_mfma_f32_16x16x32_bf16 v[224:227], a[148:151], a[16:19], v[224:227]
  v_mfma_f32_16x16x32_bf16 v[228:231], a[148:151], a[20:23], v[228:231]
  ds_read_b64_tr_b16 a[130:131], v1 offset:32320
  v_mfma_f32_16x16x32_bf16 v[228:231], a[144:147], a[4:7], v[228:231]
  v_mfma_f32_16x16x32_bf16 v[232:235], a[144:147], a[8:11], v[232:235]
  ds_read_b64_tr_b16 a[132:133], v1 offset:35904
  v_mfma_f32_16x16x32_bf16 v[232:235], a[148:151], a[24:27], v[232:235]
  buffer_load_dwordx4 a[76:79], v0, s[36:39], s57 offen offset:3072 sc1
  v_mfma_f32_16x16x32_bf16 v[236:239], a[148:151], a[28:31], v[236:239]
  ds_read_b64_tr_b16 a[134:135], v1 offset:39488
  v_mfma_f32_16x16x32_bf16 v[236:239], a[144:147], a[12:15], v[236:239]
  v_mfma_f32_16x16x32_bf16 v[252:255], a[152:155], a[12:15], v[252:255]
  ds_read_b64_tr_b16 a[136:137], v1 offset:28768
  v_mfma_f32_16x16x32_bf16 v[252:255], a[156:159], a[28:31], v[252:255]
  s_bfe_u32 s56, s84, 0x4001c
  s_mul_i32 s56, s56, 458752
  s_add_u32 m0, s77, 86016
  v_mfma_f32_16x16x32_bf16 v[248:251], a[156:159], a[24:27], v[248:251]
  buffer_load_dwordx4 a[208:211], v0, s[36:39], s59 offen offset:0 sc1
  v_add_u32 v31, 57344, v31
  v_mfma_f32_16x16x32_bf16 v[248:251], a[152:155], a[8:11], v[248:251]
  ds_read_b64_tr_b16 a[138:139], v1 offset:32352
  v_mfma_f32_16x16x32_bf16 v[244:247], a[152:155], a[4:7], v[244:247]
  ds_read_b64_tr_b16 a[140:141], v1 offset:35936
  v_mfma_f32_16x16x32_bf16 v[244:247], a[156:159], a[20:23], v[244:247]
  v_mfma_f32_16x16x32_bf16 v[240:243], a[156:159], a[16:19], v[240:243]
  ds_read_b64_tr_b16 a[142:143], v1 offset:39520
  v_mfma_f32_16x16x32_bf16 v[240:243], a[152:155], a[0:3], v[240:243]
  s_waitcnt vmcnt(8) lgkmcnt(8)
  buffer_load_dwordx4 a[212:215], v0, s[36:39], s59 offen offset:1024 sc1
  v_mfma_f32_16x16x32_bf16 v[32:35], a[160:163], a[32:35], v[32:35]
  ds_read_b64_tr_b16 a[144:145], v1 offset:28800
  v_mfma_f32_16x16x32_bf16 v[32:35], a[164:167], a[48:51], v[32:35]
  v_mfma_f32_16x16x32_bf16 v[36:39], a[164:167], a[52:55], v[36:39]
  ds_read_b64_tr_b16 a[146:147], v1 offset:32384
  v_mfma_f32_16x16x32_bf16 v[36:39], a[160:163], a[36:39], v[36:39]
  v_mfma_f32_16x16x32_bf16 v[40:43], a[160:163], a[40:43], v[40:43]
  buffer_load_dwordx4 v3, s[16:19], s56 offen offset:0 lds
  s_add_u32 s57, s57, 4096
  v_mfma_f32_16x16x32_bf16 v[40:43], a[164:167], a[56:59], v[40:43]
  ds_read_b64_tr_b16 a[148:149], v1 offset:35968
  v_mfma_f32_16x16x32_bf16 v[44:47], a[164:167], a[60:63], v[44:47]
  ds_read_b64_tr_b16 a[150:151], v1 offset:39552
  v_mfma_f32_16x16x32_bf16 v[44:47], a[160:163], a[44:47], v[44:47]
  v_mfma_f32_16x16x32_bf16 v[60:63], a[168:171], a[44:47], v[60:63]
  ds_read_b64_tr_b16 a[152:153], v1 offset:28832
  v_mfma_f32_16x16x32_bf16 v[60:63], a[172:175], a[60:63], v[60:63]
  buffer_load_dwordx4 a[80:83], v0, s[36:39], s57 offen offset:0 sc1
  v_mfma_f32_16x16x32_bf16 v[56:59], a[172:175], a[56:59], v[56:59]
  ds_read_b64_tr_b16 a[154:155], v1 offset:32416
  v_mfma_f32_16x16x32_bf16 v[56:59], a[168:171], a[40:43], v[56:59]
  v_mfma_f32_16x16x32_bf16 v[52:55], a[168:171], a[36:39], v[52:55]
  ds_read_b64_tr_b16 a[156:157], v1 offset:36000
  v_mfma_f32_16x16x32_bf16 v[52:55], a[172:175], a[52:55], v[52:55]
  v_mfma_f32_16x16x32_bf16 v[48:51], a[172:175], a[48:51], v[48:51]
  buffer_load_dwordx4 v4, s[16:19], s56 offen offset:1024 lds
  v_mfma_f32_16x16x32_bf16 v[48:51], a[168:171], a[32:35], v[48:51]
  s_waitcnt lgkmcnt(7)
  ds_read_b64_tr_b16 a[158:159], v1 offset:39584
  v_mfma_f32_16x16x32_bf16 v[64:67], a[128:131], a[32:35], v[64:67]
  ds_read_b64_tr_b16 a[160:161], v1 offset:28864
  v_mfma_f32_16x16x32_bf16 v[64:67], a[132:135], a[48:51], v[64:67]
  v_mfma_f32_16x16x32_bf16 v[68:71], a[132:135], a[52:55], v[68:71]
  ds_read_b64_tr_b16 a[162:163], v1 offset:32448
  v_mfma_f32_16x16x32_bf16 v[68:71], a[128:131], a[36:39], v[68:71]
  buffer_load_dwordx4 a[84:87], v0, s[36:39], s57 offen offset:1024 sc1
  v_mfma_f32_16x16x32_bf16 v[72:75], a[128:131], a[40:43], v[72:75]
  ds_read_b64_tr_b16 a[164:165], v1 offset:36032
  v_mfma_f32_16x16x32_bf16 v[72:75], a[132:135], a[56:59], v[72:75]
  v_mfma_f32_16x16x32_bf16 v[76:79], a[132:135], a[60:63], v[76:79]
  ds_read_b64_tr_b16 a[166:167], v1 offset:39616
  v_mfma_f32_16x16x32_bf16 v[76:79], a[128:131], a[44:47], v[76:79]
  v_mfma_f32_16x16x32_bf16 v[92:95], a[136:139], a[44:47], v[92:95]
  ds_read_b64_tr_b16 a[168:169], v1 offset:43008
  v_mfma_f32_16x16x32_bf16 v[92:95], a[140:143], a[60:63], v[92:95]
  v_mfma_f32_16x16x32_bf16 v[88:91], a[140:143], a[56:59], v[88:91]
  buffer_load_dwordx4 v5, s[16:19], s56 offen offset:2048 lds
  v_mfma_f32_16x16x32_bf16 v[88:91], a[136:139], a[40:43], v[88:91]
  ds_read_b64_tr_b16 a[170:171], v1 offset:46592
  v_mfma_f32_16x16x32_bf16 v[84:87], a[136:139], a[36:39], v[84:87]
  ds_read_b64_tr_b16 a[172:173], v1 offset:50176
  v_mfma_f32_16x16x32_bf16 v[84:87], a[140:143], a[52:55], v[84:87]
  v_mfma_f32_16x16x32_bf16 v[80:83], a[140:143], a[48:51], v[80:83]
  ds_read_b64_tr_b16 a[174:175], v1 offset:53760
  v_mfma_f32_16x16x32_bf16 v[80:83], a[136:139], a[32:35], v[80:83]
  s_waitcnt lgkmcnt(8)
  v_mfma_f32_16x16x32_bf16 v[96:99], a[144:147], a[32:35], v[96:99]
  ds_read_b64_tr_b16 a[128:129], v1 offset:43040
  v_mfma_f32_16x16x32_bf16 v[96:99], a[148:151], a[48:51], v[96:99]
  v_mfma_f32_16x16x32_bf16 v[100:103], a[148:151], a[52:55], v[100:103]
  buffer_load_dwordx4 a[88:91], v0, s[36:39], s57 offen offset:2048 sc1
  v_mfma_f32_16x16x32_bf16 v[100:103], a[144:147], a[36:39], v[100:103]
  ds_read_b64_tr_b16 a[130:131], v1 offset:46624
  v_mfma_f32_16x16x32_bf16 v[104:107], a[144:147], a[40:43], v[104:107]
  ds_read_b64_tr_b16 a[132:133], v1 offset:50208
  v_mfma_f32_16x16x32_bf16 v[104:107], a[148:151], a[56:59], v[104:107]
  v_mfma_f32_16x16x32_bf16 v[108:111], a[148:151], a[60:63], v[108:111]
  ds_read_b64_tr_b16 a[134:135], v1 offset:53792
  v_mfma_f32_16x16x32_bf16 v[108:111], a[144:147], a[44:47], v[108:111]
  v_mfma_f32_16x16x32_bf16 v[124:127], a[152:155], a[44:47], v[124:127]
  ds_read_b64_tr_b16 a[136:137], v1 offset:43072
  v_mfma_f32_16x16x32_bf16 v[124:127], a[156:159], a[60:63], v[124:127]
  buffer_load_dwordx4 v6, s[16:19], s56 offen offset:3072 lds
  v_mfma_f32_16x16x32_bf16 v[120:123], a[156:159], a[56:59], v[120:123]
  ds_read_b64_tr_b16 a[138:139], v1 offset:46656
  v_mfma_f32_16x16x32_bf16 v[120:123], a[152:155], a[40:43], v[120:123]
  v_mfma_f32_16x16x32_bf16 v[116:119], a[152:155], a[36:39], v[116:119]
  ds_read_b64_tr_b16 a[140:141], v1 offset:50240
  v_mfma_f32_16x16x32_bf16 v[116:119], a[156:159], a[52:55], v[116:119]
  v_mfma_f32_16x16x32_bf16 v[112:115], a[156:159], a[48:51], v[112:115]
  ds_read_b64_tr_b16 a[142:143], v1 offset:53824
  v_mfma_f32_16x16x32_bf16 v[112:115], a[152:155], a[32:35], v[112:115]
  s_waitcnt lgkmcnt(8)
  v_mfma_f32_16x16x32_bf16 v[128:131], a[160:163], a[32:35], v[128:131]
  ds_read_b64_tr_b16 a[144:145], v1 offset:43104
  v_mfma_f32_16x16x32_bf16 v[128:131], a[164:167], a[48:51], v[128:131]
  buffer_load_dwordx4 a[92:95], v0, s[36:39], s57 offen offset:3072 sc1
  v_mfma_f32_16x16x32_bf16 v[132:135], a[164:167], a[52:55], v[132:135]
  ds_read_b64_tr_b16 a[146:147], v1 offset:46688
  v_mfma_f32_16x16x32_bf16 v[132:135], a[160:163], a[36:39], v[132:135]
  v_mfma_f32_16x16x32_bf16 v[136:139], a[160:163], a[40:43], v[136:139]
  s_add_u32 m0, s77, 90112
  ds_read_b64_tr_b16 a[148:149], v1 offset:50272
  v_mfma_f32_16x16x32_bf16 v[136:139], a[164:167], a[56:59], v[136:139]
  v_mfma_f32_16x16x32_bf16 v[140:143], a[164:167], a[60:63], v[140:143]
  ds_read_b64_tr_b16 a[150:151], v1 offset:53856
  v_mfma_f32_16x16x32_bf16 v[140:143], a[160:163], a[44:47], v[140:143]
  v_mfma_f32_16x16x32_bf16 v[156:159], a[168:171], a[44:47], v[156:159]
  buffer_load_dwordx4 v7, s[16:19], s56 offen offset:0 lds
  s_bfe_u32 s57, s84, 0x4001c
  v_mfma_f32_16x16x32_bf16 v[156:159], a[172:175], a[60:63], v[156:159]
  s_lshl_b32 s57, s57, 13
  s_add_u32 s57, s57, s86
  ds_read_b64_tr_b16 a[152:153], v1 offset:43136
  v_mfma_f32_16x16x32_bf16 v[152:155], a[172:175], a[56:59], v[152:155]
  ds_read_b64_tr_b16 a[154:155], v1 offset:46720
  v_mfma_f32_16x16x32_bf16 v[152:155], a[168:171], a[40:43], v[152:155]
  v_mfma_f32_16x16x32_bf16 v[148:151], a[168:171], a[36:39], v[148:151]
  ds_read_b64_tr_b16 a[156:157], v1 offset:50304
  v_mfma_f32_16x16x32_bf16 v[148:151], a[172:175], a[52:55], v[148:151]
  buffer_load_dwordx4 a[96:99], v0, s[36:39], s57 offen offset:0 sc1
  v_mfma_f32_16x16x32_bf16 v[144:147], a[172:175], a[48:51], v[144:147]
  ds_read_b64_tr_b16 a[158:159], v1 offset:53888
  v_mfma_f32_16x16x32_bf16 v[144:147], a[168:171], a[32:35], v[144:147]
  s_waitcnt lgkmcnt(8)
  v_mfma_f32_16x16x32_bf16 v[160:163], a[128:131], a[32:35], v[160:163]
  ds_read_b64_tr_b16 a[160:161], v1 offset:43168
  v_mfma_f32_16x16x32_bf16 v[160:163], a[132:135], a[48:51], v[160:163]
  v_mfma_f32_16x16x32_bf16 v[164:167], a[132:135], a[52:55], v[164:167]
  ds_read_b64_tr_b16 a[162:163], v1 offset:46752
  v_mfma_f32_16x16x32_bf16 v[164:167], a[128:131], a[36:39], v[164:167]
  v_mfma_f32_16x16x32_bf16 v[168:171], a[128:131], a[40:43], v[168:171]
  ds_read_b64_tr_b16 a[164:165], v1 offset:50336
  v_mfma_f32_16x16x32_bf16 v[168:171], a[132:135], a[56:59], v[168:171]
  v_mfma_f32_16x16x32_bf16 v[172:175], a[132:135], a[60:63], v[172:175]
  ds_read_b64_tr_b16 a[166:167], v1 offset:53920
  v_mfma_f32_16x16x32_bf16 v[172:175], a[128:131], a[44:47], v[172:175]
  s_waitcnt vmcnt(14)
  s_barrier
  buffer_load_dwordx4 v8, s[16:19], s56 offen offset:1024 lds
  v_mfma_f32_16x16x32_bf16 v[188:191], a[136:139], a[44:47], v[188:191]
  ds_read_b64_tr_b16 a[168:169], v1 offset:43200
  v_mfma_f32_16x16x32_bf16 v[188:191], a[140:143], a[60:63], v[188:191]
  v_mfma_f32_16x16x32_bf16 v[184:187], a[140:143], a[56:59], v[184:187]
  ds_read_b64_tr_b16 a[170:171], v1 offset:46784
  v_mfma_f32_16x16x32_bf16 v[184:187], a[136:139], a[40:43], v[184:187]
  v_mfma_f32_16x16x32_bf16 v[180:183], a[136:139], a[36:39], v[180:183]
  buffer_load_dwordx4 a[100:103], v0, s[36:39], s57 offen offset:1024 sc1
  v_mfma_f32_16x16x32_bf16 v[180:183], a[140:143], a[52:55], v[180:183]
  ds_read_b64_tr_b16 a[172:173], v1 offset:50368
  v_mfma_f32_16x16x32_bf16 v[176:179], a[140:143], a[48:51], v[176:179]
  ds_read_b64_tr_b16 a[174:175], v1 offset:53952
  v_mfma_f32_16x16x32_bf16 v[176:179], a[136:139], a[32:35], v[176:179]
  s_waitcnt lgkmcnt(8)
  v_mfma_f32_16x16x32_bf16 v[192:195], a[144:147], a[32:35], v[192:195]
  ds_read_b64_tr_b16 a[128:129], v2 offset:0
  v_mfma_f32_16x16x32_bf16 v[192:195], a[148:151], a[48:51], v[192:195]
  v_mfma_f32_16x16x32_bf16 v[196:199], a[148:151], a[52:55], v[196:199]
  ds_read_b64_tr_b16 a[130:131], v2 offset:3584
  v_mfma_f32_16x16x32_bf16 v[196:199], a[144:147], a[36:39], v[196:199]
  v_mfma_f32_16x16x32_bf16 v[200:203], a[144:147], a[40:43], v[200:203]
  ds_read_b64_tr_b16 a[132:133], v2 offset:7168
  v_mfma_f32_16x16x32_bf16 v[200:203], a[148:151], a[56:59], v[200:203]
  ds_read_b64_tr_b16 a[176:177], v31 offset:0
  v_mfma_f32_16x16x32_bf16 v[204:207], a[148:151], a[60:63], v[204:207]
  buffer_load_dwordx4 v9, s[16:19], s56 offen offset:2048 lds
  v_mfma_f32_16x16x32_bf16 v[204:207], a[144:147], a[44:47], v[204:207]
  ds_read_b64_tr_b16 a[134:135], v2 offset:10752
  v_mfma_f32_16x16x32_bf16 v[220:223], a[152:155], a[44:47], v[220:223]
  ds_read_b64_tr_b16 a[136:137], v2 offset:32
  v_mfma_f32_16x16x32_bf16 v[220:223], a[156:159], a[60:63], v[220:223]
  ds_read_b64_tr_b16 a[178:179], v31 offset:3584
  v_mfma_f32_16x16x32_bf16 v[216:219], a[156:159], a[56:59], v[216:219]
  ds_read_b64_tr_b16 a[138:139], v2 offset:3616
  v_mfma_f32_16x16x32_bf16 v[216:219], a[152:155], a[40:43], v[216:219]
  buffer_load_dwordx4 a[104:107], v0, s[36:39], s57 offen offset:2048 sc1
  v_mfma_f32_16x16x32_bf16 v[212:215], a[152:155], a[36:39], v[212:215]
  ds_read_b64_tr_b16 a[140:141], v2 offset:7200
  v_mfma_f32_16x16x32_bf16 v[212:215], a[156:159], a[52:55], v[212:215]
  ds_read_b64_tr_b16 a[180:181], v31 offset:7168
  v_mfma_f32_16x16x32_bf16 v[208:211], a[156:159], a[48:51], v[208:211]
  ds_read_b64_tr_b16 a[142:143], v2 offset:10784
  v_mfma_f32_16x16x32_bf16 v[208:211], a[152:155], a[32:35], v[208:211]
  s_waitcnt lgkmcnt(11)
  ds_read_b64_tr_b16 a[182:183], v31 offset:10752
  v_mfma_f32_16x16x32_bf16 v[224:227], a[160:163], a[32:35], v[224:227]
  ds_read_b64_tr_b16 a[144:145], v2 offset:64
  v_mfma_f32_16x16x32_bf16 v[224:227], a[164:167], a[48:51], v[224:227]
  ds_read_b64_tr_b16 a[184:185], v31 offset:32
  v_mfma_f32_16x16x32_bf16 v[228:231], a[164:167], a[52:55], v[228:231]
  ds_read_b64_tr_b16 a[146:147], v2 offset:3648
  v_mfma_f32_16x16x32_bf16 v[228:231], a[160:163], a[36:39], v[228:231]
  ds_read_b64_tr_b16 a[186:187], v31 offset:3616
  v_mfma_f32_16x16x32_bf16 v[232:235], a[160:163], a[40:43], v[232:235]
  ds_read_b64_tr_b16 a[148:149], v2 offset:7232
  v_mfma_f32_16x16x32_bf16 v[232:235], a[164:167], a[56:59], v[232:235]
  buffer_load_dwordx4 a[108:111], v0, s[36:39], s57 offen offset:3072 sc1
  v_mfma_f32_16x16x32_bf16 v[236:239], a[164:167], a[60:63], v[236:239]
  ds_read_b64_tr_b16 a[150:151], v2 offset:10816
  v_mfma_f32_16x16x32_bf16 v[236:239], a[160:163], a[44:47], v[236:239]
  ds_read_b64_tr_b16 a[188:189], v31 offset:7200
  v_mfma_f32_16x16x32_bf16 v[252:255], a[168:171], a[44:47], v[252:255]
  ds_read_b64_tr_b16 a[152:153], v2 offset:96
  v_mfma_f32_16x16x32_bf16 v[252:255], a[172:175], a[60:63], v[252:255]
  s_bfe_u32 s56, s85, 0x40000
  s_mul_i32 s56, s56, 458752
  s_add_u32 m0, s77, 0
  v_mfma_f32_16x16x32_bf16 v[248:251], a[172:175], a[56:59], v[248:251]
  ds_read_b64_tr_b16 a[154:155], v2 offset:3680
  v_mfma_f32_16x16x32_bf16 v[248:251], a[168:171], a[40:43], v[248:251]
  ds_read_b64_tr_b16 a[190:191], v31 offset:10784
  v_mfma_f32_16x16x32_bf16 v[244:247], a[168:171], a[36:39], v[244:247]
  ds_read_b64_tr_b16 a[156:157], v2 offset:7264
  v_mfma_f32_16x16x32_bf16 v[244:247], a[172:175], a[52:55], v[244:247]
  buffer_load_dwordx4 v3, s[16:19], s56 offen offset:0 lds
  v_mfma_f32_16x16x32_bf16 v[240:243], a[172:175], a[48:51], v[240:243]
  ds_read_b64_tr_b16 a[158:159], v2 offset:10848
  v_mfma_f32_16x16x32_bf16 v[240:243], a[168:171], a[32:35], v[240:243]
  s_waitcnt vmcnt(8) lgkmcnt(13)
  ds_read_b64_tr_b16 a[192:193], v31 offset:64
  v_mfma_f32_16x16x32_bf16 v[32:35], a[128:131], a[64:67], v[32:35]
  s_add_u32 s57, s57, 4096
  ds_read_b64_tr_b16 a[194:195], v31 offset:3648
  v_mfma_f32_16x16x32_bf16 v[32:35], a[132:135], a[80:83], v[32:35]
  ds_read_b64_tr_b16 a[196:197], v31 offset:7232
  v_mfma_f32_16x16x32_bf16 v[36:39], a[132:135], a[84:87], v[36:39]
  ds_read_b64_tr_b16 a[198:199], v31 offset:10816
  v_mfma_f32_16x16x32_bf16 v[36:39], a[128:131], a[68:71], v[36:39]
  ds_read_b64_tr_b16 a[200:201], v31 offset:96
  v_mfma_f32_16x16x32_bf16 v[40:43], a[128:131], a[72:75], v[40:43]
  buffer_load_dwordx4 a[112:115], v0, s[36:39], s57 offen offset:0 sc1
  v_mfma_f32_16x16x32_bf16 v[40:43], a[132:135], a[88:91], v[40:43]
  ds_read_b64_tr_b16 a[202:203], v31 offset:3680
  v_mfma_f32_16x16x32_bf16 v[44:47], a[132:135], a[92:95], v[44:47]
  ds_read_b64_tr_b16 a[204:205], v31 offset:7264
  v_mfma_f32_16x16x32_bf16 v[44:47], a[128:131], a[76:79], v[44:47]
  ds_read_b64_tr_b16 a[206:207], v31 offset:10848
  v_mfma_f32_16x16x32_bf16 v[60:63], a[136:139], a[76:79], v[60:63]
  ds_read_b64_tr_b16 a[160:161], v2 offset:128
  v_mfma_f32_16x16x32_bf16 v[60:63], a[140:143], a[92:95], v[60:63]
  v_mfma_f32_16x16x32_bf16 v[56:59], a[140:143], a[88:91], v[56:59]
  ds_read_b64_tr_b16 a[162:163], v2 offset:3712
  v_mfma_f32_16x16x32_bf16 v[56:59], a[136:139], a[72:75], v[56:59]
  buffer_load_dwordx4 v4, s[16:19], s56 offen offset:1024 lds
  v_mfma_f32_16x16x32_bf16 v[52:55], a[136:139], a[68:71], v[52:55]
  ds_read_b64_tr_b16 a[164:165], v2 offset:7296
  v_mfma_f32_16x16x32_bf16 v[52:55], a[140:143], a[84:87], v[52:55]
  v_mfma_f32_16x16x32_bf16 v[48:51], a[140:143], a[80:83], v[48:51]
  ds_read_b64_tr_b16 a[166:167], v2 offset:10880
  v_mfma_f32_16x16x32_bf16 v[48:51], a[136:139], a[64:67], v[48:51]
  s_waitcnt lgkmcnt(12)
  v_mfma_f32_16x16x32_bf16 v[64:67], a[144:147], a[64:67], v[64:67]
  ds_read_b64_tr_b16 a[168:169], v2 offset:160
  v_mfma_f32_16x16x32_bf16 v[64:67], a[148:151], a[80:83], v[64:67]
  v_mfma_f32_16x16x32_bf16 v[68:71], a[148:151], a[84:87], v[68:71]
  ds_read_b64_tr_b16 a[170:171], v2 offset:3744
  v_mfma_f32_16x16x32_bf16 v[68:71], a[144:147], a[68:71], v[68:71]
  buffer_load_dwordx4 a[116:119], v0, s[36:39], s57 offen offset:1024 sc1
  v_mfma_f32_16x16x32_bf16 v[72:75], a[144:147], a[72:75], v[72:75]
  ds_read_b64_tr_b16 a[172:173], v2 offset:7328
  v_mfma_f32_16x16x32_bf16 v[72:75], a[148:151], a[88:91], v[72:75]
  v_mfma_f32_16x16x32_bf16 v[76:79], a[148:151], a[92:95], v[76:79]
  ds_read_b64_tr_b16 a[174:175], v2 offset:10912
  v_mfma_f32_16x16x32_bf16 v[76:79], a[144:147], a[76:79], v[76:79]
  v_mfma_f32_16x16x32_bf16 v[92:95], a[152:155], a[76:79], v[92:95]
  ds_read_b64_tr_b16 a[128:129], v2 offset:192
  v_mfma_f32_16x16x32_bf16 v[92:95], a[156:159], a[92:95], v[92:95]
  v_mfma_f32_16x16x32_bf16 v[88:91], a[156:159], a[88:91], v[88:91]
  buffer_load_dwordx4 v5, s[16:19], s56 offen offset:2048 lds
  v_mfma_f32_16x16x32_bf16 v[88:91], a[152:155], a[72:75], v[88:91]
  ds_read_b64_tr_b16 a[130:131], v2 offset:3776
  v_mfma_f32_16x16x32_bf16 v[84:87], a[152:155], a[68:71], v[84:87]
  ds_read_b64_tr_b16 a[132:133], v2 offset:7360
  v_mfma_f32_16x16x32_bf16 v[84:87], a[156:159], a[84:87], v[84:87]
  v_mfma_f32_16x16x32_bf16 v[80:83], a[156:159], a[80:83], v[80:83]
  ds_read_b64_tr_b16 a[134:135], v2 offset:10944
  v_mfma_f32_16x16x32_bf16 v[80:83], a[152:155], a[64:67], v[80:83]
  s_waitcnt vmcnt(20) lgkmcnt(12)
  v_mfma_f32_16x16x32_bf16 a[216:219], a[176:179], a[208:211], 0
  ds_read_b64_tr_b16 a[136:137], v2 offset:14336
  v_mfma_f32_16x16x32_bf16 a[216:219], a[180:183], a[212:215], a[216:219]
  v_mfma_f32_16x16x32_bf16 a[220:223], a[184:187], a[208:211], 0
  buffer_load_dwordx4 a[120:123], v0, s[36:39], s57 offen offset:2048 sc1
  v_mfma_f32_16x16x32_bf16 a[220:223], a[188:191], a[212:215], a[220:223]
  ds_read_b64_tr_b16 a[138:139], v2 offset:17920
  v_mfma_f32_16x16x32_bf16 a[224:227], a[192:195], a[208:211], 0
  ds_read_b64_tr_b16 a[140:141], v2 offset:21504
  v_mfma_f32_16x16x32_bf16 a[224:227], a[196:199], a[212:215], a[224:227]
  v_mfma_f32_16x16x32_bf16 a[228:231], a[200:203], a[208:211], 0
  ds_read_b64_tr_b16 a[142:143], v2 offset:25088
  v_mfma_f32_16x16x32_bf16 a[228:231], a[204:207], a[212:215], a[228:231]
  s_waitcnt lgkmcnt(8)
  v_mfma_f32_16x16x32_bf16 v[96:99], a[160:163], a[64:67], v[96:99]
  ds_read_b64_tr_b16 a[144:145], v2 offset:14368
  v_mfma_f32_16x16x32_bf16 v[96:99], a[164:167], a[80:83], v[96:99]
  buffer_load_dwordx4 v6, s[16:19], s56 offen offset:3072 lds
  v_mfma_f32_16x16x32_bf16 v[100:103], a[164:167], a[84:87], v[100:103]
  s_lshl2_add_u32 s78, s58, s44
  ds_read_b64_tr_b16 a[146:147], v2 offset:17952
  s_lshl_b32 s78, s78, 13
  v_mfma_f32_16x16x32_bf16 v[100:103], a[160:163], a[68:71], v[100:103]
  s_add_u32 s78, s78, 262144
  s_add_u32 s79, s78, 4096
  v_mfma_f32_16x16x32_bf16 v[104:107], a[160:163], a[72:75], v[104:107]
  ds_read_b64_tr_b16 a[148:149], v2 offset:21536
  v_mfma_f32_16x16x32_bf16 v[104:107], a[164:167], a[88:91], v[104:107]
  v_mfma_f32_16x16x32_bf16 v[108:111], a[164:167], a[92:95], v[108:111]
  ds_read_b64_tr_b16 a[150:151], v2 offset:25120
  v_mfma_f32_16x16x32_bf16 v[108:111], a[160:163], a[76:79], v[108:111]
  buffer_load_dwordx4 a[176:179], v0, s[36:39], s78 offen offset:0 sc1
  v_mfma_f32_16x16x32_bf16 v[124:127], a[168:171], a[76:79], v[124:127]
  ds_read_b64_tr_b16 a[152:153], v2 offset:14400
  v_mfma_f32_16x16x32_bf16 v[124:127], a[172:175], a[92:95], v[124:127]
  v_mfma_f32_16x16x32_bf16 v[120:123], a[172:175], a[88:91], v[120:123]
  ds_read_b64_tr_b16 a[154:155], v2 offset:17984
  v_mfma_f32_16x16x32_bf16 v[120:123], a[168:171], a[72:75], v[120:123]
  v_mfma_f32_16x16x32_bf16 v[116:119], a[168:171], a[68:71], v[116:119]
  buffer_load_dwordx4 a[124:127], v0, s[36:39], s57 offen offset:3072 sc1
  s_add_u32 m0, s77, 4096
  v_mfma_f32_16x16x32_bf16 v[116:119], a[172:175], a[84:87], v[116:119]
  ds_read_b64_tr_b16 a[156:157], v2 offset:21568
  v_mfma_f32_16x16x32_bf16 v[112:115], a[172:175], a[80:83], v[112:115]
  ds_read_b64_tr_b16 a[158:159], v2 offset:25152
  v_mfma_f32_16x16x32_bf16 v[112:115], a[168:171], a[64:67], v[112:115]
  s_waitcnt lgkmcnt(8)
  v_mfma_f32_16x16x32_bf16 v[128:131], a[128:131], a[64:67], v[128:131]
  ds_read_b64_tr_b16 a[160:161], v2 offset:14432
  v_mfma_f32_16x16x32_bf16 v[128:131], a[132:135], a[80:83], v[128:131]
  buffer_load_dwordx4 v7, s[16:19], s56 offen offset:0 lds
  s_bfe_u32 s57, s85, 0x40000
  v_mfma_f32_16x16x32_bf16 v[132:135], a[132:135], a[84:87], v[132:135]
  s_lshl_b32 s57, s57, 13
  s_add_u32 s57, s57, s86
  ds_read_b64_tr_b16 a[162:163], v2 offset:18016
  v_mfma_f32_16x16x32_bf16 v[132:135], a[128:131], a[68:71], v[132:135]
Hb2:
  s_cbranch_execz Hb2_1
  v_mfma_f32_16x16x32_bf16 v[136:139], a[128:131], a[72:75], v[136:139]
  ds_read_b64_tr_b16 a[164:165], v2 offset:21600
  v_mfma_f32_16x16x32_bf16 v[136:139], a[132:135], a[88:91], v[136:139]
  v_mfma_f32_16x16x32_bf16 v[140:143], a[132:135], a[92:95], v[140:143]
  buffer_load_dwordx4 a[0:3], v0, s[36:39], s57 offen offset:0 sc1
  v_mfma_f32_16x16x32_bf16 v[140:143], a[128:131], a[76:79], v[140:143]
  ds_read_b64_tr_b16 a[166:167], v2 offset:25184
  v_mfma_f32_16x16x32_bf16 v[156:159], a[136:139], a[76:79], v[156:159]
  ds_read_b64_tr_b16 a[168:169], v2 offset:14464
  v_mfma_f32_16x16x32_bf16 v[156:159], a[140:143], a[92:95], v[156:159]
  v_mfma_f32_16x16x32_bf16 v[152:155], a[140:143], a[88:91], v[152:155]
  ds_read_b64_tr_b16 a[170:171], v2 offset:18048
  v_mfma_f32_16x16x32_bf16 v[152:155], a[136:139], a[72:75], v[152:155]
  buffer_load_dwordx4 a[180:183], v0, s[36:39], s78 offen offset:1024 sc1
  v_mfma_f32_16x16x32_bf16 v[148:151], a[136:139], a[68:71], v[148:151]
  ds_read_b64_tr_b16 a[172:173], v2 offset:21632
  v_mfma_f32_16x16x32_bf16 v[148:151], a[140:143], a[84:87], v[148:151]
  v_mfma_f32_16x16x32_bf16 v[144:147], a[140:143], a[80:83], v[144:147]
  ds_read_b64_tr_b16 a[174:175], v2 offset:25216
  v_mfma_f32_16x16x32_bf16 v[144:147], a[136:139], a[64:67], v[144:147]
  s_waitcnt lgkmcnt(8)
  v_mfma_f32_16x16x32_bf16 v[160:163], a[144:147], a[64:67], v[160:163]
  buffer_load_dwordx4 v8, s[16:19], s56 offen offset:1024 lds
  v_mfma_f32_16x16x32_bf16 v[160:163], a[148:151], a[80:83], v[160:163]
  ds_read_b64_tr_b16 a[128:129], v2 offset:14496
  v_mfma_f32_16x16x32_bf16 v[164:167], a[148:151], a[84:87], v[164:167]
  ds_read_b64_tr_b16 a[130:131], v2 offset:18080
  v_mfma_f32_16x16x32_bf16 v[164:167], a[144:147], a[68:71], v[164:167]
  v_mfma_f32_16x16x32_bf16 v[168:171], a[144:147], a[72:75], v[168:171]
  ds_read_b64_tr_b16 a[132:133], v2 offset:21664
  v_mfma_f32_16x16x32_bf16 v[168:171], a[148:151], a[88:91], v[168:171]
  buffer_load_dwordx4 a[4:7], v0, s[36:39], s57 offen offset:1024 sc1
  v_mfma_f32_16x16x32_bf16 v[172:175], a[148:151], a[92:95], v[172:175]
  ds_read_b64_tr_b16 a[134:135], v2 offset:25248
  v_mfma_f32_16x16x32_bf16 v[172:175], a[144:147], a[76:79], v[172:175]
  s_waitcnt vmcnt(16)
  s_barrier
  v_mfma_f32_16x16x32_bf16 v[188:191], a[152:155], a[76:79], v[188:191]
  ds_read_b64_tr_b16 a[136:137], v2 offset:14528
  v_mfma_f32_16x16x32_bf16 v[188:191], a[156:159], a[92:95], v[188:191]
  v_mfma_f32_16x16x32_bf16 v[184:187], a[156:159], a[88:91], v[184:187]
  ds_read_b64_tr_b16 a[138:139], v2 offset:18112
  v_mfma_f32_16x16x32_bf16 v[184:187], a[152:155], a[72:75], v[184:187]
  buffer_load_dwordx4 a[184:187], v0, s[36:39], s78 offen offset:2048 sc1
  v_mfma_f32_16x16x32_bf16 v[180:183], a[152:155], a[68:71], v[180:183]
  ds_read_b64_tr_b16 a[140:141], v2 offset:21696
  v_mfma_f32_16x16x32_bf16 v[180:183], a[156:159], a[84:87], v[180:183]
  v_mfma_f32_16x16x32_bf16 v[176:179], a[156:159], a[80:83], v[176:179]
  ds_read_b64_tr_b16 a[142:143], v2 offset:25280
  v_mfma_f32_16x16x32_bf16 v[176:179], a[152:155], a[64:67], v[176:179]
  s_waitcnt lgkmcnt(8)
  v_mfma_f32_16x16x32_bf16 v[192:195], a[160:163], a[64:67], v[192:195]
  buffer_load_dwordx4 v9, s[16:19], s56 offen offset:2048 lds
  v_mfma_f32_16x16x32_bf16 v[192:195], a[164:167], a[80:83], v[192:195]
  ds_read_b64_tr_b16 a[144:145], v2 offset:28672
  v_mfma_f32_16x16x32_bf16 v[196:199], a[164:167], a[84:87], v[196:199]
  ds_read_b64_tr_b16 a[146:147], v2 offset:32256
  v_mfma_f32_16x16x32_bf16 v[196:199], a[160:163], a[68:71], v[196:199]
  v_mfma_f32_16x16x32_bf16 v[200:203], a[160:163], a[72:75], v[200:203]
  ds_read_b64_tr_b16 a[148:149], v2 offset:35840
  v_mfma_f32_16x16x32_bf16 v[200:203], a[164:167], a[88:91], v[200:203]
  buffer_load_dwordx4 a[8:11], v0, s[36:39], s57 offen offset:2048 sc1
  v_mfma_f32_16x16x32_bf16 v[204:207], a[164:167], a[92:95], v[204:207]
  ds_read_b64_tr_b16 a[150:151], v2 offset:39424
  v_mfma_f32_16x16x32_bf16 v[204:207], a[160:163], a[76:79], v[204:207]
  v_mfma_f32_16x16x32_bf16 v[220:223], a[168:171], a[76:79], v[220:223]
  ds_read_b64_tr_b16 a[152:153], v2 offset:28704
  v_mfma_f32_16x16x32_bf16 v[220:223], a[172:175], a[92:95], v[220:223]
  buffer_load_dwordx4 a[188:191], v0, s[36:39], s78 offen offset:3072 sc1
  v_mfma_f32_16x16x32_bf16 v[216:219], a[172:175], a[88:91], v[216:219]
  ds_read_b64_tr_b16 a[154:155], v2 offset:32288
  v_mfma_f32_16x16x32_bf16 v[216:219], a[168:171], a[72:75], v[216:219]
  v_mfma_f32_16x16x32_bf16 v[212:215], a[168:171], a[68:71], v[212:215]
  ds_read_b64_tr_b16 a[156:157], v2 offset:35872
  v_mfma_f32_16x16x32_bf16 v[212:215], a[172:175], a[84:87], v[212:215]
  v_mfma_f32_16x16x32_bf16 v[208:211], a[172:175], a[80:83], v[208:211]
  buffer_load_dwordx4 a[12:15], v0, s[36:39], s57 offen offset:3072 sc1
  v_mfma_f32_16x16x32_bf16 v[208:211], a[168:171], a[64:67], v[208:211]
  s_waitcnt lgkmcnt(7)
  ds_read_b64_tr_b16 a[158:159], v2 offset:39456
  v_mfma_f32_16x16x32_bf16 v[224:227], a[128:131], a[64:67], v[224:227]
  ds_read_b64_tr_b16 a[160:161], v2 offset:28736
  v_mfma_f32_16x16x32_bf16 v[224:227], a[132:135], a[80:83], v[224:227]
  s_bfe_u32 s56, s85, 0x40004
  s_mul_i32 s56, s56, 458752
  s_add_u32 m0, s77, 28672
  v_mfma_f32_16x16x32_bf16 v[228:231], a[132:135], a[84:87], v[228:231]
  buffer_load_dwordx4 a[192:195], v0, s[36:39], s79 offen offset:0 sc1
  v_mfma_f32_16x16x32_bf16 v[228:231], a[128:131], a[68:71], v[228:231]
  ds_read_b64_tr_b16 a[162:163], v2 offset:32320
  v_mfma_f32_16x16x32_bf16 v[232:235], a[128:131], a[72:75], v[232:235]
  ds_read_b64_tr_b16 a[164:165], v2 offset:35904
  v_mfma_f32_16x16x32_bf16 v[232:235], a[132:135], a[88:91], v[232:235]
  v_mfma_f32_16x16x32_bf16 v[236:239], a[132:135], a[92:95], v[236:239]
  ds_read_b64_tr_b16 a[166:167], v2 offset:39488
  v_mfma_f32_16x16x32_bf16 v[236:239], a[128:131], a[76:79], v[236:239]
  buffer_load_dwordx4 v3, s[16:19], s56 offen offset:0 lds
  v_mfma_f32_16x16x32_bf16 v[252:255], a[136:139], a[76:79], v[252:255]
  ds_read_b64_tr_b16 a[168:169], v2 offset:28768
  v_mfma_f32_16x16x32_bf16 v[252:255], a[140:143], a[92:95], v[252:255]
  v_mfma_f32_16x16x32_bf16 v[248:251], a[140:143], a[88:91], v[248:251]
  ds_read_b64_tr_b16 a[170:171], v2 offset:32352
  v_mfma_f32_16x16x32_bf16 v[248:251], a[136:139], a[72:75], v[248:251]
  buffer_load_dwordx4 a[196:199], v0, s[36:39], s79 offen offset:1024 sc1
  v_mfma_f32_16x16x32_bf16 v[244:247], a[136:139], a[68:71], v[244:247]
  ds_read_b64_tr_b16 a[172:173], v2 offset:35936
  v_mfma_f32_16x16x32_bf16 v[244:247], a[140:143], a[84:87], v[244:247]
  v_mfma_f32_16x16x32_bf16 v[240:243], a[140:143], a[80:83], v[240:243]
  ds_read_b64_tr_b16 a[174:175], v2 offset:39520
  v_mfma_f32_16x16x32_bf16 v[240:243], a[136:139], a[64:67], v[240:243]
  s_waitcnt vmcnt(13) lgkmcnt(8)
  v_mfma_f32_16x16x32_bf16 v[32:35], a[144:147], a[96:99], v[32:35]
  s_add_u32 s57, s57, 4096
  ds_read_b64_tr_b16 a[128:129], v2 offset:28800
  v_mfma_f32_16x16x32_bf16 v[32:35], a[148:151], a[112:115], v[32:35]
  buffer_load_dwordx4 a[200:203], v0, s[36:39], s79 offen offset:2048 sc1
  v_mfma_f32_16x16x32_bf16 v[36:39], a[148:151], a[116:119], v[36:39]
  ds_read_b64_tr_b16 a[130:131], v2 offset:32384
  v_mfma_f32_16x16x32_bf16 v[36:39], a[144:147], a[100:103], v[36:39]
  v_mfma_f32_16x16x32_bf16 v[40:43], a[144:147], a[104:107], v[40:43]
  ds_read_b64_tr_b16 a[132:133], v2 offset:35968
  v_mfma_f32_16x16x32_bf16 v[40:43], a[148:151], a[120:123], v[40:43]
  v_mfma_f32_16x16x32_bf16 v[44:47], a[148:151], a[124:127], v[44:47]
  buffer_load_dwordx4 a[16:19], v0, s[36:39], s57 offen offset:0 sc1
  v_mfma_f32_16x16x32_bf16 v[44:47], a[144:147], a[108:111], v[44:47]
  ds_read_b64_tr_b16 a[134:135], v2 offset:39552
  v_mfma_f32_16x16x32_bf16 v[60:63], a[152:155], a[108:111], v[60:63]
  ds_read_b64_tr_b16 a[136:137], v2 offset:28832
  v_mfma_f32_16x16x32_bf16 v[60:63], a[156:159], a[124:127], v[60:63]
  v_mfma_f32_16x16x32_bf16 v[56:59], a[156:159], a[120:123], v[56:59]
  ds_read_b64_tr_b16 a[138:139], v2 offset:32416
  v_mfma_f32_16x16x32_bf16 v[56:59], a[152:155], a[104:107], v[56:59]
  buffer_load_dwordx4 v4, s[16:19], s56 offen offset:1024 lds
  v_mfma_f32_16x16x32_bf16 v[52:55], a[152:155], a[100:103], v[52:55]
  ds_read_b64_tr_b16 a[140:141], v2 offset:36000
  v_mfma_f32_16x16x32_bf16 v[52:55], a[156:159], a[116:119], v[52:55]
  buffer_load_dwordx4 a[204:207], v0, s[36:39], s79 offen offset:3072 sc1
  v_mfma_f32_16x16x32_bf16 v[48:51], a[156:159], a[112:115], v[48:51]
  ds_read_b64_tr_b16 a[142:143], v2 offset:39584
  v_mfma_f32_16x16x32_bf16 v[48:51], a[152:155], a[96:99], v[48:51]
  s_waitcnt lgkmcnt(8)
  v_mfma_f32_16x16x32_bf16 v[64:67], a[160:163], a[96:99], v[64:67]
  ds_read_b64_tr_b16 a[144:145], v2 offset:28864
  v_mfma_f32_16x16x32_bf16 v[64:67], a[164:167], a[112:115], v[64:67]
  v_mfma_f32_16x16x32_bf16 v[68:71], a[164:167], a[116:119], v[68:71]
  ds_read_b64_tr_b16 a[146:147], v2 offset:32448
  v_mfma_f32_16x16x32_bf16 v[68:71], a[160:163], a[100:103], v[68:71]
  buffer_load_dwordx4 a[20:23], v0, s[36:39], s57 offen offset:1024 sc1
  v_mfma_f32_16x16x32_bf16 v[72:75], a[160:163], a[104:107], v[72:75]
  ds_read_b64_tr_b16 a[148:149], v2 offset:36032
  v_mfma_f32_16x16x32_bf16 v[72:75], a[164:167], a[120:123], v[72:75]
  v_mfma_f32_16x16x32_bf16 v[76:79], a[164:167], a[124:127], v[76:79]
  ds_read_b64_tr_b16 a[150:151], v2 offset:39616
  v_mfma_f32_16x16x32_bf16 v[76:79], a[160:163], a[108:111], v[76:79]
  v_mfma_f32_16x16x32_bf16 v[92:95], a[168:171], a[108:111], v[92:95]
  ds_read_b64_tr_b16 a[152:153], v2 offset:43008
  v_mfma_f32_16x16x32_bf16 v[92:95], a[172:175], a[124:127], v[92:95]
  v_mfma_f32_16x16x32_bf16 v[88:91], a[172:175], a[120:123], v[88:91]
  buffer_load_dwordx4 v5, s[16:19], s56 offen offset:2048 lds
  v_mfma_f32_16x16x32_bf16 v[88:91], a[168:171], a[104:107], v[88:91]
  ds_read_b64_tr_b16 a[154:155], v2 offset:46592
  v_mfma_f32_16x16x32_bf16 v[84:87], a[168:171], a[100:103], v[84:87]
  ds_read_b64_tr_b16 a[156:157], v2 offset:50176
  v_mfma_f32_16x16x32_bf16 v[84:87], a[172:175], a[116:119], v[84:87]
  v_mfma_f32_16x16x32_bf16 v[80:83], a[172:175], a[112:115], v[80:83]
  ds_read_b64_tr_b16 a[158:159], v2 offset:53760
  v_mfma_f32_16x16x32_bf16 v[80:83], a[168:171], a[96:99], v[80:83]
  s_waitcnt lgkmcnt(8)
  v_mfma_f32_16x16x32_bf16 v[96:99], a[128:131], a[96:99], v[96:99]
  ds_read_b64_tr_b16 a[160:161], v2 offset:43040
  v_mfma_f32_16x16x32_bf16 v[96:99], a[132:135], a[112:115], v[96:99]
  v_mfma_f32_16x16x32_bf16 v[100:103], a[132:135], a[116:119], v[100:103]
  buffer_load_dwordx4 a[24:27], v0, s[36:39], s57 offen offset:2048 sc1
  v_mfma_f32_16x16x32_bf16 v[100:103], a[128:131], a[100:103], v[100:103]
  ds_read_b64_tr_b16 a[162:163], v2 offset:46624
  v_mfma_f32_16x16x32_bf16 v[104:107], a[128:131], a[104:107], v[104:107]
  ds_read_b64_tr_b16 a[164:165], v2 offset:50208
  v_mfma_f32_16x16x32_bf16 v[104:107], a[132:135], a[120:123], v[104:107]
  v_mfma_f32_16x16x32_bf16 v[108:111], a[132:135], a[124:127], v[108:111]
  ds_read_b64_tr_b16 a[166:167], v2 offset:53792
  v_mfma_f32_16x16x32_bf16 v[108:111], a[128:131], a[108:111], v[108:111]
  v_mfma_f32_16x16x32_bf16 v[124:127], a[136:139], a[108:111], v[124:127]
  ds_read_b64_tr_b16 a[168:169], v2 offset:43072
  v_mfma_f32_16x16x32_bf16 v[124:127], a[140:143], a[124:127], v[124:127]
  buffer_load_dwordx4 v6, s[16:19], s56 offen offset:3072 lds
  v_mfma_f32_16x16x32_bf16 v[120:123], a[140:143], a[120:123], v[120:123]
  ds_read_b64_tr_b16 a[170:171], v2 offset:46656
  v_mfma_f32_16x16x32_bf16 v[120:123], a[136:139], a[104:107], v[120:123]
  v_mfma_f32_16x16x32_bf16 v[116:119], a[136:139], a[100:103], v[116:119]
  ds_read_b64_tr_b16 a[172:173], v2 offset:50240
  v_mfma_f32_16x16x32_bf16 v[116:119], a[140:143], a[116:119], v[116:119]
  v_mfma_f32_16x16x32_bf16 v[112:115], a[140:143], a[112:115], v[112:115]
  ds_read_b64_tr_b16 a[174:175], v2 offset:53824
  v_mfma_f32_16x16x32_bf16 v[112:115], a[136:139], a[96:99], v[112:115]
  s_waitcnt lgkmcnt(8)
  v_mfma_f32_16x16x32_bf16 v[128:131], a[144:147], a[96:99], v[128:131]
  ds_read_b64_tr_b16 a[128:129], v2 offset:43104
  v_mfma_f32_16x16x32_bf16 v[128:131], a[148:151], a[112:115], v[128:131]
  buffer_load_dwordx4 a[28:31], v0, s[36:39], s57 offen offset:3072 sc1
  v_mfma_f32_16x16x32_bf16 v[132:135], a[148:151], a[116:119], v[132:135]
  ds_read_b64_tr_b16 a[130:131], v2 offset:46688
  v_mfma_f32_16x16x32_bf16 v[132:135], a[144:147], a[100:103], v[132:135]
  v_mfma_f32_16x16x32_bf16 v[136:139], a[144:147], a[104:107], v[136:139]
  s_add_u32 m0, s77, 32768
  ds_read_b64_tr_b16 a[132:133], v2 offset:50272
  v_mfma_f32_16x16x32_bf16 v[136:139], a[148:151], a[120:123], v[136:139]
  v_mfma_f32_16x16x32_bf16 v[140:143], a[148:151], a[124:127], v[140:143]
  ds_read_b64_tr_b16 a[134:135], v2 offset:53856
  v_mfma_f32_16x16x32_bf16 v[140:143], a[144:147], a[108:111], v[140:143]
  v_mfma_f32_16x16x32_bf16 v[156:159], a[152:155], a[108:111], v[156:159]
  buffer_load_dwordx4 v7, s[16:19], s56 offen offset:0 lds
  s_bfe_u32 s57, s85, 0x40004
  v_mfma_f32_16x16x32_bf16 v[156:159], a[156:159], a[124:127], v[156:159]
  s_lshl_b32 s57, s57, 13
  s_add_u32 s57, s57, s86
  ds_read_b64_tr_b16 a[136:137], v2 offset:43136
  v_mfma_f32_16x16x32_bf16 v[152:155], a[156:159], a[120:123], v[152:155]
  ds_read_b64_tr_b16 a[138:139], v2 offset:46720
  v_mfma_f32_16x16x32_bf16 v[152:155], a[152:155], a[104:107], v[152:155]
  v_mfma_f32_16x16x32_bf16 v[148:151], a[152:155], a[100:103], v[148:151]
  ds_read_b64_tr_b16 a[140:141], v2 offset:50304
  v_mfma_f32_16x16x32_bf16 v[148:151], a[156:159], a[116:119], v[148:151]
  buffer_load_dwordx4 a[32:35], v0, s[36:39], s57 offen offset:0 sc1
  v_mfma_f32_16x16x32_bf16 v[144:147], a[156:159], a[112:115], v[144:147]
  ds_read_b64_tr_b16 a[142:143], v2 offset:53888
  v_mfma_f32_16x16x32_bf16 v[144:147], a[152:155], a[96:99], v[144:147]
  s_waitcnt lgkmcnt(8)
  v_mfma_f32_16x16x32_bf16 v[160:163], a[160:163], a[96:99], v[160:163]
  s_waitcnt vmcnt(7)
  ds_read_b64_tr_b16 a[144:145], v2 offset:43168
  v_accvgpr_read_b32 v22, a176
  v_mfma_f32_16x16x32_bf16 v[160:163], a[164:167], a[112:115], v[160:163]
  v_accvgpr_read_b32 v23, a177
  v_accvgpr_read_b32 v24, a178
  v_mfma_f32_16x16x32_bf16 v[164:167], a[164:167], a[116:119], v[164:167]
  ds_read_b64_tr_b16 a[146:147], v2 offset:46752
  v_accvgpr_read_b32 v25, a179
  v_mfma_f32_16x16x32_bf16 v[164:167], a[160:163], a[100:103], v[164:167]
  v_accvgpr_read_b32 v26, a180
  v_accvgpr_read_b32 v27, a181
  v_mfma_f32_16x16x32_bf16 v[168:171], a[160:163], a[104:107], v[168:171]
  ds_read_b64_tr_b16 a[148:149], v2 offset:50336
  v_accvgpr_read_b32 v28, a182
  v_mfma_f32_16x16x32_bf16 v[168:171], a[164:167], a[120:123], v[168:171]
  v_accvgpr_read_b32 v29, a183
  v_add_f32 v22, v22, v26
  v_mfma_f32_16x16x32_bf16 v[172:175], a[164:167], a[124:127], v[172:175]
  ds_read_b64_tr_b16 a[150:151], v2 offset:53920
  v_add_f32 v23, v23, v27
  v_mfma_f32_16x16x32_bf16 v[172:175], a[160:163], a[108:111], v[172:175]
  s_waitcnt vmcnt(17)
  s_barrier
  buffer_load_dwordx4 v8, s[16:19], s56 offen offset:1024 lds
  v_add_f32 v24, v24, v28
  v_mfma_f32_16x16x32_bf16 v[188:191], a[168:171], a[108:111], v[188:191]
  ds_read_b64_tr_b16 a[152:153], v2 offset:43200
  v_add_f32 v25, v25, v29
  v_mfma_f32_16x16x32_bf16 v[188:191], a[172:175], a[124:127], v[188:191]
  v_accvgpr_read_b32 v26, a184
  v_accvgpr_read_b32 v27, a185
  v_mfma_f32_16x16x32_bf16 v[184:187], a[172:175], a[120:123], v[184:187]
  ds_read_b64_tr_b16 a[154:155], v2 offset:46784
  v_accvgpr_read_b32 v28, a186
  v_mfma_f32_16x16x32_bf16 v[184:187], a[168:171], a[104:107], v[184:187]
  v_accvgpr_read_b32 v29, a187
  v_add_f32 v22, v22, v26
  v_mfma_f32_16x16x32_bf16 v[180:183], a[168:171], a[100:103], v[180:183]
  buffer_load_dwordx4 a[36:39], v0, s[36:39], s57 offen offset:1024 sc1
  v_add_f32 v23, v23, v27
  v_mfma_f32_16x16x32_bf16 v[180:183], a[172:175], a[116:119], v[180:183]
  ds_read_b64_tr_b16 a[156:157], v2 offset:50368
  v_add_f32 v24, v24, v28
  v_mfma_f32_16x16x32_bf16 v[176:179], a[172:175], a[112:115], v[176:179]
  ds_read_b64_tr_b16 a[158:159], v2 offset:53952
  v_add_f32 v25, v25, v29
  v_mfma_f32_16x16x32_bf16 v[176:179], a[168:171], a[96:99], v[176:179]
  s_waitcnt lgkmcnt(8)
  v_accvgpr_read_b32 v26, a188
  v_accvgpr_read_b32 v27, a189
  v_mfma_f32_16x16x32_bf16 v[192:195], a[128:131], a[96:99], v[192:195]
  ds_read_b64_tr_b16 a[160:161], v1 offset:0
  v_accvgpr_read_b32 v28, a190
  v_mfma_f32_16x16x32_bf16 v[192:195], a[132:135], a[112:115], v[192:195]
  v_accvgpr_read_b32 v29, a191
  v_add_f32 v22, v22, v26
  v_mfma_f32_16x16x32_bf16 v[196:199], a[132:135], a[116:119], v[196:199]
  ds_read_b64_tr_b16 a[162:163], v1 offset:3584
  v_add_f32 v23, v23, v27
  v_mfma_f32_16x16x32_bf16 v[196:199], a[128:131], a[100:103], v[196:199]
  v_add_f32 v24, v24, v28
  v_add_f32 v25, v25, v29
  v_mfma_f32_16x16x32_bf16 v[200:203], a[128:131], a[104:107], v[200:203]
  ds_read_b64_tr_b16 a[164:165], v1 offset:7168
  v_mov_b32 v26, v22
  v_mfma_f32_16x16x32_bf16 v[200:203], a[132:135], a[120:123], v[200:203]
  v_mov_b32 v27, v23
  v_mov_b32 v28, v24
  v_mfma_f32_16x16x32_bf16 v[204:207], a[132:135], a[124:127], v[204:207]
  buffer_load_dwordx4 v9, s[16:19], s56 offen offset:2048 lds
  v_mov_b32 v29, v25
  v_mfma_f32_16x16x32_bf16 v[204:207], a[128:131], a[108:111], v[204:207]
  ds_read_b64_tr_b16 a[166:167], v1 offset:10752
  v_permlane16_swap_b32 v22, v26
  v_mfma_f32_16x16x32_bf16 v[220:223], a[136:139], a[108:111], v[220:223]
  ds_read_b64_tr_b16 a[168:169], v1 offset:32
  v_permlane16_swap_b32 v23, v27
  v_mfma_f32_16x16x32_bf16 v[220:223], a[140:143], a[124:127], v[220:223]
  v_permlane16_swap_b32 v24, v28
  v_permlane16_swap_b32 v25, v29
  v_mfma_f32_16x16x32_bf16 v[216:219], a[140:143], a[120:123], v[216:219]
  s_add_u32 s59, s59, 16384
  ds_read_b64_tr_b16 a[170:171], v1 offset:3616
  v_add_f32 v22, v22, v26
  v_mfma_f32_16x16x32_bf16 v[216:219], a[136:139], a[104:107], v[216:219]
  buffer_load_dwordx4 a[40:43], v0, s[36:39], s57 offen offset:2048 sc1
  v_add_f32 v23, v23, v27
  v_mfma_f32_16x16x32_bf16 v[212:215], a[136:139], a[100:103], v[212:215]
  ds_read_b64_tr_b16 a[172:173], v1 offset:7200
  v_add_f32 v24, v24, v28
  v_mfma_f32_16x16x32_bf16 v[212:215], a[140:143], a[116:119], v[212:215]
  v_add_f32 v25, v25, v29
  v_mov_b32 v26, v22
  v_mfma_f32_16x16x32_bf16 v[208:211], a[140:143], a[112:115], v[208:211]
  ds_read_b64_tr_b16 a[174:175], v1 offset:10784
  v_mov_b32 v27, v23
  v_mfma_f32_16x16x32_bf16 v[208:211], a[136:139], a[96:99], v[208:211]
  s_waitcnt lgkmcnt(8)
  v_mov_b32 v28, v24
  v_mov_b32 v29, v25
  v_mfma_f32_16x16x32_bf16 v[224:227], a[144:147], a[96:99], v[224:227]
  buffer_load_dwordx4 a[208:211], v0, s[36:39], s59 offen offset:0 sc1
  v_permlane32_swap_b32 v22, v26
  v_mfma_f32_16x16x32_bf16 v[224:227], a[148:151], a[112:115], v[224:227]
  ds_read_b64_tr_b16 a[128:129], v1 offset:64
  v_permlane32_swap_b32 v23, v27
  v_mfma_f32_16x16x32_bf16 v[228:231], a[148:151], a[116:119], v[228:231]
  ds_read_b64_tr_b16 a[130:131], v1 offset:3648
  v_permlane32_swap_b32 v24, v28
  v_mfma_f32_16x16x32_bf16 v[228:231], a[144:147], a[100:103], v[228:231]
  v_permlane32_swap_b32 v25, v29
  v_add_f32 v22, v22, v26
  v_mfma_f32_16x16x32_bf16 v[232:235], a[144:147], a[104:107], v[232:235]
  ds_read_b64_tr_b16 a[132:133], v1 offset:7232
  v_add_f32 v23, v23, v27
  v_mfma_f32_16x16x32_bf16 v[232:235], a[148:151], a[120:123], v[232:235]
  buffer_load_dwordx4 a[212:215], v0, s[36:39], s59 offen offset:1024 sc1
  v_add_f32 v24, v24, v28
  v_mfma_f32_16x16x32_bf16 v[236:239], a[148:151], a[124:127], v[236:239]
  ds_read_b64_tr_b16 a[134:135], v1 offset:10816
  v_add_f32 v25, v25, v29
  v_mfma_f32_16x16x32_bf16 v[236:239], a[144:147], a[108:111], v[236:239]
  v_mul_f32 v22, 0x3a800000, v22
  v_mul_f32 v23, 0x3a800000, v23
  v_mfma_f32_16x16x32_bf16 v[252:255], a[152:155], a[108:111], v[252:255]
  ds_read_b64_tr_b16 a[136:137], v1 offset:96
  v_fma_f32 v23, -v22, v22, v23
  v_mfma_f32_16x16x32_bf16 v[252:255], a[156:159], a[124:127], v[252:255]
  v_max_f32 v23, 0, v23
  v_cvt_pk_bf16_f32 v23, v23, v23
  v_mfma_f32_16x16x32_bf16 v[248:251], a[156:159], a[120:123], v[248:251]
  buffer_load_dwordx4 a[44:47], v0, s[36:39], s57 offen offset:3072 sc1
  s_bfe_u32 s56, s85, 0x40008
  v_mfma_f32_16x16x32_bf16 v[248:251], a[152:155], a[104:107], v[248:251]
  s_mul_i32 s56, s56, 458752
  s_add_u32 m0, s77, 57344
  ds_read_b64_tr_b16 a[138:139], v1 offset:3680
  v_mfma_f32_16x16x32_bf16 v[244:247], a[152:155], a[100:103], v[244:247]
  ds_read_b64_tr_b16 a[140:141], v1 offset:7264
  v_lshlrev_b32 v23, 16, v23
  v_mfma_f32_16x16x32_bf16 v[244:247], a[156:159], a[116:119], v[244:247]
  v_add_f32 v23, 0x3727c5ac, v23
  v_cvt_pk_bf16_f32 v23, v23, v23
  v_mfma_f32_16x16x32_bf16 v[240:243], a[156:159], a[112:115], v[240:243]
  ds_read_b64_tr_b16 a[142:143], v1 offset:10848
  v_lshlrev_b32 v23, 16, v23
  v_mfma_f32_16x16x32_bf16 v[240:243], a[152:155], a[96:99], v[240:243]
  s_waitcnt vmcnt(9) lgkmcnt(8)
  buffer_load_dwordx4 v3, s[16:19], s56 offen offset:0 lds
  v_mfma_f32_16x16x32_bf16 v[32:35], a[160:163], a[0:3], v[32:35]
  s_add_u32 s57, s57, 4096
  ds_read_b64_tr_b16 a[144:145], v1 offset:128
  v_mfma_f32_16x16x32_bf16 v[32:35], a[164:167], a[16:19], v[32:35]
  s_barrier
  v_sqrt_f32 v23, v23
  v_mfma_f32_16x16x32_bf16 v[36:39], a[164:167], a[20:23], v[36:39]
  s_nop 0
  ds_read_b64_tr_b16 a[146:147], v1 offset:3712
  v_cvt_pk_bf16_f32 v12, -v22, v23
  v_mfma_f32_16x16x32_bf16 v[36:39], a[160:163], a[4:7], v[36:39]
  v_and_b32 v23, 0xffff0000, v12
  v_mfma_f32_16x16x32_bf16 v[40:43], a[160:163], a[8:11], v[40:43]
  buffer_load_dwordx4 a[48:51], v0, s[36:39], s57 offen offset:0 sc1
  v_mfma_f32_16x16x32_bf16 v[40:43], a[164:167], a[24:27], v[40:43]
  ds_read_b64_tr_b16 a[148:149], v1 offset:7296
  v_mfma_f32_16x16x32_bf16 v[44:47], a[164:167], a[28:31], v[44:47]
  ds_read_b64_tr_b16 a[150:151], v1 offset:10880
  v_mfma_f32_16x16x32_bf16 v[44:47], a[160:163], a[12:15], v[44:47]
  v_rcp_f32 v10, v23
  v_mfma_f32_16x16x32_bf16 v[60:63], a[168:171], a[12:15], v[60:63]
  ds_read_b64_tr_b16 a[152:153], v1 offset:160
  v_mul_f32 v11, v23, v23
  v_mfma_f32_16x16x32_bf16 v[60:63], a[172:175], a[28:31], v[60:63]
  v_mul_f32 v10, 0xbfb8aa3b, v10
  v_mul_f32 v24, 0x3a800000, v24
  v_mfma_f32_16x16x32_bf16 v[56:59], a[172:175], a[24:27], v[56:59]
  ds_read_b64_tr_b16 a[154:155], v1 offset:3744
  v_mul_f32 v25, 0x3a800000, v25
  v_mfma_f32_16x16x32_bf16 v[56:59], a[168:171], a[8:11], v[56:59]
  buffer_load_dwordx4 v4, s[16:19], s56 offen offset:1024 lds
  v_fma_f32 v25, -v24, v24, v25
  v_mfma_f32_16x16x32_bf16 v[52:55], a[168:171], a[4:7], v[52:55]
  ds_read_b64_tr_b16 a[156:157], v1 offset:7328
  v_max_f32 v25, 0, v25
  v_mfma_f32_16x16x32_bf16 v[52:55], a[172:175], a[20:23], v[52:55]
  v_cvt_pk_bf16_f32 v25, v25, v25
  v_lshlrev_b32 v25, 16, v25
  v_mfma_f32_16x16x32_bf16 v[48:51], a[172:175], a[16:19], v[48:51]
  ds_read_b64_tr_b16 a[158:159], v1 offset:10912
  v_add_f32 v25, 0x3727c5ac, v25
  v_mfma_f32_16x16x32_bf16 v[48:51], a[168:171], a[0:3], v[48:51]
  s_waitcnt lgkmcnt(8)
  v_cvt_pk_bf16_f32 v25, v25, v25
  v_lshlrev_b32 v25, 16, v25
  v_mfma_f32_16x16x32_bf16 v[64:67], a[128:131], a[0:3], v[64:67]
  ds_read_b64_tr_b16 a[160:161], v1 offset:192
  v_mfma_f32_16x16x32_bf16 v[64:67], a[132:135], a[16:19], v[64:67]
  v_sqrt_f32 v25, v25
  v_mfma_f32_16x16x32_bf16 v[68:71], a[132:135], a[20:23], v[68:71]
  s_nop 0
  ds_read_b64_tr_b16 a[162:163], v1 offset:3776
  v_cvt_pk_bf16_f32 v15, -v24, v25
  v_mfma_f32_16x16x32_bf16 v[68:71], a[128:131], a[4:7], v[68:71]
  buffer_load_dwordx4 a[52:55], v0, s[36:39], s57 offen offset:1024 sc1
  v_and_b32 v25, 0xffff0000, v15
  v_mfma_f32_16x16x32_bf16 v[72:75], a[128:131], a[8:11], v[72:75]
  ds_read_b64_tr_b16 a[164:165], v1 offset:7360
  v_mfma_f32_16x16x32_bf16 v[72:75], a[132:135], a[24:27], v[72:75]
  v_rcp_f32 v13, v25
  v_mfma_f32_16x16x32_bf16 v[76:79], a[132:135], a[28:31], v[76:79]
  ds_read_b64_tr_b16 a[166:167], v1 offset:10944
  v_mul_f32 v14, v25, v25
  v_mfma_f32_16x16x32_bf16 v[76:79], a[128:131], a[12:15], v[76:79]
  v_mul_f32 v13, 0xbfb8aa3b, v13
  v_accvgpr_read_b32 v22, a192
  v_mfma_f32_16x16x32_bf16 v[92:95], a[136:139], a[12:15], v[92:95]
  ds_read_b64_tr_b16 a[168:169], v1 offset:14336
  v_accvgpr_read_b32 v23, a193
  v_mfma_f32_16x16x32_bf16 v[92:95], a[140:143], a[28:31], v[92:95]
  v_accvgpr_read_b32 v24, a194
  v_accvgpr_read_b32 v25, a195
  v_mfma_f32_16x16x32_bf16 v[88:91], a[140:143], a[24:27], v[88:91]
  buffer_load_dwordx4 v5, s[16:19], s56 offen offset:2048 lds
  v_accvgpr_read_b32 v26, a196
  v_mfma_f32_16x16x32_bf16 v[88:91], a[136:139], a[8:11], v[88:91]
  ds_read_b64_tr_b16 a[170:171], v1 offset:17920
  v_accvgpr_read_b32 v27, a197
  v_mfma_f32_16x16x32_bf16 v[84:87], a[136:139], a[4:7], v[84:87]
  ds_read_b64_tr_b16 a[172:173], v1 offset:21504
  v_accvgpr_read_b32 v28, a198
  v_mfma_f32_16x16x32_bf16 v[84:87], a[140:143], a[20:23], v[84:87]
  v_accvgpr_read_b32 v29, a199
  v_add_f32 v22, v22, v26
  v_mfma_f32_16x16x32_bf16 v[80:83], a[140:143], a[16:19], v[80:83]
  ds_read_b64_tr_b16 a[174:175], v1 offset:25088
  v_add_f32 v23, v23, v27
  v_mfma_f32_16x16x32_bf16 v[80:83], a[136:139], a[0:3], v[80:83]
  s_waitcnt lgkmcnt(8)
  v_add_f32 v24, v24, v28
  v_add_f32 v25, v25, v29
  v_mfma_f32_16x16x32_bf16 v[96:99], a[144:147], a[0:3], v[96:99]
  ds_read_b64_tr_b16 a[128:129], v1 offset:14368
  v_accvgpr_read_b32 v26, a200
  v_mfma_f32_16x16x32_bf16 v[96:99], a[148:151], a[16:19], v[96:99]
  v_accvgpr_read_b32 v27, a201
  v_accvgpr_read_b32 v28, a202
  v_mfma_f32_16x16x32_bf16 v[100:103], a[148:151], a[20:23], v[100:103]
  buffer_load_dwordx4 a[56:59], v0, s[36:39], s57 offen offset:2048 sc1
  v_accvgpr_read_b32 v29, a203
  v_mfma_f32_16x16x32_bf16 v[100:103], a[144:147], a[4:7], v[100:103]
  ds_read_b64_tr_b16 a[130:131], v1 offset:17952
  v_add_f32 v22, v22, v26
  v_mfma_f32_16x16x32_bf16 v[104:107], a[144:147], a[8:11], v[104:107]
  ds_read_b64_tr_b16 a[132:133], v1 offset:21536
  v_add_f32 v23, v23, v27
  v_mfma_f32_16x16x32_bf16 v[104:107], a[148:151], a[24:27], v[104:107]
  v_add_f32 v24, v24, v28
  v_add_f32 v25, v25, v29
  v_mfma_f32_16x16x32_bf16 v[108:111], a[148:151], a[28:31], v[108:111]
  ds_read_b64_tr_b16 a[134:135], v1 offset:25120
  v_accvgpr_read_b32 v26, a204
  v_mfma_f32_16x16x32_bf16 v[108:111], a[144:147], a[12:15], v[108:111]
  v_accvgpr_read_b32 v27, a205
  v_accvgpr_read_b32 v28, a206
  v_mfma_f32_16x16x32_bf16 v[124:127], a[152:155], a[12:15], v[124:127]
  ds_read_b64_tr_b16 a[136:137], v1 offset:14400
  v_accvgpr_read_b32 v29, a207
  v_mfma_f32_16x16x32_bf16 v[124:127], a[156:159], a[28:31], v[124:127]
  buffer_load_dwordx4 v6, s[16:19], s56 offen offset:3072 lds
  v_add_f32 v22, v22, v26
  v_mfma_f32_16x16x32_bf16 v[120:123], a[156:159], a[24:27], v[120:123]
  ds_read_b64_tr_b16 a[138:139], v1 offset:17984
  v_add_f32 v23, v23, v27
  v_mfma_f32_16x16x32_bf16 v[120:123], a[152:155], a[8:11], v[120:123]
  v_add_f32 v24, v24, v28
  v_add_f32 v25, v25, v29
  v_mfma_f32_16x16x32_bf16 v[116:119], a[152:155], a[4:7], v[116:119]
  ds_read_b64_tr_b16 a[140:141], v1 offset:21568
  v_mov_b32 v26, v22
  v_mfma_f32_16x16x32_bf16 v[116:119], a[156:159], a[20:23], v[116:119]
  v_mov_b32 v27, v23
  v_mov_b32 v28, v24
  v_mfma_f32_16x16x32_bf16 v[112:115], a[156:159], a[16:19], v[112:115]
  ds_read_b64_tr_b16 a[142:143], v1 offset:25152
  v_mov_b32 v29, v25
  v_mfma_f32_16x16x32_bf16 v[112:115], a[152:155], a[0:3], v[112:115]
  s_waitcnt lgkmcnt(8)
  v_permlane16_swap_b32 v22, v26
  v_permlane16_swap_b32 v23, v27
  v_mfma_f32_16x16x32_bf16 v[128:131], a[160:163], a[0:3], v[128:131]
  ds_read_b64_tr_b16 a[144:145], v1 offset:14432
  v_permlane16_swap_b32 v24, v28
  v_mfma_f32_16x16x32_bf16 v[128:131], a[164:167], a[16:19], v[128:131]
  buffer_load_dwordx4 a[60:63], v0, s[36:39], s57 offen offset:3072 sc1
  v_permlane16_swap_b32 v25, v29
  v_mfma_f32_16x16x32_bf16 v[132:135], a[164:167], a[20:23], v[132:135]
  s_add_u32 m0, s77, 61440
  ds_read_b64_tr_b16 a[146:147], v1 offset:18016
  v_add_f32 v22, v22, v26
  v_mfma_f32_16x16x32_bf16 v[132:135], a[160:163], a[4:7], v[132:135]
  v_add_f32 v23, v23, v27
  v_add_f32 v24, v24, v28
  v_mfma_f32_16x16x32_bf16 v[136:139], a[160:163], a[8:11], v[136:139]
  ds_read_b64_tr_b16 a[148:149], v1 offset:21600
  v_add_f32 v25, v25, v29
  v_mfma_f32_16x16x32_bf16 v[136:139], a[164:167], a[24:27], v[136:139]
  v_mov_b32 v26, v22
  v_mov_b32 v27, v23
  v_mfma_f32_16x16x32_bf16 v[140:143], a[164:167], a[28:31], v[140:143]
  buffer_load_dwordx4 v7, s[16:19], s56 offen offset:0 lds
  s_bfe_u32 s57, s85, 0x40008
  v_mfma_f32_16x16x32_bf16 v[140:143], a[160:163], a[12:15], v[140:143]
  s_lshl_b32 s57, s57, 13
  s_add_u32 s57, s57, s86
  ds_read_b64_tr_b16 a[150:151], v1 offset:25184
  v_mfma_f32_16x16x32_bf16 v[156:159], a[168:171], a[12:15], v[156:159]
  ds_read_b64_tr_b16 a[152:153], v1 offset:14464
  v_mov_b32 v28, v24
  v_mfma_f32_16x16x32_bf16 v[156:159], a[172:175], a[28:31], v[156:159]
  v_mov_b32 v29, v25
  v_permlane32_swap_b32 v22, v26
  v_mfma_f32_16x16x32_bf16 v[152:155], a[172:175], a[24:27], v[152:155]
  ds_read_b64_tr_b16 a[154:155], v1 offset:18048
  v_permlane32_swap_b32 v23, v27
  v_mfma_f32_16x16x32_bf16 v[152:155], a[168:171], a[8:11], v[152:155]
  buffer_load_dwordx4 a[64:67], v0, s[36:39], s57 offen offset:0 sc1
  v_permlane32_swap_b32 v24, v28
  v_mfma_f32_16x16x32_bf16 v[148:151], a[168:171], a[4:7], v[148:151]
  ds_read_b64_tr_b16 a[156:157], v1 offset:21632
  v_permlane32_swap_b32 v25, v29
  v_mfma_f32_16x16x32_bf16 v[148:151], a[172:175], a[20:23], v[148:151]
  v_add_f32 v22, v22, v26
  v_add_f32 v23, v23, v27
  v_mfma_f32_16x16x32_bf16 v[144:147], a[172:175], a[16:19], v[144:147]
  ds_read_b64_tr_b16 a[158:159], v1 offset:25216
  v_add_f32 v24, v24, v28
  v_mfma_f32_16x16x32_bf16 v[144:147], a[168:171], a[0:3], v[144:147]
  s_waitcnt lgkmcnt(8)
  v_add_f32 v25, v25, v29
  v_mul_f32 v22, 0x3a800000, v22
  v_mfma_f32_16x16x32_bf16 v[160:163], a[128:131], a[0:3], v[160:163]
Hb0_1:
  s_cbranch_execz Hb0_2
  ds_read_b64_tr_b16 a[160:161], v1 offset:14496
  v_mul_f32 v23, 0x3a800000, v23
  v_mfma_f32_16x16x32_bf16 v[160:163], a[132:135], a[16:19], v[160:163]
  v_fma_f32 v23, -v22, v22, v23
  v_max_f32 v23, 0, v23
  v_mfma_f32_16x16x32_bf16 v[164:167], a[132:135], a[20:23], v[164:167]
  buffer_load_dwordx4 v8, s[16:19], s56 offen offset:1024 lds
  v_cvt_pk_bf16_f32 v23, v23, v23
  v_mfma_f32_16x16x32_bf16 v[164:167], a[128:131], a[4:7], v[164:167]
  ds_read_b64_tr_b16 a[162:163], v1 offset:18080
  v_lshlrev_b32 v23, 16, v23
  v_mfma_f32_16x16x32_bf16 v[168:171], a[128:131], a[8:11], v[168:171]
  ds_read_b64_tr_b16 a[164:165], v1 offset:21664
  v_add_f32 v23, 0x3727c5ac, v23
  v_mfma_f32_16x16x32_bf16 v[168:171], a[132:135], a[24:27], v[168:171]
  v_cvt_pk_bf16_f32 v23, v23, v23
  v_lshlrev_b32 v23, 16, v23
  v_mfma_f32_16x16x32_bf16 v[172:175], a[132:135], a[28:31], v[172:175]
  ds_read_b64_tr_b16 a[166:167], v1 offset:25248
  v_mfma_f32_16x16x32_bf16 v[172:175], a[128:131], a[12:15], v[172:175]
  s_waitcnt vmcnt(15)
  s_barrier
  buffer_load_dwordx4 a[68:71], v0, s[36:39], s57 offen offset:1024 sc1
  v_mfma_f32_16x16x32_bf16 v[188:191], a[136:139], a[12:15], v[188:191]
  ds_read_b64_tr_b16 a[168:169], v1 offset:14528
  v_mfma_f32_16x16x32_bf16 v[188:191], a[140:143], a[28:31], v[188:191]
  v_sqrt_f32 v23, v23
  v_mfma_f32_16x16x32_bf16 v[184:187], a[140:143], a[24:27], v[184:187]
  s_nop 0
  ds_read_b64_tr_b16 a[170:171], v1 offset:18112
  v_cvt_pk_bf16_f32 v18, -v22, v23
  v_mfma_f32_16x16x32_bf16 v[184:187], a[136:139], a[8:11], v[184:187]
  v_and_b32 v23, 0xffff0000, v18
  v_mfma_f32_16x16x32_bf16 v[180:183], a[136:139], a[4:7], v[180:183]
  ds_read_b64_tr_b16 a[172:173], v1 offset:21696
  v_mfma_f32_16x16x32_bf16 v[180:183], a[140:143], a[20:23], v[180:183]
  v_rcp_f32 v16, v23
  v_mfma_f32_16x16x32_bf16 v[176:179], a[140:143], a[16:19], v[176:179]
  buffer_load_dwordx4 v9, s[16:19], s56 offen offset:2048 lds
  v_mul_f32 v17, v23, v23
  v_mfma_f32_16x16x32_bf16 v[176:179], a[136:139], a[0:3], v[176:179]
  s_waitcnt lgkmcnt(7)
  ds_read_b64_tr_b16 a[174:175], v1 offset:25280
  v_mul_f32 v16, 0xbfb8aa3b, v16
  v_mfma_f32_16x16x32_bf16 v[192:195], a[144:147], a[0:3], v[192:195]
  ds_read_b64_tr_b16 a[128:129], v1 offset:28672
  v_mul_f32 v24, 0x3a800000, v24
  v_mfma_f32_16x16x32_bf16 v[192:195], a[148:151], a[16:19], v[192:195]
  v_mul_f32 v25, 0x3a800000, v25
  v_fma_f32 v25, -v24, v24, v25
  v_mfma_f32_16x16x32_bf16 v[196:199], a[148:151], a[20:23], v[196:199]
  ds_read_b64_tr_b16 a[130:131], v1 offset:32256
  v_max_f32 v25, 0, v25
  v_mfma_f32_16x16x32_bf16 v[196:199], a[144:147], a[4:7], v[196:199]
  v_cvt_pk_bf16_f32 v25, v25, v25
  v_lshlrev_b32 v25, 16, v25
  v_mfma_f32_16x16x32_bf16 v[200:203], a[144:147], a[8:11], v[200:203]
  ds_read_b64_tr_b16 a[132:133], v1 offset:35840
  v_add_f32 v25, 0x3727c5ac, v25
  v_mfma_f32_16x16x32_bf16 v[200:203], a[148:151], a[24:27], v[200:203]
  v_cvt_pk_bf16_f32 v25, v25, v25
  v_lshlrev_b32 v25, 16, v25
  v_mfma_f32_16x16x32_bf16 v[204:207], a[148:151], a[28:31], v[204:207]
  buffer_load_dwordx4 a[72:75], v0, s[36:39], s57 offen offset:2048 sc1
  v_mfma_f32_16x16x32_bf16 v[204:207], a[144:147], a[12:15], v[204:207]
  ds_read_b64_tr_b16 a[134:135], v1 offset:39424
  v_mfma_f32_16x16x32_bf16 v[220:223], a[152:155], a[12:15], v[220:223]
  ds_read_b64_tr_b16 a[136:137], v1 offset:28704
  v_mfma_f32_16x16x32_bf16 v[220:223], a[156:159], a[28:31], v[220:223]
  v_sqrt_f32 v25, v25
  v_mfma_f32_16x16x32_bf16 v[216:219], a[156:159], a[24:27], v[216:219]
  s_nop 0
  ds_read_b64_tr_b16 a[138:139], v1 offset:32288
  v_cvt_pk_bf16_f32 v21, -v24, v25
  v_mfma_f32_16x16x32_bf16 v[216:219], a[152:155], a[8:11], v[216:219]
  v_and_b32 v25, 0xffff0000, v21
  v_mfma_f32_16x16x32_bf16 v[212:215], a[152:155], a[4:7], v[212:215]
  s_bfe_u32 s56, s85, 0x4000c
  s_mul_i32 s56, s56, 458752
  s_add_u32 m0, s77, 86016
  v_mfma_f32_16x16x32_bf16 v[212:215], a[156:159], a[20:23], v[212:215]
  ds_read_b64_tr_b16 a[140:141], v1 offset:35872
  v_mfma_f32_16x16x32_bf16 v[208:211], a[156:159], a[16:19], v[208:211]
  ds_read_b64_tr_b16 a[142:143], v1 offset:39456
  v_mfma_f32_16x16x32_bf16 v[208:211], a[152:155], a[0:3], v[208:211]
  s_waitcnt lgkmcnt(8)
  v_rcp_f32 v19, v25
  v_mfma_f32_16x16x32_bf16 v[224:227], a[160:163], a[0:3], v[224:227]
  buffer_load_dwordx4 v3, s[16:19], s56 offen offset:0 lds
  v_mul_f32 v20, v25, v25
  v_mfma_f32_16x16x32_bf16 v[224:227], a[164:167], a[16:19], v[224:227]
  v_mul_f32 v19, 0xbfb8aa3b, v19
  v_add_u32 v31, -28672, v31
  v_mfma_f32_16x16x32_bf16 v[228:231], a[164:167], a[20:23], v[228:231]
  ds_read_b64_tr_b16 a[176:177], v31 offset:0
  v_mfma_f32_16x16x32_bf16 v[228:231], a[160:163], a[4:7], v[228:231]
  ds_read_b64_tr_b16 a[178:179], v31 offset:3584
  v_mfma_f32_16x16x32_bf16 v[232:235], a[160:163], a[8:11], v[232:235]
  ds_read_b64_tr_b16 a[180:181], v31 offset:7168
  v_mfma_f32_16x16x32_bf16 v[232:235], a[164:167], a[24:27], v[232:235]
  buffer_load_dwordx4 a[76:79], v0, s[36:39], s57 offen offset:3072 sc1
  v_mfma_f32_16x16x32_bf16 v[236:239], a[164:167], a[28:31], v[236:239]
  ds_read_b64_tr_b16 a[182:183], v31 offset:10752
  v_mfma_f32_16x16x32_bf16 v[236:239], a[160:163], a[12:15], v[236:239]
  ds_read_b64_tr_b16 a[184:185], v31 offset:32
  v_mfma_f32_16x16x32_bf16 v[252:255], a[168:171], a[12:15], v[252:255]
  ds_read_b64_tr_b16 a[144:145], v1 offset:28736
  v_mfma_f32_16x16x32_bf16 v[252:255], a[172:175], a[28:31], v[252:255]
  ds_read_b64_tr_b16 a[186:187], v31 offset:3616
  v_mfma_f32_16x16x32_bf16 v[248:251], a[172:175], a[24:27], v[248:251]
  ds_read_b64_tr_b16 a[146:147], v1 offset:32320
  v_mfma_f32_16x16x32_bf16 v[248:251], a[168:171], a[8:11], v[248:251]
  ds_read_b64_tr_b16 a[188:189], v31 offset:7200
  v_mfma_f32_16x16x32_bf16 v[244:247], a[168:171], a[4:7], v[244:247]
  buffer_load_dwordx4 v4, s[16:19], s56 offen offset:1024 lds
  v_mfma_f32_16x16x32_bf16 v[244:247], a[172:175], a[20:23], v[244:247]
  ds_read_b64_tr_b16 a[148:149], v1 offset:35904
  v_mfma_f32_16x16x32_bf16 v[240:243], a[172:175], a[16:19], v[240:243]
  s_add_u32 s57, s57, 4096
  ds_read_b64_tr_b16 a[150:151], v1 offset:39488
  v_mfma_f32_16x16x32_bf16 v[240:243], a[168:171], a[0:3], v[240:243]
  s_waitcnt vmcnt(9) lgkmcnt(11)
  ds_read_b64_tr_b16 a[190:191], v31 offset:10784
  v_mfma_f32_16x16x32_bf16 v[32:35], a[128:131], a[32:35], v[32:35]
  ds_read_b64_tr_b16 a[152:153], v1 offset:28768
  v_mfma_f32_16x16x32_bf16 v[32:35], a[132:135], a[48:51], v[32:35]
  s_barrier
  ds_read_b64_tr_b16 a[192:193], v31 offset:64
  v_mfma_f32_16x16x32_bf16 v[36:39], a[132:135], a[52:55], v[36:39]
  buffer_load_dwordx4 a[80:83], v0, s[36:39], s57 offen offset:0 sc1
  v_mfma_f32_16x16x32_bf16 v[36:39], a[128:131], a[36:39], v[36:39]
  ds_read_b64_tr_b16 a[154:155], v1 offset:32352
  v_mfma_f32_16x16x32_bf16 v[40:43], a[128:131], a[40:43], v[40:43]
  ds_read_b64_tr_b16 a[156:157], v1 offset:35936
  v_mfma_f32_16x16x32_bf16 v[40:43], a[132:135], a[56:59], v[40:43]
  ds_read_b64_tr_b16 a[194:195], v31 offset:3648
  v_mfma_f32_16x16x32_bf16 v[44:47], a[132:135], a[60:63], v[44:47]
  ds_read_b64_tr_b16 a[196:197], v31 offset:7232
  ds_read_b64_tr_b16 a[198:199], v31 offset:10816
  ds_read_b64_tr_b16 a[200:201], v31 offset:96
  ds_read_b64_tr_b16 a[202:203], v31 offset:3680
  ds_read_b64_tr_b16 a[204:205], v31 offset:7264
  ds_read_b64_tr_b16 a[206:207], v31 offset:10848
  v_mfma_f32_16x16x32_bf16 v[44:47], a[128:131], a[44:47], v[44:47]
  ds_read_b64_tr_b16 a[158:159], v1 offset:39520
  v_lshrrev_b32 v22, 4, v0
  v_mfma_f32_16x16x32_bf16 v[60:63], a[136:139], a[44:47], v[60:63]
  buffer_load_dwordx4 v5, s[16:19], s56 offen offset:2048 lds
  v_and_b32 v23, 14, v22
  v_mfma_f32_16x16x32_bf16 v[60:63], a[140:143], a[60:63], v[60:63]
  ds_read_b64_tr_b16 a[160:161], v1 offset:28800
  v_lshlrev_b32 v23, 27, v23
  v_mfma_f32_16x16x32_bf16 v[56:59], a[140:143], a[56:59], v[56:59]
  ds_read_b64_tr_b16 a[162:163], v1 offset:32384
  v_and_b32 v24, 1, v22
  v_mfma_f32_16x16x32_bf16 v[56:59], a[136:139], a[40:43], v[56:59]
  v_lshl_add_u32 v23, v24, 9, v23
  v_and_b32 v22, 0x30, v22
  v_mfma_f32_16x16x32_bf16 v[52:55], a[136:139], a[36:39], v[52:55]
  ds_read_b64_tr_b16 a[164:165], v1 offset:35968
  v_add_u32 v22, v22, v23
  v_mfma_f32_16x16x32_bf16 v[52:55], a[140:143], a[52:55], v[52:55]
  s_lshl3_add_u32 s78, s60, s58
  buffer_load_dwordx4 a[84:87], v0, s[36:39], s57 offen offset:1024 sc1
  s_lshr_b32 s79, s44, 1
  v_mfma_f32_16x16x32_bf16 v[48:51], a[140:143], a[48:51], v[48:51]
  s_lshl1_add_u32 s78, s78, s79
  ds_read_b64_tr_b16 a[166:167], v1 offset:39552
  s_and_b32 s79, s44, 1
  v_mfma_f32_16x16x32_bf16 v[48:51], a[136:139], a[32:35], v[48:51]
  s_waitcnt vmcnt(21) lgkmcnt(5)
  s_lshl2_add_u32 s78, s78, s79
  s_lshl_b32 s78, s78, 8
  v_mfma_f32_16x16x32_bf16 a[216:219], a[176:179], a[208:211], a[216:219]
  s_add_u32 s78, s78, 524288
  ds_read_b64_tr_b16 a[168:169], v1 offset:28832
  v_mfma_f32_16x16x32_bf16 a[216:219], a[180:183], a[212:215], a[216:219]
  v_mfma_f32_16x16x32_bf16 a[220:223], a[184:187], a[208:211], a[220:223]
  ds_read_b64_tr_b16 a[170:171], v1 offset:32416
  v_mfma_f32_16x16x32_bf16 a[220:223], a[188:191], a[212:215], a[220:223]
  v_mfma_f32_16x16x32_bf16 a[224:227], a[192:195], a[208:211], a[224:227]
  buffer_load_dwordx4 v6, s[16:19], s56 offen offset:3072 lds
  v_mfma_f32_16x16x32_bf16 a[224:227], a[196:199], a[212:215], a[224:227]
  ds_read_b64_tr_b16 a[172:173], v1 offset:36000
  v_mfma_f32_16x16x32_bf16 a[228:231], a[200:203], a[208:211], a[228:231]
  ds_read_b64_tr_b16 a[174:175], v1 offset:39584
  v_mfma_f32_16x16x32_bf16 a[228:231], a[204:207], a[212:215], a[228:231]
  s_waitcnt lgkmcnt(8)
  v_mfma_f32_16x16x32_bf16 v[64:67], a[144:147], a[32:35], v[64:67]
  ds_read_b64_tr_b16 a[128:129], v1 offset:28864
  v_mfma_f32_16x16x32_bf16 v[64:67], a[148:151], a[48:51], v[64:67]
  buffer_load_dwordx4 a[88:91], v0, s[36:39], s57 offen offset:2048 sc1
  v_mfma_f32_16x16x32_bf16 v[68:71], a[148:151], a[52:55], v[68:71]
  ds_read_b64_tr_b16 a[130:131], v1 offset:32448
  v_mfma_f32_16x16x32_bf16 v[68:71], a[144:147], a[36:39], v[68:71]
  s_add_u32 m0, s77, 90112
  v_mfma_f32_16x16x32_bf16 v[72:75], a[144:147], a[40:43], v[72:75]
  ds_read_b64_tr_b16 a[132:133], v1 offset:36032
  v_mfma_f32_16x16x32_bf16 v[72:75], a[148:151], a[56:59], v[72:75]
  v_mfma_f32_16x16x32_bf16 v[76:79], a[148:151], a[60:63], v[76:79]
  ds_read_b64_tr_b16 a[134:135], v1 offset:39616
  v_mfma_f32_16x16x32_bf16 v[76:79], a[144:147], a[44:47], v[76:79]
  buffer_load_dwordx4 v7, s[16:19], s56 offen offset:0 lds
  v_mfma_f32_16x16x32_bf16 v[92:95], a[152:155], a[44:47], v[92:95]
  ds_read_b64_tr_b16 a[136:137], v1 offset:43008
  v_mfma_f32_16x16x32_bf16 v[92:95], a[156:159], a[60:63], v[92:95]
  v_mfma_f32_16x16x32_bf16 v[88:91], a[156:159], a[56:59], v[88:91]
  ds_read_b64_tr_b16 a[138:139], v1 offset:46592
  v_mfma_f32_16x16x32_bf16 v[88:91], a[152:155], a[40:43], v[88:91]
  v_mfma_f32_16x16x32_bf16 v[84:87], a[152:155], a[36:39], v[84:87]
  buffer_load_dwordx4 a[92:95], v0, s[36:39], s57 offen offset:3072 sc1
  s_bfe_u32 s57, s85, 0x4000c
  v_mfma_f32_16x16x32_bf16 v[84:87], a[156:159], a[52:55], v[84:87]
  s_lshl_b32 s57, s57, 13
  s_add_u32 s57, s57, s86
  ds_read_b64_tr_b16 a[140:141], v1 offset:50176
  v_mfma_f32_16x16x32_bf16 v[80:83], a[156:159], a[48:51], v[80:83]
  ds_read_b64_tr_b16 a[142:143], v1 offset:53760
  v_mfma_f32_16x16x32_bf16 v[80:83], a[152:155], a[32:35], v[80:83]
  s_waitcnt lgkmcnt(8)
  v_mfma_f32_16x16x32_bf16 v[96:99], a[160:163], a[32:35], v[96:99]
  ds_read_b64_tr_b16 a[144:145], v1 offset:43040
  v_mfma_f32_16x16x32_bf16 v[96:99], a[164:167], a[48:51], v[96:99]
  buffer_load_dwordx4 a[96:99], v0, s[36:39], s57 offen offset:0 sc1
  v_mfma_f32_16x16x32_bf16 v[100:103], a[164:167], a[52:55], v[100:103]
  buffer_store_dwordx4 a[216:219], v22, s[36:39], s78 offen offset:0 sc1
  v_mfma_f32_16x16x32_bf16 v[100:103], a[160:163], a[36:39], v[100:103]
  ds_read_b64_tr_b16 a[146:147], v1 offset:46624
  v_mfma_f32_16x16x32_bf16 v[104:107], a[160:163], a[40:43], v[104:107]
  ds_read_b64_tr_b16 a[148:149], v1 offset:50208
  v_mfma_f32_16x16x32_bf16 v[104:107], a[164:167], a[56:59], v[104:107]
  v_mfma_f32_16x16x32_bf16 v[108:111], a[164:167], a[60:63], v[108:111]
  buffer_store_dwordx4 a[220:223], v22, s[36:39], s78 offen offset:64 sc1
  v_mfma_f32_16x16x32_bf16 v[108:111], a[160:163], a[44:47], v[108:111]
  ds_read_b64_tr_b16 a[150:151], v1 offset:53792
  v_mfma_f32_16x16x32_bf16 v[124:127], a[168:171], a[44:47], v[124:127]
  ds_read_b64_tr_b16 a[152:153], v1 offset:43072
  v_mfma_f32_16x16x32_bf16 v[124:127], a[172:175], a[60:63], v[124:127]
  v_mfma_f32_16x16x32_bf16 v[120:123], a[172:175], a[56:59], v[120:123]
  buffer_store_dwordx4 a[224:227], v22, s[36:39], s78 offen offset:128 sc1
  v_mfma_f32_16x16x32_bf16 v[120:123], a[168:171], a[40:43], v[120:123]
  ds_read_b64_tr_b16 a[154:155], v1 offset:46656
  v_mfma_f32_16x16x32_bf16 v[116:119], a[168:171], a[36:39], v[116:119]
  ds_read_b64_tr_b16 a[156:157], v1 offset:50240
  v_mfma_f32_16x16x32_bf16 v[116:119], a[172:175], a[52:55], v[116:119]
  v_mfma_f32_16x16x32_bf16 v[112:115], a[172:175], a[48:51], v[112:115]
  buffer_store_dwordx4 a[228:231], v22, s[36:39], s78 offen offset:192 sc1
  s_lshl_b32 s79, s60, 14
  v_mfma_f32_16x16x32_bf16 v[112:115], a[168:171], a[32:35], v[112:115]
  s_waitcnt lgkmcnt(7)
  ds_read_b64_tr_b16 a[158:159], v1 offset:53824
  s_lshl_b32 s80, s44, 9
  v_mfma_f32_16x16x32_bf16 v[128:131], a[128:131], a[32:35], v[128:131]
  s_add_u32 s79, s79, s80
  ds_read_b64_tr_b16 a[160:161], v1 offset:43104
  s_add_u32 s79, s79, 524288
  v_mfma_f32_16x16x32_bf16 v[128:131], a[132:135], a[48:51], v[128:131]
  s_lshr_b32 s80, s44, 1
  s_lshl_b32 s80, s80, 8
  s_and_b32 s65, s44, 1
  v_mfma_f32_16x16x32_bf16 v[132:135], a[132:135], a[52:55], v[132:135]
  s_add_u32 s80, s80, s65
  ds_read_b64_tr_b16 a[162:163], v1 offset:46688
  s_lshl3_add_u32 s80, s80, 159744
  v_mfma_f32_16x16x32_bf16 v[132:135], a[128:131], a[36:39], v[132:135]
  buffer_load_dwordx4 v8, s[16:19], s56 offen offset:1024 lds
  v_and_b32 v24, 0x1f0, v0
  v_mfma_f32_16x16x32_bf16 v[136:139], a[128:131], a[40:43], v[136:139]
  ds_read_b64_tr_b16 a[164:165], v1 offset:50272
  v_min_u32 v24, 432, v24
  v_mfma_f32_16x16x32_bf16 v[136:139], a[132:135], a[56:59], v[136:139]
  v_and_b32 v26, 0x200, v0
  v_lshl_add_u32 v25, v26, 4, v24
  v_mfma_f32_16x16x32_bf16 v[140:143], a[132:135], a[60:63], v[140:143]
  ds_read_b64_tr_b16 a[166:167], v1 offset:53856
  v_lshrrev_b32 v26, 4, v26
  v_mfma_f32_16x16x32_bf16 v[140:143], a[128:131], a[44:47], v[140:143]
  v_lshl_add_u32 v24, v24, 2, v26
  v_add_u32 v24, s80, v24
  v_mfma_f32_16x16x32_bf16 v[156:159], a[136:139], a[44:47], v[156:159]
  s_lshl2_add_u32 s65, s58, s44
  buffer_load_dwordx4 a[100:103], v0, s[36:39], s57 offen offset:1024 sc1
  s_lshl_b32 s65, s65, 19
  v_mfma_f32_16x16x32_bf16 v[156:159], a[140:143], a[60:63], v[156:159]
  s_mul_i32 s66, s60, 7
  ds_read_b64_tr_b16 a[168:169], v1 offset:43136
  s_and_b32 s80, s60, 1
  v_mfma_f32_16x16x32_bf16 v[152:155], a[140:143], a[56:59], v[152:155]
  s_add_u32 s66, s66, s80
  ds_read_b64_tr_b16 a[170:171], v1 offset:46720
  s_lshl_b32 s66, s66, 10
  v_mfma_f32_16x16x32_bf16 v[152:155], a[136:139], a[40:43], v[152:155]
  s_add_u32 s65, s65, s66
  s_add_u32 s67, s65, 19922944
  s_mul_i32 s80, s80, 8184
  v_mfma_f32_16x16x32_bf16 v[148:151], a[136:139], a[36:39], v[148:151]
  s_sub_u32 s65, s67, s80
  ds_read_b64_tr_b16 a[172:173], v1 offset:50304
  s_add_u32 s65, s65, 6144
  v_mfma_f32_16x16x32_bf16 v[148:151], a[140:143], a[52:55], v[148:151]
  s_add_u32 s66, s65, 262144
  buffer_load_dwordx4 v9, s[16:19], s56 offen offset:2048 lds
  s_lshl_b32 s45, s2, 7
  v_mfma_f32_16x16x32_bf16 v[144:147], a[140:143], a[48:51], v[144:147]
  s_add_u32 s45, s45, 5406720
  ds_read_b64_tr_b16 a[174:175], v1 offset:53888
  s_cmp_eq_u32 s44, 0
  v_mfma_f32_16x16x32_bf16 v[144:147], a[136:139], a[32:35], v[144:147]
  s_waitcnt lgkmcnt(8)
  s_cselect_b32 s45, s45, 1073741824
  s_add_u32 s78, s79, 4096
  v_mfma_f32_16x16x32_bf16 v[160:163], a[144:147], a[32:35], v[160:163]
  ds_read_b64_tr_b16 a[128:129], v1 offset:43168
  v_mfma_f32_16x16x32_bf16 v[160:163], a[148:151], a[48:51], v[160:163]
  v_mfma_f32_16x16x32_bf16 v[164:167], a[148:151], a[52:55], v[164:167]
  buffer_load_dwordx4 a[104:107], v0, s[36:39], s57 offen offset:2048 sc1
  v_mfma_f32_16x16x32_bf16 v[164:167], a[144:147], a[36:39], v[164:167]
  ds_read_b64_tr_b16 a[130:131], v1 offset:46752
  v_mfma_f32_16x16x32_bf16 v[168:171], a[144:147], a[40:43], v[168:171]
  ds_read_b64_tr_b16 a[132:133], v1 offset:50336
  v_mfma_f32_16x16x32_bf16 v[168:171], a[148:151], a[56:59], v[168:171]
  v_mfma_f32_16x16x32_bf16 v[172:175], a[148:151], a[60:63], v[172:175]
  ds_read_b64_tr_b16 a[134:135], v1 offset:53920
  v_mfma_f32_16x16x32_bf16 v[172:175], a[144:147], a[44:47], v[172:175]
  s_waitcnt vmcnt(20)
  s_barrier
  buffer_load_dwordx4 a[108:111], v0, s[36:39], s57 offen offset:3072 sc1
  s_bfe_u32 s56, s85, 0x40010
  v_mfma_f32_16x16x32_bf16 v[188:191], a[152:155], a[44:47], v[188:191]
  s_mul_i32 s56, s56, 458752
  s_add_u32 m0, s77, 0
  ds_read_b64_tr_b16 a[136:137], v1 offset:43200
  v_mfma_f32_16x16x32_bf16 v[188:191], a[156:159], a[60:63], v[188:191]
  v_mfma_f32_16x16x32_bf16 v[184:187], a[156:159], a[56:59], v[184:187]
  ds_read_b64_tr_b16 a[138:139], v1 offset:46784
  v_mfma_f32_16x16x32_bf16 v[184:187], a[152:155], a[40:43], v[184:187]
  v_mfma_f32_16x16x32_bf16 v[180:183], a[152:155], a[36:39], v[180:183]
  buffer_load_dwordx4 v3, s[16:19], s56 offen offset:0 lds
  s_add_u32 s57, s57, 4096
  v_mfma_f32_16x16x32_bf16 v[180:183], a[156:159], a[52:55], v[180:183]
  ds_read_b64_tr_b16 a[140:141], v1 offset:50368
  v_mfma_f32_16x16x32_bf16 v[176:179], a[156:159], a[48:51], v[176:179]
  ds_read_b64_tr_b16 a[142:143], v1 offset:53952
  v_mfma_f32_16x16x32_bf16 v[176:179], a[152:155], a[32:35], v[176:179]
  s_waitcnt lgkmcnt(8)
  v_mfma_f32_16x16x32_bf16 v[192:195], a[160:163], a[32:35], v[192:195]
  ds_read_b64_tr_b16 a[144:145], v2 offset:0
  v_mfma_f32_16x16x32_bf16 v[192:195], a[164:167], a[48:51], v[192:195]
  buffer_load_dwordx4 a[112:115], v0, s[36:39], s57 offen offset:0 sc1
  v_mfma_f32_16x16x32_bf16 v[196:199], a[164:167], a[52:55], v[196:199]
  ds_read_b64_tr_b16 a[146:147], v2 offset:3584
  v_mfma_f32_16x16x32_bf16 v[196:199], a[160:163], a[36:39], v[196:199]
  v_mfma_f32_16x16x32_bf16 v[200:203], a[160:163], a[40:43], v[200:203]
  ds_read_b64_tr_b16 a[148:149], v2 offset:7168
  v_mfma_f32_16x16x32_bf16 v[200:203], a[164:167], a[56:59], v[200:203]
  v_mfma_f32_16x16x32_bf16 v[204:207], a[164:167], a[60:63], v[204:207]
  buffer_load_dwordx4 v4, s[16:19], s56 offen offset:1024 lds
  v_mfma_f32_16x16x32_bf16 v[204:207], a[160:163], a[44:47], v[204:207]
  ds_read_b64_tr_b16 a[150:151], v2 offset:10752
  v_mfma_f32_16x16x32_bf16 v[220:223], a[168:171], a[44:47], v[220:223]
  ds_read_b64_tr_b16 a[152:153], v2 offset:32
  v_mfma_f32_16x16x32_bf16 v[220:223], a[172:175], a[60:63], v[220:223]
  v_mfma_f32_16x16x32_bf16 v[216:219], a[172:175], a[56:59], v[216:219]
  ds_read_b64_tr_b16 a[154:155], v2 offset:3616
  v_mfma_f32_16x16x32_bf16 v[216:219], a[168:171], a[40:43], v[216:219]
  buffer_load_dwordx4 a[116:119], v0, s[36:39], s57 offen offset:1024 sc1
  v_mfma_f32_16x16x32_bf16 v[212:215], a[168:171], a[36:39], v[212:215]
  ds_read_b64_tr_b16 a[156:157], v2 offset:7200
  v_mfma_f32_16x16x32_bf16 v[212:215], a[172:175], a[52:55], v[212:215]
  v_mfma_f32_16x16x32_bf16 v[208:211], a[172:175], a[48:51], v[208:211]
  ds_read_b64_tr_b16 a[158:159], v2 offset:10784
  v_mfma_f32_16x16x32_bf16 v[208:211], a[168:171], a[32:35], v[208:211]
  s_waitcnt lgkmcnt(8)
  v_mfma_f32_16x16x32_bf16 v[224:227], a[128:131], a[32:35], v[224:227]
  buffer_load_dwordx4 a[120:123], v0, s[36:39], s57 offen offset:2048 sc1
  v_mfma_f32_16x16x32_bf16 v[224:227], a[132:135], a[48:51], v[224:227]
  ds_read_b64_tr_b16 a[160:161], v2 offset:64
  v_mfma_f32_16x16x32_bf16 v[228:231], a[132:135], a[52:55], v[228:231]
  ds_read_b64_tr_b16 a[162:163], v2 offset:3648
  v_mfma_f32_16x16x32_bf16 v[228:231], a[128:131], a[36:39], v[228:231]
  v_mfma_f32_16x16x32_bf16 v[232:235], a[128:131], a[40:43], v[232:235]
  ds_read_b64_tr_b16 a[164:165], v2 offset:7232
  v_mfma_f32_16x16x32_bf16 v[232:235], a[132:135], a[56:59], v[232:235]
  buffer_load_dwordx4 v5, s[16:19], s56 offen offset:2048 lds
  v_mfma_f32_16x16x32_bf16 v[236:239], a[132:135], a[60:63], v[236:239]
  ds_read_b64_tr_b16 a[166:167], v2 offset:10816
  v_mfma_f32_16x16x32_bf16 v[236:239], a[128:131], a[44:47], v[236:239]
  v_mfma_f32_16x16x32_bf16 v[252:255], a[136:139], a[44:47], v[252:255]
  ds_read_b64_tr_b16 a[168:169], v2 offset:96
  v_mfma_f32_16x16x32_bf16 v[252:255], a[140:143], a[60:63], v[252:255]
  v_mfma_f32_16x16x32_bf16 v[248:251], a[140:143], a[56:59], v[248:251]
  buffer_load_dwordx4 a[124:127], v0, s[36:39], s57 offen offset:3072 sc1
  v_mfma_f32_16x16x32_bf16 v[248:251], a[136:139], a[40:43], v[248:251]
  ds_read_b64_tr_b16 a[170:171], v2 offset:3680
  v_mfma_f32_16x16x32_bf16 v[244:247], a[136:139], a[36:39], v[244:247]
  ds_read_b64_tr_b16 a[172:173], v2 offset:7264
  v_mfma_f32_16x16x32_bf16 v[244:247], a[140:143], a[52:55], v[244:247]
  v_mfma_f32_16x16x32_bf16 v[240:243], a[140:143], a[48:51], v[240:243]
  ds_read_b64_tr_b16 a[174:175], v2 offset:10848
  v_mfma_f32_16x16x32_bf16 v[240:243], a[136:139], a[32:35], v[240:243]
  s_waitcnt vmcnt(17) lgkmcnt(8)
  buffer_load_dwordx4 v6, s[16:19], s56 offen offset:3072 lds
  s_bfe_u32 s57, s85, 0x40010
  v_mfma_f32_16x16x32_bf16 v[32:35], a[144:147], a[64:67], v[32:35]
  s_lshl_b32 s57, s57, 13
  s_add_u32 s57, s57, s86
  ds_read_b64_tr_b16 a[128:129], v2 offset:128
  v_mfma_f32_16x16x32_bf16 v[32:35], a[148:151], a[80:83], v[32:35]
  s_barrier
  v_mfma_f32_16x16x32_bf16 v[36:39], a[148:151], a[84:87], v[36:39]
  ds_read_b64_tr_b16 a[130:131], v2 offset:3712
  v_mfma_f32_16x16x32_bf16 v[36:39], a[144:147], a[68:71], v[36:39]
  v_mfma_f32_16x16x32_bf16 v[40:43], a[144:147], a[72:75], v[40:43]
  buffer_load_dwordx4 a[0:3], v0, s[36:39], s57 offen offset:0 sc1
  v_mfma_f32_16x16x32_bf16 v[40:43], a[148:151], a[88:91], v[40:43]
  s_add_u32 m0, s77, 4096
  ds_read_b64_tr_b16 a[132:133], v2 offset:7296
  v_mfma_f32_16x16x32_bf16 v[44:47], a[148:151], a[92:95], v[44:47]
  ds_read_b64_tr_b16 a[134:135], v2 offset:10880
  v_mfma_f32_16x16x32_bf16 v[44:47], a[144:147], a[76:79], v[44:47]
  v_mfma_f32_16x16x32_bf16 v[60:63], a[152:155], a[76:79], v[60:63]
  ds_read_b64_tr_b16 a[136:137], v2 offset:160
  v_mfma_f32_16x16x32_bf16 v[60:63], a[156:159], a[92:95], v[60:63]
  buffer_load_dwordx4 v7, s[16:19], s56 offen offset:0 lds
  v_mfma_f32_16x16x32_bf16 v[56:59], a[156:159], a[88:91], v[56:59]
  ds_read_b64_tr_b16 a[138:139], v2 offset:3744
  v_mfma_f32_16x16x32_bf16 v[56:59], a[152:155], a[72:75], v[56:59]
  v_mfma_f32_16x16x32_bf16 v[52:55], a[152:155], a[68:71], v[52:55]
  ds_read_b64_tr_b16 a[140:141], v2 offset:7328
  v_mfma_f32_16x16x32_bf16 v[52:55], a[156:159], a[84:87], v[52:55]
  v_mfma_f32_16x16x32_bf16 v[48:51], a[156:159], a[80:83], v[48:51]
  buffer_load_dwordx4 a[4:7], v0, s[36:39], s57 offen offset:1024 sc1
  v_mfma_f32_16x16x32_bf16 v[48:51], a[152:155], a[64:67], v[48:51]
  s_waitcnt lgkmcnt(7)
  ds_read_b64_tr_b16 a[142:143], v2 offset:10912
  v_mfma_f32_16x16x32_bf16 v[64:67], a[160:163], a[64:67], v[64:67]
  ds_read_b64_tr_b16 a[144:145], v2 offset:192
  v_mfma_f32_16x16x32_bf16 v[64:67], a[164:167], a[80:83], v[64:67]
  v_mfma_f32_16x16x32_bf16 v[68:71], a[164:167], a[84:87], v[68:71]
  ds_read_b64_tr_b16 a[146:147], v2 offset:3776
  v_mfma_f32_16x16x32_bf16 v[68:71], a[160:163], a[68:71], v[68:71]
  v_mfma_f32_16x16x32_bf16 v[72:75], a[160:163], a[72:75], v[72:75]
  buffer_load_dwordx4 a[8:11], v0, s[36:39], s57 offen offset:2048 sc1
  v_mfma_f32_16x16x32_bf16 v[72:75], a[164:167], a[88:91], v[72:75]
  ds_read_b64_tr_b16 a[148:149], v2 offset:7360
  v_mfma_f32_16x16x32_bf16 v[76:79], a[164:167], a[92:95], v[76:79]
  ds_read_b64_tr_b16 a[150:151], v2 offset:10944
  v_mfma_f32_16x16x32_bf16 v[76:79], a[160:163], a[76:79], v[76:79]
  v_mfma_f32_16x16x32_bf16 v[92:95], a[168:171], a[76:79], v[92:95]
  ds_read_b64_tr_b16 a[152:153], v2 offset:14336
  v_mfma_f32_16x16x32_bf16 v[92:95], a[172:175], a[92:95], v[92:95]
  buffer_load_dwordx4 v8, s[16:19], s56 offen offset:1024 lds
  v_mfma_f32_16x16x32_bf16 v[88:91], a[172:175], a[88:91], v[88:91]
  ds_read_b64_tr_b16 a[154:155], v2 offset:17920
  v_mfma_f32_16x16x32_bf16 v[88:91], a[168:171], a[72:75], v[88:91]
  v_mfma_f32_16x16x32_bf16 v[84:87], a[168:171], a[68:71], v[84:87]
  ds_read_b64_tr_b16 a[156:157], v2 offset:21504
  v_mfma_f32_16x16x32_bf16 v[84:87], a[172:175], a[84:87], v[84:87]
  v_mfma_f32_16x16x32_bf16 v[80:83], a[172:175], a[80:83], v[80:83]
  buffer_load_dwordx4 a[12:15], v0, s[36:39], s57 offen offset:3072 sc1
  v_mfma_f32_16x16x32_bf16 v[80:83], a[168:171], a[64:67], v[80:83]
  s_waitcnt lgkmcnt(7)
  ds_read_b64_tr_b16 a[158:159], v2 offset:25088
  v_mfma_f32_16x16x32_bf16 v[96:99], a[128:131], a[64:67], v[96:99]
  ds_read_b64_tr_b16 a[160:161], v2 offset:14368
  v_mfma_f32_16x16x32_bf16 v[96:99], a[132:135], a[80:83], v[96:99]
  v_mfma_f32_16x16x32_bf16 v[100:103], a[132:135], a[84:87], v[100:103]
  ds_read_b64_tr_b16 a[162:163], v2 offset:17952
  v_mfma_f32_16x16x32_bf16 v[100:103], a[128:131], a[68:71], v[100:103]
  buffer_load_dwordx4 v9, s[16:19], s56 offen offset:2048 lds
  v_mfma_f32_16x16x32_bf16 v[104:107], a[128:131], a[72:75], v[104:107]
  s_add_u32 s57, s57, 4096
  ds_read_b64_tr_b16 a[164:165], v2 offset:21536
  v_mfma_f32_16x16x32_bf16 v[104:107], a[132:135], a[88:91], v[104:107]
  v_mfma_f32_16x16x32_bf16 v[108:111], a[132:135], a[92:95], v[108:111]
  ds_read_b64_tr_b16 a[166:167], v2 offset:25120
  v_mfma_f32_16x16x32_bf16 v[108:111], a[128:131], a[76:79], v[108:111]
  v_mfma_f32_16x16x32_bf16 v[124:127], a[136:139], a[76:79], v[124:127]
  buffer_load_dwordx4 a[16:19], v0, s[36:39], s57 offen offset:0 sc1
  v_mfma_f32_16x16x32_bf16 v[124:127], a[140:143], a[92:95], v[124:127]
  ds_read_b64_tr_b16 a[168:169], v2 offset:14400
  v_mfma_f32_16x16x32_bf16 v[120:123], a[140:143], a[88:91], v[120:123]
  ds_read_b64_tr_b16 a[170:171], v2 offset:17984
  v_mfma_f32_16x16x32_bf16 v[120:123], a[136:139], a[72:75], v[120:123]
  v_mfma_f32_16x16x32_bf16 v[116:119], a[136:139], a[68:71], v[116:119]
  ds_read_b64_tr_b16 a[172:173], v2 offset:21568
  v_mfma_f32_16x16x32_bf16 v[116:119], a[140:143], a[84:87], v[116:119]
  v_mfma_f32_16x16x32_bf16 v[112:115], a[140:143], a[80:83], v[112:115]
  ds_read_b64_tr_b16 a[174:175], v2 offset:25152
  v_mfma_f32_16x16x32_bf16 v[112:115], a[136:139], a[64:67], v[112:115]
  s_waitcnt lgkmcnt(8)
  v_mfma_f32_16x16x32_bf16 v[128:131], a[144:147], a[64:67], v[128:131]
  ds_read_b64_tr_b16 a[128:129], v2 offset:14432
  v_mfma_f32_16x16x32_bf16 v[128:131], a[148:151], a[80:83], v[128:131]
  v_mfma_f32_16x16x32_bf16 v[132:135], a[148:151], a[84:87], v[132:135]
  buffer_load_dwordx4 a[20:23], v0, s[36:39], s57 offen offset:1024 sc1
  s_bfe_u32 s56, s85, 0x40014
  v_mfma_f32_16x16x32_bf16 v[132:135], a[144:147], a[68:71], v[132:135]
  s_mul_i32 s56, s56, 458752
  s_add_u32 m0, s77, 28672
  ds_read_b64_tr_b16 a[130:131], v2 offset:18016
  v_mfma_f32_16x16x32_bf16 v[136:139], a[144:147], a[72:75], v[136:139]
  ds_read_b64_tr_b16 a[132:133], v2 offset:21600
  v_mfma_f32_16x16x32_bf16 v[136:139], a[148:151], a[88:91], v[136:139]
  v_mfma_f32_16x16x32_bf16 v[140:143], a[148:151], a[92:95], v[140:143]
  ds_read_b64_tr_b16 a[134:135], v2 offset:25184
  v_mfma_f32_16x16x32_bf16 v[140:143], a[144:147], a[76:79], v[140:143]
  buffer_load_dwordx4 v3, s[16:19], s56 offen offset:0 lds
  v_mfma_f32_16x16x32_bf16 v[156:159], a[152:155], a[76:79], v[156:159]
  ds_read_b64_tr_b16 a[136:137], v2 offset:14464
  v_mfma_f32_16x16x32_bf16 v[156:159], a[156:159], a[92:95], v[156:159]
  v_mfma_f32_16x16x32_bf16 v[152:155], a[156:159], a[88:91], v[152:155]
  ds_read_b64_tr_b16 a[138:139], v2 offset:18048
  v_mfma_f32_16x16x32_bf16 v[152:155], a[152:155], a[72:75], v[152:155]
  v_mfma_f32_16x16x32_bf16 v[148:151], a[152:155], a[68:71], v[148:151]
  buffer_load_dwordx4 a[24:27], v0, s[36:39], s57 offen offset:2048 sc1
  v_mfma_f32_16x16x32_bf16 v[148:151], a[156:159], a[84:87], v[148:151]
  ds_read_b64_tr_b16 a[140:141], v2 offset:21632
  v_mfma_f32_16x16x32_bf16 v[144:147], a[156:159], a[80:83], v[144:147]
  ds_read_b64_tr_b16 a[142:143], v2 offset:25216
  v_mfma_f32_16x16x32_bf16 v[144:147], a[152:155], a[64:67], v[144:147]
  s_waitcnt lgkmcnt(8)
  v_mfma_f32_16x16x32_bf16 v[160:163], a[160:163], a[64:67], v[160:163]
  ds_read_b64_tr_b16 a[144:145], v2 offset:14496
  v_mfma_f32_16x16x32_bf16 v[160:163], a[164:167], a[80:83], v[160:163]
  buffer_load_dwordx4 v4, s[16:19], s56 offen offset:1024 lds
  v_mfma_f32_16x16x32_bf16 v[164:167], a[164:167], a[84:87], v[164:167]
  ds_read_b64_tr_b16 a[146:147], v2 offset:18080
  v_mfma_f32_16x16x32_bf16 v[164:167], a[160:163], a[68:71], v[164:167]
  v_mfma_f32_16x16x32_bf16 v[168:171], a[160:163], a[72:75], v[168:171]
  ds_read_b64_tr_b16 a[148:149], v2 offset:21664
  v_mfma_f32_16x16x32_bf16 v[168:171], a[164:167], a[88:91], v[168:171]
  v_mfma_f32_16x16x32_bf16 v[172:175], a[164:167], a[92:95], v[172:175]
  buffer_load_dwordx4 a[28:31], v0, s[36:39], s57 offen offset:3072 sc1
  v_mfma_f32_16x16x32_bf16 v[172:175], a[160:163], a[76:79], v[172:175]
  s_waitcnt vmcnt(23)
  s_barrier
  ds_read_b64_tr_b16 a[150:151], v2 offset:25248
  v_mfma_f32_16x16x32_bf16 v[188:191], a[168:171], a[76:79], v[188:191]
  ds_read_b64_tr_b16 a[152:153], v2 offset:14528
  v_mfma_f32_16x16x32_bf16 v[188:191], a[172:175], a[92:95], v[188:191]
  v_mfma_f32_16x16x32_bf16 v[184:187], a[172:175], a[88:91], v[184:187]
  ds_read_b64_tr_b16 a[154:155], v2 offset:18112
  v_mfma_f32_16x16x32_bf16 v[184:187], a[168:171], a[72:75], v[184:187]
  buffer_load_dwordx4 v5, s[16:19], s56 offen offset:2048 lds
  s_bfe_u32 s57, s85, 0x40014
  v_mfma_f32_16x16x32_bf16 v[180:183], a[168:171], a[68:71], v[180:183]
  s_lshl_b32 s57, s57, 13
  s_add_u32 s57, s57, s86
  ds_read_b64_tr_b16 a[156:157], v2 offset:21696
  v_mfma_f32_16x16x32_bf16 v[180:183], a[172:175], a[84:87], v[180:183]
Hb1_1:
  s_cbranch_execz Hb1_2
  v_mfma_f32_16x16x32_bf16 v[176:179], a[172:175], a[80:83], v[176:179]
  ds_read_b64_tr_b16 a[158:159], v2 offset:25280
  v_mfma_f32_16x16x32_bf16 v[176:179], a[168:171], a[64:67], v[176:179]
  s_waitcnt lgkmcnt(8)
  v_mfma_f32_16x16x32_bf16 v[192:195], a[128:131], a[64:67], v[192:195]
  buffer_load_dwordx4 a[32:35], v0, s[36:39], s57 offen offset:0 sc1
  v_mfma_f32_16x16x32_bf16 v[192:195], a[132:135], a[80:83], v[192:195]
  ds_read_b64_tr_b16 a[160:161], v2 offset:28672
  v_mfma_f32_16x16x32_bf16 v[196:199], a[132:135], a[84:87], v[196:199]
  ds_read_b64_tr_b16 a[162:163], v2 offset:32256
  v_mfma_f32_16x16x32_bf16 v[196:199], a[128:131], a[68:71], v[196:199]
  v_mfma_f32_16x16x32_bf16 v[200:203], a[128:131], a[72:75], v[200:203]
  ds_read_b64_tr_b16 a[164:165], v2 offset:35840
  v_mfma_f32_16x16x32_bf16 v[200:203], a[132:135], a[88:91], v[200:203]
  buffer_load_dwordx4 a[36:39], v0, s[36:39], s57 offen offset:1024 sc1
  v_mfma_f32_16x16x32_bf16 v[204:207], a[132:135], a[92:95], v[204:207]
  ds_read_b64_tr_b16 a[166:167], v2 offset:39424
  v_mfma_f32_16x16x32_bf16 v[204:207], a[128:131], a[76:79], v[204:207]
  v_mfma_f32_16x16x32_bf16 v[220:223], a[136:139], a[76:79], v[220:223]
  ds_read_b64_tr_b16 a[168:169], v2 offset:28704
  v_mfma_f32_16x16x32_bf16 v[220:223], a[140:143], a[92:95], v[220:223]
  v_mfma_f32_16x16x32_bf16 v[216:219], a[140:143], a[88:91], v[216:219]
  buffer_load_dwordx4 v6, s[16:19], s56 offen offset:3072 lds
  v_mfma_f32_16x16x32_bf16 v[216:219], a[136:139], a[72:75], v[216:219]
  ds_read_b64_tr_b16 a[170:171], v2 offset:32288
  v_mfma_f32_16x16x32_bf16 v[212:215], a[136:139], a[68:71], v[212:215]
  ds_read_b64_tr_b16 a[172:173], v2 offset:35872
  v_mfma_f32_16x16x32_bf16 v[212:215], a[140:143], a[84:87], v[212:215]
  v_mfma_f32_16x16x32_bf16 v[208:211], a[140:143], a[80:83], v[208:211]
  ds_read_b64_tr_b16 a[174:175], v2 offset:39456
  v_mfma_f32_16x16x32_bf16 v[208:211], a[136:139], a[64:67], v[208:211]
  s_waitcnt lgkmcnt(8)
  buffer_load_dwordx4 a[40:43], v0, s[36:39], s57 offen offset:2048 sc1
  s_add_u32 m0, s77, 32768
  v_mfma_f32_16x16x32_bf16 v[224:227], a[144:147], a[64:67], v[224:227]
  ds_read_b64_tr_b16 a[128:129], v2 offset:28736
  v_mfma_f32_16x16x32_bf16 v[224:227], a[148:151], a[80:83], v[224:227]
  v_mfma_f32_16x16x32_bf16 v[228:231], a[148:151], a[84:87], v[228:231]
  ds_read_b64_tr_b16 a[130:131], v2 offset:32320
  v_mfma_f32_16x16x32_bf16 v[228:231], a[144:147], a[68:71], v[228:231]
  v_mfma_f32_16x16x32_bf16 v[232:235], a[144:147], a[72:75], v[232:235]
  buffer_load_dwordx4 v7, s[16:19], s56 offen offset:0 lds
  v_mfma_f32_16x16x32_bf16 v[232:235], a[148:151], a[88:91], v[232:235]
  ds_read_b64_tr_b16 a[132:133], v2 offset:35904
  v_mfma_f32_16x16x32_bf16 v[236:239], a[148:151], a[92:95], v[236:239]
  ds_read_b64_tr_b16 a[134:135], v2 offset:39488
  v_mfma_f32_16x16x32_bf16 v[236:239], a[144:147], a[76:79], v[236:239]
  v_mfma_f32_16x16x32_bf16 v[252:255], a[152:155], a[76:79], v[252:255]
  ds_read_b64_tr_b16 a[136:137], v2 offset:28768
  v_mfma_f32_16x16x32_bf16 v[252:255], a[156:159], a[92:95], v[252:255]
  buffer_load_dwordx4 a[44:47], v0, s[36:39], s57 offen offset:3072 sc1
  v_mfma_f32_16x16x32_bf16 v[248:251], a[156:159], a[88:91], v[248:251]
  ds_read_b64_tr_b16 a[138:139], v2 offset:32352
  v_mfma_f32_16x16x32_bf16 v[248:251], a[152:155], a[72:75], v[248:251]
  v_mfma_f32_16x16x32_bf16 v[244:247], a[152:155], a[68:71], v[244:247]
  ds_read_b64_tr_b16 a[140:141], v2 offset:35936
  v_mfma_f32_16x16x32_bf16 v[244:247], a[156:159], a[84:87], v[244:247]
  v_mfma_f32_16x16x32_bf16 v[240:243], a[156:159], a[80:83], v[240:243]
  ds_read_b64_tr_b16 a[142:143], v2 offset:39520
  v_mfma_f32_16x16x32_bf16 v[240:243], a[152:155], a[64:67], v[240:243]
  s_waitcnt vmcnt(21) lgkmcnt(8)
  buffer_load_dwordx4 v8, s[16:19], s56 offen offset:1024 lds
  s_add_u32 s57, s57, 4096
  v_mfma_f32_16x16x32_bf16 v[32:35], a[160:163], a[96:99], v[32:35]
  ds_read_b64_tr_b16 a[144:145], v2 offset:28800
  v_mfma_f32_16x16x32_bf16 v[32:35], a[164:167], a[112:115], v[32:35]
  s_barrier
  v_mfma_f32_16x16x32_bf16 v[36:39], a[164:167], a[116:119], v[36:39]
  ds_read_b64_tr_b16 a[146:147], v2 offset:32384
  v_mfma_f32_16x16x32_bf16 v[36:39], a[160:163], a[100:103], v[36:39]
  v_mfma_f32_16x16x32_bf16 v[40:43], a[160:163], a[104:107], v[40:43]
  buffer_load_dwordx4 a[48:51], v0, s[36:39], s57 offen offset:0 sc1
  v_mfma_f32_16x16x32_bf16 v[40:43], a[164:167], a[120:123], v[40:43]
  ds_read_b64_tr_b16 a[148:149], v2 offset:35968
  v_mfma_f32_16x16x32_bf16 v[44:47], a[164:167], a[124:127], v[44:47]
  ds_read_b64_tr_b16 a[150:151], v2 offset:39552
  v_mfma_f32_16x16x32_bf16 v[44:47], a[160:163], a[108:111], v[44:47]
  v_mfma_f32_16x16x32_bf16 v[60:63], a[168:171], a[108:111], v[60:63]
  ds_read_b64_tr_b16 a[152:153], v2 offset:28832
  v_mfma_f32_16x16x32_bf16 v[60:63], a[172:175], a[124:127], v[60:63]
  v_mfma_f32_16x16x32_bf16 v[56:59], a[172:175], a[120:123], v[56:59]
  ds_read_b64_tr_b16 a[154:155], v2 offset:32416
  v_mfma_f32_16x16x32_bf16 v[56:59], a[168:171], a[104:107], v[56:59]
  buffer_load_dwordx4 v9, s[16:19], s56 offen offset:2048 lds
  v_mfma_f32_16x16x32_bf16 v[52:55], a[168:171], a[100:103], v[52:55]
  ds_read_b64_tr_b16 a[156:157], v2 offset:36000
  v_mfma_f32_16x16x32_bf16 v[52:55], a[172:175], a[116:119], v[52:55]
  v_mfma_f32_16x16x32_bf16 v[48:51], a[172:175], a[112:115], v[48:51]
  ds_read_b64_tr_b16 a[158:159], v2 offset:39584
  v_mfma_f32_16x16x32_bf16 v[48:51], a[168:171], a[96:99], v[48:51]
  s_waitcnt lgkmcnt(8)
  v_mfma_f32_16x16x32_bf16 v[64:67], a[128:131], a[96:99], v[64:67]
  buffer_load_dwordx4 a[52:55], v0, s[36:39], s57 offen offset:1024 sc1
  v_mfma_f32_16x16x32_bf16 v[64:67], a[132:135], a[112:115], v[64:67]
  ds_read_b64_tr_b16 a[160:161], v2 offset:28864
  v_mfma_f32_16x16x32_bf16 v[68:71], a[132:135], a[116:119], v[68:71]
  ds_read_b64_tr_b16 a[162:163], v2 offset:32448
  v_mfma_f32_16x16x32_bf16 v[68:71], a[128:131], a[100:103], v[68:71]
  v_mfma_f32_16x16x32_bf16 v[72:75], a[128:131], a[104:107], v[72:75]
  ds_read_b64_tr_b16 a[164:165], v2 offset:36032
  v_mfma_f32_16x16x32_bf16 v[72:75], a[132:135], a[120:123], v[72:75]
  v_mfma_f32_16x16x32_bf16 v[76:79], a[132:135], a[124:127], v[76:79]
  buffer_load_dwordx4 a[56:59], v0, s[36:39], s57 offen offset:2048 sc1
  v_mfma_f32_16x16x32_bf16 v[76:79], a[128:131], a[108:111], v[76:79]
  ds_read_b64_tr_b16 a[166:167], v2 offset:39616
  v_mfma_f32_16x16x32_bf16 v[92:95], a[136:139], a[108:111], v[92:95]
  s_bfe_u32 s56, s85, 0x40018
  s_mul_i32 s56, s56, 458752
  s_add_u32 m0, s77, 57344
  v_mfma_f32_16x16x32_bf16 v[92:95], a[140:143], a[124:127], v[92:95]
  ds_read_b64_tr_b16 a[168:169], v2 offset:43008
  v_mfma_f32_16x16x32_bf16 v[88:91], a[140:143], a[120:123], v[88:91]
  ds_read_b64_tr_b16 a[170:171], v2 offset:46592
  v_mfma_f32_16x16x32_bf16 v[88:91], a[136:139], a[104:107], v[88:91]
  v_mfma_f32_16x16x32_bf16 v[84:87], a[136:139], a[100:103], v[84:87]
  buffer_load_dwordx4 v3, s[16:19], s56 offen offset:0 lds
  v_mfma_f32_16x16x32_bf16 v[84:87], a[140:143], a[116:119], v[84:87]
  ds_read_b64_tr_b16 a[172:173], v2 offset:50176
  v_mfma_f32_16x16x32_bf16 v[80:83], a[140:143], a[112:115], v[80:83]
  ds_read_b64_tr_b16 a[174:175], v2 offset:53760
  v_mfma_f32_16x16x32_bf16 v[80:83], a[136:139], a[96:99], v[80:83]
  s_waitcnt lgkmcnt(8)
  v_mfma_f32_16x16x32_bf16 v[96:99], a[144:147], a[96:99], v[96:99]
  ds_read_b64_tr_b16 a[128:129], v2 offset:43040
  v_mfma_f32_16x16x32_bf16 v[96:99], a[148:151], a[112:115], v[96:99]
  buffer_load_dwordx4 a[60:63], v0, s[36:39], s57 offen offset:3072 sc1
  s_bfe_u32 s57, s85, 0x40018
  v_mfma_f32_16x16x32_bf16 v[100:103], a[148:151], a[116:119], v[100:103]
  s_lshl_b32 s57, s57, 13
  s_add_u32 s57, s57, s86
  ds_read_b64_tr_b16 a[130:131], v2 offset:46624
  v_mfma_f32_16x16x32_bf16 v[100:103], a[144:147], a[100:103], v[100:103]
  v_mfma_f32_16x16x32_bf16 v[104:107], a[144:147], a[104:107], v[104:107]
  buffer_load_dwordx4 a[208:211], v25, s[36:39], s79 offen offset:0 sc1
  v_mfma_f32_16x16x32_bf16 v[104:107], a[148:151], a[120:123], v[104:107]
  ds_read_b64_tr_b16 a[132:133], v2 offset:50208
  v_mfma_f32_16x16x32_bf16 v[108:111], a[148:151], a[124:127], v[108:111]
  ds_read_b64_tr_b16 a[134:135], v2 offset:53792
  v_mfma_f32_16x16x32_bf16 v[108:111], a[144:147], a[108:111], v[108:111]
  v_mfma_f32_16x16x32_bf16 v[124:127], a[152:155], a[108:111], v[124:127]
  ds_read_b64_tr_b16 a[136:137], v2 offset:43072
  v_mfma_f32_16x16x32_bf16 v[124:127], a[156:159], a[124:127], v[124:127]
  buffer_load_dwordx4 a[212:215], v25, s[36:39], s79 offen offset:2048 sc1
  v_mfma_f32_16x16x32_bf16 v[120:123], a[156:159], a[120:123], v[120:123]
  ds_read_b64_tr_b16 a[138:139], v2 offset:46656
  v_mfma_f32_16x16x32_bf16 v[120:123], a[152:155], a[104:107], v[120:123]
  v_mfma_f32_16x16x32_bf16 v[116:119], a[152:155], a[100:103], v[116:119]
  ds_read_b64_tr_b16 a[140:141], v2 offset:50240
  v_mfma_f32_16x16x32_bf16 v[116:119], a[156:159], a[116:119], v[116:119]
  v_mfma_f32_16x16x32_bf16 v[112:115], a[156:159], a[112:115], v[112:115]
  buffer_load_dwordx4 a[216:219], v25, s[36:39], s78 offen offset:0 sc1
  v_mfma_f32_16x16x32_bf16 v[112:115], a[152:155], a[96:99], v[112:115]
  s_waitcnt lgkmcnt(7)
  ds_read_b64_tr_b16 a[142:143], v2 offset:53824
  v_mfma_f32_16x16x32_bf16 v[128:131], a[160:163], a[96:99], v[128:131]
  ds_read_b64_tr_b16 a[144:145], v2 offset:43104
  v_mfma_f32_16x16x32_bf16 v[128:131], a[164:167], a[112:115], v[128:131]
  v_mfma_f32_16x16x32_bf16 v[132:135], a[164:167], a[116:119], v[132:135]
  ds_read_b64_tr_b16 a[146:147], v2 offset:46688
  v_mfma_f32_16x16x32_bf16 v[132:135], a[160:163], a[100:103], v[132:135]
  buffer_load_dwordx4 a[220:223], v25, s[36:39], s78 offen offset:2048 sc1
  v_mfma_f32_16x16x32_bf16 v[136:139], a[160:163], a[104:107], v[136:139]
  ds_read_b64_tr_b16 a[148:149], v2 offset:50272
  v_mfma_f32_16x16x32_bf16 v[136:139], a[164:167], a[120:123], v[136:139]
  v_mfma_f32_16x16x32_bf16 v[140:143], a[164:167], a[124:127], v[140:143]
  ds_read_b64_tr_b16 a[150:151], v2 offset:53856
  v_mfma_f32_16x16x32_bf16 v[140:143], a[160:163], a[108:111], v[140:143]
  v_mfma_f32_16x16x32_bf16 v[156:159], a[168:171], a[108:111], v[156:159]
  buffer_load_dwordx4 a[64:67], v0, s[36:39], s57 offen offset:0 sc1
  v_mfma_f32_16x16x32_bf16 v[156:159], a[172:175], a[124:127], v[156:159]
  ds_read_b64_tr_b16 a[152:153], v2 offset:43136
  v_mfma_f32_16x16x32_bf16 v[152:155], a[172:175], a[120:123], v[152:155]
  ds_read_b64_tr_b16 a[154:155], v2 offset:46720
  v_mfma_f32_16x16x32_bf16 v[152:155], a[168:171], a[104:107], v[152:155]
  v_mfma_f32_16x16x32_bf16 v[148:151], a[168:171], a[100:103], v[148:151]
  ds_read_b64_tr_b16 a[156:157], v2 offset:50304
  v_mfma_f32_16x16x32_bf16 v[148:151], a[172:175], a[116:119], v[148:151]
  buffer_load_dwordx4 v4, s[16:19], s56 offen offset:1024 lds
  v_mfma_f32_16x16x32_bf16 v[144:147], a[172:175], a[112:115], v[144:147]
  ds_read_b64_tr_b16 a[158:159], v2 offset:53888
  v_mfma_f32_16x16x32_bf16 v[144:147], a[168:171], a[96:99], v[144:147]
  s_waitcnt lgkmcnt(8)
  v_mfma_f32_16x16x32_bf16 v[160:163], a[128:131], a[96:99], v[160:163]
  ds_read_b64_tr_b16 a[160:161], v2 offset:43168
  v_mfma_f32_16x16x32_bf16 v[160:163], a[132:135], a[112:115], v[160:163]
  v_mfma_f32_16x16x32_bf16 v[164:167], a[132:135], a[116:119], v[164:167]
  buffer_load_dwordx4 a[68:71], v0, s[36:39], s57 offen offset:1024 sc1
  v_mfma_f32_16x16x32_bf16 v[164:167], a[128:131], a[100:103], v[164:167]
  ds_read_b64_tr_b16 a[162:163], v2 offset:46752
  v_mfma_f32_16x16x32_bf16 v[168:171], a[128:131], a[104:107], v[168:171]
  ds_read_b64_tr_b16 a[164:165], v2 offset:50336
  v_mfma_f32_16x16x32_bf16 v[168:171], a[132:135], a[120:123], v[168:171]
  v_mfma_f32_16x16x32_bf16 v[172:175], a[132:135], a[124:127], v[172:175]
  ds_read_b64_tr_b16 a[166:167], v2 offset:53920
  v_mfma_f32_16x16x32_bf16 v[172:175], a[128:131], a[108:111], v[172:175]
  s_waitcnt vmcnt(27)
  s_barrier
  buffer_load_dwordx4 v5, s[16:19], s56 offen offset:2048 lds
  v_mfma_f32_16x16x32_bf16 v[188:191], a[136:139], a[108:111], v[188:191]
  ds_read_b64_tr_b16 a[168:169], v2 offset:43200
  v_mfma_f32_16x16x32_bf16 v[188:191], a[140:143], a[124:127], v[188:191]
  v_mfma_f32_16x16x32_bf16 v[184:187], a[140:143], a[120:123], v[184:187]
  ds_read_b64_tr_b16 a[170:171], v2 offset:46784
  v_mfma_f32_16x16x32_bf16 v[184:187], a[136:139], a[104:107], v[184:187]
  v_mfma_f32_16x16x32_bf16 v[180:183], a[136:139], a[100:103], v[180:183]
  buffer_load_dwordx4 a[72:75], v0, s[36:39], s57 offen offset:2048 sc1
  v_mfma_f32_16x16x32_bf16 v[180:183], a[140:143], a[116:119], v[180:183]
  ds_read_b64_tr_b16 a[172:173], v2 offset:50368
  v_mfma_f32_16x16x32_bf16 v[176:179], a[140:143], a[112:115], v[176:179]
  ds_read_b64_tr_b16 a[174:175], v2 offset:53952
  v_mfma_f32_16x16x32_bf16 v[176:179], a[136:139], a[96:99], v[176:179]
  s_waitcnt lgkmcnt(8)
  v_mfma_f32_16x16x32_bf16 v[192:195], a[144:147], a[96:99], v[192:195]
  ds_read_b64_tr_b16 a[128:129], v1 offset:0
  v_mfma_f32_16x16x32_bf16 v[192:195], a[148:151], a[112:115], v[192:195]
  buffer_load_dwordx4 v6, s[16:19], s56 offen offset:3072 lds
  v_mfma_f32_16x16x32_bf16 v[196:199], a[148:151], a[116:119], v[196:199]
  ds_read_b64_tr_b16 a[130:131], v1 offset:3584
  v_mfma_f32_16x16x32_bf16 v[196:199], a[144:147], a[100:103], v[196:199]
  v_mfma_f32_16x16x32_bf16 v[200:203], a[144:147], a[104:107], v[200:203]
  ds_read_b64_tr_b16 a[132:133], v1 offset:7168
  v_mfma_f32_16x16x32_bf16 v[200:203], a[148:151], a[120:123], v[200:203]
  v_mfma_f32_16x16x32_bf16 v[204:207], a[148:151], a[124:127], v[204:207]
  buffer_load_dwordx4 a[76:79], v0, s[36:39], s57 offen offset:3072 sc1
  s_add_u32 m0, s77, 61440
  v_mfma_f32_16x16x32_bf16 v[204:207], a[144:147], a[108:111], v[204:207]
  ds_read_b64_tr_b16 a[134:135], v1 offset:10752
  v_mfma_f32_16x16x32_bf16 v[220:223], a[152:155], a[108:111], v[220:223]
  ds_read_b64_tr_b16 a[136:137], v1 offset:32
  v_mfma_f32_16x16x32_bf16 v[220:223], a[156:159], a[124:127], v[220:223]
  v_mfma_f32_16x16x32_bf16 v[216:219], a[156:159], a[120:123], v[216:219]
  ds_read_b64_tr_b16 a[138:139], v1 offset:3616
  v_mfma_f32_16x16x32_bf16 v[216:219], a[152:155], a[104:107], v[216:219]
  buffer_load_dwordx4 v7, s[16:19], s56 offen offset:0 lds
  s_add_u32 s57, s57, 4096
  v_mfma_f32_16x16x32_bf16 v[212:215], a[152:155], a[100:103], v[212:215]
  ds_read_b64_tr_b16 a[140:141], v1 offset:7200
  v_mfma_f32_16x16x32_bf16 v[212:215], a[156:159], a[116:119], v[212:215]
  v_mfma_f32_16x16x32_bf16 v[208:211], a[156:159], a[112:115], v[208:211]
  ds_read_b64_tr_b16 a[142:143], v1 offset:10784
  v_mfma_f32_16x16x32_bf16 v[208:211], a[152:155], a[96:99], v[208:211]
  s_waitcnt lgkmcnt(8)
  v_mfma_f32_16x16x32_bf16 v[224:227], a[160:163], a[96:99], v[224:227]
  buffer_load_dwordx4 a[80:83], v0, s[36:39], s57 offen offset:0 sc1
  v_mfma_f32_16x16x32_bf16 v[224:227], a[164:167], a[112:115], v[224:227]
  ds_read_b64_tr_b16 a[144:145], v1 offset:64
  v_mfma_f32_16x16x32_bf16 v[228:231], a[164:167], a[116:119], v[228:231]
  ds_read_b64_tr_b16 a[146:147], v1 offset:3648
  v_mfma_f32_16x16x32_bf16 v[228:231], a[160:163], a[100:103], v[228:231]
  v_mfma_f32_16x16x32_bf16 v[232:235], a[160:163], a[104:107], v[232:235]
  ds_read_b64_tr_b16 a[148:149], v1 offset:7232
  v_mfma_f32_16x16x32_bf16 v[232:235], a[164:167], a[120:123], v[232:235]
  buffer_load_dwordx4 a[84:87], v0, s[36:39], s57 offen offset:1024 sc1
  v_mfma_f32_16x16x32_bf16 v[236:239], a[164:167], a[124:127], v[236:239]
  ds_read_b64_tr_b16 a[150:151], v1 offset:10816
  v_mfma_f32_16x16x32_bf16 v[236:239], a[160:163], a[108:111], v[236:239]
  v_mfma_f32_16x16x32_bf16 v[252:255], a[168:171], a[108:111], v[252:255]
  ds_read_b64_tr_b16 a[152:153], v1 offset:96
  v_mfma_f32_16x16x32_bf16 v[252:255], a[172:175], a[124:127], v[252:255]
  v_mfma_f32_16x16x32_bf16 v[248:251], a[172:175], a[120:123], v[248:251]
  buffer_load_dwordx4 v8, s[16:19], s56 offen offset:1024 lds
  v_mfma_f32_16x16x32_bf16 v[248:251], a[168:171], a[104:107], v[248:251]
  ds_read_b64_tr_b16 a[154:155], v1 offset:3680
  v_mfma_f32_16x16x32_bf16 v[244:247], a[168:171], a[100:103], v[244:247]
  ds_read_b64_tr_b16 a[156:157], v1 offset:7264
  v_mfma_f32_16x16x32_bf16 v[244:247], a[172:175], a[116:119], v[244:247]
  v_mfma_f32_16x16x32_bf16 v[240:243], a[172:175], a[112:115], v[240:243]
  ds_read_b64_tr_b16 a[158:159], v1 offset:10848
  v_mfma_f32_16x16x32_bf16 v[240:243], a[168:171], a[96:99], v[240:243]
  s_waitcnt vmcnt(29) lgkmcnt(8)
  buffer_load_dwordx4 a[88:91], v0, s[36:39], s57 offen offset:2048 sc1
  v_mfma_f32_16x16x32_bf16 v[32:35], a[128:131], a[0:3], v[32:35]
  ds_read_b64_tr_b16 a[160:161], v1 offset:128
  v_mfma_f32_16x16x32_bf16 v[32:35], a[132:135], a[16:19], v[32:35]
  s_waitcnt vmcnt(20)
  s_barrier
  v_mfma_f32_16x16x32_bf16 v[36:39], a[132:135], a[20:23], v[36:39]
  ds_read_b64_tr_b16 a[162:163], v1 offset:3712
  v_mfma_f32_16x16x32_bf16 v[36:39], a[128:131], a[4:7], v[36:39]
  v_mfma_f32_16x16x32_bf16 v[40:43], a[128:131], a[8:11], v[40:43]
  buffer_load_dwordx4 v9, s[16:19], s56 offen offset:2048 lds
  v_mfma_f32_16x16x32_bf16 v[40:43], a[132:135], a[24:27], v[40:43]
  ds_read_b64_tr_b16 a[164:165], v1 offset:7296
  v_mfma_f32_16x16x32_bf16 v[44:47], a[132:135], a[28:31], v[44:47]
  ds_read_b64_tr_b16 a[166:167], v1 offset:10880
  v_mfma_f32_16x16x32_bf16 v[44:47], a[128:131], a[12:15], v[44:47]
  v_mfma_f32_16x16x32_bf16 v[60:63], a[136:139], a[12:15], v[60:63]
  ds_read_b64_tr_b16 a[168:169], v1 offset:160
  v_mfma_f32_16x16x32_bf16 v[60:63], a[140:143], a[28:31], v[60:63]
  buffer_load_dwordx4 a[92:95], v0, s[36:39], s57 offen offset:3072 sc1
  s_bfe_u32 s57, s85, 0x4001c
  v_mfma_f32_16x16x32_bf16 v[56:59], a[140:143], a[24:27], v[56:59]
  s_lshl_b32 s57, s57, 13
  s_add_u32 s57, s57, s86
  ds_read_b64_tr_b16 a[170:171], v1 offset:3744
  v_mfma_f32_16x16x32_bf16 v[56:59], a[136:139], a[8:11], v[56:59]
  v_mfma_f32_16x16x32_bf16 v[52:55], a[136:139], a[4:7], v[52:55]
  ds_read_b64_tr_b16 a[172:173], v1 offset:7328
  v_mfma_f32_16x16x32_bf16 v[52:55], a[140:143], a[20:23], v[52:55]
  s_waitcnt vmcnt(14)
  v_accvgpr_read_b32 v26, a208
  v_accvgpr_read_b32 v27, a209
  v_mfma_f32_16x16x32_bf16 v[48:51], a[140:143], a[16:19], v[48:51]
  buffer_load_dwordx4 a[96:99], v0, s[36:39], s57 offen offset:0 sc1
  s_bfe_u32 s56, s85, 0x4001c
  v_mfma_f32_16x16x32_bf16 v[48:51], a[136:139], a[0:3], v[48:51]
  s_waitcnt lgkmcnt(7)
  s_mul_i32 s56, s56, 458752
  s_add_u32 m0, s77, 86016
  v_mfma_f32_16x16x32_bf16 v[64:67], a[144:147], a[0:3], v[64:67]
  ds_read_b64_tr_b16 a[174:175], v1 offset:10912
  v_accvgpr_read_b32 v28, a210
  v_mfma_f32_16x16x32_bf16 v[64:67], a[148:151], a[16:19], v[64:67]
  ds_read_b64_tr_b16 a[128:129], v1 offset:192
  v_accvgpr_read_b32 v29, a211
  v_mfma_f32_16x16x32_bf16 v[68:71], a[148:151], a[20:23], v[68:71]
  ds_read_b64_tr_b16 a[130:131], v1 offset:3776
  v_max_u32 v31, v26, v27
  v_mfma_f32_16x16x32_bf16 v[68:71], a[144:147], a[4:7], v[68:71]
  buffer_load_dwordx4 v3, s[16:19], s56 offen offset:0 lds
  v_max3_u32 v31, v31, v28, v29
  v_mfma_f32_16x16x32_bf16 v[72:75], a[144:147], a[8:11], v[72:75]
  ds_read_b64_tr_b16 a[132:133], v1 offset:7360
  v_accvgpr_read_b32 v22, a212
  v_mfma_f32_16x16x32_bf16 v[72:75], a[148:151], a[24:27], v[72:75]
  v_accvgpr_read_b32 v23, a213
  v_max3_u32 v31, v31, v22, v23
  v_mfma_f32_16x16x32_bf16 v[76:79], a[148:151], a[28:31], v[76:79]
  ds_read_b64_tr_b16 a[134:135], v1 offset:10944
  v_add_f32 v26, v26, v22
  v_mfma_f32_16x16x32_bf16 v[76:79], a[144:147], a[12:15], v[76:79]
  v_add_f32 v27, v27, v23
  v_accvgpr_read_b32 v22, a214
  v_mfma_f32_16x16x32_bf16 v[92:95], a[152:155], a[12:15], v[92:95]
  buffer_load_dwordx4 a[100:103], v0, s[36:39], s57 offen offset:1024 sc1
  v_accvgpr_read_b32 v23, a215
  v_mfma_f32_16x16x32_bf16 v[92:95], a[156:159], a[28:31], v[92:95]
  ds_read_b64_tr_b16 a[136:137], v1 offset:14336
  v_max3_u32 v31, v31, v22, v23
  v_mfma_f32_16x16x32_bf16 v[88:91], a[156:159], a[24:27], v[88:91]
  ds_read_b64_tr_b16 a[138:139], v1 offset:17920
  v_add_f32 v28, v28, v22
  v_mfma_f32_16x16x32_bf16 v[88:91], a[152:155], a[8:11], v[88:91]
  v_add_f32 v29, v29, v23
  v_accvgpr_read_b32 v22, a216
  v_mfma_f32_16x16x32_bf16 v[84:87], a[152:155], a[4:7], v[84:87]
  ds_read_b64_tr_b16 a[140:141], v1 offset:21504
  v_accvgpr_read_b32 v23, a217
  v_mfma_f32_16x16x32_bf16 v[84:87], a[156:159], a[20:23], v[84:87]
  buffer_load_dwordx4 v4, s[16:19], s56 offen offset:1024 lds
  v_max3_u32 v31, v31, v22, v23
  v_mfma_f32_16x16x32_bf16 v[80:83], a[156:159], a[16:19], v[80:83]
  ds_read_b64_tr_b16 a[142:143], v1 offset:25088
  v_add_f32 v26, v26, v22
  v_mfma_f32_16x16x32_bf16 v[80:83], a[152:155], a[0:3], v[80:83]
  s_waitcnt lgkmcnt(8)
  v_add_f32 v27, v27, v23
  v_accvgpr_read_b32 v22, a218
  v_mfma_f32_16x16x32_bf16 v[96:99], a[160:163], a[0:3], v[96:99]
  ds_read_b64_tr_b16 a[144:145], v1 offset:14368
  v_accvgpr_read_b32 v23, a219
  v_mfma_f32_16x16x32_bf16 v[96:99], a[164:167], a[16:19], v[96:99]
  v_max3_u32 v31, v31, v22, v23
  v_add_f32 v28, v28, v22
  v_mfma_f32_16x16x32_bf16 v[100:103], a[164:167], a[20:23], v[100:103]
  buffer_load_dwordx4 a[104:107], v0, s[36:39], s57 offen offset:2048 sc1
  v_add_f32 v29, v29, v23
  v_mfma_f32_16x16x32_bf16 v[100:103], a[160:163], a[4:7], v[100:103]
  ds_read_b64_tr_b16 a[146:147], v1 offset:17952
  v_accvgpr_read_b32 v22, a220
  v_mfma_f32_16x16x32_bf16 v[104:107], a[160:163], a[8:11], v[104:107]
  ds_read_b64_tr_b16 a[148:149], v1 offset:21536
  v_accvgpr_read_b32 v23, a221
  v_mfma_f32_16x16x32_bf16 v[104:107], a[164:167], a[24:27], v[104:107]
  v_max3_u32 v31, v31, v22, v23
  v_add_f32 v26, v26, v22
  v_mfma_f32_16x16x32_bf16 v[108:111], a[164:167], a[28:31], v[108:111]
  ds_read_b64_tr_b16 a[150:151], v1 offset:25120
  v_add_f32 v27, v27, v23
  v_mfma_f32_16x16x32_bf16 v[108:111], a[160:163], a[12:15], v[108:111]
  buffer_load_dwordx4 v5, s[16:19], s56 offen offset:2048 lds
  v_accvgpr_read_b32 v22, a222
  v_mfma_f32_16x16x32_bf16 v[124:127], a[168:171], a[12:15], v[124:127]
  ds_read_b64_tr_b16 a[152:153], v1 offset:14400
  v_accvgpr_read_b32 v23, a223
  v_mfma_f32_16x16x32_bf16 v[124:127], a[172:175], a[28:31], v[124:127]
  v_max3_u32 v31, v31, v22, v23
  v_add_f32 v28, v28, v22
  v_mfma_f32_16x16x32_bf16 v[120:123], a[172:175], a[24:27], v[120:123]
  ds_read_b64_tr_b16 a[154:155], v1 offset:17984
  v_add_f32 v29, v29, v23
  v_mfma_f32_16x16x32_bf16 v[120:123], a[168:171], a[8:11], v[120:123]
  v_cmp_eq_u32 vcc, -1, v31
  s_nop 4
  s_cbranch_vccnz CK6s
CK6x:
  v_mfma_f32_16x16x32_bf16 v[116:119], a[168:171], a[4:7], v[116:119]
  s_nop 0
  buffer_load_dwordx4 a[108:111], v0, s[36:39], s57 offen offset:3072 sc1
  v_permlane32_swap_b32 v26, v28
  v_mfma_f32_16x16x32_bf16 v[116:119], a[172:175], a[20:23], v[116:119]
  ds_read_b64_tr_b16 a[156:157], v1 offset:21568
  v_permlane32_swap_b32 v27, v29
  v_mfma_f32_16x16x32_bf16 v[112:115], a[172:175], a[16:19], v[112:115]
  ds_read_b64_tr_b16 a[158:159], v1 offset:25152
  v_add_f32 v26, v26, v28
  v_mfma_f32_16x16x32_bf16 v[112:115], a[168:171], a[0:3], v[112:115]
  s_waitcnt lgkmcnt(8)
  v_add_f32 v27, v27, v29
  v_cvt_pk_bf16_f32 v25, v26, v26
  v_mfma_f32_16x16x32_bf16 v[128:131], a[128:131], a[0:3], v[128:131]
  ds_read_b64_tr_b16 a[160:161], v1 offset:14432
  v_lshlrev_b32 v25, 16, v25
  v_mfma_f32_16x16x32_bf16 v[128:131], a[132:135], a[16:19], v[128:131]
  buffer_load_dwordx4 v6, s[16:19], s56 offen offset:3072 lds
  s_add_u32 s57, s57, 4096
  v_mfma_f32_16x16x32_bf16 v[132:135], a[132:135], a[20:23], v[132:135]
  ds_read_b64_tr_b16 a[162:163], v1 offset:18016
  v_sub_f32 v30, v26, v25
  v_mfma_f32_16x16x32_bf16 v[132:135], a[128:131], a[4:7], v[132:135]
  v_cvt_pk_bf16_f32 v22, v26, v30
  v_and_b32 v25, 0xffff0000, v22
  v_mfma_f32_16x16x32_bf16 v[136:139], a[128:131], a[8:11], v[136:139]
  ds_read_b64_tr_b16 a[164:165], v1 offset:21600
  v_sub_f32 v30, v30, v25
  v_mfma_f32_16x16x32_bf16 v[136:139], a[132:135], a[24:27], v[136:139]
  v_cvt_pk_bf16_f32 v23, v30, 0
  v_mfma_f32_16x16x32_bf16 v[140:143], a[132:135], a[28:31], v[140:143]
  buffer_load_dwordx4 a[112:115], v0, s[36:39], s57 offen offset:0 sc1
  s_add_u32 m0, s77, 90112
  v_mfma_f32_16x16x32_bf16 v[140:143], a[128:131], a[12:15], v[140:143]
  ds_read_b64_tr_b16 a[166:167], v1 offset:25184
  v_mfma_f32_16x16x32_bf16 v[156:159], a[136:139], a[12:15], v[156:159]
  ds_read_b64_tr_b16 a[168:169], v1 offset:14464
  v_mfma_f32_16x16x32_bf16 v[156:159], a[140:143], a[28:31], v[156:159]
  ds_write_b64 v24, v[22:23] offset:0
  v_cvt_pk_bf16_f32 v25, v27, v27
  v_mfma_f32_16x16x32_bf16 v[152:155], a[140:143], a[24:27], v[152:155]
  ds_read_b64_tr_b16 a[170:171], v1 offset:18048
  v_lshlrev_b32 v25, 16, v25
  v_mfma_f32_16x16x32_bf16 v[152:155], a[136:139], a[8:11], v[152:155]
  buffer_load_dwordx4 v7, s[16:19], s56 offen offset:0 lds
  v_sub_f32 v30, v27, v25
  v_mfma_f32_16x16x32_bf16 v[148:151], a[136:139], a[4:7], v[148:151]
  ds_read_b64_tr_b16 a[172:173], v1 offset:21632
  v_cvt_pk_bf16_f32 v28, v27, v30
  v_mfma_f32_16x16x32_bf16 v[148:151], a[140:143], a[20:23], v[148:151]
  v_and_b32 v25, 0xffff0000, v28
  v_sub_f32 v30, v30, v25
  v_mfma_f32_16x16x32_bf16 v[144:147], a[140:143], a[16:19], v[144:147]
  ds_read_b64_tr_b16 a[174:175], v1 offset:25216
  v_cvt_pk_bf16_f32 v29, v30, 0
  v_mfma_f32_16x16x32_bf16 v[144:147], a[136:139], a[0:3], v[144:147]
  s_waitcnt lgkmcnt(9)
  ds_write_b64 v24, v[28:29] offset:16
  s_waitcnt lgkmcnt(0)
  v_mfma_f32_16x16x32_bf16 v[160:163], a[144:147], a[0:3], v[160:163]
  buffer_load_dwordx4 a[116:119], v0, s[36:39], s57 offen offset:1024 sc1
  v_mfma_f32_16x16x32_bf16 v[160:163], a[148:151], a[16:19], v[160:163]
  s_lshl_b32 s68, s44, 8
  ds_read_b64_tr_b16 a[128:129], v1 offset:14496
  s_add_u32 s68, s68, s2
  v_mfma_f32_16x16x32_bf16 v[164:167], a[148:151], a[20:23], v[164:167]
  s_mul_i32 s68, s68, 7168
  ds_read_b64_tr_b16 a[130:131], v1 offset:18080
  v_mfma_f32_16x16x32_bf16 v[164:167], a[144:147], a[4:7], v[164:167]
  v_mfma_f32_16x16x32_bf16 v[168:171], a[144:147], a[8:11], v[168:171]
  ds_read_b64_tr_b16 a[132:133], v1 offset:21664
  v_mfma_f32_16x16x32_bf16 v[168:171], a[148:151], a[24:27], v[168:171]
  buffer_load_dwordx4 v8, s[16:19], s56 offen offset:1024 lds
  v_mfma_f32_16x16x32_bf16 v[172:175], a[148:151], a[28:31], v[172:175]
  ds_read_b64_tr_b16 a[134:135], v1 offset:25248
  v_mfma_f32_16x16x32_bf16 v[172:175], a[144:147], a[12:15], v[172:175]
  v_mfma_f32_16x16x32_bf16 v[188:191], a[152:155], a[12:15], v[188:191]
  ds_read_b64_tr_b16 a[136:137], v1 offset:14528
  v_mfma_f32_16x16x32_bf16 v[188:191], a[156:159], a[28:31], v[188:191]
  v_mfma_f32_16x16x32_bf16 v[184:187], a[156:159], a[24:27], v[184:187]
  buffer_load_dwordx4 a[120:123], v0, s[36:39], s57 offen offset:2048 sc1
  v_mfma_f32_16x16x32_bf16 v[184:187], a[152:155], a[8:11], v[184:187]
  ds_read_b64_tr_b16 a[138:139], v1 offset:18112
  v_mfma_f32_16x16x32_bf16 v[180:183], a[152:155], a[4:7], v[180:183]
  ds_read_b64_tr_b16 a[140:141], v1 offset:21696
  v_mfma_f32_16x16x32_bf16 v[180:183], a[156:159], a[20:23], v[180:183]
  v_mfma_f32_16x16x32_bf16 v[176:179], a[156:159], a[16:19], v[176:179]
  ds_read_b64_tr_b16 a[142:143], v1 offset:25280
  v_mfma_f32_16x16x32_bf16 v[176:179], a[152:155], a[0:3], v[176:179]
  s_waitcnt lgkmcnt(9)
  buffer_load_dwordx4 v9, s[16:19], s56 offen offset:2048 lds
  v_mfma_f32_16x16x32_bf16 v[192:195], a[160:163], a[0:3], v[192:195]
  ds_read_b64_tr_b16 a[144:145], v1 offset:28864
  v_mfma_f32_16x16x32_bf16 v[192:195], a[164:167], a[16:19], v[192:195]
  v_mfma_f32_16x16x32_bf16 v[196:199], a[164:167], a[20:23], v[196:199]
  ds_read_b64_tr_b16 a[146:147], v1 offset:32448
  v_mfma_f32_16x16x32_bf16 v[196:199], a[160:163], a[4:7], v[196:199]
  v_mfma_f32_16x16x32_bf16 v[200:203], a[160:163], a[8:11], v[200:203]
  buffer_load_dwordx4 a[124:127], v0, s[36:39], s57 offen offset:3072 sc1
  v_mfma_f32_16x16x32_bf16 v[200:203], a[164:167], a[24:27], v[200:203]
  ds_read_b64_tr_b16 a[148:149], v1 offset:36032
  v_mfma_f32_16x16x32_bf16 v[204:207], a[164:167], a[28:31], v[204:207]
  ds_read_b64_tr_b16 a[150:151], v1 offset:39616
  v_mfma_f32_16x16x32_bf16 v[204:207], a[160:163], a[12:15], v[204:207]
  s_waitcnt vmcnt(16)
  s_barrier
  v_mfma_f32_16x16x32_bf16 v[220:223], a[168:171], a[12:15], v[220:223]
  ds_read_b64_tr_b16 a[152:153], v1 offset:43200
  v_mfma_f32_16x16x32_bf16 v[220:223], a[172:175], a[28:31], v[220:223]
  v_mfma_f32_16x16x32_bf16 v[216:219], a[172:175], a[24:27], v[216:219]
  ds_read_b64_tr_b16 a[154:155], v1 offset:46784
  v_mfma_f32_16x16x32_bf16 v[216:219], a[168:171], a[8:11], v[216:219]
  v_mfma_f32_16x16x32_bf16 v[212:215], a[168:171], a[4:7], v[212:215]
  ds_read_b64_tr_b16 a[156:157], v1 offset:50368
  v_mfma_f32_16x16x32_bf16 v[212:215], a[172:175], a[20:23], v[212:215]
  v_mfma_f32_16x16x32_bf16 v[208:211], a[172:175], a[16:19], v[208:211]
  ds_read_b64_tr_b16 a[158:159], v1 offset:53952
  v_mfma_f32_16x16x32_bf16 v[208:211], a[168:171], a[0:3], v[208:211]
  s_waitcnt lgkmcnt(8)
  v_mfma_f32_16x16x32_bf16 v[224:227], a[128:131], a[0:3], v[224:227]
  ds_read_b64_tr_b16 a[160:161], v2 offset:192
  v_mfma_f32_16x16x32_bf16 v[224:227], a[132:135], a[16:19], v[224:227]
  v_mfma_f32_16x16x32_bf16 v[228:231], a[132:135], a[20:23], v[228:231]
  ds_read_b64_tr_b16 a[162:163], v2 offset:3776
  v_mfma_f32_16x16x32_bf16 v[228:231], a[128:131], a[4:7], v[228:231]
  v_mfma_f32_16x16x32_bf16 v[232:235], a[128:131], a[8:11], v[232:235]
  ds_read_b64_tr_b16 a[164:165], v2 offset:7360
  v_mfma_f32_16x16x32_bf16 v[232:235], a[132:135], a[24:27], v[232:235]
  v_mfma_f32_16x16x32_bf16 v[236:239], a[132:135], a[28:31], v[236:239]
  ds_read_b64_tr_b16 a[166:167], v2 offset:10944
  v_mfma_f32_16x16x32_bf16 v[236:239], a[128:131], a[12:15], v[236:239]
  v_mfma_f32_16x16x32_bf16 v[252:255], a[136:139], a[12:15], v[252:255]
  ds_read_b64_tr_b16 a[168:169], v2 offset:14528
  v_mfma_f32_16x16x32_bf16 v[252:255], a[140:143], a[28:31], v[252:255]
  v_mfma_f32_16x16x32_bf16 v[248:251], a[140:143], a[24:27], v[248:251]
  ds_read_b64_tr_b16 a[170:171], v2 offset:18112
  v_mfma_f32_16x16x32_bf16 v[248:251], a[136:139], a[8:11], v[248:251]
  v_mfma_f32_16x16x32_bf16 v[244:247], a[136:139], a[4:7], v[244:247]
  ds_read_b64_tr_b16 a[172:173], v2 offset:21696
  v_mfma_f32_16x16x32_bf16 v[244:247], a[140:143], a[20:23], v[244:247]
Hb2_1:
  s_cbranch_execz Hb2_2
  v_mfma_f32_16x16x32_bf16 v[240:243], a[140:143], a[16:19], v[240:243]
  ds_read_b64_tr_b16 a[174:175], v2 offset:25280
  v_mfma_f32_16x16x32_bf16 v[240:243], a[136:139], a[0:3], v[240:243]
  s_waitcnt vmcnt(1) lgkmcnt(8)
  s_barrier
  v_mfma_f32_16x16x32_bf16 v[128:131], a[144:147], a[32:35], v[128:131]
  v_and_b32 v31, 0xf0, v0
  v_add_u32 v31, 159744, v31
  v_mfma_f32_16x16x32_bf16 v[128:131], a[148:151], a[48:51], v[128:131]
  s_barrier
  v_cmp_gt_u32 vcc, 0x100, v0
  s_mov_b32 s78, 0x01000100
  v_mfma_f32_16x16x32_bf16 v[132:135], a[148:151], a[52:55], v[132:135]
  s_mov_b32 s79, 0x03020302
  v_cndmask_b32 v12, 0, v12, vcc
  v_perm_b32 v22, v12, v12, s78
  v_mfma_f32_16x16x32_bf16 v[132:135], a[144:147], a[36:39], v[132:135]
  v_min_u32 v3, 880, v0
  v_lshlrev_b32 v3, 3, v3
  v_mfma_f32_16x16x32_bf16 v[136:139], a[144:147], a[40:43], v[136:139]
  buffer_load_dword a252, v3, s[24:27], s68 offen
  v_and_b32 v23, 0xffff, v12
  v_mfma_f32_16x16x32_bf16 v[136:139], a[148:151], a[56:59], v[136:139]
  v_perm_b32 v24, v12, v12, s79
  v_lshrrev_b32 v25, 16, v12
  v_mfma_f32_16x16x32_bf16 v[140:143], a[148:151], a[60:63], v[140:143]
  v_accvgpr_write_b32 a0, v22
  v_accvgpr_write_b32 a1, v23
  v_mfma_f32_16x16x32_bf16 v[140:143], a[144:147], a[44:47], v[140:143]
  v_accvgpr_write_b32 a2, v24
  v_accvgpr_write_b32 a3, v25
  v_mfma_f32_16x16x32_bf16 v[252:255], a[152:155], a[44:47], v[252:255]
  ds_read_b64_tr_b16 a[128:129], v2 offset:28864
  v_cndmask_b32 v15, 0, v15, vcc
  v_mfma_f32_16x16x32_bf16 v[252:255], a[156:159], a[60:63], v[252:255]
  v_perm_b32 v26, v15, v15, s78
  v_and_b32 v27, 0xffff, v15
  v_mfma_f32_16x16x32_bf16 v[248:251], a[156:159], a[56:59], v[248:251]
  ds_read_b64_tr_b16 a[130:131], v2 offset:32448
  v_perm_b32 v28, v15, v15, s79
  v_mfma_f32_16x16x32_bf16 v[248:251], a[152:155], a[40:43], v[248:251]
  v_lshrrev_b32 v29, 16, v15
  v_accvgpr_write_b32 a4, v26
  v_mfma_f32_16x16x32_bf16 v[244:247], a[152:155], a[36:39], v[244:247]
  ds_read_b64_tr_b16 a[132:133], v2 offset:36032
  v_accvgpr_write_b32 a5, v27
  v_mfma_f32_16x16x32_bf16 v[244:247], a[156:159], a[52:55], v[244:247]
  ds_read_b128 a[16:19], v31 offset:1536
  v_accvgpr_write_b32 a6, v28
  v_mfma_f32_16x16x32_bf16 v[240:243], a[156:159], a[48:51], v[240:243]
  ds_read_b128 a[20:23], v31 offset:3584
  v_accvgpr_write_b32 a7, v29
  v_mfma_f32_16x16x32_bf16 v[240:243], a[152:155], a[32:35], v[240:243]
  s_waitcnt vmcnt(16) lgkmcnt(5)
  ds_read_b64_tr_b16 a[134:135], v2 offset:39616
  v_cndmask_b32 v18, 0, v18, vcc
  v_mfma_f32_16x16x32_bf16 v[128:131], a[160:163], a[64:67], v[128:131]
  ds_read_b64_tr_b16 a[136:137], v2 offset:43200
  v_perm_b32 v22, v18, v18, s78
  v_mfma_f32_16x16x32_bf16 v[128:131], a[164:167], a[80:83], v[128:131]
  v_and_b32 v23, 0xffff, v18
  v_perm_b32 v24, v18, v18, s79
  v_mfma_f32_16x16x32_bf16 v[132:135], a[164:167], a[84:87], v[132:135]
  ds_read_b64_tr_b16 a[138:139], v2 offset:46784
  v_lshrrev_b32 v25, 16, v18
  v_mfma_f32_16x16x32_bf16 v[132:135], a[160:163], a[68:71], v[132:135]
  v_accvgpr_write_b32 a8, v22
  v_accvgpr_write_b32 a9, v23
  v_mfma_f32_16x16x32_bf16 v[136:139], a[160:163], a[72:75], v[136:139]
  ds_read_b64_tr_b16 a[140:141], v2 offset:50368
  v_accvgpr_write_b32 a10, v24
  v_mfma_f32_16x16x32_bf16 v[136:139], a[164:167], a[88:91], v[136:139]
  v_accvgpr_write_b32 a11, v25
  v_cndmask_b32 v21, 0, v21, vcc
  v_mfma_f32_16x16x32_bf16 v[140:143], a[164:167], a[92:95], v[140:143]
  ds_read_b64_tr_b16 a[142:143], v2 offset:53952
  v_perm_b32 v26, v21, v21, s78
  v_mfma_f32_16x16x32_bf16 v[140:143], a[160:163], a[76:79], v[140:143]
  v_and_b32 v27, 0xffff, v21
  v_perm_b32 v28, v21, v21, s79
  v_mfma_f32_16x16x32_bf16 v[252:255], a[168:171], a[76:79], v[252:255]
  ds_read_b64_tr_b16 a[144:145], v1 offset:28672
  v_lshrrev_b32 v29, 16, v21
  v_mfma_f32_16x16x32_bf16 v[252:255], a[172:175], a[92:95], v[252:255]
  v_accvgpr_write_b32 a12, v26
  v_accvgpr_write_b32 a13, v27
  v_mfma_f32_16x16x32_bf16 v[248:251], a[172:175], a[88:91], v[248:251]
  ds_read_b64_tr_b16 a[146:147], v1 offset:32256
  v_accvgpr_write_b32 a14, v28
  v_mfma_f32_16x16x32_bf16 v[248:251], a[168:171], a[72:75], v[248:251]
  v_accvgpr_write_b32 a15, v29
  v_mfma_f32_16x16x32_bf16 v[244:247], a[168:171], a[68:71], v[244:247]
  ds_read_b64_tr_b16 a[148:149], v1 offset:35840
  v_mfma_f32_16x16x32_bf16 v[244:247], a[172:175], a[84:87], v[244:247]
  v_mfma_f32_16x16x32_bf16 v[240:243], a[172:175], a[80:83], v[240:243]
  ds_read_b64_tr_b16 a[150:151], v1 offset:39424
  v_mfma_f32_16x16x32_bf16 v[240:243], a[168:171], a[64:67], v[240:243]
  s_waitcnt lgkmcnt(9)
  v_mfma_f32_16x16x32_bf16 v[128:131], a[16:19], a[0:3], v[128:131]
  v_mfma_f32_16x16x32_bf16 v[132:135], a[16:19], a[4:7], v[132:135]
  v_mfma_f32_16x16x32_bf16 v[136:139], a[16:19], a[8:11], v[136:139]
  v_mfma_f32_16x16x32_bf16 v[140:143], a[16:19], a[12:15], v[140:143]
  v_mfma_f32_16x16x32_bf16 v[240:243], a[20:23], a[0:3], v[240:243]
  v_mfma_f32_16x16x32_bf16 v[244:247], a[20:23], a[4:7], v[244:247]
  v_mfma_f32_16x16x32_bf16 v[248:251], a[20:23], a[8:11], v[248:251]
  v_mfma_f32_16x16x32_bf16 v[252:255], a[20:23], a[12:15], v[252:255]
  s_waitcnt vmcnt(1) lgkmcnt(4)
  v_mfma_f32_16x16x32_bf16 v[128:131], a[128:131], a[96:99], v[128:131]
  ds_read_b128 a[24:27], v31 offset:0
  v_mfma_f32_16x16x32_bf16 v[128:131], a[132:135], a[112:115], v[128:131]
  ds_read_b64_tr_b16 a[152:153], v1 offset:43008
  v_mfma_f32_16x16x32_bf16 v[132:135], a[132:135], a[116:119], v[132:135]
  ds_read_b128 a[28:31], v31 offset:2048
  v_mfma_f32_16x16x32_bf16 v[132:135], a[128:131], a[100:103], v[132:135]
  ds_read_b64_tr_b16 a[154:155], v1 offset:46592
  v_mfma_f32_16x16x32_bf16 v[136:139], a[128:131], a[104:107], v[136:139]
  ds_read_b64_tr_b16 a[156:157], v1 offset:50176
  v_mfma_f32_16x16x32_bf16 v[136:139], a[132:135], a[120:123], v[136:139]
  v_mfma_f32_16x16x32_bf16 v[140:143], a[132:135], a[124:127], v[140:143]
  ds_read_b64_tr_b16 a[158:159], v1 offset:53760
  v_mfma_f32_16x16x32_bf16 v[140:143], a[128:131], a[108:111], v[140:143]
  v_mfma_f32_16x16x32_bf16 v[252:255], a[136:139], a[108:111], v[252:255]
  ds_read_b64_tr_b16 a[160:161], v2 offset:0
  v_mul_f32 v22, v10, v128
  v_mul_f32 v23, v10, v129
  v_mul_f32 v24, v10, v130
  v_mfma_f32_16x16x32_bf16 v[252:255], a[140:143], a[124:127], v[252:255]
  v_mul_f32 v25, v10, v131
  v_exp_f32 v22, v22
  v_mul_f32 v26, v13, v132
  v_mfma_f32_16x16x32_bf16 v[248:251], a[140:143], a[120:123], v[248:251]
  ds_read_b64_tr_b16 a[162:163], v2 offset:3584
  v_exp_f32 v23, v23
  v_mul_f32 v27, v13, v133
  v_mfma_f32_16x16x32_bf16 v[248:251], a[136:139], a[104:107], v[248:251]
  v_exp_f32 v24, v24
  v_mul_f32 v28, v13, v134
  v_mfma_f32_16x16x32_bf16 v[244:247], a[136:139], a[100:103], v[244:247]
  ds_read_b64_tr_b16 a[164:165], v2 offset:7168
  v_exp_f32 v25, v25
  v_mul_f32 v29, v13, v135
  v_mfma_f32_16x16x32_bf16 v[244:247], a[140:143], a[116:119], v[244:247]
  v_exp_f32 v26, v26
  v_fma_f32 v22, v22, v11, v11
  v_mfma_f32_16x16x32_bf16 v[240:243], a[140:143], a[112:115], v[240:243]
  ds_read_b64_tr_b16 a[166:167], v2 offset:10752
  v_exp_f32 v27, v27
  v_fma_f32 v23, v23, v11, v11
  v_mfma_f32_16x16x32_bf16 v[240:243], a[136:139], a[96:99], v[240:243]
  s_waitcnt lgkmcnt(4)
  v_exp_f32 v28, v28
  v_fma_f32 v24, v24, v11, v11
  v_mfma_f32_16x16x32_bf16 v[32:35], a[144:147], a[32:35], v[32:35]
  ds_read_b64_tr_b16 a[168:169], v2 offset:14336
  v_exp_f32 v29, v29
  v_fma_f32 v25, v25, v11, v11
  v_mfma_f32_16x16x32_bf16 v[32:35], a[148:151], a[48:51], v[32:35]
  v_rcp_f32 v22, v22
  v_fma_f32 v26, v26, v14, v14
  v_mfma_f32_16x16x32_bf16 v[36:39], a[148:151], a[52:55], v[36:39]
  ds_read_b64_tr_b16 a[170:171], v2 offset:17920
  v_rcp_f32 v23, v23
  v_fma_f32 v27, v27, v14, v14
  v_mfma_f32_16x16x32_bf16 v[36:39], a[144:147], a[36:39], v[36:39]
  v_rcp_f32 v24, v24
  v_fma_f32 v28, v28, v14, v14
  v_mfma_f32_16x16x32_bf16 v[40:43], a[144:147], a[40:43], v[40:43]
  ds_read_b64_tr_b16 a[172:173], v2 offset:21504
  v_rcp_f32 v25, v25
  v_fma_f32 v29, v29, v14, v14
  v_mfma_f32_16x16x32_bf16 v[40:43], a[148:151], a[56:59], v[40:43]
  v_rcp_f32 v26, v26
  v_mul_f32 v240, v128, v240
  v_mfma_f32_16x16x32_bf16 v[44:47], a[148:151], a[60:63], v[44:47]
  ds_read_b64_tr_b16 a[174:175], v2 offset:25088
  v_rcp_f32 v27, v27
  v_mul_f32 v241, v129, v241
  v_mfma_f32_16x16x32_bf16 v[44:47], a[144:147], a[44:47], v[44:47]
  s_waitcnt lgkmcnt(11)
  v_rcp_f32 v28, v28
  v_mul_f32 v242, v130, v242
  v_mfma_f32_16x16x32_bf16 v[32:35], a[24:27], a[0:3], v[32:35]
  ds_read_b64_tr_b16 a[128:129], v2 offset:28672
  v_rcp_f32 v29, v29
  v_mul_f32 v243, v131, v243
  v_mfma_f32_16x16x32_bf16 v[36:39], a[24:27], a[4:7], v[36:39]
  v_mul_f32 v240, v240, v22
  v_mul_f32 v241, v241, v23
  v_mul_f32 v242, v242, v24
  v_mul_f32 v243, v243, v25
  v_mfma_f32_16x16x32_bf16 v[40:43], a[24:27], a[8:11], v[40:43]
  ds_read_b64_tr_b16 a[130:131], v2 offset:32256
  v_mul_f32 v22, v16, v136
  v_mul_f32 v23, v16, v137
  v_mul_f32 v24, v16, v138
  v_mfma_f32_16x16x32_bf16 v[44:47], a[24:27], a[12:15], v[44:47]
  v_mul_f32 v25, v16, v139
  v_exp_f32 v22, v22
  v_mul_f32 v244, v132, v244
  v_mfma_f32_16x16x32_bf16 v[144:147], a[28:31], a[0:3], v[144:147]
  ds_read_b64_tr_b16 a[132:133], v2 offset:35840
  v_exp_f32 v23, v23
  v_mul_f32 v245, v133, v245
  v_mfma_f32_16x16x32_bf16 v[148:151], a[28:31], a[4:7], v[148:151]
  v_exp_f32 v24, v24
  v_mul_f32 v246, v134, v246
  v_mfma_f32_16x16x32_bf16 v[152:155], a[28:31], a[8:11], v[152:155]
  ds_read_b64_tr_b16 a[134:135], v2 offset:39424
  v_exp_f32 v25, v25
  v_mul_f32 v247, v135, v247
  v_mfma_f32_16x16x32_bf16 v[156:159], a[28:31], a[12:15], v[156:159]
  v_mul_f32 v244, v244, v26
  v_mul_f32 v245, v245, v27
  v_mul_f32 v246, v246, v28
  v_mul_f32 v247, v247, v29
  v_mfma_f32_16x16x32_bf16 v[156:159], a[152:155], a[44:47], v[156:159]
  ds_read_b64_tr_b16 a[136:137], v2 offset:43008
  v_cvt_pk_bf16_f32 v128, v240, v241
  v_cvt_pk_bf16_f32 v129, v242, v243
  v_mfma_f32_16x16x32_bf16 v[156:159], a[156:159], a[60:63], v[156:159]
  buffer_store_dwordx2 v[128:129], v0, s[36:39], s65 offen offset:0 sc1
  v_mul_f32 v26, v19, v140
  v_mul_f32 v27, v19, v141
  v_mul_f32 v28, v19, v142
  v_mfma_f32_16x16x32_bf16 v[152:155], a[156:159], a[56:59], v[152:155]
  ds_read_b64_tr_b16 a[138:139], v2 offset:46592
  v_mul_f32 v29, v19, v143
  v_exp_f32 v26, v26
  v_mfma_f32_16x16x32_bf16 v[152:155], a[152:155], a[40:43], v[152:155]
  v_fma_f32 v22, v22, v17, v17
  v_exp_f32 v27, v27
  v_fma_f32 v23, v23, v17, v17
  v_mfma_f32_16x16x32_bf16 v[148:151], a[152:155], a[36:39], v[148:151]
  ds_read_b64_tr_b16 a[140:141], v2 offset:50176
  v_exp_f32 v28, v28
  v_fma_f32 v24, v24, v17, v17
  v_mfma_f32_16x16x32_bf16 v[148:151], a[156:159], a[52:55], v[148:151]
  v_exp_f32 v29, v29
  v_fma_f32 v25, v25, v17, v17
  v_cvt_pk_bf16_f32 v132, v244, v245
  v_mfma_f32_16x16x32_bf16 v[144:147], a[156:159], a[48:51], v[144:147]
  ds_read_b64_tr_b16 a[142:143], v2 offset:53760
  v_cvt_pk_bf16_f32 v133, v246, v247
  v_mfma_f32_16x16x32_bf16 v[144:147], a[152:155], a[32:35], v[144:147]
  s_waitcnt lgkmcnt(8)
  buffer_store_dwordx2 v[132:133], v0, s[36:39], s65 offen offset:1024 sc1
  v_rcp_f32 v22, v22
  v_fma_f32 v26, v26, v20, v20
  v_mfma_f32_16x16x32_bf16 v[32:35], a[160:163], a[64:67], v[32:35]
  ds_read_b64_tr_b16 a[144:145], v1 offset:28704
  v_rcp_f32 v23, v23
  v_fma_f32 v27, v27, v20, v20
  v_mfma_f32_16x16x32_bf16 v[32:35], a[164:167], a[80:83], v[32:35]
  v_rcp_f32 v24, v24
  v_fma_f32 v28, v28, v20, v20
  v_mfma_f32_16x16x32_bf16 v[36:39], a[164:167], a[84:87], v[36:39]
  ds_read_b64_tr_b16 a[146:147], v1 offset:32288
  v_rcp_f32 v25, v25
  v_fma_f32 v29, v29, v20, v20
  v_mfma_f32_16x16x32_bf16 v[36:39], a[160:163], a[68:71], v[36:39]
  v_rcp_f32 v26, v26
  v_mul_f32 v248, v136, v248
  v_mfma_f32_16x16x32_bf16 v[40:43], a[160:163], a[72:75], v[40:43]
  ds_read_b64_tr_b16 a[148:149], v1 offset:35872
  v_rcp_f32 v27, v27
  v_mul_f32 v249, v137, v249
  v_mfma_f32_16x16x32_bf16 v[40:43], a[164:167], a[88:91], v[40:43]
  v_rcp_f32 v28, v28
  v_mul_f32 v250, v138, v250
  v_mfma_f32_16x16x32_bf16 v[44:47], a[164:167], a[92:95], v[44:47]
  ds_read_b64_tr_b16 a[150:151], v1 offset:39456
  v_rcp_f32 v29, v29
  v_mul_f32 v251, v139, v251
  v_mfma_f32_16x16x32_bf16 v[44:47], a[160:163], a[76:79], v[44:47]
  v_mul_f32 v248, v248, v22
  v_mul_f32 v249, v249, v23
  v_mul_f32 v250, v250, v24
  v_mul_f32 v251, v251, v25
  v_mfma_f32_16x16x32_bf16 v[156:159], a[168:171], a[76:79], v[156:159]
  v_mul_f32 v252, v140, v252
  v_mul_f32 v253, v141, v253
  v_mul_f32 v254, v142, v254
  v_mul_f32 v255, v143, v255
  v_mfma_f32_16x16x32_bf16 v[156:159], a[172:175], a[92:95], v[156:159]
  v_cvt_pk_bf16_f32 v136, v248, v249
  v_cvt_pk_bf16_f32 v137, v250, v251
  v_mfma_f32_16x16x32_bf16 v[152:155], a[172:175], a[88:91], v[152:155]
  buffer_store_dwordx2 v[136:137], v0, s[36:39], s66 offen offset:0 sc1
  v_mul_f32 v252, v252, v26
  v_mul_f32 v253, v253, v27
  v_mul_f32 v254, v254, v28
  v_mfma_f32_16x16x32_bf16 v[152:155], a[168:171], a[72:75], v[152:155]
  v_mul_f32 v255, v255, v29
  v_cvt_pk_bf16_f32 v140, v252, v253
  v_cvt_pk_bf16_f32 v141, v254, v255
  v_mfma_f32_16x16x32_bf16 v[148:151], a[168:171], a[68:71], v[148:151]
  buffer_store_dwordx2 v[140:141], v0, s[36:39], s66 offen offset:1024 sc1
  s_mov_b32 s65, s67
  s_add_u32 s66, s67, 262144
  v_mfma_f32_16x16x32_bf16 v[148:151], a[172:175], a[84:87], v[148:151]
  v_lshrrev_b32 v128, 4, v0
  s_add_u32 s87, s52, s54
  s_and_b32 s87, s87, 3
  s_and_b32 s90, s2, 1
  v_mfma_f32_16x16x32_bf16 v[144:147], a[172:175], a[80:83], v[144:147]
  s_lshl_b32 s89, s53, 7
  s_lshl3_add_u32 s89, s70, s89
  s_mul_i32 s88, s90, 3670016
  s_add_u32 s89, s89, s88
  s_lshr_b32 s88, s44, 1
  v_mfma_f32_16x16x32_bf16 v[144:147], a[168:171], a[64:67], v[144:147]
  s_waitcnt lgkmcnt(4)
  s_mul_i32 s88, s88, 393216
  v_bfe_u32 v129, v128, 4, 2
  v_bfe_u32 v130, v128, 1, 2
  v_xor_b32 v129, v129, v130
  v_mfma_f32_16x16x32_bf16 v[32:35], a[128:131], a[96:99], v[32:35]
  ds_read_b128 a[16:19], v31 offset:256
  v_lshlrev_b32 v129, 5, v129
  v_and_b32 v130, 1, v128
  v_lshl_add_u32 v129, v130, 4, v129
  v_mfma_f32_16x16x32_bf16 v[32:35], a[132:135], a[112:115], v[32:35]
  ds_read_b64_tr_b16 a[152:153], v1 offset:43040
  v_lshrrev_b32 v130, 3, v128
  v_lshlrev_b32 v130, 11, v130
  s_sub_u32 s24, s24, 2048
  v_mfma_f32_16x16x32_bf16 v[36:39], a[132:135], a[116:119], v[36:39]
  s_subb_u32 s25, s25, 0
  s_mov_b32 s26, 7342080
  ds_read_b128 a[20:23], v31 offset:2304
  v_add3_u32 v129, v129, v130, s89
  v_add_u32 v133, 2048, v129
  v_mfma_f32_16x16x32_bf16 v[36:39], a[128:131], a[100:103], v[36:39]
  ds_read_b64_tr_b16 a[154:155], v1 offset:46624
  v_add_u32 v134, 17408, v129
  v_xor_b32 v135, 128, v129
  v_add_u32 v136, 15360, v135
  v_mfma_f32_16x16x32_bf16 v[40:43], a[128:131], a[104:107], v[40:43]
  ds_read_b64_tr_b16 a[156:157], v1 offset:50208
  v_and_b32 v129, 7, v128
  v_lshrrev_b32 v131, 4, v128
  v_xor_b32 v129, v129, v131
  v_mfma_f32_16x16x32_bf16 v[40:43], a[132:135], a[120:123], v[40:43]
  v_lshl_add_u32 v252, v129, 4, v130
  v_xor_b32 v253, 64, v252
  v_add_u32 v253, 16384, v253
  s_lshl2_add_u32 s89, s52, s44
  v_mfma_f32_16x16x32_bf16 v[44:47], a[132:135], a[124:127], v[44:47]
  s_lshl_b32 s89, s89, 18
  s_mul_i32 s91, s90, 114688
  s_add_u32 s89, s89, s91
  s_add_u32 s89, s89, 19922944
  ds_read_b64_tr_b16 a[158:159], v1 offset:53792
  v_mfma_f32_16x16x32_bf16 v[44:47], a[128:131], a[108:111], v[44:47]
  v_add_u32 v137, s89, v0
  v_bfe_u32 v129, v128, 3, 2
  v_lshlrev_b32 v129, 5, v129
  v_and_b32 v130, 3, v128
  v_mfma_f32_16x16x32_bf16 v[156:159], a[136:139], a[108:111], v[156:159]
  ds_read_b64_tr_b16 a[160:161], v2 offset:32
  v_lshl_add_u32 v129, v130, 3, v129
  v_lshrrev_b32 v130, 2, v128
  v_lshl_add_u32 v240, v130, 7, v129
  v_mfma_f32_16x16x32_bf16 v[156:159], a[140:143], a[124:127], v[156:159]
  v_xor_b32 v241, 32, v240
  v_xor_b32 v242, 64, v240
  v_xor_b32 v243, 96, v240
  v_xor_b32 v244, 65536, v240
  v_mfma_f32_16x16x32_bf16 v[152:155], a[140:143], a[120:123], v[152:155]
  ds_read_b64_tr_b16 a[162:163], v2 offset:3616
  v_xor_b32 v245, 65568, v240
  v_xor_b32 v246, 65600, v240
  v_xor_b32 v247, 65632, v240
  v_mfma_f32_16x16x32_bf16 v[152:155], a[136:139], a[104:107], v[152:155]
  v_xor_b32 v248, 131072, v240
  v_xor_b32 v249, 131104, v240
  v_xor_b32 v250, 131136, v240
  v_xor_b32 v251, 131168, v240
  v_mfma_f32_16x16x32_bf16 v[148:151], a[136:139], a[100:103], v[148:151]
  s_lshr_b32 s89, s52, 1
  s_lshl_b32 s89, s89, 5
  s_lshl2_add_u32 s89, s90, s89
  ds_read_b64_tr_b16 a[164:165], v2 offset:7200
  v_and_b32 v129, 3, v128
  v_mfma_f32_16x16x32_bf16 v[148:151], a[140:143], a[116:119], v[148:151]
  v_bfe_u32 v130, v128, 2, 2
  v_lshl_add_u32 v129, v129, 3, v130
  v_add_lshl_u32 v138, v129, s89, 7
  v_mov_b32 v254, s3
  v_mfma_f32_16x16x32_bf16 v[144:147], a[140:143], a[112:115], v[144:147]
  s_mov_b32 s91, 5406720
  ds_read_b64_tr_b16 a[166:167], v2 offset:10784
  v_mul_f32 v22, v10, v32
  v_mul_f32 v23, v10, v33
  v_mul_f32 v24, v10, v34
  v_mfma_f32_16x16x32_bf16 v[144:147], a[136:139], a[96:99], v[144:147]
  s_waitcnt lgkmcnt(4)
  v_mul_f32 v25, v10, v35
  v_exp_f32 v22, v22
  v_mul_f32 v26, v13, v36
  v_mfma_f32_16x16x32_bf16 v[48:51], a[144:147], a[32:35], v[48:51]
  ds_read_b64_tr_b16 a[168:169], v2 offset:14368
  v_exp_f32 v23, v23
  v_mul_f32 v27, v13, v37
  v_mfma_f32_16x16x32_bf16 v[48:51], a[148:151], a[48:51], v[48:51]
  v_exp_f32 v24, v24
  v_mul_f32 v28, v13, v38
  v_mfma_f32_16x16x32_bf16 v[52:55], a[148:151], a[52:55], v[52:55]
  ds_read_b64_tr_b16 a[170:171], v2 offset:17952
  v_exp_f32 v25, v25
  v_mul_f32 v29, v13, v39
  v_mfma_f32_16x16x32_bf16 v[52:55], a[144:147], a[36:39], v[52:55]
  v_exp_f32 v26, v26
  v_fma_f32 v22, v22, v11, v11
  v_mfma_f32_16x16x32_bf16 v[56:59], a[144:147], a[40:43], v[56:59]
  ds_read_b64_tr_b16 a[172:173], v2 offset:21536
  v_exp_f32 v27, v27
  v_fma_f32 v23, v23, v11, v11
  v_mfma_f32_16x16x32_bf16 v[56:59], a[148:151], a[56:59], v[56:59]
  v_exp_f32 v28, v28
  v_fma_f32 v24, v24, v11, v11
  v_mfma_f32_16x16x32_bf16 v[60:63], a[148:151], a[60:63], v[60:63]
  ds_read_b64_tr_b16 a[174:175], v2 offset:25120
  v_exp_f32 v29, v29
  v_fma_f32 v25, v25, v11, v11
  v_mfma_f32_16x16x32_bf16 v[60:63], a[144:147], a[44:47], v[60:63]
  s_waitcnt lgkmcnt(11)
  v_rcp_f32 v22, v22
  v_fma_f32 v26, v26, v14, v14
  v_mfma_f32_16x16x32_bf16 v[48:51], a[16:19], a[0:3], v[48:51]
  ds_read_b64_tr_b16 a[128:129], v2 offset:28704
  v_rcp_f32 v23, v23
  v_fma_f32 v27, v27, v14, v14
  v_mfma_f32_16x16x32_bf16 v[52:55], a[16:19], a[4:7], v[52:55]
  v_rcp_f32 v24, v24
  v_fma_f32 v28, v28, v14, v14
  v_mfma_f32_16x16x32_bf16 v[56:59], a[16:19], a[8:11], v[56:59]
  ds_read_b64_tr_b16 a[130:131], v2 offset:32288
  v_rcp_f32 v25, v25
  v_fma_f32 v29, v29, v14, v14
  v_mfma_f32_16x16x32_bf16 v[60:63], a[16:19], a[12:15], v[60:63]
  v_rcp_f32 v26, v26
  v_mul_f32 v144, v32, v144
  v_mfma_f32_16x16x32_bf16 v[160:163], a[20:23], a[0:3], v[160:163]
  ds_read_b64_tr_b16 a[132:133], v2 offset:35872
  v_rcp_f32 v27, v27
  v_mul_f32 v145, v33, v145
  v_mfma_f32_16x16x32_bf16 v[164:167], a[20:23], a[4:7], v[164:167]
  v_rcp_f32 v28, v28
  v_mul_f32 v146, v34, v146
  v_mfma_f32_16x16x32_bf16 v[168:171], a[20:23], a[8:11], v[168:171]
  ds_read_b64_tr_b16 a[134:135], v2 offset:39456
  v_rcp_f32 v29, v29
  v_mul_f32 v147, v35, v147
  v_mfma_f32_16x16x32_bf16 v[172:175], a[20:23], a[12:15], v[172:175]
  v_mul_f32 v144, v144, v22
  v_mul_f32 v145, v145, v23
  v_mul_f32 v146, v146, v24
  v_mul_f32 v147, v147, v25
  v_mfma_f32_16x16x32_bf16 v[172:175], a[152:155], a[44:47], v[172:175]
  ds_read_b64_tr_b16 a[136:137], v2 offset:43040
  v_mul_f32 v22, v16, v40
  v_mul_f32 v23, v16, v41
  v_mul_f32 v24, v16, v42
  v_mul_f32 v25, v16, v43
  v_mfma_f32_16x16x32_bf16 v[172:175], a[156:159], a[60:63], v[172:175]
  v_exp_f32 v22, v22
  v_mul_f32 v148, v36, v148
  v_mfma_f32_16x16x32_bf16 v[168:171], a[156:159], a[56:59], v[168:171]
  ds_read_b64_tr_b16 a[138:139], v2 offset:46624
  v_exp_f32 v23, v23
  v_mul_f32 v149, v37, v149
  v_mfma_f32_16x16x32_bf16 v[168:171], a[152:155], a[40:43], v[168:171]
  v_exp_f32 v24, v24
  v_mul_f32 v150, v38, v150
  v_mfma_f32_16x16x32_bf16 v[164:167], a[152:155], a[36:39], v[164:167]
  ds_read_b64_tr_b16 a[140:141], v2 offset:50208
  v_exp_f32 v25, v25
  v_mul_f32 v151, v39, v151
  v_mfma_f32_16x16x32_bf16 v[164:167], a[156:159], a[52:55], v[164:167]
  v_mul_f32 v148, v148, v26
  v_mul_f32 v149, v149, v27
  v_mul_f32 v150, v150, v28
  v_mul_f32 v151, v151, v29
  v_mfma_f32_16x16x32_bf16 v[160:163], a[156:159], a[48:51], v[160:163]
  ds_read_b64_tr_b16 a[142:143], v2 offset:53792
  v_cvt_pk_bf16_f32 v32, v144, v145
  v_cvt_pk_bf16_f32 v33, v146, v147
  v_mul_f32 v26, v19, v44
  v_mfma_f32_16x16x32_bf16 v[160:163], a[152:155], a[32:35], v[160:163]
  s_waitcnt lgkmcnt(8)
  v_mul_f32 v27, v19, v45
  v_mul_f32 v28, v19, v46
  v_mul_f32 v29, v19, v47
  v_mfma_f32_16x16x32_bf16 v[48:51], a[160:163], a[64:67], v[48:51]
  ds_read_b64_tr_b16 a[144:145], v1 offset:28736
  v_exp_f32 v26, v26
  v_fma_f32 v22, v22, v17, v17
  v_mfma_f32_16x16x32_bf16 v[48:51], a[164:167], a[80:83], v[48:51]
  v_exp_f32 v27, v27
  v_fma_f32 v23, v23, v17, v17
  v_mfma_f32_16x16x32_bf16 v[52:55], a[164:167], a[84:87], v[52:55]
  s_mov_b32 s69, 3
  s_lshl_b32 s50, s69, 16
  s_add_u32 m0, s70, 114688
  ds_read_b64_tr_b16 a[146:147], v1 offset:32320
  v_mfma_f32_16x16x32_bf16 v[52:55], a[160:163], a[68:71], v[52:55]
  v_exp_f32 v28, v28
  v_fma_f32 v24, v24, v17, v17
  v_mfma_f32_16x16x32_bf16 v[56:59], a[160:163], a[72:75], v[56:59]
  ds_read_b64_tr_b16 a[148:149], v1 offset:35904
  v_exp_f32 v29, v29
  v_fma_f32 v25, v25, v17, v17
  v_mfma_f32_16x16x32_bf16 v[56:59], a[164:167], a[88:91], v[56:59]
  v_cvt_pk_bf16_f32 v36, v148, v149
  v_cvt_pk_bf16_f32 v37, v150, v151
  v_rcp_f32 v22, v22
  v_mfma_f32_16x16x32_bf16 v[60:63], a[164:167], a[92:95], v[60:63]
  buffer_load_dwordx4 v133, s[24:27], s50 offen offset:0 lds
  v_fma_f32 v26, v26, v20, v20
  v_rcp_f32 v23, v23
  v_mfma_f32_16x16x32_bf16 v[60:63], a[160:163], a[76:79], v[60:63]
  ds_read_b64_tr_b16 a[150:151], v1 offset:39488
  v_fma_f32 v27, v27, v20, v20
  v_rcp_f32 v24, v24
  v_mfma_f32_16x16x32_bf16 v[172:175], a[168:171], a[76:79], v[172:175]
  v_fma_f32 v28, v28, v20, v20
  v_rcp_f32 v25, v25
  v_fma_f32 v29, v29, v20, v20
  v_mfma_f32_16x16x32_bf16 v[172:175], a[172:175], a[92:95], v[172:175]
  v_rcp_f32 v26, v26
  v_mul_f32 v152, v40, v152
  v_mfma_f32_16x16x32_bf16 v[168:171], a[172:175], a[88:91], v[168:171]
  v_rcp_f32 v27, v27
  v_mul_f32 v153, v41, v153
  v_mfma_f32_16x16x32_bf16 v[168:171], a[168:171], a[72:75], v[168:171]
  buffer_load_dwordx4 v134, s[24:27], s50 offen offset:1024 lds
  v_rcp_f32 v28, v28
  v_mul_f32 v154, v42, v154
  v_mfma_f32_16x16x32_bf16 v[164:167], a[168:171], a[68:71], v[164:167]
  v_rcp_f32 v29, v29
  v_mul_f32 v155, v43, v155
  v_mul_f32 v152, v152, v22
  v_mfma_f32_16x16x32_bf16 v[164:167], a[172:175], a[84:87], v[164:167]
  v_mul_f32 v153, v153, v23
  v_mul_f32 v154, v154, v24
  v_mul_f32 v155, v155, v25
  v_mul_f32 v156, v44, v156
  v_mfma_f32_16x16x32_bf16 v[160:163], a[172:175], a[80:83], v[160:163]
  v_mul_f32 v157, v45, v157
  v_mul_f32 v158, v46, v158
  v_mul_f32 v159, v47, v159
  v_cvt_pk_bf16_f32 v40, v152, v153
  v_mfma_f32_16x16x32_bf16 v[160:163], a[168:171], a[64:67], v[160:163]
  s_waitcnt lgkmcnt(4)
  v_cvt_pk_bf16_f32 v41, v154, v155
  v_mul_f32 v156, v156, v26
  v_mul_f32 v157, v157, v27
  v_mul_f32 v158, v158, v28
  v_mfma_f32_16x16x32_bf16 v[48:51], a[128:131], a[96:99], v[48:51]
  ds_read_b128 a[24:27], v31 offset:512
  v_mul_f32 v159, v159, v29
  v_cvt_pk_bf16_f32 v44, v156, v157
  v_cvt_pk_bf16_f32 v45, v158, v159
  v_mfma_f32_16x16x32_bf16 v[48:51], a[132:135], a[112:115], v[48:51]
  buffer_load_dwordx4 v135, s[24:27], s50 offen offset:2048 lds
  v_mfma_f32_16x16x32_bf16 v[52:55], a[132:135], a[116:119], v[52:55]
  ds_read_b64_tr_b16 a[152:153], v1 offset:43072
  v_mfma_f32_16x16x32_bf16 v[52:55], a[128:131], a[100:103], v[52:55]
  ds_read_b128 a[28:31], v31 offset:2560
  v_mfma_f32_16x16x32_bf16 v[56:59], a[128:131], a[104:107], v[56:59]
  ds_read_b64_tr_b16 a[154:155], v1 offset:46656
  v_mfma_f32_16x16x32_bf16 v[56:59], a[132:135], a[120:123], v[56:59]
  ds_read_b64_tr_b16 a[156:157], v1 offset:50240
  v_mfma_f32_16x16x32_bf16 v[60:63], a[132:135], a[124:127], v[60:63]
  buffer_load_dwordx4 v136, s[24:27], s50 offen offset:3072 lds
  s_cmp_eq_u32 s87, 1
  s_cselect_b32 s71, 38, 10
  s_lshl_b32 s50, s71, 16
  v_mfma_f32_16x16x32_bf16 v[60:63], a[128:131], a[108:111], v[60:63]
  s_add_u32 m0, s70, 131072
  ds_read_b64_tr_b16 a[158:159], v1 offset:53824
  v_mfma_f32_16x16x32_bf16 v[172:175], a[136:139], a[108:111], v[172:175]
  ds_read_b64_tr_b16 a[160:161], v2 offset:64
  v_mul_f32 v22, v10, v48
  v_mul_f32 v23, v10, v49
  v_mul_f32 v24, v10, v50
  v_mfma_f32_16x16x32_bf16 v[172:175], a[140:143], a[124:127], v[172:175]
  v_mul_f32 v25, v10, v51
  v_exp_f32 v22, v22
  v_mul_f32 v26, v13, v52
  v_mfma_f32_16x16x32_bf16 v[168:171], a[140:143], a[120:123], v[168:171]
  buffer_load_dwordx4 v133, s[24:27], s50 offen offset:0 lds
  v_exp_f32 v23, v23
  v_mul_f32 v27, v13, v53
  v_mfma_f32_16x16x32_bf16 v[168:171], a[136:139], a[104:107], v[168:171]
  ds_read_b64_tr_b16 a[162:163], v2 offset:3648
  v_exp_f32 v24, v24
  v_mul_f32 v28, v13, v54
  v_mfma_f32_16x16x32_bf16 v[164:167], a[136:139], a[100:103], v[164:167]
  ds_read_b64_tr_b16 a[164:165], v2 offset:7232
  v_exp_f32 v25, v25
  v_mul_f32 v29, v13, v55
  v_mfma_f32_16x16x32_bf16 v[164:167], a[140:143], a[116:119], v[164:167]
  v_exp_f32 v26, v26
  v_fma_f32 v22, v22, v11, v11
  v_mfma_f32_16x16x32_bf16 v[160:163], a[140:143], a[112:115], v[160:163]
  ds_read_b64_tr_b16 a[166:167], v2 offset:10816
  v_exp_f32 v27, v27
  v_fma_f32 v23, v23, v11, v11
  v_mfma_f32_16x16x32_bf16 v[160:163], a[136:139], a[96:99], v[160:163]
  s_waitcnt lgkmcnt(4)
  buffer_load_dwordx4 v134, s[24:27], s50 offen offset:1024 lds
  v_exp_f32 v28, v28
  v_fma_f32 v24, v24, v11, v11
  v_mfma_f32_16x16x32_bf16 v[64:67], a[144:147], a[32:35], v[64:67]
  ds_read_b64_tr_b16 a[168:169], v2 offset:14400
  v_exp_f32 v29, v29
  v_fma_f32 v25, v25, v11, v11
  v_mfma_f32_16x16x32_bf16 v[64:67], a[148:151], a[48:51], v[64:67]
  v_rcp_f32 v22, v22
  v_fma_f32 v26, v26, v14, v14
  v_mfma_f32_16x16x32_bf16 v[68:71], a[148:151], a[52:55], v[68:71]
  ds_read_b64_tr_b16 a[170:171], v2 offset:17984
  v_rcp_f32 v23, v23
  v_fma_f32 v27, v27, v14, v14
  v_mfma_f32_16x16x32_bf16 v[68:71], a[144:147], a[36:39], v[68:71]
  v_rcp_f32 v24, v24
  v_fma_f32 v28, v28, v14, v14
  v_mfma_f32_16x16x32_bf16 v[72:75], a[144:147], a[40:43], v[72:75]
  buffer_load_dwordx4 v135, s[24:27], s50 offen offset:2048 lds
  v_rcp_f32 v25, v25
  v_fma_f32 v29, v29, v14, v14
  v_mfma_f32_16x16x32_bf16 v[72:75], a[148:151], a[56:59], v[72:75]
Hb0_2:
  s_cbranch_execz Hb0_3
  ds_read_b64_tr_b16 a[172:173], v2 offset:21568
  v_rcp_f32 v26, v26
  v_mul_f32 v160, v48, v160
  v_mfma_f32_16x16x32_bf16 v[76:79], a[148:151], a[60:63], v[76:79]
  ds_read_b64_tr_b16 a[174:175], v2 offset:25152
  v_rcp_f32 v27, v27
  v_mul_f32 v161, v49, v161
  v_mfma_f32_16x16x32_bf16 v[76:79], a[144:147], a[44:47], v[76:79]
  s_waitcnt lgkmcnt(11)
  v_rcp_f32 v28, v28
  v_mul_f32 v162, v50, v162
  v_mfma_f32_16x16x32_bf16 v[64:67], a[24:27], a[0:3], v[64:67]
  ds_read_b64_tr_b16 a[128:129], v2 offset:28736
  v_rcp_f32 v29, v29
  v_mul_f32 v163, v51, v163
  v_mfma_f32_16x16x32_bf16 v[68:71], a[24:27], a[4:7], v[68:71]
  buffer_load_dwordx4 v136, s[24:27], s50 offen offset:3072 lds
  v_mul_f32 v160, v160, v22
  v_mul_f32 v161, v161, v23
  v_mul_f32 v162, v162, v24
  v_mfma_f32_16x16x32_bf16 v[72:75], a[24:27], a[8:11], v[72:75]
  s_cmp_eq_u32 s87, 2
  s_cselect_b32 s72, 45, 17
  s_lshl_b32 s50, s72, 16
  s_add_u32 m0, s70, 0
  ds_read_b64_tr_b16 a[130:131], v2 offset:32320
  v_mfma_f32_16x16x32_bf16 v[76:79], a[24:27], a[12:15], v[76:79]
  v_mul_f32 v163, v163, v25
  v_mul_f32 v22, v16, v56
  v_mul_f32 v23, v16, v57
  v_mul_f32 v24, v16, v58
  v_mfma_f32_16x16x32_bf16 v[176:179], a[28:31], a[0:3], v[176:179]
  ds_read_b64_tr_b16 a[132:133], v2 offset:35904
  v_mul_f32 v25, v16, v59
  v_exp_f32 v22, v22
  v_mfma_f32_16x16x32_bf16 v[180:183], a[28:31], a[4:7], v[180:183]
  v_mul_f32 v164, v52, v164
  v_exp_f32 v23, v23
  v_mul_f32 v165, v53, v165
  v_mfma_f32_16x16x32_bf16 v[184:187], a[28:31], a[8:11], v[184:187]
  buffer_load_dwordx4 v133, s[24:27], s50 offen offset:0 lds
  v_exp_f32 v24, v24
  v_mul_f32 v166, v54, v166
  v_mfma_f32_16x16x32_bf16 v[188:191], a[28:31], a[12:15], v[188:191]
  ds_read_b64_tr_b16 a[134:135], v2 offset:39488
  v_exp_f32 v25, v25
  v_mul_f32 v167, v55, v167
  v_mfma_f32_16x16x32_bf16 v[188:191], a[152:155], a[44:47], v[188:191]
  ds_read_b64_tr_b16 a[136:137], v2 offset:43072
  v_mul_f32 v164, v164, v26
  v_mul_f32 v165, v165, v27
  v_mul_f32 v166, v166, v28
  v_mfma_f32_16x16x32_bf16 v[188:191], a[156:159], a[60:63], v[188:191]
  v_mul_f32 v167, v167, v29
  v_cvt_pk_bf16_f32 v34, v160, v161
  v_cvt_pk_bf16_f32 v35, v162, v163
  v_mfma_f32_16x16x32_bf16 v[184:187], a[156:159], a[56:59], v[184:187]
  ds_read_b64_tr_b16 a[138:139], v2 offset:46656
  v_mfma_f32_16x16x32_bf16 v[184:187], a[152:155], a[40:43], v[184:187]
  buffer_load_dwordx4 v134, s[24:27], s50 offen offset:1024 lds
  v_mfma_f32_16x16x32_bf16 v[180:183], a[152:155], a[36:39], v[180:183]
  ds_read_b64_tr_b16 a[140:141], v2 offset:50240
  v_mfma_f32_16x16x32_bf16 v[180:183], a[156:159], a[52:55], v[180:183]
  buffer_store_dwordx4 v[32:35], v0, s[36:39], s65 offen offset:0 sc1
  v_mul_f32 v26, v19, v60
  v_mul_f32 v27, v19, v61
  v_mul_f32 v28, v19, v62
  v_mfma_f32_16x16x32_bf16 v[176:179], a[156:159], a[48:51], v[176:179]
  ds_read_b64_tr_b16 a[142:143], v2 offset:53824
  v_mul_f32 v29, v19, v63
  v_exp_f32 v26, v26
  v_mfma_f32_16x16x32_bf16 v[176:179], a[152:155], a[32:35], v[176:179]
  s_waitcnt lgkmcnt(8)
  v_fma_f32 v22, v22, v17, v17
  v_exp_f32 v27, v27
  v_fma_f32 v23, v23, v17, v17
  v_mfma_f32_16x16x32_bf16 v[64:67], a[160:163], a[64:67], v[64:67]
  buffer_load_dwordx4 v135, s[24:27], s50 offen offset:2048 lds
  v_exp_f32 v28, v28
  v_fma_f32 v24, v24, v17, v17
  v_mfma_f32_16x16x32_bf16 v[64:67], a[164:167], a[80:83], v[64:67]
  ds_read_b64_tr_b16 a[144:145], v1 offset:28768
  v_exp_f32 v29, v29
  v_fma_f32 v25, v25, v17, v17
  v_mfma_f32_16x16x32_bf16 v[68:71], a[164:167], a[84:87], v[68:71]
  ds_read_b64_tr_b16 a[146:147], v1 offset:32352
  v_cvt_pk_bf16_f32 v38, v164, v165
  v_cvt_pk_bf16_f32 v39, v166, v167
  v_mfma_f32_16x16x32_bf16 v[68:71], a[160:163], a[68:71], v[68:71]
  buffer_store_dwordx4 v[36:39], v0, s[36:39], s65 offen offset:1024 sc1
  v_rcp_f32 v22, v22
  v_fma_f32 v26, v26, v20, v20
  v_mfma_f32_16x16x32_bf16 v[72:75], a[160:163], a[72:75], v[72:75]
  ds_read_b64_tr_b16 a[148:149], v1 offset:35936
  v_rcp_f32 v23, v23
  v_fma_f32 v27, v27, v20, v20
  v_mfma_f32_16x16x32_bf16 v[72:75], a[164:167], a[88:91], v[72:75]
  buffer_load_dwordx4 v136, s[24:27], s50 offen offset:3072 lds
  v_rcp_f32 v24, v24
  v_fma_f32 v28, v28, v20, v20
  v_mfma_f32_16x16x32_bf16 v[76:79], a[164:167], a[92:95], v[76:79]
  ds_read_b64_tr_b16 a[150:151], v1 offset:39520
  v_rcp_f32 v25, v25
  v_fma_f32 v29, v29, v20, v20
  v_mfma_f32_16x16x32_bf16 v[76:79], a[160:163], a[76:79], v[76:79]
  v_rcp_f32 v26, v26
  v_mul_f32 v168, v56, v168
  v_mfma_f32_16x16x32_bf16 v[188:191], a[168:171], a[76:79], v[188:191]
  v_rcp_f32 v27, v27
  v_mul_f32 v169, v57, v169
  v_mfma_f32_16x16x32_bf16 v[188:191], a[172:175], a[92:95], v[188:191]
  v_rcp_f32 v28, v28
  v_mul_f32 v170, v58, v170
  v_mfma_f32_16x16x32_bf16 v[184:187], a[172:175], a[88:91], v[184:187]
  v_rcp_f32 v29, v29
  v_mul_f32 v171, v59, v171
  v_mul_f32 v168, v168, v22
  v_mfma_f32_16x16x32_bf16 v[184:187], a[168:171], a[72:75], v[184:187]
  v_mul_f32 v169, v169, v23
  v_mul_f32 v170, v170, v24
  v_mul_f32 v171, v171, v25
  v_mul_f32 v172, v60, v172
  v_mfma_f32_16x16x32_bf16 v[180:183], a[168:171], a[68:71], v[180:183]
  v_mul_f32 v173, v61, v173
  v_mul_f32 v174, v62, v174
  v_mul_f32 v175, v63, v175
  v_cvt_pk_bf16_f32 v42, v168, v169
  v_mfma_f32_16x16x32_bf16 v[180:183], a[172:175], a[84:87], v[180:183]
  v_cvt_pk_bf16_f32 v43, v170, v171
  v_mfma_f32_16x16x32_bf16 v[176:179], a[172:175], a[80:83], v[176:179]
  buffer_store_dwordx4 v[40:43], v0, s[36:39], s66 offen offset:0 sc1
  v_mul_f32 v172, v172, v26
  v_mul_f32 v173, v173, v27
  v_mul_f32 v174, v174, v28
  v_mfma_f32_16x16x32_bf16 v[176:179], a[168:171], a[64:67], v[176:179]
  s_waitcnt lgkmcnt(4)
  v_mul_f32 v175, v175, v29
  v_cvt_pk_bf16_f32 v46, v172, v173
  v_cvt_pk_bf16_f32 v47, v174, v175
  v_mfma_f32_16x16x32_bf16 v[64:67], a[128:131], a[96:99], v[64:67]
  ds_read_b128 a[16:19], v31 offset:768
  v_mfma_f32_16x16x32_bf16 v[64:67], a[132:135], a[112:115], v[64:67]
  ds_read_b64_tr_b16 a[152:153], v1 offset:43104
  v_mfma_f32_16x16x32_bf16 v[68:71], a[132:135], a[116:119], v[68:71]
  ds_read_b128 a[20:23], v31 offset:2816
  v_mfma_f32_16x16x32_bf16 v[68:71], a[128:131], a[100:103], v[68:71]
  ds_read_b64_tr_b16 a[154:155], v1 offset:46688
  v_mfma_f32_16x16x32_bf16 v[72:75], a[128:131], a[104:107], v[72:75]
  ds_read_b64_tr_b16 a[156:157], v1 offset:50272
  v_mfma_f32_16x16x32_bf16 v[72:75], a[132:135], a[120:123], v[72:75]
  buffer_store_dwordx4 v[44:47], v0, s[36:39], s66 offen offset:1024 sc1
  s_add_u32 s65, s65, 2048
  s_add_u32 s66, s66, 2048
  v_mfma_f32_16x16x32_bf16 v[76:79], a[132:135], a[124:127], v[76:79]
  ds_read_b64_tr_b16 a[158:159], v1 offset:53856
  v_mfma_f32_16x16x32_bf16 v[76:79], a[128:131], a[108:111], v[76:79]
  v_mfma_f32_16x16x32_bf16 v[188:191], a[136:139], a[108:111], v[188:191]
  ds_read_b64_tr_b16 a[160:161], v2 offset:96
  v_mul_f32 v22, v10, v64
  v_mul_f32 v23, v10, v65
  v_mul_f32 v24, v10, v66
  v_mfma_f32_16x16x32_bf16 v[188:191], a[140:143], a[124:127], v[188:191]
  v_mul_f32 v25, v10, v67
  v_exp_f32 v22, v22
  v_mul_f32 v26, v13, v68
  v_mfma_f32_16x16x32_bf16 v[184:187], a[140:143], a[120:123], v[184:187]
  ds_read_b64_tr_b16 a[162:163], v2 offset:3680
  v_exp_f32 v23, v23
  v_mul_f32 v27, v13, v69
  v_mfma_f32_16x16x32_bf16 v[184:187], a[136:139], a[104:107], v[184:187]
  v_exp_f32 v24, v24
  v_mul_f32 v28, v13, v70
  v_mfma_f32_16x16x32_bf16 v[180:183], a[136:139], a[100:103], v[180:183]
  ds_read_b64_tr_b16 a[164:165], v2 offset:7264
  v_exp_f32 v25, v25
  v_mul_f32 v29, v13, v71
  v_mfma_f32_16x16x32_bf16 v[180:183], a[140:143], a[116:119], v[180:183]
  v_exp_f32 v26, v26
  v_fma_f32 v22, v22, v11, v11
  v_mfma_f32_16x16x32_bf16 v[176:179], a[140:143], a[112:115], v[176:179]
  ds_read_b64_tr_b16 a[166:167], v2 offset:10848
  v_exp_f32 v27, v27
  v_fma_f32 v23, v23, v11, v11
  v_mfma_f32_16x16x32_bf16 v[176:179], a[136:139], a[96:99], v[176:179]
  s_waitcnt lgkmcnt(4)
  v_exp_f32 v28, v28
  v_fma_f32 v24, v24, v11, v11
  v_mfma_f32_16x16x32_bf16 v[80:83], a[144:147], a[32:35], v[80:83]
  ds_read_b64_tr_b16 a[168:169], v2 offset:14432
  v_exp_f32 v29, v29
  v_fma_f32 v25, v25, v11, v11
  v_mfma_f32_16x16x32_bf16 v[80:83], a[148:151], a[48:51], v[80:83]
  v_rcp_f32 v22, v22
  v_fma_f32 v26, v26, v14, v14
  v_mfma_f32_16x16x32_bf16 v[84:87], a[148:151], a[52:55], v[84:87]
  ds_read_b64_tr_b16 a[170:171], v2 offset:18016
  v_rcp_f32 v23, v23
  v_fma_f32 v27, v27, v14, v14
  v_mfma_f32_16x16x32_bf16 v[84:87], a[144:147], a[36:39], v[84:87]
  v_rcp_f32 v24, v24
  v_fma_f32 v28, v28, v14, v14
  v_mfma_f32_16x16x32_bf16 v[88:91], a[144:147], a[40:43], v[88:91]
  ds_read_b64_tr_b16 a[172:173], v2 offset:21600
  v_rcp_f32 v25, v25
  v_fma_f32 v29, v29, v14, v14
  v_mfma_f32_16x16x32_bf16 v[88:91], a[148:151], a[56:59], v[88:91]
  v_rcp_f32 v26, v26
  v_mul_f32 v176, v64, v176
  v_mfma_f32_16x16x32_bf16 v[92:95], a[148:151], a[60:63], v[92:95]
  ds_read_b64_tr_b16 a[174:175], v2 offset:25184
  v_rcp_f32 v27, v27
  v_mul_f32 v177, v65, v177
  v_mfma_f32_16x16x32_bf16 v[92:95], a[144:147], a[44:47], v[92:95]
  s_waitcnt lgkmcnt(11)
  v_rcp_f32 v28, v28
  v_mul_f32 v178, v66, v178
  v_mfma_f32_16x16x32_bf16 v[80:83], a[16:19], a[0:3], v[80:83]
  ds_read_b64_tr_b16 a[128:129], v2 offset:28768
  v_rcp_f32 v29, v29
  v_mul_f32 v179, v67, v179
  v_mfma_f32_16x16x32_bf16 v[84:87], a[16:19], a[4:7], v[84:87]
  v_mul_f32 v176, v176, v22
  v_mul_f32 v177, v177, v23
  v_mul_f32 v178, v178, v24
  v_mul_f32 v179, v179, v25
  v_mfma_f32_16x16x32_bf16 v[88:91], a[16:19], a[8:11], v[88:91]
  ds_read_b64_tr_b16 a[130:131], v2 offset:32352
  v_mul_f32 v22, v16, v72
  v_mul_f32 v23, v16, v73
  v_mul_f32 v24, v16, v74
  v_mfma_f32_16x16x32_bf16 v[92:95], a[16:19], a[12:15], v[92:95]
  v_mul_f32 v25, v16, v75
  v_exp_f32 v22, v22
  v_mul_f32 v180, v68, v180
  v_mfma_f32_16x16x32_bf16 v[192:195], a[20:23], a[0:3], v[192:195]
  ds_read_b64_tr_b16 a[132:133], v2 offset:35936
  v_exp_f32 v23, v23
  v_mul_f32 v181, v69, v181
  v_mfma_f32_16x16x32_bf16 v[196:199], a[20:23], a[4:7], v[196:199]
  v_exp_f32 v24, v24
  v_mul_f32 v182, v70, v182
  v_mfma_f32_16x16x32_bf16 v[200:203], a[20:23], a[8:11], v[200:203]
  ds_read_b64_tr_b16 a[134:135], v2 offset:39520
  v_exp_f32 v25, v25
  v_mul_f32 v183, v71, v183
  v_mfma_f32_16x16x32_bf16 v[204:207], a[20:23], a[12:15], v[204:207]
  v_mul_f32 v180, v180, v26
  v_mul_f32 v181, v181, v27
  v_mul_f32 v182, v182, v28
  v_mul_f32 v183, v183, v29
  v_mfma_f32_16x16x32_bf16 v[204:207], a[152:155], a[44:47], v[204:207]
  ds_read_b64_tr_b16 a[136:137], v2 offset:43104
  v_cvt_pk_bf16_f32 v64, v176, v177
  v_cvt_pk_bf16_f32 v65, v178, v179
  v_mul_f32 v26, v19, v76
  v_mfma_f32_16x16x32_bf16 v[204:207], a[156:159], a[60:63], v[204:207]
  v_mul_f32 v27, v19, v77
  v_mul_f32 v28, v19, v78
  v_mul_f32 v29, v19, v79
  v_mfma_f32_16x16x32_bf16 v[200:203], a[156:159], a[56:59], v[200:203]
  ds_read_b64_tr_b16 a[138:139], v2 offset:46688
  v_exp_f32 v26, v26
  v_fma_f32 v22, v22, v17, v17
  v_mfma_f32_16x16x32_bf16 v[200:203], a[152:155], a[40:43], v[200:203]
  v_exp_f32 v27, v27
  v_fma_f32 v23, v23, v17, v17
  v_mfma_f32_16x16x32_bf16 v[196:199], a[152:155], a[36:39], v[196:199]
  ds_read_b64_tr_b16 a[140:141], v2 offset:50272
  v_exp_f32 v28, v28
  v_fma_f32 v24, v24, v17, v17
  v_mfma_f32_16x16x32_bf16 v[196:199], a[156:159], a[52:55], v[196:199]
  v_exp_f32 v29, v29
  v_fma_f32 v25, v25, v17, v17
  v_cvt_pk_bf16_f32 v68, v180, v181
  v_mfma_f32_16x16x32_bf16 v[192:195], a[156:159], a[48:51], v[192:195]
  ds_read_b64_tr_b16 a[142:143], v2 offset:53856
  v_cvt_pk_bf16_f32 v69, v182, v183
  v_rcp_f32 v22, v22
  v_mfma_f32_16x16x32_bf16 v[192:195], a[152:155], a[32:35], v[192:195]
  s_waitcnt lgkmcnt(8)
  v_fma_f32 v26, v26, v20, v20
  v_rcp_f32 v23, v23
  v_fma_f32 v27, v27, v20, v20
  v_mfma_f32_16x16x32_bf16 v[80:83], a[160:163], a[64:67], v[80:83]
  ds_read_b64_tr_b16 a[144:145], v1 offset:28800
  v_rcp_f32 v24, v24
  v_fma_f32 v28, v28, v20, v20
  v_mfma_f32_16x16x32_bf16 v[80:83], a[164:167], a[80:83], v[80:83]
  v_rcp_f32 v25, v25
  v_fma_f32 v29, v29, v20, v20
  v_mfma_f32_16x16x32_bf16 v[84:87], a[164:167], a[84:87], v[84:87]
  ds_read_b64_tr_b16 a[146:147], v1 offset:32384
  v_rcp_f32 v26, v26
  v_mul_f32 v184, v72, v184
  v_mfma_f32_16x16x32_bf16 v[84:87], a[160:163], a[68:71], v[84:87]
  v_rcp_f32 v27, v27
  v_mul_f32 v185, v73, v185
  v_mfma_f32_16x16x32_bf16 v[88:91], a[160:163], a[72:75], v[88:91]
  ds_read_b64_tr_b16 a[148:149], v1 offset:35968
  v_rcp_f32 v28, v28
  v_mul_f32 v186, v74, v186
  v_mfma_f32_16x16x32_bf16 v[88:91], a[164:167], a[88:91], v[88:91]
  v_rcp_f32 v29, v29
  v_mul_f32 v187, v75, v187
  v_mul_f32 v184, v184, v22
  v_mfma_f32_16x16x32_bf16 v[92:95], a[164:167], a[92:95], v[92:95]
  ds_read_b64_tr_b16 a[150:151], v1 offset:39552
  v_mul_f32 v185, v185, v23
  v_mul_f32 v186, v186, v24
  v_mul_f32 v187, v187, v25
  v_mfma_f32_16x16x32_bf16 v[92:95], a[160:163], a[76:79], v[92:95]
  s_waitcnt vmcnt(0)
  s_barrier
  v_mul_f32 v188, v76, v188
  v_mul_f32 v189, v77, v189
  v_mul_f32 v190, v78, v190
  v_mfma_f32_16x16x32_bf16 v[204:207], a[168:171], a[76:79], v[204:207]
  s_mov_b64 exec, 1
  buffer_store_dword v254, v0, s[36:39], s45 offen sc1
  s_mov_b64 exec, -1
  s_lshl_b32 s45, s2, 7
  v_mfma_f32_16x16x32_bf16 v[204:207], a[172:175], a[92:95], v[204:207]
  s_add_u32 s45, s45, 5439488
  s_cmp_eq_u32 s44, 0
  s_cselect_b32 s45, s45, 1073741824
  v_mul_f32 v191, v79, v191
  v_cvt_pk_bf16_f32 v72, v184, v185
  v_mfma_f32_16x16x32_bf16 v[200:203], a[172:175], a[88:91], v[200:203]
  v_cvt_pk_bf16_f32 v73, v186, v187
  v_mul_f32 v188, v188, v26
  v_mul_f32 v189, v189, v27
  v_mul_f32 v190, v190, v28
  v_mfma_f32_16x16x32_bf16 v[200:203], a[168:171], a[72:75], v[200:203]
  v_mul_f32 v191, v191, v29
  v_cvt_pk_bf16_f32 v76, v188, v189
  v_cvt_pk_bf16_f32 v77, v190, v191
  v_mfma_f32_16x16x32_bf16 v[196:199], a[168:171], a[68:71], v[196:199]
  v_mfma_f32_16x16x32_bf16 v[196:199], a[172:175], a[84:87], v[196:199]
  v_mfma_f32_16x16x32_bf16 v[192:195], a[172:175], a[80:83], v[192:195]
  v_mfma_f32_16x16x32_bf16 v[192:195], a[168:171], a[64:67], v[192:195]
  s_waitcnt lgkmcnt(4)
  v_mfma_f32_16x16x32_bf16 v[80:83], a[128:131], a[96:99], v[80:83]
  ds_read_b128 a[24:27], v31 offset:1024
  v_mfma_f32_16x16x32_bf16 v[80:83], a[132:135], a[112:115], v[80:83]
  ds_read_b64_tr_b16 a[152:153], v1 offset:43136
  v_mfma_f32_16x16x32_bf16 v[84:87], a[132:135], a[116:119], v[84:87]
  ds_read_b128 a[28:31], v31 offset:3072
  v_mfma_f32_16x16x32_bf16 v[84:87], a[128:131], a[100:103], v[84:87]
  ds_read_b64_tr_b16 a[154:155], v1 offset:46720
  v_mfma_f32_16x16x32_bf16 v[88:91], a[128:131], a[104:107], v[88:91]
  ds_read_b64_tr_b16 a[156:157], v1 offset:50304
  v_mfma_f32_16x16x32_bf16 v[88:91], a[132:135], a[120:123], v[88:91]
  v_mfma_f32_16x16x32_bf16 v[92:95], a[132:135], a[124:127], v[92:95]
  ds_read_b64_tr_b16 a[158:159], v1 offset:53888
  v_mfma_f32_16x16x32_bf16 v[92:95], a[128:131], a[108:111], v[92:95]
  v_mfma_f32_16x16x32_bf16 v[204:207], a[136:139], a[108:111], v[204:207]
  ds_read_b64_tr_b16 a[160:161], v2 offset:128
  v_mul_f32 v22, v10, v80
  v_mul_f32 v23, v10, v81
  v_mul_f32 v24, v10, v82
  v_mfma_f32_16x16x32_bf16 v[204:207], a[140:143], a[124:127], v[204:207]
  v_mul_f32 v25, v10, v83
  v_exp_f32 v22, v22
  v_mul_f32 v26, v13, v84
  v_mfma_f32_16x16x32_bf16 v[200:203], a[140:143], a[120:123], v[200:203]
  ds_read_b64_tr_b16 a[162:163], v2 offset:3712
  v_exp_f32 v23, v23
  v_mul_f32 v27, v13, v85
  v_mfma_f32_16x16x32_bf16 v[200:203], a[136:139], a[104:107], v[200:203]
  v_exp_f32 v24, v24
  v_mul_f32 v28, v13, v86
  v_mfma_f32_16x16x32_bf16 v[196:199], a[136:139], a[100:103], v[196:199]
  ds_read_b64_tr_b16 a[164:165], v2 offset:7296
  v_exp_f32 v25, v25
  v_mul_f32 v29, v13, v87
  v_mfma_f32_16x16x32_bf16 v[196:199], a[140:143], a[116:119], v[196:199]
  v_exp_f32 v26, v26
  v_fma_f32 v22, v22, v11, v11
  v_mfma_f32_16x16x32_bf16 v[192:195], a[140:143], a[112:115], v[192:195]
  ds_read_b64_tr_b16 a[166:167], v2 offset:10880
  v_exp_f32 v27, v27
  v_fma_f32 v23, v23, v11, v11
  v_mfma_f32_16x16x32_bf16 v[192:195], a[136:139], a[96:99], v[192:195]
  s_waitcnt lgkmcnt(4)
  v_exp_f32 v28, v28
  v_fma_f32 v24, v24, v11, v11
  v_mfma_f32_16x16x32_bf16 v[96:99], a[144:147], a[32:35], v[96:99]
  ds_read_b64_tr_b16 a[168:169], v2 offset:14464
  v_exp_f32 v29, v29
  v_fma_f32 v25, v25, v11, v11
  v_mfma_f32_16x16x32_bf16 v[96:99], a[148:151], a[48:51], v[96:99]
  v_rcp_f32 v22, v22
  v_fma_f32 v26, v26, v14, v14
  v_mfma_f32_16x16x32_bf16 v[100:103], a[148:151], a[52:55], v[100:103]
  ds_read_b64_tr_b16 a[170:171], v2 offset:18048
  v_rcp_f32 v23, v23
  v_fma_f32 v27, v27, v14, v14
  v_mfma_f32_16x16x32_bf16 v[100:103], a[144:147], a[36:39], v[100:103]
  v_rcp_f32 v24, v24
  v_fma_f32 v28, v28, v14, v14
  v_mfma_f32_16x16x32_bf16 v[104:107], a[144:147], a[40:43], v[104:107]
  ds_read_b64_tr_b16 a[172:173], v2 offset:21632
  v_rcp_f32 v25, v25
  v_fma_f32 v29, v29, v14, v14
  v_mfma_f32_16x16x32_bf16 v[104:107], a[148:151], a[56:59], v[104:107]
  v_rcp_f32 v26, v26
  v_mul_f32 v192, v80, v192
  v_mfma_f32_16x16x32_bf16 v[108:111], a[148:151], a[60:63], v[108:111]
  ds_read_b64_tr_b16 a[174:175], v2 offset:25216
  v_rcp_f32 v27, v27
  v_mul_f32 v193, v81, v193
  v_mfma_f32_16x16x32_bf16 v[108:111], a[144:147], a[44:47], v[108:111]
  s_waitcnt lgkmcnt(11)
  v_rcp_f32 v28, v28
  v_mul_f32 v194, v82, v194
  v_mfma_f32_16x16x32_bf16 v[96:99], a[24:27], a[0:3], v[96:99]
  ds_read_b64_tr_b16 a[128:129], v2 offset:28800
  v_rcp_f32 v29, v29
  v_mul_f32 v195, v83, v195
  v_mfma_f32_16x16x32_bf16 v[100:103], a[24:27], a[4:7], v[100:103]
  v_mul_f32 v192, v192, v22
  v_mul_f32 v193, v193, v23
  v_mul_f32 v194, v194, v24
  v_mul_f32 v195, v195, v25
  v_mfma_f32_16x16x32_bf16 v[104:107], a[24:27], a[8:11], v[104:107]
  ds_read_b64_tr_b16 a[130:131], v2 offset:32384
  v_mul_f32 v22, v16, v88
  v_mul_f32 v23, v16, v89
  v_mul_f32 v24, v16, v90
  v_mfma_f32_16x16x32_bf16 v[108:111], a[24:27], a[12:15], v[108:111]
  v_mul_f32 v25, v16, v91
  v_exp_f32 v22, v22
  v_mul_f32 v196, v84, v196
  v_mfma_f32_16x16x32_bf16 v[208:211], a[28:31], a[0:3], v[208:211]
  ds_read_b64_tr_b16 a[132:133], v2 offset:35968
  v_exp_f32 v23, v23
  v_mul_f32 v197, v85, v197
  v_mfma_f32_16x16x32_bf16 v[212:215], a[28:31], a[4:7], v[212:215]
  v_exp_f32 v24, v24
  v_mul_f32 v198, v86, v198
  v_mfma_f32_16x16x32_bf16 v[216:219], a[28:31], a[8:11], v[216:219]
  ds_read_b64_tr_b16 a[134:135], v2 offset:39552
  v_exp_f32 v25, v25
  v_mul_f32 v199, v87, v199
  v_mfma_f32_16x16x32_bf16 v[220:223], a[28:31], a[12:15], v[220:223]
  v_mul_f32 v196, v196, v26
  v_mul_f32 v197, v197, v27
  v_mul_f32 v198, v198, v28
  v_mul_f32 v199, v199, v29
  v_mfma_f32_16x16x32_bf16 v[220:223], a[152:155], a[44:47], v[220:223]
  ds_read_b64_tr_b16 a[136:137], v2 offset:43136
  v_cvt_pk_bf16_f32 v66, v192, v193
  v_cvt_pk_bf16_f32 v67, v194, v195
  v_mfma_f32_16x16x32_bf16 v[220:223], a[156:159], a[60:63], v[220:223]
  buffer_store_dwordx4 v[64:67], v0, s[36:39], s65 offen offset:0 sc1
  v_mul_f32 v26, v19, v92
  v_mul_f32 v27, v19, v93
  v_mul_f32 v28, v19, v94
  v_mfma_f32_16x16x32_bf16 v[216:219], a[156:159], a[56:59], v[216:219]
  ds_read_b64_tr_b16 a[138:139], v2 offset:46720
  v_mul_f32 v29, v19, v95
  v_exp_f32 v26, v26
  v_mfma_f32_16x16x32_bf16 v[216:219], a[152:155], a[40:43], v[216:219]
  v_fma_f32 v22, v22, v17, v17
  v_exp_f32 v27, v27
  v_fma_f32 v23, v23, v17, v17
  v_mfma_f32_16x16x32_bf16 v[212:215], a[152:155], a[36:39], v[212:215]
  ds_read_b64_tr_b16 a[140:141], v2 offset:50304
  v_exp_f32 v28, v28
  v_fma_f32 v24, v24, v17, v17
  v_mfma_f32_16x16x32_bf16 v[212:215], a[156:159], a[52:55], v[212:215]
  v_exp_f32 v29, v29
  v_fma_f32 v25, v25, v17, v17
  v_cvt_pk_bf16_f32 v70, v196, v197
  v_mfma_f32_16x16x32_bf16 v[208:211], a[156:159], a[48:51], v[208:211]
  ds_read_b64_tr_b16 a[142:143], v2 offset:53888
  v_cvt_pk_bf16_f32 v71, v198, v199
  v_mfma_f32_16x16x32_bf16 v[208:211], a[152:155], a[32:35], v[208:211]
  s_waitcnt lgkmcnt(8)
  buffer_store_dwordx4 v[68:71], v0, s[36:39], s65 offen offset:1024 sc1
  v_rcp_f32 v22, v22
  v_fma_f32 v26, v26, v20, v20
  v_mfma_f32_16x16x32_bf16 v[96:99], a[160:163], a[64:67], v[96:99]
  ds_read_b64_tr_b16 a[144:145], v1 offset:28832
  v_rcp_f32 v23, v23
  v_fma_f32 v27, v27, v20, v20
  v_mfma_f32_16x16x32_bf16 v[96:99], a[164:167], a[80:83], v[96:99]
  v_rcp_f32 v24, v24
  v_fma_f32 v28, v28, v20, v20
  v_mfma_f32_16x16x32_bf16 v[100:103], a[164:167], a[84:87], v[100:103]
  ds_read_b64_tr_b16 a[146:147], v1 offset:32416
  v_rcp_f32 v25, v25
  v_fma_f32 v29, v29, v20, v20
  v_mfma_f32_16x16x32_bf16 v[100:103], a[160:163], a[68:71], v[100:103]
  v_rcp_f32 v26, v26
  v_mul_f32 v200, v88, v200
  v_mfma_f32_16x16x32_bf16 v[104:107], a[160:163], a[72:75], v[104:107]
  ds_read_b64_tr_b16 a[148:149], v1 offset:36000
  v_rcp_f32 v27, v27
  v_mul_f32 v201, v89, v201
  v_mfma_f32_16x16x32_bf16 v[104:107], a[164:167], a[88:91], v[104:107]
  v_rcp_f32 v28, v28
  v_mul_f32 v202, v90, v202
  v_mfma_f32_16x16x32_bf16 v[108:111], a[164:167], a[92:95], v[108:111]
  ds_read_b64_tr_b16 a[150:151], v1 offset:39584
  v_rcp_f32 v29, v29
  v_mul_f32 v203, v91, v203
  v_mfma_f32_16x16x32_bf16 v[108:111], a[160:163], a[76:79], v[108:111]
  v_mul_f32 v200, v200, v22
  v_mul_f32 v201, v201, v23
  v_mul_f32 v202, v202, v24
  v_mul_f32 v203, v203, v25
  v_mfma_f32_16x16x32_bf16 v[220:223], a[168:171], a[76:79], v[220:223]
  v_mul_f32 v204, v92, v204
  v_mul_f32 v205, v93, v205
  v_mul_f32 v206, v94, v206
  v_mul_f32 v207, v95, v207
  v_mfma_f32_16x16x32_bf16 v[220:223], a[172:175], a[92:95], v[220:223]
  v_cvt_pk_bf16_f32 v74, v200, v201
  v_cvt_pk_bf16_f32 v75, v202, v203
  v_mfma_f32_16x16x32_bf16 v[216:219], a[172:175], a[88:91], v[216:219]
  buffer_store_dwordx4 v[72:75], v0, s[36:39], s66 offen offset:0 sc1
  v_mul_f32 v204, v204, v26
  v_mul_f32 v205, v205, v27
  v_mul_f32 v206, v206, v28
  v_mfma_f32_16x16x32_bf16 v[216:219], a[168:171], a[72:75], v[216:219]
  v_mul_f32 v207, v207, v29
  v_cvt_pk_bf16_f32 v78, v204, v205
  v_cvt_pk_bf16_f32 v79, v206, v207
  v_mfma_f32_16x16x32_bf16 v[212:215], a[168:171], a[68:71], v[212:215]
  buffer_store_dwordx4 v[76:79], v0, s[36:39], s66 offen offset:1024 sc1
  s_add_u32 s65, s65, 2048
  s_add_u32 s66, s66, 2048
  v_mfma_f32_16x16x32_bf16 v[212:215], a[172:175], a[84:87], v[212:215]
  v_mfma_f32_16x16x32_bf16 v[208:211], a[172:175], a[80:83], v[208:211]
  v_mfma_f32_16x16x32_bf16 v[208:211], a[168:171], a[64:67], v[208:211]
  s_waitcnt lgkmcnt(4)
  v_mfma_f32_16x16x32_bf16 v[96:99], a[128:131], a[96:99], v[96:99]
  ds_read_b128 a[16:19], v31 offset:1280
  v_mfma_f32_16x16x32_bf16 v[96:99], a[132:135], a[112:115], v[96:99]
  ds_read_b64_tr_b16 a[152:153], v1 offset:43168
  v_mfma_f32_16x16x32_bf16 v[100:103], a[132:135], a[116:119], v[100:103]
  ds_read_b128 a[20:23], v31 offset:3328
  v_mfma_f32_16x16x32_bf16 v[100:103], a[128:131], a[100:103], v[100:103]
  ds_read_b64_tr_b16 a[154:155], v1 offset:46752
  v_mfma_f32_16x16x32_bf16 v[104:107], a[128:131], a[104:107], v[104:107]
  ds_read_b64_tr_b16 a[156:157], v1 offset:50336
  v_mfma_f32_16x16x32_bf16 v[104:107], a[132:135], a[120:123], v[104:107]
  v_mfma_f32_16x16x32_bf16 v[108:111], a[132:135], a[124:127], v[108:111]
  ds_read_b64_tr_b16 a[158:159], v1 offset:53920
  v_mfma_f32_16x16x32_bf16 v[108:111], a[128:131], a[108:111], v[108:111]
  v_mfma_f32_16x16x32_bf16 v[220:223], a[136:139], a[108:111], v[220:223]
  ds_read_b64_tr_b16 a[160:161], v2 offset:160
  v_mul_f32 v22, v10, v96
  v_mul_f32 v23, v10, v97
  v_mul_f32 v24, v10, v98
  v_mul_f32 v25, v10, v99
  v_mfma_f32_16x16x32_bf16 v[220:223], a[140:143], a[124:127], v[220:223]
  v_exp_f32 v22, v22
  v_mul_f32 v26, v13, v100
  v_mfma_f32_16x16x32_bf16 v[216:219], a[140:143], a[120:123], v[216:219]
  buffer_load_dword v139, v138, s[36:39], s91 offen sc1
  v_exp_f32 v23, v23
  v_mul_f32 v27, v13, v101
  v_mfma_f32_16x16x32_bf16 v[216:219], a[136:139], a[104:107], v[216:219]
  ds_read_b64_tr_b16 a[162:163], v2 offset:3744
  v_exp_f32 v24, v24
  v_mul_f32 v28, v13, v102
  v_mfma_f32_16x16x32_bf16 v[212:215], a[136:139], a[100:103], v[212:215]
  ds_read_b64_tr_b16 a[164:165], v2 offset:7328
  v_exp_f32 v25, v25
  v_mul_f32 v29, v13, v103
  v_mfma_f32_16x16x32_bf16 v[212:215], a[140:143], a[116:119], v[212:215]
  v_exp_f32 v26, v26
  v_fma_f32 v22, v22, v11, v11
  v_mfma_f32_16x16x32_bf16 v[208:211], a[140:143], a[112:115], v[208:211]
  ds_read_b64_tr_b16 a[166:167], v2 offset:10912
  v_exp_f32 v27, v27
  v_fma_f32 v23, v23, v11, v11
  v_mfma_f32_16x16x32_bf16 v[208:211], a[136:139], a[96:99], v[208:211]
  s_waitcnt lgkmcnt(4)
  v_exp_f32 v28, v28
  v_fma_f32 v24, v24, v11, v11
  v_mfma_f32_16x16x32_bf16 v[112:115], a[144:147], a[32:35], v[112:115]
  ds_read_b64_tr_b16 a[168:169], v2 offset:14496
  v_exp_f32 v29, v29
  v_fma_f32 v25, v25, v11, v11
  v_mfma_f32_16x16x32_bf16 v[112:115], a[148:151], a[48:51], v[112:115]
  v_rcp_f32 v22, v22
  v_fma_f32 v26, v26, v14, v14
  v_mfma_f32_16x16x32_bf16 v[116:119], a[148:151], a[52:55], v[116:119]
  ds_read_b64_tr_b16 a[170:171], v2 offset:18080
  v_rcp_f32 v23, v23
  v_fma_f32 v27, v27, v14, v14
  v_mfma_f32_16x16x32_bf16 v[116:119], a[144:147], a[36:39], v[116:119]
  v_rcp_f32 v24, v24
  v_fma_f32 v28, v28, v14, v14
  v_mfma_f32_16x16x32_bf16 v[120:123], a[144:147], a[40:43], v[120:123]
  ds_read_b64_tr_b16 a[172:173], v2 offset:21664
  v_rcp_f32 v25, v25
  v_fma_f32 v29, v29, v14, v14
  v_mfma_f32_16x16x32_bf16 v[120:123], a[148:151], a[56:59], v[120:123]
  v_rcp_f32 v26, v26
  v_mul_f32 v208, v96, v208
  v_mfma_f32_16x16x32_bf16 v[124:127], a[148:151], a[60:63], v[124:127]
  ds_read_b64_tr_b16 a[174:175], v2 offset:25248
  v_rcp_f32 v27, v27
  v_mul_f32 v209, v97, v209
  v_mfma_f32_16x16x32_bf16 v[124:127], a[144:147], a[44:47], v[124:127]
  s_waitcnt lgkmcnt(11)
  v_rcp_f32 v28, v28
  v_mul_f32 v210, v98, v210
  v_mfma_f32_16x16x32_bf16 v[112:115], a[16:19], a[0:3], v[112:115]
  ds_read_b64_tr_b16 a[128:129], v2 offset:28832
  v_rcp_f32 v29, v29
  v_mul_f32 v211, v99, v211
  v_mfma_f32_16x16x32_bf16 v[116:119], a[16:19], a[4:7], v[116:119]
  v_mul_f32 v208, v208, v22
  v_mul_f32 v209, v209, v23
  v_mul_f32 v210, v210, v24
  v_mul_f32 v211, v211, v25
  v_mfma_f32_16x16x32_bf16 v[120:123], a[16:19], a[8:11], v[120:123]
  ds_read_b64_tr_b16 a[130:131], v2 offset:32416
  v_mul_f32 v22, v16, v104
  v_mul_f32 v23, v16, v105
  v_mul_f32 v24, v16, v106
  v_mfma_f32_16x16x32_bf16 v[124:127], a[16:19], a[12:15], v[124:127]
  v_mul_f32 v25, v16, v107
  v_exp_f32 v22, v22
  v_mul_f32 v212, v100, v212
  v_mfma_f32_16x16x32_bf16 v[224:227], a[20:23], a[0:3], v[224:227]
  ds_read_b64_tr_b16 a[132:133], v2 offset:36000
  v_exp_f32 v23, v23
  v_mul_f32 v213, v101, v213
  v_mfma_f32_16x16x32_bf16 v[228:231], a[20:23], a[4:7], v[228:231]
  v_exp_f32 v24, v24
  v_mul_f32 v214, v102, v214
  v_mfma_f32_16x16x32_bf16 v[232:235], a[20:23], a[8:11], v[232:235]
  ds_read_b64_tr_b16 a[134:135], v2 offset:39584
  v_exp_f32 v25, v25
  v_mul_f32 v215, v103, v215
  v_mfma_f32_16x16x32_bf16 v[236:239], a[20:23], a[12:15], v[236:239]
  v_mul_f32 v212, v212, v26
  v_mul_f32 v213, v213, v27
  v_mul_f32 v214, v214, v28
  v_mul_f32 v215, v215, v29
  v_mfma_f32_16x16x32_bf16 v[236:239], a[152:155], a[44:47], v[236:239]
  ds_read_b64_tr_b16 a[136:137], v2 offset:43168
  v_cvt_pk_bf16_f32 v96, v208, v209
  v_cvt_pk_bf16_f32 v97, v210, v211
  v_mul_f32 v26, v19, v108
  v_mfma_f32_16x16x32_bf16 v[236:239], a[156:159], a[60:63], v[236:239]
  v_mul_f32 v27, v19, v109
  v_mul_f32 v28, v19, v110
  v_mul_f32 v29, v19, v111
  v_mfma_f32_16x16x32_bf16 v[232:235], a[156:159], a[56:59], v[232:235]
  ds_read_b64_tr_b16 a[138:139], v2 offset:46752
  v_exp_f32 v26, v26
  v_fma_f32 v22, v22, v17, v17
  v_mfma_f32_16x16x32_bf16 v[232:235], a[152:155], a[40:43], v[232:235]
Hb1_2:
  s_cbranch_execz Hb1_3
  v_exp_f32 v27, v27
  v_fma_f32 v23, v23, v17, v17
  v_mfma_f32_16x16x32_bf16 v[228:231], a[152:155], a[36:39], v[228:231]
  ds_read_b64_tr_b16 a[140:141], v2 offset:50336
  v_exp_f32 v28, v28
  v_fma_f32 v24, v24, v17, v17
  v_mfma_f32_16x16x32_bf16 v[228:231], a[156:159], a[52:55], v[228:231]
  v_exp_f32 v29, v29
  v_fma_f32 v25, v25, v17, v17
  v_cvt_pk_bf16_f32 v100, v212, v213
  v_mfma_f32_16x16x32_bf16 v[224:227], a[156:159], a[48:51], v[224:227]
  s_waitcnt vmcnt(0)
  v_cmp_ne_u32 vcc, s3, v139
  s_nop 4
  s_cbranch_vccnz CK7s
CK7x:
  v_mfma_f32_16x16x32_bf16 v[224:227], a[152:155], a[32:35], v[224:227]
  s_waitcnt lgkmcnt(7)
  s_lshl_b32 s51, s69, 11
  s_mov_b32 s91, 5439488
  ds_read_b64_tr_b16 a[142:143], v2 offset:53920
  v_cvt_pk_bf16_f32 v101, v214, v215
  v_mfma_f32_16x16x32_bf16 v[112:115], a[160:163], a[64:67], v[112:115]
  buffer_load_dwordx4 a[216:219], v137, s[36:39], s51 offen offset:0 sc1
  v_rcp_f32 v22, v22
  v_fma_f32 v26, v26, v20, v20
  v_mfma_f32_16x16x32_bf16 v[112:115], a[164:167], a[80:83], v[112:115]
  v_rcp_f32 v23, v23
  v_fma_f32 v27, v27, v20, v20
  v_mfma_f32_16x16x32_bf16 v[116:119], a[164:167], a[84:87], v[116:119]
  buffer_load_dwordx4 a[220:223], v137, s[36:39], s51 offen offset:1024 sc1
  v_rcp_f32 v24, v24
  v_fma_f32 v28, v28, v20, v20
  v_mfma_f32_16x16x32_bf16 v[116:119], a[160:163], a[68:71], v[116:119]
  v_rcp_f32 v25, v25
  v_fma_f32 v29, v29, v20, v20
  v_mfma_f32_16x16x32_bf16 v[120:123], a[160:163], a[72:75], v[120:123]
  buffer_load_dwordx4 a[224:227], v137, s[36:39], s51 offen offset:2048 sc1
  v_rcp_f32 v26, v26
  v_mul_f32 v216, v104, v216
  v_mfma_f32_16x16x32_bf16 v[120:123], a[164:167], a[88:91], v[120:123]
  v_rcp_f32 v27, v27
  v_mul_f32 v217, v105, v217
  v_mfma_f32_16x16x32_bf16 v[124:127], a[164:167], a[92:95], v[124:127]
  buffer_load_dwordx4 a[228:231], v137, s[36:39], s51 offen offset:3072 sc1
  s_lshl_b32 s51, s71, 11
  v_rcp_f32 v28, v28
  v_mfma_f32_16x16x32_bf16 v[124:127], a[160:163], a[76:79], v[124:127]
  s_waitcnt vmcnt(22)
  s_barrier
  v_mul_f32 v218, v106, v218
  v_rcp_f32 v29, v29
  v_mfma_f32_16x16x32_bf16 v[236:239], a[168:171], a[76:79], v[236:239]
  buffer_load_dwordx4 a[0:3], v137, s[36:39], s51 offen offset:0 sc1
  v_mul_f32 v219, v107, v219
  v_mul_f32 v216, v216, v22
  v_mul_f32 v217, v217, v23
  v_mfma_f32_16x16x32_bf16 v[236:239], a[172:175], a[92:95], v[236:239]
  v_mul_f32 v218, v218, v24
  v_mul_f32 v219, v219, v25
  v_mul_f32 v220, v108, v220
  v_mul_f32 v221, v109, v221
  v_mfma_f32_16x16x32_bf16 v[232:235], a[172:175], a[88:91], v[232:235]
  buffer_load_dwordx4 a[4:7], v137, s[36:39], s51 offen offset:1024 sc1
  v_mul_f32 v222, v110, v222
  v_mul_f32 v223, v111, v223
  v_cvt_pk_bf16_f32 v104, v216, v217
  v_mfma_f32_16x16x32_bf16 v[232:235], a[168:171], a[72:75], v[232:235]
  v_cvt_pk_bf16_f32 v105, v218, v219
  v_mul_f32 v220, v220, v26
  v_mul_f32 v221, v221, v27
  v_mul_f32 v222, v222, v28
  v_mfma_f32_16x16x32_bf16 v[228:231], a[168:171], a[68:71], v[228:231]
  buffer_load_dwordx4 a[8:11], v137, s[36:39], s51 offen offset:2048 sc1
  v_mul_f32 v223, v223, v29
  v_cvt_pk_bf16_f32 v108, v220, v221
  v_cvt_pk_bf16_f32 v109, v222, v223
  v_mfma_f32_16x16x32_bf16 v[228:231], a[172:175], a[84:87], v[228:231]
  v_mfma_f32_16x16x32_bf16 v[224:227], a[172:175], a[80:83], v[224:227]
  buffer_load_dwordx4 a[12:15], v137, s[36:39], s51 offen offset:3072 sc1
  s_lshl_b32 s51, s72, 11
  v_mfma_f32_16x16x32_bf16 v[224:227], a[168:171], a[64:67], v[224:227]
  s_waitcnt lgkmcnt(0)
  v_mfma_f32_16x16x32_bf16 v[112:115], a[128:131], a[96:99], v[112:115]
  s_barrier
  buffer_load_dwordx4 a[16:19], v137, s[36:39], s51 offen offset:0 sc1
  ds_read_b64_tr_b16 a[176:177], v244 offset:49152
  v_mfma_f32_16x16x32_bf16 v[112:115], a[132:135], a[112:115], v[112:115]
  ds_read_b64_tr_b16 a[178:179], v244 offset:53248
  v_mfma_f32_16x16x32_bf16 v[116:119], a[132:135], a[116:119], v[116:119]
  buffer_load_dwordx4 a[20:23], v137, s[36:39], s51 offen offset:1024 sc1
  ds_read_b64_tr_b16 a[180:181], v244 offset:57344
  v_mfma_f32_16x16x32_bf16 v[116:119], a[128:131], a[100:103], v[116:119]
  ds_read_b64_tr_b16 a[182:183], v244 offset:61440
  v_mfma_f32_16x16x32_bf16 v[120:123], a[128:131], a[104:107], v[120:123]
  buffer_load_dwordx4 a[24:27], v137, s[36:39], s51 offen offset:2048 sc1
  ds_read_b64_tr_b16 a[184:185], v245 offset:49152
  v_mfma_f32_16x16x32_bf16 v[120:123], a[132:135], a[120:123], v[120:123]
  ds_read_b64_tr_b16 a[186:187], v245 offset:53248
  v_mfma_f32_16x16x32_bf16 v[124:127], a[132:135], a[124:127], v[124:127]
  buffer_load_dwordx4 a[28:31], v137, s[36:39], s51 offen offset:3072 sc1
  s_cmp_eq_u32 s87, 3
  s_cselect_b32 s73, 52, 24
  s_lshl_b32 s50, s73, 16
  v_mfma_f32_16x16x32_bf16 v[124:127], a[128:131], a[108:111], v[124:127]
  s_add_u32 m0, s70, 16384
  ds_read_b64_tr_b16 a[188:189], v245 offset:57344
  ds_read_b64_tr_b16 a[190:191], v245 offset:61440
  v_mfma_f32_16x16x32_bf16 v[236:239], a[136:139], a[108:111], v[236:239]
  ds_read_b64_tr_b16 a[192:193], v246 offset:49152
  v_mul_f32 v22, v10, v112
  v_mul_f32 v23, v10, v113
  v_mul_f32 v24, v10, v114
  v_mfma_f32_16x16x32_bf16 v[236:239], a[140:143], a[124:127], v[236:239]
  ds_read_b64_tr_b16 a[194:195], v246 offset:53248
  v_mul_f32 v25, v10, v115
  v_exp_f32 v22, v22
  v_mfma_f32_16x16x32_bf16 v[232:235], a[140:143], a[120:123], v[232:235]
  buffer_load_dwordx4 v133, s[24:27], s50 offen offset:0 lds
  ds_read_b64_tr_b16 a[196:197], v246 offset:57344
  v_mul_f32 v26, v13, v116
  v_mfma_f32_16x16x32_bf16 v[232:235], a[136:139], a[104:107], v[232:235]
  ds_read_b64_tr_b16 a[198:199], v246 offset:61440
  v_exp_f32 v23, v23
  v_mul_f32 v27, v13, v117
  v_mfma_f32_16x16x32_bf16 v[228:231], a[136:139], a[100:103], v[228:231]
  s_lshl_b32 s51, s73, 11
  ds_read_b64_tr_b16 a[200:201], v247 offset:49152
  v_exp_f32 v24, v24
  v_mul_f32 v28, v13, v118
  v_mfma_f32_16x16x32_bf16 v[228:231], a[140:143], a[116:119], v[228:231]
  ds_read_b64_tr_b16 a[202:203], v247 offset:53248
  v_exp_f32 v25, v25
  v_mul_f32 v29, v13, v119
  v_mfma_f32_16x16x32_bf16 v[224:227], a[140:143], a[112:115], v[224:227]
  ds_read_b64_tr_b16 a[204:205], v247 offset:57344
  v_exp_f32 v26, v26
  v_fma_f32 v22, v22, v11, v11
  v_mfma_f32_16x16x32_bf16 v[224:227], a[136:139], a[96:99], v[224:227]
  s_waitcnt vmcnt(9) lgkmcnt(11)
  ds_read_b64_tr_b16 a[206:207], v247 offset:61440
  v_exp_f32 v27, v27
  v_fma_f32 v23, v23, v11, v11
  v_mfma_f32_16x16x32_bf16 v[32:35], a[176:179], a[216:219], 0
  buffer_load_dwordx4 a[32:35], v137, s[36:39], s51 offen offset:0 sc1
  ds_read_b64_tr_b16 a[208:209], v244 offset:51200
  v_exp_f32 v28, v28
  v_mfma_f32_16x16x32_bf16 v[32:35], a[180:183], a[224:227], v[32:35]
  ds_read_b64_tr_b16 a[210:211], v244 offset:55296
  v_fma_f32 v24, v24, v11, v11
  v_exp_f32 v29, v29
  v_mfma_f32_16x16x32_bf16 v[36:39], a[180:183], a[228:231], 0
  buffer_load_dwordx4 v134, s[24:27], s50 offen offset:1024 lds
  ds_read_b64_tr_b16 a[212:213], v244 offset:59392
  v_fma_f32 v25, v25, v11, v11
  v_mfma_f32_16x16x32_bf16 v[36:39], a[176:179], a[220:223], v[36:39]
  s_waitcnt lgkmcnt(11)
  ds_read_b64_tr_b16 a[214:215], v244 offset:63488
  v_rcp_f32 v22, v22
  v_fma_f32 v26, v26, v14, v14
  v_mfma_f32_16x16x32_bf16 v[44:47], a[184:187], a[220:223], 0
  ds_read_b64_tr_b16 a[176:177], v245 offset:51200
  v_rcp_f32 v23, v23
  v_fma_f32 v27, v27, v14, v14
  v_mfma_f32_16x16x32_bf16 v[44:47], a[188:191], a[228:231], v[44:47]
  buffer_load_dwordx4 a[36:39], v137, s[36:39], s51 offen offset:1024 sc1
  ds_read_b64_tr_b16 a[178:179], v245 offset:55296
  v_rcp_f32 v24, v24
  v_mfma_f32_16x16x32_bf16 v[40:43], a[188:191], a[224:227], 0
  ds_read_b64_tr_b16 a[180:181], v245 offset:59392
  v_fma_f32 v28, v28, v14, v14
  v_rcp_f32 v25, v25
  v_mfma_f32_16x16x32_bf16 v[40:43], a[184:187], a[216:219], v[40:43]
  s_waitcnt vmcnt(30) lgkmcnt(11)
  s_barrier
  ds_read_b64_tr_b16 a[182:183], v245 offset:63488
  v_fma_f32 v29, v29, v14, v14
  v_mfma_f32_16x16x32_bf16 v[48:51], a[192:195], a[216:219], 0
  ds_read_b64_tr_b16 a[184:185], v246 offset:51200
  v_rcp_f32 v26, v26
  v_mul_f32 v224, v112, v224
  v_mfma_f32_16x16x32_bf16 v[48:51], a[196:199], a[224:227], v[48:51]
  buffer_load_dwordx4 v135, s[24:27], s50 offen offset:2048 lds
  ds_read_b64_tr_b16 a[186:187], v246 offset:55296
  v_rcp_f32 v27, v27
  v_mfma_f32_16x16x32_bf16 v[52:55], a[196:199], a[228:231], 0
  ds_read_b64_tr_b16 a[188:189], v246 offset:59392
  v_mul_f32 v225, v113, v225
  v_rcp_f32 v28, v28
  v_mfma_f32_16x16x32_bf16 v[52:55], a[192:195], a[220:223], v[52:55]
  s_waitcnt lgkmcnt(11)
  ds_read_b64_tr_b16 a[190:191], v246 offset:63488
  v_mul_f32 v226, v114, v226
  v_rcp_f32 v29, v29
  v_mfma_f32_16x16x32_bf16 v[60:63], a[200:203], a[220:223], 0
  ds_read_b64_tr_b16 a[192:193], v247 offset:51200
  v_mul_f32 v227, v115, v227
  v_mul_f32 v224, v224, v22
  v_mul_f32 v225, v225, v23
  v_mfma_f32_16x16x32_bf16 v[60:63], a[204:207], a[228:231], v[60:63]
  buffer_load_dwordx4 a[40:43], v137, s[36:39], s51 offen offset:2048 sc1
  ds_read_b64_tr_b16 a[194:195], v247 offset:55296
  v_mul_f32 v226, v226, v24
  v_mul_f32 v227, v227, v25
  v_mfma_f32_16x16x32_bf16 v[56:59], a[204:207], a[224:227], 0
  ds_read_b64_tr_b16 a[196:197], v247 offset:59392
  v_mul_f32 v22, v16, v120
  v_mul_f32 v23, v16, v121
  v_mul_f32 v24, v16, v122
  v_mfma_f32_16x16x32_bf16 v[56:59], a[200:203], a[216:219], v[56:59]
  s_waitcnt lgkmcnt(11)
  ds_read_b64_tr_b16 a[198:199], v247 offset:63488
  v_mul_f32 v25, v16, v123
  v_exp_f32 v22, v22
  v_mfma_f32_16x16x32_bf16 v[144:147], a[208:211], a[216:219], 0
  buffer_load_dwordx4 v136, s[24:27], s50 offen offset:3072 lds
  ds_read_b64_tr_b16 a[200:201], v248 offset:0
  v_mul_f32 v228, v116, v228
  v_mfma_f32_16x16x32_bf16 v[144:147], a[212:215], a[224:227], v[144:147]
  ds_read_b64_tr_b16 a[202:203], v248 offset:4096
  v_exp_f32 v23, v23
  v_mul_f32 v229, v117, v229
  v_mfma_f32_16x16x32_bf16 v[148:151], a[212:215], a[228:231], 0
  ds_read_b64_tr_b16 a[204:205], v248 offset:8192
  v_exp_f32 v24, v24
  v_mul_f32 v230, v118, v230
  v_mfma_f32_16x16x32_bf16 v[148:151], a[208:211], a[220:223], v[148:151]
  s_waitcnt lgkmcnt(11)
  ds_read_b64_tr_b16 a[206:207], v248 offset:12288
  v_exp_f32 v25, v25
  v_mul_f32 v231, v119, v231
  v_mfma_f32_16x16x32_bf16 v[156:159], a[176:179], a[220:223], 0
  buffer_load_dwordx4 a[44:47], v137, s[36:39], s51 offen offset:3072 sc1
  s_mov_b32 s74, 31
  s_lshl_b32 s50, s74, 16
  s_add_u32 m0, s70, 32768
  v_mfma_f32_16x16x32_bf16 v[156:159], a[180:183], a[228:231], v[156:159]
  ds_read_b64_tr_b16 a[208:209], v249 offset:0
  ds_read_b64_tr_b16 a[210:211], v249 offset:4096
  v_mul_f32 v228, v228, v26
  v_mul_f32 v229, v229, v27
  v_mfma_f32_16x16x32_bf16 v[152:155], a[180:183], a[224:227], 0
  ds_read_b64_tr_b16 a[212:213], v249 offset:8192
  v_mul_f32 v230, v230, v28
  v_mul_f32 v231, v231, v29
  v_cvt_pk_bf16_f32 v98, v224, v225
  v_mfma_f32_16x16x32_bf16 v[152:155], a[176:179], a[216:219], v[152:155]
  s_waitcnt lgkmcnt(11)
  ds_read_b64_tr_b16 a[214:215], v249 offset:12288
  v_cvt_pk_bf16_f32 v99, v226, v227
  v_mfma_f32_16x16x32_bf16 v[160:163], a[184:187], a[216:219], 0
  buffer_load_dwordx4 v133, s[24:27], s50 offen offset:0 lds
  s_lshl_b32 s51, s74, 11
  ds_read_b64_tr_b16 a[176:177], v250 offset:0
  v_mfma_f32_16x16x32_bf16 v[160:163], a[188:191], a[224:227], v[160:163]
  ds_read_b64_tr_b16 a[178:179], v250 offset:4096
  v_mfma_f32_16x16x32_bf16 v[164:167], a[188:191], a[228:231], 0
  ds_read_b64_tr_b16 a[180:181], v250 offset:8192
  buffer_store_dwordx4 v[96:99], v0, s[36:39], s65 offen offset:0 sc1
  v_mul_f32 v26, v19, v124
  v_mul_f32 v27, v19, v125
  v_mfma_f32_16x16x32_bf16 v[164:167], a[184:187], a[220:223], v[164:167]
  s_waitcnt lgkmcnt(11)
  ds_read_b64_tr_b16 a[182:183], v250 offset:12288
  v_mul_f32 v28, v19, v126
  v_mul_f32 v29, v19, v127
  v_mfma_f32_16x16x32_bf16 v[172:175], a[192:195], a[220:223], 0
  buffer_load_dwordx4 a[48:51], v137, s[36:39], s51 offen offset:0 sc1
  ds_read_b64_tr_b16 a[184:185], v251 offset:0
  v_exp_f32 v26, v26
  v_mfma_f32_16x16x32_bf16 v[172:175], a[196:199], a[228:231], v[172:175]
  ds_read_b64_tr_b16 a[186:187], v251 offset:4096
  v_fma_f32 v22, v22, v17, v17
  v_exp_f32 v27, v27
  v_mfma_f32_16x16x32_bf16 v[168:171], a[196:199], a[224:227], 0
  ds_read_b64_tr_b16 a[188:189], v251 offset:8192
  v_fma_f32 v23, v23, v17, v17
  v_exp_f32 v28, v28
  v_mfma_f32_16x16x32_bf16 v[168:171], a[192:195], a[216:219], v[168:171]
  s_waitcnt vmcnt(15) lgkmcnt(11)
  ds_read_b64_tr_b16 a[190:191], v251 offset:12288
  v_fma_f32 v24, v24, v17, v17
  v_exp_f32 v29, v29
  v_mfma_f32_16x16x32_bf16 v[32:35], a[200:203], a[0:3], v[32:35]
  buffer_load_dwordx4 v134, s[24:27], s50 offen offset:1024 lds
  ds_read_b64_tr_b16 a[192:193], v248 offset:2048
  v_fma_f32 v25, v25, v17, v17
  v_cvt_pk_bf16_f32 v102, v228, v229
  v_mfma_f32_16x16x32_bf16 v[32:35], a[204:207], a[8:11], v[32:35]
  ds_read_b64_tr_b16 a[194:195], v248 offset:6144
  v_cvt_pk_bf16_f32 v103, v230, v231
  v_mfma_f32_16x16x32_bf16 v[36:39], a[204:207], a[12:15], v[36:39]
  ds_read_b64_tr_b16 a[196:197], v248 offset:10240
  buffer_store_dwordx4 v[100:103], v0, s[36:39], s65 offen offset:1024 sc1
  v_rcp_f32 v22, v22
  v_mfma_f32_16x16x32_bf16 v[36:39], a[200:203], a[4:7], v[36:39]
  s_waitcnt lgkmcnt(11)
  ds_read_b64_tr_b16 a[198:199], v248 offset:14336
  v_fma_f32 v26, v26, v20, v20
  v_rcp_f32 v23, v23
  v_mfma_f32_16x16x32_bf16 v[44:47], a[208:211], a[4:7], v[44:47]
  buffer_load_dwordx4 a[52:55], v137, s[36:39], s51 offen offset:1024 sc1
  ds_read_b64_tr_b16 a[200:201], v249 offset:2048
  v_fma_f32 v27, v27, v20, v20
  v_mfma_f32_16x16x32_bf16 v[44:47], a[212:215], a[12:15], v[44:47]
  ds_read_b64_tr_b16 a[202:203], v249 offset:6144
  v_rcp_f32 v24, v24
  v_fma_f32 v28, v28, v20, v20
  v_mfma_f32_16x16x32_bf16 v[40:43], a[212:215], a[8:11], v[40:43]
  ds_read_b64_tr_b16 a[204:205], v249 offset:10240
  v_rcp_f32 v25, v25
  v_fma_f32 v29, v29, v20, v20
  v_mfma_f32_16x16x32_bf16 v[40:43], a[208:211], a[0:3], v[40:43]
  s_waitcnt vmcnt(34) lgkmcnt(11)
  s_barrier
  buffer_load_dwordx4 v135, s[24:27], s50 offen offset:2048 lds
  ds_read_b64_tr_b16 a[206:207], v249 offset:14336
  v_mfma_f32_16x16x32_bf16 v[48:51], a[176:179], a[0:3], v[48:51]
  ds_read_b64_tr_b16 a[208:209], v250 offset:2048
  v_rcp_f32 v26, v26
  v_mul_f32 v232, v120, v232
  v_mfma_f32_16x16x32_bf16 v[48:51], a[180:183], a[8:11], v[48:51]
  ds_read_b64_tr_b16 a[210:211], v250 offset:6144
  v_rcp_f32 v27, v27
  v_mul_f32 v233, v121, v233
  v_mfma_f32_16x16x32_bf16 v[52:55], a[180:183], a[12:15], v[52:55]
  ds_read_b64_tr_b16 a[212:213], v250 offset:10240
  v_rcp_f32 v28, v28
  v_mul_f32 v234, v122, v234
  v_mfma_f32_16x16x32_bf16 v[52:55], a[176:179], a[4:7], v[52:55]
  s_waitcnt lgkmcnt(11)
  buffer_load_dwordx4 a[56:59], v137, s[36:39], s51 offen offset:2048 sc1
  ds_read_b64_tr_b16 a[214:215], v250 offset:14336
  v_rcp_f32 v29, v29
  v_mfma_f32_16x16x32_bf16 v[60:63], a[184:187], a[4:7], v[60:63]
  ds_read_b64_tr_b16 a[176:177], v251 offset:2048
  v_mul_f32 v235, v123, v235
  v_mul_f32 v232, v232, v22
  v_mul_f32 v233, v233, v23
  v_mfma_f32_16x16x32_bf16 v[60:63], a[188:191], a[12:15], v[60:63]
  ds_read_b64_tr_b16 a[178:179], v251 offset:6144
  v_mul_f32 v234, v234, v24
  v_mul_f32 v235, v235, v25
  v_mul_f32 v236, v124, v236
  v_mfma_f32_16x16x32_bf16 v[56:59], a[188:191], a[8:11], v[56:59]
  ds_read_b64_tr_b16 a[180:181], v251 offset:10240
  v_mul_f32 v237, v125, v237
  v_mul_f32 v238, v126, v238
  v_mul_f32 v239, v127, v239
  v_mfma_f32_16x16x32_bf16 v[56:59], a[184:187], a[0:3], v[56:59]
  s_waitcnt lgkmcnt(11)
  buffer_load_dwordx4 v136, s[24:27], s50 offen offset:3072 lds
  ds_read_b64_tr_b16 a[182:183], v251 offset:14336
  v_cvt_pk_bf16_f32 v106, v232, v233
  v_cvt_pk_bf16_f32 v107, v234, v235
  v_mfma_f32_16x16x32_bf16 v[144:147], a[192:195], a[0:3], v[144:147]
  ds_read_b64_tr_b16 a[184:185], v240 offset:0
  v_mfma_f32_16x16x32_bf16 v[144:147], a[196:199], a[8:11], v[144:147]
  ds_read_b64_tr_b16 a[186:187], v240 offset:4096
  buffer_store_dwordx4 v[104:107], v0, s[36:39], s66 offen offset:0 sc1
  v_mul_f32 v236, v236, v26
  v_mul_f32 v237, v237, v27
  v_mfma_f32_16x16x32_bf16 v[148:151], a[196:199], a[12:15], v[148:151]
  ds_read_b64_tr_b16 a[188:189], v240 offset:8192
  v_mul_f32 v238, v238, v28
  v_mul_f32 v239, v239, v29
  v_cvt_pk_bf16_f32 v110, v236, v237
  v_mfma_f32_16x16x32_bf16 v[148:151], a[192:195], a[4:7], v[148:151]
  s_waitcnt lgkmcnt(11)
  buffer_load_dwordx4 a[60:63], v137, s[36:39], s51 offen offset:3072 sc1
  s_cmp_eq_u32 s87, 1
  s_cselect_b32 s75, 10, 38
  s_lshl_b32 s50, s75, 16
  v_mfma_f32_16x16x32_bf16 v[156:159], a[200:203], a[4:7], v[156:159]
  s_add_u32 m0, s70, 49152
  ds_read_b64_tr_b16 a[190:191], v240 offset:12288
  ds_read_b64_tr_b16 a[192:193], v241 offset:0
  v_cvt_pk_bf16_f32 v111, v238, v239
  v_mfma_f32_16x16x32_bf16 v[156:159], a[204:207], a[12:15], v[156:159]
  ds_read_b64_tr_b16 a[194:195], v241 offset:4096
  buffer_store_dwordx4 v[108:111], v0, s[36:39], s66 offen offset:1024 sc1
  v_mfma_f32_16x16x32_bf16 v[152:155], a[204:207], a[8:11], v[152:155]
  ds_read_b64_tr_b16 a[196:197], v241 offset:8192
  v_mfma_f32_16x16x32_bf16 v[152:155], a[200:203], a[0:3], v[152:155]
  s_waitcnt lgkmcnt(11)
  buffer_load_dwordx4 v133, s[24:27], s50 offen offset:0 lds
  s_lshl_b32 s51, s75, 11
  ds_read_b64_tr_b16 a[198:199], v241 offset:12288
  v_mfma_f32_16x16x32_bf16 v[160:163], a[208:211], a[0:3], v[160:163]
  ds_read_b64_tr_b16 a[200:201], v242 offset:0
  v_mfma_f32_16x16x32_bf16 v[160:163], a[212:215], a[8:11], v[160:163]
  ds_read_b64_tr_b16 a[202:203], v242 offset:4096
  v_mfma_f32_16x16x32_bf16 v[164:167], a[212:215], a[12:15], v[164:167]
  buffer_load_dwordx4 a[64:67], v137, s[36:39], s51 offen offset:0 sc1
  ds_read_b64_tr_b16 a[204:205], v242 offset:8192
  v_mfma_f32_16x16x32_bf16 v[164:167], a[208:211], a[4:7], v[164:167]
  s_waitcnt lgkmcnt(11)
  ds_read_b64_tr_b16 a[206:207], v242 offset:12288
  v_mfma_f32_16x16x32_bf16 v[172:175], a[176:179], a[4:7], v[172:175]
  ds_read_b64_tr_b16 a[208:209], v243 offset:0
  v_mfma_f32_16x16x32_bf16 v[172:175], a[180:183], a[12:15], v[172:175]
  ds_read_b64_tr_b16 a[210:211], v243 offset:4096
  v_mfma_f32_16x16x32_bf16 v[168:171], a[180:183], a[8:11], v[168:171]
  buffer_load_dwordx4 v134, s[24:27], s50 offen offset:1024 lds
  ds_read_b64_tr_b16 a[212:213], v243 offset:8192
  v_mfma_f32_16x16x32_bf16 v[168:171], a[176:179], a[0:3], v[168:171]
  s_waitcnt vmcnt(23) lgkmcnt(11)
  ds_read_b64_tr_b16 a[214:215], v243 offset:12288
  v_mfma_f32_16x16x32_bf16 v[32:35], a[184:187], a[16:19], v[32:35]
  ds_read_b64_tr_b16 a[176:177], v240 offset:2048
  v_mfma_f32_16x16x32_bf16 v[32:35], a[188:191], a[24:27], v[32:35]
  ds_read_b64_tr_b16 a[178:179], v240 offset:6144
  v_mfma_f32_16x16x32_bf16 v[36:39], a[188:191], a[28:31], v[36:39]
  buffer_load_dwordx4 a[68:71], v137, s[36:39], s51 offen offset:1024 sc1
  ds_read_b64_tr_b16 a[180:181], v240 offset:10240
  v_mfma_f32_16x16x32_bf16 v[36:39], a[184:187], a[20:23], v[36:39]
  s_waitcnt lgkmcnt(11)
  ds_read_b64_tr_b16 a[182:183], v240 offset:14336
  v_mfma_f32_16x16x32_bf16 v[44:47], a[192:195], a[20:23], v[44:47]
  ds_read_b64_tr_b16 a[184:185], v241 offset:2048
  v_mfma_f32_16x16x32_bf16 v[44:47], a[196:199], a[28:31], v[44:47]
  ds_read_b64_tr_b16 a[186:187], v241 offset:6144
  v_mfma_f32_16x16x32_bf16 v[40:43], a[196:199], a[24:27], v[40:43]
  buffer_load_dwordx4 v135, s[24:27], s50 offen offset:2048 lds
  ds_read_b64_tr_b16 a[188:189], v241 offset:10240
  v_mfma_f32_16x16x32_bf16 v[40:43], a[192:195], a[16:19], v[40:43]
  s_waitcnt vmcnt(18) lgkmcnt(11)
  s_barrier
  ds_read_b64_tr_b16 a[190:191], v241 offset:14336
  v_mfma_f32_16x16x32_bf16 v[48:51], a[200:203], a[16:19], v[48:51]
  ds_read_b64_tr_b16 a[192:193], v242 offset:2048
  v_mfma_f32_16x16x32_bf16 v[48:51], a[204:207], a[24:27], v[48:51]
  buffer_load_dwordx4 a[72:75], v137, s[36:39], s51 offen offset:2048 sc1
  ds_read_b64_tr_b16 a[194:195], v242 offset:6144
  v_mfma_f32_16x16x32_bf16 v[52:55], a[204:207], a[28:31], v[52:55]
  ds_read_b64_tr_b16 a[196:197], v242 offset:10240
  v_mfma_f32_16x16x32_bf16 v[52:55], a[200:203], a[20:23], v[52:55]
  s_waitcnt lgkmcnt(11)
  ds_read_b64_tr_b16 a[198:199], v242 offset:14336
  v_mfma_f32_16x16x32_bf16 v[60:63], a[208:211], a[20:23], v[60:63]
  ds_read_b64_tr_b16 a[200:201], v243 offset:2048
  v_mfma_f32_16x16x32_bf16 v[60:63], a[212:215], a[28:31], v[60:63]
  buffer_load_dwordx4 v136, s[24:27], s50 offen offset:3072 lds
  ds_read_b64_tr_b16 a[202:203], v243 offset:6144
  v_mfma_f32_16x16x32_bf16 v[56:59], a[212:215], a[24:27], v[56:59]
  ds_read_b64_tr_b16 a[204:205], v243 offset:10240
  v_mfma_f32_16x16x32_bf16 v[56:59], a[208:211], a[16:19], v[56:59]
  s_waitcnt lgkmcnt(11)
  ds_read_b64_tr_b16 a[206:207], v243 offset:14336
  v_mfma_f32_16x16x32_bf16 v[144:147], a[176:179], a[16:19], v[144:147]
  ds_read_b64_tr_b16 a[208:209], v240 offset:16384
  v_mfma_f32_16x16x32_bf16 v[144:147], a[180:183], a[24:27], v[144:147]
  buffer_load_dwordx4 a[76:79], v137, s[36:39], s51 offen offset:3072 sc1
  s_cmp_eq_u32 s87, 2
  v_mfma_f32_16x16x32_bf16 v[148:151], a[180:183], a[28:31], v[148:151]
  s_cselect_b32 s76, 17, 45
  s_lshl_b32 s50, s76, 16
  s_add_u32 m0, s70, 65536
  v_mfma_f32_16x16x32_bf16 v[148:151], a[176:179], a[20:23], v[148:151]
  s_waitcnt lgkmcnt(9)
  ds_read_b64_tr_b16 a[210:211], v240 offset:20480
  ds_read_b64_tr_b16 a[212:213], v240 offset:24576
  v_mfma_f32_16x16x32_bf16 v[156:159], a[184:187], a[20:23], v[156:159]
  ds_read_b64_tr_b16 a[214:215], v240 offset:28672
  ds_read_b64_tr_b16 a[176:177], v241 offset:16384
  v_mfma_f32_16x16x32_bf16 v[156:159], a[188:191], a[28:31], v[156:159]
  buffer_load_dwordx4 v133, s[24:27], s50 offen offset:0 lds
  s_lshl_b32 s51, s76, 11
  v_mfma_f32_16x16x32_bf16 v[152:155], a[188:191], a[24:27], v[152:155]
  ds_read_b64_tr_b16 a[178:179], v241 offset:20480
  ds_read_b64_tr_b16 a[180:181], v241 offset:24576
  v_mfma_f32_16x16x32_bf16 v[152:155], a[184:187], a[16:19], v[152:155]
  s_waitcnt lgkmcnt(11)
  ds_read_b64_tr_b16 a[182:183], v241 offset:28672
  v_mfma_f32_16x16x32_bf16 v[160:163], a[192:195], a[16:19], v[160:163]
  ds_read_b64_tr_b16 a[184:185], v242 offset:16384
  v_mfma_f32_16x16x32_bf16 v[160:163], a[196:199], a[24:27], v[160:163]
  buffer_load_dwordx4 a[80:83], v137, s[36:39], s51 offen offset:0 sc1
  ds_read_b64_tr_b16 a[186:187], v242 offset:20480
  v_mfma_f32_16x16x32_bf16 v[164:167], a[196:199], a[28:31], v[164:167]
  ds_read_b64_tr_b16 a[188:189], v242 offset:24576
  v_mfma_f32_16x16x32_bf16 v[164:167], a[192:195], a[20:23], v[164:167]
  s_waitcnt lgkmcnt(11)
  ds_read_b64_tr_b16 a[190:191], v242 offset:28672
  v_mfma_f32_16x16x32_bf16 v[172:175], a[200:203], a[20:23], v[172:175]
  buffer_load_dwordx4 v134, s[24:27], s50 offen offset:1024 lds
  ds_read_b64_tr_b16 a[192:193], v243 offset:16384
  v_mfma_f32_16x16x32_bf16 v[172:175], a[204:207], a[28:31], v[172:175]
  ds_read_b64_tr_b16 a[194:195], v243 offset:20480
  v_mfma_f32_16x16x32_bf16 v[168:171], a[204:207], a[24:27], v[168:171]
  ds_read_b64_tr_b16 a[196:197], v243 offset:24576
  v_mfma_f32_16x16x32_bf16 v[168:171], a[200:203], a[16:19], v[168:171]
  s_waitcnt vmcnt(23) lgkmcnt(11)
  ds_read_b64_tr_b16 a[198:199], v243 offset:28672
  v_mfma_f32_16x16x32_bf16 v[32:35], a[208:211], a[32:35], v[32:35]
  buffer_load_dwordx4 a[84:87], v137, s[36:39], s51 offen offset:1024 sc1
  ds_read_b64_tr_b16 a[200:201], v240 offset:18432
  v_mfma_f32_16x16x32_bf16 v[32:35], a[212:215], a[40:43], v[32:35]
  ds_read_b64_tr_b16 a[202:203], v240 offset:22528
  v_mfma_f32_16x16x32_bf16 v[36:39], a[212:215], a[44:47], v[36:39]
  ds_read_b64_tr_b16 a[204:205], v240 offset:26624
  v_mfma_f32_16x16x32_bf16 v[36:39], a[208:211], a[36:39], v[36:39]
  s_waitcnt lgkmcnt(11)
  ds_read_b64_tr_b16 a[206:207], v240 offset:30720
  v_mfma_f32_16x16x32_bf16 v[44:47], a[176:179], a[36:39], v[44:47]
  buffer_load_dwordx4 v135, s[24:27], s50 offen offset:2048 lds
  ds_read_b64_tr_b16 a[208:209], v241 offset:18432
  v_mfma_f32_16x16x32_bf16 v[44:47], a[180:183], a[44:47], v[44:47]
  ds_read_b64_tr_b16 a[210:211], v241 offset:22528
  v_mfma_f32_16x16x32_bf16 v[40:43], a[180:183], a[40:43], v[40:43]
  s_waitcnt vmcnt(13)
  ds_read_b64_tr_b16 a[212:213], v241 offset:26624
  v_mfma_f32_16x16x32_bf16 v[40:43], a[176:179], a[32:35], v[40:43]
  s_waitcnt vmcnt(16) lgkmcnt(11)
  s_barrier
  ds_read_b64_tr_b16 a[214:215], v241 offset:30720
  v_mfma_f32_16x16x32_bf16 v[48:51], a[184:187], a[32:35], v[48:51]
  s_mov_b64 exec, 1
  buffer_store_dword v254, v0, s[36:39], s45 offen sc1
  s_mov_b64 exec, -1
  v_mfma_f32_16x16x32_bf16 v[48:51], a[188:191], a[40:43], v[48:51]
  buffer_load_dwordx4 a[88:91], v137, s[36:39], s51 offen offset:2048 sc1
  ds_read_b64_tr_b16 a[176:177], v242 offset:18432
  v_mfma_f32_16x16x32_bf16 v[52:55], a[188:191], a[44:47], v[52:55]
  ds_read_b64_tr_b16 a[178:179], v242 offset:22528
  ds_read_b64_tr_b16 a[180:181], v242 offset:26624
  v_mfma_f32_16x16x32_bf16 v[52:55], a[184:187], a[36:39], v[52:55]
  s_waitcnt lgkmcnt(11)
  ds_read_b64_tr_b16 a[182:183], v242 offset:30720
  v_mfma_f32_16x16x32_bf16 v[60:63], a[192:195], a[36:39], v[60:63]
  buffer_load_dwordx4 v136, s[24:27], s50 offen offset:3072 lds
  ds_read_b64_tr_b16 a[184:185], v243 offset:18432
  v_mfma_f32_16x16x32_bf16 v[60:63], a[196:199], a[44:47], v[60:63]
  ds_read_b64_tr_b16 a[186:187], v243 offset:22528
  v_mfma_f32_16x16x32_bf16 v[56:59], a[196:199], a[40:43], v[56:59]
  ds_read_b64_tr_b16 a[188:189], v243 offset:26624
  v_mfma_f32_16x16x32_bf16 v[56:59], a[192:195], a[32:35], v[56:59]
  s_waitcnt lgkmcnt(11)
  buffer_load_dwordx4 a[92:95], v137, s[36:39], s51 offen offset:3072 sc1
  s_cmp_eq_u32 s87, 3
  v_mfma_f32_16x16x32_bf16 v[144:147], a[200:203], a[32:35], v[144:147]
  s_cselect_b32 s81, 24, 52
  s_lshl_b32 s50, s81, 16
  s_add_u32 m0, s70, 81920
  v_mfma_f32_16x16x32_bf16 v[144:147], a[204:207], a[40:43], v[144:147]
  ds_read_b64_tr_b16 a[190:191], v243 offset:30720
  ds_read_b64_tr_b16 a[192:193], v240 offset:32768
  v_mfma_f32_16x16x32_bf16 v[148:151], a[204:207], a[44:47], v[148:151]
  ds_read_b64_tr_b16 a[194:195], v240 offset:36864
  ds_read_b64_tr_b16 a[196:197], v240 offset:40960
  v_mfma_f32_16x16x32_bf16 v[148:151], a[200:203], a[36:39], v[148:151]
  s_waitcnt lgkmcnt(11)
  buffer_load_dwordx4 v133, s[24:27], s50 offen offset:0 lds
  s_lshl_b32 s51, s81, 11
  v_mfma_f32_16x16x32_bf16 v[156:159], a[208:211], a[36:39], v[156:159]
  ds_read_b64_tr_b16 a[198:199], v240 offset:45056
  ds_read_b64_tr_b16 a[200:201], v241 offset:32768
  v_mfma_f32_16x16x32_bf16 v[156:159], a[212:215], a[44:47], v[156:159]
  ds_read_b64_tr_b16 a[202:203], v241 offset:36864
  v_mfma_f32_16x16x32_bf16 v[152:155], a[212:215], a[40:43], v[152:155]
  ds_read_b64_tr_b16 a[204:205], v241 offset:40960
  v_mfma_f32_16x16x32_bf16 v[152:155], a[208:211], a[32:35], v[152:155]
  s_waitcnt lgkmcnt(11)
  buffer_load_dwordx4 a[96:99], v137, s[36:39], s51 offen offset:0 sc1
  ds_read_b64_tr_b16 a[206:207], v241 offset:45056
  v_mfma_f32_16x16x32_bf16 v[160:163], a[176:179], a[32:35], v[160:163]
  ds_read_b64_tr_b16 a[208:209], v242 offset:32768
  v_mfma_f32_16x16x32_bf16 v[160:163], a[180:183], a[40:43], v[160:163]
  ds_read_b64_tr_b16 a[210:211], v242 offset:36864
  v_mfma_f32_16x16x32_bf16 v[164:167], a[180:183], a[44:47], v[164:167]
  ds_read_b64_tr_b16 a[212:213], v242 offset:40960
  v_mfma_f32_16x16x32_bf16 v[164:167], a[176:179], a[36:39], v[164:167]
  s_waitcnt lgkmcnt(11)
  buffer_load_dwordx4 v134, s[24:27], s50 offen offset:1024 lds
  ds_read_b64_tr_b16 a[214:215], v242 offset:45056
  v_mfma_f32_16x16x32_bf16 v[172:175], a[184:187], a[36:39], v[172:175]
  ds_read_b64_tr_b16 a[176:177], v243 offset:32768
  v_mfma_f32_16x16x32_bf16 v[172:175], a[188:191], a[44:47], v[172:175]
  ds_read_b64_tr_b16 a[178:179], v243 offset:36864
  v_mfma_f32_16x16x32_bf16 v[168:171], a[188:191], a[40:43], v[168:171]
  ds_read_b64_tr_b16 a[180:181], v243 offset:40960
  v_mfma_f32_16x16x32_bf16 v[168:171], a[184:187], a[32:35], v[168:171]
  s_waitcnt vmcnt(21) lgkmcnt(11)
  buffer_load_dwordx4 a[100:103], v137, s[36:39], s51 offen offset:1024 sc1
  ds_read_b64_tr_b16 a[182:183], v243 offset:45056
  v_mfma_f32_16x16x32_bf16 v[32:35], a[192:195], a[48:51], v[32:35]
  ds_read_b64_tr_b16 a[184:185], v240 offset:34816
  v_mfma_f32_16x16x32_bf16 v[32:35], a[196:199], a[56:59], v[32:35]
  ds_read_b64_tr_b16 a[186:187], v240 offset:38912
  v_mfma_f32_16x16x32_bf16 v[36:39], a[196:199], a[60:63], v[36:39]
  buffer_load_dwordx4 v135, s[24:27], s50 offen offset:2048 lds
  ds_read_b64_tr_b16 a[188:189], v240 offset:43008
  v_mfma_f32_16x16x32_bf16 v[36:39], a[192:195], a[52:55], v[36:39]
  s_waitcnt lgkmcnt(11)
  ds_read_b64_tr_b16 a[190:191], v240 offset:47104
  v_mfma_f32_16x16x32_bf16 v[44:47], a[200:203], a[52:55], v[44:47]
  ds_read_b64_tr_b16 a[192:193], v241 offset:34816
  v_mfma_f32_16x16x32_bf16 v[44:47], a[204:207], a[60:63], v[44:47]
  ds_read_b64_tr_b16 a[194:195], v241 offset:38912
  v_mfma_f32_16x16x32_bf16 v[40:43], a[204:207], a[56:59], v[40:43]
Hb2_2:
  s_cbranch_execz Hb2_3
  buffer_load_dwordx4 a[104:107], v137, s[36:39], s51 offen offset:2048 sc1
  ds_read_b64_tr_b16 a[196:197], v241 offset:43008
  v_mfma_f32_16x16x32_bf16 v[40:43], a[200:203], a[48:51], v[40:43]
  s_waitcnt vmcnt(16) lgkmcnt(11)
  s_barrier
  ds_read_b64_tr_b16 a[198:199], v241 offset:47104
  v_mfma_f32_16x16x32_bf16 v[48:51], a[208:211], a[48:51], v[48:51]
  ds_read_b64_tr_b16 a[200:201], v242 offset:34816
  v_mfma_f32_16x16x32_bf16 v[48:51], a[212:215], a[56:59], v[48:51]
  ds_read_b64_tr_b16 a[202:203], v242 offset:38912
  v_mfma_f32_16x16x32_bf16 v[52:55], a[212:215], a[60:63], v[52:55]
  buffer_load_dwordx4 v136, s[24:27], s50 offen offset:3072 lds
  ds_read_b64_tr_b16 a[204:205], v242 offset:43008
  v_mfma_f32_16x16x32_bf16 v[52:55], a[208:211], a[52:55], v[52:55]
  s_waitcnt lgkmcnt(11)
  ds_read_b64_tr_b16 a[206:207], v242 offset:47104
  v_mfma_f32_16x16x32_bf16 v[60:63], a[176:179], a[52:55], v[60:63]
  ds_read_b64_tr_b16 a[208:209], v243 offset:34816
  v_mfma_f32_16x16x32_bf16 v[60:63], a[180:183], a[60:63], v[60:63]
  ds_read_b64_tr_b16 a[210:211], v243 offset:38912
  v_mfma_f32_16x16x32_bf16 v[56:59], a[180:183], a[56:59], v[56:59]
  buffer_load_dwordx4 a[108:111], v137, s[36:39], s51 offen offset:3072 sc1
  s_add_u32 s82, s87, 8
  v_mfma_f32_16x16x32_bf16 v[56:59], a[176:179], a[48:51], v[56:59]
  s_waitcnt lgkmcnt(10)
  s_and_b32 s82, s82, 3
  s_mul_i32 s82, s82, 14
  v_mfma_f32_16x16x32_bf16 v[144:147], a[184:187], a[48:51], v[144:147]
  s_lshl_b32 s50, s82, 16
  s_add_u32 s50, s50, s88
  s_add_u32 m0, s70, 98304
  v_mfma_f32_16x16x32_bf16 v[144:147], a[188:191], a[56:59], v[144:147]
  ds_read_b64_tr_b16 a[212:213], v243 offset:43008
  ds_read_b64_tr_b16 a[214:215], v243 offset:47104
  v_mfma_f32_16x16x32_bf16 v[148:151], a[188:191], a[60:63], v[148:151]
  ds_read_b64_tr_b16 a[176:177], v240 offset:49152
  ds_read_b64_tr_b16 a[178:179], v240 offset:53248
  v_mfma_f32_16x16x32_bf16 v[148:151], a[184:187], a[52:55], v[148:151]
  s_waitcnt lgkmcnt(10)
  buffer_load_dwordx4 v133, s[24:27], s50 offen offset:0 lds
  s_lshl_b32 s51, s82, 11
  v_mfma_f32_16x16x32_bf16 v[156:159], a[192:195], a[52:55], v[156:159]
  ds_read_b64_tr_b16 a[180:181], v240 offset:57344
  ds_read_b64_tr_b16 a[182:183], v240 offset:61440
  v_mfma_f32_16x16x32_bf16 v[156:159], a[196:199], a[60:63], v[156:159]
  ds_read_b64_tr_b16 a[184:185], v241 offset:49152
  ds_read_b64_tr_b16 a[186:187], v241 offset:53248
  v_mfma_f32_16x16x32_bf16 v[152:155], a[196:199], a[56:59], v[152:155]
  s_add_u32 s78, s70, 16384
  buffer_load_dwordx4 a[112:115], v137, s[36:39], s51 offen offset:0 sc1
  ds_read_b64_tr_b16 a[188:189], v241 offset:57344
  v_mfma_f32_16x16x32_bf16 v[152:155], a[192:195], a[48:51], v[152:155]
  s_waitcnt lgkmcnt(11)
  ds_read_b64_tr_b16 a[190:191], v241 offset:61440
  v_and_b32 v129, 15, v128
  v_mfma_f32_16x16x32_bf16 v[160:163], a[200:203], a[48:51], v[160:163]
  ds_read_b64_tr_b16 a[192:193], v242 offset:49152
  v_lshrrev_b32 v131, 1, v129
  v_mfma_f32_16x16x32_bf16 v[160:163], a[204:207], a[56:59], v[160:163]
  buffer_load_dwordx4 v134, s[24:27], s50 offen offset:1024 lds
  ds_read_b64_tr_b16 a[194:195], v242 offset:53248
  v_mfma_f32_16x16x32_bf16 v[164:167], a[204:207], a[60:63], v[164:167]
  ds_read_b64_tr_b16 a[196:197], v242 offset:57344
  v_lshrrev_b32 v130, 5, v128
  v_mfma_f32_16x16x32_bf16 v[164:167], a[200:203], a[52:55], v[164:167]
  s_waitcnt lgkmcnt(11)
  ds_read_b64_tr_b16 a[198:199], v242 offset:61440
  v_xor_b32 v131, v131, v130
  v_mfma_f32_16x16x32_bf16 v[172:175], a[208:211], a[52:55], v[172:175]
  ds_read_b64_tr_b16 a[200:201], v243 offset:49152
  v_lshlrev_b32 v131, 4, v131
  v_mfma_f32_16x16x32_bf16 v[172:175], a[212:215], a[60:63], v[172:175]
  buffer_load_dwordx4 a[116:119], v137, s[36:39], s51 offen offset:1024 sc1
  ds_read_b64_tr_b16 a[202:203], v243 offset:53248
  v_mfma_f32_16x16x32_bf16 v[168:171], a[212:215], a[56:59], v[168:171]
  ds_read_b64_tr_b16 a[204:205], v243 offset:57344
  v_lshl_add_u32 v131, v129, 7, v131
  v_mfma_f32_16x16x32_bf16 v[168:171], a[208:211], a[48:51], v[168:171]
  s_waitcnt vmcnt(21) lgkmcnt(11)
  ds_read_b64_tr_b16 a[206:207], v243 offset:61440
  v_bfe_u32 v130, v128, 4, 1
  v_mfma_f32_16x16x32_bf16 v[32:35], a[176:179], a[64:67], v[32:35]
  ds_read_b64_tr_b16 a[208:209], v240 offset:51200
  v_lshl_add_u32 v131, v130, 3, v131
  v_mfma_f32_16x16x32_bf16 v[32:35], a[180:183], a[72:75], v[32:35]
  buffer_load_dwordx4 v135, s[24:27], s50 offen offset:2048 lds
  s_add_u32 s51, s51, 12288
  v_mfma_f32_16x16x32_bf16 v[36:39], a[180:183], a[76:79], v[36:39]
  ds_read_b64_tr_b16 a[210:211], v240 offset:55296
  ds_read_b64_tr_b16 a[212:213], v240 offset:59392
  v_mfma_f32_16x16x32_bf16 v[36:39], a[176:179], a[68:71], v[36:39]
  s_waitcnt lgkmcnt(11)
  ds_read_b64_tr_b16 a[214:215], v240 offset:63488
  v_add_u32 v140, s78, v131
  v_mfma_f32_16x16x32_bf16 v[44:47], a[184:187], a[68:71], v[44:47]
  ds_read_b64_tr_b16 a[176:177], v241 offset:51200
  v_xor_b32 v141, 32, v140
  v_mfma_f32_16x16x32_bf16 v[44:47], a[188:191], a[76:79], v[44:47]
  buffer_load_dwordx4 a[120:123], v137, s[36:39], s51 offen offset:2048 sc1
  ds_read_b64_tr_b16 a[178:179], v241 offset:55296
  v_mfma_f32_16x16x32_bf16 v[40:43], a[188:191], a[72:75], v[40:43]
  ds_read_b64_tr_b16 a[180:181], v241 offset:59392
  v_xor_b32 v142, 64, v140
  v_mfma_f32_16x16x32_bf16 v[40:43], a[184:187], a[64:67], v[40:43]
  s_waitcnt vmcnt(15) lgkmcnt(11)
  s_barrier
  ds_read_b64_tr_b16 a[182:183], v241 offset:63488
  v_mfma_f32_16x16x32_bf16 v[48:51], a[192:195], a[64:67], v[48:51]
  ds_read_b64_tr_b16 a[184:185], v242 offset:51200
  v_xor_b32 v143, 96, v140
  v_mfma_f32_16x16x32_bf16 v[48:51], a[196:199], a[72:75], v[48:51]
  buffer_load_dwordx4 v136, s[24:27], s50 offen offset:3072 lds
  ds_read_b64_tr_b16 a[186:187], v242 offset:55296
  v_mfma_f32_16x16x32_bf16 v[52:55], a[196:199], a[76:79], v[52:55]
  ds_read_b64_tr_b16 a[188:189], v242 offset:59392
  v_add_u32 v255, s78, v0
  v_mfma_f32_16x16x32_bf16 v[52:55], a[192:195], a[68:71], v[52:55]
  s_waitcnt lgkmcnt(11)
  ds_read_b64_tr_b16 a[190:191], v242 offset:63488
  s_lshl_b32 s78, s44, 10
  v_mfma_f32_16x16x32_bf16 v[60:63], a[200:203], a[68:71], v[60:63]
  s_add_u32 s78, s78, 151552
  buffer_load_dwordx4 a[124:127], v137, s[36:39], s51 offen offset:3072 sc1
  s_add_u32 s83, s87, 9
  v_mfma_f32_16x16x32_bf16 v[60:63], a[204:207], a[76:79], v[60:63]
  s_and_b32 s83, s83, 3
  s_mul_i32 s83, s83, 14
  s_lshl_b32 s50, s83, 16
  v_mfma_f32_16x16x32_bf16 v[56:59], a[204:207], a[72:75], v[56:59]
  s_add_u32 s50, s50, s88
  s_add_u32 m0, s70, 114688
  ds_read_b64_tr_b16 a[192:193], v243 offset:51200
  v_mfma_f32_16x16x32_bf16 v[56:59], a[200:203], a[64:67], v[56:59]
  s_waitcnt lgkmcnt(9)
  ds_read_b64_tr_b16 a[194:195], v243 offset:55296
  ds_read_b64_tr_b16 a[196:197], v243 offset:59392
  v_mfma_f32_16x16x32_bf16 v[144:147], a[208:211], a[64:67], v[144:147]
  ds_read_b64_tr_b16 a[198:199], v243 offset:63488
  buffer_load_dwordx4 v133, s[24:27], s50 offen offset:0 lds
  v_mfma_f32_16x16x32_bf16 v[144:147], a[212:215], a[72:75], v[144:147]
  s_lshl_b32 s51, s83, 11
  ds_read_b64_tr_b16 a[200:201], v244 offset:0
  ds_read_b64_tr_b16 a[202:203], v244 offset:4096
  v_mfma_f32_16x16x32_bf16 v[148:151], a[212:215], a[76:79], v[148:151]
  ds_read_b64_tr_b16 a[204:205], v244 offset:8192
  v_add_u32 v129, s78, v0
  v_mfma_f32_16x16x32_bf16 v[148:151], a[208:211], a[68:71], v[148:151]
  s_waitcnt lgkmcnt(11)
  ds_read_b64_tr_b16 a[206:207], v244 offset:12288
  v_lshrrev_b32 v130, 4, v128
  v_mfma_f32_16x16x32_bf16 v[156:159], a[176:179], a[68:71], v[156:159]
  buffer_load_dwordx4 a[216:219], v137, s[36:39], s51 offen offset:0 sc1
  ds_read_b64_tr_b16 a[208:209], v245 offset:0
  v_mfma_f32_16x16x32_bf16 v[156:159], a[180:183], a[76:79], v[156:159]
  ds_read_b64_tr_b16 a[210:211], v245 offset:4096
  v_lshl_add_u32 v130, v130, 4, s78
  v_mfma_f32_16x16x32_bf16 v[152:155], a[180:183], a[72:75], v[152:155]
  ds_read_b64_tr_b16 a[212:213], v245 offset:8192
  ds_write_b128 v129, a[248:251]
  v_mfma_f32_16x16x32_bf16 v[152:155], a[176:179], a[64:67], v[152:155]
  s_waitcnt lgkmcnt(12)
  ds_read_b64_tr_b16 a[214:215], v245 offset:12288
  ds_read_b128 v[176:179], v130 offset:768
  v_mfma_f32_16x16x32_bf16 v[160:163], a[184:187], a[64:67], v[160:163]
  buffer_load_dwordx4 v134, s[24:27], s50 offen offset:1024 lds
  ds_read_b64_tr_b16 a[176:177], v246 offset:0
  v_mfma_f32_16x16x32_bf16 v[160:163], a[188:191], a[72:75], v[160:163]
  ds_read_b64_tr_b16 a[178:179], v246 offset:4096
  ds_read_b128 v[180:183], v130 offset:832
  v_mfma_f32_16x16x32_bf16 v[164:167], a[188:191], a[76:79], v[164:167]
  ds_read_b64_tr_b16 a[180:181], v246 offset:8192
  ds_read_b128 v[184:187], v130 offset:896
  v_mfma_f32_16x16x32_bf16 v[164:167], a[184:187], a[68:71], v[164:167]
  s_waitcnt lgkmcnt(15)
  ds_read_b64_tr_b16 a[182:183], v246 offset:12288
  ds_read_b128 v[188:191], v130 offset:960
  v_mfma_f32_16x16x32_bf16 v[172:175], a[192:195], a[68:71], v[172:175]
  buffer_load_dwordx4 a[220:223], v137, s[36:39], s51 offen offset:1024 sc1
  ds_read_b64_tr_b16 a[184:185], v247 offset:0
  v_mfma_f32_16x16x32_bf16 v[172:175], a[196:199], a[76:79], v[172:175]
  ds_read_b64_tr_b16 a[186:187], v247 offset:4096
  v_accvgpr_read_b32 v131, a232
  v_mfma_f32_16x16x32_bf16 v[168:171], a[196:199], a[72:75], v[168:171]
  ds_read_b64_tr_b16 a[188:189], v247 offset:8192
  v_lshlrev_b32 v64, 16, v131
  v_mfma_f32_16x16x32_bf16 v[168:171], a[192:195], a[64:67], v[168:171]
  s_waitcnt vmcnt(20) lgkmcnt(15)
  buffer_load_dwordx4 v135, s[24:27], s50 offen offset:2048 lds
  s_add_u32 s51, s51, 12288
  v_mfma_f32_16x16x32_bf16 v[32:35], a[200:203], a[80:83], v[32:35]
  ds_read_b64_tr_b16 a[190:191], v247 offset:12288
  ds_read_b64_tr_b16 a[192:193], v244 offset:2048
  v_mfma_f32_16x16x32_bf16 v[32:35], a[204:207], a[88:91], v[32:35]
  ds_read_b64_tr_b16 a[194:195], v244 offset:6144
  v_and_b32 v65, 0xffff0000, v131
  v_mfma_f32_16x16x32_bf16 v[36:39], a[204:207], a[92:95], v[36:39]
  ds_read_b64_tr_b16 a[196:197], v244 offset:10240
  v_accvgpr_read_b32 v131, a233
  v_mfma_f32_16x16x32_bf16 v[36:39], a[200:203], a[84:87], v[36:39]
  s_waitcnt lgkmcnt(15)
  buffer_load_dwordx4 a[224:227], v137, s[36:39], s51 offen offset:2048 sc1
  ds_read_b64_tr_b16 a[198:199], v244 offset:14336
  v_mfma_f32_16x16x32_bf16 v[44:47], a[208:211], a[84:87], v[44:47]
  ds_read_b64_tr_b16 a[200:201], v245 offset:2048
  v_lshlrev_b32 v66, 16, v131
  v_mfma_f32_16x16x32_bf16 v[44:47], a[212:215], a[92:95], v[44:47]
  ds_read_b64_tr_b16 a[202:203], v245 offset:6144
  v_and_b32 v67, 0xffff0000, v131
  v_mfma_f32_16x16x32_bf16 v[40:43], a[212:215], a[88:91], v[40:43]
  ds_read_b64_tr_b16 a[204:205], v245 offset:10240
  v_accvgpr_read_b32 v131, a234
  v_mfma_f32_16x16x32_bf16 v[40:43], a[208:211], a[80:83], v[40:43]
  s_waitcnt vmcnt(15) lgkmcnt(12)
  s_barrier
  buffer_load_dwordx4 v136, s[24:27], s50 offen offset:3072 lds
  v_mfma_f32_16x16x32_bf16 v[48:51], a[176:179], a[80:83], v[48:51]
  ds_read_b64_tr_b16 a[206:207], v245 offset:14336
  ds_read_b64_tr_b16 a[208:209], v246 offset:2048
  v_mfma_f32_16x16x32_bf16 v[48:51], a[180:183], a[88:91], v[48:51]
  ds_read_b64_tr_b16 a[210:211], v246 offset:6144
  v_lshlrev_b32 v68, 16, v131
  v_mfma_f32_16x16x32_bf16 v[52:55], a[180:183], a[92:95], v[52:55]
  ds_read_b64_tr_b16 a[212:213], v246 offset:10240
  v_and_b32 v69, 0xffff0000, v131
  v_mfma_f32_16x16x32_bf16 v[52:55], a[176:179], a[84:87], v[52:55]
  s_waitcnt lgkmcnt(11)
  buffer_load_dwordx4 a[228:231], v137, s[36:39], s51 offen offset:3072 sc1
  s_add_u32 s69, s87, 10
  v_mfma_f32_16x16x32_bf16 v[60:63], a[184:187], a[84:87], v[60:63]
  s_and_b32 s69, s69, 3
  s_mul_i32 s69, s69, 14
  s_lshl_b32 s50, s69, 16
  v_mfma_f32_16x16x32_bf16 v[60:63], a[188:191], a[92:95], v[60:63]
  s_add_u32 s50, s50, s88
  s_add_u32 m0, s70, 131072
  ds_read_b64_tr_b16 a[214:215], v246 offset:14336
  v_mfma_f32_16x16x32_bf16 v[56:59], a[188:191], a[88:91], v[56:59]
  ds_read_b64_tr_b16 a[176:177], v247 offset:2048
  ds_read_b64_tr_b16 a[178:179], v247 offset:6144
  v_mfma_f32_16x16x32_bf16 v[56:59], a[184:187], a[80:83], v[56:59]
  s_waitcnt lgkmcnt(10)
  ds_read_b64_tr_b16 a[180:181], v247 offset:10240
  buffer_load_dwordx4 v133, s[24:27], s50 offen offset:0 lds
  v_mfma_f32_16x16x32_bf16 v[144:147], a[192:195], a[80:83], v[144:147]
  s_lshl_b32 s51, s69, 11
  ds_read_b64_tr_b16 a[182:183], v247 offset:14336
  ds_read_b64_tr_b16 a[184:185], v244 offset:16384
  v_mfma_f32_16x16x32_bf16 v[144:147], a[196:199], a[88:91], v[144:147]
  ds_read_b64_tr_b16 a[186:187], v244 offset:20480
  v_accvgpr_read_b32 v131, a235
  v_mfma_f32_16x16x32_bf16 v[148:151], a[196:199], a[92:95], v[148:151]
  buffer_load_dwordx4 a[0:3], v137, s[36:39], s51 offen offset:0 sc1
  ds_read_b64_tr_b16 a[188:189], v244 offset:24576
  v_mfma_f32_16x16x32_bf16 v[148:151], a[192:195], a[84:87], v[148:151]
  s_waitcnt lgkmcnt(11)
  ds_read_b64_tr_b16 a[190:191], v244 offset:28672
  v_lshlrev_b32 v70, 16, v131
  v_mfma_f32_16x16x32_bf16 v[156:159], a[200:203], a[84:87], v[156:159]
  ds_read_b64_tr_b16 a[192:193], v245 offset:16384
  v_and_b32 v71, 0xffff0000, v131
  v_mfma_f32_16x16x32_bf16 v[156:159], a[204:207], a[92:95], v[156:159]
  ds_read_b64_tr_b16 a[194:195], v245 offset:20480
  v_accvgpr_read_b32 v131, a236
  v_mfma_f32_16x16x32_bf16 v[152:155], a[204:207], a[88:91], v[152:155]
  buffer_load_dwordx4 v134, s[24:27], s50 offen offset:1024 lds
  ds_read_b64_tr_b16 a[196:197], v245 offset:24576
  v_mfma_f32_16x16x32_bf16 v[152:155], a[200:203], a[80:83], v[152:155]
  s_waitcnt lgkmcnt(11)
  ds_read_b64_tr_b16 a[198:199], v245 offset:28672
  v_lshlrev_b32 v72, 16, v131
  v_mfma_f32_16x16x32_bf16 v[160:163], a[208:211], a[80:83], v[160:163]
  ds_read_b64_tr_b16 a[200:201], v246 offset:16384
  v_and_b32 v73, 0xffff0000, v131
  v_mfma_f32_16x16x32_bf16 v[160:163], a[212:215], a[88:91], v[160:163]
  ds_read_b64_tr_b16 a[202:203], v246 offset:20480
  v_accvgpr_read_b32 v131, a237
  v_mfma_f32_16x16x32_bf16 v[164:167], a[212:215], a[92:95], v[164:167]
  buffer_load_dword v139, v138, s[36:39], s91 offen sc1
  ds_read_b64_tr_b16 a[204:205], v246 offset:24576
  v_mfma_f32_16x16x32_bf16 v[164:167], a[208:211], a[84:87], v[164:167]
  s_waitcnt lgkmcnt(11)
  ds_read_b64_tr_b16 a[206:207], v246 offset:28672
  v_lshlrev_b32 v74, 16, v131
  v_mfma_f32_16x16x32_bf16 v[172:175], a[176:179], a[84:87], v[172:175]
  ds_read_b64_tr_b16 a[208:209], v247 offset:16384
  v_and_b32 v75, 0xffff0000, v131
  v_mfma_f32_16x16x32_bf16 v[172:175], a[180:183], a[92:95], v[172:175]
  buffer_load_dwordx4 a[4:7], v137, s[36:39], s51 offen offset:1024 sc1
  ds_read_b64_tr_b16 a[210:211], v247 offset:20480
  v_mfma_f32_16x16x32_bf16 v[168:171], a[180:183], a[88:91], v[168:171]
  ds_read_b64_tr_b16 a[212:213], v247 offset:24576
  v_accvgpr_read_b32 v131, a238
  v_mfma_f32_16x16x32_bf16 v[168:171], a[176:179], a[80:83], v[168:171]
  s_waitcnt vmcnt(21) lgkmcnt(11)
  ds_read_b64_tr_b16 a[214:215], v247 offset:28672
  v_lshlrev_b32 v76, 16, v131
  v_mfma_f32_16x16x32_bf16 v[32:35], a[184:187], a[96:99], v[32:35]
  buffer_load_dwordx4 v135, s[24:27], s50 offen offset:2048 lds
  s_add_u32 s51, s51, 12288
  v_mfma_f32_16x16x32_bf16 v[32:35], a[188:191], a[104:107], v[32:35]
  ds_read_b64_tr_b16 a[176:177], v244 offset:18432
  ds_read_b64_tr_b16 a[178:179], v244 offset:22528
  v_mfma_f32_16x16x32_bf16 v[36:39], a[188:191], a[108:111], v[36:39]
  ds_read_b64_tr_b16 a[180:181], v244 offset:26624
  v_and_b32 v77, 0xffff0000, v131
  v_mfma_f32_16x16x32_bf16 v[36:39], a[184:187], a[100:103], v[36:39]
  s_waitcnt lgkmcnt(11)
  buffer_load_dwordx4 a[8:11], v137, s[36:39], s51 offen offset:2048 sc1
  ds_read_b64_tr_b16 a[182:183], v244 offset:30720
  v_mfma_f32_16x16x32_bf16 v[44:47], a[192:195], a[100:103], v[44:47]
  ds_read_b64_tr_b16 a[184:185], v245 offset:18432
  v_accvgpr_read_b32 v131, a239
  v_mfma_f32_16x16x32_bf16 v[44:47], a[196:199], a[108:111], v[44:47]
  ds_read_b64_tr_b16 a[186:187], v245 offset:22528
  v_lshlrev_b32 v78, 16, v131
  v_mfma_f32_16x16x32_bf16 v[40:43], a[196:199], a[104:107], v[40:43]
  buffer_load_dwordx4 v136, s[24:27], s50 offen offset:3072 lds
  ds_read_b64_tr_b16 a[188:189], v245 offset:26624
  v_mfma_f32_16x16x32_bf16 v[40:43], a[192:195], a[96:99], v[40:43]
  s_waitcnt vmcnt(17) lgkmcnt(11)
  s_barrier
  ds_read_b64_tr_b16 a[190:191], v245 offset:30720
  v_mfma_f32_16x16x32_bf16 v[48:51], a[200:203], a[96:99], v[48:51]
  ds_read_b64_tr_b16 a[192:193], v246 offset:18432
  v_and_b32 v79, 0xffff0000, v131
  v_mfma_f32_16x16x32_bf16 v[48:51], a[204:207], a[104:107], v[48:51]
  buffer_load_dwordx4 a[12:15], v137, s[36:39], s51 offen offset:3072 sc1
  s_add_u32 s71, s87, 11
  v_mfma_f32_16x16x32_bf16 v[52:55], a[204:207], a[108:111], v[52:55]
  s_and_b32 s71, s71, 3
  s_mul_i32 s71, s71, 14
  s_lshl_b32 s50, s71, 16
  v_mfma_f32_16x16x32_bf16 v[52:55], a[200:203], a[100:103], v[52:55]
  s_waitcnt lgkmcnt(9)
  s_add_u32 s50, s50, s88
  s_add_u32 m0, s70, 0
  v_mfma_f32_16x16x32_bf16 v[60:63], a[208:211], a[100:103], v[60:63]
  ds_read_b64_tr_b16 a[194:195], v246 offset:22528
  ds_read_b64_tr_b16 a[196:197], v246 offset:26624
  v_mfma_f32_16x16x32_bf16 v[60:63], a[212:215], a[108:111], v[60:63]
  ds_read_b64_tr_b16 a[198:199], v246 offset:30720
  ds_read_b64_tr_b16 a[200:201], v247 offset:18432
  v_mfma_f32_16x16x32_bf16 v[56:59], a[212:215], a[104:107], v[56:59]
  buffer_load_dwordx4 v133, s[24:27], s50 offen offset:0 lds
  s_lshl_b32 s51, s71, 11
  v_mfma_f32_16x16x32_bf16 v[56:59], a[208:211], a[96:99], v[56:59]
  s_waitcnt lgkmcnt(9)
  ds_read_b64_tr_b16 a[202:203], v247 offset:22528
  ds_read_b64_tr_b16 a[204:205], v247 offset:26624
  v_mfma_f32_16x16x32_bf16 v[144:147], a[176:179], a[96:99], v[144:147]
  ds_read_b64_tr_b16 a[206:207], v247 offset:30720
  ds_read_b64_tr_b16 a[208:209], v244 offset:32768
  v_mfma_f32_16x16x32_bf16 v[144:147], a[180:183], a[104:107], v[144:147]
  buffer_load_dwordx4 a[16:19], v137, s[36:39], s51 offen offset:0 sc1
  ds_read_b64_tr_b16 a[210:211], v244 offset:36864
  v_mfma_f32_16x16x32_bf16 v[148:151], a[180:183], a[108:111], v[148:151]
  ds_read_b64_tr_b16 a[212:213], v244 offset:40960
  v_accvgpr_read_b32 v131, a240
  v_mfma_f32_16x16x32_bf16 v[148:151], a[176:179], a[100:103], v[148:151]
  s_waitcnt lgkmcnt(11)
  ds_read_b64_tr_b16 a[214:215], v244 offset:45056
  v_lshlrev_b32 v80, 16, v131
  v_mfma_f32_16x16x32_bf16 v[156:159], a[184:187], a[100:103], v[156:159]
  ds_read_b64_tr_b16 a[176:177], v245 offset:32768
  v_and_b32 v81, 0xffff0000, v131
  v_mfma_f32_16x16x32_bf16 v[156:159], a[188:191], a[108:111], v[156:159]
  buffer_load_dwordx4 v134, s[24:27], s50 offen offset:1024 lds
  ds_read_b64_tr_b16 a[178:179], v245 offset:36864
  v_mfma_f32_16x16x32_bf16 v[152:155], a[188:191], a[104:107], v[152:155]
  ds_read_b64_tr_b16 a[180:181], v245 offset:40960
  v_accvgpr_read_b32 v131, a241
  v_mfma_f32_16x16x32_bf16 v[152:155], a[184:187], a[96:99], v[152:155]
  s_waitcnt lgkmcnt(11)
  ds_read_b64_tr_b16 a[182:183], v245 offset:45056
  v_lshlrev_b32 v82, 16, v131
  v_mfma_f32_16x16x32_bf16 v[160:163], a[192:195], a[96:99], v[160:163]
  buffer_load_dwordx4 a[20:23], v137, s[36:39], s51 offen offset:1024 sc1
  ds_read_b64_tr_b16 a[184:185], v246 offset:32768
  v_mfma_f32_16x16x32_bf16 v[160:163], a[196:199], a[104:107], v[160:163]
  ds_read_b64_tr_b16 a[186:187], v246 offset:36864
  v_and_b32 v83, 0xffff0000, v131
  v_mfma_f32_16x16x32_bf16 v[164:167], a[196:199], a[108:111], v[164:167]
  ds_read_b64_tr_b16 a[188:189], v246 offset:40960
  v_accvgpr_read_b32 v131, a242
  v_mfma_f32_16x16x32_bf16 v[164:167], a[192:195], a[100:103], v[164:167]
  s_waitcnt lgkmcnt(11)
  ds_read_b64_tr_b16 a[190:191], v246 offset:45056
  v_lshlrev_b32 v84, 16, v131
  v_mfma_f32_16x16x32_bf16 v[172:175], a[200:203], a[100:103], v[172:175]
  buffer_load_dwordx4 v135, s[24:27], s50 offen offset:2048 lds
  s_add_u32 s51, s51, 12288
  v_mfma_f32_16x16x32_bf16 v[172:175], a[204:207], a[108:111], v[172:175]
  ds_read_b64_tr_b16 a[192:193], v247 offset:32768
  ds_read_b64_tr_b16 a[194:195], v247 offset:36864
  v_mfma_f32_16x16x32_bf16 v[168:171], a[204:207], a[104:107], v[168:171]
  ds_read_b64_tr_b16 a[196:197], v247 offset:40960
  v_and_b32 v85, 0xffff0000, v131
  v_mfma_f32_16x16x32_bf16 v[168:171], a[200:203], a[96:99], v[168:171]
  s_waitcnt vmcnt(22) lgkmcnt(11)
  ds_read_b64_tr_b16 a[198:199], v247 offset:45056
  v_accvgpr_read_b32 v131, a243
  v_mfma_f32_16x16x32_bf16 v[32:35], a[208:211], a[112:115], v[32:35]
  buffer_load_dwordx4 a[24:27], v137, s[36:39], s51 offen offset:2048 sc1
  ds_read_b64_tr_b16 a[200:201], v244 offset:34816
  v_mfma_f32_16x16x32_bf16 v[32:35], a[212:215], a[120:123], v[32:35]
  ds_read_b64_tr_b16 a[202:203], v244 offset:38912
  v_lshlrev_b32 v86, 16, v131
  v_mfma_f32_16x16x32_bf16 v[36:39], a[212:215], a[124:127], v[36:39]
  ds_read_b64_tr_b16 a[204:205], v244 offset:43008
  v_and_b32 v87, 0xffff0000, v131
  v_mfma_f32_16x16x32_bf16 v[36:39], a[208:211], a[116:119], v[36:39]
  s_waitcnt lgkmcnt(11)
  ds_read_b64_tr_b16 a[206:207], v244 offset:47104
  v_accvgpr_read_b32 v131, a244
  v_mfma_f32_16x16x32_bf16 v[44:47], a[176:179], a[116:119], v[44:47]
  buffer_load_dwordx4 v136, s[24:27], s50 offen offset:3072 lds
  ds_read_b64_tr_b16 a[208:209], v245 offset:34816
  v_mfma_f32_16x16x32_bf16 v[44:47], a[180:183], a[124:127], v[44:47]
  ds_read_b64_tr_b16 a[210:211], v245 offset:38912
  v_lshlrev_b32 v88, 16, v131
  v_mfma_f32_16x16x32_bf16 v[40:43], a[180:183], a[120:123], v[40:43]
  ds_read_b64_tr_b16 a[212:213], v245 offset:43008
  v_and_b32 v89, 0xffff0000, v131
  v_mfma_f32_16x16x32_bf16 v[40:43], a[176:179], a[112:115], v[40:43]
  s_waitcnt vmcnt(17) lgkmcnt(11)
  s_barrier
  ds_read_b64_tr_b16 a[214:215], v245 offset:47104
  v_mfma_f32_16x16x32_bf16 v[48:51], a[184:187], a[112:115], v[48:51]
  buffer_load_dwordx4 a[28:31], v137, s[36:39], s51 offen offset:3072 sc1
  s_mov_b32 s72, 1
  v_mfma_f32_16x16x32_bf16 v[48:51], a[188:191], a[120:123], v[48:51]
  s_lshl_b32 s50, s72, 16
  s_add_u32 m0, s70, 16384
  ds_read_b64_tr_b16 a[176:177], v246 offset:34816
  v_mfma_f32_16x16x32_bf16 v[52:55], a[188:191], a[124:127], v[52:55]
  ds_read_b64_tr_b16 a[178:179], v246 offset:38912
  ds_read_b64_tr_b16 a[180:181], v246 offset:43008
  v_mfma_f32_16x16x32_bf16 v[52:55], a[184:187], a[116:119], v[52:55]
  s_waitcnt lgkmcnt(11)
  buffer_load_dwordx4 v133, s[24:27], s50 offen offset:0 lds
  ds_read_b64_tr_b16 a[182:183], v246 offset:47104
  v_mfma_f32_16x16x32_bf16 v[60:63], a[192:195], a[116:119], v[60:63]
  s_waitcnt vmcnt(14)
  v_cmp_ne_u32 vcc, s3, v139
  s_nop 4
  s_cbranch_vccnz CK8s
CK8x:
  v_mfma_f32_16x16x32_bf16 v[60:63], a[196:199], a[124:127], v[60:63]
  s_lshl_b32 s51, s72, 11
  ds_read_b64_tr_b16 a[184:185], v247 offset:34816
  ds_read_b64_tr_b16 a[186:187], v247 offset:38912
  v_mfma_f32_16x16x32_bf16 v[56:59], a[196:199], a[120:123], v[56:59]
  ds_read_b64_tr_b16 a[188:189], v247 offset:43008
  v_accvgpr_read_b32 v131, a245
  v_mfma_f32_16x16x32_bf16 v[56:59], a[192:195], a[112:115], v[56:59]
  s_waitcnt lgkmcnt(11)
  buffer_load_dwordx4 a[32:35], v137, s[36:39], s51 offen offset:0 sc1
  ds_read_b64_tr_b16 a[190:191], v247 offset:47104
  v_mfma_f32_16x16x32_bf16 v[144:147], a[200:203], a[112:115], v[144:147]
  ds_read_b64_tr_b16 a[192:193], v244 offset:49152
  v_lshlrev_b32 v90, 16, v131
  v_mfma_f32_16x16x32_bf16 v[144:147], a[204:207], a[120:123], v[144:147]
  ds_read_b64_tr_b16 a[194:195], v244 offset:53248
  v_and_b32 v91, 0xffff0000, v131
  v_mfma_f32_16x16x32_bf16 v[148:151], a[204:207], a[124:127], v[148:151]
  ds_read_b64_tr_b16 a[196:197], v244 offset:57344
  v_accvgpr_read_b32 v131, a246
  v_mfma_f32_16x16x32_bf16 v[148:151], a[200:203], a[116:119], v[148:151]
  s_waitcnt lgkmcnt(11)
  buffer_load_dwordx4 v134, s[24:27], s50 offen offset:1024 lds
  ds_read_b64_tr_b16 a[198:199], v244 offset:61440
  v_mfma_f32_16x16x32_bf16 v[156:159], a[208:211], a[116:119], v[156:159]
  ds_read_b64_tr_b16 a[200:201], v245 offset:49152
  v_lshlrev_b32 v92, 16, v131
  v_mfma_f32_16x16x32_bf16 v[156:159], a[212:215], a[124:127], v[156:159]
  ds_read_b64_tr_b16 a[202:203], v245 offset:53248
  v_and_b32 v93, 0xffff0000, v131
  v_mfma_f32_16x16x32_bf16 v[152:155], a[212:215], a[120:123], v[152:155]
  ds_read_b64_tr_b16 a[204:205], v245 offset:57344
  v_accvgpr_read_b32 v131, a247
  v_mfma_f32_16x16x32_bf16 v[152:155], a[208:211], a[112:115], v[152:155]
  s_waitcnt lgkmcnt(11)
  buffer_load_dwordx4 a[36:39], v137, s[36:39], s51 offen offset:1024 sc1
  ds_read_b64_tr_b16 a[206:207], v245 offset:61440
  v_mfma_f32_16x16x32_bf16 v[160:163], a[176:179], a[112:115], v[160:163]
  ds_read_b64_tr_b16 a[208:209], v246 offset:49152
  v_lshlrev_b32 v94, 16, v131
  v_mfma_f32_16x16x32_bf16 v[160:163], a[180:183], a[120:123], v[160:163]
  ds_read_b64_tr_b16 a[210:211], v246 offset:53248
  v_and_b32 v95, 0xffff0000, v131
  v_mfma_f32_16x16x32_bf16 v[164:167], a[180:183], a[124:127], v[164:167]
  s_add_u32 s49, s55, 32768
  ds_read_b64_tr_b16 a[212:213], v246 offset:57344
  s_lshl_b32 s78, s2, 5
  v_mfma_f32_16x16x32_bf16 v[164:167], a[176:179], a[116:119], v[164:167]
  s_waitcnt lgkmcnt(11)
  buffer_load_dwordx4 v135, s[24:27], s50 offen offset:2048 lds
  ds_read_b64_tr_b16 a[214:215], v246 offset:61440
  v_mfma_f32_16x16x32_bf16 v[172:175], a[184:187], a[116:119], v[172:175]
  s_add_u32 s78, s78, s44
  ds_read_b64_tr_b16 a[176:177], v247 offset:49152
  s_lshl2_add_u32 s78, s78, 5472256
  v_mfma_f32_16x16x32_bf16 v[172:175], a[188:191], a[124:127], v[172:175]
  s_xor_b32 s79, s78, 128
  ds_read_b64_tr_b16 a[178:179], v247 offset:53248
  v_mov_b32 v132, 0
  v_mfma_f32_16x16x32_bf16 v[168:171], a[188:191], a[120:123], v[168:171]
  ds_read_b64_tr_b16 a[180:181], v247 offset:57344
  v_mfma_f32_16x16x32_bf16 v[168:171], a[184:187], a[112:115], v[168:171]
  s_waitcnt vmcnt(22) lgkmcnt(11)
  buffer_load_dwordx4 a[40:43], v137, s[36:39], s51 offen offset:2048 sc1
  ds_read_b64_tr_b16 a[182:183], v247 offset:61440
  v_mfma_f32_16x16x32_bf16 v[32:35], a[192:195], a[216:219], v[32:35]
  ds_read_b64_tr_b16 a[184:185], v244 offset:51200
  v_mfma_f32_16x16x32_bf16 v[32:35], a[196:199], a[224:227], v[32:35]
  ds_read_b64_tr_b16 a[186:187], v244 offset:55296
  v_mfma_f32_16x16x32_bf16 v[36:39], a[196:199], a[228:231], v[36:39]
  buffer_load_dwordx4 v136, s[24:27], s50 offen offset:3072 lds
  ds_read_b64_tr_b16 a[188:189], v244 offset:59392
  v_mfma_f32_16x16x32_bf16 v[36:39], a[192:195], a[220:223], v[36:39]
  s_waitcnt lgkmcnt(11)
  ds_read_b64_tr_b16 a[190:191], v244 offset:63488
  v_mfma_f32_16x16x32_bf16 v[44:47], a[200:203], a[220:223], v[44:47]
  ds_read_b64_tr_b16 a[192:193], v245 offset:51200
  v_mfma_f32_16x16x32_bf16 v[44:47], a[204:207], a[228:231], v[44:47]
  ds_read_b64_tr_b16 a[194:195], v245 offset:55296
  v_mfma_f32_16x16x32_bf16 v[40:43], a[204:207], a[224:227], v[40:43]
  buffer_load_dwordx4 a[44:47], v137, s[36:39], s51 offen offset:3072 sc1
  s_cmp_eq_u32 s87, 1
  v_mfma_f32_16x16x32_bf16 v[40:43], a[200:203], a[216:219], v[40:43]
  s_waitcnt vmcnt(17) lgkmcnt(10)
  s_barrier
  s_cselect_b32 s73, 19, 5
  v_mfma_f32_16x16x32_bf16 v[48:51], a[208:211], a[216:219], v[48:51]
  s_lshl_b32 s50, s73, 16
  s_add_u32 m0, s70, 32768
  ds_read_b64_tr_b16 a[196:197], v245 offset:59392
  v_mfma_f32_16x16x32_bf16 v[48:51], a[212:215], a[224:227], v[48:51]
  ds_read_b64_tr_b16 a[198:199], v245 offset:63488
  ds_read_b64_tr_b16 a[200:201], v246 offset:51200
  v_mfma_f32_16x16x32_bf16 v[52:55], a[212:215], a[228:231], v[52:55]
  ds_read_b64_tr_b16 a[202:203], v246 offset:55296
  buffer_load_dwordx4 v133, s[24:27], s50 offen offset:0 lds
  v_mfma_f32_16x16x32_bf16 v[52:55], a[208:211], a[220:223], v[52:55]
  s_waitcnt lgkmcnt(10)
  s_lshl_b32 s51, s73, 11
  ds_read_b64_tr_b16 a[204:205], v246 offset:59392
  v_mfma_f32_16x16x32_bf16 v[60:63], a[176:179], a[220:223], v[60:63]
  ds_read_b64_tr_b16 a[206:207], v246 offset:63488
  ds_read_b64_tr_b16 a[208:209], v247 offset:51200
  v_mfma_f32_16x16x32_bf16 v[60:63], a[180:183], a[228:231], v[60:63]
  ds_read_b64_tr_b16 a[210:211], v247 offset:55296
  v_mfma_f32_16x16x32_bf16 v[56:59], a[180:183], a[224:227], v[56:59]
  buffer_load_dwordx4 a[48:51], v137, s[36:39], s51 offen offset:0 sc1
  ds_read_b64_tr_b16 a[212:213], v247 offset:59392
  v_mfma_f32_16x16x32_bf16 v[56:59], a[176:179], a[216:219], v[56:59]
  s_waitcnt lgkmcnt(11)
  ds_read_b64_tr_b16 a[214:215], v247 offset:63488
  v_mfma_f32_16x16x32_bf16 v[144:147], a[184:187], a[216:219], v[144:147]
  ds_read_b64_tr_b16 a[176:177], v248 offset:0
  v_mfma_f32_16x16x32_bf16 v[144:147], a[188:191], a[224:227], v[144:147]
  ds_read_b64_tr_b16 a[178:179], v248 offset:4096
  v_mfma_f32_16x16x32_bf16 v[148:151], a[188:191], a[228:231], v[148:151]
  buffer_load_dwordx4 v134, s[24:27], s50 offen offset:1024 lds
  ds_read_b64_tr_b16 a[180:181], v248 offset:8192
  v_mfma_f32_16x16x32_bf16 v[148:151], a[184:187], a[220:223], v[148:151]
  s_waitcnt lgkmcnt(11)
  ds_read_b64_tr_b16 a[182:183], v248 offset:12288
  v_mfma_f32_16x16x32_bf16 v[156:159], a[192:195], a[220:223], v[156:159]
  ds_read_b64_tr_b16 a[184:185], v249 offset:0
  v_mfma_f32_16x16x32_bf16 v[156:159], a[196:199], a[228:231], v[156:159]
Hb0_3:
  s_cbranch_execz Rb
  buffer_load_dwordx4 a[52:55], v137, s[36:39], s51 offen offset:1024 sc1
  ds_read_b64_tr_b16 a[186:187], v249 offset:4096
  v_mfma_f32_16x16x32_bf16 v[152:155], a[196:199], a[224:227], v[152:155]
  ds_read_b64_tr_b16 a[188:189], v249 offset:8192
  v_mfma_f32_16x16x32_bf16 v[152:155], a[192:195], a[216:219], v[152:155]
  s_waitcnt lgkmcnt(11)
  ds_read_b64_tr_b16 a[190:191], v249 offset:12288
  v_mfma_f32_16x16x32_bf16 v[160:163], a[200:203], a[216:219], v[160:163]
  ds_read_b64_tr_b16 a[192:193], v250 offset:0
  v_mfma_f32_16x16x32_bf16 v[160:163], a[204:207], a[224:227], v[160:163]
  buffer_load_dwordx4 v135, s[24:27], s50 offen offset:2048 lds
  ds_read_b64_tr_b16 a[194:195], v250 offset:4096
  v_mfma_f32_16x16x32_bf16 v[164:167], a[204:207], a[228:231], v[164:167]
  ds_read_b64_tr_b16 a[196:197], v250 offset:8192
  v_mfma_f32_16x16x32_bf16 v[164:167], a[200:203], a[220:223], v[164:167]
  s_waitcnt lgkmcnt(11)
  ds_read_b64_tr_b16 a[198:199], v250 offset:12288
  v_mfma_f32_16x16x32_bf16 v[172:175], a[208:211], a[220:223], v[172:175]
  ds_read_b64_tr_b16 a[200:201], v251 offset:0
  v_mfma_f32_16x16x32_bf16 v[172:175], a[212:215], a[228:231], v[172:175]
  buffer_load_dwordx4 a[56:59], v137, s[36:39], s51 offen offset:2048 sc1
  ds_read_b64_tr_b16 a[202:203], v251 offset:4096
  v_mfma_f32_16x16x32_bf16 v[168:171], a[212:215], a[224:227], v[168:171]
  ds_read_b64_tr_b16 a[204:205], v251 offset:8192
  v_mfma_f32_16x16x32_bf16 v[168:171], a[208:211], a[216:219], v[168:171]
  s_waitcnt vmcnt(22) lgkmcnt(11)
  ds_read_b64_tr_b16 a[206:207], v251 offset:12288
  v_mfma_f32_16x16x32_bf16 v[32:35], a[176:179], a[0:3], v[32:35]
  ds_read_b64_tr_b16 a[208:209], v248 offset:2048
  v_mfma_f32_16x16x32_bf16 v[32:35], a[180:183], a[8:11], v[32:35]
  buffer_load_dwordx4 v136, s[24:27], s50 offen offset:3072 lds
  ds_read_b64_tr_b16 a[210:211], v248 offset:6144
  v_mfma_f32_16x16x32_bf16 v[36:39], a[180:183], a[12:15], v[36:39]
  ds_read_b64_tr_b16 a[212:213], v248 offset:10240
  v_mfma_f32_16x16x32_bf16 v[36:39], a[176:179], a[4:7], v[36:39]
  s_waitcnt lgkmcnt(11)
  ds_read_b64_tr_b16 a[214:215], v248 offset:14336
  v_mfma_f32_16x16x32_bf16 v[44:47], a[184:187], a[4:7], v[44:47]
  ds_read_b64_tr_b16 a[176:177], v249 offset:2048
  v_mfma_f32_16x16x32_bf16 v[44:47], a[188:191], a[12:15], v[44:47]
  buffer_load_dwordx4 a[60:63], v137, s[36:39], s51 offen offset:3072 sc1
  s_cmp_eq_u32 s87, 2
  v_mfma_f32_16x16x32_bf16 v[40:43], a[188:191], a[8:11], v[40:43]
  s_cselect_b32 s74, 22, 8
  s_lshl_b32 s50, s74, 16
  s_add_u32 m0, s70, 49152
  v_mfma_f32_16x16x32_bf16 v[40:43], a[184:187], a[0:3], v[40:43]
  s_waitcnt vmcnt(17) lgkmcnt(9)
  s_barrier
  ds_read_b64_tr_b16 a[178:179], v249 offset:6144
  v_mfma_f32_16x16x32_bf16 v[48:51], a[192:195], a[0:3], v[48:51]
  ds_read_b64_tr_b16 a[180:181], v249 offset:10240
  ds_read_b64_tr_b16 a[182:183], v249 offset:14336
  v_mfma_f32_16x16x32_bf16 v[48:51], a[196:199], a[8:11], v[48:51]
  buffer_load_dwordx4 v133, s[24:27], s50 offen offset:0 lds
  s_lshl_b32 s51, s74, 11
  v_mfma_f32_16x16x32_bf16 v[52:55], a[196:199], a[12:15], v[52:55]
  ds_read_b64_tr_b16 a[184:185], v250 offset:2048
  ds_read_b64_tr_b16 a[186:187], v250 offset:6144
  v_mfma_f32_16x16x32_bf16 v[52:55], a[192:195], a[4:7], v[52:55]
  s_waitcnt lgkmcnt(10)
  ds_read_b64_tr_b16 a[188:189], v250 offset:10240
  ds_read_b64_tr_b16 a[190:191], v250 offset:14336
  v_mfma_f32_16x16x32_bf16 v[60:63], a[200:203], a[4:7], v[60:63]
  buffer_load_dwordx4 a[64:67], v137, s[36:39], s51 offen offset:0 sc1
  ds_read_b64_tr_b16 a[192:193], v251 offset:2048
  v_mfma_f32_16x16x32_bf16 v[60:63], a[204:207], a[12:15], v[60:63]
  ds_read_b64_tr_b16 a[194:195], v251 offset:6144
  v_mfma_f32_16x16x32_bf16 v[56:59], a[204:207], a[8:11], v[56:59]
  ds_read_b64_tr_b16 a[196:197], v251 offset:10240
  v_mfma_f32_16x16x32_bf16 v[56:59], a[200:203], a[0:3], v[56:59]
  s_waitcnt lgkmcnt(11)
  ds_read_b64_tr_b16 a[198:199], v251 offset:14336
  v_mfma_f32_16x16x32_bf16 v[144:147], a[208:211], a[0:3], v[144:147]
  buffer_load_dwordx4 v134, s[24:27], s50 offen offset:1024 lds
  ds_read_b64_tr_b16 a[200:201], v240 offset:0
  v_mfma_f32_16x16x32_bf16 v[144:147], a[212:215], a[8:11], v[144:147]
  ds_read_b64_tr_b16 a[202:203], v240 offset:4096
  v_mfma_f32_16x16x32_bf16 v[148:151], a[212:215], a[12:15], v[148:151]
  ds_read_b64_tr_b16 a[204:205], v240 offset:8192
  v_mfma_f32_16x16x32_bf16 v[148:151], a[208:211], a[4:7], v[148:151]
  s_waitcnt lgkmcnt(11)
  ds_read_b64_tr_b16 a[206:207], v240 offset:12288
  v_mfma_f32_16x16x32_bf16 v[156:159], a[176:179], a[4:7], v[156:159]
  buffer_load_dwordx4 a[68:71], v137, s[36:39], s51 offen offset:1024 sc1
  ds_read_b64_tr_b16 a[208:209], v241 offset:0
  v_mfma_f32_16x16x32_bf16 v[156:159], a[180:183], a[12:15], v[156:159]
  ds_read_b64_tr_b16 a[210:211], v241 offset:4096
  v_mfma_f32_16x16x32_bf16 v[152:155], a[180:183], a[8:11], v[152:155]
  ds_read_b64_tr_b16 a[212:213], v241 offset:8192
  v_mfma_f32_16x16x32_bf16 v[152:155], a[176:179], a[0:3], v[152:155]
  s_waitcnt lgkmcnt(11)
  ds_read_b64_tr_b16 a[214:215], v241 offset:12288
  v_mfma_f32_16x16x32_bf16 v[160:163], a[184:187], a[0:3], v[160:163]
  buffer_load_dwordx4 v135, s[24:27], s50 offen offset:2048 lds
  ds_read_b64_tr_b16 a[176:177], v242 offset:0
  v_mfma_f32_16x16x32_bf16 v[160:163], a[188:191], a[8:11], v[160:163]
  ds_read_b64_tr_b16 a[178:179], v242 offset:4096
  v_mfma_f32_16x16x32_bf16 v[164:167], a[188:191], a[12:15], v[164:167]
  ds_read_b64_tr_b16 a[180:181], v242 offset:8192
  v_mfma_f32_16x16x32_bf16 v[164:167], a[184:187], a[4:7], v[164:167]
  s_waitcnt lgkmcnt(11)
  buffer_load_dwordx4 a[72:75], v137, s[36:39], s51 offen offset:2048 sc1
  ds_read_b64_tr_b16 a[182:183], v242 offset:12288
  v_mfma_f32_16x16x32_bf16 v[172:175], a[192:195], a[4:7], v[172:175]
  ds_read_b64_tr_b16 a[184:185], v243 offset:0
  v_mfma_f32_16x16x32_bf16 v[172:175], a[196:199], a[12:15], v[172:175]
  ds_read_b64_tr_b16 a[186:187], v243 offset:4096
  v_mfma_f32_16x16x32_bf16 v[168:171], a[196:199], a[8:11], v[168:171]
  ds_read_b64_tr_b16 a[188:189], v243 offset:8192
  v_mfma_f32_16x16x32_bf16 v[168:171], a[192:195], a[0:3], v[168:171]
  s_waitcnt vmcnt(22) lgkmcnt(11)
  buffer_load_dwordx4 v136, s[24:27], s50 offen offset:3072 lds
  ds_read_b64_tr_b16 a[190:191], v243 offset:12288
  v_mfma_f32_16x16x32_bf16 v[32:35], a[200:203], a[16:19], v[32:35]
  ds_read_b64_tr_b16 a[192:193], v240 offset:2048
  v_mfma_f32_16x16x32_bf16 v[32:35], a[204:207], a[24:27], v[32:35]
  ds_read_b64_tr_b16 a[194:195], v240 offset:6144
  v_mfma_f32_16x16x32_bf16 v[36:39], a[204:207], a[28:31], v[36:39]
  ds_read_b64_tr_b16 a[196:197], v240 offset:10240
  v_mfma_f32_16x16x32_bf16 v[36:39], a[200:203], a[20:23], v[36:39]
  s_waitcnt lgkmcnt(11)
  buffer_load_dwordx4 a[76:79], v137, s[36:39], s51 offen offset:3072 sc1
  s_cmp_eq_u32 s87, 3
  v_mfma_f32_16x16x32_bf16 v[44:47], a[208:211], a[20:23], v[44:47]
  s_cselect_b32 s75, 26, 12
  s_lshl_b32 s50, s75, 16
  s_add_u32 m0, s70, 65536
  v_mfma_f32_16x16x32_bf16 v[44:47], a[212:215], a[28:31], v[44:47]
  ds_read_b64_tr_b16 a[198:199], v240 offset:14336
  ds_read_b64_tr_b16 a[200:201], v241 offset:2048
  v_mfma_f32_16x16x32_bf16 v[40:43], a[212:215], a[24:27], v[40:43]
  ds_read_b64_tr_b16 a[202:203], v241 offset:6144
  ds_read_b64_tr_b16 a[204:205], v241 offset:10240
  v_mfma_f32_16x16x32_bf16 v[40:43], a[208:211], a[16:19], v[40:43]
  s_waitcnt vmcnt(17) lgkmcnt(11)
  s_barrier
  buffer_load_dwordx4 v133, s[24:27], s50 offen offset:0 lds
  v_mfma_f32_16x16x32_bf16 v[48:51], a[176:179], a[16:19], v[48:51]
  s_lshl_b32 s51, s75, 11
  ds_read_b64_tr_b16 a[206:207], v241 offset:14336
  ds_read_b64_tr_b16 a[208:209], v242 offset:2048
  v_mfma_f32_16x16x32_bf16 v[48:51], a[180:183], a[24:27], v[48:51]
  ds_read_b64_tr_b16 a[210:211], v242 offset:6144
  v_mfma_f32_16x16x32_bf16 v[52:55], a[180:183], a[28:31], v[52:55]
  ds_read_b64_tr_b16 a[212:213], v242 offset:10240
  v_mfma_f32_16x16x32_bf16 v[52:55], a[176:179], a[20:23], v[52:55]
  s_waitcnt lgkmcnt(11)
  buffer_load_dwordx4 a[80:83], v137, s[36:39], s51 offen offset:0 sc1
  ds_read_b64_tr_b16 a[214:215], v242 offset:14336
  v_mfma_f32_16x16x32_bf16 v[60:63], a[184:187], a[20:23], v[60:63]
  ds_read_b64_tr_b16 a[176:177], v243 offset:2048
  v_mfma_f32_16x16x32_bf16 v[60:63], a[188:191], a[28:31], v[60:63]
  ds_read_b64_tr_b16 a[178:179], v243 offset:6144
  v_mfma_f32_16x16x32_bf16 v[56:59], a[188:191], a[24:27], v[56:59]
  buffer_load_dwordx4 v134, s[24:27], s50 offen offset:1024 lds
  ds_read_b64_tr_b16 a[180:181], v243 offset:10240
  v_mfma_f32_16x16x32_bf16 v[56:59], a[184:187], a[16:19], v[56:59]
  s_waitcnt lgkmcnt(11)
  ds_read_b64_tr_b16 a[182:183], v243 offset:14336
  v_mfma_f32_16x16x32_bf16 v[144:147], a[192:195], a[16:19], v[144:147]
  ds_read_b64_tr_b16 a[184:185], v240 offset:16384
  v_mfma_f32_16x16x32_bf16 v[144:147], a[196:199], a[24:27], v[144:147]
  ds_read_b64_tr_b16 a[186:187], v240 offset:20480
  v_mfma_f32_16x16x32_bf16 v[148:151], a[196:199], a[28:31], v[148:151]
  buffer_load_dwordx4 a[84:87], v137, s[36:39], s51 offen offset:1024 sc1
  ds_read_b64_tr_b16 a[188:189], v240 offset:24576
  v_mfma_f32_16x16x32_bf16 v[148:151], a[192:195], a[20:23], v[148:151]
  s_waitcnt lgkmcnt(11)
  ds_read_b64_tr_b16 a[190:191], v240 offset:28672
  v_mfma_f32_16x16x32_bf16 v[156:159], a[200:203], a[20:23], v[156:159]
  ds_read_b64_tr_b16 a[192:193], v241 offset:16384
  v_mfma_f32_16x16x32_bf16 v[156:159], a[204:207], a[28:31], v[156:159]
  ds_read_b64_tr_b16 a[194:195], v241 offset:20480
  v_mfma_f32_16x16x32_bf16 v[152:155], a[204:207], a[24:27], v[152:155]
  buffer_load_dwordx4 v135, s[24:27], s50 offen offset:2048 lds
  ds_read_b64_tr_b16 a[196:197], v241 offset:24576
  v_mfma_f32_16x16x32_bf16 v[152:155], a[200:203], a[16:19], v[152:155]
  s_waitcnt lgkmcnt(11)
  ds_read_b64_tr_b16 a[198:199], v241 offset:28672
  v_mfma_f32_16x16x32_bf16 v[160:163], a[208:211], a[16:19], v[160:163]
  ds_read_b64_tr_b16 a[200:201], v242 offset:16384
  v_mfma_f32_16x16x32_bf16 v[160:163], a[212:215], a[24:27], v[160:163]
  ds_read_b64_tr_b16 a[202:203], v242 offset:20480
  v_mfma_f32_16x16x32_bf16 v[164:167], a[212:215], a[28:31], v[164:167]
  buffer_load_dwordx4 a[88:91], v137, s[36:39], s51 offen offset:2048 sc1
  ds_read_b64_tr_b16 a[204:205], v242 offset:24576
  v_mfma_f32_16x16x32_bf16 v[164:167], a[208:211], a[20:23], v[164:167]
  s_waitcnt lgkmcnt(11)
  ds_read_b64_tr_b16 a[206:207], v242 offset:28672
  v_mfma_f32_16x16x32_bf16 v[172:175], a[176:179], a[20:23], v[172:175]
  ds_read_b64_tr_b16 a[208:209], v243 offset:16384
  v_mfma_f32_16x16x32_bf16 v[172:175], a[180:183], a[28:31], v[172:175]
  ds_read_b64_tr_b16 a[210:211], v243 offset:20480
  v_mfma_f32_16x16x32_bf16 v[168:171], a[180:183], a[24:27], v[168:171]
  buffer_load_dwordx4 v136, s[24:27], s50 offen offset:3072 lds
  ds_read_b64_tr_b16 a[212:213], v243 offset:24576
  v_mfma_f32_16x16x32_bf16 v[168:171], a[176:179], a[16:19], v[168:171]
  s_waitcnt vmcnt(23) lgkmcnt(11)
  ds_read_b64_tr_b16 a[214:215], v243 offset:28672
  v_mfma_f32_16x16x32_bf16 v[32:35], a[184:187], a[32:35], v[32:35]
  ds_read_b64_tr_b16 a[176:177], v240 offset:18432
  v_mfma_f32_16x16x32_bf16 v[32:35], a[188:191], a[40:43], v[32:35]
  buffer_load_dwordx4 a[92:95], v137, s[36:39], s51 offen offset:3072 sc1
  s_cmp_eq_u32 s87, 0
  v_mfma_f32_16x16x32_bf16 v[36:39], a[188:191], a[44:47], v[36:39]
  s_cselect_b32 s76, 29, 15
  s_lshl_b32 s50, s76, 16
  s_add_u32 m0, s70, 81920
  v_mfma_f32_16x16x32_bf16 v[36:39], a[184:187], a[36:39], v[36:39]
  s_waitcnt lgkmcnt(9)
  ds_read_b64_tr_b16 a[178:179], v240 offset:22528
  ds_read_b64_tr_b16 a[180:181], v240 offset:26624
  v_mfma_f32_16x16x32_bf16 v[44:47], a[192:195], a[36:39], v[44:47]
  ds_read_b64_tr_b16 a[182:183], v240 offset:30720
  ds_read_b64_tr_b16 a[184:185], v241 offset:18432
  v_mfma_f32_16x16x32_bf16 v[44:47], a[196:199], a[44:47], v[44:47]
  buffer_load_dwordx4 v133, s[24:27], s50 offen offset:0 lds
  s_lshl_b32 s51, s76, 11
  v_mfma_f32_16x16x32_bf16 v[40:43], a[196:199], a[40:43], v[40:43]
  ds_read_b64_tr_b16 a[186:187], v241 offset:22528
  ds_read_b64_tr_b16 a[188:189], v241 offset:26624
  v_mfma_f32_16x16x32_bf16 v[40:43], a[192:195], a[32:35], v[40:43]
  s_waitcnt vmcnt(18) lgkmcnt(11)
  s_barrier
  ds_read_b64_tr_b16 a[190:191], v241 offset:30720
  v_mfma_f32_16x16x32_bf16 v[48:51], a[200:203], a[32:35], v[48:51]
  ds_read_b64_tr_b16 a[192:193], v242 offset:18432
  v_mfma_f32_16x16x32_bf16 v[48:51], a[204:207], a[40:43], v[48:51]
  buffer_load_dwordx4 a[96:99], v137, s[36:39], s51 offen offset:0 sc1
  ds_read_b64_tr_b16 a[194:195], v242 offset:22528
  v_mfma_f32_16x16x32_bf16 v[52:55], a[204:207], a[44:47], v[52:55]
  ds_read_b64_tr_b16 a[196:197], v242 offset:26624
  v_mfma_f32_16x16x32_bf16 v[52:55], a[200:203], a[36:39], v[52:55]
  s_waitcnt lgkmcnt(11)
  ds_read_b64_tr_b16 a[198:199], v242 offset:30720
  v_mfma_f32_16x16x32_bf16 v[60:63], a[208:211], a[36:39], v[60:63]
  ds_read_b64_tr_b16 a[200:201], v243 offset:18432
  v_mfma_f32_16x16x32_bf16 v[60:63], a[212:215], a[44:47], v[60:63]
  buffer_load_dwordx4 v134, s[24:27], s50 offen offset:1024 lds
  ds_read_b64_tr_b16 a[202:203], v243 offset:22528
  v_mfma_f32_16x16x32_bf16 v[56:59], a[212:215], a[40:43], v[56:59]
  ds_read_b64_tr_b16 a[204:205], v243 offset:26624
  v_mfma_f32_16x16x32_bf16 v[56:59], a[208:211], a[32:35], v[56:59]
  s_waitcnt lgkmcnt(11)
  ds_read_b64_tr_b16 a[206:207], v243 offset:30720
  v_mfma_f32_16x16x32_bf16 v[144:147], a[176:179], a[32:35], v[144:147]
  ds_read_b64_tr_b16 a[208:209], v240 offset:32768
  v_mfma_f32_16x16x32_bf16 v[144:147], a[180:183], a[40:43], v[144:147]
  buffer_load_dwordx4 a[100:103], v137, s[36:39], s51 offen offset:1024 sc1
  ds_read_b64_tr_b16 a[210:211], v240 offset:36864
  v_mfma_f32_16x16x32_bf16 v[148:151], a[180:183], a[44:47], v[148:151]
  ds_read_b64_tr_b16 a[212:213], v240 offset:40960
  v_mfma_f32_16x16x32_bf16 v[148:151], a[176:179], a[36:39], v[148:151]
  s_waitcnt lgkmcnt(11)
  ds_read_b64_tr_b16 a[214:215], v240 offset:45056
  v_mfma_f32_16x16x32_bf16 v[156:159], a[184:187], a[36:39], v[156:159]
  buffer_load_dwordx4 v135, s[24:27], s50 offen offset:2048 lds
  ds_read_b64_tr_b16 a[176:177], v241 offset:32768
  v_mfma_f32_16x16x32_bf16 v[156:159], a[188:191], a[44:47], v[156:159]
  ds_read_b64_tr_b16 a[178:179], v241 offset:36864
  v_mfma_f32_16x16x32_bf16 v[152:155], a[188:191], a[40:43], v[152:155]
  ds_read_b64_tr_b16 a[180:181], v241 offset:40960
  v_mfma_f32_16x16x32_bf16 v[152:155], a[184:187], a[32:35], v[152:155]
  s_waitcnt lgkmcnt(11)
  ds_read_b64_tr_b16 a[182:183], v241 offset:45056
  v_mfma_f32_16x16x32_bf16 v[160:163], a[192:195], a[32:35], v[160:163]
  buffer_load_dwordx4 a[104:107], v137, s[36:39], s51 offen offset:2048 sc1
  ds_read_b64_tr_b16 a[184:185], v242 offset:32768
  v_mfma_f32_16x16x32_bf16 v[160:163], a[196:199], a[40:43], v[160:163]
  ds_read_b64_tr_b16 a[186:187], v242 offset:36864
  v_mfma_f32_16x16x32_bf16 v[164:167], a[196:199], a[44:47], v[164:167]
  ds_read_b64_tr_b16 a[188:189], v242 offset:40960
  v_mfma_f32_16x16x32_bf16 v[164:167], a[192:195], a[36:39], v[164:167]
  s_waitcnt lgkmcnt(11)
  ds_read_b64_tr_b16 a[190:191], v242 offset:45056
  v_mfma_f32_16x16x32_bf16 v[172:175], a[200:203], a[36:39], v[172:175]
  buffer_load_dwordx4 v136, s[24:27], s50 offen offset:3072 lds
  ds_read_b64_tr_b16 a[192:193], v243 offset:32768
  v_mfma_f32_16x16x32_bf16 v[172:175], a[204:207], a[44:47], v[172:175]
  ds_read_b64_tr_b16 a[194:195], v243 offset:36864
  v_mfma_f32_16x16x32_bf16 v[168:171], a[204:207], a[40:43], v[168:171]
  ds_read_b64_tr_b16 a[196:197], v243 offset:40960
  v_mfma_f32_16x16x32_bf16 v[168:171], a[200:203], a[32:35], v[168:171]
  s_waitcnt vmcnt(23) lgkmcnt(11)
  ds_read_b64_tr_b16 a[198:199], v243 offset:45056
  v_mfma_f32_16x16x32_bf16 v[32:35], a[208:211], a[48:51], v[32:35]
  buffer_load_dwordx4 a[108:111], v137, s[36:39], s51 offen offset:3072 sc1
  s_cmp_eq_u32 s87, 1
  v_mfma_f32_16x16x32_bf16 v[32:35], a[212:215], a[56:59], v[32:35]
  s_cselect_b32 s81, 33, 19
  s_lshl_b32 s50, s81, 16
  s_add_u32 m0, s70, 98304
  v_mfma_f32_16x16x32_bf16 v[36:39], a[212:215], a[60:63], v[36:39]
  ds_read_b64_tr_b16 a[200:201], v240 offset:34816
  ds_read_b64_tr_b16 a[202:203], v240 offset:38912
  v_mfma_f32_16x16x32_bf16 v[36:39], a[208:211], a[52:55], v[36:39]
  s_waitcnt lgkmcnt(10)
  ds_read_b64_tr_b16 a[204:205], v240 offset:43008
  ds_read_b64_tr_b16 a[206:207], v240 offset:47104
  v_mfma_f32_16x16x32_bf16 v[44:47], a[176:179], a[52:55], v[44:47]
  buffer_load_dwordx4 v133, s[24:27], s50 offen offset:0 lds
  s_lshl_b32 s51, s81, 11
  v_mfma_f32_16x16x32_bf16 v[44:47], a[180:183], a[60:63], v[44:47]
  ds_read_b64_tr_b16 a[208:209], v241 offset:34816
  ds_read_b64_tr_b16 a[210:211], v241 offset:38912
  v_mfma_f32_16x16x32_bf16 v[40:43], a[180:183], a[56:59], v[40:43]
  ds_read_b64_tr_b16 a[212:213], v241 offset:43008
  v_mfma_f32_16x16x32_bf16 v[40:43], a[176:179], a[48:51], v[40:43]
  s_waitcnt vmcnt(18) lgkmcnt(11)
  s_barrier
  ds_read_b64_tr_b16 a[214:215], v241 offset:47104
  v_mfma_f32_16x16x32_bf16 v[48:51], a[184:187], a[48:51], v[48:51]
  buffer_load_dwordx4 a[112:115], v137, s[36:39], s51 offen offset:0 sc1
  ds_read_b64_tr_b16 a[176:177], v242 offset:34816
  v_mfma_f32_16x16x32_bf16 v[48:51], a[188:191], a[56:59], v[48:51]
  ds_read_b64_tr_b16 a[178:179], v242 offset:38912
  v_mfma_f32_16x16x32_bf16 v[52:55], a[188:191], a[60:63], v[52:55]
  ds_read_b64_tr_b16 a[180:181], v242 offset:43008
  v_mfma_f32_16x16x32_bf16 v[52:55], a[184:187], a[52:55], v[52:55]
  s_waitcnt lgkmcnt(11)
  buffer_load_dwordx4 v134, s[24:27], s50 offen offset:1024 lds
  ds_read_b64_tr_b16 a[182:183], v242 offset:47104
  v_mfma_f32_16x16x32_bf16 v[60:63], a[192:195], a[52:55], v[60:63]
  ds_read_b64_tr_b16 a[184:185], v243 offset:34816
  v_mfma_f32_16x16x32_bf16 v[60:63], a[196:199], a[60:63], v[60:63]
  ds_read_b64_tr_b16 a[186:187], v243 offset:38912
  v_mfma_f32_16x16x32_bf16 v[56:59], a[196:199], a[56:59], v[56:59]
  ds_read_b64_tr_b16 a[188:189], v243 offset:43008
  v_mfma_f32_16x16x32_bf16 v[56:59], a[192:195], a[48:51], v[56:59]
  s_waitcnt lgkmcnt(11)
  buffer_load_dwordx4 a[116:119], v137, s[36:39], s51 offen offset:1024 sc1
  ds_read_b64_tr_b16 a[190:191], v243 offset:47104
  v_mfma_f32_16x16x32_bf16 v[144:147], a[200:203], a[48:51], v[144:147]
  ds_read_b64_tr_b16 a[192:193], v240 offset:49152
  v_mfma_f32_16x16x32_bf16 v[144:147], a[204:207], a[56:59], v[144:147]
  ds_read_b64_tr_b16 a[194:195], v240 offset:53248
  v_mfma_f32_16x16x32_bf16 v[148:151], a[204:207], a[60:63], v[148:151]
  ds_read_b64_tr_b16 a[196:197], v240 offset:57344
  v_mfma_f32_16x16x32_bf16 v[148:151], a[200:203], a[52:55], v[148:151]
  s_waitcnt lgkmcnt(11)
  buffer_load_dwordx4 v135, s[24:27], s50 offen offset:2048 lds
  ds_read_b64_tr_b16 a[198:199], v240 offset:61440
  v_mfma_f32_16x16x32_bf16 v[156:159], a[208:211], a[52:55], v[156:159]
  ds_read_b64_tr_b16 a[200:201], v241 offset:49152
  v_mfma_f32_16x16x32_bf16 v[156:159], a[212:215], a[60:63], v[156:159]
  ds_read_b64_tr_b16 a[202:203], v241 offset:53248
  v_mfma_f32_16x16x32_bf16 v[152:155], a[212:215], a[56:59], v[152:155]
  ds_read_b64_tr_b16 a[204:205], v241 offset:57344
  v_mfma_f32_16x16x32_bf16 v[152:155], a[208:211], a[48:51], v[152:155]
  s_waitcnt lgkmcnt(11)
  buffer_load_dwordx4 a[120:123], v137, s[36:39], s51 offen offset:2048 sc1
  ds_read_b64_tr_b16 a[206:207], v241 offset:61440
  v_mfma_f32_16x16x32_bf16 v[160:163], a[176:179], a[48:51], v[160:163]
  ds_read_b64_tr_b16 a[208:209], v242 offset:49152
  v_mfma_f32_16x16x32_bf16 v[160:163], a[180:183], a[56:59], v[160:163]
  ds_read_b64_tr_b16 a[210:211], v242 offset:53248
  v_mfma_f32_16x16x32_bf16 v[164:167], a[180:183], a[60:63], v[164:167]
  ds_read_b64_tr_b16 a[212:213], v242 offset:57344
  v_mfma_f32_16x16x32_bf16 v[164:167], a[176:179], a[52:55], v[164:167]
  s_waitcnt lgkmcnt(11)
  buffer_load_dwordx4 v136, s[24:27], s50 offen offset:3072 lds
  ds_read_b64_tr_b16 a[214:215], v242 offset:61440
  v_mfma_f32_16x16x32_bf16 v[172:175], a[184:187], a[52:55], v[172:175]
  ds_read_b64_tr_b16 a[176:177], v243 offset:49152
  v_mfma_f32_16x16x32_bf16 v[172:175], a[188:191], a[60:63], v[172:175]
  ds_read_b64_tr_b16 a[178:179], v243 offset:53248
  v_mfma_f32_16x16x32_bf16 v[168:171], a[188:191], a[56:59], v[168:171]
  buffer_load_dwordx4 a[124:127], v137, s[36:39], s51 offen offset:3072 sc1
  s_cmp_eq_u32 s87, 2
  v_mfma_f32_16x16x32_bf16 v[168:171], a[184:187], a[48:51], v[168:171]
  s_waitcnt vmcnt(24) lgkmcnt(10)
  s_cselect_b32 s82, 36, 22
  s_lshl_b32 s50, s82, 16
  v_mfma_f32_16x16x32_bf16 v[32:35], a[192:195], a[64:67], v[32:35]
  s_add_u32 m0, s70, 114688
  ds_read_b64_tr_b16 a[180:181], v243 offset:57344
  ds_read_b64_tr_b16 a[182:183], v243 offset:61440
  v_mfma_f32_16x16x32_bf16 v[32:35], a[196:199], a[72:75], v[32:35]
  ds_read_b64_tr_b16 a[184:185], v240 offset:51200
  ds_read_b64_tr_b16 a[186:187], v240 offset:55296
  v_mfma_f32_16x16x32_bf16 v[36:39], a[196:199], a[76:79], v[36:39]
  buffer_load_dwordx4 v133, s[24:27], s50 offen offset:0 lds
  s_lshl_b32 s51, s82, 11
  v_mfma_f32_16x16x32_bf16 v[36:39], a[192:195], a[68:71], v[36:39]
  s_waitcnt lgkmcnt(10)
  ds_read_b64_tr_b16 a[188:189], v240 offset:59392
  ds_read_b64_tr_b16 a[190:191], v240 offset:63488
  v_mfma_f32_16x16x32_bf16 v[44:47], a[200:203], a[68:71], v[44:47]
  ds_read_b64_tr_b16 a[192:193], v241 offset:51200
  v_mfma_f32_16x16x32_bf16 v[44:47], a[204:207], a[76:79], v[44:47]
  ds_read_b64_tr_b16 a[194:195], v241 offset:55296
  v_mfma_f32_16x16x32_bf16 v[40:43], a[204:207], a[72:75], v[40:43]
  buffer_load_dwordx4 a[216:219], v137, s[36:39], s51 offen offset:0 sc1
  ds_read_b64_tr_b16 a[196:197], v241 offset:59392
  v_mfma_f32_16x16x32_bf16 v[40:43], a[200:203], a[64:67], v[40:43]
  s_waitcnt vmcnt(19) lgkmcnt(11)
  s_barrier
  ds_read_b64_tr_b16 a[198:199], v241 offset:63488
  v_mfma_f32_16x16x32_bf16 v[48:51], a[208:211], a[64:67], v[48:51]
  ds_read_b64_tr_b16 a[200:201], v242 offset:51200
  v_mfma_f32_16x16x32_bf16 v[48:51], a[212:215], a[72:75], v[48:51]
  ds_read_b64_tr_b16 a[202:203], v242 offset:55296
  v_mfma_f32_16x16x32_bf16 v[52:55], a[212:215], a[76:79], v[52:55]
  buffer_load_dwordx4 v134, s[24:27], s50 offen offset:1024 lds
  ds_read_b64_tr_b16 a[204:205], v242 offset:59392
  v_mfma_f32_16x16x32_bf16 v[52:55], a[208:211], a[68:71], v[52:55]
  s_waitcnt lgkmcnt(11)
  ds_read_b64_tr_b16 a[206:207], v242 offset:63488
  v_mfma_f32_16x16x32_bf16 v[60:63], a[176:179], a[68:71], v[60:63]
  ds_read_b64_tr_b16 a[208:209], v243 offset:51200
  v_mfma_f32_16x16x32_bf16 v[60:63], a[180:183], a[76:79], v[60:63]
  ds_read_b64_tr_b16 a[210:211], v243 offset:55296
  v_mfma_f32_16x16x32_bf16 v[56:59], a[180:183], a[72:75], v[56:59]
  buffer_load_dwordx4 a[220:223], v137, s[36:39], s51 offen offset:1024 sc1
  ds_read_b64_tr_b16 a[212:213], v243 offset:59392
  v_mfma_f32_16x16x32_bf16 v[56:59], a[176:179], a[64:67], v[56:59]
  s_waitcnt lgkmcnt(11)
  ds_read_b64_tr_b16 a[214:215], v243 offset:63488
  v_mfma_f32_16x16x32_bf16 v[144:147], a[184:187], a[64:67], v[144:147]
  ds_read_b64_tr_b16 a[176:177], v244 offset:0
  v_mfma_f32_16x16x32_bf16 v[144:147], a[188:191], a[72:75], v[144:147]
  buffer_load_dwordx4 v135, s[24:27], s50 offen offset:2048 lds
  ds_read_b64_tr_b16 a[178:179], v244 offset:4096
  v_mfma_f32_16x16x32_bf16 v[148:151], a[188:191], a[76:79], v[148:151]
  ds_read_b64_tr_b16 a[180:181], v244 offset:8192
  v_mfma_f32_16x16x32_bf16 v[148:151], a[184:187], a[68:71], v[148:151]
  s_waitcnt lgkmcnt(11)
  ds_read_b64_tr_b16 a[182:183], v244 offset:12288
  v_mfma_f32_16x16x32_bf16 v[156:159], a[192:195], a[68:71], v[156:159]
  ds_read_b64_tr_b16 a[184:185], v245 offset:0
  v_mfma_f32_16x16x32_bf16 v[156:159], a[196:199], a[76:79], v[156:159]
  buffer_load_dwordx4 a[224:227], v137, s[36:39], s51 offen offset:2048 sc1
  ds_read_b64_tr_b16 a[186:187], v245 offset:4096
  v_mfma_f32_16x16x32_bf16 v[152:155], a[196:199], a[72:75], v[152:155]
  ds_read_b64_tr_b16 a[188:189], v245 offset:8192
  v_mfma_f32_16x16x32_bf16 v[152:155], a[192:195], a[64:67], v[152:155]
  s_waitcnt lgkmcnt(11)
  ds_read_b64_tr_b16 a[190:191], v245 offset:12288
  v_mfma_f32_16x16x32_bf16 v[160:163], a[200:203], a[64:67], v[160:163]
  ds_read_b64_tr_b16 a[192:193], v246 offset:0
  v_mfma_f32_16x16x32_bf16 v[160:163], a[204:207], a[72:75], v[160:163]
  buffer_load_dwordx4 v136, s[24:27], s50 offen offset:3072 lds
  ds_read_b64_tr_b16 a[194:195], v246 offset:4096
  v_mfma_f32_16x16x32_bf16 v[164:167], a[204:207], a[76:79], v[164:167]
  ds_read_b64_tr_b16 a[196:197], v246 offset:8192
  v_mfma_f32_16x16x32_bf16 v[164:167], a[200:203], a[68:71], v[164:167]
  s_waitcnt lgkmcnt(11)
  ds_read_b64_tr_b16 a[198:199], v246 offset:12288
  v_mfma_f32_16x16x32_bf16 v[172:175], a[208:211], a[68:71], v[172:175]
  ds_read_b64_tr_b16 a[200:201], v247 offset:0
  v_mfma_f32_16x16x32_bf16 v[172:175], a[212:215], a[76:79], v[172:175]
  buffer_load_dwordx4 a[228:231], v137, s[36:39], s51 offen offset:3072 sc1
  s_cmp_eq_u32 s87, 3
  v_mfma_f32_16x16x32_bf16 v[168:171], a[212:215], a[72:75], v[168:171]
  s_cselect_b32 s83, 40, 26
  s_lshl_b32 s50, s83, 16
  s_add_u32 m0, s70, 131072
  v_mfma_f32_16x16x32_bf16 v[168:171], a[208:211], a[64:67], v[168:171]
  s_waitcnt vmcnt(24) lgkmcnt(9)
  ds_read_b64_tr_b16 a[202:203], v247 offset:4096
  ds_read_b64_tr_b16 a[204:205], v247 offset:8192
  v_mfma_f32_16x16x32_bf16 v[32:35], a[176:179], a[80:83], v[32:35]
  ds_read_b64_tr_b16 a[206:207], v247 offset:12288
  ds_read_b64_tr_b16 a[208:209], v244 offset:2048
  v_mfma_f32_16x16x32_bf16 v[32:35], a[180:183], a[88:91], v[32:35]
  buffer_load_dwordx4 v133, s[24:27], s50 offen offset:0 lds
  s_lshl_b32 s51, s83, 11
  v_mfma_f32_16x16x32_bf16 v[36:39], a[180:183], a[92:95], v[36:39]
  ds_read_b64_tr_b16 a[210:211], v244 offset:6144
  ds_read_b64_tr_b16 a[212:213], v244 offset:10240
  v_mfma_f32_16x16x32_bf16 v[36:39], a[176:179], a[84:87], v[36:39]
  s_waitcnt lgkmcnt(11)
  ds_read_b64_tr_b16 a[214:215], v244 offset:14336
  v_mfma_f32_16x16x32_bf16 v[44:47], a[184:187], a[84:87], v[44:47]
  buffer_load_dwordx4 a[0:3], v137, s[36:39], s51 offen offset:0 sc1
  ds_read_b64_tr_b16 a[176:177], v245 offset:2048
  v_mfma_f32_16x16x32_bf16 v[44:47], a[188:191], a[92:95], v[44:47]
  ds_read_b64_tr_b16 a[178:179], v245 offset:6144
  v_mfma_f32_16x16x32_bf16 v[40:43], a[188:191], a[88:91], v[40:43]
  ds_read_b64_tr_b16 a[180:181], v245 offset:10240
  v_mfma_f32_16x16x32_bf16 v[40:43], a[184:187], a[80:83], v[40:43]
  s_waitcnt vmcnt(19) lgkmcnt(11)
  s_barrier
  ds_read_b64_tr_b16 a[182:183], v245 offset:14336
  v_mfma_f32_16x16x32_bf16 v[48:51], a[192:195], a[80:83], v[48:51]
  buffer_load_dwordx4 v134, s[24:27], s50 offen offset:1024 lds
  ds_read_b64_tr_b16 a[184:185], v246 offset:2048
  v_mfma_f32_16x16x32_bf16 v[48:51], a[196:199], a[88:91], v[48:51]
  ds_read_b64_tr_b16 a[186:187], v246 offset:6144
  v_mfma_f32_16x16x32_bf16 v[52:55], a[196:199], a[92:95], v[52:55]
  ds_read_b64_tr_b16 a[188:189], v246 offset:10240
  v_mfma_f32_16x16x32_bf16 v[52:55], a[192:195], a[84:87], v[52:55]
  s_waitcnt lgkmcnt(11)
  ds_read_b64_tr_b16 a[190:191], v246 offset:14336
  v_mfma_f32_16x16x32_bf16 v[60:63], a[200:203], a[84:87], v[60:63]
  buffer_load_dwordx4 a[4:7], v137, s[36:39], s51 offen offset:1024 sc1
  ds_read_b64_tr_b16 a[192:193], v247 offset:2048
  v_mfma_f32_16x16x32_bf16 v[60:63], a[204:207], a[92:95], v[60:63]
  ds_read_b64_tr_b16 a[194:195], v247 offset:6144
  v_mfma_f32_16x16x32_bf16 v[56:59], a[204:207], a[88:91], v[56:59]
  ds_read_b64_tr_b16 a[196:197], v247 offset:10240
  v_mfma_f32_16x16x32_bf16 v[56:59], a[200:203], a[80:83], v[56:59]
  s_waitcnt lgkmcnt(11)
  ds_read_b64_tr_b16 a[198:199], v247 offset:14336
  v_mfma_f32_16x16x32_bf16 v[144:147], a[208:211], a[80:83], v[144:147]
  buffer_load_dwordx4 v135, s[24:27], s50 offen offset:2048 lds
  ds_read_b64_tr_b16 a[200:201], v244 offset:16384
  v_mfma_f32_16x16x32_bf16 v[144:147], a[212:215], a[88:91], v[144:147]
  ds_read_b64_tr_b16 a[202:203], v244 offset:20480
  v_mfma_f32_16x16x32_bf16 v[148:151], a[212:215], a[92:95], v[148:151]
  ds_read_b64_tr_b16 a[204:205], v244 offset:24576
  v_mfma_f32_16x16x32_bf16 v[148:151], a[208:211], a[84:87], v[148:151]
  s_waitcnt lgkmcnt(11)
  ds_read_b64_tr_b16 a[206:207], v244 offset:28672
  v_mfma_f32_16x16x32_bf16 v[156:159], a[176:179], a[84:87], v[156:159]
  buffer_load_dwordx4 a[8:11], v137, s[36:39], s51 offen offset:2048 sc1
  ds_read_b64_tr_b16 a[208:209], v245 offset:16384
  v_mfma_f32_16x16x32_bf16 v[156:159], a[180:183], a[92:95], v[156:159]
  ds_read_b64_tr_b16 a[210:211], v245 offset:20480
  v_mfma_f32_16x16x32_bf16 v[152:155], a[180:183], a[88:91], v[152:155]
  ds_read_b64_tr_b16 a[212:213], v245 offset:24576
  v_mfma_f32_16x16x32_bf16 v[152:155], a[176:179], a[80:83], v[152:155]
  s_waitcnt lgkmcnt(11)
  buffer_load_dwordx4 v136, s[24:27], s50 offen offset:3072 lds
  ds_read_b64_tr_b16 a[214:215], v245 offset:28672
  v_mfma_f32_16x16x32_bf16 v[160:163], a[184:187], a[80:83], v[160:163]
  ds_read_b64_tr_b16 a[176:177], v246 offset:16384
  v_mfma_f32_16x16x32_bf16 v[160:163], a[188:191], a[88:91], v[160:163]
  ds_read_b64_tr_b16 a[178:179], v246 offset:20480
  v_mfma_f32_16x16x32_bf16 v[164:167], a[188:191], a[92:95], v[164:167]
  ds_read_b64_tr_b16 a[180:181], v246 offset:24576
  v_mfma_f32_16x16x32_bf16 v[164:167], a[184:187], a[84:87], v[164:167]
  s_waitcnt lgkmcnt(11)
  buffer_load_dwordx4 a[12:15], v137, s[36:39], s51 offen offset:3072 sc1
  s_cmp_eq_u32 s87, 0
  v_mfma_f32_16x16x32_bf16 v[172:175], a[192:195], a[84:87], v[172:175]
  s_cselect_b32 s69, 43, 29
  s_lshl_b32 s50, s69, 16
  s_add_u32 m0, s70, 0
  v_mfma_f32_16x16x32_bf16 v[172:175], a[196:199], a[92:95], v[172:175]
  ds_read_b64_tr_b16 a[182:183], v246 offset:28672
  ds_read_b64_tr_b16 a[184:185], v247 offset:16384
  v_mfma_f32_16x16x32_bf16 v[168:171], a[196:199], a[88:91], v[168:171]
  ds_read_b64_tr_b16 a[186:187], v247 offset:20480
  ds_read_b64_tr_b16 a[188:189], v247 offset:24576
  v_mfma_f32_16x16x32_bf16 v[168:171], a[192:195], a[80:83], v[168:171]
  s_waitcnt vmcnt(24) lgkmcnt(11)
  buffer_load_dwordx4 v133, s[24:27], s50 offen offset:0 lds
  s_lshl_b32 s51, s69, 11
  v_mfma_f32_16x16x32_bf16 v[32:35], a[200:203], a[96:99], v[32:35]
  ds_read_b64_tr_b16 a[190:191], v247 offset:28672
  ds_read_b64_tr_b16 a[192:193], v244 offset:18432
  v_mfma_f32_16x16x32_bf16 v[32:35], a[204:207], a[104:107], v[32:35]
  ds_read_b64_tr_b16 a[194:195], v244 offset:22528
  v_mfma_f32_16x16x32_bf16 v[36:39], a[204:207], a[108:111], v[36:39]
Hb1_3:
  s_cbranch_execz Rb
  ds_read_b64_tr_b16 a[196:197], v244 offset:26624
  v_mfma_f32_16x16x32_bf16 v[36:39], a[200:203], a[100:103], v[36:39]
  s_waitcnt lgkmcnt(11)
  buffer_load_dwordx4 a[16:19], v137, s[36:39], s51 offen offset:0 sc1
  ds_read_b64_tr_b16 a[198:199], v244 offset:30720
  v_mfma_f32_16x16x32_bf16 v[44:47], a[208:211], a[100:103], v[44:47]
  ds_read_b64_tr_b16 a[200:201], v245 offset:18432
  v_mfma_f32_16x16x32_bf16 v[44:47], a[212:215], a[108:111], v[44:47]
  ds_read_b64_tr_b16 a[202:203], v245 offset:22528
  v_mfma_f32_16x16x32_bf16 v[40:43], a[212:215], a[104:107], v[40:43]
  ds_read_b64_tr_b16 a[204:205], v245 offset:26624
  v_mfma_f32_16x16x32_bf16 v[40:43], a[208:211], a[96:99], v[40:43]
  s_waitcnt vmcnt(19) lgkmcnt(11)
  s_barrier
  buffer_load_dwordx4 v134, s[24:27], s50 offen offset:1024 lds
  v_mfma_f32_16x16x32_bf16 v[48:51], a[176:179], a[96:99], v[48:51]
  ds_read_b64_tr_b16 a[206:207], v245 offset:30720
  ds_read_b64_tr_b16 a[208:209], v246 offset:18432
  v_mfma_f32_16x16x32_bf16 v[48:51], a[180:183], a[104:107], v[48:51]
  ds_read_b64_tr_b16 a[210:211], v246 offset:22528
  v_mfma_f32_16x16x32_bf16 v[52:55], a[180:183], a[108:111], v[52:55]
  buffer_load_dwordx4 a[20:23], v137, s[36:39], s51 offen offset:1024 sc1
  ds_read_b64_tr_b16 a[212:213], v246 offset:26624
  v_mfma_f32_16x16x32_bf16 v[52:55], a[176:179], a[100:103], v[52:55]
  s_waitcnt lgkmcnt(11)
  ds_read_b64_tr_b16 a[214:215], v246 offset:30720
  v_mfma_f32_16x16x32_bf16 v[60:63], a[184:187], a[100:103], v[60:63]
  ds_read_b64_tr_b16 a[176:177], v247 offset:18432
  v_mfma_f32_16x16x32_bf16 v[60:63], a[188:191], a[108:111], v[60:63]
  ds_read_b64_tr_b16 a[178:179], v247 offset:22528
  v_mfma_f32_16x16x32_bf16 v[56:59], a[188:191], a[104:107], v[56:59]
  buffer_load_dwordx4 v135, s[24:27], s50 offen offset:2048 lds
  ds_read_b64_tr_b16 a[180:181], v247 offset:26624
  v_mfma_f32_16x16x32_bf16 v[56:59], a[184:187], a[96:99], v[56:59]
  s_waitcnt lgkmcnt(11)
  ds_read_b64_tr_b16 a[182:183], v247 offset:30720
  v_mfma_f32_16x16x32_bf16 v[144:147], a[192:195], a[96:99], v[144:147]
  ds_read_b64_tr_b16 a[184:185], v244 offset:32768
  v_mfma_f32_16x16x32_bf16 v[144:147], a[196:199], a[104:107], v[144:147]
  ds_read_b64_tr_b16 a[186:187], v244 offset:36864
  v_mfma_f32_16x16x32_bf16 v[148:151], a[196:199], a[108:111], v[148:151]
  buffer_load_dwordx4 a[24:27], v137, s[36:39], s51 offen offset:2048 sc1
  ds_read_b64_tr_b16 a[188:189], v244 offset:40960
  v_mfma_f32_16x16x32_bf16 v[148:151], a[192:195], a[100:103], v[148:151]
  s_waitcnt lgkmcnt(11)
  ds_read_b64_tr_b16 a[190:191], v244 offset:45056
  v_mfma_f32_16x16x32_bf16 v[156:159], a[200:203], a[100:103], v[156:159]
  ds_read_b64_tr_b16 a[192:193], v245 offset:32768
  v_mfma_f32_16x16x32_bf16 v[156:159], a[204:207], a[108:111], v[156:159]
  ds_read_b64_tr_b16 a[194:195], v245 offset:36864
  v_mfma_f32_16x16x32_bf16 v[152:155], a[204:207], a[104:107], v[152:155]
  buffer_load_dwordx4 v136, s[24:27], s50 offen offset:3072 lds
  ds_read_b64_tr_b16 a[196:197], v245 offset:40960
  v_mfma_f32_16x16x32_bf16 v[152:155], a[200:203], a[96:99], v[152:155]
  s_waitcnt lgkmcnt(11)
  ds_read_b64_tr_b16 a[198:199], v245 offset:45056
  v_mfma_f32_16x16x32_bf16 v[160:163], a[208:211], a[96:99], v[160:163]
  ds_read_b64_tr_b16 a[200:201], v246 offset:32768
  v_mfma_f32_16x16x32_bf16 v[160:163], a[212:215], a[104:107], v[160:163]
  ds_read_b64_tr_b16 a[202:203], v246 offset:36864
  v_mfma_f32_16x16x32_bf16 v[164:167], a[212:215], a[108:111], v[164:167]
  buffer_load_dwordx4 a[28:31], v137, s[36:39], s51 offen offset:3072 sc1
  s_cmp_eq_u32 s87, 1
  v_mfma_f32_16x16x32_bf16 v[164:167], a[208:211], a[100:103], v[164:167]
  s_waitcnt lgkmcnt(10)
  s_cselect_b32 s71, 47, 33
  s_lshl_b32 s51, s71, 11
  v_mfma_f32_16x16x32_bf16 v[172:175], a[176:179], a[100:103], v[172:175]
  ds_read_b64_tr_b16 a[204:205], v246 offset:40960
  ds_read_b64_tr_b16 a[206:207], v246 offset:45056
  v_mfma_f32_16x16x32_bf16 v[172:175], a[180:183], a[108:111], v[172:175]
  ds_read_b64_tr_b16 a[208:209], v247 offset:32768
  buffer_load_dwordx4 a[32:35], v137, s[36:39], s51 offen offset:0 sc1
  v_mfma_f32_16x16x32_bf16 v[168:171], a[180:183], a[104:107], v[168:171]
  ds_read_b64_tr_b16 a[210:211], v247 offset:36864
  ds_read_b64_tr_b16 a[212:213], v247 offset:40960
  v_mfma_f32_16x16x32_bf16 v[168:171], a[176:179], a[96:99], v[168:171]
  s_waitcnt vmcnt(25) lgkmcnt(11)
  ds_read_b64_tr_b16 a[214:215], v247 offset:45056
  v_mfma_f32_16x16x32_bf16 v[32:35], a[184:187], a[112:115], v[32:35]
  ds_read_b64_tr_b16 a[176:177], v244 offset:34816
  v_mfma_f32_16x16x32_bf16 v[32:35], a[188:191], a[120:123], v[32:35]
  buffer_load_dwordx4 a[36:39], v137, s[36:39], s51 offen offset:1024 sc1
  s_lshl_b32 s50, s71, 16
  v_mfma_f32_16x16x32_bf16 v[36:39], a[188:191], a[124:127], v[36:39]
  s_add_u32 m0, s70, 16384
  ds_read_b64_tr_b16 a[178:179], v244 offset:38912
  ds_read_b64_tr_b16 a[180:181], v244 offset:43008
  v_mfma_f32_16x16x32_bf16 v[36:39], a[184:187], a[116:119], v[36:39]
  s_waitcnt lgkmcnt(11)
  ds_read_b64_tr_b16 a[182:183], v244 offset:47104
  v_mfma_f32_16x16x32_bf16 v[44:47], a[192:195], a[116:119], v[44:47]
  ds_read_b64_tr_b16 a[184:185], v245 offset:34816
  v_mfma_f32_16x16x32_bf16 v[44:47], a[196:199], a[124:127], v[44:47]
  buffer_load_dwordx4 v135, s[24:27], s50 offen offset:2048 lds
  ds_read_b64_tr_b16 a[186:187], v245 offset:38912
  v_mfma_f32_16x16x32_bf16 v[40:43], a[196:199], a[120:123], v[40:43]
  ds_read_b64_tr_b16 a[188:189], v245 offset:43008
  v_mfma_f32_16x16x32_bf16 v[40:43], a[192:195], a[112:115], v[40:43]
  s_waitcnt vmcnt(20) lgkmcnt(11)
  s_barrier
  ds_read_b64_tr_b16 a[190:191], v245 offset:47104
  v_mfma_f32_16x16x32_bf16 v[48:51], a[200:203], a[112:115], v[48:51]
  ds_read_b64_tr_b16 a[192:193], v246 offset:34816
  v_mfma_f32_16x16x32_bf16 v[48:51], a[204:207], a[120:123], v[48:51]
  buffer_load_dwordx4 a[40:43], v137, s[36:39], s51 offen offset:2048 sc1
  ds_read_b64_tr_b16 a[194:195], v246 offset:38912
  v_mfma_f32_16x16x32_bf16 v[52:55], a[204:207], a[124:127], v[52:55]
  ds_read_b64_tr_b16 a[196:197], v246 offset:43008
  v_mfma_f32_16x16x32_bf16 v[52:55], a[200:203], a[116:119], v[52:55]
  s_waitcnt lgkmcnt(11)
  ds_read_b64_tr_b16 a[198:199], v246 offset:47104
  v_mfma_f32_16x16x32_bf16 v[60:63], a[208:211], a[116:119], v[60:63]
  ds_read_b64_tr_b16 a[200:201], v247 offset:34816
  v_mfma_f32_16x16x32_bf16 v[60:63], a[212:215], a[124:127], v[60:63]
  buffer_load_dwordx4 v136, s[24:27], s50 offen offset:3072 lds
  ds_read_b64_tr_b16 a[202:203], v247 offset:38912
  v_mfma_f32_16x16x32_bf16 v[56:59], a[212:215], a[120:123], v[56:59]
  ds_read_b64_tr_b16 a[204:205], v247 offset:43008
  v_mfma_f32_16x16x32_bf16 v[56:59], a[208:211], a[112:115], v[56:59]
  s_waitcnt lgkmcnt(11)
  ds_read_b64_tr_b16 a[206:207], v247 offset:47104
  v_mfma_f32_16x16x32_bf16 v[144:147], a[176:179], a[112:115], v[144:147]
  ds_read_b64_tr_b16 a[208:209], v244 offset:49152
  v_mfma_f32_16x16x32_bf16 v[144:147], a[180:183], a[120:123], v[144:147]
  buffer_load_dwordx4 a[44:47], v137, s[36:39], s51 offen offset:3072 sc1
  s_cmp_eq_u32 s87, 2
  v_mfma_f32_16x16x32_bf16 v[148:151], a[180:183], a[124:127], v[148:151]
  s_cselect_b32 s72, 50, 36
  s_lshl_b32 s51, s72, 11
  ds_read_b64_tr_b16 a[210:211], v244 offset:53248
  v_mfma_f32_16x16x32_bf16 v[148:151], a[176:179], a[116:119], v[148:151]
  s_waitcnt lgkmcnt(10)
  ds_read_b64_tr_b16 a[212:213], v244 offset:57344
  ds_read_b64_tr_b16 a[214:215], v244 offset:61440
  v_mfma_f32_16x16x32_bf16 v[156:159], a[184:187], a[116:119], v[156:159]
  buffer_load_dwordx4 a[48:51], v137, s[36:39], s51 offen offset:0 sc1
  ds_read_b64_tr_b16 a[176:177], v245 offset:49152
  v_mfma_f32_16x16x32_bf16 v[156:159], a[188:191], a[124:127], v[156:159]
  ds_read_b64_tr_b16 a[178:179], v245 offset:53248
  v_mfma_f32_16x16x32_bf16 v[152:155], a[188:191], a[120:123], v[152:155]
  ds_read_b64_tr_b16 a[180:181], v245 offset:57344
  v_mfma_f32_16x16x32_bf16 v[152:155], a[184:187], a[112:115], v[152:155]
  s_waitcnt lgkmcnt(11)
  ds_read_b64_tr_b16 a[182:183], v245 offset:61440
  v_mfma_f32_16x16x32_bf16 v[160:163], a[192:195], a[112:115], v[160:163]
  buffer_load_dwordx4 a[52:55], v137, s[36:39], s51 offen offset:1024 sc1
  s_lshl_b32 s50, s72, 16
  v_mfma_f32_16x16x32_bf16 v[160:163], a[196:199], a[120:123], v[160:163]
  s_add_u32 m0, s70, 32768
  ds_read_b64_tr_b16 a[184:185], v246 offset:49152
  ds_read_b64_tr_b16 a[186:187], v246 offset:53248
  v_mfma_f32_16x16x32_bf16 v[164:167], a[196:199], a[124:127], v[164:167]
  ds_read_b64_tr_b16 a[188:189], v246 offset:57344
  v_mfma_f32_16x16x32_bf16 v[164:167], a[192:195], a[116:119], v[164:167]
  s_waitcnt lgkmcnt(11)
  ds_read_b64_tr_b16 a[190:191], v246 offset:61440
  v_mfma_f32_16x16x32_bf16 v[172:175], a[200:203], a[116:119], v[172:175]
  buffer_load_dwordx4 v135, s[24:27], s50 offen offset:2048 lds
  ds_read_b64_tr_b16 a[192:193], v247 offset:49152
  v_mfma_f32_16x16x32_bf16 v[172:175], a[204:207], a[124:127], v[172:175]
  ds_read_b64_tr_b16 a[194:195], v247 offset:53248
  v_mfma_f32_16x16x32_bf16 v[168:171], a[204:207], a[120:123], v[168:171]
  ds_read_b64_tr_b16 a[196:197], v247 offset:57344
  v_mfma_f32_16x16x32_bf16 v[168:171], a[200:203], a[112:115], v[168:171]
  s_waitcnt vmcnt(25) lgkmcnt(11)
  ds_read_b64_tr_b16 a[198:199], v247 offset:61440
  v_mfma_f32_16x16x32_bf16 v[32:35], a[208:211], a[216:219], v[32:35]
  buffer_load_dwordx4 a[56:59], v137, s[36:39], s51 offen offset:2048 sc1
  ds_read_b64_tr_b16 a[200:201], v244 offset:51200
  v_mfma_f32_16x16x32_bf16 v[32:35], a[212:215], a[224:227], v[32:35]
  ds_read_b64_tr_b16 a[202:203], v244 offset:55296
  v_mfma_f32_16x16x32_bf16 v[36:39], a[212:215], a[228:231], v[36:39]
  ds_read_b64_tr_b16 a[204:205], v244 offset:59392
  v_mfma_f32_16x16x32_bf16 v[36:39], a[208:211], a[220:223], v[36:39]
  s_waitcnt lgkmcnt(11)
  ds_read_b64_tr_b16 a[206:207], v244 offset:63488
  v_mfma_f32_16x16x32_bf16 v[44:47], a[176:179], a[220:223], v[44:47]
  buffer_load_dwordx4 v136, s[24:27], s50 offen offset:3072 lds
  ds_read_b64_tr_b16 a[208:209], v245 offset:51200
  v_mfma_f32_16x16x32_bf16 v[44:47], a[180:183], a[228:231], v[44:47]
  ds_read_b64_tr_b16 a[210:211], v245 offset:55296
  v_mfma_f32_16x16x32_bf16 v[40:43], a[180:183], a[224:227], v[40:43]
  ds_read_b64_tr_b16 a[212:213], v245 offset:59392
  v_mfma_f32_16x16x32_bf16 v[40:43], a[176:179], a[216:219], v[40:43]
  s_waitcnt vmcnt(20) lgkmcnt(11)
  s_barrier
  buffer_load_dwordx4 a[60:63], v137, s[36:39], s51 offen offset:3072 sc1
  v_mfma_f32_16x16x32_bf16 v[48:51], a[184:187], a[216:219], v[48:51]
  s_cmp_eq_u32 s87, 3
  s_cselect_b32 s73, 54, 40
  s_lshl_b32 s51, s73, 11
  v_mfma_f32_16x16x32_bf16 v[48:51], a[188:191], a[224:227], v[48:51]
  ds_read_b64_tr_b16 a[214:215], v245 offset:63488
  ds_read_b64_tr_b16 a[176:177], v246 offset:51200
  v_mfma_f32_16x16x32_bf16 v[52:55], a[188:191], a[228:231], v[52:55]
  ds_read_b64_tr_b16 a[178:179], v246 offset:55296
  ds_read_b64_tr_b16 a[180:181], v246 offset:59392
  v_mfma_f32_16x16x32_bf16 v[52:55], a[184:187], a[220:223], v[52:55]
  s_waitcnt lgkmcnt(11)
  buffer_load_dwordx4 a[64:67], v137, s[36:39], s51 offen offset:0 sc1
  ds_read_b64_tr_b16 a[182:183], v246 offset:63488
  v_mfma_f32_16x16x32_bf16 v[60:63], a[192:195], a[220:223], v[60:63]
  ds_read_b64_tr_b16 a[184:185], v247 offset:51200
  v_mfma_f32_16x16x32_bf16 v[60:63], a[196:199], a[228:231], v[60:63]
  ds_read_b64_tr_b16 a[186:187], v247 offset:55296
  v_mfma_f32_16x16x32_bf16 v[56:59], a[196:199], a[224:227], v[56:59]
  ds_read_b64_tr_b16 a[188:189], v247 offset:59392
  v_mfma_f32_16x16x32_bf16 v[56:59], a[192:195], a[216:219], v[56:59]
  s_waitcnt lgkmcnt(11)
  buffer_load_dwordx4 a[68:71], v137, s[36:39], s51 offen offset:1024 sc1
  s_lshl_b32 s50, s73, 16
  v_mfma_f32_16x16x32_bf16 v[144:147], a[200:203], a[216:219], v[144:147]
  s_add_u32 m0, s70, 49152
  ds_read_b64_tr_b16 a[190:191], v247 offset:63488
  ds_read_b64_tr_b16 a[192:193], v248 offset:0
  v_mfma_f32_16x16x32_bf16 v[144:147], a[204:207], a[224:227], v[144:147]
  ds_read_b64_tr_b16 a[194:195], v248 offset:4096
  v_mfma_f32_16x16x32_bf16 v[148:151], a[204:207], a[228:231], v[148:151]
  ds_read_b64_tr_b16 a[196:197], v248 offset:8192
  v_mfma_f32_16x16x32_bf16 v[148:151], a[200:203], a[220:223], v[148:151]
  s_waitcnt lgkmcnt(11)
  buffer_load_dwordx4 v135, s[24:27], s50 offen offset:2048 lds
  ds_read_b64_tr_b16 a[198:199], v248 offset:12288
  v_mfma_f32_16x16x32_bf16 v[156:159], a[208:211], a[220:223], v[156:159]
  ds_read_b64_tr_b16 a[200:201], v249 offset:0
  v_mfma_f32_16x16x32_bf16 v[156:159], a[212:215], a[228:231], v[156:159]
  ds_read_b64_tr_b16 a[202:203], v249 offset:4096
  v_mfma_f32_16x16x32_bf16 v[152:155], a[212:215], a[224:227], v[152:155]
  ds_read_b64_tr_b16 a[204:205], v249 offset:8192
  v_mfma_f32_16x16x32_bf16 v[152:155], a[208:211], a[216:219], v[152:155]
  s_waitcnt lgkmcnt(11)
  buffer_load_dwordx4 a[72:75], v137, s[36:39], s51 offen offset:2048 sc1
  ds_read_b64_tr_b16 a[206:207], v249 offset:12288
  v_mfma_f32_16x16x32_bf16 v[160:163], a[176:179], a[216:219], v[160:163]
  ds_read_b64_tr_b16 a[208:209], v250 offset:0
  v_mfma_f32_16x16x32_bf16 v[160:163], a[180:183], a[224:227], v[160:163]
  ds_read_b64_tr_b16 a[210:211], v250 offset:4096
  v_mfma_f32_16x16x32_bf16 v[164:167], a[180:183], a[228:231], v[164:167]
  buffer_load_dwordx4 v136, s[24:27], s50 offen offset:3072 lds
  ds_read_b64_tr_b16 a[212:213], v250 offset:8192
  v_mfma_f32_16x16x32_bf16 v[164:167], a[176:179], a[220:223], v[164:167]
  s_waitcnt lgkmcnt(11)
  ds_read_b64_tr_b16 a[214:215], v250 offset:12288
  v_mfma_f32_16x16x32_bf16 v[172:175], a[184:187], a[220:223], v[172:175]
  ds_read_b64_tr_b16 a[176:177], v251 offset:0
  v_mfma_f32_16x16x32_bf16 v[172:175], a[188:191], a[228:231], v[172:175]
  ds_read_b64_tr_b16 a[178:179], v251 offset:4096
  v_mfma_f32_16x16x32_bf16 v[168:171], a[188:191], a[224:227], v[168:171]
  buffer_load_dwordx4 a[76:79], v137, s[36:39], s51 offen offset:3072 sc1
  s_cmp_eq_u32 s87, 0
  v_mfma_f32_16x16x32_bf16 v[168:171], a[184:187], a[216:219], v[168:171]
  s_waitcnt vmcnt(26) lgkmcnt(10)
  s_cselect_b32 s74, 15, 43
  s_lshl_b32 s51, s74, 11
  v_mfma_f32_16x16x32_bf16 v[32:35], a[192:195], a[0:3], v[32:35]
  ds_read_b64_tr_b16 a[180:181], v251 offset:8192
  ds_read_b64_tr_b16 a[182:183], v251 offset:12288
  v_mfma_f32_16x16x32_bf16 v[32:35], a[196:199], a[8:11], v[32:35]
  ds_read_b64_tr_b16 a[184:185], v248 offset:2048
  ds_read_b64_tr_b16 a[186:187], v248 offset:6144
  v_mfma_f32_16x16x32_bf16 v[36:39], a[196:199], a[12:15], v[36:39]
  buffer_load_dwordx4 a[80:83], v137, s[36:39], s51 offen offset:0 sc1
  ds_read_b64_tr_b16 a[188:189], v248 offset:10240
  v_mfma_f32_16x16x32_bf16 v[36:39], a[192:195], a[4:7], v[36:39]
  s_waitcnt lgkmcnt(11)
  ds_read_b64_tr_b16 a[190:191], v248 offset:14336
  v_mfma_f32_16x16x32_bf16 v[44:47], a[200:203], a[4:7], v[44:47]
  ds_read_b64_tr_b16 a[192:193], v249 offset:2048
  v_mfma_f32_16x16x32_bf16 v[44:47], a[204:207], a[12:15], v[44:47]
  ds_read_b64_tr_b16 a[194:195], v249 offset:6144
  v_mfma_f32_16x16x32_bf16 v[40:43], a[204:207], a[8:11], v[40:43]
  buffer_load_dwordx4 a[84:87], v137, s[36:39], s51 offen offset:1024 sc1
  s_lshl_b32 s50, s74, 16
  v_mfma_f32_16x16x32_bf16 v[40:43], a[200:203], a[0:3], v[40:43]
  s_waitcnt vmcnt(21) lgkmcnt(10)
  s_barrier
  s_add_u32 m0, s70, 65536
  v_mfma_f32_16x16x32_bf16 v[48:51], a[208:211], a[0:3], v[48:51]
  ds_read_b64_tr_b16 a[196:197], v249 offset:10240
  ds_read_b64_tr_b16 a[198:199], v249 offset:14336
  v_mfma_f32_16x16x32_bf16 v[48:51], a[212:215], a[8:11], v[48:51]
  ds_read_b64_tr_b16 a[200:201], v250 offset:2048
  ds_read_b64_tr_b16 a[202:203], v250 offset:6144
  v_mfma_f32_16x16x32_bf16 v[52:55], a[212:215], a[12:15], v[52:55]
  buffer_load_dwordx4 v135, s[24:27], s50 offen offset:2048 lds
  ds_read_b64_tr_b16 a[204:205], v250 offset:10240
  v_mfma_f32_16x16x32_bf16 v[52:55], a[208:211], a[4:7], v[52:55]
  s_waitcnt lgkmcnt(11)
  ds_read_b64_tr_b16 a[206:207], v250 offset:14336
  v_mfma_f32_16x16x32_bf16 v[60:63], a[176:179], a[4:7], v[60:63]
  ds_read_b64_tr_b16 a[208:209], v251 offset:2048
  v_mfma_f32_16x16x32_bf16 v[60:63], a[180:183], a[12:15], v[60:63]
  buffer_load_dwordx4 a[88:91], v137, s[36:39], s51 offen offset:2048 sc1
  ds_read_b64_tr_b16 a[210:211], v251 offset:6144
  v_mfma_f32_16x16x32_bf16 v[56:59], a[180:183], a[8:11], v[56:59]
  ds_read_b64_tr_b16 a[212:213], v251 offset:10240
  v_mfma_f32_16x16x32_bf16 v[56:59], a[176:179], a[0:3], v[56:59]
  s_waitcnt lgkmcnt(11)
  ds_read_b64_tr_b16 a[214:215], v251 offset:14336
  v_mfma_f32_16x16x32_bf16 v[144:147], a[184:187], a[0:3], v[144:147]
  ds_read_b64_tr_b16 a[176:177], v240 offset:0
  v_mfma_f32_16x16x32_bf16 v[144:147], a[188:191], a[8:11], v[144:147]
  buffer_load_dwordx4 v136, s[24:27], s50 offen offset:3072 lds
  ds_read_b64_tr_b16 a[178:179], v240 offset:4096
  v_mfma_f32_16x16x32_bf16 v[148:151], a[188:191], a[12:15], v[148:151]
  ds_read_b64_tr_b16 a[180:181], v240 offset:8192
  v_mfma_f32_16x16x32_bf16 v[148:151], a[184:187], a[4:7], v[148:151]
  s_waitcnt lgkmcnt(11)
  ds_read_b64_tr_b16 a[182:183], v240 offset:12288
  v_mfma_f32_16x16x32_bf16 v[156:159], a[192:195], a[4:7], v[156:159]
  ds_read_b64_tr_b16 a[184:185], v241 offset:0
  v_mfma_f32_16x16x32_bf16 v[156:159], a[196:199], a[12:15], v[156:159]
  buffer_load_dwordx4 a[92:95], v137, s[36:39], s51 offen offset:3072 sc1
  s_cmp_eq_u32 s87, 1
  v_mfma_f32_16x16x32_bf16 v[152:155], a[196:199], a[8:11], v[152:155]
  s_cselect_b32 s75, 5, 47
  s_lshl_b32 s51, s75, 11
  ds_read_b64_tr_b16 a[186:187], v241 offset:4096
  v_mfma_f32_16x16x32_bf16 v[152:155], a[192:195], a[0:3], v[152:155]
  s_waitcnt lgkmcnt(10)
  ds_read_b64_tr_b16 a[188:189], v241 offset:8192
  ds_read_b64_tr_b16 a[190:191], v241 offset:12288
  v_mfma_f32_16x16x32_bf16 v[160:163], a[200:203], a[0:3], v[160:163]
  ds_read_b64_tr_b16 a[192:193], v242 offset:0
  v_mfma_f32_16x16x32_bf16 v[160:163], a[204:207], a[8:11], v[160:163]
  buffer_load_dwordx4 a[96:99], v137, s[36:39], s51 offen offset:0 sc1
  ds_read_b64_tr_b16 a[194:195], v242 offset:4096
  v_mfma_f32_16x16x32_bf16 v[164:167], a[204:207], a[12:15], v[164:167]
  ds_read_b64_tr_b16 a[196:197], v242 offset:8192
  v_mfma_f32_16x16x32_bf16 v[164:167], a[200:203], a[4:7], v[164:167]
  s_waitcnt lgkmcnt(11)
  ds_read_b64_tr_b16 a[198:199], v242 offset:12288
  v_mfma_f32_16x16x32_bf16 v[172:175], a[208:211], a[4:7], v[172:175]
  ds_read_b64_tr_b16 a[200:201], v243 offset:0
  v_mfma_f32_16x16x32_bf16 v[172:175], a[212:215], a[12:15], v[172:175]
  buffer_load_dwordx4 a[100:103], v137, s[36:39], s51 offen offset:1024 sc1
  s_lshl_b32 s50, s75, 16
  v_mfma_f32_16x16x32_bf16 v[168:171], a[212:215], a[8:11], v[168:171]
  s_add_u32 m0, s70, 81920
  ds_read_b64_tr_b16 a[202:203], v243 offset:4096
  ds_read_b64_tr_b16 a[204:205], v243 offset:8192
  v_mfma_f32_16x16x32_bf16 v[168:171], a[208:211], a[0:3], v[168:171]
  s_waitcnt vmcnt(26) lgkmcnt(11)
  ds_read_b64_tr_b16 a[206:207], v243 offset:12288
  v_mfma_f32_16x16x32_bf16 v[32:35], a[176:179], a[16:19], v[32:35]
  buffer_load_dwordx4 v135, s[24:27], s50 offen offset:2048 lds
  ds_read_b64_tr_b16 a[208:209], v240 offset:2048
  v_mfma_f32_16x16x32_bf16 v[32:35], a[180:183], a[24:27], v[32:35]
  ds_read_b64_tr_b16 a[210:211], v240 offset:6144
  v_mfma_f32_16x16x32_bf16 v[36:39], a[180:183], a[28:31], v[36:39]
  ds_read_b64_tr_b16 a[212:213], v240 offset:10240
  v_mfma_f32_16x16x32_bf16 v[36:39], a[176:179], a[20:23], v[36:39]
  s_waitcnt lgkmcnt(11)
  ds_read_b64_tr_b16 a[214:215], v240 offset:14336
  v_mfma_f32_16x16x32_bf16 v[44:47], a[184:187], a[20:23], v[44:47]
  buffer_load_dwordx4 a[104:107], v137, s[36:39], s51 offen offset:2048 sc1
  ds_read_b64_tr_b16 a[176:177], v241 offset:2048
  v_mfma_f32_16x16x32_bf16 v[44:47], a[188:191], a[28:31], v[44:47]
  ds_read_b64_tr_b16 a[178:179], v241 offset:6144
  v_mfma_f32_16x16x32_bf16 v[40:43], a[188:191], a[24:27], v[40:43]
  ds_read_b64_tr_b16 a[180:181], v241 offset:10240
  v_mfma_f32_16x16x32_bf16 v[40:43], a[184:187], a[16:19], v[40:43]
  s_waitcnt vmcnt(23) lgkmcnt(11)
  s_barrier
  ds_read_b64_tr_b16 a[182:183], v241 offset:14336
  v_mfma_f32_16x16x32_bf16 v[48:51], a[192:195], a[16:19], v[48:51]
  buffer_load_dwordx4 v136, s[24:27], s50 offen offset:3072 lds
  ds_read_b64_tr_b16 a[184:185], v242 offset:2048
  v_mfma_f32_16x16x32_bf16 v[48:51], a[196:199], a[24:27], v[48:51]
  ds_read_b64_tr_b16 a[186:187], v242 offset:6144
  v_mfma_f32_16x16x32_bf16 v[52:55], a[196:199], a[28:31], v[52:55]
  ds_read_b64_tr_b16 a[188:189], v242 offset:10240
  v_mfma_f32_16x16x32_bf16 v[52:55], a[192:195], a[20:23], v[52:55]
  s_waitcnt lgkmcnt(11)
  ds_read_b64_tr_b16 a[190:191], v242 offset:14336
  v_mfma_f32_16x16x32_bf16 v[60:63], a[200:203], a[20:23], v[60:63]
  buffer_load_dwordx4 a[108:111], v137, s[36:39], s51 offen offset:3072 sc1
  s_cmp_eq_u32 s87, 2
  v_mfma_f32_16x16x32_bf16 v[60:63], a[204:207], a[28:31], v[60:63]
  s_cselect_b32 s76, 8, 50
  s_lshl_b32 s51, s76, 11
  ds_read_b64_tr_b16 a[192:193], v243 offset:2048
  v_mfma_f32_16x16x32_bf16 v[56:59], a[204:207], a[24:27], v[56:59]
  ds_read_b64_tr_b16 a[194:195], v243 offset:6144
  ds_read_b64_tr_b16 a[196:197], v243 offset:10240
  v_mfma_f32_16x16x32_bf16 v[56:59], a[200:203], a[16:19], v[56:59]
  s_waitcnt lgkmcnt(11)
  ds_read_b64_tr_b16 a[198:199], v243 offset:14336
  v_mfma_f32_16x16x32_bf16 v[144:147], a[208:211], a[16:19], v[144:147]
  buffer_load_dwordx4 a[112:115], v137, s[36:39], s51 offen offset:0 sc1
  ds_read_b64_tr_b16 a[200:201], v240 offset:18432
  v_mfma_f32_16x16x32_bf16 v[144:147], a[212:215], a[24:27], v[144:147]
  ds_read_b64_tr_b16 a[202:203], v240 offset:22528
  v_mfma_f32_16x16x32_bf16 v[148:151], a[212:215], a[28:31], v[148:151]
  ds_read_b64_tr_b16 a[204:205], v240 offset:26624
  v_mfma_f32_16x16x32_bf16 v[148:151], a[208:211], a[20:23], v[148:151]
  s_waitcnt lgkmcnt(11)
  buffer_load_dwordx4 a[116:119], v137, s[36:39], s51 offen offset:1024 sc1
  s_lshl_b32 s50, s76, 16
  v_mfma_f32_16x16x32_bf16 v[156:159], a[176:179], a[20:23], v[156:159]
  s_add_u32 m0, s70, 98304
  ds_read_b64_tr_b16 a[206:207], v240 offset:30720
  ds_read_b64_tr_b16 a[208:209], v241 offset:18432
  v_mfma_f32_16x16x32_bf16 v[156:159], a[180:183], a[28:31], v[156:159]
  ds_read_b64_tr_b16 a[210:211], v241 offset:22528
  v_mfma_f32_16x16x32_bf16 v[152:155], a[180:183], a[24:27], v[152:155]
  ds_read_b64_tr_b16 a[212:213], v241 offset:26624
  v_mfma_f32_16x16x32_bf16 v[152:155], a[176:179], a[16:19], v[152:155]
  s_waitcnt vmcnt(21) lgkmcnt(11)
  s_barrier
  buffer_load_dwordx4 v135, s[24:27], s50 offen offset:2048 lds
  v_mfma_f32_16x16x32_bf16 v[160:163], a[184:187], a[16:19], v[160:163]
  ds_read_b64_tr_b16 a[214:215], v241 offset:30720
  ds_read_b64_tr_b16 a[176:177], v242 offset:18432
  v_mfma_f32_16x16x32_bf16 v[160:163], a[188:191], a[24:27], v[160:163]
  ds_read_b64_tr_b16 a[178:179], v242 offset:22528
  v_mfma_f32_16x16x32_bf16 v[164:167], a[188:191], a[28:31], v[164:167]
  ds_read_b64_tr_b16 a[180:181], v242 offset:26624
  v_mfma_f32_16x16x32_bf16 v[164:167], a[184:187], a[20:23], v[164:167]
  s_waitcnt lgkmcnt(11)
  buffer_load_dwordx4 a[120:123], v137, s[36:39], s51 offen offset:2048 sc1
  ds_read_b64_tr_b16 a[182:183], v242 offset:30720
  v_mfma_f32_16x16x32_bf16 v[172:175], a[192:195], a[20:23], v[172:175]
  ds_read_b64_tr_b16 a[184:185], v243 offset:18432
  v_mfma_f32_16x16x32_bf16 v[172:175], a[196:199], a[28:31], v[172:175]
  ds_read_b64_tr_b16 a[186:187], v243 offset:22528
  v_mfma_f32_16x16x32_bf16 v[168:171], a[196:199], a[24:27], v[168:171]
  ds_read_b64_tr_b16 a[188:189], v243 offset:26624
  v_mfma_f32_16x16x32_bf16 v[168:171], a[192:195], a[16:19], v[168:171]
  s_waitcnt vmcnt(28) lgkmcnt(11)
  buffer_load_dwordx4 v136, s[24:27], s50 offen offset:3072 lds
  ds_read_b64_tr_b16 a[190:191], v243 offset:30720
  v_mfma_f32_16x16x32_bf16 v[144:147], a[200:203], a[32:35], v[144:147]
  ds_read_b64_tr_b16 a[192:193], v240 offset:34816
  v_mfma_f32_16x16x32_bf16 v[144:147], a[204:207], a[40:43], v[144:147]
  ds_read_b64_tr_b16 a[194:195], v240 offset:38912
  v_mfma_f32_16x16x32_bf16 v[148:151], a[204:207], a[44:47], v[148:151]
  ds_read_b64_tr_b16 a[196:197], v240 offset:43008
  v_mfma_f32_16x16x32_bf16 v[148:151], a[200:203], a[36:39], v[148:151]
  s_waitcnt lgkmcnt(11)
  buffer_load_dwordx4 a[124:127], v137, s[36:39], s51 offen offset:3072 sc1
  s_cmp_eq_u32 s87, 3
  v_mfma_f32_16x16x32_bf16 v[156:159], a[208:211], a[36:39], v[156:159]
  s_cselect_b32 s81, 12, 54
  s_lshl_b32 s51, s81, 11
  ds_read_b64_tr_b16 a[198:199], v240 offset:47104
  v_mfma_f32_16x16x32_bf16 v[156:159], a[212:215], a[44:47], v[156:159]
  ds_read_b64_tr_b16 a[200:201], v241 offset:34816
  ds_read_b64_tr_b16 a[202:203], v241 offset:38912
  v_mfma_f32_16x16x32_bf16 v[152:155], a[212:215], a[40:43], v[152:155]
  buffer_load_dwordx4 a[216:219], v137, s[36:39], s51 offen offset:0 sc1
  ds_read_b64_tr_b16 a[204:205], v241 offset:43008
  v_mfma_f32_16x16x32_bf16 v[152:155], a[208:211], a[32:35], v[152:155]
  s_waitcnt vmcnt(20) lgkmcnt(11)
  s_barrier
  ds_read_b64_tr_b16 a[206:207], v241 offset:47104
  v_mfma_f32_16x16x32_bf16 v[160:163], a[176:179], a[32:35], v[160:163]
  ds_read_b64_tr_b16 a[208:209], v242 offset:34816
  v_mfma_f32_16x16x32_bf16 v[160:163], a[180:183], a[40:43], v[160:163]
  ds_read_b64_tr_b16 a[210:211], v242 offset:38912
  v_mfma_f32_16x16x32_bf16 v[164:167], a[180:183], a[44:47], v[164:167]
  buffer_load_dwordx4 a[220:223], v137, s[36:39], s51 offen offset:1024 sc1
  s_lshl_b32 s50, s81, 16
  v_mfma_f32_16x16x32_bf16 v[164:167], a[176:179], a[36:39], v[164:167]
  s_waitcnt lgkmcnt(10)
  s_add_u32 m0, s70, 114688
  ds_read_b64_tr_b16 a[212:213], v242 offset:43008
  v_mfma_f32_16x16x32_bf16 v[172:175], a[184:187], a[36:39], v[172:175]
  ds_read_b64_tr_b16 a[214:215], v242 offset:47104
  ds_read_b64_tr_b16 a[176:177], v243 offset:34816
  v_mfma_f32_16x16x32_bf16 v[172:175], a[188:191], a[44:47], v[172:175]
  ds_read_b64_tr_b16 a[178:179], v243 offset:38912
  v_mfma_f32_16x16x32_bf16 v[168:171], a[188:191], a[40:43], v[168:171]
  buffer_load_dwordx4 v135, s[24:27], s50 offen offset:2048 lds
  ds_read_b64_tr_b16 a[180:181], v243 offset:43008
  v_mfma_f32_16x16x32_bf16 v[168:171], a[184:187], a[32:35], v[168:171]
  s_waitcnt vmcnt(27) lgkmcnt(11)
  ds_read_b64_tr_b16 a[182:183], v243 offset:47104
  v_mfma_f32_16x16x32_bf16 v[144:147], a[192:195], a[48:51], v[144:147]
  ds_read_b64_tr_b16 a[184:185], v240 offset:51200
  v_mfma_f32_16x16x32_bf16 v[144:147], a[196:199], a[56:59], v[144:147]
  ds_read_b64_tr_b16 a[186:187], v240 offset:55296
  v_mfma_f32_16x16x32_bf16 v[148:151], a[196:199], a[60:63], v[148:151]
  buffer_load_dwordx4 a[224:227], v137, s[36:39], s51 offen offset:2048 sc1
  ds_read_b64_tr_b16 a[188:189], v240 offset:59392
  v_mfma_f32_16x16x32_bf16 v[148:151], a[192:195], a[52:55], v[148:151]
  s_waitcnt lgkmcnt(11)
  ds_read_b64_tr_b16 a[190:191], v240 offset:63488
  v_mfma_f32_16x16x32_bf16 v[156:159], a[200:203], a[52:55], v[156:159]
  ds_read_b64_tr_b16 a[192:193], v241 offset:51200
  v_mfma_f32_16x16x32_bf16 v[156:159], a[204:207], a[60:63], v[156:159]
  ds_read_b64_tr_b16 a[194:195], v241 offset:55296
  v_mfma_f32_16x16x32_bf16 v[152:155], a[204:207], a[56:59], v[152:155]
  buffer_load_dwordx4 v136, s[24:27], s50 offen offset:3072 lds
  ds_read_b64_tr_b16 a[196:197], v241 offset:59392
  v_mfma_f32_16x16x32_bf16 v[152:155], a[200:203], a[48:51], v[152:155]
  s_waitcnt vmcnt(18) lgkmcnt(11)
  s_barrier
  ds_read_b64_tr_b16 a[198:199], v241 offset:63488
  v_mfma_f32_16x16x32_bf16 v[160:163], a[208:211], a[48:51], v[160:163]
  ds_read_b64_tr_b16 a[200:201], v242 offset:51200
  v_mfma_f32_16x16x32_bf16 v[160:163], a[212:215], a[56:59], v[160:163]
  ds_read_b64_tr_b16 a[202:203], v242 offset:55296
  v_mfma_f32_16x16x32_bf16 v[164:167], a[212:215], a[60:63], v[164:167]
  buffer_load_dwordx4 a[228:231], v137, s[36:39], s51 offen offset:3072 sc1
  s_lshl_b32 s50, s71, 16
  v_mfma_f32_16x16x32_bf16 v[164:167], a[208:211], a[52:55], v[164:167]
  s_waitcnt lgkmcnt(10)
  s_add_u32 m0, s70, 16384
  ds_read_b64_tr_b16 a[204:205], v242 offset:59392
  v_mfma_f32_16x16x32_bf16 v[172:175], a[176:179], a[52:55], v[172:175]
  ds_read_b64_tr_b16 a[206:207], v242 offset:63488
  ds_read_b64_tr_b16 a[208:209], v243 offset:51200
  v_mfma_f32_16x16x32_bf16 v[172:175], a[180:183], a[60:63], v[172:175]
  ds_read_b64_tr_b16 a[210:211], v243 offset:55296
  v_mfma_f32_16x16x32_bf16 v[168:171], a[180:183], a[56:59], v[168:171]
  buffer_load_dwordx4 v133, s[24:27], s50 offen offset:0 lds
  ds_read_b64_tr_b16 a[212:213], v243 offset:59392
  v_mfma_f32_16x16x32_bf16 v[168:171], a[176:179], a[48:51], v[168:171]
  s_waitcnt vmcnt(25) lgkmcnt(11)
  ds_read_b64_tr_b16 a[214:215], v243 offset:63488
  v_mfma_f32_16x16x32_bf16 v[144:147], a[184:187], a[64:67], v[144:147]
  ds_read_b64_tr_b16 a[176:177], v244 offset:2048
  v_mfma_f32_16x16x32_bf16 v[144:147], a[188:191], a[72:75], v[144:147]
  ds_read_b64_tr_b16 a[178:179], v244 offset:6144
  v_mfma_f32_16x16x32_bf16 v[148:151], a[188:191], a[76:79], v[148:151]
  buffer_load_dwordx4 v134, s[24:27], s50 offen offset:1024 lds
  s_lshl_b32 s50, s72, 16
  v_mfma_f32_16x16x32_bf16 v[148:151], a[184:187], a[68:71], v[148:151]
  s_waitcnt lgkmcnt(10)
  s_add_u32 m0, s70, 32768
  ds_read_b64_tr_b16 a[180:181], v244 offset:10240
  v_mfma_f32_16x16x32_bf16 v[156:159], a[192:195], a[68:71], v[156:159]
  ds_read_b64_tr_b16 a[182:183], v244 offset:14336
  ds_read_b64_tr_b16 a[184:185], v245 offset:2048
  v_mfma_f32_16x16x32_bf16 v[156:159], a[196:199], a[76:79], v[156:159]
  ds_read_b64_tr_b16 a[186:187], v245 offset:6144
  v_mfma_f32_16x16x32_bf16 v[152:155], a[196:199], a[72:75], v[152:155]
  buffer_load_dwordx4 v133, s[24:27], s50 offen offset:0 lds
  ds_read_b64_tr_b16 a[188:189], v245 offset:10240
  v_mfma_f32_16x16x32_bf16 v[152:155], a[192:195], a[64:67], v[152:155]
  s_waitcnt vmcnt(16) lgkmcnt(11)
  s_barrier
  ds_read_b64_tr_b16 a[190:191], v245 offset:14336
  v_mfma_f32_16x16x32_bf16 v[160:163], a[200:203], a[64:67], v[160:163]
  ds_read_b64_tr_b16 a[192:193], v246 offset:2048
  v_mfma_f32_16x16x32_bf16 v[160:163], a[204:207], a[72:75], v[160:163]
  ds_read_b64_tr_b16 a[194:195], v246 offset:6144
  v_mfma_f32_16x16x32_bf16 v[164:167], a[204:207], a[76:79], v[164:167]
  buffer_load_dwordx4 v134, s[24:27], s50 offen offset:1024 lds
  s_lshl_b32 s50, s73, 16
  v_mfma_f32_16x16x32_bf16 v[164:167], a[200:203], a[68:71], v[164:167]
  s_waitcnt lgkmcnt(10)
  s_add_u32 m0, s70, 49152
  ds_read_b64_tr_b16 a[196:197], v246 offset:10240
  v_mfma_f32_16x16x32_bf16 v[172:175], a[208:211], a[68:71], v[172:175]
Hb2_3:
  s_cbranch_execz Rb
  ds_read_b64_tr_b16 a[198:199], v246 offset:14336
  ds_read_b64_tr_b16 a[200:201], v247 offset:2048
  v_mfma_f32_16x16x32_bf16 v[172:175], a[212:215], a[76:79], v[172:175]
  ds_read_b64_tr_b16 a[202:203], v247 offset:6144
  v_mfma_f32_16x16x32_bf16 v[168:171], a[212:215], a[72:75], v[168:171]
  buffer_load_dwordx4 v133, s[24:27], s50 offen offset:0 lds
  ds_read_b64_tr_b16 a[204:205], v247 offset:10240
  v_mfma_f32_16x16x32_bf16 v[168:171], a[208:211], a[64:67], v[168:171]
  s_waitcnt vmcnt(23) lgkmcnt(11)
  ds_read_b64_tr_b16 a[206:207], v247 offset:14336
  v_mfma_f32_16x16x32_bf16 v[144:147], a[176:179], a[80:83], v[144:147]
  ds_read_b64_tr_b16 a[208:209], v244 offset:18432
  v_mfma_f32_16x16x32_bf16 v[144:147], a[180:183], a[88:91], v[144:147]
  ds_read_b64_tr_b16 a[210:211], v244 offset:22528
  v_mfma_f32_16x16x32_bf16 v[148:151], a[180:183], a[92:95], v[148:151]
  buffer_load_dwordx4 v134, s[24:27], s50 offen offset:1024 lds
  s_lshl_b32 s50, s74, 16
  v_mfma_f32_16x16x32_bf16 v[148:151], a[176:179], a[84:87], v[148:151]
  s_waitcnt lgkmcnt(10)
  s_add_u32 m0, s70, 65536
  ds_read_b64_tr_b16 a[212:213], v244 offset:26624
  v_mfma_f32_16x16x32_bf16 v[156:159], a[184:187], a[84:87], v[156:159]
  ds_read_b64_tr_b16 a[214:215], v244 offset:30720
  ds_read_b64_tr_b16 a[176:177], v245 offset:18432
  v_mfma_f32_16x16x32_bf16 v[156:159], a[188:191], a[92:95], v[156:159]
  ds_read_b64_tr_b16 a[178:179], v245 offset:22528
  v_mfma_f32_16x16x32_bf16 v[152:155], a[188:191], a[88:91], v[152:155]
  buffer_load_dwordx4 v133, s[24:27], s50 offen offset:0 lds
  ds_read_b64_tr_b16 a[180:181], v245 offset:26624
  v_mfma_f32_16x16x32_bf16 v[152:155], a[184:187], a[80:83], v[152:155]
  s_waitcnt vmcnt(14) lgkmcnt(11)
  s_barrier
  ds_read_b64_tr_b16 a[182:183], v245 offset:30720
  v_mfma_f32_16x16x32_bf16 v[160:163], a[192:195], a[80:83], v[160:163]
  ds_read_b64_tr_b16 a[184:185], v246 offset:18432
  v_mfma_f32_16x16x32_bf16 v[160:163], a[196:199], a[88:91], v[160:163]
  ds_read_b64_tr_b16 a[186:187], v246 offset:22528
  v_mfma_f32_16x16x32_bf16 v[164:167], a[196:199], a[92:95], v[164:167]
  buffer_load_dwordx4 v134, s[24:27], s50 offen offset:1024 lds
  s_lshl_b32 s50, s75, 16
  v_mfma_f32_16x16x32_bf16 v[164:167], a[192:195], a[84:87], v[164:167]
  s_waitcnt lgkmcnt(10)
  s_add_u32 m0, s70, 81920
  ds_read_b64_tr_b16 a[188:189], v246 offset:26624
  v_mfma_f32_16x16x32_bf16 v[172:175], a[200:203], a[84:87], v[172:175]
  ds_read_b64_tr_b16 a[190:191], v246 offset:30720
  ds_read_b64_tr_b16 a[192:193], v247 offset:18432
  v_mfma_f32_16x16x32_bf16 v[172:175], a[204:207], a[92:95], v[172:175]
  ds_read_b64_tr_b16 a[194:195], v247 offset:22528
  v_mfma_f32_16x16x32_bf16 v[168:171], a[204:207], a[88:91], v[168:171]
  buffer_load_dwordx4 v133, s[24:27], s50 offen offset:0 lds
  ds_read_b64_tr_b16 a[196:197], v247 offset:26624
  v_mfma_f32_16x16x32_bf16 v[168:171], a[200:203], a[80:83], v[168:171]
  s_waitcnt vmcnt(21) lgkmcnt(11)
  ds_read_b64_tr_b16 a[198:199], v247 offset:30720
  v_mfma_f32_16x16x32_bf16 v[144:147], a[208:211], a[96:99], v[144:147]
  ds_read_b64_tr_b16 a[200:201], v244 offset:34816
  v_mfma_f32_16x16x32_bf16 v[144:147], a[212:215], a[104:107], v[144:147]
  ds_read_b64_tr_b16 a[202:203], v244 offset:38912
  v_mfma_f32_16x16x32_bf16 v[148:151], a[212:215], a[108:111], v[148:151]
  buffer_load_dwordx4 v134, s[24:27], s50 offen offset:1024 lds
  s_lshl_b32 s50, s76, 16
  v_mfma_f32_16x16x32_bf16 v[148:151], a[208:211], a[100:103], v[148:151]
  s_waitcnt lgkmcnt(10)
  s_add_u32 m0, s70, 98304
  ds_read_b64_tr_b16 a[204:205], v244 offset:43008
  v_mfma_f32_16x16x32_bf16 v[156:159], a[176:179], a[100:103], v[156:159]
  ds_read_b64_tr_b16 a[206:207], v244 offset:47104
  ds_read_b64_tr_b16 a[208:209], v245 offset:34816
  v_mfma_f32_16x16x32_bf16 v[156:159], a[180:183], a[108:111], v[156:159]
  ds_read_b64_tr_b16 a[210:211], v245 offset:38912
  v_mfma_f32_16x16x32_bf16 v[152:155], a[180:183], a[104:107], v[152:155]
  buffer_load_dwordx4 v133, s[24:27], s50 offen offset:0 lds
  ds_read_b64_tr_b16 a[212:213], v245 offset:43008
  v_mfma_f32_16x16x32_bf16 v[152:155], a[176:179], a[96:99], v[152:155]
  s_waitcnt vmcnt(12) lgkmcnt(11)
  s_barrier
  ds_read_b64_tr_b16 a[214:215], v245 offset:47104
  v_mfma_f32_16x16x32_bf16 v[160:163], a[184:187], a[96:99], v[160:163]
  ds_read_b64_tr_b16 a[176:177], v246 offset:34816
  v_mfma_f32_16x16x32_bf16 v[160:163], a[188:191], a[104:107], v[160:163]
  ds_read_b64_tr_b16 a[178:179], v246 offset:38912
  v_mfma_f32_16x16x32_bf16 v[164:167], a[188:191], a[108:111], v[164:167]
  buffer_load_dwordx4 v134, s[24:27], s50 offen offset:1024 lds
  s_lshl_b32 s50, s81, 16
  v_mfma_f32_16x16x32_bf16 v[164:167], a[184:187], a[100:103], v[164:167]
  s_waitcnt lgkmcnt(10)
  s_add_u32 m0, s70, 114688
  ds_read_b64_tr_b16 a[180:181], v246 offset:43008
  v_mfma_f32_16x16x32_bf16 v[172:175], a[192:195], a[100:103], v[172:175]
  ds_read_b64_tr_b16 a[182:183], v246 offset:47104
  ds_read_b64_tr_b16 a[184:185], v247 offset:34816
  v_mfma_f32_16x16x32_bf16 v[172:175], a[196:199], a[108:111], v[172:175]
  ds_read_b64_tr_b16 a[186:187], v247 offset:38912
  v_mfma_f32_16x16x32_bf16 v[168:171], a[196:199], a[104:107], v[168:171]
  buffer_load_dwordx4 v133, s[24:27], s50 offen offset:0 lds
  ds_read_b64_tr_b16 a[188:189], v247 offset:43008
  v_mfma_f32_16x16x32_bf16 v[168:171], a[192:195], a[96:99], v[168:171]
  s_waitcnt vmcnt(19) lgkmcnt(11)
  ds_read_b64_tr_b16 a[190:191], v247 offset:47104
  v_mfma_f32_16x16x32_bf16 v[144:147], a[200:203], a[112:115], v[144:147]
  ds_read_b64_tr_b16 a[192:193], v244 offset:51200
  v_mfma_f32_16x16x32_bf16 v[144:147], a[204:207], a[120:123], v[144:147]
  ds_read_b64_tr_b16 a[194:195], v244 offset:55296
  v_mfma_f32_16x16x32_bf16 v[148:151], a[204:207], a[124:127], v[148:151]
  buffer_load_dwordx4 v134, s[24:27], s50 offen offset:1024 lds
  ds_read_b64_tr_b16 a[196:197], v244 offset:59392
  v_mfma_f32_16x16x32_bf16 v[148:151], a[200:203], a[116:119], v[148:151]
  s_waitcnt lgkmcnt(11)
  ds_read_b64_tr_b16 a[198:199], v244 offset:63488
  v_mfma_f32_16x16x32_bf16 v[156:159], a[208:211], a[116:119], v[156:159]
  ds_read_b64_tr_b16 a[200:201], v245 offset:51200
  v_mfma_f32_16x16x32_bf16 v[156:159], a[212:215], a[124:127], v[156:159]
  ds_read_b64_tr_b16 a[202:203], v245 offset:55296
  v_mfma_f32_16x16x32_bf16 v[152:155], a[212:215], a[120:123], v[152:155]
  ds_read_b64_tr_b16 a[204:205], v245 offset:59392
  v_mfma_f32_16x16x32_bf16 v[152:155], a[208:211], a[112:115], v[152:155]
  s_waitcnt vmcnt(12) lgkmcnt(11)
  s_barrier
  ds_read_b64_tr_b16 a[206:207], v245 offset:63488
  v_mfma_f32_16x16x32_bf16 v[160:163], a[176:179], a[112:115], v[160:163]
  ds_read_b64_tr_b16 a[208:209], v246 offset:51200
  v_mfma_f32_16x16x32_bf16 v[160:163], a[180:183], a[120:123], v[160:163]
  ds_read_b64_tr_b16 a[210:211], v246 offset:55296
  v_mfma_f32_16x16x32_bf16 v[164:167], a[180:183], a[124:127], v[164:167]
  ds_read_b64_tr_b16 a[212:213], v246 offset:59392
  v_mfma_f32_16x16x32_bf16 v[164:167], a[176:179], a[116:119], v[164:167]
  s_waitcnt lgkmcnt(11)
  ds_read_b64_tr_b16 a[214:215], v246 offset:63488
  v_mfma_f32_16x16x32_bf16 v[172:175], a[184:187], a[116:119], v[172:175]
  ds_read_b64_tr_b16 a[176:177], v247 offset:51200
  v_mfma_f32_16x16x32_bf16 v[172:175], a[188:191], a[124:127], v[172:175]
  ds_read_b64_tr_b16 a[178:179], v247 offset:55296
  v_mfma_f32_16x16x32_bf16 v[168:171], a[188:191], a[120:123], v[168:171]
  ds_read_b64_tr_b16 a[180:181], v247 offset:59392
  v_mfma_f32_16x16x32_bf16 v[168:171], a[184:187], a[112:115], v[168:171]
  s_waitcnt vmcnt(14) lgkmcnt(11)
  ds_read_b64_tr_b16 a[182:183], v247 offset:63488
  v_mfma_f32_16x16x32_bf16 v[144:147], a[192:195], a[216:219], v[144:147]
  ds_read_b64_tr_b16 a[184:185], v240 offset:16384
  v_mfma_f32_16x16x32_bf16 v[144:147], a[196:199], a[224:227], v[144:147]
  ds_read_b64_tr_b16 a[186:187], v240 offset:20480
  v_mfma_f32_16x16x32_bf16 v[148:151], a[196:199], a[228:231], v[148:151]
  ds_read_b64_tr_b16 a[188:189], v240 offset:24576
  v_mfma_f32_16x16x32_bf16 v[148:151], a[192:195], a[220:223], v[148:151]
  s_waitcnt lgkmcnt(11)
  ds_read_b64_tr_b16 a[190:191], v240 offset:28672
  v_mfma_f32_16x16x32_bf16 v[156:159], a[200:203], a[220:223], v[156:159]
  ds_read_b64_tr_b16 a[192:193], v241 offset:16384
  v_mfma_f32_16x16x32_bf16 v[156:159], a[204:207], a[228:231], v[156:159]
  ds_read_b64_tr_b16 a[194:195], v241 offset:20480
  v_mfma_f32_16x16x32_bf16 v[152:155], a[204:207], a[224:227], v[152:155]
  ds_read_b64_tr_b16 a[196:197], v241 offset:24576
  v_mfma_f32_16x16x32_bf16 v[152:155], a[200:203], a[216:219], v[152:155]
  s_waitcnt vmcnt(10) lgkmcnt(11)
  s_barrier
  ds_read_b64_tr_b16 a[198:199], v241 offset:28672
  v_mfma_f32_16x16x32_bf16 v[160:163], a[208:211], a[216:219], v[160:163]
  ds_read_b64_tr_b16 a[200:201], v242 offset:16384
  buffer_store_dwordx4 v[144:147], v0, s[36:39], s61 offen offset:0 sc1
  v_mfma_f32_16x16x32_bf16 v[160:163], a[212:215], a[224:227], v[160:163]
  buffer_store_dwordx4 v[148:151], v0, s[36:39], s61 offen offset:1024 sc1
  ds_read_b64_tr_b16 a[202:203], v242 offset:20480
  v_mfma_f32_16x16x32_bf16 v[164:167], a[212:215], a[228:231], v[164:167]
  ds_read_b64_tr_b16 a[204:205], v242 offset:24576
  v_mfma_f32_16x16x32_bf16 v[164:167], a[208:211], a[220:223], v[164:167]
  s_waitcnt lgkmcnt(11)
  ds_read_b64_tr_b16 a[206:207], v242 offset:28672
  v_mfma_f32_16x16x32_bf16 v[172:175], a[176:179], a[220:223], v[172:175]
  ds_read_b64_tr_b16 a[208:209], v243 offset:16384
  buffer_store_dwordx4 v[152:155], v0, s[36:39], s61 offen offset:2048 sc1
  v_mfma_f32_16x16x32_bf16 v[172:175], a[180:183], a[228:231], v[172:175]
  buffer_store_dwordx4 v[156:159], v0, s[36:39], s61 offen offset:3072 sc1
  ds_read_b64_tr_b16 a[210:211], v243 offset:20480
  v_mfma_f32_16x16x32_bf16 v[168:171], a[180:183], a[224:227], v[168:171]
  ds_read_b64_tr_b16 a[212:213], v243 offset:24576
  v_mfma_f32_16x16x32_bf16 v[168:171], a[176:179], a[216:219], v[168:171]
  s_waitcnt lgkmcnt(11)
  ds_read_b64_tr_b16 a[214:215], v243 offset:28672
  v_mfma_f32_16x16x32_bf16 v[32:35], a[184:187], a[32:35], v[32:35]
  ds_read_b64_tr_b16 a[176:177], v240 offset:32768
  buffer_store_dwordx4 v[160:163], v0, s[36:39], s62 offen offset:0 sc1
  v_mfma_f32_16x16x32_bf16 v[32:35], a[188:191], a[40:43], v[32:35]
  buffer_store_dwordx4 v[164:167], v0, s[36:39], s62 offen offset:1024 sc1
  ds_read_b64_tr_b16 a[178:179], v240 offset:36864
  v_mfma_f32_16x16x32_bf16 v[36:39], a[188:191], a[44:47], v[36:39]
  ds_read_b64_tr_b16 a[180:181], v240 offset:40960
  v_mfma_f32_16x16x32_bf16 v[36:39], a[184:187], a[36:39], v[36:39]
  s_waitcnt lgkmcnt(11)
  ds_read_b64_tr_b16 a[182:183], v240 offset:45056
  v_mfma_f32_16x16x32_bf16 v[44:47], a[192:195], a[36:39], v[44:47]
  ds_read_b64_tr_b16 a[184:185], v241 offset:32768
  buffer_store_dwordx4 v[168:171], v0, s[36:39], s62 offen offset:2048 sc1
  v_mfma_f32_16x16x32_bf16 v[44:47], a[196:199], a[44:47], v[44:47]
  buffer_store_dwordx4 v[172:175], v0, s[36:39], s62 offen offset:3072 sc1
  ds_read_b64_tr_b16 a[186:187], v241 offset:36864
  v_mfma_f32_16x16x32_bf16 v[40:43], a[196:199], a[40:43], v[40:43]
  ds_read_b64_tr_b16 a[188:189], v241 offset:40960
  v_mfma_f32_16x16x32_bf16 v[40:43], a[192:195], a[32:35], v[40:43]
  s_waitcnt vmcnt(16) lgkmcnt(11)
  s_barrier
  ds_read_b64_tr_b16 a[190:191], v241 offset:45056
  v_mfma_f32_16x16x32_bf16 v[48:51], a[200:203], a[32:35], v[48:51]
  ds_read_b64_tr_b16 a[192:193], v242 offset:32768
  v_mfma_f32_16x16x32_bf16 v[48:51], a[204:207], a[40:43], v[48:51]
  ds_read_b64_tr_b16 a[194:195], v242 offset:36864
  v_mfma_f32_16x16x32_bf16 v[52:55], a[204:207], a[44:47], v[52:55]
  ds_read_b64_tr_b16 a[196:197], v242 offset:40960
  v_mfma_f32_16x16x32_bf16 v[52:55], a[200:203], a[36:39], v[52:55]
  s_waitcnt lgkmcnt(11)
  ds_read_b64_tr_b16 a[198:199], v242 offset:45056
  v_mfma_f32_16x16x32_bf16 v[60:63], a[208:211], a[36:39], v[60:63]
  ds_read_b64_tr_b16 a[200:201], v243 offset:32768
  v_mfma_f32_16x16x32_bf16 v[60:63], a[212:215], a[44:47], v[60:63]
  ds_read_b64_tr_b16 a[202:203], v243 offset:36864
  v_mfma_f32_16x16x32_bf16 v[56:59], a[212:215], a[40:43], v[56:59]
  ds_read_b64_tr_b16 a[204:205], v243 offset:40960
  v_mfma_f32_16x16x32_bf16 v[56:59], a[208:211], a[32:35], v[56:59]
  s_waitcnt lgkmcnt(11)
  ds_read_b64_tr_b16 a[206:207], v243 offset:45056
  v_mfma_f32_16x16x32_bf16 v[32:35], a[176:179], a[48:51], v[32:35]
  ds_read_b64_tr_b16 a[208:209], v240 offset:49152
  v_mfma_f32_16x16x32_bf16 v[32:35], a[180:183], a[56:59], v[32:35]
  ds_read_b64_tr_b16 a[210:211], v240 offset:53248
  v_mfma_f32_16x16x32_bf16 v[36:39], a[180:183], a[60:63], v[36:39]
  ds_read_b64_tr_b16 a[212:213], v240 offset:57344
  v_mfma_f32_16x16x32_bf16 v[36:39], a[176:179], a[52:55], v[36:39]
  s_waitcnt lgkmcnt(11)
  ds_read_b64_tr_b16 a[214:215], v240 offset:61440
  v_mfma_f32_16x16x32_bf16 v[44:47], a[184:187], a[52:55], v[44:47]
  ds_read_b64_tr_b16 a[176:177], v241 offset:49152
  v_mfma_f32_16x16x32_bf16 v[44:47], a[188:191], a[60:63], v[44:47]
  ds_read_b64_tr_b16 a[178:179], v241 offset:53248
  v_mfma_f32_16x16x32_bf16 v[40:43], a[188:191], a[56:59], v[40:43]
  ds_read_b64_tr_b16 a[180:181], v241 offset:57344
  v_mfma_f32_16x16x32_bf16 v[40:43], a[184:187], a[48:51], v[40:43]
  s_waitcnt vmcnt(14) lgkmcnt(11)
  s_barrier
  ds_read_b64_tr_b16 a[182:183], v241 offset:61440
  v_mfma_f32_16x16x32_bf16 v[48:51], a[192:195], a[48:51], v[48:51]
  ds_read_b64_tr_b16 a[184:185], v242 offset:49152
  v_mfma_f32_16x16x32_bf16 v[48:51], a[196:199], a[56:59], v[48:51]
  ds_read_b64_tr_b16 a[186:187], v242 offset:53248
  v_mfma_f32_16x16x32_bf16 v[52:55], a[196:199], a[60:63], v[52:55]
  ds_read_b64_tr_b16 a[188:189], v242 offset:57344
  v_mfma_f32_16x16x32_bf16 v[52:55], a[192:195], a[52:55], v[52:55]
  s_waitcnt lgkmcnt(11)
  ds_read_b64_tr_b16 a[190:191], v242 offset:61440
  v_mfma_f32_16x16x32_bf16 v[60:63], a[200:203], a[52:55], v[60:63]
  ds_read_b64_tr_b16 a[192:193], v243 offset:49152
  v_mfma_f32_16x16x32_bf16 v[60:63], a[204:207], a[60:63], v[60:63]
  ds_read_b64_tr_b16 a[194:195], v243 offset:53248
  v_mfma_f32_16x16x32_bf16 v[56:59], a[204:207], a[56:59], v[56:59]
  ds_read_b64_tr_b16 a[196:197], v243 offset:57344
  v_mfma_f32_16x16x32_bf16 v[56:59], a[200:203], a[48:51], v[56:59]
  s_waitcnt lgkmcnt(11)
  ds_read_b64_tr_b16 a[198:199], v243 offset:61440
  v_mfma_f32_16x16x32_bf16 v[32:35], a[208:211], a[64:67], v[32:35]
  ds_read_b64_tr_b16 a[200:201], v244 offset:0
  v_mfma_f32_16x16x32_bf16 v[32:35], a[212:215], a[72:75], v[32:35]
  ds_read_b64_tr_b16 a[202:203], v244 offset:4096
  v_mfma_f32_16x16x32_bf16 v[36:39], a[212:215], a[76:79], v[36:39]
  ds_read_b64_tr_b16 a[204:205], v244 offset:8192
  v_mfma_f32_16x16x32_bf16 v[36:39], a[208:211], a[68:71], v[36:39]
  s_waitcnt lgkmcnt(11)
  ds_read_b64_tr_b16 a[206:207], v244 offset:12288
  v_mfma_f32_16x16x32_bf16 v[44:47], a[176:179], a[68:71], v[44:47]
  ds_read_b64_tr_b16 a[208:209], v245 offset:0
  v_mfma_f32_16x16x32_bf16 v[44:47], a[180:183], a[76:79], v[44:47]
  ds_read_b64_tr_b16 a[210:211], v245 offset:4096
  v_mfma_f32_16x16x32_bf16 v[40:43], a[180:183], a[72:75], v[40:43]
  ds_read_b64_tr_b16 a[212:213], v245 offset:8192
  v_mfma_f32_16x16x32_bf16 v[40:43], a[176:179], a[64:67], v[40:43]
  s_waitcnt vmcnt(12) lgkmcnt(11)
  s_barrier
  ds_read_b64_tr_b16 a[214:215], v245 offset:12288
  v_mfma_f32_16x16x32_bf16 v[48:51], a[184:187], a[64:67], v[48:51]
  ds_read_b64_tr_b16 a[176:177], v246 offset:0
  v_mfma_f32_16x16x32_bf16 v[48:51], a[188:191], a[72:75], v[48:51]
  ds_read_b64_tr_b16 a[178:179], v246 offset:4096
  v_mfma_f32_16x16x32_bf16 v[52:55], a[188:191], a[76:79], v[52:55]
  ds_read_b64_tr_b16 a[180:181], v246 offset:8192
  v_mfma_f32_16x16x32_bf16 v[52:55], a[184:187], a[68:71], v[52:55]
  s_waitcnt lgkmcnt(11)
  ds_read_b64_tr_b16 a[182:183], v246 offset:12288
  v_mfma_f32_16x16x32_bf16 v[60:63], a[192:195], a[68:71], v[60:63]
  ds_read_b64_tr_b16 a[184:185], v247 offset:0
  v_mfma_f32_16x16x32_bf16 v[60:63], a[196:199], a[76:79], v[60:63]
  ds_read_b64_tr_b16 a[186:187], v247 offset:4096
  v_mfma_f32_16x16x32_bf16 v[56:59], a[196:199], a[72:75], v[56:59]
  ds_read_b64_tr_b16 a[188:189], v247 offset:8192
  v_mfma_f32_16x16x32_bf16 v[56:59], a[192:195], a[64:67], v[56:59]
  s_waitcnt lgkmcnt(11)
  ds_read_b64_tr_b16 a[190:191], v247 offset:12288
  v_mfma_f32_16x16x32_bf16 v[32:35], a[200:203], a[80:83], v[32:35]
  s_waitcnt vmcnt(0)
  ds_read_b64_tr_b16 a[192:193], v244 offset:16384
  s_mov_b64 exec, 1
  buffer_store_dword v254, v0, s[36:39], s78 offen sc1
  s_mov_b64 exec, -1
  v_mfma_f32_16x16x32_bf16 v[32:35], a[204:207], a[88:91], v[32:35]
  ds_read_b64_tr_b16 a[194:195], v244 offset:20480
  v_mfma_f32_16x16x32_bf16 v[36:39], a[204:207], a[92:95], v[36:39]
  ds_read_b64_tr_b16 a[196:197], v244 offset:24576
  v_mfma_f32_16x16x32_bf16 v[36:39], a[200:203], a[84:87], v[36:39]
  s_waitcnt lgkmcnt(11)
  ds_read_b64_tr_b16 a[198:199], v244 offset:28672
  v_mfma_f32_16x16x32_bf16 v[44:47], a[208:211], a[84:87], v[44:47]
  ds_read_b64_tr_b16 a[200:201], v245 offset:16384
  buffer_load_dword v139, v132, s[36:39], s79 offen sc1
  v_mfma_f32_16x16x32_bf16 v[44:47], a[212:215], a[92:95], v[44:47]
  ds_read_b64_tr_b16 a[202:203], v245 offset:20480
  v_mfma_f32_16x16x32_bf16 v[40:43], a[212:215], a[88:91], v[40:43]
  ds_read_b64_tr_b16 a[204:205], v245 offset:24576
  v_mfma_f32_16x16x32_bf16 v[40:43], a[208:211], a[80:83], v[40:43]
  s_waitcnt vmcnt(12) lgkmcnt(11)
  s_barrier
  ds_read_b64_tr_b16 a[206:207], v245 offset:28672
  v_mfma_f32_16x16x32_bf16 v[48:51], a[176:179], a[80:83], v[48:51]
  ds_read_b64_tr_b16 a[208:209], v246 offset:16384
  v_mfma_f32_16x16x32_bf16 v[48:51], a[180:183], a[88:91], v[48:51]
  ds_read_b64_tr_b16 a[210:211], v246 offset:20480
  v_mfma_f32_16x16x32_bf16 v[52:55], a[180:183], a[92:95], v[52:55]
  ds_read_b64_tr_b16 a[212:213], v246 offset:24576
  v_mfma_f32_16x16x32_bf16 v[52:55], a[176:179], a[84:87], v[52:55]
  s_waitcnt lgkmcnt(11)
  ds_read_b64_tr_b16 a[214:215], v246 offset:28672
  v_mfma_f32_16x16x32_bf16 v[60:63], a[184:187], a[84:87], v[60:63]
  ds_read_b64_tr_b16 a[176:177], v247 offset:16384
  v_mfma_f32_16x16x32_bf16 v[60:63], a[188:191], a[92:95], v[60:63]
  ds_read_b64_tr_b16 a[178:179], v247 offset:20480
  v_mfma_f32_16x16x32_bf16 v[56:59], a[188:191], a[88:91], v[56:59]
  ds_read_b64_tr_b16 a[180:181], v247 offset:24576
  v_mfma_f32_16x16x32_bf16 v[56:59], a[184:187], a[80:83], v[56:59]
  s_waitcnt lgkmcnt(11)
  ds_read_b64_tr_b16 a[182:183], v247 offset:28672
  v_mfma_f32_16x16x32_bf16 v[32:35], a[192:195], a[96:99], v[32:35]
  ds_read_b64_tr_b16 a[184:185], v244 offset:32768
  v_mfma_f32_16x16x32_bf16 v[32:35], a[196:199], a[104:107], v[32:35]
  ds_read_b64_tr_b16 a[186:187], v244 offset:36864
  v_mfma_f32_16x16x32_bf16 v[36:39], a[196:199], a[108:111], v[36:39]
  ds_read_b64_tr_b16 a[188:189], v244 offset:40960
  v_mfma_f32_16x16x32_bf16 v[36:39], a[192:195], a[100:103], v[36:39]
  s_waitcnt lgkmcnt(11)
  ds_read_b64_tr_b16 a[190:191], v244 offset:45056
  v_mfma_f32_16x16x32_bf16 v[44:47], a[200:203], a[100:103], v[44:47]
  ds_read_b64_tr_b16 a[192:193], v245 offset:32768
  v_mfma_f32_16x16x32_bf16 v[44:47], a[204:207], a[108:111], v[44:47]
  ds_read_b64_tr_b16 a[194:195], v245 offset:36864
  v_mfma_f32_16x16x32_bf16 v[40:43], a[204:207], a[104:107], v[40:43]
  ds_read_b64_tr_b16 a[196:197], v245 offset:40960
  v_mfma_f32_16x16x32_bf16 v[40:43], a[200:203], a[96:99], v[40:43]
  s_waitcnt vmcnt(10) lgkmcnt(11)
  s_barrier
  ds_read_b64_tr_b16 a[198:199], v245 offset:45056
  v_mfma_f32_16x16x32_bf16 v[48:51], a[208:211], a[96:99], v[48:51]
  ds_read_b64_tr_b16 a[200:201], v246 offset:32768
  v_mfma_f32_16x16x32_bf16 v[48:51], a[212:215], a[104:107], v[48:51]
  ds_read_b64_tr_b16 a[202:203], v246 offset:36864
  v_mfma_f32_16x16x32_bf16 v[52:55], a[212:215], a[108:111], v[52:55]
  ds_read_b64_tr_b16 a[204:205], v246 offset:40960
  v_mfma_f32_16x16x32_bf16 v[52:55], a[208:211], a[100:103], v[52:55]
  s_waitcnt lgkmcnt(11)
  ds_read_b64_tr_b16 a[206:207], v246 offset:45056
  v_mfma_f32_16x16x32_bf16 v[60:63], a[176:179], a[100:103], v[60:63]
  ds_read_b64_tr_b16 a[208:209], v247 offset:32768
  v_mfma_f32_16x16x32_bf16 v[60:63], a[180:183], a[108:111], v[60:63]
  ds_read_b64_tr_b16 a[210:211], v247 offset:36864
  v_mfma_f32_16x16x32_bf16 v[56:59], a[180:183], a[104:107], v[56:59]
  s_waitcnt vmcnt(0)
  ds_read_b64_tr_b16 a[212:213], v247 offset:40960
  v_readfirstlane_b32 s80, v139
  v_mfma_f32_16x16x32_bf16 v[56:59], a[176:179], a[96:99], v[56:59]
  s_waitcnt lgkmcnt(11)
  ds_read_b64_tr_b16 a[214:215], v247 offset:45056
  s_nop 0
  v_mfma_f32_16x16x32_bf16 v[32:35], a[184:187], a[112:115], v[32:35]
  s_cmp_eq_u32 s80, s3
  ds_read_b64_tr_b16 a[176:177], v244 offset:49152
  s_cselect_b32 s89, s63, 1073741824
  v_mfma_f32_16x16x32_bf16 v[32:35], a[188:191], a[120:123], v[32:35]
  s_cselect_b32 s90, s64, 1073741824
  ds_read_b64_tr_b16 a[178:179], v244 offset:53248
  buffer_load_dwordx4 v[96:99], v0, s[36:39], s89 offen offset:0 sc1
  v_mfma_f32_16x16x32_bf16 v[36:39], a[188:191], a[124:127], v[36:39]
  ds_read_b64_tr_b16 a[180:181], v244 offset:57344
  v_mfma_f32_16x16x32_bf16 v[36:39], a[184:187], a[116:119], v[36:39]
  s_waitcnt lgkmcnt(11)
  ds_read_b64_tr_b16 a[182:183], v244 offset:61440
  v_mfma_f32_16x16x32_bf16 v[44:47], a[192:195], a[116:119], v[44:47]
  ds_read_b64_tr_b16 a[184:185], v245 offset:49152
  buffer_load_dwordx4 v[100:103], v0, s[36:39], s89 offen offset:1024 sc1
  v_mfma_f32_16x16x32_bf16 v[44:47], a[196:199], a[124:127], v[44:47]
  ds_read_b64_tr_b16 a[186:187], v245 offset:53248
  v_mfma_f32_16x16x32_bf16 v[40:43], a[196:199], a[120:123], v[40:43]
  ds_read_b64_tr_b16 a[188:189], v245 offset:57344
  v_mfma_f32_16x16x32_bf16 v[40:43], a[192:195], a[112:115], v[40:43]
  s_waitcnt lgkmcnt(11)
  buffer_load_dwordx4 v[104:107], v0, s[36:39], s89 offen offset:2048 sc1
  ds_read_b64_tr_b16 a[190:191], v245 offset:61440
  v_mfma_f32_16x16x32_bf16 v[48:51], a[200:203], a[112:115], v[48:51]
  ds_read_b64_tr_b16 a[192:193], v246 offset:49152
  v_mfma_f32_16x16x32_bf16 v[48:51], a[204:207], a[120:123], v[48:51]
  buffer_load_dwordx4 v[108:111], v0, s[36:39], s89 offen offset:3072 sc1
  ds_read_b64_tr_b16 a[194:195], v246 offset:53248
  v_mfma_f32_16x16x32_bf16 v[52:55], a[204:207], a[124:127], v[52:55]
  ds_read_b64_tr_b16 a[196:197], v246 offset:57344
  v_mfma_f32_16x16x32_bf16 v[52:55], a[200:203], a[116:119], v[52:55]
  s_waitcnt lgkmcnt(11)
  buffer_load_dwordx4 v[112:115], v0, s[36:39], s90 offen offset:0 sc1
  ds_read_b64_tr_b16 a[198:199], v246 offset:61440
  v_mfma_f32_16x16x32_bf16 v[60:63], a[208:211], a[116:119], v[60:63]
  ds_read_b64_tr_b16 a[200:201], v247 offset:49152
  v_mfma_f32_16x16x32_bf16 v[60:63], a[212:215], a[124:127], v[60:63]
  buffer_load_dwordx4 v[116:119], v0, s[36:39], s90 offen offset:1024 sc1
  ds_read_b64_tr_b16 a[202:203], v247 offset:53248
  v_mfma_f32_16x16x32_bf16 v[56:59], a[212:215], a[120:123], v[56:59]
  ds_read_b64_tr_b16 a[204:205], v247 offset:57344
  v_mfma_f32_16x16x32_bf16 v[56:59], a[208:211], a[112:115], v[56:59]
  s_waitcnt lgkmcnt(11)
  buffer_load_dwordx4 v[120:123], v0, s[36:39], s90 offen offset:2048 sc1
  ds_read_b64_tr_b16 a[206:207], v247 offset:61440
  v_mfma_f32_16x16x32_bf16 v[32:35], a[176:179], a[216:219], v[32:35]
  v_mfma_f32_16x16x32_bf16 v[32:35], a[180:183], a[224:227], v[32:35]
  buffer_load_dwordx4 v[124:127], v0, s[36:39], s90 offen offset:3072 sc1
  v_mfma_f32_16x16x32_bf16 v[36:39], a[180:183], a[228:231], v[36:39]
  v_mfma_f32_16x16x32_bf16 v[36:39], a[176:179], a[220:223], v[36:39]
  s_waitcnt lgkmcnt(8)
  v_mfma_f32_16x16x32_bf16 v[44:47], a[184:187], a[220:223], v[44:47]
  v_mfma_f32_16x16x32_bf16 v[44:47], a[188:191], a[228:231], v[44:47]
  v_mfma_f32_16x16x32_bf16 v[40:43], a[188:191], a[224:227], v[40:43]
  v_mfma_f32_16x16x32_bf16 v[40:43], a[184:187], a[216:219], v[40:43]
  s_waitcnt lgkmcnt(4)
  v_mfma_f32_16x16x32_bf16 v[48:51], a[192:195], a[216:219], v[48:51]
  v_mfma_f32_16x16x32_bf16 v[48:51], a[196:199], a[224:227], v[48:51]
  v_mfma_f32_16x16x32_bf16 v[52:55], a[196:199], a[228:231], v[52:55]
  v_mfma_f32_16x16x32_bf16 v[52:55], a[192:195], a[220:223], v[52:55]
  s_waitcnt lgkmcnt(0)
  v_mfma_f32_16x16x32_bf16 v[60:63], a[200:203], a[220:223], v[60:63]
  v_mfma_f32_16x16x32_bf16 v[60:63], a[204:207], a[228:231], v[60:63]
  v_mfma_f32_16x16x32_bf16 v[56:59], a[204:207], a[224:227], v[56:59]
  v_mfma_f32_16x16x32_bf16 v[56:59], a[200:203], a[216:219], v[56:59]
  s_cmp_eq_u32 s80, s3
  s_cbranch_scc0 CKXs
CKXx:
  v_pk_fma_f32 v[64:65], v[176:177], v[32:33], v[64:65]
  v_pk_fma_f32 v[66:67], v[178:179], v[34:35], v[66:67]
  v_pk_fma_f32 v[80:81], v[176:177], v[36:37], v[80:81]
  v_pk_fma_f32 v[82:83], v[178:179], v[38:39], v[82:83]
  v_pk_fma_f32 v[68:69], v[180:181], v[40:41], v[68:69]
  v_pk_fma_f32 v[70:71], v[182:183], v[42:43], v[70:71]
  v_pk_fma_f32 v[84:85], v[180:181], v[44:45], v[84:85]
  v_pk_fma_f32 v[86:87], v[182:183], v[46:47], v[86:87]
  v_pk_fma_f32 v[72:73], v[184:185], v[48:49], v[72:73]
  v_pk_fma_f32 v[74:75], v[186:187], v[50:51], v[74:75]
  v_pk_fma_f32 v[88:89], v[184:185], v[52:53], v[88:89]
  v_pk_fma_f32 v[90:91], v[186:187], v[54:55], v[90:91]
  v_pk_fma_f32 v[76:77], v[188:189], v[56:57], v[76:77]
  v_pk_fma_f32 v[78:79], v[190:191], v[58:59], v[78:79]
  v_pk_fma_f32 v[92:93], v[188:189], v[60:61], v[92:93]
  v_pk_fma_f32 v[94:95], v[190:191], v[62:63], v[94:95]
  s_waitcnt vmcnt(7)
  v_pk_fma_f32 v[64:65], v[176:177], v[96:97], v[64:65]
  v_pk_fma_f32 v[66:67], v[178:179], v[98:99], v[66:67]
  v_cvt_pk_bf16_f32 v192, v64, v65
  v_cvt_pk_bf16_f32 v193, v66, v67
  ds_write_b64 v140, v[192:193] offset:0
  s_waitcnt vmcnt(6)
  v_pk_fma_f32 v[80:81], v[176:177], v[100:101], v[80:81]
  v_pk_fma_f32 v[82:83], v[178:179], v[102:103], v[82:83]
  v_cvt_pk_bf16_f32 v200, v80, v81
  v_cvt_pk_bf16_f32 v201, v82, v83
  ds_write_b64 v140, v[200:201] offset:2048
  s_waitcnt vmcnt(5)
  v_pk_fma_f32 v[68:69], v[180:181], v[104:105], v[68:69]
  v_pk_fma_f32 v[70:71], v[182:183], v[106:107], v[70:71]
  v_cvt_pk_bf16_f32 v194, v68, v69
  v_cvt_pk_bf16_f32 v195, v70, v71
  ds_write_b64 v141, v[194:195] offset:0
  s_waitcnt vmcnt(4)
  v_pk_fma_f32 v[84:85], v[180:181], v[108:109], v[84:85]
  v_pk_fma_f32 v[86:87], v[182:183], v[110:111], v[86:87]
  v_cvt_pk_bf16_f32 v202, v84, v85
  v_cvt_pk_bf16_f32 v203, v86, v87
  ds_write_b64 v141, v[202:203] offset:2048
  s_waitcnt vmcnt(3)
  v_pk_fma_f32 v[72:73], v[184:185], v[112:113], v[72:73]
  v_pk_fma_f32 v[74:75], v[186:187], v[114:115], v[74:75]
  v_cvt_pk_bf16_f32 v196, v72, v73
  v_cvt_pk_bf16_f32 v197, v74, v75
  ds_write_b64 v142, v[196:197] offset:0
  s_waitcnt vmcnt(2)
  v_pk_fma_f32 v[88:89], v[184:185], v[116:117], v[88:89]
  v_pk_fma_f32 v[90:91], v[186:187], v[118:119], v[90:91]
  v_cvt_pk_bf16_f32 v204, v88, v89
  v_cvt_pk_bf16_f32 v205, v90, v91
  ds_write_b64 v142, v[204:205] offset:2048
  s_waitcnt vmcnt(1)
  v_pk_fma_f32 v[76:77], v[188:189], v[120:121], v[76:77]
  v_pk_fma_f32 v[78:79], v[190:191], v[122:123], v[78:79]
  v_cvt_pk_bf16_f32 v198, v76, v77
  v_cvt_pk_bf16_f32 v199, v78, v79
  ds_write_b64 v143, v[198:199] offset:0
  s_waitcnt vmcnt(0)
  v_pk_fma_f32 v[92:93], v[188:189], v[124:125], v[92:93]
  v_pk_fma_f32 v[94:95], v[190:191], v[126:127], v[94:95]
  v_cvt_pk_bf16_f32 v206, v92, v93
  v_cvt_pk_bf16_f32 v207, v94, v95
  ds_write_b64 v143, v[206:207] offset:2048
  ds_read_b128 v[64:67], v255 offset:0
  ds_read_b128 v[68:71], v255 offset:1024
  ds_read_b128 v[72:75], v255 offset:2048
  ds_read_b128 v[76:79], v255 offset:3072
  s_waitcnt lgkmcnt(3)
  buffer_store_dwordx4 v[64:67], v252, s[32:35], s55 offen
  s_waitcnt lgkmcnt(2)
  buffer_store_dwordx4 v[68:71], v253, s[32:35], s55 offen
  s_waitcnt lgkmcnt(1)
  buffer_store_dwordx4 v[72:75], v252, s[32:35], s49 offen
  s_waitcnt lgkmcnt(0)
  buffer_store_dwordx4 v[76:79], v253, s[32:35], s49 offen
XEND:
  s_endpgm
CK4s:
  s_mov_b32 s46, 30000
CK4:
  s_mov_b32 s49, 0
  buffer_load_dwordx4 v[156:159], v248, s[36:39], s49 offen sc1
  s_mov_b32 s49, 24576
  buffer_load_dwordx4 v[160:163], v248, s[36:39], s49 offen sc1
  s_mov_b32 s49, 49152
  buffer_load_dwordx4 v[164:167], v248, s[36:39], s49 offen sc1
  s_mov_b32 s49, 73728
  buffer_load_dwordx4 v[168:171], v248, s[36:39], s49 offen sc1
  s_sub_u32 s46, s46, 1
  s_waitcnt vmcnt(0)
  v_max_u32 v15, v156, v157
  v_max3_u32 v15, v15, v158, v159
  v_max3_u32 v15, v15, v160, v161
  v_max3_u32 v15, v15, v162, v163
  v_max3_u32 v15, v15, v164, v165
  v_max3_u32 v15, v15, v166, v167
  v_max3_u32 v15, v15, v168, v169
  v_max3_u32 v15, v15, v170, v171
  s_cmp_eq_u32 s46, 0
  s_cbranch_scc1 CK4x
  v_cmp_eq_u32 vcc, -1, v15
  s_nop 4
  s_cbranch_vccnz CK4
  s_branch CK4x
CKSs:
  s_mov_b32 s46, 30000
  v_lshlrev_b32 v14, 3, v0
CKS:
  s_mov_b32 s48, 5242880
  buffer_load_dword v16, v14, s[36:39], s48 offen sc1
  s_mov_b32 s48, 5251072
  buffer_load_dword v17, v14, s[36:39], s48 offen sc1
  s_mov_b32 s48, 5259264
  buffer_load_dword v18, v14, s[36:39], s48 offen sc1
  s_mov_b32 s48, 5267456
  buffer_load_dword v19, v14, s[36:39], s48 offen sc1
  s_sub_u32 s46, s46, 1
  s_cmp_eq_u32 s46, 0
  s_waitcnt vmcnt(0)
  s_cbranch_scc1 CKSy
  v_xor_b32 v15, s3, v16
  v_bitop3_b32 v15, v15, v17, s3 bitop3:0xf6
  v_bitop3_b32 v15, v15, v18, s3 bitop3:0xf6
  v_bitop3_b32 v15, v15, v19, s3 bitop3:0xf6
  v_cmp_ne_u32 vcc, 0, v15
  s_nop 4
  s_cbranch_vccnz CKS
CKSy:
  s_mov_b32 s48, 5505024
  s_mov_b64 exec, 1
  buffer_store_dword v12, v0, s[36:39], s48 offen sc1
  s_mov_b64 exec, -1
  s_branch CKSx
CK6s:
  s_mov_b32 s46, 30000
CK6:
  buffer_load_dwordx4 a[208:211], v25, s[36:39], s79 offen offset:0 sc1
  buffer_load_dwordx4 a[212:215], v25, s[36:39], s79 offen offset:2048 sc1
  buffer_load_dwordx4 a[216:219], v25, s[36:39], s78 offen offset:0 sc1
  buffer_load_dwordx4 a[220:223], v25, s[36:39], s78 offen offset:2048 sc1
  s_sub_u32 s46, s46, 1
  s_waitcnt vmcnt(0)
  v_accvgpr_read_b32 v26, a208
  v_accvgpr_read_b32 v27, a209
  v_accvgpr_read_b32 v28, a210
  v_accvgpr_read_b32 v29, a211
  v_max_u32 v31, v26, v27
  v_max3_u32 v31, v31, v28, v29
  v_accvgpr_read_b32 v22, a212
  v_accvgpr_read_b32 v23, a213
  v_max3_u32 v31, v31, v22, v23
  v_add_f32 v26, v26, v22
  v_add_f32 v27, v27, v23
  v_accvgpr_read_b32 v22, a214
  v_accvgpr_read_b32 v23, a215
  v_max3_u32 v31, v31, v22, v23
  v_add_f32 v28, v28, v22
  v_add_f32 v29, v29, v23
  v_accvgpr_read_b32 v22, a216
  v_accvgpr_read_b32 v23, a217
  v_max3_u32 v31, v31, v22, v23
  v_add_f32 v26, v26, v22
  v_add_f32 v27, v27, v23
  v_accvgpr_read_b32 v22, a218
  v_accvgpr_read_b32 v23, a219
  v_max3_u32 v31, v31, v22, v23
  v_add_f32 v28, v28, v22
  v_add_f32 v29, v29, v23
  v_accvgpr_read_b32 v22, a220
  v_accvgpr_read_b32 v23, a221
  v_max3_u32 v31, v31, v22, v23
  v_add_f32 v26, v26, v22
  v_add_f32 v27, v27, v23
  v_accvgpr_read_b32 v22, a222
  v_accvgpr_read_b32 v23, a223
  v_max3_u32 v31, v31, v22, v23
  v_add_f32 v28, v28, v22
  v_add_f32 v29, v29, v23
  s_cmp_eq_u32 s46, 0
  s_cbranch_scc1 CK6x
  v_cmp_eq_u32 vcc, -1, v31
  s_nop 4
  s_cbranch_vccnz CK6
  s_branch CK6x
CK7s:
  s_mov_b32 s46, 60000
CK7:
  buffer_load_dword v139, v138, s[36:39], s91 offen sc1
  s_sub_u32 s46, s46, 1
  s_cmp_eq_u32 s46, 0
  s_waitcnt vmcnt(0)
  s_cbranch_scc1 CK7x
  v_cmp_ne_u32 vcc, s3, v139
  s_nop 4
  s_cbranch_vccnz CK7
  s_branch CK7x
CK8s:
  s_mov_b32 s46, 60000
CK8:
  buffer_load_dword v139, v138, s[36:39], s91 offen sc1
  s_sub_u32 s46, s46, 1
  s_cmp_eq_u32 s46, 0
  s_waitcnt vmcnt(0)
  s_cbranch_scc1 CK8x
  v_cmp_ne_u32 vcc, s3, v139
  s_nop 4
  s_cbranch_vccnz CK8
  s_branch CK8x
CKXs:
  s_mov_b32 s46, 60000
CKX:
  buffer_load_dword v139, v132, s[36:39], s79 offen sc1
  s_sub_u32 s46, s46, 1
  s_cmp_eq_u32 s46, 0
  s_waitcnt vmcnt(0)
  s_cbranch_scc1 CKXy
  v_cmp_ne_u32 vcc, s3, v139
  s_nop 4
  s_cbranch_vccnz CKX
CKXy:
  buffer_load_dwordx4 v[96:99], v0, s[36:39], s63 offen offset:0 sc1
  buffer_load_dwordx4 v[100:103], v0, s[36:39], s63 offen offset:1024 sc1
  buffer_load_dwordx4 v[104:107], v0, s[36:39], s63 offen offset:2048 sc1
  buffer_load_dwordx4 v[108:111], v0, s[36:39], s63 offen offset:3072 sc1
  buffer_load_dwordx4 v[112:115], v0, s[36:39], s64 offen offset:0 sc1
  buffer_load_dwordx4 v[116:119], v0, s[36:39], s64 offen offset:1024 sc1
  buffer_load_dwordx4 v[120:123], v0, s[36:39], s64 offen offset:2048 sc1
  buffer_load_dwordx4 v[124:127], v0, s[36:39], s64 offen offset:3072 sc1
  s_branch CKXx
code_end:
.fill 2048, 4, 0xBF800000
.section .rodata,"a"
.p2align 6
.amdhsa_kernel adaLN_cond__sliding_local_dilated__swiglu_ffn__prompt_kernel
  .amdhsa_next_free_vgpr 512
  .amdhsa_next_free_sgpr 102
  .amdhsa_accum_offset 256
  .amdhsa_group_segment_fixed_size 0
  .amdhsa_kernarg_size 96
  .amdhsa_user_sgpr_count 2
  .amdhsa_user_sgpr_kernarg_segment_ptr 1
  .amdhsa_system_sgpr_workgroup_id_x 1
  .amdhsa_float_denorm_mode_32 3
.end_amdhsa_kernel
```

```asm
; @launch grid=(256,1,1) block=(256,1,1) lds=163840
.amdgcn_target "amdgcn-amd-amdhsa--gfx950"
.text
.globl adaLN_cond__sliding_local_dilated__swiglu_ffn__prompt_kernel
.type adaLN_cond__sliding_local_dilated__swiglu_ffn__prompt_kernel,@function
.p2align 12
.p2align 8
adaLN_cond__sliding_local_dilated__swiglu_ffn__prompt_kernel:
  s_cmp_ge_u32 s2, 256
  s_cbranch_scc1 XEND
  s_load_dwordx2 s[36:37], s[0:1], 88
  s_load_dwordx2 s[40:41], s[0:1], 56
  s_load_dwordx2 s[28:29], s[0:1], 64
  s_load_dwordx2 s[4:5], s[0:1], 0
  s_load_dwordx2 s[8:9], s[0:1], 8
  s_load_dwordx2 s[12:13], s[0:1], 16
  s_load_dwordx2 s[16:17], s[0:1], 32
  s_load_dwordx2 s[20:21], s[0:1], 40
  s_load_dwordx2 s[24:25], s[0:1], 48
  s_load_dwordx2 s[32:33], s[0:1], 72
  v_lshrrev_b32 v1, 6, v0
  v_and_b32 v10, 63, v0
  v_readfirstlane_b32 s44, v1
  v_lshlrev_b32 v0, 4, v10
  s_mov_b32 s38, 50331648
  s_mov_b32 s39, 0x20000
  s_mov_b32 s42, 2048
  s_mov_b32 s43, 0x20000
  s_mov_b32 s30, 12582912
  s_mov_b32 s31, 0x20000
  s_mov_b32 s6, 4194304
  s_mov_b32 s7, 0x20000
  s_mov_b32 s10, 6291456
  s_mov_b32 s11, 0x20000
  s_mov_b32 s14, 2097152
  s_mov_b32 s15, 0x20000
  s_mov_b32 s18, 7340032
  s_mov_b32 s19, 0x20000
  s_mov_b32 s22, 7340032
  s_mov_b32 s23, 0x20000
  s_mov_b32 s26, 7340032
  s_mov_b32 s27, 0x20000
  s_mov_b32 s34, 4194304
  s_mov_b32 s35, 0x20000
  s_and_b32 s48, s2, 3
  s_lshl2_add_u32 s48, s48, s44
  s_lshl_b32 s48, s48, 6
  v_and_b32 v176, 0x38, v10
  v_add_u32 v176, s48, v176
  v_lshlrev_b32 v177, 1, v176
  v_mul_u32_u24 v176, 12288, v176
  v_and_b32 v12, 7, v10
  v_lshl_add_u32 v176, v12, 4, v176
  v_mov_b32 v178, 0
  s_bfe_u32 s51, s2, 0x40003
  s_and_b32 s49, s2, 4
  s_lshl2_add_u32 s51, s49, s51
  s_and_b32 s49, s2, 128
  s_lshl2_add_u32 s51, s51, s49
  s_lshl_b32 s51, s51, 5
  s_mov_b32 s49, s51
  s_mov_b32 s50, 5505024
  v_lshrrev_b32 v13, 3, v10
  v_lshlrev_b32 v132, 11, v12
  v_lshl_add_u32 v132, v13, 4, v132
  s_and_b32 s48, s2, 127
  s_lshl_b32 s48, s48, 6
  s_add_u32 s48, s48, s44
  s_lshl_b32 s48, s48, 9
  s_cmp_lt_u32 s2, 128
  s_waitcnt lgkmcnt(0)
  buffer_load_dwordx4 v[188:191], v177, s[40:43], 0 offen
  s_cbranch_scc0 F_x
  buffer_load_dwordx4 v[136:139], v176, s[28:31], s49 offen nt
  s_add_u32 s49, s49, 12288
  buffer_load_dwordx4 v[140:143], v176, s[28:31], s49 offen nt
  s_add_u32 s49, s49, 12288
  buffer_load_dwordx4 v[144:147], v176, s[28:31], s49 offen nt
  s_add_u32 s49, s49, 12288
  buffer_load_dwordx4 v[148:151], v176, s[28:31], s49 offen nt
  s_add_u32 s49, s49, 12288
  buffer_load_dwordx4 v[152:155], v176, s[28:31], s49 offen nt
  s_add_u32 s49, s49, 12288
  buffer_load_dwordx4 v[156:159], v176, s[28:31], s49 offen nt
  s_add_u32 s49, s49, 12288
  buffer_load_dwordx4 v[160:163], v176, s[28:31], s49 offen nt
  s_add_u32 s49, s49, 12288
  buffer_load_dwordx4 v[164:167], v176, s[28:31], s49 offen nt
F_x:
  buffer_load_dword v195, v178, s[36:39], s50 offen sc1
  s_mov_b32 s50, s48
  s_getpc_b64 s[92:93]
PC0:
  s_sub_u32 s92, s92, PC0-adaLN_cond__sliding_local_dilated__swiglu_ffn__prompt_kernel
  s_subb_u32 s93, s93, 0
  s_cmp_lt_u32 s2, 128
  s_cbranch_scc1 F_ct
  s_bfe_u32 s48, s2, 0x30004
  s_and_b32 s49, s2, 3
  s_lshl3_add_u32 s48, s49, s48
  s_mul_i32 s48, s48, 393216
  s_and_b32 s49, s2, 4
  s_lshl_b32 s49, s49, 9
  s_add_u32 s48, s48, s49
  s_and_b32 s49, s2, 8
  s_lshl_b32 s49, s49, 7
  s_add_u32 s48, s48, s49
  s_cmp_lt_u32 s44, 1
  s_cselect_b32 s48, s48, 1073741824
  v_and_b32 v19, 31, v10
  v_mul_u32_u24 v19, 12288, v19
  buffer_load_dword a252, v19, s[28:31], s48 offen offset:384
  s_bfe_u32 s48, s2, 0x40003
  s_cmp_lt_u32 s48, (code_end-adaLN_cond__sliding_local_dilated__swiglu_ffn__prompt_kernel)/8192+1
  s_cselect_b32 s49, 3, 4
  s_lshl_b32 s48, s48, 13
  v_lshl_add_u32 v19, v0, 3, s48
  s_cmp_eq_u32 s44, s49
  s_cselect_b32 s49, -1, 0
  v_and_b32 v19, s49, v19
  global_load_dword a252, v19, s[92:93]
  s_bfe_u32 s48, s2, 0x20003
  s_mul_i32 s48, s48, 24576
  s_lshr_b32 s49, s2, 5
  s_lshl3_add_u32 s49, s44, s49
  s_cmp_eq_u32 s49, 15
  s_cselect_b32 s48, s48, 1073741824
  v_lshlrev_b32 v19, 3, v0
  buffer_load_dword a252, v19, s[36:39], s48 offen sc1
F_ct:
  s_and_b32 s48, s2, 7
  s_lshr_b32 s49, s2, 3
  s_and_b32 s58, s48, 3
  s_lshl_b32 s58, s58, 2
  s_and_b32 s57, s49, 3
  s_add_u32 s58, s58, s57
  s_lshr_b32 s57, s48, 2
  s_lshl_b32 s57, s57, 3
  s_lshr_b32 s49, s49, 2
  s_add_u32 s57, s57, s49
  s_lshr_b32 s59, s44, 1
  s_and_b32 s60, s44, 1
  s_mul_i32 s63, s44, 3072
  s_lshl_b32 s64, s44, 11
  s_lshl_b32 s65, s44, 8
  v_bfe_u32 v14, v10, 4, 2
  v_bfe_u32 v15, v10, 1, 2
  v_xor_b32 v14, v14, v15
  v_lshlrev_b32 v14, 5, v14
  v_and_b32 v15, 1, v10
  v_lshl_add_u32 v213, v15, 4, v14
  s_lshl_b32 s48, s58, 7
  s_mul_i32 s49, s44, 49152
  s_add_u32 s48, s48, s49
  v_mul_u32_u24 v14, 6144, v13
  v_add3_u32 v202, v14, v213, s48
  v_add_u32 v203, 1024, v202
  v_add_u32 v204, 2048, v202
  v_bfe_u32 v14, v10, 3, 2
  v_lshlrev_b32 v14, 5, v14
  v_and_b32 v15, 3, v10
  v_lshl_add_u32 v214, v15, 3, v14
  v_bfe_u32 v14, v10, 2, 3
  v_lshrrev_b32 v15, 5, v10
  v_mul_u32_u24 v15, 24, v15
  v_add_lshl_u32 v14, v14, v15, 7
  s_lshl_b32 s48, s60, 1
  s_add_u32 s48, s48, s59
  s_lshl_b32 s48, s48, 5
  v_xor_b32 v15, s48, v214
  v_add_u32 v196, v14, v15
  v_xor_b32 v197, 32, v196
  v_add_u32 v198, 64512, v196
  v_add_u32 v199, 64512, v197
  v_add_u32 v200, 129024, v196
  v_add_u32 v201, 129024, v197
  s_lshl_b32 s48, s57, 2
  s_add_u32 s49, s48, s44
  s_lshl_b32 s49, s49, 16
  s_add_u32 s49, s49, 1048576
  v_add_u32 v205, s49, v0
  s_max_u32 s48, s48, 1
  s_lshl_b32 s48, s48, 16
  s_add_u32 s48, s48, 984064
  s_add_u32 s48, s48, s65
  v_lshl_add_u32 v206, v10, 2, s48
  s_lshl_b32 s48, s59, 12
  v_add_u32 v210, 0, v0
  v_add_u32 v207, s48, v210
  v_add_u32 v211, 64512, v0
  v_add_u32 v208, s48, v211
  v_add_u32 v212, 129024, v0
  v_add_u32 v209, s48, v212
  s_lshl3_add_u32 s48, s57, 127
  v_min_u32 v215, 8, v10
  v_add_u32 v215, s48, v215
  v_max_u32 v215, 0x80, v215
  v_lshlrev_b32 v215, 7, v215
  v_lshlrev_b32 v18, 5, v12
  v_lshrrev_b32 v19, 4, v10
  v_lshl_add_u32 v18, v19, 3, v18
  s_add_u32 s48, s65, 162816
  v_add_u32 v177, s48, v18
  v_lshlrev_b32 v178, 2, v10
  s_and_b32 s49, s2, 3
  s_mul_i32 s56, s49, 24576
  s_lshl1_add_u32 s56, s51, s56
  s_add_u32 s51, s51, 4096
  s_cmp_lt_u32 s2, 128
  s_cbranch_scc1 F_cw
  s_waitcnt vmcnt(4)
F_cw:
  s_waitcnt vmcnt(9)
  v_lshlrev_b32 v168, 16, v188
  v_and_b32 v169, 0xffff0000, v188
  v_lshlrev_b32 v170, 16, v189
  v_and_b32 v171, 0xffff0000, v189
  v_lshlrev_b32 v172, 16, v190
  v_and_b32 v173, 0xffff0000, v190
  v_lshlrev_b32 v174, 16, v191
  v_and_b32 v175, 0xffff0000, v191
  v_mul_f32 v180, 0xbfb8aa3b, v168
  v_mul_f32 v181, 0xbfb8aa3b, v169
  v_mul_f32 v182, 0xbfb8aa3b, v170
  v_mul_f32 v183, 0xbfb8aa3b, v171
  v_mul_f32 v184, 0xbfb8aa3b, v172
  v_mul_f32 v185, 0xbfb8aa3b, v173
  v_mul_f32 v186, 0xbfb8aa3b, v174
  v_mul_f32 v187, 0xbfb8aa3b, v175
  v_exp_f32 v180, v180
  v_exp_f32 v181, v181
  v_exp_f32 v182, v182
  v_exp_f32 v183, v183
  v_exp_f32 v184, v184
  v_exp_f32 v185, v185
  v_exp_f32 v186, v186
  v_exp_f32 v187, v187
  v_add_f32 v180, 1.0, v180
  v_add_f32 v181, 1.0, v181
  v_add_f32 v182, 1.0, v182
  v_add_f32 v183, 1.0, v183
  v_add_f32 v184, 1.0, v184
  v_add_f32 v185, 1.0, v185
  v_add_f32 v186, 1.0, v186
  v_add_f32 v187, 1.0, v187
  v_rcp_f32 v180, v180
  v_rcp_f32 v181, v181
  v_rcp_f32 v182, v182
  v_rcp_f32 v183, v183
  v_rcp_f32 v184, v184
  v_rcp_f32 v185, v185
  v_rcp_f32 v186, v186
  v_rcp_f32 v187, v187
  v_mul_f32 v168, v168, v180
  v_mul_f32 v169, v169, v181
  v_mul_f32 v170, v170, v182
  v_mul_f32 v171, v171, v183
  v_mul_f32 v172, v172, v184
  v_mul_f32 v173, v173, v185
  v_mul_f32 v174, v174, v186
  v_mul_f32 v175, v175, v187
  v_cvt_pk_bf16_f32 v192, v168, v169
  v_lshlrev_b32 v168, 16, v192
  v_and_b32 v169, 0xffff0000, v192
  v_cvt_pk_bf16_f32 v192, v170, v171
  v_lshlrev_b32 v170, 16, v192
  v_and_b32 v171, 0xffff0000, v192
  v_cvt_pk_bf16_f32 v192, v172, v173
  v_lshlrev_b32 v172, 16, v192
  v_and_b32 v173, 0xffff0000, v192
  v_cvt_pk_bf16_f32 v192, v174, v175
  v_lshlrev_b32 v174, 16, v192
  v_and_b32 v175, 0xffff0000, v192
  s_cmp_lt_u32 s2, 128
  s_cbranch_scc1 F_xl1
  buffer_load_dwordx4 v[136:139], v132, s[4:7], s50 offen offset:0
  buffer_load_dwordx4 v[140:143], v132, s[4:7], s50 offen offset:128
  buffer_load_dwordx4 v[144:147], v132, s[4:7], s50 offen offset:256
  buffer_load_dwordx4 v[148:151], v132, s[4:7], s50 offen offset:384
  s_add_u32 s50, s50, 16384
  buffer_load_dwordx4 v[152:155], v132, s[4:7], s50 offen offset:0
  buffer_load_dwordx4 v[156:159], v132, s[4:7], s50 offen offset:128
  buffer_load_dwordx4 v[160:163], v132, s[4:7], s50 offen offset:256
  buffer_load_dwordx4 v[164:167], v132, s[4:7], s50 offen offset:384
F_xl1:
  s_cmp_lt_u32 s2, 128
  s_cbranch_scc0 AL
  s_waitcnt vmcnt(8)
  v_lshlrev_b32 v188, 16, v136
  v_and_b32 v189, 0xffff0000, v136
  v_lshlrev_b32 v190, 16, v137
  v_and_b32 v191, 0xffff0000, v137
  v_pk_mul_f32 v[180:181], v[188:189], v[168:169] op_sel_hi:[1,0]
  v_pk_mul_f32 v[182:183], v[190:191], v[168:169] op_sel_hi:[1,0]
  v_lshlrev_b32 v188, 16, v138
  v_and_b32 v189, 0xffff0000, v138
  v_lshlrev_b32 v190, 16, v139
  v_and_b32 v191, 0xffff0000, v139
  v_pk_mul_f32 v[184:185], v[188:189], v[168:169] op_sel_hi:[1,0]
  v_pk_mul_f32 v[186:187], v[190:191], v[168:169] op_sel_hi:[1,0]
  s_waitcnt vmcnt(7)
  v_lshlrev_b32 v188, 16, v140
  v_and_b32 v189, 0xffff0000, v140
  v_lshlrev_b32 v190, 16, v141
  v_and_b32 v191, 0xffff0000, v141
  v_pk_fma_f32 v[180:181], v[188:189], v[168:169], v[180:181] op_sel:[0,1,0] op_sel_hi:[1,1,1]
  v_pk_fma_f32 v[182:183], v[190:191], v[168:169], v[182:183] op_sel:[0,1,0] op_sel_hi:[1,1,1]
  v_lshlrev_b32 v188, 16, v142
  v_and_b32 v189, 0xffff0000, v142
  v_lshlrev_b32 v190, 16, v143
  v_and_b32 v191, 0xffff0000, v143
  v_pk_fma_f32 v[184:185], v[188:189], v[168:169], v[184:185] op_sel:[0,1,0] op_sel_hi:[1,1,1]
  v_pk_fma_f32 v[186:187], v[190:191], v[168:169], v[186:187] op_sel:[0,1,0] op_sel_hi:[1,1,1]
  s_waitcnt vmcnt(6)
  v_lshlrev_b32 v188, 16, v144
  v_and_b32 v189, 0xffff0000, v144
  v_lshlrev_b32 v190, 16, v145
  v_and_b32 v191, 0xffff0000, v145
  v_pk_fma_f32 v[180:181], v[188:189], v[170:171], v[180:181] op_sel:[0,0,0] op_sel_hi:[1,0,1]
  v_pk_fma_f32 v[182:183], v[190:191], v[170:171], v[182:183] op_sel:[0,0,0] op_sel_hi:[1,0,1]
  v_lshlrev_b32 v188, 16, v146
  v_and_b32 v189, 0xffff0000, v146
  v_lshlrev_b32 v190, 16, v147
  v_and_b32 v191, 0xffff0000, v147
  v_pk_fma_f32 v[184:185], v[188:189], v[170:171], v[184:185] op_sel:[0,0,0] op_sel_hi:[1,0,1]
  v_pk_fma_f32 v[186:187], v[190:191], v[170:171], v[186:187] op_sel:[0,0,0] op_sel_hi:[1,0,1]
  s_waitcnt vmcnt(5)
  v_lshlrev_b32 v188, 16, v148
  v_and_b32 v189, 0xffff0000, v148
  v_lshlrev_b32 v190, 16, v149
  v_and_b32 v191, 0xffff0000, v149
  v_pk_fma_f32 v[180:181], v[188:189], v[170:171], v[180:181] op_sel:[0,1,0] op_sel_hi:[1,1,1]
  v_pk_fma_f32 v[182:183], v[190:191], v[170:171], v[182:183] op_sel:[0,1,0] op_sel_hi:[1,1,1]
  v_lshlrev_b32 v188, 16, v150
  v_and_b32 v189, 0xffff0000, v150
  v_lshlrev_b32 v190, 16, v151
  v_and_b32 v191, 0xffff0000, v151
  v_pk_fma_f32 v[184:185], v[188:189], v[170:171], v[184:185] op_sel:[0,1,0] op_sel_hi:[1,1,1]
  v_pk_fma_f32 v[186:187], v[190:191], v[170:171], v[186:187] op_sel:[0,1,0] op_sel_hi:[1,1,1]
  s_waitcnt vmcnt(4)
  v_lshlrev_b32 v188, 16, v152
  v_and_b32 v189, 0xffff0000, v152
  v_lshlrev_b32 v190, 16, v153
  v_and_b32 v191, 0xffff0000, v153
  v_pk_fma_f32 v[180:181], v[188:189], v[172:173], v[180:181] op_sel:[0,0,0] op_sel_hi:[1,0,1]
  v_pk_fma_f32 v[182:183], v[190:191], v[172:173], v[182:183] op_sel:[0,0,0] op_sel_hi:[1,0,1]
  v_lshlrev_b32 v188, 16, v154
  v_and_b32 v189, 0xffff0000, v154
  v_lshlrev_b32 v190, 16, v155
  v_and_b32 v191, 0xffff0000, v155
  v_pk_fma_f32 v[184:185], v[188:189], v[172:173], v[184:185] op_sel:[0,0,0] op_sel_hi:[1,0,1]
  v_pk_fma_f32 v[186:187], v[190:191], v[172:173], v[186:187] op_sel:[0,0,0] op_sel_hi:[1,0,1]
  s_waitcnt vmcnt(3)
  v_lshlrev_b32 v188, 16, v156
  v_and_b32 v189, 0xffff0000, v156
  v_lshlrev_b32 v190, 16, v157
  v_and_b32 v191, 0xffff0000, v157
  v_pk_fma_f32 v[180:181], v[188:189], v[172:173], v[180:181] op_sel:[0,1,0] op_sel_hi:[1,1,1]
  v_pk_fma_f32 v[182:183], v[190:191], v[172:173], v[182:183] op_sel:[0,1,0] op_sel_hi:[1,1,1]
  v_lshlrev_b32 v188, 16, v158
  v_and_b32 v189, 0xffff0000, v158
  v_lshlrev_b32 v190, 16, v159
  v_and_b32 v191, 0xffff0000, v159
  v_pk_fma_f32 v[184:185], v[188:189], v[172:173], v[184:185] op_sel:[0,1,0] op_sel_hi:[1,1,1]
  v_pk_fma_f32 v[186:187], v[190:191], v[172:173], v[186:187] op_sel:[0,1,0] op_sel_hi:[1,1,1]
  s_waitcnt vmcnt(2)
  v_lshlrev_b32 v188, 16, v160
  v_and_b32 v189, 0xffff0000, v160
  v_lshlrev_b32 v190, 16, v161
  v_and_b32 v191, 0xffff0000, v161
  v_pk_fma_f32 v[180:181], v[188:189], v[174:175], v[180:181] op_sel:[0,0,0] op_sel_hi:[1,0,1]
  v_pk_fma_f32 v[182:183], v[190:191], v[174:175], v[182:183] op_sel:[0,0,0] op_sel_hi:[1,0,1]
  v_lshlrev_b32 v188, 16, v162
  v_and_b32 v189, 0xffff0000, v162
  v_lshlrev_b32 v190, 16, v163
  v_and_b32 v191, 0xffff0000, v163
  v_pk_fma_f32 v[184:185], v[188:189], v[174:175], v[184:185] op_sel:[0,0,0] op_sel_hi:[1,0,1]
  v_pk_fma_f32 v[186:187], v[190:191], v[174:175], v[186:187] op_sel:[0,0,0] op_sel_hi:[1,0,1]
  s_waitcnt vmcnt(1)
  v_lshlrev_b32 v188, 16, v164
  v_and_b32 v189, 0xffff0000, v164
  v_lshlrev_b32 v190, 16, v165
  v_and_b32 v191, 0xffff0000, v165
  v_pk_fma_f32 v[180:181], v[188:189], v[174:175], v[180:181] op_sel:[0,1,0] op_sel_hi:[1,1,1]
  v_pk_fma_f32 v[182:183], v[190:191], v[174:175], v[182:183] op_sel:[0,1,0] op_sel_hi:[1,1,1]
  v_lshlrev_b32 v188, 16, v166
  v_and_b32 v189, 0xffff0000, v166
  v_lshlrev_b32 v190, 16, v167
  v_and_b32 v191, 0xffff0000, v167
  v_pk_fma_f32 v[184:185], v[188:189], v[174:175], v[184:185] op_sel:[0,1,0] op_sel_hi:[1,1,1]
  v_pk_fma_f32 v[186:187], v[190:191], v[174:175], v[186:187] op_sel:[0,1,0] op_sel_hi:[1,1,1]
  s_nop 0
  v_permlane32_swap_b32 v180, v184
  v_permlane32_swap_b32 v181, v185
  v_permlane32_swap_b32 v182, v186
  v_permlane32_swap_b32 v183, v187
  v_add_f32 v180, v180, v184
  v_add_f32 v181, v181, v185
  v_add_f32 v182, v182, v186
  v_add_f32 v183, v183, v187
  s_nop 0
  v_permlane16_swap_b32 v180, v182
  v_permlane16_swap_b32 v181, v183
  v_add_f32 v180, v180, v182
  v_add_f32 v181, v181, v183
  v_add_u32 v188, 162816, v178
  v_add_f32_dpp v180, v180, v180 row_ror:8 row_mask:0xf bank_mask:0xf
  v_add_f32_dpp v181, v181, v181 row_ror:8 row_mask:0xf bank_mask:0xf
  ds_write_b64 v177, v[180:181]
  v_and_b32 v184, 3, v10
  v_lshlrev_b32 v184, 3, v184
  s_cmp_eq_u32 s44, 0
  s_cselect_b32 s48, s56, 1073741824
  s_waitcnt lgkmcnt(0)
  s_barrier
  ds_read_b32 v180, v188 offset:0
  ds_read_b32 v181, v188 offset:256
  ds_read_b32 v182, v188 offset:512
  ds_read_b32 v183, v188 offset:768
  s_waitcnt vmcnt(0)
  v_readfirstlane_b32 s3, v195
  s_lshl_b32 s45, s2, 7
  s_add_u32 s45, s45, 5242880
  s_cmp_eq_u32 s44, 0
  s_cselect_b32 s45, s45, 1073741824
  s_mul_i32 s3, s3, 0x9e3779b1
  s_add_u32 s3, s3, 0x7f4a7c15
  s_and_b32 s70, s2, 7
  s_bfe_u32 s49, s2, 0x20003
  s_lshl2_add_u32 s70, s70, s49
  s_lshr_b32 s49, s2, 5
  s_lshl3_add_u32 s70, s70, s49
  s_lshl1_add_u32 s70, s70, s44
  s_lshl_b32 s70, s70, 10
  s_add_u32 s70, s70, 524288
  s_add_u32 s56, s56, 8192
  s_cmp_lt_u32 s44, 2
  s_cselect_b32 s70, s70, 1073741824
  s_cmp_eq_u32 s44, 2
  s_cselect_b32 s71, s56, 1073741824
  v_bfe_u32 v184, s3, v184, 8
  v_mov_b32 v185, 0xffffff00
  s_waitcnt lgkmcnt(0)
  v_add_f32 v180, v180, v181
  v_add_f32 v182, v182, v183
  v_add_f32 v180, v180, v182
  v_add_u32 v180, 0x80, v180
  v_and_or_b32 v180, v180, v185, v184
  buffer_store_dword v180, v178, s[36:39], s48 offen sc1
  v_mov_b32 v184, -1
  v_mov_b32 v185, -1
  v_mov_b32 v186, -1
  v_mov_b32 v187, -1
  buffer_store_dwordx4 v[184:187], v0, s[36:39], s70 offen sc1
  buffer_store_dword v184, v178, s[36:39], s71 offen sc1
  s_lshl_b32 s48, s44, 7
  s_add_u32 s48, s48, s2
  s_lshl_b32 s48, s48, 13
  v_lshlrev_b32 v14, 3, v0
  s_mov_b32 s50, s48
  buffer_load_dword a252, v14, s[8:11], s50 offen
  s_mov_b32 s55, 0x20000
  s_sub_u32 s49, s48, 2097152
  s_add_u32 s48, s48, 4194304
  s_cmp_ge_u32 s44, 2
  s_cselect_b64 s[52:53], s[12:13], s[8:9]
  s_cselect_b32 s54, s14, s10
  s_cselect_b32 s48, s49, s48
  v_mov_b32 v12, s3
  s_waitcnt vmcnt(1)
  s_barrier
  s_mov_b64 exec, 1
  buffer_store_dword v12, v0, s[36:39], s45 offen sc1
  s_mov_b64 exec, -1
  s_waitcnt vmcnt(1)
  s_lshr_b32 s49, s2, 3
  s_mul_i32 s49, s49, 393216
  s_add_u32 s49, s49, s64
  s_and_b32 s50, s2, 2
  s_lshl_b32 s50, s50, 9
  s_add_u32 s49, s49, s50
  s_and_b32 s50, s2, 1
  s_lshl2_add_u32 s50, s50, s44
  s_cmp_lt_u32 s50, 3
  s_cselect_b32 s49, s49, 1073741824
  v_min_u32 v15, 63, v10
  v_mul_u32_u24 v15, 6144, v15
  buffer_load_dword a252, v15, s[8:11], s49 offen offset:384
  buffer_load_dword a252, v14, s[52:55], s48 offen
  s_branch J2
.p2align 12
AL:
  s_waitcnt vmcnt(8)
  v_readfirstlane_b32 s3, v195
  s_lshl_b32 s45, s2, 7
  s_add_u32 s45, s45, 5242880
  s_cmp_eq_u32 s44, 0
  s_cselect_b32 s45, s45, 1073741824
  s_mul_i32 s3, s3, 0x9e3779b1
  s_add_u32 s3, s3, 0x7f4a7c15
  s_and_b32 s70, s2, 7
  s_bfe_u32 s49, s2, 0x20003
  s_lshl2_add_u32 s70, s70, s49
  s_lshr_b32 s49, s2, 5
  s_lshl3_add_u32 s70, s70, s49
  s_lshl1_add_u32 s70, s70, s44
  s_lshl_b32 s70, s70, 10
  s_add_u32 s70, s70, 524288
  s_add_u32 s56, s56, 8192
  s_cmp_lt_u32 s44, 2
  s_cselect_b32 s70, s70, 1073741824
  s_cmp_eq_u32 s44, 2
  s_cselect_b32 s71, s56, 1073741824
  s_add_u32 s48, s64, 150528
  v_add_u32 v14, s48, v0
  v_lshl_add_u32 v15, v13, 5, s48
  v_lshlrev_b32 v17, 6, v12
  v_add_u32 v17, 158720, v17
  s_lshl_b32 s48, s44, 4
  v_add_u32 v16, s48, v17
  v_bfe_u32 v18, v10, 3, 1
  v_lshlrev_b32 v132, 9, v18
  v_bfe_u32 v18, v10, 4, 1
  v_lshl_add_u32 v132, v18, 8, v132
  v_lshrrev_b32 v18, 5, v10
  v_lshl_add_u32 v132, v18, 11, v132
  v_lshl_add_u32 v132, v12, 4, v132
  s_bfe_u32 s50, s2, 0x60001
  s_lshl2_add_u32 s50, s50, s44
  s_lshl_b32 s50, s50, 4
  s_and_b32 s48, s2, 1
  s_add_u32 s50, s50, s48
  s_lshl_b32 s50, s50, 10
  s_add_u32 s50, s50, 1048576
  s_bfe_u32 s66, s3, 0x80000
  s_bfe_u32 s67, s3, 0x80008
  s_bfe_u32 s68, s3, 0x80010
  s_bfe_u32 s69, s3, 0x80018
  s_waitcnt vmcnt(7)
  v_lshlrev_b32 v20, 16, v136
  v_and_b32 v21, 0xffff0000, v136
  v_lshlrev_b32 v22, 16, v137
  v_and_b32 v23, 0xffff0000, v137
  v_lshlrev_b32 v24, 16, v138
  v_and_b32 v25, 0xffff0000, v138
  v_lshlrev_b32 v26, 16, v139
  v_and_b32 v27, 0xffff0000, v139
  v_pk_mul_f32 v[126:127], v[20:21], v[20:21]
  v_pk_mul_f32 v[130:131], v[22:23], v[22:23]
  v_pk_fma_f32 v[126:127], v[24:25], v[24:25], v[126:127]
  v_pk_add_f32 v[124:125], v[24:25], v[20:21]
  v_pk_fma_f32 v[130:131], v[26:27], v[26:27], v[130:131]
  v_pk_add_f32 v[128:129], v[26:27], v[22:23]
  s_waitcnt vmcnt(6)
  v_lshlrev_b32 v28, 16, v140
  v_and_b32 v29, 0xffff0000, v140
  v_lshlrev_b32 v30, 16, v141
  v_and_b32 v31, 0xffff0000, v141
  v_lshlrev_b32 v32, 16, v142
  v_and_b32 v33, 0xffff0000, v142
  v_lshlrev_b32 v34, 16, v143
  v_and_b32 v35, 0xffff0000, v143
  v_pk_fma_f32 v[126:127], v[28:29], v[28:29], v[126:127]
  v_pk_add_f32 v[124:125], v[28:29], v[124:125]
  v_pk_fma_f32 v[130:131], v[30:31], v[30:31], v[130:131]
  v_pk_add_f32 v[128:129], v[30:31], v[128:129]
  v_pk_fma_f32 v[126:127], v[32:33], v[32:33], v[126:127]
  v_pk_add_f32 v[124:125], v[32:33], v[124:125]
  v_pk_fma_f32 v[130:131], v[34:35], v[34:35], v[130:131]
  v_pk_add_f32 v[128:129], v[34:35], v[128:129]
  s_waitcnt vmcnt(5)
  v_lshlrev_b32 v36, 16, v144
  v_and_b32 v37, 0xffff0000, v144
  v_lshlrev_b32 v38, 16, v145
  v_and_b32 v39, 0xffff0000, v145
  v_lshlrev_b32 v40, 16, v146
  v_and_b32 v41, 0xffff0000, v146
  v_lshlrev_b32 v42, 16, v147
  v_and_b32 v43, 0xffff0000, v147
  v_pk_fma_f32 v[126:127], v[36:37], v[36:37], v[126:127]
  v_pk_add_f32 v[124:125], v[36:37], v[124:125]
  v_pk_fma_f32 v[130:131], v[38:39], v[38:39], v[130:131]
  v_pk_add_f32 v[128:129], v[38:39], v[128:129]
  v_pk_fma_f32 v[126:127], v[40:41], v[40:41], v[126:127]
  v_pk_add_f32 v[124:125], v[40:41], v[124:125]
  v_pk_fma_f32 v[130:131], v[42:43], v[42:43], v[130:131]
  v_pk_add_f32 v[128:129], v[42:43], v[128:129]
  s_waitcnt vmcnt(4)
  v_lshlrev_b32 v44, 16, v148
  v_and_b32 v45, 0xffff0000, v148
  v_lshlrev_b32 v46, 16, v149
  v_and_b32 v47, 0xffff0000, v149
  v_lshlrev_b32 v48, 16, v150
  v_and_b32 v49, 0xffff0000, v150
  v_lshlrev_b32 v50, 16, v151
  v_and_b32 v51, 0xffff0000, v151
  v_pk_fma_f32 v[126:127], v[44:45], v[44:45], v[126:127]
  v_pk_add_f32 v[124:125], v[44:45], v[124:125]
  v_pk_fma_f32 v[130:131], v[46:47], v[46:47], v[130:131]
  v_pk_add_f32 v[128:129], v[46:47], v[128:129]
  v_pk_fma_f32 v[126:127], v[48:49], v[48:49], v[126:127]
  v_pk_add_f32 v[124:125], v[48:49], v[124:125]
  v_pk_fma_f32 v[130:131], v[50:51], v[50:51], v[130:131]
  v_pk_add_f32 v[128:129], v[50:51], v[128:129]
  v_pk_add_f32 v[124:125], v[124:125], v[128:129]
  v_pk_add_f32 v[126:127], v[126:127], v[130:131]
  v_add_f32 v180, v124, v125
  v_add_f32 v181, v126, v127
  s_waitcnt vmcnt(3)
  v_lshlrev_b32 v52, 16, v152
  v_and_b32 v53, 0xffff0000, v152
  v_lshlrev_b32 v54, 16, v153
  v_and_b32 v55, 0xffff0000, v153
  v_lshlrev_b32 v56, 16, v154
  v_and_b32 v57, 0xffff0000, v154
  v_lshlrev_b32 v58, 16, v155
  v_and_b32 v59, 0xffff0000, v155
  v_pk_mul_f32 v[126:127], v[52:53], v[52:53]
  v_pk_mul_f32 v[130:131], v[54:55], v[54:55]
  v_pk_fma_f32 v[126:127], v[56:57], v[56:57], v[126:127]
  v_pk_add_f32 v[124:125], v[56:57], v[52:53]
  v_pk_fma_f32 v[130:131], v[58:59], v[58:59], v[130:131]
  v_pk_add_f32 v[128:129], v[58:59], v[54:55]
  s_waitcnt vmcnt(2)
  v_lshlrev_b32 v60, 16, v156
  v_and_b32 v61, 0xffff0000, v156
  v_lshlrev_b32 v62, 16, v157
  v_and_b32 v63, 0xffff0000, v157
  v_lshlrev_b32 v64, 16, v158
  v_and_b32 v65, 0xffff0000, v158
  v_lshlrev_b32 v66, 16, v159
  v_and_b32 v67, 0xffff0000, v159
  v_pk_fma_f32 v[126:127], v[60:61], v[60:61], v[126:127]
  v_pk_add_f32 v[124:125], v[60:61], v[124:125]
  v_pk_fma_f32 v[130:131], v[62:63], v[62:63], v[130:131]
  v_pk_add_f32 v[128:129], v[62:63], v[128:129]
  v_pk_fma_f32 v[126:127], v[64:65], v[64:65], v[126:127]
  v_pk_add_f32 v[124:125], v[64:65], v[124:125]
  v_pk_fma_f32 v[130:131], v[66:67], v[66:67], v[130:131]
  v_pk_add_f32 v[128:129], v[66:67], v[128:129]
  s_waitcnt vmcnt(1)
  v_lshlrev_b32 v68, 16, v160
  v_and_b32 v69, 0xffff0000, v160
  v_lshlrev_b32 v70, 16, v161
  v_and_b32 v71, 0xffff0000, v161
  v_lshlrev_b32 v72, 16, v162
  v_and_b32 v73, 0xffff0000, v162
  v_lshlrev_b32 v74, 16, v163
  v_and_b32 v75, 0xffff0000, v163
  v_pk_fma_f32 v[126:127], v[68:69], v[68:69], v[126:127]
  v_pk_add_f32 v[124:125], v[68:69], v[124:125]
  v_pk_fma_f32 v[130:131], v[70:71], v[70:71], v[130:131]
  v_pk_add_f32 v[128:129], v[70:71], v[128:129]
  v_pk_fma_f32 v[126:127], v[72:73], v[72:73], v[126:127]
  v_pk_add_f32 v[124:125], v[72:73], v[124:125]
  v_pk_fma_f32 v[130:131], v[74:75], v[74:75], v[130:131]
  v_pk_add_f32 v[128:129], v[74:75], v[128:129]
  s_waitcnt vmcnt(0)
  v_lshlrev_b32 v76, 16, v164
  v_and_b32 v77, 0xffff0000, v164
  v_lshlrev_b32 v78, 16, v165
  v_and_b32 v79, 0xffff0000, v165
  v_lshlrev_b32 v80, 16, v166
  v_and_b32 v81, 0xffff0000, v166
  v_lshlrev_b32 v82, 16, v167
  v_and_b32 v83, 0xffff0000, v167
  v_pk_fma_f32 v[126:127], v[76:77], v[76:77], v[126:127]
  v_pk_add_f32 v[124:125], v[76:77], v[124:125]
  v_pk_fma_f32 v[130:131], v[78:79], v[78:79], v[130:131]
  v_pk_add_f32 v[128:129], v[78:79], v[128:129]
  v_pk_fma_f32 v[126:127], v[80:81], v[80:81], v[126:127]
  v_pk_add_f32 v[124:125], v[80:81], v[124:125]
  v_pk_fma_f32 v[130:131], v[82:83], v[82:83], v[130:131]
  v_pk_add_f32 v[128:129], v[82:83], v[128:129]
  v_pk_add_f32 v[124:125], v[124:125], v[128:129]
  v_pk_add_f32 v[126:127], v[126:127], v[130:131]
  v_add_f32 v182, v124, v125
  v_add_f32 v183, v126, v127
  s_nop 0
  v_add_f32_dpp v188, v180, v180 row_ror:8 row_mask:0xf bank_mask:0xf
  v_add_f32_dpp v189, v181, v181 row_ror:8 row_mask:0xf bank_mask:0xf
  v_add_f32_dpp v190, v182, v182 row_ror:8 row_mask:0xf bank_mask:0xf
  v_add_f32_dpp v191, v183, v183 row_ror:8 row_mask:0xf bank_mask:0xf
  v_mov_b32 v180, v188
  v_mov_b32 v181, v189
  v_mov_b32 v182, v190
  v_mov_b32 v183, v191
  v_permlane16_swap_b32 v188, v180
  v_permlane16_swap_b32 v189, v181
  v_permlane16_swap_b32 v190, v182
  v_permlane16_swap_b32 v191, v183
  v_pk_add_f32 v[188:189], v[188:189], v[180:181]
  v_pk_add_f32 v[190:191], v[190:191], v[182:183]
  v_mov_b32 v180, v188
  v_mov_b32 v181, v189
  v_mov_b32 v182, v190
  v_mov_b32 v183, v191
  v_permlane32_swap_b32 v188, v180
  v_permlane32_swap_b32 v189, v181
  v_permlane32_swap_b32 v190, v182
  v_permlane32_swap_b32 v191, v183
  v_pk_add_f32 v[188:189], v[188:189], v[180:181]
  v_pk_add_f32 v[190:191], v[190:191], v[182:183]
  ds_write_b128 v16, v[188:191]
  s_waitcnt lgkmcnt(0)
  s_barrier
  ds_read_b128 v[136:139], v17 offset:0
  ds_read_b128 v[140:143], v17 offset:16
  ds_read_b128 v[144:147], v17 offset:32
  ds_read_b128 v[148:151], v17 offset:48
  s_lshl_b32 s49, s44, 10
  buffer_load_dwordx4 v[220:223], v0, s[36:39], s49 offen sc1
  s_add_u32 s49, s49, 4096
  buffer_load_dwordx4 v[84:87], v0, s[36:39], s49 offen sc1
  s_add_u32 s49, s49, 20480
  buffer_load_dwordx4 v[224:227], v0, s[36:39], s49 offen sc1
  s_add_u32 s49, s49, 4096
  buffer_load_dwordx4 v[88:91], v0, s[36:39], s49 offen sc1
  s_add_u32 s49, s49, 20480
  buffer_load_dwordx4 v[228:231], v0, s[36:39], s49 offen sc1
  s_add_u32 s49, s49, 4096
  buffer_load_dwordx4 v[92:95], v0, s[36:39], s49 offen sc1
  s_add_u32 s49, s49, 20480
  buffer_load_dwordx4 v[232:235], v0, s[36:39], s49 offen sc1
  s_add_u32 s49, s49, 4096
  buffer_load_dwordx4 v[96:99], v0, s[36:39], s49 offen sc1
  s_waitcnt lgkmcnt(0)
  v_pk_add_f32 v[136:137], v[136:137], v[144:145]
  v_pk_add_f32 v[138:139], v[138:139], v[146:147]
  v_pk_add_f32 v[140:141], v[140:141], v[148:149]
  v_pk_add_f32 v[142:143], v[142:143], v[150:151]
  v_pk_add_f32 v[136:137], v[136:137], v[140:141]
  v_pk_add_f32 v[138:139], v[138:139], v[142:143]
  v_mul_f32 v188, 0x3a800000, v136
  v_mul_f32 v189, 0x3a800000, v137
  v_mul_f32 v190, 0x3a800000, v138
  v_mul_f32 v191, 0x3a800000, v139
  v_fma_f32 v189, -v188, v188, v189
  v_fma_f32 v191, -v190, v190, v191
  v_max_f32 v189, 0, v189
  v_max_f32 v191, 0, v191
  v_cvt_pk_bf16_f32 v189, v189, v189
  v_cvt_pk_bf16_f32 v191, v191, v191
  v_lshlrev_b32 v189, 16, v189
  v_lshlrev_b32 v191, 16, v191
  v_add_f32 v189, 0x3727c5ac, v189
  v_add_f32 v191, 0x3727c5ac, v191
  v_cvt_pk_bf16_f32 v189, v189, v189
  v_cvt_pk_bf16_f32 v191, v191, v191
  v_lshlrev_b32 v189, 16, v189
  v_lshlrev_b32 v191, 16, v191
  v_sqrt_f32 v189, v189
  v_sqrt_f32 v191, v191
  v_cvt_pk_bf16_f32 v188, v188, v188
  v_cvt_pk_bf16_f32 v190, v190, v190
  v_lshlrev_b32 v188, 16, v188
  v_lshlrev_b32 v190, 16, v190
  v_cvt_pk_bf16_f32 v189, v189, v189
  v_cvt_pk_bf16_f32 v191, v191, v191
  v_lshlrev_b32 v189, 16, v189
  v_lshlrev_b32 v191, 16, v191
  v_rcp_f32 v189, v189
  v_rcp_f32 v191, v191
  v_mul_f32 v188, -v188, v189
  v_mul_f32 v190, -v190, v191
  v_pk_fma_f32 v[20:21], v[20:21], v[188:189], v[188:189] op_sel:[0,1,0] op_sel_hi:[1,1,0]
  v_pk_fma_f32 v[22:23], v[22:23], v[188:189], v[188:189] op_sel:[0,1,0] op_sel_hi:[1,1,0]
  v_pk_fma_f32 v[24:25], v[24:25], v[188:189], v[188:189] op_sel:[0,1,0] op_sel_hi:[1,1,0]
  v_pk_fma_f32 v[26:27], v[26:27], v[188:189], v[188:189] op_sel:[0,1,0] op_sel_hi:[1,1,0]
  v_pk_fma_f32 v[28:29], v[28:29], v[188:189], v[188:189] op_sel:[0,1,0] op_sel_hi:[1,1,0]
  v_pk_fma_f32 v[30:31], v[30:31], v[188:189], v[188:189] op_sel:[0,1,0] op_sel_hi:[1,1,0]
  v_pk_fma_f32 v[32:33], v[32:33], v[188:189], v[188:189] op_sel:[0,1,0] op_sel_hi:[1,1,0]
  v_pk_fma_f32 v[34:35], v[34:35], v[188:189], v[188:189] op_sel:[0,1,0] op_sel_hi:[1,1,0]
  v_pk_fma_f32 v[36:37], v[36:37], v[188:189], v[188:189] op_sel:[0,1,0] op_sel_hi:[1,1,0]
  v_pk_fma_f32 v[38:39], v[38:39], v[188:189], v[188:189] op_sel:[0,1,0] op_sel_hi:[1,1,0]
  v_pk_fma_f32 v[40:41], v[40:41], v[188:189], v[188:189] op_sel:[0,1,0] op_sel_hi:[1,1,0]
  v_pk_fma_f32 v[42:43], v[42:43], v[188:189], v[188:189] op_sel:[0,1,0] op_sel_hi:[1,1,0]
  v_pk_fma_f32 v[44:45], v[44:45], v[188:189], v[188:189] op_sel:[0,1,0] op_sel_hi:[1,1,0]
  v_pk_fma_f32 v[46:47], v[46:47], v[188:189], v[188:189] op_sel:[0,1,0] op_sel_hi:[1,1,0]
  v_pk_fma_f32 v[48:49], v[48:49], v[188:189], v[188:189] op_sel:[0,1,0] op_sel_hi:[1,1,0]
  v_pk_fma_f32 v[50:51], v[50:51], v[188:189], v[188:189] op_sel:[0,1,0] op_sel_hi:[1,1,0]
  v_pk_fma_f32 v[52:53], v[52:53], v[190:191], v[190:191] op_sel:[0,1,0] op_sel_hi:[1,1,0]
  v_pk_fma_f32 v[54:55], v[54:55], v[190:191], v[190:191] op_sel:[0,1,0] op_sel_hi:[1,1,0]
  v_pk_fma_f32 v[56:57], v[56:57], v[190:191], v[190:191] op_sel:[0,1,0] op_sel_hi:[1,1,0]
  v_pk_fma_f32 v[58:59], v[58:59], v[190:191], v[190:191] op_sel:[0,1,0] op_sel_hi:[1,1,0]
  v_pk_fma_f32 v[60:61], v[60:61], v[190:191], v[190:191] op_sel:[0,1,0] op_sel_hi:[1,1,0]
  v_pk_fma_f32 v[62:63], v[62:63], v[190:191], v[190:191] op_sel:[0,1,0] op_sel_hi:[1,1,0]
  v_pk_fma_f32 v[64:65], v[64:65], v[190:191], v[190:191] op_sel:[0,1,0] op_sel_hi:[1,1,0]
  v_pk_fma_f32 v[66:67], v[66:67], v[190:191], v[190:191] op_sel:[0,1,0] op_sel_hi:[1,1,0]
  v_pk_fma_f32 v[68:69], v[68:69], v[190:191], v[190:191] op_sel:[0,1,0] op_sel_hi:[1,1,0]
  v_pk_fma_f32 v[70:71], v[70:71], v[190:191], v[190:191] op_sel:[0,1,0] op_sel_hi:[1,1,0]
  v_pk_fma_f32 v[72:73], v[72:73], v[190:191], v[190:191] op_sel:[0,1,0] op_sel_hi:[1,1,0]
  v_pk_fma_f32 v[74:75], v[74:75], v[190:191], v[190:191] op_sel:[0,1,0] op_sel_hi:[1,1,0]
  v_pk_fma_f32 v[76:77], v[76:77], v[190:191], v[190:191] op_sel:[0,1,0] op_sel_hi:[1,1,0]
  v_pk_fma_f32 v[78:79], v[78:79], v[190:191], v[190:191] op_sel:[0,1,0] op_sel_hi:[1,1,0]
  v_pk_fma_f32 v[80:81], v[80:81], v[190:191], v[190:191] op_sel:[0,1,0] op_sel_hi:[1,1,0]
  v_pk_fma_f32 v[82:83], v[82:83], v[190:191], v[190:191] op_sel:[0,1,0] op_sel_hi:[1,1,0]
  s_mov_b32 s46, 30000
  s_branch PLC
PLP:
  s_lshl_b32 s49, s44, 10
  buffer_load_dwordx4 v[220:223], v0, s[36:39], s49 offen sc1
  s_add_u32 s49, s49, 4096
  buffer_load_dwordx4 v[84:87], v0, s[36:39], s49 offen sc1
  s_add_u32 s49, s49, 20480
  buffer_load_dwordx4 v[224:227], v0, s[36:39], s49 offen sc1
  s_add_u32 s49, s49, 4096
  buffer_load_dwordx4 v[88:91], v0, s[36:39], s49 offen sc1
  s_add_u32 s49, s49, 20480
  buffer_load_dwordx4 v[228:231], v0, s[36:39], s49 offen sc1
  s_add_u32 s49, s49, 4096
  buffer_load_dwordx4 v[92:95], v0, s[36:39], s49 offen sc1
  s_add_u32 s49, s49, 20480
  buffer_load_dwordx4 v[232:235], v0, s[36:39], s49 offen sc1
  s_add_u32 s49, s49, 4096
  buffer_load_dwordx4 v[96:99], v0, s[36:39], s49 offen sc1
PLC:
  s_waitcnt vmcnt(7)
  v_xor_b32 v220, s66, v220
  v_xor_b32 v221, s67, v221
  v_xor_b32 v222, s68, v222
  v_xor_b32 v223, s69, v223
  v_or3_b32 v184, 0, v220, v221
  v_or3_b32 v184, v184, v222, v223
  s_waitcnt vmcnt(6)
  v_xor_b32 v84, s66, v84
  v_xor_b32 v85, s67, v85
  v_xor_b32 v86, s68, v86
  v_xor_b32 v87, s69, v87
  v_or3_b32 v184, v184, v84, v85
  v_or3_b32 v184, v184, v86, v87
  s_waitcnt vmcnt(5)
  v_xor_b32 v224, s66, v224
  v_xor_b32 v225, s67, v225
  v_xor_b32 v226, s68, v226
  v_xor_b32 v227, s69, v227
  v_or3_b32 v184, v184, v224, v225
  v_or3_b32 v184, v184, v226, v227
  s_waitcnt vmcnt(4)
  v_xor_b32 v88, s66, v88
  v_xor_b32 v89, s67, v89
  v_xor_b32 v90, s68, v90
  v_xor_b32 v91, s69, v91
  v_or3_b32 v184, v184, v88, v89
  v_or3_b32 v184, v184, v90, v91
  s_waitcnt vmcnt(3)
  v_xor_b32 v228, s66, v228
  v_xor_b32 v229, s67, v229
  v_xor_b32 v230, s68, v230
  v_xor_b32 v231, s69, v231
  v_or3_b32 v184, v184, v228, v229
  v_or3_b32 v184, v184, v230, v231
  s_waitcnt vmcnt(2)
  v_xor_b32 v92, s66, v92
  v_xor_b32 v93, s67, v93
  v_xor_b32 v94, s68, v94
  v_xor_b32 v95, s69, v95
  v_or3_b32 v184, v184, v92, v93
  v_or3_b32 v184, v184, v94, v95
  s_waitcnt vmcnt(1)
  v_xor_b32 v232, s66, v232
  v_xor_b32 v233, s67, v233
  v_xor_b32 v234, s68, v234
  v_xor_b32 v235, s69, v235
  v_or3_b32 v184, v184, v232, v233
  v_or3_b32 v184, v184, v234, v235
  s_waitcnt vmcnt(0)
  v_xor_b32 v96, s66, v96
  v_xor_b32 v97, s67, v97
  v_xor_b32 v98, s68, v98
  v_xor_b32 v99, s69, v99
  v_or3_b32 v184, v184, v96, v97
  v_or3_b32 v184, v184, v98, v99
  v_and_b32 v184, 0xff, v184
  v_cmp_ne_u32 vcc, 0, v184
  s_sub_u32 s46, s46, 1
  s_cmp_eq_u32 s46, 0
  s_cbranch_scc1 PLX
  s_nop 1
  s_cbranch_vccnz PLP
PLX:
  v_mov_b32 v180, -1
  v_mov_b32 v181, -1
  v_mov_b32 v182, -1
  v_mov_b32 v183, -1
  buffer_store_dwordx4 v[180:183], v0, s[36:39], s70 offen sc1
  buffer_store_dword v180, v178, s[36:39], s71 offen sc1
  v_pk_add_f32 v[84:85], v[84:85], v[92:93]
  v_pk_add_f32 v[220:221], v[220:221], v[228:229]
  v_pk_add_f32 v[86:87], v[86:87], v[94:95]
  v_pk_add_f32 v[222:223], v[222:223], v[230:231]
  v_pk_add_f32 v[88:89], v[88:89], v[96:97]
  v_pk_add_f32 v[224:225], v[224:225], v[232:233]
  v_pk_add_f32 v[90:91], v[90:91], v[98:99]
  v_pk_add_f32 v[226:227], v[226:227], v[234:235]
  v_pk_add_f32 v[84:85], v[84:85], v[88:89]
  v_pk_add_f32 v[220:221], v[220:221], v[224:225]
  v_pk_add_f32 v[86:87], v[86:87], v[90:91]
  v_pk_add_f32 v[222:223], v[222:223], v[226:227]
  v_cvt_pk_bf16_f32 v184, v220, v221
  v_lshlrev_b32 v220, 16, v184
  v_and_b32 v221, 0xffff0000, v184
  v_cvt_pk_bf16_f32 v184, v222, v223
  v_lshlrev_b32 v222, 16, v184
  v_and_b32 v223, 0xffff0000, v184
  ds_write_b128 v14, v[220:223] offset:1024
  v_cvt_pk_bf16_f32 v184, v84, v85
  v_lshlrev_b32 v84, 16, v184
  v_and_b32 v85, 0xffff0000, v184
  v_pk_add_f32 v[84:85], v[84:85], 1.0 op_sel_hi:[1,0]
  v_cvt_pk_bf16_f32 v184, v84, v85
  v_lshlrev_b32 v84, 16, v184
  v_and_b32 v85, 0xffff0000, v184
  v_cvt_pk_bf16_f32 v184, v86, v87
  v_lshlrev_b32 v86, 16, v184
  v_and_b32 v87, 0xffff0000, v184
  v_pk_add_f32 v[86:87], v[86:87], 1.0 op_sel_hi:[1,0]
  v_cvt_pk_bf16_f32 v184, v86, v87
  v_lshlrev_b32 v86, 16, v184
  v_and_b32 v87, 0xffff0000, v184
  ds_write_b128 v14, v[84:87]
  ds_read_b128 v[220:223], v15 offset:1024
  ds_read_b128 v[84:87], v15 offset:0
  ds_read_b128 v[224:227], v15 offset:1040
  ds_read_b128 v[88:91], v15 offset:16
  ds_read_b128 v[228:231], v15 offset:1280
  ds_read_b128 v[92:95], v15 offset:256
  ds_read_b128 v[232:235], v15 offset:1296
  ds_read_b128 v[96:99], v15 offset:272
  ds_read_b128 v[236:239], v15 offset:1536
  ds_read_b128 v[100:103], v15 offset:512
  ds_read_b128 v[240:243], v15 offset:1552
  ds_read_b128 v[104:107], v15 offset:528
  ds_read_b128 v[244:247], v15 offset:1792
  ds_read_b128 v[108:111], v15 offset:768
  ds_read_b128 v[248:251], v15 offset:1808
  ds_read_b128 v[112:115], v15 offset:784
  s_waitcnt lgkmcnt(12)
  v_pk_fma_f32 v[20:21], v[20:21], v[84:85], v[220:221]
  v_pk_fma_f32 v[22:23], v[22:23], v[86:87], v[222:223]
  v_pk_fma_f32 v[24:25], v[24:25], v[88:89], v[224:225]
  v_pk_fma_f32 v[26:27], v[26:27], v[90:91], v[226:227]
  v_pk_fma_f32 v[52:53], v[52:53], v[84:85], v[220:221]
  v_pk_fma_f32 v[54:55], v[54:55], v[86:87], v[222:223]
  v_pk_fma_f32 v[56:57], v[56:57], v[88:89], v[224:225]
  v_pk_fma_f32 v[58:59], v[58:59], v[90:91], v[226:227]
  v_cvt_pk_bf16_f32 v136, v20, v21
  v_cvt_pk_bf16_f32 v137, v22, v23
  v_cvt_pk_bf16_f32 v138, v24, v25
  v_cvt_pk_bf16_f32 v139, v26, v27
  v_cvt_pk_bf16_f32 v152, v52, v53
  v_cvt_pk_bf16_f32 v153, v54, v55
  v_cvt_pk_bf16_f32 v154, v56, v57
  v_cvt_pk_bf16_f32 v155, v58, v59
  v_permlane16_swap_b32 v136, v138
  v_permlane16_swap_b32 v137, v139
  v_permlane16_swap_b32 v152, v154
  v_permlane16_swap_b32 v153, v155
  buffer_store_dwordx4 v[136:139], v132, s[36:39], s50 offen offset:0 sc1
  buffer_store_dwordx4 v[152:155], v132, s[36:39], s50 offen offset:128 sc1
  s_add_u32 s50, s50, 4096
  s_waitcnt lgkmcnt(8)
  v_pk_fma_f32 v[28:29], v[28:29], v[92:93], v[228:229]
  v_pk_fma_f32 v[30:31], v[30:31], v[94:95], v[230:231]
  v_pk_fma_f32 v[32:33], v[32:33], v[96:97], v[232:233]
  v_pk_fma_f32 v[34:35], v[34:35], v[98:99], v[234:235]
  v_pk_fma_f32 v[60:61], v[60:61], v[92:93], v[228:229]
  v_pk_fma_f32 v[62:63], v[62:63], v[94:95], v[230:231]
  v_pk_fma_f32 v[64:65], v[64:65], v[96:97], v[232:233]
  v_pk_fma_f32 v[66:67], v[66:67], v[98:99], v[234:235]
  v_cvt_pk_bf16_f32 v140, v28, v29
  v_cvt_pk_bf16_f32 v141, v30, v31
  v_cvt_pk_bf16_f32 v142, v32, v33
  v_cvt_pk_bf16_f32 v143, v34, v35
  v_cvt_pk_bf16_f32 v156, v60, v61
  v_cvt_pk_bf16_f32 v157, v62, v63
  v_cvt_pk_bf16_f32 v158, v64, v65
  v_cvt_pk_bf16_f32 v159, v66, v67
  v_permlane16_swap_b32 v140, v142
  v_permlane16_swap_b32 v141, v143
  v_permlane16_swap_b32 v156, v158
  v_permlane16_swap_b32 v157, v159
  buffer_store_dwordx4 v[140:143], v132, s[36:39], s50 offen offset:0 sc1
  buffer_store_dwordx4 v[156:159], v132, s[36:39], s50 offen offset:128 sc1
  s_add_u32 s50, s50, 4096
  s_waitcnt lgkmcnt(4)
  v_pk_fma_f32 v[36:37], v[36:37], v[100:101], v[236:237]
  v_pk_fma_f32 v[38:39], v[38:39], v[102:103], v[238:239]
  v_pk_fma_f32 v[40:41], v[40:41], v[104:105], v[240:241]
  v_pk_fma_f32 v[42:43], v[42:43], v[106:107], v[242:243]
  v_pk_fma_f32 v[68:69], v[68:69], v[100:101], v[236:237]
  v_pk_fma_f32 v[70:71], v[70:71], v[102:103], v[238:239]
  v_pk_fma_f32 v[72:73], v[72:73], v[104:105], v[240:241]
  v_pk_fma_f32 v[74:75], v[74:75], v[106:107], v[242:243]
  v_cvt_pk_bf16_f32 v144, v36, v37
  v_cvt_pk_bf16_f32 v145, v38, v39
  v_cvt_pk_bf16_f32 v146, v40, v41
  v_cvt_pk_bf16_f32 v147, v42, v43
  v_cvt_pk_bf16_f32 v160, v68, v69
  v_cvt_pk_bf16_f32 v161, v70, v71
  v_cvt_pk_bf16_f32 v162, v72, v73
  v_cvt_pk_bf16_f32 v163, v74, v75
  v_permlane16_swap_b32 v144, v146
  v_permlane16_swap_b32 v145, v147
  v_permlane16_swap_b32 v160, v162
  v_permlane16_swap_b32 v161, v163
  buffer_store_dwordx4 v[144:147], v132, s[36:39], s50 offen offset:0 sc1
  buffer_store_dwordx4 v[160:163], v132, s[36:39], s50 offen offset:128 sc1
  s_add_u32 s50, s50, 4096
  s_waitcnt lgkmcnt(0)
  v_pk_fma_f32 v[44:45], v[44:45], v[108:109], v[244:245]
  v_pk_fma_f32 v[46:47], v[46:47], v[110:111], v[246:247]
  v_pk_fma_f32 v[48:49], v[48:49], v[112:113], v[248:249]
  v_pk_fma_f32 v[50:51], v[50:51], v[114:115], v[250:251]
  v_pk_fma_f32 v[76:77], v[76:77], v[108:109], v[244:245]
  v_pk_fma_f32 v[78:79], v[78:79], v[110:111], v[246:247]
  v_pk_fma_f32 v[80:81], v[80:81], v[112:113], v[248:249]
  v_pk_fma_f32 v[82:83], v[82:83], v[114:115], v[250:251]
  v_cvt_pk_bf16_f32 v148, v44, v45
  v_cvt_pk_bf16_f32 v149, v46, v47
  v_cvt_pk_bf16_f32 v150, v48, v49
  v_cvt_pk_bf16_f32 v151, v50, v51
  v_cvt_pk_bf16_f32 v164, v76, v77
  v_cvt_pk_bf16_f32 v165, v78, v79
  v_cvt_pk_bf16_f32 v166, v80, v81
  v_cvt_pk_bf16_f32 v167, v82, v83
  v_permlane16_swap_b32 v148, v150
  v_permlane16_swap_b32 v149, v151
  v_permlane16_swap_b32 v164, v166
  v_permlane16_swap_b32 v165, v167
  buffer_store_dwordx4 v[148:151], v132, s[36:39], s50 offen offset:0 sc1
  buffer_store_dwordx4 v[164:167], v132, s[36:39], s50 offen offset:128 sc1
  v_mov_b32 v12, s3
  s_waitcnt vmcnt(0) lgkmcnt(0)
  s_barrier
  s_mov_b64 exec, 1
  buffer_store_dword v12, v0, s[36:39], s45 offen sc1
  s_mov_b64 exec, -1
J2:
  s_mov_b32 s61, 0
  s_add_u32 m0, s63, 64512
  s_nop 0
  buffer_load_dwordx4 v202, s[8:11], s61 offen offset:0 lds
  buffer_load_dwordx4 v203, s[8:11], s61 offen offset:1024 lds
  buffer_load_dwordx4 v204, s[8:11], s61 offen offset:2048 lds
  s_mov_b32 s61, 196608
  s_add_u32 m0, s63, 86016
  s_nop 0
  buffer_load_dwordx4 v202, s[8:11], s61 offen offset:0 lds
  buffer_load_dwordx4 v203, s[8:11], s61 offen offset:1024 lds
  buffer_load_dwordx4 v204, s[8:11], s61 offen offset:2048 lds
  s_mov_b32 s61, 393216
  s_add_u32 m0, s63, 107520
  s_nop 0
  buffer_load_dwordx4 v202, s[8:11], s61 offen offset:0 lds
  buffer_load_dwordx4 v203, s[8:11], s61 offen offset:1024 lds
  buffer_load_dwordx4 v204, s[8:11], s61 offen offset:2048 lds
  s_mov_b32 s61, 589824
  s_add_u32 m0, s63, 129024
  s_nop 0
  buffer_load_dwordx4 v202, s[8:11], s61 offen offset:0 lds
  buffer_load_dwordx4 v203, s[8:11], s61 offen offset:1024 lds
  buffer_load_dwordx4 v204, s[8:11], s61 offen offset:2048 lds
  s_mov_b32 s61, 786432
  s_add_u32 m0, s63, 0
  s_nop 0
  buffer_load_dwordx4 v202, s[8:11], s61 offen offset:0 lds
  buffer_load_dwordx4 v203, s[8:11], s61 offen offset:1024 lds
  buffer_load_dwordx4 v204, s[8:11], s61 offen offset:2048 lds
  s_mov_b64 exec, 0
  s_cmp_eq_u32 s44, 1
  s_cbranch_scc1 Ha0
  s_cmp_eq_u32 s44, 2
  s_cbranch_scc1 Ha1
  s_cmp_eq_u32 s44, 3
  s_cbranch_scc1 Ha2
Ra:
  s_mov_b64 exec, -1
  s_cmp_lg_u32 s44, 0
  s_cbranch_scc1 SM2x
  s_mov_b32 s46, 60000
  s_mov_b32 s47, 5242880
SM2:
  buffer_load_dword v12, v215, s[36:39], s47 offen sc1
  s_sub_u32 s46, s46, 1
  s_cmp_eq_u32 s46, 0
  s_waitcnt vmcnt(0)
  s_cbranch_scc1 SM2x
  v_cmp_ne_u32 vcc, s3, v12
  s_nop 4
  s_cbranch_vccnz SM2
SM2x:
  s_barrier
  s_mov_b32 s62, 0
  s_add_u32 m0, s64, 76800
  s_nop 0
  buffer_load_dwordx4 v205, s[36:39], s62 offen offset:0 sc1 lds
  buffer_load_dwordx4 v205, s[36:39], s62 offen offset:1024 sc1 lds
  s_add_u32 m0, s65, 84992
  s_nop 0
  buffer_load_dword v206, s[36:39], s62 offen sc1 lds
  s_mov_b32 s62, 2048
  s_add_u32 m0, s64, 98304
  s_nop 0
  buffer_load_dwordx4 v205, s[36:39], s62 offen offset:0 sc1 lds
  buffer_load_dwordx4 v205, s[36:39], s62 offen offset:1024 sc1 lds
  s_add_u32 m0, s65, 106496
  s_nop 0
  buffer_load_dword v206, s[36:39], s62 offen sc1 lds
  s_mov_b32 s62, 4096
  s_add_u32 m0, s64, 119808
  s_nop 0
  buffer_load_dwordx4 v205, s[36:39], s62 offen offset:0 sc1 lds
  buffer_load_dwordx4 v205, s[36:39], s62 offen offset:1024 sc1 lds
  s_add_u32 m0, s65, 128000
  s_nop 0
  buffer_load_dword v206, s[36:39], s62 offen sc1 lds
  s_mov_b32 s62, 6144
  s_add_u32 m0, s64, 141312
  s_nop 0
  buffer_load_dwordx4 v205, s[36:39], s62 offen offset:0 sc1 lds
  buffer_load_dwordx4 v205, s[36:39], s62 offen offset:1024 sc1 lds
  s_add_u32 m0, s65, 149504
  s_nop 0
  buffer_load_dword v206, s[36:39], s62 offen sc1 lds
  s_waitcnt vmcnt(9)
  s_barrier
  ds_read_b64_tr_b16 a[40:41], v198 offset:1024
Ha0:
  s_cbranch_execz Ha0_1
  ds_read_b64_tr_b16 a[42:43], v198 offset:7168
  ds_read_b64_tr_b16 a[44:45], v199 offset:1024
  ds_read_b64_tr_b16 a[46:47], v199 offset:7168
  ds_read_b64_tr_b16 a[48:49], v198 offset:2048
  ds_read_b64_tr_b16 a[50:51], v198 offset:8192
  ds_read_b64_tr_b16 a[52:53], v199 offset:2048
  ds_read_b64_tr_b16 a[54:55], v199 offset:8192
  ds_read_b128 a[0:3], v208 offset:12288
  ds_read_b128 a[4:7], v208 offset:13312
  ds_read_b128 a[8:11], v208 offset:14336
  ds_read_b128 a[12:15], v208 offset:15360
  ds_read_b128 a[16:19], v211 offset:20480
  s_waitcnt lgkmcnt(0)
  v_mfma_f32_16x16x32_bf16 v[20:23], a[40:43], a[0:3], 0
  s_waitcnt vmcnt(6)
  s_barrier
  s_mov_b32 s62, 8192
  v_mfma_f32_16x16x32_bf16 v[24:27], a[40:43], a[4:7], 0
  s_add_u32 m0, s64, 12288
  ds_read_b64_tr_b16 a[56:57], v198 offset:0
  v_mfma_f32_16x16x32_bf16 v[28:31], a[40:43], a[8:11], 0
  buffer_load_dwordx4 v205, s[36:39], s62 offen offset:0 sc1 lds
  v_mfma_f32_16x16x32_bf16 v[32:35], a[40:43], a[12:15], 0
  ds_read_b64_tr_b16 a[58:59], v198 offset:6144
  v_mfma_f32_16x16x32_bf16 v[116:119], a[40:43], a[16:19], 0
  ds_read_b64_tr_b16 a[60:61], v199 offset:0
  v_mfma_f32_16x16x32_bf16 v[48:51], a[44:47], a[12:15], 0
  v_mfma_f32_16x16x32_bf16 v[44:47], a[44:47], a[8:11], 0
  buffer_load_dwordx4 v205, s[36:39], s62 offen offset:1024 sc1 lds
  s_add_u32 m0, s65, 20480
  v_mfma_f32_16x16x32_bf16 v[40:43], a[44:47], a[4:7], 0
  ds_read_b64_tr_b16 a[62:63], v199 offset:6144
  v_mfma_f32_16x16x32_bf16 v[36:39], a[44:47], a[0:3], 0
  s_waitcnt lgkmcnt(9)
  ds_read_b64_tr_b16 a[64:65], v198 offset:22528
  v_mfma_f32_16x16x32_bf16 v[52:55], a[0:3], a[48:51], 0
  ds_read_b128 a[20:23], v208 offset:33792
  v_mfma_f32_16x16x32_bf16 v[56:59], a[4:7], a[48:51], 0
  buffer_load_dword v206, s[36:39], s62 offen sc1 lds
  s_mov_b32 s61, 983040
  v_mfma_f32_16x16x32_bf16 v[60:63], a[8:11], a[48:51], 0
  s_add_u32 m0, s63, 21504
  ds_read_b64_tr_b16 a[66:67], v198 offset:28672
  v_mfma_f32_16x16x32_bf16 v[64:67], a[12:15], a[48:51], 0
  ds_read_b128 a[24:27], v208 offset:34816
  v_mfma_f32_16x16x32_bf16 v[120:123], a[16:19], a[48:51], 0
  ds_read_b64_tr_b16 a[68:69], v199 offset:22528
  v_mfma_f32_16x16x32_bf16 v[80:83], a[12:15], a[52:55], 0
  buffer_load_dwordx4 v202, s[8:11], s61 offen offset:0 lds
  v_mfma_f32_16x16x32_bf16 v[76:79], a[8:11], a[52:55], 0
  ds_read_b128 a[28:31], v208 offset:35840
  v_mfma_f32_16x16x32_bf16 v[72:75], a[4:7], a[52:55], 0
  ds_read_b64_tr_b16 a[70:71], v199 offset:28672
  v_mfma_f32_16x16x32_bf16 v[68:71], a[0:3], a[52:55], 0
  s_waitcnt lgkmcnt(7)
  ds_read_b128 a[32:35], v208 offset:36864
  v_mfma_f32_16x16x32_bf16 v[84:87], a[56:59], a[0:3], 0
  buffer_load_dwordx4 v203, s[8:11], s61 offen offset:1024 lds
  v_mfma_f32_16x16x32_bf16 v[88:91], a[56:59], a[4:7], 0
  ds_read_b128 a[36:39], v211 offset:41984
  v_mfma_f32_16x16x32_bf16 v[92:95], a[56:59], a[8:11], 0
  ds_read_b64_tr_b16 a[40:41], v198 offset:23552
  v_mfma_f32_16x16x32_bf16 v[96:99], a[56:59], a[12:15], 0
  ds_read_b64_tr_b16 a[42:43], v198 offset:29696
  v_mfma_f32_16x16x32_bf16 v[112:115], a[60:63], a[12:15], 0
  buffer_load_dwordx4 v204, s[8:11], s61 offen offset:2048 lds
  s_mov_b32 s62, 10240
  v_mfma_f32_16x16x32_bf16 v[108:111], a[60:63], a[8:11], 0
  s_add_u32 m0, s64, 33792
  ds_read_b64_tr_b16 a[44:45], v199 offset:23552
  v_mfma_f32_16x16x32_bf16 v[104:107], a[60:63], a[4:7], 0
  ds_read_b64_tr_b16 a[46:47], v199 offset:29696
  v_mfma_f32_16x16x32_bf16 v[100:103], a[60:63], a[0:3], 0
  s_waitcnt vmcnt(9) lgkmcnt(4)
  s_barrier
  v_mfma_f32_16x16x32_bf16 v[20:23], a[64:67], a[20:23], v[20:23]
  buffer_load_dwordx4 v205, s[36:39], s62 offen offset:0 sc1 lds
  v_mfma_f32_16x16x32_bf16 v[24:27], a[64:67], a[24:27], v[24:27]
  ds_read_b64_tr_b16 a[48:49], v198 offset:21504
  v_mfma_f32_16x16x32_bf16 v[28:31], a[64:67], a[28:31], v[28:31]
  ds_read_b64_tr_b16 a[50:51], v198 offset:27648
  v_mfma_f32_16x16x32_bf16 v[32:35], a[64:67], a[32:35], v[32:35]
  v_mfma_f32_16x16x32_bf16 v[116:119], a[64:67], a[36:39], v[116:119]
  buffer_load_dwordx4 v205, s[36:39], s62 offen offset:1024 sc1 lds
  s_add_u32 m0, s65, 41984
  v_mfma_f32_16x16x32_bf16 v[48:51], a[68:71], a[32:35], v[48:51]
  ds_read_b64_tr_b16 a[52:53], v199 offset:21504
  v_mfma_f32_16x16x32_bf16 v[44:47], a[68:71], a[28:31], v[44:47]
  ds_read_b64_tr_b16 a[54:55], v199 offset:27648
  v_mfma_f32_16x16x32_bf16 v[40:43], a[68:71], a[24:27], v[40:43]
  v_mfma_f32_16x16x32_bf16 v[36:39], a[68:71], a[20:23], v[36:39]
  s_waitcnt lgkmcnt(4)
  buffer_load_dword v206, s[36:39], s62 offen sc1 lds
  s_mov_b32 s61, 1179648
  v_mfma_f32_16x16x32_bf16 v[52:55], a[20:23], a[40:43], v[52:55]
  s_add_u32 m0, s63, 43008
  ds_read_b64_tr_b16 a[56:57], v198 offset:44032
  v_mfma_f32_16x16x32_bf16 v[56:59], a[24:27], a[40:43], v[56:59]
  ds_read_b128 a[0:3], v208 offset:55296
  v_mfma_f32_16x16x32_bf16 v[60:63], a[28:31], a[40:43], v[60:63]
  ds_read_b64_tr_b16 a[58:59], v198 offset:50176
  v_mfma_f32_16x16x32_bf16 v[64:67], a[32:35], a[40:43], v[64:67]
  buffer_load_dwordx4 v202, s[8:11], s61 offen offset:0 lds
  v_mfma_f32_16x16x32_bf16 v[120:123], a[36:39], a[40:43], v[120:123]
  ds_read_b128 a[4:7], v208 offset:56320
  v_mfma_f32_16x16x32_bf16 v[80:83], a[32:35], a[44:47], v[80:83]
  ds_read_b64_tr_b16 a[60:61], v199 offset:44032
  v_mfma_f32_16x16x32_bf16 v[76:79], a[28:31], a[44:47], v[76:79]
  ds_read_b128 a[8:11], v208 offset:57344
  v_mfma_f32_16x16x32_bf16 v[72:75], a[24:27], a[44:47], v[72:75]
  buffer_load_dwordx4 v203, s[8:11], s61 offen offset:1024 lds
  v_mfma_f32_16x16x32_bf16 v[68:71], a[20:23], a[44:47], v[68:71]
  s_waitcnt lgkmcnt(6)
  ds_read_b64_tr_b16 a[62:63], v199 offset:50176
  v_mfma_f32_16x16x32_bf16 v[84:87], a[48:51], a[20:23], v[84:87]
  ds_read_b128 a[12:15], v208 offset:58368
  v_mfma_f32_16x16x32_bf16 v[88:91], a[48:51], a[24:27], v[88:91]
  ds_read_b128 a[16:19], v211 offset:63488
  v_mfma_f32_16x16x32_bf16 v[92:95], a[48:51], a[28:31], v[92:95]
  buffer_load_dwordx4 v204, s[8:11], s61 offen offset:2048 lds
  s_mov_b32 s62, 12288
  v_mfma_f32_16x16x32_bf16 v[96:99], a[48:51], a[32:35], v[96:99]
  s_add_u32 m0, s64, 55296
  ds_read_b64_tr_b16 a[64:65], v198 offset:45056
  v_mfma_f32_16x16x32_bf16 v[112:115], a[52:55], a[32:35], v[112:115]
  ds_read_b64_tr_b16 a[66:67], v198 offset:51200
  v_mfma_f32_16x16x32_bf16 v[108:111], a[52:55], a[28:31], v[108:111]
  ds_read_b64_tr_b16 a[68:69], v199 offset:45056
  v_mfma_f32_16x16x32_bf16 v[104:107], a[52:55], a[24:27], v[104:107]
  buffer_load_dwordx4 v205, s[36:39], s62 offen offset:0 sc1 lds
  v_mfma_f32_16x16x32_bf16 v[100:103], a[52:55], a[20:23], v[100:103]
  s_waitcnt vmcnt(13) lgkmcnt(3)
  s_barrier
  ds_read_b64_tr_b16 a[70:71], v199 offset:51200
  v_mfma_f32_16x16x32_bf16 v[20:23], a[56:59], a[0:3], v[20:23]
  ds_read_b64_tr_b16 a[40:41], v198 offset:43008
  v_mfma_f32_16x16x32_bf16 v[24:27], a[56:59], a[4:7], v[24:27]
  v_mfma_f32_16x16x32_bf16 v[28:31], a[56:59], a[8:11], v[28:31]
  buffer_load_dwordx4 v205, s[36:39], s62 offen offset:1024 sc1 lds
  s_add_u32 m0, s65, 63488
  v_mfma_f32_16x16x32_bf16 v[32:35], a[56:59], a[12:15], v[32:35]
  ds_read_b64_tr_b16 a[42:43], v198 offset:49152
  v_mfma_f32_16x16x32_bf16 v[116:119], a[56:59], a[16:19], v[116:119]
  ds_read_b64_tr_b16 a[44:45], v199 offset:43008
  v_mfma_f32_16x16x32_bf16 v[48:51], a[60:63], a[12:15], v[48:51]
  v_mfma_f32_16x16x32_bf16 v[44:47], a[60:63], a[8:11], v[44:47]
  buffer_load_dword v206, s[36:39], s62 offen sc1 lds
  s_mov_b32 s61, 1376256
  v_mfma_f32_16x16x32_bf16 v[40:43], a[60:63], a[4:7], v[40:43]
  s_add_u32 m0, s63, 64512
  ds_read_b64_tr_b16 a[46:47], v199 offset:49152
  v_mfma_f32_16x16x32_bf16 v[36:39], a[60:63], a[0:3], v[36:39]
  s_waitcnt lgkmcnt(4)
  ds_read_b64_tr_b16 a[48:49], v200 offset:1024
  v_mfma_f32_16x16x32_bf16 v[52:55], a[0:3], a[64:67], v[52:55]
  ds_read_b128 a[20:23], v209 offset:12288
  v_mfma_f32_16x16x32_bf16 v[56:59], a[4:7], a[64:67], v[56:59]
  buffer_load_dwordx4 v202, s[8:11], s61 offen offset:0 lds
  v_mfma_f32_16x16x32_bf16 v[60:63], a[8:11], a[64:67], v[60:63]
  ds_read_b64_tr_b16 a[50:51], v200 offset:7168
  v_mfma_f32_16x16x32_bf16 v[64:67], a[12:15], a[64:67], v[64:67]
  ds_read_b128 a[24:27], v209 offset:13312
  v_mfma_f32_16x16x32_bf16 v[120:123], a[16:19], a[64:67], v[120:123]
  ds_read_b64_tr_b16 a[52:53], v201 offset:1024
  v_mfma_f32_16x16x32_bf16 v[80:83], a[12:15], a[68:71], v[80:83]
  buffer_load_dwordx4 v203, s[8:11], s61 offen offset:1024 lds
  v_mfma_f32_16x16x32_bf16 v[76:79], a[8:11], a[68:71], v[76:79]
  ds_read_b128 a[28:31], v209 offset:14336
  v_mfma_f32_16x16x32_bf16 v[72:75], a[4:7], a[68:71], v[72:75]
  ds_read_b64_tr_b16 a[54:55], v201 offset:7168
  v_mfma_f32_16x16x32_bf16 v[68:71], a[0:3], a[68:71], v[68:71]
  s_waitcnt lgkmcnt(7)
  ds_read_b128 a[32:35], v209 offset:15360
  v_mfma_f32_16x16x32_bf16 v[84:87], a[40:43], a[0:3], v[84:87]
  buffer_load_dwordx4 v204, s[8:11], s61 offen offset:2048 lds
  s_mov_b32 s62, 14336
  v_mfma_f32_16x16x32_bf16 v[88:91], a[40:43], a[4:7], v[88:91]
  s_add_u32 m0, s64, 76800
  ds_read_b128 a[36:39], v212 offset:20480
  v_mfma_f32_16x16x32_bf16 v[92:95], a[40:43], a[8:11], v[92:95]
  ds_read_b64_tr_b16 a[56:57], v200 offset:2048
  v_mfma_f32_16x16x32_bf16 v[96:99], a[40:43], a[12:15], v[96:99]
  ds_read_b64_tr_b16 a[58:59], v200 offset:8192
  v_mfma_f32_16x16x32_bf16 v[112:115], a[44:47], a[12:15], v[112:115]
  buffer_load_dwordx4 v205, s[36:39], s62 offen offset:0 sc1 lds
  v_mfma_f32_16x16x32_bf16 v[108:111], a[44:47], a[8:11], v[108:111]
  ds_read_b64_tr_b16 a[60:61], v201 offset:2048
  v_mfma_f32_16x16x32_bf16 v[104:107], a[44:47], a[4:7], v[104:107]
  ds_read_b64_tr_b16 a[62:63], v201 offset:8192
  v_mfma_f32_16x16x32_bf16 v[100:103], a[44:47], a[0:3], v[100:103]
  s_waitcnt vmcnt(16) lgkmcnt(4)
  s_barrier
  v_mfma_f32_16x16x32_bf16 v[20:23], a[48:51], a[20:23], v[20:23]
  buffer_load_dwordx4 v205, s[36:39], s62 offen offset:1024 sc1 lds
  s_add_u32 m0, s65, 84992
  v_mfma_f32_16x16x32_bf16 v[24:27], a[48:51], a[24:27], v[24:27]
  ds_read_b64_tr_b16 a[64:65], v200 offset:0
  v_mfma_f32_16x16x32_bf16 v[28:31], a[48:51], a[28:31], v[28:31]
  ds_read_b64_tr_b16 a[66:67], v200 offset:6144
  v_mfma_f32_16x16x32_bf16 v[32:35], a[48:51], a[32:35], v[32:35]
  v_mfma_f32_16x16x32_bf16 v[116:119], a[48:51], a[36:39], v[116:119]
  buffer_load_dword v206, s[36:39], s62 offen sc1 lds
  s_mov_b32 s61, 1572864
  v_mfma_f32_16x16x32_bf16 v[48:51], a[52:55], a[32:35], v[48:51]
  s_add_u32 m0, s63, 86016
  ds_read_b64_tr_b16 a[68:69], v201 offset:0
  v_mfma_f32_16x16x32_bf16 v[44:47], a[52:55], a[28:31], v[44:47]
  ds_read_b64_tr_b16 a[70:71], v201 offset:6144
  v_mfma_f32_16x16x32_bf16 v[40:43], a[52:55], a[24:27], v[40:43]
  v_mfma_f32_16x16x32_bf16 v[36:39], a[52:55], a[20:23], v[36:39]
  s_waitcnt lgkmcnt(4)
  buffer_load_dwordx4 v202, s[8:11], s61 offen offset:0 lds
  v_mfma_f32_16x16x32_bf16 v[52:55], a[20:23], a[56:59], v[52:55]
  ds_read_b64_tr_b16 a[40:41], v196 offset:1024
  v_mfma_f32_16x16x32_bf16 v[56:59], a[24:27], a[56:59], v[56:59]
  ds_read_b128 a[0:3], v207 offset:12288
  v_mfma_f32_16x16x32_bf16 v[60:63], a[28:31], a[56:59], v[60:63]
  ds_read_b64_tr_b16 a[42:43], v196 offset:7168
  v_mfma_f32_16x16x32_bf16 v[64:67], a[32:35], a[56:59], v[64:67]
  buffer_load_dwordx4 v203, s[8:11], s61 offen offset:1024 lds
  v_mfma_f32_16x16x32_bf16 v[120:123], a[36:39], a[56:59], v[120:123]
  ds_read_b128 a[4:7], v207 offset:13312
  v_mfma_f32_16x16x32_bf16 v[80:83], a[32:35], a[60:63], v[80:83]
  ds_read_b64_tr_b16 a[44:45], v197 offset:1024
  v_mfma_f32_16x16x32_bf16 v[76:79], a[28:31], a[60:63], v[76:79]
  ds_read_b128 a[8:11], v207 offset:14336
  v_mfma_f32_16x16x32_bf16 v[72:75], a[24:27], a[60:63], v[72:75]
  buffer_load_dwordx4 v204, s[8:11], s61 offen offset:2048 lds
  s_mov_b32 s62, 16384
  v_mfma_f32_16x16x32_bf16 v[68:71], a[20:23], a[60:63], v[68:71]
  s_waitcnt lgkmcnt(6)
  s_add_u32 m0, s64, 98304
  ds_read_b64_tr_b16 a[46:47], v197 offset:7168
  v_mfma_f32_16x16x32_bf16 v[84:87], a[64:67], a[20:23], v[84:87]
  ds_read_b128 a[12:15], v207 offset:15360
  v_mfma_f32_16x16x32_bf16 v[88:91], a[64:67], a[24:27], v[88:91]
  ds_read_b128 a[16:19], v210 offset:20480
  v_mfma_f32_16x16x32_bf16 v[92:95], a[64:67], a[28:31], v[92:95]
  buffer_load_dwordx4 v205, s[36:39], s62 offen offset:0 sc1 lds
  v_mfma_f32_16x16x32_bf16 v[96:99], a[64:67], a[32:35], v[96:99]
  ds_read_b64_tr_b16 a[48:49], v196 offset:2048
  v_mfma_f32_16x16x32_bf16 v[112:115], a[68:71], a[32:35], v[112:115]
  s_lshr_b32 s49, s2, 3
  ds_read_b64_tr_b16 a[50:51], v196 offset:8192
  s_and_b32 s54, s49, 7
  v_mfma_f32_16x16x32_bf16 v[108:111], a[68:71], a[28:31], v[108:111]
  s_and_b32 s48, s2, 1
  ds_read_b64_tr_b16 a[52:53], v197 offset:2048
  s_lshl1_add_u32 s53, s54, s48
  v_mfma_f32_16x16x32_bf16 v[104:107], a[68:71], a[24:27], v[104:107]
  buffer_load_dwordx4 v205, s[36:39], s62 offen offset:1024 sc1 lds
  s_add_u32 m0, s65, 106496
  v_mfma_f32_16x16x32_bf16 v[100:103], a[68:71], a[20:23], v[100:103]
  s_waitcnt vmcnt(17) lgkmcnt(3)
  s_barrier
  ds_read_b64_tr_b16 a[54:55], v197 offset:8192
  v_mfma_f32_16x16x32_bf16 v[20:23], a[40:43], a[0:3], v[20:23]
  ds_read_b64_tr_b16 a[56:57], v196 offset:0
  v_mfma_f32_16x16x32_bf16 v[24:27], a[40:43], a[4:7], v[24:27]
  v_mfma_f32_16x16x32_bf16 v[28:31], a[40:43], a[8:11], v[28:31]
  s_bfe_u32 s52, s2, 0x20001
  buffer_load_dword v206, s[36:39], s62 offen sc1 lds
  s_mov_b32 s61, 1769472
  v_mfma_f32_16x16x32_bf16 v[32:35], a[40:43], a[12:15], v[32:35]
  s_add_u32 m0, s63, 107520
  ds_read_b64_tr_b16 a[58:59], v196 offset:6144
  s_lshr_b32 s49, s2, 6
  v_mfma_f32_16x16x32_bf16 v[116:119], a[40:43], a[16:19], v[116:119]
  s_lshl2_add_u32 s52, s52, s49
  ds_read_b64_tr_b16 a[60:61], v197 offset:0
  s_lshl_b32 s70, s44, 12
  v_mfma_f32_16x16x32_bf16 v[48:51], a[44:47], a[12:15], v[48:51]
  v_mfma_f32_16x16x32_bf16 v[44:47], a[44:47], a[8:11], v[44:47]
  buffer_load_dwordx4 v202, s[8:11], s61 offen offset:0 lds
  v_mfma_f32_16x16x32_bf16 v[40:43], a[44:47], a[4:7], v[40:43]
  ds_read_b64_tr_b16 a[62:63], v197 offset:6144
  v_mfma_f32_16x16x32_bf16 v[36:39], a[44:47], a[0:3], v[36:39]
  s_waitcnt lgkmcnt(4)
  ds_read_b64_tr_b16 a[64:65], v196 offset:22528
  s_lshl_b32 s48, s53, 7
  v_mfma_f32_16x16x32_bf16 v[52:55], a[0:3], a[48:51], v[52:55]
  s_lshl_b32 s49, s44, 16
  ds_read_b128 a[20:23], v207 offset:33792
  s_add_u32 s48, s48, s49
  v_mfma_f32_16x16x32_bf16 v[56:59], a[4:7], a[48:51], v[56:59]
  buffer_load_dwordx4 v203, s[8:11], s61 offen offset:1024 lds
  v_lshrrev_b32 v12, 3, v10
  v_mfma_f32_16x16x32_bf16 v[60:63], a[8:11], a[48:51], v[60:63]
  ds_read_b64_tr_b16 a[66:67], v196 offset:28672
  v_lshlrev_b32 v12, 11, v12
  v_mfma_f32_16x16x32_bf16 v[64:67], a[12:15], a[48:51], v[64:67]
  ds_read_b128 a[24:27], v207 offset:34816
  v_add3_u32 v216, v12, v213, s48
  v_mfma_f32_16x16x32_bf16 v[120:123], a[16:19], a[48:51], v[120:123]
  ds_read_b64_tr_b16 a[68:69], v197 offset:22528
  v_mfma_f32_16x16x32_bf16 v[80:83], a[12:15], a[52:55], v[80:83]
  buffer_load_dwordx4 v204, s[8:11], s61 offen offset:2048 lds
  s_mov_b32 s62, 18432
  v_mfma_f32_16x16x32_bf16 v[76:79], a[8:11], a[52:55], v[76:79]
  s_add_u32 m0, s64, 119808
  ds_read_b128 a[28:31], v207 offset:35840
  v_mfma_f32_16x16x32_bf16 v[72:75], a[4:7], a[52:55], v[72:75]
  ds_read_b64_tr_b16 a[70:71], v197 offset:28672
  v_mfma_f32_16x16x32_bf16 v[68:71], a[0:3], a[52:55], v[68:71]
  s_waitcnt lgkmcnt(7)
  ds_read_b128 a[32:35], v207 offset:36864
  v_mfma_f32_16x16x32_bf16 v[84:87], a[56:59], a[0:3], v[84:87]
  buffer_load_dwordx4 v205, s[36:39], s62 offen offset:0 sc1 lds
  v_add_u32 v217, 15360, v216
  v_mfma_f32_16x16x32_bf16 v[88:91], a[56:59], a[4:7], v[88:91]
  ds_read_b128 a[36:39], v210 offset:41984
  v_mfma_f32_16x16x32_bf16 v[92:95], a[56:59], a[8:11], v[92:95]
  ds_read_b64_tr_b16 a[40:41], v196 offset:23552
  v_add_u32 v218, 30720, v216
  v_mfma_f32_16x16x32_bf16 v[96:99], a[56:59], a[12:15], v[96:99]
  ds_read_b64_tr_b16 a[42:43], v196 offset:29696
  v_add_u32 v219, 46080, v216
  v_mfma_f32_16x16x32_bf16 v[112:115], a[60:63], a[12:15], v[112:115]
  buffer_load_dwordx4 v205, s[36:39], s62 offen offset:1024 sc1 lds
  s_add_u32 m0, s65, 128000
  v_mfma_f32_16x16x32_bf16 v[108:111], a[60:63], a[8:11], v[108:111]
  s_lshl_b32 s55, s52, 18
  ds_read_b64_tr_b16 a[44:45], v197 offset:23552
  s_add_u32 s55, s55, s48
  v_mfma_f32_16x16x32_bf16 v[104:107], a[60:63], a[4:7], v[104:107]
  ds_read_b64_tr_b16 a[46:47], v197 offset:29696
  v_mfma_f32_16x16x32_bf16 v[100:103], a[60:63], a[0:3], v[100:103]
  s_waitcnt vmcnt(17) lgkmcnt(4)
  s_barrier
  v_mfma_f32_16x16x32_bf16 v[20:23], a[64:67], a[20:23], v[20:23]
  buffer_load_dword v206, s[36:39], s62 offen sc1 lds
  s_mov_b32 s61, 1966080
  v_mfma_f32_16x16x32_bf16 v[24:27], a[64:67], a[24:27], v[24:27]
  s_add_u32 m0, s63, 129024
  ds_read_b64_tr_b16 a[48:49], v196 offset:21504
  v_and_b32 v13, 7, v10
  v_mfma_f32_16x16x32_bf16 v[28:31], a[64:67], a[28:31], v[28:31]
  ds_read_b64_tr_b16 a[50:51], v196 offset:27648
  v_lshrrev_b32 v14, 4, v10
  v_mfma_f32_16x16x32_bf16 v[32:35], a[64:67], a[32:35], v[32:35]
  v_xor_b32 v13, v13, v14
  v_lshl_add_u32 v220, v13, 4, v12
  v_mfma_f32_16x16x32_bf16 v[116:119], a[64:67], a[36:39], v[116:119]
  buffer_load_dwordx4 v202, s[8:11], s61 offen offset:0 lds
  v_xor_b32 v221, 64, v220
  v_mfma_f32_16x16x32_bf16 v[48:51], a[68:71], a[32:35], v[48:51]
  ds_read_b64_tr_b16 a[52:53], v197 offset:21504
  v_add_u32 v221, 15360, v221
  v_mfma_f32_16x16x32_bf16 v[44:47], a[68:71], a[28:31], v[44:47]
  ds_read_b64_tr_b16 a[54:55], v197 offset:27648
  v_mfma_f32_16x16x32_bf16 v[40:43], a[68:71], a[24:27], v[40:43]
  v_mfma_f32_16x16x32_bf16 v[36:39], a[68:71], a[20:23], v[36:39]
  s_waitcnt lgkmcnt(4)
  buffer_load_dwordx4 v203, s[8:11], s61 offen offset:1024 lds
  v_mfma_f32_16x16x32_bf16 v[52:55], a[20:23], a[40:43], v[52:55]
  s_lshl_b32 s48, s44, 10
  ds_read_b64_tr_b16 a[56:57], v196 offset:44032
  s_add_u32 s48, s48, 147456
  v_mfma_f32_16x16x32_bf16 v[56:59], a[24:27], a[40:43], v[56:59]
  ds_read_b128 a[0:3], v207 offset:55296
  v_add_u32 v247, s48, v0
  v_mfma_f32_16x16x32_bf16 v[60:63], a[28:31], a[40:43], v[60:63]
  ds_read_b64_tr_b16 a[58:59], v196 offset:50176
  v_lshl_add_u32 v245, v14, 4, s48
  v_mfma_f32_16x16x32_bf16 v[64:67], a[32:35], a[40:43], v[64:67]
  buffer_load_dwordx4 v204, s[8:11], s61 offen offset:2048 lds
  s_mov_b32 s62, 20480
  v_mfma_f32_16x16x32_bf16 v[120:123], a[36:39], a[40:43], v[120:123]
  s_add_u32 m0, s64, 141312
  ds_read_b128 a[4:7], v207 offset:56320
  v_and_b32 v12, 1, v10
  v_mfma_f32_16x16x32_bf16 v[80:83], a[32:35], a[44:47], v[80:83]
  ds_read_b64_tr_b16 a[60:61], v197 offset:44032
  v_lshlrev_b32 v12, 8, v12
  v_mfma_f32_16x16x32_bf16 v[76:79], a[28:31], a[44:47], v[76:79]
  ds_read_b128 a[8:11], v207 offset:57344
  v_sub_u32 v246, v245, v12
  v_mfma_f32_16x16x32_bf16 v[72:75], a[24:27], a[44:47], v[72:75]
  buffer_load_dwordx4 v205, s[36:39], s62 offen offset:0 sc1 lds
  v_mfma_f32_16x16x32_bf16 v[68:71], a[20:23], a[44:47], v[68:71]
  s_waitcnt lgkmcnt(6)
  ds_read_b64_tr_b16 a[62:63], v197 offset:50176
  v_mfma_f32_16x16x32_bf16 v[84:87], a[48:51], a[20:23], v[84:87]
  ds_read_b128 a[12:15], v207 offset:58368
  v_mfma_f32_16x16x32_bf16 v[88:91], a[48:51], a[24:27], v[88:91]
  ds_read_b128 a[16:19], v210 offset:63488
  v_mfma_f32_16x16x32_bf16 v[92:95], a[48:51], a[28:31], v[92:95]
  buffer_load_dwordx4 v205, s[36:39], s62 offen offset:1024 sc1 lds
  s_add_u32 m0, s65, 149504
  v_mfma_f32_16x16x32_bf16 v[96:99], a[48:51], a[32:35], v[96:99]
  s_lshl_b32 s48, s53, 7
  ds_read_b64_tr_b16 a[64:65], v196 offset:45056
  v_and_b32 v13, 0xf0, v0
  v_mfma_f32_16x16x32_bf16 v[112:115], a[52:55], a[32:35], v[112:115]
  ds_read_b64_tr_b16 a[66:67], v196 offset:51200
  v_lshl_add_u32 v13, v14, 12, v13
  v_mfma_f32_16x16x32_bf16 v[108:111], a[52:55], a[28:31], v[108:111]
  s_lshl1_add_u32 s48, s48, 8192
  ds_read_b64_tr_b16 a[68:69], v197 offset:45056
  v_add_u32 v249, s48, v13
  v_mfma_f32_16x16x32_bf16 v[104:107], a[52:55], a[24:27], v[104:107]
  buffer_load_dword v206, s[36:39], s62 offen sc1 lds
  s_mov_b32 s61, 2162688
  v_mfma_f32_16x16x32_bf16 v[100:103], a[52:55], a[20:23], v[100:103]
  s_waitcnt vmcnt(18) lgkmcnt(3)
  s_barrier
  s_add_u32 m0, s63, 0
  v_mfma_f32_16x16x32_bf16 v[20:23], a[56:59], a[0:3], v[20:23]
  ds_read_b64_tr_b16 a[70:71], v197 offset:51200
  v_mfma_f32_16x16x32_bf16 v[24:27], a[56:59], a[4:7], v[24:27]
  ds_read_b64_tr_b16 a[40:41], v196 offset:43008
  v_mfma_f32_16x16x32_bf16 v[28:31], a[56:59], a[8:11], v[28:31]
  buffer_load_dwordx4 v202, s[8:11], s61 offen offset:0 lds
  v_mfma_f32_16x16x32_bf16 v[32:35], a[56:59], a[12:15], v[32:35]
  ds_read_b64_tr_b16 a[42:43], v196 offset:49152
  v_lshrrev_b32 v12, 2, v10
  v_mfma_f32_16x16x32_bf16 v[116:119], a[56:59], a[16:19], v[116:119]
  ds_read_b64_tr_b16 a[44:45], v197 offset:43008
  v_lshl_add_u32 v232, v12, 7, v214
  v_mfma_f32_16x16x32_bf16 v[48:51], a[60:63], a[12:15], v[48:51]
  v_mfma_f32_16x16x32_bf16 v[44:47], a[60:63], a[8:11], v[44:47]
  buffer_load_dwordx4 v203, s[8:11], s61 offen offset:1024 lds
  v_xor_b32 v233, 32, v232
  v_mfma_f32_16x16x32_bf16 v[40:43], a[60:63], a[4:7], v[40:43]
  ds_read_b64_tr_b16 a[46:47], v197 offset:49152
  v_xor_b32 v234, 64, v232
  v_mfma_f32_16x16x32_bf16 v[36:39], a[60:63], a[0:3], v[36:39]
  s_waitcnt lgkmcnt(4)
  ds_read_b64_tr_b16 a[48:49], v198 offset:1024
  v_mfma_f32_16x16x32_bf16 v[52:55], a[0:3], a[64:67], v[52:55]
  ds_read_b128 a[20:23], v208 offset:12288
  v_xor_b32 v235, 96, v232
  v_mfma_f32_16x16x32_bf16 v[56:59], a[4:7], a[64:67], v[56:59]
  buffer_load_dwordx4 v204, s[8:11], s61 offen offset:2048 lds
  s_mov_b32 s62, 22528
  v_mfma_f32_16x16x32_bf16 v[60:63], a[8:11], a[64:67], v[60:63]
  s_add_u32 m0, s64, 12288
  ds_read_b64_tr_b16 a[50:51], v198 offset:7168
  v_xor_b32 v236, 65536, v232
  v_mfma_f32_16x16x32_bf16 v[64:67], a[12:15], a[64:67], v[64:67]
  ds_read_b128 a[24:27], v208 offset:13312
  v_xor_b32 v237, 65568, v232
  v_mfma_f32_16x16x32_bf16 v[120:123], a[16:19], a[64:67], v[120:123]
  ds_read_b64_tr_b16 a[52:53], v199 offset:1024
  v_mfma_f32_16x16x32_bf16 v[80:83], a[12:15], a[68:71], v[80:83]
  buffer_load_dwordx4 v205, s[36:39], s62 offen offset:0 sc1 lds
  v_xor_b32 v238, 65600, v232
  v_mfma_f32_16x16x32_bf16 v[76:79], a[8:11], a[68:71], v[76:79]
  ds_read_b128 a[28:31], v208 offset:14336
  v_xor_b32 v239, 65632, v232
  v_mfma_f32_16x16x32_bf16 v[72:75], a[4:7], a[68:71], v[72:75]
  ds_read_b64_tr_b16 a[54:55], v199 offset:7168
  v_mfma_f32_16x16x32_bf16 v[68:71], a[0:3], a[68:71], v[68:71]
  s_waitcnt lgkmcnt(7)
  ds_read_b128 a[32:35], v208 offset:15360
  s_add_u32 s48, s70, 131072
  v_mfma_f32_16x16x32_bf16 v[84:87], a[40:43], a[0:3], v[84:87]
  buffer_load_dwordx4 v205, s[36:39], s62 offen offset:1024 sc1 lds
  s_add_u32 m0, s65, 20480
  v_mfma_f32_16x16x32_bf16 v[88:91], a[40:43], a[4:7], v[88:91]
  ds_read_b128 a[36:39], v211 offset:20480
  v_and_b32 v12, 15, v10
  v_mfma_f32_16x16x32_bf16 v[92:95], a[40:43], a[8:11], v[92:95]
  ds_read_b64_tr_b16 a[56:57], v198 offset:2048
  v_lshrrev_b32 v14, 1, v12
  v_mfma_f32_16x16x32_bf16 v[96:99], a[40:43], a[12:15], v[96:99]
  ds_read_b64_tr_b16 a[58:59], v198 offset:8192
  v_lshrrev_b32 v13, 5, v10
  v_mfma_f32_16x16x32_bf16 v[112:115], a[44:47], a[12:15], v[112:115]
  buffer_load_dword v206, s[36:39], s62 offen sc1 lds
  s_mov_b32 s61, 2359296
  v_mfma_f32_16x16x32_bf16 v[108:111], a[44:47], a[8:11], v[108:111]
  s_add_u32 m0, s63, 21504
  ds_read_b64_tr_b16 a[60:61], v199 offset:2048
  v_xor_b32 v14, v14, v13
  v_mfma_f32_16x16x32_bf16 v[104:107], a[44:47], a[4:7], v[104:107]
  ds_read_b64_tr_b16 a[62:63], v199 offset:8192
  v_lshlrev_b32 v14, 4, v14
  v_mfma_f32_16x16x32_bf16 v[100:103], a[44:47], a[0:3], v[100:103]
  s_waitcnt vmcnt(18) lgkmcnt(4)
  s_barrier
  v_lshl_add_u32 v14, v12, 7, v14
  v_mfma_f32_16x16x32_bf16 v[20:23], a[48:51], a[20:23], v[20:23]
  buffer_load_dwordx4 v202, s[8:11], s61 offen offset:0 lds
  v_bfe_u32 v13, v10, 4, 1
  v_mfma_f32_16x16x32_bf16 v[24:27], a[48:51], a[24:27], v[24:27]
  ds_read_b64_tr_b16 a[64:65], v198 offset:0
  v_lshl_add_u32 v14, v13, 3, v14
  v_mfma_f32_16x16x32_bf16 v[28:31], a[48:51], a[28:31], v[28:31]
  ds_read_b64_tr_b16 a[66:67], v198 offset:6144
  v_add_u32 v240, s48, v14
  v_mfma_f32_16x16x32_bf16 v[32:35], a[48:51], a[32:35], v[32:35]
  v_xor_b32 v241, 32, v240
  v_xor_b32 v242, 64, v240
  v_mfma_f32_16x16x32_bf16 v[116:119], a[48:51], a[36:39], v[116:119]
  buffer_load_dwordx4 v203, s[8:11], s61 offen offset:1024 lds
  v_xor_b32 v243, 96, v240
  v_mfma_f32_16x16x32_bf16 v[48:51], a[52:55], a[32:35], v[48:51]
  ds_read_b64_tr_b16 a[68:69], v199 offset:0
  v_mfma_f32_16x16x32_bf16 v[44:47], a[52:55], a[28:31], v[44:47]
  ds_read_b64_tr_b16 a[70:71], v199 offset:6144
  v_mfma_f32_16x16x32_bf16 v[40:43], a[52:55], a[24:27], v[40:43]
  v_mfma_f32_16x16x32_bf16 v[36:39], a[52:55], a[20:23], v[36:39]
  s_waitcnt lgkmcnt(4)
  buffer_load_dwordx4 v204, s[8:11], s61 offen offset:2048 lds
  s_mov_b32 s62, 24576
  v_mfma_f32_16x16x32_bf16 v[52:55], a[20:23], a[56:59], v[52:55]
  s_add_u32 m0, s64, 33792
  ds_read_b64_tr_b16 a[40:41], v198 offset:22528
  v_mfma_f32_16x16x32_bf16 v[56:59], a[24:27], a[56:59], v[56:59]
  ds_read_b128 a[0:3], v208 offset:33792
  v_mfma_f32_16x16x32_bf16 v[60:63], a[28:31], a[56:59], v[60:63]
  ds_read_b64_tr_b16 a[42:43], v198 offset:28672
  v_mfma_f32_16x16x32_bf16 v[64:67], a[32:35], a[56:59], v[64:67]
  s_lshl2_add_u32 s48, s52, s44
  buffer_load_dwordx4 v205, s[36:39], s62 offen offset:0 sc1 lds
  s_lshl_b32 s49, s48, 16
  v_mfma_f32_16x16x32_bf16 v[120:123], a[36:39], a[56:59], v[120:123]
  s_add_u32 s49, s49, 7340032
  ds_read_b128 a[4:7], v208 offset:34816
  v_add_u32 v244, s49, v0
  v_mfma_f32_16x16x32_bf16 v[80:83], a[32:35], a[60:63], v[80:83]
  ds_read_b64_tr_b16 a[44:45], v199 offset:22528
  v_mfma_f32_16x16x32_bf16 v[76:79], a[28:31], a[60:63], v[76:79]
  ds_read_b128 a[8:11], v208 offset:35840
  v_mfma_f32_16x16x32_bf16 v[72:75], a[24:27], a[60:63], v[72:75]
  buffer_load_dwordx4 v205, s[36:39], s62 offen offset:1024 sc1 lds
  s_add_u32 m0, s65, 41984
  v_mfma_f32_16x16x32_bf16 v[68:71], a[20:23], a[60:63], v[68:71]
  s_waitcnt lgkmcnt(6)
  ds_read_b64_tr_b16 a[46:47], v199 offset:28672
  v_mfma_f32_16x16x32_bf16 v[84:87], a[64:67], a[20:23], v[84:87]
  s_lshl4_add_u32 s74, s48, s53
  ds_read_b128 a[12:15], v208 offset:36864
  s_lshl_b32 s74, s74, 8
  v_mfma_f32_16x16x32_bf16 v[88:91], a[64:67], a[24:27], v[88:91]
  s_add_u32 s74, s74, 262144
  ds_read_b128 a[16:19], v211 offset:41984
  v_mfma_f32_16x16x32_bf16 v[92:95], a[64:67], a[28:31], v[92:95]
  buffer_load_dword v206, s[36:39], s62 offen sc1 lds
  s_mov_b32 s61, 2555904
  v_mfma_f32_16x16x32_bf16 v[96:99], a[64:67], a[32:35], v[96:99]
  s_add_u32 m0, s63, 43008
  ds_read_b64_tr_b16 a[48:49], v198 offset:23552
  v_mfma_f32_16x16x32_bf16 v[112:115], a[68:71], a[32:35], v[112:115]
Ha1:
  s_cbranch_execz Ha1_1
  ds_read_b64_tr_b16 a[50:51], v198 offset:29696
  v_mfma_f32_16x16x32_bf16 v[108:111], a[68:71], a[28:31], v[108:111]
  s_lshr_b32 s73, s48, 1
  ds_read_b64_tr_b16 a[52:53], v199 offset:23552
  s_lshl4_add_u32 s73, s73, s53
  v_mfma_f32_16x16x32_bf16 v[104:107], a[68:71], a[24:27], v[104:107]
  s_and_b32 s49, s48, 1
  buffer_load_dwordx4 v202, s[8:11], s61 offen offset:0 lds
  s_lshl2_add_u32 s73, s73, s49
  v_mfma_f32_16x16x32_bf16 v[100:103], a[68:71], a[20:23], v[100:103]
  s_waitcnt vmcnt(19) lgkmcnt(3)
  s_barrier
  ds_read_b64_tr_b16 a[54:55], v199 offset:29696
  v_mfma_f32_16x16x32_bf16 v[20:23], a[40:43], a[0:3], v[20:23]
  s_lshl_b32 s73, s73, 11
  ds_read_b64_tr_b16 a[56:57], v198 offset:21504
  s_add_u32 s73, s73, 36700160
  v_mfma_f32_16x16x32_bf16 v[24:27], a[40:43], a[4:7], v[24:27]
  v_mfma_f32_16x16x32_bf16 v[28:31], a[40:43], a[8:11], v[28:31]
  buffer_load_dwordx4 v203, s[8:11], s61 offen offset:1024 lds
  v_mfma_f32_16x16x32_bf16 v[32:35], a[40:43], a[12:15], v[32:35]
  ds_read_b64_tr_b16 a[58:59], v198 offset:27648
  v_mfma_f32_16x16x32_bf16 v[116:119], a[40:43], a[16:19], v[116:119]
  ds_read_b64_tr_b16 a[60:61], v199 offset:21504
  v_mfma_f32_16x16x32_bf16 v[48:51], a[44:47], a[12:15], v[48:51]
  v_mfma_f32_16x16x32_bf16 v[44:47], a[44:47], a[8:11], v[44:47]
  buffer_load_dwordx4 v204, s[8:11], s61 offen offset:2048 lds
  s_mov_b32 s62, 26624
  v_mfma_f32_16x16x32_bf16 v[40:43], a[44:47], a[4:7], v[40:43]
  s_add_u32 m0, s64, 55296
  ds_read_b64_tr_b16 a[62:63], v199 offset:27648
  s_lshl1_add_u32 s75, s48, s53
  v_mfma_f32_16x16x32_bf16 v[36:39], a[44:47], a[0:3], v[36:39]
  s_waitcnt lgkmcnt(4)
  ds_read_b64_tr_b16 a[64:65], v198 offset:44032
  s_lshl_b32 s75, s75, 11
  v_mfma_f32_16x16x32_bf16 v[52:55], a[0:3], a[48:51], v[52:55]
  s_add_u32 s75, s75, 5767168
  ds_read_b128 a[20:23], v208 offset:55296
  s_and_b32 s48, s48, 7
  v_mfma_f32_16x16x32_bf16 v[56:59], a[4:7], a[48:51], v[56:59]
  s_cselect_b32 s75, 1073741824, s75
  buffer_load_dwordx4 v205, s[36:39], s62 offen offset:0 sc1 lds
  v_mfma_f32_16x16x32_bf16 v[60:63], a[8:11], a[48:51], v[60:63]
  ds_read_b64_tr_b16 a[66:67], v198 offset:50176
  v_mfma_f32_16x16x32_bf16 v[64:67], a[12:15], a[48:51], v[64:67]
  ds_read_b128 a[24:27], v208 offset:56320
  v_mfma_f32_16x16x32_bf16 v[120:123], a[16:19], a[48:51], v[120:123]
  ds_read_b64_tr_b16 a[68:69], v199 offset:44032
  v_mfma_f32_16x16x32_bf16 v[80:83], a[12:15], a[52:55], v[80:83]
  buffer_load_dwordx4 v205, s[36:39], s62 offen offset:1024 sc1 lds
  s_add_u32 m0, s65, 63488
  v_mfma_f32_16x16x32_bf16 v[76:79], a[8:11], a[52:55], v[76:79]
  s_and_b32 s48, s52, 7
  ds_read_b128 a[28:31], v208 offset:57344
  s_lshl_b32 s48, s48, 5
  v_mfma_f32_16x16x32_bf16 v[72:75], a[4:7], a[52:55], v[72:75]
  s_lshr_b32 s49, s52, 3
  ds_read_b64_tr_b16 a[70:71], v199 offset:50176
  s_lshl2_add_u32 s48, s49, s48
  v_mfma_f32_16x16x32_bf16 v[68:71], a[0:3], a[52:55], v[68:71]
  s_waitcnt lgkmcnt(7)
  ds_read_b128 a[32:35], v208 offset:58368
  v_mfma_f32_16x16x32_bf16 v[84:87], a[56:59], a[0:3], v[84:87]
  buffer_load_dword v206, s[36:39], s62 offen sc1 lds
  s_mov_b32 s61, 2752512
  v_mfma_f32_16x16x32_bf16 v[88:91], a[56:59], a[4:7], v[88:91]
  s_add_u32 m0, s63, 64512
  ds_read_b128 a[36:39], v211 offset:63488
  v_mfma_f32_16x16x32_bf16 v[92:95], a[56:59], a[8:11], v[92:95]
  ds_read_b64_tr_b16 a[40:41], v198 offset:45056
  v_mfma_f32_16x16x32_bf16 v[96:99], a[56:59], a[12:15], v[96:99]
  ds_read_b64_tr_b16 a[42:43], v198 offset:51200
  v_and_b32 v12, 3, v10
  v_mfma_f32_16x16x32_bf16 v[112:115], a[60:63], a[12:15], v[112:115]
  buffer_load_dwordx4 v202, s[8:11], s61 offen offset:0 lds
  v_bfe_u32 v13, v10, 2, 2
  v_mfma_f32_16x16x32_bf16 v[108:111], a[60:63], a[8:11], v[108:111]
  ds_read_b64_tr_b16 a[44:45], v199 offset:45056
  v_lshl_add_u32 v12, v12, 3, v13
  v_mfma_f32_16x16x32_bf16 v[104:107], a[60:63], a[4:7], v[104:107]
  ds_read_b64_tr_b16 a[46:47], v199 offset:51200
  v_add_lshl_u32 v250, v12, s48, 7
  v_mfma_f32_16x16x32_bf16 v[100:103], a[60:63], a[0:3], v[100:103]
  s_waitcnt vmcnt(19) lgkmcnt(4)
  s_barrier
  v_mfma_f32_16x16x32_bf16 v[20:23], a[64:67], a[20:23], v[20:23]
  buffer_load_dwordx4 v203, s[8:11], s61 offen offset:1024 lds
  v_mfma_f32_16x16x32_bf16 v[24:27], a[64:67], a[24:27], v[24:27]
  ds_read_b64_tr_b16 a[48:49], v198 offset:43008
  v_add_u32 v250, 32768, v250
  v_mfma_f32_16x16x32_bf16 v[28:31], a[64:67], a[28:31], v[28:31]
  ds_read_b64_tr_b16 a[50:51], v198 offset:49152
  v_and_b32 v12, 7, v10
  v_mfma_f32_16x16x32_bf16 v[32:35], a[64:67], a[32:35], v[32:35]
  v_and_b32 v13, 8, v10
  v_lshl_add_u32 v12, v13, 4, v12
  v_mfma_f32_16x16x32_bf16 v[116:119], a[64:67], a[36:39], v[116:119]
  s_lshl_b32 s48, s53, 3
  buffer_load_dwordx4 v204, s[8:11], s61 offen offset:2048 lds
  s_mov_b32 s62, 28672
  v_mfma_f32_16x16x32_bf16 v[48:51], a[68:71], a[32:35], v[48:51]
  s_add_u32 m0, s64, 76800
  ds_read_b64_tr_b16 a[52:53], v199 offset:43008
  v_add_lshl_u32 v12, v12, s48, 7
  v_mfma_f32_16x16x32_bf16 v[44:47], a[68:71], a[28:31], v[44:47]
  ds_read_b64_tr_b16 a[54:55], v199 offset:49152
  v_cmp_gt_u32 vcc, 16, v10
  v_mfma_f32_16x16x32_bf16 v[40:43], a[68:71], a[24:27], v[40:43]
  s_nop 1
  v_cndmask_b32 v250, v12, v250, vcc
  v_mfma_f32_16x16x32_bf16 v[36:39], a[68:71], a[20:23], v[36:39]
  s_waitcnt lgkmcnt(4)
  buffer_load_dwordx4 v205, s[36:39], s62 offen offset:0 sc1 lds
  v_mfma_f32_16x16x32_bf16 v[52:55], a[20:23], a[40:43], v[52:55]
  ds_read_b64_tr_b16 a[56:57], v200 offset:1024
  v_mfma_f32_16x16x32_bf16 v[56:59], a[24:27], a[40:43], v[56:59]
  ds_read_b128 a[0:3], v209 offset:12288
  v_mfma_f32_16x16x32_bf16 v[60:63], a[28:31], a[40:43], v[60:63]
  ds_read_b64_tr_b16 a[58:59], v200 offset:7168
  v_mfma_f32_16x16x32_bf16 v[64:67], a[32:35], a[40:43], v[64:67]
  buffer_load_dwordx4 v205, s[36:39], s62 offen offset:1024 sc1 lds
  s_add_u32 m0, s65, 84992
  v_mfma_f32_16x16x32_bf16 v[120:123], a[36:39], a[40:43], v[120:123]
  ds_read_b128 a[4:7], v209 offset:13312
  v_mfma_f32_16x16x32_bf16 v[80:83], a[32:35], a[44:47], v[80:83]
  ds_read_b64_tr_b16 a[60:61], v201 offset:1024
  v_mfma_f32_16x16x32_bf16 v[76:79], a[28:31], a[44:47], v[76:79]
  ds_read_b128 a[8:11], v209 offset:14336
  v_mfma_f32_16x16x32_bf16 v[72:75], a[24:27], a[44:47], v[72:75]
  s_lshl_b32 s48, s59, 3
  buffer_load_dword v206, s[36:39], s62 offen sc1 lds
  s_mov_b32 s61, 2949120
  v_mfma_f32_16x16x32_bf16 v[68:71], a[20:23], a[44:47], v[68:71]
  s_waitcnt lgkmcnt(6)
  s_add_u32 m0, s63, 86016
  ds_read_b64_tr_b16 a[62:63], v201 offset:7168
  v_mfma_f32_16x16x32_bf16 v[84:87], a[48:51], a[20:23], v[84:87]
  s_add_u32 s48, s48, 150528
  ds_read_b128 a[12:15], v209 offset:15360
  v_add_u32 v12, s48, v0
  v_mfma_f32_16x16x32_bf16 v[88:91], a[48:51], a[24:27], v[88:91]
  ds_read_b128 a[16:19], v212 offset:20480
  v_add_u32 v222, s64, v12
  v_mfma_f32_16x16x32_bf16 v[92:95], a[48:51], a[28:31], v[92:95]
  buffer_load_dwordx4 v202, s[8:11], s61 offen offset:0 lds
  v_xor_b32 v223, 8, v222
  v_mfma_f32_16x16x32_bf16 v[96:99], a[48:51], a[32:35], v[96:99]
  ds_read_b64_tr_b16 a[64:65], v200 offset:2048
  v_mfma_f32_16x16x32_bf16 v[112:115], a[52:55], a[32:35], v[112:115]
  ds_read_b64_tr_b16 a[66:67], v200 offset:8192
  v_mfma_f32_16x16x32_bf16 v[108:111], a[52:55], a[28:31], v[108:111]
  ds_read_b64_tr_b16 a[68:69], v201 offset:2048
  v_mfma_f32_16x16x32_bf16 v[104:107], a[52:55], a[24:27], v[104:107]
  s_lshl_b32 s48, s60, 11
  buffer_load_dwordx4 v203, s[8:11], s61 offen offset:1024 lds
  s_add_u32 s48, s48, 8192
  v_mfma_f32_16x16x32_bf16 v[100:103], a[52:55], a[20:23], v[100:103]
  s_waitcnt vmcnt(20) lgkmcnt(3)
  s_barrier
  ds_read_b64_tr_b16 a[70:71], v201 offset:8192
  v_mfma_f32_16x16x32_bf16 v[20:23], a[56:59], a[0:3], v[20:23]
  ds_read_b64_tr_b16 a[40:41], v200 offset:0
  v_add_u32 v224, s48, v12
  v_mfma_f32_16x16x32_bf16 v[24:27], a[56:59], a[4:7], v[24:27]
  s_lshl_b32 s48, s59, 13
  v_subrev_u32 v225, s48, v224
  v_xor_b32 v226, 8, v225
  v_mfma_f32_16x16x32_bf16 v[28:31], a[56:59], a[8:11], v[28:31]
  buffer_load_dwordx4 v204, s[8:11], s61 offen offset:2048 lds
  s_mov_b32 s62, 30720
  v_mfma_f32_16x16x32_bf16 v[32:35], a[56:59], a[12:15], v[32:35]
  s_add_u32 m0, s64, 98304
  ds_read_b64_tr_b16 a[42:43], v200 offset:6144
  v_and_b32 v227, -9, v225
  v_mfma_f32_16x16x32_bf16 v[116:119], a[56:59], a[16:19], v[116:119]
  ds_read_b64_tr_b16 a[44:45], v201 offset:0
  v_mfma_f32_16x16x32_bf16 v[48:51], a[60:63], a[12:15], v[48:51]
  v_mfma_f32_16x16x32_bf16 v[44:47], a[60:63], a[8:11], v[44:47]
  buffer_load_dwordx4 v205, s[36:39], s62 offen offset:0 sc1 lds
  v_mfma_f32_16x16x32_bf16 v[40:43], a[60:63], a[4:7], v[40:43]
  ds_read_b64_tr_b16 a[46:47], v201 offset:6144
  v_mfma_f32_16x16x32_bf16 v[36:39], a[60:63], a[0:3], v[36:39]
  s_waitcnt lgkmcnt(4)
  ds_read_b64_tr_b16 a[48:49], v196 offset:1024
  v_mfma_f32_16x16x32_bf16 v[52:55], a[0:3], a[64:67], v[52:55]
  s_mov_b32 s76, 0xaaaaaaaa
  ds_read_b128 a[20:23], v207 offset:12288
  s_mov_b32 s77, 0xaaaaaaaa
  v_mfma_f32_16x16x32_bf16 v[56:59], a[4:7], a[64:67], v[56:59]
  s_mov_b32 s78, 0x000f0000
  buffer_load_dwordx4 v205, s[36:39], s62 offen offset:1024 sc1 lds
  s_add_u32 m0, s65, 106496
  v_mfma_f32_16x16x32_bf16 v[60:63], a[8:11], a[64:67], v[60:63]
  s_mov_b32 s79, 0x0fff00ff
  ds_read_b64_tr_b16 a[50:51], v196 offset:7168
  s_mov_b32 s80, 0x003f0003
  v_mfma_f32_16x16x32_bf16 v[64:67], a[12:15], a[64:67], v[64:67]
  s_mov_b32 s81, 0x3fff03ff
  ds_read_b128 a[24:27], v207 offset:13312
  v_mfma_f32_16x16x32_bf16 v[120:123], a[16:19], a[64:67], v[120:123]
  ds_read_b64_tr_b16 a[52:53], v197 offset:1024
  v_mfma_f32_16x16x32_bf16 v[80:83], a[12:15], a[68:71], v[80:83]
  buffer_load_dword v206, s[36:39], s62 offen sc1 lds
  s_mov_b32 s61, 3145728
  v_mfma_f32_16x16x32_bf16 v[76:79], a[8:11], a[68:71], v[76:79]
  s_add_u32 m0, s63, 107520
  ds_read_b128 a[28:31], v207 offset:14336
  v_mfma_f32_16x16x32_bf16 v[72:75], a[4:7], a[68:71], v[72:75]
  ds_read_b64_tr_b16 a[54:55], v197 offset:7168
  v_mfma_f32_16x16x32_bf16 v[68:71], a[0:3], a[68:71], v[68:71]
  s_waitcnt lgkmcnt(7)
  ds_read_b128 a[32:35], v207 offset:15360
  v_mfma_f32_16x16x32_bf16 v[84:87], a[40:43], a[0:3], v[84:87]
  buffer_load_dwordx4 v202, s[8:11], s61 offen offset:0 lds
  v_mfma_f32_16x16x32_bf16 v[88:91], a[40:43], a[4:7], v[88:91]
  ds_read_b128 a[36:39], v210 offset:20480
  v_mov_b32 v12, 0x0c0c0100
  v_mfma_f32_16x16x32_bf16 v[92:95], a[40:43], a[8:11], v[92:95]
  ds_read_b64_tr_b16 a[56:57], v196 offset:2048
  v_mov_b32 v13, 0x01000c0c
  v_mfma_f32_16x16x32_bf16 v[96:99], a[40:43], a[12:15], v[96:99]
  ds_read_b64_tr_b16 a[58:59], v196 offset:8192
  v_cndmask_b32 v12, v12, v13, s[76:77]
  v_mfma_f32_16x16x32_bf16 v[112:115], a[44:47], a[12:15], v[112:115]
  buffer_load_dwordx4 v203, s[8:11], s61 offen offset:1024 lds
  v_mov_b32 v14, 0x0c0c0c0c
  v_mfma_f32_16x16x32_bf16 v[108:111], a[44:47], a[8:11], v[108:111]
  ds_read_b64_tr_b16 a[60:61], v197 offset:2048
  v_cndmask_b32 v228, v14, v12, s[78:79]
  v_mfma_f32_16x16x32_bf16 v[104:107], a[44:47], a[4:7], v[104:107]
  ds_read_b64_tr_b16 a[62:63], v197 offset:8192
  v_cndmask_b32 v230, v12, v14, s[78:79]
  v_mfma_f32_16x16x32_bf16 v[100:103], a[44:47], a[0:3], v[100:103]
  s_waitcnt vmcnt(20) lgkmcnt(4)
  s_barrier
  v_mfma_f32_16x16x32_bf16 v[20:23], a[48:51], a[20:23], v[20:23]
  buffer_load_dwordx4 v204, s[8:11], s61 offen offset:2048 lds
  s_mov_b32 s62, 32768
  v_mfma_f32_16x16x32_bf16 v[24:27], a[48:51], a[24:27], v[24:27]
  s_add_u32 m0, s64, 119808
  ds_read_b64_tr_b16 a[64:65], v196 offset:0
  v_mfma_f32_16x16x32_bf16 v[28:31], a[48:51], a[28:31], v[28:31]
  ds_read_b64_tr_b16 a[66:67], v196 offset:6144
  v_mov_b32 v12, 0x0c0c0302
  v_mfma_f32_16x16x32_bf16 v[32:35], a[48:51], a[32:35], v[32:35]
  v_mov_b32 v13, 0x03020c0c
  v_cndmask_b32 v12, v12, v13, s[76:77]
  v_mfma_f32_16x16x32_bf16 v[116:119], a[48:51], a[36:39], v[116:119]
  buffer_load_dwordx4 v205, s[36:39], s62 offen offset:0 sc1 lds
  v_cndmask_b32 v229, v14, v12, s[80:81]
  v_mfma_f32_16x16x32_bf16 v[48:51], a[52:55], a[32:35], v[48:51]
  ds_read_b64_tr_b16 a[68:69], v197 offset:0
  v_cndmask_b32 v231, v12, v14, s[80:81]
  v_mfma_f32_16x16x32_bf16 v[44:47], a[52:55], a[28:31], v[44:47]
  ds_read_b64_tr_b16 a[70:71], v197 offset:6144
  v_mfma_f32_16x16x32_bf16 v[40:43], a[52:55], a[24:27], v[40:43]
  v_mfma_f32_16x16x32_bf16 v[36:39], a[52:55], a[20:23], v[36:39]
  s_waitcnt lgkmcnt(4)
  buffer_load_dwordx4 v205, s[36:39], s62 offen offset:1024 sc1 lds
  s_add_u32 m0, s65, 128000
  v_mfma_f32_16x16x32_bf16 v[52:55], a[20:23], a[56:59], v[52:55]
  ds_read_b64_tr_b16 a[40:41], v196 offset:22528
  v_mfma_f32_16x16x32_bf16 v[56:59], a[24:27], a[56:59], v[56:59]
  s_lshl1_add_u32 s48, s57, s59
  ds_read_b128 a[0:3], v207 offset:33792
  s_lshl_b32 s71, s48, 17
  v_mfma_f32_16x16x32_bf16 v[60:63], a[28:31], a[56:59], v[60:63]
  s_lshl1_add_u32 s48, s58, s60
  ds_read_b64_tr_b16 a[42:43], v196 offset:28672
  s_lshl_b32 s48, s48, 11
  v_mfma_f32_16x16x32_bf16 v[64:67], a[32:35], a[56:59], v[64:67]
  buffer_load_dword v206, s[36:39], s62 offen sc1 lds
  s_mov_b32 s61, 3342336
  v_mfma_f32_16x16x32_bf16 v[120:123], a[36:39], a[56:59], v[120:123]
  s_add_u32 m0, s63, 129024
  ds_read_b128 a[4:7], v207 offset:34816
  v_mfma_f32_16x16x32_bf16 v[80:83], a[32:35], a[60:63], v[80:83]
  ds_read_b64_tr_b16 a[44:45], v197 offset:22528
  v_mfma_f32_16x16x32_bf16 v[76:79], a[28:31], a[60:63], v[76:79]
  ds_read_b128 a[8:11], v207 offset:35840
  v_mfma_f32_16x16x32_bf16 v[72:75], a[24:27], a[60:63], v[72:75]
  buffer_load_dwordx4 v202, s[8:11], s61 offen offset:0 lds
  v_mfma_f32_16x16x32_bf16 v[68:71], a[20:23], a[60:63], v[68:71]
  s_waitcnt lgkmcnt(6)
  ds_read_b64_tr_b16 a[46:47], v197 offset:28672
  s_add_u32 s71, s71, s48
  v_mfma_f32_16x16x32_bf16 v[84:87], a[64:67], a[20:23], v[84:87]
  s_add_u32 s71, s71, 7340032
  ds_read_b128 a[12:15], v207 offset:36864
  s_add_u32 s72, s71, 65536
  v_mfma_f32_16x16x32_bf16 v[88:91], a[64:67], a[24:27], v[88:91]
  s_or_b32 s57, s57, s59
  ds_read_b128 a[16:19], v210 offset:41984
  v_mfma_f32_16x16x32_bf16 v[92:95], a[64:67], a[28:31], v[92:95]
  buffer_load_dwordx4 v203, s[8:11], s61 offen offset:1024 lds
  v_mfma_f32_16x16x32_bf16 v[96:99], a[64:67], a[32:35], v[96:99]
  ds_read_b64_tr_b16 a[48:49], v196 offset:23552
  v_mfma_f32_16x16x32_bf16 v[112:115], a[68:71], a[32:35], v[112:115]
  ds_read_b64_tr_b16 a[50:51], v196 offset:29696
  v_mfma_f32_16x16x32_bf16 v[108:111], a[68:71], a[28:31], v[108:111]
  s_lshl_b32 s45, s2, 7
  ds_read_b64_tr_b16 a[52:53], v197 offset:23552
  s_add_u32 s45, s45, 5275648
  v_mfma_f32_16x16x32_bf16 v[104:107], a[68:71], a[24:27], v[104:107]
  s_cmp_eq_u32 s44, 0
  buffer_load_dwordx4 v204, s[8:11], s61 offen offset:2048 lds
  s_mov_b32 s62, 34816
  v_mfma_f32_16x16x32_bf16 v[100:103], a[68:71], a[20:23], v[100:103]
  s_waitcnt vmcnt(21) lgkmcnt(3)
  s_barrier
  ds_read_b64_tr_b16 a[54:55], v197 offset:29696
  v_mfma_f32_16x16x32_bf16 v[20:23], a[40:43], a[0:3], v[20:23]
  s_cselect_b32 s45, s45, 1073741824
  s_add_u32 m0, s64, 141312
  ds_read_b64_tr_b16 a[56:57], v196 offset:21504
  v_mfma_f32_16x16x32_bf16 v[24:27], a[40:43], a[4:7], v[24:27]
  v_mfma_f32_16x16x32_bf16 v[28:31], a[40:43], a[8:11], v[28:31]
  buffer_load_dwordx4 v205, s[36:39], s62 offen offset:0 sc1 lds
  v_mfma_f32_16x16x32_bf16 v[32:35], a[40:43], a[12:15], v[32:35]
  s_lshr_b32 s49, s2, 3
  ds_read_b64_tr_b16 a[58:59], v196 offset:27648
  s_and_b32 s60, s49, 3
  v_mfma_f32_16x16x32_bf16 v[116:119], a[40:43], a[16:19], v[116:119]
  s_lshr_b32 s58, s49, 2
  ds_read_b64_tr_b16 a[60:61], v197 offset:21504
  s_lshl1_add_u32 s49, s60, s58
  v_mfma_f32_16x16x32_bf16 v[48:51], a[44:47], a[12:15], v[48:51]
  s_and_b32 s49, s49, 7
  s_and_b32 s48, s2, 7
  s_lshl2_add_u32 s60, s48, s60
  v_mfma_f32_16x16x32_bf16 v[44:47], a[44:47], a[8:11], v[44:47]
  buffer_load_dwordx4 v205, s[36:39], s62 offen offset:1024 sc1 lds
  s_add_u32 m0, s65, 149504
  v_mfma_f32_16x16x32_bf16 v[40:43], a[44:47], a[4:7], v[40:43]
  ds_read_b64_tr_b16 a[62:63], v197 offset:27648
  v_mfma_f32_16x16x32_bf16 v[36:39], a[44:47], a[0:3], v[36:39]
  s_waitcnt lgkmcnt(4)
  ds_read_b64_tr_b16 a[64:65], v196 offset:44032
  v_mfma_f32_16x16x32_bf16 v[52:55], a[0:3], a[48:51], v[52:55]
  ds_read_b128 a[20:23], v207 offset:55296
  v_mfma_f32_16x16x32_bf16 v[56:59], a[4:7], a[48:51], v[56:59]
  buffer_load_dword v206, s[36:39], s62 offen sc1 lds
  s_mov_b32 s61, 3538944
  v_mfma_f32_16x16x32_bf16 v[60:63], a[8:11], a[48:51], v[60:63]
  s_add_u32 m0, s63, 0
  ds_read_b64_tr_b16 a[66:67], v196 offset:50176
  v_mfma_f32_16x16x32_bf16 v[64:67], a[12:15], a[48:51], v[64:67]
  ds_read_b128 a[24:27], v207 offset:56320
  v_mfma_f32_16x16x32_bf16 v[120:123], a[16:19], a[48:51], v[120:123]
  ds_read_b64_tr_b16 a[68:69], v197 offset:44032
  v_mfma_f32_16x16x32_bf16 v[80:83], a[12:15], a[52:55], v[80:83]
  buffer_load_dwordx4 v202, s[8:11], s61 offen offset:0 lds
  v_mfma_f32_16x16x32_bf16 v[76:79], a[8:11], a[52:55], v[76:79]
  s_mov_b32 s82, 0xc0653421
  ds_read_b128 a[28:31], v207 offset:57344
  s_mov_b32 s83, 0xfedba987
  v_mfma_f32_16x16x32_bf16 v[72:75], a[4:7], a[52:55], v[72:75]
  ds_read_b64_tr_b16 a[70:71], v197 offset:50176
  v_mfma_f32_16x16x32_bf16 v[68:71], a[0:3], a[52:55], v[68:71]
  s_waitcnt lgkmcnt(7)
  ds_read_b128 a[32:35], v207 offset:58368
  v_mfma_f32_16x16x32_bf16 v[84:87], a[56:59], a[0:3], v[84:87]
  s_cmp_eq_u32 s49, 1
  buffer_load_dwordx4 v203, s[8:11], s61 offen offset:1024 lds
  s_cselect_b32 s82, 0xd1643520, s82
  v_mfma_f32_16x16x32_bf16 v[88:91], a[56:59], a[4:7], v[88:91]
  s_cselect_b32 s83, 0xfecba897, s83
  ds_read_b128 a[36:39], v210 offset:63488
  v_mfma_f32_16x16x32_bf16 v[92:95], a[56:59], a[8:11], v[92:95]
  ds_read_b64_tr_b16 a[40:41], v196 offset:45056
  v_mfma_f32_16x16x32_bf16 v[96:99], a[56:59], a[12:15], v[96:99]
  ds_read_b64_tr_b16 a[42:43], v196 offset:51200
  v_mfma_f32_16x16x32_bf16 v[112:115], a[60:63], a[12:15], v[112:115]
  buffer_load_dwordx4 v204, s[8:11], s61 offen offset:2048 lds
  s_mov_b32 s62, 36864
  v_mfma_f32_16x16x32_bf16 v[108:111], a[60:63], a[8:11], v[108:111]
  s_add_u32 m0, s64, 12288
  ds_read_b64_tr_b16 a[44:45], v197 offset:45056
  s_cmp_eq_u32 s49, 2
  v_mfma_f32_16x16x32_bf16 v[104:107], a[60:63], a[4:7], v[104:107]
  s_cselect_b32 s82, 0x72546310, s82
  ds_read_b64_tr_b16 a[46:47], v197 offset:51200
  s_cselect_b32 s83, 0xfdcb98ae, s83
  v_mfma_f32_16x16x32_bf16 v[100:103], a[60:63], a[0:3], v[100:103]
  s_waitcnt vmcnt(21) lgkmcnt(4)
  s_barrier
  v_mfma_f32_16x16x32_bf16 v[20:23], a[64:67], a[20:23], v[20:23]
  buffer_load_dwordx4 v205, s[36:39], s62 offen offset:0 sc1 lds
  v_mfma_f32_16x16x32_bf16 v[24:27], a[64:67], a[24:27], v[24:27]
  s_cmp_eq_u32 s49, 3
  ds_read_b64_tr_b16 a[48:49], v196 offset:43008
  s_cselect_b32 s82, 0x63547210, s82
  v_mfma_f32_16x16x32_bf16 v[28:31], a[64:67], a[28:31], v[28:31]
  s_cselect_b32 s83, 0xfedca9b8, s83
  ds_read_b64_tr_b16 a[50:51], v196 offset:49152
  v_mfma_f32_16x16x32_bf16 v[32:35], a[64:67], a[32:35], v[32:35]
  v_mfma_f32_16x16x32_bf16 v[116:119], a[64:67], a[36:39], v[116:119]
  buffer_load_dwordx4 v205, s[36:39], s62 offen offset:1024 sc1 lds
  s_add_u32 m0, s65, 20480
  v_mfma_f32_16x16x32_bf16 v[48:51], a[68:71], a[32:35], v[48:51]
  ds_read_b64_tr_b16 a[52:53], v197 offset:43008
  v_mfma_f32_16x16x32_bf16 v[44:47], a[68:71], a[28:31], v[44:47]
  s_cmp_eq_u32 s49, 4
  ds_read_b64_tr_b16 a[54:55], v197 offset:49152
  s_cselect_b32 s82, 0x64583210, s82
  v_mfma_f32_16x16x32_bf16 v[40:43], a[68:71], a[24:27], v[40:43]
  s_cselect_b32 s83, 0xfedba9c7, s83
  v_mfma_f32_16x16x32_bf16 v[36:39], a[68:71], a[20:23], v[36:39]
  s_waitcnt lgkmcnt(4)
  buffer_load_dword v206, s[36:39], s62 offen sc1 lds
  s_mov_b32 s61, 3735552
  v_mfma_f32_16x16x32_bf16 v[52:55], a[20:23], a[40:43], v[52:55]
  s_add_u32 m0, s63, 21504
  ds_read_b64_tr_b16 a[56:57], v198 offset:1024
  v_mfma_f32_16x16x32_bf16 v[56:59], a[24:27], a[40:43], v[56:59]
  ds_read_b128 a[0:3], v208 offset:12288
  v_mfma_f32_16x16x32_bf16 v[60:63], a[28:31], a[40:43], v[60:63]
  s_cmp_eq_u32 s49, 5
  ds_read_b64_tr_b16 a[58:59], v198 offset:7168
  s_cselect_b32 s82, 0x65493210, s82
  v_mfma_f32_16x16x32_bf16 v[64:67], a[32:35], a[40:43], v[64:67]
  s_cselect_b32 s83, 0xfecba8d7, s83
  buffer_load_dwordx4 v202, s[8:11], s61 offen offset:0 lds
  v_mfma_f32_16x16x32_bf16 v[120:123], a[36:39], a[40:43], v[120:123]
  ds_read_b128 a[4:7], v208 offset:13312
  v_mfma_f32_16x16x32_bf16 v[80:83], a[32:35], a[44:47], v[80:83]
  ds_read_b64_tr_b16 a[60:61], v199 offset:1024
  v_mfma_f32_16x16x32_bf16 v[76:79], a[28:31], a[44:47], v[76:79]
  ds_read_b128 a[8:11], v208 offset:14336
  v_mfma_f32_16x16x32_bf16 v[72:75], a[24:27], a[44:47], v[72:75]
  s_cmp_eq_u32 s49, 6
  buffer_load_dwordx4 v203, s[8:11], s61 offen offset:1024 lds
  s_cselect_b32 s82, 0x56a43210, s82
  v_mfma_f32_16x16x32_bf16 v[68:71], a[20:23], a[44:47], v[68:71]
  s_waitcnt lgkmcnt(6)
  ds_read_b64_tr_b16 a[62:63], v199 offset:7168
  s_cselect_b32 s83, 0xfdcb98e7, s83
  v_mfma_f32_16x16x32_bf16 v[84:87], a[48:51], a[20:23], v[84:87]
  ds_read_b128 a[12:15], v208 offset:15360
  v_mfma_f32_16x16x32_bf16 v[88:91], a[48:51], a[24:27], v[88:91]
  ds_read_b128 a[16:19], v211 offset:20480
  v_mfma_f32_16x16x32_bf16 v[92:95], a[48:51], a[28:31], v[92:95]
  buffer_load_dwordx4 v204, s[8:11], s61 offen offset:2048 lds
  s_mov_b32 s62, 38912
  v_mfma_f32_16x16x32_bf16 v[96:99], a[48:51], a[32:35], v[96:99]
  s_add_u32 m0, s64, 33792
  ds_read_b64_tr_b16 a[64:65], v198 offset:2048
  s_cmp_eq_u32 s49, 7
  v_mfma_f32_16x16x32_bf16 v[112:115], a[52:55], a[32:35], v[112:115]
  s_cselect_b32 s82, 0x57b43210, s82
  ds_read_b64_tr_b16 a[66:67], v198 offset:8192
  s_cselect_b32 s83, 0xedca98f6, s83
  v_mfma_f32_16x16x32_bf16 v[108:111], a[52:55], a[28:31], v[108:111]
  ds_read_b64_tr_b16 a[68:69], v199 offset:2048
  v_mfma_f32_16x16x32_bf16 v[104:107], a[52:55], a[24:27], v[104:107]
  buffer_load_dwordx4 v205, s[36:39], s62 offen offset:0 sc1 lds
  v_mfma_f32_16x16x32_bf16 v[100:103], a[52:55], a[20:23], v[100:103]
  s_waitcnt vmcnt(22) lgkmcnt(3)
  s_barrier
  ds_read_b64_tr_b16 a[70:71], v199 offset:8192
  v_mfma_f32_16x16x32_bf16 v[20:23], a[56:59], a[0:3], v[20:23]
  s_mul_i32 s84, s44, 7168
  ds_read_b64_tr_b16 a[40:41], v198 offset:0
  s_lshl2_add_u32 s85, s58, s44
  v_mfma_f32_16x16x32_bf16 v[24:27], a[56:59], a[4:7], v[24:27]
  s_lshl_b32 s85, s85, 17
  s_add_u32 s85, s85, 36700160
  v_mfma_f32_16x16x32_bf16 v[28:31], a[56:59], a[8:11], v[28:31]
  buffer_load_dwordx4 v205, s[36:39], s62 offen offset:1024 sc1 lds
  s_add_u32 m0, s65, 41984
  v_mfma_f32_16x16x32_bf16 v[32:35], a[56:59], a[12:15], v[32:35]
  ds_read_b64_tr_b16 a[42:43], v198 offset:6144
  v_mfma_f32_16x16x32_bf16 v[116:119], a[56:59], a[16:19], v[116:119]
  ds_read_b64_tr_b16 a[44:45], v199 offset:0
  v_mfma_f32_16x16x32_bf16 v[48:51], a[60:63], a[12:15], v[48:51]
  v_mfma_f32_16x16x32_bf16 v[44:47], a[60:63], a[8:11], v[44:47]
  s_cmp_ge_u32 s44, 2
  buffer_load_dword v206, s[36:39], s62 offen sc1 lds
  s_mov_b32 s61, 3932160
  v_mfma_f32_16x16x32_bf16 v[40:43], a[60:63], a[4:7], v[40:43]
  s_cselect_b64 s[16:17], s[20:21], s[16:17]
  s_add_u32 m0, s63, 43008
  ds_read_b64_tr_b16 a[46:47], v199 offset:6144
  v_mfma_f32_16x16x32_bf16 v[36:39], a[60:63], a[0:3], v[36:39]
  s_waitcnt lgkmcnt(4)
  ds_read_b64_tr_b16 a[48:49], v198 offset:22528
  v_mfma_f32_16x16x32_bf16 v[52:55], a[0:3], a[64:67], v[52:55]
  ds_read_b128 a[20:23], v208 offset:33792
  v_lshrrev_b32 v12, 2, v10
  v_mfma_f32_16x16x32_bf16 v[56:59], a[4:7], a[64:67], v[56:59]
  buffer_load_dwordx4 v202, s[8:11], s61 offen offset:0 lds
  v_mul_u32_u24 v12, 224, v12
  v_mfma_f32_16x16x32_bf16 v[60:63], a[8:11], a[64:67], v[60:63]
  ds_read_b64_tr_b16 a[50:51], v198 offset:28672
  v_and_b32 v13, 3, v10
  v_mfma_f32_16x16x32_bf16 v[64:67], a[12:15], a[64:67], v[64:67]
  ds_read_b128 a[24:27], v208 offset:34816
  v_lshl_add_u32 v1, v13, 3, v12
  v_mfma_f32_16x16x32_bf16 v[120:123], a[16:19], a[64:67], v[120:123]
  ds_read_b64_tr_b16 a[52:53], v199 offset:22528
  v_add_u32 v2, 57344, v1
  v_mfma_f32_16x16x32_bf16 v[80:83], a[12:15], a[68:71], v[80:83]
  buffer_load_dwordx4 v203, s[8:11], s61 offen offset:1024 lds
  v_mfma_f32_16x16x32_bf16 v[76:79], a[8:11], a[68:71], v[76:79]
  ds_read_b128 a[28:31], v208 offset:35840
  v_mfma_f32_16x16x32_bf16 v[72:75], a[4:7], a[68:71], v[72:75]
  ds_read_b64_tr_b16 a[54:55], v199 offset:28672
  v_mfma_f32_16x16x32_bf16 v[68:71], a[0:3], a[68:71], v[68:71]
  s_waitcnt lgkmcnt(7)
  ds_read_b128 a[32:35], v208 offset:36864
  s_mul_i32 s48, s60, 224
  v_mfma_f32_16x16x32_bf16 v[84:87], a[40:43], a[0:3], v[84:87]
  s_and_b32 s49, s44, 1
  buffer_load_dwordx4 v204, s[8:11], s61 offen offset:2048 lds
  s_mov_b32 s62, 40960
  v_mfma_f32_16x16x32_bf16 v[88:91], a[40:43], a[4:7], v[88:91]
  s_add_u32 m0, s64, 55296
  ds_read_b128 a[36:39], v211 offset:41984
  s_mul_i32 s49, s49, 229376
  v_mfma_f32_16x16x32_bf16 v[92:95], a[40:43], a[8:11], v[92:95]
  s_add_u32 s48, s48, s49
  ds_read_b64_tr_b16 a[56:57], v198 offset:23552
  s_and_b32 s49, s60, 1
  v_mfma_f32_16x16x32_bf16 v[96:99], a[40:43], a[12:15], v[96:99]
  s_lshl_b32 s49, s49, 1
  ds_read_b64_tr_b16 a[58:59], v198 offset:29696
  v_mfma_f32_16x16x32_bf16 v[112:115], a[44:47], a[12:15], v[112:115]
  buffer_load_dwordx4 v205, s[36:39], s62 offen offset:0 sc1 lds
  v_mfma_f32_16x16x32_bf16 v[108:111], a[44:47], a[8:11], v[108:111]
  ds_read_b64_tr_b16 a[60:61], v199 offset:23552
  v_mfma_f32_16x16x32_bf16 v[104:107], a[44:47], a[4:7], v[104:107]
  ds_read_b64_tr_b16 a[62:63], v199 offset:29696
  v_mfma_f32_16x16x32_bf16 v[100:103], a[44:47], a[0:3], v[100:103]
  s_waitcnt vmcnt(22) lgkmcnt(4)
  s_barrier
  v_mfma_f32_16x16x32_bf16 v[20:23], a[48:51], a[20:23], v[20:23]
  buffer_load_dwordx4 v205, s[36:39], s62 offen offset:1024 sc1 lds
  s_add_u32 m0, s65, 63488
  v_mfma_f32_16x16x32_bf16 v[24:27], a[48:51], a[24:27], v[24:27]
  ds_read_b64_tr_b16 a[64:65], v198 offset:21504
  v_add_u32 v12, 0, v10
  v_mfma_f32_16x16x32_bf16 v[28:31], a[48:51], a[28:31], v[28:31]
  ds_read_b64_tr_b16 a[66:67], v198 offset:27648
  v_mul_u32_u24 v13, 4682, v12
  v_mfma_f32_16x16x32_bf16 v[32:35], a[48:51], a[32:35], v[32:35]
  v_lshrrev_b32 v13, 16, v13
  v_mul_i32_i24 v14, -14, v13
  v_mfma_f32_16x16x32_bf16 v[116:119], a[48:51], a[36:39], v[116:119]
  buffer_load_dword v206, s[36:39], s62 offen sc1 lds
  s_mov_b32 s61, 4128768
  v_mfma_f32_16x16x32_bf16 v[48:51], a[52:55], a[32:35], v[48:51]
  s_add_u32 m0, s63, 64512
  ds_read_b64_tr_b16 a[68:69], v199 offset:21504
  v_add3_u32 v12, v12, v14, s49
  v_mfma_f32_16x16x32_bf16 v[44:47], a[52:55], a[28:31], v[44:47]
  ds_read_b64_tr_b16 a[70:71], v199 offset:27648
  v_mfma_f32_16x16x32_bf16 v[40:43], a[52:55], a[24:27], v[40:43]
  v_mfma_f32_16x16x32_bf16 v[36:39], a[52:55], a[20:23], v[36:39]
  s_waitcnt lgkmcnt(4)
  buffer_load_dwordx4 v202, s[8:11], s61 offen offset:0 lds
  v_mfma_f32_16x16x32_bf16 v[52:55], a[20:23], a[56:59], v[52:55]
Ha2:
  s_cbranch_execz Ha2_1
  ds_read_b64_tr_b16 a[40:41], v198 offset:44032
  v_add_u32 v14, -14, v12
  v_mfma_f32_16x16x32_bf16 v[56:59], a[24:27], a[56:59], v[56:59]
  ds_read_b128 a[0:3], v208 offset:55296
  v_min_u32 v12, v12, v14
  v_mfma_f32_16x16x32_bf16 v[60:63], a[28:31], a[56:59], v[60:63]
  ds_read_b64_tr_b16 a[42:43], v198 offset:50176
  v_mul_u32_u24 v13, 7168, v13
  v_mfma_f32_16x16x32_bf16 v[64:67], a[32:35], a[56:59], v[64:67]
  buffer_load_dwordx4 v203, s[8:11], s61 offen offset:1024 lds
  v_lshl_add_u32 v12, v12, 4, v13
  v_mfma_f32_16x16x32_bf16 v[120:123], a[36:39], a[56:59], v[120:123]
  ds_read_b128 a[4:7], v208 offset:56320
  v_add_u32 v3, s48, v12
  v_mfma_f32_16x16x32_bf16 v[80:83], a[32:35], a[60:63], v[80:83]
  ds_read_b64_tr_b16 a[44:45], v199 offset:44032
  v_mfma_f32_16x16x32_bf16 v[76:79], a[28:31], a[60:63], v[76:79]
  ds_read_b128 a[8:11], v208 offset:57344
  v_mfma_f32_16x16x32_bf16 v[72:75], a[24:27], a[60:63], v[72:75]
  buffer_load_dwordx4 v204, s[8:11], s61 offen offset:2048 lds
  s_mov_b32 s62, 43008
  v_mfma_f32_16x16x32_bf16 v[68:71], a[20:23], a[60:63], v[68:71]
  s_waitcnt lgkmcnt(6)
  s_add_u32 m0, s64, 76800
  ds_read_b64_tr_b16 a[46:47], v199 offset:50176
  v_mfma_f32_16x16x32_bf16 v[84:87], a[64:67], a[20:23], v[84:87]
  s_sub_u32 s48, s48, 1024
  ds_read_b128 a[12:15], v208 offset:58368
  v_add_u32 v12, 64, v10
  v_mfma_f32_16x16x32_bf16 v[88:91], a[64:67], a[24:27], v[88:91]
  ds_read_b128 a[16:19], v211 offset:63488
  v_mul_u32_u24 v13, 4682, v12
  v_mfma_f32_16x16x32_bf16 v[92:95], a[64:67], a[28:31], v[92:95]
  buffer_load_dwordx4 v205, s[36:39], s62 offen offset:0 sc1 lds
  v_lshrrev_b32 v13, 16, v13
  v_mfma_f32_16x16x32_bf16 v[96:99], a[64:67], a[32:35], v[96:99]
  ds_read_b64_tr_b16 a[48:49], v198 offset:45056
  v_mul_i32_i24 v14, -14, v13
  v_mfma_f32_16x16x32_bf16 v[112:115], a[68:71], a[32:35], v[112:115]
  ds_read_b64_tr_b16 a[50:51], v198 offset:51200
  v_add3_u32 v12, v12, v14, s49
  v_mfma_f32_16x16x32_bf16 v[108:111], a[68:71], a[28:31], v[108:111]
  ds_read_b64_tr_b16 a[52:53], v199 offset:45056
  v_mfma_f32_16x16x32_bf16 v[104:107], a[68:71], a[24:27], v[104:107]
  buffer_load_dwordx4 v205, s[36:39], s62 offen offset:1024 sc1 lds
  s_add_u32 m0, s65, 84992
  v_mfma_f32_16x16x32_bf16 v[100:103], a[68:71], a[20:23], v[100:103]
  s_waitcnt vmcnt(23) lgkmcnt(3)
  s_barrier
  ds_read_b64_tr_b16 a[54:55], v199 offset:51200
  v_mfma_f32_16x16x32_bf16 v[20:23], a[40:43], a[0:3], v[20:23]
  ds_read_b64_tr_b16 a[56:57], v198 offset:43008
  v_add_u32 v14, -14, v12
  v_mfma_f32_16x16x32_bf16 v[24:27], a[40:43], a[4:7], v[24:27]
  v_min_u32 v12, v12, v14
  v_mul_u32_u24 v13, 7168, v13
  v_mfma_f32_16x16x32_bf16 v[28:31], a[40:43], a[8:11], v[28:31]
  buffer_load_dword v206, s[36:39], s62 offen sc1 lds
  s_mov_b32 s61, 4325376
  v_mfma_f32_16x16x32_bf16 v[32:35], a[40:43], a[12:15], v[32:35]
  s_add_u32 m0, s63, 86016
  ds_read_b64_tr_b16 a[58:59], v198 offset:49152
  v_lshl_add_u32 v12, v12, 4, v13
  v_mfma_f32_16x16x32_bf16 v[116:119], a[40:43], a[16:19], v[116:119]
  ds_read_b64_tr_b16 a[60:61], v199 offset:43008
  v_add_u32 v4, s48, v12
  v_mfma_f32_16x16x32_bf16 v[48:51], a[44:47], a[12:15], v[48:51]
  v_mfma_f32_16x16x32_bf16 v[44:47], a[44:47], a[8:11], v[44:47]
  buffer_load_dwordx4 v202, s[8:11], s61 offen offset:0 lds
  v_mfma_f32_16x16x32_bf16 v[40:43], a[44:47], a[4:7], v[40:43]
  ds_read_b64_tr_b16 a[62:63], v199 offset:49152
  v_mfma_f32_16x16x32_bf16 v[36:39], a[44:47], a[0:3], v[36:39]
  s_waitcnt lgkmcnt(4)
  ds_read_b64_tr_b16 a[64:65], v200 offset:1024
  s_sub_u32 s48, s48, 1024
  v_mfma_f32_16x16x32_bf16 v[52:55], a[0:3], a[48:51], v[52:55]
  ds_read_b128 a[20:23], v209 offset:12288
  v_mfma_f32_16x16x32_bf16 v[56:59], a[4:7], a[48:51], v[56:59]
  buffer_load_dwordx4 v203, s[8:11], s61 offen offset:1024 lds
  v_add_u32 v12, 128, v10
  v_mfma_f32_16x16x32_bf16 v[60:63], a[8:11], a[48:51], v[60:63]
  ds_read_b64_tr_b16 a[66:67], v200 offset:7168
  v_mul_u32_u24 v13, 4682, v12
  v_mfma_f32_16x16x32_bf16 v[64:67], a[12:15], a[48:51], v[64:67]
  ds_read_b128 a[24:27], v209 offset:13312
  v_lshrrev_b32 v13, 16, v13
  v_mfma_f32_16x16x32_bf16 v[120:123], a[16:19], a[48:51], v[120:123]
  ds_read_b64_tr_b16 a[68:69], v201 offset:1024
  v_mul_i32_i24 v14, -14, v13
  v_mfma_f32_16x16x32_bf16 v[80:83], a[12:15], a[52:55], v[80:83]
  buffer_load_dwordx4 v204, s[8:11], s61 offen offset:2048 lds
  s_mov_b32 s62, 45056
  v_mfma_f32_16x16x32_bf16 v[76:79], a[8:11], a[52:55], v[76:79]
  s_add_u32 m0, s64, 98304
  ds_read_b128 a[28:31], v209 offset:14336
  v_add3_u32 v12, v12, v14, s49
  v_mfma_f32_16x16x32_bf16 v[72:75], a[4:7], a[52:55], v[72:75]
  ds_read_b64_tr_b16 a[70:71], v201 offset:7168
  v_mfma_f32_16x16x32_bf16 v[68:71], a[0:3], a[52:55], v[68:71]
  s_waitcnt lgkmcnt(7)
  ds_read_b128 a[32:35], v209 offset:15360
  v_mfma_f32_16x16x32_bf16 v[84:87], a[56:59], a[0:3], v[84:87]
  buffer_load_dwordx4 v205, s[36:39], s62 offen offset:0 sc1 lds
  v_add_u32 v14, -14, v12
  v_mfma_f32_16x16x32_bf16 v[88:91], a[56:59], a[4:7], v[88:91]
  ds_read_b128 a[36:39], v212 offset:20480
  v_min_u32 v12, v12, v14
  v_mfma_f32_16x16x32_bf16 v[92:95], a[56:59], a[8:11], v[92:95]
  ds_read_b64_tr_b16 a[40:41], v200 offset:2048
  v_mul_u32_u24 v13, 7168, v13
  v_mfma_f32_16x16x32_bf16 v[96:99], a[56:59], a[12:15], v[96:99]
  ds_read_b64_tr_b16 a[42:43], v200 offset:8192
  v_lshl_add_u32 v12, v12, 4, v13
  v_mfma_f32_16x16x32_bf16 v[112:115], a[60:63], a[12:15], v[112:115]
  buffer_load_dwordx4 v205, s[36:39], s62 offen offset:1024 sc1 lds
  s_add_u32 m0, s65, 106496
  v_mfma_f32_16x16x32_bf16 v[108:111], a[60:63], a[8:11], v[108:111]
  ds_read_b64_tr_b16 a[44:45], v201 offset:2048
  v_add_u32 v5, s48, v12
  v_mfma_f32_16x16x32_bf16 v[104:107], a[60:63], a[4:7], v[104:107]
  ds_read_b64_tr_b16 a[46:47], v201 offset:8192
  v_mfma_f32_16x16x32_bf16 v[100:103], a[60:63], a[0:3], v[100:103]
  s_waitcnt vmcnt(23) lgkmcnt(4)
  s_barrier
  v_mfma_f32_16x16x32_bf16 v[20:23], a[64:67], a[20:23], v[20:23]
  s_sub_u32 s48, s48, 1024
  buffer_load_dword v206, s[36:39], s62 offen sc1 lds
  s_mov_b32 s61, 4521984
  v_mfma_f32_16x16x32_bf16 v[24:27], a[64:67], a[24:27], v[24:27]
  s_add_u32 m0, s63, 107520
  ds_read_b64_tr_b16 a[48:49], v200 offset:0
  v_mfma_f32_16x16x32_bf16 v[28:31], a[64:67], a[28:31], v[28:31]
  ds_read_b64_tr_b16 a[50:51], v200 offset:6144
  v_add_u32 v12, 192, v10
  v_mfma_f32_16x16x32_bf16 v[32:35], a[64:67], a[32:35], v[32:35]
  v_mul_u32_u24 v13, 4682, v12
  v_lshrrev_b32 v13, 16, v13
  v_mfma_f32_16x16x32_bf16 v[116:119], a[64:67], a[36:39], v[116:119]
  buffer_load_dwordx4 v202, s[8:11], s61 offen offset:0 lds
  v_mul_i32_i24 v14, -14, v13
  v_mfma_f32_16x16x32_bf16 v[48:51], a[68:71], a[32:35], v[48:51]
  ds_read_b64_tr_b16 a[52:53], v201 offset:0
  v_add3_u32 v12, v12, v14, s49
  v_mfma_f32_16x16x32_bf16 v[44:47], a[68:71], a[28:31], v[44:47]
  ds_read_b64_tr_b16 a[54:55], v201 offset:6144
  v_mfma_f32_16x16x32_bf16 v[40:43], a[68:71], a[24:27], v[40:43]
  v_mfma_f32_16x16x32_bf16 v[36:39], a[68:71], a[20:23], v[36:39]
  s_waitcnt lgkmcnt(4)
  buffer_load_dwordx4 v203, s[8:11], s61 offen offset:1024 lds
  v_mfma_f32_16x16x32_bf16 v[52:55], a[20:23], a[40:43], v[52:55]
  ds_read_b64_tr_b16 a[56:57], v196 offset:1024
  v_mfma_f32_16x16x32_bf16 v[56:59], a[24:27], a[40:43], v[56:59]
  ds_read_b128 a[0:3], v207 offset:12288
  v_add_u32 v14, -14, v12
  v_mfma_f32_16x16x32_bf16 v[60:63], a[28:31], a[40:43], v[60:63]
  ds_read_b64_tr_b16 a[58:59], v196 offset:7168
  v_min_u32 v12, v12, v14
  v_mfma_f32_16x16x32_bf16 v[64:67], a[32:35], a[40:43], v[64:67]
  buffer_load_dwordx4 v204, s[8:11], s61 offen offset:2048 lds
  s_mov_b32 s62, 47104
  v_mfma_f32_16x16x32_bf16 v[120:123], a[36:39], a[40:43], v[120:123]
  s_add_u32 m0, s64, 119808
  ds_read_b128 a[4:7], v207 offset:13312
  v_mul_u32_u24 v13, 7168, v13
  v_mfma_f32_16x16x32_bf16 v[80:83], a[32:35], a[44:47], v[80:83]
  ds_read_b64_tr_b16 a[60:61], v197 offset:1024
  v_lshl_add_u32 v12, v12, 4, v13
  v_mfma_f32_16x16x32_bf16 v[76:79], a[28:31], a[44:47], v[76:79]
  ds_read_b128 a[8:11], v207 offset:14336
  v_add_u32 v6, s48, v12
  v_mfma_f32_16x16x32_bf16 v[72:75], a[24:27], a[44:47], v[72:75]
  buffer_load_dwordx4 v205, s[36:39], s62 offen offset:0 sc1 lds
  v_mfma_f32_16x16x32_bf16 v[68:71], a[20:23], a[44:47], v[68:71]
  s_waitcnt lgkmcnt(6)
  ds_read_b64_tr_b16 a[62:63], v197 offset:7168
  v_mfma_f32_16x16x32_bf16 v[84:87], a[48:51], a[20:23], v[84:87]
  s_sub_u32 s48, s48, -3072
  ds_read_b128 a[12:15], v207 offset:15360
  v_mfma_f32_16x16x32_bf16 v[88:91], a[48:51], a[24:27], v[88:91]
  ds_read_b128 a[16:19], v210 offset:20480
  v_add_u32 v12, 256, v10
  v_mfma_f32_16x16x32_bf16 v[92:95], a[48:51], a[28:31], v[92:95]
  ds_read_b64_tr_b16 a[64:65], v196 offset:2048
  v_mul_u32_u24 v13, 4682, v12
  v_mfma_f32_16x16x32_bf16 v[96:99], a[48:51], a[32:35], v[96:99]
  buffer_load_dwordx4 v205, s[36:39], s62 offen offset:1024 sc1 lds
  s_add_u32 m0, s65, 128000
  v_mfma_f32_16x16x32_bf16 v[112:115], a[52:55], a[32:35], v[112:115]
  ds_read_b64_tr_b16 a[66:67], v196 offset:8192
  v_lshrrev_b32 v13, 16, v13
  v_mfma_f32_16x16x32_bf16 v[108:111], a[52:55], a[28:31], v[108:111]
  ds_read_b64_tr_b16 a[68:69], v197 offset:2048
  v_mul_i32_i24 v14, -14, v13
  v_mfma_f32_16x16x32_bf16 v[104:107], a[52:55], a[24:27], v[104:107]
  ds_read_b64_tr_b16 a[70:71], v197 offset:8192
  v_add3_u32 v12, v12, v14, s49
  v_mfma_f32_16x16x32_bf16 v[100:103], a[52:55], a[20:23], v[100:103]
  s_waitcnt vmcnt(23) lgkmcnt(4)
  s_barrier
  buffer_load_dword v206, s[36:39], s62 offen sc1 lds
  v_mfma_f32_16x16x32_bf16 v[20:23], a[56:59], a[0:3], v[20:23]
  s_mov_b32 s61, 4718592
  s_add_u32 m0, s63, 129024
  ds_read_b64_tr_b16 a[40:41], v196 offset:0
  v_mfma_f32_16x16x32_bf16 v[24:27], a[56:59], a[4:7], v[24:27]
  v_add_u32 v14, -14, v12
  v_min_u32 v12, v12, v14
  v_mfma_f32_16x16x32_bf16 v[28:31], a[56:59], a[8:11], v[28:31]
  ds_read_b64_tr_b16 a[42:43], v196 offset:6144
  v_mul_u32_u24 v13, 7168, v13
  v_mfma_f32_16x16x32_bf16 v[32:35], a[56:59], a[12:15], v[32:35]
  buffer_load_dwordx4 v202, s[8:11], s61 offen offset:0 lds
  v_lshl_add_u32 v12, v12, 4, v13
  v_mfma_f32_16x16x32_bf16 v[116:119], a[56:59], a[16:19], v[116:119]
  ds_read_b64_tr_b16 a[44:45], v197 offset:0
  v_add_u32 v7, s48, v12
  v_mfma_f32_16x16x32_bf16 v[48:51], a[60:63], a[12:15], v[48:51]
  v_mfma_f32_16x16x32_bf16 v[44:47], a[60:63], a[8:11], v[44:47]
  ds_read_b64_tr_b16 a[46:47], v197 offset:6144
  v_mfma_f32_16x16x32_bf16 v[40:43], a[60:63], a[4:7], v[40:43]
  buffer_load_dwordx4 v203, s[8:11], s61 offen offset:1024 lds
  v_mfma_f32_16x16x32_bf16 v[36:39], a[60:63], a[0:3], v[36:39]
  s_waitcnt lgkmcnt(4)
  ds_read_b64_tr_b16 a[48:49], v196 offset:22528
  v_mfma_f32_16x16x32_bf16 v[52:55], a[0:3], a[64:67], v[52:55]
  s_sub_u32 s48, s48, 1024
  ds_read_b128 a[20:23], v207 offset:33792
  v_mfma_f32_16x16x32_bf16 v[56:59], a[4:7], a[64:67], v[56:59]
  ds_read_b64_tr_b16 a[50:51], v196 offset:28672
  v_mfma_f32_16x16x32_bf16 v[60:63], a[8:11], a[64:67], v[60:63]
  buffer_load_dwordx4 v204, s[8:11], s61 offen offset:2048 lds
  s_mov_b32 s62, 49152
  v_mfma_f32_16x16x32_bf16 v[64:67], a[12:15], a[64:67], v[64:67]
  s_add_u32 m0, s64, 141312
  ds_read_b128 a[24:27], v207 offset:34816
  v_add_u32 v12, 320, v10
  v_mfma_f32_16x16x32_bf16 v[120:123], a[16:19], a[64:67], v[120:123]
  ds_read_b64_tr_b16 a[52:53], v197 offset:22528
  v_mul_u32_u24 v13, 4682, v12
  v_mfma_f32_16x16x32_bf16 v[80:83], a[12:15], a[68:71], v[80:83]
  ds_read_b128 a[28:31], v207 offset:35840
  v_lshrrev_b32 v13, 16, v13
  v_mfma_f32_16x16x32_bf16 v[76:79], a[8:11], a[68:71], v[76:79]
  buffer_load_dwordx4 v205, s[36:39], s62 offen offset:0 sc1 lds
  v_mul_i32_i24 v14, -14, v13
  v_mfma_f32_16x16x32_bf16 v[72:75], a[4:7], a[68:71], v[72:75]
  ds_read_b64_tr_b16 a[54:55], v197 offset:28672
  v_add3_u32 v12, v12, v14, s49
  v_mfma_f32_16x16x32_bf16 v[68:71], a[0:3], a[68:71], v[68:71]
  s_waitcnt lgkmcnt(7)
  ds_read_b128 a[32:35], v207 offset:36864
  v_mfma_f32_16x16x32_bf16 v[84:87], a[40:43], a[0:3], v[84:87]
  ds_read_b128 a[36:39], v210 offset:41984
  v_mfma_f32_16x16x32_bf16 v[88:91], a[40:43], a[4:7], v[88:91]
  ds_read_b64_tr_b16 a[56:57], v196 offset:23552
  v_add_u32 v14, -14, v12
  v_mfma_f32_16x16x32_bf16 v[92:95], a[40:43], a[8:11], v[92:95]
  buffer_load_dwordx4 v205, s[36:39], s62 offen offset:1024 sc1 lds
  s_add_u32 m0, s65, 149504
  v_mfma_f32_16x16x32_bf16 v[96:99], a[40:43], a[12:15], v[96:99]
  ds_read_b64_tr_b16 a[58:59], v196 offset:29696
  v_min_u32 v12, v12, v14
  v_mfma_f32_16x16x32_bf16 v[112:115], a[44:47], a[12:15], v[112:115]
  ds_read_b64_tr_b16 a[60:61], v197 offset:23552
  v_mul_u32_u24 v13, 7168, v13
  v_mfma_f32_16x16x32_bf16 v[108:111], a[44:47], a[8:11], v[108:111]
  v_lshl_add_u32 v12, v12, 4, v13
  v_add_u32 v8, s48, v12
  v_mfma_f32_16x16x32_bf16 v[104:107], a[44:47], a[4:7], v[104:107]
  buffer_load_dword v206, s[36:39], s62 offen sc1 lds
  s_mov_b32 s61, 4915200
  v_mfma_f32_16x16x32_bf16 v[100:103], a[44:47], a[0:3], v[100:103]
  s_waitcnt vmcnt(24) lgkmcnt(3)
  s_barrier
  s_add_u32 m0, s63, 0
  v_mfma_f32_16x16x32_bf16 v[20:23], a[48:51], a[20:23], v[20:23]
  ds_read_b64_tr_b16 a[62:63], v197 offset:29696
  v_mfma_f32_16x16x32_bf16 v[24:27], a[48:51], a[24:27], v[24:27]
  s_sub_u32 s48, s48, 1024
  ds_read_b64_tr_b16 a[64:65], v196 offset:21504
  v_mfma_f32_16x16x32_bf16 v[28:31], a[48:51], a[28:31], v[28:31]
  buffer_load_dwordx4 v202, s[8:11], s61 offen offset:0 lds
  v_add_u32 v12, 384, v10
  v_mfma_f32_16x16x32_bf16 v[32:35], a[48:51], a[32:35], v[32:35]
  ds_read_b64_tr_b16 a[66:67], v196 offset:27648
  v_mul_u32_u24 v13, 4682, v12
  v_mfma_f32_16x16x32_bf16 v[116:119], a[48:51], a[36:39], v[116:119]
  ds_read_b64_tr_b16 a[68:69], v197 offset:21504
  v_lshrrev_b32 v13, 16, v13
  v_mfma_f32_16x16x32_bf16 v[48:51], a[52:55], a[32:35], v[48:51]
  v_mul_i32_i24 v14, -14, v13
  v_add3_u32 v12, v12, v14, s49
  v_mfma_f32_16x16x32_bf16 v[44:47], a[52:55], a[28:31], v[44:47]
  buffer_load_dwordx4 v203, s[8:11], s61 offen offset:1024 lds
  v_mfma_f32_16x16x32_bf16 v[40:43], a[52:55], a[24:27], v[40:43]
  ds_read_b64_tr_b16 a[70:71], v197 offset:27648
  v_mfma_f32_16x16x32_bf16 v[36:39], a[52:55], a[20:23], v[36:39]
  s_waitcnt lgkmcnt(4)
  ds_read_b64_tr_b16 a[40:41], v196 offset:44032
  v_mfma_f32_16x16x32_bf16 v[52:55], a[20:23], a[56:59], v[52:55]
  ds_read_b128 a[0:3], v207 offset:55296
  v_mfma_f32_16x16x32_bf16 v[56:59], a[24:27], a[56:59], v[56:59]
  buffer_load_dwordx4 v204, s[8:11], s61 offen offset:2048 lds
  v_add_u32 v14, -14, v12
  v_mfma_f32_16x16x32_bf16 v[60:63], a[28:31], a[56:59], v[60:63]
  s_mov_b32 s62, 51200
  ds_read_b64_tr_b16 a[42:43], v196 offset:50176
  s_add_u32 m0, s64, 12288
  v_mfma_f32_16x16x32_bf16 v[64:67], a[32:35], a[56:59], v[64:67]
  ds_read_b128 a[4:7], v207 offset:56320
  v_min_u32 v12, v12, v14
  v_mfma_f32_16x16x32_bf16 v[120:123], a[36:39], a[56:59], v[120:123]
  ds_read_b64_tr_b16 a[44:45], v197 offset:44032
  v_mul_u32_u24 v13, 7168, v13
  v_mfma_f32_16x16x32_bf16 v[80:83], a[32:35], a[60:63], v[80:83]
  ds_read_b128 a[8:11], v207 offset:57344
  v_lshl_add_u32 v12, v12, 4, v13
  v_mfma_f32_16x16x32_bf16 v[76:79], a[28:31], a[60:63], v[76:79]
  buffer_load_dwordx4 v205, s[36:39], s62 offen offset:0 sc1 lds
  v_add_u32 v9, s48, v12
  v_mfma_f32_16x16x32_bf16 v[72:75], a[24:27], a[60:63], v[72:75]
  ds_read_b64_tr_b16 a[46:47], v197 offset:50176
  v_mfma_f32_16x16x32_bf16 v[68:71], a[20:23], a[60:63], v[68:71]
  s_waitcnt lgkmcnt(7)
  ds_read_b128 a[12:15], v207 offset:58368
  v_mfma_f32_16x16x32_bf16 v[84:87], a[64:67], a[20:23], v[84:87]
  s_sub_u32 s48, s48, 1024
  ds_read_b128 a[16:19], v210 offset:63488
  v_mfma_f32_16x16x32_bf16 v[88:91], a[64:67], a[24:27], v[88:91]
  ds_read_b64_tr_b16 a[48:49], v196 offset:45056
  v_mfma_f32_16x16x32_bf16 v[92:95], a[64:67], a[28:31], v[92:95]
  s_and_b32 s48, s58, 1
  buffer_load_dwordx4 v205, s[36:39], s62 offen offset:1024 sc1 lds
  s_add_u32 m0, s65, 20480
  v_mfma_f32_16x16x32_bf16 v[96:99], a[64:67], a[32:35], v[96:99]
  s_lshl_b32 s48, s48, 7
  ds_read_b64_tr_b16 a[50:51], v196 offset:51200
  s_and_b32 s49, s58, 6
  v_mfma_f32_16x16x32_bf16 v[112:115], a[68:71], a[32:35], v[112:115]
  s_add_u32 s48, s48, s49
  ds_read_b64_tr_b16 a[52:53], v197 offset:45056
  v_mfma_f32_16x16x32_bf16 v[108:111], a[68:71], a[28:31], v[108:111]
  v_mfma_f32_16x16x32_bf16 v[104:107], a[68:71], a[24:27], v[104:107]
  buffer_load_dword v206, s[36:39], s62 offen sc1 lds
  s_mov_b32 s61, 5111808
  v_mfma_f32_16x16x32_bf16 v[100:103], a[68:71], a[20:23], v[100:103]
  s_waitcnt vmcnt(24) lgkmcnt(3)
  s_barrier
  s_add_u32 m0, s63, 21504
  v_mfma_f32_16x16x32_bf16 v[20:23], a[40:43], a[0:3], v[20:23]
  ds_read_b64_tr_b16 a[54:55], v197 offset:51200
  v_bfe_u32 v12, v10, 1, 4
  v_mfma_f32_16x16x32_bf16 v[24:27], a[40:43], a[4:7], v[24:27]
  ds_read_b64_tr_b16 a[56:57], v196 offset:43008
  v_and_b32 v13, 1, v10
  v_mfma_f32_16x16x32_bf16 v[28:31], a[40:43], a[8:11], v[28:31]
  buffer_load_dwordx4 v202, s[8:11], s61 offen offset:0 lds
  v_lshl_add_u32 v12, v12, 3, v13
  v_mfma_f32_16x16x32_bf16 v[32:35], a[40:43], a[12:15], v[32:35]
  ds_read_b64_tr_b16 a[58:59], v196 offset:49152
  v_add_lshl_u32 v251, v12, s48, 7
  v_mfma_f32_16x16x32_bf16 v[116:119], a[40:43], a[16:19], v[116:119]
  ds_read_b64_tr_b16 a[60:61], v197 offset:43008
  v_mfma_f32_16x16x32_bf16 v[48:51], a[44:47], a[12:15], v[48:51]
  v_mfma_f32_16x16x32_bf16 v[44:47], a[44:47], a[8:11], v[44:47]
  buffer_load_dwordx4 v203, s[8:11], s61 offen offset:1024 lds
  v_mfma_f32_16x16x32_bf16 v[40:43], a[44:47], a[4:7], v[40:43]
  ds_read_b64_tr_b16 a[62:63], v197 offset:49152
  v_add_u32 v251, 98304, v251
  v_mfma_f32_16x16x32_bf16 v[36:39], a[44:47], a[0:3], v[36:39]
  s_waitcnt lgkmcnt(4)
  ds_read_b64_tr_b16 a[64:65], v198 offset:1024
  v_and_b32 v12, 7, v10
  v_mfma_f32_16x16x32_bf16 v[52:55], a[0:3], a[48:51], v[52:55]
  ds_read_b128 a[20:23], v208 offset:12288
  v_lshlrev_b32 v12, 5, v12
  v_mfma_f32_16x16x32_bf16 v[56:59], a[4:7], a[48:51], v[56:59]
  s_and_b32 s48, s2, 31
  buffer_load_dwordx4 v204, s[8:11], s61 offen offset:2048 lds
  v_add_lshl_u32 v12, v12, s48, 7
  v_mfma_f32_16x16x32_bf16 v[60:63], a[8:11], a[48:51], v[60:63]
  s_mov_b32 s62, 53248
  ds_read_b64_tr_b16 a[66:67], v198 offset:7168
  s_add_u32 m0, s64, 33792
  v_mfma_f32_16x16x32_bf16 v[64:67], a[12:15], a[48:51], v[64:67]
  ds_read_b128 a[24:27], v208 offset:13312
  v_cmp_gt_u32 vcc, 32, v10
  v_mfma_f32_16x16x32_bf16 v[120:123], a[16:19], a[48:51], v[120:123]
  s_nop 1
  ds_read_b64_tr_b16 a[68:69], v199 offset:1024
  v_cndmask_b32 v251, v12, v251, vcc
  v_mfma_f32_16x16x32_bf16 v[80:83], a[12:15], a[52:55], v[80:83]
  ds_read_b128 a[28:31], v208 offset:14336
  v_mfma_f32_16x16x32_bf16 v[76:79], a[8:11], a[52:55], v[76:79]
  buffer_load_dwordx4 v205, s[36:39], s62 offen offset:0 sc1 lds
  v_mfma_f32_16x16x32_bf16 v[72:75], a[4:7], a[52:55], v[72:75]
  ds_read_b64_tr_b16 a[70:71], v199 offset:7168
  v_mfma_f32_16x16x32_bf16 v[68:71], a[0:3], a[52:55], v[68:71]
  s_waitcnt lgkmcnt(7)
  ds_read_b128 a[32:35], v208 offset:15360
  v_mfma_f32_16x16x32_bf16 v[84:87], a[56:59], a[0:3], v[84:87]
  ds_read_b128 a[36:39], v211 offset:20480
  v_mfma_f32_16x16x32_bf16 v[88:91], a[56:59], a[4:7], v[88:91]
  ds_read_b64_tr_b16 a[40:41], v198 offset:2048
  v_mfma_f32_16x16x32_bf16 v[92:95], a[56:59], a[8:11], v[92:95]
  buffer_load_dwordx4 v205, s[36:39], s62 offen offset:1024 sc1 lds
  s_add_u32 m0, s65, 41984
  v_mfma_f32_16x16x32_bf16 v[96:99], a[56:59], a[12:15], v[96:99]
  ds_read_b64_tr_b16 a[42:43], v198 offset:8192
  v_mfma_f32_16x16x32_bf16 v[112:115], a[60:63], a[12:15], v[112:115]
  ds_read_b64_tr_b16 a[44:45], v199 offset:2048
  v_mfma_f32_16x16x32_bf16 v[108:111], a[60:63], a[8:11], v[108:111]
  v_mfma_f32_16x16x32_bf16 v[104:107], a[60:63], a[4:7], v[104:107]
  buffer_load_dword v206, s[36:39], s62 offen sc1 lds
  s_mov_b32 s61, 5308416
  v_mfma_f32_16x16x32_bf16 v[100:103], a[60:63], a[0:3], v[100:103]
  s_waitcnt vmcnt(24) lgkmcnt(3)
  s_barrier
  s_add_u32 m0, s63, 43008
  v_mfma_f32_16x16x32_bf16 v[20:23], a[64:67], a[20:23], v[20:23]
  ds_read_b64_tr_b16 a[46:47], v199 offset:8192
  v_mfma_f32_16x16x32_bf16 v[24:27], a[64:67], a[24:27], v[24:27]
  ds_read_b64_tr_b16 a[48:49], v198 offset:0
  v_mfma_f32_16x16x32_bf16 v[28:31], a[64:67], a[28:31], v[28:31]
  buffer_load_dwordx4 v202, s[8:11], s61 offen offset:0 lds
  v_mfma_f32_16x16x32_bf16 v[32:35], a[64:67], a[32:35], v[32:35]
  ds_read_b64_tr_b16 a[50:51], v198 offset:6144
  v_mfma_f32_16x16x32_bf16 v[116:119], a[64:67], a[36:39], v[116:119]
  ds_read_b64_tr_b16 a[52:53], v199 offset:0
  v_mfma_f32_16x16x32_bf16 v[48:51], a[68:71], a[32:35], v[48:51]
  v_mfma_f32_16x16x32_bf16 v[44:47], a[68:71], a[28:31], v[44:47]
  buffer_load_dwordx4 v203, s[8:11], s61 offen offset:1024 lds
  v_mfma_f32_16x16x32_bf16 v[40:43], a[68:71], a[24:27], v[40:43]
  ds_read_b64_tr_b16 a[54:55], v199 offset:6144
  v_mfma_f32_16x16x32_bf16 v[36:39], a[68:71], a[20:23], v[36:39]
  s_waitcnt lgkmcnt(4)
  ds_read_b64_tr_b16 a[56:57], v198 offset:22528
  v_mfma_f32_16x16x32_bf16 v[52:55], a[20:23], a[40:43], v[52:55]
  ds_read_b128 a[0:3], v208 offset:33792
  v_mfma_f32_16x16x32_bf16 v[56:59], a[24:27], a[40:43], v[56:59]
  buffer_load_dwordx4 v204, s[8:11], s61 offen offset:2048 lds
  v_mfma_f32_16x16x32_bf16 v[60:63], a[28:31], a[40:43], v[60:63]
  s_mov_b32 s62, 55296
  ds_read_b64_tr_b16 a[58:59], v198 offset:28672
  s_add_u32 m0, s64, 55296
  v_mfma_f32_16x16x32_bf16 v[64:67], a[32:35], a[40:43], v[64:67]
  ds_read_b128 a[4:7], v208 offset:34816
  v_mfma_f32_16x16x32_bf16 v[120:123], a[36:39], a[40:43], v[120:123]
  ds_read_b64_tr_b16 a[60:61], v199 offset:22528
  v_mfma_f32_16x16x32_bf16 v[80:83], a[32:35], a[44:47], v[80:83]
  ds_read_b128 a[8:11], v208 offset:35840
  v_mfma_f32_16x16x32_bf16 v[76:79], a[28:31], a[44:47], v[76:79]
  buffer_load_dwordx4 v205, s[36:39], s62 offen offset:0 sc1 lds
  v_mfma_f32_16x16x32_bf16 v[72:75], a[24:27], a[44:47], v[72:75]
  ds_read_b64_tr_b16 a[62:63], v199 offset:28672
  v_mfma_f32_16x16x32_bf16 v[68:71], a[20:23], a[44:47], v[68:71]
  s_waitcnt lgkmcnt(7)
  ds_read_b128 a[12:15], v208 offset:36864
  v_mfma_f32_16x16x32_bf16 v[84:87], a[48:51], a[20:23], v[84:87]
  ds_read_b128 a[16:19], v211 offset:41984
  v_mfma_f32_16x16x32_bf16 v[88:91], a[48:51], a[24:27], v[88:91]
  ds_read_b64_tr_b16 a[64:65], v198 offset:23552
  v_mfma_f32_16x16x32_bf16 v[92:95], a[48:51], a[28:31], v[92:95]
  buffer_load_dwordx4 v205, s[36:39], s62 offen offset:1024 sc1 lds
  s_add_u32 m0, s65, 63488
  v_mfma_f32_16x16x32_bf16 v[96:99], a[48:51], a[32:35], v[96:99]
  ds_read_b64_tr_b16 a[66:67], v198 offset:29696
  v_mfma_f32_16x16x32_bf16 v[112:115], a[52:55], a[32:35], v[112:115]
  ds_read_b64_tr_b16 a[68:69], v199 offset:23552
  v_mfma_f32_16x16x32_bf16 v[108:111], a[52:55], a[28:31], v[108:111]
  v_mfma_f32_16x16x32_bf16 v[104:107], a[52:55], a[24:27], v[104:107]
  buffer_load_dword v206, s[36:39], s62 offen sc1 lds
  s_mov_b32 s61, 5505024
  v_mfma_f32_16x16x32_bf16 v[100:103], a[52:55], a[20:23], v[100:103]
  s_waitcnt vmcnt(24) lgkmcnt(3)
  s_barrier
  s_add_u32 m0, s63, 64512
  v_mfma_f32_16x16x32_bf16 v[20:23], a[56:59], a[0:3], v[20:23]
  ds_read_b64_tr_b16 a[70:71], v199 offset:29696
  v_mfma_f32_16x16x32_bf16 v[24:27], a[56:59], a[4:7], v[24:27]
  ds_read_b64_tr_b16 a[40:41], v198 offset:21504
  v_mfma_f32_16x16x32_bf16 v[28:31], a[56:59], a[8:11], v[28:31]
  buffer_load_dwordx4 v202, s[8:11], s61 offen offset:0 lds
  v_mfma_f32_16x16x32_bf16 v[32:35], a[56:59], a[12:15], v[32:35]
  ds_read_b64_tr_b16 a[42:43], v198 offset:27648
  v_mfma_f32_16x16x32_bf16 v[116:119], a[56:59], a[16:19], v[116:119]
  ds_read_b64_tr_b16 a[44:45], v199 offset:21504
  v_mfma_f32_16x16x32_bf16 v[48:51], a[60:63], a[12:15], v[48:51]
  v_mfma_f32_16x16x32_bf16 v[44:47], a[60:63], a[8:11], v[44:47]
  buffer_load_dwordx4 v203, s[8:11], s61 offen offset:1024 lds
  v_mfma_f32_16x16x32_bf16 v[40:43], a[60:63], a[4:7], v[40:43]
  ds_read_b64_tr_b16 a[46:47], v199 offset:27648
  v_mfma_f32_16x16x32_bf16 v[36:39], a[60:63], a[0:3], v[36:39]
  s_waitcnt lgkmcnt(4)
  ds_read_b64_tr_b16 a[48:49], v198 offset:44032
  v_mfma_f32_16x16x32_bf16 v[52:55], a[0:3], a[64:67], v[52:55]
  ds_read_b128 a[20:23], v208 offset:55296
  v_mfma_f32_16x16x32_bf16 v[56:59], a[4:7], a[64:67], v[56:59]
  s_lshr_b32 s68, s2, 3
  buffer_load_dwordx4 v204, s[8:11], s61 offen offset:2048 lds
  s_lshl2_add_u32 s68, s68, s44
  v_mfma_f32_16x16x32_bf16 v[60:63], a[8:11], a[64:67], v[60:63]
  s_bfe_u32 s69, s2, 0x20001
  s_lshl_b32 s69, s69, 7
  s_add_u32 s69, s69, s68
  v_mfma_f32_16x16x32_bf16 v[64:67], a[12:15], a[64:67], v[64:67]
  s_lshl_b32 s69, s69, 13
  s_lshl_b32 s68, s68, 14
  s_bitcmp1_b32 s2, 0
  v_mfma_f32_16x16x32_bf16 v[120:123], a[16:19], a[64:67], v[120:123]
  s_cselect_b32 s68, s68, 1073741824
  s_cselect_b32 s69, s69, 1073741824
  ds_read_b64_tr_b16 a[50:51], v198 offset:50176
  v_mfma_f32_16x16x32_bf16 v[80:83], a[12:15], a[68:71], v[80:83]
  s_mov_b32 s62, 57344
  s_add_u32 m0, s64, 76800
  ds_read_b128 a[24:27], v208 offset:56320
  v_mfma_f32_16x16x32_bf16 v[76:79], a[8:11], a[68:71], v[76:79]
  ds_read_b64_tr_b16 a[52:53], v199 offset:44032
  v_and_b32 v214, 15, v10
  v_mfma_f32_16x16x32_bf16 v[72:75], a[4:7], a[68:71], v[72:75]
  ds_read_b128 a[28:31], v208 offset:57344
  v_lshlrev_b32 v214, 10, v214
  v_mfma_f32_16x16x32_bf16 v[68:71], a[0:3], a[68:71], v[68:71]
  s_waitcnt lgkmcnt(6)
  buffer_load_dwordx4 v205, s[36:39], s62 offen offset:0 sc1 lds
  v_mfma_f32_16x16x32_bf16 v[84:87], a[40:43], a[0:3], v[84:87]
  ds_read_b64_tr_b16 a[54:55], v199 offset:50176
  v_mfma_f32_16x16x32_bf16 v[88:91], a[40:43], a[4:7], v[88:91]
  ds_read_b128 a[32:35], v208 offset:58368
  v_mfma_f32_16x16x32_bf16 v[92:95], a[40:43], a[8:11], v[92:95]
  ds_read_b128 a[36:39], v211 offset:63488
  v_mfma_f32_16x16x32_bf16 v[96:99], a[40:43], a[12:15], v[96:99]
  ds_read_b64_tr_b16 a[56:57], v198 offset:45056
  v_mfma_f32_16x16x32_bf16 v[112:115], a[44:47], a[12:15], v[112:115]
  buffer_load_dwordx4 v205, s[36:39], s62 offen offset:1024 sc1 lds
  s_add_u32 m0, s65, 84992
  v_mfma_f32_16x16x32_bf16 v[108:111], a[44:47], a[8:11], v[108:111]
  ds_read_b64_tr_b16 a[58:59], v198 offset:51200
  v_mfma_f32_16x16x32_bf16 v[104:107], a[44:47], a[4:7], v[104:107]
  ds_read_b64_tr_b16 a[60:61], v199 offset:45056
  v_mfma_f32_16x16x32_bf16 v[100:103], a[44:47], a[0:3], v[100:103]
  s_waitcnt vmcnt(23) lgkmcnt(3)
  s_barrier
  ds_read_b64_tr_b16 a[62:63], v199 offset:51200
  v_mfma_f32_16x16x32_bf16 v[20:23], a[48:51], a[20:23], v[20:23]
  buffer_load_dword v206, s[36:39], s62 offen sc1 lds
  s_mov_b32 s61, 5701632
  v_mfma_f32_16x16x32_bf16 v[24:27], a[48:51], a[24:27], v[24:27]
  s_add_u32 m0, s63, 86016
  ds_read_b64_tr_b16 a[64:65], v198 offset:43008
  v_mfma_f32_16x16x32_bf16 v[28:31], a[48:51], a[28:31], v[28:31]
  ds_read_b64_tr_b16 a[66:67], v198 offset:49152
  v_mfma_f32_16x16x32_bf16 v[32:35], a[48:51], a[32:35], v[32:35]
Ha0_1:
  s_cbranch_execz Ha0_2
  v_mfma_f32_16x16x32_bf16 v[116:119], a[48:51], a[36:39], v[116:119]
  buffer_load_dwordx4 v202, s[8:11], s61 offen offset:0 lds
  v_mfma_f32_16x16x32_bf16 v[48:51], a[52:55], a[32:35], v[48:51]
  ds_read_b64_tr_b16 a[68:69], v199 offset:43008
  v_mfma_f32_16x16x32_bf16 v[44:47], a[52:55], a[28:31], v[44:47]
  ds_read_b64_tr_b16 a[70:71], v199 offset:49152
  v_mfma_f32_16x16x32_bf16 v[40:43], a[52:55], a[24:27], v[40:43]
  v_mfma_f32_16x16x32_bf16 v[36:39], a[52:55], a[20:23], v[36:39]
  s_waitcnt lgkmcnt(4)
  buffer_load_dwordx4 v203, s[8:11], s61 offen offset:1024 lds
  v_mfma_f32_16x16x32_bf16 v[52:55], a[20:23], a[56:59], v[52:55]
  ds_read_b64_tr_b16 a[40:41], v200 offset:1024
  v_mfma_f32_16x16x32_bf16 v[56:59], a[24:27], a[56:59], v[56:59]
  ds_read_b128 a[0:3], v209 offset:12288
  v_mfma_f32_16x16x32_bf16 v[60:63], a[28:31], a[56:59], v[60:63]
  ds_read_b64_tr_b16 a[42:43], v200 offset:7168
  v_mfma_f32_16x16x32_bf16 v[64:67], a[32:35], a[56:59], v[64:67]
  buffer_load_dwordx4 v204, s[8:11], s61 offen offset:2048 lds
  s_mov_b32 s62, 59392
  v_mfma_f32_16x16x32_bf16 v[120:123], a[36:39], a[56:59], v[120:123]
  s_add_u32 m0, s64, 98304
  ds_read_b128 a[4:7], v209 offset:13312
  v_mfma_f32_16x16x32_bf16 v[80:83], a[32:35], a[60:63], v[80:83]
  ds_read_b64_tr_b16 a[44:45], v201 offset:1024
  v_mfma_f32_16x16x32_bf16 v[76:79], a[28:31], a[60:63], v[76:79]
  ds_read_b128 a[8:11], v209 offset:14336
  v_mfma_f32_16x16x32_bf16 v[72:75], a[24:27], a[60:63], v[72:75]
  buffer_load_dword a252, v214, s[12:15], s68 offen offset:384
  v_and_b32 v214, 0x1fff, v214
  v_mfma_f32_16x16x32_bf16 v[68:71], a[20:23], a[60:63], v[68:71]
  s_waitcnt lgkmcnt(6)
  ds_read_b64_tr_b16 a[46:47], v201 offset:7168
  v_mfma_f32_16x16x32_bf16 v[84:87], a[64:67], a[20:23], v[84:87]
  ds_read_b128 a[12:15], v209 offset:15360
  v_mfma_f32_16x16x32_bf16 v[88:91], a[64:67], a[24:27], v[88:91]
  ds_read_b128 a[16:19], v212 offset:20480
  v_mfma_f32_16x16x32_bf16 v[92:95], a[64:67], a[28:31], v[92:95]
  buffer_load_dwordx4 v205, s[36:39], s62 offen offset:0 sc1 lds
  v_mfma_f32_16x16x32_bf16 v[96:99], a[64:67], a[32:35], v[96:99]
  ds_read_b64_tr_b16 a[48:49], v200 offset:2048
  v_mfma_f32_16x16x32_bf16 v[112:115], a[68:71], a[32:35], v[112:115]
  ds_read_b64_tr_b16 a[50:51], v200 offset:8192
  v_mfma_f32_16x16x32_bf16 v[108:111], a[68:71], a[28:31], v[108:111]
  ds_read_b64_tr_b16 a[52:53], v201 offset:2048
  v_mfma_f32_16x16x32_bf16 v[104:107], a[68:71], a[24:27], v[104:107]
  buffer_load_dword a252, v214, s[4:7], s69 offen offset:384
  v_mfma_f32_16x16x32_bf16 v[100:103], a[68:71], a[20:23], v[100:103]
  s_waitcnt vmcnt(24) lgkmcnt(3)
  s_barrier
  ds_read_b64_tr_b16 a[54:55], v201 offset:8192
  v_mfma_f32_16x16x32_bf16 v[20:23], a[40:43], a[0:3], v[20:23]
  ds_read_b64_tr_b16 a[56:57], v200 offset:0
  v_mfma_f32_16x16x32_bf16 v[24:27], a[40:43], a[4:7], v[24:27]
  v_mfma_f32_16x16x32_bf16 v[28:31], a[40:43], a[8:11], v[28:31]
  buffer_load_dwordx4 v205, s[36:39], s62 offen offset:1024 sc1 lds
  s_add_u32 m0, s65, 106496
  v_mfma_f32_16x16x32_bf16 v[32:35], a[40:43], a[12:15], v[32:35]
  ds_read_b64_tr_b16 a[58:59], v200 offset:6144
  v_mfma_f32_16x16x32_bf16 v[116:119], a[40:43], a[16:19], v[116:119]
  ds_read_b64_tr_b16 a[60:61], v201 offset:0
  v_mfma_f32_16x16x32_bf16 v[48:51], a[44:47], a[12:15], v[48:51]
  v_mfma_f32_16x16x32_bf16 v[44:47], a[44:47], a[8:11], v[44:47]
  buffer_load_dword v206, s[36:39], s62 offen sc1 lds
  s_mov_b32 s61, 5898240
  v_mfma_f32_16x16x32_bf16 v[40:43], a[44:47], a[4:7], v[40:43]
  s_add_u32 m0, s63, 107520
  ds_read_b64_tr_b16 a[62:63], v201 offset:6144
  v_mfma_f32_16x16x32_bf16 v[36:39], a[44:47], a[0:3], v[36:39]
  s_waitcnt lgkmcnt(4)
  ds_read_b64_tr_b16 a[64:65], v196 offset:1024
  v_mfma_f32_16x16x32_bf16 v[52:55], a[0:3], a[48:51], v[52:55]
  ds_read_b128 a[20:23], v207 offset:12288
  v_mfma_f32_16x16x32_bf16 v[56:59], a[4:7], a[48:51], v[56:59]
  buffer_load_dwordx4 v202, s[8:11], s61 offen offset:0 lds
  v_mfma_f32_16x16x32_bf16 v[60:63], a[8:11], a[48:51], v[60:63]
  ds_read_b64_tr_b16 a[66:67], v196 offset:7168
  v_mfma_f32_16x16x32_bf16 v[64:67], a[12:15], a[48:51], v[64:67]
  ds_read_b128 a[24:27], v207 offset:13312
  v_mfma_f32_16x16x32_bf16 v[120:123], a[16:19], a[48:51], v[120:123]
  ds_read_b64_tr_b16 a[68:69], v197 offset:1024
  v_mfma_f32_16x16x32_bf16 v[80:83], a[12:15], a[52:55], v[80:83]
  buffer_load_dwordx4 v203, s[8:11], s61 offen offset:1024 lds
  v_mfma_f32_16x16x32_bf16 v[76:79], a[8:11], a[52:55], v[76:79]
  ds_read_b128 a[28:31], v207 offset:14336
  v_mfma_f32_16x16x32_bf16 v[72:75], a[4:7], a[52:55], v[72:75]
  ds_read_b64_tr_b16 a[70:71], v197 offset:7168
  v_mfma_f32_16x16x32_bf16 v[68:71], a[0:3], a[52:55], v[68:71]
  s_waitcnt lgkmcnt(7)
  ds_read_b128 a[32:35], v207 offset:15360
  v_mfma_f32_16x16x32_bf16 v[84:87], a[56:59], a[0:3], v[84:87]
  buffer_load_dwordx4 v204, s[8:11], s61 offen offset:2048 lds
  s_mov_b32 s62, 61440
  v_mfma_f32_16x16x32_bf16 v[88:91], a[56:59], a[4:7], v[88:91]
  s_add_u32 m0, s64, 119808
  ds_read_b128 a[36:39], v210 offset:20480
  v_mfma_f32_16x16x32_bf16 v[92:95], a[56:59], a[8:11], v[92:95]
  ds_read_b64_tr_b16 a[40:41], v196 offset:2048
  v_mfma_f32_16x16x32_bf16 v[96:99], a[56:59], a[12:15], v[96:99]
  ds_read_b64_tr_b16 a[42:43], v196 offset:8192
  v_mfma_f32_16x16x32_bf16 v[112:115], a[60:63], a[12:15], v[112:115]
  buffer_load_dwordx4 v205, s[36:39], s62 offen offset:0 sc1 lds
  v_mfma_f32_16x16x32_bf16 v[108:111], a[60:63], a[8:11], v[108:111]
  ds_read_b64_tr_b16 a[44:45], v197 offset:2048
  v_mfma_f32_16x16x32_bf16 v[104:107], a[60:63], a[4:7], v[104:107]
  ds_read_b64_tr_b16 a[46:47], v197 offset:8192
  v_mfma_f32_16x16x32_bf16 v[100:103], a[60:63], a[0:3], v[100:103]
  s_waitcnt vmcnt(24) lgkmcnt(4)
  s_barrier
  v_mfma_f32_16x16x32_bf16 v[20:23], a[64:67], a[20:23], v[20:23]
  buffer_load_dwordx4 v205, s[36:39], s62 offen offset:1024 sc1 lds
  s_add_u32 m0, s65, 128000
  v_mfma_f32_16x16x32_bf16 v[24:27], a[64:67], a[24:27], v[24:27]
  ds_read_b64_tr_b16 a[48:49], v196 offset:0
  v_mfma_f32_16x16x32_bf16 v[28:31], a[64:67], a[28:31], v[28:31]
  ds_read_b64_tr_b16 a[50:51], v196 offset:6144
  v_mfma_f32_16x16x32_bf16 v[32:35], a[64:67], a[32:35], v[32:35]
  v_mfma_f32_16x16x32_bf16 v[116:119], a[64:67], a[36:39], v[116:119]
  buffer_load_dword v206, s[36:39], s62 offen sc1 lds
  s_mov_b32 s61, 6094848
  v_mfma_f32_16x16x32_bf16 v[48:51], a[68:71], a[32:35], v[48:51]
  s_add_u32 m0, s63, 129024
  ds_read_b64_tr_b16 a[52:53], v197 offset:0
  v_mfma_f32_16x16x32_bf16 v[44:47], a[68:71], a[28:31], v[44:47]
  ds_read_b64_tr_b16 a[54:55], v197 offset:6144
  v_mfma_f32_16x16x32_bf16 v[40:43], a[68:71], a[24:27], v[40:43]
  v_mfma_f32_16x16x32_bf16 v[36:39], a[68:71], a[20:23], v[36:39]
  s_waitcnt lgkmcnt(4)
  buffer_load_dwordx4 v202, s[8:11], s61 offen offset:0 lds
  v_mfma_f32_16x16x32_bf16 v[52:55], a[20:23], a[40:43], v[52:55]
  ds_read_b64_tr_b16 a[56:57], v196 offset:22528
  v_mfma_f32_16x16x32_bf16 v[56:59], a[24:27], a[40:43], v[56:59]
  ds_read_b128 a[0:3], v207 offset:33792
  v_mfma_f32_16x16x32_bf16 v[60:63], a[28:31], a[40:43], v[60:63]
  ds_read_b64_tr_b16 a[58:59], v196 offset:28672
  v_mfma_f32_16x16x32_bf16 v[64:67], a[32:35], a[40:43], v[64:67]
  buffer_load_dwordx4 v203, s[8:11], s61 offen offset:1024 lds
  v_mfma_f32_16x16x32_bf16 v[120:123], a[36:39], a[40:43], v[120:123]
  ds_read_b128 a[4:7], v207 offset:34816
  v_mfma_f32_16x16x32_bf16 v[80:83], a[32:35], a[44:47], v[80:83]
  ds_read_b64_tr_b16 a[60:61], v197 offset:22528
  v_mfma_f32_16x16x32_bf16 v[76:79], a[28:31], a[44:47], v[76:79]
  ds_read_b128 a[8:11], v207 offset:35840
  v_mfma_f32_16x16x32_bf16 v[72:75], a[24:27], a[44:47], v[72:75]
  buffer_load_dwordx4 v204, s[8:11], s61 offen offset:2048 lds
  s_mov_b32 s62, 63488
  v_mfma_f32_16x16x32_bf16 v[68:71], a[20:23], a[44:47], v[68:71]
  s_waitcnt lgkmcnt(6)
  s_add_u32 m0, s64, 141312
  ds_read_b64_tr_b16 a[62:63], v197 offset:28672
  v_mfma_f32_16x16x32_bf16 v[84:87], a[48:51], a[20:23], v[84:87]
  ds_read_b128 a[12:15], v207 offset:36864
  v_mfma_f32_16x16x32_bf16 v[88:91], a[48:51], a[24:27], v[88:91]
  ds_read_b128 a[16:19], v210 offset:41984
  v_mfma_f32_16x16x32_bf16 v[92:95], a[48:51], a[28:31], v[92:95]
  buffer_load_dwordx4 v205, s[36:39], s62 offen offset:0 sc1 lds
  v_mfma_f32_16x16x32_bf16 v[96:99], a[48:51], a[32:35], v[96:99]
  ds_read_b64_tr_b16 a[64:65], v196 offset:23552
  v_mfma_f32_16x16x32_bf16 v[112:115], a[52:55], a[32:35], v[112:115]
  ds_read_b64_tr_b16 a[66:67], v196 offset:29696
  v_mfma_f32_16x16x32_bf16 v[108:111], a[52:55], a[28:31], v[108:111]
  ds_read_b64_tr_b16 a[68:69], v197 offset:23552
  v_mfma_f32_16x16x32_bf16 v[104:107], a[52:55], a[24:27], v[104:107]
  buffer_load_dwordx4 v205, s[36:39], s62 offen offset:1024 sc1 lds
  s_add_u32 m0, s65, 149504
  v_mfma_f32_16x16x32_bf16 v[100:103], a[52:55], a[20:23], v[100:103]
  s_waitcnt vmcnt(25) lgkmcnt(3)
  s_barrier
  ds_read_b64_tr_b16 a[70:71], v197 offset:29696
  v_mfma_f32_16x16x32_bf16 v[20:23], a[56:59], a[0:3], v[20:23]
  ds_read_b64_tr_b16 a[40:41], v196 offset:21504
  v_mfma_f32_16x16x32_bf16 v[24:27], a[56:59], a[4:7], v[24:27]
  v_mfma_f32_16x16x32_bf16 v[28:31], a[56:59], a[8:11], v[28:31]
  buffer_load_dword v206, s[36:39], s62 offen sc1 lds
  s_nop 0
  v_mfma_f32_16x16x32_bf16 v[32:35], a[56:59], a[12:15], v[32:35]
  s_mov_b32 s50, 0
  s_add_u32 m0, s70, 0
  ds_read_b64_tr_b16 a[42:43], v196 offset:27648
  v_mfma_f32_16x16x32_bf16 v[116:119], a[56:59], a[16:19], v[116:119]
  ds_read_b64_tr_b16 a[44:45], v197 offset:21504
  v_mfma_f32_16x16x32_bf16 v[48:51], a[60:63], a[12:15], v[48:51]
  v_mfma_f32_16x16x32_bf16 v[44:47], a[60:63], a[8:11], v[44:47]
  buffer_load_dwordx4 v216, s[12:15], s50 offen offset:0 lds
  v_mfma_f32_16x16x32_bf16 v[40:43], a[60:63], a[4:7], v[40:43]
  ds_read_b64_tr_b16 a[46:47], v197 offset:27648
  v_mfma_f32_16x16x32_bf16 v[36:39], a[60:63], a[0:3], v[36:39]
  s_waitcnt lgkmcnt(4)
  ds_read_b64_tr_b16 a[48:49], v196 offset:44032
  v_mfma_f32_16x16x32_bf16 v[52:55], a[0:3], a[64:67], v[52:55]
  ds_read_b128 a[20:23], v207 offset:55296
  v_mfma_f32_16x16x32_bf16 v[56:59], a[4:7], a[64:67], v[56:59]
  buffer_load_dwordx4 v217, s[12:15], s50 offen offset:1024 lds
  v_mfma_f32_16x16x32_bf16 v[60:63], a[8:11], a[64:67], v[60:63]
  ds_read_b64_tr_b16 a[50:51], v196 offset:50176
  v_mfma_f32_16x16x32_bf16 v[64:67], a[12:15], a[64:67], v[64:67]
  ds_read_b128 a[24:27], v207 offset:56320
  v_mfma_f32_16x16x32_bf16 v[120:123], a[16:19], a[64:67], v[120:123]
  ds_read_b64_tr_b16 a[52:53], v197 offset:44032
  v_mfma_f32_16x16x32_bf16 v[80:83], a[12:15], a[68:71], v[80:83]
  buffer_load_dwordx4 v218, s[12:15], s50 offen offset:2048 lds
  v_mfma_f32_16x16x32_bf16 v[76:79], a[8:11], a[68:71], v[76:79]
  ds_read_b128 a[28:31], v207 offset:57344
  v_mfma_f32_16x16x32_bf16 v[72:75], a[4:7], a[68:71], v[72:75]
  ds_read_b64_tr_b16 a[54:55], v197 offset:50176
  v_mfma_f32_16x16x32_bf16 v[68:71], a[0:3], a[68:71], v[68:71]
  s_waitcnt lgkmcnt(7)
  ds_read_b128 a[32:35], v207 offset:58368
  v_mfma_f32_16x16x32_bf16 v[84:87], a[40:43], a[0:3], v[84:87]
  buffer_load_dwordx4 v219, s[12:15], s50 offen offset:3072 lds
  s_bfe_u32 s66, s2, 0x30004
  v_mfma_f32_16x16x32_bf16 v[88:91], a[40:43], a[4:7], v[88:91]
  s_and_b32 s67, s2, 3
  s_lshl3_add_u32 s66, s67, s66
  s_lshl2_add_u32 s66, s66, s44
  v_mfma_f32_16x16x32_bf16 v[92:95], a[40:43], a[8:11], v[92:95]
  s_mul_i32 s66, s66, 98304
  s_and_b32 s67, s51, 0x3800
  s_add_u32 s66, s66, s67
  v_mfma_f32_16x16x32_bf16 v[96:99], a[40:43], a[12:15], v[96:99]
  s_and_b32 s67, s2, 8
  s_lshl_b32 s67, s67, 7
  s_add_u32 s66, s66, s67
  v_mfma_f32_16x16x32_bf16 v[112:115], a[44:47], a[12:15], v[112:115]
  ds_read_b128 a[36:39], v210 offset:63488
  v_and_b32 v215, 7, v10
  v_mfma_f32_16x16x32_bf16 v[108:111], a[44:47], a[8:11], v[108:111]
  ds_read_b64_tr_b16 a[56:57], v196 offset:45056
  v_mul_u32_u24 v215, 12288, v215
  v_mfma_f32_16x16x32_bf16 v[104:107], a[44:47], a[4:7], v[104:107]
  buffer_load_dword a252, v215, s[28:31], s66 offen offset:384
  v_mfma_f32_16x16x32_bf16 v[100:103], a[44:47], a[0:3], v[100:103]
  s_waitcnt vmcnt(25) lgkmcnt(1)
  s_barrier
  ds_read_b64_tr_b16 a[58:59], v196 offset:51200
  v_mfma_f32_16x16x32_bf16 v[20:23], a[48:51], a[20:23], v[20:23]
  ds_read_b64_tr_b16 a[60:61], v197 offset:45056
  v_mfma_f32_16x16x32_bf16 v[24:27], a[48:51], a[24:27], v[24:27]
  ds_read_b64_tr_b16 a[62:63], v197 offset:51200
  v_mfma_f32_16x16x32_bf16 v[28:31], a[48:51], a[28:31], v[28:31]
  buffer_load_dwordx4 v[136:139], v176, s[28:31], s51 offen nt
  s_add_u32 s51, s51, 12288
  v_mfma_f32_16x16x32_bf16 v[32:35], a[48:51], a[32:35], v[32:35]
  ds_read_b64_tr_b16 a[64:65], v196 offset:43008
  v_mfma_f32_16x16x32_bf16 v[116:119], a[48:51], a[36:39], v[116:119]
  ds_read_b64_tr_b16 a[66:67], v196 offset:49152
  v_mfma_f32_16x16x32_bf16 v[48:51], a[52:55], a[32:35], v[48:51]
  ds_read_b64_tr_b16 a[68:69], v197 offset:43008
  v_mfma_f32_16x16x32_bf16 v[44:47], a[52:55], a[28:31], v[44:47]
  buffer_load_dwordx4 v[140:143], v176, s[28:31], s51 offen nt
  s_add_u32 s51, s51, 12288
  v_mfma_f32_16x16x32_bf16 v[40:43], a[52:55], a[24:27], v[40:43]
  ds_read_b64_tr_b16 a[70:71], v197 offset:49152
  v_mfma_f32_16x16x32_bf16 v[36:39], a[52:55], a[20:23], v[36:39]
  s_waitcnt lgkmcnt(4)
  ds_read_b64_tr_b16 a[40:41], v198 offset:1024
  v_mfma_f32_16x16x32_bf16 v[52:55], a[20:23], a[56:59], v[52:55]
  ds_read_b128 a[0:3], v208 offset:12288
  v_mfma_f32_16x16x32_bf16 v[56:59], a[24:27], a[56:59], v[56:59]
  buffer_load_dwordx4 v[144:147], v176, s[28:31], s51 offen nt
  s_add_u32 s51, s51, 12288
  v_mfma_f32_16x16x32_bf16 v[60:63], a[28:31], a[56:59], v[60:63]
  ds_read_b64_tr_b16 a[42:43], v198 offset:7168
  v_mfma_f32_16x16x32_bf16 v[64:67], a[32:35], a[56:59], v[64:67]
  ds_read_b128 a[4:7], v208 offset:13312
  v_mfma_f32_16x16x32_bf16 v[120:123], a[36:39], a[56:59], v[120:123]
  ds_read_b64_tr_b16 a[44:45], v199 offset:1024
  v_mfma_f32_16x16x32_bf16 v[80:83], a[32:35], a[60:63], v[80:83]
  buffer_load_dwordx4 v[148:151], v176, s[28:31], s51 offen nt
  s_add_u32 s51, s51, 12288
  v_mfma_f32_16x16x32_bf16 v[76:79], a[28:31], a[60:63], v[76:79]
  ds_read_b128 a[8:11], v208 offset:14336
  v_mfma_f32_16x16x32_bf16 v[72:75], a[24:27], a[60:63], v[72:75]
  ds_read_b64_tr_b16 a[46:47], v199 offset:7168
  v_mfma_f32_16x16x32_bf16 v[68:71], a[20:23], a[60:63], v[68:71]
  s_waitcnt lgkmcnt(7)
  ds_read_b128 a[12:15], v208 offset:15360
  v_mfma_f32_16x16x32_bf16 v[84:87], a[64:67], a[20:23], v[84:87]
  buffer_load_dwordx4 v[152:155], v176, s[28:31], s51 offen nt
  s_add_u32 s51, s51, 12288
  v_mfma_f32_16x16x32_bf16 v[88:91], a[64:67], a[24:27], v[88:91]
  ds_read_b128 a[16:19], v211 offset:20480
  v_mfma_f32_16x16x32_bf16 v[92:95], a[64:67], a[28:31], v[92:95]
  ds_read_b64_tr_b16 a[48:49], v198 offset:2048
  v_mfma_f32_16x16x32_bf16 v[96:99], a[64:67], a[32:35], v[96:99]
  ds_read_b64_tr_b16 a[50:51], v198 offset:8192
  v_mfma_f32_16x16x32_bf16 v[112:115], a[68:71], a[32:35], v[112:115]
  buffer_load_dwordx4 v[156:159], v176, s[28:31], s51 offen nt
  s_add_u32 s51, s51, 12288
  v_mfma_f32_16x16x32_bf16 v[108:111], a[68:71], a[28:31], v[108:111]
  ds_read_b64_tr_b16 a[52:53], v199 offset:2048
  v_mfma_f32_16x16x32_bf16 v[104:107], a[68:71], a[24:27], v[104:107]
  ds_read_b64_tr_b16 a[54:55], v199 offset:8192
  v_mfma_f32_16x16x32_bf16 v[100:103], a[68:71], a[20:23], v[100:103]
  s_waitcnt vmcnt(23) lgkmcnt(4)
  s_barrier
  v_mfma_f32_16x16x32_bf16 v[20:23], a[40:43], a[0:3], v[20:23]
  buffer_load_dwordx4 v[160:163], v176, s[28:31], s51 offen nt
  s_add_u32 s51, s51, 12288
  v_mfma_f32_16x16x32_bf16 v[24:27], a[40:43], a[4:7], v[24:27]
  ds_read_b64_tr_b16 a[56:57], v198 offset:0
  v_mfma_f32_16x16x32_bf16 v[28:31], a[40:43], a[8:11], v[28:31]
  ds_read_b64_tr_b16 a[58:59], v198 offset:6144
  v_mfma_f32_16x16x32_bf16 v[32:35], a[40:43], a[12:15], v[32:35]
  v_mfma_f32_16x16x32_bf16 v[116:119], a[40:43], a[16:19], v[116:119]
  buffer_load_dwordx4 v[164:167], v176, s[28:31], s51 offen nt
  v_lshrrev_b32 v215, 2, v10
  v_mfma_f32_16x16x32_bf16 v[48:51], a[44:47], a[12:15], v[48:51]
  ds_read_b64_tr_b16 a[60:61], v199 offset:0
  v_min_u32 v215, (XEND-G3S)/4096, v215
  v_mfma_f32_16x16x32_bf16 v[44:47], a[44:47], a[8:11], v[44:47]
  ds_read_b64_tr_b16 a[62:63], v199 offset:6144
  v_and_b32 v213, 3, v10
  v_mfma_f32_16x16x32_bf16 v[40:43], a[44:47], a[4:7], v[40:43]
  v_lshlrev_b32 v213, 7, v213
  v_lshl_add_u32 v215, v215, 12, v213
  v_mfma_f32_16x16x32_bf16 v[36:39], a[44:47], a[0:3], v[36:39]
  s_waitcnt lgkmcnt(4)
  s_add_u32 s94, s92, AL-adaLN_cond__sliding_local_dilated__swiglu_ffn__prompt_kernel+((G3S-AL+4095)/4096)*4096
  s_addc_u32 s95, s93, 0
  v_mfma_f32_16x16x32_bf16 v[52:55], a[0:3], a[48:51], v[52:55]
  global_load_dword a252, v215, s[94:95]
  s_and_b32 s66, s44, 1
  v_mfma_f32_16x16x32_bf16 v[56:59], a[4:7], a[48:51], v[56:59]
  s_lshl1_add_u32 s66, s2, s66
  s_mul_i32 s66, s66, 2688
  ds_read_b64_tr_b16 a[64:65], v198 offset:22528
  v_mfma_f32_16x16x32_bf16 v[60:63], a[8:11], a[48:51], v[60:63]
  ds_read_b128 a[20:23], v208 offset:33792
  v_min_u32 v215, 20, v10
  v_mfma_f32_16x16x32_bf16 v[64:67], a[12:15], a[48:51], v[64:67]
  ds_read_b64_tr_b16 a[66:67], v198 offset:28672
  v_lshlrev_b32 v215, 7, v215
  v_mfma_f32_16x16x32_bf16 v[120:123], a[16:19], a[48:51], v[120:123]
  buffer_load_dword a252, v215, s[16:19], s66 offen
  v_mfma_f32_16x16x32_bf16 v[80:83], a[12:15], a[52:55], v[80:83]
  ds_read_b128 a[24:27], v208 offset:34816
  v_mfma_f32_16x16x32_bf16 v[76:79], a[8:11], a[52:55], v[76:79]
  ds_read_b64_tr_b16 a[68:69], v199 offset:22528
  v_mfma_f32_16x16x32_bf16 v[72:75], a[4:7], a[52:55], v[72:75]
  ds_read_b128 a[28:31], v208 offset:35840
  v_mfma_f32_16x16x32_bf16 v[68:71], a[0:3], a[52:55], v[68:71]
  s_waitcnt lgkmcnt(6)
  ds_read_b64_tr_b16 a[70:71], v199 offset:28672
  v_mfma_f32_16x16x32_bf16 v[84:87], a[56:59], a[0:3], v[84:87]
  ds_read_b128 a[32:35], v208 offset:36864
  v_mfma_f32_16x16x32_bf16 v[88:91], a[56:59], a[4:7], v[88:91]
  ds_read_b128 a[36:39], v211 offset:41984
  v_mfma_f32_16x16x32_bf16 v[92:95], a[56:59], a[8:11], v[92:95]
  ds_read_b64_tr_b16 a[40:41], v198 offset:23552
  v_mfma_f32_16x16x32_bf16 v[96:99], a[56:59], a[12:15], v[96:99]
  ds_read_b64_tr_b16 a[42:43], v198 offset:29696
  v_mfma_f32_16x16x32_bf16 v[112:115], a[60:63], a[12:15], v[112:115]
  ds_read_b64_tr_b16 a[44:45], v199 offset:23552
  v_mfma_f32_16x16x32_bf16 v[108:111], a[60:63], a[8:11], v[108:111]
  v_mfma_f32_16x16x32_bf16 v[104:107], a[60:63], a[4:7], v[104:107]
  ds_read_b64_tr_b16 a[46:47], v199 offset:29696
  v_mfma_f32_16x16x32_bf16 v[100:103], a[60:63], a[0:3], v[100:103]
  s_waitcnt vmcnt(21) lgkmcnt(4)
  s_barrier
  v_mfma_f32_16x16x32_bf16 v[20:23], a[64:67], a[20:23], v[20:23]
  ds_read_b64_tr_b16 a[48:49], v198 offset:21504
  v_mfma_f32_16x16x32_bf16 v[24:27], a[64:67], a[24:27], v[24:27]
  v_mfma_f32_16x16x32_bf16 v[28:31], a[64:67], a[28:31], v[28:31]
  ds_read_b64_tr_b16 a[50:51], v198 offset:27648
  v_mfma_f32_16x16x32_bf16 v[32:35], a[64:67], a[32:35], v[32:35]
  v_mfma_f32_16x16x32_bf16 v[116:119], a[64:67], a[36:39], v[116:119]
  ds_read_b64_tr_b16 a[52:53], v199 offset:21504
  v_mfma_f32_16x16x32_bf16 v[48:51], a[68:71], a[32:35], v[48:51]
  v_mfma_f32_16x16x32_bf16 v[44:47], a[68:71], a[28:31], v[44:47]
  ds_read_b64_tr_b16 a[54:55], v199 offset:27648
  v_mfma_f32_16x16x32_bf16 v[40:43], a[68:71], a[24:27], v[40:43]
  v_mfma_f32_16x16x32_bf16 v[36:39], a[68:71], a[20:23], v[36:39]
  s_waitcnt lgkmcnt(4)
  ds_read_b64_tr_b16 a[56:57], v198 offset:44032
  v_mfma_f32_16x16x32_bf16 v[52:55], a[20:23], a[40:43], v[52:55]
  ds_read_b128 a[0:3], v208 offset:55296
  v_mfma_f32_16x16x32_bf16 v[56:59], a[24:27], a[40:43], v[56:59]
  ds_read_b64_tr_b16 a[58:59], v198 offset:50176
  v_mfma_f32_16x16x32_bf16 v[60:63], a[28:31], a[40:43], v[60:63]
  ds_read_b128 a[4:7], v208 offset:56320
  v_mfma_f32_16x16x32_bf16 v[64:67], a[32:35], a[40:43], v[64:67]
  v_mfma_f32_16x16x32_bf16 v[120:123], a[36:39], a[40:43], v[120:123]
  ds_read_b64_tr_b16 a[60:61], v199 offset:44032
  v_mfma_f32_16x16x32_bf16 v[80:83], a[32:35], a[44:47], v[80:83]
  ds_read_b128 a[8:11], v208 offset:57344
  v_mfma_f32_16x16x32_bf16 v[76:79], a[28:31], a[44:47], v[76:79]
  ds_read_b64_tr_b16 a[62:63], v199 offset:50176
  v_mfma_f32_16x16x32_bf16 v[72:75], a[24:27], a[44:47], v[72:75]
  ds_read_b128 a[12:15], v208 offset:58368
  v_mfma_f32_16x16x32_bf16 v[68:71], a[20:23], a[44:47], v[68:71]
  s_waitcnt lgkmcnt(8)
  ds_read_b128 a[16:19], v211 offset:63488
  v_mfma_f32_16x16x32_bf16 v[84:87], a[48:51], a[20:23], v[84:87]
  ds_read_b64_tr_b16 a[64:65], v198 offset:45056
  v_mfma_f32_16x16x32_bf16 v[88:91], a[48:51], a[24:27], v[88:91]
  ds_read_b64_tr_b16 a[66:67], v198 offset:51200
  v_mfma_f32_16x16x32_bf16 v[92:95], a[48:51], a[28:31], v[92:95]
  v_mfma_f32_16x16x32_bf16 v[96:99], a[48:51], a[32:35], v[96:99]
  v_mfma_f32_16x16x32_bf16 v[112:115], a[52:55], a[32:35], v[112:115]
  ds_read_b64_tr_b16 a[68:69], v199 offset:45056
  v_mfma_f32_16x16x32_bf16 v[108:111], a[52:55], a[28:31], v[108:111]
  v_mfma_f32_16x16x32_bf16 v[104:107], a[52:55], a[24:27], v[104:107]
  ds_read_b64_tr_b16 a[70:71], v199 offset:51200
  v_mfma_f32_16x16x32_bf16 v[100:103], a[52:55], a[20:23], v[100:103]
  s_waitcnt vmcnt(15) lgkmcnt(4)
  s_barrier
  v_mfma_f32_16x16x32_bf16 v[20:23], a[56:59], a[0:3], v[20:23]
  ds_read_b64_tr_b16 a[40:41], v198 offset:43008
  v_mfma_f32_16x16x32_bf16 v[24:27], a[56:59], a[4:7], v[24:27]
  v_mfma_f32_16x16x32_bf16 v[28:31], a[56:59], a[8:11], v[28:31]
  ds_read_b64_tr_b16 a[42:43], v198 offset:49152
  v_mfma_f32_16x16x32_bf16 v[32:35], a[56:59], a[12:15], v[32:35]
  v_mfma_f32_16x16x32_bf16 v[116:119], a[56:59], a[16:19], v[116:119]
  ds_read_b64_tr_b16 a[44:45], v199 offset:43008
  v_mfma_f32_16x16x32_bf16 v[48:51], a[60:63], a[12:15], v[48:51]
  v_mfma_f32_16x16x32_bf16 v[44:47], a[60:63], a[8:11], v[44:47]
  ds_read_b64_tr_b16 a[46:47], v199 offset:49152
  v_mfma_f32_16x16x32_bf16 v[40:43], a[60:63], a[4:7], v[40:43]
  v_mfma_f32_16x16x32_bf16 v[36:39], a[60:63], a[0:3], v[36:39]
  s_waitcnt lgkmcnt(4)
  ds_read_b64_tr_b16 a[48:49], v200 offset:1024
  v_mfma_f32_16x16x32_bf16 v[52:55], a[0:3], a[64:67], v[52:55]
  ds_read_b128 a[20:23], v209 offset:12288
  v_mfma_f32_16x16x32_bf16 v[56:59], a[4:7], a[64:67], v[56:59]
  ds_read_b64_tr_b16 a[50:51], v200 offset:7168
  v_mfma_f32_16x16x32_bf16 v[60:63], a[8:11], a[64:67], v[60:63]
  ds_read_b128 a[24:27], v209 offset:13312
  v_mfma_f32_16x16x32_bf16 v[64:67], a[12:15], a[64:67], v[64:67]
  v_mfma_f32_16x16x32_bf16 v[120:123], a[16:19], a[64:67], v[120:123]
  ds_read_b64_tr_b16 a[52:53], v201 offset:1024
  v_mfma_f32_16x16x32_bf16 v[80:83], a[12:15], a[68:71], v[80:83]
  ds_read_b128 a[28:31], v209 offset:14336
  v_mfma_f32_16x16x32_bf16 v[76:79], a[8:11], a[68:71], v[76:79]
  ds_read_b64_tr_b16 a[54:55], v201 offset:7168
  v_mfma_f32_16x16x32_bf16 v[72:75], a[4:7], a[68:71], v[72:75]
  ds_read_b128 a[32:35], v209 offset:15360
  v_mfma_f32_16x16x32_bf16 v[68:71], a[0:3], a[68:71], v[68:71]
  s_waitcnt lgkmcnt(8)
  ds_read_b128 a[36:39], v212 offset:20480
  v_mfma_f32_16x16x32_bf16 v[84:87], a[40:43], a[0:3], v[84:87]
  ds_read_b64_tr_b16 a[56:57], v200 offset:2048
  v_mfma_f32_16x16x32_bf16 v[88:91], a[40:43], a[4:7], v[88:91]
  ds_read_b64_tr_b16 a[58:59], v200 offset:8192
  v_mfma_f32_16x16x32_bf16 v[92:95], a[40:43], a[8:11], v[92:95]
  v_mfma_f32_16x16x32_bf16 v[96:99], a[40:43], a[12:15], v[96:99]
  v_mfma_f32_16x16x32_bf16 v[112:115], a[44:47], a[12:15], v[112:115]
  ds_read_b64_tr_b16 a[60:61], v201 offset:2048
  v_mfma_f32_16x16x32_bf16 v[108:111], a[44:47], a[8:11], v[108:111]
  v_mfma_f32_16x16x32_bf16 v[104:107], a[44:47], a[4:7], v[104:107]
  ds_read_b64_tr_b16 a[62:63], v201 offset:8192
  v_mfma_f32_16x16x32_bf16 v[100:103], a[44:47], a[0:3], v[100:103]
  s_waitcnt lgkmcnt(4)
  v_mfma_f32_16x16x32_bf16 v[20:23], a[48:51], a[20:23], v[20:23]
  ds_read_b64_tr_b16 a[64:65], v200 offset:0
  v_mfma_f32_16x16x32_bf16 v[24:27], a[48:51], a[24:27], v[24:27]
  v_mfma_f32_16x16x32_bf16 v[28:31], a[48:51], a[28:31], v[28:31]
  ds_read_b64_tr_b16 a[66:67], v200 offset:6144
  v_mfma_f32_16x16x32_bf16 v[32:35], a[48:51], a[32:35], v[32:35]
  v_mfma_f32_16x16x32_bf16 v[116:119], a[48:51], a[36:39], v[116:119]
  ds_read_b64_tr_b16 a[68:69], v201 offset:0
  v_mfma_f32_16x16x32_bf16 v[48:51], a[52:55], a[32:35], v[48:51]
  v_mfma_f32_16x16x32_bf16 v[44:47], a[52:55], a[28:31], v[44:47]
  ds_read_b64_tr_b16 a[70:71], v201 offset:6144
  v_mfma_f32_16x16x32_bf16 v[40:43], a[52:55], a[24:27], v[40:43]
  v_mfma_f32_16x16x32_bf16 v[36:39], a[52:55], a[20:23], v[36:39]
  s_waitcnt lgkmcnt(4)
  v_mfma_f32_16x16x32_bf16 v[52:55], a[20:23], a[56:59], v[52:55]
  v_cvt_pk_bf16_f32 v116, v116, v117
  v_cvt_pk_bf16_f32 v117, v118, v119
  v_mfma_f32_16x16x32_bf16 v[56:59], a[24:27], a[56:59], v[56:59]
  v_cvt_pk_bf16_f32 v32, v32, v33
  v_cvt_pk_bf16_f32 v33, v34, v35
  v_mfma_f32_16x16x32_bf16 v[60:63], a[28:31], a[56:59], v[60:63]
  v_cvt_pk_bf16_f32 v34, v48, v49
  v_cvt_pk_bf16_f32 v35, v50, v51
  v_mfma_f32_16x16x32_bf16 v[64:67], a[32:35], a[56:59], v[64:67]
  ds_write_b64 v224, v[116:117]
  v_mfma_f32_16x16x32_bf16 v[120:123], a[36:39], a[56:59], v[120:123]
  ds_write_b64 v222, v[32:33]
  v_mfma_f32_16x16x32_bf16 v[80:83], a[32:35], a[60:63], v[80:83]
  ds_write_b64 v223, v[34:35]
  v_mfma_f32_16x16x32_bf16 v[76:79], a[28:31], a[60:63], v[76:79]
  v_cvt_pk_bf16_f32 v55, v54, v55
  v_cvt_pk_bf16_f32 v54, v52, v53
  v_mfma_f32_16x16x32_bf16 v[72:75], a[24:27], a[60:63], v[72:75]
  v_cvt_pk_bf16_f32 v56, v56, v57
  v_cvt_pk_bf16_f32 v57, v58, v59
  v_mfma_f32_16x16x32_bf16 v[68:71], a[20:23], a[60:63], v[68:71]
  s_waitcnt lgkmcnt(3)
  v_cvt_pk_bf16_f32 v58, v60, v61
  v_cvt_pk_bf16_f32 v59, v62, v63
  v_mfma_f32_16x16x32_bf16 v[84:87], a[64:67], a[20:23], v[84:87]
  v_cvt_pk_bf16_f32 v60, v64, v65
  v_cvt_pk_bf16_f32 v61, v66, v67
  v_mfma_f32_16x16x32_bf16 v[88:91], a[64:67], a[24:27], v[88:91]
  v_cvt_pk_bf16_f32 v120, v120, v121
  v_cvt_pk_bf16_f32 v121, v122, v123
  v_mfma_f32_16x16x32_bf16 v[92:95], a[64:67], a[28:31], v[92:95]
  ds_write_b64 v222, v[60:61] offset:1024
  v_mfma_f32_16x16x32_bf16 v[96:99], a[64:67], a[32:35], v[96:99]
  ds_write_b64 v224, v[120:121] offset:1024
  v_cvt_pk_bf16_f32 v71, v70, v71
  v_mfma_f32_16x16x32_bf16 v[112:115], a[68:71], a[32:35], v[112:115]
  v_cvt_pk_bf16_f32 v70, v68, v69
  v_cvt_pk_bf16_f32 v72, v72, v73
  v_mfma_f32_16x16x32_bf16 v[108:111], a[68:71], a[28:31], v[108:111]
  v_cvt_pk_bf16_f32 v73, v74, v75
  v_cvt_pk_bf16_f32 v74, v76, v77
  v_mfma_f32_16x16x32_bf16 v[104:107], a[68:71], a[24:27], v[104:107]
  v_cvt_pk_bf16_f32 v75, v78, v79
  v_cvt_pk_bf16_f32 v76, v80, v81
  v_mfma_f32_16x16x32_bf16 v[100:103], a[68:71], a[20:23], v[100:103]
  v_cvt_pk_bf16_f32 v77, v82, v83
  ds_write_b64 v223, v[76:77] offset:1024
  v_cvt_pk_bf16_f32 v28, v28, v29
  v_cvt_pk_bf16_f32 v29, v30, v31
  v_cvt_pk_bf16_f32 v30, v44, v45
  v_cvt_pk_bf16_f32 v31, v46, v47
  v_cvt_pk_bf16_f32 v24, v24, v25
  v_cvt_pk_bf16_f32 v25, v26, v27
  v_cvt_pk_bf16_f32 v26, v40, v41
  v_cvt_pk_bf16_f32 v27, v42, v43
  v_cvt_pk_bf16_f32 v20, v20, v21
  v_cvt_pk_bf16_f32 v21, v22, v23
  v_cvt_pk_bf16_f32 v22, v36, v37
  v_cvt_pk_bf16_f32 v23, v38, v39
  s_waitcnt lgkmcnt(0)
  s_barrier
  ds_read_b64 v[124:125], v225
  ds_read_b64 v[126:127], v226
  ds_read_b64 v[52:53], v227 offset:1024
  ds_read_b64 v[68:69], v227 offset:1032
  v_cvt_pk_bf16_f32 v96, v96, v97
  v_cvt_pk_bf16_f32 v97, v98, v99
  v_cvt_pk_bf16_f32 v98, v112, v113
  v_cvt_pk_bf16_f32 v99, v114, v115
  v_cvt_pk_bf16_f32 v92, v92, v93
  v_cvt_pk_bf16_f32 v93, v94, v95
  v_cvt_pk_bf16_f32 v94, v108, v109
  v_cvt_pk_bf16_f32 v95, v110, v111
  v_mfma_f32_16x16x32_bf16 v[112:115], v[32:35], v[96:99], 0
Ha1_1:
  s_cbranch_execz Ra
  v_mfma_f32_16x16x32_bf16 v[48:51], v[28:31], v[96:99], 0
  v_cvt_pk_bf16_f32 v88, v88, v89
  v_cvt_pk_bf16_f32 v89, v90, v91
  v_cvt_pk_bf16_f32 v90, v104, v105
  v_cvt_pk_bf16_f32 v91, v106, v107
  v_mfma_f32_16x16x32_bf16 v[108:111], v[28:31], v[92:95], 0
  v_mfma_f32_16x16x32_bf16 v[44:47], v[24:27], v[92:95], 0
  v_cvt_pk_bf16_f32 v84, v84, v85
  v_cvt_pk_bf16_f32 v85, v86, v87
  v_cvt_pk_bf16_f32 v86, v100, v101
  v_cvt_pk_bf16_f32 v87, v102, v103
  v_mfma_f32_16x16x32_bf16 v[104:107], v[24:27], v[88:91], 0
  v_mfma_f32_16x16x32_bf16 v[40:43], v[20:23], v[88:91], 0
  s_cmp_eq_u32 s57, 0
  s_cselect_b64 s[66:67], s[78:79], 0
  s_cselect_b64 s[68:69], s[80:81], 0
  s_waitcnt lgkmcnt(2)
  v_mfma_f32_16x16x32_bf16 v[100:103], v[20:23], v[84:87], 0
  v_mfma_f32_16x16x32_bf16 v[36:39], v[124:127], v[84:87], 0
  s_cmp_eq_u32 s59, 0
  s_cbranch_scc1 F_sw
  v_swap_b32 v54, v70
  v_swap_b32 v55, v71
  v_swap_b32 v56, v72
  v_swap_b32 v57, v73
  v_swap_b32 v58, v74
  v_swap_b32 v59, v75
  v_swap_b32 v60, v76
  v_swap_b32 v61, v77
F_sw:
  v_mov_b32 v12, 0xcfa8965f
  s_mov_b32 s50, 262144
  s_add_u32 m0, s70, 16384
  s_nop 0
  buffer_load_dwordx4 v216, s[12:15], s50 offen offset:0 lds
  v_mov_b32 v14, 0x3e8293ee
  v_cndmask_b32 v194, v112, v113, s[76:77]
  v_cndmask_b32 v195, v114, v115, s[76:77]
  v_cndmask_b32 v192, v48, v49, s[76:77]
  v_cndmask_b32 v193, v50, v51, s[76:77]
  v_cndmask_b32 v190, v108, v109, s[76:77]
  v_cndmask_b32 v191, v110, v111, s[76:77]
  v_cndmask_b32 v188, v44, v45, s[76:77]
  v_cndmask_b32 v189, v46, v47, s[76:77]
  v_cndmask_b32 v186, v104, v105, s[76:77]
  buffer_load_dwordx4 v217, s[12:15], s50 offen offset:1024 lds
  v_cndmask_b32 v187, v106, v107, s[76:77]
  v_cndmask_b32 v184, v40, v41, s[76:77]
  v_cndmask_b32 v185, v42, v43, s[76:77]
  v_cndmask_b32 v182, v100, v101, s[76:77]
  v_cndmask_b32 v183, v102, v103, s[76:77]
  v_cndmask_b32 v180, v36, v37, s[76:77]
  v_cndmask_b32 v181, v38, v39, s[76:77]
  v_cndmask_b32 v192, v194, v192, s[78:79]
  v_cndmask_b32 v193, v195, v193, s[80:81]
  v_cndmask_b32 v188, v190, v188, s[78:79]
  buffer_load_dwordx4 v218, s[12:15], s50 offen offset:2048 lds
  v_cndmask_b32 v189, v191, v189, s[80:81]
  v_cndmask_b32 v184, v186, v184, s[78:79]
  v_cndmask_b32 v185, v187, v185, s[80:81]
  v_cndmask_b32 v180, v182, v180, s[78:79]
  v_cndmask_b32 v181, v183, v181, s[80:81]
  v_cndmask_b32 v180, v180, v12, s[66:67]
  v_cndmask_b32 v181, v181, v12, s[68:69]
  v_max_f32 v194, v192, v193
  v_max_f32 v195, v192, v193
  v_max_f32 v190, v188, v189
  buffer_load_dwordx4 v219, s[12:15], s50 offen offset:3072 lds
  v_max_f32 v191, v188, v189
  v_max_f32 v186, v184, v185
  v_max_f32 v187, v184, v185
  v_max_f32 v182, v180, v181
  v_max_f32 v183, v180, v181
  v_permlane16_swap_b32 v194, v195
  v_permlane16_swap_b32 v190, v191
  v_permlane16_swap_b32 v186, v187
  v_permlane16_swap_b32 v182, v183
  v_max_f32 v194, v194, v195
  s_mov_b32 s50, 524288
  s_add_u32 m0, s70, 32768
  s_nop 0
  buffer_load_dwordx4 v216, s[12:15], s50 offen offset:0 lds
  v_max_f32 v190, v190, v191
  v_max_f32 v186, v186, v187
  v_max_f32 v182, v182, v183
  v_mov_b32 v195, v194
  v_mov_b32 v191, v190
  v_mov_b32 v187, v186
  v_mov_b32 v183, v182
  v_permlane32_swap_b32 v194, v195
  v_permlane32_swap_b32 v190, v191
  v_permlane32_swap_b32 v186, v187
  buffer_load_dwordx4 v217, s[12:15], s50 offen offset:1024 lds
  v_permlane32_swap_b32 v182, v183
  v_max_f32 v194, v194, v195
  v_max_f32 v190, v190, v191
  v_max_f32 v186, v186, v187
  v_max_f32 v182, v182, v183
  v_mul_f32 v194, 0xbe8293ee, v194
  v_mul_f32 v190, 0xbe8293ee, v190
  v_mul_f32 v186, 0xbe8293ee, v186
  v_mul_f32 v182, 0xbe8293ee, v182
  v_pk_fma_f32 v[192:193], v[192:193], v[14:15], v[194:195] op_sel_hi:[1,0,0]
  buffer_load_dwordx4 v218, s[12:15], s50 offen offset:2048 lds
  v_pk_fma_f32 v[188:189], v[188:189], v[14:15], v[190:191] op_sel_hi:[1,0,0]
  v_pk_fma_f32 v[184:185], v[184:185], v[14:15], v[186:187] op_sel_hi:[1,0,0]
  v_pk_fma_f32 v[180:181], v[180:181], v[14:15], v[182:183] op_sel_hi:[1,0,0]
  v_exp_f32 v192, v192
  v_exp_f32 v193, v193
  v_exp_f32 v188, v188
  v_exp_f32 v189, v189
  v_exp_f32 v184, v184
  v_exp_f32 v185, v185
  v_exp_f32 v180, v180
  buffer_load_dwordx4 v219, s[12:15], s50 offen offset:3072 lds
  v_exp_f32 v181, v181
  v_add_f32 v194, v192, v193
  v_add_f32 v195, v192, v193
  v_add_f32 v190, v188, v189
  v_add_f32 v191, v188, v189
  v_add_f32 v186, v184, v185
  v_add_f32 v187, v184, v185
  v_add_f32 v182, v180, v181
  v_add_f32 v183, v180, v181
  v_permlane16_swap_b32 v194, v195
  s_mov_b32 s50, 786432
  s_add_u32 m0, s70, 49152
  s_nop 0
  buffer_load_dwordx4 v216, s[12:15], s50 offen offset:0 lds
  v_permlane16_swap_b32 v190, v191
  v_permlane16_swap_b32 v186, v187
  v_permlane16_swap_b32 v182, v183
  v_add_f32 v194, v194, v195
  v_add_f32 v190, v190, v191
  v_add_f32 v186, v186, v187
  v_add_f32 v182, v182, v183
  v_mov_b32 v195, v194
  v_mov_b32 v191, v190
  v_mov_b32 v187, v186
  buffer_load_dwordx4 v217, s[12:15], s50 offen offset:1024 lds
  v_mov_b32 v183, v182
  v_permlane32_swap_b32 v194, v195
  v_permlane32_swap_b32 v190, v191
  v_permlane32_swap_b32 v186, v187
  v_permlane32_swap_b32 v182, v183
  v_add_f32 v194, v194, v195
  v_add_f32 v190, v190, v191
  v_add_f32 v186, v186, v187
  v_add_f32 v182, v182, v183
  v_rcp_f32 v194, v194
  buffer_load_dwordx4 v218, s[12:15], s50 offen offset:2048 lds
  v_rcp_f32 v190, v190
  v_rcp_f32 v186, v186
  v_rcp_f32 v182, v182
  v_pk_mul_f32 v[192:193], v[192:193], v[194:195] op_sel_hi:[1,0]
  v_pk_mul_f32 v[188:189], v[188:189], v[190:191] op_sel_hi:[1,0]
  v_pk_mul_f32 v[184:185], v[184:185], v[186:187] op_sel_hi:[1,0]
  v_pk_mul_f32 v[180:181], v[180:181], v[182:183] op_sel_hi:[1,0]
  v_cvt_pk_bf16_f32 v192, v192, v193
  v_cvt_pk_bf16_f32 v188, v188, v189
  v_cvt_pk_bf16_f32 v184, v184, v185
  buffer_load_dwordx4 v219, s[12:15], s50 offen offset:3072 lds
  v_cvt_pk_bf16_f32 v180, v180, v181
  s_waitcnt lgkmcnt(0)
  v_perm_b32 v48, v192, v192, v228
  v_perm_b32 v49, v192, v192, v229
  v_perm_b32 v50, v192, v192, v230
  v_perm_b32 v51, v192, v192, v231
  v_perm_b32 v44, v188, v188, v228
  v_perm_b32 v45, v188, v188, v229
  v_perm_b32 v46, v188, v188, v230
  v_perm_b32 v47, v188, v188, v231
  v_mfma_f32_16x16x32_bf16 v[32:35], v[58:61], v[48:51], 0
  v_mfma_f32_16x16x32_bf16 v[96:99], v[74:77], v[48:51], 0
  v_perm_b32 v40, v184, v184, v228
  v_perm_b32 v41, v184, v184, v229
  v_perm_b32 v42, v184, v184, v230
  v_perm_b32 v43, v184, v184, v231
  v_mfma_f32_16x16x32_bf16 v[28:31], v[56:59], v[44:47], 0
  v_mfma_f32_16x16x32_bf16 v[92:95], v[72:75], v[44:47], 0
  v_perm_b32 v36, v180, v180, v228
  v_perm_b32 v37, v180, v180, v229
  v_perm_b32 v38, v180, v180, v230
  v_perm_b32 v39, v180, v180, v231
  v_mfma_f32_16x16x32_bf16 v[24:27], v[54:57], v[40:43], 0
  v_mfma_f32_16x16x32_bf16 v[88:91], v[70:73], v[40:43], 0
  s_nop 0
  v_mfma_f32_16x16x32_bf16 v[20:23], v[52:55], v[36:39], 0
  v_mfma_f32_16x16x32_bf16 v[84:87], v[68:71], v[36:39], 0
  v_cvt_pk_bf16_f32 v192, v32, v33
  v_cvt_pk_bf16_f32 v193, v34, v35
  v_cvt_pk_bf16_f32 v194, v96, v97
  v_cvt_pk_bf16_f32 v195, v98, v99
  buffer_store_dwordx4 v[192:195], v0, s[36:39], s72 offen offset:1024 sc1
  v_cvt_pk_bf16_f32 v188, v28, v29
  v_cvt_pk_bf16_f32 v189, v30, v31
  v_cvt_pk_bf16_f32 v190, v92, v93
  v_cvt_pk_bf16_f32 v191, v94, v95
  buffer_store_dwordx4 v[188:191], v0, s[36:39], s72 offen offset:0 sc1
  v_cvt_pk_bf16_f32 v184, v24, v25
  v_cvt_pk_bf16_f32 v185, v26, v27
  v_cvt_pk_bf16_f32 v186, v88, v89
  v_cvt_pk_bf16_f32 v187, v90, v91
  buffer_store_dwordx4 v[184:187], v0, s[36:39], s71 offen offset:1024 sc1
  v_cvt_pk_bf16_f32 v180, v20, v21
  v_cvt_pk_bf16_f32 v181, v22, v23
  v_cvt_pk_bf16_f32 v182, v84, v85
  v_cvt_pk_bf16_f32 v183, v86, v87
  buffer_store_dwordx4 v[180:183], v0, s[36:39], s71 offen offset:0 sc1
  s_waitcnt vmcnt(18)
  v_lshlrev_b32 v60, 16, v136
  v_and_b32 v61, 0xffff0000, v136
  v_lshlrev_b32 v62, 16, v137
  v_and_b32 v63, 0xffff0000, v137
  v_pk_mul_f32 v[52:53], v[60:61], v[168:169] op_sel_hi:[1,0]
  v_pk_mul_f32 v[54:55], v[62:63], v[168:169] op_sel_hi:[1,0]
  v_lshlrev_b32 v60, 16, v138
  v_and_b32 v61, 0xffff0000, v138
  v_lshlrev_b32 v62, 16, v139
  v_and_b32 v63, 0xffff0000, v139
  v_pk_mul_f32 v[56:57], v[60:61], v[168:169] op_sel_hi:[1,0]
  v_pk_mul_f32 v[58:59], v[62:63], v[168:169] op_sel_hi:[1,0]
  s_mov_b32 s50, 1048576
  s_add_u32 m0, s70, 65536
  s_nop 0
  buffer_load_dwordx4 v216, s[12:15], s50 offen offset:0 lds
  v_lshlrev_b32 v60, 16, v140
  v_and_b32 v61, 0xffff0000, v140
  v_lshlrev_b32 v62, 16, v141
  v_and_b32 v63, 0xffff0000, v141
  v_pk_fma_f32 v[52:53], v[60:61], v[168:169], v[52:53] op_sel:[0,1,0] op_sel_hi:[1,1,1]
  v_pk_fma_f32 v[54:55], v[62:63], v[168:169], v[54:55] op_sel:[0,1,0] op_sel_hi:[1,1,1]
  v_lshlrev_b32 v60, 16, v142
  v_and_b32 v61, 0xffff0000, v142
  v_lshlrev_b32 v62, 16, v143
  v_and_b32 v63, 0xffff0000, v143
  v_pk_fma_f32 v[56:57], v[60:61], v[168:169], v[56:57] op_sel:[0,1,0] op_sel_hi:[1,1,1]
  v_pk_fma_f32 v[58:59], v[62:63], v[168:169], v[58:59] op_sel:[0,1,0] op_sel_hi:[1,1,1]
  buffer_load_dwordx4 v217, s[12:15], s50 offen offset:1024 lds
  v_lshlrev_b32 v60, 16, v144
  v_and_b32 v61, 0xffff0000, v144
  v_lshlrev_b32 v62, 16, v145
  v_and_b32 v63, 0xffff0000, v145
  v_pk_fma_f32 v[52:53], v[60:61], v[170:171], v[52:53] op_sel:[0,0,0] op_sel_hi:[1,0,1]
  v_pk_fma_f32 v[54:55], v[62:63], v[170:171], v[54:55] op_sel:[0,0,0] op_sel_hi:[1,0,1]
  v_lshlrev_b32 v60, 16, v146
  v_and_b32 v61, 0xffff0000, v146
  v_lshlrev_b32 v62, 16, v147
  v_and_b32 v63, 0xffff0000, v147
  v_pk_fma_f32 v[56:57], v[60:61], v[170:171], v[56:57] op_sel:[0,0,0] op_sel_hi:[1,0,1]
  v_pk_fma_f32 v[58:59], v[62:63], v[170:171], v[58:59] op_sel:[0,0,0] op_sel_hi:[1,0,1]
  buffer_load_dwordx4 v218, s[12:15], s50 offen offset:2048 lds
  v_lshlrev_b32 v60, 16, v148
  v_and_b32 v61, 0xffff0000, v148
  v_lshlrev_b32 v62, 16, v149
  v_and_b32 v63, 0xffff0000, v149
  v_pk_fma_f32 v[52:53], v[60:61], v[170:171], v[52:53] op_sel:[0,1,0] op_sel_hi:[1,1,1]
  v_pk_fma_f32 v[54:55], v[62:63], v[170:171], v[54:55] op_sel:[0,1,0] op_sel_hi:[1,1,1]
  v_lshlrev_b32 v60, 16, v150
  v_and_b32 v61, 0xffff0000, v150
  v_lshlrev_b32 v62, 16, v151
  v_and_b32 v63, 0xffff0000, v151
  v_pk_fma_f32 v[56:57], v[60:61], v[170:171], v[56:57] op_sel:[0,1,0] op_sel_hi:[1,1,1]
  v_pk_fma_f32 v[58:59], v[62:63], v[170:171], v[58:59] op_sel:[0,1,0] op_sel_hi:[1,1,1]
  buffer_load_dwordx4 v219, s[12:15], s50 offen offset:3072 lds
  v_lshlrev_b32 v60, 16, v152
  v_and_b32 v61, 0xffff0000, v152
  v_lshlrev_b32 v62, 16, v153
  v_and_b32 v63, 0xffff0000, v153
  v_pk_fma_f32 v[52:53], v[60:61], v[172:173], v[52:53] op_sel:[0,0,0] op_sel_hi:[1,0,1]
  v_pk_fma_f32 v[54:55], v[62:63], v[172:173], v[54:55] op_sel:[0,0,0] op_sel_hi:[1,0,1]
  v_lshlrev_b32 v60, 16, v154
  v_and_b32 v61, 0xffff0000, v154
  v_lshlrev_b32 v62, 16, v155
  v_and_b32 v63, 0xffff0000, v155
  v_pk_fma_f32 v[56:57], v[60:61], v[172:173], v[56:57] op_sel:[0,0,0] op_sel_hi:[1,0,1]
  v_pk_fma_f32 v[58:59], v[62:63], v[172:173], v[58:59] op_sel:[0,0,0] op_sel_hi:[1,0,1]
  v_lshlrev_b32 v60, 16, v156
  v_and_b32 v61, 0xffff0000, v156
  v_lshlrev_b32 v62, 16, v157
  v_and_b32 v63, 0xffff0000, v157
  v_pk_fma_f32 v[52:53], v[60:61], v[172:173], v[52:53] op_sel:[0,1,0] op_sel_hi:[1,1,1]
  v_pk_fma_f32 v[54:55], v[62:63], v[172:173], v[54:55] op_sel:[0,1,0] op_sel_hi:[1,1,1]
  v_lshlrev_b32 v60, 16, v158
  v_and_b32 v61, 0xffff0000, v158
  v_lshlrev_b32 v62, 16, v159
  v_and_b32 v63, 0xffff0000, v159
  v_pk_fma_f32 v[56:57], v[60:61], v[172:173], v[56:57] op_sel:[0,1,0] op_sel_hi:[1,1,1]
  v_pk_fma_f32 v[58:59], v[62:63], v[172:173], v[58:59] op_sel:[0,1,0] op_sel_hi:[1,1,1]
  v_lshlrev_b32 v60, 16, v160
  v_and_b32 v61, 0xffff0000, v160
  v_lshlrev_b32 v62, 16, v161
  v_and_b32 v63, 0xffff0000, v161
  v_pk_fma_f32 v[52:53], v[60:61], v[174:175], v[52:53] op_sel:[0,0,0] op_sel_hi:[1,0,1]
  v_pk_fma_f32 v[54:55], v[62:63], v[174:175], v[54:55] op_sel:[0,0,0] op_sel_hi:[1,0,1]
  v_lshlrev_b32 v60, 16, v162
  v_and_b32 v61, 0xffff0000, v162
  v_lshlrev_b32 v62, 16, v163
  v_and_b32 v63, 0xffff0000, v163
  v_pk_fma_f32 v[56:57], v[60:61], v[174:175], v[56:57] op_sel:[0,0,0] op_sel_hi:[1,0,1]
  v_pk_fma_f32 v[58:59], v[62:63], v[174:175], v[58:59] op_sel:[0,0,0] op_sel_hi:[1,0,1]
  v_lshlrev_b32 v60, 16, v164
  v_and_b32 v61, 0xffff0000, v164
  v_lshlrev_b32 v62, 16, v165
  v_and_b32 v63, 0xffff0000, v165
  v_pk_fma_f32 v[52:53], v[60:61], v[174:175], v[52:53] op_sel:[0,1,0] op_sel_hi:[1,1,1]
  v_pk_fma_f32 v[54:55], v[62:63], v[174:175], v[54:55] op_sel:[0,1,0] op_sel_hi:[1,1,1]
  v_lshlrev_b32 v60, 16, v166
  v_and_b32 v61, 0xffff0000, v166
  v_lshlrev_b32 v62, 16, v167
  v_and_b32 v63, 0xffff0000, v167
  v_pk_fma_f32 v[56:57], v[60:61], v[174:175], v[56:57] op_sel:[0,1,0] op_sel_hi:[1,1,1]
  v_pk_fma_f32 v[58:59], v[62:63], v[174:175], v[58:59] op_sel:[0,1,0] op_sel_hi:[1,1,1]
  s_nop 0
  v_permlane32_swap_b32 v52, v56
  v_permlane32_swap_b32 v53, v57
  v_permlane32_swap_b32 v54, v58
  v_permlane32_swap_b32 v55, v59
  v_add_f32 v52, v52, v56
  v_add_f32 v53, v53, v57
  v_add_f32 v54, v54, v58
  v_add_f32 v55, v55, v59
  s_nop 0
  v_permlane16_swap_b32 v52, v54
  v_permlane16_swap_b32 v53, v55
  v_add_f32 v52, v52, v54
  v_add_f32 v53, v53, v55
  v_add_u32 v60, 162816, v178
  v_add_f32_dpp v52, v52, v52 row_ror:8 row_mask:0xf bank_mask:0xf
  v_add_f32_dpp v53, v53, v53 row_ror:8 row_mask:0xf bank_mask:0xf
  ds_write_b64 v177, v[52:53]
  v_mov_b32 v12, s3
  s_waitcnt vmcnt(4) lgkmcnt(0)
  s_barrier
  s_mov_b64 exec, 1
  buffer_store_dword v12, v0, s[36:39], s45 offen sc1
  s_mov_b64 exec, -1
  ds_read_b32 v52, v60 offset:0
  ds_read_b32 v53, v60 offset:256
  ds_read_b32 v54, v60 offset:512
  ds_read_b32 v55, v60 offset:768
  s_cmp_eq_u32 s44, 1
  s_cselect_b32 s49, s56, 1073741824
  s_lshl_b32 s45, s2, 7
  s_add_u32 s45, s45, 5341184
  s_cmp_eq_u32 s44, 0
  s_cselect_b32 s45, s45, 1073741824
  s_waitcnt lgkmcnt(0)
  v_add_f32 v52, v52, v53
  v_add_f32 v54, v54, v55
  v_add_f32 v52, v52, v54
  buffer_store_dword v52, v178, s[36:39], s49 offen sc1
  s_mov_b32 s50, 1310720
  s_add_u32 m0, s70, 81920
  s_nop 0
  buffer_load_dwordx4 v216, s[12:15], s50 offen offset:0 lds
  buffer_load_dwordx4 v217, s[12:15], s50 offen offset:1024 lds
  buffer_load_dwordx4 v218, s[12:15], s50 offen offset:2048 lds
  buffer_load_dwordx4 v219, s[12:15], s50 offen offset:3072 lds
  s_mov_b32 s50, 1572864
  s_add_u32 m0, s70, 98304
  s_nop 0
  buffer_load_dwordx4 v216, s[12:15], s50 offen offset:0 lds
  buffer_load_dwordx4 v217, s[12:15], s50 offen offset:1024 lds
  buffer_load_dwordx4 v218, s[12:15], s50 offen offset:2048 lds
  buffer_load_dwordx4 v219, s[12:15], s50 offen offset:3072 lds
  s_mov_b32 s50, 1835008
  s_add_u32 m0, s70, 114688
  s_nop 0
  buffer_load_dwordx4 v216, s[12:15], s50 offen offset:0 lds
  buffer_load_dwordx4 v217, s[12:15], s50 offen offset:1024 lds
  buffer_load_dwordx4 v218, s[12:15], s50 offen offset:2048 lds
  buffer_load_dwordx4 v219, s[12:15], s50 offen offset:3072 lds
  s_add_u32 m0, s70, 131072
  s_nop 0
  buffer_load_dwordx4 v220, s[4:7], s55 offen offset:0 lds
  buffer_load_dwordx4 v221, s[4:7], s55 offen offset:1024 lds
  s_add_u32 m0, s70, 133120
  s_add_u32 s48, s55, 32768
  buffer_load_dwordx4 v220, s[4:7], s48 offen offset:0 lds
  buffer_load_dwordx4 v221, s[4:7], s48 offen offset:1024 lds
  ds_read_b64_tr_b16 a[80:81], v232 offset:0
  ds_read_b64_tr_b16 a[82:83], v232 offset:2048
  ds_read_b64_tr_b16 a[84:85], v232 offset:4096
  ds_read_b64_tr_b16 a[86:87], v232 offset:6144
  ds_read_b64_tr_b16 a[88:89], v233 offset:0
  ds_read_b64_tr_b16 a[90:91], v233 offset:2048
  ds_read_b64_tr_b16 a[92:93], v233 offset:4096
  ds_read_b64_tr_b16 a[94:95], v233 offset:6144
  ds_read_b64_tr_b16 a[96:97], v234 offset:0
  ds_read_b64_tr_b16 a[98:99], v234 offset:2048
  ds_read_b64_tr_b16 a[100:101], v234 offset:4096
  ds_read_b64_tr_b16 a[102:103], v234 offset:6144
  ds_read_b64_tr_b16 a[104:105], v235 offset:0
  ds_read_b64_tr_b16 a[106:107], v235 offset:2048
  ds_read_b64_tr_b16 a[108:109], v235 offset:4096
  ds_read_b64_tr_b16 a[110:111], v235 offset:6144
  ds_read_b64_tr_b16 a[112:113], v232 offset:8192
  ds_read_b64_tr_b16 a[114:115], v232 offset:10240
  ds_read_b64_tr_b16 a[116:117], v232 offset:12288
  ds_read_b64_tr_b16 a[118:119], v232 offset:14336
  ds_read_b64_tr_b16 a[120:121], v233 offset:8192
  ds_read_b64_tr_b16 a[122:123], v233 offset:10240
  ds_read_b64_tr_b16 a[124:125], v233 offset:12288
  ds_read_b64_tr_b16 a[126:127], v233 offset:14336
  ds_read_b64_tr_b16 a[128:129], v234 offset:8192
  ds_read_b64_tr_b16 a[130:131], v234 offset:10240
  ds_read_b64_tr_b16 a[132:133], v234 offset:12288
  ds_read_b64_tr_b16 a[134:135], v234 offset:14336
  ds_read_b64_tr_b16 a[136:137], v235 offset:8192
  ds_read_b64_tr_b16 a[138:139], v235 offset:10240
  ds_read_b64_tr_b16 a[140:141], v235 offset:12288
  ds_read_b64_tr_b16 a[142:143], v235 offset:14336
  s_cmp_lg_u32 s44, 0
  s_cbranch_scc1 SM3x
  s_mov_b32 s46, 60000
  s_mov_b32 s47, 5242880
SM3:
  buffer_load_dword v13, v250, s[36:39], s47 offen sc1
  s_sub_u32 s46, s46, 1
  s_cmp_eq_u32 s46, 0
  s_waitcnt vmcnt(0)
  s_cbranch_scc1 SM3x
  v_cmp_ne_u32 vcc, s3, v13
  s_nop 4
  s_cbranch_vccnz SM3
SM3x:
  s_waitcnt vmcnt(0)
  s_barrier
  buffer_load_dwordx4 a[0:3], v244, s[36:39], 0 offen offset:0 sc1
  buffer_load_dwordx4 a[8:11], v244, s[36:39], 0 offen offset:2048 sc1
  buffer_load_dwordx4 a[4:7], v244, s[36:39], 0 offen offset:1024 sc1
  buffer_load_dwordx4 a[12:15], v244, s[36:39], 0 offen offset:3072 sc1
  s_mov_b32 s50, 4096
  buffer_load_dwordx4 a[16:19], v244, s[36:39], s50 offen offset:0 sc1
  buffer_load_dwordx4 a[20:23], v244, s[36:39], s50 offen offset:1024 sc1
  buffer_load_dwordx4 a[24:27], v244, s[36:39], s50 offen offset:2048 sc1
  buffer_load_dwordx4 a[28:31], v244, s[36:39], s50 offen offset:3072 sc1
  ds_read_b64_tr_b16 a[144:145], v232 offset:16384
  ds_read_b64_tr_b16 a[146:147], v232 offset:18432
  ds_read_b64_tr_b16 a[148:149], v232 offset:20480
  ds_read_b64_tr_b16 a[150:151], v232 offset:22528
  ds_read_b64_tr_b16 a[152:153], v233 offset:16384
  ds_read_b64_tr_b16 a[154:155], v233 offset:18432
  ds_read_b64_tr_b16 a[156:157], v233 offset:20480
  ds_read_b64_tr_b16 a[158:159], v233 offset:22528
  ds_read_b64_tr_b16 a[160:161], v234 offset:16384
  ds_read_b64_tr_b16 a[162:163], v234 offset:18432
  ds_read_b64_tr_b16 a[164:165], v234 offset:20480
  ds_read_b64_tr_b16 a[166:167], v234 offset:22528
  ds_read_b64_tr_b16 a[168:169], v235 offset:16384
  ds_read_b64_tr_b16 a[170:171], v235 offset:18432
  ds_read_b64_tr_b16 a[172:173], v235 offset:20480
  ds_read_b64_tr_b16 a[174:175], v235 offset:22528
  ds_read_b64_tr_b16 a[176:177], v232 offset:24576
  ds_read_b64_tr_b16 a[178:179], v232 offset:26624
  ds_read_b64_tr_b16 a[180:181], v232 offset:28672
  ds_read_b64_tr_b16 a[182:183], v232 offset:30720
  ds_read_b64_tr_b16 a[184:185], v233 offset:24576
  ds_read_b64_tr_b16 a[186:187], v233 offset:26624
  ds_read_b64_tr_b16 a[188:189], v233 offset:28672
  ds_read_b64_tr_b16 a[190:191], v233 offset:30720
  ds_read_b64_tr_b16 a[192:193], v234 offset:24576
  ds_read_b64_tr_b16 a[194:195], v234 offset:26624
  ds_read_b64_tr_b16 a[196:197], v234 offset:28672
  ds_read_b64_tr_b16 a[198:199], v234 offset:30720
  ds_read_b64_tr_b16 a[200:201], v235 offset:24576
  ds_read_b64_tr_b16 a[202:203], v235 offset:26624
  ds_read_b64_tr_b16 a[204:205], v235 offset:28672
  ds_read_b64_tr_b16 a[206:207], v235 offset:30720
  ds_read_b64_tr_b16 a[208:209], v232 offset:32768
  ds_read_b64_tr_b16 a[210:211], v232 offset:34816
  ds_read_b64_tr_b16 a[212:213], v232 offset:36864
  ds_read_b64_tr_b16 a[214:215], v232 offset:38912
  ds_read_b64_tr_b16 a[216:217], v233 offset:32768
  ds_read_b64_tr_b16 a[218:219], v233 offset:34816
  ds_read_b64_tr_b16 a[220:221], v233 offset:36864
  ds_read_b64_tr_b16 a[222:223], v233 offset:38912
  ds_read_b64 v[116:117], v240 offset:0
  ds_read_b64 v[118:119], v241 offset:0
  ds_read_b64 v[120:121], v242 offset:0
  ds_read_b64 v[122:123], v243 offset:0
  ds_read_b64 v[124:125], v240 offset:2048
  ds_read_b64 v[126:127], v241 offset:2048
  ds_read_b64 v[128:129], v242 offset:2048
  ds_read_b64 v[130:131], v243 offset:2048
  v_lshrrev_b32 v13, 4, v10
  v_cmp_eq_u32 vcc, 2, v13
  s_add_u32 s51, s73, 4096
  s_nop 0
  v_cndmask_b32 v13, 0, 1.0, vcc
  s_waitcnt lgkmcnt(0)
  v_lshlrev_b32 v52, 16, v116
  v_and_b32 v53, 0xffff0000, v116
  v_lshlrev_b32 v54, 16, v117
  v_and_b32 v55, 0xffff0000, v117
  v_lshlrev_b32 v56, 16, v118
  v_and_b32 v57, 0xffff0000, v118
  v_lshlrev_b32 v58, 16, v119
  v_and_b32 v59, 0xffff0000, v119
  v_lshlrev_b32 v60, 16, v120
  v_and_b32 v61, 0xffff0000, v120
  v_lshlrev_b32 v62, 16, v121
  v_and_b32 v63, 0xffff0000, v121
  v_lshlrev_b32 v64, 16, v122
  v_and_b32 v65, 0xffff0000, v122
  v_lshlrev_b32 v66, 16, v123
  v_and_b32 v67, 0xffff0000, v123
  v_lshlrev_b32 v68, 16, v124
  v_and_b32 v69, 0xffff0000, v124
  v_lshlrev_b32 v70, 16, v125
  v_and_b32 v71, 0xffff0000, v125
  v_lshlrev_b32 v72, 16, v126
  v_and_b32 v73, 0xffff0000, v126
  v_lshlrev_b32 v74, 16, v127
  v_and_b32 v75, 0xffff0000, v127
  v_lshlrev_b32 v76, 16, v128
  v_and_b32 v77, 0xffff0000, v128
  v_lshlrev_b32 v78, 16, v129
  v_and_b32 v79, 0xffff0000, v129
  v_lshlrev_b32 v80, 16, v130
  v_and_b32 v81, 0xffff0000, v130
  v_lshlrev_b32 v82, 16, v131
  v_and_b32 v83, 0xffff0000, v131
  s_waitcnt vmcnt(7) lgkmcnt(15)
  v_mfma_f32_16x16x32_bf16 v[20:23], a[80:83], a[0:3], 0
  s_waitcnt vmcnt(6)
  s_mov_b32 s50, 8192
  buffer_load_dwordx4 a[32:35], v244, s[36:39], s50 offen offset:0 sc1
  v_mfma_f32_16x16x32_bf16 v[20:23], a[84:87], a[8:11], v[20:23]
  s_waitcnt vmcnt(5)
  v_mfma_f32_16x16x32_bf16 v[24:27], a[84:87], a[12:15], 0
  s_waitcnt vmcnt(6)
  buffer_load_dwordx4 a[36:39], v244, s[36:39], s50 offen offset:1024 sc1
  v_mfma_f32_16x16x32_bf16 v[24:27], a[80:83], a[4:7], v[24:27]
  s_waitcnt lgkmcnt(15)
  ds_read_b64_tr_b16 a[80:81], v234 offset:32768
  ds_read_b64_tr_b16 a[82:83], v234 offset:34816
  v_mfma_f32_16x16x32_bf16 v[32:35], a[88:91], a[4:7], 0
  ds_read_b64_tr_b16 a[84:85], v234 offset:36864
  ds_read_b64_tr_b16 a[86:87], v234 offset:38912
  v_mfma_f32_16x16x32_bf16 v[32:35], a[92:95], a[12:15], v[32:35]
  buffer_load_dwordx4 a[40:43], v244, s[36:39], s50 offen offset:2048 sc1
  v_mfma_f32_16x16x32_bf16 v[28:31], a[92:95], a[8:11], 0
  buffer_load_dwordx4 a[44:47], v244, s[36:39], s50 offen offset:3072 sc1
  v_mfma_f32_16x16x32_bf16 v[28:31], a[88:91], a[0:3], v[28:31]
  s_waitcnt lgkmcnt(15)
  s_mov_b32 s50, 12288
  ds_read_b64_tr_b16 a[88:89], v235 offset:32768
  v_mfma_f32_16x16x32_bf16 v[36:39], a[96:99], a[0:3], 0
  ds_read_b64_tr_b16 a[90:91], v235 offset:34816
  ds_read_b64_tr_b16 a[92:93], v235 offset:36864
  v_mfma_f32_16x16x32_bf16 v[36:39], a[100:103], a[8:11], v[36:39]
  buffer_load_dwordx4 a[48:51], v244, s[36:39], s50 offen offset:0 sc1
  ds_read_b64_tr_b16 a[94:95], v235 offset:38912
  v_mfma_f32_16x16x32_bf16 v[40:43], a[100:103], a[12:15], 0
  buffer_load_dwordx4 a[52:55], v244, s[36:39], s50 offen offset:1024 sc1
  v_mfma_f32_16x16x32_bf16 v[40:43], a[96:99], a[4:7], v[40:43]
  s_waitcnt lgkmcnt(15)
  ds_read_b64_tr_b16 a[96:97], v232 offset:40960
  ds_read_b64_tr_b16 a[98:99], v232 offset:43008
  v_mfma_f32_16x16x32_bf16 v[48:51], a[104:107], a[4:7], 0
  s_mov_b32 s49, 0
  buffer_load_dwordx4 a[56:59], v244, s[36:39], s50 offen offset:2048 sc1
  ds_read_b64_tr_b16 a[100:101], v232 offset:45056
  v_mfma_f32_16x16x32_bf16 v[48:51], a[108:111], a[12:15], v[48:51]
  buffer_load_dwordx4 v[156:159], v249, s[36:39], s49 offen sc1
  s_mov_b32 s49, 24576
  v_mfma_f32_16x16x32_bf16 v[44:47], a[108:111], a[8:11], 0
  buffer_load_dwordx4 v[160:163], v249, s[36:39], s49 offen sc1
  s_mov_b32 s49, 49152
  v_mfma_f32_16x16x32_bf16 v[44:47], a[104:107], a[0:3], v[44:47]
  s_waitcnt vmcnt(9) lgkmcnt(15)
  buffer_load_dwordx4 v[164:167], v249, s[36:39], s49 offen sc1
  s_mov_b32 s49, 73728
  v_mfma_f32_16x16x32_bf16 v[20:23], a[112:115], a[16:19], v[20:23]
  buffer_load_dwordx4 v[168:171], v249, s[36:39], s49 offen sc1
  buffer_load_dwordx4 a[60:63], v244, s[36:39], s50 offen offset:3072 sc1
  v_mfma_f32_16x16x32_bf16 v[20:23], a[116:119], a[24:27], v[20:23]
  s_mov_b32 s50, 16384
  ds_read_b64_tr_b16 a[102:103], v232 offset:47104
  ds_read_b64_tr_b16 a[104:105], v233 offset:40960
  v_mfma_f32_16x16x32_bf16 v[24:27], a[116:119], a[28:31], v[24:27]
  buffer_load_dwordx4 a[64:67], v244, s[36:39], s50 offen offset:0 sc1
  ds_read_b64_tr_b16 a[106:107], v233 offset:43008
  v_mfma_f32_16x16x32_bf16 v[24:27], a[112:115], a[20:23], v[24:27]
  s_waitcnt lgkmcnt(15)
  ds_read_b64_tr_b16 a[108:109], v233 offset:45056
  buffer_load_dwordx4 a[68:71], v244, s[36:39], s50 offen offset:1024 sc1
  v_mfma_f32_16x16x32_bf16 v[32:35], a[120:123], a[20:23], v[32:35]
  ds_read_b64_tr_b16 a[110:111], v233 offset:47104
  buffer_load_dwordx4 a[72:75], v244, s[36:39], s50 offen offset:2048 sc1
  v_mfma_f32_16x16x32_bf16 v[32:35], a[124:127], a[28:31], v[32:35]
  ds_read_b64_tr_b16 a[112:113], v234 offset:40960
  ds_read_b64_tr_b16 a[114:115], v234 offset:43008
  v_mfma_f32_16x16x32_bf16 v[28:31], a[124:127], a[24:27], v[28:31]
  buffer_load_dwordx4 a[76:79], v244, s[36:39], s50 offen offset:3072 sc1
  v_mfma_f32_16x16x32_bf16 v[28:31], a[120:123], a[16:19], v[28:31]
  s_waitcnt lgkmcnt(15)
  s_mov_b32 s50, 20480
  ds_read_b64_tr_b16 a[116:117], v234 offset:45056
  v_mfma_f32_16x16x32_bf16 v[36:39], a[128:131], a[16:19], v[36:39]
  buffer_load_dwordx4 a[0:3], v244, s[36:39], s50 offen offset:0 sc1
  ds_read_b64_tr_b16 a[118:119], v234 offset:47104
  v_mfma_f32_16x16x32_bf16 v[36:39], a[132:135], a[24:27], v[36:39]
  ds_read_b64_tr_b16 a[120:121], v235 offset:40960
  v_mfma_f32_16x16x32_bf16 v[40:43], a[132:135], a[28:31], v[40:43]
  buffer_load_dwordx4 a[4:7], v244, s[36:39], s50 offen offset:1024 sc1
  ds_read_b64_tr_b16 a[122:123], v235 offset:43008
  v_mfma_f32_16x16x32_bf16 v[40:43], a[128:131], a[20:23], v[40:43]
  s_waitcnt lgkmcnt(15)
  v_mfma_f32_16x16x32_bf16 v[48:51], a[136:139], a[20:23], v[48:51]
Ha2_1:
  s_cbranch_execz Ra
  buffer_load_dwordx4 a[8:11], v244, s[36:39], s50 offen offset:2048 sc1
  ds_read_b64_tr_b16 a[124:125], v235 offset:45056
  v_mfma_f32_16x16x32_bf16 v[48:51], a[140:143], a[28:31], v[48:51]
  ds_read_b64_tr_b16 a[126:127], v235 offset:47104
  v_mfma_f32_16x16x32_bf16 v[44:47], a[140:143], a[24:27], v[44:47]
  buffer_load_dwordx4 a[12:15], v244, s[36:39], s50 offen offset:3072 sc1
  ds_read_b64_tr_b16 a[128:129], v232 offset:49152
  v_mfma_f32_16x16x32_bf16 v[44:47], a[136:139], a[16:19], v[44:47]
  s_waitcnt vmcnt(16) lgkmcnt(15)
  v_mfma_f32_16x16x32_bf16 v[20:23], a[144:147], a[32:35], v[20:23]
  s_mov_b32 s50, 24576
  ds_read_b64_tr_b16 a[130:131], v232 offset:51200
  v_mfma_f32_16x16x32_bf16 v[20:23], a[148:151], a[40:43], v[20:23]
  buffer_load_dwordx4 a[16:19], v244, s[36:39], s50 offen offset:0 sc1
  ds_read_b64_tr_b16 a[132:133], v232 offset:53248
  v_mfma_f32_16x16x32_bf16 v[24:27], a[148:151], a[44:47], v[24:27]
  ds_read_b64_tr_b16 a[134:135], v232 offset:55296
  v_mfma_f32_16x16x32_bf16 v[24:27], a[144:147], a[36:39], v[24:27]
  s_waitcnt lgkmcnt(15)
  ds_read_b64_tr_b16 a[136:137], v233 offset:49152
  v_mfma_f32_16x16x32_bf16 v[32:35], a[152:155], a[36:39], v[32:35]
  v_mfma_f32_16x16x32_bf16 v[32:35], a[156:159], a[44:47], v[32:35]
  buffer_load_dwordx4 a[20:23], v244, s[36:39], s50 offen offset:1024 sc1
  ds_read_b64_tr_b16 a[138:139], v233 offset:51200
  v_mfma_f32_16x16x32_bf16 v[28:31], a[156:159], a[40:43], v[28:31]
  ds_read_b64_tr_b16 a[140:141], v233 offset:53248
  v_mfma_f32_16x16x32_bf16 v[28:31], a[152:155], a[32:35], v[28:31]
  s_waitcnt lgkmcnt(15)
  ds_read_b64_tr_b16 a[142:143], v233 offset:55296
  v_mfma_f32_16x16x32_bf16 v[36:39], a[160:163], a[32:35], v[36:39]
  v_mfma_f32_16x16x32_bf16 v[36:39], a[164:167], a[40:43], v[36:39]
  buffer_load_dwordx4 a[24:27], v244, s[36:39], s50 offen offset:2048 sc1
  ds_read_b64_tr_b16 a[144:145], v234 offset:49152
  v_mfma_f32_16x16x32_bf16 v[40:43], a[164:167], a[44:47], v[40:43]
  ds_read_b64_tr_b16 a[146:147], v234 offset:51200
  v_mfma_f32_16x16x32_bf16 v[40:43], a[160:163], a[36:39], v[40:43]
  s_waitcnt lgkmcnt(15)
  ds_read_b64_tr_b16 a[148:149], v234 offset:53248
  v_mfma_f32_16x16x32_bf16 v[48:51], a[168:171], a[36:39], v[48:51]
  ds_read_b64_tr_b16 a[150:151], v234 offset:55296
  v_mfma_f32_16x16x32_bf16 v[48:51], a[172:175], a[44:47], v[48:51]
  buffer_load_dwordx4 a[28:31], v244, s[36:39], s50 offen offset:3072 sc1
  v_mfma_f32_16x16x32_bf16 v[44:47], a[172:175], a[40:43], v[44:47]
  ds_read_b64_tr_b16 a[152:153], v235 offset:49152
  v_mfma_f32_16x16x32_bf16 v[44:47], a[168:171], a[32:35], v[44:47]
  s_waitcnt vmcnt(12) lgkmcnt(15)
  ds_read_b64_tr_b16 a[154:155], v235 offset:51200
  v_mfma_f32_16x16x32_bf16 v[20:23], a[176:179], a[48:51], v[20:23]
  s_mov_b32 s50, 28672
  ds_read_b64_tr_b16 a[156:157], v235 offset:53248
  v_mfma_f32_16x16x32_bf16 v[20:23], a[180:183], a[56:59], v[20:23]
  buffer_load_dwordx4 a[32:35], v244, s[36:39], s50 offen offset:0 sc1
  v_mfma_f32_16x16x32_bf16 v[24:27], a[180:183], a[60:63], v[24:27]
  ds_read_b64_tr_b16 a[158:159], v235 offset:55296
  v_mfma_f32_16x16x32_bf16 v[24:27], a[176:179], a[52:55], v[24:27]
  s_waitcnt lgkmcnt(15)
  ds_read_b64_tr_b16 a[160:161], v232 offset:57344
  v_mfma_f32_16x16x32_bf16 v[32:35], a[184:187], a[52:55], v[32:35]
  ds_read_b64_tr_b16 a[162:163], v232 offset:59392
  v_mfma_f32_16x16x32_bf16 v[32:35], a[188:191], a[60:63], v[32:35]
  buffer_load_dwordx4 a[36:39], v244, s[36:39], s50 offen offset:1024 sc1
  ds_read_b64_tr_b16 a[164:165], v232 offset:61440
  v_mfma_f32_16x16x32_bf16 v[28:31], a[188:191], a[56:59], v[28:31]
  v_mfma_f32_16x16x32_bf16 v[28:31], a[184:187], a[48:51], v[28:31]
  s_waitcnt lgkmcnt(15)
  ds_read_b64_tr_b16 a[166:167], v232 offset:63488
  v_mfma_f32_16x16x32_bf16 v[36:39], a[192:195], a[48:51], v[36:39]
  ds_read_b64_tr_b16 a[168:169], v233 offset:57344
  v_mfma_f32_16x16x32_bf16 v[36:39], a[196:199], a[56:59], v[36:39]
  buffer_load_dwordx4 a[40:43], v244, s[36:39], s50 offen offset:2048 sc1
  ds_read_b64_tr_b16 a[170:171], v233 offset:59392
  v_mfma_f32_16x16x32_bf16 v[40:43], a[196:199], a[60:63], v[40:43]
  v_mfma_f32_16x16x32_bf16 v[40:43], a[192:195], a[52:55], v[40:43]
  s_waitcnt lgkmcnt(15)
  ds_read_b64_tr_b16 a[172:173], v233 offset:61440
  v_mfma_f32_16x16x32_bf16 v[48:51], a[200:203], a[52:55], v[48:51]
  ds_read_b64_tr_b16 a[174:175], v233 offset:63488
  v_mfma_f32_16x16x32_bf16 v[48:51], a[204:207], a[60:63], v[48:51]
  buffer_load_dwordx4 a[44:47], v244, s[36:39], s50 offen offset:3072 sc1
  ds_read_b64_tr_b16 a[176:177], v234 offset:57344
  v_mfma_f32_16x16x32_bf16 v[44:47], a[204:207], a[56:59], v[44:47]
  ds_read_b64_tr_b16 a[178:179], v234 offset:59392
  v_mfma_f32_16x16x32_bf16 v[44:47], a[200:203], a[48:51], v[44:47]
  s_waitcnt vmcnt(12) lgkmcnt(15)
  v_mfma_f32_16x16x32_bf16 v[20:23], a[208:211], a[64:67], v[20:23]
  s_mov_b32 s50, 32768
  ds_read_b64_tr_b16 a[180:181], v234 offset:61440
  v_mfma_f32_16x16x32_bf16 v[20:23], a[212:215], a[72:75], v[20:23]
  buffer_load_dwordx4 a[48:51], v244, s[36:39], s50 offen offset:0 sc1
  ds_read_b64_tr_b16 a[182:183], v234 offset:63488
  v_mfma_f32_16x16x32_bf16 v[24:27], a[212:215], a[76:79], v[24:27]
  ds_read_b64_tr_b16 a[184:185], v235 offset:57344
  v_mfma_f32_16x16x32_bf16 v[24:27], a[208:211], a[68:71], v[24:27]
  s_waitcnt lgkmcnt(15)
  ds_read_b64_tr_b16 a[186:187], v235 offset:59392
  v_mfma_f32_16x16x32_bf16 v[32:35], a[216:219], a[68:71], v[32:35]
  v_mfma_f32_16x16x32_bf16 v[32:35], a[220:223], a[76:79], v[32:35]
  buffer_load_dwordx4 a[52:55], v244, s[36:39], s50 offen offset:1024 sc1
  ds_read_b64_tr_b16 a[188:189], v235 offset:61440
  v_mfma_f32_16x16x32_bf16 v[28:31], a[220:223], a[72:75], v[28:31]
  ds_read_b64_tr_b16 a[190:191], v235 offset:63488
  v_mfma_f32_16x16x32_bf16 v[28:31], a[216:219], a[64:67], v[28:31]
  s_waitcnt lgkmcnt(15)
  ds_read_b64_tr_b16 a[192:193], v236 offset:0
  v_mfma_f32_16x16x32_bf16 v[36:39], a[80:83], a[64:67], v[36:39]
  v_mfma_f32_16x16x32_bf16 v[36:39], a[84:87], a[72:75], v[36:39]
  buffer_load_dwordx4 a[56:59], v244, s[36:39], s50 offen offset:2048 sc1
  ds_read_b64_tr_b16 a[194:195], v236 offset:2048
  v_mfma_f32_16x16x32_bf16 v[40:43], a[84:87], a[76:79], v[40:43]
  ds_read_b64_tr_b16 a[196:197], v236 offset:4096
  v_mfma_f32_16x16x32_bf16 v[40:43], a[80:83], a[68:71], v[40:43]
  s_waitcnt lgkmcnt(15)
  ds_read_b64_tr_b16 a[198:199], v236 offset:6144
  v_mfma_f32_16x16x32_bf16 v[48:51], a[88:91], a[68:71], v[48:51]
  ds_read_b64_tr_b16 a[200:201], v237 offset:0
  v_mfma_f32_16x16x32_bf16 v[48:51], a[92:95], a[76:79], v[48:51]
  buffer_load_dwordx4 a[60:63], v244, s[36:39], s50 offen offset:3072 sc1
  v_mfma_f32_16x16x32_bf16 v[44:47], a[92:95], a[72:75], v[44:47]
  ds_read_b64_tr_b16 a[202:203], v237 offset:2048
  v_mfma_f32_16x16x32_bf16 v[44:47], a[88:91], a[64:67], v[44:47]
  s_waitcnt vmcnt(12) lgkmcnt(15)
  ds_read_b64_tr_b16 a[204:205], v237 offset:4096
  v_mfma_f32_16x16x32_bf16 v[20:23], a[96:99], a[0:3], v[20:23]
  s_mov_b32 s50, 36864
  ds_read_b64_tr_b16 a[206:207], v237 offset:6144
  v_mfma_f32_16x16x32_bf16 v[20:23], a[100:103], a[8:11], v[20:23]
  buffer_load_dwordx4 a[64:67], v244, s[36:39], s50 offen offset:0 sc1
  v_mfma_f32_16x16x32_bf16 v[24:27], a[100:103], a[12:15], v[24:27]
  ds_read_b64_tr_b16 a[208:209], v238 offset:0
  v_mfma_f32_16x16x32_bf16 v[24:27], a[96:99], a[4:7], v[24:27]
  s_waitcnt lgkmcnt(15)
  ds_read_b64_tr_b16 a[210:211], v238 offset:2048
  v_mfma_f32_16x16x32_bf16 v[32:35], a[104:107], a[4:7], v[32:35]
  ds_read_b64_tr_b16 a[212:213], v238 offset:4096
  v_mfma_f32_16x16x32_bf16 v[32:35], a[108:111], a[12:15], v[32:35]
  buffer_load_dwordx4 a[68:71], v244, s[36:39], s50 offen offset:1024 sc1
  ds_read_b64_tr_b16 a[214:215], v238 offset:6144
  v_mfma_f32_16x16x32_bf16 v[28:31], a[108:111], a[8:11], v[28:31]
  v_mfma_f32_16x16x32_bf16 v[28:31], a[104:107], a[0:3], v[28:31]
  s_waitcnt lgkmcnt(15)
  ds_read_b64_tr_b16 a[216:217], v239 offset:0
  v_mfma_f32_16x16x32_bf16 v[36:39], a[112:115], a[0:3], v[36:39]
  s_waitcnt vmcnt(23)
  ds_read_b64_tr_b16 a[218:219], v239 offset:2048
  v_max_u32 v15, v156, v157
  v_mfma_f32_16x16x32_bf16 v[36:39], a[116:119], a[8:11], v[36:39]
  buffer_load_dwordx4 a[72:75], v244, s[36:39], s50 offen offset:2048 sc1
  ds_read_b64_tr_b16 a[220:221], v239 offset:4096
  v_mfma_f32_16x16x32_bf16 v[40:43], a[116:119], a[12:15], v[40:43]
  v_max3_u32 v15, v15, v158, v159
  v_max3_u32 v15, v15, v160, v161
  v_mfma_f32_16x16x32_bf16 v[40:43], a[112:115], a[4:7], v[40:43]
  s_waitcnt lgkmcnt(15)
  ds_read_b64_tr_b16 a[222:223], v239 offset:6144
  v_max3_u32 v15, v15, v162, v163
  v_mfma_f32_16x16x32_bf16 v[48:51], a[120:123], a[4:7], v[48:51]
  ds_read_b64_tr_b16 a[80:81], v236 offset:8192
  v_max3_u32 v15, v15, v164, v165
  v_mfma_f32_16x16x32_bf16 v[48:51], a[124:127], a[12:15], v[48:51]
  buffer_load_dwordx4 a[76:79], v244, s[36:39], s50 offen offset:3072 sc1
  ds_read_b64_tr_b16 a[82:83], v236 offset:10240
  v_mfma_f32_16x16x32_bf16 v[44:47], a[124:127], a[8:11], v[44:47]
  ds_read_b64_tr_b16 a[84:85], v236 offset:12288
  v_max3_u32 v15, v15, v166, v167
  v_mfma_f32_16x16x32_bf16 v[44:47], a[120:123], a[0:3], v[44:47]
  s_waitcnt vmcnt(12) lgkmcnt(15)
  v_max3_u32 v15, v15, v168, v169
  v_max3_u32 v15, v15, v170, v171
  v_mfma_f32_16x16x32_bf16 v[20:23], a[128:131], a[16:19], v[20:23]
  s_mov_b32 s50, 40960
  ds_read_b64_tr_b16 a[86:87], v236 offset:14336
  v_mfma_f32_16x16x32_bf16 v[20:23], a[132:135], a[24:27], v[20:23]
  buffer_load_dwordx4 a[0:3], v244, s[36:39], s50 offen offset:0 sc1
  ds_read_b64_tr_b16 a[88:89], v237 offset:8192
  v_mfma_f32_16x16x32_bf16 v[24:27], a[132:135], a[28:31], v[24:27]
  ds_read_b64_tr_b16 a[90:91], v237 offset:10240
  v_mfma_f32_16x16x32_bf16 v[24:27], a[128:131], a[20:23], v[24:27]
  s_waitcnt lgkmcnt(15)
  v_cmp_eq_u32 vcc, -1, v15
  s_nop 4
  s_cbranch_vccnz CK4s
CK4x:
  v_mfma_f32_16x16x32_bf16 v[32:35], a[136:139], a[20:23], v[32:35]
  ds_read_b64_tr_b16 a[92:93], v237 offset:12288
  v_add_f32 v156, v156, v164
  v_mfma_f32_16x16x32_bf16 v[32:35], a[140:143], a[28:31], v[32:35]
  buffer_load_dwordx4 a[4:7], v244, s[36:39], s50 offen offset:1024 sc1
  ds_read_b64_tr_b16 a[94:95], v237 offset:14336
  v_mfma_f32_16x16x32_bf16 v[28:31], a[140:143], a[24:27], v[28:31]
  ds_read_b64_tr_b16 a[96:97], v238 offset:8192
  v_add_f32 v157, v157, v165
  v_mfma_f32_16x16x32_bf16 v[28:31], a[136:139], a[16:19], v[28:31]
  s_waitcnt lgkmcnt(15)
  ds_read_b64_tr_b16 a[98:99], v238 offset:10240
  v_add_f32 v158, v158, v166
  v_mfma_f32_16x16x32_bf16 v[36:39], a[144:147], a[16:19], v[36:39]
  v_add_f32 v159, v159, v167
  v_add_f32 v160, v160, v168
  v_mfma_f32_16x16x32_bf16 v[36:39], a[148:151], a[24:27], v[36:39]
  buffer_load_dwordx4 a[8:11], v244, s[36:39], s50 offen offset:2048 sc1
  ds_read_b64_tr_b16 a[100:101], v238 offset:12288
  v_mfma_f32_16x16x32_bf16 v[40:43], a[148:151], a[28:31], v[40:43]
  ds_read_b64_tr_b16 a[102:103], v238 offset:14336
  v_add_f32 v161, v161, v169
  v_mfma_f32_16x16x32_bf16 v[40:43], a[144:147], a[20:23], v[40:43]
  s_waitcnt lgkmcnt(15)
  ds_read_b64_tr_b16 a[104:105], v239 offset:8192
  v_add_f32 v162, v162, v170
  v_mfma_f32_16x16x32_bf16 v[48:51], a[152:155], a[20:23], v[48:51]
  v_add_f32 v163, v163, v171
  v_add_f32 v156, v156, v160
  v_mfma_f32_16x16x32_bf16 v[48:51], a[156:159], a[28:31], v[48:51]
  buffer_load_dwordx4 a[12:15], v244, s[36:39], s50 offen offset:3072 sc1
  ds_read_b64_tr_b16 a[106:107], v239 offset:10240
  v_mfma_f32_16x16x32_bf16 v[44:47], a[156:159], a[24:27], v[44:47]
  ds_read_b64_tr_b16 a[108:109], v239 offset:12288
  v_add_f32 v157, v157, v161
  v_mfma_f32_16x16x32_bf16 v[44:47], a[152:155], a[16:19], v[44:47]
  s_waitcnt vmcnt(12) lgkmcnt(15)
  ds_read_b64_tr_b16 a[110:111], v239 offset:14336
  v_add_f32 v158, v158, v162
  v_mfma_f32_16x16x32_bf16 v[20:23], a[160:163], a[32:35], v[20:23]
  s_mov_b32 s50, 45056
  ds_read_b64_tr_b16 a[112:113], v236 offset:16384
  v_add_f32 v159, v159, v163
  v_mfma_f32_16x16x32_bf16 v[20:23], a[164:167], a[40:43], v[20:23]
  buffer_load_dwordx4 a[16:19], v244, s[36:39], s50 offen offset:0 sc1
  v_cvt_pk_bf16_f32 v160, v156, v157
  v_mfma_f32_16x16x32_bf16 v[24:27], a[164:167], a[44:47], v[24:27]
  ds_read_b64_tr_b16 a[114:115], v236 offset:18432
  v_lshlrev_b32 v156, 16, v160
  v_mfma_f32_16x16x32_bf16 v[24:27], a[160:163], a[36:39], v[24:27]
  s_waitcnt lgkmcnt(15)
  ds_read_b64_tr_b16 a[116:117], v236 offset:20480
  v_and_b32 v157, 0xffff0000, v160
  v_mfma_f32_16x16x32_bf16 v[32:35], a[168:171], a[36:39], v[32:35]
  ds_read_b64_tr_b16 a[118:119], v236 offset:22528
  v_cvt_pk_bf16_f32 v161, v158, v159
  v_mfma_f32_16x16x32_bf16 v[32:35], a[172:175], a[44:47], v[32:35]
  buffer_load_dwordx4 a[20:23], v244, s[36:39], s50 offen offset:1024 sc1
  v_lshlrev_b32 v158, 16, v161
  v_mfma_f32_16x16x32_bf16 v[28:31], a[172:175], a[40:43], v[28:31]
  ds_read_b64_tr_b16 a[120:121], v237 offset:16384
  v_and_b32 v159, 0xffff0000, v161
  v_mfma_f32_16x16x32_bf16 v[28:31], a[168:171], a[32:35], v[28:31]
  s_waitcnt lgkmcnt(15)
  ds_read_b64_tr_b16 a[122:123], v237 offset:18432
  v_add_f32 v156, v13, v156
  v_mfma_f32_16x16x32_bf16 v[36:39], a[176:179], a[32:35], v[36:39]
  ds_read_b64_tr_b16 a[124:125], v237 offset:20480
  v_add_f32 v157, v13, v157
  v_mfma_f32_16x16x32_bf16 v[36:39], a[180:183], a[40:43], v[36:39]
  buffer_load_dwordx4 a[24:27], v244, s[36:39], s50 offen offset:2048 sc1
  ds_read_b64_tr_b16 a[126:127], v237 offset:22528
  v_mfma_f32_16x16x32_bf16 v[40:43], a[180:183], a[44:47], v[40:43]
  v_add_f32 v158, v13, v158
  v_add_f32 v159, v13, v159
  v_mfma_f32_16x16x32_bf16 v[40:43], a[176:179], a[36:39], v[40:43]
  s_waitcnt lgkmcnt(15)
  ds_read_b64_tr_b16 a[128:129], v238 offset:16384
  v_cvt_pk_bf16_f32 v160, v156, v157
  v_mfma_f32_16x16x32_bf16 v[48:51], a[184:187], a[36:39], v[48:51]
  ds_read_b64_tr_b16 a[130:131], v238 offset:18432
  v_lshlrev_b32 v156, 16, v160
  v_mfma_f32_16x16x32_bf16 v[48:51], a[188:191], a[44:47], v[48:51]
  buffer_load_dwordx4 a[28:31], v244, s[36:39], s50 offen offset:3072 sc1
  ds_read_b64_tr_b16 a[132:133], v238 offset:20480
  v_mfma_f32_16x16x32_bf16 v[44:47], a[188:191], a[40:43], v[44:47]
  ds_read_b64_tr_b16 a[134:135], v238 offset:22528
  v_and_b32 v157, 0xffff0000, v160
  v_mfma_f32_16x16x32_bf16 v[44:47], a[184:187], a[32:35], v[44:47]
  s_waitcnt vmcnt(12) lgkmcnt(15)
  v_cvt_pk_bf16_f32 v161, v158, v159
  v_lshlrev_b32 v158, 16, v161
  v_mfma_f32_16x16x32_bf16 v[20:23], a[192:195], a[48:51], v[20:23]
  s_mov_b32 s50, 49152
  ds_read_b64_tr_b16 a[136:137], v239 offset:16384
  v_and_b32 v159, 0xffff0000, v161
  v_mfma_f32_16x16x32_bf16 v[20:23], a[196:199], a[56:59], v[20:23]
  ds_write_b128 v247, v[156:159]
  ds_read_b128 v[84:87], v245 offset:0
  v_mfma_f32_16x16x32_bf16 v[24:27], a[196:199], a[60:63], v[24:27]
  ds_read_b128 v[100:103], v245 offset:512
  ds_read_b128 v[88:91], v245 offset:64
  v_mfma_f32_16x16x32_bf16 v[24:27], a[192:195], a[52:55], v[24:27]
  s_waitcnt lgkmcnt(15)
  ds_read_b128 v[104:107], v245 offset:576
  ds_read_b128 v[92:95], v245 offset:128
  v_mfma_f32_16x16x32_bf16 v[32:35], a[200:203], a[52:55], v[32:35]
  ds_read_b128 v[108:111], v245 offset:640
  ds_read_b128 v[96:99], v245 offset:192
  v_mfma_f32_16x16x32_bf16 v[32:35], a[204:207], a[60:63], v[32:35]
  ds_read_b128 v[112:115], v245 offset:704
  ds_read_b128 v[116:119], v246 offset:512
  v_mfma_f32_16x16x32_bf16 v[28:31], a[204:207], a[56:59], v[28:31]
  ds_read_b128 v[120:123], v246 offset:576
  ds_read_b128 v[124:127], v246 offset:640
  v_mfma_f32_16x16x32_bf16 v[28:31], a[200:203], a[48:51], v[28:31]
  s_waitcnt lgkmcnt(15)
  ds_read_b128 v[128:131], v246 offset:704
  buffer_load_dwordx4 a[32:35], v244, s[36:39], s50 offen offset:0 sc1
  v_mfma_f32_16x16x32_bf16 v[36:39], a[208:211], a[48:51], v[36:39]
  ds_read_b64_tr_b16 a[138:139], v239 offset:18432
  ds_read_b64_tr_b16 a[140:141], v239 offset:20480
  v_mfma_f32_16x16x32_bf16 v[36:39], a[212:215], a[56:59], v[36:39]
  ds_read_b64_tr_b16 a[142:143], v239 offset:22528
  buffer_load_dwordx4 a[36:39], v244, s[36:39], s50 offen offset:1024 sc1
  v_mfma_f32_16x16x32_bf16 v[40:43], a[212:215], a[60:63], v[40:43]
  ds_read_b64_tr_b16 a[144:145], v236 offset:24576
  ds_read_b64_tr_b16 a[146:147], v236 offset:26624
  v_mfma_f32_16x16x32_bf16 v[40:43], a[208:211], a[52:55], v[40:43]
  s_waitcnt lgkmcnt(15)
  ds_read_b64_tr_b16 a[148:149], v236 offset:28672
  buffer_load_dwordx4 a[40:43], v244, s[36:39], s50 offen offset:2048 sc1
  v_mfma_f32_16x16x32_bf16 v[48:51], a[216:219], a[52:55], v[48:51]
  ds_read_b64_tr_b16 a[150:151], v236 offset:30720
  ds_read_b64_tr_b16 a[152:153], v237 offset:24576
  v_mfma_f32_16x16x32_bf16 v[48:51], a[220:223], a[60:63], v[48:51]
  ds_read_b64_tr_b16 a[154:155], v237 offset:26624
  buffer_load_dwordx4 a[44:47], v244, s[36:39], s50 offen offset:3072 sc1
  v_mfma_f32_16x16x32_bf16 v[44:47], a[220:223], a[56:59], v[44:47]
  ds_read_b64_tr_b16 a[156:157], v237 offset:28672
  ds_read_b64_tr_b16 a[158:159], v237 offset:30720
  v_mfma_f32_16x16x32_bf16 v[44:47], a[216:219], a[48:51], v[44:47]
  s_waitcnt vmcnt(12) lgkmcnt(15)
  ds_read_b64_tr_b16 a[160:161], v238 offset:24576
  v_accvgpr_write_b32 a248, v156
  v_mfma_f32_16x16x32_bf16 v[20:23], a[80:83], a[64:67], v[20:23]
  s_mov_b32 s50, 53248
  ds_read_b64_tr_b16 a[162:163], v238 offset:26624
  v_accvgpr_write_b32 a249, v157
  v_mfma_f32_16x16x32_bf16 v[20:23], a[84:87], a[72:75], v[20:23]
  buffer_load_dwordx4 a[48:51], v244, s[36:39], s50 offen offset:0 sc1
  v_accvgpr_write_b32 a250, v158
  v_mfma_f32_16x16x32_bf16 v[24:27], a[84:87], a[76:79], v[24:27]
  ds_read_b64_tr_b16 a[164:165], v238 offset:28672
  v_accvgpr_write_b32 a251, v159
  v_mfma_f32_16x16x32_bf16 v[24:27], a[80:83], a[68:71], v[24:27]
  s_waitcnt lgkmcnt(14)
  ds_read_b64_tr_b16 a[166:167], v238 offset:30720
  v_mfma_f32_16x16x32_bf16 v[32:35], a[88:91], a[68:71], v[32:35]
  ds_read_b64_tr_b16 a[168:169], v239 offset:24576
  v_cvt_pk_bf16_f32 v148, v116, v117
  v_mfma_f32_16x16x32_bf16 v[32:35], a[92:95], a[76:79], v[32:35]
  buffer_load_dwordx4 a[52:55], v244, s[36:39], s50 offen offset:1024 sc1
  v_cvt_pk_bf16_f32 v149, v118, v119
  v_mfma_f32_16x16x32_bf16 v[28:31], a[92:95], a[72:75], v[28:31]
  ds_read_b64_tr_b16 a[170:171], v239 offset:26624
  v_cvt_pk_bf16_f32 v150, v120, v121
  v_mfma_f32_16x16x32_bf16 v[28:31], a[88:91], a[64:67], v[28:31]
  s_waitcnt lgkmcnt(15)
  ds_read_b64_tr_b16 a[172:173], v239 offset:28672
  v_cvt_pk_bf16_f32 v151, v122, v123
  v_mfma_f32_16x16x32_bf16 v[36:39], a[96:99], a[64:67], v[36:39]
  ds_read_b64_tr_b16 a[174:175], v239 offset:30720
  v_cvt_pk_bf16_f32 v152, v124, v125
  v_mfma_f32_16x16x32_bf16 v[36:39], a[100:103], a[72:75], v[36:39]
  buffer_load_dwordx4 a[56:59], v244, s[36:39], s50 offen offset:2048 sc1
  ds_read_b64_tr_b16 a[176:177], v236 offset:32768
  v_mfma_f32_16x16x32_bf16 v[40:43], a[100:103], a[76:79], v[40:43]
  v_cvt_pk_bf16_f32 v153, v126, v127
  v_cvt_pk_bf16_f32 v154, v128, v129
  v_mfma_f32_16x16x32_bf16 v[40:43], a[96:99], a[68:71], v[40:43]
  s_waitcnt lgkmcnt(15)
  ds_read_b64_tr_b16 a[178:179], v236 offset:34816
  v_cvt_pk_bf16_f32 v155, v130, v131
  v_mfma_f32_16x16x32_bf16 v[48:51], a[104:107], a[68:71], v[48:51]
  buffer_store_dwordx4 v[148:151], v0, s[36:39], s75 offen offset:0 sc1
  buffer_store_dwordx4 v[152:155], v0, s[36:39], s75 offen offset:1024 sc1
  v_mfma_f32_16x16x32_bf16 v[48:51], a[108:111], a[76:79], v[48:51]
  ds_read_b64_tr_b16 a[180:181], v236 offset:36864
  buffer_load_dwordx4 a[60:63], v244, s[36:39], s50 offen offset:3072 sc1
  v_mfma_f32_16x16x32_bf16 v[44:47], a[108:111], a[72:75], v[44:47]
  ds_read_b64_tr_b16 a[182:183], v236 offset:38912
  v_mfma_f32_16x16x32_bf16 v[44:47], a[104:107], a[64:67], v[44:47]
  s_waitcnt vmcnt(14) lgkmcnt(15)
  ds_read_b64_tr_b16 a[184:185], v237 offset:32768
  v_mfma_f32_16x16x32_bf16 v[20:23], a[112:115], a[0:3], v[20:23]
  s_mov_b32 s50, 57344
  ds_read_b64_tr_b16 a[186:187], v237 offset:34816
  v_mfma_f32_16x16x32_bf16 v[20:23], a[116:119], a[8:11], v[20:23]
  buffer_load_dwordx4 a[64:67], v244, s[36:39], s50 offen offset:0 sc1
  ds_read_b64_tr_b16 a[188:189], v237 offset:36864
  v_mfma_f32_16x16x32_bf16 v[24:27], a[116:119], a[12:15], v[24:27]
  ds_read_b64_tr_b16 a[190:191], v237 offset:38912
  v_mfma_f32_16x16x32_bf16 v[24:27], a[112:115], a[4:7], v[24:27]
  s_waitcnt lgkmcnt(15)
  v_mfma_f32_16x16x32_bf16 v[32:35], a[120:123], a[4:7], v[32:35]
  ds_read_b64_tr_b16 a[192:193], v238 offset:32768
  v_mfma_f32_16x16x32_bf16 v[32:35], a[124:127], a[12:15], v[32:35]
  buffer_load_dwordx4 a[68:71], v244, s[36:39], s50 offen offset:1024 sc1
  ds_read_b64_tr_b16 a[194:195], v238 offset:34816
  v_mfma_f32_16x16x32_bf16 v[28:31], a[124:127], a[8:11], v[28:31]
  ds_read_b64_tr_b16 a[196:197], v238 offset:36864
  v_mfma_f32_16x16x32_bf16 v[28:31], a[120:123], a[0:3], v[28:31]
  s_waitcnt lgkmcnt(15)
  v_mfma_f32_16x16x32_bf16 v[36:39], a[128:131], a[0:3], v[36:39]
  ds_read_b64_tr_b16 a[198:199], v238 offset:38912
  v_mfma_f32_16x16x32_bf16 v[36:39], a[132:135], a[8:11], v[36:39]
  buffer_load_dwordx4 a[72:75], v244, s[36:39], s50 offen offset:2048 sc1
  ds_read_b64_tr_b16 a[200:201], v239 offset:32768
  v_mfma_f32_16x16x32_bf16 v[40:43], a[132:135], a[12:15], v[40:43]
  ds_read_b64_tr_b16 a[202:203], v239 offset:34816
  v_mfma_f32_16x16x32_bf16 v[40:43], a[128:131], a[4:7], v[40:43]
  s_waitcnt lgkmcnt(15)
  ds_read_b64_tr_b16 a[204:205], v239 offset:36864
  v_mfma_f32_16x16x32_bf16 v[48:51], a[136:139], a[4:7], v[48:51]
  v_mfma_f32_16x16x32_bf16 v[48:51], a[140:143], a[12:15], v[48:51]
  buffer_load_dwordx4 a[76:79], v244, s[36:39], s50 offen offset:3072 sc1
  ds_read_b64_tr_b16 a[206:207], v239 offset:38912
  v_mfma_f32_16x16x32_bf16 v[44:47], a[140:143], a[8:11], v[44:47]
  ds_read_b64_tr_b16 a[208:209], v236 offset:40960
  v_mfma_f32_16x16x32_bf16 v[44:47], a[136:139], a[0:3], v[44:47]
  s_waitcnt vmcnt(14) lgkmcnt(15)
  ds_read_b64_tr_b16 a[210:211], v236 offset:43008
  v_mfma_f32_16x16x32_bf16 v[20:23], a[144:147], a[16:19], v[20:23]
  s_mov_b32 s50, 61440
  v_mfma_f32_16x16x32_bf16 v[20:23], a[148:151], a[24:27], v[20:23]
  buffer_load_dwordx4 a[0:3], v244, s[36:39], s50 offen offset:0 sc1
  ds_read_b64_tr_b16 a[212:213], v236 offset:45056
  v_mfma_f32_16x16x32_bf16 v[24:27], a[148:151], a[28:31], v[24:27]
  ds_read_b64_tr_b16 a[214:215], v236 offset:47104
  v_mfma_f32_16x16x32_bf16 v[24:27], a[144:147], a[20:23], v[24:27]
  s_waitcnt lgkmcnt(15)
  ds_read_b64_tr_b16 a[216:217], v237 offset:40960
  v_mfma_f32_16x16x32_bf16 v[32:35], a[152:155], a[20:23], v[32:35]
  ds_read_b64_tr_b16 a[218:219], v237 offset:43008
  v_mfma_f32_16x16x32_bf16 v[32:35], a[156:159], a[28:31], v[32:35]
  buffer_load_dwordx4 a[4:7], v244, s[36:39], s50 offen offset:1024 sc1
  v_mfma_f32_16x16x32_bf16 v[28:31], a[156:159], a[24:27], v[28:31]
  ds_read_b64_tr_b16 a[220:221], v237 offset:45056
  v_mfma_f32_16x16x32_bf16 v[28:31], a[152:155], a[16:19], v[28:31]
  s_waitcnt lgkmcnt(15)
  ds_read_b64_tr_b16 a[222:223], v237 offset:47104
  v_mfma_f32_16x16x32_bf16 v[36:39], a[160:163], a[16:19], v[36:39]
  ds_read_b64_tr_b16 a[80:81], v238 offset:40960
  v_mfma_f32_16x16x32_bf16 v[36:39], a[164:167], a[24:27], v[36:39]
  buffer_load_dwordx4 a[8:11], v244, s[36:39], s50 offen offset:2048 sc1
  ds_read_b64_tr_b16 a[82:83], v238 offset:43008
  v_mfma_f32_16x16x32_bf16 v[40:43], a[164:167], a[28:31], v[40:43]
  v_mfma_f32_16x16x32_bf16 v[40:43], a[160:163], a[20:23], v[40:43]
  s_waitcnt lgkmcnt(15)
  ds_read_b64_tr_b16 a[84:85], v238 offset:45056
  v_mfma_f32_16x16x32_bf16 v[48:51], a[168:171], a[20:23], v[48:51]
  ds_read_b64_tr_b16 a[86:87], v238 offset:47104
  v_mfma_f32_16x16x32_bf16 v[48:51], a[172:175], a[28:31], v[48:51]
  buffer_load_dwordx4 a[12:15], v244, s[36:39], s50 offen offset:3072 sc1
  ds_read_b64_tr_b16 a[88:89], v239 offset:40960
  v_mfma_f32_16x16x32_bf16 v[44:47], a[172:175], a[24:27], v[44:47]
  v_mfma_f32_16x16x32_bf16 v[44:47], a[168:171], a[16:19], v[44:47]
  s_waitcnt vmcnt(14) lgkmcnt(15)
  ds_read_b64_tr_b16 a[90:91], v239 offset:43008
  v_mfma_f32_16x16x32_bf16 v[20:23], a[176:179], a[32:35], v[20:23]
  ds_read_b64_tr_b16 a[92:93], v239 offset:45056
  v_mfma_f32_16x16x32_bf16 v[20:23], a[180:183], a[40:43], v[20:23]
  ds_read_b64_tr_b16 a[94:95], v239 offset:47104
  v_mfma_f32_16x16x32_bf16 v[24:27], a[180:183], a[44:47], v[24:27]
  ds_read_b64_tr_b16 a[96:97], v236 offset:49152
  v_mfma_f32_16x16x32_bf16 v[24:27], a[176:179], a[36:39], v[24:27]
  s_waitcnt lgkmcnt(15)
  v_mfma_f32_16x16x32_bf16 v[32:35], a[184:187], a[36:39], v[32:35]
  ds_read_b64_tr_b16 a[98:99], v236 offset:51200
  v_mfma_f32_16x16x32_bf16 v[32:35], a[188:191], a[44:47], v[32:35]
  ds_read_b64_tr_b16 a[100:101], v236 offset:53248
  v_mfma_f32_16x16x32_bf16 v[28:31], a[188:191], a[40:43], v[28:31]
  ds_read_b64_tr_b16 a[102:103], v236 offset:55296
  v_mfma_f32_16x16x32_bf16 v[28:31], a[184:187], a[32:35], v[28:31]
  s_waitcnt lgkmcnt(15)
  v_mfma_f32_16x16x32_bf16 v[36:39], a[192:195], a[32:35], v[36:39]
  ds_read_b64_tr_b16 a[104:105], v237 offset:49152
  v_mfma_f32_16x16x32_bf16 v[36:39], a[196:199], a[40:43], v[36:39]
  ds_read_b64_tr_b16 a[106:107], v237 offset:51200
  v_mfma_f32_16x16x32_bf16 v[40:43], a[196:199], a[44:47], v[40:43]
  ds_read_b64_tr_b16 a[108:109], v237 offset:53248
  v_mfma_f32_16x16x32_bf16 v[40:43], a[192:195], a[36:39], v[40:43]
  s_waitcnt lgkmcnt(15)
  ds_read_b64_tr_b16 a[110:111], v237 offset:55296
  v_mfma_f32_16x16x32_bf16 v[48:51], a[200:203], a[36:39], v[48:51]
  v_mfma_f32_16x16x32_bf16 v[48:51], a[204:207], a[44:47], v[48:51]
  ds_read_b64_tr_b16 a[112:113], v238 offset:49152
  v_mfma_f32_16x16x32_bf16 v[44:47], a[204:207], a[40:43], v[44:47]
  ds_read_b64_tr_b16 a[114:115], v238 offset:51200
  v_mfma_f32_16x16x32_bf16 v[44:47], a[200:203], a[32:35], v[44:47]
  s_waitcnt vmcnt(8) lgkmcnt(15)
  ds_read_b64_tr_b16 a[116:117], v238 offset:53248
  v_mfma_f32_16x16x32_bf16 v[20:23], a[208:211], a[48:51], v[20:23]
  v_mfma_f32_16x16x32_bf16 v[20:23], a[212:215], a[56:59], v[20:23]
  ds_read_b64_tr_b16 a[118:119], v238 offset:55296
  v_mfma_f32_16x16x32_bf16 v[24:27], a[212:215], a[60:63], v[24:27]
  ds_read_b64_tr_b16 a[120:121], v239 offset:49152
  v_mfma_f32_16x16x32_bf16 v[24:27], a[208:211], a[52:55], v[24:27]
  s_waitcnt lgkmcnt(15)
  ds_read_b64_tr_b16 a[122:123], v239 offset:51200
  v_mfma_f32_16x16x32_bf16 v[32:35], a[216:219], a[52:55], v[32:35]
  ds_read_b64_tr_b16 a[124:125], v239 offset:53248
  v_mfma_f32_16x16x32_bf16 v[32:35], a[220:223], a[60:63], v[32:35]
  v_mfma_f32_16x16x32_bf16 v[28:31], a[220:223], a[56:59], v[28:31]
  ds_read_b64_tr_b16 a[126:127], v239 offset:55296
  v_mfma_f32_16x16x32_bf16 v[28:31], a[216:219], a[48:51], v[28:31]
  s_waitcnt lgkmcnt(15)
  ds_read_b64_tr_b16 a[128:129], v236 offset:57344
  v_mfma_f32_16x16x32_bf16 v[36:39], a[80:83], a[48:51], v[36:39]
  ds_read_b64_tr_b16 a[130:131], v236 offset:59392
  v_mfma_f32_16x16x32_bf16 v[36:39], a[84:87], a[56:59], v[36:39]
  v_mfma_f32_16x16x32_bf16 v[40:43], a[84:87], a[60:63], v[40:43]
  ds_read_b64_tr_b16 a[132:133], v236 offset:61440
  v_mfma_f32_16x16x32_bf16 v[40:43], a[80:83], a[52:55], v[40:43]
  s_waitcnt lgkmcnt(15)
  ds_read_b64_tr_b16 a[134:135], v236 offset:63488
  v_mfma_f32_16x16x32_bf16 v[48:51], a[88:91], a[52:55], v[48:51]
  ds_read_b64_tr_b16 a[136:137], v237 offset:57344
  v_mfma_f32_16x16x32_bf16 v[48:51], a[92:95], a[60:63], v[48:51]
  ds_read_b64_tr_b16 a[138:139], v237 offset:59392
  v_mfma_f32_16x16x32_bf16 v[44:47], a[92:95], a[56:59], v[44:47]
  v_mfma_f32_16x16x32_bf16 v[44:47], a[88:91], a[48:51], v[44:47]
  s_waitcnt vmcnt(4) lgkmcnt(15)
  ds_read_b64_tr_b16 a[140:141], v237 offset:61440
  v_mfma_f32_16x16x32_bf16 v[20:23], a[96:99], a[64:67], v[20:23]
  ds_read_b64_tr_b16 a[142:143], v237 offset:63488
  v_mfma_f32_16x16x32_bf16 v[20:23], a[100:103], a[72:75], v[20:23]
  ds_read_b64_tr_b16 a[144:145], v238 offset:57344
  v_mfma_f32_16x16x32_bf16 v[24:27], a[100:103], a[76:79], v[24:27]
  v_mfma_f32_16x16x32_bf16 v[24:27], a[96:99], a[68:71], v[24:27]
  s_waitcnt lgkmcnt(15)
  ds_read_b64_tr_b16 a[146:147], v238 offset:59392
  v_mfma_f32_16x16x32_bf16 v[32:35], a[104:107], a[68:71], v[32:35]
  ds_read_b64_tr_b16 a[148:149], v238 offset:61440
  v_mfma_f32_16x16x32_bf16 v[32:35], a[108:111], a[76:79], v[32:35]
  ds_read_b64_tr_b16 a[150:151], v238 offset:63488
  v_mfma_f32_16x16x32_bf16 v[28:31], a[108:111], a[72:75], v[28:31]
  ds_read_b64_tr_b16 a[152:153], v239 offset:57344
  v_mfma_f32_16x16x32_bf16 v[28:31], a[104:107], a[64:67], v[28:31]
  s_waitcnt lgkmcnt(15)
  v_mfma_f32_16x16x32_bf16 v[36:39], a[112:115], a[64:67], v[36:39]
  ds_read_b64_tr_b16 a[154:155], v239 offset:59392
  v_mfma_f32_16x16x32_bf16 v[36:39], a[116:119], a[72:75], v[36:39]
  ds_read_b64_tr_b16 a[156:157], v239 offset:61440
  v_mfma_f32_16x16x32_bf16 v[40:43], a[116:119], a[76:79], v[40:43]
  ds_read_b64_tr_b16 a[158:159], v239 offset:63488
  v_mfma_f32_16x16x32_bf16 v[40:43], a[112:115], a[68:71], v[40:43]
  s_waitcnt lgkmcnt(15)
  v_mfma_f32_16x16x32_bf16 v[48:51], a[120:123], a[68:71], v[48:51]
  v_mfma_f32_16x16x32_bf16 v[48:51], a[124:127], a[76:79], v[48:51]
  v_mfma_f32_16x16x32_bf16 v[44:47], a[124:127], a[72:75], v[44:47]
  v_mfma_f32_16x16x32_bf16 v[44:47], a[120:123], a[64:67], v[44:47]
  s_waitcnt vmcnt(0) lgkmcnt(12)
  v_mfma_f32_16x16x32_bf16 v[20:23], a[128:131], a[0:3], v[20:23]
  v_mfma_f32_16x16x32_bf16 v[20:23], a[132:135], a[8:11], v[20:23]
  v_mfma_f32_16x16x32_bf16 v[24:27], a[132:135], a[12:15], v[24:27]
Ha0_2:
  s_cbranch_execz Ra
  v_mfma_f32_16x16x32_bf16 v[24:27], a[128:131], a[4:7], v[24:27]
  s_waitcnt lgkmcnt(8)
  v_mfma_f32_16x16x32_bf16 v[32:35], a[136:139], a[4:7], v[32:35]
  v_mfma_f32_16x16x32_bf16 v[32:35], a[140:143], a[12:15], v[32:35]
  v_mfma_f32_16x16x32_bf16 v[28:31], a[140:143], a[8:11], v[28:31]
  v_mfma_f32_16x16x32_bf16 v[28:31], a[136:139], a[0:3], v[28:31]
  s_waitcnt lgkmcnt(4)
  v_mfma_f32_16x16x32_bf16 v[36:39], a[144:147], a[0:3], v[36:39]
  v_mfma_f32_16x16x32_bf16 v[36:39], a[148:151], a[8:11], v[36:39]
  v_mfma_f32_16x16x32_bf16 v[40:43], a[148:151], a[12:15], v[40:43]
  v_mfma_f32_16x16x32_bf16 v[40:43], a[144:147], a[4:7], v[40:43]
  s_waitcnt lgkmcnt(0)
  v_mfma_f32_16x16x32_bf16 v[48:51], a[152:155], a[4:7], v[48:51]
  v_mfma_f32_16x16x32_bf16 v[48:51], a[156:159], a[12:15], v[48:51]
  v_mfma_f32_16x16x32_bf16 v[44:47], a[156:159], a[8:11], v[44:47]
  v_mfma_f32_16x16x32_bf16 v[44:47], a[152:155], a[0:3], v[44:47]
  s_waitcnt lgkmcnt(0)
  s_nop 2
  v_pk_fma_f32 v[52:53], v[84:85], v[20:21], v[52:53]
  v_pk_fma_f32 v[54:55], v[86:87], v[22:23], v[54:55]
  v_pk_fma_f32 v[56:57], v[88:89], v[28:29], v[56:57]
  v_pk_fma_f32 v[58:59], v[90:91], v[30:31], v[58:59]
  v_pk_mul_f32 v[20:21], v[52:53], v[100:101]
  v_pk_mul_f32 v[22:23], v[54:55], v[102:103]
  v_pk_mul_f32 v[28:29], v[56:57], v[104:105]
  v_pk_mul_f32 v[30:31], v[58:59], v[106:107]
  v_cvt_pk_bf16_f32 v132, v20, v21
  v_cvt_pk_bf16_f32 v133, v22, v23
  v_cvt_pk_bf16_f32 v134, v28, v29
  v_cvt_pk_bf16_f32 v135, v30, v31
  buffer_store_dwordx4 v[132:135], v0, s[36:39], s73 offen offset:0 sc1
  v_pk_fma_f32 v[68:69], v[84:85], v[24:25], v[68:69]
  v_pk_fma_f32 v[70:71], v[86:87], v[26:27], v[70:71]
  v_pk_fma_f32 v[72:73], v[88:89], v[32:33], v[72:73]
  v_pk_fma_f32 v[74:75], v[90:91], v[34:35], v[74:75]
  v_pk_mul_f32 v[24:25], v[68:69], v[100:101]
  v_pk_mul_f32 v[26:27], v[70:71], v[102:103]
  v_pk_mul_f32 v[32:33], v[72:73], v[104:105]
  v_pk_mul_f32 v[34:35], v[74:75], v[106:107]
  v_cvt_pk_bf16_f32 v140, v24, v25
  v_cvt_pk_bf16_f32 v141, v26, v27
  v_cvt_pk_bf16_f32 v142, v32, v33
  v_cvt_pk_bf16_f32 v143, v34, v35
  buffer_store_dwordx4 v[140:143], v0, s[36:39], s73 offen offset:1024 sc1
  v_pk_fma_f32 v[60:61], v[92:93], v[36:37], v[60:61]
  v_pk_fma_f32 v[62:63], v[94:95], v[38:39], v[62:63]
  v_pk_fma_f32 v[64:65], v[96:97], v[44:45], v[64:65]
  v_pk_fma_f32 v[66:67], v[98:99], v[46:47], v[66:67]
  v_pk_mul_f32 v[36:37], v[60:61], v[108:109]
  v_pk_mul_f32 v[38:39], v[62:63], v[110:111]
  v_pk_mul_f32 v[44:45], v[64:65], v[112:113]
  v_pk_mul_f32 v[46:47], v[66:67], v[114:115]
  v_cvt_pk_bf16_f32 v136, v36, v37
  v_cvt_pk_bf16_f32 v137, v38, v39
  v_cvt_pk_bf16_f32 v138, v44, v45
  v_cvt_pk_bf16_f32 v139, v46, v47
  buffer_store_dwordx4 v[136:139], v0, s[36:39], s51 offen offset:0 sc1
  v_pk_fma_f32 v[76:77], v[92:93], v[40:41], v[76:77]
  v_pk_fma_f32 v[78:79], v[94:95], v[42:43], v[78:79]
  v_pk_fma_f32 v[80:81], v[96:97], v[48:49], v[80:81]
  v_pk_fma_f32 v[82:83], v[98:99], v[50:51], v[82:83]
  v_pk_mul_f32 v[40:41], v[76:77], v[108:109]
  v_pk_mul_f32 v[42:43], v[78:79], v[110:111]
  v_pk_mul_f32 v[48:49], v[80:81], v[112:113]
  v_pk_mul_f32 v[50:51], v[82:83], v[114:115]
  v_cvt_pk_bf16_f32 v144, v40, v41
  v_cvt_pk_bf16_f32 v145, v42, v43
  v_cvt_pk_bf16_f32 v146, v48, v49
  v_cvt_pk_bf16_f32 v147, v50, v51
  buffer_store_dwordx4 v[144:147], v0, s[36:39], s51 offen offset:1024 sc1
  v_pk_mul_f32 v[30:31], v[52:53], v[52:53]
  v_pk_mul_f32 v[34:35], v[68:69], v[68:69]
  v_pk_fma_f32 v[30:31], v[54:55], v[54:55], v[30:31]
  v_pk_add_f32 v[28:29], v[54:55], v[52:53]
  v_pk_fma_f32 v[34:35], v[70:71], v[70:71], v[34:35]
  v_pk_add_f32 v[32:33], v[70:71], v[68:69]
  v_pk_fma_f32 v[30:31], v[56:57], v[56:57], v[30:31]
  v_pk_add_f32 v[28:29], v[56:57], v[28:29]
  v_pk_fma_f32 v[34:35], v[72:73], v[72:73], v[34:35]
  v_pk_add_f32 v[32:33], v[72:73], v[32:33]
  v_pk_fma_f32 v[30:31], v[58:59], v[58:59], v[30:31]
  v_pk_add_f32 v[28:29], v[58:59], v[28:29]
  v_pk_fma_f32 v[34:35], v[74:75], v[74:75], v[34:35]
  v_pk_add_f32 v[32:33], v[74:75], v[32:33]
  v_pk_fma_f32 v[30:31], v[60:61], v[60:61], v[30:31]
  v_pk_add_f32 v[28:29], v[60:61], v[28:29]
  v_pk_fma_f32 v[34:35], v[76:77], v[76:77], v[34:35]
  v_pk_add_f32 v[32:33], v[76:77], v[32:33]
  v_pk_fma_f32 v[30:31], v[62:63], v[62:63], v[30:31]
  v_pk_add_f32 v[28:29], v[62:63], v[28:29]
  v_pk_fma_f32 v[34:35], v[78:79], v[78:79], v[34:35]
  v_pk_add_f32 v[32:33], v[78:79], v[32:33]
  v_pk_fma_f32 v[30:31], v[64:65], v[64:65], v[30:31]
  v_pk_add_f32 v[28:29], v[64:65], v[28:29]
  v_pk_fma_f32 v[34:35], v[80:81], v[80:81], v[34:35]
  v_pk_add_f32 v[32:33], v[80:81], v[32:33]
  v_pk_fma_f32 v[30:31], v[66:67], v[66:67], v[30:31]
  v_pk_add_f32 v[28:29], v[66:67], v[28:29]
  v_pk_fma_f32 v[34:35], v[82:83], v[82:83], v[34:35]
  v_pk_add_f32 v[32:33], v[82:83], v[32:33]
  v_add_f32 v20, v28, v29
  v_add_f32 v21, v30, v31
  v_add_f32 v22, v32, v33
  v_add_f32 v23, v34, v35
  v_mov_b32 v24, v20
  v_mov_b32 v25, v21
  v_mov_b32 v26, v22
  v_mov_b32 v27, v23
  v_permlane16_swap_b32 v20, v24
  v_permlane16_swap_b32 v21, v25
  v_permlane16_swap_b32 v22, v26
  v_permlane16_swap_b32 v23, v27
  v_pk_add_f32 v[20:21], v[20:21], v[24:25]
  v_pk_add_f32 v[22:23], v[22:23], v[26:27]
  v_mov_b32 v24, v20
  v_mov_b32 v25, v21
  v_mov_b32 v26, v22
  v_mov_b32 v27, v23
  v_permlane32_swap_b32 v20, v24
  v_permlane32_swap_b32 v21, v25
  v_permlane32_swap_b32 v22, v26
  v_permlane32_swap_b32 v23, v27
  v_pk_add_f32 v[20:21], v[20:21], v[24:25]
  v_pk_add_f32 v[22:23], v[22:23], v[26:27]
  s_mov_b64 exec, 0xffff
  buffer_store_dwordx4 v[20:23], v0, s[36:39], s74 offen sc1
  s_mov_b64 exec, -1
  v_cvt_pk_bf16_f32 v116, v52, v53
  v_cvt_pk_bf16_f32 v117, v54, v55
  v_cvt_pk_bf16_f32 v118, v56, v57
  v_cvt_pk_bf16_f32 v119, v58, v59
  v_cvt_pk_bf16_f32 v120, v60, v61
  v_cvt_pk_bf16_f32 v121, v62, v63
  v_cvt_pk_bf16_f32 v122, v64, v65
  v_cvt_pk_bf16_f32 v123, v66, v67
  v_cvt_pk_bf16_f32 v124, v68, v69
  v_cvt_pk_bf16_f32 v125, v70, v71
  v_cvt_pk_bf16_f32 v126, v72, v73
  v_cvt_pk_bf16_f32 v127, v74, v75
  v_cvt_pk_bf16_f32 v128, v76, v77
  v_cvt_pk_bf16_f32 v129, v78, v79
  v_cvt_pk_bf16_f32 v130, v80, v81
  v_cvt_pk_bf16_f32 v131, v82, v83
  v_accvgpr_write_b32 a232, v116
  v_accvgpr_write_b32 a233, v117
  v_accvgpr_write_b32 a234, v118
  v_accvgpr_write_b32 a235, v119
  v_accvgpr_write_b32 a236, v120
  v_accvgpr_write_b32 a237, v121
  v_accvgpr_write_b32 a238, v122
  v_accvgpr_write_b32 a239, v123
  v_accvgpr_write_b32 a240, v124
  v_accvgpr_write_b32 a241, v125
  v_accvgpr_write_b32 a242, v126
  v_accvgpr_write_b32 a243, v127
  v_accvgpr_write_b32 a244, v128
  v_accvgpr_write_b32 a245, v129
  v_accvgpr_write_b32 a246, v130
  v_accvgpr_write_b32 a247, v131
  v_mov_b32 v12, s3
  s_waitcnt vmcnt(0) lgkmcnt(0)
  s_barrier
  s_mov_b64 exec, 1
  buffer_store_dword v12, v0, s[36:39], s45 offen sc1
  s_mov_b64 exec, -1
  s_bfe_u32 s56, s82, 0x40000
  s_mul_i32 s56, s56, 458752
  s_add_u32 m0, s84, 0
  s_nop 0
  buffer_load_dwordx4 v3, s[16:19], s56 offen offset:0 lds
  buffer_load_dwordx4 v4, s[16:19], s56 offen offset:1024 lds
  buffer_load_dwordx4 v5, s[16:19], s56 offen offset:2048 lds
  buffer_load_dwordx4 v6, s[16:19], s56 offen offset:3072 lds
  s_add_u32 m0, s84, 4096
  s_nop 0
  buffer_load_dwordx4 v7, s[16:19], s56 offen offset:0 lds
  buffer_load_dwordx4 v8, s[16:19], s56 offen offset:1024 lds
  buffer_load_dwordx4 v9, s[16:19], s56 offen offset:2048 lds
  s_bfe_u32 s56, s82, 0x40004
  s_mul_i32 s56, s56, 458752
  s_add_u32 m0, s84, 28672
  s_nop 0
  buffer_load_dwordx4 v3, s[16:19], s56 offen offset:0 lds
  buffer_load_dwordx4 v4, s[16:19], s56 offen offset:1024 lds
  buffer_load_dwordx4 v5, s[16:19], s56 offen offset:2048 lds
  buffer_load_dwordx4 v6, s[16:19], s56 offen offset:3072 lds
  s_add_u32 m0, s84, 32768
  s_nop 0
  buffer_load_dwordx4 v7, s[16:19], s56 offen offset:0 lds
  buffer_load_dwordx4 v8, s[16:19], s56 offen offset:1024 lds
  buffer_load_dwordx4 v9, s[16:19], s56 offen offset:2048 lds
  s_bfe_u32 s57, s82, 0x40000
  s_lshl_b32 s57, s57, 13
  s_add_u32 s57, s57, s85
  s_lshl2_add_u32 s48, s2, s44
  s_cmp_eq_u32 s48, 1
  s_cbranch_scc1 CKSs
CKSx:
  s_mov_b64 exec, 0
  s_cmp_eq_u32 s44, 1
  s_cbranch_scc1 Hb0
  s_cmp_eq_u32 s44, 2
  s_cbranch_scc1 Hb1
  s_cmp_eq_u32 s44, 3
  s_cbranch_scc1 Hb2
Rb:
  s_mov_b64 exec, -1
G3S:
  s_cmp_lg_u32 s44, 0
  s_cbranch_scc1 SM5x
  s_mov_b32 s46, 60000
  s_mov_b32 s47, 5242880
SM5:
  buffer_load_dword v13, v251, s[36:39], s47 offen sc1
  s_sub_u32 s46, s46, 1
  s_cmp_eq_u32 s46, 0
  s_waitcnt vmcnt(0)
  s_cbranch_scc1 SM5x
  v_cmp_ne_u32 vcc, s3, v13
  s_nop 4
  s_cbranch_vccnz SM5
SM5x:
  s_waitcnt vmcnt(7)
  s_barrier
  buffer_load_dwordx4 a[0:3], v0, s[36:39], s57 offen offset:0 sc1
  buffer_load_dwordx4 a[4:7], v0, s[36:39], s57 offen offset:1024 sc1
  buffer_load_dwordx4 a[8:11], v0, s[36:39], s57 offen offset:2048 sc1
  buffer_load_dwordx4 a[12:15], v0, s[36:39], s57 offen offset:3072 sc1
  s_add_u32 s57, s57, 4096
  buffer_load_dwordx4 a[16:19], v0, s[36:39], s57 offen offset:0 sc1
  buffer_load_dwordx4 a[20:23], v0, s[36:39], s57 offen offset:1024 sc1
  buffer_load_dwordx4 a[24:27], v0, s[36:39], s57 offen offset:2048 sc1
  buffer_load_dwordx4 a[28:31], v0, s[36:39], s57 offen offset:3072 sc1
  ds_read_b64_tr_b16 a[128:129], v1 offset:0
  ds_read_b64_tr_b16 a[130:131], v1 offset:3584
  ds_read_b64_tr_b16 a[132:133], v1 offset:7168
  ds_read_b64_tr_b16 a[134:135], v1 offset:10752
  ds_read_b64_tr_b16 a[136:137], v1 offset:32
  ds_read_b64_tr_b16 a[138:139], v1 offset:3616
  ds_read_b64_tr_b16 a[140:141], v1 offset:7200
  ds_read_b64_tr_b16 a[142:143], v1 offset:10784
  ds_read_b64_tr_b16 a[144:145], v1 offset:64
  ds_read_b64_tr_b16 a[146:147], v1 offset:3648
  ds_read_b64_tr_b16 a[148:149], v1 offset:7232
  ds_read_b64_tr_b16 a[150:151], v1 offset:10816
  ds_read_b64_tr_b16 a[152:153], v1 offset:96
  ds_read_b64_tr_b16 a[154:155], v1 offset:3680
  ds_read_b64_tr_b16 a[156:157], v1 offset:7264
  ds_read_b64_tr_b16 a[158:159], v1 offset:10848
  s_waitcnt vmcnt(7) lgkmcnt(8)
  v_mfma_f32_16x16x32_bf16 v[32:35], a[128:131], a[0:3], 0
  s_waitcnt vmcnt(3)
  s_bfe_u32 s57, s82, 0x40004
  s_lshl_b32 s57, s57, 13
  v_mfma_f32_16x16x32_bf16 v[32:35], a[132:135], a[16:19], v[32:35]
  s_waitcnt vmcnt(2)
  s_add_u32 s57, s57, s85
  buffer_load_dwordx4 a[32:35], v0, s[36:39], s57 offen offset:0 sc1
  v_mfma_f32_16x16x32_bf16 v[36:39], a[132:135], a[20:23], 0
  s_waitcnt vmcnt(7)
  ds_read_b64_tr_b16 a[160:161], v1 offset:128
  v_mfma_f32_16x16x32_bf16 v[36:39], a[128:131], a[4:7], v[36:39]
  s_waitcnt vmcnt(6)
  ds_read_b64_tr_b16 a[162:163], v1 offset:3712
  v_mfma_f32_16x16x32_bf16 v[40:43], a[128:131], a[8:11], 0
  s_waitcnt vmcnt(2)
  ds_read_b64_tr_b16 a[164:165], v1 offset:7296
  v_mfma_f32_16x16x32_bf16 v[40:43], a[132:135], a[24:27], v[40:43]
  s_waitcnt vmcnt(1)
  v_mfma_f32_16x16x32_bf16 v[44:47], a[132:135], a[28:31], 0
  s_waitcnt vmcnt(5)
  buffer_load_dwordx4 a[36:39], v0, s[36:39], s57 offen offset:1024 sc1
  v_mfma_f32_16x16x32_bf16 v[44:47], a[128:131], a[12:15], v[44:47]
  ds_read_b64_tr_b16 a[166:167], v1 offset:10880
  v_mfma_f32_16x16x32_bf16 v[60:63], a[136:139], a[12:15], 0
  ds_read_b64_tr_b16 a[168:169], v1 offset:160
  v_mfma_f32_16x16x32_bf16 v[60:63], a[140:143], a[28:31], v[60:63]
  v_mfma_f32_16x16x32_bf16 v[56:59], a[140:143], a[24:27], 0
  ds_read_b64_tr_b16 a[170:171], v1 offset:3744
  v_mfma_f32_16x16x32_bf16 v[56:59], a[136:139], a[8:11], v[56:59]
  buffer_load_dwordx4 a[40:43], v0, s[36:39], s57 offen offset:2048 sc1
  v_mfma_f32_16x16x32_bf16 v[52:55], a[136:139], a[4:7], 0
  ds_read_b64_tr_b16 a[172:173], v1 offset:7328
  v_mfma_f32_16x16x32_bf16 v[52:55], a[140:143], a[20:23], v[52:55]
  v_mfma_f32_16x16x32_bf16 v[48:51], a[140:143], a[16:19], 0
  ds_read_b64_tr_b16 a[174:175], v1 offset:10912
  v_mfma_f32_16x16x32_bf16 v[48:51], a[136:139], a[0:3], v[48:51]
  s_waitcnt lgkmcnt(8)
  v_mfma_f32_16x16x32_bf16 v[64:67], a[144:147], a[0:3], 0
  buffer_load_dwordx4 a[44:47], v0, s[36:39], s57 offen offset:3072 sc1
  s_bfe_u32 s56, s82, 0x40008
  v_mfma_f32_16x16x32_bf16 v[64:67], a[148:151], a[16:19], v[64:67]
  s_mul_i32 s56, s56, 458752
  s_add_u32 m0, s84, 57344
  ds_read_b64_tr_b16 a[128:129], v1 offset:192
  v_mfma_f32_16x16x32_bf16 v[68:71], a[148:151], a[20:23], 0
  ds_read_b64_tr_b16 a[130:131], v1 offset:3776
  v_mfma_f32_16x16x32_bf16 v[68:71], a[144:147], a[4:7], v[68:71]
  v_mfma_f32_16x16x32_bf16 v[72:75], a[144:147], a[8:11], 0
  ds_read_b64_tr_b16 a[132:133], v1 offset:7360
  v_mfma_f32_16x16x32_bf16 v[72:75], a[148:151], a[24:27], v[72:75]
  buffer_load_dwordx4 v3, s[16:19], s56 offen offset:0 lds
  s_add_u32 s57, s57, 4096
  v_mfma_f32_16x16x32_bf16 v[76:79], a[148:151], a[28:31], 0
  ds_read_b64_tr_b16 a[134:135], v1 offset:10944
  v_mfma_f32_16x16x32_bf16 v[76:79], a[144:147], a[12:15], v[76:79]
  v_mfma_f32_16x16x32_bf16 v[92:95], a[152:155], a[12:15], 0
  ds_read_b64_tr_b16 a[136:137], v1 offset:14336
  v_mfma_f32_16x16x32_bf16 v[92:95], a[156:159], a[28:31], v[92:95]
  v_mfma_f32_16x16x32_bf16 v[88:91], a[156:159], a[24:27], 0
  buffer_load_dwordx4 a[48:51], v0, s[36:39], s57 offen offset:0 sc1
  v_mfma_f32_16x16x32_bf16 v[88:91], a[152:155], a[8:11], v[88:91]
  ds_read_b64_tr_b16 a[138:139], v1 offset:17920
  v_mfma_f32_16x16x32_bf16 v[84:87], a[152:155], a[4:7], 0
  ds_read_b64_tr_b16 a[140:141], v1 offset:21504
  v_mfma_f32_16x16x32_bf16 v[84:87], a[156:159], a[20:23], v[84:87]
  v_mfma_f32_16x16x32_bf16 v[80:83], a[156:159], a[16:19], 0
  ds_read_b64_tr_b16 a[142:143], v1 offset:25088
  v_mfma_f32_16x16x32_bf16 v[80:83], a[152:155], a[0:3], v[80:83]
  s_waitcnt lgkmcnt(8)
  buffer_load_dwordx4 v4, s[16:19], s56 offen offset:1024 lds
  v_mfma_f32_16x16x32_bf16 v[96:99], a[160:163], a[0:3], 0
  ds_read_b64_tr_b16 a[144:145], v1 offset:14368
  v_mfma_f32_16x16x32_bf16 v[96:99], a[164:167], a[16:19], v[96:99]
  v_mfma_f32_16x16x32_bf16 v[100:103], a[164:167], a[20:23], 0
  ds_read_b64_tr_b16 a[146:147], v1 offset:17952
  v_mfma_f32_16x16x32_bf16 v[100:103], a[160:163], a[4:7], v[100:103]
  v_mfma_f32_16x16x32_bf16 v[104:107], a[160:163], a[8:11], 0
  buffer_load_dwordx4 a[52:55], v0, s[36:39], s57 offen offset:1024 sc1
  v_mfma_f32_16x16x32_bf16 v[104:107], a[164:167], a[24:27], v[104:107]
  ds_read_b64_tr_b16 a[148:149], v1 offset:21536
  v_mfma_f32_16x16x32_bf16 v[108:111], a[164:167], a[28:31], 0
  ds_read_b64_tr_b16 a[150:151], v1 offset:25120
  v_mfma_f32_16x16x32_bf16 v[108:111], a[160:163], a[12:15], v[108:111]
  v_mfma_f32_16x16x32_bf16 v[124:127], a[168:171], a[12:15], 0
  s_bfe_u32 s59, s82, 0x40018
  s_lshl4_add_u32 s59, s58, s59
  s_lshl_b32 s59, s59, 11
  v_mfma_f32_16x16x32_bf16 v[124:127], a[172:175], a[28:31], v[124:127]
  s_add_u32 s59, s59, 5767168
  buffer_load_dwordx4 v5, s[16:19], s56 offen offset:2048 lds
  s_lshr_b32 s76, s44, 1
  v_mfma_f32_16x16x32_bf16 v[120:123], a[172:175], a[24:27], 0
  s_mul_i32 s76, s76, 14336
  ds_read_b64_tr_b16 a[152:153], v1 offset:14400
  s_and_b32 s77, s44, 1
  v_mfma_f32_16x16x32_bf16 v[120:123], a[168:171], a[8:11], v[120:123]
  s_lshl_b32 s77, s77, 7
  ds_read_b64_tr_b16 a[154:155], v1 offset:17984
  s_add_u32 s76, s76, s77
  v_mfma_f32_16x16x32_bf16 v[116:119], a[168:171], a[4:7], 0
  ds_read_b64_tr_b16 a[156:157], v1 offset:21568
  v_add_u32 v31, s76, v1
  v_mfma_f32_16x16x32_bf16 v[116:119], a[172:175], a[20:23], v[116:119]
  s_lshl_b32 s61, s2, 15
  s_lshl1_add_u32 s61, s70, s61
  s_xor_b32 s63, s61, 32768
  v_mfma_f32_16x16x32_bf16 v[112:115], a[172:175], a[16:19], 0
  s_add_u32 s61, s61, 41943040
  buffer_load_dwordx4 a[56:59], v0, s[36:39], s57 offen offset:2048 sc1
  s_add_u32 s62, s61, 4096
  v_mfma_f32_16x16x32_bf16 v[112:115], a[168:171], a[0:3], v[112:115]
  s_waitcnt lgkmcnt(7)
  ds_read_b64_tr_b16 a[158:159], v1 offset:25152
  s_add_u32 s63, s63, 41943040
  v_mfma_f32_16x16x32_bf16 v[128:131], a[128:131], a[0:3], 0
  s_add_u32 s64, s63, 4096
  ds_read_b64_tr_b16 a[160:161], v1 offset:14432
  v_mfma_f32_16x16x32_bf16 v[128:131], a[132:135], a[16:19], v[128:131]
  v_mfma_f32_16x16x32_bf16 v[132:135], a[132:135], a[20:23], 0
  ds_read_b64_tr_b16 a[162:163], v1 offset:18016
  v_mfma_f32_16x16x32_bf16 v[132:135], a[128:131], a[4:7], v[132:135]
  buffer_load_dwordx4 v6, s[16:19], s56 offen offset:3072 lds
  v_mfma_f32_16x16x32_bf16 v[136:139], a[128:131], a[8:11], 0
  ds_read_b64_tr_b16 a[164:165], v1 offset:21600
  v_mfma_f32_16x16x32_bf16 v[136:139], a[132:135], a[24:27], v[136:139]
  v_mfma_f32_16x16x32_bf16 v[140:143], a[132:135], a[28:31], 0
  ds_read_b64_tr_b16 a[166:167], v1 offset:25184
  v_mfma_f32_16x16x32_bf16 v[140:143], a[128:131], a[12:15], v[140:143]
  v_mfma_f32_16x16x32_bf16 v[156:159], a[136:139], a[12:15], 0
  buffer_load_dwordx4 a[60:63], v0, s[36:39], s57 offen offset:3072 sc1
  s_add_u32 m0, s84, 61440
  v_mfma_f32_16x16x32_bf16 v[156:159], a[140:143], a[28:31], v[156:159]
  ds_read_b64_tr_b16 a[168:169], v1 offset:14464
  v_mfma_f32_16x16x32_bf16 v[152:155], a[140:143], a[24:27], 0
  ds_read_b64_tr_b16 a[170:171], v1 offset:18048
  v_mfma_f32_16x16x32_bf16 v[152:155], a[136:139], a[8:11], v[152:155]
  v_mfma_f32_16x16x32_bf16 v[148:151], a[136:139], a[4:7], 0
  ds_read_b64_tr_b16 a[172:173], v1 offset:21632
  v_mfma_f32_16x16x32_bf16 v[148:151], a[140:143], a[20:23], v[148:151]
  buffer_load_dwordx4 v7, s[16:19], s56 offen offset:0 lds
  s_bfe_u32 s57, s82, 0x40008
  v_mfma_f32_16x16x32_bf16 v[144:147], a[140:143], a[16:19], 0
  s_lshl_b32 s57, s57, 13
  s_add_u32 s57, s57, s85
  ds_read_b64_tr_b16 a[174:175], v1 offset:25216
  v_mfma_f32_16x16x32_bf16 v[144:147], a[136:139], a[0:3], v[144:147]
  s_waitcnt lgkmcnt(8)
  v_mfma_f32_16x16x32_bf16 v[160:163], a[144:147], a[0:3], 0
  ds_read_b64_tr_b16 a[128:129], v1 offset:14496
  v_mfma_f32_16x16x32_bf16 v[160:163], a[148:151], a[16:19], v[160:163]
  v_mfma_f32_16x16x32_bf16 v[164:167], a[148:151], a[20:23], 0
  buffer_load_dwordx4 a[64:67], v0, s[36:39], s57 offen offset:0 sc1
  v_mfma_f32_16x16x32_bf16 v[164:167], a[144:147], a[4:7], v[164:167]
  ds_read_b64_tr_b16 a[130:131], v1 offset:18080
  v_mfma_f32_16x16x32_bf16 v[168:171], a[144:147], a[8:11], 0
  ds_read_b64_tr_b16 a[132:133], v1 offset:21664
  v_mfma_f32_16x16x32_bf16 v[168:171], a[148:151], a[24:27], v[168:171]
  v_mfma_f32_16x16x32_bf16 v[172:175], a[148:151], a[28:31], 0
  ds_read_b64_tr_b16 a[134:135], v1 offset:25248
  v_mfma_f32_16x16x32_bf16 v[172:175], a[144:147], a[12:15], v[172:175]
  s_waitcnt vmcnt(22)
  s_barrier
  buffer_load_dwordx4 v8, s[16:19], s56 offen offset:1024 lds
  v_mfma_f32_16x16x32_bf16 v[188:191], a[152:155], a[12:15], 0
  ds_read_b64_tr_b16 a[136:137], v1 offset:14528
  v_mfma_f32_16x16x32_bf16 v[188:191], a[156:159], a[28:31], v[188:191]
  v_mfma_f32_16x16x32_bf16 v[184:187], a[156:159], a[24:27], 0
  ds_read_b64_tr_b16 a[138:139], v1 offset:18112
  v_mfma_f32_16x16x32_bf16 v[184:187], a[152:155], a[8:11], v[184:187]
  v_mfma_f32_16x16x32_bf16 v[180:183], a[152:155], a[4:7], 0
  buffer_load_dwordx4 a[68:71], v0, s[36:39], s57 offen offset:1024 sc1
  v_mfma_f32_16x16x32_bf16 v[180:183], a[156:159], a[20:23], v[180:183]
  ds_read_b64_tr_b16 a[140:141], v1 offset:21696
  v_mfma_f32_16x16x32_bf16 v[176:179], a[156:159], a[16:19], 0
  ds_read_b64_tr_b16 a[142:143], v1 offset:25280
  v_mfma_f32_16x16x32_bf16 v[176:179], a[152:155], a[0:3], v[176:179]
  s_waitcnt lgkmcnt(8)
  v_mfma_f32_16x16x32_bf16 v[192:195], a[160:163], a[0:3], 0
  ds_read_b64_tr_b16 a[144:145], v1 offset:28672
  v_mfma_f32_16x16x32_bf16 v[192:195], a[164:167], a[16:19], v[192:195]
  v_mfma_f32_16x16x32_bf16 v[196:199], a[164:167], a[20:23], 0
  ds_read_b64_tr_b16 a[146:147], v1 offset:32256
  v_mfma_f32_16x16x32_bf16 v[196:199], a[160:163], a[4:7], v[196:199]
  v_mfma_f32_16x16x32_bf16 v[200:203], a[160:163], a[8:11], 0
  ds_read_b64_tr_b16 a[148:149], v1 offset:35840
  v_mfma_f32_16x16x32_bf16 v[200:203], a[164:167], a[24:27], v[200:203]
  v_mfma_f32_16x16x32_bf16 v[204:207], a[164:167], a[28:31], 0
  buffer_load_dwordx4 v9, s[16:19], s56 offen offset:2048 lds
  v_mfma_f32_16x16x32_bf16 v[204:207], a[160:163], a[12:15], v[204:207]
  ds_read_b64_tr_b16 a[150:151], v1 offset:39424
  v_mfma_f32_16x16x32_bf16 v[220:223], a[168:171], a[12:15], 0
  ds_read_b64_tr_b16 a[152:153], v1 offset:28704
  v_mfma_f32_16x16x32_bf16 v[220:223], a[172:175], a[28:31], v[220:223]
  v_mfma_f32_16x16x32_bf16 v[216:219], a[172:175], a[24:27], 0
  ds_read_b64_tr_b16 a[154:155], v1 offset:32288
  v_mfma_f32_16x16x32_bf16 v[216:219], a[168:171], a[8:11], v[216:219]
  buffer_load_dwordx4 a[72:75], v0, s[36:39], s57 offen offset:2048 sc1
  v_mfma_f32_16x16x32_bf16 v[212:215], a[168:171], a[4:7], 0
  ds_read_b64_tr_b16 a[156:157], v1 offset:35872
  v_mfma_f32_16x16x32_bf16 v[212:215], a[172:175], a[20:23], v[212:215]
  v_mfma_f32_16x16x32_bf16 v[208:211], a[172:175], a[16:19], 0
  ds_read_b64_tr_b16 a[158:159], v1 offset:39456
  v_mfma_f32_16x16x32_bf16 v[208:211], a[168:171], a[0:3], v[208:211]
  s_waitcnt lgkmcnt(8)
  v_mfma_f32_16x16x32_bf16 v[224:227], a[128:131], a[0:3], 0
  ds_read_b64_tr_b16 a[160:161], v1 offset:28736
  v_mfma_f32_16x16x32_bf16 v[224:227], a[132:135], a[16:19], v[224:227]
  v_mfma_f32_16x16x32_bf16 v[228:231], a[132:135], a[20:23], 0
  ds_read_b64_tr_b16 a[162:163], v1 offset:32320
  v_mfma_f32_16x16x32_bf16 v[228:231], a[128:131], a[4:7], v[228:231]
  v_mfma_f32_16x16x32_bf16 v[232:235], a[128:131], a[8:11], 0
  ds_read_b64_tr_b16 a[164:165], v1 offset:35904
  v_mfma_f32_16x16x32_bf16 v[232:235], a[132:135], a[24:27], v[232:235]
  buffer_load_dwordx4 a[76:79], v0, s[36:39], s57 offen offset:3072 sc1
  v_mfma_f32_16x16x32_bf16 v[236:239], a[132:135], a[28:31], 0
  ds_read_b64_tr_b16 a[166:167], v1 offset:39488
  v_mfma_f32_16x16x32_bf16 v[236:239], a[128:131], a[12:15], v[236:239]
  v_mfma_f32_16x16x32_bf16 v[252:255], a[136:139], a[12:15], 0
  ds_read_b64_tr_b16 a[168:169], v1 offset:28768
  v_mfma_f32_16x16x32_bf16 v[252:255], a[140:143], a[28:31], v[252:255]
  s_bfe_u32 s56, s82, 0x4000c
  s_mul_i32 s56, s56, 458752
  s_add_u32 m0, s84, 86016
  v_mfma_f32_16x16x32_bf16 v[248:251], a[140:143], a[24:27], 0
  ds_read_b64_tr_b16 a[170:171], v1 offset:32352
  v_mfma_f32_16x16x32_bf16 v[248:251], a[136:139], a[8:11], v[248:251]
  v_mfma_f32_16x16x32_bf16 v[244:247], a[136:139], a[4:7], 0
  ds_read_b64_tr_b16 a[172:173], v1 offset:35936
  v_mfma_f32_16x16x32_bf16 v[244:247], a[140:143], a[20:23], v[244:247]
  buffer_load_dwordx4 v3, s[16:19], s56 offen offset:0 lds
  v_mfma_f32_16x16x32_bf16 v[240:243], a[140:143], a[16:19], 0
  ds_read_b64_tr_b16 a[174:175], v1 offset:39520
  v_mfma_f32_16x16x32_bf16 v[240:243], a[136:139], a[0:3], v[240:243]
  s_waitcnt vmcnt(8) lgkmcnt(8)
  v_mfma_f32_16x16x32_bf16 v[32:35], a[144:147], a[32:35], v[32:35]
  s_add_u32 s57, s57, 4096
  ds_read_b64_tr_b16 a[128:129], v1 offset:28800
  v_mfma_f32_16x16x32_bf16 v[32:35], a[148:151], a[48:51], v[32:35]
  v_mfma_f32_16x16x32_bf16 v[36:39], a[148:151], a[52:55], v[36:39]
  ds_read_b64_tr_b16 a[130:131], v1 offset:32384
  v_mfma_f32_16x16x32_bf16 v[36:39], a[144:147], a[36:39], v[36:39]
  v_mfma_f32_16x16x32_bf16 v[40:43], a[144:147], a[40:43], v[40:43]
  buffer_load_dwordx4 a[80:83], v0, s[36:39], s57 offen offset:0 sc1
  v_mfma_f32_16x16x32_bf16 v[40:43], a[148:151], a[56:59], v[40:43]
  ds_read_b64_tr_b16 a[132:133], v1 offset:35968
  v_mfma_f32_16x16x32_bf16 v[44:47], a[148:151], a[60:63], v[44:47]
  ds_read_b64_tr_b16 a[134:135], v1 offset:39552
  v_mfma_f32_16x16x32_bf16 v[44:47], a[144:147], a[44:47], v[44:47]
  v_mfma_f32_16x16x32_bf16 v[60:63], a[152:155], a[44:47], v[60:63]
  ds_read_b64_tr_b16 a[136:137], v1 offset:28832
  v_mfma_f32_16x16x32_bf16 v[60:63], a[156:159], a[60:63], v[60:63]
  v_mfma_f32_16x16x32_bf16 v[56:59], a[156:159], a[56:59], v[56:59]
  ds_read_b64_tr_b16 a[138:139], v1 offset:32416
  v_mfma_f32_16x16x32_bf16 v[56:59], a[152:155], a[40:43], v[56:59]
  buffer_load_dwordx4 v4, s[16:19], s56 offen offset:1024 lds
  v_mfma_f32_16x16x32_bf16 v[52:55], a[152:155], a[36:39], v[52:55]
  ds_read_b64_tr_b16 a[140:141], v1 offset:36000
  v_mfma_f32_16x16x32_bf16 v[52:55], a[156:159], a[52:55], v[52:55]
  v_mfma_f32_16x16x32_bf16 v[48:51], a[156:159], a[48:51], v[48:51]
  ds_read_b64_tr_b16 a[142:143], v1 offset:39584
  v_mfma_f32_16x16x32_bf16 v[48:51], a[152:155], a[32:35], v[48:51]
  s_waitcnt lgkmcnt(8)
  v_mfma_f32_16x16x32_bf16 v[64:67], a[160:163], a[32:35], v[64:67]
  ds_read_b64_tr_b16 a[144:145], v1 offset:28864
  v_mfma_f32_16x16x32_bf16 v[64:67], a[164:167], a[48:51], v[64:67]
  v_mfma_f32_16x16x32_bf16 v[68:71], a[164:167], a[52:55], v[68:71]
  ds_read_b64_tr_b16 a[146:147], v1 offset:32448
  v_mfma_f32_16x16x32_bf16 v[68:71], a[160:163], a[36:39], v[68:71]
  buffer_load_dwordx4 a[84:87], v0, s[36:39], s57 offen offset:1024 sc1
  v_mfma_f32_16x16x32_bf16 v[72:75], a[160:163], a[40:43], v[72:75]
  ds_read_b64_tr_b16 a[148:149], v1 offset:36032
  v_mfma_f32_16x16x32_bf16 v[72:75], a[164:167], a[56:59], v[72:75]
  v_mfma_f32_16x16x32_bf16 v[76:79], a[164:167], a[60:63], v[76:79]
  ds_read_b64_tr_b16 a[150:151], v1 offset:39616
  v_mfma_f32_16x16x32_bf16 v[76:79], a[160:163], a[44:47], v[76:79]
  v_mfma_f32_16x16x32_bf16 v[92:95], a[168:171], a[44:47], v[92:95]
  ds_read_b64_tr_b16 a[152:153], v1 offset:43008
  v_mfma_f32_16x16x32_bf16 v[92:95], a[172:175], a[60:63], v[92:95]
  v_mfma_f32_16x16x32_bf16 v[88:91], a[172:175], a[56:59], v[88:91]
  buffer_load_dwordx4 v5, s[16:19], s56 offen offset:2048 lds
  v_mfma_f32_16x16x32_bf16 v[88:91], a[168:171], a[40:43], v[88:91]
  ds_read_b64_tr_b16 a[154:155], v1 offset:46592
  v_mfma_f32_16x16x32_bf16 v[84:87], a[168:171], a[36:39], v[84:87]
  ds_read_b64_tr_b16 a[156:157], v1 offset:50176
  v_mfma_f32_16x16x32_bf16 v[84:87], a[172:175], a[52:55], v[84:87]
  v_mfma_f32_16x16x32_bf16 v[80:83], a[172:175], a[48:51], v[80:83]
  ds_read_b64_tr_b16 a[158:159], v1 offset:53760
  v_mfma_f32_16x16x32_bf16 v[80:83], a[168:171], a[32:35], v[80:83]
  s_waitcnt lgkmcnt(8)
  v_mfma_f32_16x16x32_bf16 v[96:99], a[128:131], a[32:35], v[96:99]
  ds_read_b64_tr_b16 a[160:161], v1 offset:43040
  v_mfma_f32_16x16x32_bf16 v[96:99], a[132:135], a[48:51], v[96:99]
  v_mfma_f32_16x16x32_bf16 v[100:103], a[132:135], a[52:55], v[100:103]
  buffer_load_dwordx4 a[88:91], v0, s[36:39], s57 offen offset:2048 sc1
  v_mfma_f32_16x16x32_bf16 v[100:103], a[128:131], a[36:39], v[100:103]
  ds_read_b64_tr_b16 a[162:163], v1 offset:46624
  v_mfma_f32_16x16x32_bf16 v[104:107], a[128:131], a[40:43], v[104:107]
  ds_read_b64_tr_b16 a[164:165], v1 offset:50208
  v_mfma_f32_16x16x32_bf16 v[104:107], a[132:135], a[56:59], v[104:107]
  v_mfma_f32_16x16x32_bf16 v[108:111], a[132:135], a[60:63], v[108:111]
  ds_read_b64_tr_b16 a[166:167], v1 offset:53792
  v_mfma_f32_16x16x32_bf16 v[108:111], a[128:131], a[44:47], v[108:111]
  v_mfma_f32_16x16x32_bf16 v[124:127], a[136:139], a[44:47], v[124:127]
  ds_read_b64_tr_b16 a[168:169], v1 offset:43072
  v_mfma_f32_16x16x32_bf16 v[124:127], a[140:143], a[60:63], v[124:127]
  buffer_load_dwordx4 v6, s[16:19], s56 offen offset:3072 lds
  v_mfma_f32_16x16x32_bf16 v[120:123], a[140:143], a[56:59], v[120:123]
  ds_read_b64_tr_b16 a[170:171], v1 offset:46656
  v_mfma_f32_16x16x32_bf16 v[120:123], a[136:139], a[40:43], v[120:123]
  v_mfma_f32_16x16x32_bf16 v[116:119], a[136:139], a[36:39], v[116:119]
  ds_read_b64_tr_b16 a[172:173], v1 offset:50240
  v_mfma_f32_16x16x32_bf16 v[116:119], a[140:143], a[52:55], v[116:119]
Hb0:
  s_cbranch_execz Hb0_1
  v_mfma_f32_16x16x32_bf16 v[112:115], a[140:143], a[48:51], v[112:115]
  ds_read_b64_tr_b16 a[174:175], v1 offset:53824
  v_mfma_f32_16x16x32_bf16 v[112:115], a[136:139], a[32:35], v[112:115]
  s_waitcnt lgkmcnt(8)
  v_mfma_f32_16x16x32_bf16 v[128:131], a[144:147], a[32:35], v[128:131]
  ds_read_b64_tr_b16 a[128:129], v1 offset:43104
  v_mfma_f32_16x16x32_bf16 v[128:131], a[148:151], a[48:51], v[128:131]
  buffer_load_dwordx4 a[92:95], v0, s[36:39], s57 offen offset:3072 sc1
  v_mfma_f32_16x16x32_bf16 v[132:135], a[148:151], a[52:55], v[132:135]
  ds_read_b64_tr_b16 a[130:131], v1 offset:46688
  v_mfma_f32_16x16x32_bf16 v[132:135], a[144:147], a[36:39], v[132:135]
  v_mfma_f32_16x16x32_bf16 v[136:139], a[144:147], a[40:43], v[136:139]
  s_add_u32 m0, s84, 90112
  ds_read_b64_tr_b16 a[132:133], v1 offset:50272
  v_mfma_f32_16x16x32_bf16 v[136:139], a[148:151], a[56:59], v[136:139]
  v_mfma_f32_16x16x32_bf16 v[140:143], a[148:151], a[60:63], v[140:143]
  ds_read_b64_tr_b16 a[134:135], v1 offset:53856
  v_mfma_f32_16x16x32_bf16 v[140:143], a[144:147], a[44:47], v[140:143]
  v_mfma_f32_16x16x32_bf16 v[156:159], a[152:155], a[44:47], v[156:159]
  buffer_load_dwordx4 v7, s[16:19], s56 offen offset:0 lds
  s_bfe_u32 s57, s82, 0x4000c
  v_mfma_f32_16x16x32_bf16 v[156:159], a[156:159], a[60:63], v[156:159]
  s_lshl_b32 s57, s57, 13
  s_add_u32 s57, s57, s85
  ds_read_b64_tr_b16 a[136:137], v1 offset:43136
  v_mfma_f32_16x16x32_bf16 v[152:155], a[156:159], a[56:59], v[152:155]
  ds_read_b64_tr_b16 a[138:139], v1 offset:46720
  v_mfma_f32_16x16x32_bf16 v[152:155], a[152:155], a[40:43], v[152:155]
  v_mfma_f32_16x16x32_bf16 v[148:151], a[152:155], a[36:39], v[148:151]
  ds_read_b64_tr_b16 a[140:141], v1 offset:50304
  v_mfma_f32_16x16x32_bf16 v[148:151], a[156:159], a[52:55], v[148:151]
  buffer_load_dwordx4 a[96:99], v0, s[36:39], s57 offen offset:0 sc1
  v_mfma_f32_16x16x32_bf16 v[144:147], a[156:159], a[48:51], v[144:147]
  ds_read_b64_tr_b16 a[142:143], v1 offset:53888
  v_mfma_f32_16x16x32_bf16 v[144:147], a[152:155], a[32:35], v[144:147]
  s_waitcnt lgkmcnt(8)
  v_mfma_f32_16x16x32_bf16 v[160:163], a[160:163], a[32:35], v[160:163]
  ds_read_b64_tr_b16 a[144:145], v1 offset:43168
  v_mfma_f32_16x16x32_bf16 v[160:163], a[164:167], a[48:51], v[160:163]
  v_mfma_f32_16x16x32_bf16 v[164:167], a[164:167], a[52:55], v[164:167]
  ds_read_b64_tr_b16 a[146:147], v1 offset:46752
  v_mfma_f32_16x16x32_bf16 v[164:167], a[160:163], a[36:39], v[164:167]
  v_mfma_f32_16x16x32_bf16 v[168:171], a[160:163], a[40:43], v[168:171]
  ds_read_b64_tr_b16 a[148:149], v1 offset:50336
  v_mfma_f32_16x16x32_bf16 v[168:171], a[164:167], a[56:59], v[168:171]
  v_mfma_f32_16x16x32_bf16 v[172:175], a[164:167], a[60:63], v[172:175]
  ds_read_b64_tr_b16 a[150:151], v1 offset:53920
  v_mfma_f32_16x16x32_bf16 v[172:175], a[160:163], a[44:47], v[172:175]
  s_waitcnt vmcnt(12)
  s_barrier
  buffer_load_dwordx4 v8, s[16:19], s56 offen offset:1024 lds
  v_mfma_f32_16x16x32_bf16 v[188:191], a[168:171], a[44:47], v[188:191]
  ds_read_b64_tr_b16 a[152:153], v1 offset:43200
  v_mfma_f32_16x16x32_bf16 v[188:191], a[172:175], a[60:63], v[188:191]
  v_mfma_f32_16x16x32_bf16 v[184:187], a[172:175], a[56:59], v[184:187]
  ds_read_b64_tr_b16 a[154:155], v1 offset:46784
  v_mfma_f32_16x16x32_bf16 v[184:187], a[168:171], a[40:43], v[184:187]
  v_mfma_f32_16x16x32_bf16 v[180:183], a[168:171], a[36:39], v[180:183]
  buffer_load_dwordx4 a[100:103], v0, s[36:39], s57 offen offset:1024 sc1
  v_mfma_f32_16x16x32_bf16 v[180:183], a[172:175], a[52:55], v[180:183]
  ds_read_b64_tr_b16 a[156:157], v1 offset:50368
  v_mfma_f32_16x16x32_bf16 v[176:179], a[172:175], a[48:51], v[176:179]
  ds_read_b64_tr_b16 a[158:159], v1 offset:53952
  v_mfma_f32_16x16x32_bf16 v[176:179], a[168:171], a[32:35], v[176:179]
  s_waitcnt lgkmcnt(8)
  v_mfma_f32_16x16x32_bf16 v[192:195], a[128:131], a[32:35], v[192:195]
  ds_read_b64_tr_b16 a[160:161], v2 offset:0
  v_mfma_f32_16x16x32_bf16 v[192:195], a[132:135], a[48:51], v[192:195]
  v_mfma_f32_16x16x32_bf16 v[196:199], a[132:135], a[52:55], v[196:199]
  ds_read_b64_tr_b16 a[162:163], v2 offset:3584
  v_mfma_f32_16x16x32_bf16 v[196:199], a[128:131], a[36:39], v[196:199]
  v_mfma_f32_16x16x32_bf16 v[200:203], a[128:131], a[40:43], v[200:203]
  ds_read_b64_tr_b16 a[164:165], v2 offset:7168
  v_mfma_f32_16x16x32_bf16 v[200:203], a[132:135], a[56:59], v[200:203]
  v_mfma_f32_16x16x32_bf16 v[204:207], a[132:135], a[60:63], v[204:207]
  buffer_load_dwordx4 v9, s[16:19], s56 offen offset:2048 lds
  v_mfma_f32_16x16x32_bf16 v[204:207], a[128:131], a[44:47], v[204:207]
  ds_read_b64_tr_b16 a[166:167], v2 offset:10752
  v_mfma_f32_16x16x32_bf16 v[220:223], a[136:139], a[44:47], v[220:223]
  ds_read_b64_tr_b16 a[168:169], v2 offset:32
  v_mfma_f32_16x16x32_bf16 v[220:223], a[140:143], a[60:63], v[220:223]
  v_mfma_f32_16x16x32_bf16 v[216:219], a[140:143], a[56:59], v[216:219]
  ds_read_b64_tr_b16 a[170:171], v2 offset:3616
  v_mfma_f32_16x16x32_bf16 v[216:219], a[136:139], a[40:43], v[216:219]
  buffer_load_dwordx4 a[104:107], v0, s[36:39], s57 offen offset:2048 sc1
  v_mfma_f32_16x16x32_bf16 v[212:215], a[136:139], a[36:39], v[212:215]
  ds_read_b64_tr_b16 a[172:173], v2 offset:7200
  v_mfma_f32_16x16x32_bf16 v[212:215], a[140:143], a[52:55], v[212:215]
  v_mfma_f32_16x16x32_bf16 v[208:211], a[140:143], a[48:51], v[208:211]
  ds_read_b64_tr_b16 a[174:175], v2 offset:10784
  v_mfma_f32_16x16x32_bf16 v[208:211], a[136:139], a[32:35], v[208:211]
  s_waitcnt lgkmcnt(8)
  v_mfma_f32_16x16x32_bf16 v[224:227], a[144:147], a[32:35], v[224:227]
  ds_read_b64_tr_b16 a[128:129], v2 offset:64
  v_mfma_f32_16x16x32_bf16 v[224:227], a[148:151], a[48:51], v[224:227]
  v_mfma_f32_16x16x32_bf16 v[228:231], a[148:151], a[52:55], v[228:231]
  ds_read_b64_tr_b16 a[130:131], v2 offset:3648
  v_mfma_f32_16x16x32_bf16 v[228:231], a[144:147], a[36:39], v[228:231]
  v_mfma_f32_16x16x32_bf16 v[232:235], a[144:147], a[40:43], v[232:235]
  ds_read_b64_tr_b16 a[132:133], v2 offset:7232
  v_mfma_f32_16x16x32_bf16 v[232:235], a[148:151], a[56:59], v[232:235]
  buffer_load_dwordx4 a[108:111], v0, s[36:39], s57 offen offset:3072 sc1
  v_mfma_f32_16x16x32_bf16 v[236:239], a[148:151], a[60:63], v[236:239]
  ds_read_b64_tr_b16 a[134:135], v2 offset:10816
  v_mfma_f32_16x16x32_bf16 v[236:239], a[144:147], a[44:47], v[236:239]
  v_mfma_f32_16x16x32_bf16 v[252:255], a[152:155], a[44:47], v[252:255]
  ds_read_b64_tr_b16 a[136:137], v2 offset:96
  v_mfma_f32_16x16x32_bf16 v[252:255], a[156:159], a[60:63], v[252:255]
  s_bfe_u32 s56, s82, 0x40010
  s_mul_i32 s56, s56, 458752
  s_add_u32 m0, s84, 0
  v_mfma_f32_16x16x32_bf16 v[248:251], a[156:159], a[56:59], v[248:251]
  ds_read_b64_tr_b16 a[138:139], v2 offset:3680
  v_mfma_f32_16x16x32_bf16 v[248:251], a[152:155], a[40:43], v[248:251]
  v_mfma_f32_16x16x32_bf16 v[244:247], a[152:155], a[36:39], v[244:247]
  ds_read_b64_tr_b16 a[140:141], v2 offset:7264
  v_mfma_f32_16x16x32_bf16 v[244:247], a[156:159], a[52:55], v[244:247]
  buffer_load_dwordx4 v3, s[16:19], s56 offen offset:0 lds
  v_mfma_f32_16x16x32_bf16 v[240:243], a[156:159], a[48:51], v[240:243]
  ds_read_b64_tr_b16 a[142:143], v2 offset:10848
  v_mfma_f32_16x16x32_bf16 v[240:243], a[152:155], a[32:35], v[240:243]
  s_waitcnt vmcnt(8) lgkmcnt(8)
  v_mfma_f32_16x16x32_bf16 v[32:35], a[160:163], a[64:67], v[32:35]
  s_add_u32 s57, s57, 4096
  ds_read_b64_tr_b16 a[144:145], v2 offset:128
  v_mfma_f32_16x16x32_bf16 v[32:35], a[164:167], a[80:83], v[32:35]
  v_mfma_f32_16x16x32_bf16 v[36:39], a[164:167], a[84:87], v[36:39]
  ds_read_b64_tr_b16 a[146:147], v2 offset:3712
  v_mfma_f32_16x16x32_bf16 v[36:39], a[160:163], a[68:71], v[36:39]
  v_mfma_f32_16x16x32_bf16 v[40:43], a[160:163], a[72:75], v[40:43]
  buffer_load_dwordx4 a[112:115], v0, s[36:39], s57 offen offset:0 sc1
  v_mfma_f32_16x16x32_bf16 v[40:43], a[164:167], a[88:91], v[40:43]
  ds_read_b64_tr_b16 a[148:149], v2 offset:7296
  v_mfma_f32_16x16x32_bf16 v[44:47], a[164:167], a[92:95], v[44:47]
  ds_read_b64_tr_b16 a[150:151], v2 offset:10880
  v_mfma_f32_16x16x32_bf16 v[44:47], a[160:163], a[76:79], v[44:47]
  v_mfma_f32_16x16x32_bf16 v[60:63], a[168:171], a[76:79], v[60:63]
  ds_read_b64_tr_b16 a[152:153], v2 offset:160
  v_mfma_f32_16x16x32_bf16 v[60:63], a[172:175], a[92:95], v[60:63]
  v_mfma_f32_16x16x32_bf16 v[56:59], a[172:175], a[88:91], v[56:59]
  ds_read_b64_tr_b16 a[154:155], v2 offset:3744
  v_mfma_f32_16x16x32_bf16 v[56:59], a[168:171], a[72:75], v[56:59]
  buffer_load_dwordx4 v4, s[16:19], s56 offen offset:1024 lds
  v_mfma_f32_16x16x32_bf16 v[52:55], a[168:171], a[68:71], v[52:55]
  ds_read_b64_tr_b16 a[156:157], v2 offset:7328
  v_mfma_f32_16x16x32_bf16 v[52:55], a[172:175], a[84:87], v[52:55]
  v_mfma_f32_16x16x32_bf16 v[48:51], a[172:175], a[80:83], v[48:51]
  ds_read_b64_tr_b16 a[158:159], v2 offset:10912
  v_mfma_f32_16x16x32_bf16 v[48:51], a[168:171], a[64:67], v[48:51]
  s_waitcnt lgkmcnt(8)
  v_mfma_f32_16x16x32_bf16 v[64:67], a[128:131], a[64:67], v[64:67]
  ds_read_b64_tr_b16 a[160:161], v2 offset:192
  v_mfma_f32_16x16x32_bf16 v[64:67], a[132:135], a[80:83], v[64:67]
  v_mfma_f32_16x16x32_bf16 v[68:71], a[132:135], a[84:87], v[68:71]
  ds_read_b64_tr_b16 a[162:163], v2 offset:3776
  v_mfma_f32_16x16x32_bf16 v[68:71], a[128:131], a[68:71], v[68:71]
  buffer_load_dwordx4 a[116:119], v0, s[36:39], s57 offen offset:1024 sc1
  v_mfma_f32_16x16x32_bf16 v[72:75], a[128:131], a[72:75], v[72:75]
  ds_read_b64_tr_b16 a[164:165], v2 offset:7360
  v_mfma_f32_16x16x32_bf16 v[72:75], a[132:135], a[88:91], v[72:75]
  v_mfma_f32_16x16x32_bf16 v[76:79], a[132:135], a[92:95], v[76:79]
  ds_read_b64_tr_b16 a[166:167], v2 offset:10944
  v_mfma_f32_16x16x32_bf16 v[76:79], a[128:131], a[76:79], v[76:79]
  v_mfma_f32_16x16x32_bf16 v[92:95], a[136:139], a[76:79], v[92:95]
  ds_read_b64_tr_b16 a[168:169], v2 offset:14336
  v_mfma_f32_16x16x32_bf16 v[92:95], a[140:143], a[92:95], v[92:95]
  v_mfma_f32_16x16x32_bf16 v[88:91], a[140:143], a[88:91], v[88:91]
  buffer_load_dwordx4 v5, s[16:19], s56 offen offset:2048 lds
  v_mfma_f32_16x16x32_bf16 v[88:91], a[136:139], a[72:75], v[88:91]
  ds_read_b64_tr_b16 a[170:171], v2 offset:17920
  v_mfma_f32_16x16x32_bf16 v[84:87], a[136:139], a[68:71], v[84:87]
  ds_read_b64_tr_b16 a[172:173], v2 offset:21504
  v_mfma_f32_16x16x32_bf16 v[84:87], a[140:143], a[84:87], v[84:87]
  v_mfma_f32_16x16x32_bf16 v[80:83], a[140:143], a[80:83], v[80:83]
  ds_read_b64_tr_b16 a[174:175], v2 offset:25088
  v_mfma_f32_16x16x32_bf16 v[80:83], a[136:139], a[64:67], v[80:83]
  s_waitcnt lgkmcnt(8)
  v_mfma_f32_16x16x32_bf16 v[96:99], a[144:147], a[64:67], v[96:99]
  ds_read_b64_tr_b16 a[128:129], v2 offset:14368
  v_mfma_f32_16x16x32_bf16 v[96:99], a[148:151], a[80:83], v[96:99]
  v_mfma_f32_16x16x32_bf16 v[100:103], a[148:151], a[84:87], v[100:103]
  buffer_load_dwordx4 a[120:123], v0, s[36:39], s57 offen offset:2048 sc1
  v_mfma_f32_16x16x32_bf16 v[100:103], a[144:147], a[68:71], v[100:103]
  ds_read_b64_tr_b16 a[130:131], v2 offset:17952
  v_mfma_f32_16x16x32_bf16 v[104:107], a[144:147], a[72:75], v[104:107]
  ds_read_b64_tr_b16 a[132:133], v2 offset:21536
  v_mfma_f32_16x16x32_bf16 v[104:107], a[148:151], a[88:91], v[104:107]
  v_mfma_f32_16x16x32_bf16 v[108:111], a[148:151], a[92:95], v[108:111]
  ds_read_b64_tr_b16 a[134:135], v2 offset:25120
  v_mfma_f32_16x16x32_bf16 v[108:111], a[144:147], a[76:79], v[108:111]
  v_mfma_f32_16x16x32_bf16 v[124:127], a[152:155], a[76:79], v[124:127]
  ds_read_b64_tr_b16 a[136:137], v2 offset:14400
  v_mfma_f32_16x16x32_bf16 v[124:127], a[156:159], a[92:95], v[124:127]
  buffer_load_dwordx4 v6, s[16:19], s56 offen offset:3072 lds
  v_mfma_f32_16x16x32_bf16 v[120:123], a[156:159], a[88:91], v[120:123]
  ds_read_b64_tr_b16 a[138:139], v2 offset:17984
  v_mfma_f32_16x16x32_bf16 v[120:123], a[152:155], a[72:75], v[120:123]
  v_mfma_f32_16x16x32_bf16 v[116:119], a[152:155], a[68:71], v[116:119]
  ds_read_b64_tr_b16 a[140:141], v2 offset:21568
  v_mfma_f32_16x16x32_bf16 v[116:119], a[156:159], a[84:87], v[116:119]
  v_mfma_f32_16x16x32_bf16 v[112:115], a[156:159], a[80:83], v[112:115]
  ds_read_b64_tr_b16 a[142:143], v2 offset:25152
  v_mfma_f32_16x16x32_bf16 v[112:115], a[152:155], a[64:67], v[112:115]
  s_waitcnt lgkmcnt(8)
  v_mfma_f32_16x16x32_bf16 v[128:131], a[160:163], a[64:67], v[128:131]
  ds_read_b64_tr_b16 a[144:145], v2 offset:14432
  v_mfma_f32_16x16x32_bf16 v[128:131], a[164:167], a[80:83], v[128:131]
  buffer_load_dwordx4 a[124:127], v0, s[36:39], s57 offen offset:3072 sc1
  v_mfma_f32_16x16x32_bf16 v[132:135], a[164:167], a[84:87], v[132:135]
  ds_read_b64_tr_b16 a[146:147], v2 offset:18016
  v_mfma_f32_16x16x32_bf16 v[132:135], a[160:163], a[68:71], v[132:135]
  v_mfma_f32_16x16x32_bf16 v[136:139], a[160:163], a[72:75], v[136:139]
  s_add_u32 m0, s84, 4096
  ds_read_b64_tr_b16 a[148:149], v2 offset:21600
  v_mfma_f32_16x16x32_bf16 v[136:139], a[164:167], a[88:91], v[136:139]
  v_mfma_f32_16x16x32_bf16 v[140:143], a[164:167], a[92:95], v[140:143]
  ds_read_b64_tr_b16 a[150:151], v2 offset:25184
  v_mfma_f32_16x16x32_bf16 v[140:143], a[160:163], a[76:79], v[140:143]
  v_mfma_f32_16x16x32_bf16 v[156:159], a[168:171], a[76:79], v[156:159]
  buffer_load_dwordx4 v7, s[16:19], s56 offen offset:0 lds
  s_bfe_u32 s57, s82, 0x40010
  v_mfma_f32_16x16x32_bf16 v[156:159], a[172:175], a[92:95], v[156:159]
  s_lshl_b32 s57, s57, 13
  s_add_u32 s57, s57, s85
  ds_read_b64_tr_b16 a[152:153], v2 offset:14464
  v_mfma_f32_16x16x32_bf16 v[152:155], a[172:175], a[88:91], v[152:155]
  ds_read_b64_tr_b16 a[154:155], v2 offset:18048
  v_mfma_f32_16x16x32_bf16 v[152:155], a[168:171], a[72:75], v[152:155]
  v_mfma_f32_16x16x32_bf16 v[148:151], a[168:171], a[68:71], v[148:151]
  ds_read_b64_tr_b16 a[156:157], v2 offset:21632
  v_mfma_f32_16x16x32_bf16 v[148:151], a[172:175], a[84:87], v[148:151]
  buffer_load_dwordx4 a[0:3], v0, s[36:39], s57 offen offset:0 sc1
  v_mfma_f32_16x16x32_bf16 v[144:147], a[172:175], a[80:83], v[144:147]
  ds_read_b64_tr_b16 a[158:159], v2 offset:25216
  v_mfma_f32_16x16x32_bf16 v[144:147], a[168:171], a[64:67], v[144:147]
  s_waitcnt lgkmcnt(8)
  v_mfma_f32_16x16x32_bf16 v[160:163], a[128:131], a[64:67], v[160:163]
  ds_read_b64_tr_b16 a[160:161], v2 offset:14496
  v_mfma_f32_16x16x32_bf16 v[160:163], a[132:135], a[80:83], v[160:163]
  v_mfma_f32_16x16x32_bf16 v[164:167], a[132:135], a[84:87], v[164:167]
  ds_read_b64_tr_b16 a[162:163], v2 offset:18080
  v_mfma_f32_16x16x32_bf16 v[164:167], a[128:131], a[68:71], v[164:167]
  v_mfma_f32_16x16x32_bf16 v[168:171], a[128:131], a[72:75], v[168:171]
  ds_read_b64_tr_b16 a[164:165], v2 offset:21664
  v_mfma_f32_16x16x32_bf16 v[168:171], a[132:135], a[88:91], v[168:171]
  v_mfma_f32_16x16x32_bf16 v[172:175], a[132:135], a[92:95], v[172:175]
  ds_read_b64_tr_b16 a[166:167], v2 offset:25248
  v_mfma_f32_16x16x32_bf16 v[172:175], a[128:131], a[76:79], v[172:175]
  s_waitcnt vmcnt(12)
  s_barrier
  buffer_load_dwordx4 v8, s[16:19], s56 offen offset:1024 lds
  v_mfma_f32_16x16x32_bf16 v[188:191], a[136:139], a[76:79], v[188:191]
  ds_read_b64_tr_b16 a[168:169], v2 offset:14528
  v_mfma_f32_16x16x32_bf16 v[188:191], a[140:143], a[92:95], v[188:191]
  v_mfma_f32_16x16x32_bf16 v[184:187], a[140:143], a[88:91], v[184:187]
  ds_read_b64_tr_b16 a[170:171], v2 offset:18112
  v_mfma_f32_16x16x32_bf16 v[184:187], a[136:139], a[72:75], v[184:187]
  v_mfma_f32_16x16x32_bf16 v[180:183], a[136:139], a[68:71], v[180:183]
  buffer_load_dwordx4 a[4:7], v0, s[36:39], s57 offen offset:1024 sc1
  v_mfma_f32_16x16x32_bf16 v[180:183], a[140:143], a[84:87], v[180:183]
  ds_read_b64_tr_b16 a[172:173], v2 offset:21696
  v_mfma_f32_16x16x32_bf16 v[176:179], a[140:143], a[80:83], v[176:179]
  ds_read_b64_tr_b16 a[174:175], v2 offset:25280
  v_mfma_f32_16x16x32_bf16 v[176:179], a[136:139], a[64:67], v[176:179]
  s_waitcnt lgkmcnt(8)
  v_mfma_f32_16x16x32_bf16 v[192:195], a[144:147], a[64:67], v[192:195]
  ds_read_b64_tr_b16 a[128:129], v2 offset:28672
  v_mfma_f32_16x16x32_bf16 v[192:195], a[148:151], a[80:83], v[192:195]
  v_mfma_f32_16x16x32_bf16 v[196:199], a[148:151], a[84:87], v[196:199]
  ds_read_b64_tr_b16 a[130:131], v2 offset:32256
  v_mfma_f32_16x16x32_bf16 v[196:199], a[144:147], a[68:71], v[196:199]
  v_mfma_f32_16x16x32_bf16 v[200:203], a[144:147], a[72:75], v[200:203]
  ds_read_b64_tr_b16 a[132:133], v2 offset:35840
  v_mfma_f32_16x16x32_bf16 v[200:203], a[148:151], a[88:91], v[200:203]
  v_mfma_f32_16x16x32_bf16 v[204:207], a[148:151], a[92:95], v[204:207]
  buffer_load_dwordx4 v9, s[16:19], s56 offen offset:2048 lds
  v_mfma_f32_16x16x32_bf16 v[204:207], a[144:147], a[76:79], v[204:207]
  ds_read_b64_tr_b16 a[134:135], v2 offset:39424
  v_mfma_f32_16x16x32_bf16 v[220:223], a[152:155], a[76:79], v[220:223]
  ds_read_b64_tr_b16 a[136:137], v2 offset:28704
  v_mfma_f32_16x16x32_bf16 v[220:223], a[156:159], a[92:95], v[220:223]
  v_mfma_f32_16x16x32_bf16 v[216:219], a[156:159], a[88:91], v[216:219]
  ds_read_b64_tr_b16 a[138:139], v2 offset:32288
  v_mfma_f32_16x16x32_bf16 v[216:219], a[152:155], a[72:75], v[216:219]
  buffer_load_dwordx4 a[8:11], v0, s[36:39], s57 offen offset:2048 sc1
  v_mfma_f32_16x16x32_bf16 v[212:215], a[152:155], a[68:71], v[212:215]
  ds_read_b64_tr_b16 a[140:141], v2 offset:35872
  v_mfma_f32_16x16x32_bf16 v[212:215], a[156:159], a[84:87], v[212:215]
  v_mfma_f32_16x16x32_bf16 v[208:211], a[156:159], a[80:83], v[208:211]
  ds_read_b64_tr_b16 a[142:143], v2 offset:39456
  v_mfma_f32_16x16x32_bf16 v[208:211], a[152:155], a[64:67], v[208:211]
  s_waitcnt lgkmcnt(8)
  v_mfma_f32_16x16x32_bf16 v[224:227], a[160:163], a[64:67], v[224:227]
  ds_read_b64_tr_b16 a[144:145], v2 offset:28736
  v_mfma_f32_16x16x32_bf16 v[224:227], a[164:167], a[80:83], v[224:227]
  v_mfma_f32_16x16x32_bf16 v[228:231], a[164:167], a[84:87], v[228:231]
  ds_read_b64_tr_b16 a[146:147], v2 offset:32320
  v_mfma_f32_16x16x32_bf16 v[228:231], a[160:163], a[68:71], v[228:231]
  v_mfma_f32_16x16x32_bf16 v[232:235], a[160:163], a[72:75], v[232:235]
  ds_read_b64_tr_b16 a[148:149], v2 offset:35904
  v_mfma_f32_16x16x32_bf16 v[232:235], a[164:167], a[88:91], v[232:235]
  buffer_load_dwordx4 a[12:15], v0, s[36:39], s57 offen offset:3072 sc1
  v_mfma_f32_16x16x32_bf16 v[236:239], a[164:167], a[92:95], v[236:239]
  ds_read_b64_tr_b16 a[150:151], v2 offset:39488
  v_mfma_f32_16x16x32_bf16 v[236:239], a[160:163], a[76:79], v[236:239]
  v_mfma_f32_16x16x32_bf16 v[252:255], a[168:171], a[76:79], v[252:255]
  ds_read_b64_tr_b16 a[152:153], v2 offset:28768
  v_mfma_f32_16x16x32_bf16 v[252:255], a[172:175], a[92:95], v[252:255]
  s_bfe_u32 s56, s82, 0x40014
  s_mul_i32 s56, s56, 458752
  s_add_u32 m0, s84, 28672
  v_mfma_f32_16x16x32_bf16 v[248:251], a[172:175], a[88:91], v[248:251]
  ds_read_b64_tr_b16 a[154:155], v2 offset:32352
  v_mfma_f32_16x16x32_bf16 v[248:251], a[168:171], a[72:75], v[248:251]
  v_mfma_f32_16x16x32_bf16 v[244:247], a[168:171], a[68:71], v[244:247]
  ds_read_b64_tr_b16 a[156:157], v2 offset:35936
  v_mfma_f32_16x16x32_bf16 v[244:247], a[172:175], a[84:87], v[244:247]
  buffer_load_dwordx4 v3, s[16:19], s56 offen offset:0 lds
  v_mfma_f32_16x16x32_bf16 v[240:243], a[172:175], a[80:83], v[240:243]
  ds_read_b64_tr_b16 a[158:159], v2 offset:39520
  v_mfma_f32_16x16x32_bf16 v[240:243], a[168:171], a[64:67], v[240:243]
  s_waitcnt vmcnt(8) lgkmcnt(8)
  v_mfma_f32_16x16x32_bf16 v[32:35], a[128:131], a[96:99], v[32:35]
  s_add_u32 s57, s57, 4096
  ds_read_b64_tr_b16 a[160:161], v2 offset:28800
  v_mfma_f32_16x16x32_bf16 v[32:35], a[132:135], a[112:115], v[32:35]
  v_mfma_f32_16x16x32_bf16 v[36:39], a[132:135], a[116:119], v[36:39]
  ds_read_b64_tr_b16 a[162:163], v2 offset:32384
  v_mfma_f32_16x16x32_bf16 v[36:39], a[128:131], a[100:103], v[36:39]
  v_mfma_f32_16x16x32_bf16 v[40:43], a[128:131], a[104:107], v[40:43]
  buffer_load_dwordx4 a[16:19], v0, s[36:39], s57 offen offset:0 sc1
  v_mfma_f32_16x16x32_bf16 v[40:43], a[132:135], a[120:123], v[40:43]
  ds_read_b64_tr_b16 a[164:165], v2 offset:35968
  v_mfma_f32_16x16x32_bf16 v[44:47], a[132:135], a[124:127], v[44:47]
  ds_read_b64_tr_b16 a[166:167], v2 offset:39552
  v_mfma_f32_16x16x32_bf16 v[44:47], a[128:131], a[108:111], v[44:47]
  v_mfma_f32_16x16x32_bf16 v[60:63], a[136:139], a[108:111], v[60:63]
  ds_read_b64_tr_b16 a[168:169], v2 offset:28832
  v_mfma_f32_16x16x32_bf16 v[60:63], a[140:143], a[124:127], v[60:63]
  v_mfma_f32_16x16x32_bf16 v[56:59], a[140:143], a[120:123], v[56:59]
  ds_read_b64_tr_b16 a[170:171], v2 offset:32416
  v_mfma_f32_16x16x32_bf16 v[56:59], a[136:139], a[104:107], v[56:59]
  buffer_load_dwordx4 v4, s[16:19], s56 offen offset:1024 lds
  v_mfma_f32_16x16x32_bf16 v[52:55], a[136:139], a[100:103], v[52:55]
  ds_read_b64_tr_b16 a[172:173], v2 offset:36000
  v_mfma_f32_16x16x32_bf16 v[52:55], a[140:143], a[116:119], v[52:55]
  v_mfma_f32_16x16x32_bf16 v[48:51], a[140:143], a[112:115], v[48:51]
  ds_read_b64_tr_b16 a[174:175], v2 offset:39584
  v_mfma_f32_16x16x32_bf16 v[48:51], a[136:139], a[96:99], v[48:51]
  s_waitcnt lgkmcnt(8)
  v_mfma_f32_16x16x32_bf16 v[64:67], a[144:147], a[96:99], v[64:67]
  ds_read_b64_tr_b16 a[128:129], v2 offset:28864
  v_mfma_f32_16x16x32_bf16 v[64:67], a[148:151], a[112:115], v[64:67]
  v_mfma_f32_16x16x32_bf16 v[68:71], a[148:151], a[116:119], v[68:71]
  ds_read_b64_tr_b16 a[130:131], v2 offset:32448
  v_mfma_f32_16x16x32_bf16 v[68:71], a[144:147], a[100:103], v[68:71]
  buffer_load_dwordx4 a[20:23], v0, s[36:39], s57 offen offset:1024 sc1
  v_mfma_f32_16x16x32_bf16 v[72:75], a[144:147], a[104:107], v[72:75]
  ds_read_b64_tr_b16 a[132:133], v2 offset:36032
  v_mfma_f32_16x16x32_bf16 v[72:75], a[148:151], a[120:123], v[72:75]
  v_mfma_f32_16x16x32_bf16 v[76:79], a[148:151], a[124:127], v[76:79]
  ds_read_b64_tr_b16 a[134:135], v2 offset:39616
  v_mfma_f32_16x16x32_bf16 v[76:79], a[144:147], a[108:111], v[76:79]
  v_mfma_f32_16x16x32_bf16 v[92:95], a[152:155], a[108:111], v[92:95]
  ds_read_b64_tr_b16 a[136:137], v2 offset:43008
  v_mfma_f32_16x16x32_bf16 v[92:95], a[156:159], a[124:127], v[92:95]
  v_mfma_f32_16x16x32_bf16 v[88:91], a[156:159], a[120:123], v[88:91]
  buffer_load_dwordx4 v5, s[16:19], s56 offen offset:2048 lds
  v_mfma_f32_16x16x32_bf16 v[88:91], a[152:155], a[104:107], v[88:91]
  ds_read_b64_tr_b16 a[138:139], v2 offset:46592
  v_mfma_f32_16x16x32_bf16 v[84:87], a[152:155], a[100:103], v[84:87]
  ds_read_b64_tr_b16 a[140:141], v2 offset:50176
  v_mfma_f32_16x16x32_bf16 v[84:87], a[156:159], a[116:119], v[84:87]
  v_mfma_f32_16x16x32_bf16 v[80:83], a[156:159], a[112:115], v[80:83]
  ds_read_b64_tr_b16 a[142:143], v2 offset:53760
  v_mfma_f32_16x16x32_bf16 v[80:83], a[152:155], a[96:99], v[80:83]
  s_waitcnt lgkmcnt(8)
  v_mfma_f32_16x16x32_bf16 v[96:99], a[160:163], a[96:99], v[96:99]
  ds_read_b64_tr_b16 a[144:145], v2 offset:43040
  v_mfma_f32_16x16x32_bf16 v[96:99], a[164:167], a[112:115], v[96:99]
  v_mfma_f32_16x16x32_bf16 v[100:103], a[164:167], a[116:119], v[100:103]
  buffer_load_dwordx4 a[24:27], v0, s[36:39], s57 offen offset:2048 sc1
  v_mfma_f32_16x16x32_bf16 v[100:103], a[160:163], a[100:103], v[100:103]
  ds_read_b64_tr_b16 a[146:147], v2 offset:46624
  v_mfma_f32_16x16x32_bf16 v[104:107], a[160:163], a[104:107], v[104:107]
  ds_read_b64_tr_b16 a[148:149], v2 offset:50208
  v_mfma_f32_16x16x32_bf16 v[104:107], a[164:167], a[120:123], v[104:107]
  v_mfma_f32_16x16x32_bf16 v[108:111], a[164:167], a[124:127], v[108:111]
  ds_read_b64_tr_b16 a[150:151], v2 offset:53792
  v_mfma_f32_16x16x32_bf16 v[108:111], a[160:163], a[108:111], v[108:111]
  v_mfma_f32_16x16x32_bf16 v[124:127], a[168:171], a[108:111], v[124:127]
  ds_read_b64_tr_b16 a[152:153], v2 offset:43072
  v_mfma_f32_16x16x32_bf16 v[124:127], a[172:175], a[124:127], v[124:127]
  buffer_load_dwordx4 v6, s[16:19], s56 offen offset:3072 lds
  v_mfma_f32_16x16x32_bf16 v[120:123], a[172:175], a[120:123], v[120:123]
  ds_read_b64_tr_b16 a[154:155], v2 offset:46656
  v_mfma_f32_16x16x32_bf16 v[120:123], a[168:171], a[104:107], v[120:123]
  v_mfma_f32_16x16x32_bf16 v[116:119], a[168:171], a[100:103], v[116:119]
  ds_read_b64_tr_b16 a[156:157], v2 offset:50240
  v_mfma_f32_16x16x32_bf16 v[116:119], a[172:175], a[116:119], v[116:119]
  v_mfma_f32_16x16x32_bf16 v[112:115], a[172:175], a[112:115], v[112:115]
  ds_read_b64_tr_b16 a[158:159], v2 offset:53824
  v_mfma_f32_16x16x32_bf16 v[112:115], a[168:171], a[96:99], v[112:115]
  s_waitcnt lgkmcnt(8)
  v_mfma_f32_16x16x32_bf16 v[128:131], a[128:131], a[96:99], v[128:131]
  ds_read_b64_tr_b16 a[160:161], v2 offset:43104
  v_mfma_f32_16x16x32_bf16 v[128:131], a[132:135], a[112:115], v[128:131]
  buffer_load_dwordx4 a[28:31], v0, s[36:39], s57 offen offset:3072 sc1
  v_mfma_f32_16x16x32_bf16 v[132:135], a[132:135], a[116:119], v[132:135]
  ds_read_b64_tr_b16 a[162:163], v2 offset:46688
  v_mfma_f32_16x16x32_bf16 v[132:135], a[128:131], a[100:103], v[132:135]
  v_mfma_f32_16x16x32_bf16 v[136:139], a[128:131], a[104:107], v[136:139]
  s_add_u32 m0, s84, 32768
  ds_read_b64_tr_b16 a[164:165], v2 offset:50272
  v_mfma_f32_16x16x32_bf16 v[136:139], a[132:135], a[120:123], v[136:139]
  v_mfma_f32_16x16x32_bf16 v[140:143], a[132:135], a[124:127], v[140:143]
  ds_read_b64_tr_b16 a[166:167], v2 offset:53856
  v_mfma_f32_16x16x32_bf16 v[140:143], a[128:131], a[108:111], v[140:143]
  v_mfma_f32_16x16x32_bf16 v[156:159], a[136:139], a[108:111], v[156:159]
  buffer_load_dwordx4 v7, s[16:19], s56 offen offset:0 lds
  s_bfe_u32 s57, s82, 0x40014
  v_mfma_f32_16x16x32_bf16 v[156:159], a[140:143], a[124:127], v[156:159]
  s_lshl_b32 s57, s57, 13
  s_add_u32 s57, s57, s85
  ds_read_b64_tr_b16 a[168:169], v2 offset:43136
  v_mfma_f32_16x16x32_bf16 v[152:155], a[140:143], a[120:123], v[152:155]
  ds_read_b64_tr_b16 a[170:171], v2 offset:46720
  v_mfma_f32_16x16x32_bf16 v[152:155], a[136:139], a[104:107], v[152:155]
  v_mfma_f32_16x16x32_bf16 v[148:151], a[136:139], a[100:103], v[148:151]
  ds_read_b64_tr_b16 a[172:173], v2 offset:50304
  v_mfma_f32_16x16x32_bf16 v[148:151], a[140:143], a[116:119], v[148:151]
  buffer_load_dwordx4 a[32:35], v0, s[36:39], s57 offen offset:0 sc1
  v_mfma_f32_16x16x32_bf16 v[144:147], a[140:143], a[112:115], v[144:147]
  ds_read_b64_tr_b16 a[174:175], v2 offset:53888
  v_mfma_f32_16x16x32_bf16 v[144:147], a[136:139], a[96:99], v[144:147]
  s_waitcnt lgkmcnt(8)
  v_mfma_f32_16x16x32_bf16 v[160:163], a[144:147], a[96:99], v[160:163]
  ds_read_b64_tr_b16 a[128:129], v2 offset:43168
  v_mfma_f32_16x16x32_bf16 v[160:163], a[148:151], a[112:115], v[160:163]
  v_mfma_f32_16x16x32_bf16 v[164:167], a[148:151], a[116:119], v[164:167]
  ds_read_b64_tr_b16 a[130:131], v2 offset:46752
  v_mfma_f32_16x16x32_bf16 v[164:167], a[144:147], a[100:103], v[164:167]
  v_mfma_f32_16x16x32_bf16 v[168:171], a[144:147], a[104:107], v[168:171]
  ds_read_b64_tr_b16 a[132:133], v2 offset:50336
  v_mfma_f32_16x16x32_bf16 v[168:171], a[148:151], a[120:123], v[168:171]
  v_mfma_f32_16x16x32_bf16 v[172:175], a[148:151], a[124:127], v[172:175]
  ds_read_b64_tr_b16 a[134:135], v2 offset:53920
  v_mfma_f32_16x16x32_bf16 v[172:175], a[144:147], a[108:111], v[172:175]
  s_waitcnt vmcnt(12)
  s_barrier
  buffer_load_dwordx4 v8, s[16:19], s56 offen offset:1024 lds
  v_mfma_f32_16x16x32_bf16 v[188:191], a[152:155], a[108:111], v[188:191]
  ds_read_b64_tr_b16 a[136:137], v2 offset:43200
  v_mfma_f32_16x16x32_bf16 v[188:191], a[156:159], a[124:127], v[188:191]
  v_mfma_f32_16x16x32_bf16 v[184:187], a[156:159], a[120:123], v[184:187]
  ds_read_b64_tr_b16 a[138:139], v2 offset:46784
  v_mfma_f32_16x16x32_bf16 v[184:187], a[152:155], a[104:107], v[184:187]
  v_mfma_f32_16x16x32_bf16 v[180:183], a[152:155], a[100:103], v[180:183]
  buffer_load_dwordx4 a[36:39], v0, s[36:39], s57 offen offset:1024 sc1
  v_mfma_f32_16x16x32_bf16 v[180:183], a[156:159], a[116:119], v[180:183]
  ds_read_b64_tr_b16 a[140:141], v2 offset:50368
  v_mfma_f32_16x16x32_bf16 v[176:179], a[156:159], a[112:115], v[176:179]
  ds_read_b64_tr_b16 a[142:143], v2 offset:53952
  v_mfma_f32_16x16x32_bf16 v[176:179], a[152:155], a[96:99], v[176:179]
  s_waitcnt lgkmcnt(8)
  v_mfma_f32_16x16x32_bf16 v[192:195], a[160:163], a[96:99], v[192:195]
  ds_read_b64_tr_b16 a[144:145], v1 offset:0
  v_mfma_f32_16x16x32_bf16 v[192:195], a[164:167], a[112:115], v[192:195]
  v_mfma_f32_16x16x32_bf16 v[196:199], a[164:167], a[116:119], v[196:199]
  ds_read_b64_tr_b16 a[146:147], v1 offset:3584
  v_mfma_f32_16x16x32_bf16 v[196:199], a[160:163], a[100:103], v[196:199]
  v_mfma_f32_16x16x32_bf16 v[200:203], a[160:163], a[104:107], v[200:203]
  ds_read_b64_tr_b16 a[148:149], v1 offset:7168
  v_mfma_f32_16x16x32_bf16 v[200:203], a[164:167], a[120:123], v[200:203]
  v_mfma_f32_16x16x32_bf16 v[204:207], a[164:167], a[124:127], v[204:207]
  buffer_load_dwordx4 v9, s[16:19], s56 offen offset:2048 lds
  v_mfma_f32_16x16x32_bf16 v[204:207], a[160:163], a[108:111], v[204:207]
  ds_read_b64_tr_b16 a[150:151], v1 offset:10752
  v_mfma_f32_16x16x32_bf16 v[220:223], a[168:171], a[108:111], v[220:223]
  ds_read_b64_tr_b16 a[152:153], v1 offset:32
  v_mfma_f32_16x16x32_bf16 v[220:223], a[172:175], a[124:127], v[220:223]
  v_mfma_f32_16x16x32_bf16 v[216:219], a[172:175], a[120:123], v[216:219]
  ds_read_b64_tr_b16 a[154:155], v1 offset:3616
  v_mfma_f32_16x16x32_bf16 v[216:219], a[168:171], a[104:107], v[216:219]
  buffer_load_dwordx4 a[40:43], v0, s[36:39], s57 offen offset:2048 sc1
  v_mfma_f32_16x16x32_bf16 v[212:215], a[168:171], a[100:103], v[212:215]
  ds_read_b64_tr_b16 a[156:157], v1 offset:7200
  v_mfma_f32_16x16x32_bf16 v[212:215], a[172:175], a[116:119], v[212:215]
  v_mfma_f32_16x16x32_bf16 v[208:211], a[172:175], a[112:115], v[208:211]
  ds_read_b64_tr_b16 a[158:159], v1 offset:10784
  v_mfma_f32_16x16x32_bf16 v[208:211], a[168:171], a[96:99], v[208:211]
  s_waitcnt lgkmcnt(8)
  v_mfma_f32_16x16x32_bf16 v[224:227], a[128:131], a[96:99], v[224:227]
  ds_read_b64_tr_b16 a[160:161], v1 offset:64
  v_mfma_f32_16x16x32_bf16 v[224:227], a[132:135], a[112:115], v[224:227]
  v_mfma_f32_16x16x32_bf16 v[228:231], a[132:135], a[116:119], v[228:231]
  ds_read_b64_tr_b16 a[162:163], v1 offset:3648
  v_mfma_f32_16x16x32_bf16 v[228:231], a[128:131], a[100:103], v[228:231]
  v_mfma_f32_16x16x32_bf16 v[232:235], a[128:131], a[104:107], v[232:235]
  ds_read_b64_tr_b16 a[164:165], v1 offset:7232
  v_mfma_f32_16x16x32_bf16 v[232:235], a[132:135], a[120:123], v[232:235]
  buffer_load_dwordx4 a[44:47], v0, s[36:39], s57 offen offset:3072 sc1
  v_mfma_f32_16x16x32_bf16 v[236:239], a[132:135], a[124:127], v[236:239]
  ds_read_b64_tr_b16 a[166:167], v1 offset:10816
  v_mfma_f32_16x16x32_bf16 v[236:239], a[128:131], a[108:111], v[236:239]
  v_mfma_f32_16x16x32_bf16 v[252:255], a[136:139], a[108:111], v[252:255]
  ds_read_b64_tr_b16 a[168:169], v1 offset:96
  v_mfma_f32_16x16x32_bf16 v[252:255], a[140:143], a[124:127], v[252:255]
  s_bfe_u32 s56, s82, 0x40018
  s_mul_i32 s56, s56, 458752
  s_add_u32 m0, s84, 57344
  v_mfma_f32_16x16x32_bf16 v[248:251], a[140:143], a[120:123], v[248:251]
  ds_read_b64_tr_b16 a[170:171], v1 offset:3680
  v_mfma_f32_16x16x32_bf16 v[248:251], a[136:139], a[104:107], v[248:251]
  v_mfma_f32_16x16x32_bf16 v[244:247], a[136:139], a[100:103], v[244:247]
  ds_read_b64_tr_b16 a[172:173], v1 offset:7264
  v_mfma_f32_16x16x32_bf16 v[244:247], a[140:143], a[116:119], v[244:247]
  buffer_load_dwordx4 v3, s[16:19], s56 offen offset:0 lds
  v_mfma_f32_16x16x32_bf16 v[240:243], a[140:143], a[112:115], v[240:243]
  ds_read_b64_tr_b16 a[174:175], v1 offset:10848
  v_mfma_f32_16x16x32_bf16 v[240:243], a[136:139], a[96:99], v[240:243]
  s_waitcnt vmcnt(8) lgkmcnt(8)
  v_mfma_f32_16x16x32_bf16 v[32:35], a[144:147], a[0:3], v[32:35]
  s_add_u32 s57, s57, 4096
  ds_read_b64_tr_b16 a[128:129], v1 offset:128
  v_mfma_f32_16x16x32_bf16 v[32:35], a[148:151], a[16:19], v[32:35]
  v_mfma_f32_16x16x32_bf16 v[36:39], a[148:151], a[20:23], v[36:39]
Hb1:
  s_cbranch_execz Hb1_1
  ds_read_b64_tr_b16 a[130:131], v1 offset:3712
  v_mfma_f32_16x16x32_bf16 v[36:39], a[144:147], a[4:7], v[36:39]
  v_mfma_f32_16x16x32_bf16 v[40:43], a[144:147], a[8:11], v[40:43]
  buffer_load_dwordx4 a[48:51], v0, s[36:39], s57 offen offset:0 sc1
  v_mfma_f32_16x16x32_bf16 v[40:43], a[148:151], a[24:27], v[40:43]
  ds_read_b64_tr_b16 a[132:133], v1 offset:7296
  v_mfma_f32_16x16x32_bf16 v[44:47], a[148:151], a[28:31], v[44:47]
  ds_read_b64_tr_b16 a[134:135], v1 offset:10880
  v_mfma_f32_16x16x32_bf16 v[44:47], a[144:147], a[12:15], v[44:47]
  v_mfma_f32_16x16x32_bf16 v[60:63], a[152:155], a[12:15], v[60:63]
  ds_read_b64_tr_b16 a[136:137], v1 offset:160
  v_mfma_f32_16x16x32_bf16 v[60:63], a[156:159], a[28:31], v[60:63]
  v_mfma_f32_16x16x32_bf16 v[56:59], a[156:159], a[24:27], v[56:59]
  ds_read_b64_tr_b16 a[138:139], v1 offset:3744
  v_mfma_f32_16x16x32_bf16 v[56:59], a[152:155], a[8:11], v[56:59]
  buffer_load_dwordx4 v4, s[16:19], s56 offen offset:1024 lds
  v_mfma_f32_16x16x32_bf16 v[52:55], a[152:155], a[4:7], v[52:55]
  ds_read_b64_tr_b16 a[140:141], v1 offset:7328
  v_mfma_f32_16x16x32_bf16 v[52:55], a[156:159], a[20:23], v[52:55]
  v_mfma_f32_16x16x32_bf16 v[48:51], a[156:159], a[16:19], v[48:51]
  ds_read_b64_tr_b16 a[142:143], v1 offset:10912
  v_mfma_f32_16x16x32_bf16 v[48:51], a[152:155], a[0:3], v[48:51]
  s_waitcnt lgkmcnt(8)
  v_mfma_f32_16x16x32_bf16 v[64:67], a[160:163], a[0:3], v[64:67]
  ds_read_b64_tr_b16 a[144:145], v1 offset:192
  v_mfma_f32_16x16x32_bf16 v[64:67], a[164:167], a[16:19], v[64:67]
  v_mfma_f32_16x16x32_bf16 v[68:71], a[164:167], a[20:23], v[68:71]
  ds_read_b64_tr_b16 a[146:147], v1 offset:3776
  v_mfma_f32_16x16x32_bf16 v[68:71], a[160:163], a[4:7], v[68:71]
  buffer_load_dwordx4 a[52:55], v0, s[36:39], s57 offen offset:1024 sc1
  v_mfma_f32_16x16x32_bf16 v[72:75], a[160:163], a[8:11], v[72:75]
  ds_read_b64_tr_b16 a[148:149], v1 offset:7360
  v_mfma_f32_16x16x32_bf16 v[72:75], a[164:167], a[24:27], v[72:75]
  v_mfma_f32_16x16x32_bf16 v[76:79], a[164:167], a[28:31], v[76:79]
  ds_read_b64_tr_b16 a[150:151], v1 offset:10944
  v_mfma_f32_16x16x32_bf16 v[76:79], a[160:163], a[12:15], v[76:79]
  v_mfma_f32_16x16x32_bf16 v[92:95], a[168:171], a[12:15], v[92:95]
  ds_read_b64_tr_b16 a[152:153], v1 offset:14336
  v_mfma_f32_16x16x32_bf16 v[92:95], a[172:175], a[28:31], v[92:95]
  v_mfma_f32_16x16x32_bf16 v[88:91], a[172:175], a[24:27], v[88:91]
  buffer_load_dwordx4 v5, s[16:19], s56 offen offset:2048 lds
  v_mfma_f32_16x16x32_bf16 v[88:91], a[168:171], a[8:11], v[88:91]
  ds_read_b64_tr_b16 a[154:155], v1 offset:17920
  v_mfma_f32_16x16x32_bf16 v[84:87], a[168:171], a[4:7], v[84:87]
  ds_read_b64_tr_b16 a[156:157], v1 offset:21504
  v_mfma_f32_16x16x32_bf16 v[84:87], a[172:175], a[20:23], v[84:87]
  v_mfma_f32_16x16x32_bf16 v[80:83], a[172:175], a[16:19], v[80:83]
  ds_read_b64_tr_b16 a[158:159], v1 offset:25088
  v_mfma_f32_16x16x32_bf16 v[80:83], a[168:171], a[0:3], v[80:83]
  s_waitcnt lgkmcnt(8)
  v_mfma_f32_16x16x32_bf16 v[96:99], a[128:131], a[0:3], v[96:99]
  ds_read_b64_tr_b16 a[160:161], v1 offset:14368
  v_mfma_f32_16x16x32_bf16 v[96:99], a[132:135], a[16:19], v[96:99]
  v_mfma_f32_16x16x32_bf16 v[100:103], a[132:135], a[20:23], v[100:103]
  buffer_load_dwordx4 a[56:59], v0, s[36:39], s57 offen offset:2048 sc1
  v_mfma_f32_16x16x32_bf16 v[100:103], a[128:131], a[4:7], v[100:103]
  ds_read_b64_tr_b16 a[162:163], v1 offset:17952
  v_mfma_f32_16x16x32_bf16 v[104:107], a[128:131], a[8:11], v[104:107]
  ds_read_b64_tr_b16 a[164:165], v1 offset:21536
  v_mfma_f32_16x16x32_bf16 v[104:107], a[132:135], a[24:27], v[104:107]
  v_mfma_f32_16x16x32_bf16 v[108:111], a[132:135], a[28:31], v[108:111]
  ds_read_b64_tr_b16 a[166:167], v1 offset:25120
  v_mfma_f32_16x16x32_bf16 v[108:111], a[128:131], a[12:15], v[108:111]
  v_mfma_f32_16x16x32_bf16 v[124:127], a[136:139], a[12:15], v[124:127]
  ds_read_b64_tr_b16 a[168:169], v1 offset:14400
  v_mfma_f32_16x16x32_bf16 v[124:127], a[140:143], a[28:31], v[124:127]
  buffer_load_dwordx4 v6, s[16:19], s56 offen offset:3072 lds
  v_mfma_f32_16x16x32_bf16 v[120:123], a[140:143], a[24:27], v[120:123]
  ds_read_b64_tr_b16 a[170:171], v1 offset:17984
  v_mfma_f32_16x16x32_bf16 v[120:123], a[136:139], a[8:11], v[120:123]
  v_mfma_f32_16x16x32_bf16 v[116:119], a[136:139], a[4:7], v[116:119]
  ds_read_b64_tr_b16 a[172:173], v1 offset:21568
  v_mfma_f32_16x16x32_bf16 v[116:119], a[140:143], a[20:23], v[116:119]
  v_mfma_f32_16x16x32_bf16 v[112:115], a[140:143], a[16:19], v[112:115]
  ds_read_b64_tr_b16 a[174:175], v1 offset:25152
  v_mfma_f32_16x16x32_bf16 v[112:115], a[136:139], a[0:3], v[112:115]
  s_waitcnt lgkmcnt(8)
  v_mfma_f32_16x16x32_bf16 v[128:131], a[144:147], a[0:3], v[128:131]
  ds_read_b64_tr_b16 a[128:129], v1 offset:14432
  v_mfma_f32_16x16x32_bf16 v[128:131], a[148:151], a[16:19], v[128:131]
  buffer_load_dwordx4 a[60:63], v0, s[36:39], s57 offen offset:3072 sc1
  v_mfma_f32_16x16x32_bf16 v[132:135], a[148:151], a[20:23], v[132:135]
  ds_read_b64_tr_b16 a[130:131], v1 offset:18016
  v_mfma_f32_16x16x32_bf16 v[132:135], a[144:147], a[4:7], v[132:135]
  v_mfma_f32_16x16x32_bf16 v[136:139], a[144:147], a[8:11], v[136:139]
  s_add_u32 m0, s84, 61440
  ds_read_b64_tr_b16 a[132:133], v1 offset:21600
  v_mfma_f32_16x16x32_bf16 v[136:139], a[148:151], a[24:27], v[136:139]
  v_mfma_f32_16x16x32_bf16 v[140:143], a[148:151], a[28:31], v[140:143]
  ds_read_b64_tr_b16 a[134:135], v1 offset:25184
  v_mfma_f32_16x16x32_bf16 v[140:143], a[144:147], a[12:15], v[140:143]
  v_mfma_f32_16x16x32_bf16 v[156:159], a[152:155], a[12:15], v[156:159]
  buffer_load_dwordx4 v7, s[16:19], s56 offen offset:0 lds
  s_bfe_u32 s57, s82, 0x40018
  v_mfma_f32_16x16x32_bf16 v[156:159], a[156:159], a[28:31], v[156:159]
  s_lshl_b32 s57, s57, 13
  s_add_u32 s57, s57, s85
  ds_read_b64_tr_b16 a[136:137], v1 offset:14464
  v_mfma_f32_16x16x32_bf16 v[152:155], a[156:159], a[24:27], v[152:155]
  ds_read_b64_tr_b16 a[138:139], v1 offset:18048
  v_mfma_f32_16x16x32_bf16 v[152:155], a[152:155], a[8:11], v[152:155]
  v_mfma_f32_16x16x32_bf16 v[148:151], a[152:155], a[4:7], v[148:151]
  ds_read_b64_tr_b16 a[140:141], v1 offset:21632
  v_mfma_f32_16x16x32_bf16 v[148:151], a[156:159], a[20:23], v[148:151]
  buffer_load_dwordx4 a[64:67], v0, s[36:39], s57 offen offset:0 sc1
  v_mfma_f32_16x16x32_bf16 v[144:147], a[156:159], a[16:19], v[144:147]
  ds_read_b64_tr_b16 a[142:143], v1 offset:25216
  v_mfma_f32_16x16x32_bf16 v[144:147], a[152:155], a[0:3], v[144:147]
  s_waitcnt lgkmcnt(8)
  v_mfma_f32_16x16x32_bf16 v[160:163], a[160:163], a[0:3], v[160:163]
  ds_read_b64_tr_b16 a[144:145], v1 offset:14496
  v_mfma_f32_16x16x32_bf16 v[160:163], a[164:167], a[16:19], v[160:163]
  v_mfma_f32_16x16x32_bf16 v[164:167], a[164:167], a[20:23], v[164:167]
  ds_read_b64_tr_b16 a[146:147], v1 offset:18080
  v_mfma_f32_16x16x32_bf16 v[164:167], a[160:163], a[4:7], v[164:167]
  v_mfma_f32_16x16x32_bf16 v[168:171], a[160:163], a[8:11], v[168:171]
  ds_read_b64_tr_b16 a[148:149], v1 offset:21664
  v_mfma_f32_16x16x32_bf16 v[168:171], a[164:167], a[24:27], v[168:171]
  v_mfma_f32_16x16x32_bf16 v[172:175], a[164:167], a[28:31], v[172:175]
  ds_read_b64_tr_b16 a[150:151], v1 offset:25248
  v_mfma_f32_16x16x32_bf16 v[172:175], a[160:163], a[12:15], v[172:175]
  s_waitcnt vmcnt(12)
  s_barrier
  buffer_load_dwordx4 v8, s[16:19], s56 offen offset:1024 lds
  v_mfma_f32_16x16x32_bf16 v[188:191], a[168:171], a[12:15], v[188:191]
  ds_read_b64_tr_b16 a[152:153], v1 offset:14528
  v_mfma_f32_16x16x32_bf16 v[188:191], a[172:175], a[28:31], v[188:191]
  v_mfma_f32_16x16x32_bf16 v[184:187], a[172:175], a[24:27], v[184:187]
  ds_read_b64_tr_b16 a[154:155], v1 offset:18112
  v_mfma_f32_16x16x32_bf16 v[184:187], a[168:171], a[8:11], v[184:187]
  v_mfma_f32_16x16x32_bf16 v[180:183], a[168:171], a[4:7], v[180:183]
  buffer_load_dwordx4 a[68:71], v0, s[36:39], s57 offen offset:1024 sc1
  v_mfma_f32_16x16x32_bf16 v[180:183], a[172:175], a[20:23], v[180:183]
  ds_read_b64_tr_b16 a[156:157], v1 offset:21696
  v_mfma_f32_16x16x32_bf16 v[176:179], a[172:175], a[16:19], v[176:179]
  ds_read_b64_tr_b16 a[158:159], v1 offset:25280
  v_mfma_f32_16x16x32_bf16 v[176:179], a[168:171], a[0:3], v[176:179]
  s_waitcnt lgkmcnt(8)
  v_mfma_f32_16x16x32_bf16 v[192:195], a[128:131], a[0:3], v[192:195]
  ds_read_b64_tr_b16 a[160:161], v1 offset:28672
  v_mfma_f32_16x16x32_bf16 v[192:195], a[132:135], a[16:19], v[192:195]
  v_mfma_f32_16x16x32_bf16 v[196:199], a[132:135], a[20:23], v[196:199]
  ds_read_b64_tr_b16 a[162:163], v1 offset:32256
  v_mfma_f32_16x16x32_bf16 v[196:199], a[128:131], a[4:7], v[196:199]
  v_mfma_f32_16x16x32_bf16 v[200:203], a[128:131], a[8:11], v[200:203]
  ds_read_b64_tr_b16 a[164:165], v1 offset:35840
  v_mfma_f32_16x16x32_bf16 v[200:203], a[132:135], a[24:27], v[200:203]
  v_mfma_f32_16x16x32_bf16 v[204:207], a[132:135], a[28:31], v[204:207]
  buffer_load_dwordx4 v9, s[16:19], s56 offen offset:2048 lds
  v_mfma_f32_16x16x32_bf16 v[204:207], a[128:131], a[12:15], v[204:207]
  ds_read_b64_tr_b16 a[166:167], v1 offset:39424
  v_mfma_f32_16x16x32_bf16 v[220:223], a[136:139], a[12:15], v[220:223]
  ds_read_b64_tr_b16 a[168:169], v1 offset:28704
  v_mfma_f32_16x16x32_bf16 v[220:223], a[140:143], a[28:31], v[220:223]
  v_mfma_f32_16x16x32_bf16 v[216:219], a[140:143], a[24:27], v[216:219]
  ds_read_b64_tr_b16 a[170:171], v1 offset:32288
  v_mfma_f32_16x16x32_bf16 v[216:219], a[136:139], a[8:11], v[216:219]
  buffer_load_dwordx4 a[72:75], v0, s[36:39], s57 offen offset:2048 sc1
  v_mfma_f32_16x16x32_bf16 v[212:215], a[136:139], a[4:7], v[212:215]
  ds_read_b64_tr_b16 a[172:173], v1 offset:35872
  v_mfma_f32_16x16x32_bf16 v[212:215], a[140:143], a[20:23], v[212:215]
  v_mfma_f32_16x16x32_bf16 v[208:211], a[140:143], a[16:19], v[208:211]
  ds_read_b64_tr_b16 a[174:175], v1 offset:39456
  v_mfma_f32_16x16x32_bf16 v[208:211], a[136:139], a[0:3], v[208:211]
  s_waitcnt lgkmcnt(8)
  v_mfma_f32_16x16x32_bf16 v[224:227], a[144:147], a[0:3], v[224:227]
  ds_read_b64_tr_b16 a[128:129], v1 offset:28736
  v_mfma_f32_16x16x32_bf16 v[224:227], a[148:151], a[16:19], v[224:227]
  v_mfma_f32_16x16x32_bf16 v[228:231], a[148:151], a[20:23], v[228:231]
  ds_read_b64_tr_b16 a[130:131], v1 offset:32320
  v_mfma_f32_16x16x32_bf16 v[228:231], a[144:147], a[4:7], v[228:231]
  v_mfma_f32_16x16x32_bf16 v[232:235], a[144:147], a[8:11], v[232:235]
  ds_read_b64_tr_b16 a[132:133], v1 offset:35904
  v_mfma_f32_16x16x32_bf16 v[232:235], a[148:151], a[24:27], v[232:235]
  buffer_load_dwordx4 a[76:79], v0, s[36:39], s57 offen offset:3072 sc1
  v_mfma_f32_16x16x32_bf16 v[236:239], a[148:151], a[28:31], v[236:239]
  ds_read_b64_tr_b16 a[134:135], v1 offset:39488
  v_mfma_f32_16x16x32_bf16 v[236:239], a[144:147], a[12:15], v[236:239]
  v_mfma_f32_16x16x32_bf16 v[252:255], a[152:155], a[12:15], v[252:255]
  ds_read_b64_tr_b16 a[136:137], v1 offset:28768
  v_mfma_f32_16x16x32_bf16 v[252:255], a[156:159], a[28:31], v[252:255]
  s_bfe_u32 s56, s82, 0x4001c
  s_mul_i32 s56, s56, 458752
  s_add_u32 m0, s84, 86016
  v_mfma_f32_16x16x32_bf16 v[248:251], a[156:159], a[24:27], v[248:251]
  buffer_load_dwordx4 a[208:211], v0, s[36:39], s59 offen offset:0 sc1
  v_add_u32 v31, 57344, v31
  v_mfma_f32_16x16x32_bf16 v[248:251], a[152:155], a[8:11], v[248:251]
  ds_read_b64_tr_b16 a[138:139], v1 offset:32352
  v_mfma_f32_16x16x32_bf16 v[244:247], a[152:155], a[4:7], v[244:247]
  ds_read_b64_tr_b16 a[140:141], v1 offset:35936
  v_mfma_f32_16x16x32_bf16 v[244:247], a[156:159], a[20:23], v[244:247]
  v_mfma_f32_16x16x32_bf16 v[240:243], a[156:159], a[16:19], v[240:243]
  ds_read_b64_tr_b16 a[142:143], v1 offset:39520
  v_mfma_f32_16x16x32_bf16 v[240:243], a[152:155], a[0:3], v[240:243]
  s_waitcnt vmcnt(8) lgkmcnt(8)
  buffer_load_dwordx4 a[212:215], v0, s[36:39], s59 offen offset:1024 sc1
  v_mfma_f32_16x16x32_bf16 v[32:35], a[160:163], a[32:35], v[32:35]
  ds_read_b64_tr_b16 a[144:145], v1 offset:28800
  v_mfma_f32_16x16x32_bf16 v[32:35], a[164:167], a[48:51], v[32:35]
  v_mfma_f32_16x16x32_bf16 v[36:39], a[164:167], a[52:55], v[36:39]
  ds_read_b64_tr_b16 a[146:147], v1 offset:32384
  v_mfma_f32_16x16x32_bf16 v[36:39], a[160:163], a[36:39], v[36:39]
  v_mfma_f32_16x16x32_bf16 v[40:43], a[160:163], a[40:43], v[40:43]
  buffer_load_dwordx4 v3, s[16:19], s56 offen offset:0 lds
  s_add_u32 s57, s57, 4096
  v_mfma_f32_16x16x32_bf16 v[40:43], a[164:167], a[56:59], v[40:43]
  ds_read_b64_tr_b16 a[148:149], v1 offset:35968
  v_mfma_f32_16x16x32_bf16 v[44:47], a[164:167], a[60:63], v[44:47]
  ds_read_b64_tr_b16 a[150:151], v1 offset:39552
  v_mfma_f32_16x16x32_bf16 v[44:47], a[160:163], a[44:47], v[44:47]
  v_mfma_f32_16x16x32_bf16 v[60:63], a[168:171], a[44:47], v[60:63]
  ds_read_b64_tr_b16 a[152:153], v1 offset:28832
  v_mfma_f32_16x16x32_bf16 v[60:63], a[172:175], a[60:63], v[60:63]
  buffer_load_dwordx4 a[80:83], v0, s[36:39], s57 offen offset:0 sc1
  v_mfma_f32_16x16x32_bf16 v[56:59], a[172:175], a[56:59], v[56:59]
  ds_read_b64_tr_b16 a[154:155], v1 offset:32416
  v_mfma_f32_16x16x32_bf16 v[56:59], a[168:171], a[40:43], v[56:59]
  v_mfma_f32_16x16x32_bf16 v[52:55], a[168:171], a[36:39], v[52:55]
  ds_read_b64_tr_b16 a[156:157], v1 offset:36000
  v_mfma_f32_16x16x32_bf16 v[52:55], a[172:175], a[52:55], v[52:55]
  v_mfma_f32_16x16x32_bf16 v[48:51], a[172:175], a[48:51], v[48:51]
  buffer_load_dwordx4 v4, s[16:19], s56 offen offset:1024 lds
  v_mfma_f32_16x16x32_bf16 v[48:51], a[168:171], a[32:35], v[48:51]
  s_waitcnt lgkmcnt(7)
  ds_read_b64_tr_b16 a[158:159], v1 offset:39584
  v_mfma_f32_16x16x32_bf16 v[64:67], a[128:131], a[32:35], v[64:67]
  ds_read_b64_tr_b16 a[160:161], v1 offset:28864
  v_mfma_f32_16x16x32_bf16 v[64:67], a[132:135], a[48:51], v[64:67]
  v_mfma_f32_16x16x32_bf16 v[68:71], a[132:135], a[52:55], v[68:71]
  ds_read_b64_tr_b16 a[162:163], v1 offset:32448
  v_mfma_f32_16x16x32_bf16 v[68:71], a[128:131], a[36:39], v[68:71]
  buffer_load_dwordx4 a[84:87], v0, s[36:39], s57 offen offset:1024 sc1
  v_mfma_f32_16x16x32_bf16 v[72:75], a[128:131], a[40:43], v[72:75]
  ds_read_b64_tr_b16 a[164:165], v1 offset:36032
  v_mfma_f32_16x16x32_bf16 v[72:75], a[132:135], a[56:59], v[72:75]
  v_mfma_f32_16x16x32_bf16 v[76:79], a[132:135], a[60:63], v[76:79]
  ds_read_b64_tr_b16 a[166:167], v1 offset:39616
  v_mfma_f32_16x16x32_bf16 v[76:79], a[128:131], a[44:47], v[76:79]
  v_mfma_f32_16x16x32_bf16 v[92:95], a[136:139], a[44:47], v[92:95]
  ds_read_b64_tr_b16 a[168:169], v1 offset:43008
  v_mfma_f32_16x16x32_bf16 v[92:95], a[140:143], a[60:63], v[92:95]
  v_mfma_f32_16x16x32_bf16 v[88:91], a[140:143], a[56:59], v[88:91]
  buffer_load_dwordx4 v5, s[16:19], s56 offen offset:2048 lds
  v_mfma_f32_16x16x32_bf16 v[88:91], a[136:139], a[40:43], v[88:91]
  ds_read_b64_tr_b16 a[170:171], v1 offset:46592
  v_mfma_f32_16x16x32_bf16 v[84:87], a[136:139], a[36:39], v[84:87]
  ds_read_b64_tr_b16 a[172:173], v1 offset:50176
  v_mfma_f32_16x16x32_bf16 v[84:87], a[140:143], a[52:55], v[84:87]
  v_mfma_f32_16x16x32_bf16 v[80:83], a[140:143], a[48:51], v[80:83]
  ds_read_b64_tr_b16 a[174:175], v1 offset:53760
  v_mfma_f32_16x16x32_bf16 v[80:83], a[136:139], a[32:35], v[80:83]
  s_waitcnt lgkmcnt(8)
  v_mfma_f32_16x16x32_bf16 v[96:99], a[144:147], a[32:35], v[96:99]
  ds_read_b64_tr_b16 a[128:129], v1 offset:43040
  v_mfma_f32_16x16x32_bf16 v[96:99], a[148:151], a[48:51], v[96:99]
  v_mfma_f32_16x16x32_bf16 v[100:103], a[148:151], a[52:55], v[100:103]
  buffer_load_dwordx4 a[88:91], v0, s[36:39], s57 offen offset:2048 sc1
  v_mfma_f32_16x16x32_bf16 v[100:103], a[144:147], a[36:39], v[100:103]
  ds_read_b64_tr_b16 a[130:131], v1 offset:46624
  v_mfma_f32_16x16x32_bf16 v[104:107], a[144:147], a[40:43], v[104:107]
  ds_read_b64_tr_b16 a[132:133], v1 offset:50208
  v_mfma_f32_16x16x32_bf16 v[104:107], a[148:151], a[56:59], v[104:107]
  v_mfma_f32_16x16x32_bf16 v[108:111], a[148:151], a[60:63], v[108:111]
  ds_read_b64_tr_b16 a[134:135], v1 offset:53792
  v_mfma_f32_16x16x32_bf16 v[108:111], a[144:147], a[44:47], v[108:111]
  v_mfma_f32_16x16x32_bf16 v[124:127], a[152:155], a[44:47], v[124:127]
  ds_read_b64_tr_b16 a[136:137], v1 offset:43072
  v_mfma_f32_16x16x32_bf16 v[124:127], a[156:159], a[60:63], v[124:127]
  buffer_load_dwordx4 v6, s[16:19], s56 offen offset:3072 lds
  v_mfma_f32_16x16x32_bf16 v[120:123], a[156:159], a[56:59], v[120:123]
  ds_read_b64_tr_b16 a[138:139], v1 offset:46656
  v_mfma_f32_16x16x32_bf16 v[120:123], a[152:155], a[40:43], v[120:123]
  v_mfma_f32_16x16x32_bf16 v[116:119], a[152:155], a[36:39], v[116:119]
  ds_read_b64_tr_b16 a[140:141], v1 offset:50240
  v_mfma_f32_16x16x32_bf16 v[116:119], a[156:159], a[52:55], v[116:119]
  v_mfma_f32_16x16x32_bf16 v[112:115], a[156:159], a[48:51], v[112:115]
  ds_read_b64_tr_b16 a[142:143], v1 offset:53824
  v_mfma_f32_16x16x32_bf16 v[112:115], a[152:155], a[32:35], v[112:115]
  s_waitcnt lgkmcnt(8)
  v_mfma_f32_16x16x32_bf16 v[128:131], a[160:163], a[32:35], v[128:131]
  ds_read_b64_tr_b16 a[144:145], v1 offset:43104
  v_mfma_f32_16x16x32_bf16 v[128:131], a[164:167], a[48:51], v[128:131]
  buffer_load_dwordx4 a[92:95], v0, s[36:39], s57 offen offset:3072 sc1
  v_mfma_f32_16x16x32_bf16 v[132:135], a[164:167], a[52:55], v[132:135]
  ds_read_b64_tr_b16 a[146:147], v1 offset:46688
  v_mfma_f32_16x16x32_bf16 v[132:135], a[160:163], a[36:39], v[132:135]
  v_mfma_f32_16x16x32_bf16 v[136:139], a[160:163], a[40:43], v[136:139]
  s_add_u32 m0, s84, 90112
  ds_read_b64_tr_b16 a[148:149], v1 offset:50272
  v_mfma_f32_16x16x32_bf16 v[136:139], a[164:167], a[56:59], v[136:139]
  v_mfma_f32_16x16x32_bf16 v[140:143], a[164:167], a[60:63], v[140:143]
  ds_read_b64_tr_b16 a[150:151], v1 offset:53856
  v_mfma_f32_16x16x32_bf16 v[140:143], a[160:163], a[44:47], v[140:143]
  v_mfma_f32_16x16x32_bf16 v[156:159], a[168:171], a[44:47], v[156:159]
  buffer_load_dwordx4 v7, s[16:19], s56 offen offset:0 lds
  s_bfe_u32 s57, s82, 0x4001c
  v_mfma_f32_16x16x32_bf16 v[156:159], a[172:175], a[60:63], v[156:159]
  s_lshl_b32 s57, s57, 13
  s_add_u32 s57, s57, s85
  ds_read_b64_tr_b16 a[152:153], v1 offset:43136
  v_mfma_f32_16x16x32_bf16 v[152:155], a[172:175], a[56:59], v[152:155]
  ds_read_b64_tr_b16 a[154:155], v1 offset:46720
  v_mfma_f32_16x16x32_bf16 v[152:155], a[168:171], a[40:43], v[152:155]
  v_mfma_f32_16x16x32_bf16 v[148:151], a[168:171], a[36:39], v[148:151]
  ds_read_b64_tr_b16 a[156:157], v1 offset:50304
  v_mfma_f32_16x16x32_bf16 v[148:151], a[172:175], a[52:55], v[148:151]
  buffer_load_dwordx4 a[96:99], v0, s[36:39], s57 offen offset:0 sc1
  v_mfma_f32_16x16x32_bf16 v[144:147], a[172:175], a[48:51], v[144:147]
  ds_read_b64_tr_b16 a[158:159], v1 offset:53888
  v_mfma_f32_16x16x32_bf16 v[144:147], a[168:171], a[32:35], v[144:147]
  s_waitcnt lgkmcnt(8)
  v_mfma_f32_16x16x32_bf16 v[160:163], a[128:131], a[32:35], v[160:163]
  ds_read_b64_tr_b16 a[160:161], v1 offset:43168
  v_mfma_f32_16x16x32_bf16 v[160:163], a[132:135], a[48:51], v[160:163]
  v_mfma_f32_16x16x32_bf16 v[164:167], a[132:135], a[52:55], v[164:167]
  ds_read_b64_tr_b16 a[162:163], v1 offset:46752
  v_mfma_f32_16x16x32_bf16 v[164:167], a[128:131], a[36:39], v[164:167]
  v_mfma_f32_16x16x32_bf16 v[168:171], a[128:131], a[40:43], v[168:171]
  ds_read_b64_tr_b16 a[164:165], v1 offset:50336
  v_mfma_f32_16x16x32_bf16 v[168:171], a[132:135], a[56:59], v[168:171]
  v_mfma_f32_16x16x32_bf16 v[172:175], a[132:135], a[60:63], v[172:175]
  ds_read_b64_tr_b16 a[166:167], v1 offset:53920
  v_mfma_f32_16x16x32_bf16 v[172:175], a[128:131], a[44:47], v[172:175]
  s_waitcnt vmcnt(14)
  s_barrier
  buffer_load_dwordx4 v8, s[16:19], s56 offen offset:1024 lds
  v_mfma_f32_16x16x32_bf16 v[188:191], a[136:139], a[44:47], v[188:191]
  ds_read_b64_tr_b16 a[168:169], v1 offset:43200
  v_mfma_f32_16x16x32_bf16 v[188:191], a[140:143], a[60:63], v[188:191]
  v_mfma_f32_16x16x32_bf16 v[184:187], a[140:143], a[56:59], v[184:187]
  ds_read_b64_tr_b16 a[170:171], v1 offset:46784
  v_mfma_f32_16x16x32_bf16 v[184:187], a[136:139], a[40:43], v[184:187]
  v_mfma_f32_16x16x32_bf16 v[180:183], a[136:139], a[36:39], v[180:183]
  buffer_load_dwordx4 a[100:103], v0, s[36:39], s57 offen offset:1024 sc1
  v_mfma_f32_16x16x32_bf16 v[180:183], a[140:143], a[52:55], v[180:183]
  ds_read_b64_tr_b16 a[172:173], v1 offset:50368
  v_mfma_f32_16x16x32_bf16 v[176:179], a[140:143], a[48:51], v[176:179]
  ds_read_b64_tr_b16 a[174:175], v1 offset:53952
  v_mfma_f32_16x16x32_bf16 v[176:179], a[136:139], a[32:35], v[176:179]
  s_waitcnt lgkmcnt(8)
  v_mfma_f32_16x16x32_bf16 v[192:195], a[144:147], a[32:35], v[192:195]
  ds_read_b64_tr_b16 a[128:129], v2 offset:0
  v_mfma_f32_16x16x32_bf16 v[192:195], a[148:151], a[48:51], v[192:195]
  v_mfma_f32_16x16x32_bf16 v[196:199], a[148:151], a[52:55], v[196:199]
  ds_read_b64_tr_b16 a[130:131], v2 offset:3584
  v_mfma_f32_16x16x32_bf16 v[196:199], a[144:147], a[36:39], v[196:199]
  v_mfma_f32_16x16x32_bf16 v[200:203], a[144:147], a[40:43], v[200:203]
  ds_read_b64_tr_b16 a[132:133], v2 offset:7168
  v_mfma_f32_16x16x32_bf16 v[200:203], a[148:151], a[56:59], v[200:203]
  ds_read_b64_tr_b16 a[176:177], v31 offset:0
  v_mfma_f32_16x16x32_bf16 v[204:207], a[148:151], a[60:63], v[204:207]
  buffer_load_dwordx4 v9, s[16:19], s56 offen offset:2048 lds
  v_mfma_f32_16x16x32_bf16 v[204:207], a[144:147], a[44:47], v[204:207]
  ds_read_b64_tr_b16 a[134:135], v2 offset:10752
  v_mfma_f32_16x16x32_bf16 v[220:223], a[152:155], a[44:47], v[220:223]
  ds_read_b64_tr_b16 a[136:137], v2 offset:32
  v_mfma_f32_16x16x32_bf16 v[220:223], a[156:159], a[60:63], v[220:223]
  ds_read_b64_tr_b16 a[178:179], v31 offset:3584
  v_mfma_f32_16x16x32_bf16 v[216:219], a[156:159], a[56:59], v[216:219]
  ds_read_b64_tr_b16 a[138:139], v2 offset:3616
  v_mfma_f32_16x16x32_bf16 v[216:219], a[152:155], a[40:43], v[216:219]
  buffer_load_dwordx4 a[104:107], v0, s[36:39], s57 offen offset:2048 sc1
  v_mfma_f32_16x16x32_bf16 v[212:215], a[152:155], a[36:39], v[212:215]
  ds_read_b64_tr_b16 a[140:141], v2 offset:7200
  v_mfma_f32_16x16x32_bf16 v[212:215], a[156:159], a[52:55], v[212:215]
  ds_read_b64_tr_b16 a[180:181], v31 offset:7168
  v_mfma_f32_16x16x32_bf16 v[208:211], a[156:159], a[48:51], v[208:211]
  ds_read_b64_tr_b16 a[142:143], v2 offset:10784
  v_mfma_f32_16x16x32_bf16 v[208:211], a[152:155], a[32:35], v[208:211]
  s_waitcnt lgkmcnt(11)
  ds_read_b64_tr_b16 a[182:183], v31 offset:10752
  v_mfma_f32_16x16x32_bf16 v[224:227], a[160:163], a[32:35], v[224:227]
  ds_read_b64_tr_b16 a[144:145], v2 offset:64
  v_mfma_f32_16x16x32_bf16 v[224:227], a[164:167], a[48:51], v[224:227]
  ds_read_b64_tr_b16 a[184:185], v31 offset:32
  v_mfma_f32_16x16x32_bf16 v[228:231], a[164:167], a[52:55], v[228:231]
  ds_read_b64_tr_b16 a[146:147], v2 offset:3648
  v_mfma_f32_16x16x32_bf16 v[228:231], a[160:163], a[36:39], v[228:231]
  ds_read_b64_tr_b16 a[186:187], v31 offset:3616
  v_mfma_f32_16x16x32_bf16 v[232:235], a[160:163], a[40:43], v[232:235]
  ds_read_b64_tr_b16 a[148:149], v2 offset:7232
  v_mfma_f32_16x16x32_bf16 v[232:235], a[164:167], a[56:59], v[232:235]
  buffer_load_dwordx4 a[108:111], v0, s[36:39], s57 offen offset:3072 sc1
  v_mfma_f32_16x16x32_bf16 v[236:239], a[164:167], a[60:63], v[236:239]
  ds_read_b64_tr_b16 a[150:151], v2 offset:10816
  v_mfma_f32_16x16x32_bf16 v[236:239], a[160:163], a[44:47], v[236:239]
  ds_read_b64_tr_b16 a[188:189], v31 offset:7200
  v_mfma_f32_16x16x32_bf16 v[252:255], a[168:171], a[44:47], v[252:255]
  ds_read_b64_tr_b16 a[152:153], v2 offset:96
  v_mfma_f32_16x16x32_bf16 v[252:255], a[172:175], a[60:63], v[252:255]
  s_bfe_u32 s56, s83, 0x40000
  s_mul_i32 s56, s56, 458752
  s_add_u32 m0, s84, 0
  v_mfma_f32_16x16x32_bf16 v[248:251], a[172:175], a[56:59], v[248:251]
  ds_read_b64_tr_b16 a[154:155], v2 offset:3680
  v_mfma_f32_16x16x32_bf16 v[248:251], a[168:171], a[40:43], v[248:251]
  ds_read_b64_tr_b16 a[190:191], v31 offset:10784
  v_mfma_f32_16x16x32_bf16 v[244:247], a[168:171], a[36:39], v[244:247]
  ds_read_b64_tr_b16 a[156:157], v2 offset:7264
  v_mfma_f32_16x16x32_bf16 v[244:247], a[172:175], a[52:55], v[244:247]
  buffer_load_dwordx4 v3, s[16:19], s56 offen offset:0 lds
  v_mfma_f32_16x16x32_bf16 v[240:243], a[172:175], a[48:51], v[240:243]
  ds_read_b64_tr_b16 a[158:159], v2 offset:10848
  v_mfma_f32_16x16x32_bf16 v[240:243], a[168:171], a[32:35], v[240:243]
  s_waitcnt vmcnt(8) lgkmcnt(13)
  ds_read_b64_tr_b16 a[192:193], v31 offset:64
  v_mfma_f32_16x16x32_bf16 v[32:35], a[128:131], a[64:67], v[32:35]
  s_add_u32 s57, s57, 4096
  ds_read_b64_tr_b16 a[194:195], v31 offset:3648
  v_mfma_f32_16x16x32_bf16 v[32:35], a[132:135], a[80:83], v[32:35]
  ds_read_b64_tr_b16 a[196:197], v31 offset:7232
  v_mfma_f32_16x16x32_bf16 v[36:39], a[132:135], a[84:87], v[36:39]
  ds_read_b64_tr_b16 a[198:199], v31 offset:10816
  v_mfma_f32_16x16x32_bf16 v[36:39], a[128:131], a[68:71], v[36:39]
  ds_read_b64_tr_b16 a[200:201], v31 offset:96
  v_mfma_f32_16x16x32_bf16 v[40:43], a[128:131], a[72:75], v[40:43]
  buffer_load_dwordx4 a[112:115], v0, s[36:39], s57 offen offset:0 sc1
  v_mfma_f32_16x16x32_bf16 v[40:43], a[132:135], a[88:91], v[40:43]
  ds_read_b64_tr_b16 a[202:203], v31 offset:3680
  v_mfma_f32_16x16x32_bf16 v[44:47], a[132:135], a[92:95], v[44:47]
  ds_read_b64_tr_b16 a[204:205], v31 offset:7264
  v_mfma_f32_16x16x32_bf16 v[44:47], a[128:131], a[76:79], v[44:47]
  ds_read_b64_tr_b16 a[206:207], v31 offset:10848
  v_mfma_f32_16x16x32_bf16 v[60:63], a[136:139], a[76:79], v[60:63]
  ds_read_b64_tr_b16 a[160:161], v2 offset:128
  v_mfma_f32_16x16x32_bf16 v[60:63], a[140:143], a[92:95], v[60:63]
  v_mfma_f32_16x16x32_bf16 v[56:59], a[140:143], a[88:91], v[56:59]
  ds_read_b64_tr_b16 a[162:163], v2 offset:3712
  v_mfma_f32_16x16x32_bf16 v[56:59], a[136:139], a[72:75], v[56:59]
  buffer_load_dwordx4 v4, s[16:19], s56 offen offset:1024 lds
  v_mfma_f32_16x16x32_bf16 v[52:55], a[136:139], a[68:71], v[52:55]
  ds_read_b64_tr_b16 a[164:165], v2 offset:7296
  v_mfma_f32_16x16x32_bf16 v[52:55], a[140:143], a[84:87], v[52:55]
  v_mfma_f32_16x16x32_bf16 v[48:51], a[140:143], a[80:83], v[48:51]
  ds_read_b64_tr_b16 a[166:167], v2 offset:10880
  v_mfma_f32_16x16x32_bf16 v[48:51], a[136:139], a[64:67], v[48:51]
  s_waitcnt lgkmcnt(12)
  v_mfma_f32_16x16x32_bf16 v[64:67], a[144:147], a[64:67], v[64:67]
  ds_read_b64_tr_b16 a[168:169], v2 offset:160
  v_mfma_f32_16x16x32_bf16 v[64:67], a[148:151], a[80:83], v[64:67]
  v_mfma_f32_16x16x32_bf16 v[68:71], a[148:151], a[84:87], v[68:71]
  ds_read_b64_tr_b16 a[170:171], v2 offset:3744
  v_mfma_f32_16x16x32_bf16 v[68:71], a[144:147], a[68:71], v[68:71]
  buffer_load_dwordx4 a[116:119], v0, s[36:39], s57 offen offset:1024 sc1
  v_mfma_f32_16x16x32_bf16 v[72:75], a[144:147], a[72:75], v[72:75]
  ds_read_b64_tr_b16 a[172:173], v2 offset:7328
  v_mfma_f32_16x16x32_bf16 v[72:75], a[148:151], a[88:91], v[72:75]
  v_mfma_f32_16x16x32_bf16 v[76:79], a[148:151], a[92:95], v[76:79]
  ds_read_b64_tr_b16 a[174:175], v2 offset:10912
  v_mfma_f32_16x16x32_bf16 v[76:79], a[144:147], a[76:79], v[76:79]
  v_mfma_f32_16x16x32_bf16 v[92:95], a[152:155], a[76:79], v[92:95]
  ds_read_b64_tr_b16 a[128:129], v2 offset:192
  v_mfma_f32_16x16x32_bf16 v[92:95], a[156:159], a[92:95], v[92:95]
  v_mfma_f32_16x16x32_bf16 v[88:91], a[156:159], a[88:91], v[88:91]
  buffer_load_dwordx4 v5, s[16:19], s56 offen offset:2048 lds
  v_mfma_f32_16x16x32_bf16 v[88:91], a[152:155], a[72:75], v[88:91]
  ds_read_b64_tr_b16 a[130:131], v2 offset:3776
  v_mfma_f32_16x16x32_bf16 v[84:87], a[152:155], a[68:71], v[84:87]
  ds_read_b64_tr_b16 a[132:133], v2 offset:7360
  v_mfma_f32_16x16x32_bf16 v[84:87], a[156:159], a[84:87], v[84:87]
  v_mfma_f32_16x16x32_bf16 v[80:83], a[156:159], a[80:83], v[80:83]
  ds_read_b64_tr_b16 a[134:135], v2 offset:10944
  v_mfma_f32_16x16x32_bf16 v[80:83], a[152:155], a[64:67], v[80:83]
  s_waitcnt vmcnt(20) lgkmcnt(12)
  v_mfma_f32_16x16x32_bf16 a[216:219], a[176:179], a[208:211], 0
  ds_read_b64_tr_b16 a[136:137], v2 offset:14336
  v_mfma_f32_16x16x32_bf16 a[216:219], a[180:183], a[212:215], a[216:219]
  v_mfma_f32_16x16x32_bf16 a[220:223], a[184:187], a[208:211], 0
  buffer_load_dwordx4 a[120:123], v0, s[36:39], s57 offen offset:2048 sc1
  v_mfma_f32_16x16x32_bf16 a[220:223], a[188:191], a[212:215], a[220:223]
  ds_read_b64_tr_b16 a[138:139], v2 offset:17920
  v_mfma_f32_16x16x32_bf16 a[224:227], a[192:195], a[208:211], 0
  ds_read_b64_tr_b16 a[140:141], v2 offset:21504
  v_mfma_f32_16x16x32_bf16 a[224:227], a[196:199], a[212:215], a[224:227]
  v_mfma_f32_16x16x32_bf16 a[228:231], a[200:203], a[208:211], 0
  ds_read_b64_tr_b16 a[142:143], v2 offset:25088
  v_mfma_f32_16x16x32_bf16 a[228:231], a[204:207], a[212:215], a[228:231]
  s_waitcnt lgkmcnt(8)
  v_mfma_f32_16x16x32_bf16 v[96:99], a[160:163], a[64:67], v[96:99]
  ds_read_b64_tr_b16 a[144:145], v2 offset:14368
  v_mfma_f32_16x16x32_bf16 v[96:99], a[164:167], a[80:83], v[96:99]
  buffer_load_dwordx4 v6, s[16:19], s56 offen offset:3072 lds
  v_mfma_f32_16x16x32_bf16 v[100:103], a[164:167], a[84:87], v[100:103]
  s_lshl2_add_u32 s76, s58, s44
  ds_read_b64_tr_b16 a[146:147], v2 offset:17952
  s_lshl_b32 s76, s76, 13
  v_mfma_f32_16x16x32_bf16 v[100:103], a[160:163], a[68:71], v[100:103]
  s_add_u32 s76, s76, 262144
  s_add_u32 s77, s76, 4096
  v_mfma_f32_16x16x32_bf16 v[104:107], a[160:163], a[72:75], v[104:107]
  ds_read_b64_tr_b16 a[148:149], v2 offset:21536
  v_mfma_f32_16x16x32_bf16 v[104:107], a[164:167], a[88:91], v[104:107]
  v_mfma_f32_16x16x32_bf16 v[108:111], a[164:167], a[92:95], v[108:111]
  ds_read_b64_tr_b16 a[150:151], v2 offset:25120
  v_mfma_f32_16x16x32_bf16 v[108:111], a[160:163], a[76:79], v[108:111]
  buffer_load_dwordx4 a[176:179], v0, s[36:39], s76 offen offset:0 sc1
  v_mfma_f32_16x16x32_bf16 v[124:127], a[168:171], a[76:79], v[124:127]
  ds_read_b64_tr_b16 a[152:153], v2 offset:14400
  v_mfma_f32_16x16x32_bf16 v[124:127], a[172:175], a[92:95], v[124:127]
  v_mfma_f32_16x16x32_bf16 v[120:123], a[172:175], a[88:91], v[120:123]
  ds_read_b64_tr_b16 a[154:155], v2 offset:17984
  v_mfma_f32_16x16x32_bf16 v[120:123], a[168:171], a[72:75], v[120:123]
  v_mfma_f32_16x16x32_bf16 v[116:119], a[168:171], a[68:71], v[116:119]
  buffer_load_dwordx4 a[124:127], v0, s[36:39], s57 offen offset:3072 sc1
  s_add_u32 m0, s84, 4096
  v_mfma_f32_16x16x32_bf16 v[116:119], a[172:175], a[84:87], v[116:119]
  ds_read_b64_tr_b16 a[156:157], v2 offset:21568
  v_mfma_f32_16x16x32_bf16 v[112:115], a[172:175], a[80:83], v[112:115]
  ds_read_b64_tr_b16 a[158:159], v2 offset:25152
  v_mfma_f32_16x16x32_bf16 v[112:115], a[168:171], a[64:67], v[112:115]
  s_waitcnt lgkmcnt(8)
  v_mfma_f32_16x16x32_bf16 v[128:131], a[128:131], a[64:67], v[128:131]
  ds_read_b64_tr_b16 a[160:161], v2 offset:14432
  v_mfma_f32_16x16x32_bf16 v[128:131], a[132:135], a[80:83], v[128:131]
  buffer_load_dwordx4 v7, s[16:19], s56 offen offset:0 lds
  s_bfe_u32 s57, s83, 0x40000
  v_mfma_f32_16x16x32_bf16 v[132:135], a[132:135], a[84:87], v[132:135]
  s_lshl_b32 s57, s57, 13
  s_add_u32 s57, s57, s85
  ds_read_b64_tr_b16 a[162:163], v2 offset:18016
  v_mfma_f32_16x16x32_bf16 v[132:135], a[128:131], a[68:71], v[132:135]
  v_mfma_f32_16x16x32_bf16 v[136:139], a[128:131], a[72:75], v[136:139]
  ds_read_b64_tr_b16 a[164:165], v2 offset:21600
  v_mfma_f32_16x16x32_bf16 v[136:139], a[132:135], a[88:91], v[136:139]
  v_mfma_f32_16x16x32_bf16 v[140:143], a[132:135], a[92:95], v[140:143]
  buffer_load_dwordx4 a[0:3], v0, s[36:39], s57 offen offset:0 sc1
  v_mfma_f32_16x16x32_bf16 v[140:143], a[128:131], a[76:79], v[140:143]
Hb2:
  s_cbranch_execz Hb2_1
  ds_read_b64_tr_b16 a[166:167], v2 offset:25184
  v_mfma_f32_16x16x32_bf16 v[156:159], a[136:139], a[76:79], v[156:159]
  ds_read_b64_tr_b16 a[168:169], v2 offset:14464
  v_mfma_f32_16x16x32_bf16 v[156:159], a[140:143], a[92:95], v[156:159]
  v_mfma_f32_16x16x32_bf16 v[152:155], a[140:143], a[88:91], v[152:155]
  ds_read_b64_tr_b16 a[170:171], v2 offset:18048
  v_mfma_f32_16x16x32_bf16 v[152:155], a[136:139], a[72:75], v[152:155]
  buffer_load_dwordx4 a[180:183], v0, s[36:39], s76 offen offset:1024 sc1
  v_mfma_f32_16x16x32_bf16 v[148:151], a[136:139], a[68:71], v[148:151]
  ds_read_b64_tr_b16 a[172:173], v2 offset:21632
  v_mfma_f32_16x16x32_bf16 v[148:151], a[140:143], a[84:87], v[148:151]
  v_mfma_f32_16x16x32_bf16 v[144:147], a[140:143], a[80:83], v[144:147]
  ds_read_b64_tr_b16 a[174:175], v2 offset:25216
  v_mfma_f32_16x16x32_bf16 v[144:147], a[136:139], a[64:67], v[144:147]
  s_waitcnt lgkmcnt(8)
  v_mfma_f32_16x16x32_bf16 v[160:163], a[144:147], a[64:67], v[160:163]
  buffer_load_dwordx4 v8, s[16:19], s56 offen offset:1024 lds
  v_mfma_f32_16x16x32_bf16 v[160:163], a[148:151], a[80:83], v[160:163]
  ds_read_b64_tr_b16 a[128:129], v2 offset:14496
  v_mfma_f32_16x16x32_bf16 v[164:167], a[148:151], a[84:87], v[164:167]
  ds_read_b64_tr_b16 a[130:131], v2 offset:18080
  v_mfma_f32_16x16x32_bf16 v[164:167], a[144:147], a[68:71], v[164:167]
  v_mfma_f32_16x16x32_bf16 v[168:171], a[144:147], a[72:75], v[168:171]
  ds_read_b64_tr_b16 a[132:133], v2 offset:21664
  v_mfma_f32_16x16x32_bf16 v[168:171], a[148:151], a[88:91], v[168:171]
  buffer_load_dwordx4 a[4:7], v0, s[36:39], s57 offen offset:1024 sc1
  v_mfma_f32_16x16x32_bf16 v[172:175], a[148:151], a[92:95], v[172:175]
  ds_read_b64_tr_b16 a[134:135], v2 offset:25248
  v_mfma_f32_16x16x32_bf16 v[172:175], a[144:147], a[76:79], v[172:175]
  s_waitcnt vmcnt(16)
  s_barrier
  v_mfma_f32_16x16x32_bf16 v[188:191], a[152:155], a[76:79], v[188:191]
  ds_read_b64_tr_b16 a[136:137], v2 offset:14528
  v_mfma_f32_16x16x32_bf16 v[188:191], a[156:159], a[92:95], v[188:191]
  v_mfma_f32_16x16x32_bf16 v[184:187], a[156:159], a[88:91], v[184:187]
  ds_read_b64_tr_b16 a[138:139], v2 offset:18112
  v_mfma_f32_16x16x32_bf16 v[184:187], a[152:155], a[72:75], v[184:187]
  buffer_load_dwordx4 a[184:187], v0, s[36:39], s76 offen offset:2048 sc1
  v_mfma_f32_16x16x32_bf16 v[180:183], a[152:155], a[68:71], v[180:183]
  ds_read_b64_tr_b16 a[140:141], v2 offset:21696
  v_mfma_f32_16x16x32_bf16 v[180:183], a[156:159], a[84:87], v[180:183]
  v_mfma_f32_16x16x32_bf16 v[176:179], a[156:159], a[80:83], v[176:179]
  ds_read_b64_tr_b16 a[142:143], v2 offset:25280
  v_mfma_f32_16x16x32_bf16 v[176:179], a[152:155], a[64:67], v[176:179]
  s_waitcnt lgkmcnt(8)
  v_mfma_f32_16x16x32_bf16 v[192:195], a[160:163], a[64:67], v[192:195]
  buffer_load_dwordx4 v9, s[16:19], s56 offen offset:2048 lds
  v_mfma_f32_16x16x32_bf16 v[192:195], a[164:167], a[80:83], v[192:195]
  ds_read_b64_tr_b16 a[144:145], v2 offset:28672
  v_mfma_f32_16x16x32_bf16 v[196:199], a[164:167], a[84:87], v[196:199]
  ds_read_b64_tr_b16 a[146:147], v2 offset:32256
  v_mfma_f32_16x16x32_bf16 v[196:199], a[160:163], a[68:71], v[196:199]
  v_mfma_f32_16x16x32_bf16 v[200:203], a[160:163], a[72:75], v[200:203]
  ds_read_b64_tr_b16 a[148:149], v2 offset:35840
  v_mfma_f32_16x16x32_bf16 v[200:203], a[164:167], a[88:91], v[200:203]
  buffer_load_dwordx4 a[8:11], v0, s[36:39], s57 offen offset:2048 sc1
  v_mfma_f32_16x16x32_bf16 v[204:207], a[164:167], a[92:95], v[204:207]
  ds_read_b64_tr_b16 a[150:151], v2 offset:39424
  v_mfma_f32_16x16x32_bf16 v[204:207], a[160:163], a[76:79], v[204:207]
  v_mfma_f32_16x16x32_bf16 v[220:223], a[168:171], a[76:79], v[220:223]
  ds_read_b64_tr_b16 a[152:153], v2 offset:28704
  v_mfma_f32_16x16x32_bf16 v[220:223], a[172:175], a[92:95], v[220:223]
  buffer_load_dwordx4 a[188:191], v0, s[36:39], s76 offen offset:3072 sc1
  v_mfma_f32_16x16x32_bf16 v[216:219], a[172:175], a[88:91], v[216:219]
  ds_read_b64_tr_b16 a[154:155], v2 offset:32288
  v_mfma_f32_16x16x32_bf16 v[216:219], a[168:171], a[72:75], v[216:219]
  v_mfma_f32_16x16x32_bf16 v[212:215], a[168:171], a[68:71], v[212:215]
  ds_read_b64_tr_b16 a[156:157], v2 offset:35872
  v_mfma_f32_16x16x32_bf16 v[212:215], a[172:175], a[84:87], v[212:215]
  v_mfma_f32_16x16x32_bf16 v[208:211], a[172:175], a[80:83], v[208:211]
  buffer_load_dwordx4 a[12:15], v0, s[36:39], s57 offen offset:3072 sc1
  v_mfma_f32_16x16x32_bf16 v[208:211], a[168:171], a[64:67], v[208:211]
  s_waitcnt lgkmcnt(7)
  ds_read_b64_tr_b16 a[158:159], v2 offset:39456
  v_mfma_f32_16x16x32_bf16 v[224:227], a[128:131], a[64:67], v[224:227]
  ds_read_b64_tr_b16 a[160:161], v2 offset:28736
  v_mfma_f32_16x16x32_bf16 v[224:227], a[132:135], a[80:83], v[224:227]
  s_bfe_u32 s56, s83, 0x40004
  s_mul_i32 s56, s56, 458752
  s_add_u32 m0, s84, 28672
  v_mfma_f32_16x16x32_bf16 v[228:231], a[132:135], a[84:87], v[228:231]
  buffer_load_dwordx4 a[192:195], v0, s[36:39], s77 offen offset:0 sc1
  v_mfma_f32_16x16x32_bf16 v[228:231], a[128:131], a[68:71], v[228:231]
  ds_read_b64_tr_b16 a[162:163], v2 offset:32320
  v_mfma_f32_16x16x32_bf16 v[232:235], a[128:131], a[72:75], v[232:235]
  ds_read_b64_tr_b16 a[164:165], v2 offset:35904
  v_mfma_f32_16x16x32_bf16 v[232:235], a[132:135], a[88:91], v[232:235]
  v_mfma_f32_16x16x32_bf16 v[236:239], a[132:135], a[92:95], v[236:239]
  ds_read_b64_tr_b16 a[166:167], v2 offset:39488
  v_mfma_f32_16x16x32_bf16 v[236:239], a[128:131], a[76:79], v[236:239]
  buffer_load_dwordx4 v3, s[16:19], s56 offen offset:0 lds
  v_mfma_f32_16x16x32_bf16 v[252:255], a[136:139], a[76:79], v[252:255]
  ds_read_b64_tr_b16 a[168:169], v2 offset:28768
  v_mfma_f32_16x16x32_bf16 v[252:255], a[140:143], a[92:95], v[252:255]
  v_mfma_f32_16x16x32_bf16 v[248:251], a[140:143], a[88:91], v[248:251]
  ds_read_b64_tr_b16 a[170:171], v2 offset:32352
  v_mfma_f32_16x16x32_bf16 v[248:251], a[136:139], a[72:75], v[248:251]
  buffer_load_dwordx4 a[196:199], v0, s[36:39], s77 offen offset:1024 sc1
  v_mfma_f32_16x16x32_bf16 v[244:247], a[136:139], a[68:71], v[244:247]
  ds_read_b64_tr_b16 a[172:173], v2 offset:35936
  v_mfma_f32_16x16x32_bf16 v[244:247], a[140:143], a[84:87], v[244:247]
  v_mfma_f32_16x16x32_bf16 v[240:243], a[140:143], a[80:83], v[240:243]
  ds_read_b64_tr_b16 a[174:175], v2 offset:39520
  v_mfma_f32_16x16x32_bf16 v[240:243], a[136:139], a[64:67], v[240:243]
  s_waitcnt vmcnt(13) lgkmcnt(8)
  v_mfma_f32_16x16x32_bf16 v[32:35], a[144:147], a[96:99], v[32:35]
  s_add_u32 s57, s57, 4096
  ds_read_b64_tr_b16 a[128:129], v2 offset:28800
  v_mfma_f32_16x16x32_bf16 v[32:35], a[148:151], a[112:115], v[32:35]
  buffer_load_dwordx4 a[200:203], v0, s[36:39], s77 offen offset:2048 sc1
  v_mfma_f32_16x16x32_bf16 v[36:39], a[148:151], a[116:119], v[36:39]
  ds_read_b64_tr_b16 a[130:131], v2 offset:32384
  v_mfma_f32_16x16x32_bf16 v[36:39], a[144:147], a[100:103], v[36:39]
  v_mfma_f32_16x16x32_bf16 v[40:43], a[144:147], a[104:107], v[40:43]
  ds_read_b64_tr_b16 a[132:133], v2 offset:35968
  v_mfma_f32_16x16x32_bf16 v[40:43], a[148:151], a[120:123], v[40:43]
  v_mfma_f32_16x16x32_bf16 v[44:47], a[148:151], a[124:127], v[44:47]
  buffer_load_dwordx4 a[16:19], v0, s[36:39], s57 offen offset:0 sc1
  v_mfma_f32_16x16x32_bf16 v[44:47], a[144:147], a[108:111], v[44:47]
  ds_read_b64_tr_b16 a[134:135], v2 offset:39552
  v_mfma_f32_16x16x32_bf16 v[60:63], a[152:155], a[108:111], v[60:63]
  ds_read_b64_tr_b16 a[136:137], v2 offset:28832
  v_mfma_f32_16x16x32_bf16 v[60:63], a[156:159], a[124:127], v[60:63]
  v_mfma_f32_16x16x32_bf16 v[56:59], a[156:159], a[120:123], v[56:59]
  ds_read_b64_tr_b16 a[138:139], v2 offset:32416
  v_mfma_f32_16x16x32_bf16 v[56:59], a[152:155], a[104:107], v[56:59]
  buffer_load_dwordx4 v4, s[16:19], s56 offen offset:1024 lds
  v_mfma_f32_16x16x32_bf16 v[52:55], a[152:155], a[100:103], v[52:55]
  ds_read_b64_tr_b16 a[140:141], v2 offset:36000
  v_mfma_f32_16x16x32_bf16 v[52:55], a[156:159], a[116:119], v[52:55]
  buffer_load_dwordx4 a[204:207], v0, s[36:39], s77 offen offset:3072 sc1
  v_mfma_f32_16x16x32_bf16 v[48:51], a[156:159], a[112:115], v[48:51]
  ds_read_b64_tr_b16 a[142:143], v2 offset:39584
  v_mfma_f32_16x16x32_bf16 v[48:51], a[152:155], a[96:99], v[48:51]
  s_waitcnt lgkmcnt(8)
  v_mfma_f32_16x16x32_bf16 v[64:67], a[160:163], a[96:99], v[64:67]
  ds_read_b64_tr_b16 a[144:145], v2 offset:28864
  v_mfma_f32_16x16x32_bf16 v[64:67], a[164:167], a[112:115], v[64:67]
  v_mfma_f32_16x16x32_bf16 v[68:71], a[164:167], a[116:119], v[68:71]
  ds_read_b64_tr_b16 a[146:147], v2 offset:32448
  v_mfma_f32_16x16x32_bf16 v[68:71], a[160:163], a[100:103], v[68:71]
  buffer_load_dwordx4 a[20:23], v0, s[36:39], s57 offen offset:1024 sc1
  v_mfma_f32_16x16x32_bf16 v[72:75], a[160:163], a[104:107], v[72:75]
  ds_read_b64_tr_b16 a[148:149], v2 offset:36032
  v_mfma_f32_16x16x32_bf16 v[72:75], a[164:167], a[120:123], v[72:75]
  v_mfma_f32_16x16x32_bf16 v[76:79], a[164:167], a[124:127], v[76:79]
  ds_read_b64_tr_b16 a[150:151], v2 offset:39616
  v_mfma_f32_16x16x32_bf16 v[76:79], a[160:163], a[108:111], v[76:79]
  v_mfma_f32_16x16x32_bf16 v[92:95], a[168:171], a[108:111], v[92:95]
  ds_read_b64_tr_b16 a[152:153], v2 offset:43008
  v_mfma_f32_16x16x32_bf16 v[92:95], a[172:175], a[124:127], v[92:95]
  v_mfma_f32_16x16x32_bf16 v[88:91], a[172:175], a[120:123], v[88:91]
  buffer_load_dwordx4 v5, s[16:19], s56 offen offset:2048 lds
  v_mfma_f32_16x16x32_bf16 v[88:91], a[168:171], a[104:107], v[88:91]
  ds_read_b64_tr_b16 a[154:155], v2 offset:46592
  v_mfma_f32_16x16x32_bf16 v[84:87], a[168:171], a[100:103], v[84:87]
  ds_read_b64_tr_b16 a[156:157], v2 offset:50176
  v_mfma_f32_16x16x32_bf16 v[84:87], a[172:175], a[116:119], v[84:87]
  v_mfma_f32_16x16x32_bf16 v[80:83], a[172:175], a[112:115], v[80:83]
  ds_read_b64_tr_b16 a[158:159], v2 offset:53760
  v_mfma_f32_16x16x32_bf16 v[80:83], a[168:171], a[96:99], v[80:83]
  s_waitcnt lgkmcnt(8)
  v_mfma_f32_16x16x32_bf16 v[96:99], a[128:131], a[96:99], v[96:99]
  ds_read_b64_tr_b16 a[160:161], v2 offset:43040
  v_mfma_f32_16x16x32_bf16 v[96:99], a[132:135], a[112:115], v[96:99]
  v_mfma_f32_16x16x32_bf16 v[100:103], a[132:135], a[116:119], v[100:103]
  buffer_load_dwordx4 a[24:27], v0, s[36:39], s57 offen offset:2048 sc1
  v_mfma_f32_16x16x32_bf16 v[100:103], a[128:131], a[100:103], v[100:103]
  ds_read_b64_tr_b16 a[162:163], v2 offset:46624
  v_mfma_f32_16x16x32_bf16 v[104:107], a[128:131], a[104:107], v[104:107]
  ds_read_b64_tr_b16 a[164:165], v2 offset:50208
  v_mfma_f32_16x16x32_bf16 v[104:107], a[132:135], a[120:123], v[104:107]
  v_mfma_f32_16x16x32_bf16 v[108:111], a[132:135], a[124:127], v[108:111]
  ds_read_b64_tr_b16 a[166:167], v2 offset:53792
  v_mfma_f32_16x16x32_bf16 v[108:111], a[128:131], a[108:111], v[108:111]
  v_mfma_f32_16x16x32_bf16 v[124:127], a[136:139], a[108:111], v[124:127]
  ds_read_b64_tr_b16 a[168:169], v2 offset:43072
  v_mfma_f32_16x16x32_bf16 v[124:127], a[140:143], a[124:127], v[124:127]
  buffer_load_dwordx4 v6, s[16:19], s56 offen offset:3072 lds
  v_mfma_f32_16x16x32_bf16 v[120:123], a[140:143], a[120:123], v[120:123]
  ds_read_b64_tr_b16 a[170:171], v2 offset:46656
  v_mfma_f32_16x16x32_bf16 v[120:123], a[136:139], a[104:107], v[120:123]
  v_mfma_f32_16x16x32_bf16 v[116:119], a[136:139], a[100:103], v[116:119]
  ds_read_b64_tr_b16 a[172:173], v2 offset:50240
  v_mfma_f32_16x16x32_bf16 v[116:119], a[140:143], a[116:119], v[116:119]
  v_mfma_f32_16x16x32_bf16 v[112:115], a[140:143], a[112:115], v[112:115]
  ds_read_b64_tr_b16 a[174:175], v2 offset:53824
  v_mfma_f32_16x16x32_bf16 v[112:115], a[136:139], a[96:99], v[112:115]
  s_waitcnt lgkmcnt(8)
  v_mfma_f32_16x16x32_bf16 v[128:131], a[144:147], a[96:99], v[128:131]
  ds_read_b64_tr_b16 a[128:129], v2 offset:43104
  v_mfma_f32_16x16x32_bf16 v[128:131], a[148:151], a[112:115], v[128:131]
  buffer_load_dwordx4 a[28:31], v0, s[36:39], s57 offen offset:3072 sc1
  v_mfma_f32_16x16x32_bf16 v[132:135], a[148:151], a[116:119], v[132:135]
  ds_read_b64_tr_b16 a[130:131], v2 offset:46688
  v_mfma_f32_16x16x32_bf16 v[132:135], a[144:147], a[100:103], v[132:135]
  v_mfma_f32_16x16x32_bf16 v[136:139], a[144:147], a[104:107], v[136:139]
  s_add_u32 m0, s84, 32768
  ds_read_b64_tr_b16 a[132:133], v2 offset:50272
  v_mfma_f32_16x16x32_bf16 v[136:139], a[148:151], a[120:123], v[136:139]
  v_mfma_f32_16x16x32_bf16 v[140:143], a[148:151], a[124:127], v[140:143]
  ds_read_b64_tr_b16 a[134:135], v2 offset:53856
  v_mfma_f32_16x16x32_bf16 v[140:143], a[144:147], a[108:111], v[140:143]
  v_mfma_f32_16x16x32_bf16 v[156:159], a[152:155], a[108:111], v[156:159]
  buffer_load_dwordx4 v7, s[16:19], s56 offen offset:0 lds
  s_bfe_u32 s57, s83, 0x40004
  v_mfma_f32_16x16x32_bf16 v[156:159], a[156:159], a[124:127], v[156:159]
  s_lshl_b32 s57, s57, 13
  s_add_u32 s57, s57, s85
  ds_read_b64_tr_b16 a[136:137], v2 offset:43136
  v_mfma_f32_16x16x32_bf16 v[152:155], a[156:159], a[120:123], v[152:155]
  ds_read_b64_tr_b16 a[138:139], v2 offset:46720
  v_mfma_f32_16x16x32_bf16 v[152:155], a[152:155], a[104:107], v[152:155]
  v_mfma_f32_16x16x32_bf16 v[148:151], a[152:155], a[100:103], v[148:151]
  ds_read_b64_tr_b16 a[140:141], v2 offset:50304
  v_mfma_f32_16x16x32_bf16 v[148:151], a[156:159], a[116:119], v[148:151]
  buffer_load_dwordx4 a[32:35], v0, s[36:39], s57 offen offset:0 sc1
  v_mfma_f32_16x16x32_bf16 v[144:147], a[156:159], a[112:115], v[144:147]
  ds_read_b64_tr_b16 a[142:143], v2 offset:53888
  v_mfma_f32_16x16x32_bf16 v[144:147], a[152:155], a[96:99], v[144:147]
  s_waitcnt lgkmcnt(8)
  v_mfma_f32_16x16x32_bf16 v[160:163], a[160:163], a[96:99], v[160:163]
  s_waitcnt vmcnt(7)
  ds_read_b64_tr_b16 a[144:145], v2 offset:43168
  v_accvgpr_read_b32 v22, a176
  v_mfma_f32_16x16x32_bf16 v[160:163], a[164:167], a[112:115], v[160:163]
  v_accvgpr_read_b32 v23, a177
  v_accvgpr_read_b32 v24, a178
  v_mfma_f32_16x16x32_bf16 v[164:167], a[164:167], a[116:119], v[164:167]
  ds_read_b64_tr_b16 a[146:147], v2 offset:46752
  v_accvgpr_read_b32 v25, a179
  v_mfma_f32_16x16x32_bf16 v[164:167], a[160:163], a[100:103], v[164:167]
  v_accvgpr_read_b32 v26, a180
  v_accvgpr_read_b32 v27, a181
  v_mfma_f32_16x16x32_bf16 v[168:171], a[160:163], a[104:107], v[168:171]
  ds_read_b64_tr_b16 a[148:149], v2 offset:50336
  v_accvgpr_read_b32 v28, a182
  v_mfma_f32_16x16x32_bf16 v[168:171], a[164:167], a[120:123], v[168:171]
  v_accvgpr_read_b32 v29, a183
  v_add_f32 v22, v22, v26
  v_mfma_f32_16x16x32_bf16 v[172:175], a[164:167], a[124:127], v[172:175]
  ds_read_b64_tr_b16 a[150:151], v2 offset:53920
  v_add_f32 v23, v23, v27
  v_mfma_f32_16x16x32_bf16 v[172:175], a[160:163], a[108:111], v[172:175]
  s_waitcnt vmcnt(17)
  s_barrier
  buffer_load_dwordx4 v8, s[16:19], s56 offen offset:1024 lds
  v_add_f32 v24, v24, v28
  v_mfma_f32_16x16x32_bf16 v[188:191], a[168:171], a[108:111], v[188:191]
  ds_read_b64_tr_b16 a[152:153], v2 offset:43200
  v_add_f32 v25, v25, v29
  v_mfma_f32_16x16x32_bf16 v[188:191], a[172:175], a[124:127], v[188:191]
  v_accvgpr_read_b32 v26, a184
  v_accvgpr_read_b32 v27, a185
  v_mfma_f32_16x16x32_bf16 v[184:187], a[172:175], a[120:123], v[184:187]
  ds_read_b64_tr_b16 a[154:155], v2 offset:46784
  v_accvgpr_read_b32 v28, a186
  v_mfma_f32_16x16x32_bf16 v[184:187], a[168:171], a[104:107], v[184:187]
  v_accvgpr_read_b32 v29, a187
  v_add_f32 v22, v22, v26
  v_mfma_f32_16x16x32_bf16 v[180:183], a[168:171], a[100:103], v[180:183]
  buffer_load_dwordx4 a[36:39], v0, s[36:39], s57 offen offset:1024 sc1
  v_add_f32 v23, v23, v27
  v_mfma_f32_16x16x32_bf16 v[180:183], a[172:175], a[116:119], v[180:183]
  ds_read_b64_tr_b16 a[156:157], v2 offset:50368
  v_add_f32 v24, v24, v28
  v_mfma_f32_16x16x32_bf16 v[176:179], a[172:175], a[112:115], v[176:179]
  ds_read_b64_tr_b16 a[158:159], v2 offset:53952
  v_add_f32 v25, v25, v29
  v_mfma_f32_16x16x32_bf16 v[176:179], a[168:171], a[96:99], v[176:179]
  s_waitcnt lgkmcnt(8)
  v_accvgpr_read_b32 v26, a188
  v_accvgpr_read_b32 v27, a189
  v_mfma_f32_16x16x32_bf16 v[192:195], a[128:131], a[96:99], v[192:195]
  ds_read_b64_tr_b16 a[160:161], v1 offset:0
  v_accvgpr_read_b32 v28, a190
  v_mfma_f32_16x16x32_bf16 v[192:195], a[132:135], a[112:115], v[192:195]
  v_accvgpr_read_b32 v29, a191
  v_add_f32 v22, v22, v26
  v_mfma_f32_16x16x32_bf16 v[196:199], a[132:135], a[116:119], v[196:199]
  ds_read_b64_tr_b16 a[162:163], v1 offset:3584
  v_add_f32 v23, v23, v27
  v_mfma_f32_16x16x32_bf16 v[196:199], a[128:131], a[100:103], v[196:199]
  v_add_f32 v24, v24, v28
  v_add_f32 v25, v25, v29
  v_mfma_f32_16x16x32_bf16 v[200:203], a[128:131], a[104:107], v[200:203]
  ds_read_b64_tr_b16 a[164:165], v1 offset:7168
  v_mov_b32 v26, v22
  v_mfma_f32_16x16x32_bf16 v[200:203], a[132:135], a[120:123], v[200:203]
  v_mov_b32 v27, v23
  v_mov_b32 v28, v24
  v_mfma_f32_16x16x32_bf16 v[204:207], a[132:135], a[124:127], v[204:207]
  buffer_load_dwordx4 v9, s[16:19], s56 offen offset:2048 lds
  v_mov_b32 v29, v25
  v_mfma_f32_16x16x32_bf16 v[204:207], a[128:131], a[108:111], v[204:207]
  ds_read_b64_tr_b16 a[166:167], v1 offset:10752
  v_permlane16_swap_b32 v22, v26
  v_mfma_f32_16x16x32_bf16 v[220:223], a[136:139], a[108:111], v[220:223]
  ds_read_b64_tr_b16 a[168:169], v1 offset:32
  v_permlane16_swap_b32 v23, v27
  v_mfma_f32_16x16x32_bf16 v[220:223], a[140:143], a[124:127], v[220:223]
  v_permlane16_swap_b32 v24, v28
  v_permlane16_swap_b32 v25, v29
  v_mfma_f32_16x16x32_bf16 v[216:219], a[140:143], a[120:123], v[216:219]
  s_add_u32 s59, s59, 16384
  ds_read_b64_tr_b16 a[170:171], v1 offset:3616
  v_add_f32 v22, v22, v26
  v_mfma_f32_16x16x32_bf16 v[216:219], a[136:139], a[104:107], v[216:219]
  buffer_load_dwordx4 a[40:43], v0, s[36:39], s57 offen offset:2048 sc1
  v_add_f32 v23, v23, v27
  v_mfma_f32_16x16x32_bf16 v[212:215], a[136:139], a[100:103], v[212:215]
  ds_read_b64_tr_b16 a[172:173], v1 offset:7200
  v_add_f32 v24, v24, v28
  v_mfma_f32_16x16x32_bf16 v[212:215], a[140:143], a[116:119], v[212:215]
  v_add_f32 v25, v25, v29
  v_mov_b32 v26, v22
  v_mfma_f32_16x16x32_bf16 v[208:211], a[140:143], a[112:115], v[208:211]
  ds_read_b64_tr_b16 a[174:175], v1 offset:10784
  v_mov_b32 v27, v23
  v_mfma_f32_16x16x32_bf16 v[208:211], a[136:139], a[96:99], v[208:211]
  s_waitcnt lgkmcnt(8)
  v_mov_b32 v28, v24
  v_mov_b32 v29, v25
  v_mfma_f32_16x16x32_bf16 v[224:227], a[144:147], a[96:99], v[224:227]
  buffer_load_dwordx4 a[208:211], v0, s[36:39], s59 offen offset:0 sc1
  v_permlane32_swap_b32 v22, v26
  v_mfma_f32_16x16x32_bf16 v[224:227], a[148:151], a[112:115], v[224:227]
  ds_read_b64_tr_b16 a[128:129], v1 offset:64
  v_permlane32_swap_b32 v23, v27
  v_mfma_f32_16x16x32_bf16 v[228:231], a[148:151], a[116:119], v[228:231]
  ds_read_b64_tr_b16 a[130:131], v1 offset:3648
  v_permlane32_swap_b32 v24, v28
  v_mfma_f32_16x16x32_bf16 v[228:231], a[144:147], a[100:103], v[228:231]
  v_permlane32_swap_b32 v25, v29
  v_add_f32 v22, v22, v26
  v_mfma_f32_16x16x32_bf16 v[232:235], a[144:147], a[104:107], v[232:235]
  ds_read_b64_tr_b16 a[132:133], v1 offset:7232
  v_add_f32 v23, v23, v27
  v_mfma_f32_16x16x32_bf16 v[232:235], a[148:151], a[120:123], v[232:235]
  buffer_load_dwordx4 a[212:215], v0, s[36:39], s59 offen offset:1024 sc1
  v_add_f32 v24, v24, v28
  v_mfma_f32_16x16x32_bf16 v[236:239], a[148:151], a[124:127], v[236:239]
  ds_read_b64_tr_b16 a[134:135], v1 offset:10816
  v_add_f32 v25, v25, v29
  v_mfma_f32_16x16x32_bf16 v[236:239], a[144:147], a[108:111], v[236:239]
  v_mul_f32 v22, 0x3a800000, v22
  v_mul_f32 v23, 0x3a800000, v23
  v_mfma_f32_16x16x32_bf16 v[252:255], a[152:155], a[108:111], v[252:255]
  ds_read_b64_tr_b16 a[136:137], v1 offset:96
  v_fma_f32 v23, -v22, v22, v23
  v_mfma_f32_16x16x32_bf16 v[252:255], a[156:159], a[124:127], v[252:255]
  v_max_f32 v23, 0, v23
  v_cvt_pk_bf16_f32 v23, v23, v23
  v_mfma_f32_16x16x32_bf16 v[248:251], a[156:159], a[120:123], v[248:251]
  buffer_load_dwordx4 a[44:47], v0, s[36:39], s57 offen offset:3072 sc1
  s_bfe_u32 s56, s83, 0x40008
  v_mfma_f32_16x16x32_bf16 v[248:251], a[152:155], a[104:107], v[248:251]
  s_mul_i32 s56, s56, 458752
  s_add_u32 m0, s84, 57344
  ds_read_b64_tr_b16 a[138:139], v1 offset:3680
  v_mfma_f32_16x16x32_bf16 v[244:247], a[152:155], a[100:103], v[244:247]
  ds_read_b64_tr_b16 a[140:141], v1 offset:7264
  v_lshlrev_b32 v23, 16, v23
  v_mfma_f32_16x16x32_bf16 v[244:247], a[156:159], a[116:119], v[244:247]
  v_add_f32 v23, 0x3727c5ac, v23
  v_cvt_pk_bf16_f32 v23, v23, v23
  v_mfma_f32_16x16x32_bf16 v[240:243], a[156:159], a[112:115], v[240:243]
  ds_read_b64_tr_b16 a[142:143], v1 offset:10848
  v_lshlrev_b32 v23, 16, v23
  v_mfma_f32_16x16x32_bf16 v[240:243], a[152:155], a[96:99], v[240:243]
  s_waitcnt vmcnt(9) lgkmcnt(8)
  buffer_load_dwordx4 v3, s[16:19], s56 offen offset:0 lds
  v_mfma_f32_16x16x32_bf16 v[32:35], a[160:163], a[0:3], v[32:35]
  s_add_u32 s57, s57, 4096
  ds_read_b64_tr_b16 a[144:145], v1 offset:128
  v_mfma_f32_16x16x32_bf16 v[32:35], a[164:167], a[16:19], v[32:35]
  s_barrier
  v_sqrt_f32 v23, v23
  v_mfma_f32_16x16x32_bf16 v[36:39], a[164:167], a[20:23], v[36:39]
  s_nop 0
  ds_read_b64_tr_b16 a[146:147], v1 offset:3712
  v_cvt_pk_bf16_f32 v12, -v22, v23
  v_mfma_f32_16x16x32_bf16 v[36:39], a[160:163], a[4:7], v[36:39]
  v_and_b32 v23, 0xffff0000, v12
  v_mfma_f32_16x16x32_bf16 v[40:43], a[160:163], a[8:11], v[40:43]
  buffer_load_dwordx4 a[48:51], v0, s[36:39], s57 offen offset:0 sc1
  v_mfma_f32_16x16x32_bf16 v[40:43], a[164:167], a[24:27], v[40:43]
  ds_read_b64_tr_b16 a[148:149], v1 offset:7296
  v_mfma_f32_16x16x32_bf16 v[44:47], a[164:167], a[28:31], v[44:47]
  ds_read_b64_tr_b16 a[150:151], v1 offset:10880
  v_mfma_f32_16x16x32_bf16 v[44:47], a[160:163], a[12:15], v[44:47]
  v_rcp_f32 v10, v23
  v_mfma_f32_16x16x32_bf16 v[60:63], a[168:171], a[12:15], v[60:63]
  ds_read_b64_tr_b16 a[152:153], v1 offset:160
  v_mul_f32 v11, v23, v23
  v_mfma_f32_16x16x32_bf16 v[60:63], a[172:175], a[28:31], v[60:63]
  v_mul_f32 v10, 0xbfb8aa3b, v10
  v_mul_f32 v24, 0x3a800000, v24
  v_mfma_f32_16x16x32_bf16 v[56:59], a[172:175], a[24:27], v[56:59]
  ds_read_b64_tr_b16 a[154:155], v1 offset:3744
  v_mul_f32 v25, 0x3a800000, v25
  v_mfma_f32_16x16x32_bf16 v[56:59], a[168:171], a[8:11], v[56:59]
  buffer_load_dwordx4 v4, s[16:19], s56 offen offset:1024 lds
  v_fma_f32 v25, -v24, v24, v25
  v_mfma_f32_16x16x32_bf16 v[52:55], a[168:171], a[4:7], v[52:55]
  ds_read_b64_tr_b16 a[156:157], v1 offset:7328
  v_max_f32 v25, 0, v25
  v_mfma_f32_16x16x32_bf16 v[52:55], a[172:175], a[20:23], v[52:55]
  v_cvt_pk_bf16_f32 v25, v25, v25
  v_lshlrev_b32 v25, 16, v25
  v_mfma_f32_16x16x32_bf16 v[48:51], a[172:175], a[16:19], v[48:51]
  ds_read_b64_tr_b16 a[158:159], v1 offset:10912
  v_add_f32 v25, 0x3727c5ac, v25
  v_mfma_f32_16x16x32_bf16 v[48:51], a[168:171], a[0:3], v[48:51]
  s_waitcnt lgkmcnt(8)
  v_cvt_pk_bf16_f32 v25, v25, v25
  v_lshlrev_b32 v25, 16, v25
  v_mfma_f32_16x16x32_bf16 v[64:67], a[128:131], a[0:3], v[64:67]
  ds_read_b64_tr_b16 a[160:161], v1 offset:192
  v_mfma_f32_16x16x32_bf16 v[64:67], a[132:135], a[16:19], v[64:67]
  v_sqrt_f32 v25, v25
  v_mfma_f32_16x16x32_bf16 v[68:71], a[132:135], a[20:23], v[68:71]
  s_nop 0
  ds_read_b64_tr_b16 a[162:163], v1 offset:3776
  v_cvt_pk_bf16_f32 v15, -v24, v25
  v_mfma_f32_16x16x32_bf16 v[68:71], a[128:131], a[4:7], v[68:71]
  buffer_load_dwordx4 a[52:55], v0, s[36:39], s57 offen offset:1024 sc1
  v_and_b32 v25, 0xffff0000, v15
  v_mfma_f32_16x16x32_bf16 v[72:75], a[128:131], a[8:11], v[72:75]
  ds_read_b64_tr_b16 a[164:165], v1 offset:7360
  v_mfma_f32_16x16x32_bf16 v[72:75], a[132:135], a[24:27], v[72:75]
  v_rcp_f32 v13, v25
  v_mfma_f32_16x16x32_bf16 v[76:79], a[132:135], a[28:31], v[76:79]
  ds_read_b64_tr_b16 a[166:167], v1 offset:10944
  v_mul_f32 v14, v25, v25
  v_mfma_f32_16x16x32_bf16 v[76:79], a[128:131], a[12:15], v[76:79]
  v_mul_f32 v13, 0xbfb8aa3b, v13
  v_accvgpr_read_b32 v22, a192
  v_mfma_f32_16x16x32_bf16 v[92:95], a[136:139], a[12:15], v[92:95]
  ds_read_b64_tr_b16 a[168:169], v1 offset:14336
  v_accvgpr_read_b32 v23, a193
  v_mfma_f32_16x16x32_bf16 v[92:95], a[140:143], a[28:31], v[92:95]
  v_accvgpr_read_b32 v24, a194
  v_accvgpr_read_b32 v25, a195
  v_mfma_f32_16x16x32_bf16 v[88:91], a[140:143], a[24:27], v[88:91]
  buffer_load_dwordx4 v5, s[16:19], s56 offen offset:2048 lds
  v_accvgpr_read_b32 v26, a196
  v_mfma_f32_16x16x32_bf16 v[88:91], a[136:139], a[8:11], v[88:91]
  ds_read_b64_tr_b16 a[170:171], v1 offset:17920
  v_accvgpr_read_b32 v27, a197
  v_mfma_f32_16x16x32_bf16 v[84:87], a[136:139], a[4:7], v[84:87]
  ds_read_b64_tr_b16 a[172:173], v1 offset:21504
  v_accvgpr_read_b32 v28, a198
  v_mfma_f32_16x16x32_bf16 v[84:87], a[140:143], a[20:23], v[84:87]
  v_accvgpr_read_b32 v29, a199
  v_add_f32 v22, v22, v26
  v_mfma_f32_16x16x32_bf16 v[80:83], a[140:143], a[16:19], v[80:83]
  ds_read_b64_tr_b16 a[174:175], v1 offset:25088
  v_add_f32 v23, v23, v27
  v_mfma_f32_16x16x32_bf16 v[80:83], a[136:139], a[0:3], v[80:83]
  s_waitcnt lgkmcnt(8)
  v_add_f32 v24, v24, v28
  v_add_f32 v25, v25, v29
  v_mfma_f32_16x16x32_bf16 v[96:99], a[144:147], a[0:3], v[96:99]
  ds_read_b64_tr_b16 a[128:129], v1 offset:14368
  v_accvgpr_read_b32 v26, a200
  v_mfma_f32_16x16x32_bf16 v[96:99], a[148:151], a[16:19], v[96:99]
  v_accvgpr_read_b32 v27, a201
  v_accvgpr_read_b32 v28, a202
  v_mfma_f32_16x16x32_bf16 v[100:103], a[148:151], a[20:23], v[100:103]
  buffer_load_dwordx4 a[56:59], v0, s[36:39], s57 offen offset:2048 sc1
  v_accvgpr_read_b32 v29, a203
  v_mfma_f32_16x16x32_bf16 v[100:103], a[144:147], a[4:7], v[100:103]
  ds_read_b64_tr_b16 a[130:131], v1 offset:17952
  v_add_f32 v22, v22, v26
  v_mfma_f32_16x16x32_bf16 v[104:107], a[144:147], a[8:11], v[104:107]
  ds_read_b64_tr_b16 a[132:133], v1 offset:21536
  v_add_f32 v23, v23, v27
  v_mfma_f32_16x16x32_bf16 v[104:107], a[148:151], a[24:27], v[104:107]
  v_add_f32 v24, v24, v28
  v_add_f32 v25, v25, v29
  v_mfma_f32_16x16x32_bf16 v[108:111], a[148:151], a[28:31], v[108:111]
  ds_read_b64_tr_b16 a[134:135], v1 offset:25120
  v_accvgpr_read_b32 v26, a204
  v_mfma_f32_16x16x32_bf16 v[108:111], a[144:147], a[12:15], v[108:111]
  v_accvgpr_read_b32 v27, a205
  v_accvgpr_read_b32 v28, a206
  v_mfma_f32_16x16x32_bf16 v[124:127], a[152:155], a[12:15], v[124:127]
  ds_read_b64_tr_b16 a[136:137], v1 offset:14400
  v_accvgpr_read_b32 v29, a207
  v_mfma_f32_16x16x32_bf16 v[124:127], a[156:159], a[28:31], v[124:127]
  buffer_load_dwordx4 v6, s[16:19], s56 offen offset:3072 lds
  v_add_f32 v22, v22, v26
  v_mfma_f32_16x16x32_bf16 v[120:123], a[156:159], a[24:27], v[120:123]
  ds_read_b64_tr_b16 a[138:139], v1 offset:17984
  v_add_f32 v23, v23, v27
  v_mfma_f32_16x16x32_bf16 v[120:123], a[152:155], a[8:11], v[120:123]
  v_add_f32 v24, v24, v28
  v_add_f32 v25, v25, v29
  v_mfma_f32_16x16x32_bf16 v[116:119], a[152:155], a[4:7], v[116:119]
  ds_read_b64_tr_b16 a[140:141], v1 offset:21568
  v_mov_b32 v26, v22
  v_mfma_f32_16x16x32_bf16 v[116:119], a[156:159], a[20:23], v[116:119]
  v_mov_b32 v27, v23
  v_mov_b32 v28, v24
  v_mfma_f32_16x16x32_bf16 v[112:115], a[156:159], a[16:19], v[112:115]
  ds_read_b64_tr_b16 a[142:143], v1 offset:25152
  v_mov_b32 v29, v25
  v_mfma_f32_16x16x32_bf16 v[112:115], a[152:155], a[0:3], v[112:115]
  s_waitcnt lgkmcnt(8)
  v_permlane16_swap_b32 v22, v26
  v_permlane16_swap_b32 v23, v27
  v_mfma_f32_16x16x32_bf16 v[128:131], a[160:163], a[0:3], v[128:131]
  ds_read_b64_tr_b16 a[144:145], v1 offset:14432
  v_permlane16_swap_b32 v24, v28
  v_mfma_f32_16x16x32_bf16 v[128:131], a[164:167], a[16:19], v[128:131]
  buffer_load_dwordx4 a[60:63], v0, s[36:39], s57 offen offset:3072 sc1
  v_permlane16_swap_b32 v25, v29
  v_mfma_f32_16x16x32_bf16 v[132:135], a[164:167], a[20:23], v[132:135]
  s_add_u32 m0, s84, 61440
  ds_read_b64_tr_b16 a[146:147], v1 offset:18016
  v_add_f32 v22, v22, v26
  v_mfma_f32_16x16x32_bf16 v[132:135], a[160:163], a[4:7], v[132:135]
  v_add_f32 v23, v23, v27
  v_add_f32 v24, v24, v28
  v_mfma_f32_16x16x32_bf16 v[136:139], a[160:163], a[8:11], v[136:139]
  ds_read_b64_tr_b16 a[148:149], v1 offset:21600
  v_add_f32 v25, v25, v29
  v_mfma_f32_16x16x32_bf16 v[136:139], a[164:167], a[24:27], v[136:139]
  v_mov_b32 v26, v22
  v_mov_b32 v27, v23
  v_mfma_f32_16x16x32_bf16 v[140:143], a[164:167], a[28:31], v[140:143]
  buffer_load_dwordx4 v7, s[16:19], s56 offen offset:0 lds
  s_bfe_u32 s57, s83, 0x40008
  v_mfma_f32_16x16x32_bf16 v[140:143], a[160:163], a[12:15], v[140:143]
  s_lshl_b32 s57, s57, 13
  s_add_u32 s57, s57, s85
  ds_read_b64_tr_b16 a[150:151], v1 offset:25184
  v_mfma_f32_16x16x32_bf16 v[156:159], a[168:171], a[12:15], v[156:159]
  ds_read_b64_tr_b16 a[152:153], v1 offset:14464
  v_mov_b32 v28, v24
  v_mfma_f32_16x16x32_bf16 v[156:159], a[172:175], a[28:31], v[156:159]
  v_mov_b32 v29, v25
  v_permlane32_swap_b32 v22, v26
  v_mfma_f32_16x16x32_bf16 v[152:155], a[172:175], a[24:27], v[152:155]
  ds_read_b64_tr_b16 a[154:155], v1 offset:18048
  v_permlane32_swap_b32 v23, v27
  v_mfma_f32_16x16x32_bf16 v[152:155], a[168:171], a[8:11], v[152:155]
  buffer_load_dwordx4 a[64:67], v0, s[36:39], s57 offen offset:0 sc1
  v_permlane32_swap_b32 v24, v28
  v_mfma_f32_16x16x32_bf16 v[148:151], a[168:171], a[4:7], v[148:151]
  ds_read_b64_tr_b16 a[156:157], v1 offset:21632
  v_permlane32_swap_b32 v25, v29
  v_mfma_f32_16x16x32_bf16 v[148:151], a[172:175], a[20:23], v[148:151]
  v_add_f32 v22, v22, v26
  v_add_f32 v23, v23, v27
  v_mfma_f32_16x16x32_bf16 v[144:147], a[172:175], a[16:19], v[144:147]
  ds_read_b64_tr_b16 a[158:159], v1 offset:25216
  v_add_f32 v24, v24, v28
  v_mfma_f32_16x16x32_bf16 v[144:147], a[168:171], a[0:3], v[144:147]
  s_waitcnt lgkmcnt(8)
  v_add_f32 v25, v25, v29
  v_mul_f32 v22, 0x3a800000, v22
  v_mfma_f32_16x16x32_bf16 v[160:163], a[128:131], a[0:3], v[160:163]
  ds_read_b64_tr_b16 a[160:161], v1 offset:14496
  v_mul_f32 v23, 0x3a800000, v23
  v_mfma_f32_16x16x32_bf16 v[160:163], a[132:135], a[16:19], v[160:163]
Hb0_1:
  s_cbranch_execz Hb0_2
  v_fma_f32 v23, -v22, v22, v23
  v_max_f32 v23, 0, v23
  v_mfma_f32_16x16x32_bf16 v[164:167], a[132:135], a[20:23], v[164:167]
  buffer_load_dwordx4 v8, s[16:19], s56 offen offset:1024 lds
  v_cvt_pk_bf16_f32 v23, v23, v23
  v_mfma_f32_16x16x32_bf16 v[164:167], a[128:131], a[4:7], v[164:167]
  ds_read_b64_tr_b16 a[162:163], v1 offset:18080
  v_lshlrev_b32 v23, 16, v23
  v_mfma_f32_16x16x32_bf16 v[168:171], a[128:131], a[8:11], v[168:171]
  ds_read_b64_tr_b16 a[164:165], v1 offset:21664
  v_add_f32 v23, 0x3727c5ac, v23
  v_mfma_f32_16x16x32_bf16 v[168:171], a[132:135], a[24:27], v[168:171]
  v_cvt_pk_bf16_f32 v23, v23, v23
  v_lshlrev_b32 v23, 16, v23
  v_mfma_f32_16x16x32_bf16 v[172:175], a[132:135], a[28:31], v[172:175]
  ds_read_b64_tr_b16 a[166:167], v1 offset:25248
  v_mfma_f32_16x16x32_bf16 v[172:175], a[128:131], a[12:15], v[172:175]
  s_waitcnt vmcnt(15)
  s_barrier
  buffer_load_dwordx4 a[68:71], v0, s[36:39], s57 offen offset:1024 sc1
  v_mfma_f32_16x16x32_bf16 v[188:191], a[136:139], a[12:15], v[188:191]
  ds_read_b64_tr_b16 a[168:169], v1 offset:14528
  v_mfma_f32_16x16x32_bf16 v[188:191], a[140:143], a[28:31], v[188:191]
  v_sqrt_f32 v23, v23
  v_mfma_f32_16x16x32_bf16 v[184:187], a[140:143], a[24:27], v[184:187]
  s_nop 0
  ds_read_b64_tr_b16 a[170:171], v1 offset:18112
  v_cvt_pk_bf16_f32 v18, -v22, v23
  v_mfma_f32_16x16x32_bf16 v[184:187], a[136:139], a[8:11], v[184:187]
  v_and_b32 v23, 0xffff0000, v18
  v_mfma_f32_16x16x32_bf16 v[180:183], a[136:139], a[4:7], v[180:183]
  ds_read_b64_tr_b16 a[172:173], v1 offset:21696
  v_mfma_f32_16x16x32_bf16 v[180:183], a[140:143], a[20:23], v[180:183]
  v_rcp_f32 v16, v23
  v_mfma_f32_16x16x32_bf16 v[176:179], a[140:143], a[16:19], v[176:179]
  buffer_load_dwordx4 v9, s[16:19], s56 offen offset:2048 lds
  v_mul_f32 v17, v23, v23
  v_mfma_f32_16x16x32_bf16 v[176:179], a[136:139], a[0:3], v[176:179]
  s_waitcnt lgkmcnt(7)
  ds_read_b64_tr_b16 a[174:175], v1 offset:25280
  v_mul_f32 v16, 0xbfb8aa3b, v16
  v_mfma_f32_16x16x32_bf16 v[192:195], a[144:147], a[0:3], v[192:195]
  ds_read_b64_tr_b16 a[128:129], v1 offset:28672
  v_mul_f32 v24, 0x3a800000, v24
  v_mfma_f32_16x16x32_bf16 v[192:195], a[148:151], a[16:19], v[192:195]
  v_mul_f32 v25, 0x3a800000, v25
  v_fma_f32 v25, -v24, v24, v25
  v_mfma_f32_16x16x32_bf16 v[196:199], a[148:151], a[20:23], v[196:199]
  ds_read_b64_tr_b16 a[130:131], v1 offset:32256
  v_max_f32 v25, 0, v25
  v_mfma_f32_16x16x32_bf16 v[196:199], a[144:147], a[4:7], v[196:199]
  v_cvt_pk_bf16_f32 v25, v25, v25
  v_lshlrev_b32 v25, 16, v25
  v_mfma_f32_16x16x32_bf16 v[200:203], a[144:147], a[8:11], v[200:203]
  ds_read_b64_tr_b16 a[132:133], v1 offset:35840
  v_add_f32 v25, 0x3727c5ac, v25
  v_mfma_f32_16x16x32_bf16 v[200:203], a[148:151], a[24:27], v[200:203]
  v_cvt_pk_bf16_f32 v25, v25, v25
  v_lshlrev_b32 v25, 16, v25
  v_mfma_f32_16x16x32_bf16 v[204:207], a[148:151], a[28:31], v[204:207]
  buffer_load_dwordx4 a[72:75], v0, s[36:39], s57 offen offset:2048 sc1
  v_mfma_f32_16x16x32_bf16 v[204:207], a[144:147], a[12:15], v[204:207]
  ds_read_b64_tr_b16 a[134:135], v1 offset:39424
  v_mfma_f32_16x16x32_bf16 v[220:223], a[152:155], a[12:15], v[220:223]
  ds_read_b64_tr_b16 a[136:137], v1 offset:28704
  v_mfma_f32_16x16x32_bf16 v[220:223], a[156:159], a[28:31], v[220:223]
  v_sqrt_f32 v25, v25
  v_mfma_f32_16x16x32_bf16 v[216:219], a[156:159], a[24:27], v[216:219]
  s_nop 0
  ds_read_b64_tr_b16 a[138:139], v1 offset:32288
  v_cvt_pk_bf16_f32 v21, -v24, v25
  v_mfma_f32_16x16x32_bf16 v[216:219], a[152:155], a[8:11], v[216:219]
  v_and_b32 v25, 0xffff0000, v21
  v_mfma_f32_16x16x32_bf16 v[212:215], a[152:155], a[4:7], v[212:215]
  s_bfe_u32 s56, s83, 0x4000c
  s_mul_i32 s56, s56, 458752
  s_add_u32 m0, s84, 86016
  v_mfma_f32_16x16x32_bf16 v[212:215], a[156:159], a[20:23], v[212:215]
  ds_read_b64_tr_b16 a[140:141], v1 offset:35872
  v_mfma_f32_16x16x32_bf16 v[208:211], a[156:159], a[16:19], v[208:211]
  ds_read_b64_tr_b16 a[142:143], v1 offset:39456
  v_mfma_f32_16x16x32_bf16 v[208:211], a[152:155], a[0:3], v[208:211]
  s_waitcnt lgkmcnt(8)
  v_rcp_f32 v19, v25
  v_mfma_f32_16x16x32_bf16 v[224:227], a[160:163], a[0:3], v[224:227]
  buffer_load_dwordx4 v3, s[16:19], s56 offen offset:0 lds
  v_mul_f32 v20, v25, v25
  v_mfma_f32_16x16x32_bf16 v[224:227], a[164:167], a[16:19], v[224:227]
  v_mul_f32 v19, 0xbfb8aa3b, v19
  v_add_u32 v31, -28672, v31
  v_mfma_f32_16x16x32_bf16 v[228:231], a[164:167], a[20:23], v[228:231]
  ds_read_b64_tr_b16 a[176:177], v31 offset:0
  v_mfma_f32_16x16x32_bf16 v[228:231], a[160:163], a[4:7], v[228:231]
  ds_read_b64_tr_b16 a[178:179], v31 offset:3584
  v_mfma_f32_16x16x32_bf16 v[232:235], a[160:163], a[8:11], v[232:235]
  ds_read_b64_tr_b16 a[180:181], v31 offset:7168
  v_mfma_f32_16x16x32_bf16 v[232:235], a[164:167], a[24:27], v[232:235]
  buffer_load_dwordx4 a[76:79], v0, s[36:39], s57 offen offset:3072 sc1
  v_mfma_f32_16x16x32_bf16 v[236:239], a[164:167], a[28:31], v[236:239]
  ds_read_b64_tr_b16 a[182:183], v31 offset:10752
  v_mfma_f32_16x16x32_bf16 v[236:239], a[160:163], a[12:15], v[236:239]
  ds_read_b64_tr_b16 a[184:185], v31 offset:32
  v_mfma_f32_16x16x32_bf16 v[252:255], a[168:171], a[12:15], v[252:255]
  ds_read_b64_tr_b16 a[144:145], v1 offset:28736
  v_mfma_f32_16x16x32_bf16 v[252:255], a[172:175], a[28:31], v[252:255]
  ds_read_b64_tr_b16 a[186:187], v31 offset:3616
  v_mfma_f32_16x16x32_bf16 v[248:251], a[172:175], a[24:27], v[248:251]
  ds_read_b64_tr_b16 a[146:147], v1 offset:32320
  v_mfma_f32_16x16x32_bf16 v[248:251], a[168:171], a[8:11], v[248:251]
  ds_read_b64_tr_b16 a[188:189], v31 offset:7200
  v_mfma_f32_16x16x32_bf16 v[244:247], a[168:171], a[4:7], v[244:247]
  buffer_load_dwordx4 v4, s[16:19], s56 offen offset:1024 lds
  v_mfma_f32_16x16x32_bf16 v[244:247], a[172:175], a[20:23], v[244:247]
  ds_read_b64_tr_b16 a[148:149], v1 offset:35904
  v_mfma_f32_16x16x32_bf16 v[240:243], a[172:175], a[16:19], v[240:243]
  s_add_u32 s57, s57, 4096
  ds_read_b64_tr_b16 a[150:151], v1 offset:39488
  v_mfma_f32_16x16x32_bf16 v[240:243], a[168:171], a[0:3], v[240:243]
  s_waitcnt vmcnt(9) lgkmcnt(11)
  ds_read_b64_tr_b16 a[190:191], v31 offset:10784
  v_mfma_f32_16x16x32_bf16 v[32:35], a[128:131], a[32:35], v[32:35]
  ds_read_b64_tr_b16 a[152:153], v1 offset:28768
  v_mfma_f32_16x16x32_bf16 v[32:35], a[132:135], a[48:51], v[32:35]
  s_barrier
  ds_read_b64_tr_b16 a[192:193], v31 offset:64
  v_mfma_f32_16x16x32_bf16 v[36:39], a[132:135], a[52:55], v[36:39]
  buffer_load_dwordx4 a[80:83], v0, s[36:39], s57 offen offset:0 sc1
  v_mfma_f32_16x16x32_bf16 v[36:39], a[128:131], a[36:39], v[36:39]
  ds_read_b64_tr_b16 a[154:155], v1 offset:32352
  v_mfma_f32_16x16x32_bf16 v[40:43], a[128:131], a[40:43], v[40:43]
  ds_read_b64_tr_b16 a[156:157], v1 offset:35936
  v_mfma_f32_16x16x32_bf16 v[40:43], a[132:135], a[56:59], v[40:43]
  ds_read_b64_tr_b16 a[194:195], v31 offset:3648
  v_mfma_f32_16x16x32_bf16 v[44:47], a[132:135], a[60:63], v[44:47]
  ds_read_b64_tr_b16 a[196:197], v31 offset:7232
  ds_read_b64_tr_b16 a[198:199], v31 offset:10816
  ds_read_b64_tr_b16 a[200:201], v31 offset:96
  ds_read_b64_tr_b16 a[202:203], v31 offset:3680
  ds_read_b64_tr_b16 a[204:205], v31 offset:7264
  ds_read_b64_tr_b16 a[206:207], v31 offset:10848
  v_mfma_f32_16x16x32_bf16 v[44:47], a[128:131], a[44:47], v[44:47]
  ds_read_b64_tr_b16 a[158:159], v1 offset:39520
  v_lshrrev_b32 v22, 4, v0
  v_mfma_f32_16x16x32_bf16 v[60:63], a[136:139], a[44:47], v[60:63]
  buffer_load_dwordx4 v5, s[16:19], s56 offen offset:2048 lds
  v_and_b32 v23, 14, v22
  v_mfma_f32_16x16x32_bf16 v[60:63], a[140:143], a[60:63], v[60:63]
  ds_read_b64_tr_b16 a[160:161], v1 offset:28800
  v_lshlrev_b32 v23, 27, v23
  v_mfma_f32_16x16x32_bf16 v[56:59], a[140:143], a[56:59], v[56:59]
  ds_read_b64_tr_b16 a[162:163], v1 offset:32384
  v_and_b32 v24, 1, v22
  v_mfma_f32_16x16x32_bf16 v[56:59], a[136:139], a[40:43], v[56:59]
  v_lshl_add_u32 v23, v24, 9, v23
  v_and_b32 v22, 0x30, v22
  v_mfma_f32_16x16x32_bf16 v[52:55], a[136:139], a[36:39], v[52:55]
  ds_read_b64_tr_b16 a[164:165], v1 offset:35968
  v_add_u32 v22, v22, v23
  v_mfma_f32_16x16x32_bf16 v[52:55], a[140:143], a[52:55], v[52:55]
  s_lshl3_add_u32 s76, s60, s58
  buffer_load_dwordx4 a[84:87], v0, s[36:39], s57 offen offset:1024 sc1
  s_lshr_b32 s77, s44, 1
  v_mfma_f32_16x16x32_bf16 v[48:51], a[140:143], a[48:51], v[48:51]
  s_lshl1_add_u32 s76, s76, s77
  ds_read_b64_tr_b16 a[166:167], v1 offset:39552
  s_and_b32 s77, s44, 1
  v_mfma_f32_16x16x32_bf16 v[48:51], a[136:139], a[32:35], v[48:51]
  s_waitcnt vmcnt(21) lgkmcnt(5)
  s_lshl2_add_u32 s76, s76, s77
  s_lshl_b32 s76, s76, 8
  v_mfma_f32_16x16x32_bf16 a[216:219], a[176:179], a[208:211], a[216:219]
  s_add_u32 s76, s76, 524288
  ds_read_b64_tr_b16 a[168:169], v1 offset:28832
  v_mfma_f32_16x16x32_bf16 a[216:219], a[180:183], a[212:215], a[216:219]
  v_mfma_f32_16x16x32_bf16 a[220:223], a[184:187], a[208:211], a[220:223]
  ds_read_b64_tr_b16 a[170:171], v1 offset:32416
  v_mfma_f32_16x16x32_bf16 a[220:223], a[188:191], a[212:215], a[220:223]
  v_mfma_f32_16x16x32_bf16 a[224:227], a[192:195], a[208:211], a[224:227]
  buffer_load_dwordx4 v6, s[16:19], s56 offen offset:3072 lds
  v_mfma_f32_16x16x32_bf16 a[224:227], a[196:199], a[212:215], a[224:227]
  ds_read_b64_tr_b16 a[172:173], v1 offset:36000
  v_mfma_f32_16x16x32_bf16 a[228:231], a[200:203], a[208:211], a[228:231]
  ds_read_b64_tr_b16 a[174:175], v1 offset:39584
  v_mfma_f32_16x16x32_bf16 a[228:231], a[204:207], a[212:215], a[228:231]
  s_waitcnt lgkmcnt(8)
  v_mfma_f32_16x16x32_bf16 v[64:67], a[144:147], a[32:35], v[64:67]
  ds_read_b64_tr_b16 a[128:129], v1 offset:28864
  v_mfma_f32_16x16x32_bf16 v[64:67], a[148:151], a[48:51], v[64:67]
  buffer_load_dwordx4 a[88:91], v0, s[36:39], s57 offen offset:2048 sc1
  v_mfma_f32_16x16x32_bf16 v[68:71], a[148:151], a[52:55], v[68:71]
  ds_read_b64_tr_b16 a[130:131], v1 offset:32448
  v_mfma_f32_16x16x32_bf16 v[68:71], a[144:147], a[36:39], v[68:71]
  s_add_u32 m0, s84, 90112
  v_mfma_f32_16x16x32_bf16 v[72:75], a[144:147], a[40:43], v[72:75]
  ds_read_b64_tr_b16 a[132:133], v1 offset:36032
  v_mfma_f32_16x16x32_bf16 v[72:75], a[148:151], a[56:59], v[72:75]
  v_mfma_f32_16x16x32_bf16 v[76:79], a[148:151], a[60:63], v[76:79]
  ds_read_b64_tr_b16 a[134:135], v1 offset:39616
  v_mfma_f32_16x16x32_bf16 v[76:79], a[144:147], a[44:47], v[76:79]
  buffer_load_dwordx4 v7, s[16:19], s56 offen offset:0 lds
  v_mfma_f32_16x16x32_bf16 v[92:95], a[152:155], a[44:47], v[92:95]
  ds_read_b64_tr_b16 a[136:137], v1 offset:43008
  v_mfma_f32_16x16x32_bf16 v[92:95], a[156:159], a[60:63], v[92:95]
  v_mfma_f32_16x16x32_bf16 v[88:91], a[156:159], a[56:59], v[88:91]
  ds_read_b64_tr_b16 a[138:139], v1 offset:46592
  v_mfma_f32_16x16x32_bf16 v[88:91], a[152:155], a[40:43], v[88:91]
  v_mfma_f32_16x16x32_bf16 v[84:87], a[152:155], a[36:39], v[84:87]
  buffer_load_dwordx4 a[92:95], v0, s[36:39], s57 offen offset:3072 sc1
  s_bfe_u32 s57, s83, 0x4000c
  v_mfma_f32_16x16x32_bf16 v[84:87], a[156:159], a[52:55], v[84:87]
  s_lshl_b32 s57, s57, 13
  s_add_u32 s57, s57, s85
  ds_read_b64_tr_b16 a[140:141], v1 offset:50176
  v_mfma_f32_16x16x32_bf16 v[80:83], a[156:159], a[48:51], v[80:83]
  ds_read_b64_tr_b16 a[142:143], v1 offset:53760
  v_mfma_f32_16x16x32_bf16 v[80:83], a[152:155], a[32:35], v[80:83]
  s_waitcnt lgkmcnt(8)
  v_mfma_f32_16x16x32_bf16 v[96:99], a[160:163], a[32:35], v[96:99]
  ds_read_b64_tr_b16 a[144:145], v1 offset:43040
  v_mfma_f32_16x16x32_bf16 v[96:99], a[164:167], a[48:51], v[96:99]
  buffer_load_dwordx4 a[96:99], v0, s[36:39], s57 offen offset:0 sc1
  v_mfma_f32_16x16x32_bf16 v[100:103], a[164:167], a[52:55], v[100:103]
  buffer_store_dwordx4 a[216:219], v22, s[36:39], s76 offen offset:0 sc1
  v_mfma_f32_16x16x32_bf16 v[100:103], a[160:163], a[36:39], v[100:103]
  ds_read_b64_tr_b16 a[146:147], v1 offset:46624
  v_mfma_f32_16x16x32_bf16 v[104:107], a[160:163], a[40:43], v[104:107]
  ds_read_b64_tr_b16 a[148:149], v1 offset:50208
  v_mfma_f32_16x16x32_bf16 v[104:107], a[164:167], a[56:59], v[104:107]
  v_mfma_f32_16x16x32_bf16 v[108:111], a[164:167], a[60:63], v[108:111]
  buffer_store_dwordx4 a[220:223], v22, s[36:39], s76 offen offset:64 sc1
  v_mfma_f32_16x16x32_bf16 v[108:111], a[160:163], a[44:47], v[108:111]
  ds_read_b64_tr_b16 a[150:151], v1 offset:53792
  v_mfma_f32_16x16x32_bf16 v[124:127], a[168:171], a[44:47], v[124:127]
  ds_read_b64_tr_b16 a[152:153], v1 offset:43072
  v_mfma_f32_16x16x32_bf16 v[124:127], a[172:175], a[60:63], v[124:127]
  v_mfma_f32_16x16x32_bf16 v[120:123], a[172:175], a[56:59], v[120:123]
  buffer_store_dwordx4 a[224:227], v22, s[36:39], s76 offen offset:128 sc1
  v_mfma_f32_16x16x32_bf16 v[120:123], a[168:171], a[40:43], v[120:123]
  ds_read_b64_tr_b16 a[154:155], v1 offset:46656
  v_mfma_f32_16x16x32_bf16 v[116:119], a[168:171], a[36:39], v[116:119]
  ds_read_b64_tr_b16 a[156:157], v1 offset:50240
  v_mfma_f32_16x16x32_bf16 v[116:119], a[172:175], a[52:55], v[116:119]
  v_mfma_f32_16x16x32_bf16 v[112:115], a[172:175], a[48:51], v[112:115]
  buffer_store_dwordx4 a[228:231], v22, s[36:39], s76 offen offset:192 sc1
  s_lshl_b32 s77, s60, 14
  v_mfma_f32_16x16x32_bf16 v[112:115], a[168:171], a[32:35], v[112:115]
  s_waitcnt lgkmcnt(7)
  ds_read_b64_tr_b16 a[158:159], v1 offset:53824
  s_lshl_b32 s78, s44, 9
  v_mfma_f32_16x16x32_bf16 v[128:131], a[128:131], a[32:35], v[128:131]
  s_add_u32 s77, s77, s78
  ds_read_b64_tr_b16 a[160:161], v1 offset:43104
  s_add_u32 s77, s77, 524288
  v_mfma_f32_16x16x32_bf16 v[128:131], a[132:135], a[48:51], v[128:131]
  s_lshr_b32 s78, s44, 1
  s_lshl_b32 s78, s78, 8
  s_and_b32 s65, s44, 1
  v_mfma_f32_16x16x32_bf16 v[132:135], a[132:135], a[52:55], v[132:135]
  s_add_u32 s78, s78, s65
  ds_read_b64_tr_b16 a[162:163], v1 offset:46688
  s_lshl3_add_u32 s78, s78, 159744
  v_mfma_f32_16x16x32_bf16 v[132:135], a[128:131], a[36:39], v[132:135]
  buffer_load_dwordx4 v8, s[16:19], s56 offen offset:1024 lds
  v_and_b32 v24, 0x1f0, v0
  v_mfma_f32_16x16x32_bf16 v[136:139], a[128:131], a[40:43], v[136:139]
  ds_read_b64_tr_b16 a[164:165], v1 offset:50272
  v_min_u32 v24, 432, v24
  v_mfma_f32_16x16x32_bf16 v[136:139], a[132:135], a[56:59], v[136:139]
  v_and_b32 v26, 0x200, v0
  v_lshl_add_u32 v25, v26, 4, v24
  v_mfma_f32_16x16x32_bf16 v[140:143], a[132:135], a[60:63], v[140:143]
  ds_read_b64_tr_b16 a[166:167], v1 offset:53856
  v_lshrrev_b32 v26, 4, v26
  v_mfma_f32_16x16x32_bf16 v[140:143], a[128:131], a[44:47], v[140:143]
  v_lshl_add_u32 v24, v24, 2, v26
  v_add_u32 v24, s78, v24
  v_mfma_f32_16x16x32_bf16 v[156:159], a[136:139], a[44:47], v[156:159]
  s_lshl2_add_u32 s65, s58, s44
  buffer_load_dwordx4 a[100:103], v0, s[36:39], s57 offen offset:1024 sc1
  s_lshl_b32 s65, s65, 19
  v_mfma_f32_16x16x32_bf16 v[156:159], a[140:143], a[60:63], v[156:159]
  s_mul_i32 s66, s60, 7
  ds_read_b64_tr_b16 a[168:169], v1 offset:43136
  s_and_b32 s78, s60, 1
  v_mfma_f32_16x16x32_bf16 v[152:155], a[140:143], a[56:59], v[152:155]
  s_add_u32 s66, s66, s78
  ds_read_b64_tr_b16 a[170:171], v1 offset:46720
  s_lshl_b32 s66, s66, 10
  v_mfma_f32_16x16x32_bf16 v[152:155], a[136:139], a[40:43], v[152:155]
  s_add_u32 s65, s65, s66
  s_add_u32 s67, s65, 19922944
  s_mul_i32 s78, s78, 8184
  v_mfma_f32_16x16x32_bf16 v[148:151], a[136:139], a[36:39], v[148:151]
  s_sub_u32 s65, s67, s78
  ds_read_b64_tr_b16 a[172:173], v1 offset:50304
  s_add_u32 s65, s65, 6144
  v_mfma_f32_16x16x32_bf16 v[148:151], a[140:143], a[52:55], v[148:151]
  s_add_u32 s66, s65, 262144
  buffer_load_dwordx4 v9, s[16:19], s56 offen offset:2048 lds
  s_lshl_b32 s45, s2, 7
  v_mfma_f32_16x16x32_bf16 v[144:147], a[140:143], a[48:51], v[144:147]
  s_add_u32 s45, s45, 5406720
  ds_read_b64_tr_b16 a[174:175], v1 offset:53888
  s_cmp_eq_u32 s44, 0
  v_mfma_f32_16x16x32_bf16 v[144:147], a[136:139], a[32:35], v[144:147]
  s_waitcnt lgkmcnt(8)
  s_cselect_b32 s45, s45, 1073741824
  s_add_u32 s76, s77, 4096
  v_mfma_f32_16x16x32_bf16 v[160:163], a[144:147], a[32:35], v[160:163]
  ds_read_b64_tr_b16 a[128:129], v1 offset:43168
  v_mfma_f32_16x16x32_bf16 v[160:163], a[148:151], a[48:51], v[160:163]
  v_mfma_f32_16x16x32_bf16 v[164:167], a[148:151], a[52:55], v[164:167]
  buffer_load_dwordx4 a[104:107], v0, s[36:39], s57 offen offset:2048 sc1
  v_mfma_f32_16x16x32_bf16 v[164:167], a[144:147], a[36:39], v[164:167]
  ds_read_b64_tr_b16 a[130:131], v1 offset:46752
  v_mfma_f32_16x16x32_bf16 v[168:171], a[144:147], a[40:43], v[168:171]
  ds_read_b64_tr_b16 a[132:133], v1 offset:50336
  v_mfma_f32_16x16x32_bf16 v[168:171], a[148:151], a[56:59], v[168:171]
  v_mfma_f32_16x16x32_bf16 v[172:175], a[148:151], a[60:63], v[172:175]
  ds_read_b64_tr_b16 a[134:135], v1 offset:53920
  v_mfma_f32_16x16x32_bf16 v[172:175], a[144:147], a[44:47], v[172:175]
  s_waitcnt vmcnt(20)
  s_barrier
  buffer_load_dwordx4 a[108:111], v0, s[36:39], s57 offen offset:3072 sc1
  s_bfe_u32 s56, s83, 0x40010
  v_mfma_f32_16x16x32_bf16 v[188:191], a[152:155], a[44:47], v[188:191]
  s_mul_i32 s56, s56, 458752
  s_add_u32 m0, s84, 0
  ds_read_b64_tr_b16 a[136:137], v1 offset:43200
  v_mfma_f32_16x16x32_bf16 v[188:191], a[156:159], a[60:63], v[188:191]
  v_mfma_f32_16x16x32_bf16 v[184:187], a[156:159], a[56:59], v[184:187]
  ds_read_b64_tr_b16 a[138:139], v1 offset:46784
  v_mfma_f32_16x16x32_bf16 v[184:187], a[152:155], a[40:43], v[184:187]
  v_mfma_f32_16x16x32_bf16 v[180:183], a[152:155], a[36:39], v[180:183]
  buffer_load_dwordx4 v3, s[16:19], s56 offen offset:0 lds
  s_add_u32 s57, s57, 4096
  v_mfma_f32_16x16x32_bf16 v[180:183], a[156:159], a[52:55], v[180:183]
  ds_read_b64_tr_b16 a[140:141], v1 offset:50368
  v_mfma_f32_16x16x32_bf16 v[176:179], a[156:159], a[48:51], v[176:179]
  ds_read_b64_tr_b16 a[142:143], v1 offset:53952
  v_mfma_f32_16x16x32_bf16 v[176:179], a[152:155], a[32:35], v[176:179]
  s_waitcnt lgkmcnt(8)
  v_mfma_f32_16x16x32_bf16 v[192:195], a[160:163], a[32:35], v[192:195]
  ds_read_b64_tr_b16 a[144:145], v2 offset:0
  v_mfma_f32_16x16x32_bf16 v[192:195], a[164:167], a[48:51], v[192:195]
  buffer_load_dwordx4 a[112:115], v0, s[36:39], s57 offen offset:0 sc1
  v_mfma_f32_16x16x32_bf16 v[196:199], a[164:167], a[52:55], v[196:199]
  ds_read_b64_tr_b16 a[146:147], v2 offset:3584
  v_mfma_f32_16x16x32_bf16 v[196:199], a[160:163], a[36:39], v[196:199]
  v_mfma_f32_16x16x32_bf16 v[200:203], a[160:163], a[40:43], v[200:203]
  ds_read_b64_tr_b16 a[148:149], v2 offset:7168
  v_mfma_f32_16x16x32_bf16 v[200:203], a[164:167], a[56:59], v[200:203]
  v_mfma_f32_16x16x32_bf16 v[204:207], a[164:167], a[60:63], v[204:207]
  buffer_load_dwordx4 v4, s[16:19], s56 offen offset:1024 lds
  v_mfma_f32_16x16x32_bf16 v[204:207], a[160:163], a[44:47], v[204:207]
  ds_read_b64_tr_b16 a[150:151], v2 offset:10752
  v_mfma_f32_16x16x32_bf16 v[220:223], a[168:171], a[44:47], v[220:223]
  ds_read_b64_tr_b16 a[152:153], v2 offset:32
  v_mfma_f32_16x16x32_bf16 v[220:223], a[172:175], a[60:63], v[220:223]
  v_mfma_f32_16x16x32_bf16 v[216:219], a[172:175], a[56:59], v[216:219]
  ds_read_b64_tr_b16 a[154:155], v2 offset:3616
  v_mfma_f32_16x16x32_bf16 v[216:219], a[168:171], a[40:43], v[216:219]
  buffer_load_dwordx4 a[116:119], v0, s[36:39], s57 offen offset:1024 sc1
  v_mfma_f32_16x16x32_bf16 v[212:215], a[168:171], a[36:39], v[212:215]
  ds_read_b64_tr_b16 a[156:157], v2 offset:7200
  v_mfma_f32_16x16x32_bf16 v[212:215], a[172:175], a[52:55], v[212:215]
  v_mfma_f32_16x16x32_bf16 v[208:211], a[172:175], a[48:51], v[208:211]
  ds_read_b64_tr_b16 a[158:159], v2 offset:10784
  v_mfma_f32_16x16x32_bf16 v[208:211], a[168:171], a[32:35], v[208:211]
  s_waitcnt lgkmcnt(8)
  v_mfma_f32_16x16x32_bf16 v[224:227], a[128:131], a[32:35], v[224:227]
  buffer_load_dwordx4 a[120:123], v0, s[36:39], s57 offen offset:2048 sc1
  v_mfma_f32_16x16x32_bf16 v[224:227], a[132:135], a[48:51], v[224:227]
  ds_read_b64_tr_b16 a[160:161], v2 offset:64
  v_mfma_f32_16x16x32_bf16 v[228:231], a[132:135], a[52:55], v[228:231]
  ds_read_b64_tr_b16 a[162:163], v2 offset:3648
  v_mfma_f32_16x16x32_bf16 v[228:231], a[128:131], a[36:39], v[228:231]
  v_mfma_f32_16x16x32_bf16 v[232:235], a[128:131], a[40:43], v[232:235]
  ds_read_b64_tr_b16 a[164:165], v2 offset:7232
  v_mfma_f32_16x16x32_bf16 v[232:235], a[132:135], a[56:59], v[232:235]
  buffer_load_dwordx4 v5, s[16:19], s56 offen offset:2048 lds
  v_mfma_f32_16x16x32_bf16 v[236:239], a[132:135], a[60:63], v[236:239]
  ds_read_b64_tr_b16 a[166:167], v2 offset:10816
  v_mfma_f32_16x16x32_bf16 v[236:239], a[128:131], a[44:47], v[236:239]
  v_mfma_f32_16x16x32_bf16 v[252:255], a[136:139], a[44:47], v[252:255]
  ds_read_b64_tr_b16 a[168:169], v2 offset:96
  v_mfma_f32_16x16x32_bf16 v[252:255], a[140:143], a[60:63], v[252:255]
  v_mfma_f32_16x16x32_bf16 v[248:251], a[140:143], a[56:59], v[248:251]
  buffer_load_dwordx4 a[124:127], v0, s[36:39], s57 offen offset:3072 sc1
  v_mfma_f32_16x16x32_bf16 v[248:251], a[136:139], a[40:43], v[248:251]
  ds_read_b64_tr_b16 a[170:171], v2 offset:3680
  v_mfma_f32_16x16x32_bf16 v[244:247], a[136:139], a[36:39], v[244:247]
  ds_read_b64_tr_b16 a[172:173], v2 offset:7264
  v_mfma_f32_16x16x32_bf16 v[244:247], a[140:143], a[52:55], v[244:247]
  v_mfma_f32_16x16x32_bf16 v[240:243], a[140:143], a[48:51], v[240:243]
  ds_read_b64_tr_b16 a[174:175], v2 offset:10848
  v_mfma_f32_16x16x32_bf16 v[240:243], a[136:139], a[32:35], v[240:243]
  s_waitcnt vmcnt(17) lgkmcnt(8)
  buffer_load_dwordx4 v6, s[16:19], s56 offen offset:3072 lds
  s_bfe_u32 s57, s83, 0x40010
  v_mfma_f32_16x16x32_bf16 v[32:35], a[144:147], a[64:67], v[32:35]
  s_lshl_b32 s57, s57, 13
  s_add_u32 s57, s57, s85
  ds_read_b64_tr_b16 a[128:129], v2 offset:128
  v_mfma_f32_16x16x32_bf16 v[32:35], a[148:151], a[80:83], v[32:35]
  s_barrier
  v_mfma_f32_16x16x32_bf16 v[36:39], a[148:151], a[84:87], v[36:39]
  ds_read_b64_tr_b16 a[130:131], v2 offset:3712
  v_mfma_f32_16x16x32_bf16 v[36:39], a[144:147], a[68:71], v[36:39]
  v_mfma_f32_16x16x32_bf16 v[40:43], a[144:147], a[72:75], v[40:43]
  buffer_load_dwordx4 a[0:3], v0, s[36:39], s57 offen offset:0 sc1
  v_mfma_f32_16x16x32_bf16 v[40:43], a[148:151], a[88:91], v[40:43]
  s_add_u32 m0, s84, 4096
  ds_read_b64_tr_b16 a[132:133], v2 offset:7296
  v_mfma_f32_16x16x32_bf16 v[44:47], a[148:151], a[92:95], v[44:47]
  ds_read_b64_tr_b16 a[134:135], v2 offset:10880
  v_mfma_f32_16x16x32_bf16 v[44:47], a[144:147], a[76:79], v[44:47]
  v_mfma_f32_16x16x32_bf16 v[60:63], a[152:155], a[76:79], v[60:63]
  ds_read_b64_tr_b16 a[136:137], v2 offset:160
  v_mfma_f32_16x16x32_bf16 v[60:63], a[156:159], a[92:95], v[60:63]
  buffer_load_dwordx4 v7, s[16:19], s56 offen offset:0 lds
  v_mfma_f32_16x16x32_bf16 v[56:59], a[156:159], a[88:91], v[56:59]
  ds_read_b64_tr_b16 a[138:139], v2 offset:3744
  v_mfma_f32_16x16x32_bf16 v[56:59], a[152:155], a[72:75], v[56:59]
  v_mfma_f32_16x16x32_bf16 v[52:55], a[152:155], a[68:71], v[52:55]
  ds_read_b64_tr_b16 a[140:141], v2 offset:7328
  v_mfma_f32_16x16x32_bf16 v[52:55], a[156:159], a[84:87], v[52:55]
  v_mfma_f32_16x16x32_bf16 v[48:51], a[156:159], a[80:83], v[48:51]
  buffer_load_dwordx4 a[4:7], v0, s[36:39], s57 offen offset:1024 sc1
  v_mfma_f32_16x16x32_bf16 v[48:51], a[152:155], a[64:67], v[48:51]
  s_waitcnt lgkmcnt(7)
  ds_read_b64_tr_b16 a[142:143], v2 offset:10912
  v_mfma_f32_16x16x32_bf16 v[64:67], a[160:163], a[64:67], v[64:67]
  ds_read_b64_tr_b16 a[144:145], v2 offset:192
  v_mfma_f32_16x16x32_bf16 v[64:67], a[164:167], a[80:83], v[64:67]
  v_mfma_f32_16x16x32_bf16 v[68:71], a[164:167], a[84:87], v[68:71]
  ds_read_b64_tr_b16 a[146:147], v2 offset:3776
  v_mfma_f32_16x16x32_bf16 v[68:71], a[160:163], a[68:71], v[68:71]
  v_mfma_f32_16x16x32_bf16 v[72:75], a[160:163], a[72:75], v[72:75]
  buffer_load_dwordx4 a[8:11], v0, s[36:39], s57 offen offset:2048 sc1
  v_mfma_f32_16x16x32_bf16 v[72:75], a[164:167], a[88:91], v[72:75]
  ds_read_b64_tr_b16 a[148:149], v2 offset:7360
  v_mfma_f32_16x16x32_bf16 v[76:79], a[164:167], a[92:95], v[76:79]
  ds_read_b64_tr_b16 a[150:151], v2 offset:10944
  v_mfma_f32_16x16x32_bf16 v[76:79], a[160:163], a[76:79], v[76:79]
  v_mfma_f32_16x16x32_bf16 v[92:95], a[168:171], a[76:79], v[92:95]
  ds_read_b64_tr_b16 a[152:153], v2 offset:14336
  v_mfma_f32_16x16x32_bf16 v[92:95], a[172:175], a[92:95], v[92:95]
  buffer_load_dwordx4 v8, s[16:19], s56 offen offset:1024 lds
  v_mfma_f32_16x16x32_bf16 v[88:91], a[172:175], a[88:91], v[88:91]
  ds_read_b64_tr_b16 a[154:155], v2 offset:17920
  v_mfma_f32_16x16x32_bf16 v[88:91], a[168:171], a[72:75], v[88:91]
  v_mfma_f32_16x16x32_bf16 v[84:87], a[168:171], a[68:71], v[84:87]
  ds_read_b64_tr_b16 a[156:157], v2 offset:21504
  v_mfma_f32_16x16x32_bf16 v[84:87], a[172:175], a[84:87], v[84:87]
  v_mfma_f32_16x16x32_bf16 v[80:83], a[172:175], a[80:83], v[80:83]
  buffer_load_dwordx4 a[12:15], v0, s[36:39], s57 offen offset:3072 sc1
  v_mfma_f32_16x16x32_bf16 v[80:83], a[168:171], a[64:67], v[80:83]
  s_waitcnt lgkmcnt(7)
  ds_read_b64_tr_b16 a[158:159], v2 offset:25088
  v_mfma_f32_16x16x32_bf16 v[96:99], a[128:131], a[64:67], v[96:99]
  ds_read_b64_tr_b16 a[160:161], v2 offset:14368
  v_mfma_f32_16x16x32_bf16 v[96:99], a[132:135], a[80:83], v[96:99]
  v_mfma_f32_16x16x32_bf16 v[100:103], a[132:135], a[84:87], v[100:103]
  ds_read_b64_tr_b16 a[162:163], v2 offset:17952
  v_mfma_f32_16x16x32_bf16 v[100:103], a[128:131], a[68:71], v[100:103]
  buffer_load_dwordx4 v9, s[16:19], s56 offen offset:2048 lds
  v_mfma_f32_16x16x32_bf16 v[104:107], a[128:131], a[72:75], v[104:107]
  s_add_u32 s57, s57, 4096
  ds_read_b64_tr_b16 a[164:165], v2 offset:21536
  v_mfma_f32_16x16x32_bf16 v[104:107], a[132:135], a[88:91], v[104:107]
  v_mfma_f32_16x16x32_bf16 v[108:111], a[132:135], a[92:95], v[108:111]
  ds_read_b64_tr_b16 a[166:167], v2 offset:25120
  v_mfma_f32_16x16x32_bf16 v[108:111], a[128:131], a[76:79], v[108:111]
  v_mfma_f32_16x16x32_bf16 v[124:127], a[136:139], a[76:79], v[124:127]
  buffer_load_dwordx4 a[16:19], v0, s[36:39], s57 offen offset:0 sc1
  v_mfma_f32_16x16x32_bf16 v[124:127], a[140:143], a[92:95], v[124:127]
  ds_read_b64_tr_b16 a[168:169], v2 offset:14400
  v_mfma_f32_16x16x32_bf16 v[120:123], a[140:143], a[88:91], v[120:123]
  ds_read_b64_tr_b16 a[170:171], v2 offset:17984
  v_mfma_f32_16x16x32_bf16 v[120:123], a[136:139], a[72:75], v[120:123]
  v_mfma_f32_16x16x32_bf16 v[116:119], a[136:139], a[68:71], v[116:119]
  ds_read_b64_tr_b16 a[172:173], v2 offset:21568
  v_mfma_f32_16x16x32_bf16 v[116:119], a[140:143], a[84:87], v[116:119]
  v_mfma_f32_16x16x32_bf16 v[112:115], a[140:143], a[80:83], v[112:115]
  ds_read_b64_tr_b16 a[174:175], v2 offset:25152
  v_mfma_f32_16x16x32_bf16 v[112:115], a[136:139], a[64:67], v[112:115]
  s_waitcnt lgkmcnt(8)
  v_mfma_f32_16x16x32_bf16 v[128:131], a[144:147], a[64:67], v[128:131]
  ds_read_b64_tr_b16 a[128:129], v2 offset:14432
  v_mfma_f32_16x16x32_bf16 v[128:131], a[148:151], a[80:83], v[128:131]
  v_mfma_f32_16x16x32_bf16 v[132:135], a[148:151], a[84:87], v[132:135]
  buffer_load_dwordx4 a[20:23], v0, s[36:39], s57 offen offset:1024 sc1
  s_bfe_u32 s56, s83, 0x40014
  v_mfma_f32_16x16x32_bf16 v[132:135], a[144:147], a[68:71], v[132:135]
  s_mul_i32 s56, s56, 458752
  s_add_u32 m0, s84, 28672
  ds_read_b64_tr_b16 a[130:131], v2 offset:18016
  v_mfma_f32_16x16x32_bf16 v[136:139], a[144:147], a[72:75], v[136:139]
  ds_read_b64_tr_b16 a[132:133], v2 offset:21600
  v_mfma_f32_16x16x32_bf16 v[136:139], a[148:151], a[88:91], v[136:139]
  v_mfma_f32_16x16x32_bf16 v[140:143], a[148:151], a[92:95], v[140:143]
  ds_read_b64_tr_b16 a[134:135], v2 offset:25184
  v_mfma_f32_16x16x32_bf16 v[140:143], a[144:147], a[76:79], v[140:143]
  buffer_load_dwordx4 v3, s[16:19], s56 offen offset:0 lds
  v_mfma_f32_16x16x32_bf16 v[156:159], a[152:155], a[76:79], v[156:159]
  ds_read_b64_tr_b16 a[136:137], v2 offset:14464
  v_mfma_f32_16x16x32_bf16 v[156:159], a[156:159], a[92:95], v[156:159]
  v_mfma_f32_16x16x32_bf16 v[152:155], a[156:159], a[88:91], v[152:155]
  ds_read_b64_tr_b16 a[138:139], v2 offset:18048
  v_mfma_f32_16x16x32_bf16 v[152:155], a[152:155], a[72:75], v[152:155]
  v_mfma_f32_16x16x32_bf16 v[148:151], a[152:155], a[68:71], v[148:151]
  buffer_load_dwordx4 a[24:27], v0, s[36:39], s57 offen offset:2048 sc1
  v_mfma_f32_16x16x32_bf16 v[148:151], a[156:159], a[84:87], v[148:151]
  ds_read_b64_tr_b16 a[140:141], v2 offset:21632
  v_mfma_f32_16x16x32_bf16 v[144:147], a[156:159], a[80:83], v[144:147]
  ds_read_b64_tr_b16 a[142:143], v2 offset:25216
  v_mfma_f32_16x16x32_bf16 v[144:147], a[152:155], a[64:67], v[144:147]
  s_waitcnt lgkmcnt(8)
  v_mfma_f32_16x16x32_bf16 v[160:163], a[160:163], a[64:67], v[160:163]
  ds_read_b64_tr_b16 a[144:145], v2 offset:14496
  v_mfma_f32_16x16x32_bf16 v[160:163], a[164:167], a[80:83], v[160:163]
  buffer_load_dwordx4 v4, s[16:19], s56 offen offset:1024 lds
  v_mfma_f32_16x16x32_bf16 v[164:167], a[164:167], a[84:87], v[164:167]
  ds_read_b64_tr_b16 a[146:147], v2 offset:18080
  v_mfma_f32_16x16x32_bf16 v[164:167], a[160:163], a[68:71], v[164:167]
  v_mfma_f32_16x16x32_bf16 v[168:171], a[160:163], a[72:75], v[168:171]
  ds_read_b64_tr_b16 a[148:149], v2 offset:21664
  v_mfma_f32_16x16x32_bf16 v[168:171], a[164:167], a[88:91], v[168:171]
  v_mfma_f32_16x16x32_bf16 v[172:175], a[164:167], a[92:95], v[172:175]
  buffer_load_dwordx4 a[28:31], v0, s[36:39], s57 offen offset:3072 sc1
  v_mfma_f32_16x16x32_bf16 v[172:175], a[160:163], a[76:79], v[172:175]
  s_waitcnt vmcnt(23)
  s_barrier
  ds_read_b64_tr_b16 a[150:151], v2 offset:25248
  v_mfma_f32_16x16x32_bf16 v[188:191], a[168:171], a[76:79], v[188:191]
  ds_read_b64_tr_b16 a[152:153], v2 offset:14528
  v_mfma_f32_16x16x32_bf16 v[188:191], a[172:175], a[92:95], v[188:191]
  v_mfma_f32_16x16x32_bf16 v[184:187], a[172:175], a[88:91], v[184:187]
  ds_read_b64_tr_b16 a[154:155], v2 offset:18112
  v_mfma_f32_16x16x32_bf16 v[184:187], a[168:171], a[72:75], v[184:187]
  buffer_load_dwordx4 v5, s[16:19], s56 offen offset:2048 lds
  s_bfe_u32 s57, s83, 0x40014
  v_mfma_f32_16x16x32_bf16 v[180:183], a[168:171], a[68:71], v[180:183]
  s_lshl_b32 s57, s57, 13
  s_add_u32 s57, s57, s85
  ds_read_b64_tr_b16 a[156:157], v2 offset:21696
  v_mfma_f32_16x16x32_bf16 v[180:183], a[172:175], a[84:87], v[180:183]
Hb1_1:
  s_cbranch_execz Hb1_2
  v_mfma_f32_16x16x32_bf16 v[176:179], a[172:175], a[80:83], v[176:179]
  ds_read_b64_tr_b16 a[158:159], v2 offset:25280
  v_mfma_f32_16x16x32_bf16 v[176:179], a[168:171], a[64:67], v[176:179]
  s_waitcnt lgkmcnt(8)
  v_mfma_f32_16x16x32_bf16 v[192:195], a[128:131], a[64:67], v[192:195]
  buffer_load_dwordx4 a[32:35], v0, s[36:39], s57 offen offset:0 sc1
  v_mfma_f32_16x16x32_bf16 v[192:195], a[132:135], a[80:83], v[192:195]
  ds_read_b64_tr_b16 a[160:161], v2 offset:28672
  v_mfma_f32_16x16x32_bf16 v[196:199], a[132:135], a[84:87], v[196:199]
  ds_read_b64_tr_b16 a[162:163], v2 offset:32256
  v_mfma_f32_16x16x32_bf16 v[196:199], a[128:131], a[68:71], v[196:199]
  v_mfma_f32_16x16x32_bf16 v[200:203], a[128:131], a[72:75], v[200:203]
  ds_read_b64_tr_b16 a[164:165], v2 offset:35840
  v_mfma_f32_16x16x32_bf16 v[200:203], a[132:135], a[88:91], v[200:203]
  buffer_load_dwordx4 a[36:39], v0, s[36:39], s57 offen offset:1024 sc1
  v_mfma_f32_16x16x32_bf16 v[204:207], a[132:135], a[92:95], v[204:207]
  ds_read_b64_tr_b16 a[166:167], v2 offset:39424
  v_mfma_f32_16x16x32_bf16 v[204:207], a[128:131], a[76:79], v[204:207]
  v_mfma_f32_16x16x32_bf16 v[220:223], a[136:139], a[76:79], v[220:223]
  ds_read_b64_tr_b16 a[168:169], v2 offset:28704
  v_mfma_f32_16x16x32_bf16 v[220:223], a[140:143], a[92:95], v[220:223]
  v_mfma_f32_16x16x32_bf16 v[216:219], a[140:143], a[88:91], v[216:219]
  buffer_load_dwordx4 v6, s[16:19], s56 offen offset:3072 lds
  v_mfma_f32_16x16x32_bf16 v[216:219], a[136:139], a[72:75], v[216:219]
  ds_read_b64_tr_b16 a[170:171], v2 offset:32288
  v_mfma_f32_16x16x32_bf16 v[212:215], a[136:139], a[68:71], v[212:215]
  ds_read_b64_tr_b16 a[172:173], v2 offset:35872
  v_mfma_f32_16x16x32_bf16 v[212:215], a[140:143], a[84:87], v[212:215]
  v_mfma_f32_16x16x32_bf16 v[208:211], a[140:143], a[80:83], v[208:211]
  ds_read_b64_tr_b16 a[174:175], v2 offset:39456
  v_mfma_f32_16x16x32_bf16 v[208:211], a[136:139], a[64:67], v[208:211]
  s_waitcnt lgkmcnt(8)
  buffer_load_dwordx4 a[40:43], v0, s[36:39], s57 offen offset:2048 sc1
  s_add_u32 m0, s84, 32768
  v_mfma_f32_16x16x32_bf16 v[224:227], a[144:147], a[64:67], v[224:227]
  ds_read_b64_tr_b16 a[128:129], v2 offset:28736
  v_mfma_f32_16x16x32_bf16 v[224:227], a[148:151], a[80:83], v[224:227]
  v_mfma_f32_16x16x32_bf16 v[228:231], a[148:151], a[84:87], v[228:231]
  ds_read_b64_tr_b16 a[130:131], v2 offset:32320
  v_mfma_f32_16x16x32_bf16 v[228:231], a[144:147], a[68:71], v[228:231]
  v_mfma_f32_16x16x32_bf16 v[232:235], a[144:147], a[72:75], v[232:235]
  buffer_load_dwordx4 v7, s[16:19], s56 offen offset:0 lds
  v_mfma_f32_16x16x32_bf16 v[232:235], a[148:151], a[88:91], v[232:235]
  ds_read_b64_tr_b16 a[132:133], v2 offset:35904
  v_mfma_f32_16x16x32_bf16 v[236:239], a[148:151], a[92:95], v[236:239]
  ds_read_b64_tr_b16 a[134:135], v2 offset:39488
  v_mfma_f32_16x16x32_bf16 v[236:239], a[144:147], a[76:79], v[236:239]
  v_mfma_f32_16x16x32_bf16 v[252:255], a[152:155], a[76:79], v[252:255]
  ds_read_b64_tr_b16 a[136:137], v2 offset:28768
  v_mfma_f32_16x16x32_bf16 v[252:255], a[156:159], a[92:95], v[252:255]
  buffer_load_dwordx4 a[44:47], v0, s[36:39], s57 offen offset:3072 sc1
  v_mfma_f32_16x16x32_bf16 v[248:251], a[156:159], a[88:91], v[248:251]
  ds_read_b64_tr_b16 a[138:139], v2 offset:32352
  v_mfma_f32_16x16x32_bf16 v[248:251], a[152:155], a[72:75], v[248:251]
  v_mfma_f32_16x16x32_bf16 v[244:247], a[152:155], a[68:71], v[244:247]
  ds_read_b64_tr_b16 a[140:141], v2 offset:35936
  v_mfma_f32_16x16x32_bf16 v[244:247], a[156:159], a[84:87], v[244:247]
  v_mfma_f32_16x16x32_bf16 v[240:243], a[156:159], a[80:83], v[240:243]
  ds_read_b64_tr_b16 a[142:143], v2 offset:39520
  v_mfma_f32_16x16x32_bf16 v[240:243], a[152:155], a[64:67], v[240:243]
  s_waitcnt vmcnt(21) lgkmcnt(8)
  buffer_load_dwordx4 v8, s[16:19], s56 offen offset:1024 lds
  s_add_u32 s57, s57, 4096
  v_mfma_f32_16x16x32_bf16 v[32:35], a[160:163], a[96:99], v[32:35]
  ds_read_b64_tr_b16 a[144:145], v2 offset:28800
  v_mfma_f32_16x16x32_bf16 v[32:35], a[164:167], a[112:115], v[32:35]
  s_barrier
  v_mfma_f32_16x16x32_bf16 v[36:39], a[164:167], a[116:119], v[36:39]
  ds_read_b64_tr_b16 a[146:147], v2 offset:32384
  v_mfma_f32_16x16x32_bf16 v[36:39], a[160:163], a[100:103], v[36:39]
  v_mfma_f32_16x16x32_bf16 v[40:43], a[160:163], a[104:107], v[40:43]
  buffer_load_dwordx4 a[48:51], v0, s[36:39], s57 offen offset:0 sc1
  v_mfma_f32_16x16x32_bf16 v[40:43], a[164:167], a[120:123], v[40:43]
  ds_read_b64_tr_b16 a[148:149], v2 offset:35968
  v_mfma_f32_16x16x32_bf16 v[44:47], a[164:167], a[124:127], v[44:47]
  ds_read_b64_tr_b16 a[150:151], v2 offset:39552
  v_mfma_f32_16x16x32_bf16 v[44:47], a[160:163], a[108:111], v[44:47]
  v_mfma_f32_16x16x32_bf16 v[60:63], a[168:171], a[108:111], v[60:63]
  ds_read_b64_tr_b16 a[152:153], v2 offset:28832
  v_mfma_f32_16x16x32_bf16 v[60:63], a[172:175], a[124:127], v[60:63]
  v_mfma_f32_16x16x32_bf16 v[56:59], a[172:175], a[120:123], v[56:59]
  ds_read_b64_tr_b16 a[154:155], v2 offset:32416
  v_mfma_f32_16x16x32_bf16 v[56:59], a[168:171], a[104:107], v[56:59]
  buffer_load_dwordx4 v9, s[16:19], s56 offen offset:2048 lds
  v_mfma_f32_16x16x32_bf16 v[52:55], a[168:171], a[100:103], v[52:55]
  ds_read_b64_tr_b16 a[156:157], v2 offset:36000
  v_mfma_f32_16x16x32_bf16 v[52:55], a[172:175], a[116:119], v[52:55]
  v_mfma_f32_16x16x32_bf16 v[48:51], a[172:175], a[112:115], v[48:51]
  ds_read_b64_tr_b16 a[158:159], v2 offset:39584
  v_mfma_f32_16x16x32_bf16 v[48:51], a[168:171], a[96:99], v[48:51]
  s_waitcnt lgkmcnt(8)
  v_mfma_f32_16x16x32_bf16 v[64:67], a[128:131], a[96:99], v[64:67]
  buffer_load_dwordx4 a[52:55], v0, s[36:39], s57 offen offset:1024 sc1
  v_mfma_f32_16x16x32_bf16 v[64:67], a[132:135], a[112:115], v[64:67]
  ds_read_b64_tr_b16 a[160:161], v2 offset:28864
  v_mfma_f32_16x16x32_bf16 v[68:71], a[132:135], a[116:119], v[68:71]
  ds_read_b64_tr_b16 a[162:163], v2 offset:32448
  v_mfma_f32_16x16x32_bf16 v[68:71], a[128:131], a[100:103], v[68:71]
  v_mfma_f32_16x16x32_bf16 v[72:75], a[128:131], a[104:107], v[72:75]
  ds_read_b64_tr_b16 a[164:165], v2 offset:36032
  v_mfma_f32_16x16x32_bf16 v[72:75], a[132:135], a[120:123], v[72:75]
  v_mfma_f32_16x16x32_bf16 v[76:79], a[132:135], a[124:127], v[76:79]
  buffer_load_dwordx4 a[56:59], v0, s[36:39], s57 offen offset:2048 sc1
  v_mfma_f32_16x16x32_bf16 v[76:79], a[128:131], a[108:111], v[76:79]
  ds_read_b64_tr_b16 a[166:167], v2 offset:39616
  v_mfma_f32_16x16x32_bf16 v[92:95], a[136:139], a[108:111], v[92:95]
  s_bfe_u32 s56, s83, 0x40018
  s_mul_i32 s56, s56, 458752
  s_add_u32 m0, s84, 57344
  v_mfma_f32_16x16x32_bf16 v[92:95], a[140:143], a[124:127], v[92:95]
  ds_read_b64_tr_b16 a[168:169], v2 offset:43008
  v_mfma_f32_16x16x32_bf16 v[88:91], a[140:143], a[120:123], v[88:91]
  ds_read_b64_tr_b16 a[170:171], v2 offset:46592
  v_mfma_f32_16x16x32_bf16 v[88:91], a[136:139], a[104:107], v[88:91]
  v_mfma_f32_16x16x32_bf16 v[84:87], a[136:139], a[100:103], v[84:87]
  buffer_load_dwordx4 v3, s[16:19], s56 offen offset:0 lds
  v_mfma_f32_16x16x32_bf16 v[84:87], a[140:143], a[116:119], v[84:87]
  ds_read_b64_tr_b16 a[172:173], v2 offset:50176
  v_mfma_f32_16x16x32_bf16 v[80:83], a[140:143], a[112:115], v[80:83]
  ds_read_b64_tr_b16 a[174:175], v2 offset:53760
  v_mfma_f32_16x16x32_bf16 v[80:83], a[136:139], a[96:99], v[80:83]
  s_waitcnt lgkmcnt(8)
  v_mfma_f32_16x16x32_bf16 v[96:99], a[144:147], a[96:99], v[96:99]
  ds_read_b64_tr_b16 a[128:129], v2 offset:43040
  v_mfma_f32_16x16x32_bf16 v[96:99], a[148:151], a[112:115], v[96:99]
  buffer_load_dwordx4 a[60:63], v0, s[36:39], s57 offen offset:3072 sc1
  s_bfe_u32 s57, s83, 0x40018
  v_mfma_f32_16x16x32_bf16 v[100:103], a[148:151], a[116:119], v[100:103]
  s_lshl_b32 s57, s57, 13
  s_add_u32 s57, s57, s85
  ds_read_b64_tr_b16 a[130:131], v2 offset:46624
  v_mfma_f32_16x16x32_bf16 v[100:103], a[144:147], a[100:103], v[100:103]
  v_mfma_f32_16x16x32_bf16 v[104:107], a[144:147], a[104:107], v[104:107]
  buffer_load_dwordx4 a[208:211], v25, s[36:39], s77 offen offset:0 sc1
  v_mfma_f32_16x16x32_bf16 v[104:107], a[148:151], a[120:123], v[104:107]
  ds_read_b64_tr_b16 a[132:133], v2 offset:50208
  v_mfma_f32_16x16x32_bf16 v[108:111], a[148:151], a[124:127], v[108:111]
  ds_read_b64_tr_b16 a[134:135], v2 offset:53792
  v_mfma_f32_16x16x32_bf16 v[108:111], a[144:147], a[108:111], v[108:111]
  v_mfma_f32_16x16x32_bf16 v[124:127], a[152:155], a[108:111], v[124:127]
  ds_read_b64_tr_b16 a[136:137], v2 offset:43072
  v_mfma_f32_16x16x32_bf16 v[124:127], a[156:159], a[124:127], v[124:127]
  buffer_load_dwordx4 a[212:215], v25, s[36:39], s77 offen offset:2048 sc1
  v_mfma_f32_16x16x32_bf16 v[120:123], a[156:159], a[120:123], v[120:123]
  ds_read_b64_tr_b16 a[138:139], v2 offset:46656
  v_mfma_f32_16x16x32_bf16 v[120:123], a[152:155], a[104:107], v[120:123]
  v_mfma_f32_16x16x32_bf16 v[116:119], a[152:155], a[100:103], v[116:119]
  ds_read_b64_tr_b16 a[140:141], v2 offset:50240
  v_mfma_f32_16x16x32_bf16 v[116:119], a[156:159], a[116:119], v[116:119]
  v_mfma_f32_16x16x32_bf16 v[112:115], a[156:159], a[112:115], v[112:115]
  buffer_load_dwordx4 a[216:219], v25, s[36:39], s76 offen offset:0 sc1
  v_mfma_f32_16x16x32_bf16 v[112:115], a[152:155], a[96:99], v[112:115]
  s_waitcnt lgkmcnt(7)
  ds_read_b64_tr_b16 a[142:143], v2 offset:53824
  v_mfma_f32_16x16x32_bf16 v[128:131], a[160:163], a[96:99], v[128:131]
  ds_read_b64_tr_b16 a[144:145], v2 offset:43104
  v_mfma_f32_16x16x32_bf16 v[128:131], a[164:167], a[112:115], v[128:131]
  v_mfma_f32_16x16x32_bf16 v[132:135], a[164:167], a[116:119], v[132:135]
  ds_read_b64_tr_b16 a[146:147], v2 offset:46688
  v_mfma_f32_16x16x32_bf16 v[132:135], a[160:163], a[100:103], v[132:135]
  buffer_load_dwordx4 a[220:223], v25, s[36:39], s76 offen offset:2048 sc1
  v_mfma_f32_16x16x32_bf16 v[136:139], a[160:163], a[104:107], v[136:139]
  ds_read_b64_tr_b16 a[148:149], v2 offset:50272
  v_mfma_f32_16x16x32_bf16 v[136:139], a[164:167], a[120:123], v[136:139]
  v_mfma_f32_16x16x32_bf16 v[140:143], a[164:167], a[124:127], v[140:143]
  ds_read_b64_tr_b16 a[150:151], v2 offset:53856
  v_mfma_f32_16x16x32_bf16 v[140:143], a[160:163], a[108:111], v[140:143]
  v_mfma_f32_16x16x32_bf16 v[156:159], a[168:171], a[108:111], v[156:159]
  buffer_load_dwordx4 a[64:67], v0, s[36:39], s57 offen offset:0 sc1
  v_mfma_f32_16x16x32_bf16 v[156:159], a[172:175], a[124:127], v[156:159]
  ds_read_b64_tr_b16 a[152:153], v2 offset:43136
  v_mfma_f32_16x16x32_bf16 v[152:155], a[172:175], a[120:123], v[152:155]
  ds_read_b64_tr_b16 a[154:155], v2 offset:46720
  v_mfma_f32_16x16x32_bf16 v[152:155], a[168:171], a[104:107], v[152:155]
  v_mfma_f32_16x16x32_bf16 v[148:151], a[168:171], a[100:103], v[148:151]
  ds_read_b64_tr_b16 a[156:157], v2 offset:50304
  v_mfma_f32_16x16x32_bf16 v[148:151], a[172:175], a[116:119], v[148:151]
  buffer_load_dwordx4 v4, s[16:19], s56 offen offset:1024 lds
  v_mfma_f32_16x16x32_bf16 v[144:147], a[172:175], a[112:115], v[144:147]
  ds_read_b64_tr_b16 a[158:159], v2 offset:53888
  v_mfma_f32_16x16x32_bf16 v[144:147], a[168:171], a[96:99], v[144:147]
  s_waitcnt lgkmcnt(8)
  v_mfma_f32_16x16x32_bf16 v[160:163], a[128:131], a[96:99], v[160:163]
  ds_read_b64_tr_b16 a[160:161], v2 offset:43168
  v_mfma_f32_16x16x32_bf16 v[160:163], a[132:135], a[112:115], v[160:163]
  v_mfma_f32_16x16x32_bf16 v[164:167], a[132:135], a[116:119], v[164:167]
  buffer_load_dwordx4 a[68:71], v0, s[36:39], s57 offen offset:1024 sc1
  v_mfma_f32_16x16x32_bf16 v[164:167], a[128:131], a[100:103], v[164:167]
  ds_read_b64_tr_b16 a[162:163], v2 offset:46752
  v_mfma_f32_16x16x32_bf16 v[168:171], a[128:131], a[104:107], v[168:171]
  ds_read_b64_tr_b16 a[164:165], v2 offset:50336
  v_mfma_f32_16x16x32_bf16 v[168:171], a[132:135], a[120:123], v[168:171]
  v_mfma_f32_16x16x32_bf16 v[172:175], a[132:135], a[124:127], v[172:175]
  ds_read_b64_tr_b16 a[166:167], v2 offset:53920
  v_mfma_f32_16x16x32_bf16 v[172:175], a[128:131], a[108:111], v[172:175]
  s_waitcnt vmcnt(27)
  s_barrier
  buffer_load_dwordx4 v5, s[16:19], s56 offen offset:2048 lds
  v_mfma_f32_16x16x32_bf16 v[188:191], a[136:139], a[108:111], v[188:191]
  ds_read_b64_tr_b16 a[168:169], v2 offset:43200
  v_mfma_f32_16x16x32_bf16 v[188:191], a[140:143], a[124:127], v[188:191]
  v_mfma_f32_16x16x32_bf16 v[184:187], a[140:143], a[120:123], v[184:187]
  ds_read_b64_tr_b16 a[170:171], v2 offset:46784
  v_mfma_f32_16x16x32_bf16 v[184:187], a[136:139], a[104:107], v[184:187]
  v_mfma_f32_16x16x32_bf16 v[180:183], a[136:139], a[100:103], v[180:183]
  buffer_load_dwordx4 a[72:75], v0, s[36:39], s57 offen offset:2048 sc1
  v_mfma_f32_16x16x32_bf16 v[180:183], a[140:143], a[116:119], v[180:183]
  ds_read_b64_tr_b16 a[172:173], v2 offset:50368
  v_mfma_f32_16x16x32_bf16 v[176:179], a[140:143], a[112:115], v[176:179]
  ds_read_b64_tr_b16 a[174:175], v2 offset:53952
  v_mfma_f32_16x16x32_bf16 v[176:179], a[136:139], a[96:99], v[176:179]
  s_waitcnt lgkmcnt(8)
  v_mfma_f32_16x16x32_bf16 v[192:195], a[144:147], a[96:99], v[192:195]
  ds_read_b64_tr_b16 a[128:129], v1 offset:0
  v_mfma_f32_16x16x32_bf16 v[192:195], a[148:151], a[112:115], v[192:195]
  buffer_load_dwordx4 v6, s[16:19], s56 offen offset:3072 lds
  v_mfma_f32_16x16x32_bf16 v[196:199], a[148:151], a[116:119], v[196:199]
  ds_read_b64_tr_b16 a[130:131], v1 offset:3584
  v_mfma_f32_16x16x32_bf16 v[196:199], a[144:147], a[100:103], v[196:199]
  v_mfma_f32_16x16x32_bf16 v[200:203], a[144:147], a[104:107], v[200:203]
  ds_read_b64_tr_b16 a[132:133], v1 offset:7168
  v_mfma_f32_16x16x32_bf16 v[200:203], a[148:151], a[120:123], v[200:203]
  v_mfma_f32_16x16x32_bf16 v[204:207], a[148:151], a[124:127], v[204:207]
  buffer_load_dwordx4 a[76:79], v0, s[36:39], s57 offen offset:3072 sc1
  s_add_u32 m0, s84, 61440
  v_mfma_f32_16x16x32_bf16 v[204:207], a[144:147], a[108:111], v[204:207]
  ds_read_b64_tr_b16 a[134:135], v1 offset:10752
  v_mfma_f32_16x16x32_bf16 v[220:223], a[152:155], a[108:111], v[220:223]
  ds_read_b64_tr_b16 a[136:137], v1 offset:32
  v_mfma_f32_16x16x32_bf16 v[220:223], a[156:159], a[124:127], v[220:223]
  v_mfma_f32_16x16x32_bf16 v[216:219], a[156:159], a[120:123], v[216:219]
  ds_read_b64_tr_b16 a[138:139], v1 offset:3616
  v_mfma_f32_16x16x32_bf16 v[216:219], a[152:155], a[104:107], v[216:219]
  buffer_load_dwordx4 v7, s[16:19], s56 offen offset:0 lds
  s_add_u32 s57, s57, 4096
  v_mfma_f32_16x16x32_bf16 v[212:215], a[152:155], a[100:103], v[212:215]
  ds_read_b64_tr_b16 a[140:141], v1 offset:7200
  v_mfma_f32_16x16x32_bf16 v[212:215], a[156:159], a[116:119], v[212:215]
  v_mfma_f32_16x16x32_bf16 v[208:211], a[156:159], a[112:115], v[208:211]
  ds_read_b64_tr_b16 a[142:143], v1 offset:10784
  v_mfma_f32_16x16x32_bf16 v[208:211], a[152:155], a[96:99], v[208:211]
  s_waitcnt lgkmcnt(8)
  v_mfma_f32_16x16x32_bf16 v[224:227], a[160:163], a[96:99], v[224:227]
  buffer_load_dwordx4 a[80:83], v0, s[36:39], s57 offen offset:0 sc1
  v_mfma_f32_16x16x32_bf16 v[224:227], a[164:167], a[112:115], v[224:227]
  ds_read_b64_tr_b16 a[144:145], v1 offset:64
  v_mfma_f32_16x16x32_bf16 v[228:231], a[164:167], a[116:119], v[228:231]
  ds_read_b64_tr_b16 a[146:147], v1 offset:3648
  v_mfma_f32_16x16x32_bf16 v[228:231], a[160:163], a[100:103], v[228:231]
  v_mfma_f32_16x16x32_bf16 v[232:235], a[160:163], a[104:107], v[232:235]
  ds_read_b64_tr_b16 a[148:149], v1 offset:7232
  v_mfma_f32_16x16x32_bf16 v[232:235], a[164:167], a[120:123], v[232:235]
  buffer_load_dwordx4 a[84:87], v0, s[36:39], s57 offen offset:1024 sc1
  v_mfma_f32_16x16x32_bf16 v[236:239], a[164:167], a[124:127], v[236:239]
  ds_read_b64_tr_b16 a[150:151], v1 offset:10816
  v_mfma_f32_16x16x32_bf16 v[236:239], a[160:163], a[108:111], v[236:239]
  v_mfma_f32_16x16x32_bf16 v[252:255], a[168:171], a[108:111], v[252:255]
  ds_read_b64_tr_b16 a[152:153], v1 offset:96
  v_mfma_f32_16x16x32_bf16 v[252:255], a[172:175], a[124:127], v[252:255]
  v_mfma_f32_16x16x32_bf16 v[248:251], a[172:175], a[120:123], v[248:251]
  buffer_load_dwordx4 v8, s[16:19], s56 offen offset:1024 lds
  v_mfma_f32_16x16x32_bf16 v[248:251], a[168:171], a[104:107], v[248:251]
  ds_read_b64_tr_b16 a[154:155], v1 offset:3680
  v_mfma_f32_16x16x32_bf16 v[244:247], a[168:171], a[100:103], v[244:247]
  ds_read_b64_tr_b16 a[156:157], v1 offset:7264
  v_mfma_f32_16x16x32_bf16 v[244:247], a[172:175], a[116:119], v[244:247]
  v_mfma_f32_16x16x32_bf16 v[240:243], a[172:175], a[112:115], v[240:243]
  ds_read_b64_tr_b16 a[158:159], v1 offset:10848
  v_mfma_f32_16x16x32_bf16 v[240:243], a[168:171], a[96:99], v[240:243]
  s_waitcnt vmcnt(29) lgkmcnt(8)
  buffer_load_dwordx4 a[88:91], v0, s[36:39], s57 offen offset:2048 sc1
  v_mfma_f32_16x16x32_bf16 v[32:35], a[128:131], a[0:3], v[32:35]
  ds_read_b64_tr_b16 a[160:161], v1 offset:128
  v_mfma_f32_16x16x32_bf16 v[32:35], a[132:135], a[16:19], v[32:35]
  s_waitcnt vmcnt(20)
  s_barrier
  v_mfma_f32_16x16x32_bf16 v[36:39], a[132:135], a[20:23], v[36:39]
  ds_read_b64_tr_b16 a[162:163], v1 offset:3712
  v_mfma_f32_16x16x32_bf16 v[36:39], a[128:131], a[4:7], v[36:39]
  v_mfma_f32_16x16x32_bf16 v[40:43], a[128:131], a[8:11], v[40:43]
  buffer_load_dwordx4 v9, s[16:19], s56 offen offset:2048 lds
  v_mfma_f32_16x16x32_bf16 v[40:43], a[132:135], a[24:27], v[40:43]
  ds_read_b64_tr_b16 a[164:165], v1 offset:7296
  v_mfma_f32_16x16x32_bf16 v[44:47], a[132:135], a[28:31], v[44:47]
  ds_read_b64_tr_b16 a[166:167], v1 offset:10880
  v_mfma_f32_16x16x32_bf16 v[44:47], a[128:131], a[12:15], v[44:47]
  v_mfma_f32_16x16x32_bf16 v[60:63], a[136:139], a[12:15], v[60:63]
  ds_read_b64_tr_b16 a[168:169], v1 offset:160
  v_mfma_f32_16x16x32_bf16 v[60:63], a[140:143], a[28:31], v[60:63]
  buffer_load_dwordx4 a[92:95], v0, s[36:39], s57 offen offset:3072 sc1
  s_bfe_u32 s57, s83, 0x4001c
  v_mfma_f32_16x16x32_bf16 v[56:59], a[140:143], a[24:27], v[56:59]
  s_lshl_b32 s57, s57, 13
  s_add_u32 s57, s57, s85
  ds_read_b64_tr_b16 a[170:171], v1 offset:3744
  v_mfma_f32_16x16x32_bf16 v[56:59], a[136:139], a[8:11], v[56:59]
  v_mfma_f32_16x16x32_bf16 v[52:55], a[136:139], a[4:7], v[52:55]
  ds_read_b64_tr_b16 a[172:173], v1 offset:7328
  v_mfma_f32_16x16x32_bf16 v[52:55], a[140:143], a[20:23], v[52:55]
  s_waitcnt vmcnt(14)
  v_accvgpr_read_b32 v26, a208
  v_accvgpr_read_b32 v27, a209
  v_mfma_f32_16x16x32_bf16 v[48:51], a[140:143], a[16:19], v[48:51]
  buffer_load_dwordx4 a[96:99], v0, s[36:39], s57 offen offset:0 sc1
  s_bfe_u32 s56, s83, 0x4001c
  v_mfma_f32_16x16x32_bf16 v[48:51], a[136:139], a[0:3], v[48:51]
  s_waitcnt lgkmcnt(7)
  s_mul_i32 s56, s56, 458752
  s_add_u32 m0, s84, 86016
  v_mfma_f32_16x16x32_bf16 v[64:67], a[144:147], a[0:3], v[64:67]
  ds_read_b64_tr_b16 a[174:175], v1 offset:10912
  v_accvgpr_read_b32 v28, a210
  v_mfma_f32_16x16x32_bf16 v[64:67], a[148:151], a[16:19], v[64:67]
  ds_read_b64_tr_b16 a[128:129], v1 offset:192
  v_accvgpr_read_b32 v29, a211
  v_mfma_f32_16x16x32_bf16 v[68:71], a[148:151], a[20:23], v[68:71]
  ds_read_b64_tr_b16 a[130:131], v1 offset:3776
  v_max_u32 v31, v26, v27
  v_mfma_f32_16x16x32_bf16 v[68:71], a[144:147], a[4:7], v[68:71]
  buffer_load_dwordx4 v3, s[16:19], s56 offen offset:0 lds
  v_max3_u32 v31, v31, v28, v29
  v_mfma_f32_16x16x32_bf16 v[72:75], a[144:147], a[8:11], v[72:75]
  ds_read_b64_tr_b16 a[132:133], v1 offset:7360
  v_accvgpr_read_b32 v22, a212
  v_mfma_f32_16x16x32_bf16 v[72:75], a[148:151], a[24:27], v[72:75]
  v_accvgpr_read_b32 v23, a213
  v_max3_u32 v31, v31, v22, v23
  v_mfma_f32_16x16x32_bf16 v[76:79], a[148:151], a[28:31], v[76:79]
  ds_read_b64_tr_b16 a[134:135], v1 offset:10944
  v_add_f32 v26, v26, v22
  v_mfma_f32_16x16x32_bf16 v[76:79], a[144:147], a[12:15], v[76:79]
  v_add_f32 v27, v27, v23
  v_accvgpr_read_b32 v22, a214
  v_mfma_f32_16x16x32_bf16 v[92:95], a[152:155], a[12:15], v[92:95]
  buffer_load_dwordx4 a[100:103], v0, s[36:39], s57 offen offset:1024 sc1
  v_accvgpr_read_b32 v23, a215
  v_mfma_f32_16x16x32_bf16 v[92:95], a[156:159], a[28:31], v[92:95]
  ds_read_b64_tr_b16 a[136:137], v1 offset:14336
  v_max3_u32 v31, v31, v22, v23
  v_mfma_f32_16x16x32_bf16 v[88:91], a[156:159], a[24:27], v[88:91]
  ds_read_b64_tr_b16 a[138:139], v1 offset:17920
  v_add_f32 v28, v28, v22
  v_mfma_f32_16x16x32_bf16 v[88:91], a[152:155], a[8:11], v[88:91]
  v_add_f32 v29, v29, v23
  v_accvgpr_read_b32 v22, a216
  v_mfma_f32_16x16x32_bf16 v[84:87], a[152:155], a[4:7], v[84:87]
  ds_read_b64_tr_b16 a[140:141], v1 offset:21504
  v_accvgpr_read_b32 v23, a217
  v_mfma_f32_16x16x32_bf16 v[84:87], a[156:159], a[20:23], v[84:87]
  buffer_load_dwordx4 v4, s[16:19], s56 offen offset:1024 lds
  v_max3_u32 v31, v31, v22, v23
  v_mfma_f32_16x16x32_bf16 v[80:83], a[156:159], a[16:19], v[80:83]
  ds_read_b64_tr_b16 a[142:143], v1 offset:25088
  v_add_f32 v26, v26, v22
  v_mfma_f32_16x16x32_bf16 v[80:83], a[152:155], a[0:3], v[80:83]
  s_waitcnt lgkmcnt(8)
  v_add_f32 v27, v27, v23
  v_accvgpr_read_b32 v22, a218
  v_mfma_f32_16x16x32_bf16 v[96:99], a[160:163], a[0:3], v[96:99]
  ds_read_b64_tr_b16 a[144:145], v1 offset:14368
  v_accvgpr_read_b32 v23, a219
  v_mfma_f32_16x16x32_bf16 v[96:99], a[164:167], a[16:19], v[96:99]
  v_max3_u32 v31, v31, v22, v23
  v_add_f32 v28, v28, v22
  v_mfma_f32_16x16x32_bf16 v[100:103], a[164:167], a[20:23], v[100:103]
  buffer_load_dwordx4 a[104:107], v0, s[36:39], s57 offen offset:2048 sc1
  v_add_f32 v29, v29, v23
  v_mfma_f32_16x16x32_bf16 v[100:103], a[160:163], a[4:7], v[100:103]
  ds_read_b64_tr_b16 a[146:147], v1 offset:17952
  v_accvgpr_read_b32 v22, a220
  v_mfma_f32_16x16x32_bf16 v[104:107], a[160:163], a[8:11], v[104:107]
  ds_read_b64_tr_b16 a[148:149], v1 offset:21536
  v_accvgpr_read_b32 v23, a221
  v_mfma_f32_16x16x32_bf16 v[104:107], a[164:167], a[24:27], v[104:107]
  v_max3_u32 v31, v31, v22, v23
  v_add_f32 v26, v26, v22
  v_mfma_f32_16x16x32_bf16 v[108:111], a[164:167], a[28:31], v[108:111]
  ds_read_b64_tr_b16 a[150:151], v1 offset:25120
  v_add_f32 v27, v27, v23
  v_mfma_f32_16x16x32_bf16 v[108:111], a[160:163], a[12:15], v[108:111]
  buffer_load_dwordx4 v5, s[16:19], s56 offen offset:2048 lds
  v_accvgpr_read_b32 v22, a222
  v_mfma_f32_16x16x32_bf16 v[124:127], a[168:171], a[12:15], v[124:127]
  ds_read_b64_tr_b16 a[152:153], v1 offset:14400
  v_accvgpr_read_b32 v23, a223
  v_mfma_f32_16x16x32_bf16 v[124:127], a[172:175], a[28:31], v[124:127]
  v_max3_u32 v31, v31, v22, v23
  v_add_f32 v28, v28, v22
  v_mfma_f32_16x16x32_bf16 v[120:123], a[172:175], a[24:27], v[120:123]
  ds_read_b64_tr_b16 a[154:155], v1 offset:17984
  v_add_f32 v29, v29, v23
  v_mfma_f32_16x16x32_bf16 v[120:123], a[168:171], a[8:11], v[120:123]
  v_cmp_eq_u32 vcc, -1, v31
  s_nop 4
  s_cbranch_vccnz CK6s
CK6x:
  v_mfma_f32_16x16x32_bf16 v[116:119], a[168:171], a[4:7], v[116:119]
  s_nop 0
  buffer_load_dwordx4 a[108:111], v0, s[36:39], s57 offen offset:3072 sc1
  v_permlane32_swap_b32 v26, v28
  v_mfma_f32_16x16x32_bf16 v[116:119], a[172:175], a[20:23], v[116:119]
  ds_read_b64_tr_b16 a[156:157], v1 offset:21568
  v_permlane32_swap_b32 v27, v29
  v_mfma_f32_16x16x32_bf16 v[112:115], a[172:175], a[16:19], v[112:115]
  ds_read_b64_tr_b16 a[158:159], v1 offset:25152
  v_add_f32 v26, v26, v28
  v_mfma_f32_16x16x32_bf16 v[112:115], a[168:171], a[0:3], v[112:115]
  s_waitcnt lgkmcnt(8)
  v_add_f32 v27, v27, v29
  v_cvt_pk_bf16_f32 v25, v26, v26
  v_mfma_f32_16x16x32_bf16 v[128:131], a[128:131], a[0:3], v[128:131]
  ds_read_b64_tr_b16 a[160:161], v1 offset:14432
  v_lshlrev_b32 v25, 16, v25
  v_mfma_f32_16x16x32_bf16 v[128:131], a[132:135], a[16:19], v[128:131]
  buffer_load_dwordx4 v6, s[16:19], s56 offen offset:3072 lds
  s_add_u32 s57, s57, 4096
  v_mfma_f32_16x16x32_bf16 v[132:135], a[132:135], a[20:23], v[132:135]
  ds_read_b64_tr_b16 a[162:163], v1 offset:18016
  v_sub_f32 v30, v26, v25
  v_mfma_f32_16x16x32_bf16 v[132:135], a[128:131], a[4:7], v[132:135]
  v_cvt_pk_bf16_f32 v22, v26, v30
  v_and_b32 v25, 0xffff0000, v22
  v_mfma_f32_16x16x32_bf16 v[136:139], a[128:131], a[8:11], v[136:139]
  ds_read_b64_tr_b16 a[164:165], v1 offset:21600
  v_sub_f32 v30, v30, v25
  v_mfma_f32_16x16x32_bf16 v[136:139], a[132:135], a[24:27], v[136:139]
  v_cvt_pk_bf16_f32 v23, v30, 0
  v_mfma_f32_16x16x32_bf16 v[140:143], a[132:135], a[28:31], v[140:143]
  buffer_load_dwordx4 a[112:115], v0, s[36:39], s57 offen offset:0 sc1
  s_add_u32 m0, s84, 90112
  v_mfma_f32_16x16x32_bf16 v[140:143], a[128:131], a[12:15], v[140:143]
  ds_read_b64_tr_b16 a[166:167], v1 offset:25184
  v_mfma_f32_16x16x32_bf16 v[156:159], a[136:139], a[12:15], v[156:159]
  ds_read_b64_tr_b16 a[168:169], v1 offset:14464
  v_mfma_f32_16x16x32_bf16 v[156:159], a[140:143], a[28:31], v[156:159]
  ds_write_b64 v24, v[22:23] offset:0
  v_cvt_pk_bf16_f32 v25, v27, v27
  v_mfma_f32_16x16x32_bf16 v[152:155], a[140:143], a[24:27], v[152:155]
  ds_read_b64_tr_b16 a[170:171], v1 offset:18048
  v_lshlrev_b32 v25, 16, v25
  v_mfma_f32_16x16x32_bf16 v[152:155], a[136:139], a[8:11], v[152:155]
  buffer_load_dwordx4 v7, s[16:19], s56 offen offset:0 lds
  v_sub_f32 v30, v27, v25
  v_mfma_f32_16x16x32_bf16 v[148:151], a[136:139], a[4:7], v[148:151]
  ds_read_b64_tr_b16 a[172:173], v1 offset:21632
  v_cvt_pk_bf16_f32 v28, v27, v30
  v_mfma_f32_16x16x32_bf16 v[148:151], a[140:143], a[20:23], v[148:151]
  v_and_b32 v25, 0xffff0000, v28
  v_sub_f32 v30, v30, v25
  v_mfma_f32_16x16x32_bf16 v[144:147], a[140:143], a[16:19], v[144:147]
  ds_read_b64_tr_b16 a[174:175], v1 offset:25216
  v_cvt_pk_bf16_f32 v29, v30, 0
  v_mfma_f32_16x16x32_bf16 v[144:147], a[136:139], a[0:3], v[144:147]
  s_waitcnt lgkmcnt(9)
  ds_write_b64 v24, v[28:29] offset:16
  s_waitcnt lgkmcnt(0)
  v_mfma_f32_16x16x32_bf16 v[160:163], a[144:147], a[0:3], v[160:163]
  buffer_load_dwordx4 a[116:119], v0, s[36:39], s57 offen offset:1024 sc1
  v_mfma_f32_16x16x32_bf16 v[160:163], a[148:151], a[16:19], v[160:163]
  s_lshl_b32 s68, s44, 8
  ds_read_b64_tr_b16 a[128:129], v1 offset:14496
  s_add_u32 s68, s68, s2
  v_mfma_f32_16x16x32_bf16 v[164:167], a[148:151], a[20:23], v[164:167]
  s_mul_i32 s68, s68, 7168
  ds_read_b64_tr_b16 a[130:131], v1 offset:18080
  v_mfma_f32_16x16x32_bf16 v[164:167], a[144:147], a[4:7], v[164:167]
  v_mfma_f32_16x16x32_bf16 v[168:171], a[144:147], a[8:11], v[168:171]
  ds_read_b64_tr_b16 a[132:133], v1 offset:21664
  v_mfma_f32_16x16x32_bf16 v[168:171], a[148:151], a[24:27], v[168:171]
  buffer_load_dwordx4 v8, s[16:19], s56 offen offset:1024 lds
  v_mfma_f32_16x16x32_bf16 v[172:175], a[148:151], a[28:31], v[172:175]
  ds_read_b64_tr_b16 a[134:135], v1 offset:25248
  v_mfma_f32_16x16x32_bf16 v[172:175], a[144:147], a[12:15], v[172:175]
  v_mfma_f32_16x16x32_bf16 v[188:191], a[152:155], a[12:15], v[188:191]
  ds_read_b64_tr_b16 a[136:137], v1 offset:14528
  v_mfma_f32_16x16x32_bf16 v[188:191], a[156:159], a[28:31], v[188:191]
  v_mfma_f32_16x16x32_bf16 v[184:187], a[156:159], a[24:27], v[184:187]
  buffer_load_dwordx4 a[120:123], v0, s[36:39], s57 offen offset:2048 sc1
  v_mfma_f32_16x16x32_bf16 v[184:187], a[152:155], a[8:11], v[184:187]
  ds_read_b64_tr_b16 a[138:139], v1 offset:18112
  v_mfma_f32_16x16x32_bf16 v[180:183], a[152:155], a[4:7], v[180:183]
  ds_read_b64_tr_b16 a[140:141], v1 offset:21696
  v_mfma_f32_16x16x32_bf16 v[180:183], a[156:159], a[20:23], v[180:183]
  v_mfma_f32_16x16x32_bf16 v[176:179], a[156:159], a[16:19], v[176:179]
  ds_read_b64_tr_b16 a[142:143], v1 offset:25280
  v_mfma_f32_16x16x32_bf16 v[176:179], a[152:155], a[0:3], v[176:179]
  s_waitcnt lgkmcnt(9)
  buffer_load_dwordx4 v9, s[16:19], s56 offen offset:2048 lds
  v_mfma_f32_16x16x32_bf16 v[192:195], a[160:163], a[0:3], v[192:195]
  ds_read_b64_tr_b16 a[144:145], v1 offset:28864
  v_mfma_f32_16x16x32_bf16 v[192:195], a[164:167], a[16:19], v[192:195]
  v_mfma_f32_16x16x32_bf16 v[196:199], a[164:167], a[20:23], v[196:199]
  ds_read_b64_tr_b16 a[146:147], v1 offset:32448
  v_mfma_f32_16x16x32_bf16 v[196:199], a[160:163], a[4:7], v[196:199]
  v_mfma_f32_16x16x32_bf16 v[200:203], a[160:163], a[8:11], v[200:203]
  buffer_load_dwordx4 a[124:127], v0, s[36:39], s57 offen offset:3072 sc1
  v_mfma_f32_16x16x32_bf16 v[200:203], a[164:167], a[24:27], v[200:203]
  ds_read_b64_tr_b16 a[148:149], v1 offset:36032
  v_mfma_f32_16x16x32_bf16 v[204:207], a[164:167], a[28:31], v[204:207]
  ds_read_b64_tr_b16 a[150:151], v1 offset:39616
  v_mfma_f32_16x16x32_bf16 v[204:207], a[160:163], a[12:15], v[204:207]
  s_waitcnt vmcnt(16)
  s_barrier
  v_mfma_f32_16x16x32_bf16 v[220:223], a[168:171], a[12:15], v[220:223]
  ds_read_b64_tr_b16 a[152:153], v1 offset:43200
  v_mfma_f32_16x16x32_bf16 v[220:223], a[172:175], a[28:31], v[220:223]
  v_mfma_f32_16x16x32_bf16 v[216:219], a[172:175], a[24:27], v[216:219]
  ds_read_b64_tr_b16 a[154:155], v1 offset:46784
  v_mfma_f32_16x16x32_bf16 v[216:219], a[168:171], a[8:11], v[216:219]
  v_mfma_f32_16x16x32_bf16 v[212:215], a[168:171], a[4:7], v[212:215]
  ds_read_b64_tr_b16 a[156:157], v1 offset:50368
  v_mfma_f32_16x16x32_bf16 v[212:215], a[172:175], a[20:23], v[212:215]
  v_mfma_f32_16x16x32_bf16 v[208:211], a[172:175], a[16:19], v[208:211]
  ds_read_b64_tr_b16 a[158:159], v1 offset:53952
  v_mfma_f32_16x16x32_bf16 v[208:211], a[168:171], a[0:3], v[208:211]
  s_waitcnt lgkmcnt(8)
  v_mfma_f32_16x16x32_bf16 v[224:227], a[128:131], a[0:3], v[224:227]
  ds_read_b64_tr_b16 a[160:161], v2 offset:192
  v_mfma_f32_16x16x32_bf16 v[224:227], a[132:135], a[16:19], v[224:227]
  v_mfma_f32_16x16x32_bf16 v[228:231], a[132:135], a[20:23], v[228:231]
  ds_read_b64_tr_b16 a[162:163], v2 offset:3776
  v_mfma_f32_16x16x32_bf16 v[228:231], a[128:131], a[4:7], v[228:231]
  v_mfma_f32_16x16x32_bf16 v[232:235], a[128:131], a[8:11], v[232:235]
  ds_read_b64_tr_b16 a[164:165], v2 offset:7360
  v_mfma_f32_16x16x32_bf16 v[232:235], a[132:135], a[24:27], v[232:235]
  v_mfma_f32_16x16x32_bf16 v[236:239], a[132:135], a[28:31], v[236:239]
  ds_read_b64_tr_b16 a[166:167], v2 offset:10944
  v_mfma_f32_16x16x32_bf16 v[236:239], a[128:131], a[12:15], v[236:239]
  v_mfma_f32_16x16x32_bf16 v[252:255], a[136:139], a[12:15], v[252:255]
  ds_read_b64_tr_b16 a[168:169], v2 offset:14528
  v_mfma_f32_16x16x32_bf16 v[252:255], a[140:143], a[28:31], v[252:255]
  v_mfma_f32_16x16x32_bf16 v[248:251], a[140:143], a[24:27], v[248:251]
  ds_read_b64_tr_b16 a[170:171], v2 offset:18112
  v_mfma_f32_16x16x32_bf16 v[248:251], a[136:139], a[8:11], v[248:251]
  v_mfma_f32_16x16x32_bf16 v[244:247], a[136:139], a[4:7], v[244:247]
  ds_read_b64_tr_b16 a[172:173], v2 offset:21696
  v_mfma_f32_16x16x32_bf16 v[244:247], a[140:143], a[20:23], v[244:247]
  v_mfma_f32_16x16x32_bf16 v[240:243], a[140:143], a[16:19], v[240:243]
  ds_read_b64_tr_b16 a[174:175], v2 offset:25280
  v_mfma_f32_16x16x32_bf16 v[240:243], a[136:139], a[0:3], v[240:243]
  s_waitcnt vmcnt(1) lgkmcnt(8)
  s_barrier
  v_mfma_f32_16x16x32_bf16 v[128:131], a[144:147], a[32:35], v[128:131]
Hb2_1:
  s_cbranch_execz Hb2_2
  v_and_b32 v31, 0xf0, v0
  v_add_u32 v31, 159744, v31
  v_mfma_f32_16x16x32_bf16 v[128:131], a[148:151], a[48:51], v[128:131]
  s_barrier
  v_cmp_gt_u32 vcc, 0x100, v0
  s_mov_b32 s76, 0x01000100
  v_mfma_f32_16x16x32_bf16 v[132:135], a[148:151], a[52:55], v[132:135]
  s_mov_b32 s77, 0x03020302
  v_cndmask_b32 v12, 0, v12, vcc
  v_perm_b32 v22, v12, v12, s76
  v_mfma_f32_16x16x32_bf16 v[132:135], a[144:147], a[36:39], v[132:135]
  v_min_u32 v3, 880, v0
  v_lshlrev_b32 v3, 3, v3
  v_mfma_f32_16x16x32_bf16 v[136:139], a[144:147], a[40:43], v[136:139]
  buffer_load_dword a252, v3, s[24:27], s68 offen
  v_and_b32 v23, 0xffff, v12
  v_mfma_f32_16x16x32_bf16 v[136:139], a[148:151], a[56:59], v[136:139]
  v_perm_b32 v24, v12, v12, s77
  v_lshrrev_b32 v25, 16, v12
  v_mfma_f32_16x16x32_bf16 v[140:143], a[148:151], a[60:63], v[140:143]
  v_accvgpr_write_b32 a0, v22
  v_accvgpr_write_b32 a1, v23
  v_mfma_f32_16x16x32_bf16 v[140:143], a[144:147], a[44:47], v[140:143]
  v_accvgpr_write_b32 a2, v24
  v_accvgpr_write_b32 a3, v25
  v_mfma_f32_16x16x32_bf16 v[252:255], a[152:155], a[44:47], v[252:255]
  ds_read_b64_tr_b16 a[128:129], v2 offset:28864
  v_cndmask_b32 v15, 0, v15, vcc
  v_mfma_f32_16x16x32_bf16 v[252:255], a[156:159], a[60:63], v[252:255]
  v_perm_b32 v26, v15, v15, s76
  v_and_b32 v27, 0xffff, v15
  v_mfma_f32_16x16x32_bf16 v[248:251], a[156:159], a[56:59], v[248:251]
  ds_read_b64_tr_b16 a[130:131], v2 offset:32448
  v_perm_b32 v28, v15, v15, s77
  v_mfma_f32_16x16x32_bf16 v[248:251], a[152:155], a[40:43], v[248:251]
  v_lshrrev_b32 v29, 16, v15
  v_accvgpr_write_b32 a4, v26
  v_mfma_f32_16x16x32_bf16 v[244:247], a[152:155], a[36:39], v[244:247]
  ds_read_b64_tr_b16 a[132:133], v2 offset:36032
  v_accvgpr_write_b32 a5, v27
  v_mfma_f32_16x16x32_bf16 v[244:247], a[156:159], a[52:55], v[244:247]
  ds_read_b128 a[16:19], v31 offset:1536
  v_accvgpr_write_b32 a6, v28
  v_mfma_f32_16x16x32_bf16 v[240:243], a[156:159], a[48:51], v[240:243]
  ds_read_b128 a[20:23], v31 offset:3584
  v_accvgpr_write_b32 a7, v29
  v_mfma_f32_16x16x32_bf16 v[240:243], a[152:155], a[32:35], v[240:243]
  s_waitcnt vmcnt(16) lgkmcnt(5)
  ds_read_b64_tr_b16 a[134:135], v2 offset:39616
  v_cndmask_b32 v18, 0, v18, vcc
  v_mfma_f32_16x16x32_bf16 v[128:131], a[160:163], a[64:67], v[128:131]
  ds_read_b64_tr_b16 a[136:137], v2 offset:43200
  v_perm_b32 v22, v18, v18, s76
  v_mfma_f32_16x16x32_bf16 v[128:131], a[164:167], a[80:83], v[128:131]
  v_and_b32 v23, 0xffff, v18
  v_perm_b32 v24, v18, v18, s77
  v_mfma_f32_16x16x32_bf16 v[132:135], a[164:167], a[84:87], v[132:135]
  ds_read_b64_tr_b16 a[138:139], v2 offset:46784
  v_lshrrev_b32 v25, 16, v18
  v_mfma_f32_16x16x32_bf16 v[132:135], a[160:163], a[68:71], v[132:135]
  v_accvgpr_write_b32 a8, v22
  v_accvgpr_write_b32 a9, v23
  v_mfma_f32_16x16x32_bf16 v[136:139], a[160:163], a[72:75], v[136:139]
  ds_read_b64_tr_b16 a[140:141], v2 offset:50368
  v_accvgpr_write_b32 a10, v24
  v_mfma_f32_16x16x32_bf16 v[136:139], a[164:167], a[88:91], v[136:139]
  v_accvgpr_write_b32 a11, v25
  v_cndmask_b32 v21, 0, v21, vcc
  v_mfma_f32_16x16x32_bf16 v[140:143], a[164:167], a[92:95], v[140:143]
  ds_read_b64_tr_b16 a[142:143], v2 offset:53952
  v_perm_b32 v26, v21, v21, s76
  v_mfma_f32_16x16x32_bf16 v[140:143], a[160:163], a[76:79], v[140:143]
  v_and_b32 v27, 0xffff, v21
  v_perm_b32 v28, v21, v21, s77
  v_mfma_f32_16x16x32_bf16 v[252:255], a[168:171], a[76:79], v[252:255]
  ds_read_b64_tr_b16 a[144:145], v1 offset:28672
  v_lshrrev_b32 v29, 16, v21
  v_mfma_f32_16x16x32_bf16 v[252:255], a[172:175], a[92:95], v[252:255]
  v_accvgpr_write_b32 a12, v26
  v_accvgpr_write_b32 a13, v27
  v_mfma_f32_16x16x32_bf16 v[248:251], a[172:175], a[88:91], v[248:251]
  ds_read_b64_tr_b16 a[146:147], v1 offset:32256
  v_accvgpr_write_b32 a14, v28
  v_mfma_f32_16x16x32_bf16 v[248:251], a[168:171], a[72:75], v[248:251]
  v_accvgpr_write_b32 a15, v29
  v_mfma_f32_16x16x32_bf16 v[244:247], a[168:171], a[68:71], v[244:247]
  ds_read_b64_tr_b16 a[148:149], v1 offset:35840
  v_mfma_f32_16x16x32_bf16 v[244:247], a[172:175], a[84:87], v[244:247]
  v_mfma_f32_16x16x32_bf16 v[240:243], a[172:175], a[80:83], v[240:243]
  ds_read_b64_tr_b16 a[150:151], v1 offset:39424
  v_mfma_f32_16x16x32_bf16 v[240:243], a[168:171], a[64:67], v[240:243]
  s_waitcnt lgkmcnt(9)
  v_mfma_f32_16x16x32_bf16 v[128:131], a[16:19], a[0:3], v[128:131]
  v_mfma_f32_16x16x32_bf16 v[132:135], a[16:19], a[4:7], v[132:135]
  v_mfma_f32_16x16x32_bf16 v[136:139], a[16:19], a[8:11], v[136:139]
  v_mfma_f32_16x16x32_bf16 v[140:143], a[16:19], a[12:15], v[140:143]
  v_mfma_f32_16x16x32_bf16 v[240:243], a[20:23], a[0:3], v[240:243]
  v_mfma_f32_16x16x32_bf16 v[244:247], a[20:23], a[4:7], v[244:247]
  v_mfma_f32_16x16x32_bf16 v[248:251], a[20:23], a[8:11], v[248:251]
  v_mfma_f32_16x16x32_bf16 v[252:255], a[20:23], a[12:15], v[252:255]
  s_waitcnt vmcnt(1) lgkmcnt(4)
  v_mfma_f32_16x16x32_bf16 v[128:131], a[128:131], a[96:99], v[128:131]
  ds_read_b128 a[24:27], v31 offset:0
  v_mfma_f32_16x16x32_bf16 v[128:131], a[132:135], a[112:115], v[128:131]
  ds_read_b64_tr_b16 a[152:153], v1 offset:43008
  v_mfma_f32_16x16x32_bf16 v[132:135], a[132:135], a[116:119], v[132:135]
  ds_read_b128 a[28:31], v31 offset:2048
  v_mfma_f32_16x16x32_bf16 v[132:135], a[128:131], a[100:103], v[132:135]
  ds_read_b64_tr_b16 a[154:155], v1 offset:46592
  v_mfma_f32_16x16x32_bf16 v[136:139], a[128:131], a[104:107], v[136:139]
  ds_read_b64_tr_b16 a[156:157], v1 offset:50176
  v_mfma_f32_16x16x32_bf16 v[136:139], a[132:135], a[120:123], v[136:139]
  v_mfma_f32_16x16x32_bf16 v[140:143], a[132:135], a[124:127], v[140:143]
  ds_read_b64_tr_b16 a[158:159], v1 offset:53760
  v_mfma_f32_16x16x32_bf16 v[140:143], a[128:131], a[108:111], v[140:143]
  v_mfma_f32_16x16x32_bf16 v[252:255], a[136:139], a[108:111], v[252:255]
  ds_read_b64_tr_b16 a[160:161], v2 offset:0
  v_mul_f32 v22, v10, v128
  v_mul_f32 v23, v10, v129
  v_mul_f32 v24, v10, v130
  v_mfma_f32_16x16x32_bf16 v[252:255], a[140:143], a[124:127], v[252:255]
  v_mul_f32 v25, v10, v131
  v_exp_f32 v22, v22
  v_mul_f32 v26, v13, v132
  v_mfma_f32_16x16x32_bf16 v[248:251], a[140:143], a[120:123], v[248:251]
  ds_read_b64_tr_b16 a[162:163], v2 offset:3584
  v_exp_f32 v23, v23
  v_mul_f32 v27, v13, v133
  v_mfma_f32_16x16x32_bf16 v[248:251], a[136:139], a[104:107], v[248:251]
  v_exp_f32 v24, v24
  v_mul_f32 v28, v13, v134
  v_mfma_f32_16x16x32_bf16 v[244:247], a[136:139], a[100:103], v[244:247]
  ds_read_b64_tr_b16 a[164:165], v2 offset:7168
  v_exp_f32 v25, v25
  v_mul_f32 v29, v13, v135
  v_mfma_f32_16x16x32_bf16 v[244:247], a[140:143], a[116:119], v[244:247]
  v_exp_f32 v26, v26
  v_fma_f32 v22, v22, v11, v11
  v_mfma_f32_16x16x32_bf16 v[240:243], a[140:143], a[112:115], v[240:243]
  ds_read_b64_tr_b16 a[166:167], v2 offset:10752
  v_exp_f32 v27, v27
  v_fma_f32 v23, v23, v11, v11
  v_mfma_f32_16x16x32_bf16 v[240:243], a[136:139], a[96:99], v[240:243]
  s_waitcnt lgkmcnt(4)
  v_exp_f32 v28, v28
  v_fma_f32 v24, v24, v11, v11
  v_mfma_f32_16x16x32_bf16 v[32:35], a[144:147], a[32:35], v[32:35]
  ds_read_b64_tr_b16 a[168:169], v2 offset:14336
  v_exp_f32 v29, v29
  v_fma_f32 v25, v25, v11, v11
  v_mfma_f32_16x16x32_bf16 v[32:35], a[148:151], a[48:51], v[32:35]
  v_rcp_f32 v22, v22
  v_fma_f32 v26, v26, v14, v14
  v_mfma_f32_16x16x32_bf16 v[36:39], a[148:151], a[52:55], v[36:39]
  ds_read_b64_tr_b16 a[170:171], v2 offset:17920
  v_rcp_f32 v23, v23
  v_fma_f32 v27, v27, v14, v14
  v_mfma_f32_16x16x32_bf16 v[36:39], a[144:147], a[36:39], v[36:39]
  v_rcp_f32 v24, v24
  v_fma_f32 v28, v28, v14, v14
  v_mfma_f32_16x16x32_bf16 v[40:43], a[144:147], a[40:43], v[40:43]
  ds_read_b64_tr_b16 a[172:173], v2 offset:21504
  v_rcp_f32 v25, v25
  v_fma_f32 v29, v29, v14, v14
  v_mfma_f32_16x16x32_bf16 v[40:43], a[148:151], a[56:59], v[40:43]
  v_rcp_f32 v26, v26
  v_mul_f32 v240, v128, v240
  v_mfma_f32_16x16x32_bf16 v[44:47], a[148:151], a[60:63], v[44:47]
  ds_read_b64_tr_b16 a[174:175], v2 offset:25088
  v_rcp_f32 v27, v27
  v_mul_f32 v241, v129, v241
  v_mfma_f32_16x16x32_bf16 v[44:47], a[144:147], a[44:47], v[44:47]
  s_waitcnt lgkmcnt(11)
  v_rcp_f32 v28, v28
  v_mul_f32 v242, v130, v242
  v_mfma_f32_16x16x32_bf16 v[32:35], a[24:27], a[0:3], v[32:35]
  ds_read_b64_tr_b16 a[128:129], v2 offset:28672
  v_rcp_f32 v29, v29
  v_mul_f32 v243, v131, v243
  v_mfma_f32_16x16x32_bf16 v[36:39], a[24:27], a[4:7], v[36:39]
  v_mul_f32 v240, v240, v22
  v_mul_f32 v241, v241, v23
  v_mul_f32 v242, v242, v24
  v_mul_f32 v243, v243, v25
  v_mfma_f32_16x16x32_bf16 v[40:43], a[24:27], a[8:11], v[40:43]
  ds_read_b64_tr_b16 a[130:131], v2 offset:32256
  v_mul_f32 v22, v16, v136
  v_mul_f32 v23, v16, v137
  v_mul_f32 v24, v16, v138
  v_mfma_f32_16x16x32_bf16 v[44:47], a[24:27], a[12:15], v[44:47]
  v_mul_f32 v25, v16, v139
  v_exp_f32 v22, v22
  v_mul_f32 v244, v132, v244
  v_mfma_f32_16x16x32_bf16 v[144:147], a[28:31], a[0:3], v[144:147]
  ds_read_b64_tr_b16 a[132:133], v2 offset:35840
  v_exp_f32 v23, v23
  v_mul_f32 v245, v133, v245
  v_mfma_f32_16x16x32_bf16 v[148:151], a[28:31], a[4:7], v[148:151]
  v_exp_f32 v24, v24
  v_mul_f32 v246, v134, v246
  v_mfma_f32_16x16x32_bf16 v[152:155], a[28:31], a[8:11], v[152:155]
  ds_read_b64_tr_b16 a[134:135], v2 offset:39424
  v_exp_f32 v25, v25
  v_mul_f32 v247, v135, v247
  v_mfma_f32_16x16x32_bf16 v[156:159], a[28:31], a[12:15], v[156:159]
  v_mul_f32 v244, v244, v26
  v_mul_f32 v245, v245, v27
  v_mul_f32 v246, v246, v28
  v_mul_f32 v247, v247, v29
  v_mfma_f32_16x16x32_bf16 v[156:159], a[152:155], a[44:47], v[156:159]
  ds_read_b64_tr_b16 a[136:137], v2 offset:43008
  v_cvt_pk_bf16_f32 v128, v240, v241
  v_cvt_pk_bf16_f32 v129, v242, v243
  v_mfma_f32_16x16x32_bf16 v[156:159], a[156:159], a[60:63], v[156:159]
  buffer_store_dwordx2 v[128:129], v0, s[36:39], s65 offen offset:0 sc1
  v_mul_f32 v26, v19, v140
  v_mul_f32 v27, v19, v141
  v_mul_f32 v28, v19, v142
  v_mfma_f32_16x16x32_bf16 v[152:155], a[156:159], a[56:59], v[152:155]
  ds_read_b64_tr_b16 a[138:139], v2 offset:46592
  v_mul_f32 v29, v19, v143
  v_exp_f32 v26, v26
  v_mfma_f32_16x16x32_bf16 v[152:155], a[152:155], a[40:43], v[152:155]
  v_fma_f32 v22, v22, v17, v17
  v_exp_f32 v27, v27
  v_fma_f32 v23, v23, v17, v17
  v_mfma_f32_16x16x32_bf16 v[148:151], a[152:155], a[36:39], v[148:151]
  ds_read_b64_tr_b16 a[140:141], v2 offset:50176
  v_exp_f32 v28, v28
  v_fma_f32 v24, v24, v17, v17
  v_mfma_f32_16x16x32_bf16 v[148:151], a[156:159], a[52:55], v[148:151]
  v_exp_f32 v29, v29
  v_fma_f32 v25, v25, v17, v17
  v_cvt_pk_bf16_f32 v132, v244, v245
  v_mfma_f32_16x16x32_bf16 v[144:147], a[156:159], a[48:51], v[144:147]
  ds_read_b64_tr_b16 a[142:143], v2 offset:53760
  v_cvt_pk_bf16_f32 v133, v246, v247
  v_mfma_f32_16x16x32_bf16 v[144:147], a[152:155], a[32:35], v[144:147]
  s_waitcnt lgkmcnt(8)
  buffer_store_dwordx2 v[132:133], v0, s[36:39], s65 offen offset:1024 sc1
  v_rcp_f32 v22, v22
  v_fma_f32 v26, v26, v20, v20
  v_mfma_f32_16x16x32_bf16 v[32:35], a[160:163], a[64:67], v[32:35]
  ds_read_b64_tr_b16 a[144:145], v1 offset:28704
  v_rcp_f32 v23, v23
  v_fma_f32 v27, v27, v20, v20
  v_mfma_f32_16x16x32_bf16 v[32:35], a[164:167], a[80:83], v[32:35]
  v_rcp_f32 v24, v24
  v_fma_f32 v28, v28, v20, v20
  v_mfma_f32_16x16x32_bf16 v[36:39], a[164:167], a[84:87], v[36:39]
  ds_read_b64_tr_b16 a[146:147], v1 offset:32288
  v_rcp_f32 v25, v25
  v_fma_f32 v29, v29, v20, v20
  v_mfma_f32_16x16x32_bf16 v[36:39], a[160:163], a[68:71], v[36:39]
  v_rcp_f32 v26, v26
  v_mul_f32 v248, v136, v248
  v_mfma_f32_16x16x32_bf16 v[40:43], a[160:163], a[72:75], v[40:43]
  ds_read_b64_tr_b16 a[148:149], v1 offset:35872
  v_rcp_f32 v27, v27
  v_mul_f32 v249, v137, v249
  v_mfma_f32_16x16x32_bf16 v[40:43], a[164:167], a[88:91], v[40:43]
  v_rcp_f32 v28, v28
  v_mul_f32 v250, v138, v250
  v_mfma_f32_16x16x32_bf16 v[44:47], a[164:167], a[92:95], v[44:47]
  ds_read_b64_tr_b16 a[150:151], v1 offset:39456
  v_rcp_f32 v29, v29
  v_mul_f32 v251, v139, v251
  v_mfma_f32_16x16x32_bf16 v[44:47], a[160:163], a[76:79], v[44:47]
  v_mul_f32 v248, v248, v22
  v_mul_f32 v249, v249, v23
  v_mul_f32 v250, v250, v24
  v_mul_f32 v251, v251, v25
  v_mfma_f32_16x16x32_bf16 v[156:159], a[168:171], a[76:79], v[156:159]
  v_mul_f32 v252, v140, v252
  v_mul_f32 v253, v141, v253
  v_mul_f32 v254, v142, v254
  v_mul_f32 v255, v143, v255
  v_mfma_f32_16x16x32_bf16 v[156:159], a[172:175], a[92:95], v[156:159]
  v_cvt_pk_bf16_f32 v136, v248, v249
  v_cvt_pk_bf16_f32 v137, v250, v251
  v_mfma_f32_16x16x32_bf16 v[152:155], a[172:175], a[88:91], v[152:155]
  buffer_store_dwordx2 v[136:137], v0, s[36:39], s66 offen offset:0 sc1
  v_mul_f32 v252, v252, v26
  v_mul_f32 v253, v253, v27
  v_mul_f32 v254, v254, v28
  v_mfma_f32_16x16x32_bf16 v[152:155], a[168:171], a[72:75], v[152:155]
  v_mul_f32 v255, v255, v29
  v_cvt_pk_bf16_f32 v140, v252, v253
  v_cvt_pk_bf16_f32 v141, v254, v255
  v_mfma_f32_16x16x32_bf16 v[148:151], a[168:171], a[68:71], v[148:151]
  buffer_store_dwordx2 v[140:141], v0, s[36:39], s66 offen offset:1024 sc1
  s_mov_b32 s65, s67
  s_add_u32 s66, s67, 262144
  v_mfma_f32_16x16x32_bf16 v[148:151], a[172:175], a[84:87], v[148:151]
  v_lshrrev_b32 v128, 4, v0
  s_add_u32 s87, s52, s54
  s_and_b32 s87, s87, 3
  s_and_b32 s90, s2, 1
  v_mfma_f32_16x16x32_bf16 v[144:147], a[172:175], a[80:83], v[144:147]
  s_lshl_b32 s89, s53, 7
  s_lshl3_add_u32 s89, s70, s89
  s_mul_i32 s88, s90, 3670016
  s_add_u32 s89, s89, s88
  s_lshr_b32 s88, s44, 1
  v_mfma_f32_16x16x32_bf16 v[144:147], a[168:171], a[64:67], v[144:147]
  s_waitcnt lgkmcnt(4)
  s_mul_i32 s88, s88, 393216
  v_bfe_u32 v129, v128, 4, 2
  v_bfe_u32 v130, v128, 1, 2
  v_xor_b32 v129, v129, v130
  v_mfma_f32_16x16x32_bf16 v[32:35], a[128:131], a[96:99], v[32:35]
  ds_read_b128 a[16:19], v31 offset:256
  v_lshlrev_b32 v129, 5, v129
  v_and_b32 v130, 1, v128
  v_lshl_add_u32 v129, v130, 4, v129
  v_mfma_f32_16x16x32_bf16 v[32:35], a[132:135], a[112:115], v[32:35]
  ds_read_b64_tr_b16 a[152:153], v1 offset:43040
  v_lshrrev_b32 v130, 3, v128
  v_lshlrev_b32 v130, 11, v130
  s_sub_u32 s24, s24, 2048
  v_mfma_f32_16x16x32_bf16 v[36:39], a[132:135], a[116:119], v[36:39]
  s_subb_u32 s25, s25, 0
  s_mov_b32 s26, 7342080
  ds_read_b128 a[20:23], v31 offset:2304
  v_add3_u32 v129, v129, v130, s89
  v_add_u32 v133, 2048, v129
  v_mfma_f32_16x16x32_bf16 v[36:39], a[128:131], a[100:103], v[36:39]
  ds_read_b64_tr_b16 a[154:155], v1 offset:46624
  v_add_u32 v134, 17408, v129
  v_xor_b32 v135, 128, v129
  v_add_u32 v136, 15360, v135
  v_mfma_f32_16x16x32_bf16 v[40:43], a[128:131], a[104:107], v[40:43]
  ds_read_b64_tr_b16 a[156:157], v1 offset:50208
  v_and_b32 v129, 7, v128
  v_lshrrev_b32 v131, 4, v128
  v_xor_b32 v129, v129, v131
  v_mfma_f32_16x16x32_bf16 v[40:43], a[132:135], a[120:123], v[40:43]
  v_lshl_add_u32 v252, v129, 4, v130
  v_xor_b32 v253, 64, v252
  v_add_u32 v253, 16384, v253
  s_lshl2_add_u32 s89, s52, s44
  v_mfma_f32_16x16x32_bf16 v[44:47], a[132:135], a[124:127], v[44:47]
  s_lshl_b32 s89, s89, 18
  s_mul_i32 s91, s90, 114688
  s_add_u32 s89, s89, s91
  s_add_u32 s89, s89, 19922944
  ds_read_b64_tr_b16 a[158:159], v1 offset:53792
  v_mfma_f32_16x16x32_bf16 v[44:47], a[128:131], a[108:111], v[44:47]
  v_add_u32 v137, s89, v0
  v_bfe_u32 v129, v128, 3, 2
  v_lshlrev_b32 v129, 5, v129
  v_and_b32 v130, 3, v128
  v_mfma_f32_16x16x32_bf16 v[156:159], a[136:139], a[108:111], v[156:159]
  ds_read_b64_tr_b16 a[160:161], v2 offset:32
  v_lshl_add_u32 v129, v130, 3, v129
  v_lshrrev_b32 v130, 2, v128
  v_lshl_add_u32 v240, v130, 7, v129
  v_mfma_f32_16x16x32_bf16 v[156:159], a[140:143], a[124:127], v[156:159]
  v_xor_b32 v241, 32, v240
  v_xor_b32 v242, 64, v240
  v_xor_b32 v243, 96, v240
  v_xor_b32 v244, 65536, v240
  v_mfma_f32_16x16x32_bf16 v[152:155], a[140:143], a[120:123], v[152:155]
  ds_read_b64_tr_b16 a[162:163], v2 offset:3616
  v_xor_b32 v245, 65568, v240
  v_xor_b32 v246, 65600, v240
  v_xor_b32 v247, 65632, v240
  v_mfma_f32_16x16x32_bf16 v[152:155], a[136:139], a[104:107], v[152:155]
  v_xor_b32 v248, 131072, v240
  v_xor_b32 v249, 131104, v240
  v_xor_b32 v250, 131136, v240
  v_xor_b32 v251, 131168, v240
  v_mfma_f32_16x16x32_bf16 v[148:151], a[136:139], a[100:103], v[148:151]
  s_lshr_b32 s89, s52, 1
  s_lshl_b32 s89, s89, 5
  s_lshl2_add_u32 s89, s90, s89
  ds_read_b64_tr_b16 a[164:165], v2 offset:7200
  v_and_b32 v129, 3, v128
  v_mfma_f32_16x16x32_bf16 v[148:151], a[140:143], a[116:119], v[148:151]
  v_bfe_u32 v130, v128, 2, 2
  v_lshl_add_u32 v129, v129, 3, v130
  v_add_lshl_u32 v138, v129, s89, 7
  v_mov_b32 v254, s3
  v_mfma_f32_16x16x32_bf16 v[144:147], a[140:143], a[112:115], v[144:147]
  s_mov_b32 s91, 5406720
  ds_read_b64_tr_b16 a[166:167], v2 offset:10784
  v_mul_f32 v22, v10, v32
  v_mul_f32 v23, v10, v33
  v_mul_f32 v24, v10, v34
  v_mfma_f32_16x16x32_bf16 v[144:147], a[136:139], a[96:99], v[144:147]
  s_waitcnt lgkmcnt(4)
  v_mul_f32 v25, v10, v35
  v_exp_f32 v22, v22
  v_mul_f32 v26, v13, v36
  v_mfma_f32_16x16x32_bf16 v[48:51], a[144:147], a[32:35], v[48:51]
  ds_read_b64_tr_b16 a[168:169], v2 offset:14368
  v_exp_f32 v23, v23
  v_mul_f32 v27, v13, v37
  v_mfma_f32_16x16x32_bf16 v[48:51], a[148:151], a[48:51], v[48:51]
  v_exp_f32 v24, v24
  v_mul_f32 v28, v13, v38
  v_mfma_f32_16x16x32_bf16 v[52:55], a[148:151], a[52:55], v[52:55]
  ds_read_b64_tr_b16 a[170:171], v2 offset:17952
  v_exp_f32 v25, v25
  v_mul_f32 v29, v13, v39
  v_mfma_f32_16x16x32_bf16 v[52:55], a[144:147], a[36:39], v[52:55]
  v_exp_f32 v26, v26
  v_fma_f32 v22, v22, v11, v11
  v_mfma_f32_16x16x32_bf16 v[56:59], a[144:147], a[40:43], v[56:59]
  ds_read_b64_tr_b16 a[172:173], v2 offset:21536
  v_exp_f32 v27, v27
  v_fma_f32 v23, v23, v11, v11
  v_mfma_f32_16x16x32_bf16 v[56:59], a[148:151], a[56:59], v[56:59]
  v_exp_f32 v28, v28
  v_fma_f32 v24, v24, v11, v11
  v_mfma_f32_16x16x32_bf16 v[60:63], a[148:151], a[60:63], v[60:63]
  ds_read_b64_tr_b16 a[174:175], v2 offset:25120
  v_exp_f32 v29, v29
  v_fma_f32 v25, v25, v11, v11
  v_mfma_f32_16x16x32_bf16 v[60:63], a[144:147], a[44:47], v[60:63]
  s_waitcnt lgkmcnt(11)
  v_rcp_f32 v22, v22
  v_fma_f32 v26, v26, v14, v14
  v_mfma_f32_16x16x32_bf16 v[48:51], a[16:19], a[0:3], v[48:51]
  ds_read_b64_tr_b16 a[128:129], v2 offset:28704
  v_rcp_f32 v23, v23
  v_fma_f32 v27, v27, v14, v14
  v_mfma_f32_16x16x32_bf16 v[52:55], a[16:19], a[4:7], v[52:55]
  v_rcp_f32 v24, v24
  v_fma_f32 v28, v28, v14, v14
  v_mfma_f32_16x16x32_bf16 v[56:59], a[16:19], a[8:11], v[56:59]
  ds_read_b64_tr_b16 a[130:131], v2 offset:32288
  v_rcp_f32 v25, v25
  v_fma_f32 v29, v29, v14, v14
  v_mfma_f32_16x16x32_bf16 v[60:63], a[16:19], a[12:15], v[60:63]
  v_rcp_f32 v26, v26
  v_mul_f32 v144, v32, v144
  v_mfma_f32_16x16x32_bf16 v[160:163], a[20:23], a[0:3], v[160:163]
  ds_read_b64_tr_b16 a[132:133], v2 offset:35872
  v_rcp_f32 v27, v27
  v_mul_f32 v145, v33, v145
  v_mfma_f32_16x16x32_bf16 v[164:167], a[20:23], a[4:7], v[164:167]
  v_rcp_f32 v28, v28
  v_mul_f32 v146, v34, v146
  v_mfma_f32_16x16x32_bf16 v[168:171], a[20:23], a[8:11], v[168:171]
  ds_read_b64_tr_b16 a[134:135], v2 offset:39456
  v_rcp_f32 v29, v29
  v_mul_f32 v147, v35, v147
  v_mfma_f32_16x16x32_bf16 v[172:175], a[20:23], a[12:15], v[172:175]
  v_mul_f32 v144, v144, v22
  v_mul_f32 v145, v145, v23
  v_mul_f32 v146, v146, v24
  v_mul_f32 v147, v147, v25
  v_mfma_f32_16x16x32_bf16 v[172:175], a[152:155], a[44:47], v[172:175]
  ds_read_b64_tr_b16 a[136:137], v2 offset:43040
  v_mul_f32 v22, v16, v40
  v_mul_f32 v23, v16, v41
  v_mul_f32 v24, v16, v42
  v_mul_f32 v25, v16, v43
  v_mfma_f32_16x16x32_bf16 v[172:175], a[156:159], a[60:63], v[172:175]
  v_exp_f32 v22, v22
  v_mul_f32 v148, v36, v148
  v_mfma_f32_16x16x32_bf16 v[168:171], a[156:159], a[56:59], v[168:171]
  ds_read_b64_tr_b16 a[138:139], v2 offset:46624
  v_exp_f32 v23, v23
  v_mul_f32 v149, v37, v149
  v_mfma_f32_16x16x32_bf16 v[168:171], a[152:155], a[40:43], v[168:171]
  v_exp_f32 v24, v24
  v_mul_f32 v150, v38, v150
  v_mfma_f32_16x16x32_bf16 v[164:167], a[152:155], a[36:39], v[164:167]
  ds_read_b64_tr_b16 a[140:141], v2 offset:50208
  v_exp_f32 v25, v25
  v_mul_f32 v151, v39, v151
  v_mfma_f32_16x16x32_bf16 v[164:167], a[156:159], a[52:55], v[164:167]
  v_mul_f32 v148, v148, v26
  v_mul_f32 v149, v149, v27
  v_mul_f32 v150, v150, v28
  v_mul_f32 v151, v151, v29
  v_mfma_f32_16x16x32_bf16 v[160:163], a[156:159], a[48:51], v[160:163]
  ds_read_b64_tr_b16 a[142:143], v2 offset:53792
  v_cvt_pk_bf16_f32 v32, v144, v145
  v_cvt_pk_bf16_f32 v33, v146, v147
  v_mul_f32 v26, v19, v44
  v_mfma_f32_16x16x32_bf16 v[160:163], a[152:155], a[32:35], v[160:163]
  s_waitcnt lgkmcnt(8)
  v_mul_f32 v27, v19, v45
  v_mul_f32 v28, v19, v46
  v_mul_f32 v29, v19, v47
  v_mfma_f32_16x16x32_bf16 v[48:51], a[160:163], a[64:67], v[48:51]
  ds_read_b64_tr_b16 a[144:145], v1 offset:28736
  v_exp_f32 v26, v26
  v_fma_f32 v22, v22, v17, v17
  v_mfma_f32_16x16x32_bf16 v[48:51], a[164:167], a[80:83], v[48:51]
  v_exp_f32 v27, v27
  v_fma_f32 v23, v23, v17, v17
  v_mfma_f32_16x16x32_bf16 v[52:55], a[164:167], a[84:87], v[52:55]
  s_mov_b32 s69, 3
  s_lshl_b32 s50, s69, 16
  s_add_u32 m0, s70, 114688
  ds_read_b64_tr_b16 a[146:147], v1 offset:32320
  v_mfma_f32_16x16x32_bf16 v[52:55], a[160:163], a[68:71], v[52:55]
  v_exp_f32 v28, v28
  v_fma_f32 v24, v24, v17, v17
  v_mfma_f32_16x16x32_bf16 v[56:59], a[160:163], a[72:75], v[56:59]
  ds_read_b64_tr_b16 a[148:149], v1 offset:35904
  v_exp_f32 v29, v29
  v_fma_f32 v25, v25, v17, v17
  v_mfma_f32_16x16x32_bf16 v[56:59], a[164:167], a[88:91], v[56:59]
  v_cvt_pk_bf16_f32 v36, v148, v149
  v_cvt_pk_bf16_f32 v37, v150, v151
  v_rcp_f32 v22, v22
  v_mfma_f32_16x16x32_bf16 v[60:63], a[164:167], a[92:95], v[60:63]
  buffer_load_dwordx4 v133, s[24:27], s50 offen offset:0 lds
  v_fma_f32 v26, v26, v20, v20
  v_rcp_f32 v23, v23
  v_mfma_f32_16x16x32_bf16 v[60:63], a[160:163], a[76:79], v[60:63]
  ds_read_b64_tr_b16 a[150:151], v1 offset:39488
  v_fma_f32 v27, v27, v20, v20
  v_rcp_f32 v24, v24
  v_mfma_f32_16x16x32_bf16 v[172:175], a[168:171], a[76:79], v[172:175]
  v_fma_f32 v28, v28, v20, v20
  v_rcp_f32 v25, v25
  v_fma_f32 v29, v29, v20, v20
  v_mfma_f32_16x16x32_bf16 v[172:175], a[172:175], a[92:95], v[172:175]
  v_rcp_f32 v26, v26
  v_mul_f32 v152, v40, v152
  v_mfma_f32_16x16x32_bf16 v[168:171], a[172:175], a[88:91], v[168:171]
  v_rcp_f32 v27, v27
  v_mul_f32 v153, v41, v153
  v_mfma_f32_16x16x32_bf16 v[168:171], a[168:171], a[72:75], v[168:171]
  buffer_load_dwordx4 v134, s[24:27], s50 offen offset:1024 lds
  v_rcp_f32 v28, v28
  v_mul_f32 v154, v42, v154
  v_mfma_f32_16x16x32_bf16 v[164:167], a[168:171], a[68:71], v[164:167]
  v_rcp_f32 v29, v29
  v_mul_f32 v155, v43, v155
  v_mul_f32 v152, v152, v22
  v_mfma_f32_16x16x32_bf16 v[164:167], a[172:175], a[84:87], v[164:167]
  v_mul_f32 v153, v153, v23
  v_mul_f32 v154, v154, v24
  v_mul_f32 v155, v155, v25
  v_mul_f32 v156, v44, v156
  v_mfma_f32_16x16x32_bf16 v[160:163], a[172:175], a[80:83], v[160:163]
  v_mul_f32 v157, v45, v157
  v_mul_f32 v158, v46, v158
  v_mul_f32 v159, v47, v159
  v_cvt_pk_bf16_f32 v40, v152, v153
  v_mfma_f32_16x16x32_bf16 v[160:163], a[168:171], a[64:67], v[160:163]
  s_waitcnt lgkmcnt(4)
  v_cvt_pk_bf16_f32 v41, v154, v155
  v_mul_f32 v156, v156, v26
  v_mul_f32 v157, v157, v27
  v_mul_f32 v158, v158, v28
  v_mfma_f32_16x16x32_bf16 v[48:51], a[128:131], a[96:99], v[48:51]
  ds_read_b128 a[24:27], v31 offset:512
  v_mul_f32 v159, v159, v29
  v_cvt_pk_bf16_f32 v44, v156, v157
  v_cvt_pk_bf16_f32 v45, v158, v159
  v_mfma_f32_16x16x32_bf16 v[48:51], a[132:135], a[112:115], v[48:51]
  buffer_load_dwordx4 v135, s[24:27], s50 offen offset:2048 lds
  v_mfma_f32_16x16x32_bf16 v[52:55], a[132:135], a[116:119], v[52:55]
  ds_read_b64_tr_b16 a[152:153], v1 offset:43072
  v_mfma_f32_16x16x32_bf16 v[52:55], a[128:131], a[100:103], v[52:55]
  ds_read_b128 a[28:31], v31 offset:2560
  v_mfma_f32_16x16x32_bf16 v[56:59], a[128:131], a[104:107], v[56:59]
  ds_read_b64_tr_b16 a[154:155], v1 offset:46656
  v_mfma_f32_16x16x32_bf16 v[56:59], a[132:135], a[120:123], v[56:59]
  ds_read_b64_tr_b16 a[156:157], v1 offset:50240
  v_mfma_f32_16x16x32_bf16 v[60:63], a[132:135], a[124:127], v[60:63]
  buffer_load_dwordx4 v136, s[24:27], s50 offen offset:3072 lds
  s_cmp_eq_u32 s87, 1
  s_cselect_b32 s71, 38, 10
  s_lshl_b32 s50, s71, 16
  v_mfma_f32_16x16x32_bf16 v[60:63], a[128:131], a[108:111], v[60:63]
  s_add_u32 m0, s70, 131072
  ds_read_b64_tr_b16 a[158:159], v1 offset:53824
  v_mfma_f32_16x16x32_bf16 v[172:175], a[136:139], a[108:111], v[172:175]
  ds_read_b64_tr_b16 a[160:161], v2 offset:64
  v_mul_f32 v22, v10, v48
  v_mul_f32 v23, v10, v49
  v_mul_f32 v24, v10, v50
  v_mfma_f32_16x16x32_bf16 v[172:175], a[140:143], a[124:127], v[172:175]
  v_mul_f32 v25, v10, v51
  v_exp_f32 v22, v22
  v_mul_f32 v26, v13, v52
  v_mfma_f32_16x16x32_bf16 v[168:171], a[140:143], a[120:123], v[168:171]
  buffer_load_dwordx4 v133, s[24:27], s50 offen offset:0 lds
  v_exp_f32 v23, v23
  v_mul_f32 v27, v13, v53
  v_mfma_f32_16x16x32_bf16 v[168:171], a[136:139], a[104:107], v[168:171]
  ds_read_b64_tr_b16 a[162:163], v2 offset:3648
  v_exp_f32 v24, v24
  v_mul_f32 v28, v13, v54
  v_mfma_f32_16x16x32_bf16 v[164:167], a[136:139], a[100:103], v[164:167]
  ds_read_b64_tr_b16 a[164:165], v2 offset:7232
  v_exp_f32 v25, v25
  v_mul_f32 v29, v13, v55
  v_mfma_f32_16x16x32_bf16 v[164:167], a[140:143], a[116:119], v[164:167]
  v_exp_f32 v26, v26
  v_fma_f32 v22, v22, v11, v11
  v_mfma_f32_16x16x32_bf16 v[160:163], a[140:143], a[112:115], v[160:163]
  ds_read_b64_tr_b16 a[166:167], v2 offset:10816
  v_exp_f32 v27, v27
  v_fma_f32 v23, v23, v11, v11
  v_mfma_f32_16x16x32_bf16 v[160:163], a[136:139], a[96:99], v[160:163]
  s_waitcnt lgkmcnt(4)
  buffer_load_dwordx4 v134, s[24:27], s50 offen offset:1024 lds
  v_exp_f32 v28, v28
  v_fma_f32 v24, v24, v11, v11
  v_mfma_f32_16x16x32_bf16 v[64:67], a[144:147], a[32:35], v[64:67]
  ds_read_b64_tr_b16 a[168:169], v2 offset:14400
  v_exp_f32 v29, v29
  v_fma_f32 v25, v25, v11, v11
  v_mfma_f32_16x16x32_bf16 v[64:67], a[148:151], a[48:51], v[64:67]
  v_rcp_f32 v22, v22
  v_fma_f32 v26, v26, v14, v14
  v_mfma_f32_16x16x32_bf16 v[68:71], a[148:151], a[52:55], v[68:71]
  ds_read_b64_tr_b16 a[170:171], v2 offset:17984
  v_rcp_f32 v23, v23
  v_fma_f32 v27, v27, v14, v14
  v_mfma_f32_16x16x32_bf16 v[68:71], a[144:147], a[36:39], v[68:71]
  v_rcp_f32 v24, v24
  v_fma_f32 v28, v28, v14, v14
  v_mfma_f32_16x16x32_bf16 v[72:75], a[144:147], a[40:43], v[72:75]
  buffer_load_dwordx4 v135, s[24:27], s50 offen offset:2048 lds
  v_rcp_f32 v25, v25
  v_fma_f32 v29, v29, v14, v14
  v_mfma_f32_16x16x32_bf16 v[72:75], a[148:151], a[56:59], v[72:75]
  ds_read_b64_tr_b16 a[172:173], v2 offset:21568
  v_rcp_f32 v26, v26
  v_mul_f32 v160, v48, v160
  v_mfma_f32_16x16x32_bf16 v[76:79], a[148:151], a[60:63], v[76:79]
Hb0_2:
  s_cbranch_execz Hb0_3
  ds_read_b64_tr_b16 a[174:175], v2 offset:25152
  v_rcp_f32 v27, v27
  v_mul_f32 v161, v49, v161
  v_mfma_f32_16x16x32_bf16 v[76:79], a[144:147], a[44:47], v[76:79]
  s_waitcnt lgkmcnt(11)
  v_rcp_f32 v28, v28
  v_mul_f32 v162, v50, v162
  v_mfma_f32_16x16x32_bf16 v[64:67], a[24:27], a[0:3], v[64:67]
  ds_read_b64_tr_b16 a[128:129], v2 offset:28736
  v_rcp_f32 v29, v29
  v_mul_f32 v163, v51, v163
  v_mfma_f32_16x16x32_bf16 v[68:71], a[24:27], a[4:7], v[68:71]
  buffer_load_dwordx4 v136, s[24:27], s50 offen offset:3072 lds
  v_mul_f32 v160, v160, v22
  v_mul_f32 v161, v161, v23
  v_mul_f32 v162, v162, v24
  v_mfma_f32_16x16x32_bf16 v[72:75], a[24:27], a[8:11], v[72:75]
  s_cmp_eq_u32 s87, 2
  s_cselect_b32 s72, 45, 17
  s_lshl_b32 s50, s72, 16
  s_add_u32 m0, s70, 0
  ds_read_b64_tr_b16 a[130:131], v2 offset:32320
  v_mfma_f32_16x16x32_bf16 v[76:79], a[24:27], a[12:15], v[76:79]
  v_mul_f32 v163, v163, v25
  v_mul_f32 v22, v16, v56
  v_mul_f32 v23, v16, v57
  v_mul_f32 v24, v16, v58
  v_mfma_f32_16x16x32_bf16 v[176:179], a[28:31], a[0:3], v[176:179]
  ds_read_b64_tr_b16 a[132:133], v2 offset:35904
  v_mul_f32 v25, v16, v59
  v_exp_f32 v22, v22
  v_mfma_f32_16x16x32_bf16 v[180:183], a[28:31], a[4:7], v[180:183]
  v_mul_f32 v164, v52, v164
  v_exp_f32 v23, v23
  v_mul_f32 v165, v53, v165
  v_mfma_f32_16x16x32_bf16 v[184:187], a[28:31], a[8:11], v[184:187]
  buffer_load_dwordx4 v133, s[24:27], s50 offen offset:0 lds
  v_exp_f32 v24, v24
  v_mul_f32 v166, v54, v166
  v_mfma_f32_16x16x32_bf16 v[188:191], a[28:31], a[12:15], v[188:191]
  ds_read_b64_tr_b16 a[134:135], v2 offset:39488
  v_exp_f32 v25, v25
  v_mul_f32 v167, v55, v167
  v_mfma_f32_16x16x32_bf16 v[188:191], a[152:155], a[44:47], v[188:191]
  ds_read_b64_tr_b16 a[136:137], v2 offset:43072
  v_mul_f32 v164, v164, v26
  v_mul_f32 v165, v165, v27
  v_mul_f32 v166, v166, v28
  v_mfma_f32_16x16x32_bf16 v[188:191], a[156:159], a[60:63], v[188:191]
  v_mul_f32 v167, v167, v29
  v_cvt_pk_bf16_f32 v34, v160, v161
  v_cvt_pk_bf16_f32 v35, v162, v163
  v_mfma_f32_16x16x32_bf16 v[184:187], a[156:159], a[56:59], v[184:187]
  ds_read_b64_tr_b16 a[138:139], v2 offset:46656
  v_mfma_f32_16x16x32_bf16 v[184:187], a[152:155], a[40:43], v[184:187]
  buffer_load_dwordx4 v134, s[24:27], s50 offen offset:1024 lds
  v_mfma_f32_16x16x32_bf16 v[180:183], a[152:155], a[36:39], v[180:183]
  ds_read_b64_tr_b16 a[140:141], v2 offset:50240
  v_mfma_f32_16x16x32_bf16 v[180:183], a[156:159], a[52:55], v[180:183]
  buffer_store_dwordx4 v[32:35], v0, s[36:39], s65 offen offset:0 sc1
  v_mul_f32 v26, v19, v60
  v_mul_f32 v27, v19, v61
  v_mul_f32 v28, v19, v62
  v_mfma_f32_16x16x32_bf16 v[176:179], a[156:159], a[48:51], v[176:179]
  ds_read_b64_tr_b16 a[142:143], v2 offset:53824
  v_mul_f32 v29, v19, v63
  v_exp_f32 v26, v26
  v_mfma_f32_16x16x32_bf16 v[176:179], a[152:155], a[32:35], v[176:179]
  s_waitcnt lgkmcnt(8)
  v_fma_f32 v22, v22, v17, v17
  v_exp_f32 v27, v27
  v_fma_f32 v23, v23, v17, v17
  v_mfma_f32_16x16x32_bf16 v[64:67], a[160:163], a[64:67], v[64:67]
  buffer_load_dwordx4 v135, s[24:27], s50 offen offset:2048 lds
  v_exp_f32 v28, v28
  v_fma_f32 v24, v24, v17, v17
  v_mfma_f32_16x16x32_bf16 v[64:67], a[164:167], a[80:83], v[64:67]
  ds_read_b64_tr_b16 a[144:145], v1 offset:28768
  v_exp_f32 v29, v29
  v_fma_f32 v25, v25, v17, v17
  v_mfma_f32_16x16x32_bf16 v[68:71], a[164:167], a[84:87], v[68:71]
  ds_read_b64_tr_b16 a[146:147], v1 offset:32352
  v_cvt_pk_bf16_f32 v38, v164, v165
  v_cvt_pk_bf16_f32 v39, v166, v167
  v_mfma_f32_16x16x32_bf16 v[68:71], a[160:163], a[68:71], v[68:71]
  buffer_store_dwordx4 v[36:39], v0, s[36:39], s65 offen offset:1024 sc1
  v_rcp_f32 v22, v22
  v_fma_f32 v26, v26, v20, v20
  v_mfma_f32_16x16x32_bf16 v[72:75], a[160:163], a[72:75], v[72:75]
  ds_read_b64_tr_b16 a[148:149], v1 offset:35936
  v_rcp_f32 v23, v23
  v_fma_f32 v27, v27, v20, v20
  v_mfma_f32_16x16x32_bf16 v[72:75], a[164:167], a[88:91], v[72:75]
  buffer_load_dwordx4 v136, s[24:27], s50 offen offset:3072 lds
  v_rcp_f32 v24, v24
  v_fma_f32 v28, v28, v20, v20
  v_mfma_f32_16x16x32_bf16 v[76:79], a[164:167], a[92:95], v[76:79]
  ds_read_b64_tr_b16 a[150:151], v1 offset:39520
  v_rcp_f32 v25, v25
  v_fma_f32 v29, v29, v20, v20
  v_mfma_f32_16x16x32_bf16 v[76:79], a[160:163], a[76:79], v[76:79]
  v_rcp_f32 v26, v26
  v_mul_f32 v168, v56, v168
  v_mfma_f32_16x16x32_bf16 v[188:191], a[168:171], a[76:79], v[188:191]
  v_rcp_f32 v27, v27
  v_mul_f32 v169, v57, v169
  v_mfma_f32_16x16x32_bf16 v[188:191], a[172:175], a[92:95], v[188:191]
  v_rcp_f32 v28, v28
  v_mul_f32 v170, v58, v170
  v_mfma_f32_16x16x32_bf16 v[184:187], a[172:175], a[88:91], v[184:187]
  v_rcp_f32 v29, v29
  v_mul_f32 v171, v59, v171
  v_mul_f32 v168, v168, v22
  v_mfma_f32_16x16x32_bf16 v[184:187], a[168:171], a[72:75], v[184:187]
  v_mul_f32 v169, v169, v23
  v_mul_f32 v170, v170, v24
  v_mul_f32 v171, v171, v25
  v_mul_f32 v172, v60, v172
  v_mfma_f32_16x16x32_bf16 v[180:183], a[168:171], a[68:71], v[180:183]
  v_mul_f32 v173, v61, v173
  v_mul_f32 v174, v62, v174
  v_mul_f32 v175, v63, v175
  v_cvt_pk_bf16_f32 v42, v168, v169
  v_mfma_f32_16x16x32_bf16 v[180:183], a[172:175], a[84:87], v[180:183]
  v_cvt_pk_bf16_f32 v43, v170, v171
  v_mfma_f32_16x16x32_bf16 v[176:179], a[172:175], a[80:83], v[176:179]
  buffer_store_dwordx4 v[40:43], v0, s[36:39], s66 offen offset:0 sc1
  v_mul_f32 v172, v172, v26
  v_mul_f32 v173, v173, v27
  v_mul_f32 v174, v174, v28
  v_mfma_f32_16x16x32_bf16 v[176:179], a[168:171], a[64:67], v[176:179]
  s_waitcnt lgkmcnt(4)
  v_mul_f32 v175, v175, v29
  v_cvt_pk_bf16_f32 v46, v172, v173
  v_cvt_pk_bf16_f32 v47, v174, v175
  v_mfma_f32_16x16x32_bf16 v[64:67], a[128:131], a[96:99], v[64:67]
  ds_read_b128 a[16:19], v31 offset:768
  v_mfma_f32_16x16x32_bf16 v[64:67], a[132:135], a[112:115], v[64:67]
  ds_read_b64_tr_b16 a[152:153], v1 offset:43104
  v_mfma_f32_16x16x32_bf16 v[68:71], a[132:135], a[116:119], v[68:71]
  ds_read_b128 a[20:23], v31 offset:2816
  v_mfma_f32_16x16x32_bf16 v[68:71], a[128:131], a[100:103], v[68:71]
  ds_read_b64_tr_b16 a[154:155], v1 offset:46688
  v_mfma_f32_16x16x32_bf16 v[72:75], a[128:131], a[104:107], v[72:75]
  ds_read_b64_tr_b16 a[156:157], v1 offset:50272
  v_mfma_f32_16x16x32_bf16 v[72:75], a[132:135], a[120:123], v[72:75]
  buffer_store_dwordx4 v[44:47], v0, s[36:39], s66 offen offset:1024 sc1
  s_add_u32 s65, s65, 2048
  s_add_u32 s66, s66, 2048
  v_mfma_f32_16x16x32_bf16 v[76:79], a[132:135], a[124:127], v[76:79]
  ds_read_b64_tr_b16 a[158:159], v1 offset:53856
  v_mfma_f32_16x16x32_bf16 v[76:79], a[128:131], a[108:111], v[76:79]
  v_mfma_f32_16x16x32_bf16 v[188:191], a[136:139], a[108:111], v[188:191]
  ds_read_b64_tr_b16 a[160:161], v2 offset:96
  v_mul_f32 v22, v10, v64
  v_mul_f32 v23, v10, v65
  v_mul_f32 v24, v10, v66
  v_mfma_f32_16x16x32_bf16 v[188:191], a[140:143], a[124:127], v[188:191]
  v_mul_f32 v25, v10, v67
  v_exp_f32 v22, v22
  v_mul_f32 v26, v13, v68
  v_mfma_f32_16x16x32_bf16 v[184:187], a[140:143], a[120:123], v[184:187]
  ds_read_b64_tr_b16 a[162:163], v2 offset:3680
  v_exp_f32 v23, v23
  v_mul_f32 v27, v13, v69
  v_mfma_f32_16x16x32_bf16 v[184:187], a[136:139], a[104:107], v[184:187]
  v_exp_f32 v24, v24
  v_mul_f32 v28, v13, v70
  v_mfma_f32_16x16x32_bf16 v[180:183], a[136:139], a[100:103], v[180:183]
  ds_read_b64_tr_b16 a[164:165], v2 offset:7264
  v_exp_f32 v25, v25
  v_mul_f32 v29, v13, v71
  v_mfma_f32_16x16x32_bf16 v[180:183], a[140:143], a[116:119], v[180:183]
  v_exp_f32 v26, v26
  v_fma_f32 v22, v22, v11, v11
  v_mfma_f32_16x16x32_bf16 v[176:179], a[140:143], a[112:115], v[176:179]
  ds_read_b64_tr_b16 a[166:167], v2 offset:10848
  v_exp_f32 v27, v27
  v_fma_f32 v23, v23, v11, v11
  v_mfma_f32_16x16x32_bf16 v[176:179], a[136:139], a[96:99], v[176:179]
  s_waitcnt lgkmcnt(4)
  v_exp_f32 v28, v28
  v_fma_f32 v24, v24, v11, v11
  v_mfma_f32_16x16x32_bf16 v[80:83], a[144:147], a[32:35], v[80:83]
  ds_read_b64_tr_b16 a[168:169], v2 offset:14432
  v_exp_f32 v29, v29
  v_fma_f32 v25, v25, v11, v11
  v_mfma_f32_16x16x32_bf16 v[80:83], a[148:151], a[48:51], v[80:83]
  v_rcp_f32 v22, v22
  v_fma_f32 v26, v26, v14, v14
  v_mfma_f32_16x16x32_bf16 v[84:87], a[148:151], a[52:55], v[84:87]
  ds_read_b64_tr_b16 a[170:171], v2 offset:18016
  v_rcp_f32 v23, v23
  v_fma_f32 v27, v27, v14, v14
  v_mfma_f32_16x16x32_bf16 v[84:87], a[144:147], a[36:39], v[84:87]
  v_rcp_f32 v24, v24
  v_fma_f32 v28, v28, v14, v14
  v_mfma_f32_16x16x32_bf16 v[88:91], a[144:147], a[40:43], v[88:91]
  ds_read_b64_tr_b16 a[172:173], v2 offset:21600
  v_rcp_f32 v25, v25
  v_fma_f32 v29, v29, v14, v14
  v_mfma_f32_16x16x32_bf16 v[88:91], a[148:151], a[56:59], v[88:91]
  v_rcp_f32 v26, v26
  v_mul_f32 v176, v64, v176
  v_mfma_f32_16x16x32_bf16 v[92:95], a[148:151], a[60:63], v[92:95]
  ds_read_b64_tr_b16 a[174:175], v2 offset:25184
  v_rcp_f32 v27, v27
  v_mul_f32 v177, v65, v177
  v_mfma_f32_16x16x32_bf16 v[92:95], a[144:147], a[44:47], v[92:95]
  s_waitcnt lgkmcnt(11)
  v_rcp_f32 v28, v28
  v_mul_f32 v178, v66, v178
  v_mfma_f32_16x16x32_bf16 v[80:83], a[16:19], a[0:3], v[80:83]
  ds_read_b64_tr_b16 a[128:129], v2 offset:28768
  v_rcp_f32 v29, v29
  v_mul_f32 v179, v67, v179
  v_mfma_f32_16x16x32_bf16 v[84:87], a[16:19], a[4:7], v[84:87]
  v_mul_f32 v176, v176, v22
  v_mul_f32 v177, v177, v23
  v_mul_f32 v178, v178, v24
  v_mul_f32 v179, v179, v25
  v_mfma_f32_16x16x32_bf16 v[88:91], a[16:19], a[8:11], v[88:91]
  ds_read_b64_tr_b16 a[130:131], v2 offset:32352
  v_mul_f32 v22, v16, v72
  v_mul_f32 v23, v16, v73
  v_mul_f32 v24, v16, v74
  v_mfma_f32_16x16x32_bf16 v[92:95], a[16:19], a[12:15], v[92:95]
  v_mul_f32 v25, v16, v75
  v_exp_f32 v22, v22
  v_mul_f32 v180, v68, v180
  v_mfma_f32_16x16x32_bf16 v[192:195], a[20:23], a[0:3], v[192:195]
  ds_read_b64_tr_b16 a[132:133], v2 offset:35936
  v_exp_f32 v23, v23
  v_mul_f32 v181, v69, v181
  v_mfma_f32_16x16x32_bf16 v[196:199], a[20:23], a[4:7], v[196:199]
  v_exp_f32 v24, v24
  v_mul_f32 v182, v70, v182
  v_mfma_f32_16x16x32_bf16 v[200:203], a[20:23], a[8:11], v[200:203]
  ds_read_b64_tr_b16 a[134:135], v2 offset:39520
  v_exp_f32 v25, v25
  v_mul_f32 v183, v71, v183
  v_mfma_f32_16x16x32_bf16 v[204:207], a[20:23], a[12:15], v[204:207]
  v_mul_f32 v180, v180, v26
  v_mul_f32 v181, v181, v27
  v_mul_f32 v182, v182, v28
  v_mul_f32 v183, v183, v29
  v_mfma_f32_16x16x32_bf16 v[204:207], a[152:155], a[44:47], v[204:207]
  ds_read_b64_tr_b16 a[136:137], v2 offset:43104
  v_cvt_pk_bf16_f32 v64, v176, v177
  v_cvt_pk_bf16_f32 v65, v178, v179
  v_mul_f32 v26, v19, v76
  v_mfma_f32_16x16x32_bf16 v[204:207], a[156:159], a[60:63], v[204:207]
  v_mul_f32 v27, v19, v77
  v_mul_f32 v28, v19, v78
  v_mul_f32 v29, v19, v79
  v_mfma_f32_16x16x32_bf16 v[200:203], a[156:159], a[56:59], v[200:203]
  ds_read_b64_tr_b16 a[138:139], v2 offset:46688
  v_exp_f32 v26, v26
  v_fma_f32 v22, v22, v17, v17
  v_mfma_f32_16x16x32_bf16 v[200:203], a[152:155], a[40:43], v[200:203]
  v_exp_f32 v27, v27
  v_fma_f32 v23, v23, v17, v17
  v_mfma_f32_16x16x32_bf16 v[196:199], a[152:155], a[36:39], v[196:199]
  ds_read_b64_tr_b16 a[140:141], v2 offset:50272
  v_exp_f32 v28, v28
  v_fma_f32 v24, v24, v17, v17
  v_mfma_f32_16x16x32_bf16 v[196:199], a[156:159], a[52:55], v[196:199]
  v_exp_f32 v29, v29
  v_fma_f32 v25, v25, v17, v17
  v_cvt_pk_bf16_f32 v68, v180, v181
  v_mfma_f32_16x16x32_bf16 v[192:195], a[156:159], a[48:51], v[192:195]
  ds_read_b64_tr_b16 a[142:143], v2 offset:53856
  v_cvt_pk_bf16_f32 v69, v182, v183
  v_rcp_f32 v22, v22
  v_mfma_f32_16x16x32_bf16 v[192:195], a[152:155], a[32:35], v[192:195]
  s_waitcnt lgkmcnt(8)
  v_fma_f32 v26, v26, v20, v20
  v_rcp_f32 v23, v23
  v_fma_f32 v27, v27, v20, v20
  v_mfma_f32_16x16x32_bf16 v[80:83], a[160:163], a[64:67], v[80:83]
  ds_read_b64_tr_b16 a[144:145], v1 offset:28800
  v_rcp_f32 v24, v24
  v_fma_f32 v28, v28, v20, v20
  v_mfma_f32_16x16x32_bf16 v[80:83], a[164:167], a[80:83], v[80:83]
  v_rcp_f32 v25, v25
  v_fma_f32 v29, v29, v20, v20
  v_mfma_f32_16x16x32_bf16 v[84:87], a[164:167], a[84:87], v[84:87]
  ds_read_b64_tr_b16 a[146:147], v1 offset:32384
  v_rcp_f32 v26, v26
  v_mul_f32 v184, v72, v184
  v_mfma_f32_16x16x32_bf16 v[84:87], a[160:163], a[68:71], v[84:87]
  v_rcp_f32 v27, v27
  v_mul_f32 v185, v73, v185
  v_mfma_f32_16x16x32_bf16 v[88:91], a[160:163], a[72:75], v[88:91]
  ds_read_b64_tr_b16 a[148:149], v1 offset:35968
  v_rcp_f32 v28, v28
  v_mul_f32 v186, v74, v186
  v_mfma_f32_16x16x32_bf16 v[88:91], a[164:167], a[88:91], v[88:91]
  v_rcp_f32 v29, v29
  v_mul_f32 v187, v75, v187
  v_mul_f32 v184, v184, v22
  v_mfma_f32_16x16x32_bf16 v[92:95], a[164:167], a[92:95], v[92:95]
  ds_read_b64_tr_b16 a[150:151], v1 offset:39552
  v_mul_f32 v185, v185, v23
  v_mul_f32 v186, v186, v24
  v_mul_f32 v187, v187, v25
  v_mfma_f32_16x16x32_bf16 v[92:95], a[160:163], a[76:79], v[92:95]
  s_waitcnt vmcnt(0)
  s_barrier
  v_mul_f32 v188, v76, v188
  v_mul_f32 v189, v77, v189
  v_mul_f32 v190, v78, v190
  v_mfma_f32_16x16x32_bf16 v[204:207], a[168:171], a[76:79], v[204:207]
  s_mov_b64 exec, 1
  buffer_store_dword v254, v0, s[36:39], s45 offen sc1
  s_mov_b64 exec, -1
  s_lshl_b32 s45, s2, 7
  v_mfma_f32_16x16x32_bf16 v[204:207], a[172:175], a[92:95], v[204:207]
  s_add_u32 s45, s45, 5439488
  s_cmp_eq_u32 s44, 0
  s_cselect_b32 s45, s45, 1073741824
  v_mul_f32 v191, v79, v191
  v_cvt_pk_bf16_f32 v72, v184, v185
  v_mfma_f32_16x16x32_bf16 v[200:203], a[172:175], a[88:91], v[200:203]
  v_cvt_pk_bf16_f32 v73, v186, v187
  v_mul_f32 v188, v188, v26
  v_mul_f32 v189, v189, v27
  v_mul_f32 v190, v190, v28
  v_mfma_f32_16x16x32_bf16 v[200:203], a[168:171], a[72:75], v[200:203]
  v_mul_f32 v191, v191, v29
  v_cvt_pk_bf16_f32 v76, v188, v189
  v_cvt_pk_bf16_f32 v77, v190, v191
  v_mfma_f32_16x16x32_bf16 v[196:199], a[168:171], a[68:71], v[196:199]
  v_mfma_f32_16x16x32_bf16 v[196:199], a[172:175], a[84:87], v[196:199]
  v_mfma_f32_16x16x32_bf16 v[192:195], a[172:175], a[80:83], v[192:195]
  v_mfma_f32_16x16x32_bf16 v[192:195], a[168:171], a[64:67], v[192:195]
  s_waitcnt lgkmcnt(4)
  v_mfma_f32_16x16x32_bf16 v[80:83], a[128:131], a[96:99], v[80:83]
  ds_read_b128 a[24:27], v31 offset:1024
  v_mfma_f32_16x16x32_bf16 v[80:83], a[132:135], a[112:115], v[80:83]
  ds_read_b64_tr_b16 a[152:153], v1 offset:43136
  v_mfma_f32_16x16x32_bf16 v[84:87], a[132:135], a[116:119], v[84:87]
  ds_read_b128 a[28:31], v31 offset:3072
  v_mfma_f32_16x16x32_bf16 v[84:87], a[128:131], a[100:103], v[84:87]
  ds_read_b64_tr_b16 a[154:155], v1 offset:46720
  v_mfma_f32_16x16x32_bf16 v[88:91], a[128:131], a[104:107], v[88:91]
  ds_read_b64_tr_b16 a[156:157], v1 offset:50304
  v_mfma_f32_16x16x32_bf16 v[88:91], a[132:135], a[120:123], v[88:91]
  v_mfma_f32_16x16x32_bf16 v[92:95], a[132:135], a[124:127], v[92:95]
  ds_read_b64_tr_b16 a[158:159], v1 offset:53888
  v_mfma_f32_16x16x32_bf16 v[92:95], a[128:131], a[108:111], v[92:95]
  v_mfma_f32_16x16x32_bf16 v[204:207], a[136:139], a[108:111], v[204:207]
  ds_read_b64_tr_b16 a[160:161], v2 offset:128
  v_mul_f32 v22, v10, v80
  v_mul_f32 v23, v10, v81
  v_mul_f32 v24, v10, v82
  v_mfma_f32_16x16x32_bf16 v[204:207], a[140:143], a[124:127], v[204:207]
  v_mul_f32 v25, v10, v83
  v_exp_f32 v22, v22
  v_mul_f32 v26, v13, v84
  v_mfma_f32_16x16x32_bf16 v[200:203], a[140:143], a[120:123], v[200:203]
  ds_read_b64_tr_b16 a[162:163], v2 offset:3712
  v_exp_f32 v23, v23
  v_mul_f32 v27, v13, v85
  v_mfma_f32_16x16x32_bf16 v[200:203], a[136:139], a[104:107], v[200:203]
  v_exp_f32 v24, v24
  v_mul_f32 v28, v13, v86
  v_mfma_f32_16x16x32_bf16 v[196:199], a[136:139], a[100:103], v[196:199]
  ds_read_b64_tr_b16 a[164:165], v2 offset:7296
  v_exp_f32 v25, v25
  v_mul_f32 v29, v13, v87
  v_mfma_f32_16x16x32_bf16 v[196:199], a[140:143], a[116:119], v[196:199]
  v_exp_f32 v26, v26
  v_fma_f32 v22, v22, v11, v11
  v_mfma_f32_16x16x32_bf16 v[192:195], a[140:143], a[112:115], v[192:195]
  ds_read_b64_tr_b16 a[166:167], v2 offset:10880
  v_exp_f32 v27, v27
  v_fma_f32 v23, v23, v11, v11
  v_mfma_f32_16x16x32_bf16 v[192:195], a[136:139], a[96:99], v[192:195]
  s_waitcnt lgkmcnt(4)
  v_exp_f32 v28, v28
  v_fma_f32 v24, v24, v11, v11
  v_mfma_f32_16x16x32_bf16 v[96:99], a[144:147], a[32:35], v[96:99]
  ds_read_b64_tr_b16 a[168:169], v2 offset:14464
  v_exp_f32 v29, v29
  v_fma_f32 v25, v25, v11, v11
  v_mfma_f32_16x16x32_bf16 v[96:99], a[148:151], a[48:51], v[96:99]
  v_rcp_f32 v22, v22
  v_fma_f32 v26, v26, v14, v14
  v_mfma_f32_16x16x32_bf16 v[100:103], a[148:151], a[52:55], v[100:103]
  ds_read_b64_tr_b16 a[170:171], v2 offset:18048
  v_rcp_f32 v23, v23
  v_fma_f32 v27, v27, v14, v14
  v_mfma_f32_16x16x32_bf16 v[100:103], a[144:147], a[36:39], v[100:103]
  v_rcp_f32 v24, v24
  v_fma_f32 v28, v28, v14, v14
  v_mfma_f32_16x16x32_bf16 v[104:107], a[144:147], a[40:43], v[104:107]
  ds_read_b64_tr_b16 a[172:173], v2 offset:21632
  v_rcp_f32 v25, v25
  v_fma_f32 v29, v29, v14, v14
  v_mfma_f32_16x16x32_bf16 v[104:107], a[148:151], a[56:59], v[104:107]
  v_rcp_f32 v26, v26
  v_mul_f32 v192, v80, v192
  v_mfma_f32_16x16x32_bf16 v[108:111], a[148:151], a[60:63], v[108:111]
  ds_read_b64_tr_b16 a[174:175], v2 offset:25216
  v_rcp_f32 v27, v27
  v_mul_f32 v193, v81, v193
  v_mfma_f32_16x16x32_bf16 v[108:111], a[144:147], a[44:47], v[108:111]
  s_waitcnt lgkmcnt(11)
  v_rcp_f32 v28, v28
  v_mul_f32 v194, v82, v194
  v_mfma_f32_16x16x32_bf16 v[96:99], a[24:27], a[0:3], v[96:99]
  ds_read_b64_tr_b16 a[128:129], v2 offset:28800
  v_rcp_f32 v29, v29
  v_mul_f32 v195, v83, v195
  v_mfma_f32_16x16x32_bf16 v[100:103], a[24:27], a[4:7], v[100:103]
  v_mul_f32 v192, v192, v22
  v_mul_f32 v193, v193, v23
  v_mul_f32 v194, v194, v24
  v_mul_f32 v195, v195, v25
  v_mfma_f32_16x16x32_bf16 v[104:107], a[24:27], a[8:11], v[104:107]
  ds_read_b64_tr_b16 a[130:131], v2 offset:32384
  v_mul_f32 v22, v16, v88
  v_mul_f32 v23, v16, v89
  v_mul_f32 v24, v16, v90
  v_mfma_f32_16x16x32_bf16 v[108:111], a[24:27], a[12:15], v[108:111]
  v_mul_f32 v25, v16, v91
  v_exp_f32 v22, v22
  v_mul_f32 v196, v84, v196
  v_mfma_f32_16x16x32_bf16 v[208:211], a[28:31], a[0:3], v[208:211]
  ds_read_b64_tr_b16 a[132:133], v2 offset:35968
  v_exp_f32 v23, v23
  v_mul_f32 v197, v85, v197
  v_mfma_f32_16x16x32_bf16 v[212:215], a[28:31], a[4:7], v[212:215]
  v_exp_f32 v24, v24
  v_mul_f32 v198, v86, v198
  v_mfma_f32_16x16x32_bf16 v[216:219], a[28:31], a[8:11], v[216:219]
  ds_read_b64_tr_b16 a[134:135], v2 offset:39552
  v_exp_f32 v25, v25
  v_mul_f32 v199, v87, v199
  v_mfma_f32_16x16x32_bf16 v[220:223], a[28:31], a[12:15], v[220:223]
  v_mul_f32 v196, v196, v26
  v_mul_f32 v197, v197, v27
  v_mul_f32 v198, v198, v28
  v_mul_f32 v199, v199, v29
  v_mfma_f32_16x16x32_bf16 v[220:223], a[152:155], a[44:47], v[220:223]
  ds_read_b64_tr_b16 a[136:137], v2 offset:43136
  v_cvt_pk_bf16_f32 v66, v192, v193
  v_cvt_pk_bf16_f32 v67, v194, v195
  v_mfma_f32_16x16x32_bf16 v[220:223], a[156:159], a[60:63], v[220:223]
  buffer_store_dwordx4 v[64:67], v0, s[36:39], s65 offen offset:0 sc1
  v_mul_f32 v26, v19, v92
  v_mul_f32 v27, v19, v93
  v_mul_f32 v28, v19, v94
  v_mfma_f32_16x16x32_bf16 v[216:219], a[156:159], a[56:59], v[216:219]
  ds_read_b64_tr_b16 a[138:139], v2 offset:46720
  v_mul_f32 v29, v19, v95
  v_exp_f32 v26, v26
  v_mfma_f32_16x16x32_bf16 v[216:219], a[152:155], a[40:43], v[216:219]
  v_fma_f32 v22, v22, v17, v17
  v_exp_f32 v27, v27
  v_fma_f32 v23, v23, v17, v17
  v_mfma_f32_16x16x32_bf16 v[212:215], a[152:155], a[36:39], v[212:215]
  ds_read_b64_tr_b16 a[140:141], v2 offset:50304
  v_exp_f32 v28, v28
  v_fma_f32 v24, v24, v17, v17
  v_mfma_f32_16x16x32_bf16 v[212:215], a[156:159], a[52:55], v[212:215]
  v_exp_f32 v29, v29
  v_fma_f32 v25, v25, v17, v17
  v_cvt_pk_bf16_f32 v70, v196, v197
  v_mfma_f32_16x16x32_bf16 v[208:211], a[156:159], a[48:51], v[208:211]
  ds_read_b64_tr_b16 a[142:143], v2 offset:53888
  v_cvt_pk_bf16_f32 v71, v198, v199
  v_mfma_f32_16x16x32_bf16 v[208:211], a[152:155], a[32:35], v[208:211]
  s_waitcnt lgkmcnt(8)
  buffer_store_dwordx4 v[68:71], v0, s[36:39], s65 offen offset:1024 sc1
  v_rcp_f32 v22, v22
  v_fma_f32 v26, v26, v20, v20
  v_mfma_f32_16x16x32_bf16 v[96:99], a[160:163], a[64:67], v[96:99]
  ds_read_b64_tr_b16 a[144:145], v1 offset:28832
  v_rcp_f32 v23, v23
  v_fma_f32 v27, v27, v20, v20
  v_mfma_f32_16x16x32_bf16 v[96:99], a[164:167], a[80:83], v[96:99]
  v_rcp_f32 v24, v24
  v_fma_f32 v28, v28, v20, v20
  v_mfma_f32_16x16x32_bf16 v[100:103], a[164:167], a[84:87], v[100:103]
  ds_read_b64_tr_b16 a[146:147], v1 offset:32416
  v_rcp_f32 v25, v25
  v_fma_f32 v29, v29, v20, v20
  v_mfma_f32_16x16x32_bf16 v[100:103], a[160:163], a[68:71], v[100:103]
  v_rcp_f32 v26, v26
  v_mul_f32 v200, v88, v200
  v_mfma_f32_16x16x32_bf16 v[104:107], a[160:163], a[72:75], v[104:107]
  ds_read_b64_tr_b16 a[148:149], v1 offset:36000
  v_rcp_f32 v27, v27
  v_mul_f32 v201, v89, v201
  v_mfma_f32_16x16x32_bf16 v[104:107], a[164:167], a[88:91], v[104:107]
  v_rcp_f32 v28, v28
  v_mul_f32 v202, v90, v202
  v_mfma_f32_16x16x32_bf16 v[108:111], a[164:167], a[92:95], v[108:111]
  ds_read_b64_tr_b16 a[150:151], v1 offset:39584
  v_rcp_f32 v29, v29
  v_mul_f32 v203, v91, v203
  v_mfma_f32_16x16x32_bf16 v[108:111], a[160:163], a[76:79], v[108:111]
  v_mul_f32 v200, v200, v22
  v_mul_f32 v201, v201, v23
  v_mul_f32 v202, v202, v24
  v_mul_f32 v203, v203, v25
  v_mfma_f32_16x16x32_bf16 v[220:223], a[168:171], a[76:79], v[220:223]
  v_mul_f32 v204, v92, v204
  v_mul_f32 v205, v93, v205
  v_mul_f32 v206, v94, v206
  v_mul_f32 v207, v95, v207
  v_mfma_f32_16x16x32_bf16 v[220:223], a[172:175], a[92:95], v[220:223]
  v_cvt_pk_bf16_f32 v74, v200, v201
  v_cvt_pk_bf16_f32 v75, v202, v203
  v_mfma_f32_16x16x32_bf16 v[216:219], a[172:175], a[88:91], v[216:219]
  buffer_store_dwordx4 v[72:75], v0, s[36:39], s66 offen offset:0 sc1
  v_mul_f32 v204, v204, v26
  v_mul_f32 v205, v205, v27
  v_mul_f32 v206, v206, v28
  v_mfma_f32_16x16x32_bf16 v[216:219], a[168:171], a[72:75], v[216:219]
  v_mul_f32 v207, v207, v29
  v_cvt_pk_bf16_f32 v78, v204, v205
  v_cvt_pk_bf16_f32 v79, v206, v207
  v_mfma_f32_16x16x32_bf16 v[212:215], a[168:171], a[68:71], v[212:215]
  buffer_store_dwordx4 v[76:79], v0, s[36:39], s66 offen offset:1024 sc1
  s_add_u32 s65, s65, 2048
  s_add_u32 s66, s66, 2048
  v_mfma_f32_16x16x32_bf16 v[212:215], a[172:175], a[84:87], v[212:215]
  v_mfma_f32_16x16x32_bf16 v[208:211], a[172:175], a[80:83], v[208:211]
  v_mfma_f32_16x16x32_bf16 v[208:211], a[168:171], a[64:67], v[208:211]
  s_waitcnt lgkmcnt(4)
  v_mfma_f32_16x16x32_bf16 v[96:99], a[128:131], a[96:99], v[96:99]
  ds_read_b128 a[16:19], v31 offset:1280
  v_mfma_f32_16x16x32_bf16 v[96:99], a[132:135], a[112:115], v[96:99]
  ds_read_b64_tr_b16 a[152:153], v1 offset:43168
  v_mfma_f32_16x16x32_bf16 v[100:103], a[132:135], a[116:119], v[100:103]
  ds_read_b128 a[20:23], v31 offset:3328
  v_mfma_f32_16x16x32_bf16 v[100:103], a[128:131], a[100:103], v[100:103]
  ds_read_b64_tr_b16 a[154:155], v1 offset:46752
  v_mfma_f32_16x16x32_bf16 v[104:107], a[128:131], a[104:107], v[104:107]
  ds_read_b64_tr_b16 a[156:157], v1 offset:50336
  v_mfma_f32_16x16x32_bf16 v[104:107], a[132:135], a[120:123], v[104:107]
  v_mfma_f32_16x16x32_bf16 v[108:111], a[132:135], a[124:127], v[108:111]
  ds_read_b64_tr_b16 a[158:159], v1 offset:53920
  v_mfma_f32_16x16x32_bf16 v[108:111], a[128:131], a[108:111], v[108:111]
  v_mfma_f32_16x16x32_bf16 v[220:223], a[136:139], a[108:111], v[220:223]
  ds_read_b64_tr_b16 a[160:161], v2 offset:160
  v_mul_f32 v22, v10, v96
  v_mul_f32 v23, v10, v97
  v_mul_f32 v24, v10, v98
  v_mul_f32 v25, v10, v99
  v_mfma_f32_16x16x32_bf16 v[220:223], a[140:143], a[124:127], v[220:223]
  v_exp_f32 v22, v22
  v_mul_f32 v26, v13, v100
  v_mfma_f32_16x16x32_bf16 v[216:219], a[140:143], a[120:123], v[216:219]
  buffer_load_dword v139, v138, s[36:39], s91 offen sc1
  v_exp_f32 v23, v23
  v_mul_f32 v27, v13, v101
  v_mfma_f32_16x16x32_bf16 v[216:219], a[136:139], a[104:107], v[216:219]
  ds_read_b64_tr_b16 a[162:163], v2 offset:3744
  v_exp_f32 v24, v24
  v_mul_f32 v28, v13, v102
  v_mfma_f32_16x16x32_bf16 v[212:215], a[136:139], a[100:103], v[212:215]
  ds_read_b64_tr_b16 a[164:165], v2 offset:7328
  v_exp_f32 v25, v25
  v_mul_f32 v29, v13, v103
  v_mfma_f32_16x16x32_bf16 v[212:215], a[140:143], a[116:119], v[212:215]
  v_exp_f32 v26, v26
  v_fma_f32 v22, v22, v11, v11
  v_mfma_f32_16x16x32_bf16 v[208:211], a[140:143], a[112:115], v[208:211]
  ds_read_b64_tr_b16 a[166:167], v2 offset:10912
  v_exp_f32 v27, v27
  v_fma_f32 v23, v23, v11, v11
  v_mfma_f32_16x16x32_bf16 v[208:211], a[136:139], a[96:99], v[208:211]
  s_waitcnt lgkmcnt(4)
  v_exp_f32 v28, v28
  v_fma_f32 v24, v24, v11, v11
  v_mfma_f32_16x16x32_bf16 v[112:115], a[144:147], a[32:35], v[112:115]
  ds_read_b64_tr_b16 a[168:169], v2 offset:14496
  v_exp_f32 v29, v29
  v_fma_f32 v25, v25, v11, v11
  v_mfma_f32_16x16x32_bf16 v[112:115], a[148:151], a[48:51], v[112:115]
  v_rcp_f32 v22, v22
  v_fma_f32 v26, v26, v14, v14
  v_mfma_f32_16x16x32_bf16 v[116:119], a[148:151], a[52:55], v[116:119]
  ds_read_b64_tr_b16 a[170:171], v2 offset:18080
  v_rcp_f32 v23, v23
  v_fma_f32 v27, v27, v14, v14
  v_mfma_f32_16x16x32_bf16 v[116:119], a[144:147], a[36:39], v[116:119]
  v_rcp_f32 v24, v24
  v_fma_f32 v28, v28, v14, v14
  v_mfma_f32_16x16x32_bf16 v[120:123], a[144:147], a[40:43], v[120:123]
  ds_read_b64_tr_b16 a[172:173], v2 offset:21664
  v_rcp_f32 v25, v25
  v_fma_f32 v29, v29, v14, v14
  v_mfma_f32_16x16x32_bf16 v[120:123], a[148:151], a[56:59], v[120:123]
  v_rcp_f32 v26, v26
  v_mul_f32 v208, v96, v208
  v_mfma_f32_16x16x32_bf16 v[124:127], a[148:151], a[60:63], v[124:127]
  ds_read_b64_tr_b16 a[174:175], v2 offset:25248
  v_rcp_f32 v27, v27
  v_mul_f32 v209, v97, v209
  v_mfma_f32_16x16x32_bf16 v[124:127], a[144:147], a[44:47], v[124:127]
  s_waitcnt lgkmcnt(11)
  v_rcp_f32 v28, v28
  v_mul_f32 v210, v98, v210
  v_mfma_f32_16x16x32_bf16 v[112:115], a[16:19], a[0:3], v[112:115]
  ds_read_b64_tr_b16 a[128:129], v2 offset:28832
  v_rcp_f32 v29, v29
  v_mul_f32 v211, v99, v211
  v_mfma_f32_16x16x32_bf16 v[116:119], a[16:19], a[4:7], v[116:119]
  v_mul_f32 v208, v208, v22
  v_mul_f32 v209, v209, v23
  v_mul_f32 v210, v210, v24
  v_mul_f32 v211, v211, v25
  v_mfma_f32_16x16x32_bf16 v[120:123], a[16:19], a[8:11], v[120:123]
  ds_read_b64_tr_b16 a[130:131], v2 offset:32416
  v_mul_f32 v22, v16, v104
  v_mul_f32 v23, v16, v105
  v_mul_f32 v24, v16, v106
  v_mfma_f32_16x16x32_bf16 v[124:127], a[16:19], a[12:15], v[124:127]
  v_mul_f32 v25, v16, v107
  v_exp_f32 v22, v22
  v_mul_f32 v212, v100, v212
  v_mfma_f32_16x16x32_bf16 v[224:227], a[20:23], a[0:3], v[224:227]
  ds_read_b64_tr_b16 a[132:133], v2 offset:36000
  v_exp_f32 v23, v23
  v_mul_f32 v213, v101, v213
  v_mfma_f32_16x16x32_bf16 v[228:231], a[20:23], a[4:7], v[228:231]
  v_exp_f32 v24, v24
  v_mul_f32 v214, v102, v214
  v_mfma_f32_16x16x32_bf16 v[232:235], a[20:23], a[8:11], v[232:235]
  ds_read_b64_tr_b16 a[134:135], v2 offset:39584
  v_exp_f32 v25, v25
  v_mul_f32 v215, v103, v215
  v_mfma_f32_16x16x32_bf16 v[236:239], a[20:23], a[12:15], v[236:239]
  v_mul_f32 v212, v212, v26
  v_mul_f32 v213, v213, v27
  v_mul_f32 v214, v214, v28
  v_mul_f32 v215, v215, v29
  v_mfma_f32_16x16x32_bf16 v[236:239], a[152:155], a[44:47], v[236:239]
  ds_read_b64_tr_b16 a[136:137], v2 offset:43168
  v_cvt_pk_bf16_f32 v96, v208, v209
  v_cvt_pk_bf16_f32 v97, v210, v211
  v_mul_f32 v26, v19, v108
  v_mfma_f32_16x16x32_bf16 v[236:239], a[156:159], a[60:63], v[236:239]
  v_mul_f32 v27, v19, v109
  v_mul_f32 v28, v19, v110
  v_mul_f32 v29, v19, v111
  v_mfma_f32_16x16x32_bf16 v[232:235], a[156:159], a[56:59], v[232:235]
  ds_read_b64_tr_b16 a[138:139], v2 offset:46752
  v_exp_f32 v26, v26
  v_fma_f32 v22, v22, v17, v17
  v_mfma_f32_16x16x32_bf16 v[232:235], a[152:155], a[40:43], v[232:235]
  v_exp_f32 v27, v27
  v_fma_f32 v23, v23, v17, v17
  v_mfma_f32_16x16x32_bf16 v[228:231], a[152:155], a[36:39], v[228:231]
  ds_read_b64_tr_b16 a[140:141], v2 offset:50336
  v_exp_f32 v28, v28
  v_fma_f32 v24, v24, v17, v17
  v_mfma_f32_16x16x32_bf16 v[228:231], a[156:159], a[52:55], v[228:231]
Hb1_2:
  s_cbranch_execz Hb1_3
  v_exp_f32 v29, v29
  v_fma_f32 v25, v25, v17, v17
  v_cvt_pk_bf16_f32 v100, v212, v213
  v_mfma_f32_16x16x32_bf16 v[224:227], a[156:159], a[48:51], v[224:227]
  s_waitcnt vmcnt(0)
  v_cmp_ne_u32 vcc, s3, v139
  s_nop 4
  s_cbranch_vccnz CK7s
CK7x:
  v_mfma_f32_16x16x32_bf16 v[224:227], a[152:155], a[32:35], v[224:227]
  s_waitcnt lgkmcnt(7)
  s_lshl_b32 s51, s69, 11
  s_mov_b32 s91, 5439488
  ds_read_b64_tr_b16 a[142:143], v2 offset:53920
  v_cvt_pk_bf16_f32 v101, v214, v215
  v_mfma_f32_16x16x32_bf16 v[112:115], a[160:163], a[64:67], v[112:115]
  buffer_load_dwordx4 a[216:219], v137, s[36:39], s51 offen offset:0 sc1
  v_rcp_f32 v22, v22
  v_fma_f32 v26, v26, v20, v20
  v_mfma_f32_16x16x32_bf16 v[112:115], a[164:167], a[80:83], v[112:115]
  v_rcp_f32 v23, v23
  v_fma_f32 v27, v27, v20, v20
  v_mfma_f32_16x16x32_bf16 v[116:119], a[164:167], a[84:87], v[116:119]
  buffer_load_dwordx4 a[220:223], v137, s[36:39], s51 offen offset:1024 sc1
  v_rcp_f32 v24, v24
  v_fma_f32 v28, v28, v20, v20
  v_mfma_f32_16x16x32_bf16 v[116:119], a[160:163], a[68:71], v[116:119]
  v_rcp_f32 v25, v25
  v_fma_f32 v29, v29, v20, v20
  v_mfma_f32_16x16x32_bf16 v[120:123], a[160:163], a[72:75], v[120:123]
  buffer_load_dwordx4 a[224:227], v137, s[36:39], s51 offen offset:2048 sc1
  v_rcp_f32 v26, v26
  v_mul_f32 v216, v104, v216
  v_mfma_f32_16x16x32_bf16 v[120:123], a[164:167], a[88:91], v[120:123]
  v_rcp_f32 v27, v27
  v_mul_f32 v217, v105, v217
  v_mfma_f32_16x16x32_bf16 v[124:127], a[164:167], a[92:95], v[124:127]
  buffer_load_dwordx4 a[228:231], v137, s[36:39], s51 offen offset:3072 sc1
  s_lshl_b32 s51, s71, 11
  v_rcp_f32 v28, v28
  v_mfma_f32_16x16x32_bf16 v[124:127], a[160:163], a[76:79], v[124:127]
  s_waitcnt vmcnt(22)
  s_barrier
  v_mul_f32 v218, v106, v218
  v_rcp_f32 v29, v29
  v_mfma_f32_16x16x32_bf16 v[236:239], a[168:171], a[76:79], v[236:239]
  buffer_load_dwordx4 a[0:3], v137, s[36:39], s51 offen offset:0 sc1
  v_mul_f32 v219, v107, v219
  v_mul_f32 v216, v216, v22
  v_mul_f32 v217, v217, v23
  v_mfma_f32_16x16x32_bf16 v[236:239], a[172:175], a[92:95], v[236:239]
  v_mul_f32 v218, v218, v24
  v_mul_f32 v219, v219, v25
  v_mul_f32 v220, v108, v220
  v_mul_f32 v221, v109, v221
  v_mfma_f32_16x16x32_bf16 v[232:235], a[172:175], a[88:91], v[232:235]
  buffer_load_dwordx4 a[4:7], v137, s[36:39], s51 offen offset:1024 sc1
  v_mul_f32 v222, v110, v222
  v_mul_f32 v223, v111, v223
  v_cvt_pk_bf16_f32 v104, v216, v217
  v_mfma_f32_16x16x32_bf16 v[232:235], a[168:171], a[72:75], v[232:235]
  v_cvt_pk_bf16_f32 v105, v218, v219
  v_mul_f32 v220, v220, v26
  v_mul_f32 v221, v221, v27
  v_mul_f32 v222, v222, v28
  v_mfma_f32_16x16x32_bf16 v[228:231], a[168:171], a[68:71], v[228:231]
  buffer_load_dwordx4 a[8:11], v137, s[36:39], s51 offen offset:2048 sc1
  v_mul_f32 v223, v223, v29
  v_cvt_pk_bf16_f32 v108, v220, v221
  v_cvt_pk_bf16_f32 v109, v222, v223
  v_mfma_f32_16x16x32_bf16 v[228:231], a[172:175], a[84:87], v[228:231]
  v_mfma_f32_16x16x32_bf16 v[224:227], a[172:175], a[80:83], v[224:227]
  buffer_load_dwordx4 a[12:15], v137, s[36:39], s51 offen offset:3072 sc1
  s_lshl_b32 s51, s72, 11
  v_mfma_f32_16x16x32_bf16 v[224:227], a[168:171], a[64:67], v[224:227]
  s_waitcnt lgkmcnt(0)
  v_mfma_f32_16x16x32_bf16 v[112:115], a[128:131], a[96:99], v[112:115]
  s_barrier
  buffer_load_dwordx4 a[16:19], v137, s[36:39], s51 offen offset:0 sc1
  ds_read_b64_tr_b16 a[176:177], v244 offset:49152
  v_mfma_f32_16x16x32_bf16 v[112:115], a[132:135], a[112:115], v[112:115]
  ds_read_b64_tr_b16 a[178:179], v244 offset:53248
  v_mfma_f32_16x16x32_bf16 v[116:119], a[132:135], a[116:119], v[116:119]
  buffer_load_dwordx4 a[20:23], v137, s[36:39], s51 offen offset:1024 sc1
  ds_read_b64_tr_b16 a[180:181], v244 offset:57344
  v_mfma_f32_16x16x32_bf16 v[116:119], a[128:131], a[100:103], v[116:119]
  ds_read_b64_tr_b16 a[182:183], v244 offset:61440
  v_mfma_f32_16x16x32_bf16 v[120:123], a[128:131], a[104:107], v[120:123]
  buffer_load_dwordx4 a[24:27], v137, s[36:39], s51 offen offset:2048 sc1
  ds_read_b64_tr_b16 a[184:185], v245 offset:49152
  v_mfma_f32_16x16x32_bf16 v[120:123], a[132:135], a[120:123], v[120:123]
  ds_read_b64_tr_b16 a[186:187], v245 offset:53248
  v_mfma_f32_16x16x32_bf16 v[124:127], a[132:135], a[124:127], v[124:127]
  buffer_load_dwordx4 a[28:31], v137, s[36:39], s51 offen offset:3072 sc1
  s_cmp_eq_u32 s87, 3
  s_cselect_b32 s73, 52, 24
  s_lshl_b32 s50, s73, 16
  v_mfma_f32_16x16x32_bf16 v[124:127], a[128:131], a[108:111], v[124:127]
  s_add_u32 m0, s70, 16384
  ds_read_b64_tr_b16 a[188:189], v245 offset:57344
  ds_read_b64_tr_b16 a[190:191], v245 offset:61440
  v_mfma_f32_16x16x32_bf16 v[236:239], a[136:139], a[108:111], v[236:239]
  ds_read_b64_tr_b16 a[192:193], v246 offset:49152
  v_mul_f32 v22, v10, v112
  v_mul_f32 v23, v10, v113
  v_mul_f32 v24, v10, v114
  v_mfma_f32_16x16x32_bf16 v[236:239], a[140:143], a[124:127], v[236:239]
  ds_read_b64_tr_b16 a[194:195], v246 offset:53248
  v_mul_f32 v25, v10, v115
  v_exp_f32 v22, v22
  v_mfma_f32_16x16x32_bf16 v[232:235], a[140:143], a[120:123], v[232:235]
  buffer_load_dwordx4 v133, s[24:27], s50 offen offset:0 lds
  ds_read_b64_tr_b16 a[196:197], v246 offset:57344
  v_mul_f32 v26, v13, v116
  v_mfma_f32_16x16x32_bf16 v[232:235], a[136:139], a[104:107], v[232:235]
  ds_read_b64_tr_b16 a[198:199], v246 offset:61440
  v_exp_f32 v23, v23
  v_mul_f32 v27, v13, v117
  v_mfma_f32_16x16x32_bf16 v[228:231], a[136:139], a[100:103], v[228:231]
  s_lshl_b32 s51, s73, 11
  ds_read_b64_tr_b16 a[200:201], v247 offset:49152
  v_exp_f32 v24, v24
  v_mul_f32 v28, v13, v118
  v_mfma_f32_16x16x32_bf16 v[228:231], a[140:143], a[116:119], v[228:231]
  ds_read_b64_tr_b16 a[202:203], v247 offset:53248
  v_exp_f32 v25, v25
  v_mul_f32 v29, v13, v119
  v_mfma_f32_16x16x32_bf16 v[224:227], a[140:143], a[112:115], v[224:227]
  ds_read_b64_tr_b16 a[204:205], v247 offset:57344
  v_exp_f32 v26, v26
  v_fma_f32 v22, v22, v11, v11
  v_mfma_f32_16x16x32_bf16 v[224:227], a[136:139], a[96:99], v[224:227]
  s_waitcnt vmcnt(9) lgkmcnt(11)
  ds_read_b64_tr_b16 a[206:207], v247 offset:61440
  v_exp_f32 v27, v27
  v_fma_f32 v23, v23, v11, v11
  v_mfma_f32_16x16x32_bf16 v[32:35], a[176:179], a[216:219], 0
  buffer_load_dwordx4 a[32:35], v137, s[36:39], s51 offen offset:0 sc1
  ds_read_b64_tr_b16 a[208:209], v244 offset:51200
  v_exp_f32 v28, v28
  v_mfma_f32_16x16x32_bf16 v[32:35], a[180:183], a[224:227], v[32:35]
  ds_read_b64_tr_b16 a[210:211], v244 offset:55296
  v_fma_f32 v24, v24, v11, v11
  v_exp_f32 v29, v29
  v_mfma_f32_16x16x32_bf16 v[36:39], a[180:183], a[228:231], 0
  buffer_load_dwordx4 v134, s[24:27], s50 offen offset:1024 lds
  ds_read_b64_tr_b16 a[212:213], v244 offset:59392
  v_fma_f32 v25, v25, v11, v11
  v_mfma_f32_16x16x32_bf16 v[36:39], a[176:179], a[220:223], v[36:39]
  s_waitcnt lgkmcnt(11)
  ds_read_b64_tr_b16 a[214:215], v244 offset:63488
  v_rcp_f32 v22, v22
  v_fma_f32 v26, v26, v14, v14
  v_mfma_f32_16x16x32_bf16 v[44:47], a[184:187], a[220:223], 0
  ds_read_b64_tr_b16 a[176:177], v245 offset:51200
  v_rcp_f32 v23, v23
  v_fma_f32 v27, v27, v14, v14
  v_mfma_f32_16x16x32_bf16 v[44:47], a[188:191], a[228:231], v[44:47]
  buffer_load_dwordx4 a[36:39], v137, s[36:39], s51 offen offset:1024 sc1
  ds_read_b64_tr_b16 a[178:179], v245 offset:55296
  v_rcp_f32 v24, v24
  v_mfma_f32_16x16x32_bf16 v[40:43], a[188:191], a[224:227], 0
  ds_read_b64_tr_b16 a[180:181], v245 offset:59392
  v_fma_f32 v28, v28, v14, v14
  v_rcp_f32 v25, v25
  v_mfma_f32_16x16x32_bf16 v[40:43], a[184:187], a[216:219], v[40:43]
  s_waitcnt vmcnt(30) lgkmcnt(11)
  s_barrier
  ds_read_b64_tr_b16 a[182:183], v245 offset:63488
  v_fma_f32 v29, v29, v14, v14
  v_mfma_f32_16x16x32_bf16 v[48:51], a[192:195], a[216:219], 0
  ds_read_b64_tr_b16 a[184:185], v246 offset:51200
  v_rcp_f32 v26, v26
  v_mul_f32 v224, v112, v224
  v_mfma_f32_16x16x32_bf16 v[48:51], a[196:199], a[224:227], v[48:51]
  buffer_load_dwordx4 v135, s[24:27], s50 offen offset:2048 lds
  ds_read_b64_tr_b16 a[186:187], v246 offset:55296
  v_rcp_f32 v27, v27
  v_mfma_f32_16x16x32_bf16 v[52:55], a[196:199], a[228:231], 0
  ds_read_b64_tr_b16 a[188:189], v246 offset:59392
  v_mul_f32 v225, v113, v225
  v_rcp_f32 v28, v28
  v_mfma_f32_16x16x32_bf16 v[52:55], a[192:195], a[220:223], v[52:55]
  s_waitcnt lgkmcnt(11)
  ds_read_b64_tr_b16 a[190:191], v246 offset:63488
  v_mul_f32 v226, v114, v226
  v_rcp_f32 v29, v29
  v_mfma_f32_16x16x32_bf16 v[60:63], a[200:203], a[220:223], 0
  ds_read_b64_tr_b16 a[192:193], v247 offset:51200
  v_mul_f32 v227, v115, v227
  v_mul_f32 v224, v224, v22
  v_mul_f32 v225, v225, v23
  v_mfma_f32_16x16x32_bf16 v[60:63], a[204:207], a[228:231], v[60:63]
  buffer_load_dwordx4 a[40:43], v137, s[36:39], s51 offen offset:2048 sc1
  ds_read_b64_tr_b16 a[194:195], v247 offset:55296
  v_mul_f32 v226, v226, v24
  v_mul_f32 v227, v227, v25
  v_mfma_f32_16x16x32_bf16 v[56:59], a[204:207], a[224:227], 0
  ds_read_b64_tr_b16 a[196:197], v247 offset:59392
  v_mul_f32 v22, v16, v120
  v_mul_f32 v23, v16, v121
  v_mul_f32 v24, v16, v122
  v_mfma_f32_16x16x32_bf16 v[56:59], a[200:203], a[216:219], v[56:59]
  s_waitcnt lgkmcnt(11)
  ds_read_b64_tr_b16 a[198:199], v247 offset:63488
  v_mul_f32 v25, v16, v123
  v_exp_f32 v22, v22
  v_mfma_f32_16x16x32_bf16 v[144:147], a[208:211], a[216:219], 0
  buffer_load_dwordx4 v136, s[24:27], s50 offen offset:3072 lds
  ds_read_b64_tr_b16 a[200:201], v248 offset:0
  v_mul_f32 v228, v116, v228
  v_mfma_f32_16x16x32_bf16 v[144:147], a[212:215], a[224:227], v[144:147]
  ds_read_b64_tr_b16 a[202:203], v248 offset:4096
  v_exp_f32 v23, v23
  v_mul_f32 v229, v117, v229
  v_mfma_f32_16x16x32_bf16 v[148:151], a[212:215], a[228:231], 0
  ds_read_b64_tr_b16 a[204:205], v248 offset:8192
  v_exp_f32 v24, v24
  v_mul_f32 v230, v118, v230
  v_mfma_f32_16x16x32_bf16 v[148:151], a[208:211], a[220:223], v[148:151]
  s_waitcnt lgkmcnt(11)
  ds_read_b64_tr_b16 a[206:207], v248 offset:12288
  v_exp_f32 v25, v25
  v_mul_f32 v231, v119, v231
  v_mfma_f32_16x16x32_bf16 v[156:159], a[176:179], a[220:223], 0
  buffer_load_dwordx4 a[44:47], v137, s[36:39], s51 offen offset:3072 sc1
  s_mov_b32 s74, 31
  s_lshl_b32 s50, s74, 16
  s_add_u32 m0, s70, 32768
  v_mfma_f32_16x16x32_bf16 v[156:159], a[180:183], a[228:231], v[156:159]
  ds_read_b64_tr_b16 a[208:209], v249 offset:0
  ds_read_b64_tr_b16 a[210:211], v249 offset:4096
  v_mul_f32 v228, v228, v26
  v_mul_f32 v229, v229, v27
  v_mfma_f32_16x16x32_bf16 v[152:155], a[180:183], a[224:227], 0
  ds_read_b64_tr_b16 a[212:213], v249 offset:8192
  v_mul_f32 v230, v230, v28
  v_mul_f32 v231, v231, v29
  v_cvt_pk_bf16_f32 v98, v224, v225
  v_mfma_f32_16x16x32_bf16 v[152:155], a[176:179], a[216:219], v[152:155]
  s_waitcnt lgkmcnt(11)
  ds_read_b64_tr_b16 a[214:215], v249 offset:12288
  v_cvt_pk_bf16_f32 v99, v226, v227
  v_mfma_f32_16x16x32_bf16 v[160:163], a[184:187], a[216:219], 0
  buffer_load_dwordx4 v133, s[24:27], s50 offen offset:0 lds
  s_lshl_b32 s51, s74, 11
  ds_read_b64_tr_b16 a[176:177], v250 offset:0
  v_mfma_f32_16x16x32_bf16 v[160:163], a[188:191], a[224:227], v[160:163]
  ds_read_b64_tr_b16 a[178:179], v250 offset:4096
  v_mfma_f32_16x16x32_bf16 v[164:167], a[188:191], a[228:231], 0
  ds_read_b64_tr_b16 a[180:181], v250 offset:8192
  buffer_store_dwordx4 v[96:99], v0, s[36:39], s65 offen offset:0 sc1
  v_mul_f32 v26, v19, v124
  v_mul_f32 v27, v19, v125
  v_mfma_f32_16x16x32_bf16 v[164:167], a[184:187], a[220:223], v[164:167]
  s_waitcnt lgkmcnt(11)
  ds_read_b64_tr_b16 a[182:183], v250 offset:12288
  v_mul_f32 v28, v19, v126
  v_mul_f32 v29, v19, v127
  v_mfma_f32_16x16x32_bf16 v[172:175], a[192:195], a[220:223], 0
  buffer_load_dwordx4 a[48:51], v137, s[36:39], s51 offen offset:0 sc1
  ds_read_b64_tr_b16 a[184:185], v251 offset:0
  v_exp_f32 v26, v26
  v_mfma_f32_16x16x32_bf16 v[172:175], a[196:199], a[228:231], v[172:175]
  ds_read_b64_tr_b16 a[186:187], v251 offset:4096
  v_fma_f32 v22, v22, v17, v17
  v_exp_f32 v27, v27
  v_mfma_f32_16x16x32_bf16 v[168:171], a[196:199], a[224:227], 0
  ds_read_b64_tr_b16 a[188:189], v251 offset:8192
  v_fma_f32 v23, v23, v17, v17
  v_exp_f32 v28, v28
  v_mfma_f32_16x16x32_bf16 v[168:171], a[192:195], a[216:219], v[168:171]
  s_waitcnt vmcnt(15) lgkmcnt(11)
  ds_read_b64_tr_b16 a[190:191], v251 offset:12288
  v_fma_f32 v24, v24, v17, v17
  v_exp_f32 v29, v29
  v_mfma_f32_16x16x32_bf16 v[32:35], a[200:203], a[0:3], v[32:35]
  buffer_load_dwordx4 v134, s[24:27], s50 offen offset:1024 lds
  ds_read_b64_tr_b16 a[192:193], v248 offset:2048
  v_fma_f32 v25, v25, v17, v17
  v_cvt_pk_bf16_f32 v102, v228, v229
  v_mfma_f32_16x16x32_bf16 v[32:35], a[204:207], a[8:11], v[32:35]
  ds_read_b64_tr_b16 a[194:195], v248 offset:6144
  v_cvt_pk_bf16_f32 v103, v230, v231
  v_mfma_f32_16x16x32_bf16 v[36:39], a[204:207], a[12:15], v[36:39]
  ds_read_b64_tr_b16 a[196:197], v248 offset:10240
  buffer_store_dwordx4 v[100:103], v0, s[36:39], s65 offen offset:1024 sc1
  v_rcp_f32 v22, v22
  v_mfma_f32_16x16x32_bf16 v[36:39], a[200:203], a[4:7], v[36:39]
  s_waitcnt lgkmcnt(11)
  ds_read_b64_tr_b16 a[198:199], v248 offset:14336
  v_fma_f32 v26, v26, v20, v20
  v_rcp_f32 v23, v23
  v_mfma_f32_16x16x32_bf16 v[44:47], a[208:211], a[4:7], v[44:47]
  buffer_load_dwordx4 a[52:55], v137, s[36:39], s51 offen offset:1024 sc1
  ds_read_b64_tr_b16 a[200:201], v249 offset:2048
  v_fma_f32 v27, v27, v20, v20
  v_mfma_f32_16x16x32_bf16 v[44:47], a[212:215], a[12:15], v[44:47]
  ds_read_b64_tr_b16 a[202:203], v249 offset:6144
  v_rcp_f32 v24, v24
  v_fma_f32 v28, v28, v20, v20
  v_mfma_f32_16x16x32_bf16 v[40:43], a[212:215], a[8:11], v[40:43]
  ds_read_b64_tr_b16 a[204:205], v249 offset:10240
  v_rcp_f32 v25, v25
  v_fma_f32 v29, v29, v20, v20
  v_mfma_f32_16x16x32_bf16 v[40:43], a[208:211], a[0:3], v[40:43]
  s_waitcnt vmcnt(34) lgkmcnt(11)
  s_barrier
  buffer_load_dwordx4 v135, s[24:27], s50 offen offset:2048 lds
  ds_read_b64_tr_b16 a[206:207], v249 offset:14336
  v_mfma_f32_16x16x32_bf16 v[48:51], a[176:179], a[0:3], v[48:51]
  ds_read_b64_tr_b16 a[208:209], v250 offset:2048
  v_rcp_f32 v26, v26
  v_mul_f32 v232, v120, v232
  v_mfma_f32_16x16x32_bf16 v[48:51], a[180:183], a[8:11], v[48:51]
  ds_read_b64_tr_b16 a[210:211], v250 offset:6144
  v_rcp_f32 v27, v27
  v_mul_f32 v233, v121, v233
  v_mfma_f32_16x16x32_bf16 v[52:55], a[180:183], a[12:15], v[52:55]
  ds_read_b64_tr_b16 a[212:213], v250 offset:10240
  v_rcp_f32 v28, v28
  v_mul_f32 v234, v122, v234
  v_mfma_f32_16x16x32_bf16 v[52:55], a[176:179], a[4:7], v[52:55]
  s_waitcnt lgkmcnt(11)
  buffer_load_dwordx4 a[56:59], v137, s[36:39], s51 offen offset:2048 sc1
  ds_read_b64_tr_b16 a[214:215], v250 offset:14336
  v_rcp_f32 v29, v29
  v_mfma_f32_16x16x32_bf16 v[60:63], a[184:187], a[4:7], v[60:63]
  ds_read_b64_tr_b16 a[176:177], v251 offset:2048
  v_mul_f32 v235, v123, v235
  v_mul_f32 v232, v232, v22
  v_mul_f32 v233, v233, v23
  v_mfma_f32_16x16x32_bf16 v[60:63], a[188:191], a[12:15], v[60:63]
  ds_read_b64_tr_b16 a[178:179], v251 offset:6144
  v_mul_f32 v234, v234, v24
  v_mul_f32 v235, v235, v25
  v_mul_f32 v236, v124, v236
  v_mfma_f32_16x16x32_bf16 v[56:59], a[188:191], a[8:11], v[56:59]
  ds_read_b64_tr_b16 a[180:181], v251 offset:10240
  v_mul_f32 v237, v125, v237
  v_mul_f32 v238, v126, v238
  v_mul_f32 v239, v127, v239
  v_mfma_f32_16x16x32_bf16 v[56:59], a[184:187], a[0:3], v[56:59]
  s_waitcnt lgkmcnt(11)
  buffer_load_dwordx4 v136, s[24:27], s50 offen offset:3072 lds
  ds_read_b64_tr_b16 a[182:183], v251 offset:14336
  v_cvt_pk_bf16_f32 v106, v232, v233
  v_cvt_pk_bf16_f32 v107, v234, v235
  v_mfma_f32_16x16x32_bf16 v[144:147], a[192:195], a[0:3], v[144:147]
  ds_read_b64_tr_b16 a[184:185], v240 offset:0
  v_mfma_f32_16x16x32_bf16 v[144:147], a[196:199], a[8:11], v[144:147]
  ds_read_b64_tr_b16 a[186:187], v240 offset:4096
  buffer_store_dwordx4 v[104:107], v0, s[36:39], s66 offen offset:0 sc1
  v_mul_f32 v236, v236, v26
  v_mul_f32 v237, v237, v27
  v_mfma_f32_16x16x32_bf16 v[148:151], a[196:199], a[12:15], v[148:151]
  ds_read_b64_tr_b16 a[188:189], v240 offset:8192
  v_mul_f32 v238, v238, v28
  v_mul_f32 v239, v239, v29
  v_cvt_pk_bf16_f32 v110, v236, v237
  v_mfma_f32_16x16x32_bf16 v[148:151], a[192:195], a[4:7], v[148:151]
  s_waitcnt lgkmcnt(11)
  buffer_load_dwordx4 a[60:63], v137, s[36:39], s51 offen offset:3072 sc1
  s_cmp_eq_u32 s87, 1
  s_cselect_b32 s75, 10, 38
  s_lshl_b32 s50, s75, 16
  v_mfma_f32_16x16x32_bf16 v[156:159], a[200:203], a[4:7], v[156:159]
  s_add_u32 m0, s70, 49152
  ds_read_b64_tr_b16 a[190:191], v240 offset:12288
  ds_read_b64_tr_b16 a[192:193], v241 offset:0
  v_cvt_pk_bf16_f32 v111, v238, v239
  v_mfma_f32_16x16x32_bf16 v[156:159], a[204:207], a[12:15], v[156:159]
  ds_read_b64_tr_b16 a[194:195], v241 offset:4096
  buffer_store_dwordx4 v[108:111], v0, s[36:39], s66 offen offset:1024 sc1
  v_mfma_f32_16x16x32_bf16 v[152:155], a[204:207], a[8:11], v[152:155]
  ds_read_b64_tr_b16 a[196:197], v241 offset:8192
  v_mfma_f32_16x16x32_bf16 v[152:155], a[200:203], a[0:3], v[152:155]
  s_waitcnt lgkmcnt(11)
  buffer_load_dwordx4 v133, s[24:27], s50 offen offset:0 lds
  s_lshl_b32 s51, s75, 11
  ds_read_b64_tr_b16 a[198:199], v241 offset:12288
  v_mfma_f32_16x16x32_bf16 v[160:163], a[208:211], a[0:3], v[160:163]
  ds_read_b64_tr_b16 a[200:201], v242 offset:0
  v_mfma_f32_16x16x32_bf16 v[160:163], a[212:215], a[8:11], v[160:163]
  ds_read_b64_tr_b16 a[202:203], v242 offset:4096
  v_mfma_f32_16x16x32_bf16 v[164:167], a[212:215], a[12:15], v[164:167]
  buffer_load_dwordx4 a[64:67], v137, s[36:39], s51 offen offset:0 sc1
  ds_read_b64_tr_b16 a[204:205], v242 offset:8192
  v_mfma_f32_16x16x32_bf16 v[164:167], a[208:211], a[4:7], v[164:167]
  s_waitcnt lgkmcnt(11)
  ds_read_b64_tr_b16 a[206:207], v242 offset:12288
  v_mfma_f32_16x16x32_bf16 v[172:175], a[176:179], a[4:7], v[172:175]
  ds_read_b64_tr_b16 a[208:209], v243 offset:0
  v_mfma_f32_16x16x32_bf16 v[172:175], a[180:183], a[12:15], v[172:175]
  ds_read_b64_tr_b16 a[210:211], v243 offset:4096
  v_mfma_f32_16x16x32_bf16 v[168:171], a[180:183], a[8:11], v[168:171]
  buffer_load_dwordx4 v134, s[24:27], s50 offen offset:1024 lds
  ds_read_b64_tr_b16 a[212:213], v243 offset:8192
  v_mfma_f32_16x16x32_bf16 v[168:171], a[176:179], a[0:3], v[168:171]
  s_waitcnt vmcnt(23) lgkmcnt(11)
  ds_read_b64_tr_b16 a[214:215], v243 offset:12288
  v_mfma_f32_16x16x32_bf16 v[32:35], a[184:187], a[16:19], v[32:35]
  ds_read_b64_tr_b16 a[176:177], v240 offset:2048
  v_mfma_f32_16x16x32_bf16 v[32:35], a[188:191], a[24:27], v[32:35]
  ds_read_b64_tr_b16 a[178:179], v240 offset:6144
  v_mfma_f32_16x16x32_bf16 v[36:39], a[188:191], a[28:31], v[36:39]
  buffer_load_dwordx4 a[68:71], v137, s[36:39], s51 offen offset:1024 sc1
  ds_read_b64_tr_b16 a[180:181], v240 offset:10240
  v_mfma_f32_16x16x32_bf16 v[36:39], a[184:187], a[20:23], v[36:39]
  s_waitcnt lgkmcnt(11)
  ds_read_b64_tr_b16 a[182:183], v240 offset:14336
  v_mfma_f32_16x16x32_bf16 v[44:47], a[192:195], a[20:23], v[44:47]
  ds_read_b64_tr_b16 a[184:185], v241 offset:2048
  v_mfma_f32_16x16x32_bf16 v[44:47], a[196:199], a[28:31], v[44:47]
  ds_read_b64_tr_b16 a[186:187], v241 offset:6144
  v_mfma_f32_16x16x32_bf16 v[40:43], a[196:199], a[24:27], v[40:43]
  buffer_load_dwordx4 v135, s[24:27], s50 offen offset:2048 lds
  ds_read_b64_tr_b16 a[188:189], v241 offset:10240
  v_mfma_f32_16x16x32_bf16 v[40:43], a[192:195], a[16:19], v[40:43]
  s_waitcnt vmcnt(18) lgkmcnt(11)
  s_barrier
  ds_read_b64_tr_b16 a[190:191], v241 offset:14336
  v_mfma_f32_16x16x32_bf16 v[48:51], a[200:203], a[16:19], v[48:51]
  ds_read_b64_tr_b16 a[192:193], v242 offset:2048
  v_mfma_f32_16x16x32_bf16 v[48:51], a[204:207], a[24:27], v[48:51]
  buffer_load_dwordx4 a[72:75], v137, s[36:39], s51 offen offset:2048 sc1
  ds_read_b64_tr_b16 a[194:195], v242 offset:6144
  v_mfma_f32_16x16x32_bf16 v[52:55], a[204:207], a[28:31], v[52:55]
  ds_read_b64_tr_b16 a[196:197], v242 offset:10240
  v_mfma_f32_16x16x32_bf16 v[52:55], a[200:203], a[20:23], v[52:55]
  s_waitcnt lgkmcnt(11)
  ds_read_b64_tr_b16 a[198:199], v242 offset:14336
  v_mfma_f32_16x16x32_bf16 v[60:63], a[208:211], a[20:23], v[60:63]
  ds_read_b64_tr_b16 a[200:201], v243 offset:2048
  v_mfma_f32_16x16x32_bf16 v[60:63], a[212:215], a[28:31], v[60:63]
  buffer_load_dwordx4 v136, s[24:27], s50 offen offset:3072 lds
  ds_read_b64_tr_b16 a[202:203], v243 offset:6144
  v_mfma_f32_16x16x32_bf16 v[56:59], a[212:215], a[24:27], v[56:59]
  ds_read_b64_tr_b16 a[204:205], v243 offset:10240
  v_mfma_f32_16x16x32_bf16 v[56:59], a[208:211], a[16:19], v[56:59]
  s_waitcnt lgkmcnt(11)
  ds_read_b64_tr_b16 a[206:207], v243 offset:14336
  v_mfma_f32_16x16x32_bf16 v[144:147], a[176:179], a[16:19], v[144:147]
  ds_read_b64_tr_b16 a[208:209], v240 offset:16384
  v_mfma_f32_16x16x32_bf16 v[144:147], a[180:183], a[24:27], v[144:147]
  buffer_load_dwordx4 a[76:79], v137, s[36:39], s51 offen offset:3072 sc1
  s_cmp_eq_u32 s87, 2
  v_mfma_f32_16x16x32_bf16 v[148:151], a[180:183], a[28:31], v[148:151]
  s_cselect_b32 s79, 17, 45
  s_lshl_b32 s50, s79, 16
  s_add_u32 m0, s70, 65536
  v_mfma_f32_16x16x32_bf16 v[148:151], a[176:179], a[20:23], v[148:151]
  s_waitcnt lgkmcnt(9)
  ds_read_b64_tr_b16 a[210:211], v240 offset:20480
  ds_read_b64_tr_b16 a[212:213], v240 offset:24576
  v_mfma_f32_16x16x32_bf16 v[156:159], a[184:187], a[20:23], v[156:159]
  ds_read_b64_tr_b16 a[214:215], v240 offset:28672
  ds_read_b64_tr_b16 a[176:177], v241 offset:16384
  v_mfma_f32_16x16x32_bf16 v[156:159], a[188:191], a[28:31], v[156:159]
  buffer_load_dwordx4 v133, s[24:27], s50 offen offset:0 lds
  s_lshl_b32 s51, s79, 11
  v_mfma_f32_16x16x32_bf16 v[152:155], a[188:191], a[24:27], v[152:155]
  ds_read_b64_tr_b16 a[178:179], v241 offset:20480
  ds_read_b64_tr_b16 a[180:181], v241 offset:24576
  v_mfma_f32_16x16x32_bf16 v[152:155], a[184:187], a[16:19], v[152:155]
  s_waitcnt lgkmcnt(11)
  ds_read_b64_tr_b16 a[182:183], v241 offset:28672
  v_mfma_f32_16x16x32_bf16 v[160:163], a[192:195], a[16:19], v[160:163]
  ds_read_b64_tr_b16 a[184:185], v242 offset:16384
  v_mfma_f32_16x16x32_bf16 v[160:163], a[196:199], a[24:27], v[160:163]
  buffer_load_dwordx4 a[80:83], v137, s[36:39], s51 offen offset:0 sc1
  ds_read_b64_tr_b16 a[186:187], v242 offset:20480
  v_mfma_f32_16x16x32_bf16 v[164:167], a[196:199], a[28:31], v[164:167]
  ds_read_b64_tr_b16 a[188:189], v242 offset:24576
  v_mfma_f32_16x16x32_bf16 v[164:167], a[192:195], a[20:23], v[164:167]
  s_waitcnt lgkmcnt(11)
  ds_read_b64_tr_b16 a[190:191], v242 offset:28672
  v_mfma_f32_16x16x32_bf16 v[172:175], a[200:203], a[20:23], v[172:175]
  buffer_load_dwordx4 v134, s[24:27], s50 offen offset:1024 lds
  ds_read_b64_tr_b16 a[192:193], v243 offset:16384
  v_mfma_f32_16x16x32_bf16 v[172:175], a[204:207], a[28:31], v[172:175]
  ds_read_b64_tr_b16 a[194:195], v243 offset:20480
  v_mfma_f32_16x16x32_bf16 v[168:171], a[204:207], a[24:27], v[168:171]
  ds_read_b64_tr_b16 a[196:197], v243 offset:24576
  v_mfma_f32_16x16x32_bf16 v[168:171], a[200:203], a[16:19], v[168:171]
  s_waitcnt vmcnt(23) lgkmcnt(11)
  ds_read_b64_tr_b16 a[198:199], v243 offset:28672
  v_mfma_f32_16x16x32_bf16 v[32:35], a[208:211], a[32:35], v[32:35]
  buffer_load_dwordx4 a[84:87], v137, s[36:39], s51 offen offset:1024 sc1
  ds_read_b64_tr_b16 a[200:201], v240 offset:18432
  v_mfma_f32_16x16x32_bf16 v[32:35], a[212:215], a[40:43], v[32:35]
  ds_read_b64_tr_b16 a[202:203], v240 offset:22528
  v_mfma_f32_16x16x32_bf16 v[36:39], a[212:215], a[44:47], v[36:39]
  ds_read_b64_tr_b16 a[204:205], v240 offset:26624
  v_mfma_f32_16x16x32_bf16 v[36:39], a[208:211], a[36:39], v[36:39]
  s_waitcnt lgkmcnt(11)
  ds_read_b64_tr_b16 a[206:207], v240 offset:30720
  v_mfma_f32_16x16x32_bf16 v[44:47], a[176:179], a[36:39], v[44:47]
  buffer_load_dwordx4 v135, s[24:27], s50 offen offset:2048 lds
  ds_read_b64_tr_b16 a[208:209], v241 offset:18432
  v_mfma_f32_16x16x32_bf16 v[44:47], a[180:183], a[44:47], v[44:47]
  ds_read_b64_tr_b16 a[210:211], v241 offset:22528
  v_mfma_f32_16x16x32_bf16 v[40:43], a[180:183], a[40:43], v[40:43]
  s_waitcnt vmcnt(13)
  ds_read_b64_tr_b16 a[212:213], v241 offset:26624
  v_mfma_f32_16x16x32_bf16 v[40:43], a[176:179], a[32:35], v[40:43]
  s_waitcnt vmcnt(16) lgkmcnt(11)
  s_barrier
  ds_read_b64_tr_b16 a[214:215], v241 offset:30720
  v_mfma_f32_16x16x32_bf16 v[48:51], a[184:187], a[32:35], v[48:51]
  s_mov_b64 exec, 1
  buffer_store_dword v254, v0, s[36:39], s45 offen sc1
  s_mov_b64 exec, -1
  v_mfma_f32_16x16x32_bf16 v[48:51], a[188:191], a[40:43], v[48:51]
  buffer_load_dwordx4 a[88:91], v137, s[36:39], s51 offen offset:2048 sc1
  ds_read_b64_tr_b16 a[176:177], v242 offset:18432
  v_mfma_f32_16x16x32_bf16 v[52:55], a[188:191], a[44:47], v[52:55]
  ds_read_b64_tr_b16 a[178:179], v242 offset:22528
  ds_read_b64_tr_b16 a[180:181], v242 offset:26624
  v_mfma_f32_16x16x32_bf16 v[52:55], a[184:187], a[36:39], v[52:55]
  s_waitcnt lgkmcnt(11)
  ds_read_b64_tr_b16 a[182:183], v242 offset:30720
  v_mfma_f32_16x16x32_bf16 v[60:63], a[192:195], a[36:39], v[60:63]
  buffer_load_dwordx4 v136, s[24:27], s50 offen offset:3072 lds
  ds_read_b64_tr_b16 a[184:185], v243 offset:18432
  v_mfma_f32_16x16x32_bf16 v[60:63], a[196:199], a[44:47], v[60:63]
  ds_read_b64_tr_b16 a[186:187], v243 offset:22528
  v_mfma_f32_16x16x32_bf16 v[56:59], a[196:199], a[40:43], v[56:59]
  ds_read_b64_tr_b16 a[188:189], v243 offset:26624
  v_mfma_f32_16x16x32_bf16 v[56:59], a[192:195], a[32:35], v[56:59]
  s_waitcnt lgkmcnt(11)
  buffer_load_dwordx4 a[92:95], v137, s[36:39], s51 offen offset:3072 sc1
  s_cmp_eq_u32 s87, 3
  v_mfma_f32_16x16x32_bf16 v[144:147], a[200:203], a[32:35], v[144:147]
  s_cselect_b32 s80, 24, 52
  s_lshl_b32 s50, s80, 16
  s_add_u32 m0, s70, 81920
  v_mfma_f32_16x16x32_bf16 v[144:147], a[204:207], a[40:43], v[144:147]
  ds_read_b64_tr_b16 a[190:191], v243 offset:30720
  ds_read_b64_tr_b16 a[192:193], v240 offset:32768
  v_mfma_f32_16x16x32_bf16 v[148:151], a[204:207], a[44:47], v[148:151]
  ds_read_b64_tr_b16 a[194:195], v240 offset:36864
  ds_read_b64_tr_b16 a[196:197], v240 offset:40960
  v_mfma_f32_16x16x32_bf16 v[148:151], a[200:203], a[36:39], v[148:151]
  s_waitcnt lgkmcnt(11)
  buffer_load_dwordx4 v133, s[24:27], s50 offen offset:0 lds
  s_lshl_b32 s51, s80, 11
  v_mfma_f32_16x16x32_bf16 v[156:159], a[208:211], a[36:39], v[156:159]
  ds_read_b64_tr_b16 a[198:199], v240 offset:45056
  ds_read_b64_tr_b16 a[200:201], v241 offset:32768
  v_mfma_f32_16x16x32_bf16 v[156:159], a[212:215], a[44:47], v[156:159]
  ds_read_b64_tr_b16 a[202:203], v241 offset:36864
  v_mfma_f32_16x16x32_bf16 v[152:155], a[212:215], a[40:43], v[152:155]
  ds_read_b64_tr_b16 a[204:205], v241 offset:40960
  v_mfma_f32_16x16x32_bf16 v[152:155], a[208:211], a[32:35], v[152:155]
  s_waitcnt lgkmcnt(11)
  buffer_load_dwordx4 a[96:99], v137, s[36:39], s51 offen offset:0 sc1
  ds_read_b64_tr_b16 a[206:207], v241 offset:45056
  v_mfma_f32_16x16x32_bf16 v[160:163], a[176:179], a[32:35], v[160:163]
  ds_read_b64_tr_b16 a[208:209], v242 offset:32768
  v_mfma_f32_16x16x32_bf16 v[160:163], a[180:183], a[40:43], v[160:163]
  ds_read_b64_tr_b16 a[210:211], v242 offset:36864
  v_mfma_f32_16x16x32_bf16 v[164:167], a[180:183], a[44:47], v[164:167]
  ds_read_b64_tr_b16 a[212:213], v242 offset:40960
  v_mfma_f32_16x16x32_bf16 v[164:167], a[176:179], a[36:39], v[164:167]
  s_waitcnt lgkmcnt(11)
  buffer_load_dwordx4 v134, s[24:27], s50 offen offset:1024 lds
  ds_read_b64_tr_b16 a[214:215], v242 offset:45056
  v_mfma_f32_16x16x32_bf16 v[172:175], a[184:187], a[36:39], v[172:175]
  ds_read_b64_tr_b16 a[176:177], v243 offset:32768
  v_mfma_f32_16x16x32_bf16 v[172:175], a[188:191], a[44:47], v[172:175]
  ds_read_b64_tr_b16 a[178:179], v243 offset:36864
  v_mfma_f32_16x16x32_bf16 v[168:171], a[188:191], a[40:43], v[168:171]
  ds_read_b64_tr_b16 a[180:181], v243 offset:40960
  v_mfma_f32_16x16x32_bf16 v[168:171], a[184:187], a[32:35], v[168:171]
  s_waitcnt vmcnt(21) lgkmcnt(11)
  buffer_load_dwordx4 a[100:103], v137, s[36:39], s51 offen offset:1024 sc1
  ds_read_b64_tr_b16 a[182:183], v243 offset:45056
  v_mfma_f32_16x16x32_bf16 v[32:35], a[192:195], a[48:51], v[32:35]
  ds_read_b64_tr_b16 a[184:185], v240 offset:34816
  v_mfma_f32_16x16x32_bf16 v[32:35], a[196:199], a[56:59], v[32:35]
  ds_read_b64_tr_b16 a[186:187], v240 offset:38912
  v_mfma_f32_16x16x32_bf16 v[36:39], a[196:199], a[60:63], v[36:39]
  buffer_load_dwordx4 v135, s[24:27], s50 offen offset:2048 lds
  ds_read_b64_tr_b16 a[188:189], v240 offset:43008
  v_mfma_f32_16x16x32_bf16 v[36:39], a[192:195], a[52:55], v[36:39]
  s_waitcnt lgkmcnt(11)
  ds_read_b64_tr_b16 a[190:191], v240 offset:47104
  v_mfma_f32_16x16x32_bf16 v[44:47], a[200:203], a[52:55], v[44:47]
  ds_read_b64_tr_b16 a[192:193], v241 offset:34816
  v_mfma_f32_16x16x32_bf16 v[44:47], a[204:207], a[60:63], v[44:47]
  ds_read_b64_tr_b16 a[194:195], v241 offset:38912
  v_mfma_f32_16x16x32_bf16 v[40:43], a[204:207], a[56:59], v[40:43]
  buffer_load_dwordx4 a[104:107], v137, s[36:39], s51 offen offset:2048 sc1
  ds_read_b64_tr_b16 a[196:197], v241 offset:43008
  v_mfma_f32_16x16x32_bf16 v[40:43], a[200:203], a[48:51], v[40:43]
  s_waitcnt vmcnt(16) lgkmcnt(11)
  s_barrier
  ds_read_b64_tr_b16 a[198:199], v241 offset:47104
  v_mfma_f32_16x16x32_bf16 v[48:51], a[208:211], a[48:51], v[48:51]
Hb2_2:
  s_cbranch_execz Hb2_3
  ds_read_b64_tr_b16 a[200:201], v242 offset:34816
  v_mfma_f32_16x16x32_bf16 v[48:51], a[212:215], a[56:59], v[48:51]
  ds_read_b64_tr_b16 a[202:203], v242 offset:38912
  v_mfma_f32_16x16x32_bf16 v[52:55], a[212:215], a[60:63], v[52:55]
  buffer_load_dwordx4 v136, s[24:27], s50 offen offset:3072 lds
  ds_read_b64_tr_b16 a[204:205], v242 offset:43008
  v_mfma_f32_16x16x32_bf16 v[52:55], a[208:211], a[52:55], v[52:55]
  s_waitcnt lgkmcnt(11)
  ds_read_b64_tr_b16 a[206:207], v242 offset:47104
  v_mfma_f32_16x16x32_bf16 v[60:63], a[176:179], a[52:55], v[60:63]
  ds_read_b64_tr_b16 a[208:209], v243 offset:34816
  v_mfma_f32_16x16x32_bf16 v[60:63], a[180:183], a[60:63], v[60:63]
  ds_read_b64_tr_b16 a[210:211], v243 offset:38912
  v_mfma_f32_16x16x32_bf16 v[56:59], a[180:183], a[56:59], v[56:59]
  buffer_load_dwordx4 a[108:111], v137, s[36:39], s51 offen offset:3072 sc1
  s_add_u32 s81, s87, 8
  v_mfma_f32_16x16x32_bf16 v[56:59], a[176:179], a[48:51], v[56:59]
  s_waitcnt lgkmcnt(10)
  s_and_b32 s81, s81, 3
  s_mul_i32 s81, s81, 14
  v_mfma_f32_16x16x32_bf16 v[144:147], a[184:187], a[48:51], v[144:147]
  s_lshl_b32 s50, s81, 16
  s_add_u32 s50, s50, s88
  s_add_u32 m0, s70, 98304
  v_mfma_f32_16x16x32_bf16 v[144:147], a[188:191], a[56:59], v[144:147]
  ds_read_b64_tr_b16 a[212:213], v243 offset:43008
  ds_read_b64_tr_b16 a[214:215], v243 offset:47104
  v_mfma_f32_16x16x32_bf16 v[148:151], a[188:191], a[60:63], v[148:151]
  ds_read_b64_tr_b16 a[176:177], v240 offset:49152
  ds_read_b64_tr_b16 a[178:179], v240 offset:53248
  v_mfma_f32_16x16x32_bf16 v[148:151], a[184:187], a[52:55], v[148:151]
  s_waitcnt lgkmcnt(10)
  buffer_load_dwordx4 v133, s[24:27], s50 offen offset:0 lds
  s_lshl_b32 s51, s81, 11
  v_mfma_f32_16x16x32_bf16 v[156:159], a[192:195], a[52:55], v[156:159]
  ds_read_b64_tr_b16 a[180:181], v240 offset:57344
  ds_read_b64_tr_b16 a[182:183], v240 offset:61440
  v_mfma_f32_16x16x32_bf16 v[156:159], a[196:199], a[60:63], v[156:159]
  ds_read_b64_tr_b16 a[184:185], v241 offset:49152
  ds_read_b64_tr_b16 a[186:187], v241 offset:53248
  v_mfma_f32_16x16x32_bf16 v[152:155], a[196:199], a[56:59], v[152:155]
  s_add_u32 s76, s70, 16384
  buffer_load_dwordx4 a[112:115], v137, s[36:39], s51 offen offset:0 sc1
  ds_read_b64_tr_b16 a[188:189], v241 offset:57344
  v_mfma_f32_16x16x32_bf16 v[152:155], a[192:195], a[48:51], v[152:155]
  s_waitcnt lgkmcnt(11)
  ds_read_b64_tr_b16 a[190:191], v241 offset:61440
  v_and_b32 v129, 15, v128
  v_mfma_f32_16x16x32_bf16 v[160:163], a[200:203], a[48:51], v[160:163]
  ds_read_b64_tr_b16 a[192:193], v242 offset:49152
  v_lshrrev_b32 v131, 1, v129
  v_mfma_f32_16x16x32_bf16 v[160:163], a[204:207], a[56:59], v[160:163]
  buffer_load_dwordx4 v134, s[24:27], s50 offen offset:1024 lds
  ds_read_b64_tr_b16 a[194:195], v242 offset:53248
  v_mfma_f32_16x16x32_bf16 v[164:167], a[204:207], a[60:63], v[164:167]
  ds_read_b64_tr_b16 a[196:197], v242 offset:57344
  v_lshrrev_b32 v130, 5, v128
  v_mfma_f32_16x16x32_bf16 v[164:167], a[200:203], a[52:55], v[164:167]
  s_waitcnt lgkmcnt(11)
  ds_read_b64_tr_b16 a[198:199], v242 offset:61440
  v_xor_b32 v131, v131, v130
  v_mfma_f32_16x16x32_bf16 v[172:175], a[208:211], a[52:55], v[172:175]
  ds_read_b64_tr_b16 a[200:201], v243 offset:49152
  v_lshlrev_b32 v131, 4, v131
  v_mfma_f32_16x16x32_bf16 v[172:175], a[212:215], a[60:63], v[172:175]
  buffer_load_dwordx4 a[116:119], v137, s[36:39], s51 offen offset:1024 sc1
  ds_read_b64_tr_b16 a[202:203], v243 offset:53248
  v_mfma_f32_16x16x32_bf16 v[168:171], a[212:215], a[56:59], v[168:171]
  ds_read_b64_tr_b16 a[204:205], v243 offset:57344
  v_lshl_add_u32 v131, v129, 7, v131
  v_mfma_f32_16x16x32_bf16 v[168:171], a[208:211], a[48:51], v[168:171]
  s_waitcnt vmcnt(21) lgkmcnt(11)
  ds_read_b64_tr_b16 a[206:207], v243 offset:61440
  v_bfe_u32 v130, v128, 4, 1
  v_mfma_f32_16x16x32_bf16 v[32:35], a[176:179], a[64:67], v[32:35]
  ds_read_b64_tr_b16 a[208:209], v240 offset:51200
  v_lshl_add_u32 v131, v130, 3, v131
  v_mfma_f32_16x16x32_bf16 v[32:35], a[180:183], a[72:75], v[32:35]
  buffer_load_dwordx4 v135, s[24:27], s50 offen offset:2048 lds
  s_add_u32 s51, s51, 12288
  v_mfma_f32_16x16x32_bf16 v[36:39], a[180:183], a[76:79], v[36:39]
  ds_read_b64_tr_b16 a[210:211], v240 offset:55296
  ds_read_b64_tr_b16 a[212:213], v240 offset:59392
  v_mfma_f32_16x16x32_bf16 v[36:39], a[176:179], a[68:71], v[36:39]
  s_waitcnt lgkmcnt(11)
  ds_read_b64_tr_b16 a[214:215], v240 offset:63488
  v_add_u32 v140, s76, v131
  v_mfma_f32_16x16x32_bf16 v[44:47], a[184:187], a[68:71], v[44:47]
  ds_read_b64_tr_b16 a[176:177], v241 offset:51200
  v_xor_b32 v141, 32, v140
  v_mfma_f32_16x16x32_bf16 v[44:47], a[188:191], a[76:79], v[44:47]
  buffer_load_dwordx4 a[120:123], v137, s[36:39], s51 offen offset:2048 sc1
  ds_read_b64_tr_b16 a[178:179], v241 offset:55296
  v_mfma_f32_16x16x32_bf16 v[40:43], a[188:191], a[72:75], v[40:43]
  ds_read_b64_tr_b16 a[180:181], v241 offset:59392
  v_xor_b32 v142, 64, v140
  v_mfma_f32_16x16x32_bf16 v[40:43], a[184:187], a[64:67], v[40:43]
  s_waitcnt vmcnt(15) lgkmcnt(11)
  s_barrier
  ds_read_b64_tr_b16 a[182:183], v241 offset:63488
  v_mfma_f32_16x16x32_bf16 v[48:51], a[192:195], a[64:67], v[48:51]
  ds_read_b64_tr_b16 a[184:185], v242 offset:51200
  v_xor_b32 v143, 96, v140
  v_mfma_f32_16x16x32_bf16 v[48:51], a[196:199], a[72:75], v[48:51]
  buffer_load_dwordx4 v136, s[24:27], s50 offen offset:3072 lds
  ds_read_b64_tr_b16 a[186:187], v242 offset:55296
  v_mfma_f32_16x16x32_bf16 v[52:55], a[196:199], a[76:79], v[52:55]
  ds_read_b64_tr_b16 a[188:189], v242 offset:59392
  v_add_u32 v255, s76, v0
  v_mfma_f32_16x16x32_bf16 v[52:55], a[192:195], a[68:71], v[52:55]
  s_waitcnt lgkmcnt(11)
  ds_read_b64_tr_b16 a[190:191], v242 offset:63488
  s_lshl_b32 s76, s44, 10
  v_mfma_f32_16x16x32_bf16 v[60:63], a[200:203], a[68:71], v[60:63]
  s_add_u32 s76, s76, 151552
  buffer_load_dwordx4 a[124:127], v137, s[36:39], s51 offen offset:3072 sc1
  s_add_u32 s86, s87, 9
  v_mfma_f32_16x16x32_bf16 v[60:63], a[204:207], a[76:79], v[60:63]
  s_and_b32 s86, s86, 3
  s_mul_i32 s86, s86, 14
  s_lshl_b32 s50, s86, 16
  v_mfma_f32_16x16x32_bf16 v[56:59], a[204:207], a[72:75], v[56:59]
  s_add_u32 s50, s50, s88
  s_add_u32 m0, s70, 114688
  ds_read_b64_tr_b16 a[192:193], v243 offset:51200
  v_mfma_f32_16x16x32_bf16 v[56:59], a[200:203], a[64:67], v[56:59]
  s_waitcnt lgkmcnt(9)
  ds_read_b64_tr_b16 a[194:195], v243 offset:55296
  ds_read_b64_tr_b16 a[196:197], v243 offset:59392
  v_mfma_f32_16x16x32_bf16 v[144:147], a[208:211], a[64:67], v[144:147]
  ds_read_b64_tr_b16 a[198:199], v243 offset:63488
  buffer_load_dwordx4 v133, s[24:27], s50 offen offset:0 lds
  v_mfma_f32_16x16x32_bf16 v[144:147], a[212:215], a[72:75], v[144:147]
  s_lshl_b32 s51, s86, 11
  ds_read_b64_tr_b16 a[200:201], v244 offset:0
  ds_read_b64_tr_b16 a[202:203], v244 offset:4096
  v_mfma_f32_16x16x32_bf16 v[148:151], a[212:215], a[76:79], v[148:151]
  ds_read_b64_tr_b16 a[204:205], v244 offset:8192
  v_add_u32 v129, s76, v0
  v_mfma_f32_16x16x32_bf16 v[148:151], a[208:211], a[68:71], v[148:151]
  s_waitcnt lgkmcnt(11)
  ds_read_b64_tr_b16 a[206:207], v244 offset:12288
  v_lshrrev_b32 v130, 4, v128
  v_mfma_f32_16x16x32_bf16 v[156:159], a[176:179], a[68:71], v[156:159]
  buffer_load_dwordx4 a[216:219], v137, s[36:39], s51 offen offset:0 sc1
  ds_read_b64_tr_b16 a[208:209], v245 offset:0
  v_mfma_f32_16x16x32_bf16 v[156:159], a[180:183], a[76:79], v[156:159]
  ds_read_b64_tr_b16 a[210:211], v245 offset:4096
  v_lshl_add_u32 v130, v130, 4, s76
  v_mfma_f32_16x16x32_bf16 v[152:155], a[180:183], a[72:75], v[152:155]
  ds_read_b64_tr_b16 a[212:213], v245 offset:8192
  ds_write_b128 v129, a[248:251]
  v_mfma_f32_16x16x32_bf16 v[152:155], a[176:179], a[64:67], v[152:155]
  s_waitcnt lgkmcnt(12)
  ds_read_b64_tr_b16 a[214:215], v245 offset:12288
  ds_read_b128 v[176:179], v130 offset:768
  v_mfma_f32_16x16x32_bf16 v[160:163], a[184:187], a[64:67], v[160:163]
  buffer_load_dwordx4 v134, s[24:27], s50 offen offset:1024 lds
  ds_read_b64_tr_b16 a[176:177], v246 offset:0
  v_mfma_f32_16x16x32_bf16 v[160:163], a[188:191], a[72:75], v[160:163]
  ds_read_b64_tr_b16 a[178:179], v246 offset:4096
  ds_read_b128 v[180:183], v130 offset:832
  v_mfma_f32_16x16x32_bf16 v[164:167], a[188:191], a[76:79], v[164:167]
  ds_read_b64_tr_b16 a[180:181], v246 offset:8192
  ds_read_b128 v[184:187], v130 offset:896
  v_mfma_f32_16x16x32_bf16 v[164:167], a[184:187], a[68:71], v[164:167]
  s_waitcnt lgkmcnt(15)
  ds_read_b64_tr_b16 a[182:183], v246 offset:12288
  ds_read_b128 v[188:191], v130 offset:960
  v_mfma_f32_16x16x32_bf16 v[172:175], a[192:195], a[68:71], v[172:175]
  buffer_load_dwordx4 a[220:223], v137, s[36:39], s51 offen offset:1024 sc1
  ds_read_b64_tr_b16 a[184:185], v247 offset:0
  v_mfma_f32_16x16x32_bf16 v[172:175], a[196:199], a[76:79], v[172:175]
  ds_read_b64_tr_b16 a[186:187], v247 offset:4096
  v_accvgpr_read_b32 v131, a232
  v_mfma_f32_16x16x32_bf16 v[168:171], a[196:199], a[72:75], v[168:171]
  ds_read_b64_tr_b16 a[188:189], v247 offset:8192
  v_lshlrev_b32 v64, 16, v131
  v_mfma_f32_16x16x32_bf16 v[168:171], a[192:195], a[64:67], v[168:171]
  s_waitcnt vmcnt(20) lgkmcnt(15)
  buffer_load_dwordx4 v135, s[24:27], s50 offen offset:2048 lds
  s_add_u32 s51, s51, 12288
  v_mfma_f32_16x16x32_bf16 v[32:35], a[200:203], a[80:83], v[32:35]
  ds_read_b64_tr_b16 a[190:191], v247 offset:12288
  ds_read_b64_tr_b16 a[192:193], v244 offset:2048
  v_mfma_f32_16x16x32_bf16 v[32:35], a[204:207], a[88:91], v[32:35]
  ds_read_b64_tr_b16 a[194:195], v244 offset:6144
  v_and_b32 v65, 0xffff0000, v131
  v_mfma_f32_16x16x32_bf16 v[36:39], a[204:207], a[92:95], v[36:39]
  ds_read_b64_tr_b16 a[196:197], v244 offset:10240
  v_accvgpr_read_b32 v131, a233
  v_mfma_f32_16x16x32_bf16 v[36:39], a[200:203], a[84:87], v[36:39]
  s_waitcnt lgkmcnt(15)
  buffer_load_dwordx4 a[224:227], v137, s[36:39], s51 offen offset:2048 sc1
  ds_read_b64_tr_b16 a[198:199], v244 offset:14336
  v_mfma_f32_16x16x32_bf16 v[44:47], a[208:211], a[84:87], v[44:47]
  ds_read_b64_tr_b16 a[200:201], v245 offset:2048
  v_lshlrev_b32 v66, 16, v131
  v_mfma_f32_16x16x32_bf16 v[44:47], a[212:215], a[92:95], v[44:47]
  ds_read_b64_tr_b16 a[202:203], v245 offset:6144
  v_and_b32 v67, 0xffff0000, v131
  v_mfma_f32_16x16x32_bf16 v[40:43], a[212:215], a[88:91], v[40:43]
  ds_read_b64_tr_b16 a[204:205], v245 offset:10240
  v_accvgpr_read_b32 v131, a234
  v_mfma_f32_16x16x32_bf16 v[40:43], a[208:211], a[80:83], v[40:43]
  s_waitcnt vmcnt(15) lgkmcnt(12)
  s_barrier
  buffer_load_dwordx4 v136, s[24:27], s50 offen offset:3072 lds
  v_mfma_f32_16x16x32_bf16 v[48:51], a[176:179], a[80:83], v[48:51]
  ds_read_b64_tr_b16 a[206:207], v245 offset:14336
  ds_read_b64_tr_b16 a[208:209], v246 offset:2048
  v_mfma_f32_16x16x32_bf16 v[48:51], a[180:183], a[88:91], v[48:51]
  ds_read_b64_tr_b16 a[210:211], v246 offset:6144
  v_lshlrev_b32 v68, 16, v131
  v_mfma_f32_16x16x32_bf16 v[52:55], a[180:183], a[92:95], v[52:55]
  ds_read_b64_tr_b16 a[212:213], v246 offset:10240
  v_and_b32 v69, 0xffff0000, v131
  v_mfma_f32_16x16x32_bf16 v[52:55], a[176:179], a[84:87], v[52:55]
  s_waitcnt lgkmcnt(11)
  buffer_load_dwordx4 a[228:231], v137, s[36:39], s51 offen offset:3072 sc1
  s_add_u32 s69, s87, 10
  v_mfma_f32_16x16x32_bf16 v[60:63], a[184:187], a[84:87], v[60:63]
  s_and_b32 s69, s69, 3
  s_mul_i32 s69, s69, 14
  s_lshl_b32 s50, s69, 16
  v_mfma_f32_16x16x32_bf16 v[60:63], a[188:191], a[92:95], v[60:63]
  s_add_u32 s50, s50, s88
  s_add_u32 m0, s70, 131072
  ds_read_b64_tr_b16 a[214:215], v246 offset:14336
  v_mfma_f32_16x16x32_bf16 v[56:59], a[188:191], a[88:91], v[56:59]
  ds_read_b64_tr_b16 a[176:177], v247 offset:2048
  ds_read_b64_tr_b16 a[178:179], v247 offset:6144
  v_mfma_f32_16x16x32_bf16 v[56:59], a[184:187], a[80:83], v[56:59]
  s_waitcnt lgkmcnt(10)
  ds_read_b64_tr_b16 a[180:181], v247 offset:10240
  buffer_load_dwordx4 v133, s[24:27], s50 offen offset:0 lds
  v_mfma_f32_16x16x32_bf16 v[144:147], a[192:195], a[80:83], v[144:147]
  s_lshl_b32 s51, s69, 11
  ds_read_b64_tr_b16 a[182:183], v247 offset:14336
  ds_read_b64_tr_b16 a[184:185], v244 offset:16384
  v_mfma_f32_16x16x32_bf16 v[144:147], a[196:199], a[88:91], v[144:147]
  ds_read_b64_tr_b16 a[186:187], v244 offset:20480
  v_accvgpr_read_b32 v131, a235
  v_mfma_f32_16x16x32_bf16 v[148:151], a[196:199], a[92:95], v[148:151]
  buffer_load_dwordx4 a[0:3], v137, s[36:39], s51 offen offset:0 sc1
  ds_read_b64_tr_b16 a[188:189], v244 offset:24576
  v_mfma_f32_16x16x32_bf16 v[148:151], a[192:195], a[84:87], v[148:151]
  s_waitcnt lgkmcnt(11)
  ds_read_b64_tr_b16 a[190:191], v244 offset:28672
  v_lshlrev_b32 v70, 16, v131
  v_mfma_f32_16x16x32_bf16 v[156:159], a[200:203], a[84:87], v[156:159]
  ds_read_b64_tr_b16 a[192:193], v245 offset:16384
  v_and_b32 v71, 0xffff0000, v131
  v_mfma_f32_16x16x32_bf16 v[156:159], a[204:207], a[92:95], v[156:159]
  ds_read_b64_tr_b16 a[194:195], v245 offset:20480
  v_accvgpr_read_b32 v131, a236
  v_mfma_f32_16x16x32_bf16 v[152:155], a[204:207], a[88:91], v[152:155]
  buffer_load_dwordx4 v134, s[24:27], s50 offen offset:1024 lds
  ds_read_b64_tr_b16 a[196:197], v245 offset:24576
  v_mfma_f32_16x16x32_bf16 v[152:155], a[200:203], a[80:83], v[152:155]
  s_waitcnt lgkmcnt(11)
  ds_read_b64_tr_b16 a[198:199], v245 offset:28672
  v_lshlrev_b32 v72, 16, v131
  v_mfma_f32_16x16x32_bf16 v[160:163], a[208:211], a[80:83], v[160:163]
  ds_read_b64_tr_b16 a[200:201], v246 offset:16384
  v_and_b32 v73, 0xffff0000, v131
  v_mfma_f32_16x16x32_bf16 v[160:163], a[212:215], a[88:91], v[160:163]
  ds_read_b64_tr_b16 a[202:203], v246 offset:20480
  v_accvgpr_read_b32 v131, a237
  v_mfma_f32_16x16x32_bf16 v[164:167], a[212:215], a[92:95], v[164:167]
  buffer_load_dword v139, v138, s[36:39], s91 offen sc1
  ds_read_b64_tr_b16 a[204:205], v246 offset:24576
  v_mfma_f32_16x16x32_bf16 v[164:167], a[208:211], a[84:87], v[164:167]
  s_waitcnt lgkmcnt(11)
  ds_read_b64_tr_b16 a[206:207], v246 offset:28672
  v_lshlrev_b32 v74, 16, v131
  v_mfma_f32_16x16x32_bf16 v[172:175], a[176:179], a[84:87], v[172:175]
  ds_read_b64_tr_b16 a[208:209], v247 offset:16384
  v_and_b32 v75, 0xffff0000, v131
  v_mfma_f32_16x16x32_bf16 v[172:175], a[180:183], a[92:95], v[172:175]
  buffer_load_dwordx4 a[4:7], v137, s[36:39], s51 offen offset:1024 sc1
  ds_read_b64_tr_b16 a[210:211], v247 offset:20480
  v_mfma_f32_16x16x32_bf16 v[168:171], a[180:183], a[88:91], v[168:171]
  ds_read_b64_tr_b16 a[212:213], v247 offset:24576
  v_accvgpr_read_b32 v131, a238
  v_mfma_f32_16x16x32_bf16 v[168:171], a[176:179], a[80:83], v[168:171]
  s_waitcnt vmcnt(21) lgkmcnt(11)
  ds_read_b64_tr_b16 a[214:215], v247 offset:28672
  v_lshlrev_b32 v76, 16, v131
  v_mfma_f32_16x16x32_bf16 v[32:35], a[184:187], a[96:99], v[32:35]
  buffer_load_dwordx4 v135, s[24:27], s50 offen offset:2048 lds
  s_add_u32 s51, s51, 12288
  v_mfma_f32_16x16x32_bf16 v[32:35], a[188:191], a[104:107], v[32:35]
  ds_read_b64_tr_b16 a[176:177], v244 offset:18432
  ds_read_b64_tr_b16 a[178:179], v244 offset:22528
  v_mfma_f32_16x16x32_bf16 v[36:39], a[188:191], a[108:111], v[36:39]
  ds_read_b64_tr_b16 a[180:181], v244 offset:26624
  v_and_b32 v77, 0xffff0000, v131
  v_mfma_f32_16x16x32_bf16 v[36:39], a[184:187], a[100:103], v[36:39]
  s_waitcnt lgkmcnt(11)
  buffer_load_dwordx4 a[8:11], v137, s[36:39], s51 offen offset:2048 sc1
  ds_read_b64_tr_b16 a[182:183], v244 offset:30720
  v_mfma_f32_16x16x32_bf16 v[44:47], a[192:195], a[100:103], v[44:47]
  ds_read_b64_tr_b16 a[184:185], v245 offset:18432
  v_accvgpr_read_b32 v131, a239
  v_mfma_f32_16x16x32_bf16 v[44:47], a[196:199], a[108:111], v[44:47]
  ds_read_b64_tr_b16 a[186:187], v245 offset:22528
  v_lshlrev_b32 v78, 16, v131
  v_mfma_f32_16x16x32_bf16 v[40:43], a[196:199], a[104:107], v[40:43]
  buffer_load_dwordx4 v136, s[24:27], s50 offen offset:3072 lds
  ds_read_b64_tr_b16 a[188:189], v245 offset:26624
  v_mfma_f32_16x16x32_bf16 v[40:43], a[192:195], a[96:99], v[40:43]
  s_waitcnt vmcnt(17) lgkmcnt(11)
  s_barrier
  ds_read_b64_tr_b16 a[190:191], v245 offset:30720
  v_mfma_f32_16x16x32_bf16 v[48:51], a[200:203], a[96:99], v[48:51]
  ds_read_b64_tr_b16 a[192:193], v246 offset:18432
  v_and_b32 v79, 0xffff0000, v131
  v_mfma_f32_16x16x32_bf16 v[48:51], a[204:207], a[104:107], v[48:51]
  buffer_load_dwordx4 a[12:15], v137, s[36:39], s51 offen offset:3072 sc1
  s_add_u32 s71, s87, 11
  v_mfma_f32_16x16x32_bf16 v[52:55], a[204:207], a[108:111], v[52:55]
  s_and_b32 s71, s71, 3
  s_mul_i32 s71, s71, 14
  s_lshl_b32 s50, s71, 16
  v_mfma_f32_16x16x32_bf16 v[52:55], a[200:203], a[100:103], v[52:55]
  s_waitcnt lgkmcnt(9)
  s_add_u32 s50, s50, s88
  s_add_u32 m0, s70, 0
  v_mfma_f32_16x16x32_bf16 v[60:63], a[208:211], a[100:103], v[60:63]
  ds_read_b64_tr_b16 a[194:195], v246 offset:22528
  ds_read_b64_tr_b16 a[196:197], v246 offset:26624
  v_mfma_f32_16x16x32_bf16 v[60:63], a[212:215], a[108:111], v[60:63]
  ds_read_b64_tr_b16 a[198:199], v246 offset:30720
  ds_read_b64_tr_b16 a[200:201], v247 offset:18432
  v_mfma_f32_16x16x32_bf16 v[56:59], a[212:215], a[104:107], v[56:59]
  buffer_load_dwordx4 v133, s[24:27], s50 offen offset:0 lds
  s_lshl_b32 s51, s71, 11
  v_mfma_f32_16x16x32_bf16 v[56:59], a[208:211], a[96:99], v[56:59]
  s_waitcnt lgkmcnt(9)
  ds_read_b64_tr_b16 a[202:203], v247 offset:22528
  ds_read_b64_tr_b16 a[204:205], v247 offset:26624
  v_mfma_f32_16x16x32_bf16 v[144:147], a[176:179], a[96:99], v[144:147]
  ds_read_b64_tr_b16 a[206:207], v247 offset:30720
  ds_read_b64_tr_b16 a[208:209], v244 offset:32768
  v_mfma_f32_16x16x32_bf16 v[144:147], a[180:183], a[104:107], v[144:147]
  buffer_load_dwordx4 a[16:19], v137, s[36:39], s51 offen offset:0 sc1
  ds_read_b64_tr_b16 a[210:211], v244 offset:36864
  v_mfma_f32_16x16x32_bf16 v[148:151], a[180:183], a[108:111], v[148:151]
  ds_read_b64_tr_b16 a[212:213], v244 offset:40960
  v_accvgpr_read_b32 v131, a240
  v_mfma_f32_16x16x32_bf16 v[148:151], a[176:179], a[100:103], v[148:151]
  s_waitcnt lgkmcnt(11)
  ds_read_b64_tr_b16 a[214:215], v244 offset:45056
  v_lshlrev_b32 v80, 16, v131
  v_mfma_f32_16x16x32_bf16 v[156:159], a[184:187], a[100:103], v[156:159]
  ds_read_b64_tr_b16 a[176:177], v245 offset:32768
  v_and_b32 v81, 0xffff0000, v131
  v_mfma_f32_16x16x32_bf16 v[156:159], a[188:191], a[108:111], v[156:159]
  buffer_load_dwordx4 v134, s[24:27], s50 offen offset:1024 lds
  ds_read_b64_tr_b16 a[178:179], v245 offset:36864
  v_mfma_f32_16x16x32_bf16 v[152:155], a[188:191], a[104:107], v[152:155]
  ds_read_b64_tr_b16 a[180:181], v245 offset:40960
  v_accvgpr_read_b32 v131, a241
  v_mfma_f32_16x16x32_bf16 v[152:155], a[184:187], a[96:99], v[152:155]
  s_waitcnt lgkmcnt(11)
  ds_read_b64_tr_b16 a[182:183], v245 offset:45056
  v_lshlrev_b32 v82, 16, v131
  v_mfma_f32_16x16x32_bf16 v[160:163], a[192:195], a[96:99], v[160:163]
  buffer_load_dwordx4 a[20:23], v137, s[36:39], s51 offen offset:1024 sc1
  ds_read_b64_tr_b16 a[184:185], v246 offset:32768
  v_mfma_f32_16x16x32_bf16 v[160:163], a[196:199], a[104:107], v[160:163]
  ds_read_b64_tr_b16 a[186:187], v246 offset:36864
  v_and_b32 v83, 0xffff0000, v131
  v_mfma_f32_16x16x32_bf16 v[164:167], a[196:199], a[108:111], v[164:167]
  ds_read_b64_tr_b16 a[188:189], v246 offset:40960
  v_accvgpr_read_b32 v131, a242
  v_mfma_f32_16x16x32_bf16 v[164:167], a[192:195], a[100:103], v[164:167]
  s_waitcnt lgkmcnt(11)
  ds_read_b64_tr_b16 a[190:191], v246 offset:45056
  v_lshlrev_b32 v84, 16, v131
  v_mfma_f32_16x16x32_bf16 v[172:175], a[200:203], a[100:103], v[172:175]
  buffer_load_dwordx4 v135, s[24:27], s50 offen offset:2048 lds
  s_add_u32 s51, s51, 12288
  v_mfma_f32_16x16x32_bf16 v[172:175], a[204:207], a[108:111], v[172:175]
  ds_read_b64_tr_b16 a[192:193], v247 offset:32768
  ds_read_b64_tr_b16 a[194:195], v247 offset:36864
  v_mfma_f32_16x16x32_bf16 v[168:171], a[204:207], a[104:107], v[168:171]
  ds_read_b64_tr_b16 a[196:197], v247 offset:40960
  v_and_b32 v85, 0xffff0000, v131
  v_mfma_f32_16x16x32_bf16 v[168:171], a[200:203], a[96:99], v[168:171]
  s_waitcnt vmcnt(22) lgkmcnt(11)
  ds_read_b64_tr_b16 a[198:199], v247 offset:45056
  v_accvgpr_read_b32 v131, a243
  v_mfma_f32_16x16x32_bf16 v[32:35], a[208:211], a[112:115], v[32:35]
  buffer_load_dwordx4 a[24:27], v137, s[36:39], s51 offen offset:2048 sc1
  ds_read_b64_tr_b16 a[200:201], v244 offset:34816
  v_mfma_f32_16x16x32_bf16 v[32:35], a[212:215], a[120:123], v[32:35]
  ds_read_b64_tr_b16 a[202:203], v244 offset:38912
  v_lshlrev_b32 v86, 16, v131
  v_mfma_f32_16x16x32_bf16 v[36:39], a[212:215], a[124:127], v[36:39]
  ds_read_b64_tr_b16 a[204:205], v244 offset:43008
  v_and_b32 v87, 0xffff0000, v131
  v_mfma_f32_16x16x32_bf16 v[36:39], a[208:211], a[116:119], v[36:39]
  s_waitcnt lgkmcnt(11)
  ds_read_b64_tr_b16 a[206:207], v244 offset:47104
  v_accvgpr_read_b32 v131, a244
  v_mfma_f32_16x16x32_bf16 v[44:47], a[176:179], a[116:119], v[44:47]
  buffer_load_dwordx4 v136, s[24:27], s50 offen offset:3072 lds
  ds_read_b64_tr_b16 a[208:209], v245 offset:34816
  v_mfma_f32_16x16x32_bf16 v[44:47], a[180:183], a[124:127], v[44:47]
  ds_read_b64_tr_b16 a[210:211], v245 offset:38912
  v_lshlrev_b32 v88, 16, v131
  v_mfma_f32_16x16x32_bf16 v[40:43], a[180:183], a[120:123], v[40:43]
  ds_read_b64_tr_b16 a[212:213], v245 offset:43008
  v_and_b32 v89, 0xffff0000, v131
  v_mfma_f32_16x16x32_bf16 v[40:43], a[176:179], a[112:115], v[40:43]
  s_waitcnt vmcnt(17) lgkmcnt(11)
  s_barrier
  ds_read_b64_tr_b16 a[214:215], v245 offset:47104
  v_mfma_f32_16x16x32_bf16 v[48:51], a[184:187], a[112:115], v[48:51]
  buffer_load_dwordx4 a[28:31], v137, s[36:39], s51 offen offset:3072 sc1
  s_mov_b32 s72, 1
  v_mfma_f32_16x16x32_bf16 v[48:51], a[188:191], a[120:123], v[48:51]
  s_lshl_b32 s50, s72, 16
  s_add_u32 m0, s70, 16384
  ds_read_b64_tr_b16 a[176:177], v246 offset:34816
  v_mfma_f32_16x16x32_bf16 v[52:55], a[188:191], a[124:127], v[52:55]
  ds_read_b64_tr_b16 a[178:179], v246 offset:38912
  ds_read_b64_tr_b16 a[180:181], v246 offset:43008
  v_mfma_f32_16x16x32_bf16 v[52:55], a[184:187], a[116:119], v[52:55]
  s_waitcnt lgkmcnt(11)
  buffer_load_dwordx4 v133, s[24:27], s50 offen offset:0 lds
  ds_read_b64_tr_b16 a[182:183], v246 offset:47104
  v_mfma_f32_16x16x32_bf16 v[60:63], a[192:195], a[116:119], v[60:63]
  s_waitcnt vmcnt(14)
  v_cmp_ne_u32 vcc, s3, v139
  s_nop 4
  s_cbranch_vccnz CK8s
CK8x:
  v_mfma_f32_16x16x32_bf16 v[60:63], a[196:199], a[124:127], v[60:63]
  s_lshl_b32 s51, s72, 11
  ds_read_b64_tr_b16 a[184:185], v247 offset:34816
  ds_read_b64_tr_b16 a[186:187], v247 offset:38912
  v_mfma_f32_16x16x32_bf16 v[56:59], a[196:199], a[120:123], v[56:59]
  ds_read_b64_tr_b16 a[188:189], v247 offset:43008
  v_accvgpr_read_b32 v131, a245
  v_mfma_f32_16x16x32_bf16 v[56:59], a[192:195], a[112:115], v[56:59]
  s_waitcnt lgkmcnt(11)
  buffer_load_dwordx4 a[32:35], v137, s[36:39], s51 offen offset:0 sc1
  ds_read_b64_tr_b16 a[190:191], v247 offset:47104
  v_mfma_f32_16x16x32_bf16 v[144:147], a[200:203], a[112:115], v[144:147]
  ds_read_b64_tr_b16 a[192:193], v244 offset:49152
  v_lshlrev_b32 v90, 16, v131
  v_mfma_f32_16x16x32_bf16 v[144:147], a[204:207], a[120:123], v[144:147]
  ds_read_b64_tr_b16 a[194:195], v244 offset:53248
  v_and_b32 v91, 0xffff0000, v131
  v_mfma_f32_16x16x32_bf16 v[148:151], a[204:207], a[124:127], v[148:151]
  ds_read_b64_tr_b16 a[196:197], v244 offset:57344
  v_accvgpr_read_b32 v131, a246
  v_mfma_f32_16x16x32_bf16 v[148:151], a[200:203], a[116:119], v[148:151]
  s_waitcnt lgkmcnt(11)
  buffer_load_dwordx4 v134, s[24:27], s50 offen offset:1024 lds
  ds_read_b64_tr_b16 a[198:199], v244 offset:61440
  v_mfma_f32_16x16x32_bf16 v[156:159], a[208:211], a[116:119], v[156:159]
  ds_read_b64_tr_b16 a[200:201], v245 offset:49152
  v_lshlrev_b32 v92, 16, v131
  v_mfma_f32_16x16x32_bf16 v[156:159], a[212:215], a[124:127], v[156:159]
  ds_read_b64_tr_b16 a[202:203], v245 offset:53248
  v_and_b32 v93, 0xffff0000, v131
  v_mfma_f32_16x16x32_bf16 v[152:155], a[212:215], a[120:123], v[152:155]
  ds_read_b64_tr_b16 a[204:205], v245 offset:57344
  v_accvgpr_read_b32 v131, a247
  v_mfma_f32_16x16x32_bf16 v[152:155], a[208:211], a[112:115], v[152:155]
  s_waitcnt lgkmcnt(11)
  buffer_load_dwordx4 a[36:39], v137, s[36:39], s51 offen offset:1024 sc1
  ds_read_b64_tr_b16 a[206:207], v245 offset:61440
  v_mfma_f32_16x16x32_bf16 v[160:163], a[176:179], a[112:115], v[160:163]
  ds_read_b64_tr_b16 a[208:209], v246 offset:49152
  v_lshlrev_b32 v94, 16, v131
  v_mfma_f32_16x16x32_bf16 v[160:163], a[180:183], a[120:123], v[160:163]
  ds_read_b64_tr_b16 a[210:211], v246 offset:53248
  v_and_b32 v95, 0xffff0000, v131
  v_mfma_f32_16x16x32_bf16 v[164:167], a[180:183], a[124:127], v[164:167]
  s_add_u32 s49, s55, 32768
  ds_read_b64_tr_b16 a[212:213], v246 offset:57344
  s_lshl_b32 s76, s2, 5
  v_mfma_f32_16x16x32_bf16 v[164:167], a[176:179], a[116:119], v[164:167]
  s_waitcnt lgkmcnt(11)
  buffer_load_dwordx4 v135, s[24:27], s50 offen offset:2048 lds
  ds_read_b64_tr_b16 a[214:215], v246 offset:61440
  v_mfma_f32_16x16x32_bf16 v[172:175], a[184:187], a[116:119], v[172:175]
  s_add_u32 s76, s76, s44
  ds_read_b64_tr_b16 a[176:177], v247 offset:49152
  s_lshl2_add_u32 s76, s76, 5472256
  v_mfma_f32_16x16x32_bf16 v[172:175], a[188:191], a[124:127], v[172:175]
  s_xor_b32 s77, s76, 128
  ds_read_b64_tr_b16 a[178:179], v247 offset:53248
  v_mov_b32 v132, 0
  v_mfma_f32_16x16x32_bf16 v[168:171], a[188:191], a[120:123], v[168:171]
  ds_read_b64_tr_b16 a[180:181], v247 offset:57344
  v_mfma_f32_16x16x32_bf16 v[168:171], a[184:187], a[112:115], v[168:171]
  s_waitcnt vmcnt(22) lgkmcnt(11)
  buffer_load_dwordx4 a[40:43], v137, s[36:39], s51 offen offset:2048 sc1
  ds_read_b64_tr_b16 a[182:183], v247 offset:61440
  v_mfma_f32_16x16x32_bf16 v[32:35], a[192:195], a[216:219], v[32:35]
  ds_read_b64_tr_b16 a[184:185], v244 offset:51200
  v_mfma_f32_16x16x32_bf16 v[32:35], a[196:199], a[224:227], v[32:35]
  ds_read_b64_tr_b16 a[186:187], v244 offset:55296
  v_mfma_f32_16x16x32_bf16 v[36:39], a[196:199], a[228:231], v[36:39]
  buffer_load_dwordx4 v136, s[24:27], s50 offen offset:3072 lds
  ds_read_b64_tr_b16 a[188:189], v244 offset:59392
  v_mfma_f32_16x16x32_bf16 v[36:39], a[192:195], a[220:223], v[36:39]
  s_waitcnt lgkmcnt(11)
  ds_read_b64_tr_b16 a[190:191], v244 offset:63488
  v_mfma_f32_16x16x32_bf16 v[44:47], a[200:203], a[220:223], v[44:47]
  ds_read_b64_tr_b16 a[192:193], v245 offset:51200
  v_mfma_f32_16x16x32_bf16 v[44:47], a[204:207], a[228:231], v[44:47]
  ds_read_b64_tr_b16 a[194:195], v245 offset:55296
  v_mfma_f32_16x16x32_bf16 v[40:43], a[204:207], a[224:227], v[40:43]
  buffer_load_dwordx4 a[44:47], v137, s[36:39], s51 offen offset:3072 sc1
  s_cmp_eq_u32 s87, 1
  v_mfma_f32_16x16x32_bf16 v[40:43], a[200:203], a[216:219], v[40:43]
  s_waitcnt vmcnt(17) lgkmcnt(10)
  s_barrier
  s_cselect_b32 s73, 19, 5
  v_mfma_f32_16x16x32_bf16 v[48:51], a[208:211], a[216:219], v[48:51]
  s_lshl_b32 s50, s73, 16
  s_add_u32 m0, s70, 32768
  ds_read_b64_tr_b16 a[196:197], v245 offset:59392
  v_mfma_f32_16x16x32_bf16 v[48:51], a[212:215], a[224:227], v[48:51]
  ds_read_b64_tr_b16 a[198:199], v245 offset:63488
  ds_read_b64_tr_b16 a[200:201], v246 offset:51200
  v_mfma_f32_16x16x32_bf16 v[52:55], a[212:215], a[228:231], v[52:55]
  ds_read_b64_tr_b16 a[202:203], v246 offset:55296
  buffer_load_dwordx4 v133, s[24:27], s50 offen offset:0 lds
  v_mfma_f32_16x16x32_bf16 v[52:55], a[208:211], a[220:223], v[52:55]
  s_waitcnt lgkmcnt(10)
  s_lshl_b32 s51, s73, 11
  ds_read_b64_tr_b16 a[204:205], v246 offset:59392
  v_mfma_f32_16x16x32_bf16 v[60:63], a[176:179], a[220:223], v[60:63]
  ds_read_b64_tr_b16 a[206:207], v246 offset:63488
  ds_read_b64_tr_b16 a[208:209], v247 offset:51200
  v_mfma_f32_16x16x32_bf16 v[60:63], a[180:183], a[228:231], v[60:63]
  ds_read_b64_tr_b16 a[210:211], v247 offset:55296
  v_mfma_f32_16x16x32_bf16 v[56:59], a[180:183], a[224:227], v[56:59]
  buffer_load_dwordx4 a[48:51], v137, s[36:39], s51 offen offset:0 sc1
  ds_read_b64_tr_b16 a[212:213], v247 offset:59392
  v_mfma_f32_16x16x32_bf16 v[56:59], a[176:179], a[216:219], v[56:59]
  s_waitcnt lgkmcnt(11)
  ds_read_b64_tr_b16 a[214:215], v247 offset:63488
  v_mfma_f32_16x16x32_bf16 v[144:147], a[184:187], a[216:219], v[144:147]
  ds_read_b64_tr_b16 a[176:177], v248 offset:0
  v_mfma_f32_16x16x32_bf16 v[144:147], a[188:191], a[224:227], v[144:147]
  ds_read_b64_tr_b16 a[178:179], v248 offset:4096
  v_mfma_f32_16x16x32_bf16 v[148:151], a[188:191], a[228:231], v[148:151]
  buffer_load_dwordx4 v134, s[24:27], s50 offen offset:1024 lds
  ds_read_b64_tr_b16 a[180:181], v248 offset:8192
  v_mfma_f32_16x16x32_bf16 v[148:151], a[184:187], a[220:223], v[148:151]
  s_waitcnt lgkmcnt(11)
  ds_read_b64_tr_b16 a[182:183], v248 offset:12288
  v_mfma_f32_16x16x32_bf16 v[156:159], a[192:195], a[220:223], v[156:159]
  ds_read_b64_tr_b16 a[184:185], v249 offset:0
  v_mfma_f32_16x16x32_bf16 v[156:159], a[196:199], a[228:231], v[156:159]
  buffer_load_dwordx4 a[52:55], v137, s[36:39], s51 offen offset:1024 sc1
  ds_read_b64_tr_b16 a[186:187], v249 offset:4096
  v_mfma_f32_16x16x32_bf16 v[152:155], a[196:199], a[224:227], v[152:155]
  ds_read_b64_tr_b16 a[188:189], v249 offset:8192
  v_mfma_f32_16x16x32_bf16 v[152:155], a[192:195], a[216:219], v[152:155]
  s_waitcnt lgkmcnt(11)
  ds_read_b64_tr_b16 a[190:191], v249 offset:12288
  v_mfma_f32_16x16x32_bf16 v[160:163], a[200:203], a[216:219], v[160:163]
Hb0_3:
  s_cbranch_execz Rb
  ds_read_b64_tr_b16 a[192:193], v250 offset:0
  v_mfma_f32_16x16x32_bf16 v[160:163], a[204:207], a[224:227], v[160:163]
  buffer_load_dwordx4 v135, s[24:27], s50 offen offset:2048 lds
  ds_read_b64_tr_b16 a[194:195], v250 offset:4096
  v_mfma_f32_16x16x32_bf16 v[164:167], a[204:207], a[228:231], v[164:167]
  ds_read_b64_tr_b16 a[196:197], v250 offset:8192
  v_mfma_f32_16x16x32_bf16 v[164:167], a[200:203], a[220:223], v[164:167]
  s_waitcnt lgkmcnt(11)
  ds_read_b64_tr_b16 a[198:199], v250 offset:12288
  v_mfma_f32_16x16x32_bf16 v[172:175], a[208:211], a[220:223], v[172:175]
  ds_read_b64_tr_b16 a[200:201], v251 offset:0
  v_mfma_f32_16x16x32_bf16 v[172:175], a[212:215], a[228:231], v[172:175]
  buffer_load_dwordx4 a[56:59], v137, s[36:39], s51 offen offset:2048 sc1
  ds_read_b64_tr_b16 a[202:203], v251 offset:4096
  v_mfma_f32_16x16x32_bf16 v[168:171], a[212:215], a[224:227], v[168:171]
  ds_read_b64_tr_b16 a[204:205], v251 offset:8192
  v_mfma_f32_16x16x32_bf16 v[168:171], a[208:211], a[216:219], v[168:171]
  s_waitcnt vmcnt(22) lgkmcnt(11)
  ds_read_b64_tr_b16 a[206:207], v251 offset:12288
  v_mfma_f32_16x16x32_bf16 v[32:35], a[176:179], a[0:3], v[32:35]
  ds_read_b64_tr_b16 a[208:209], v248 offset:2048
  v_mfma_f32_16x16x32_bf16 v[32:35], a[180:183], a[8:11], v[32:35]
  buffer_load_dwordx4 v136, s[24:27], s50 offen offset:3072 lds
  ds_read_b64_tr_b16 a[210:211], v248 offset:6144
  v_mfma_f32_16x16x32_bf16 v[36:39], a[180:183], a[12:15], v[36:39]
  ds_read_b64_tr_b16 a[212:213], v248 offset:10240
  v_mfma_f32_16x16x32_bf16 v[36:39], a[176:179], a[4:7], v[36:39]
  s_waitcnt lgkmcnt(11)
  ds_read_b64_tr_b16 a[214:215], v248 offset:14336
  v_mfma_f32_16x16x32_bf16 v[44:47], a[184:187], a[4:7], v[44:47]
  ds_read_b64_tr_b16 a[176:177], v249 offset:2048
  v_mfma_f32_16x16x32_bf16 v[44:47], a[188:191], a[12:15], v[44:47]
  buffer_load_dwordx4 a[60:63], v137, s[36:39], s51 offen offset:3072 sc1
  s_cmp_eq_u32 s87, 2
  v_mfma_f32_16x16x32_bf16 v[40:43], a[188:191], a[8:11], v[40:43]
  s_cselect_b32 s74, 22, 8
  s_lshl_b32 s50, s74, 16
  s_add_u32 m0, s70, 49152
  v_mfma_f32_16x16x32_bf16 v[40:43], a[184:187], a[0:3], v[40:43]
  s_waitcnt vmcnt(17) lgkmcnt(9)
  s_barrier
  ds_read_b64_tr_b16 a[178:179], v249 offset:6144
  v_mfma_f32_16x16x32_bf16 v[48:51], a[192:195], a[0:3], v[48:51]
  ds_read_b64_tr_b16 a[180:181], v249 offset:10240
  ds_read_b64_tr_b16 a[182:183], v249 offset:14336
  v_mfma_f32_16x16x32_bf16 v[48:51], a[196:199], a[8:11], v[48:51]
  buffer_load_dwordx4 v133, s[24:27], s50 offen offset:0 lds
  s_lshl_b32 s51, s74, 11
  v_mfma_f32_16x16x32_bf16 v[52:55], a[196:199], a[12:15], v[52:55]
  ds_read_b64_tr_b16 a[184:185], v250 offset:2048
  ds_read_b64_tr_b16 a[186:187], v250 offset:6144
  v_mfma_f32_16x16x32_bf16 v[52:55], a[192:195], a[4:7], v[52:55]
  s_waitcnt lgkmcnt(10)
  ds_read_b64_tr_b16 a[188:189], v250 offset:10240
  ds_read_b64_tr_b16 a[190:191], v250 offset:14336
  v_mfma_f32_16x16x32_bf16 v[60:63], a[200:203], a[4:7], v[60:63]
  buffer_load_dwordx4 a[64:67], v137, s[36:39], s51 offen offset:0 sc1
  ds_read_b64_tr_b16 a[192:193], v251 offset:2048
  v_mfma_f32_16x16x32_bf16 v[60:63], a[204:207], a[12:15], v[60:63]
  ds_read_b64_tr_b16 a[194:195], v251 offset:6144
  v_mfma_f32_16x16x32_bf16 v[56:59], a[204:207], a[8:11], v[56:59]
  ds_read_b64_tr_b16 a[196:197], v251 offset:10240
  v_mfma_f32_16x16x32_bf16 v[56:59], a[200:203], a[0:3], v[56:59]
  s_waitcnt lgkmcnt(11)
  ds_read_b64_tr_b16 a[198:199], v251 offset:14336
  v_mfma_f32_16x16x32_bf16 v[144:147], a[208:211], a[0:3], v[144:147]
  buffer_load_dwordx4 v134, s[24:27], s50 offen offset:1024 lds
  ds_read_b64_tr_b16 a[200:201], v240 offset:0
  v_mfma_f32_16x16x32_bf16 v[144:147], a[212:215], a[8:11], v[144:147]
  ds_read_b64_tr_b16 a[202:203], v240 offset:4096
  v_mfma_f32_16x16x32_bf16 v[148:151], a[212:215], a[12:15], v[148:151]
  ds_read_b64_tr_b16 a[204:205], v240 offset:8192
  v_mfma_f32_16x16x32_bf16 v[148:151], a[208:211], a[4:7], v[148:151]
  s_waitcnt lgkmcnt(11)
  ds_read_b64_tr_b16 a[206:207], v240 offset:12288
  v_mfma_f32_16x16x32_bf16 v[156:159], a[176:179], a[4:7], v[156:159]
  buffer_load_dwordx4 a[68:71], v137, s[36:39], s51 offen offset:1024 sc1
  ds_read_b64_tr_b16 a[208:209], v241 offset:0
  v_mfma_f32_16x16x32_bf16 v[156:159], a[180:183], a[12:15], v[156:159]
  ds_read_b64_tr_b16 a[210:211], v241 offset:4096
  v_mfma_f32_16x16x32_bf16 v[152:155], a[180:183], a[8:11], v[152:155]
  ds_read_b64_tr_b16 a[212:213], v241 offset:8192
  v_mfma_f32_16x16x32_bf16 v[152:155], a[176:179], a[0:3], v[152:155]
  s_waitcnt lgkmcnt(11)
  ds_read_b64_tr_b16 a[214:215], v241 offset:12288
  v_mfma_f32_16x16x32_bf16 v[160:163], a[184:187], a[0:3], v[160:163]
  buffer_load_dwordx4 v135, s[24:27], s50 offen offset:2048 lds
  ds_read_b64_tr_b16 a[176:177], v242 offset:0
  v_mfma_f32_16x16x32_bf16 v[160:163], a[188:191], a[8:11], v[160:163]
  ds_read_b64_tr_b16 a[178:179], v242 offset:4096
  v_mfma_f32_16x16x32_bf16 v[164:167], a[188:191], a[12:15], v[164:167]
  ds_read_b64_tr_b16 a[180:181], v242 offset:8192
  v_mfma_f32_16x16x32_bf16 v[164:167], a[184:187], a[4:7], v[164:167]
  s_waitcnt lgkmcnt(11)
  buffer_load_dwordx4 a[72:75], v137, s[36:39], s51 offen offset:2048 sc1
  ds_read_b64_tr_b16 a[182:183], v242 offset:12288
  v_mfma_f32_16x16x32_bf16 v[172:175], a[192:195], a[4:7], v[172:175]
  ds_read_b64_tr_b16 a[184:185], v243 offset:0
  v_mfma_f32_16x16x32_bf16 v[172:175], a[196:199], a[12:15], v[172:175]
  ds_read_b64_tr_b16 a[186:187], v243 offset:4096
  v_mfma_f32_16x16x32_bf16 v[168:171], a[196:199], a[8:11], v[168:171]
  ds_read_b64_tr_b16 a[188:189], v243 offset:8192
  v_mfma_f32_16x16x32_bf16 v[168:171], a[192:195], a[0:3], v[168:171]
  s_waitcnt vmcnt(22) lgkmcnt(11)
  buffer_load_dwordx4 v136, s[24:27], s50 offen offset:3072 lds
  ds_read_b64_tr_b16 a[190:191], v243 offset:12288
  v_mfma_f32_16x16x32_bf16 v[32:35], a[200:203], a[16:19], v[32:35]
  ds_read_b64_tr_b16 a[192:193], v240 offset:2048
  v_mfma_f32_16x16x32_bf16 v[32:35], a[204:207], a[24:27], v[32:35]
  ds_read_b64_tr_b16 a[194:195], v240 offset:6144
  v_mfma_f32_16x16x32_bf16 v[36:39], a[204:207], a[28:31], v[36:39]
  ds_read_b64_tr_b16 a[196:197], v240 offset:10240
  v_mfma_f32_16x16x32_bf16 v[36:39], a[200:203], a[20:23], v[36:39]
  s_waitcnt lgkmcnt(11)
  buffer_load_dwordx4 a[76:79], v137, s[36:39], s51 offen offset:3072 sc1
  s_cmp_eq_u32 s87, 3
  v_mfma_f32_16x16x32_bf16 v[44:47], a[208:211], a[20:23], v[44:47]
  s_cselect_b32 s75, 26, 12
  s_lshl_b32 s50, s75, 16
  s_add_u32 m0, s70, 65536
  v_mfma_f32_16x16x32_bf16 v[44:47], a[212:215], a[28:31], v[44:47]
  ds_read_b64_tr_b16 a[198:199], v240 offset:14336
  ds_read_b64_tr_b16 a[200:201], v241 offset:2048
  v_mfma_f32_16x16x32_bf16 v[40:43], a[212:215], a[24:27], v[40:43]
  ds_read_b64_tr_b16 a[202:203], v241 offset:6144
  ds_read_b64_tr_b16 a[204:205], v241 offset:10240
  v_mfma_f32_16x16x32_bf16 v[40:43], a[208:211], a[16:19], v[40:43]
  s_waitcnt vmcnt(17) lgkmcnt(11)
  s_barrier
  buffer_load_dwordx4 v133, s[24:27], s50 offen offset:0 lds
  v_mfma_f32_16x16x32_bf16 v[48:51], a[176:179], a[16:19], v[48:51]
  s_lshl_b32 s51, s75, 11
  ds_read_b64_tr_b16 a[206:207], v241 offset:14336
  ds_read_b64_tr_b16 a[208:209], v242 offset:2048
  v_mfma_f32_16x16x32_bf16 v[48:51], a[180:183], a[24:27], v[48:51]
  ds_read_b64_tr_b16 a[210:211], v242 offset:6144
  v_mfma_f32_16x16x32_bf16 v[52:55], a[180:183], a[28:31], v[52:55]
  ds_read_b64_tr_b16 a[212:213], v242 offset:10240
  v_mfma_f32_16x16x32_bf16 v[52:55], a[176:179], a[20:23], v[52:55]
  s_waitcnt lgkmcnt(11)
  buffer_load_dwordx4 a[80:83], v137, s[36:39], s51 offen offset:0 sc1
  ds_read_b64_tr_b16 a[214:215], v242 offset:14336
  v_mfma_f32_16x16x32_bf16 v[60:63], a[184:187], a[20:23], v[60:63]
  ds_read_b64_tr_b16 a[176:177], v243 offset:2048
  v_mfma_f32_16x16x32_bf16 v[60:63], a[188:191], a[28:31], v[60:63]
  ds_read_b64_tr_b16 a[178:179], v243 offset:6144
  v_mfma_f32_16x16x32_bf16 v[56:59], a[188:191], a[24:27], v[56:59]
  buffer_load_dwordx4 v134, s[24:27], s50 offen offset:1024 lds
  ds_read_b64_tr_b16 a[180:181], v243 offset:10240
  v_mfma_f32_16x16x32_bf16 v[56:59], a[184:187], a[16:19], v[56:59]
  s_waitcnt lgkmcnt(11)
  ds_read_b64_tr_b16 a[182:183], v243 offset:14336
  v_mfma_f32_16x16x32_bf16 v[144:147], a[192:195], a[16:19], v[144:147]
  ds_read_b64_tr_b16 a[184:185], v240 offset:16384
  v_mfma_f32_16x16x32_bf16 v[144:147], a[196:199], a[24:27], v[144:147]
  ds_read_b64_tr_b16 a[186:187], v240 offset:20480
  v_mfma_f32_16x16x32_bf16 v[148:151], a[196:199], a[28:31], v[148:151]
  buffer_load_dwordx4 a[84:87], v137, s[36:39], s51 offen offset:1024 sc1
  ds_read_b64_tr_b16 a[188:189], v240 offset:24576
  v_mfma_f32_16x16x32_bf16 v[148:151], a[192:195], a[20:23], v[148:151]
  s_waitcnt lgkmcnt(11)
  ds_read_b64_tr_b16 a[190:191], v240 offset:28672
  v_mfma_f32_16x16x32_bf16 v[156:159], a[200:203], a[20:23], v[156:159]
  ds_read_b64_tr_b16 a[192:193], v241 offset:16384
  v_mfma_f32_16x16x32_bf16 v[156:159], a[204:207], a[28:31], v[156:159]
  ds_read_b64_tr_b16 a[194:195], v241 offset:20480
  v_mfma_f32_16x16x32_bf16 v[152:155], a[204:207], a[24:27], v[152:155]
  buffer_load_dwordx4 v135, s[24:27], s50 offen offset:2048 lds
  ds_read_b64_tr_b16 a[196:197], v241 offset:24576
  v_mfma_f32_16x16x32_bf16 v[152:155], a[200:203], a[16:19], v[152:155]
  s_waitcnt lgkmcnt(11)
  ds_read_b64_tr_b16 a[198:199], v241 offset:28672
  v_mfma_f32_16x16x32_bf16 v[160:163], a[208:211], a[16:19], v[160:163]
  ds_read_b64_tr_b16 a[200:201], v242 offset:16384
  v_mfma_f32_16x16x32_bf16 v[160:163], a[212:215], a[24:27], v[160:163]
  ds_read_b64_tr_b16 a[202:203], v242 offset:20480
  v_mfma_f32_16x16x32_bf16 v[164:167], a[212:215], a[28:31], v[164:167]
  buffer_load_dwordx4 a[88:91], v137, s[36:39], s51 offen offset:2048 sc1
  ds_read_b64_tr_b16 a[204:205], v242 offset:24576
  v_mfma_f32_16x16x32_bf16 v[164:167], a[208:211], a[20:23], v[164:167]
  s_waitcnt lgkmcnt(11)
  ds_read_b64_tr_b16 a[206:207], v242 offset:28672
  v_mfma_f32_16x16x32_bf16 v[172:175], a[176:179], a[20:23], v[172:175]
  ds_read_b64_tr_b16 a[208:209], v243 offset:16384
  v_mfma_f32_16x16x32_bf16 v[172:175], a[180:183], a[28:31], v[172:175]
  ds_read_b64_tr_b16 a[210:211], v243 offset:20480
  v_mfma_f32_16x16x32_bf16 v[168:171], a[180:183], a[24:27], v[168:171]
  buffer_load_dwordx4 v136, s[24:27], s50 offen offset:3072 lds
  ds_read_b64_tr_b16 a[212:213], v243 offset:24576
  v_mfma_f32_16x16x32_bf16 v[168:171], a[176:179], a[16:19], v[168:171]
  s_waitcnt vmcnt(23) lgkmcnt(11)
  ds_read_b64_tr_b16 a[214:215], v243 offset:28672
  v_mfma_f32_16x16x32_bf16 v[32:35], a[184:187], a[32:35], v[32:35]
  ds_read_b64_tr_b16 a[176:177], v240 offset:18432
  v_mfma_f32_16x16x32_bf16 v[32:35], a[188:191], a[40:43], v[32:35]
  buffer_load_dwordx4 a[92:95], v137, s[36:39], s51 offen offset:3072 sc1
  s_cmp_eq_u32 s87, 0
  v_mfma_f32_16x16x32_bf16 v[36:39], a[188:191], a[44:47], v[36:39]
  s_cselect_b32 s79, 29, 15
  s_lshl_b32 s50, s79, 16
  s_add_u32 m0, s70, 81920
  v_mfma_f32_16x16x32_bf16 v[36:39], a[184:187], a[36:39], v[36:39]
  s_waitcnt lgkmcnt(9)
  ds_read_b64_tr_b16 a[178:179], v240 offset:22528
  ds_read_b64_tr_b16 a[180:181], v240 offset:26624
  v_mfma_f32_16x16x32_bf16 v[44:47], a[192:195], a[36:39], v[44:47]
  ds_read_b64_tr_b16 a[182:183], v240 offset:30720
  ds_read_b64_tr_b16 a[184:185], v241 offset:18432
  v_mfma_f32_16x16x32_bf16 v[44:47], a[196:199], a[44:47], v[44:47]
  buffer_load_dwordx4 v133, s[24:27], s50 offen offset:0 lds
  s_lshl_b32 s51, s79, 11
  v_mfma_f32_16x16x32_bf16 v[40:43], a[196:199], a[40:43], v[40:43]
  ds_read_b64_tr_b16 a[186:187], v241 offset:22528
  ds_read_b64_tr_b16 a[188:189], v241 offset:26624
  v_mfma_f32_16x16x32_bf16 v[40:43], a[192:195], a[32:35], v[40:43]
  s_waitcnt vmcnt(18) lgkmcnt(11)
  s_barrier
  ds_read_b64_tr_b16 a[190:191], v241 offset:30720
  v_mfma_f32_16x16x32_bf16 v[48:51], a[200:203], a[32:35], v[48:51]
  ds_read_b64_tr_b16 a[192:193], v242 offset:18432
  v_mfma_f32_16x16x32_bf16 v[48:51], a[204:207], a[40:43], v[48:51]
  buffer_load_dwordx4 a[96:99], v137, s[36:39], s51 offen offset:0 sc1
  ds_read_b64_tr_b16 a[194:195], v242 offset:22528
  v_mfma_f32_16x16x32_bf16 v[52:55], a[204:207], a[44:47], v[52:55]
  ds_read_b64_tr_b16 a[196:197], v242 offset:26624
  v_mfma_f32_16x16x32_bf16 v[52:55], a[200:203], a[36:39], v[52:55]
  s_waitcnt lgkmcnt(11)
  ds_read_b64_tr_b16 a[198:199], v242 offset:30720
  v_mfma_f32_16x16x32_bf16 v[60:63], a[208:211], a[36:39], v[60:63]
  ds_read_b64_tr_b16 a[200:201], v243 offset:18432
  v_mfma_f32_16x16x32_bf16 v[60:63], a[212:215], a[44:47], v[60:63]
  buffer_load_dwordx4 v134, s[24:27], s50 offen offset:1024 lds
  ds_read_b64_tr_b16 a[202:203], v243 offset:22528
  v_mfma_f32_16x16x32_bf16 v[56:59], a[212:215], a[40:43], v[56:59]
  ds_read_b64_tr_b16 a[204:205], v243 offset:26624
  v_mfma_f32_16x16x32_bf16 v[56:59], a[208:211], a[32:35], v[56:59]
  s_waitcnt lgkmcnt(11)
  ds_read_b64_tr_b16 a[206:207], v243 offset:30720
  v_mfma_f32_16x16x32_bf16 v[144:147], a[176:179], a[32:35], v[144:147]
  ds_read_b64_tr_b16 a[208:209], v240 offset:32768
  v_mfma_f32_16x16x32_bf16 v[144:147], a[180:183], a[40:43], v[144:147]
  buffer_load_dwordx4 a[100:103], v137, s[36:39], s51 offen offset:1024 sc1
  ds_read_b64_tr_b16 a[210:211], v240 offset:36864
  v_mfma_f32_16x16x32_bf16 v[148:151], a[180:183], a[44:47], v[148:151]
  ds_read_b64_tr_b16 a[212:213], v240 offset:40960
  v_mfma_f32_16x16x32_bf16 v[148:151], a[176:179], a[36:39], v[148:151]
  s_waitcnt lgkmcnt(11)
  ds_read_b64_tr_b16 a[214:215], v240 offset:45056
  v_mfma_f32_16x16x32_bf16 v[156:159], a[184:187], a[36:39], v[156:159]
  buffer_load_dwordx4 v135, s[24:27], s50 offen offset:2048 lds
  ds_read_b64_tr_b16 a[176:177], v241 offset:32768
  v_mfma_f32_16x16x32_bf16 v[156:159], a[188:191], a[44:47], v[156:159]
  ds_read_b64_tr_b16 a[178:179], v241 offset:36864
  v_mfma_f32_16x16x32_bf16 v[152:155], a[188:191], a[40:43], v[152:155]
  ds_read_b64_tr_b16 a[180:181], v241 offset:40960
  v_mfma_f32_16x16x32_bf16 v[152:155], a[184:187], a[32:35], v[152:155]
  s_waitcnt lgkmcnt(11)
  ds_read_b64_tr_b16 a[182:183], v241 offset:45056
  v_mfma_f32_16x16x32_bf16 v[160:163], a[192:195], a[32:35], v[160:163]
  buffer_load_dwordx4 a[104:107], v137, s[36:39], s51 offen offset:2048 sc1
  ds_read_b64_tr_b16 a[184:185], v242 offset:32768
  v_mfma_f32_16x16x32_bf16 v[160:163], a[196:199], a[40:43], v[160:163]
  ds_read_b64_tr_b16 a[186:187], v242 offset:36864
  v_mfma_f32_16x16x32_bf16 v[164:167], a[196:199], a[44:47], v[164:167]
  ds_read_b64_tr_b16 a[188:189], v242 offset:40960
  v_mfma_f32_16x16x32_bf16 v[164:167], a[192:195], a[36:39], v[164:167]
  s_waitcnt lgkmcnt(11)
  ds_read_b64_tr_b16 a[190:191], v242 offset:45056
  v_mfma_f32_16x16x32_bf16 v[172:175], a[200:203], a[36:39], v[172:175]
  buffer_load_dwordx4 v136, s[24:27], s50 offen offset:3072 lds
  ds_read_b64_tr_b16 a[192:193], v243 offset:32768
  v_mfma_f32_16x16x32_bf16 v[172:175], a[204:207], a[44:47], v[172:175]
  ds_read_b64_tr_b16 a[194:195], v243 offset:36864
  v_mfma_f32_16x16x32_bf16 v[168:171], a[204:207], a[40:43], v[168:171]
  ds_read_b64_tr_b16 a[196:197], v243 offset:40960
  v_mfma_f32_16x16x32_bf16 v[168:171], a[200:203], a[32:35], v[168:171]
  s_waitcnt vmcnt(23) lgkmcnt(11)
  ds_read_b64_tr_b16 a[198:199], v243 offset:45056
  v_mfma_f32_16x16x32_bf16 v[32:35], a[208:211], a[48:51], v[32:35]
  buffer_load_dwordx4 a[108:111], v137, s[36:39], s51 offen offset:3072 sc1
  s_cmp_eq_u32 s87, 1
  v_mfma_f32_16x16x32_bf16 v[32:35], a[212:215], a[56:59], v[32:35]
  s_cselect_b32 s80, 33, 19
  s_lshl_b32 s50, s80, 16
  s_add_u32 m0, s70, 98304
  v_mfma_f32_16x16x32_bf16 v[36:39], a[212:215], a[60:63], v[36:39]
  ds_read_b64_tr_b16 a[200:201], v240 offset:34816
  ds_read_b64_tr_b16 a[202:203], v240 offset:38912
  v_mfma_f32_16x16x32_bf16 v[36:39], a[208:211], a[52:55], v[36:39]
  s_waitcnt lgkmcnt(10)
  ds_read_b64_tr_b16 a[204:205], v240 offset:43008
  ds_read_b64_tr_b16 a[206:207], v240 offset:47104
  v_mfma_f32_16x16x32_bf16 v[44:47], a[176:179], a[52:55], v[44:47]
  buffer_load_dwordx4 v133, s[24:27], s50 offen offset:0 lds
  s_lshl_b32 s51, s80, 11
  v_mfma_f32_16x16x32_bf16 v[44:47], a[180:183], a[60:63], v[44:47]
  ds_read_b64_tr_b16 a[208:209], v241 offset:34816
  ds_read_b64_tr_b16 a[210:211], v241 offset:38912
  v_mfma_f32_16x16x32_bf16 v[40:43], a[180:183], a[56:59], v[40:43]
  ds_read_b64_tr_b16 a[212:213], v241 offset:43008
  v_mfma_f32_16x16x32_bf16 v[40:43], a[176:179], a[48:51], v[40:43]
  s_waitcnt vmcnt(18) lgkmcnt(11)
  s_barrier
  ds_read_b64_tr_b16 a[214:215], v241 offset:47104
  v_mfma_f32_16x16x32_bf16 v[48:51], a[184:187], a[48:51], v[48:51]
  buffer_load_dwordx4 a[112:115], v137, s[36:39], s51 offen offset:0 sc1
  ds_read_b64_tr_b16 a[176:177], v242 offset:34816
  v_mfma_f32_16x16x32_bf16 v[48:51], a[188:191], a[56:59], v[48:51]
  ds_read_b64_tr_b16 a[178:179], v242 offset:38912
  v_mfma_f32_16x16x32_bf16 v[52:55], a[188:191], a[60:63], v[52:55]
  ds_read_b64_tr_b16 a[180:181], v242 offset:43008
  v_mfma_f32_16x16x32_bf16 v[52:55], a[184:187], a[52:55], v[52:55]
  s_waitcnt lgkmcnt(11)
  buffer_load_dwordx4 v134, s[24:27], s50 offen offset:1024 lds
  ds_read_b64_tr_b16 a[182:183], v242 offset:47104
  v_mfma_f32_16x16x32_bf16 v[60:63], a[192:195], a[52:55], v[60:63]
  ds_read_b64_tr_b16 a[184:185], v243 offset:34816
  v_mfma_f32_16x16x32_bf16 v[60:63], a[196:199], a[60:63], v[60:63]
  ds_read_b64_tr_b16 a[186:187], v243 offset:38912
  v_mfma_f32_16x16x32_bf16 v[56:59], a[196:199], a[56:59], v[56:59]
  ds_read_b64_tr_b16 a[188:189], v243 offset:43008
  v_mfma_f32_16x16x32_bf16 v[56:59], a[192:195], a[48:51], v[56:59]
  s_waitcnt lgkmcnt(11)
  buffer_load_dwordx4 a[116:119], v137, s[36:39], s51 offen offset:1024 sc1
  ds_read_b64_tr_b16 a[190:191], v243 offset:47104
  v_mfma_f32_16x16x32_bf16 v[144:147], a[200:203], a[48:51], v[144:147]
  ds_read_b64_tr_b16 a[192:193], v240 offset:49152
  v_mfma_f32_16x16x32_bf16 v[144:147], a[204:207], a[56:59], v[144:147]
  ds_read_b64_tr_b16 a[194:195], v240 offset:53248
  v_mfma_f32_16x16x32_bf16 v[148:151], a[204:207], a[60:63], v[148:151]
  ds_read_b64_tr_b16 a[196:197], v240 offset:57344
  v_mfma_f32_16x16x32_bf16 v[148:151], a[200:203], a[52:55], v[148:151]
  s_waitcnt lgkmcnt(11)
  buffer_load_dwordx4 v135, s[24:27], s50 offen offset:2048 lds
  ds_read_b64_tr_b16 a[198:199], v240 offset:61440
  v_mfma_f32_16x16x32_bf16 v[156:159], a[208:211], a[52:55], v[156:159]
  ds_read_b64_tr_b16 a[200:201], v241 offset:49152
  v_mfma_f32_16x16x32_bf16 v[156:159], a[212:215], a[60:63], v[156:159]
  ds_read_b64_tr_b16 a[202:203], v241 offset:53248
  v_mfma_f32_16x16x32_bf16 v[152:155], a[212:215], a[56:59], v[152:155]
  ds_read_b64_tr_b16 a[204:205], v241 offset:57344
  v_mfma_f32_16x16x32_bf16 v[152:155], a[208:211], a[48:51], v[152:155]
  s_waitcnt lgkmcnt(11)
  buffer_load_dwordx4 a[120:123], v137, s[36:39], s51 offen offset:2048 sc1
  ds_read_b64_tr_b16 a[206:207], v241 offset:61440
  v_mfma_f32_16x16x32_bf16 v[160:163], a[176:179], a[48:51], v[160:163]
  ds_read_b64_tr_b16 a[208:209], v242 offset:49152
  v_mfma_f32_16x16x32_bf16 v[160:163], a[180:183], a[56:59], v[160:163]
  ds_read_b64_tr_b16 a[210:211], v242 offset:53248
  v_mfma_f32_16x16x32_bf16 v[164:167], a[180:183], a[60:63], v[164:167]
  ds_read_b64_tr_b16 a[212:213], v242 offset:57344
  v_mfma_f32_16x16x32_bf16 v[164:167], a[176:179], a[52:55], v[164:167]
  s_waitcnt lgkmcnt(11)
  buffer_load_dwordx4 v136, s[24:27], s50 offen offset:3072 lds
  ds_read_b64_tr_b16 a[214:215], v242 offset:61440
  v_mfma_f32_16x16x32_bf16 v[172:175], a[184:187], a[52:55], v[172:175]
  ds_read_b64_tr_b16 a[176:177], v243 offset:49152
  v_mfma_f32_16x16x32_bf16 v[172:175], a[188:191], a[60:63], v[172:175]
  ds_read_b64_tr_b16 a[178:179], v243 offset:53248
  v_mfma_f32_16x16x32_bf16 v[168:171], a[188:191], a[56:59], v[168:171]
  buffer_load_dwordx4 a[124:127], v137, s[36:39], s51 offen offset:3072 sc1
  s_cmp_eq_u32 s87, 2
  v_mfma_f32_16x16x32_bf16 v[168:171], a[184:187], a[48:51], v[168:171]
  s_waitcnt vmcnt(24) lgkmcnt(10)
  s_cselect_b32 s81, 36, 22
  s_lshl_b32 s50, s81, 16
  v_mfma_f32_16x16x32_bf16 v[32:35], a[192:195], a[64:67], v[32:35]
  s_add_u32 m0, s70, 114688
  ds_read_b64_tr_b16 a[180:181], v243 offset:57344
  ds_read_b64_tr_b16 a[182:183], v243 offset:61440
  v_mfma_f32_16x16x32_bf16 v[32:35], a[196:199], a[72:75], v[32:35]
  ds_read_b64_tr_b16 a[184:185], v240 offset:51200
  ds_read_b64_tr_b16 a[186:187], v240 offset:55296
  v_mfma_f32_16x16x32_bf16 v[36:39], a[196:199], a[76:79], v[36:39]
  buffer_load_dwordx4 v133, s[24:27], s50 offen offset:0 lds
  s_lshl_b32 s51, s81, 11
  v_mfma_f32_16x16x32_bf16 v[36:39], a[192:195], a[68:71], v[36:39]
  s_waitcnt lgkmcnt(10)
  ds_read_b64_tr_b16 a[188:189], v240 offset:59392
  ds_read_b64_tr_b16 a[190:191], v240 offset:63488
  v_mfma_f32_16x16x32_bf16 v[44:47], a[200:203], a[68:71], v[44:47]
  ds_read_b64_tr_b16 a[192:193], v241 offset:51200
  v_mfma_f32_16x16x32_bf16 v[44:47], a[204:207], a[76:79], v[44:47]
  ds_read_b64_tr_b16 a[194:195], v241 offset:55296
  v_mfma_f32_16x16x32_bf16 v[40:43], a[204:207], a[72:75], v[40:43]
  buffer_load_dwordx4 a[216:219], v137, s[36:39], s51 offen offset:0 sc1
  ds_read_b64_tr_b16 a[196:197], v241 offset:59392
  v_mfma_f32_16x16x32_bf16 v[40:43], a[200:203], a[64:67], v[40:43]
  s_waitcnt vmcnt(19) lgkmcnt(11)
  s_barrier
  ds_read_b64_tr_b16 a[198:199], v241 offset:63488
  v_mfma_f32_16x16x32_bf16 v[48:51], a[208:211], a[64:67], v[48:51]
  ds_read_b64_tr_b16 a[200:201], v242 offset:51200
  v_mfma_f32_16x16x32_bf16 v[48:51], a[212:215], a[72:75], v[48:51]
  ds_read_b64_tr_b16 a[202:203], v242 offset:55296
  v_mfma_f32_16x16x32_bf16 v[52:55], a[212:215], a[76:79], v[52:55]
  buffer_load_dwordx4 v134, s[24:27], s50 offen offset:1024 lds
  ds_read_b64_tr_b16 a[204:205], v242 offset:59392
  v_mfma_f32_16x16x32_bf16 v[52:55], a[208:211], a[68:71], v[52:55]
  s_waitcnt lgkmcnt(11)
  ds_read_b64_tr_b16 a[206:207], v242 offset:63488
  v_mfma_f32_16x16x32_bf16 v[60:63], a[176:179], a[68:71], v[60:63]
  ds_read_b64_tr_b16 a[208:209], v243 offset:51200
  v_mfma_f32_16x16x32_bf16 v[60:63], a[180:183], a[76:79], v[60:63]
  ds_read_b64_tr_b16 a[210:211], v243 offset:55296
  v_mfma_f32_16x16x32_bf16 v[56:59], a[180:183], a[72:75], v[56:59]
  buffer_load_dwordx4 a[220:223], v137, s[36:39], s51 offen offset:1024 sc1
  ds_read_b64_tr_b16 a[212:213], v243 offset:59392
  v_mfma_f32_16x16x32_bf16 v[56:59], a[176:179], a[64:67], v[56:59]
  s_waitcnt lgkmcnt(11)
  ds_read_b64_tr_b16 a[214:215], v243 offset:63488
  v_mfma_f32_16x16x32_bf16 v[144:147], a[184:187], a[64:67], v[144:147]
  ds_read_b64_tr_b16 a[176:177], v244 offset:0
  v_mfma_f32_16x16x32_bf16 v[144:147], a[188:191], a[72:75], v[144:147]
  buffer_load_dwordx4 v135, s[24:27], s50 offen offset:2048 lds
  ds_read_b64_tr_b16 a[178:179], v244 offset:4096
  v_mfma_f32_16x16x32_bf16 v[148:151], a[188:191], a[76:79], v[148:151]
  ds_read_b64_tr_b16 a[180:181], v244 offset:8192
  v_mfma_f32_16x16x32_bf16 v[148:151], a[184:187], a[68:71], v[148:151]
  s_waitcnt lgkmcnt(11)
  ds_read_b64_tr_b16 a[182:183], v244 offset:12288
  v_mfma_f32_16x16x32_bf16 v[156:159], a[192:195], a[68:71], v[156:159]
  ds_read_b64_tr_b16 a[184:185], v245 offset:0
  v_mfma_f32_16x16x32_bf16 v[156:159], a[196:199], a[76:79], v[156:159]
  buffer_load_dwordx4 a[224:227], v137, s[36:39], s51 offen offset:2048 sc1
  ds_read_b64_tr_b16 a[186:187], v245 offset:4096
  v_mfma_f32_16x16x32_bf16 v[152:155], a[196:199], a[72:75], v[152:155]
  ds_read_b64_tr_b16 a[188:189], v245 offset:8192
  v_mfma_f32_16x16x32_bf16 v[152:155], a[192:195], a[64:67], v[152:155]
  s_waitcnt lgkmcnt(11)
  ds_read_b64_tr_b16 a[190:191], v245 offset:12288
  v_mfma_f32_16x16x32_bf16 v[160:163], a[200:203], a[64:67], v[160:163]
  ds_read_b64_tr_b16 a[192:193], v246 offset:0
  v_mfma_f32_16x16x32_bf16 v[160:163], a[204:207], a[72:75], v[160:163]
  buffer_load_dwordx4 v136, s[24:27], s50 offen offset:3072 lds
  ds_read_b64_tr_b16 a[194:195], v246 offset:4096
  v_mfma_f32_16x16x32_bf16 v[164:167], a[204:207], a[76:79], v[164:167]
  ds_read_b64_tr_b16 a[196:197], v246 offset:8192
  v_mfma_f32_16x16x32_bf16 v[164:167], a[200:203], a[68:71], v[164:167]
  s_waitcnt lgkmcnt(11)
  ds_read_b64_tr_b16 a[198:199], v246 offset:12288
  v_mfma_f32_16x16x32_bf16 v[172:175], a[208:211], a[68:71], v[172:175]
  ds_read_b64_tr_b16 a[200:201], v247 offset:0
  v_mfma_f32_16x16x32_bf16 v[172:175], a[212:215], a[76:79], v[172:175]
  buffer_load_dwordx4 a[228:231], v137, s[36:39], s51 offen offset:3072 sc1
  s_cmp_eq_u32 s87, 3
  v_mfma_f32_16x16x32_bf16 v[168:171], a[212:215], a[72:75], v[168:171]
  s_cselect_b32 s86, 40, 26
  s_lshl_b32 s50, s86, 16
  s_add_u32 m0, s70, 131072
  v_mfma_f32_16x16x32_bf16 v[168:171], a[208:211], a[64:67], v[168:171]
  s_waitcnt vmcnt(24) lgkmcnt(9)
  ds_read_b64_tr_b16 a[202:203], v247 offset:4096
  ds_read_b64_tr_b16 a[204:205], v247 offset:8192
  v_mfma_f32_16x16x32_bf16 v[32:35], a[176:179], a[80:83], v[32:35]
  ds_read_b64_tr_b16 a[206:207], v247 offset:12288
  ds_read_b64_tr_b16 a[208:209], v244 offset:2048
  v_mfma_f32_16x16x32_bf16 v[32:35], a[180:183], a[88:91], v[32:35]
  buffer_load_dwordx4 v133, s[24:27], s50 offen offset:0 lds
  s_lshl_b32 s51, s86, 11
  v_mfma_f32_16x16x32_bf16 v[36:39], a[180:183], a[92:95], v[36:39]
  ds_read_b64_tr_b16 a[210:211], v244 offset:6144
  ds_read_b64_tr_b16 a[212:213], v244 offset:10240
  v_mfma_f32_16x16x32_bf16 v[36:39], a[176:179], a[84:87], v[36:39]
  s_waitcnt lgkmcnt(11)
  ds_read_b64_tr_b16 a[214:215], v244 offset:14336
  v_mfma_f32_16x16x32_bf16 v[44:47], a[184:187], a[84:87], v[44:47]
  buffer_load_dwordx4 a[0:3], v137, s[36:39], s51 offen offset:0 sc1
  ds_read_b64_tr_b16 a[176:177], v245 offset:2048
  v_mfma_f32_16x16x32_bf16 v[44:47], a[188:191], a[92:95], v[44:47]
  ds_read_b64_tr_b16 a[178:179], v245 offset:6144
  v_mfma_f32_16x16x32_bf16 v[40:43], a[188:191], a[88:91], v[40:43]
  ds_read_b64_tr_b16 a[180:181], v245 offset:10240
  v_mfma_f32_16x16x32_bf16 v[40:43], a[184:187], a[80:83], v[40:43]
  s_waitcnt vmcnt(19) lgkmcnt(11)
  s_barrier
  ds_read_b64_tr_b16 a[182:183], v245 offset:14336
  v_mfma_f32_16x16x32_bf16 v[48:51], a[192:195], a[80:83], v[48:51]
  buffer_load_dwordx4 v134, s[24:27], s50 offen offset:1024 lds
  ds_read_b64_tr_b16 a[184:185], v246 offset:2048
  v_mfma_f32_16x16x32_bf16 v[48:51], a[196:199], a[88:91], v[48:51]
  ds_read_b64_tr_b16 a[186:187], v246 offset:6144
  v_mfma_f32_16x16x32_bf16 v[52:55], a[196:199], a[92:95], v[52:55]
  ds_read_b64_tr_b16 a[188:189], v246 offset:10240
  v_mfma_f32_16x16x32_bf16 v[52:55], a[192:195], a[84:87], v[52:55]
  s_waitcnt lgkmcnt(11)
  ds_read_b64_tr_b16 a[190:191], v246 offset:14336
  v_mfma_f32_16x16x32_bf16 v[60:63], a[200:203], a[84:87], v[60:63]
  buffer_load_dwordx4 a[4:7], v137, s[36:39], s51 offen offset:1024 sc1
  ds_read_b64_tr_b16 a[192:193], v247 offset:2048
  v_mfma_f32_16x16x32_bf16 v[60:63], a[204:207], a[92:95], v[60:63]
  ds_read_b64_tr_b16 a[194:195], v247 offset:6144
  v_mfma_f32_16x16x32_bf16 v[56:59], a[204:207], a[88:91], v[56:59]
  ds_read_b64_tr_b16 a[196:197], v247 offset:10240
  v_mfma_f32_16x16x32_bf16 v[56:59], a[200:203], a[80:83], v[56:59]
  s_waitcnt lgkmcnt(11)
  ds_read_b64_tr_b16 a[198:199], v247 offset:14336
  v_mfma_f32_16x16x32_bf16 v[144:147], a[208:211], a[80:83], v[144:147]
  buffer_load_dwordx4 v135, s[24:27], s50 offen offset:2048 lds
  ds_read_b64_tr_b16 a[200:201], v244 offset:16384
  v_mfma_f32_16x16x32_bf16 v[144:147], a[212:215], a[88:91], v[144:147]
  ds_read_b64_tr_b16 a[202:203], v244 offset:20480
  v_mfma_f32_16x16x32_bf16 v[148:151], a[212:215], a[92:95], v[148:151]
  ds_read_b64_tr_b16 a[204:205], v244 offset:24576
  v_mfma_f32_16x16x32_bf16 v[148:151], a[208:211], a[84:87], v[148:151]
  s_waitcnt lgkmcnt(11)
  ds_read_b64_tr_b16 a[206:207], v244 offset:28672
  v_mfma_f32_16x16x32_bf16 v[156:159], a[176:179], a[84:87], v[156:159]
  buffer_load_dwordx4 a[8:11], v137, s[36:39], s51 offen offset:2048 sc1
  ds_read_b64_tr_b16 a[208:209], v245 offset:16384
  v_mfma_f32_16x16x32_bf16 v[156:159], a[180:183], a[92:95], v[156:159]
  ds_read_b64_tr_b16 a[210:211], v245 offset:20480
  v_mfma_f32_16x16x32_bf16 v[152:155], a[180:183], a[88:91], v[152:155]
  ds_read_b64_tr_b16 a[212:213], v245 offset:24576
  v_mfma_f32_16x16x32_bf16 v[152:155], a[176:179], a[80:83], v[152:155]
  s_waitcnt lgkmcnt(11)
  buffer_load_dwordx4 v136, s[24:27], s50 offen offset:3072 lds
  ds_read_b64_tr_b16 a[214:215], v245 offset:28672
  v_mfma_f32_16x16x32_bf16 v[160:163], a[184:187], a[80:83], v[160:163]
  ds_read_b64_tr_b16 a[176:177], v246 offset:16384
  v_mfma_f32_16x16x32_bf16 v[160:163], a[188:191], a[88:91], v[160:163]
  ds_read_b64_tr_b16 a[178:179], v246 offset:20480
  v_mfma_f32_16x16x32_bf16 v[164:167], a[188:191], a[92:95], v[164:167]
  ds_read_b64_tr_b16 a[180:181], v246 offset:24576
  v_mfma_f32_16x16x32_bf16 v[164:167], a[184:187], a[84:87], v[164:167]
  s_waitcnt lgkmcnt(11)
  buffer_load_dwordx4 a[12:15], v137, s[36:39], s51 offen offset:3072 sc1
  s_cmp_eq_u32 s87, 0
  v_mfma_f32_16x16x32_bf16 v[172:175], a[192:195], a[84:87], v[172:175]
  s_cselect_b32 s69, 43, 29
  s_lshl_b32 s50, s69, 16
  s_add_u32 m0, s70, 0
  v_mfma_f32_16x16x32_bf16 v[172:175], a[196:199], a[92:95], v[172:175]
  ds_read_b64_tr_b16 a[182:183], v246 offset:28672
  ds_read_b64_tr_b16 a[184:185], v247 offset:16384
  v_mfma_f32_16x16x32_bf16 v[168:171], a[196:199], a[88:91], v[168:171]
  ds_read_b64_tr_b16 a[186:187], v247 offset:20480
  ds_read_b64_tr_b16 a[188:189], v247 offset:24576
  v_mfma_f32_16x16x32_bf16 v[168:171], a[192:195], a[80:83], v[168:171]
  s_waitcnt vmcnt(24) lgkmcnt(11)
  buffer_load_dwordx4 v133, s[24:27], s50 offen offset:0 lds
  s_lshl_b32 s51, s69, 11
  v_mfma_f32_16x16x32_bf16 v[32:35], a[200:203], a[96:99], v[32:35]
  ds_read_b64_tr_b16 a[190:191], v247 offset:28672
  ds_read_b64_tr_b16 a[192:193], v244 offset:18432
  v_mfma_f32_16x16x32_bf16 v[32:35], a[204:207], a[104:107], v[32:35]
  ds_read_b64_tr_b16 a[194:195], v244 offset:22528
  v_mfma_f32_16x16x32_bf16 v[36:39], a[204:207], a[108:111], v[36:39]
  ds_read_b64_tr_b16 a[196:197], v244 offset:26624
  v_mfma_f32_16x16x32_bf16 v[36:39], a[200:203], a[100:103], v[36:39]
  s_waitcnt lgkmcnt(11)
  buffer_load_dwordx4 a[16:19], v137, s[36:39], s51 offen offset:0 sc1
  ds_read_b64_tr_b16 a[198:199], v244 offset:30720
  v_mfma_f32_16x16x32_bf16 v[44:47], a[208:211], a[100:103], v[44:47]
Hb1_3:
  s_cbranch_execz Rb
  ds_read_b64_tr_b16 a[200:201], v245 offset:18432
  v_mfma_f32_16x16x32_bf16 v[44:47], a[212:215], a[108:111], v[44:47]
  ds_read_b64_tr_b16 a[202:203], v245 offset:22528
  v_mfma_f32_16x16x32_bf16 v[40:43], a[212:215], a[104:107], v[40:43]
  ds_read_b64_tr_b16 a[204:205], v245 offset:26624
  v_mfma_f32_16x16x32_bf16 v[40:43], a[208:211], a[96:99], v[40:43]
  s_waitcnt vmcnt(19) lgkmcnt(11)
  s_barrier
  buffer_load_dwordx4 v134, s[24:27], s50 offen offset:1024 lds
  v_mfma_f32_16x16x32_bf16 v[48:51], a[176:179], a[96:99], v[48:51]
  ds_read_b64_tr_b16 a[206:207], v245 offset:30720
  ds_read_b64_tr_b16 a[208:209], v246 offset:18432
  v_mfma_f32_16x16x32_bf16 v[48:51], a[180:183], a[104:107], v[48:51]
  ds_read_b64_tr_b16 a[210:211], v246 offset:22528
  v_mfma_f32_16x16x32_bf16 v[52:55], a[180:183], a[108:111], v[52:55]
  buffer_load_dwordx4 a[20:23], v137, s[36:39], s51 offen offset:1024 sc1
  ds_read_b64_tr_b16 a[212:213], v246 offset:26624
  v_mfma_f32_16x16x32_bf16 v[52:55], a[176:179], a[100:103], v[52:55]
  s_waitcnt lgkmcnt(11)
  ds_read_b64_tr_b16 a[214:215], v246 offset:30720
  v_mfma_f32_16x16x32_bf16 v[60:63], a[184:187], a[100:103], v[60:63]
  ds_read_b64_tr_b16 a[176:177], v247 offset:18432
  v_mfma_f32_16x16x32_bf16 v[60:63], a[188:191], a[108:111], v[60:63]
  ds_read_b64_tr_b16 a[178:179], v247 offset:22528
  v_mfma_f32_16x16x32_bf16 v[56:59], a[188:191], a[104:107], v[56:59]
  buffer_load_dwordx4 v135, s[24:27], s50 offen offset:2048 lds
  ds_read_b64_tr_b16 a[180:181], v247 offset:26624
  v_mfma_f32_16x16x32_bf16 v[56:59], a[184:187], a[96:99], v[56:59]
  s_waitcnt lgkmcnt(11)
  ds_read_b64_tr_b16 a[182:183], v247 offset:30720
  v_mfma_f32_16x16x32_bf16 v[144:147], a[192:195], a[96:99], v[144:147]
  ds_read_b64_tr_b16 a[184:185], v244 offset:32768
  v_mfma_f32_16x16x32_bf16 v[144:147], a[196:199], a[104:107], v[144:147]
  ds_read_b64_tr_b16 a[186:187], v244 offset:36864
  v_mfma_f32_16x16x32_bf16 v[148:151], a[196:199], a[108:111], v[148:151]
  buffer_load_dwordx4 a[24:27], v137, s[36:39], s51 offen offset:2048 sc1
  ds_read_b64_tr_b16 a[188:189], v244 offset:40960
  v_mfma_f32_16x16x32_bf16 v[148:151], a[192:195], a[100:103], v[148:151]
  s_waitcnt lgkmcnt(11)
  ds_read_b64_tr_b16 a[190:191], v244 offset:45056
  v_mfma_f32_16x16x32_bf16 v[156:159], a[200:203], a[100:103], v[156:159]
  ds_read_b64_tr_b16 a[192:193], v245 offset:32768
  v_mfma_f32_16x16x32_bf16 v[156:159], a[204:207], a[108:111], v[156:159]
  ds_read_b64_tr_b16 a[194:195], v245 offset:36864
  v_mfma_f32_16x16x32_bf16 v[152:155], a[204:207], a[104:107], v[152:155]
  buffer_load_dwordx4 v136, s[24:27], s50 offen offset:3072 lds
  ds_read_b64_tr_b16 a[196:197], v245 offset:40960
  v_mfma_f32_16x16x32_bf16 v[152:155], a[200:203], a[96:99], v[152:155]
  s_waitcnt lgkmcnt(11)
  ds_read_b64_tr_b16 a[198:199], v245 offset:45056
  v_mfma_f32_16x16x32_bf16 v[160:163], a[208:211], a[96:99], v[160:163]
  ds_read_b64_tr_b16 a[200:201], v246 offset:32768
  v_mfma_f32_16x16x32_bf16 v[160:163], a[212:215], a[104:107], v[160:163]
  ds_read_b64_tr_b16 a[202:203], v246 offset:36864
  v_mfma_f32_16x16x32_bf16 v[164:167], a[212:215], a[108:111], v[164:167]
  buffer_load_dwordx4 a[28:31], v137, s[36:39], s51 offen offset:3072 sc1
  s_cmp_eq_u32 s87, 1
  v_mfma_f32_16x16x32_bf16 v[164:167], a[208:211], a[100:103], v[164:167]
  s_waitcnt lgkmcnt(10)
  s_cselect_b32 s71, 47, 33
  s_lshl_b32 s51, s71, 11
  v_mfma_f32_16x16x32_bf16 v[172:175], a[176:179], a[100:103], v[172:175]
  ds_read_b64_tr_b16 a[204:205], v246 offset:40960
  ds_read_b64_tr_b16 a[206:207], v246 offset:45056
  v_mfma_f32_16x16x32_bf16 v[172:175], a[180:183], a[108:111], v[172:175]
  ds_read_b64_tr_b16 a[208:209], v247 offset:32768
  buffer_load_dwordx4 a[32:35], v137, s[36:39], s51 offen offset:0 sc1
  v_mfma_f32_16x16x32_bf16 v[168:171], a[180:183], a[104:107], v[168:171]
  ds_read_b64_tr_b16 a[210:211], v247 offset:36864
  ds_read_b64_tr_b16 a[212:213], v247 offset:40960
  v_mfma_f32_16x16x32_bf16 v[168:171], a[176:179], a[96:99], v[168:171]
  s_waitcnt vmcnt(25) lgkmcnt(11)
  ds_read_b64_tr_b16 a[214:215], v247 offset:45056
  v_mfma_f32_16x16x32_bf16 v[32:35], a[184:187], a[112:115], v[32:35]
  ds_read_b64_tr_b16 a[176:177], v244 offset:34816
  v_mfma_f32_16x16x32_bf16 v[32:35], a[188:191], a[120:123], v[32:35]
  buffer_load_dwordx4 a[36:39], v137, s[36:39], s51 offen offset:1024 sc1
  s_lshl_b32 s50, s71, 16
  v_mfma_f32_16x16x32_bf16 v[36:39], a[188:191], a[124:127], v[36:39]
  s_add_u32 m0, s70, 16384
  ds_read_b64_tr_b16 a[178:179], v244 offset:38912
  ds_read_b64_tr_b16 a[180:181], v244 offset:43008
  v_mfma_f32_16x16x32_bf16 v[36:39], a[184:187], a[116:119], v[36:39]
  s_waitcnt lgkmcnt(11)
  ds_read_b64_tr_b16 a[182:183], v244 offset:47104
  v_mfma_f32_16x16x32_bf16 v[44:47], a[192:195], a[116:119], v[44:47]
  ds_read_b64_tr_b16 a[184:185], v245 offset:34816
  v_mfma_f32_16x16x32_bf16 v[44:47], a[196:199], a[124:127], v[44:47]
  buffer_load_dwordx4 v135, s[24:27], s50 offen offset:2048 lds
  ds_read_b64_tr_b16 a[186:187], v245 offset:38912
  v_mfma_f32_16x16x32_bf16 v[40:43], a[196:199], a[120:123], v[40:43]
  ds_read_b64_tr_b16 a[188:189], v245 offset:43008
  v_mfma_f32_16x16x32_bf16 v[40:43], a[192:195], a[112:115], v[40:43]
  s_waitcnt vmcnt(20) lgkmcnt(11)
  s_barrier
  ds_read_b64_tr_b16 a[190:191], v245 offset:47104
  v_mfma_f32_16x16x32_bf16 v[48:51], a[200:203], a[112:115], v[48:51]
  ds_read_b64_tr_b16 a[192:193], v246 offset:34816
  v_mfma_f32_16x16x32_bf16 v[48:51], a[204:207], a[120:123], v[48:51]
  buffer_load_dwordx4 a[40:43], v137, s[36:39], s51 offen offset:2048 sc1
  ds_read_b64_tr_b16 a[194:195], v246 offset:38912
  v_mfma_f32_16x16x32_bf16 v[52:55], a[204:207], a[124:127], v[52:55]
  ds_read_b64_tr_b16 a[196:197], v246 offset:43008
  v_mfma_f32_16x16x32_bf16 v[52:55], a[200:203], a[116:119], v[52:55]
  s_waitcnt lgkmcnt(11)
  ds_read_b64_tr_b16 a[198:199], v246 offset:47104
  v_mfma_f32_16x16x32_bf16 v[60:63], a[208:211], a[116:119], v[60:63]
  ds_read_b64_tr_b16 a[200:201], v247 offset:34816
  v_mfma_f32_16x16x32_bf16 v[60:63], a[212:215], a[124:127], v[60:63]
  buffer_load_dwordx4 v136, s[24:27], s50 offen offset:3072 lds
  ds_read_b64_tr_b16 a[202:203], v247 offset:38912
  v_mfma_f32_16x16x32_bf16 v[56:59], a[212:215], a[120:123], v[56:59]
  ds_read_b64_tr_b16 a[204:205], v247 offset:43008
  v_mfma_f32_16x16x32_bf16 v[56:59], a[208:211], a[112:115], v[56:59]
  s_waitcnt lgkmcnt(11)
  ds_read_b64_tr_b16 a[206:207], v247 offset:47104
  v_mfma_f32_16x16x32_bf16 v[144:147], a[176:179], a[112:115], v[144:147]
  ds_read_b64_tr_b16 a[208:209], v244 offset:49152
  v_mfma_f32_16x16x32_bf16 v[144:147], a[180:183], a[120:123], v[144:147]
  buffer_load_dwordx4 a[44:47], v137, s[36:39], s51 offen offset:3072 sc1
  s_cmp_eq_u32 s87, 2
  v_mfma_f32_16x16x32_bf16 v[148:151], a[180:183], a[124:127], v[148:151]
  s_cselect_b32 s72, 50, 36
  s_lshl_b32 s51, s72, 11
  ds_read_b64_tr_b16 a[210:211], v244 offset:53248
  v_mfma_f32_16x16x32_bf16 v[148:151], a[176:179], a[116:119], v[148:151]
  s_waitcnt lgkmcnt(10)
  ds_read_b64_tr_b16 a[212:213], v244 offset:57344
  ds_read_b64_tr_b16 a[214:215], v244 offset:61440
  v_mfma_f32_16x16x32_bf16 v[156:159], a[184:187], a[116:119], v[156:159]
  buffer_load_dwordx4 a[48:51], v137, s[36:39], s51 offen offset:0 sc1
  ds_read_b64_tr_b16 a[176:177], v245 offset:49152
  v_mfma_f32_16x16x32_bf16 v[156:159], a[188:191], a[124:127], v[156:159]
  ds_read_b64_tr_b16 a[178:179], v245 offset:53248
  v_mfma_f32_16x16x32_bf16 v[152:155], a[188:191], a[120:123], v[152:155]
  ds_read_b64_tr_b16 a[180:181], v245 offset:57344
  v_mfma_f32_16x16x32_bf16 v[152:155], a[184:187], a[112:115], v[152:155]
  s_waitcnt lgkmcnt(11)
  ds_read_b64_tr_b16 a[182:183], v245 offset:61440
  v_mfma_f32_16x16x32_bf16 v[160:163], a[192:195], a[112:115], v[160:163]
  buffer_load_dwordx4 a[52:55], v137, s[36:39], s51 offen offset:1024 sc1
  s_lshl_b32 s50, s72, 16
  v_mfma_f32_16x16x32_bf16 v[160:163], a[196:199], a[120:123], v[160:163]
  s_add_u32 m0, s70, 32768
  ds_read_b64_tr_b16 a[184:185], v246 offset:49152
  ds_read_b64_tr_b16 a[186:187], v246 offset:53248
  v_mfma_f32_16x16x32_bf16 v[164:167], a[196:199], a[124:127], v[164:167]
  ds_read_b64_tr_b16 a[188:189], v246 offset:57344
  v_mfma_f32_16x16x32_bf16 v[164:167], a[192:195], a[116:119], v[164:167]
  s_waitcnt lgkmcnt(11)
  ds_read_b64_tr_b16 a[190:191], v246 offset:61440
  v_mfma_f32_16x16x32_bf16 v[172:175], a[200:203], a[116:119], v[172:175]
  buffer_load_dwordx4 v135, s[24:27], s50 offen offset:2048 lds
  ds_read_b64_tr_b16 a[192:193], v247 offset:49152
  v_mfma_f32_16x16x32_bf16 v[172:175], a[204:207], a[124:127], v[172:175]
  ds_read_b64_tr_b16 a[194:195], v247 offset:53248
  v_mfma_f32_16x16x32_bf16 v[168:171], a[204:207], a[120:123], v[168:171]
  ds_read_b64_tr_b16 a[196:197], v247 offset:57344
  v_mfma_f32_16x16x32_bf16 v[168:171], a[200:203], a[112:115], v[168:171]
  s_waitcnt vmcnt(25) lgkmcnt(11)
  ds_read_b64_tr_b16 a[198:199], v247 offset:61440
  v_mfma_f32_16x16x32_bf16 v[32:35], a[208:211], a[216:219], v[32:35]
  buffer_load_dwordx4 a[56:59], v137, s[36:39], s51 offen offset:2048 sc1
  ds_read_b64_tr_b16 a[200:201], v244 offset:51200
  v_mfma_f32_16x16x32_bf16 v[32:35], a[212:215], a[224:227], v[32:35]
  ds_read_b64_tr_b16 a[202:203], v244 offset:55296
  v_mfma_f32_16x16x32_bf16 v[36:39], a[212:215], a[228:231], v[36:39]
  ds_read_b64_tr_b16 a[204:205], v244 offset:59392
  v_mfma_f32_16x16x32_bf16 v[36:39], a[208:211], a[220:223], v[36:39]
  s_waitcnt lgkmcnt(11)
  ds_read_b64_tr_b16 a[206:207], v244 offset:63488
  v_mfma_f32_16x16x32_bf16 v[44:47], a[176:179], a[220:223], v[44:47]
  buffer_load_dwordx4 v136, s[24:27], s50 offen offset:3072 lds
  ds_read_b64_tr_b16 a[208:209], v245 offset:51200
  v_mfma_f32_16x16x32_bf16 v[44:47], a[180:183], a[228:231], v[44:47]
  ds_read_b64_tr_b16 a[210:211], v245 offset:55296
  v_mfma_f32_16x16x32_bf16 v[40:43], a[180:183], a[224:227], v[40:43]
  ds_read_b64_tr_b16 a[212:213], v245 offset:59392
  v_mfma_f32_16x16x32_bf16 v[40:43], a[176:179], a[216:219], v[40:43]
  s_waitcnt vmcnt(20) lgkmcnt(11)
  s_barrier
  buffer_load_dwordx4 a[60:63], v137, s[36:39], s51 offen offset:3072 sc1
  v_mfma_f32_16x16x32_bf16 v[48:51], a[184:187], a[216:219], v[48:51]
  s_cmp_eq_u32 s87, 3
  s_cselect_b32 s73, 54, 40
  s_lshl_b32 s51, s73, 11
  v_mfma_f32_16x16x32_bf16 v[48:51], a[188:191], a[224:227], v[48:51]
  ds_read_b64_tr_b16 a[214:215], v245 offset:63488
  ds_read_b64_tr_b16 a[176:177], v246 offset:51200
  v_mfma_f32_16x16x32_bf16 v[52:55], a[188:191], a[228:231], v[52:55]
  ds_read_b64_tr_b16 a[178:179], v246 offset:55296
  ds_read_b64_tr_b16 a[180:181], v246 offset:59392
  v_mfma_f32_16x16x32_bf16 v[52:55], a[184:187], a[220:223], v[52:55]
  s_waitcnt lgkmcnt(11)
  buffer_load_dwordx4 a[64:67], v137, s[36:39], s51 offen offset:0 sc1
  ds_read_b64_tr_b16 a[182:183], v246 offset:63488
  v_mfma_f32_16x16x32_bf16 v[60:63], a[192:195], a[220:223], v[60:63]
  ds_read_b64_tr_b16 a[184:185], v247 offset:51200
  v_mfma_f32_16x16x32_bf16 v[60:63], a[196:199], a[228:231], v[60:63]
  ds_read_b64_tr_b16 a[186:187], v247 offset:55296
  v_mfma_f32_16x16x32_bf16 v[56:59], a[196:199], a[224:227], v[56:59]
  ds_read_b64_tr_b16 a[188:189], v247 offset:59392
  v_mfma_f32_16x16x32_bf16 v[56:59], a[192:195], a[216:219], v[56:59]
  s_waitcnt lgkmcnt(11)
  buffer_load_dwordx4 a[68:71], v137, s[36:39], s51 offen offset:1024 sc1
  s_lshl_b32 s50, s73, 16
  v_mfma_f32_16x16x32_bf16 v[144:147], a[200:203], a[216:219], v[144:147]
  s_add_u32 m0, s70, 49152
  ds_read_b64_tr_b16 a[190:191], v247 offset:63488
  ds_read_b64_tr_b16 a[192:193], v248 offset:0
  v_mfma_f32_16x16x32_bf16 v[144:147], a[204:207], a[224:227], v[144:147]
  ds_read_b64_tr_b16 a[194:195], v248 offset:4096
  v_mfma_f32_16x16x32_bf16 v[148:151], a[204:207], a[228:231], v[148:151]
  ds_read_b64_tr_b16 a[196:197], v248 offset:8192
  v_mfma_f32_16x16x32_bf16 v[148:151], a[200:203], a[220:223], v[148:151]
  s_waitcnt lgkmcnt(11)
  buffer_load_dwordx4 v135, s[24:27], s50 offen offset:2048 lds
  ds_read_b64_tr_b16 a[198:199], v248 offset:12288
  v_mfma_f32_16x16x32_bf16 v[156:159], a[208:211], a[220:223], v[156:159]
  ds_read_b64_tr_b16 a[200:201], v249 offset:0
  v_mfma_f32_16x16x32_bf16 v[156:159], a[212:215], a[228:231], v[156:159]
  ds_read_b64_tr_b16 a[202:203], v249 offset:4096
  v_mfma_f32_16x16x32_bf16 v[152:155], a[212:215], a[224:227], v[152:155]
  ds_read_b64_tr_b16 a[204:205], v249 offset:8192
  v_mfma_f32_16x16x32_bf16 v[152:155], a[208:211], a[216:219], v[152:155]
  s_waitcnt lgkmcnt(11)
  buffer_load_dwordx4 a[72:75], v137, s[36:39], s51 offen offset:2048 sc1
  ds_read_b64_tr_b16 a[206:207], v249 offset:12288
  v_mfma_f32_16x16x32_bf16 v[160:163], a[176:179], a[216:219], v[160:163]
  ds_read_b64_tr_b16 a[208:209], v250 offset:0
  v_mfma_f32_16x16x32_bf16 v[160:163], a[180:183], a[224:227], v[160:163]
  ds_read_b64_tr_b16 a[210:211], v250 offset:4096
  v_mfma_f32_16x16x32_bf16 v[164:167], a[180:183], a[228:231], v[164:167]
  buffer_load_dwordx4 v136, s[24:27], s50 offen offset:3072 lds
  ds_read_b64_tr_b16 a[212:213], v250 offset:8192
  v_mfma_f32_16x16x32_bf16 v[164:167], a[176:179], a[220:223], v[164:167]
  s_waitcnt lgkmcnt(11)
  ds_read_b64_tr_b16 a[214:215], v250 offset:12288
  v_mfma_f32_16x16x32_bf16 v[172:175], a[184:187], a[220:223], v[172:175]
  ds_read_b64_tr_b16 a[176:177], v251 offset:0
  v_mfma_f32_16x16x32_bf16 v[172:175], a[188:191], a[228:231], v[172:175]
  ds_read_b64_tr_b16 a[178:179], v251 offset:4096
  v_mfma_f32_16x16x32_bf16 v[168:171], a[188:191], a[224:227], v[168:171]
  buffer_load_dwordx4 a[76:79], v137, s[36:39], s51 offen offset:3072 sc1
  s_cmp_eq_u32 s87, 0
  v_mfma_f32_16x16x32_bf16 v[168:171], a[184:187], a[216:219], v[168:171]
  s_waitcnt vmcnt(26) lgkmcnt(10)
  s_cselect_b32 s74, 15, 43
  s_lshl_b32 s51, s74, 11
  v_mfma_f32_16x16x32_bf16 v[32:35], a[192:195], a[0:3], v[32:35]
  ds_read_b64_tr_b16 a[180:181], v251 offset:8192
  ds_read_b64_tr_b16 a[182:183], v251 offset:12288
  v_mfma_f32_16x16x32_bf16 v[32:35], a[196:199], a[8:11], v[32:35]
  ds_read_b64_tr_b16 a[184:185], v248 offset:2048
  ds_read_b64_tr_b16 a[186:187], v248 offset:6144
  v_mfma_f32_16x16x32_bf16 v[36:39], a[196:199], a[12:15], v[36:39]
  buffer_load_dwordx4 a[80:83], v137, s[36:39], s51 offen offset:0 sc1
  ds_read_b64_tr_b16 a[188:189], v248 offset:10240
  v_mfma_f32_16x16x32_bf16 v[36:39], a[192:195], a[4:7], v[36:39]
  s_waitcnt lgkmcnt(11)
  ds_read_b64_tr_b16 a[190:191], v248 offset:14336
  v_mfma_f32_16x16x32_bf16 v[44:47], a[200:203], a[4:7], v[44:47]
  ds_read_b64_tr_b16 a[192:193], v249 offset:2048
  v_mfma_f32_16x16x32_bf16 v[44:47], a[204:207], a[12:15], v[44:47]
  ds_read_b64_tr_b16 a[194:195], v249 offset:6144
  v_mfma_f32_16x16x32_bf16 v[40:43], a[204:207], a[8:11], v[40:43]
  buffer_load_dwordx4 a[84:87], v137, s[36:39], s51 offen offset:1024 sc1
  s_lshl_b32 s50, s74, 16
  v_mfma_f32_16x16x32_bf16 v[40:43], a[200:203], a[0:3], v[40:43]
  s_waitcnt vmcnt(21) lgkmcnt(10)
  s_barrier
  s_add_u32 m0, s70, 65536
  v_mfma_f32_16x16x32_bf16 v[48:51], a[208:211], a[0:3], v[48:51]
  ds_read_b64_tr_b16 a[196:197], v249 offset:10240
  ds_read_b64_tr_b16 a[198:199], v249 offset:14336
  v_mfma_f32_16x16x32_bf16 v[48:51], a[212:215], a[8:11], v[48:51]
  ds_read_b64_tr_b16 a[200:201], v250 offset:2048
  ds_read_b64_tr_b16 a[202:203], v250 offset:6144
  v_mfma_f32_16x16x32_bf16 v[52:55], a[212:215], a[12:15], v[52:55]
  buffer_load_dwordx4 v135, s[24:27], s50 offen offset:2048 lds
  ds_read_b64_tr_b16 a[204:205], v250 offset:10240
  v_mfma_f32_16x16x32_bf16 v[52:55], a[208:211], a[4:7], v[52:55]
  s_waitcnt lgkmcnt(11)
  ds_read_b64_tr_b16 a[206:207], v250 offset:14336
  v_mfma_f32_16x16x32_bf16 v[60:63], a[176:179], a[4:7], v[60:63]
  ds_read_b64_tr_b16 a[208:209], v251 offset:2048
  v_mfma_f32_16x16x32_bf16 v[60:63], a[180:183], a[12:15], v[60:63]
  buffer_load_dwordx4 a[88:91], v137, s[36:39], s51 offen offset:2048 sc1
  ds_read_b64_tr_b16 a[210:211], v251 offset:6144
  v_mfma_f32_16x16x32_bf16 v[56:59], a[180:183], a[8:11], v[56:59]
  ds_read_b64_tr_b16 a[212:213], v251 offset:10240
  v_mfma_f32_16x16x32_bf16 v[56:59], a[176:179], a[0:3], v[56:59]
  s_waitcnt lgkmcnt(11)
  ds_read_b64_tr_b16 a[214:215], v251 offset:14336
  v_mfma_f32_16x16x32_bf16 v[144:147], a[184:187], a[0:3], v[144:147]
  ds_read_b64_tr_b16 a[176:177], v240 offset:0
  v_mfma_f32_16x16x32_bf16 v[144:147], a[188:191], a[8:11], v[144:147]
  buffer_load_dwordx4 v136, s[24:27], s50 offen offset:3072 lds
  ds_read_b64_tr_b16 a[178:179], v240 offset:4096
  v_mfma_f32_16x16x32_bf16 v[148:151], a[188:191], a[12:15], v[148:151]
  ds_read_b64_tr_b16 a[180:181], v240 offset:8192
  v_mfma_f32_16x16x32_bf16 v[148:151], a[184:187], a[4:7], v[148:151]
  s_waitcnt lgkmcnt(11)
  ds_read_b64_tr_b16 a[182:183], v240 offset:12288
  v_mfma_f32_16x16x32_bf16 v[156:159], a[192:195], a[4:7], v[156:159]
  ds_read_b64_tr_b16 a[184:185], v241 offset:0
  v_mfma_f32_16x16x32_bf16 v[156:159], a[196:199], a[12:15], v[156:159]
  buffer_load_dwordx4 a[92:95], v137, s[36:39], s51 offen offset:3072 sc1
  s_cmp_eq_u32 s87, 1
  v_mfma_f32_16x16x32_bf16 v[152:155], a[196:199], a[8:11], v[152:155]
  s_cselect_b32 s75, 5, 47
  s_lshl_b32 s51, s75, 11
  ds_read_b64_tr_b16 a[186:187], v241 offset:4096
  v_mfma_f32_16x16x32_bf16 v[152:155], a[192:195], a[0:3], v[152:155]
  s_waitcnt lgkmcnt(10)
  ds_read_b64_tr_b16 a[188:189], v241 offset:8192
  ds_read_b64_tr_b16 a[190:191], v241 offset:12288
  v_mfma_f32_16x16x32_bf16 v[160:163], a[200:203], a[0:3], v[160:163]
  ds_read_b64_tr_b16 a[192:193], v242 offset:0
  v_mfma_f32_16x16x32_bf16 v[160:163], a[204:207], a[8:11], v[160:163]
  buffer_load_dwordx4 a[96:99], v137, s[36:39], s51 offen offset:0 sc1
  ds_read_b64_tr_b16 a[194:195], v242 offset:4096
  v_mfma_f32_16x16x32_bf16 v[164:167], a[204:207], a[12:15], v[164:167]
  ds_read_b64_tr_b16 a[196:197], v242 offset:8192
  v_mfma_f32_16x16x32_bf16 v[164:167], a[200:203], a[4:7], v[164:167]
  s_waitcnt lgkmcnt(11)
  ds_read_b64_tr_b16 a[198:199], v242 offset:12288
  v_mfma_f32_16x16x32_bf16 v[172:175], a[208:211], a[4:7], v[172:175]
  ds_read_b64_tr_b16 a[200:201], v243 offset:0
  v_mfma_f32_16x16x32_bf16 v[172:175], a[212:215], a[12:15], v[172:175]
  buffer_load_dwordx4 a[100:103], v137, s[36:39], s51 offen offset:1024 sc1
  s_lshl_b32 s50, s75, 16
  v_mfma_f32_16x16x32_bf16 v[168:171], a[212:215], a[8:11], v[168:171]
  s_add_u32 m0, s70, 81920
  ds_read_b64_tr_b16 a[202:203], v243 offset:4096
  ds_read_b64_tr_b16 a[204:205], v243 offset:8192
  v_mfma_f32_16x16x32_bf16 v[168:171], a[208:211], a[0:3], v[168:171]
  s_waitcnt vmcnt(26) lgkmcnt(11)
  ds_read_b64_tr_b16 a[206:207], v243 offset:12288
  v_mfma_f32_16x16x32_bf16 v[32:35], a[176:179], a[16:19], v[32:35]
  buffer_load_dwordx4 v135, s[24:27], s50 offen offset:2048 lds
  ds_read_b64_tr_b16 a[208:209], v240 offset:2048
  v_mfma_f32_16x16x32_bf16 v[32:35], a[180:183], a[24:27], v[32:35]
  ds_read_b64_tr_b16 a[210:211], v240 offset:6144
  v_mfma_f32_16x16x32_bf16 v[36:39], a[180:183], a[28:31], v[36:39]
  ds_read_b64_tr_b16 a[212:213], v240 offset:10240
  v_mfma_f32_16x16x32_bf16 v[36:39], a[176:179], a[20:23], v[36:39]
  s_waitcnt lgkmcnt(11)
  ds_read_b64_tr_b16 a[214:215], v240 offset:14336
  v_mfma_f32_16x16x32_bf16 v[44:47], a[184:187], a[20:23], v[44:47]
  buffer_load_dwordx4 a[104:107], v137, s[36:39], s51 offen offset:2048 sc1
  ds_read_b64_tr_b16 a[176:177], v241 offset:2048
  v_mfma_f32_16x16x32_bf16 v[44:47], a[188:191], a[28:31], v[44:47]
  ds_read_b64_tr_b16 a[178:179], v241 offset:6144
  v_mfma_f32_16x16x32_bf16 v[40:43], a[188:191], a[24:27], v[40:43]
  ds_read_b64_tr_b16 a[180:181], v241 offset:10240
  v_mfma_f32_16x16x32_bf16 v[40:43], a[184:187], a[16:19], v[40:43]
  s_waitcnt vmcnt(23) lgkmcnt(11)
  s_barrier
  ds_read_b64_tr_b16 a[182:183], v241 offset:14336
  v_mfma_f32_16x16x32_bf16 v[48:51], a[192:195], a[16:19], v[48:51]
  buffer_load_dwordx4 v136, s[24:27], s50 offen offset:3072 lds
  ds_read_b64_tr_b16 a[184:185], v242 offset:2048
  v_mfma_f32_16x16x32_bf16 v[48:51], a[196:199], a[24:27], v[48:51]
  ds_read_b64_tr_b16 a[186:187], v242 offset:6144
  v_mfma_f32_16x16x32_bf16 v[52:55], a[196:199], a[28:31], v[52:55]
  ds_read_b64_tr_b16 a[188:189], v242 offset:10240
  v_mfma_f32_16x16x32_bf16 v[52:55], a[192:195], a[20:23], v[52:55]
  s_waitcnt lgkmcnt(11)
  ds_read_b64_tr_b16 a[190:191], v242 offset:14336
  v_mfma_f32_16x16x32_bf16 v[60:63], a[200:203], a[20:23], v[60:63]
  buffer_load_dwordx4 a[108:111], v137, s[36:39], s51 offen offset:3072 sc1
  s_cmp_eq_u32 s87, 2
  v_mfma_f32_16x16x32_bf16 v[60:63], a[204:207], a[28:31], v[60:63]
  s_cselect_b32 s79, 8, 50
  s_lshl_b32 s51, s79, 11
  ds_read_b64_tr_b16 a[192:193], v243 offset:2048
  v_mfma_f32_16x16x32_bf16 v[56:59], a[204:207], a[24:27], v[56:59]
  ds_read_b64_tr_b16 a[194:195], v243 offset:6144
  ds_read_b64_tr_b16 a[196:197], v243 offset:10240
  v_mfma_f32_16x16x32_bf16 v[56:59], a[200:203], a[16:19], v[56:59]
  s_waitcnt lgkmcnt(11)
  ds_read_b64_tr_b16 a[198:199], v243 offset:14336
  v_mfma_f32_16x16x32_bf16 v[144:147], a[208:211], a[16:19], v[144:147]
  buffer_load_dwordx4 a[112:115], v137, s[36:39], s51 offen offset:0 sc1
  ds_read_b64_tr_b16 a[200:201], v240 offset:18432
  v_mfma_f32_16x16x32_bf16 v[144:147], a[212:215], a[24:27], v[144:147]
  ds_read_b64_tr_b16 a[202:203], v240 offset:22528
  v_mfma_f32_16x16x32_bf16 v[148:151], a[212:215], a[28:31], v[148:151]
  ds_read_b64_tr_b16 a[204:205], v240 offset:26624
  v_mfma_f32_16x16x32_bf16 v[148:151], a[208:211], a[20:23], v[148:151]
  s_waitcnt lgkmcnt(11)
  buffer_load_dwordx4 a[116:119], v137, s[36:39], s51 offen offset:1024 sc1
  s_lshl_b32 s50, s79, 16
  v_mfma_f32_16x16x32_bf16 v[156:159], a[176:179], a[20:23], v[156:159]
  s_add_u32 m0, s70, 98304
  ds_read_b64_tr_b16 a[206:207], v240 offset:30720
  ds_read_b64_tr_b16 a[208:209], v241 offset:18432
  v_mfma_f32_16x16x32_bf16 v[156:159], a[180:183], a[28:31], v[156:159]
  ds_read_b64_tr_b16 a[210:211], v241 offset:22528
  v_mfma_f32_16x16x32_bf16 v[152:155], a[180:183], a[24:27], v[152:155]
  ds_read_b64_tr_b16 a[212:213], v241 offset:26624
  v_mfma_f32_16x16x32_bf16 v[152:155], a[176:179], a[16:19], v[152:155]
  s_waitcnt vmcnt(21) lgkmcnt(11)
  s_barrier
  buffer_load_dwordx4 v135, s[24:27], s50 offen offset:2048 lds
  v_mfma_f32_16x16x32_bf16 v[160:163], a[184:187], a[16:19], v[160:163]
  ds_read_b64_tr_b16 a[214:215], v241 offset:30720
  ds_read_b64_tr_b16 a[176:177], v242 offset:18432
  v_mfma_f32_16x16x32_bf16 v[160:163], a[188:191], a[24:27], v[160:163]
  ds_read_b64_tr_b16 a[178:179], v242 offset:22528
  v_mfma_f32_16x16x32_bf16 v[164:167], a[188:191], a[28:31], v[164:167]
  ds_read_b64_tr_b16 a[180:181], v242 offset:26624
  v_mfma_f32_16x16x32_bf16 v[164:167], a[184:187], a[20:23], v[164:167]
  s_waitcnt lgkmcnt(11)
  buffer_load_dwordx4 a[120:123], v137, s[36:39], s51 offen offset:2048 sc1
  ds_read_b64_tr_b16 a[182:183], v242 offset:30720
  v_mfma_f32_16x16x32_bf16 v[172:175], a[192:195], a[20:23], v[172:175]
  ds_read_b64_tr_b16 a[184:185], v243 offset:18432
  v_mfma_f32_16x16x32_bf16 v[172:175], a[196:199], a[28:31], v[172:175]
  ds_read_b64_tr_b16 a[186:187], v243 offset:22528
  v_mfma_f32_16x16x32_bf16 v[168:171], a[196:199], a[24:27], v[168:171]
  ds_read_b64_tr_b16 a[188:189], v243 offset:26624
  v_mfma_f32_16x16x32_bf16 v[168:171], a[192:195], a[16:19], v[168:171]
  s_waitcnt vmcnt(28) lgkmcnt(11)
  buffer_load_dwordx4 v136, s[24:27], s50 offen offset:3072 lds
  ds_read_b64_tr_b16 a[190:191], v243 offset:30720
  v_mfma_f32_16x16x32_bf16 v[144:147], a[200:203], a[32:35], v[144:147]
  ds_read_b64_tr_b16 a[192:193], v240 offset:34816
  v_mfma_f32_16x16x32_bf16 v[144:147], a[204:207], a[40:43], v[144:147]
  ds_read_b64_tr_b16 a[194:195], v240 offset:38912
  v_mfma_f32_16x16x32_bf16 v[148:151], a[204:207], a[44:47], v[148:151]
  ds_read_b64_tr_b16 a[196:197], v240 offset:43008
  v_mfma_f32_16x16x32_bf16 v[148:151], a[200:203], a[36:39], v[148:151]
  s_waitcnt lgkmcnt(11)
  buffer_load_dwordx4 a[124:127], v137, s[36:39], s51 offen offset:3072 sc1
  s_cmp_eq_u32 s87, 3
  v_mfma_f32_16x16x32_bf16 v[156:159], a[208:211], a[36:39], v[156:159]
  s_cselect_b32 s80, 12, 54
  s_lshl_b32 s51, s80, 11
  ds_read_b64_tr_b16 a[198:199], v240 offset:47104
  v_mfma_f32_16x16x32_bf16 v[156:159], a[212:215], a[44:47], v[156:159]
  ds_read_b64_tr_b16 a[200:201], v241 offset:34816
  ds_read_b64_tr_b16 a[202:203], v241 offset:38912
  v_mfma_f32_16x16x32_bf16 v[152:155], a[212:215], a[40:43], v[152:155]
  buffer_load_dwordx4 a[216:219], v137, s[36:39], s51 offen offset:0 sc1
  ds_read_b64_tr_b16 a[204:205], v241 offset:43008
  v_mfma_f32_16x16x32_bf16 v[152:155], a[208:211], a[32:35], v[152:155]
  s_waitcnt vmcnt(20) lgkmcnt(11)
  s_barrier
  ds_read_b64_tr_b16 a[206:207], v241 offset:47104
  v_mfma_f32_16x16x32_bf16 v[160:163], a[176:179], a[32:35], v[160:163]
  ds_read_b64_tr_b16 a[208:209], v242 offset:34816
  v_mfma_f32_16x16x32_bf16 v[160:163], a[180:183], a[40:43], v[160:163]
  ds_read_b64_tr_b16 a[210:211], v242 offset:38912
  v_mfma_f32_16x16x32_bf16 v[164:167], a[180:183], a[44:47], v[164:167]
  buffer_load_dwordx4 a[220:223], v137, s[36:39], s51 offen offset:1024 sc1
  s_lshl_b32 s50, s80, 16
  v_mfma_f32_16x16x32_bf16 v[164:167], a[176:179], a[36:39], v[164:167]
  s_waitcnt lgkmcnt(10)
  s_add_u32 m0, s70, 114688
  ds_read_b64_tr_b16 a[212:213], v242 offset:43008
  v_mfma_f32_16x16x32_bf16 v[172:175], a[184:187], a[36:39], v[172:175]
  ds_read_b64_tr_b16 a[214:215], v242 offset:47104
  ds_read_b64_tr_b16 a[176:177], v243 offset:34816
  v_mfma_f32_16x16x32_bf16 v[172:175], a[188:191], a[44:47], v[172:175]
  ds_read_b64_tr_b16 a[178:179], v243 offset:38912
  v_mfma_f32_16x16x32_bf16 v[168:171], a[188:191], a[40:43], v[168:171]
  buffer_load_dwordx4 v135, s[24:27], s50 offen offset:2048 lds
  ds_read_b64_tr_b16 a[180:181], v243 offset:43008
  v_mfma_f32_16x16x32_bf16 v[168:171], a[184:187], a[32:35], v[168:171]
  s_waitcnt vmcnt(27) lgkmcnt(11)
  ds_read_b64_tr_b16 a[182:183], v243 offset:47104
  v_mfma_f32_16x16x32_bf16 v[144:147], a[192:195], a[48:51], v[144:147]
  ds_read_b64_tr_b16 a[184:185], v240 offset:51200
  v_mfma_f32_16x16x32_bf16 v[144:147], a[196:199], a[56:59], v[144:147]
  ds_read_b64_tr_b16 a[186:187], v240 offset:55296
  v_mfma_f32_16x16x32_bf16 v[148:151], a[196:199], a[60:63], v[148:151]
  buffer_load_dwordx4 a[224:227], v137, s[36:39], s51 offen offset:2048 sc1
  ds_read_b64_tr_b16 a[188:189], v240 offset:59392
  v_mfma_f32_16x16x32_bf16 v[148:151], a[192:195], a[52:55], v[148:151]
  s_waitcnt lgkmcnt(11)
  ds_read_b64_tr_b16 a[190:191], v240 offset:63488
  v_mfma_f32_16x16x32_bf16 v[156:159], a[200:203], a[52:55], v[156:159]
  ds_read_b64_tr_b16 a[192:193], v241 offset:51200
  v_mfma_f32_16x16x32_bf16 v[156:159], a[204:207], a[60:63], v[156:159]
  ds_read_b64_tr_b16 a[194:195], v241 offset:55296
  v_mfma_f32_16x16x32_bf16 v[152:155], a[204:207], a[56:59], v[152:155]
  buffer_load_dwordx4 v136, s[24:27], s50 offen offset:3072 lds
  ds_read_b64_tr_b16 a[196:197], v241 offset:59392
  v_mfma_f32_16x16x32_bf16 v[152:155], a[200:203], a[48:51], v[152:155]
  s_waitcnt vmcnt(18) lgkmcnt(11)
  s_barrier
  ds_read_b64_tr_b16 a[198:199], v241 offset:63488
  v_mfma_f32_16x16x32_bf16 v[160:163], a[208:211], a[48:51], v[160:163]
  ds_read_b64_tr_b16 a[200:201], v242 offset:51200
  v_mfma_f32_16x16x32_bf16 v[160:163], a[212:215], a[56:59], v[160:163]
  ds_read_b64_tr_b16 a[202:203], v242 offset:55296
  v_mfma_f32_16x16x32_bf16 v[164:167], a[212:215], a[60:63], v[164:167]
  buffer_load_dwordx4 a[228:231], v137, s[36:39], s51 offen offset:3072 sc1
  s_lshl_b32 s50, s71, 16
  v_mfma_f32_16x16x32_bf16 v[164:167], a[208:211], a[52:55], v[164:167]
  s_waitcnt lgkmcnt(10)
  s_add_u32 m0, s70, 16384
  ds_read_b64_tr_b16 a[204:205], v242 offset:59392
  v_mfma_f32_16x16x32_bf16 v[172:175], a[176:179], a[52:55], v[172:175]
  ds_read_b64_tr_b16 a[206:207], v242 offset:63488
  ds_read_b64_tr_b16 a[208:209], v243 offset:51200
  v_mfma_f32_16x16x32_bf16 v[172:175], a[180:183], a[60:63], v[172:175]
  ds_read_b64_tr_b16 a[210:211], v243 offset:55296
  v_mfma_f32_16x16x32_bf16 v[168:171], a[180:183], a[56:59], v[168:171]
  buffer_load_dwordx4 v133, s[24:27], s50 offen offset:0 lds
  ds_read_b64_tr_b16 a[212:213], v243 offset:59392
  v_mfma_f32_16x16x32_bf16 v[168:171], a[176:179], a[48:51], v[168:171]
  s_waitcnt vmcnt(25) lgkmcnt(11)
  ds_read_b64_tr_b16 a[214:215], v243 offset:63488
  v_mfma_f32_16x16x32_bf16 v[144:147], a[184:187], a[64:67], v[144:147]
  ds_read_b64_tr_b16 a[176:177], v244 offset:2048
  v_mfma_f32_16x16x32_bf16 v[144:147], a[188:191], a[72:75], v[144:147]
  ds_read_b64_tr_b16 a[178:179], v244 offset:6144
  v_mfma_f32_16x16x32_bf16 v[148:151], a[188:191], a[76:79], v[148:151]
  buffer_load_dwordx4 v134, s[24:27], s50 offen offset:1024 lds
  s_lshl_b32 s50, s72, 16
  v_mfma_f32_16x16x32_bf16 v[148:151], a[184:187], a[68:71], v[148:151]
  s_waitcnt lgkmcnt(10)
  s_add_u32 m0, s70, 32768
  ds_read_b64_tr_b16 a[180:181], v244 offset:10240
  v_mfma_f32_16x16x32_bf16 v[156:159], a[192:195], a[68:71], v[156:159]
  ds_read_b64_tr_b16 a[182:183], v244 offset:14336
  ds_read_b64_tr_b16 a[184:185], v245 offset:2048
  v_mfma_f32_16x16x32_bf16 v[156:159], a[196:199], a[76:79], v[156:159]
  ds_read_b64_tr_b16 a[186:187], v245 offset:6144
  v_mfma_f32_16x16x32_bf16 v[152:155], a[196:199], a[72:75], v[152:155]
  buffer_load_dwordx4 v133, s[24:27], s50 offen offset:0 lds
  ds_read_b64_tr_b16 a[188:189], v245 offset:10240
  v_mfma_f32_16x16x32_bf16 v[152:155], a[192:195], a[64:67], v[152:155]
  s_waitcnt vmcnt(16) lgkmcnt(11)
  s_barrier
  ds_read_b64_tr_b16 a[190:191], v245 offset:14336
  v_mfma_f32_16x16x32_bf16 v[160:163], a[200:203], a[64:67], v[160:163]
  ds_read_b64_tr_b16 a[192:193], v246 offset:2048
  v_mfma_f32_16x16x32_bf16 v[160:163], a[204:207], a[72:75], v[160:163]
  ds_read_b64_tr_b16 a[194:195], v246 offset:6144
  v_mfma_f32_16x16x32_bf16 v[164:167], a[204:207], a[76:79], v[164:167]
  buffer_load_dwordx4 v134, s[24:27], s50 offen offset:1024 lds
  s_lshl_b32 s50, s73, 16
  v_mfma_f32_16x16x32_bf16 v[164:167], a[200:203], a[68:71], v[164:167]
  s_waitcnt lgkmcnt(10)
  s_add_u32 m0, s70, 49152
  ds_read_b64_tr_b16 a[196:197], v246 offset:10240
  v_mfma_f32_16x16x32_bf16 v[172:175], a[208:211], a[68:71], v[172:175]
  ds_read_b64_tr_b16 a[198:199], v246 offset:14336
  ds_read_b64_tr_b16 a[200:201], v247 offset:2048
  v_mfma_f32_16x16x32_bf16 v[172:175], a[212:215], a[76:79], v[172:175]
  ds_read_b64_tr_b16 a[202:203], v247 offset:6144
  v_mfma_f32_16x16x32_bf16 v[168:171], a[212:215], a[72:75], v[168:171]
Hb2_3:
  s_cbranch_execz Rb
  buffer_load_dwordx4 v133, s[24:27], s50 offen offset:0 lds
  ds_read_b64_tr_b16 a[204:205], v247 offset:10240
  v_mfma_f32_16x16x32_bf16 v[168:171], a[208:211], a[64:67], v[168:171]
  s_waitcnt vmcnt(23) lgkmcnt(11)
  ds_read_b64_tr_b16 a[206:207], v247 offset:14336
  v_mfma_f32_16x16x32_bf16 v[144:147], a[176:179], a[80:83], v[144:147]
  ds_read_b64_tr_b16 a[208:209], v244 offset:18432
  v_mfma_f32_16x16x32_bf16 v[144:147], a[180:183], a[88:91], v[144:147]
  ds_read_b64_tr_b16 a[210:211], v244 offset:22528
  v_mfma_f32_16x16x32_bf16 v[148:151], a[180:183], a[92:95], v[148:151]
  buffer_load_dwordx4 v134, s[24:27], s50 offen offset:1024 lds
  s_lshl_b32 s50, s74, 16
  v_mfma_f32_16x16x32_bf16 v[148:151], a[176:179], a[84:87], v[148:151]
  s_waitcnt lgkmcnt(10)
  s_add_u32 m0, s70, 65536
  ds_read_b64_tr_b16 a[212:213], v244 offset:26624
  v_mfma_f32_16x16x32_bf16 v[156:159], a[184:187], a[84:87], v[156:159]
  ds_read_b64_tr_b16 a[214:215], v244 offset:30720
  ds_read_b64_tr_b16 a[176:177], v245 offset:18432
  v_mfma_f32_16x16x32_bf16 v[156:159], a[188:191], a[92:95], v[156:159]
  ds_read_b64_tr_b16 a[178:179], v245 offset:22528
  v_mfma_f32_16x16x32_bf16 v[152:155], a[188:191], a[88:91], v[152:155]
  buffer_load_dwordx4 v133, s[24:27], s50 offen offset:0 lds
  ds_read_b64_tr_b16 a[180:181], v245 offset:26624
  v_mfma_f32_16x16x32_bf16 v[152:155], a[184:187], a[80:83], v[152:155]
  s_waitcnt vmcnt(14) lgkmcnt(11)
  s_barrier
  ds_read_b64_tr_b16 a[182:183], v245 offset:30720
  v_mfma_f32_16x16x32_bf16 v[160:163], a[192:195], a[80:83], v[160:163]
  ds_read_b64_tr_b16 a[184:185], v246 offset:18432
  v_mfma_f32_16x16x32_bf16 v[160:163], a[196:199], a[88:91], v[160:163]
  ds_read_b64_tr_b16 a[186:187], v246 offset:22528
  v_mfma_f32_16x16x32_bf16 v[164:167], a[196:199], a[92:95], v[164:167]
  buffer_load_dwordx4 v134, s[24:27], s50 offen offset:1024 lds
  s_lshl_b32 s50, s75, 16
  v_mfma_f32_16x16x32_bf16 v[164:167], a[192:195], a[84:87], v[164:167]
  s_waitcnt lgkmcnt(10)
  s_add_u32 m0, s70, 81920
  ds_read_b64_tr_b16 a[188:189], v246 offset:26624
  v_mfma_f32_16x16x32_bf16 v[172:175], a[200:203], a[84:87], v[172:175]
  ds_read_b64_tr_b16 a[190:191], v246 offset:30720
  ds_read_b64_tr_b16 a[192:193], v247 offset:18432
  v_mfma_f32_16x16x32_bf16 v[172:175], a[204:207], a[92:95], v[172:175]
  ds_read_b64_tr_b16 a[194:195], v247 offset:22528
  v_mfma_f32_16x16x32_bf16 v[168:171], a[204:207], a[88:91], v[168:171]
  buffer_load_dwordx4 v133, s[24:27], s50 offen offset:0 lds
  ds_read_b64_tr_b16 a[196:197], v247 offset:26624
  v_mfma_f32_16x16x32_bf16 v[168:171], a[200:203], a[80:83], v[168:171]
  s_waitcnt vmcnt(21) lgkmcnt(11)
  ds_read_b64_tr_b16 a[198:199], v247 offset:30720
  v_mfma_f32_16x16x32_bf16 v[144:147], a[208:211], a[96:99], v[144:147]
  ds_read_b64_tr_b16 a[200:201], v244 offset:34816
  v_mfma_f32_16x16x32_bf16 v[144:147], a[212:215], a[104:107], v[144:147]
  ds_read_b64_tr_b16 a[202:203], v244 offset:38912
  v_mfma_f32_16x16x32_bf16 v[148:151], a[212:215], a[108:111], v[148:151]
  buffer_load_dwordx4 v134, s[24:27], s50 offen offset:1024 lds
  s_lshl_b32 s50, s79, 16
  v_mfma_f32_16x16x32_bf16 v[148:151], a[208:211], a[100:103], v[148:151]
  s_waitcnt lgkmcnt(10)
  s_add_u32 m0, s70, 98304
  ds_read_b64_tr_b16 a[204:205], v244 offset:43008
  v_mfma_f32_16x16x32_bf16 v[156:159], a[176:179], a[100:103], v[156:159]
  ds_read_b64_tr_b16 a[206:207], v244 offset:47104
  ds_read_b64_tr_b16 a[208:209], v245 offset:34816
  v_mfma_f32_16x16x32_bf16 v[156:159], a[180:183], a[108:111], v[156:159]
  ds_read_b64_tr_b16 a[210:211], v245 offset:38912
  v_mfma_f32_16x16x32_bf16 v[152:155], a[180:183], a[104:107], v[152:155]
  buffer_load_dwordx4 v133, s[24:27], s50 offen offset:0 lds
  ds_read_b64_tr_b16 a[212:213], v245 offset:43008
  v_mfma_f32_16x16x32_bf16 v[152:155], a[176:179], a[96:99], v[152:155]
  s_waitcnt vmcnt(12) lgkmcnt(11)
  s_barrier
  ds_read_b64_tr_b16 a[214:215], v245 offset:47104
  v_mfma_f32_16x16x32_bf16 v[160:163], a[184:187], a[96:99], v[160:163]
  ds_read_b64_tr_b16 a[176:177], v246 offset:34816
  v_mfma_f32_16x16x32_bf16 v[160:163], a[188:191], a[104:107], v[160:163]
  ds_read_b64_tr_b16 a[178:179], v246 offset:38912
  v_mfma_f32_16x16x32_bf16 v[164:167], a[188:191], a[108:111], v[164:167]
  buffer_load_dwordx4 v134, s[24:27], s50 offen offset:1024 lds
  s_lshl_b32 s50, s80, 16
  v_mfma_f32_16x16x32_bf16 v[164:167], a[184:187], a[100:103], v[164:167]
  s_waitcnt lgkmcnt(10)
  s_add_u32 m0, s70, 114688
  ds_read_b64_tr_b16 a[180:181], v246 offset:43008
  v_mfma_f32_16x16x32_bf16 v[172:175], a[192:195], a[100:103], v[172:175]
  ds_read_b64_tr_b16 a[182:183], v246 offset:47104
  ds_read_b64_tr_b16 a[184:185], v247 offset:34816
  v_mfma_f32_16x16x32_bf16 v[172:175], a[196:199], a[108:111], v[172:175]
  ds_read_b64_tr_b16 a[186:187], v247 offset:38912
  v_mfma_f32_16x16x32_bf16 v[168:171], a[196:199], a[104:107], v[168:171]
  buffer_load_dwordx4 v133, s[24:27], s50 offen offset:0 lds
  ds_read_b64_tr_b16 a[188:189], v247 offset:43008
  v_mfma_f32_16x16x32_bf16 v[168:171], a[192:195], a[96:99], v[168:171]
  s_waitcnt vmcnt(19) lgkmcnt(11)
  ds_read_b64_tr_b16 a[190:191], v247 offset:47104
  v_mfma_f32_16x16x32_bf16 v[144:147], a[200:203], a[112:115], v[144:147]
  ds_read_b64_tr_b16 a[192:193], v244 offset:51200
  v_mfma_f32_16x16x32_bf16 v[144:147], a[204:207], a[120:123], v[144:147]
  ds_read_b64_tr_b16 a[194:195], v244 offset:55296
  v_mfma_f32_16x16x32_bf16 v[148:151], a[204:207], a[124:127], v[148:151]
  buffer_load_dwordx4 v134, s[24:27], s50 offen offset:1024 lds
  ds_read_b64_tr_b16 a[196:197], v244 offset:59392
  v_mfma_f32_16x16x32_bf16 v[148:151], a[200:203], a[116:119], v[148:151]
  s_waitcnt lgkmcnt(11)
  ds_read_b64_tr_b16 a[198:199], v244 offset:63488
  v_mfma_f32_16x16x32_bf16 v[156:159], a[208:211], a[116:119], v[156:159]
  ds_read_b64_tr_b16 a[200:201], v245 offset:51200
  v_mfma_f32_16x16x32_bf16 v[156:159], a[212:215], a[124:127], v[156:159]
  ds_read_b64_tr_b16 a[202:203], v245 offset:55296
  v_mfma_f32_16x16x32_bf16 v[152:155], a[212:215], a[120:123], v[152:155]
  ds_read_b64_tr_b16 a[204:205], v245 offset:59392
  v_mfma_f32_16x16x32_bf16 v[152:155], a[208:211], a[112:115], v[152:155]
  s_waitcnt vmcnt(12) lgkmcnt(11)
  s_barrier
  ds_read_b64_tr_b16 a[206:207], v245 offset:63488
  v_mfma_f32_16x16x32_bf16 v[160:163], a[176:179], a[112:115], v[160:163]
  ds_read_b64_tr_b16 a[208:209], v246 offset:51200
  v_mfma_f32_16x16x32_bf16 v[160:163], a[180:183], a[120:123], v[160:163]
  ds_read_b64_tr_b16 a[210:211], v246 offset:55296
  v_mfma_f32_16x16x32_bf16 v[164:167], a[180:183], a[124:127], v[164:167]
  ds_read_b64_tr_b16 a[212:213], v246 offset:59392
  v_mfma_f32_16x16x32_bf16 v[164:167], a[176:179], a[116:119], v[164:167]
  s_waitcnt lgkmcnt(11)
  ds_read_b64_tr_b16 a[214:215], v246 offset:63488
  v_mfma_f32_16x16x32_bf16 v[172:175], a[184:187], a[116:119], v[172:175]
  ds_read_b64_tr_b16 a[176:177], v247 offset:51200
  v_mfma_f32_16x16x32_bf16 v[172:175], a[188:191], a[124:127], v[172:175]
  ds_read_b64_tr_b16 a[178:179], v247 offset:55296
  v_mfma_f32_16x16x32_bf16 v[168:171], a[188:191], a[120:123], v[168:171]
  ds_read_b64_tr_b16 a[180:181], v247 offset:59392
  v_mfma_f32_16x16x32_bf16 v[168:171], a[184:187], a[112:115], v[168:171]
  s_waitcnt vmcnt(14) lgkmcnt(11)
  ds_read_b64_tr_b16 a[182:183], v247 offset:63488
  v_mfma_f32_16x16x32_bf16 v[144:147], a[192:195], a[216:219], v[144:147]
  ds_read_b64_tr_b16 a[184:185], v240 offset:16384
  v_mfma_f32_16x16x32_bf16 v[144:147], a[196:199], a[224:227], v[144:147]
  ds_read_b64_tr_b16 a[186:187], v240 offset:20480
  v_mfma_f32_16x16x32_bf16 v[148:151], a[196:199], a[228:231], v[148:151]
  ds_read_b64_tr_b16 a[188:189], v240 offset:24576
  v_mfma_f32_16x16x32_bf16 v[148:151], a[192:195], a[220:223], v[148:151]
  s_waitcnt lgkmcnt(11)
  ds_read_b64_tr_b16 a[190:191], v240 offset:28672
  v_mfma_f32_16x16x32_bf16 v[156:159], a[200:203], a[220:223], v[156:159]
  ds_read_b64_tr_b16 a[192:193], v241 offset:16384
  v_mfma_f32_16x16x32_bf16 v[156:159], a[204:207], a[228:231], v[156:159]
  ds_read_b64_tr_b16 a[194:195], v241 offset:20480
  v_mfma_f32_16x16x32_bf16 v[152:155], a[204:207], a[224:227], v[152:155]
  ds_read_b64_tr_b16 a[196:197], v241 offset:24576
  v_mfma_f32_16x16x32_bf16 v[152:155], a[200:203], a[216:219], v[152:155]
  s_waitcnt vmcnt(10) lgkmcnt(11)
  s_barrier
  ds_read_b64_tr_b16 a[198:199], v241 offset:28672
  v_mfma_f32_16x16x32_bf16 v[160:163], a[208:211], a[216:219], v[160:163]
  ds_read_b64_tr_b16 a[200:201], v242 offset:16384
  buffer_store_dwordx4 v[144:147], v0, s[36:39], s61 offen offset:0 sc1
  v_mfma_f32_16x16x32_bf16 v[160:163], a[212:215], a[224:227], v[160:163]
  buffer_store_dwordx4 v[148:151], v0, s[36:39], s61 offen offset:1024 sc1
  ds_read_b64_tr_b16 a[202:203], v242 offset:20480
  v_mfma_f32_16x16x32_bf16 v[164:167], a[212:215], a[228:231], v[164:167]
  ds_read_b64_tr_b16 a[204:205], v242 offset:24576
  v_mfma_f32_16x16x32_bf16 v[164:167], a[208:211], a[220:223], v[164:167]
  s_waitcnt lgkmcnt(11)
  ds_read_b64_tr_b16 a[206:207], v242 offset:28672
  v_mfma_f32_16x16x32_bf16 v[172:175], a[176:179], a[220:223], v[172:175]
  ds_read_b64_tr_b16 a[208:209], v243 offset:16384
  buffer_store_dwordx4 v[152:155], v0, s[36:39], s61 offen offset:2048 sc1
  v_mfma_f32_16x16x32_bf16 v[172:175], a[180:183], a[228:231], v[172:175]
  buffer_store_dwordx4 v[156:159], v0, s[36:39], s61 offen offset:3072 sc1
  ds_read_b64_tr_b16 a[210:211], v243 offset:20480
  v_mfma_f32_16x16x32_bf16 v[168:171], a[180:183], a[224:227], v[168:171]
  ds_read_b64_tr_b16 a[212:213], v243 offset:24576
  v_mfma_f32_16x16x32_bf16 v[168:171], a[176:179], a[216:219], v[168:171]
  s_waitcnt lgkmcnt(11)
  ds_read_b64_tr_b16 a[214:215], v243 offset:28672
  v_mfma_f32_16x16x32_bf16 v[32:35], a[184:187], a[32:35], v[32:35]
  ds_read_b64_tr_b16 a[176:177], v240 offset:32768
  buffer_store_dwordx4 v[160:163], v0, s[36:39], s62 offen offset:0 sc1
  v_mfma_f32_16x16x32_bf16 v[32:35], a[188:191], a[40:43], v[32:35]
  buffer_store_dwordx4 v[164:167], v0, s[36:39], s62 offen offset:1024 sc1
  ds_read_b64_tr_b16 a[178:179], v240 offset:36864
  v_mfma_f32_16x16x32_bf16 v[36:39], a[188:191], a[44:47], v[36:39]
  ds_read_b64_tr_b16 a[180:181], v240 offset:40960
  v_mfma_f32_16x16x32_bf16 v[36:39], a[184:187], a[36:39], v[36:39]
  s_waitcnt lgkmcnt(11)
  ds_read_b64_tr_b16 a[182:183], v240 offset:45056
  v_mfma_f32_16x16x32_bf16 v[44:47], a[192:195], a[36:39], v[44:47]
  ds_read_b64_tr_b16 a[184:185], v241 offset:32768
  buffer_store_dwordx4 v[168:171], v0, s[36:39], s62 offen offset:2048 sc1
  v_mfma_f32_16x16x32_bf16 v[44:47], a[196:199], a[44:47], v[44:47]
  buffer_store_dwordx4 v[172:175], v0, s[36:39], s62 offen offset:3072 sc1
  ds_read_b64_tr_b16 a[186:187], v241 offset:36864
  v_mfma_f32_16x16x32_bf16 v[40:43], a[196:199], a[40:43], v[40:43]
  ds_read_b64_tr_b16 a[188:189], v241 offset:40960
  v_mfma_f32_16x16x32_bf16 v[40:43], a[192:195], a[32:35], v[40:43]
  s_waitcnt vmcnt(16) lgkmcnt(11)
  s_barrier
  ds_read_b64_tr_b16 a[190:191], v241 offset:45056
  v_mfma_f32_16x16x32_bf16 v[48:51], a[200:203], a[32:35], v[48:51]
  ds_read_b64_tr_b16 a[192:193], v242 offset:32768
  v_mfma_f32_16x16x32_bf16 v[48:51], a[204:207], a[40:43], v[48:51]
  ds_read_b64_tr_b16 a[194:195], v242 offset:36864
  v_mfma_f32_16x16x32_bf16 v[52:55], a[204:207], a[44:47], v[52:55]
  ds_read_b64_tr_b16 a[196:197], v242 offset:40960
  v_mfma_f32_16x16x32_bf16 v[52:55], a[200:203], a[36:39], v[52:55]
  s_waitcnt lgkmcnt(11)
  ds_read_b64_tr_b16 a[198:199], v242 offset:45056
  v_mfma_f32_16x16x32_bf16 v[60:63], a[208:211], a[36:39], v[60:63]
  ds_read_b64_tr_b16 a[200:201], v243 offset:32768
  v_mfma_f32_16x16x32_bf16 v[60:63], a[212:215], a[44:47], v[60:63]
  ds_read_b64_tr_b16 a[202:203], v243 offset:36864
  v_mfma_f32_16x16x32_bf16 v[56:59], a[212:215], a[40:43], v[56:59]
  ds_read_b64_tr_b16 a[204:205], v243 offset:40960
  v_mfma_f32_16x16x32_bf16 v[56:59], a[208:211], a[32:35], v[56:59]
  s_waitcnt lgkmcnt(11)
  ds_read_b64_tr_b16 a[206:207], v243 offset:45056
  v_mfma_f32_16x16x32_bf16 v[32:35], a[176:179], a[48:51], v[32:35]
  ds_read_b64_tr_b16 a[208:209], v240 offset:49152
  v_mfma_f32_16x16x32_bf16 v[32:35], a[180:183], a[56:59], v[32:35]
  ds_read_b64_tr_b16 a[210:211], v240 offset:53248
  v_mfma_f32_16x16x32_bf16 v[36:39], a[180:183], a[60:63], v[36:39]
  ds_read_b64_tr_b16 a[212:213], v240 offset:57344
  v_mfma_f32_16x16x32_bf16 v[36:39], a[176:179], a[52:55], v[36:39]
  s_waitcnt lgkmcnt(11)
  ds_read_b64_tr_b16 a[214:215], v240 offset:61440
  v_mfma_f32_16x16x32_bf16 v[44:47], a[184:187], a[52:55], v[44:47]
  ds_read_b64_tr_b16 a[176:177], v241 offset:49152
  v_mfma_f32_16x16x32_bf16 v[44:47], a[188:191], a[60:63], v[44:47]
  ds_read_b64_tr_b16 a[178:179], v241 offset:53248
  v_mfma_f32_16x16x32_bf16 v[40:43], a[188:191], a[56:59], v[40:43]
  ds_read_b64_tr_b16 a[180:181], v241 offset:57344
  v_mfma_f32_16x16x32_bf16 v[40:43], a[184:187], a[48:51], v[40:43]
  s_waitcnt vmcnt(14) lgkmcnt(11)
  s_barrier
  ds_read_b64_tr_b16 a[182:183], v241 offset:61440
  v_mfma_f32_16x16x32_bf16 v[48:51], a[192:195], a[48:51], v[48:51]
  ds_read_b64_tr_b16 a[184:185], v242 offset:49152
  v_mfma_f32_16x16x32_bf16 v[48:51], a[196:199], a[56:59], v[48:51]
  ds_read_b64_tr_b16 a[186:187], v242 offset:53248
  v_mfma_f32_16x16x32_bf16 v[52:55], a[196:199], a[60:63], v[52:55]
  ds_read_b64_tr_b16 a[188:189], v242 offset:57344
  v_mfma_f32_16x16x32_bf16 v[52:55], a[192:195], a[52:55], v[52:55]
  s_waitcnt lgkmcnt(11)
  ds_read_b64_tr_b16 a[190:191], v242 offset:61440
  v_mfma_f32_16x16x32_bf16 v[60:63], a[200:203], a[52:55], v[60:63]
  ds_read_b64_tr_b16 a[192:193], v243 offset:49152
  v_mfma_f32_16x16x32_bf16 v[60:63], a[204:207], a[60:63], v[60:63]
  ds_read_b64_tr_b16 a[194:195], v243 offset:53248
  v_mfma_f32_16x16x32_bf16 v[56:59], a[204:207], a[56:59], v[56:59]
  ds_read_b64_tr_b16 a[196:197], v243 offset:57344
  v_mfma_f32_16x16x32_bf16 v[56:59], a[200:203], a[48:51], v[56:59]
  s_waitcnt lgkmcnt(11)
  ds_read_b64_tr_b16 a[198:199], v243 offset:61440
  v_mfma_f32_16x16x32_bf16 v[32:35], a[208:211], a[64:67], v[32:35]
  ds_read_b64_tr_b16 a[200:201], v244 offset:0
  v_mfma_f32_16x16x32_bf16 v[32:35], a[212:215], a[72:75], v[32:35]
  ds_read_b64_tr_b16 a[202:203], v244 offset:4096
  v_mfma_f32_16x16x32_bf16 v[36:39], a[212:215], a[76:79], v[36:39]
  ds_read_b64_tr_b16 a[204:205], v244 offset:8192
  v_mfma_f32_16x16x32_bf16 v[36:39], a[208:211], a[68:71], v[36:39]
  s_waitcnt lgkmcnt(11)
  ds_read_b64_tr_b16 a[206:207], v244 offset:12288
  v_mfma_f32_16x16x32_bf16 v[44:47], a[176:179], a[68:71], v[44:47]
  ds_read_b64_tr_b16 a[208:209], v245 offset:0
  v_mfma_f32_16x16x32_bf16 v[44:47], a[180:183], a[76:79], v[44:47]
  ds_read_b64_tr_b16 a[210:211], v245 offset:4096
  v_mfma_f32_16x16x32_bf16 v[40:43], a[180:183], a[72:75], v[40:43]
  ds_read_b64_tr_b16 a[212:213], v245 offset:8192
  v_mfma_f32_16x16x32_bf16 v[40:43], a[176:179], a[64:67], v[40:43]
  s_waitcnt vmcnt(12) lgkmcnt(11)
  s_barrier
  ds_read_b64_tr_b16 a[214:215], v245 offset:12288
  v_mfma_f32_16x16x32_bf16 v[48:51], a[184:187], a[64:67], v[48:51]
  ds_read_b64_tr_b16 a[176:177], v246 offset:0
  v_mfma_f32_16x16x32_bf16 v[48:51], a[188:191], a[72:75], v[48:51]
  ds_read_b64_tr_b16 a[178:179], v246 offset:4096
  v_mfma_f32_16x16x32_bf16 v[52:55], a[188:191], a[76:79], v[52:55]
  ds_read_b64_tr_b16 a[180:181], v246 offset:8192
  v_mfma_f32_16x16x32_bf16 v[52:55], a[184:187], a[68:71], v[52:55]
  s_waitcnt lgkmcnt(11)
  ds_read_b64_tr_b16 a[182:183], v246 offset:12288
  v_mfma_f32_16x16x32_bf16 v[60:63], a[192:195], a[68:71], v[60:63]
  ds_read_b64_tr_b16 a[184:185], v247 offset:0
  v_mfma_f32_16x16x32_bf16 v[60:63], a[196:199], a[76:79], v[60:63]
  ds_read_b64_tr_b16 a[186:187], v247 offset:4096
  v_mfma_f32_16x16x32_bf16 v[56:59], a[196:199], a[72:75], v[56:59]
  ds_read_b64_tr_b16 a[188:189], v247 offset:8192
  v_mfma_f32_16x16x32_bf16 v[56:59], a[192:195], a[64:67], v[56:59]
  s_waitcnt lgkmcnt(11)
  ds_read_b64_tr_b16 a[190:191], v247 offset:12288
  v_mfma_f32_16x16x32_bf16 v[32:35], a[200:203], a[80:83], v[32:35]
  s_waitcnt vmcnt(0)
  ds_read_b64_tr_b16 a[192:193], v244 offset:16384
  s_mov_b64 exec, 1
  buffer_store_dword v254, v0, s[36:39], s76 offen sc1
  s_mov_b64 exec, -1
  v_mfma_f32_16x16x32_bf16 v[32:35], a[204:207], a[88:91], v[32:35]
  ds_read_b64_tr_b16 a[194:195], v244 offset:20480
  v_mfma_f32_16x16x32_bf16 v[36:39], a[204:207], a[92:95], v[36:39]
  ds_read_b64_tr_b16 a[196:197], v244 offset:24576
  v_mfma_f32_16x16x32_bf16 v[36:39], a[200:203], a[84:87], v[36:39]
  s_waitcnt lgkmcnt(11)
  ds_read_b64_tr_b16 a[198:199], v244 offset:28672
  v_mfma_f32_16x16x32_bf16 v[44:47], a[208:211], a[84:87], v[44:47]
  ds_read_b64_tr_b16 a[200:201], v245 offset:16384
  buffer_load_dword v139, v132, s[36:39], s77 offen sc1
  v_mfma_f32_16x16x32_bf16 v[44:47], a[212:215], a[92:95], v[44:47]
  ds_read_b64_tr_b16 a[202:203], v245 offset:20480
  v_mfma_f32_16x16x32_bf16 v[40:43], a[212:215], a[88:91], v[40:43]
  ds_read_b64_tr_b16 a[204:205], v245 offset:24576
  v_mfma_f32_16x16x32_bf16 v[40:43], a[208:211], a[80:83], v[40:43]
  s_waitcnt vmcnt(12) lgkmcnt(11)
  s_barrier
  ds_read_b64_tr_b16 a[206:207], v245 offset:28672
  v_mfma_f32_16x16x32_bf16 v[48:51], a[176:179], a[80:83], v[48:51]
  ds_read_b64_tr_b16 a[208:209], v246 offset:16384
  v_mfma_f32_16x16x32_bf16 v[48:51], a[180:183], a[88:91], v[48:51]
  ds_read_b64_tr_b16 a[210:211], v246 offset:20480
  v_mfma_f32_16x16x32_bf16 v[52:55], a[180:183], a[92:95], v[52:55]
  ds_read_b64_tr_b16 a[212:213], v246 offset:24576
  v_mfma_f32_16x16x32_bf16 v[52:55], a[176:179], a[84:87], v[52:55]
  s_waitcnt lgkmcnt(11)
  ds_read_b64_tr_b16 a[214:215], v246 offset:28672
  v_mfma_f32_16x16x32_bf16 v[60:63], a[184:187], a[84:87], v[60:63]
  ds_read_b64_tr_b16 a[176:177], v247 offset:16384
  v_mfma_f32_16x16x32_bf16 v[60:63], a[188:191], a[92:95], v[60:63]
  ds_read_b64_tr_b16 a[178:179], v247 offset:20480
  v_mfma_f32_16x16x32_bf16 v[56:59], a[188:191], a[88:91], v[56:59]
  ds_read_b64_tr_b16 a[180:181], v247 offset:24576
  v_mfma_f32_16x16x32_bf16 v[56:59], a[184:187], a[80:83], v[56:59]
  s_waitcnt lgkmcnt(11)
  ds_read_b64_tr_b16 a[182:183], v247 offset:28672
  v_mfma_f32_16x16x32_bf16 v[32:35], a[192:195], a[96:99], v[32:35]
  ds_read_b64_tr_b16 a[184:185], v244 offset:32768
  v_mfma_f32_16x16x32_bf16 v[32:35], a[196:199], a[104:107], v[32:35]
  ds_read_b64_tr_b16 a[186:187], v244 offset:36864
  v_mfma_f32_16x16x32_bf16 v[36:39], a[196:199], a[108:111], v[36:39]
  ds_read_b64_tr_b16 a[188:189], v244 offset:40960
  v_mfma_f32_16x16x32_bf16 v[36:39], a[192:195], a[100:103], v[36:39]
  s_waitcnt lgkmcnt(11)
  ds_read_b64_tr_b16 a[190:191], v244 offset:45056
  v_mfma_f32_16x16x32_bf16 v[44:47], a[200:203], a[100:103], v[44:47]
  ds_read_b64_tr_b16 a[192:193], v245 offset:32768
  v_mfma_f32_16x16x32_bf16 v[44:47], a[204:207], a[108:111], v[44:47]
  ds_read_b64_tr_b16 a[194:195], v245 offset:36864
  v_mfma_f32_16x16x32_bf16 v[40:43], a[204:207], a[104:107], v[40:43]
  ds_read_b64_tr_b16 a[196:197], v245 offset:40960
  v_mfma_f32_16x16x32_bf16 v[40:43], a[200:203], a[96:99], v[40:43]
  s_waitcnt vmcnt(10) lgkmcnt(11)
  s_barrier
  ds_read_b64_tr_b16 a[198:199], v245 offset:45056
  v_mfma_f32_16x16x32_bf16 v[48:51], a[208:211], a[96:99], v[48:51]
  ds_read_b64_tr_b16 a[200:201], v246 offset:32768
  v_mfma_f32_16x16x32_bf16 v[48:51], a[212:215], a[104:107], v[48:51]
  ds_read_b64_tr_b16 a[202:203], v246 offset:36864
  v_mfma_f32_16x16x32_bf16 v[52:55], a[212:215], a[108:111], v[52:55]
  ds_read_b64_tr_b16 a[204:205], v246 offset:40960
  v_mfma_f32_16x16x32_bf16 v[52:55], a[208:211], a[100:103], v[52:55]
  s_waitcnt lgkmcnt(11)
  ds_read_b64_tr_b16 a[206:207], v246 offset:45056
  v_mfma_f32_16x16x32_bf16 v[60:63], a[176:179], a[100:103], v[60:63]
  ds_read_b64_tr_b16 a[208:209], v247 offset:32768
  v_mfma_f32_16x16x32_bf16 v[60:63], a[180:183], a[108:111], v[60:63]
  ds_read_b64_tr_b16 a[210:211], v247 offset:36864
  v_mfma_f32_16x16x32_bf16 v[56:59], a[180:183], a[104:107], v[56:59]
  s_waitcnt vmcnt(0)
  ds_read_b64_tr_b16 a[212:213], v247 offset:40960
  v_readfirstlane_b32 s78, v139
  v_mfma_f32_16x16x32_bf16 v[56:59], a[176:179], a[96:99], v[56:59]
  s_waitcnt lgkmcnt(11)
  ds_read_b64_tr_b16 a[214:215], v247 offset:45056
  s_nop 0
  v_mfma_f32_16x16x32_bf16 v[32:35], a[184:187], a[112:115], v[32:35]
  s_cmp_eq_u32 s78, s3
  ds_read_b64_tr_b16 a[176:177], v244 offset:49152
  s_cselect_b32 s89, s63, 1073741824
  v_mfma_f32_16x16x32_bf16 v[32:35], a[188:191], a[120:123], v[32:35]
  s_cselect_b32 s90, s64, 1073741824
  ds_read_b64_tr_b16 a[178:179], v244 offset:53248
  buffer_load_dwordx4 v[96:99], v0, s[36:39], s89 offen offset:0 sc1
  v_mfma_f32_16x16x32_bf16 v[36:39], a[188:191], a[124:127], v[36:39]
  ds_read_b64_tr_b16 a[180:181], v244 offset:57344
  v_mfma_f32_16x16x32_bf16 v[36:39], a[184:187], a[116:119], v[36:39]
  s_waitcnt lgkmcnt(11)
  ds_read_b64_tr_b16 a[182:183], v244 offset:61440
  v_mfma_f32_16x16x32_bf16 v[44:47], a[192:195], a[116:119], v[44:47]
  ds_read_b64_tr_b16 a[184:185], v245 offset:49152
  buffer_load_dwordx4 v[100:103], v0, s[36:39], s89 offen offset:1024 sc1
  v_mfma_f32_16x16x32_bf16 v[44:47], a[196:199], a[124:127], v[44:47]
  ds_read_b64_tr_b16 a[186:187], v245 offset:53248
  v_mfma_f32_16x16x32_bf16 v[40:43], a[196:199], a[120:123], v[40:43]
  ds_read_b64_tr_b16 a[188:189], v245 offset:57344
  v_mfma_f32_16x16x32_bf16 v[40:43], a[192:195], a[112:115], v[40:43]
  s_waitcnt lgkmcnt(11)
  buffer_load_dwordx4 v[104:107], v0, s[36:39], s89 offen offset:2048 sc1
  ds_read_b64_tr_b16 a[190:191], v245 offset:61440
  v_mfma_f32_16x16x32_bf16 v[48:51], a[200:203], a[112:115], v[48:51]
  ds_read_b64_tr_b16 a[192:193], v246 offset:49152
  v_mfma_f32_16x16x32_bf16 v[48:51], a[204:207], a[120:123], v[48:51]
  buffer_load_dwordx4 v[108:111], v0, s[36:39], s89 offen offset:3072 sc1
  ds_read_b64_tr_b16 a[194:195], v246 offset:53248
  v_mfma_f32_16x16x32_bf16 v[52:55], a[204:207], a[124:127], v[52:55]
  ds_read_b64_tr_b16 a[196:197], v246 offset:57344
  v_mfma_f32_16x16x32_bf16 v[52:55], a[200:203], a[116:119], v[52:55]
  s_waitcnt lgkmcnt(11)
  buffer_load_dwordx4 v[112:115], v0, s[36:39], s90 offen offset:0 sc1
  ds_read_b64_tr_b16 a[198:199], v246 offset:61440
  v_mfma_f32_16x16x32_bf16 v[60:63], a[208:211], a[116:119], v[60:63]
  ds_read_b64_tr_b16 a[200:201], v247 offset:49152
  v_mfma_f32_16x16x32_bf16 v[60:63], a[212:215], a[124:127], v[60:63]
  buffer_load_dwordx4 v[116:119], v0, s[36:39], s90 offen offset:1024 sc1
  ds_read_b64_tr_b16 a[202:203], v247 offset:53248
  v_mfma_f32_16x16x32_bf16 v[56:59], a[212:215], a[120:123], v[56:59]
  ds_read_b64_tr_b16 a[204:205], v247 offset:57344
  v_mfma_f32_16x16x32_bf16 v[56:59], a[208:211], a[112:115], v[56:59]
  s_waitcnt lgkmcnt(11)
  buffer_load_dwordx4 v[120:123], v0, s[36:39], s90 offen offset:2048 sc1
  ds_read_b64_tr_b16 a[206:207], v247 offset:61440
  v_mfma_f32_16x16x32_bf16 v[32:35], a[176:179], a[216:219], v[32:35]
  v_mfma_f32_16x16x32_bf16 v[32:35], a[180:183], a[224:227], v[32:35]
  buffer_load_dwordx4 v[124:127], v0, s[36:39], s90 offen offset:3072 sc1
  v_mfma_f32_16x16x32_bf16 v[36:39], a[180:183], a[228:231], v[36:39]
  v_mfma_f32_16x16x32_bf16 v[36:39], a[176:179], a[220:223], v[36:39]
  s_waitcnt lgkmcnt(8)
  v_mfma_f32_16x16x32_bf16 v[44:47], a[184:187], a[220:223], v[44:47]
  v_mfma_f32_16x16x32_bf16 v[44:47], a[188:191], a[228:231], v[44:47]
  v_mfma_f32_16x16x32_bf16 v[40:43], a[188:191], a[224:227], v[40:43]
  v_mfma_f32_16x16x32_bf16 v[40:43], a[184:187], a[216:219], v[40:43]
  s_waitcnt lgkmcnt(4)
  v_mfma_f32_16x16x32_bf16 v[48:51], a[192:195], a[216:219], v[48:51]
  v_mfma_f32_16x16x32_bf16 v[48:51], a[196:199], a[224:227], v[48:51]
  v_mfma_f32_16x16x32_bf16 v[52:55], a[196:199], a[228:231], v[52:55]
  v_mfma_f32_16x16x32_bf16 v[52:55], a[192:195], a[220:223], v[52:55]
  s_waitcnt lgkmcnt(0)
  v_mfma_f32_16x16x32_bf16 v[60:63], a[200:203], a[220:223], v[60:63]
  v_mfma_f32_16x16x32_bf16 v[60:63], a[204:207], a[228:231], v[60:63]
  v_mfma_f32_16x16x32_bf16 v[56:59], a[204:207], a[224:227], v[56:59]
  v_mfma_f32_16x16x32_bf16 v[56:59], a[200:203], a[216:219], v[56:59]
  s_cmp_eq_u32 s78, s3
  s_cbranch_scc0 CKXs
CKXx:
  v_pk_fma_f32 v[64:65], v[176:177], v[32:33], v[64:65]
  v_pk_fma_f32 v[66:67], v[178:179], v[34:35], v[66:67]
  v_pk_fma_f32 v[80:81], v[176:177], v[36:37], v[80:81]
  v_pk_fma_f32 v[82:83], v[178:179], v[38:39], v[82:83]
  v_pk_fma_f32 v[68:69], v[180:181], v[40:41], v[68:69]
  v_pk_fma_f32 v[70:71], v[182:183], v[42:43], v[70:71]
  v_pk_fma_f32 v[84:85], v[180:181], v[44:45], v[84:85]
  v_pk_fma_f32 v[86:87], v[182:183], v[46:47], v[86:87]
  v_pk_fma_f32 v[72:73], v[184:185], v[48:49], v[72:73]
  v_pk_fma_f32 v[74:75], v[186:187], v[50:51], v[74:75]
  v_pk_fma_f32 v[88:89], v[184:185], v[52:53], v[88:89]
  v_pk_fma_f32 v[90:91], v[186:187], v[54:55], v[90:91]
  v_pk_fma_f32 v[76:77], v[188:189], v[56:57], v[76:77]
  v_pk_fma_f32 v[78:79], v[190:191], v[58:59], v[78:79]
  v_pk_fma_f32 v[92:93], v[188:189], v[60:61], v[92:93]
  v_pk_fma_f32 v[94:95], v[190:191], v[62:63], v[94:95]
  s_waitcnt vmcnt(7)
  v_pk_fma_f32 v[64:65], v[176:177], v[96:97], v[64:65]
  v_pk_fma_f32 v[66:67], v[178:179], v[98:99], v[66:67]
  v_cvt_pk_bf16_f32 v192, v64, v65
  v_cvt_pk_bf16_f32 v193, v66, v67
  ds_write_b64 v140, v[192:193] offset:0
  s_waitcnt vmcnt(6)
  v_pk_fma_f32 v[80:81], v[176:177], v[100:101], v[80:81]
  v_pk_fma_f32 v[82:83], v[178:179], v[102:103], v[82:83]
  v_cvt_pk_bf16_f32 v200, v80, v81
  v_cvt_pk_bf16_f32 v201, v82, v83
  ds_write_b64 v140, v[200:201] offset:2048
  s_waitcnt vmcnt(5)
  v_pk_fma_f32 v[68:69], v[180:181], v[104:105], v[68:69]
  v_pk_fma_f32 v[70:71], v[182:183], v[106:107], v[70:71]
  v_cvt_pk_bf16_f32 v194, v68, v69
  v_cvt_pk_bf16_f32 v195, v70, v71
  ds_write_b64 v141, v[194:195] offset:0
  s_waitcnt vmcnt(4)
  v_pk_fma_f32 v[84:85], v[180:181], v[108:109], v[84:85]
  v_pk_fma_f32 v[86:87], v[182:183], v[110:111], v[86:87]
  v_cvt_pk_bf16_f32 v202, v84, v85
  v_cvt_pk_bf16_f32 v203, v86, v87
  ds_write_b64 v141, v[202:203] offset:2048
  s_waitcnt vmcnt(3)
  v_pk_fma_f32 v[72:73], v[184:185], v[112:113], v[72:73]
  v_pk_fma_f32 v[74:75], v[186:187], v[114:115], v[74:75]
  v_cvt_pk_bf16_f32 v196, v72, v73
  v_cvt_pk_bf16_f32 v197, v74, v75
  ds_write_b64 v142, v[196:197] offset:0
  s_waitcnt vmcnt(2)
  v_pk_fma_f32 v[88:89], v[184:185], v[116:117], v[88:89]
  v_pk_fma_f32 v[90:91], v[186:187], v[118:119], v[90:91]
  v_cvt_pk_bf16_f32 v204, v88, v89
  v_cvt_pk_bf16_f32 v205, v90, v91
  ds_write_b64 v142, v[204:205] offset:2048
  s_waitcnt vmcnt(1)
  v_pk_fma_f32 v[76:77], v[188:189], v[120:121], v[76:77]
  v_pk_fma_f32 v[78:79], v[190:191], v[122:123], v[78:79]
  v_cvt_pk_bf16_f32 v198, v76, v77
  v_cvt_pk_bf16_f32 v199, v78, v79
  ds_write_b64 v143, v[198:199] offset:0
  s_waitcnt vmcnt(0)
  v_pk_fma_f32 v[92:93], v[188:189], v[124:125], v[92:93]
  v_pk_fma_f32 v[94:95], v[190:191], v[126:127], v[94:95]
  v_cvt_pk_bf16_f32 v206, v92, v93
  v_cvt_pk_bf16_f32 v207, v94, v95
  ds_write_b64 v143, v[206:207] offset:2048
  ds_read_b128 v[64:67], v255 offset:0
  ds_read_b128 v[68:71], v255 offset:1024
  ds_read_b128 v[72:75], v255 offset:2048
  ds_read_b128 v[76:79], v255 offset:3072
  s_waitcnt lgkmcnt(3)
  buffer_store_dwordx4 v[64:67], v252, s[32:35], s55 offen
  s_waitcnt lgkmcnt(2)
  buffer_store_dwordx4 v[68:71], v253, s[32:35], s55 offen
  s_waitcnt lgkmcnt(1)
  buffer_store_dwordx4 v[72:75], v252, s[32:35], s49 offen
  s_waitcnt lgkmcnt(0)
  buffer_store_dwordx4 v[76:79], v253, s[32:35], s49 offen
XEND:
  s_endpgm
CK4s:
  s_mov_b32 s46, 30000
CK4:
  s_mov_b32 s49, 0
  buffer_load_dwordx4 v[156:159], v249, s[36:39], s49 offen sc1
  s_mov_b32 s49, 24576
  buffer_load_dwordx4 v[160:163], v249, s[36:39], s49 offen sc1
  s_mov_b32 s49, 49152
  buffer_load_dwordx4 v[164:167], v249, s[36:39], s49 offen sc1
  s_mov_b32 s49, 73728
  buffer_load_dwordx4 v[168:171], v249, s[36:39], s49 offen sc1
  s_sub_u32 s46, s46, 1
  s_waitcnt vmcnt(0)
  v_max_u32 v15, v156, v157
  v_max3_u32 v15, v15, v158, v159
  v_max3_u32 v15, v15, v160, v161
  v_max3_u32 v15, v15, v162, v163
  v_max3_u32 v15, v15, v164, v165
  v_max3_u32 v15, v15, v166, v167
  v_max3_u32 v15, v15, v168, v169
  v_max3_u32 v15, v15, v170, v171
  s_cmp_eq_u32 s46, 0
  s_cbranch_scc1 CK4x
  v_cmp_eq_u32 vcc, -1, v15
  s_nop 4
  s_cbranch_vccnz CK4
  s_branch CK4x
CKSs:
  s_mov_b32 s46, 30000
  v_lshlrev_b32 v14, 3, v0
CKS:
  s_mov_b32 s48, 5242880
  buffer_load_dword v16, v14, s[36:39], s48 offen sc1
  s_mov_b32 s48, 5251072
  buffer_load_dword v17, v14, s[36:39], s48 offen sc1
  s_mov_b32 s48, 5259264
  buffer_load_dword v18, v14, s[36:39], s48 offen sc1
  s_mov_b32 s48, 5267456
  buffer_load_dword v19, v14, s[36:39], s48 offen sc1
  s_sub_u32 s46, s46, 1
  s_cmp_eq_u32 s46, 0
  s_waitcnt vmcnt(0)
  s_cbranch_scc1 CKSy
  v_xor_b32 v15, s3, v16
  v_bitop3_b32 v15, v15, v17, s3 bitop3:0xf6
  v_bitop3_b32 v15, v15, v18, s3 bitop3:0xf6
  v_bitop3_b32 v15, v15, v19, s3 bitop3:0xf6
  v_cmp_ne_u32 vcc, 0, v15
  s_nop 4
  s_cbranch_vccnz CKS
CKSy:
  s_mov_b32 s48, 5505024
  s_mov_b64 exec, 1
  buffer_store_dword v12, v0, s[36:39], s48 offen sc1
  s_mov_b64 exec, -1
  s_branch CKSx
CK6s:
  s_mov_b32 s46, 30000
CK6:
  buffer_load_dwordx4 a[208:211], v25, s[36:39], s77 offen offset:0 sc1
  buffer_load_dwordx4 a[212:215], v25, s[36:39], s77 offen offset:2048 sc1
  buffer_load_dwordx4 a[216:219], v25, s[36:39], s76 offen offset:0 sc1
  buffer_load_dwordx4 a[220:223], v25, s[36:39], s76 offen offset:2048 sc1
  s_sub_u32 s46, s46, 1
  s_waitcnt vmcnt(0)
  v_accvgpr_read_b32 v26, a208
  v_accvgpr_read_b32 v27, a209
  v_accvgpr_read_b32 v28, a210
  v_accvgpr_read_b32 v29, a211
  v_max_u32 v31, v26, v27
  v_max3_u32 v31, v31, v28, v29
  v_accvgpr_read_b32 v22, a212
  v_accvgpr_read_b32 v23, a213
  v_max3_u32 v31, v31, v22, v23
  v_add_f32 v26, v26, v22
  v_add_f32 v27, v27, v23
  v_accvgpr_read_b32 v22, a214
  v_accvgpr_read_b32 v23, a215
  v_max3_u32 v31, v31, v22, v23
  v_add_f32 v28, v28, v22
  v_add_f32 v29, v29, v23
  v_accvgpr_read_b32 v22, a216
  v_accvgpr_read_b32 v23, a217
  v_max3_u32 v31, v31, v22, v23
  v_add_f32 v26, v26, v22
  v_add_f32 v27, v27, v23
  v_accvgpr_read_b32 v22, a218
  v_accvgpr_read_b32 v23, a219
  v_max3_u32 v31, v31, v22, v23
  v_add_f32 v28, v28, v22
  v_add_f32 v29, v29, v23
  v_accvgpr_read_b32 v22, a220
  v_accvgpr_read_b32 v23, a221
  v_max3_u32 v31, v31, v22, v23
  v_add_f32 v26, v26, v22
  v_add_f32 v27, v27, v23
  v_accvgpr_read_b32 v22, a222
  v_accvgpr_read_b32 v23, a223
  v_max3_u32 v31, v31, v22, v23
  v_add_f32 v28, v28, v22
  v_add_f32 v29, v29, v23
  s_cmp_eq_u32 s46, 0
  s_cbranch_scc1 CK6x
  v_cmp_eq_u32 vcc, -1, v31
  s_nop 4
  s_cbranch_vccnz CK6
  s_branch CK6x
CK7s:
  s_mov_b32 s46, 60000
CK7:
  buffer_load_dword v139, v138, s[36:39], s91 offen sc1
  s_sub_u32 s46, s46, 1
  s_cmp_eq_u32 s46, 0
  s_waitcnt vmcnt(0)
  s_cbranch_scc1 CK7x
  v_cmp_ne_u32 vcc, s3, v139
  s_nop 4
  s_cbranch_vccnz CK7
  s_branch CK7x
CK8s:
  s_mov_b32 s46, 60000
CK8:
  buffer_load_dword v139, v138, s[36:39], s91 offen sc1
  s_sub_u32 s46, s46, 1
  s_cmp_eq_u32 s46, 0
  s_waitcnt vmcnt(0)
  s_cbranch_scc1 CK8x
  v_cmp_ne_u32 vcc, s3, v139
  s_nop 4
  s_cbranch_vccnz CK8
  s_branch CK8x
CKXs:
  s_mov_b32 s46, 60000
CKX:
  buffer_load_dword v139, v132, s[36:39], s77 offen sc1
  s_sub_u32 s46, s46, 1
  s_cmp_eq_u32 s46, 0
  s_waitcnt vmcnt(0)
  s_cbranch_scc1 CKXy
  v_cmp_ne_u32 vcc, s3, v139
  s_nop 4
  s_cbranch_vccnz CKX
CKXy:
  buffer_load_dwordx4 v[96:99], v0, s[36:39], s63 offen offset:0 sc1
  buffer_load_dwordx4 v[100:103], v0, s[36:39], s63 offen offset:1024 sc1
  buffer_load_dwordx4 v[104:107], v0, s[36:39], s63 offen offset:2048 sc1
  buffer_load_dwordx4 v[108:111], v0, s[36:39], s63 offen offset:3072 sc1
  buffer_load_dwordx4 v[112:115], v0, s[36:39], s64 offen offset:0 sc1
  buffer_load_dwordx4 v[116:119], v0, s[36:39], s64 offen offset:1024 sc1
  buffer_load_dwordx4 v[120:123], v0, s[36:39], s64 offen offset:2048 sc1
  buffer_load_dwordx4 v[124:127], v0, s[36:39], s64 offen offset:3072 sc1
  s_branch CKXx
code_end:
.fill 2048, 4, 0xBF800000
.section .rodata,"a"
.p2align 6
.amdhsa_kernel adaLN_cond__sliding_local_dilated__swiglu_ffn__prompt_kernel
  .amdhsa_next_free_vgpr 512
  .amdhsa_next_free_sgpr 102
  .amdhsa_accum_offset 256
  .amdhsa_group_segment_fixed_size 0
  .amdhsa_kernarg_size 96
  .amdhsa_user_sgpr_count 2
  .amdhsa_user_sgpr_kernarg_segment_ptr 1
  .amdhsa_system_sgpr_workgroup_id_x 1
  .amdhsa_float_denorm_mode_32 3
.end_amdhsa_kernel
```

```asm
; @launch grid=(256,1,1) block=(256,1,1) lds=163840
.amdgcn_target "amdgcn-amd-amdhsa--gfx950"
.text
.globl adaLN_cond__sliding_local_dilated__swiglu_ffn__prompt_kernel
.type adaLN_cond__sliding_local_dilated__swiglu_ffn__prompt_kernel,@function
.p2align 12
.p2align 8
adaLN_cond__sliding_local_dilated__swiglu_ffn__prompt_kernel:
  s_cmp_ge_u32 s2, 256
  s_cbranch_scc1 XEND
  s_load_dwordx2 s[36:37], s[0:1], 88
  s_load_dwordx2 s[40:41], s[0:1], 56
  s_load_dwordx2 s[28:29], s[0:1], 64
  s_load_dwordx2 s[4:5], s[0:1], 0
  s_load_dwordx2 s[8:9], s[0:1], 8
  s_load_dwordx2 s[12:13], s[0:1], 16
  s_load_dwordx2 s[16:17], s[0:1], 32
  s_load_dwordx2 s[20:21], s[0:1], 40
  s_load_dwordx2 s[24:25], s[0:1], 48
  s_load_dwordx2 s[32:33], s[0:1], 72
  v_lshrrev_b32 v1, 6, v0
  v_and_b32 v10, 63, v0
  v_readfirstlane_b32 s44, v1
  v_lshlrev_b32 v0, 4, v10
  s_mov_b32 s38, 50331648
  s_mov_b32 s39, 0x20000
  s_mov_b32 s42, 2048
  s_mov_b32 s43, 0x20000
  s_mov_b32 s30, 12582912
  s_mov_b32 s31, 0x20000
  s_mov_b32 s6, 4194304
  s_mov_b32 s7, 0x20000
  s_mov_b32 s10, 6291456
  s_mov_b32 s11, 0x20000
  s_mov_b32 s14, 2097152
  s_mov_b32 s15, 0x20000
  s_mov_b32 s18, 7340032
  s_mov_b32 s19, 0x20000
  s_mov_b32 s22, 7340032
  s_mov_b32 s23, 0x20000
  s_mov_b32 s26, 7340032
  s_mov_b32 s27, 0x20000
  s_mov_b32 s34, 4194304
  s_mov_b32 s35, 0x20000
  s_and_b32 s48, s2, 3
  s_lshl2_add_u32 s48, s48, s44
  s_lshl_b32 s48, s48, 6
  v_and_b32 v176, 0x38, v10
  v_add_u32 v176, s48, v176
  v_lshlrev_b32 v177, 1, v176
  v_mul_u32_u24 v176, 12288, v176
  v_and_b32 v12, 7, v10
  v_lshl_add_u32 v176, v12, 4, v176
  v_mov_b32 v178, 0
  s_bfe_u32 s51, s2, 0x40003
  s_and_b32 s49, s2, 4
  s_lshl2_add_u32 s51, s49, s51
  s_and_b32 s49, s2, 128
  s_lshl2_add_u32 s51, s51, s49
  s_lshl_b32 s51, s51, 5
  s_mov_b32 s49, s51
  s_mov_b32 s50, 5505024
  v_lshrrev_b32 v13, 3, v10
  v_lshlrev_b32 v132, 11, v12
  v_lshl_add_u32 v132, v13, 4, v132
  s_and_b32 s48, s2, 127
  s_lshl_b32 s48, s48, 6
  s_add_u32 s48, s48, s44
  s_lshl_b32 s48, s48, 9
  s_cmp_lt_u32 s2, 128
  s_waitcnt lgkmcnt(0)
  buffer_load_dwordx4 v[188:191], v177, s[40:43], 0 offen
  s_cbranch_scc0 F_x
  buffer_load_dwordx4 v[136:139], v176, s[28:31], s49 offen nt
  s_add_u32 s49, s49, 12288
  buffer_load_dwordx4 v[140:143], v176, s[28:31], s49 offen nt
  s_add_u32 s49, s49, 12288
  buffer_load_dwordx4 v[144:147], v176, s[28:31], s49 offen nt
  s_add_u32 s49, s49, 12288
  buffer_load_dwordx4 v[148:151], v176, s[28:31], s49 offen nt
  s_add_u32 s49, s49, 12288
  buffer_load_dwordx4 v[152:155], v176, s[28:31], s49 offen nt
  s_add_u32 s49, s49, 12288
  buffer_load_dwordx4 v[156:159], v176, s[28:31], s49 offen nt
  s_add_u32 s49, s49, 12288
  buffer_load_dwordx4 v[160:163], v176, s[28:31], s49 offen nt
  s_add_u32 s49, s49, 12288
  buffer_load_dwordx4 v[164:167], v176, s[28:31], s49 offen nt
F_x:
  buffer_load_dword v195, v178, s[36:39], s50 offen sc1
  s_mov_b32 s50, s48
  s_getpc_b64 s[92:93]
PC0:
  s_sub_u32 s92, s92, PC0-adaLN_cond__sliding_local_dilated__swiglu_ffn__prompt_kernel
  s_subb_u32 s93, s93, 0
  s_cmp_lt_u32 s2, 128
  s_cbranch_scc1 F_ct
  s_bfe_u32 s48, s2, 0x30004
  s_and_b32 s49, s2, 3
  s_lshl3_add_u32 s48, s49, s48
  s_mul_i32 s48, s48, 393216
  s_and_b32 s49, s2, 4
  s_lshl_b32 s49, s49, 9
  s_add_u32 s48, s48, s49
  s_and_b32 s49, s2, 8
  s_lshl_b32 s49, s49, 7
  s_add_u32 s48, s48, s49
  s_cmp_lt_u32 s44, 1
  s_cselect_b32 s48, s48, 1073741824
  v_and_b32 v19, 31, v10
  v_mul_u32_u24 v19, 12288, v19
  buffer_load_dword a252, v19, s[28:31], s48 offen offset:384
  s_bfe_u32 s48, s2, 0x40003
  s_cmp_lt_u32 s48, (code_end-adaLN_cond__sliding_local_dilated__swiglu_ffn__prompt_kernel)/8192+1
  s_cselect_b32 s49, 3, 4
  s_lshl_b32 s48, s48, 13
  v_lshl_add_u32 v19, v0, 3, s48
  s_cmp_eq_u32 s44, s49
  s_cselect_b32 s49, -1, 0
  v_and_b32 v19, s49, v19
  global_load_dword a252, v19, s[92:93]
  s_bfe_u32 s48, s2, 0x20003
  s_mul_i32 s48, s48, 24576
  s_lshr_b32 s49, s2, 5
  s_lshl3_add_u32 s49, s44, s49
  s_cmp_eq_u32 s49, 15
  s_cselect_b32 s48, s48, 1073741824
  v_lshlrev_b32 v19, 3, v0
  buffer_load_dword a252, v19, s[36:39], s48 offen sc1
F_ct:
  s_and_b32 s48, s2, 7
  s_lshr_b32 s49, s2, 3
  s_and_b32 s58, s48, 3
  s_lshl_b32 s58, s58, 2
  s_and_b32 s57, s49, 3
  s_add_u32 s58, s58, s57
  s_lshr_b32 s57, s48, 2
  s_lshl_b32 s57, s57, 3
  s_lshr_b32 s49, s49, 2
  s_add_u32 s57, s57, s49
  s_lshr_b32 s59, s44, 1
  s_and_b32 s60, s44, 1
  s_mul_i32 s63, s44, 3072
  s_lshl_b32 s64, s44, 11
  s_lshl_b32 s65, s44, 8
  v_bfe_u32 v14, v10, 4, 2
  v_bfe_u32 v15, v10, 1, 2
  v_xor_b32 v14, v14, v15
  v_lshlrev_b32 v14, 5, v14
  v_and_b32 v15, 1, v10
  v_lshl_add_u32 v213, v15, 4, v14
  s_lshl_b32 s48, s58, 7
  s_mul_i32 s49, s44, 49152
  s_add_u32 s48, s48, s49
  v_mul_u32_u24 v14, 6144, v13
  v_add3_u32 v202, v14, v213, s48
  v_add_u32 v203, 195584, v202
  v_add_u32 v204, 391168, v202
  v_bfe_u32 v14, v10, 3, 2
  v_lshlrev_b32 v14, 5, v14
  v_and_b32 v15, 3, v10
  v_lshl_add_u32 v214, v15, 3, v14
  v_bfe_u32 v14, v10, 2, 3
  v_lshrrev_b32 v15, 5, v10
  v_mul_u32_u24 v15, 24, v15
  v_add_lshl_u32 v14, v14, v15, 7
  s_lshl_b32 s48, s60, 1
  s_add_u32 s48, s48, s59
  s_lshl_b32 s48, s48, 5
  v_xor_b32 v15, s48, v214
  v_add_u32 v196, v14, v15
  v_xor_b32 v197, 32, v196
  v_add_u32 v198, 64512, v196
  v_add_u32 v199, 64512, v197
  v_add_u32 v200, 129024, v196
  v_add_u32 v201, 129024, v197
  s_lshl_b32 s48, s57, 2
  s_add_u32 s49, s48, s44
  s_lshl_b32 s49, s49, 16
  s_add_u32 s49, s49, 1048576
  v_add_u32 v205, s49, v0
  s_max_u32 s48, s48, 1
  s_lshl_b32 s48, s48, 16
  s_add_u32 s48, s48, 984064
  s_add_u32 s48, s48, s65
  v_lshl_add_u32 v206, v10, 2, s48
  s_lshl_b32 s48, s59, 12
  v_add_u32 v210, 0, v0
  v_add_u32 v207, s48, v210
  v_add_u32 v211, 64512, v0
  v_add_u32 v208, s48, v211
  v_add_u32 v212, 129024, v0
  v_add_u32 v209, s48, v212
  s_lshl3_add_u32 s48, s57, 127
  v_min_u32 v215, 8, v10
  v_add_u32 v215, s48, v215
  v_max_u32 v215, 0x80, v215
  v_lshlrev_b32 v215, 7, v215
  v_lshlrev_b32 v18, 5, v12
  v_lshrrev_b32 v19, 4, v10
  v_lshl_add_u32 v18, v19, 3, v18
  s_add_u32 s48, s65, 162816
  v_add_u32 v177, s48, v18
  v_lshlrev_b32 v178, 2, v10
  s_and_b32 s49, s2, 3
  s_mul_i32 s56, s49, 24576
  s_lshl1_add_u32 s56, s51, s56
  s_add_u32 s51, s51, 4096
  s_cmp_lt_u32 s2, 128
  s_cbranch_scc1 F_cw
  s_waitcnt vmcnt(4)
F_cw:
  s_waitcnt vmcnt(9)
  v_lshlrev_b32 v168, 16, v188
  v_and_b32 v169, 0xffff0000, v188
  v_lshlrev_b32 v170, 16, v189
  v_and_b32 v171, 0xffff0000, v189
  v_lshlrev_b32 v172, 16, v190
  v_and_b32 v173, 0xffff0000, v190
  v_lshlrev_b32 v174, 16, v191
  v_and_b32 v175, 0xffff0000, v191
  v_mul_f32 v180, 0xbfb8aa3b, v168
  v_mul_f32 v181, 0xbfb8aa3b, v169
  v_mul_f32 v182, 0xbfb8aa3b, v170
  v_mul_f32 v183, 0xbfb8aa3b, v171
  v_mul_f32 v184, 0xbfb8aa3b, v172
  v_mul_f32 v185, 0xbfb8aa3b, v173
  v_mul_f32 v186, 0xbfb8aa3b, v174
  v_mul_f32 v187, 0xbfb8aa3b, v175
  v_exp_f32 v180, v180
  v_exp_f32 v181, v181
  v_exp_f32 v182, v182
  v_exp_f32 v183, v183
  v_exp_f32 v184, v184
  v_exp_f32 v185, v185
  v_exp_f32 v186, v186
  v_exp_f32 v187, v187
  v_add_f32 v180, 1.0, v180
  v_add_f32 v181, 1.0, v181
  v_add_f32 v182, 1.0, v182
  v_add_f32 v183, 1.0, v183
  v_add_f32 v184, 1.0, v184
  v_add_f32 v185, 1.0, v185
  v_add_f32 v186, 1.0, v186
  v_add_f32 v187, 1.0, v187
  v_rcp_f32 v180, v180
  v_rcp_f32 v181, v181
  v_rcp_f32 v182, v182
  v_rcp_f32 v183, v183
  v_rcp_f32 v184, v184
  v_rcp_f32 v185, v185
  v_rcp_f32 v186, v186
  v_rcp_f32 v187, v187
  v_mul_f32 v168, v168, v180
  v_mul_f32 v169, v169, v181
  v_mul_f32 v170, v170, v182
  v_mul_f32 v171, v171, v183
  v_mul_f32 v172, v172, v184
  v_mul_f32 v173, v173, v185
  v_mul_f32 v174, v174, v186
  v_mul_f32 v175, v175, v187
  v_cvt_pk_bf16_f32 v192, v168, v169
  v_lshlrev_b32 v168, 16, v192
  v_and_b32 v169, 0xffff0000, v192
  v_cvt_pk_bf16_f32 v192, v170, v171
  v_lshlrev_b32 v170, 16, v192
  v_and_b32 v171, 0xffff0000, v192
  v_cvt_pk_bf16_f32 v192, v172, v173
  v_lshlrev_b32 v172, 16, v192
  v_and_b32 v173, 0xffff0000, v192
  v_cvt_pk_bf16_f32 v192, v174, v175
  v_lshlrev_b32 v174, 16, v192
  v_and_b32 v175, 0xffff0000, v192
  s_cmp_lt_u32 s2, 128
  s_cbranch_scc1 F_xl1
  buffer_load_dwordx4 v[136:139], v132, s[4:7], s50 offen offset:0
  buffer_load_dwordx4 v[140:143], v132, s[4:7], s50 offen offset:128
  buffer_load_dwordx4 v[144:147], v132, s[4:7], s50 offen offset:256
  buffer_load_dwordx4 v[148:151], v132, s[4:7], s50 offen offset:384
  s_add_u32 s50, s50, 16384
  buffer_load_dwordx4 v[152:155], v132, s[4:7], s50 offen offset:0
  buffer_load_dwordx4 v[156:159], v132, s[4:7], s50 offen offset:128
  buffer_load_dwordx4 v[160:163], v132, s[4:7], s50 offen offset:256
  buffer_load_dwordx4 v[164:167], v132, s[4:7], s50 offen offset:384
F_xl1:
  s_cmp_lt_u32 s2, 128
  s_cbranch_scc0 AL
  s_waitcnt vmcnt(8)
  v_lshlrev_b32 v188, 16, v136
  v_and_b32 v189, 0xffff0000, v136
  v_lshlrev_b32 v190, 16, v137
  v_and_b32 v191, 0xffff0000, v137
  v_pk_mul_f32 v[180:181], v[188:189], v[168:169] op_sel_hi:[1,0]
  v_pk_mul_f32 v[182:183], v[190:191], v[168:169] op_sel_hi:[1,0]
  v_lshlrev_b32 v188, 16, v138
  v_and_b32 v189, 0xffff0000, v138
  v_lshlrev_b32 v190, 16, v139
  v_and_b32 v191, 0xffff0000, v139
  v_pk_mul_f32 v[184:185], v[188:189], v[168:169] op_sel_hi:[1,0]
  v_pk_mul_f32 v[186:187], v[190:191], v[168:169] op_sel_hi:[1,0]
  s_waitcnt vmcnt(7)
  v_lshlrev_b32 v188, 16, v140
  v_and_b32 v189, 0xffff0000, v140
  v_lshlrev_b32 v190, 16, v141
  v_and_b32 v191, 0xffff0000, v141
  v_pk_fma_f32 v[180:181], v[188:189], v[168:169], v[180:181] op_sel:[0,1,0] op_sel_hi:[1,1,1]
  v_pk_fma_f32 v[182:183], v[190:191], v[168:169], v[182:183] op_sel:[0,1,0] op_sel_hi:[1,1,1]
  v_lshlrev_b32 v188, 16, v142
  v_and_b32 v189, 0xffff0000, v142
  v_lshlrev_b32 v190, 16, v143
  v_and_b32 v191, 0xffff0000, v143
  v_pk_fma_f32 v[184:185], v[188:189], v[168:169], v[184:185] op_sel:[0,1,0] op_sel_hi:[1,1,1]
  v_pk_fma_f32 v[186:187], v[190:191], v[168:169], v[186:187] op_sel:[0,1,0] op_sel_hi:[1,1,1]
  s_waitcnt vmcnt(6)
  v_lshlrev_b32 v188, 16, v144
  v_and_b32 v189, 0xffff0000, v144
  v_lshlrev_b32 v190, 16, v145
  v_and_b32 v191, 0xffff0000, v145
  v_pk_fma_f32 v[180:181], v[188:189], v[170:171], v[180:181] op_sel:[0,0,0] op_sel_hi:[1,0,1]
  v_pk_fma_f32 v[182:183], v[190:191], v[170:171], v[182:183] op_sel:[0,0,0] op_sel_hi:[1,0,1]
  v_lshlrev_b32 v188, 16, v146
  v_and_b32 v189, 0xffff0000, v146
  v_lshlrev_b32 v190, 16, v147
  v_and_b32 v191, 0xffff0000, v147
  v_pk_fma_f32 v[184:185], v[188:189], v[170:171], v[184:185] op_sel:[0,0,0] op_sel_hi:[1,0,1]
  v_pk_fma_f32 v[186:187], v[190:191], v[170:171], v[186:187] op_sel:[0,0,0] op_sel_hi:[1,0,1]
  s_waitcnt vmcnt(5)
  v_lshlrev_b32 v188, 16, v148
  v_and_b32 v189, 0xffff0000, v148
  v_lshlrev_b32 v190, 16, v149
  v_and_b32 v191, 0xffff0000, v149
  v_pk_fma_f32 v[180:181], v[188:189], v[170:171], v[180:181] op_sel:[0,1,0] op_sel_hi:[1,1,1]
  v_pk_fma_f32 v[182:183], v[190:191], v[170:171], v[182:183] op_sel:[0,1,0] op_sel_hi:[1,1,1]
  v_lshlrev_b32 v188, 16, v150
  v_and_b32 v189, 0xffff0000, v150
  v_lshlrev_b32 v190, 16, v151
  v_and_b32 v191, 0xffff0000, v151
  v_pk_fma_f32 v[184:185], v[188:189], v[170:171], v[184:185] op_sel:[0,1,0] op_sel_hi:[1,1,1]
  v_pk_fma_f32 v[186:187], v[190:191], v[170:171], v[186:187] op_sel:[0,1,0] op_sel_hi:[1,1,1]
  s_waitcnt vmcnt(4)
  v_lshlrev_b32 v188, 16, v152
  v_and_b32 v189, 0xffff0000, v152
  v_lshlrev_b32 v190, 16, v153
  v_and_b32 v191, 0xffff0000, v153
  v_pk_fma_f32 v[180:181], v[188:189], v[172:173], v[180:181] op_sel:[0,0,0] op_sel_hi:[1,0,1]
  v_pk_fma_f32 v[182:183], v[190:191], v[172:173], v[182:183] op_sel:[0,0,0] op_sel_hi:[1,0,1]
  v_lshlrev_b32 v188, 16, v154
  v_and_b32 v189, 0xffff0000, v154
  v_lshlrev_b32 v190, 16, v155
  v_and_b32 v191, 0xffff0000, v155
  v_pk_fma_f32 v[184:185], v[188:189], v[172:173], v[184:185] op_sel:[0,0,0] op_sel_hi:[1,0,1]
  v_pk_fma_f32 v[186:187], v[190:191], v[172:173], v[186:187] op_sel:[0,0,0] op_sel_hi:[1,0,1]
  s_waitcnt vmcnt(3)
  v_lshlrev_b32 v188, 16, v156
  v_and_b32 v189, 0xffff0000, v156
  v_lshlrev_b32 v190, 16, v157
  v_and_b32 v191, 0xffff0000, v157
  v_pk_fma_f32 v[180:181], v[188:189], v[172:173], v[180:181] op_sel:[0,1,0] op_sel_hi:[1,1,1]
  v_pk_fma_f32 v[182:183], v[190:191], v[172:173], v[182:183] op_sel:[0,1,0] op_sel_hi:[1,1,1]
  v_lshlrev_b32 v188, 16, v158
  v_and_b32 v189, 0xffff0000, v158
  v_lshlrev_b32 v190, 16, v159
  v_and_b32 v191, 0xffff0000, v159
  v_pk_fma_f32 v[184:185], v[188:189], v[172:173], v[184:185] op_sel:[0,1,0] op_sel_hi:[1,1,1]
  v_pk_fma_f32 v[186:187], v[190:191], v[172:173], v[186:187] op_sel:[0,1,0] op_sel_hi:[1,1,1]
  s_waitcnt vmcnt(2)
  v_lshlrev_b32 v188, 16, v160
  v_and_b32 v189, 0xffff0000, v160
  v_lshlrev_b32 v190, 16, v161
  v_and_b32 v191, 0xffff0000, v161
  v_pk_fma_f32 v[180:181], v[188:189], v[174:175], v[180:181] op_sel:[0,0,0] op_sel_hi:[1,0,1]
  v_pk_fma_f32 v[182:183], v[190:191], v[174:175], v[182:183] op_sel:[0,0,0] op_sel_hi:[1,0,1]
  v_lshlrev_b32 v188, 16, v162
  v_and_b32 v189, 0xffff0000, v162
  v_lshlrev_b32 v190, 16, v163
  v_and_b32 v191, 0xffff0000, v163
  v_pk_fma_f32 v[184:185], v[188:189], v[174:175], v[184:185] op_sel:[0,0,0] op_sel_hi:[1,0,1]
  v_pk_fma_f32 v[186:187], v[190:191], v[174:175], v[186:187] op_sel:[0,0,0] op_sel_hi:[1,0,1]
  s_waitcnt vmcnt(1)
  v_lshlrev_b32 v188, 16, v164
  v_and_b32 v189, 0xffff0000, v164
  v_lshlrev_b32 v190, 16, v165
  v_and_b32 v191, 0xffff0000, v165
  v_pk_fma_f32 v[180:181], v[188:189], v[174:175], v[180:181] op_sel:[0,1,0] op_sel_hi:[1,1,1]
  v_pk_fma_f32 v[182:183], v[190:191], v[174:175], v[182:183] op_sel:[0,1,0] op_sel_hi:[1,1,1]
  v_lshlrev_b32 v188, 16, v166
  v_and_b32 v189, 0xffff0000, v166
  v_lshlrev_b32 v190, 16, v167
  v_and_b32 v191, 0xffff0000, v167
  v_pk_fma_f32 v[184:185], v[188:189], v[174:175], v[184:185] op_sel:[0,1,0] op_sel_hi:[1,1,1]
  v_pk_fma_f32 v[186:187], v[190:191], v[174:175], v[186:187] op_sel:[0,1,0] op_sel_hi:[1,1,1]
  s_nop 0
  v_permlane32_swap_b32 v180, v184
  v_permlane32_swap_b32 v181, v185
  v_permlane32_swap_b32 v182, v186
  v_permlane32_swap_b32 v183, v187
  v_add_f32 v180, v180, v184
  v_add_f32 v181, v181, v185
  v_add_f32 v182, v182, v186
  v_add_f32 v183, v183, v187
  s_nop 0
  v_permlane16_swap_b32 v180, v182
  v_permlane16_swap_b32 v181, v183
  v_add_f32 v180, v180, v182
  v_add_f32 v181, v181, v183
  v_add_u32 v188, 162816, v178
  v_add_f32_dpp v180, v180, v180 row_ror:8 row_mask:0xf bank_mask:0xf
  v_add_f32_dpp v181, v181, v181 row_ror:8 row_mask:0xf bank_mask:0xf
  ds_write_b64 v177, v[180:181]
  v_and_b32 v184, 3, v10
  v_lshlrev_b32 v184, 3, v184
  s_cmp_eq_u32 s44, 0
  s_cselect_b32 s48, s56, 1073741824
  s_waitcnt lgkmcnt(0)
  s_barrier
  ds_read_b32 v180, v188 offset:0
  ds_read_b32 v181, v188 offset:256
  ds_read_b32 v182, v188 offset:512
  ds_read_b32 v183, v188 offset:768
  s_waitcnt vmcnt(0)
  v_readfirstlane_b32 s3, v195
  s_lshl_b32 s45, s2, 7
  s_add_u32 s45, s45, 5242880
  s_cmp_eq_u32 s44, 0
  s_cselect_b32 s45, s45, 1073741824
  s_mul_i32 s3, s3, 0x9e3779b1
  s_add_u32 s3, s3, 0x7f4a7c15
  s_and_b32 s70, s2, 7
  s_bfe_u32 s49, s2, 0x20003
  s_lshl2_add_u32 s70, s70, s49
  s_lshr_b32 s49, s2, 5
  s_lshl3_add_u32 s70, s70, s49
  s_lshl1_add_u32 s70, s70, s44
  s_lshl_b32 s70, s70, 10
  s_add_u32 s70, s70, 524288
  s_add_u32 s56, s56, 8192
  s_cmp_lt_u32 s44, 2
  s_cselect_b32 s70, s70, 1073741824
  s_cmp_eq_u32 s44, 2
  s_cselect_b32 s71, s56, 1073741824
  v_bfe_u32 v184, s3, v184, 8
  v_mov_b32 v185, 0xffffff00
  s_waitcnt lgkmcnt(0)
  v_add_f32 v180, v180, v181
  v_add_f32 v182, v182, v183
  v_add_f32 v180, v180, v182
  v_add_u32 v180, 0x80, v180
  v_and_or_b32 v180, v180, v185, v184
  buffer_store_dword v180, v178, s[36:39], s48 offen sc1
  v_mov_b32 v184, -1
  v_mov_b32 v185, -1
  v_mov_b32 v186, -1
  v_mov_b32 v187, -1
  buffer_store_dwordx4 v[184:187], v0, s[36:39], s70 offen sc1
  buffer_store_dword v184, v178, s[36:39], s71 offen sc1
  s_lshl_b32 s48, s44, 7
  s_add_u32 s48, s48, s2
  s_lshl_b32 s48, s48, 13
  v_lshlrev_b32 v14, 3, v0
  s_mov_b32 s50, s48
  buffer_load_dword a252, v14, s[8:11], s50 offen
  s_mov_b32 s55, 0x20000
  s_sub_u32 s49, s48, 2097152
  s_add_u32 s48, s48, 4194304
  s_cmp_ge_u32 s44, 2
  s_cselect_b64 s[52:53], s[12:13], s[8:9]
  s_cselect_b32 s54, s14, s10
  s_cselect_b32 s48, s49, s48
  v_mov_b32 v12, s3
  s_waitcnt vmcnt(1)
  s_barrier
  s_mov_b64 exec, 1
  buffer_store_dword v12, v0, s[36:39], s45 offen sc1
  s_mov_b64 exec, -1
  s_waitcnt vmcnt(1)
  s_lshr_b32 s49, s2, 3
  s_mul_i32 s49, s49, 393216
  s_add_u32 s49, s49, s64
  s_and_b32 s50, s2, 2
  s_lshl_b32 s50, s50, 9
  s_add_u32 s49, s49, s50
  s_and_b32 s50, s2, 1
  s_lshl2_add_u32 s50, s50, s44
  s_cmp_lt_u32 s50, 3
  s_cselect_b32 s49, s49, 1073741824
  v_min_u32 v15, 63, v10
  v_mul_u32_u24 v15, 6144, v15
  buffer_load_dword a252, v15, s[8:11], s49 offen offset:384
  buffer_load_dword a252, v14, s[52:55], s48 offen
  s_branch J2
.p2align 12
AL:
  s_waitcnt vmcnt(8)
  v_readfirstlane_b32 s3, v195
  s_lshl_b32 s45, s2, 7
  s_add_u32 s45, s45, 5242880
  s_cmp_eq_u32 s44, 0
  s_cselect_b32 s45, s45, 1073741824
  s_mul_i32 s3, s3, 0x9e3779b1
  s_add_u32 s3, s3, 0x7f4a7c15
  s_and_b32 s70, s2, 7
  s_bfe_u32 s49, s2, 0x20003
  s_lshl2_add_u32 s70, s70, s49
  s_lshr_b32 s49, s2, 5
  s_lshl3_add_u32 s70, s70, s49
  s_lshl1_add_u32 s70, s70, s44
  s_lshl_b32 s70, s70, 10
  s_add_u32 s70, s70, 524288
  s_add_u32 s56, s56, 8192
  s_cmp_lt_u32 s44, 2
  s_cselect_b32 s70, s70, 1073741824
  s_cmp_eq_u32 s44, 2
  s_cselect_b32 s71, s56, 1073741824
  s_add_u32 s48, s64, 150528
  v_add_u32 v14, s48, v0
  v_lshl_add_u32 v15, v13, 5, s48
  v_lshlrev_b32 v17, 6, v12
  v_add_u32 v17, 158720, v17
  s_lshl_b32 s48, s44, 4
  v_add_u32 v16, s48, v17
  v_bfe_u32 v18, v10, 3, 1
  v_lshlrev_b32 v132, 9, v18
  v_bfe_u32 v18, v10, 4, 1
  v_lshl_add_u32 v132, v18, 8, v132
  v_lshrrev_b32 v18, 5, v10
  v_lshl_add_u32 v132, v18, 11, v132
  v_lshl_add_u32 v132, v12, 4, v132
  s_bfe_u32 s50, s2, 0x60001
  s_lshl2_add_u32 s50, s50, s44
  s_lshl_b32 s50, s50, 4
  s_and_b32 s48, s2, 1
  s_add_u32 s50, s50, s48
  s_lshl_b32 s50, s50, 10
  s_add_u32 s50, s50, 1048576
  s_bfe_u32 s66, s3, 0x80000
  s_bfe_u32 s67, s3, 0x80008
  s_bfe_u32 s68, s3, 0x80010
  s_bfe_u32 s69, s3, 0x80018
  s_waitcnt vmcnt(7)
  v_lshlrev_b32 v20, 16, v136
  v_and_b32 v21, 0xffff0000, v136
  v_lshlrev_b32 v22, 16, v137
  v_and_b32 v23, 0xffff0000, v137
  v_lshlrev_b32 v24, 16, v138
  v_and_b32 v25, 0xffff0000, v138
  v_lshlrev_b32 v26, 16, v139
  v_and_b32 v27, 0xffff0000, v139
  v_pk_mul_f32 v[126:127], v[20:21], v[20:21]
  v_pk_mul_f32 v[130:131], v[22:23], v[22:23]
  v_pk_fma_f32 v[126:127], v[24:25], v[24:25], v[126:127]
  v_pk_add_f32 v[124:125], v[24:25], v[20:21]
  v_pk_fma_f32 v[130:131], v[26:27], v[26:27], v[130:131]
  v_pk_add_f32 v[128:129], v[26:27], v[22:23]
  s_waitcnt vmcnt(6)
  v_lshlrev_b32 v28, 16, v140
  v_and_b32 v29, 0xffff0000, v140
  v_lshlrev_b32 v30, 16, v141
  v_and_b32 v31, 0xffff0000, v141
  v_lshlrev_b32 v32, 16, v142
  v_and_b32 v33, 0xffff0000, v142
  v_lshlrev_b32 v34, 16, v143
  v_and_b32 v35, 0xffff0000, v143
  v_pk_fma_f32 v[126:127], v[28:29], v[28:29], v[126:127]
  v_pk_add_f32 v[124:125], v[28:29], v[124:125]
  v_pk_fma_f32 v[130:131], v[30:31], v[30:31], v[130:131]
  v_pk_add_f32 v[128:129], v[30:31], v[128:129]
  v_pk_fma_f32 v[126:127], v[32:33], v[32:33], v[126:127]
  v_pk_add_f32 v[124:125], v[32:33], v[124:125]
  v_pk_fma_f32 v[130:131], v[34:35], v[34:35], v[130:131]
  v_pk_add_f32 v[128:129], v[34:35], v[128:129]
  s_waitcnt vmcnt(5)
  v_lshlrev_b32 v36, 16, v144
  v_and_b32 v37, 0xffff0000, v144
  v_lshlrev_b32 v38, 16, v145
  v_and_b32 v39, 0xffff0000, v145
  v_lshlrev_b32 v40, 16, v146
  v_and_b32 v41, 0xffff0000, v146
  v_lshlrev_b32 v42, 16, v147
  v_and_b32 v43, 0xffff0000, v147
  v_pk_fma_f32 v[126:127], v[36:37], v[36:37], v[126:127]
  v_pk_add_f32 v[124:125], v[36:37], v[124:125]
  v_pk_fma_f32 v[130:131], v[38:39], v[38:39], v[130:131]
  v_pk_add_f32 v[128:129], v[38:39], v[128:129]
  v_pk_fma_f32 v[126:127], v[40:41], v[40:41], v[126:127]
  v_pk_add_f32 v[124:125], v[40:41], v[124:125]
  v_pk_fma_f32 v[130:131], v[42:43], v[42:43], v[130:131]
  v_pk_add_f32 v[128:129], v[42:43], v[128:129]
  s_waitcnt vmcnt(4)
  v_lshlrev_b32 v44, 16, v148
  v_and_b32 v45, 0xffff0000, v148
  v_lshlrev_b32 v46, 16, v149
  v_and_b32 v47, 0xffff0000, v149
  v_lshlrev_b32 v48, 16, v150
  v_and_b32 v49, 0xffff0000, v150
  v_lshlrev_b32 v50, 16, v151
  v_and_b32 v51, 0xffff0000, v151
  v_pk_fma_f32 v[126:127], v[44:45], v[44:45], v[126:127]
  v_pk_add_f32 v[124:125], v[44:45], v[124:125]
  v_pk_fma_f32 v[130:131], v[46:47], v[46:47], v[130:131]
  v_pk_add_f32 v[128:129], v[46:47], v[128:129]
  v_pk_fma_f32 v[126:127], v[48:49], v[48:49], v[126:127]
  v_pk_add_f32 v[124:125], v[48:49], v[124:125]
  v_pk_fma_f32 v[130:131], v[50:51], v[50:51], v[130:131]
  v_pk_add_f32 v[128:129], v[50:51], v[128:129]
  v_pk_add_f32 v[124:125], v[124:125], v[128:129]
  v_pk_add_f32 v[126:127], v[126:127], v[130:131]
  v_add_f32 v180, v124, v125
  v_add_f32 v181, v126, v127
  s_waitcnt vmcnt(3)
  v_lshlrev_b32 v52, 16, v152
  v_and_b32 v53, 0xffff0000, v152
  v_lshlrev_b32 v54, 16, v153
  v_and_b32 v55, 0xffff0000, v153
  v_lshlrev_b32 v56, 16, v154
  v_and_b32 v57, 0xffff0000, v154
  v_lshlrev_b32 v58, 16, v155
  v_and_b32 v59, 0xffff0000, v155
  v_pk_mul_f32 v[126:127], v[52:53], v[52:53]
  v_pk_mul_f32 v[130:131], v[54:55], v[54:55]
  v_pk_fma_f32 v[126:127], v[56:57], v[56:57], v[126:127]
  v_pk_add_f32 v[124:125], v[56:57], v[52:53]
  v_pk_fma_f32 v[130:131], v[58:59], v[58:59], v[130:131]
  v_pk_add_f32 v[128:129], v[58:59], v[54:55]
  s_waitcnt vmcnt(2)
  v_lshlrev_b32 v60, 16, v156
  v_and_b32 v61, 0xffff0000, v156
  v_lshlrev_b32 v62, 16, v157
  v_and_b32 v63, 0xffff0000, v157
  v_lshlrev_b32 v64, 16, v158
  v_and_b32 v65, 0xffff0000, v158
  v_lshlrev_b32 v66, 16, v159
  v_and_b32 v67, 0xffff0000, v159
  v_pk_fma_f32 v[126:127], v[60:61], v[60:61], v[126:127]
  v_pk_add_f32 v[124:125], v[60:61], v[124:125]
  v_pk_fma_f32 v[130:131], v[62:63], v[62:63], v[130:131]
  v_pk_add_f32 v[128:129], v[62:63], v[128:129]
  v_pk_fma_f32 v[126:127], v[64:65], v[64:65], v[126:127]
  v_pk_add_f32 v[124:125], v[64:65], v[124:125]
  v_pk_fma_f32 v[130:131], v[66:67], v[66:67], v[130:131]
  v_pk_add_f32 v[128:129], v[66:67], v[128:129]
  s_waitcnt vmcnt(1)
  v_lshlrev_b32 v68, 16, v160
  v_and_b32 v69, 0xffff0000, v160
  v_lshlrev_b32 v70, 16, v161
  v_and_b32 v71, 0xffff0000, v161
  v_lshlrev_b32 v72, 16, v162
  v_and_b32 v73, 0xffff0000, v162
  v_lshlrev_b32 v74, 16, v163
  v_and_b32 v75, 0xffff0000, v163
  v_pk_fma_f32 v[126:127], v[68:69], v[68:69], v[126:127]
  v_pk_add_f32 v[124:125], v[68:69], v[124:125]
  v_pk_fma_f32 v[130:131], v[70:71], v[70:71], v[130:131]
  v_pk_add_f32 v[128:129], v[70:71], v[128:129]
  v_pk_fma_f32 v[126:127], v[72:73], v[72:73], v[126:127]
  v_pk_add_f32 v[124:125], v[72:73], v[124:125]
  v_pk_fma_f32 v[130:131], v[74:75], v[74:75], v[130:131]
  v_pk_add_f32 v[128:129], v[74:75], v[128:129]
  s_waitcnt vmcnt(0)
  v_lshlrev_b32 v76, 16, v164
  v_and_b32 v77, 0xffff0000, v164
  v_lshlrev_b32 v78, 16, v165
  v_and_b32 v79, 0xffff0000, v165
  v_lshlrev_b32 v80, 16, v166
  v_and_b32 v81, 0xffff0000, v166
  v_lshlrev_b32 v82, 16, v167
  v_and_b32 v83, 0xffff0000, v167
  v_pk_fma_f32 v[126:127], v[76:77], v[76:77], v[126:127]
  v_pk_add_f32 v[124:125], v[76:77], v[124:125]
  v_pk_fma_f32 v[130:131], v[78:79], v[78:79], v[130:131]
  v_pk_add_f32 v[128:129], v[78:79], v[128:129]
  v_pk_fma_f32 v[126:127], v[80:81], v[80:81], v[126:127]
  v_pk_add_f32 v[124:125], v[80:81], v[124:125]
  v_pk_fma_f32 v[130:131], v[82:83], v[82:83], v[130:131]
  v_pk_add_f32 v[128:129], v[82:83], v[128:129]
  v_pk_add_f32 v[124:125], v[124:125], v[128:129]
  v_pk_add_f32 v[126:127], v[126:127], v[130:131]
  v_add_f32 v182, v124, v125
  v_add_f32 v183, v126, v127
  s_nop 0
  v_add_f32_dpp v188, v180, v180 row_ror:8 row_mask:0xf bank_mask:0xf
  v_add_f32_dpp v189, v181, v181 row_ror:8 row_mask:0xf bank_mask:0xf
  v_add_f32_dpp v190, v182, v182 row_ror:8 row_mask:0xf bank_mask:0xf
  v_add_f32_dpp v191, v183, v183 row_ror:8 row_mask:0xf bank_mask:0xf
  v_mov_b32 v180, v188
  v_mov_b32 v181, v189
  v_mov_b32 v182, v190
  v_mov_b32 v183, v191
  v_permlane16_swap_b32 v188, v180
  v_permlane16_swap_b32 v189, v181
  v_permlane16_swap_b32 v190, v182
  v_permlane16_swap_b32 v191, v183
  v_pk_add_f32 v[188:189], v[188:189], v[180:181]
  v_pk_add_f32 v[190:191], v[190:191], v[182:183]
  v_mov_b32 v180, v188
  v_mov_b32 v181, v189
  v_mov_b32 v182, v190
  v_mov_b32 v183, v191
  v_permlane32_swap_b32 v188, v180
  v_permlane32_swap_b32 v189, v181
  v_permlane32_swap_b32 v190, v182
  v_permlane32_swap_b32 v191, v183
  v_pk_add_f32 v[188:189], v[188:189], v[180:181]
  v_pk_add_f32 v[190:191], v[190:191], v[182:183]
  ds_write_b128 v16, v[188:191]
  s_waitcnt lgkmcnt(0)
  s_barrier
  ds_read_b128 v[136:139], v17 offset:0
  ds_read_b128 v[140:143], v17 offset:16
  ds_read_b128 v[144:147], v17 offset:32
  ds_read_b128 v[148:151], v17 offset:48
  s_lshl_b32 s49, s44, 10
  buffer_load_dwordx4 v[220:223], v0, s[36:39], s49 offen sc1
  s_add_u32 s49, s49, 4096
  buffer_load_dwordx4 v[84:87], v0, s[36:39], s49 offen sc1
  s_add_u32 s49, s49, 20480
  buffer_load_dwordx4 v[224:227], v0, s[36:39], s49 offen sc1
  s_add_u32 s49, s49, 4096
  buffer_load_dwordx4 v[88:91], v0, s[36:39], s49 offen sc1
  s_add_u32 s49, s49, 20480
  buffer_load_dwordx4 v[228:231], v0, s[36:39], s49 offen sc1
  s_add_u32 s49, s49, 4096
  buffer_load_dwordx4 v[92:95], v0, s[36:39], s49 offen sc1
  s_add_u32 s49, s49, 20480
  buffer_load_dwordx4 v[232:235], v0, s[36:39], s49 offen sc1
  s_add_u32 s49, s49, 4096
  buffer_load_dwordx4 v[96:99], v0, s[36:39], s49 offen sc1
  s_waitcnt lgkmcnt(0)
  v_pk_add_f32 v[136:137], v[136:137], v[144:145]
  v_pk_add_f32 v[138:139], v[138:139], v[146:147]
  v_pk_add_f32 v[140:141], v[140:141], v[148:149]
  v_pk_add_f32 v[142:143], v[142:143], v[150:151]
  v_pk_add_f32 v[136:137], v[136:137], v[140:141]
  v_pk_add_f32 v[138:139], v[138:139], v[142:143]
  v_mul_f32 v188, 0x3a800000, v136
  v_mul_f32 v189, 0x3a800000, v137
  v_mul_f32 v190, 0x3a800000, v138
  v_mul_f32 v191, 0x3a800000, v139
  v_fma_f32 v189, -v188, v188, v189
  v_fma_f32 v191, -v190, v190, v191
  v_max_f32 v189, 0, v189
  v_max_f32 v191, 0, v191
  v_cvt_pk_bf16_f32 v189, v189, v189
  v_cvt_pk_bf16_f32 v191, v191, v191
  v_lshlrev_b32 v189, 16, v189
  v_lshlrev_b32 v191, 16, v191
  v_add_f32 v189, 0x3727c5ac, v189
  v_add_f32 v191, 0x3727c5ac, v191
  v_cvt_pk_bf16_f32 v189, v189, v189
  v_cvt_pk_bf16_f32 v191, v191, v191
  v_lshlrev_b32 v189, 16, v189
  v_lshlrev_b32 v191, 16, v191
  v_sqrt_f32 v189, v189
  v_sqrt_f32 v191, v191
  v_cvt_pk_bf16_f32 v188, v188, v188
  v_cvt_pk_bf16_f32 v190, v190, v190
  v_lshlrev_b32 v188, 16, v188
  v_lshlrev_b32 v190, 16, v190
  v_cvt_pk_bf16_f32 v189, v189, v189
  v_cvt_pk_bf16_f32 v191, v191, v191
  v_lshlrev_b32 v189, 16, v189
  v_lshlrev_b32 v191, 16, v191
  v_rcp_f32 v189, v189
  v_rcp_f32 v191, v191
  v_mul_f32 v188, -v188, v189
  v_mul_f32 v190, -v190, v191
  v_pk_fma_f32 v[20:21], v[20:21], v[188:189], v[188:189] op_sel:[0,1,0] op_sel_hi:[1,1,0]
  v_pk_fma_f32 v[22:23], v[22:23], v[188:189], v[188:189] op_sel:[0,1,0] op_sel_hi:[1,1,0]
  v_pk_fma_f32 v[24:25], v[24:25], v[188:189], v[188:189] op_sel:[0,1,0] op_sel_hi:[1,1,0]
  v_pk_fma_f32 v[26:27], v[26:27], v[188:189], v[188:189] op_sel:[0,1,0] op_sel_hi:[1,1,0]
  v_pk_fma_f32 v[28:29], v[28:29], v[188:189], v[188:189] op_sel:[0,1,0] op_sel_hi:[1,1,0]
  v_pk_fma_f32 v[30:31], v[30:31], v[188:189], v[188:189] op_sel:[0,1,0] op_sel_hi:[1,1,0]
  v_pk_fma_f32 v[32:33], v[32:33], v[188:189], v[188:189] op_sel:[0,1,0] op_sel_hi:[1,1,0]
  v_pk_fma_f32 v[34:35], v[34:35], v[188:189], v[188:189] op_sel:[0,1,0] op_sel_hi:[1,1,0]
  v_pk_fma_f32 v[36:37], v[36:37], v[188:189], v[188:189] op_sel:[0,1,0] op_sel_hi:[1,1,0]
  v_pk_fma_f32 v[38:39], v[38:39], v[188:189], v[188:189] op_sel:[0,1,0] op_sel_hi:[1,1,0]
  v_pk_fma_f32 v[40:41], v[40:41], v[188:189], v[188:189] op_sel:[0,1,0] op_sel_hi:[1,1,0]
  v_pk_fma_f32 v[42:43], v[42:43], v[188:189], v[188:189] op_sel:[0,1,0] op_sel_hi:[1,1,0]
  v_pk_fma_f32 v[44:45], v[44:45], v[188:189], v[188:189] op_sel:[0,1,0] op_sel_hi:[1,1,0]
  v_pk_fma_f32 v[46:47], v[46:47], v[188:189], v[188:189] op_sel:[0,1,0] op_sel_hi:[1,1,0]
  v_pk_fma_f32 v[48:49], v[48:49], v[188:189], v[188:189] op_sel:[0,1,0] op_sel_hi:[1,1,0]
  v_pk_fma_f32 v[50:51], v[50:51], v[188:189], v[188:189] op_sel:[0,1,0] op_sel_hi:[1,1,0]
  v_pk_fma_f32 v[52:53], v[52:53], v[190:191], v[190:191] op_sel:[0,1,0] op_sel_hi:[1,1,0]
  v_pk_fma_f32 v[54:55], v[54:55], v[190:191], v[190:191] op_sel:[0,1,0] op_sel_hi:[1,1,0]
  v_pk_fma_f32 v[56:57], v[56:57], v[190:191], v[190:191] op_sel:[0,1,0] op_sel_hi:[1,1,0]
  v_pk_fma_f32 v[58:59], v[58:59], v[190:191], v[190:191] op_sel:[0,1,0] op_sel_hi:[1,1,0]
  v_pk_fma_f32 v[60:61], v[60:61], v[190:191], v[190:191] op_sel:[0,1,0] op_sel_hi:[1,1,0]
  v_pk_fma_f32 v[62:63], v[62:63], v[190:191], v[190:191] op_sel:[0,1,0] op_sel_hi:[1,1,0]
  v_pk_fma_f32 v[64:65], v[64:65], v[190:191], v[190:191] op_sel:[0,1,0] op_sel_hi:[1,1,0]
  v_pk_fma_f32 v[66:67], v[66:67], v[190:191], v[190:191] op_sel:[0,1,0] op_sel_hi:[1,1,0]
  v_pk_fma_f32 v[68:69], v[68:69], v[190:191], v[190:191] op_sel:[0,1,0] op_sel_hi:[1,1,0]
  v_pk_fma_f32 v[70:71], v[70:71], v[190:191], v[190:191] op_sel:[0,1,0] op_sel_hi:[1,1,0]
  v_pk_fma_f32 v[72:73], v[72:73], v[190:191], v[190:191] op_sel:[0,1,0] op_sel_hi:[1,1,0]
  v_pk_fma_f32 v[74:75], v[74:75], v[190:191], v[190:191] op_sel:[0,1,0] op_sel_hi:[1,1,0]
  v_pk_fma_f32 v[76:77], v[76:77], v[190:191], v[190:191] op_sel:[0,1,0] op_sel_hi:[1,1,0]
  v_pk_fma_f32 v[78:79], v[78:79], v[190:191], v[190:191] op_sel:[0,1,0] op_sel_hi:[1,1,0]
  v_pk_fma_f32 v[80:81], v[80:81], v[190:191], v[190:191] op_sel:[0,1,0] op_sel_hi:[1,1,0]
  v_pk_fma_f32 v[82:83], v[82:83], v[190:191], v[190:191] op_sel:[0,1,0] op_sel_hi:[1,1,0]
  s_mov_b32 s46, 30000
  s_branch PLC
PLP:
  s_lshl_b32 s49, s44, 10
  buffer_load_dwordx4 v[220:223], v0, s[36:39], s49 offen sc1
  s_add_u32 s49, s49, 4096
  buffer_load_dwordx4 v[84:87], v0, s[36:39], s49 offen sc1
  s_add_u32 s49, s49, 20480
  buffer_load_dwordx4 v[224:227], v0, s[36:39], s49 offen sc1
  s_add_u32 s49, s49, 4096
  buffer_load_dwordx4 v[88:91], v0, s[36:39], s49 offen sc1
  s_add_u32 s49, s49, 20480
  buffer_load_dwordx4 v[228:231], v0, s[36:39], s49 offen sc1
  s_add_u32 s49, s49, 4096
  buffer_load_dwordx4 v[92:95], v0, s[36:39], s49 offen sc1
  s_add_u32 s49, s49, 20480
  buffer_load_dwordx4 v[232:235], v0, s[36:39], s49 offen sc1
  s_add_u32 s49, s49, 4096
  buffer_load_dwordx4 v[96:99], v0, s[36:39], s49 offen sc1
PLC:
  s_waitcnt vmcnt(7)
  v_xor_b32 v220, s66, v220
  v_xor_b32 v221, s67, v221
  v_xor_b32 v222, s68, v222
  v_xor_b32 v223, s69, v223
  v_or3_b32 v184, 0, v220, v221
  v_or3_b32 v184, v184, v222, v223
  s_waitcnt vmcnt(6)
  v_xor_b32 v84, s66, v84
  v_xor_b32 v85, s67, v85
  v_xor_b32 v86, s68, v86
  v_xor_b32 v87, s69, v87
  v_or3_b32 v184, v184, v84, v85
  v_or3_b32 v184, v184, v86, v87
  s_waitcnt vmcnt(5)
  v_xor_b32 v224, s66, v224
  v_xor_b32 v225, s67, v225
  v_xor_b32 v226, s68, v226
  v_xor_b32 v227, s69, v227
  v_or3_b32 v184, v184, v224, v225
  v_or3_b32 v184, v184, v226, v227
  s_waitcnt vmcnt(4)
  v_xor_b32 v88, s66, v88
  v_xor_b32 v89, s67, v89
  v_xor_b32 v90, s68, v90
  v_xor_b32 v91, s69, v91
  v_or3_b32 v184, v184, v88, v89
  v_or3_b32 v184, v184, v90, v91
  s_waitcnt vmcnt(3)
  v_xor_b32 v228, s66, v228
  v_xor_b32 v229, s67, v229
  v_xor_b32 v230, s68, v230
  v_xor_b32 v231, s69, v231
  v_or3_b32 v184, v184, v228, v229
  v_or3_b32 v184, v184, v230, v231
  s_waitcnt vmcnt(2)
  v_xor_b32 v92, s66, v92
  v_xor_b32 v93, s67, v93
  v_xor_b32 v94, s68, v94
  v_xor_b32 v95, s69, v95
  v_or3_b32 v184, v184, v92, v93
  v_or3_b32 v184, v184, v94, v95
  s_waitcnt vmcnt(1)
  v_xor_b32 v232, s66, v232
  v_xor_b32 v233, s67, v233
  v_xor_b32 v234, s68, v234
  v_xor_b32 v235, s69, v235
  v_or3_b32 v184, v184, v232, v233
  v_or3_b32 v184, v184, v234, v235
  s_waitcnt vmcnt(0)
  v_xor_b32 v96, s66, v96
  v_xor_b32 v97, s67, v97
  v_xor_b32 v98, s68, v98
  v_xor_b32 v99, s69, v99
  v_or3_b32 v184, v184, v96, v97
  v_or3_b32 v184, v184, v98, v99
  v_and_b32 v184, 0xff, v184
  v_cmp_ne_u32 vcc, 0, v184
  s_sub_u32 s46, s46, 1
  s_cmp_eq_u32 s46, 0
  s_cbranch_scc1 PLX
  s_nop 1
  s_cbranch_vccnz PLP
PLX:
  v_mov_b32 v180, -1
  v_mov_b32 v181, -1
  v_mov_b32 v182, -1
  v_mov_b32 v183, -1
  buffer_store_dwordx4 v[180:183], v0, s[36:39], s70 offen sc1
  buffer_store_dword v180, v178, s[36:39], s71 offen sc1
  v_pk_add_f32 v[84:85], v[84:85], v[92:93]
  v_pk_add_f32 v[220:221], v[220:221], v[228:229]
  v_pk_add_f32 v[86:87], v[86:87], v[94:95]
  v_pk_add_f32 v[222:223], v[222:223], v[230:231]
  v_pk_add_f32 v[88:89], v[88:89], v[96:97]
  v_pk_add_f32 v[224:225], v[224:225], v[232:233]
  v_pk_add_f32 v[90:91], v[90:91], v[98:99]
  v_pk_add_f32 v[226:227], v[226:227], v[234:235]
  v_pk_add_f32 v[84:85], v[84:85], v[88:89]
  v_pk_add_f32 v[220:221], v[220:221], v[224:225]
  v_pk_add_f32 v[86:87], v[86:87], v[90:91]
  v_pk_add_f32 v[222:223], v[222:223], v[226:227]
  v_cvt_pk_bf16_f32 v184, v220, v221
  v_lshlrev_b32 v220, 16, v184
  v_and_b32 v221, 0xffff0000, v184
  v_cvt_pk_bf16_f32 v184, v222, v223
  v_lshlrev_b32 v222, 16, v184
  v_and_b32 v223, 0xffff0000, v184
  ds_write_b128 v14, v[220:223] offset:1024
  v_cvt_pk_bf16_f32 v184, v84, v85
  v_lshlrev_b32 v84, 16, v184
  v_and_b32 v85, 0xffff0000, v184
  v_pk_add_f32 v[84:85], v[84:85], 1.0 op_sel_hi:[1,0]
  v_cvt_pk_bf16_f32 v184, v84, v85
  v_lshlrev_b32 v84, 16, v184
  v_and_b32 v85, 0xffff0000, v184
  v_cvt_pk_bf16_f32 v184, v86, v87
  v_lshlrev_b32 v86, 16, v184
  v_and_b32 v87, 0xffff0000, v184
  v_pk_add_f32 v[86:87], v[86:87], 1.0 op_sel_hi:[1,0]
  v_cvt_pk_bf16_f32 v184, v86, v87
  v_lshlrev_b32 v86, 16, v184
  v_and_b32 v87, 0xffff0000, v184
  ds_write_b128 v14, v[84:87]
  ds_read_b128 v[220:223], v15 offset:1024
  ds_read_b128 v[84:87], v15 offset:0
  ds_read_b128 v[224:227], v15 offset:1040
  ds_read_b128 v[88:91], v15 offset:16
  ds_read_b128 v[228:231], v15 offset:1280
  ds_read_b128 v[92:95], v15 offset:256
  ds_read_b128 v[232:235], v15 offset:1296
  ds_read_b128 v[96:99], v15 offset:272
  ds_read_b128 v[236:239], v15 offset:1536
  ds_read_b128 v[100:103], v15 offset:512
  ds_read_b128 v[240:243], v15 offset:1552
  ds_read_b128 v[104:107], v15 offset:528
  ds_read_b128 v[244:247], v15 offset:1792
  ds_read_b128 v[108:111], v15 offset:768
  ds_read_b128 v[248:251], v15 offset:1808
  ds_read_b128 v[112:115], v15 offset:784
  s_waitcnt lgkmcnt(12)
  v_pk_fma_f32 v[20:21], v[20:21], v[84:85], v[220:221]
  v_pk_fma_f32 v[22:23], v[22:23], v[86:87], v[222:223]
  v_pk_fma_f32 v[24:25], v[24:25], v[88:89], v[224:225]
  v_pk_fma_f32 v[26:27], v[26:27], v[90:91], v[226:227]
  v_pk_fma_f32 v[52:53], v[52:53], v[84:85], v[220:221]
  v_pk_fma_f32 v[54:55], v[54:55], v[86:87], v[222:223]
  v_pk_fma_f32 v[56:57], v[56:57], v[88:89], v[224:225]
  v_pk_fma_f32 v[58:59], v[58:59], v[90:91], v[226:227]
  v_cvt_pk_bf16_f32 v136, v20, v21
  v_cvt_pk_bf16_f32 v137, v22, v23
  v_cvt_pk_bf16_f32 v138, v24, v25
  v_cvt_pk_bf16_f32 v139, v26, v27
  v_cvt_pk_bf16_f32 v152, v52, v53
  v_cvt_pk_bf16_f32 v153, v54, v55
  v_cvt_pk_bf16_f32 v154, v56, v57
  v_cvt_pk_bf16_f32 v155, v58, v59
  v_permlane16_swap_b32 v136, v138
  v_permlane16_swap_b32 v137, v139
  v_permlane16_swap_b32 v152, v154
  v_permlane16_swap_b32 v153, v155
  buffer_store_dwordx4 v[136:139], v132, s[36:39], s50 offen offset:0 sc1
  buffer_store_dwordx4 v[152:155], v132, s[36:39], s50 offen offset:128 sc1
  s_add_u32 s50, s50, 4096
  s_waitcnt lgkmcnt(8)
  v_pk_fma_f32 v[28:29], v[28:29], v[92:93], v[228:229]
  v_pk_fma_f32 v[30:31], v[30:31], v[94:95], v[230:231]
  v_pk_fma_f32 v[32:33], v[32:33], v[96:97], v[232:233]
  v_pk_fma_f32 v[34:35], v[34:35], v[98:99], v[234:235]
  v_pk_fma_f32 v[60:61], v[60:61], v[92:93], v[228:229]
  v_pk_fma_f32 v[62:63], v[62:63], v[94:95], v[230:231]
  v_pk_fma_f32 v[64:65], v[64:65], v[96:97], v[232:233]
  v_pk_fma_f32 v[66:67], v[66:67], v[98:99], v[234:235]
  v_cvt_pk_bf16_f32 v140, v28, v29
  v_cvt_pk_bf16_f32 v141, v30, v31
  v_cvt_pk_bf16_f32 v142, v32, v33
  v_cvt_pk_bf16_f32 v143, v34, v35
  v_cvt_pk_bf16_f32 v156, v60, v61
  v_cvt_pk_bf16_f32 v157, v62, v63
  v_cvt_pk_bf16_f32 v158, v64, v65
  v_cvt_pk_bf16_f32 v159, v66, v67
  v_permlane16_swap_b32 v140, v142
  v_permlane16_swap_b32 v141, v143
  v_permlane16_swap_b32 v156, v158
  v_permlane16_swap_b32 v157, v159
  buffer_store_dwordx4 v[140:143], v132, s[36:39], s50 offen offset:0 sc1
  buffer_store_dwordx4 v[156:159], v132, s[36:39], s50 offen offset:128 sc1
  s_add_u32 s50, s50, 4096
  s_waitcnt lgkmcnt(4)
  v_pk_fma_f32 v[36:37], v[36:37], v[100:101], v[236:237]
  v_pk_fma_f32 v[38:39], v[38:39], v[102:103], v[238:239]
  v_pk_fma_f32 v[40:41], v[40:41], v[104:105], v[240:241]
  v_pk_fma_f32 v[42:43], v[42:43], v[106:107], v[242:243]
  v_pk_fma_f32 v[68:69], v[68:69], v[100:101], v[236:237]
  v_pk_fma_f32 v[70:71], v[70:71], v[102:103], v[238:239]
  v_pk_fma_f32 v[72:73], v[72:73], v[104:105], v[240:241]
  v_pk_fma_f32 v[74:75], v[74:75], v[106:107], v[242:243]
  v_cvt_pk_bf16_f32 v144, v36, v37
  v_cvt_pk_bf16_f32 v145, v38, v39
  v_cvt_pk_bf16_f32 v146, v40, v41
  v_cvt_pk_bf16_f32 v147, v42, v43
  v_cvt_pk_bf16_f32 v160, v68, v69
  v_cvt_pk_bf16_f32 v161, v70, v71
  v_cvt_pk_bf16_f32 v162, v72, v73
  v_cvt_pk_bf16_f32 v163, v74, v75
  v_permlane16_swap_b32 v144, v146
  v_permlane16_swap_b32 v145, v147
  v_permlane16_swap_b32 v160, v162
  v_permlane16_swap_b32 v161, v163
  buffer_store_dwordx4 v[144:147], v132, s[36:39], s50 offen offset:0 sc1
  buffer_store_dwordx4 v[160:163], v132, s[36:39], s50 offen offset:128 sc1
  s_add_u32 s50, s50, 4096
  s_waitcnt lgkmcnt(0)
  v_pk_fma_f32 v[44:45], v[44:45], v[108:109], v[244:245]
  v_pk_fma_f32 v[46:47], v[46:47], v[110:111], v[246:247]
  v_pk_fma_f32 v[48:49], v[48:49], v[112:113], v[248:249]
  v_pk_fma_f32 v[50:51], v[50:51], v[114:115], v[250:251]
  v_pk_fma_f32 v[76:77], v[76:77], v[108:109], v[244:245]
  v_pk_fma_f32 v[78:79], v[78:79], v[110:111], v[246:247]
  v_pk_fma_f32 v[80:81], v[80:81], v[112:113], v[248:249]
  v_pk_fma_f32 v[82:83], v[82:83], v[114:115], v[250:251]
  v_cvt_pk_bf16_f32 v148, v44, v45
  v_cvt_pk_bf16_f32 v149, v46, v47
  v_cvt_pk_bf16_f32 v150, v48, v49
  v_cvt_pk_bf16_f32 v151, v50, v51
  v_cvt_pk_bf16_f32 v164, v76, v77
  v_cvt_pk_bf16_f32 v165, v78, v79
  v_cvt_pk_bf16_f32 v166, v80, v81
  v_cvt_pk_bf16_f32 v167, v82, v83
  v_permlane16_swap_b32 v148, v150
  v_permlane16_swap_b32 v149, v151
  v_permlane16_swap_b32 v164, v166
  v_permlane16_swap_b32 v165, v167
  buffer_store_dwordx4 v[148:151], v132, s[36:39], s50 offen offset:0 sc1
  buffer_store_dwordx4 v[164:167], v132, s[36:39], s50 offen offset:128 sc1
  v_mov_b32 v12, s3
  s_waitcnt vmcnt(0) lgkmcnt(0)
  s_barrier
  s_mov_b64 exec, 1
  buffer_store_dword v12, v0, s[36:39], s45 offen sc1
  s_mov_b64 exec, -1
J2:
  s_mov_b32 s61, 0
  s_add_u32 m0, s63, 21504
  s_nop 0
  buffer_load_dwordx4 v202, s[8:11], s61 offen offset:0 lds
  s_mov_b32 s61, 2048
  s_add_u32 m0, s63, 43008
  s_nop 0
  buffer_load_dwordx4 v202, s[8:11], s61 offen offset:0 lds
  buffer_load_dwordx4 v203, s[8:11], s61 offen offset:1024 lds
  s_mov_b32 s61, 4096
  s_add_u32 m0, s63, 64512
  s_nop 0
  buffer_load_dwordx4 v202, s[8:11], s61 offen offset:0 lds
  buffer_load_dwordx4 v203, s[8:11], s61 offen offset:1024 lds
  buffer_load_dwordx4 v204, s[8:11], s61 offen offset:2048 lds
  s_mov_b32 s61, 196608
  s_add_u32 m0, s63, 86016
  s_nop 0
  buffer_load_dwordx4 v202, s[8:11], s61 offen offset:0 lds
  buffer_load_dwordx4 v203, s[8:11], s61 offen offset:1024 lds
  buffer_load_dwordx4 v204, s[8:11], s61 offen offset:2048 lds
  s_mov_b32 s61, 395264
  s_add_u32 m0, s63, 107520
  s_nop 0
  buffer_load_dwordx4 v202, s[8:11], s61 offen offset:0 lds
  buffer_load_dwordx4 v203, s[8:11], s61 offen offset:1024 lds
  buffer_load_dwordx4 v204, s[8:11], s61 offen offset:2048 lds
  s_mov_b64 exec, 0
  s_cmp_eq_u32 s44, 1
  s_cbranch_scc1 Ha0
  s_cmp_eq_u32 s44, 2
  s_cbranch_scc1 Ha1
  s_cmp_eq_u32 s44, 3
  s_cbranch_scc1 Ha2
Ra:
  s_mov_b64 exec, -1
  s_cmp_lg_u32 s44, 0
  s_cbranch_scc1 SM2x
  s_mov_b32 s46, 60000
  s_mov_b32 s47, 5242880
SM2:
  buffer_load_dword v12, v215, s[36:39], s47 offen sc1
  s_sub_u32 s46, s46, 1
  s_cmp_eq_u32 s46, 0
  s_waitcnt vmcnt(0)
  s_cbranch_scc1 SM2x
  v_cmp_ne_u32 vcc, s3, v12
  s_nop 4
  s_cbranch_vccnz SM2
SM2x:
  s_barrier
  s_mov_b32 s62, 0
  s_add_u32 m0, s64, 33792
  s_nop 0
  buffer_load_dwordx4 v205, s[36:39], s62 offen offset:0 sc1 lds
  buffer_load_dwordx4 v205, s[36:39], s62 offen offset:1024 sc1 lds
  s_add_u32 m0, s65, 41984
  s_nop 0
  buffer_load_dword v206, s[36:39], s62 offen sc1 lds
  s_mov_b32 s62, 2048
  s_add_u32 m0, s64, 55296
  s_nop 0
  buffer_load_dwordx4 v205, s[36:39], s62 offen offset:0 sc1 lds
  buffer_load_dwordx4 v205, s[36:39], s62 offen offset:1024 sc1 lds
  s_add_u32 m0, s65, 63488
  s_nop 0
  buffer_load_dword v206, s[36:39], s62 offen sc1 lds
  s_mov_b32 s62, 4096
  s_add_u32 m0, s64, 76800
  s_nop 0
  buffer_load_dwordx4 v205, s[36:39], s62 offen offset:0 sc1 lds
  buffer_load_dwordx4 v205, s[36:39], s62 offen offset:1024 sc1 lds
  s_add_u32 m0, s65, 84992
  s_nop 0
  buffer_load_dword v206, s[36:39], s62 offen sc1 lds
  s_mov_b32 s62, 6144
  s_add_u32 m0, s64, 98304
  s_nop 0
  buffer_load_dwordx4 v205, s[36:39], s62 offen offset:0 sc1 lds
  buffer_load_dwordx4 v205, s[36:39], s62 offen offset:1024 sc1 lds
  s_add_u32 m0, s65, 106496
  s_nop 0
  buffer_load_dword v206, s[36:39], s62 offen sc1 lds
  s_waitcnt vmcnt(6)
  s_barrier
  ds_read_b64_tr_b16 a[80:81], v196 offset:21504
  ds_read_b64_tr_b16 a[82:83], v196 offset:27648
  ds_read_b64_tr_b16 a[84:85], v197 offset:21504
  ds_read_b64_tr_b16 a[86:87], v197 offset:27648
Ha0:
  s_cbranch_execz Ha0_1
  ds_read_b64_tr_b16 a[88:89], v196 offset:43008
  ds_read_b64_tr_b16 a[90:91], v196 offset:49152
  ds_read_b64_tr_b16 a[92:93], v196 offset:44032
  ds_read_b64_tr_b16 a[94:95], v196 offset:50176
  ds_read_b64_tr_b16 a[96:97], v197 offset:43008
  ds_read_b128 a[0:3], v207 offset:33792
  ds_read_b128 a[4:7], v207 offset:34816
  ds_read_b128 a[8:11], v207 offset:35840
  ds_read_b128 a[12:15], v207 offset:36864
  ds_read_b128 a[16:19], v210 offset:41984
  s_waitcnt lgkmcnt(0)
  v_mfma_f32_16x16x32_bf16 v[84:87], a[80:83], a[0:3], 0
  s_mov_b32 s62, 8192
  ds_read_b128 a[20:23], v207 offset:55296
  s_add_u32 m0, s64, 119808
  v_mfma_f32_16x16x32_bf16 v[88:91], a[80:83], a[4:7], 0
  s_waitcnt vmcnt(3)
  s_barrier
  ds_read_b128 a[24:27], v207 offset:56320
  v_mfma_f32_16x16x32_bf16 v[92:95], a[80:83], a[8:11], 0
  ds_read_b128 a[28:31], v207 offset:57344
  v_mfma_f32_16x16x32_bf16 v[96:99], a[80:83], a[12:15], 0
  s_waitcnt lgkmcnt(13)
  ds_read_b128 a[32:35], v207 offset:58368
  v_mfma_f32_16x16x32_bf16 v[112:115], a[84:87], a[12:15], 0
  ds_read_b128 a[36:39], v210 offset:63488
  v_mfma_f32_16x16x32_bf16 v[108:111], a[84:87], a[8:11], 0
  buffer_load_dwordx4 v205, s[36:39], s62 offen offset:0 sc1 lds
  v_mfma_f32_16x16x32_bf16 v[104:107], a[84:87], a[4:7], 0
  ds_read_b64_tr_b16 a[98:99], v197 offset:49152
  v_mfma_f32_16x16x32_bf16 v[100:103], a[84:87], a[0:3], 0
  s_waitcnt lgkmcnt(1)
  ds_read_b64_tr_b16 a[100:101], v197 offset:44032
  v_mfma_f32_16x16x32_bf16 v[20:23], a[88:91], a[0:3], 0
  ds_read_b64_tr_b16 a[102:103], v197 offset:50176
  v_mfma_f32_16x16x32_bf16 v[20:23], a[92:95], a[20:23], v[20:23]
  buffer_load_dwordx4 v205, s[36:39], s62 offen offset:1024 sc1 lds
  s_add_u32 m0, s65, 128000
  v_mfma_f32_16x16x32_bf16 v[24:27], a[92:95], a[24:27], 0
  ds_read_b128 a[40:43], v208 offset:12288
  v_mfma_f32_16x16x32_bf16 v[24:27], a[88:91], a[4:7], v[24:27]
  ds_read_b64_tr_b16 a[104:105], v198 offset:0
  v_mfma_f32_16x16x32_bf16 v[28:31], a[88:91], a[8:11], 0
  ds_read_b128 a[44:47], v208 offset:13312
  v_mfma_f32_16x16x32_bf16 v[28:31], a[92:95], a[28:31], v[28:31]
  buffer_load_dword v206, s[36:39], s62 offen sc1 lds
  s_mov_b32 s61, 593920
  v_mfma_f32_16x16x32_bf16 v[32:35], a[92:95], a[32:35], 0
  s_add_u32 m0, s63, 129024
  ds_read_b64_tr_b16 a[106:107], v198 offset:6144
  v_mfma_f32_16x16x32_bf16 v[32:35], a[88:91], a[12:15], v[32:35]
  ds_read_b128 a[48:51], v208 offset:14336
  v_mfma_f32_16x16x32_bf16 v[116:119], a[88:91], a[16:19], 0
  ds_read_b64_tr_b16 a[108:109], v198 offset:1024
  v_mfma_f32_16x16x32_bf16 v[116:119], a[92:95], a[36:39], v[116:119]
  s_waitcnt lgkmcnt(6)
  ds_read_b128 a[52:55], v208 offset:15360
  v_mfma_f32_16x16x32_bf16 v[48:51], a[96:99], a[12:15], 0
  buffer_load_dwordx4 v202, s[8:11], s61 offen offset:0 lds
  v_mfma_f32_16x16x32_bf16 v[48:51], a[100:103], a[32:35], v[48:51]
  ds_read_b128 a[56:59], v211 offset:20480
  v_mfma_f32_16x16x32_bf16 v[44:47], a[100:103], a[28:31], 0
  ds_read_b64_tr_b16 a[110:111], v198 offset:7168
  v_mfma_f32_16x16x32_bf16 v[44:47], a[96:99], a[8:11], v[44:47]
  ds_read_b64_tr_b16 a[112:113], v198 offset:2048
  v_mfma_f32_16x16x32_bf16 v[40:43], a[96:99], a[4:7], 0
  buffer_load_dwordx4 v203, s[8:11], s61 offen offset:1024 lds
  v_mfma_f32_16x16x32_bf16 v[40:43], a[100:103], a[24:27], v[40:43]
  ds_read_b64_tr_b16 a[114:115], v198 offset:8192
  v_mfma_f32_16x16x32_bf16 v[36:39], a[100:103], a[20:23], 0
  ds_read_b64_tr_b16 a[80:81], v199 offset:0
  v_mfma_f32_16x16x32_bf16 v[36:39], a[96:99], a[0:3], v[36:39]
  s_waitcnt lgkmcnt(1)
  ds_read_b64_tr_b16 a[82:83], v199 offset:6144
  v_mfma_f32_16x16x32_bf16 v[52:55], a[0:3], a[104:107], 0
  buffer_load_dwordx4 v204, s[8:11], s61 offen offset:2048 lds
  s_mov_b32 s62, 10240
  v_mfma_f32_16x16x32_bf16 v[52:55], a[20:23], a[108:111], v[52:55]
  s_add_u32 m0, s64, 141312
  ds_read_b64_tr_b16 a[84:85], v199 offset:1024
  v_mfma_f32_16x16x32_bf16 v[52:55], a[40:43], a[112:115], v[52:55]
  s_waitcnt vmcnt(6)
  s_barrier
  ds_read_b64_tr_b16 a[86:87], v199 offset:7168
  v_mfma_f32_16x16x32_bf16 v[56:59], a[44:47], a[112:115], 0
  ds_read_b64_tr_b16 a[88:89], v199 offset:2048
  v_mfma_f32_16x16x32_bf16 v[56:59], a[24:27], a[108:111], v[56:59]
  buffer_load_dwordx4 v205, s[36:39], s62 offen offset:0 sc1 lds
  v_mfma_f32_16x16x32_bf16 v[56:59], a[4:7], a[104:107], v[56:59]
  ds_read_b64_tr_b16 a[90:91], v199 offset:8192
  v_mfma_f32_16x16x32_bf16 v[60:63], a[8:11], a[104:107], 0
  ds_read_b128 a[60:63], v208 offset:33792
  v_mfma_f32_16x16x32_bf16 v[60:63], a[28:31], a[108:111], v[60:63]
  ds_read_b64_tr_b16 a[92:93], v198 offset:21504
  v_mfma_f32_16x16x32_bf16 v[60:63], a[48:51], a[112:115], v[60:63]
  buffer_load_dwordx4 v205, s[36:39], s62 offen offset:1024 sc1 lds
  s_add_u32 m0, s65, 149504
  v_mfma_f32_16x16x32_bf16 v[64:67], a[52:55], a[112:115], 0
  ds_read_b128 a[64:67], v208 offset:34816
  v_mfma_f32_16x16x32_bf16 v[64:67], a[32:35], a[108:111], v[64:67]
  ds_read_b64_tr_b16 a[94:95], v198 offset:27648
  v_mfma_f32_16x16x32_bf16 v[64:67], a[12:15], a[104:107], v[64:67]
  ds_read_b128 a[68:71], v208 offset:35840
  v_mfma_f32_16x16x32_bf16 v[120:123], a[16:19], a[104:107], 0
  buffer_load_dword v206, s[36:39], s62 offen sc1 lds
  s_mov_b32 s61, 786432
  v_mfma_f32_16x16x32_bf16 v[120:123], a[36:39], a[108:111], v[120:123]
  s_add_u32 m0, s63, 0
  ds_read_b64_tr_b16 a[96:97], v198 offset:22528
  v_mfma_f32_16x16x32_bf16 v[120:123], a[56:59], a[112:115], v[120:123]
  s_waitcnt lgkmcnt(6)
  ds_read_b128 a[72:75], v208 offset:36864
  v_mfma_f32_16x16x32_bf16 v[80:83], a[12:15], a[80:83], 0
  ds_read_b64_tr_b16 a[98:99], v198 offset:28672
  v_mfma_f32_16x16x32_bf16 v[80:83], a[32:35], a[84:87], v[80:83]
  buffer_load_dwordx4 v202, s[8:11], s61 offen offset:0 lds
  v_mfma_f32_16x16x32_bf16 v[80:83], a[52:55], a[88:91], v[80:83]
  ds_read_b128 a[76:79], v211 offset:41984
  v_mfma_f32_16x16x32_bf16 v[76:79], a[48:51], a[88:91], 0
  ds_read_b64_tr_b16 a[100:101], v198 offset:23552
  v_mfma_f32_16x16x32_bf16 v[76:79], a[28:31], a[84:87], v[76:79]
  ds_read_b64_tr_b16 a[102:103], v198 offset:29696
  v_mfma_f32_16x16x32_bf16 v[76:79], a[8:11], a[80:83], v[76:79]
  buffer_load_dwordx4 v203, s[8:11], s61 offen offset:1024 lds
  v_mfma_f32_16x16x32_bf16 v[72:75], a[4:7], a[80:83], 0
  ds_read_b64_tr_b16 a[104:105], v199 offset:21504
  v_mfma_f32_16x16x32_bf16 v[72:75], a[24:27], a[84:87], v[72:75]
  ds_read_b64_tr_b16 a[106:107], v199 offset:27648
  v_mfma_f32_16x16x32_bf16 v[72:75], a[44:47], a[88:91], v[72:75]
  ds_read_b64_tr_b16 a[108:109], v199 offset:22528
  v_mfma_f32_16x16x32_bf16 v[68:71], a[40:43], a[88:91], 0
  buffer_load_dwordx4 v204, s[8:11], s61 offen offset:2048 lds
  s_mov_b32 s62, 12288
  v_mfma_f32_16x16x32_bf16 v[68:71], a[20:23], a[84:87], v[68:71]
  s_add_u32 m0, s64, 12288
  ds_read_b64_tr_b16 a[110:111], v199 offset:28672
  v_mfma_f32_16x16x32_bf16 v[68:71], a[0:3], a[80:83], v[68:71]
  s_waitcnt vmcnt(9) lgkmcnt(4)
  s_barrier
  v_mfma_f32_16x16x32_bf16 v[84:87], a[92:95], a[20:23], v[84:87]
  ds_read_b64_tr_b16 a[112:113], v199 offset:23552
  v_mfma_f32_16x16x32_bf16 v[84:87], a[96:99], a[40:43], v[84:87]
  buffer_load_dwordx4 v205, s[36:39], s62 offen offset:0 sc1 lds
  v_mfma_f32_16x16x32_bf16 v[84:87], a[100:103], a[60:63], v[84:87]
  ds_read_b64_tr_b16 a[114:115], v199 offset:29696
  v_mfma_f32_16x16x32_bf16 v[88:91], a[100:103], a[64:67], v[88:91]
  ds_read_b128 a[0:3], v208 offset:55296
  v_mfma_f32_16x16x32_bf16 v[88:91], a[96:99], a[44:47], v[88:91]
  ds_read_b64_tr_b16 a[80:81], v198 offset:43008
  v_mfma_f32_16x16x32_bf16 v[88:91], a[92:95], a[24:27], v[88:91]
  buffer_load_dwordx4 v205, s[36:39], s62 offen offset:1024 sc1 lds
  s_add_u32 m0, s65, 20480
  v_mfma_f32_16x16x32_bf16 v[92:95], a[92:95], a[28:31], v[92:95]
  ds_read_b128 a[4:7], v208 offset:56320
  v_mfma_f32_16x16x32_bf16 v[92:95], a[96:99], a[48:51], v[92:95]
  ds_read_b64_tr_b16 a[82:83], v198 offset:49152
  v_mfma_f32_16x16x32_bf16 v[92:95], a[100:103], a[68:71], v[92:95]
  ds_read_b128 a[8:11], v208 offset:57344
  v_mfma_f32_16x16x32_bf16 v[96:99], a[100:103], a[72:75], v[96:99]
  buffer_load_dword v206, s[36:39], s62 offen sc1 lds
  s_mov_b32 s61, 985088
  v_mfma_f32_16x16x32_bf16 v[96:99], a[96:99], a[52:55], v[96:99]
  s_add_u32 m0, s63, 21504
  ds_read_b64_tr_b16 a[84:85], v198 offset:44032
  v_mfma_f32_16x16x32_bf16 v[96:99], a[92:95], a[32:35], v[96:99]
  s_waitcnt lgkmcnt(6)
  ds_read_b128 a[12:15], v208 offset:58368
  v_mfma_f32_16x16x32_bf16 v[112:115], a[104:107], a[32:35], v[112:115]
  ds_read_b128 a[16:19], v211 offset:63488
  v_mfma_f32_16x16x32_bf16 v[112:115], a[108:111], a[52:55], v[112:115]
  buffer_load_dwordx4 v202, s[8:11], s61 offen offset:0 lds
  v_mfma_f32_16x16x32_bf16 v[112:115], a[112:115], a[72:75], v[112:115]
  ds_read_b64_tr_b16 a[86:87], v198 offset:50176
  v_mfma_f32_16x16x32_bf16 v[108:111], a[112:115], a[68:71], v[108:111]
  ds_read_b64_tr_b16 a[88:89], v198 offset:45056
  v_mfma_f32_16x16x32_bf16 v[108:111], a[108:111], a[48:51], v[108:111]
  ds_read_b64_tr_b16 a[90:91], v198 offset:51200
  v_mfma_f32_16x16x32_bf16 v[108:111], a[104:107], a[28:31], v[108:111]
  buffer_load_dwordx4 v203, s[8:11], s61 offen offset:1024 lds
  v_mfma_f32_16x16x32_bf16 v[104:107], a[104:107], a[24:27], v[104:107]
  v_mfma_f32_16x16x32_bf16 v[104:107], a[108:111], a[44:47], v[104:107]
  ds_read_b64_tr_b16 a[92:93], v199 offset:43008
  v_mfma_f32_16x16x32_bf16 v[104:107], a[112:115], a[64:67], v[104:107]
  v_mfma_f32_16x16x32_bf16 v[100:103], a[112:115], a[60:63], v[100:103]
  buffer_load_dwordx4 v204, s[8:11], s61 offen offset:2048 lds
  s_mov_b32 s62, 14336
  v_mfma_f32_16x16x32_bf16 v[100:103], a[108:111], a[40:43], v[100:103]
  s_add_u32 m0, s64, 33792
  ds_read_b64_tr_b16 a[94:95], v199 offset:49152
  v_mfma_f32_16x16x32_bf16 v[100:103], a[104:107], a[20:23], v[100:103]
  s_waitcnt lgkmcnt(2)
  ds_read_b64_tr_b16 a[96:97], v199 offset:44032
  v_mfma_f32_16x16x32_bf16 v[20:23], a[80:83], a[40:43], v[20:23]
  v_mfma_f32_16x16x32_bf16 v[20:23], a[84:87], a[60:63], v[20:23]
  buffer_load_dwordx4 v205, s[36:39], s62 offen offset:0 sc1 lds
  v_mfma_f32_16x16x32_bf16 v[20:23], a[88:91], a[0:3], v[20:23]
  s_waitcnt vmcnt(10)
  s_barrier
  ds_read_b64_tr_b16 a[98:99], v199 offset:50176
  v_mfma_f32_16x16x32_bf16 v[24:27], a[88:91], a[4:7], v[24:27]
  ds_read_b64_tr_b16 a[100:101], v199 offset:45056
  v_mfma_f32_16x16x32_bf16 v[24:27], a[84:87], a[64:67], v[24:27]
  v_mfma_f32_16x16x32_bf16 v[24:27], a[80:83], a[44:47], v[24:27]
  buffer_load_dwordx4 v205, s[36:39], s62 offen offset:1024 sc1 lds
  s_add_u32 m0, s65, 41984
  v_mfma_f32_16x16x32_bf16 v[28:31], a[80:83], a[48:51], v[28:31]
  ds_read_b64_tr_b16 a[102:103], v199 offset:51200
  v_mfma_f32_16x16x32_bf16 v[28:31], a[84:87], a[68:71], v[28:31]
  ds_read_b128 a[20:23], v209 offset:12288
  v_mfma_f32_16x16x32_bf16 v[28:31], a[88:91], a[8:11], v[28:31]
  ds_read_b64_tr_b16 a[104:105], v200 offset:0
  v_mfma_f32_16x16x32_bf16 v[32:35], a[88:91], a[12:15], v[32:35]
  buffer_load_dword v206, s[36:39], s62 offen sc1 lds
  s_mov_b32 s61, 1183744
  v_mfma_f32_16x16x32_bf16 v[32:35], a[84:87], a[72:75], v[32:35]
  s_add_u32 m0, s63, 43008
  ds_read_b128 a[24:27], v209 offset:13312
  v_mfma_f32_16x16x32_bf16 v[32:35], a[80:83], a[52:55], v[32:35]
  ds_read_b64_tr_b16 a[106:107], v200 offset:6144
  v_mfma_f32_16x16x32_bf16 v[116:119], a[80:83], a[56:59], v[116:119]
  ds_read_b128 a[28:31], v209 offset:14336
  v_mfma_f32_16x16x32_bf16 v[116:119], a[84:87], a[76:79], v[116:119]
  buffer_load_dwordx4 v202, s[8:11], s61 offen offset:0 lds
  v_mfma_f32_16x16x32_bf16 v[116:119], a[88:91], a[16:19], v[116:119]
  s_waitcnt lgkmcnt(5)
  ds_read_b64_tr_b16 a[108:109], v200 offset:1024
  v_mfma_f32_16x16x32_bf16 v[48:51], a[92:95], a[52:55], v[48:51]
  ds_read_b128 a[32:35], v209 offset:15360
  v_mfma_f32_16x16x32_bf16 v[48:51], a[96:99], a[72:75], v[48:51]
  ds_read_b128 a[36:39], v212 offset:20480
  v_mfma_f32_16x16x32_bf16 v[48:51], a[100:103], a[12:15], v[48:51]
  buffer_load_dwordx4 v203, s[8:11], s61 offen offset:1024 lds
  v_mfma_f32_16x16x32_bf16 v[44:47], a[100:103], a[8:11], v[44:47]
  ds_read_b64_tr_b16 a[110:111], v200 offset:7168
  v_mfma_f32_16x16x32_bf16 v[44:47], a[96:99], a[68:71], v[44:47]
  ds_read_b64_tr_b16 a[112:113], v200 offset:2048
  v_mfma_f32_16x16x32_bf16 v[44:47], a[92:95], a[48:51], v[44:47]
  ds_read_b64_tr_b16 a[114:115], v200 offset:8192
  v_mfma_f32_16x16x32_bf16 v[40:43], a[92:95], a[44:47], v[40:43]
  buffer_load_dwordx4 v204, s[8:11], s61 offen offset:2048 lds
  s_mov_b32 s62, 16384
  v_mfma_f32_16x16x32_bf16 v[40:43], a[96:99], a[64:67], v[40:43]
  s_add_u32 m0, s64, 55296
  ds_read_b64_tr_b16 a[80:81], v201 offset:0
  v_mfma_f32_16x16x32_bf16 v[40:43], a[100:103], a[4:7], v[40:43]
  s_bfe_u32 s54, s2, 0x30003
  s_xor_b32 s54, s54, 1
  s_and_b32 s48, s2, 1
  v_mfma_f32_16x16x32_bf16 v[36:39], a[100:103], a[0:3], v[36:39]
  s_lshl1_add_u32 s53, s54, s48
  ds_read_b64_tr_b16 a[82:83], v201 offset:6144
  v_mfma_f32_16x16x32_bf16 v[36:39], a[96:99], a[60:63], v[36:39]
  buffer_load_dwordx4 v205, s[36:39], s62 offen offset:0 sc1 lds
  v_mfma_f32_16x16x32_bf16 v[36:39], a[92:95], a[40:43], v[36:39]
  s_waitcnt lgkmcnt(2)
  ds_read_b64_tr_b16 a[84:85], v201 offset:1024
  v_mfma_f32_16x16x32_bf16 v[52:55], a[60:63], a[104:107], v[52:55]
  v_mfma_f32_16x16x32_bf16 v[52:55], a[0:3], a[108:111], v[52:55]
  ds_read_b64_tr_b16 a[86:87], v201 offset:7168
  v_mfma_f32_16x16x32_bf16 v[52:55], a[20:23], a[112:115], v[52:55]
  s_waitcnt vmcnt(10)
  s_barrier
  buffer_load_dwordx4 v205, s[36:39], s62 offen offset:1024 sc1 lds
  v_mfma_f32_16x16x32_bf16 v[56:59], a[24:27], a[112:115], v[56:59]
  s_add_u32 m0, s65, 63488
  ds_read_b64_tr_b16 a[88:89], v201 offset:2048
  s_bfe_u32 s52, s2, 0x20001
  v_mfma_f32_16x16x32_bf16 v[56:59], a[4:7], a[108:111], v[56:59]
  s_lshr_b32 s49, s2, 6
  s_lshl2_add_u32 s52, s52, s49
  s_lshl_b32 s70, s44, 12
  v_mfma_f32_16x16x32_bf16 v[56:59], a[64:67], a[104:107], v[56:59]
  ds_read_b64_tr_b16 a[90:91], v201 offset:8192
  v_mfma_f32_16x16x32_bf16 v[60:63], a[68:71], a[104:107], v[60:63]
  buffer_load_dword v206, s[36:39], s62 offen sc1 lds
  s_mov_b32 s61, 1376256
  v_mfma_f32_16x16x32_bf16 v[60:63], a[8:11], a[108:111], v[60:63]
  s_add_u32 m0, s63, 64512
  ds_read_b128 a[40:43], v207 offset:12288
  v_mfma_f32_16x16x32_bf16 v[60:63], a[28:31], a[112:115], v[60:63]
  s_lshl_b32 s48, s53, 7
  ds_read_b64_tr_b16 a[92:93], v196 offset:0
  s_lshl_b32 s49, s44, 16
  v_mfma_f32_16x16x32_bf16 v[64:67], a[32:35], a[112:115], v[64:67]
  s_add_u32 s48, s48, s49
  ds_read_b128 a[44:47], v207 offset:13312
  v_lshrrev_b32 v12, 3, v10
  v_mfma_f32_16x16x32_bf16 v[64:67], a[12:15], a[108:111], v[64:67]
  buffer_load_dwordx4 v202, s[8:11], s61 offen offset:0 lds
  v_lshlrev_b32 v12, 11, v12
  v_mfma_f32_16x16x32_bf16 v[64:67], a[72:75], a[104:107], v[64:67]
  ds_read_b64_tr_b16 a[94:95], v196 offset:6144
  v_add3_u32 v216, v12, v213, s48
  v_mfma_f32_16x16x32_bf16 v[120:123], a[76:79], a[104:107], v[120:123]
  ds_read_b128 a[48:51], v207 offset:14336
  v_mfma_f32_16x16x32_bf16 v[120:123], a[16:19], a[108:111], v[120:123]
  ds_read_b64_tr_b16 a[96:97], v196 offset:1024
  v_mfma_f32_16x16x32_bf16 v[120:123], a[36:39], a[112:115], v[120:123]
  s_waitcnt lgkmcnt(6)
  buffer_load_dwordx4 v203, s[8:11], s61 offen offset:1024 lds
  v_mfma_f32_16x16x32_bf16 v[80:83], a[72:75], a[80:83], v[80:83]
  ds_read_b128 a[52:55], v207 offset:15360
  v_mfma_f32_16x16x32_bf16 v[80:83], a[12:15], a[84:87], v[80:83]
  ds_read_b64_tr_b16 a[98:99], v196 offset:7168
  v_mfma_f32_16x16x32_bf16 v[80:83], a[32:35], a[88:91], v[80:83]
  ds_read_b128 a[56:59], v210 offset:20480
  v_mfma_f32_16x16x32_bf16 v[76:79], a[28:31], a[88:91], v[76:79]
  buffer_load_dwordx4 v204, s[8:11], s61 offen offset:2048 lds
  s_mov_b32 s62, 18432
  v_mfma_f32_16x16x32_bf16 v[76:79], a[8:11], a[84:87], v[76:79]
  s_add_u32 m0, s64, 76800
  ds_read_b64_tr_b16 a[100:101], v196 offset:2048
  v_add_u32 v217, 15360, v216
  v_mfma_f32_16x16x32_bf16 v[76:79], a[68:71], a[80:83], v[76:79]
  ds_read_b64_tr_b16 a[102:103], v196 offset:8192
  v_add_u32 v218, 30720, v216
  v_mfma_f32_16x16x32_bf16 v[72:75], a[64:67], a[80:83], v[72:75]
  ds_read_b64_tr_b16 a[104:105], v197 offset:0
  v_add_u32 v219, 46080, v216
  v_mfma_f32_16x16x32_bf16 v[72:75], a[4:7], a[84:87], v[72:75]
  buffer_load_dwordx4 v205, s[36:39], s62 offen offset:0 sc1 lds
  v_mfma_f32_16x16x32_bf16 v[72:75], a[24:27], a[88:91], v[72:75]
  s_lshl_b32 s55, s52, 18
  ds_read_b64_tr_b16 a[106:107], v197 offset:6144
  s_add_u32 s55, s55, s48
  v_mfma_f32_16x16x32_bf16 v[68:71], a[20:23], a[88:91], v[68:71]
  ds_read_b64_tr_b16 a[108:109], v197 offset:1024
  v_mfma_f32_16x16x32_bf16 v[68:71], a[0:3], a[84:87], v[68:71]
  ds_read_b64_tr_b16 a[110:111], v197 offset:7168
  v_mfma_f32_16x16x32_bf16 v[68:71], a[60:63], a[80:83], v[68:71]
  s_waitcnt vmcnt(10) lgkmcnt(4)
  s_barrier
  buffer_load_dwordx4 v205, s[36:39], s62 offen offset:1024 sc1 lds
  v_mfma_f32_16x16x32_bf16 v[84:87], a[92:95], a[0:3], v[84:87]
  s_add_u32 m0, s65, 84992
  ds_read_b64_tr_b16 a[112:113], v197 offset:2048
  v_and_b32 v13, 7, v10
  v_mfma_f32_16x16x32_bf16 v[84:87], a[96:99], a[20:23], v[84:87]
  v_lshrrev_b32 v14, 4, v10
  v_xor_b32 v13, v13, v14
  v_mfma_f32_16x16x32_bf16 v[84:87], a[100:103], a[40:43], v[84:87]
  ds_read_b64_tr_b16 a[114:115], v197 offset:8192
  v_lshl_add_u32 v220, v13, 4, v12
  v_mfma_f32_16x16x32_bf16 v[88:91], a[100:103], a[44:47], v[88:91]
  buffer_load_dword v206, s[36:39], s62 offen sc1 lds
  s_mov_b32 s61, 1574912
  v_mfma_f32_16x16x32_bf16 v[88:91], a[96:99], a[24:27], v[88:91]
  s_add_u32 m0, s63, 86016
  ds_read_b128 a[60:63], v207 offset:33792
  v_xor_b32 v221, 64, v220
  v_mfma_f32_16x16x32_bf16 v[88:91], a[92:95], a[4:7], v[88:91]
  ds_read_b64_tr_b16 a[80:81], v196 offset:21504
  v_add_u32 v221, 15360, v221
  v_mfma_f32_16x16x32_bf16 v[92:95], a[92:95], a[8:11], v[92:95]
  ds_read_b128 a[64:67], v207 offset:34816
  v_mfma_f32_16x16x32_bf16 v[92:95], a[96:99], a[28:31], v[92:95]
  buffer_load_dwordx4 v202, s[8:11], s61 offen offset:0 lds
  v_mfma_f32_16x16x32_bf16 v[92:95], a[100:103], a[48:51], v[92:95]
  s_lshl_b32 s48, s44, 10
  ds_read_b64_tr_b16 a[82:83], v196 offset:27648
  s_add_u32 s48, s48, 147456
  v_mfma_f32_16x16x32_bf16 v[96:99], a[100:103], a[52:55], v[96:99]
  ds_read_b128 a[68:71], v207 offset:35840
  v_add_u32 v247, s48, v0
  v_mfma_f32_16x16x32_bf16 v[96:99], a[96:99], a[32:35], v[96:99]
  ds_read_b64_tr_b16 a[84:85], v196 offset:22528
  v_lshl_add_u32 v245, v14, 4, s48
  v_mfma_f32_16x16x32_bf16 v[96:99], a[92:95], a[12:15], v[96:99]
  s_waitcnt lgkmcnt(6)
  buffer_load_dwordx4 v203, s[8:11], s61 offen offset:1024 lds
  v_and_b32 v12, 1, v10
  v_mfma_f32_16x16x32_bf16 v[112:115], a[104:107], a[12:15], v[112:115]
  ds_read_b128 a[72:75], v207 offset:36864
  v_lshlrev_b32 v12, 8, v12
  v_mfma_f32_16x16x32_bf16 v[112:115], a[108:111], a[32:35], v[112:115]
  ds_read_b128 a[76:79], v210 offset:41984
  v_sub_u32 v246, v245, v12
  v_mfma_f32_16x16x32_bf16 v[112:115], a[112:115], a[52:55], v[112:115]
  ds_read_b64_tr_b16 a[86:87], v196 offset:28672
  v_mfma_f32_16x16x32_bf16 v[108:111], a[112:115], a[48:51], v[108:111]
  buffer_load_dwordx4 v204, s[8:11], s61 offen offset:2048 lds
  s_mov_b32 s62, 20480
  v_mfma_f32_16x16x32_bf16 v[108:111], a[108:111], a[28:31], v[108:111]
  s_add_u32 m0, s64, 98304
  ds_read_b64_tr_b16 a[88:89], v196 offset:23552
  v_mfma_f32_16x16x32_bf16 v[108:111], a[104:107], a[8:11], v[108:111]
  ds_read_b64_tr_b16 a[90:91], v196 offset:29696
  v_mfma_f32_16x16x32_bf16 v[104:107], a[104:107], a[4:7], v[104:107]
  v_mfma_f32_16x16x32_bf16 v[104:107], a[108:111], a[24:27], v[104:107]
  buffer_load_dwordx4 v205, s[36:39], s62 offen offset:0 sc1 lds
  v_mfma_f32_16x16x32_bf16 v[104:107], a[112:115], a[44:47], v[104:107]
  s_lshl_b32 s48, s53, 7
  ds_read_b64_tr_b16 a[92:93], v197 offset:21504
  v_and_b32 v13, 0xf0, v0
  v_mfma_f32_16x16x32_bf16 v[100:103], a[112:115], a[40:43], v[100:103]
  ds_read_b64_tr_b16 a[94:95], v197 offset:27648
  v_lshl_add_u32 v13, v14, 12, v13
  v_mfma_f32_16x16x32_bf16 v[100:103], a[108:111], a[20:23], v[100:103]
  s_lshl1_add_u32 s48, s48, 8192
  v_add_u32 v249, s48, v13
  v_mfma_f32_16x16x32_bf16 v[100:103], a[104:107], a[0:3], v[100:103]
  s_waitcnt lgkmcnt(2)
  buffer_load_dwordx4 v205, s[36:39], s62 offen offset:1024 sc1 lds
  s_add_u32 m0, s65, 106496
  v_mfma_f32_16x16x32_bf16 v[20:23], a[80:83], a[20:23], v[20:23]
  ds_read_b64_tr_b16 a[96:97], v197 offset:22528
  v_mfma_f32_16x16x32_bf16 v[20:23], a[84:87], a[40:43], v[20:23]
  ds_read_b64_tr_b16 a[98:99], v197 offset:28672
  v_mfma_f32_16x16x32_bf16 v[20:23], a[88:91], a[60:63], v[20:23]
  s_waitcnt vmcnt(11)
  s_barrier
  v_mfma_f32_16x16x32_bf16 v[24:27], a[88:91], a[64:67], v[24:27]
  buffer_load_dword v206, s[36:39], s62 offen sc1 lds
  s_mov_b32 s61, 1773568
  v_mfma_f32_16x16x32_bf16 v[24:27], a[84:87], a[44:47], v[24:27]
  s_add_u32 m0, s63, 107520
  ds_read_b64_tr_b16 a[100:101], v197 offset:23552
  v_lshrrev_b32 v12, 2, v10
  v_mfma_f32_16x16x32_bf16 v[24:27], a[80:83], a[24:27], v[24:27]
  ds_read_b64_tr_b16 a[102:103], v197 offset:29696
  v_lshl_add_u32 v232, v12, 7, v214
  v_mfma_f32_16x16x32_bf16 v[28:31], a[80:83], a[28:31], v[28:31]
  ds_read_b128 a[0:3], v207 offset:55296
  v_mfma_f32_16x16x32_bf16 v[28:31], a[84:87], a[48:51], v[28:31]
  buffer_load_dwordx4 v202, s[8:11], s61 offen offset:0 lds
  v_xor_b32 v233, 32, v232
  v_mfma_f32_16x16x32_bf16 v[28:31], a[88:91], a[68:71], v[28:31]
  ds_read_b64_tr_b16 a[104:105], v196 offset:43008
  v_xor_b32 v234, 64, v232
  v_mfma_f32_16x16x32_bf16 v[32:35], a[88:91], a[72:75], v[32:35]
  ds_read_b128 a[4:7], v207 offset:56320
  v_mfma_f32_16x16x32_bf16 v[32:35], a[84:87], a[52:55], v[32:35]
  ds_read_b64_tr_b16 a[106:107], v196 offset:49152
  v_xor_b32 v235, 96, v232
  v_mfma_f32_16x16x32_bf16 v[32:35], a[80:83], a[32:35], v[32:35]
  buffer_load_dwordx4 v203, s[8:11], s61 offen offset:1024 lds
  v_mfma_f32_16x16x32_bf16 v[116:119], a[80:83], a[36:39], v[116:119]
  ds_read_b128 a[8:11], v207 offset:57344
  v_xor_b32 v236, 65536, v232
  v_mfma_f32_16x16x32_bf16 v[116:119], a[84:87], a[56:59], v[116:119]
  ds_read_b64_tr_b16 a[108:109], v196 offset:44032
  v_xor_b32 v237, 65568, v232
  v_mfma_f32_16x16x32_bf16 v[116:119], a[88:91], a[76:79], v[116:119]
  s_waitcnt lgkmcnt(6)
  ds_read_b128 a[12:15], v207 offset:58368
  v_mfma_f32_16x16x32_bf16 v[48:51], a[92:95], a[32:35], v[48:51]
  buffer_load_dwordx4 v204, s[8:11], s61 offen offset:2048 lds
  s_mov_b32 s62, 22528
  v_mfma_f32_16x16x32_bf16 v[48:51], a[96:99], a[52:55], v[48:51]
  s_add_u32 m0, s64, 119808
  ds_read_b128 a[16:19], v210 offset:63488
  v_xor_b32 v238, 65600, v232
  v_mfma_f32_16x16x32_bf16 v[48:51], a[100:103], a[72:75], v[48:51]
  ds_read_b64_tr_b16 a[110:111], v196 offset:50176
  v_xor_b32 v239, 65632, v232
  v_mfma_f32_16x16x32_bf16 v[44:47], a[100:103], a[68:71], v[44:47]
  s_add_u32 s48, s70, 131072
  ds_read_b64_tr_b16 a[112:113], v196 offset:45056
  v_and_b32 v12, 15, v10
  v_mfma_f32_16x16x32_bf16 v[44:47], a[96:99], a[48:51], v[44:47]
  buffer_load_dwordx4 v205, s[36:39], s62 offen offset:0 sc1 lds
  v_lshrrev_b32 v14, 1, v12
  v_mfma_f32_16x16x32_bf16 v[44:47], a[92:95], a[28:31], v[44:47]
  ds_read_b64_tr_b16 a[114:115], v196 offset:51200
  v_lshrrev_b32 v13, 5, v10
  v_mfma_f32_16x16x32_bf16 v[40:43], a[92:95], a[24:27], v[40:43]
  v_xor_b32 v14, v14, v13
  v_lshlrev_b32 v14, 4, v14
  v_mfma_f32_16x16x32_bf16 v[40:43], a[96:99], a[44:47], v[40:43]
  ds_read_b64_tr_b16 a[80:81], v197 offset:43008
  v_lshl_add_u32 v14, v12, 7, v14
  v_mfma_f32_16x16x32_bf16 v[40:43], a[100:103], a[64:67], v[40:43]
  buffer_load_dwordx4 v205, s[36:39], s62 offen offset:1024 sc1 lds
  s_add_u32 m0, s65, 128000
  v_mfma_f32_16x16x32_bf16 v[36:39], a[100:103], a[60:63], v[36:39]
  ds_read_b64_tr_b16 a[82:83], v197 offset:49152
  v_bfe_u32 v13, v10, 4, 1
  v_mfma_f32_16x16x32_bf16 v[36:39], a[96:99], a[40:43], v[36:39]
  v_lshl_add_u32 v14, v13, 3, v14
  v_add_u32 v240, s48, v14
  v_mfma_f32_16x16x32_bf16 v[36:39], a[92:95], a[20:23], v[36:39]
  s_waitcnt lgkmcnt(2)
  ds_read_b64_tr_b16 a[84:85], v197 offset:44032
  v_xor_b32 v241, 32, v240
  v_mfma_f32_16x16x32_bf16 v[52:55], a[40:43], a[104:107], v[52:55]
  buffer_load_dword v206, s[36:39], s62 offen sc1 lds
  s_mov_b32 s61, 1966080
  v_mfma_f32_16x16x32_bf16 v[52:55], a[60:63], a[108:111], v[52:55]
  s_add_u32 m0, s63, 129024
  ds_read_b64_tr_b16 a[86:87], v197 offset:50176
  v_xor_b32 v242, 64, v240
  v_mfma_f32_16x16x32_bf16 v[52:55], a[0:3], a[112:115], v[52:55]
  s_waitcnt vmcnt(12)
  s_barrier
  v_xor_b32 v243, 96, v240
  v_mfma_f32_16x16x32_bf16 v[56:59], a[4:7], a[112:115], v[56:59]
  ds_read_b64_tr_b16 a[88:89], v197 offset:45056
  v_mfma_f32_16x16x32_bf16 v[56:59], a[64:67], a[108:111], v[56:59]
  buffer_load_dwordx4 v202, s[8:11], s61 offen offset:0 lds
  v_mfma_f32_16x16x32_bf16 v[56:59], a[44:47], a[104:107], v[56:59]
  ds_read_b64_tr_b16 a[90:91], v197 offset:51200
  v_mfma_f32_16x16x32_bf16 v[60:63], a[48:51], a[104:107], v[60:63]
  ds_read_b128 a[20:23], v208 offset:12288
  v_mfma_f32_16x16x32_bf16 v[60:63], a[68:71], a[108:111], v[60:63]
  ds_read_b64_tr_b16 a[92:93], v198 offset:0
  v_mfma_f32_16x16x32_bf16 v[60:63], a[8:11], a[112:115], v[60:63]
  buffer_load_dwordx4 v203, s[8:11], s61 offen offset:1024 lds
  v_mfma_f32_16x16x32_bf16 v[64:67], a[12:15], a[112:115], v[64:67]
  ds_read_b128 a[24:27], v208 offset:13312
  v_mfma_f32_16x16x32_bf16 v[64:67], a[72:75], a[108:111], v[64:67]
  ds_read_b64_tr_b16 a[94:95], v198 offset:6144
  v_mfma_f32_16x16x32_bf16 v[64:67], a[52:55], a[104:107], v[64:67]
  ds_read_b128 a[28:31], v208 offset:14336
  v_mfma_f32_16x16x32_bf16 v[120:123], a[56:59], a[104:107], v[120:123]
  s_lshl2_add_u32 s48, s52, s44
  buffer_load_dwordx4 v204, s[8:11], s61 offen offset:2048 lds
  s_mov_b32 s62, 24576
  v_mfma_f32_16x16x32_bf16 v[120:123], a[76:79], a[108:111], v[120:123]
  s_add_u32 m0, s64, 141312
  ds_read_b64_tr_b16 a[96:97], v198 offset:1024
  s_lshl_b32 s49, s48, 16
  v_mfma_f32_16x16x32_bf16 v[120:123], a[16:19], a[112:115], v[120:123]
  s_waitcnt lgkmcnt(6)
  ds_read_b128 a[32:35], v208 offset:15360
  s_add_u32 s49, s49, 7340032
  v_mfma_f32_16x16x32_bf16 v[80:83], a[52:55], a[80:83], v[80:83]
  ds_read_b64_tr_b16 a[98:99], v198 offset:7168
  v_add_u32 v244, s49, v0
  v_mfma_f32_16x16x32_bf16 v[80:83], a[72:75], a[84:87], v[80:83]
  buffer_load_dwordx4 v205, s[36:39], s62 offen offset:0 sc1 lds
  v_mfma_f32_16x16x32_bf16 v[80:83], a[12:15], a[88:91], v[80:83]
  ds_read_b128 a[36:39], v211 offset:20480
  v_mfma_f32_16x16x32_bf16 v[76:79], a[8:11], a[88:91], v[76:79]
  s_lshl4_add_u32 s74, s48, s53
  ds_read_b64_tr_b16 a[100:101], v198 offset:2048
  s_lshl_b32 s74, s74, 8
  v_mfma_f32_16x16x32_bf16 v[76:79], a[68:71], a[84:87], v[76:79]
  s_add_u32 s74, s74, 262144
  ds_read_b64_tr_b16 a[102:103], v198 offset:8192
  v_mfma_f32_16x16x32_bf16 v[76:79], a[48:51], a[80:83], v[76:79]
  buffer_load_dwordx4 v205, s[36:39], s62 offen offset:1024 sc1 lds
  s_add_u32 m0, s65, 149504
  v_mfma_f32_16x16x32_bf16 v[72:75], a[44:47], a[80:83], v[72:75]
Ha1:
  s_cbranch_execz Ha1_1
  ds_read_b64_tr_b16 a[104:105], v199 offset:0
  v_mfma_f32_16x16x32_bf16 v[72:75], a[64:67], a[84:87], v[72:75]
  ds_read_b64_tr_b16 a[106:107], v199 offset:6144
  v_mfma_f32_16x16x32_bf16 v[72:75], a[4:7], a[88:91], v[72:75]
  s_lshr_b32 s73, s48, 1
  ds_read_b64_tr_b16 a[108:109], v199 offset:1024
  s_lshl4_add_u32 s73, s73, s53
  v_mfma_f32_16x16x32_bf16 v[68:71], a[0:3], a[88:91], v[68:71]
  s_and_b32 s49, s48, 1
  buffer_load_dword v206, s[36:39], s62 offen sc1 lds
  s_mov_b32 s61, 2164736
  v_mfma_f32_16x16x32_bf16 v[68:71], a[60:63], a[84:87], v[68:71]
  s_add_u32 m0, s63, 0
  ds_read_b64_tr_b16 a[110:111], v199 offset:7168
  s_lshl2_add_u32 s73, s73, s49
  v_mfma_f32_16x16x32_bf16 v[68:71], a[40:43], a[80:83], v[68:71]
  s_waitcnt vmcnt(6) lgkmcnt(4)
  s_barrier
  s_lshl_b32 s73, s73, 11
  v_mfma_f32_16x16x32_bf16 v[84:87], a[92:95], a[60:63], v[84:87]
  s_add_u32 s73, s73, 36700160
  ds_read_b64_tr_b16 a[112:113], v199 offset:2048
  v_mfma_f32_16x16x32_bf16 v[84:87], a[96:99], a[0:3], v[84:87]
  buffer_load_dwordx4 v202, s[8:11], s61 offen offset:0 lds
  v_mfma_f32_16x16x32_bf16 v[84:87], a[100:103], a[20:23], v[84:87]
  ds_read_b64_tr_b16 a[114:115], v199 offset:8192
  v_mfma_f32_16x16x32_bf16 v[88:91], a[100:103], a[24:27], v[88:91]
  ds_read_b128 a[40:43], v208 offset:33792
  v_mfma_f32_16x16x32_bf16 v[88:91], a[96:99], a[4:7], v[88:91]
  ds_read_b64_tr_b16 a[80:81], v198 offset:21504
  v_mfma_f32_16x16x32_bf16 v[88:91], a[92:95], a[64:67], v[88:91]
  buffer_load_dwordx4 v203, s[8:11], s61 offen offset:1024 lds
  v_mfma_f32_16x16x32_bf16 v[92:95], a[92:95], a[68:71], v[92:95]
  s_lshl1_add_u32 s75, s48, s53
  ds_read_b128 a[44:47], v208 offset:34816
  s_lshl_b32 s75, s75, 11
  v_mfma_f32_16x16x32_bf16 v[92:95], a[96:99], a[8:11], v[92:95]
  s_add_u32 s75, s75, 5767168
  ds_read_b64_tr_b16 a[82:83], v198 offset:27648
  s_and_b32 s48, s48, 7
  v_mfma_f32_16x16x32_bf16 v[92:95], a[100:103], a[28:31], v[92:95]
  s_cselect_b32 s75, 1073741824, s75
  ds_read_b128 a[48:51], v208 offset:35840
  v_mfma_f32_16x16x32_bf16 v[96:99], a[100:103], a[32:35], v[96:99]
  buffer_load_dwordx4 v204, s[8:11], s61 offen offset:2048 lds
  s_mov_b32 s62, 26624
  v_mfma_f32_16x16x32_bf16 v[96:99], a[96:99], a[12:15], v[96:99]
  s_add_u32 m0, s64, 12288
  ds_read_b64_tr_b16 a[84:85], v198 offset:22528
  v_mfma_f32_16x16x32_bf16 v[96:99], a[92:95], a[72:75], v[96:99]
  s_waitcnt lgkmcnt(6)
  ds_read_b128 a[52:55], v208 offset:36864
  v_mfma_f32_16x16x32_bf16 v[112:115], a[104:107], a[72:75], v[112:115]
  ds_read_b128 a[56:59], v211 offset:41984
  v_mfma_f32_16x16x32_bf16 v[112:115], a[108:111], a[12:15], v[112:115]
  buffer_load_dwordx4 v205, s[36:39], s62 offen offset:0 sc1 lds
  v_mfma_f32_16x16x32_bf16 v[112:115], a[112:115], a[32:35], v[112:115]
  s_and_b32 s48, s52, 7
  ds_read_b64_tr_b16 a[86:87], v198 offset:28672
  s_lshl_b32 s48, s48, 5
  v_mfma_f32_16x16x32_bf16 v[108:111], a[112:115], a[28:31], v[108:111]
  s_lshr_b32 s49, s52, 3
  ds_read_b64_tr_b16 a[88:89], v198 offset:23552
  s_lshl2_add_u32 s48, s49, s48
  v_mfma_f32_16x16x32_bf16 v[108:111], a[108:111], a[8:11], v[108:111]
  ds_read_b64_tr_b16 a[90:91], v198 offset:29696
  v_mfma_f32_16x16x32_bf16 v[108:111], a[104:107], a[68:71], v[108:111]
  buffer_load_dwordx4 v205, s[36:39], s62 offen offset:1024 sc1 lds
  s_add_u32 m0, s65, 20480
  v_mfma_f32_16x16x32_bf16 v[104:107], a[104:107], a[64:67], v[104:107]
  v_mfma_f32_16x16x32_bf16 v[104:107], a[108:111], a[4:7], v[104:107]
  ds_read_b64_tr_b16 a[92:93], v199 offset:21504
  v_mfma_f32_16x16x32_bf16 v[104:107], a[112:115], a[24:27], v[104:107]
  v_and_b32 v12, 3, v10
  v_bfe_u32 v13, v10, 2, 2
  v_mfma_f32_16x16x32_bf16 v[100:103], a[112:115], a[20:23], v[100:103]
  buffer_load_dword v206, s[36:39], s62 offen sc1 lds
  s_mov_b32 s61, 2363392
  v_mfma_f32_16x16x32_bf16 v[100:103], a[108:111], a[0:3], v[100:103]
  s_add_u32 m0, s63, 21504
  ds_read_b64_tr_b16 a[94:95], v199 offset:27648
  v_lshl_add_u32 v12, v12, 3, v13
  v_mfma_f32_16x16x32_bf16 v[100:103], a[104:107], a[60:63], v[100:103]
  s_waitcnt lgkmcnt(2)
  ds_read_b64_tr_b16 a[96:97], v199 offset:22528
  v_add_lshl_u32 v250, v12, s48, 7
  v_mfma_f32_16x16x32_bf16 v[20:23], a[80:83], a[0:3], v[20:23]
  v_mfma_f32_16x16x32_bf16 v[20:23], a[84:87], a[20:23], v[20:23]
  buffer_load_dwordx4 v202, s[8:11], s61 offen offset:0 lds
  v_mfma_f32_16x16x32_bf16 v[20:23], a[88:91], a[40:43], v[20:23]
  ds_read_b64_tr_b16 a[98:99], v199 offset:28672
  v_add_u32 v250, 32768, v250
  v_mfma_f32_16x16x32_bf16 v[24:27], a[88:91], a[44:47], v[24:27]
  ds_read_b64_tr_b16 a[100:101], v199 offset:23552
  v_and_b32 v12, 7, v10
  v_mfma_f32_16x16x32_bf16 v[24:27], a[84:87], a[24:27], v[24:27]
  v_and_b32 v13, 8, v10
  v_lshl_add_u32 v12, v13, 4, v12
  v_mfma_f32_16x16x32_bf16 v[24:27], a[80:83], a[4:7], v[24:27]
  s_lshl_b32 s48, s53, 3
  buffer_load_dwordx4 v203, s[8:11], s61 offen offset:1024 lds
  v_add_lshl_u32 v12, v12, s48, 7
  v_mfma_f32_16x16x32_bf16 v[28:31], a[80:83], a[8:11], v[28:31]
  ds_read_b64_tr_b16 a[102:103], v199 offset:29696
  v_cmp_gt_u32 vcc, 16, v10
  v_mfma_f32_16x16x32_bf16 v[28:31], a[84:87], a[28:31], v[28:31]
  s_nop 1
  ds_read_b128 a[60:63], v208 offset:55296
  v_cndmask_b32 v250, v12, v250, vcc
  v_mfma_f32_16x16x32_bf16 v[28:31], a[88:91], a[48:51], v[28:31]
  ds_read_b64_tr_b16 a[104:105], v198 offset:43008
  v_mfma_f32_16x16x32_bf16 v[32:35], a[88:91], a[52:55], v[32:35]
  buffer_load_dwordx4 v204, s[8:11], s61 offen offset:2048 lds
  s_mov_b32 s62, 28672
  v_mfma_f32_16x16x32_bf16 v[32:35], a[84:87], a[32:35], v[32:35]
  s_add_u32 m0, s64, 33792
  ds_read_b128 a[64:67], v208 offset:56320
  v_mfma_f32_16x16x32_bf16 v[32:35], a[80:83], a[12:15], v[32:35]
  ds_read_b64_tr_b16 a[106:107], v198 offset:49152
  v_mfma_f32_16x16x32_bf16 v[116:119], a[80:83], a[16:19], v[116:119]
  ds_read_b128 a[68:71], v208 offset:57344
  v_mfma_f32_16x16x32_bf16 v[116:119], a[84:87], a[36:39], v[116:119]
  buffer_load_dwordx4 v205, s[36:39], s62 offen offset:0 sc1 lds
  v_mfma_f32_16x16x32_bf16 v[116:119], a[88:91], a[56:59], v[116:119]
  s_waitcnt lgkmcnt(5)
  ds_read_b64_tr_b16 a[108:109], v198 offset:44032
  v_mfma_f32_16x16x32_bf16 v[48:51], a[92:95], a[12:15], v[48:51]
  ds_read_b128 a[72:75], v208 offset:58368
  v_mfma_f32_16x16x32_bf16 v[48:51], a[96:99], a[32:35], v[48:51]
  ds_read_b128 a[76:79], v211 offset:63488
  v_mfma_f32_16x16x32_bf16 v[48:51], a[100:103], a[52:55], v[48:51]
  s_lshl_b32 s48, s59, 3
  buffer_load_dwordx4 v205, s[36:39], s62 offen offset:1024 sc1 lds
  s_add_u32 m0, s65, 41984
  v_mfma_f32_16x16x32_bf16 v[44:47], a[100:103], a[48:51], v[44:47]
  s_add_u32 s48, s48, 150528
  ds_read_b64_tr_b16 a[110:111], v198 offset:50176
  v_add_u32 v12, s48, v0
  v_mfma_f32_16x16x32_bf16 v[44:47], a[96:99], a[28:31], v[44:47]
  ds_read_b64_tr_b16 a[112:113], v198 offset:45056
  v_add_u32 v222, s64, v12
  v_mfma_f32_16x16x32_bf16 v[44:47], a[92:95], a[8:11], v[44:47]
  ds_read_b64_tr_b16 a[114:115], v198 offset:51200
  v_xor_b32 v223, 8, v222
  v_mfma_f32_16x16x32_bf16 v[40:43], a[92:95], a[4:7], v[40:43]
  buffer_load_dword v206, s[36:39], s62 offen sc1 lds
  s_mov_b32 s61, 2555904
  v_mfma_f32_16x16x32_bf16 v[40:43], a[96:99], a[24:27], v[40:43]
  s_add_u32 m0, s63, 43008
  ds_read_b64_tr_b16 a[80:81], v199 offset:43008
  v_mfma_f32_16x16x32_bf16 v[40:43], a[100:103], a[44:47], v[40:43]
  v_mfma_f32_16x16x32_bf16 v[36:39], a[100:103], a[40:43], v[36:39]
  ds_read_b64_tr_b16 a[82:83], v199 offset:49152
  v_mfma_f32_16x16x32_bf16 v[36:39], a[96:99], a[20:23], v[36:39]
  s_lshl_b32 s48, s60, 11
  buffer_load_dwordx4 v202, s[8:11], s61 offen offset:0 lds
  s_add_u32 s48, s48, 8192
  v_mfma_f32_16x16x32_bf16 v[36:39], a[92:95], a[0:3], v[36:39]
  s_waitcnt lgkmcnt(2)
  ds_read_b64_tr_b16 a[84:85], v199 offset:44032
  v_add_u32 v224, s48, v12
  v_mfma_f32_16x16x32_bf16 v[52:55], a[20:23], a[104:107], v[52:55]
  s_lshl_b32 s48, s59, 13
  v_subrev_u32 v225, s48, v224
  v_xor_b32 v226, 8, v225
  v_mfma_f32_16x16x32_bf16 v[52:55], a[40:43], a[108:111], v[52:55]
  ds_read_b64_tr_b16 a[86:87], v199 offset:50176
  v_and_b32 v227, -9, v225
  v_mfma_f32_16x16x32_bf16 v[52:55], a[60:63], a[112:115], v[52:55]
  s_waitcnt vmcnt(7)
  s_barrier
  buffer_load_dwordx4 v203, s[8:11], s61 offen offset:1024 lds
  v_mfma_f32_16x16x32_bf16 v[56:59], a[64:67], a[112:115], v[56:59]
  ds_read_b64_tr_b16 a[88:89], v199 offset:45056
  v_mfma_f32_16x16x32_bf16 v[56:59], a[44:47], a[108:111], v[56:59]
  v_mfma_f32_16x16x32_bf16 v[56:59], a[24:27], a[104:107], v[56:59]
  ds_read_b64_tr_b16 a[90:91], v199 offset:51200
  v_mfma_f32_16x16x32_bf16 v[60:63], a[28:31], a[104:107], v[60:63]
  buffer_load_dwordx4 v204, s[8:11], s61 offen offset:2048 lds
  s_mov_b32 s62, 30720
  v_mfma_f32_16x16x32_bf16 v[60:63], a[48:51], a[108:111], v[60:63]
  s_add_u32 m0, s64, 55296
  ds_read_b128 a[0:3], v209 offset:12288
  v_mfma_f32_16x16x32_bf16 v[60:63], a[68:71], a[112:115], v[60:63]
  ds_read_b64_tr_b16 a[92:93], v200 offset:0
  v_mfma_f32_16x16x32_bf16 v[64:67], a[72:75], a[112:115], v[64:67]
  s_mov_b32 s76, 0xaaaaaaaa
  ds_read_b128 a[4:7], v209 offset:13312
  s_mov_b32 s77, 0xaaaaaaaa
  v_mfma_f32_16x16x32_bf16 v[64:67], a[52:55], a[108:111], v[64:67]
  s_mov_b32 s78, 0x000f0000
  buffer_load_dwordx4 v205, s[36:39], s62 offen offset:0 sc1 lds
  s_mov_b32 s79, 0x0fff00ff
  v_mfma_f32_16x16x32_bf16 v[64:67], a[32:35], a[104:107], v[64:67]
  s_mov_b32 s80, 0x003f0003
  ds_read_b64_tr_b16 a[94:95], v200 offset:6144
  s_mov_b32 s81, 0x3fff03ff
  v_mfma_f32_16x16x32_bf16 v[120:123], a[36:39], a[104:107], v[120:123]
  ds_read_b128 a[8:11], v209 offset:14336
  v_mfma_f32_16x16x32_bf16 v[120:123], a[56:59], a[108:111], v[120:123]
  ds_read_b64_tr_b16 a[96:97], v200 offset:1024
  v_mfma_f32_16x16x32_bf16 v[120:123], a[76:79], a[112:115], v[120:123]
  s_waitcnt lgkmcnt(6)
  buffer_load_dwordx4 v205, s[36:39], s62 offen offset:1024 sc1 lds
  s_add_u32 m0, s65, 63488
  v_mfma_f32_16x16x32_bf16 v[80:83], a[32:35], a[80:83], v[80:83]
  ds_read_b128 a[12:15], v209 offset:15360
  v_mfma_f32_16x16x32_bf16 v[80:83], a[52:55], a[84:87], v[80:83]
  ds_read_b64_tr_b16 a[98:99], v200 offset:7168
  v_mfma_f32_16x16x32_bf16 v[80:83], a[72:75], a[88:91], v[80:83]
  ds_read_b128 a[16:19], v212 offset:20480
  v_mfma_f32_16x16x32_bf16 v[76:79], a[68:71], a[88:91], v[76:79]
  buffer_load_dword v206, s[36:39], s62 offen sc1 lds
  s_mov_b32 s61, 2754560
  v_mfma_f32_16x16x32_bf16 v[76:79], a[48:51], a[84:87], v[76:79]
  s_add_u32 m0, s63, 64512
  ds_read_b64_tr_b16 a[100:101], v200 offset:2048
  v_mov_b32 v12, 0x0c0c0100
  v_mfma_f32_16x16x32_bf16 v[76:79], a[28:31], a[80:83], v[76:79]
  ds_read_b64_tr_b16 a[102:103], v200 offset:8192
  v_mov_b32 v13, 0x01000c0c
  v_mfma_f32_16x16x32_bf16 v[72:75], a[24:27], a[80:83], v[72:75]
  ds_read_b64_tr_b16 a[104:105], v201 offset:0
  v_cndmask_b32 v12, v12, v13, s[76:77]
  v_mfma_f32_16x16x32_bf16 v[72:75], a[44:47], a[84:87], v[72:75]
  buffer_load_dwordx4 v202, s[8:11], s61 offen offset:0 lds
  v_mov_b32 v14, 0x0c0c0c0c
  v_mfma_f32_16x16x32_bf16 v[72:75], a[64:67], a[88:91], v[72:75]
  ds_read_b64_tr_b16 a[106:107], v201 offset:6144
  v_cndmask_b32 v228, v14, v12, s[78:79]
  v_mfma_f32_16x16x32_bf16 v[68:71], a[60:63], a[88:91], v[68:71]
  ds_read_b64_tr_b16 a[108:109], v201 offset:1024
  v_cndmask_b32 v230, v12, v14, s[78:79]
  v_mfma_f32_16x16x32_bf16 v[68:71], a[40:43], a[84:87], v[68:71]
  ds_read_b64_tr_b16 a[110:111], v201 offset:7168
  v_mfma_f32_16x16x32_bf16 v[68:71], a[20:23], a[80:83], v[68:71]
  s_waitcnt lgkmcnt(4)
  buffer_load_dwordx4 v203, s[8:11], s61 offen offset:1024 lds
  v_mfma_f32_16x16x32_bf16 v[84:87], a[92:95], a[40:43], v[84:87]
  ds_read_b64_tr_b16 a[112:113], v201 offset:2048
  v_mfma_f32_16x16x32_bf16 v[84:87], a[96:99], a[60:63], v[84:87]
  v_mov_b32 v12, 0x0c0c0302
  v_mov_b32 v13, 0x03020c0c
  v_mfma_f32_16x16x32_bf16 v[84:87], a[100:103], a[0:3], v[84:87]
  ds_read_b64_tr_b16 a[114:115], v201 offset:8192
  v_cndmask_b32 v12, v12, v13, s[76:77]
  v_mfma_f32_16x16x32_bf16 v[88:91], a[100:103], a[4:7], v[88:91]
  buffer_load_dwordx4 v204, s[8:11], s61 offen offset:2048 lds
  s_mov_b32 s62, 32768
  v_mfma_f32_16x16x32_bf16 v[88:91], a[96:99], a[64:67], v[88:91]
  s_add_u32 m0, s64, 76800
  ds_read_b128 a[20:23], v207 offset:12288
  v_cndmask_b32 v229, v14, v12, s[80:81]
  v_mfma_f32_16x16x32_bf16 v[88:91], a[92:95], a[44:47], v[88:91]
  ds_read_b64_tr_b16 a[80:81], v196 offset:0
  v_cndmask_b32 v231, v12, v14, s[80:81]
  v_mfma_f32_16x16x32_bf16 v[92:95], a[92:95], a[48:51], v[92:95]
  ds_read_b128 a[24:27], v207 offset:13312
  v_mfma_f32_16x16x32_bf16 v[92:95], a[96:99], a[68:71], v[92:95]
  buffer_load_dwordx4 v205, s[36:39], s62 offen offset:0 sc1 lds
  v_mfma_f32_16x16x32_bf16 v[92:95], a[100:103], a[8:11], v[92:95]
  ds_read_b64_tr_b16 a[82:83], v196 offset:6144
  v_mfma_f32_16x16x32_bf16 v[96:99], a[100:103], a[12:15], v[96:99]
  s_lshl1_add_u32 s48, s57, s59
  ds_read_b128 a[28:31], v207 offset:14336
  s_lshl_b32 s71, s48, 17
  v_mfma_f32_16x16x32_bf16 v[96:99], a[96:99], a[72:75], v[96:99]
  s_lshl1_add_u32 s48, s58, s60
  ds_read_b64_tr_b16 a[84:85], v196 offset:1024
  s_lshl_b32 s48, s48, 11
  v_mfma_f32_16x16x32_bf16 v[96:99], a[92:95], a[52:55], v[96:99]
  s_waitcnt lgkmcnt(6)
  buffer_load_dwordx4 v205, s[36:39], s62 offen offset:1024 sc1 lds
  s_add_u32 m0, s65, 84992
  v_mfma_f32_16x16x32_bf16 v[112:115], a[104:107], a[52:55], v[112:115]
  ds_read_b128 a[32:35], v207 offset:15360
  v_mfma_f32_16x16x32_bf16 v[112:115], a[108:111], a[72:75], v[112:115]
  ds_read_b128 a[36:39], v210 offset:20480
  v_mfma_f32_16x16x32_bf16 v[112:115], a[112:115], a[12:15], v[112:115]
  ds_read_b64_tr_b16 a[86:87], v196 offset:7168
  v_mfma_f32_16x16x32_bf16 v[108:111], a[112:115], a[8:11], v[108:111]
  buffer_load_dword v206, s[36:39], s62 offen sc1 lds
  s_mov_b32 s61, 2953216
  v_mfma_f32_16x16x32_bf16 v[108:111], a[108:111], a[68:71], v[108:111]
  s_add_u32 m0, s63, 86016
  ds_read_b64_tr_b16 a[88:89], v196 offset:2048
  s_add_u32 s71, s71, s48
  v_mfma_f32_16x16x32_bf16 v[108:111], a[104:107], a[48:51], v[108:111]
  s_add_u32 s71, s71, 7340032
  ds_read_b64_tr_b16 a[90:91], v196 offset:8192
  s_add_u32 s72, s71, 65536
  v_mfma_f32_16x16x32_bf16 v[104:107], a[104:107], a[44:47], v[104:107]
  s_or_b32 s57, s57, s59
  v_mfma_f32_16x16x32_bf16 v[104:107], a[108:111], a[64:67], v[104:107]
  buffer_load_dwordx4 v202, s[8:11], s61 offen offset:0 lds
  v_mfma_f32_16x16x32_bf16 v[104:107], a[112:115], a[4:7], v[104:107]
  ds_read_b64_tr_b16 a[92:93], v197 offset:0
  v_mfma_f32_16x16x32_bf16 v[100:103], a[112:115], a[0:3], v[100:103]
  ds_read_b64_tr_b16 a[94:95], v197 offset:6144
  v_mfma_f32_16x16x32_bf16 v[100:103], a[108:111], a[60:63], v[100:103]
  s_lshl_b32 s45, s2, 7
  s_add_u32 s45, s45, 5275648
  s_cmp_eq_u32 s44, 0
  v_mfma_f32_16x16x32_bf16 v[100:103], a[104:107], a[40:43], v[100:103]
  s_waitcnt lgkmcnt(2)
  buffer_load_dwordx4 v203, s[8:11], s61 offen offset:1024 lds
  s_cselect_b32 s45, s45, 1073741824
  v_mfma_f32_16x16x32_bf16 v[20:23], a[80:83], a[60:63], v[20:23]
  ds_read_b64_tr_b16 a[96:97], v197 offset:1024
  v_mfma_f32_16x16x32_bf16 v[20:23], a[84:87], a[0:3], v[20:23]
  ds_read_b64_tr_b16 a[98:99], v197 offset:7168
  v_mfma_f32_16x16x32_bf16 v[20:23], a[88:91], a[20:23], v[20:23]
  s_waitcnt vmcnt(8)
  s_barrier
  v_mfma_f32_16x16x32_bf16 v[24:27], a[88:91], a[24:27], v[24:27]
  buffer_load_dwordx4 v204, s[8:11], s61 offen offset:2048 lds
  s_mov_b32 s62, 34816
  v_mfma_f32_16x16x32_bf16 v[24:27], a[84:87], a[4:7], v[24:27]
  s_add_u32 m0, s64, 98304
  ds_read_b64_tr_b16 a[100:101], v197 offset:2048
  s_lshr_b32 s49, s2, 3
  v_mfma_f32_16x16x32_bf16 v[24:27], a[80:83], a[64:67], v[24:27]
  s_and_b32 s60, s49, 3
  ds_read_b64_tr_b16 a[102:103], v197 offset:8192
  s_lshr_b32 s58, s49, 2
  v_mfma_f32_16x16x32_bf16 v[28:31], a[80:83], a[68:71], v[28:31]
  s_lshl1_add_u32 s49, s60, s58
  ds_read_b128 a[40:43], v207 offset:33792
  s_and_b32 s49, s49, 7
  v_mfma_f32_16x16x32_bf16 v[28:31], a[84:87], a[8:11], v[28:31]
  s_and_b32 s48, s2, 7
  buffer_load_dwordx4 v205, s[36:39], s62 offen offset:0 sc1 lds
  s_lshl2_add_u32 s60, s48, s60
  v_mfma_f32_16x16x32_bf16 v[28:31], a[88:91], a[28:31], v[28:31]
  ds_read_b64_tr_b16 a[104:105], v196 offset:21504
  v_mfma_f32_16x16x32_bf16 v[32:35], a[88:91], a[32:35], v[32:35]
  ds_read_b128 a[44:47], v207 offset:34816
  v_mfma_f32_16x16x32_bf16 v[32:35], a[84:87], a[12:15], v[32:35]
  ds_read_b64_tr_b16 a[106:107], v196 offset:27648
  v_mfma_f32_16x16x32_bf16 v[32:35], a[80:83], a[72:75], v[32:35]
  buffer_load_dwordx4 v205, s[36:39], s62 offen offset:1024 sc1 lds
  s_add_u32 m0, s65, 106496
  v_mfma_f32_16x16x32_bf16 v[116:119], a[80:83], a[76:79], v[116:119]
  ds_read_b128 a[48:51], v207 offset:35840
  v_mfma_f32_16x16x32_bf16 v[116:119], a[84:87], a[16:19], v[116:119]
  ds_read_b64_tr_b16 a[108:109], v196 offset:22528
  v_mfma_f32_16x16x32_bf16 v[116:119], a[88:91], a[36:39], v[116:119]
  s_waitcnt lgkmcnt(6)
  ds_read_b128 a[52:55], v207 offset:36864
  v_mfma_f32_16x16x32_bf16 v[48:51], a[92:95], a[72:75], v[48:51]
  buffer_load_dword v206, s[36:39], s62 offen sc1 lds
  s_mov_b32 s61, 3145728
  v_mfma_f32_16x16x32_bf16 v[48:51], a[96:99], a[12:15], v[48:51]
  s_add_u32 m0, s63, 107520
  ds_read_b128 a[56:59], v210 offset:41984
  s_mov_b32 s82, 0xc0653421
  v_mfma_f32_16x16x32_bf16 v[48:51], a[100:103], a[32:35], v[48:51]
  s_mov_b32 s83, 0xfedba987
  ds_read_b64_tr_b16 a[110:111], v196 offset:28672
  v_mfma_f32_16x16x32_bf16 v[44:47], a[100:103], a[28:31], v[44:47]
  ds_read_b64_tr_b16 a[112:113], v196 offset:23552
  v_mfma_f32_16x16x32_bf16 v[44:47], a[96:99], a[8:11], v[44:47]
  s_cmp_eq_u32 s49, 1
  buffer_load_dwordx4 v202, s[8:11], s61 offen offset:0 lds
  s_cselect_b32 s82, 0xd1643520, s82
  v_mfma_f32_16x16x32_bf16 v[44:47], a[92:95], a[68:71], v[44:47]
  s_cselect_b32 s83, 0xfecba897, s83
  ds_read_b64_tr_b16 a[114:115], v196 offset:29696
  v_mfma_f32_16x16x32_bf16 v[40:43], a[92:95], a[64:67], v[40:43]
  v_mfma_f32_16x16x32_bf16 v[40:43], a[96:99], a[4:7], v[40:43]
  ds_read_b64_tr_b16 a[80:81], v197 offset:21504
  v_mfma_f32_16x16x32_bf16 v[40:43], a[100:103], a[24:27], v[40:43]
  buffer_load_dwordx4 v203, s[8:11], s61 offen offset:1024 lds
  v_mfma_f32_16x16x32_bf16 v[36:39], a[100:103], a[20:23], v[36:39]
  s_cmp_eq_u32 s49, 2
  ds_read_b64_tr_b16 a[82:83], v197 offset:27648
  s_cselect_b32 s82, 0x72546310, s82
  v_mfma_f32_16x16x32_bf16 v[36:39], a[96:99], a[0:3], v[36:39]
  s_cselect_b32 s83, 0xfdcb98ae, s83
  v_mfma_f32_16x16x32_bf16 v[36:39], a[92:95], a[60:63], v[36:39]
  s_waitcnt lgkmcnt(2)
  ds_read_b64_tr_b16 a[84:85], v197 offset:22528
  v_mfma_f32_16x16x32_bf16 v[52:55], a[0:3], a[104:107], v[52:55]
  buffer_load_dwordx4 v204, s[8:11], s61 offen offset:2048 lds
  s_mov_b32 s62, 36864
  v_mfma_f32_16x16x32_bf16 v[52:55], a[20:23], a[108:111], v[52:55]
  s_add_u32 m0, s64, 119808
  ds_read_b64_tr_b16 a[86:87], v197 offset:28672
  s_cmp_eq_u32 s49, 3
  v_mfma_f32_16x16x32_bf16 v[52:55], a[40:43], a[112:115], v[52:55]
  s_cselect_b32 s82, 0x63547210, s82
  s_cselect_b32 s83, 0xfedca9b8, s83
  v_mfma_f32_16x16x32_bf16 v[56:59], a[44:47], a[112:115], v[56:59]
  ds_read_b64_tr_b16 a[88:89], v197 offset:23552
  v_mfma_f32_16x16x32_bf16 v[56:59], a[24:27], a[108:111], v[56:59]
  buffer_load_dwordx4 v205, s[36:39], s62 offen offset:0 sc1 lds
  v_mfma_f32_16x16x32_bf16 v[56:59], a[4:7], a[104:107], v[56:59]
  ds_read_b64_tr_b16 a[90:91], v197 offset:29696
  v_mfma_f32_16x16x32_bf16 v[60:63], a[8:11], a[104:107], v[60:63]
  s_cmp_eq_u32 s49, 4
  ds_read_b128 a[60:63], v207 offset:55296
  s_cselect_b32 s82, 0x64583210, s82
  v_mfma_f32_16x16x32_bf16 v[60:63], a[28:31], a[108:111], v[60:63]
  s_cselect_b32 s83, 0xfedba9c7, s83
  ds_read_b64_tr_b16 a[92:93], v196 offset:43008
  v_mfma_f32_16x16x32_bf16 v[60:63], a[48:51], a[112:115], v[60:63]
  buffer_load_dwordx4 v205, s[36:39], s62 offen offset:1024 sc1 lds
  s_add_u32 m0, s65, 128000
  v_mfma_f32_16x16x32_bf16 v[64:67], a[52:55], a[112:115], v[64:67]
  ds_read_b128 a[64:67], v207 offset:56320
  v_mfma_f32_16x16x32_bf16 v[64:67], a[32:35], a[108:111], v[64:67]
  ds_read_b64_tr_b16 a[94:95], v196 offset:49152
  v_mfma_f32_16x16x32_bf16 v[64:67], a[12:15], a[104:107], v[64:67]
  s_cmp_eq_u32 s49, 5
  ds_read_b128 a[68:71], v207 offset:57344
  s_cselect_b32 s82, 0x65493210, s82
  v_mfma_f32_16x16x32_bf16 v[120:123], a[16:19], a[104:107], v[120:123]
  s_cselect_b32 s83, 0xfecba8d7, s83
  buffer_load_dword v206, s[36:39], s62 offen sc1 lds
  s_mov_b32 s61, 3344384
  v_mfma_f32_16x16x32_bf16 v[120:123], a[36:39], a[108:111], v[120:123]
  s_add_u32 m0, s63, 129024
  ds_read_b64_tr_b16 a[96:97], v196 offset:44032
  v_mfma_f32_16x16x32_bf16 v[120:123], a[56:59], a[112:115], v[120:123]
  s_waitcnt lgkmcnt(6)
  ds_read_b128 a[72:75], v207 offset:58368
  v_mfma_f32_16x16x32_bf16 v[80:83], a[12:15], a[80:83], v[80:83]
  ds_read_b64_tr_b16 a[98:99], v196 offset:50176
  v_mfma_f32_16x16x32_bf16 v[80:83], a[32:35], a[84:87], v[80:83]
  s_cmp_eq_u32 s49, 6
  buffer_load_dwordx4 v202, s[8:11], s61 offen offset:0 lds
  s_cselect_b32 s82, 0x56a43210, s82
  v_mfma_f32_16x16x32_bf16 v[80:83], a[52:55], a[88:91], v[80:83]
  s_cselect_b32 s83, 0xfdcb98e7, s83
  ds_read_b128 a[76:79], v210 offset:63488
  v_mfma_f32_16x16x32_bf16 v[76:79], a[48:51], a[88:91], v[76:79]
  ds_read_b64_tr_b16 a[100:101], v196 offset:45056
  v_mfma_f32_16x16x32_bf16 v[76:79], a[28:31], a[84:87], v[76:79]
  ds_read_b64_tr_b16 a[102:103], v196 offset:51200
  v_mfma_f32_16x16x32_bf16 v[76:79], a[8:11], a[80:83], v[76:79]
  buffer_load_dwordx4 v203, s[8:11], s61 offen offset:1024 lds
  v_mfma_f32_16x16x32_bf16 v[72:75], a[4:7], a[80:83], v[72:75]
  s_cmp_eq_u32 s49, 7
  ds_read_b64_tr_b16 a[104:105], v197 offset:43008
  s_cselect_b32 s82, 0x57b43210, s82
  v_mfma_f32_16x16x32_bf16 v[72:75], a[24:27], a[84:87], v[72:75]
  s_cselect_b32 s83, 0xedca98f6, s83
  ds_read_b64_tr_b16 a[106:107], v197 offset:49152
  v_mfma_f32_16x16x32_bf16 v[72:75], a[44:47], a[88:91], v[72:75]
  ds_read_b64_tr_b16 a[108:109], v197 offset:44032
  v_mfma_f32_16x16x32_bf16 v[68:71], a[40:43], a[88:91], v[68:71]
  buffer_load_dwordx4 v204, s[8:11], s61 offen offset:2048 lds
  s_mov_b32 s62, 38912
  v_mfma_f32_16x16x32_bf16 v[68:71], a[20:23], a[84:87], v[68:71]
  s_add_u32 m0, s64, 141312
  ds_read_b64_tr_b16 a[110:111], v197 offset:50176
  v_mfma_f32_16x16x32_bf16 v[68:71], a[0:3], a[80:83], v[68:71]
  s_waitcnt vmcnt(9) lgkmcnt(4)
  s_barrier
  s_mul_i32 s84, s44, 7168
  v_mfma_f32_16x16x32_bf16 v[84:87], a[92:95], a[20:23], v[84:87]
  s_lshl2_add_u32 s85, s58, s44
  ds_read_b64_tr_b16 a[112:113], v197 offset:45056
  s_lshl_b32 s85, s85, 17
  v_mfma_f32_16x16x32_bf16 v[84:87], a[96:99], a[40:43], v[84:87]
  s_add_u32 s85, s85, 36700160
  buffer_load_dwordx4 v205, s[36:39], s62 offen offset:0 sc1 lds
  v_mfma_f32_16x16x32_bf16 v[84:87], a[100:103], a[60:63], v[84:87]
  ds_read_b64_tr_b16 a[114:115], v197 offset:51200
  v_mfma_f32_16x16x32_bf16 v[88:91], a[100:103], a[64:67], v[88:91]
  ds_read_b128 a[0:3], v208 offset:12288
  v_mfma_f32_16x16x32_bf16 v[88:91], a[96:99], a[44:47], v[88:91]
  ds_read_b64_tr_b16 a[80:81], v198 offset:0
  v_mfma_f32_16x16x32_bf16 v[88:91], a[92:95], a[24:27], v[88:91]
  s_cmp_ge_u32 s44, 2
  buffer_load_dwordx4 v205, s[36:39], s62 offen offset:1024 sc1 lds
  s_cselect_b64 s[16:17], s[20:21], s[16:17]
  v_mfma_f32_16x16x32_bf16 v[92:95], a[92:95], a[28:31], v[92:95]
  s_add_u32 m0, s65, 149504
  ds_read_b128 a[4:7], v208 offset:13312
  v_mfma_f32_16x16x32_bf16 v[92:95], a[96:99], a[48:51], v[92:95]
  ds_read_b64_tr_b16 a[82:83], v198 offset:6144
  v_mfma_f32_16x16x32_bf16 v[92:95], a[100:103], a[68:71], v[92:95]
  ds_read_b128 a[8:11], v208 offset:14336
  v_lshrrev_b32 v12, 2, v10
  v_mfma_f32_16x16x32_bf16 v[96:99], a[100:103], a[72:75], v[96:99]
  buffer_load_dword v206, s[36:39], s62 offen sc1 lds
  s_mov_b32 s61, 3543040
  v_mfma_f32_16x16x32_bf16 v[96:99], a[96:99], a[52:55], v[96:99]
  s_add_u32 m0, s63, 0
  ds_read_b64_tr_b16 a[84:85], v198 offset:1024
  v_mul_u32_u24 v12, 224, v12
  v_mfma_f32_16x16x32_bf16 v[96:99], a[92:95], a[32:35], v[96:99]
  s_waitcnt lgkmcnt(6)
  ds_read_b128 a[12:15], v208 offset:15360
  v_and_b32 v13, 3, v10
  v_mfma_f32_16x16x32_bf16 v[112:115], a[104:107], a[32:35], v[112:115]
  ds_read_b128 a[16:19], v211 offset:20480
  v_lshl_add_u32 v1, v13, 3, v12
  v_mfma_f32_16x16x32_bf16 v[112:115], a[108:111], a[52:55], v[112:115]
  buffer_load_dwordx4 v202, s[8:11], s61 offen offset:0 lds
  v_add_u32 v2, 57344, v1
  v_mfma_f32_16x16x32_bf16 v[112:115], a[112:115], a[72:75], v[112:115]
  ds_read_b64_tr_b16 a[86:87], v198 offset:7168
  v_mfma_f32_16x16x32_bf16 v[108:111], a[112:115], a[68:71], v[108:111]
  ds_read_b64_tr_b16 a[88:89], v198 offset:2048
  v_mfma_f32_16x16x32_bf16 v[108:111], a[108:111], a[48:51], v[108:111]
  s_mul_i32 s48, s60, 224
  ds_read_b64_tr_b16 a[90:91], v198 offset:8192
  s_and_b32 s49, s44, 1
  v_mfma_f32_16x16x32_bf16 v[108:111], a[104:107], a[28:31], v[108:111]
  s_mul_i32 s49, s49, 229376
  buffer_load_dwordx4 v203, s[8:11], s61 offen offset:1024 lds
  s_add_u32 s48, s48, s49
  v_mfma_f32_16x16x32_bf16 v[104:107], a[104:107], a[24:27], v[104:107]
  s_and_b32 s49, s60, 1
  s_lshl_b32 s49, s49, 1
  v_mfma_f32_16x16x32_bf16 v[104:107], a[108:111], a[44:47], v[104:107]
  ds_read_b64_tr_b16 a[92:93], v199 offset:0
  v_mfma_f32_16x16x32_bf16 v[104:107], a[112:115], a[64:67], v[104:107]
  v_mfma_f32_16x16x32_bf16 v[100:103], a[112:115], a[60:63], v[100:103]
  buffer_load_dwordx4 v204, s[8:11], s61 offen offset:2048 lds
  s_mov_b32 s62, 40960
  v_mfma_f32_16x16x32_bf16 v[100:103], a[108:111], a[40:43], v[100:103]
  s_add_u32 m0, s64, 12288
  ds_read_b64_tr_b16 a[94:95], v199 offset:6144
  v_mfma_f32_16x16x32_bf16 v[100:103], a[104:107], a[20:23], v[100:103]
  s_waitcnt lgkmcnt(2)
  ds_read_b64_tr_b16 a[96:97], v199 offset:1024
  v_mfma_f32_16x16x32_bf16 v[20:23], a[80:83], a[40:43], v[20:23]
  v_mfma_f32_16x16x32_bf16 v[20:23], a[84:87], a[60:63], v[20:23]
  buffer_load_dwordx4 v205, s[36:39], s62 offen offset:0 sc1 lds
  v_mfma_f32_16x16x32_bf16 v[20:23], a[88:91], a[0:3], v[20:23]
  ds_read_b64_tr_b16 a[98:99], v199 offset:7168
  v_add_u32 v12, 0, v10
  v_mfma_f32_16x16x32_bf16 v[24:27], a[88:91], a[4:7], v[24:27]
  ds_read_b64_tr_b16 a[100:101], v199 offset:2048
  v_mul_u32_u24 v13, 4682, v12
  v_mfma_f32_16x16x32_bf16 v[24:27], a[84:87], a[64:67], v[24:27]
  v_lshrrev_b32 v13, 16, v13
  v_mul_i32_i24 v14, -14, v13
  v_mfma_f32_16x16x32_bf16 v[24:27], a[80:83], a[44:47], v[24:27]
  buffer_load_dwordx4 v205, s[36:39], s62 offen offset:1024 sc1 lds
  s_add_u32 m0, s65, 20480
  v_mfma_f32_16x16x32_bf16 v[28:31], a[80:83], a[48:51], v[28:31]
  ds_read_b64_tr_b16 a[102:103], v199 offset:8192
  v_add3_u32 v12, v12, v14, s49
  v_mfma_f32_16x16x32_bf16 v[28:31], a[84:87], a[68:71], v[28:31]
  ds_read_b128 a[20:23], v208 offset:33792
  v_mfma_f32_16x16x32_bf16 v[28:31], a[88:91], a[8:11], v[28:31]
  ds_read_b64_tr_b16 a[104:105], v198 offset:21504
  v_mfma_f32_16x16x32_bf16 v[32:35], a[88:91], a[12:15], v[32:35]
  buffer_load_dword v206, s[36:39], s62 offen sc1 lds
  s_mov_b32 s61, 3735552
  v_mfma_f32_16x16x32_bf16 v[32:35], a[84:87], a[72:75], v[32:35]
  s_add_u32 m0, s63, 21504
  ds_read_b128 a[24:27], v208 offset:34816
  v_add_u32 v14, -14, v12
  v_mfma_f32_16x16x32_bf16 v[32:35], a[80:83], a[52:55], v[32:35]
Ha2:
  s_cbranch_execz Ha2_1
  ds_read_b64_tr_b16 a[106:107], v198 offset:27648
  v_min_u32 v12, v12, v14
  v_mfma_f32_16x16x32_bf16 v[116:119], a[80:83], a[56:59], v[116:119]
  ds_read_b128 a[28:31], v208 offset:35840
  v_mul_u32_u24 v13, 7168, v13
  v_mfma_f32_16x16x32_bf16 v[116:119], a[84:87], a[76:79], v[116:119]
  buffer_load_dwordx4 v202, s[8:11], s61 offen offset:0 lds
  v_lshl_add_u32 v12, v12, 4, v13
  v_mfma_f32_16x16x32_bf16 v[116:119], a[88:91], a[16:19], v[116:119]
  s_waitcnt lgkmcnt(5)
  ds_read_b64_tr_b16 a[108:109], v198 offset:22528
  v_add_u32 v3, s48, v12
  v_mfma_f32_16x16x32_bf16 v[48:51], a[92:95], a[52:55], v[48:51]
  ds_read_b128 a[32:35], v208 offset:36864
  v_mfma_f32_16x16x32_bf16 v[48:51], a[96:99], a[72:75], v[48:51]
  ds_read_b128 a[36:39], v211 offset:41984
  v_mfma_f32_16x16x32_bf16 v[48:51], a[100:103], a[12:15], v[48:51]
  buffer_load_dwordx4 v203, s[8:11], s61 offen offset:1024 lds
  v_mfma_f32_16x16x32_bf16 v[44:47], a[100:103], a[8:11], v[44:47]
  s_sub_u32 s48, s48, 1024
  ds_read_b64_tr_b16 a[110:111], v198 offset:28672
  v_mfma_f32_16x16x32_bf16 v[44:47], a[96:99], a[68:71], v[44:47]
  ds_read_b64_tr_b16 a[112:113], v198 offset:23552
  v_add_u32 v12, 64, v10
  v_mfma_f32_16x16x32_bf16 v[44:47], a[92:95], a[48:51], v[44:47]
  ds_read_b64_tr_b16 a[114:115], v198 offset:29696
  v_mul_u32_u24 v13, 4682, v12
  v_mfma_f32_16x16x32_bf16 v[40:43], a[92:95], a[44:47], v[40:43]
  buffer_load_dwordx4 v204, s[8:11], s61 offen offset:2048 lds
  s_mov_b32 s62, 43008
  v_mfma_f32_16x16x32_bf16 v[40:43], a[96:99], a[64:67], v[40:43]
  s_add_u32 m0, s64, 33792
  ds_read_b64_tr_b16 a[80:81], v199 offset:21504
  v_lshrrev_b32 v13, 16, v13
  v_mfma_f32_16x16x32_bf16 v[40:43], a[100:103], a[4:7], v[40:43]
  v_mul_i32_i24 v14, -14, v13
  v_add3_u32 v12, v12, v14, s49
  v_mfma_f32_16x16x32_bf16 v[36:39], a[100:103], a[0:3], v[36:39]
  ds_read_b64_tr_b16 a[82:83], v199 offset:27648
  v_mfma_f32_16x16x32_bf16 v[36:39], a[96:99], a[60:63], v[36:39]
  buffer_load_dwordx4 v205, s[36:39], s62 offen offset:0 sc1 lds
  v_mfma_f32_16x16x32_bf16 v[36:39], a[92:95], a[40:43], v[36:39]
  s_waitcnt lgkmcnt(2)
  ds_read_b64_tr_b16 a[84:85], v199 offset:22528
  v_mfma_f32_16x16x32_bf16 v[52:55], a[60:63], a[104:107], v[52:55]
  v_add_u32 v14, -14, v12
  v_min_u32 v12, v12, v14
  v_mfma_f32_16x16x32_bf16 v[52:55], a[0:3], a[108:111], v[52:55]
  ds_read_b64_tr_b16 a[86:87], v199 offset:28672
  v_mul_u32_u24 v13, 7168, v13
  v_mfma_f32_16x16x32_bf16 v[52:55], a[20:23], a[112:115], v[52:55]
  s_waitcnt vmcnt(10)
  s_barrier
  buffer_load_dwordx4 v205, s[36:39], s62 offen offset:1024 sc1 lds
  v_mfma_f32_16x16x32_bf16 v[56:59], a[24:27], a[112:115], v[56:59]
  s_add_u32 m0, s65, 41984
  ds_read_b64_tr_b16 a[88:89], v199 offset:23552
  v_lshl_add_u32 v12, v12, 4, v13
  v_mfma_f32_16x16x32_bf16 v[56:59], a[4:7], a[108:111], v[56:59]
  v_add_u32 v4, s48, v12
  v_mfma_f32_16x16x32_bf16 v[56:59], a[64:67], a[104:107], v[56:59]
  ds_read_b64_tr_b16 a[90:91], v199 offset:29696
  v_mfma_f32_16x16x32_bf16 v[60:63], a[68:71], a[104:107], v[60:63]
  buffer_load_dword v206, s[36:39], s62 offen sc1 lds
  s_mov_b32 s61, 3934208
  v_mfma_f32_16x16x32_bf16 v[60:63], a[8:11], a[108:111], v[60:63]
  s_add_u32 m0, s63, 43008
  ds_read_b128 a[40:43], v208 offset:55296
  v_mfma_f32_16x16x32_bf16 v[60:63], a[28:31], a[112:115], v[60:63]
  s_sub_u32 s48, s48, 1024
  ds_read_b64_tr_b16 a[92:93], v198 offset:43008
  v_mfma_f32_16x16x32_bf16 v[64:67], a[32:35], a[112:115], v[64:67]
  ds_read_b128 a[44:47], v208 offset:56320
  v_mfma_f32_16x16x32_bf16 v[64:67], a[12:15], a[108:111], v[64:67]
  buffer_load_dwordx4 v202, s[8:11], s61 offen offset:0 lds
  v_add_u32 v12, 128, v10
  v_mfma_f32_16x16x32_bf16 v[64:67], a[72:75], a[104:107], v[64:67]
  ds_read_b64_tr_b16 a[94:95], v198 offset:49152
  v_mul_u32_u24 v13, 4682, v12
  v_mfma_f32_16x16x32_bf16 v[120:123], a[76:79], a[104:107], v[120:123]
  ds_read_b128 a[48:51], v208 offset:57344
  v_lshrrev_b32 v13, 16, v13
  v_mfma_f32_16x16x32_bf16 v[120:123], a[16:19], a[108:111], v[120:123]
  ds_read_b64_tr_b16 a[96:97], v198 offset:44032
  v_mul_i32_i24 v14, -14, v13
  v_mfma_f32_16x16x32_bf16 v[120:123], a[36:39], a[112:115], v[120:123]
  s_waitcnt lgkmcnt(6)
  buffer_load_dwordx4 v203, s[8:11], s61 offen offset:1024 lds
  v_add3_u32 v12, v12, v14, s49
  v_mfma_f32_16x16x32_bf16 v[80:83], a[72:75], a[80:83], v[80:83]
  ds_read_b128 a[52:55], v208 offset:58368
  v_mfma_f32_16x16x32_bf16 v[80:83], a[12:15], a[84:87], v[80:83]
  ds_read_b64_tr_b16 a[98:99], v198 offset:50176
  v_mfma_f32_16x16x32_bf16 v[80:83], a[32:35], a[88:91], v[80:83]
  ds_read_b128 a[56:59], v211 offset:63488
  v_mfma_f32_16x16x32_bf16 v[76:79], a[28:31], a[88:91], v[76:79]
  buffer_load_dwordx4 v204, s[8:11], s61 offen offset:2048 lds
  s_mov_b32 s62, 45056
  v_mfma_f32_16x16x32_bf16 v[76:79], a[8:11], a[84:87], v[76:79]
  s_add_u32 m0, s64, 55296
  ds_read_b64_tr_b16 a[100:101], v198 offset:45056
  v_add_u32 v14, -14, v12
  v_mfma_f32_16x16x32_bf16 v[76:79], a[68:71], a[80:83], v[76:79]
  ds_read_b64_tr_b16 a[102:103], v198 offset:51200
  v_min_u32 v12, v12, v14
  v_mfma_f32_16x16x32_bf16 v[72:75], a[64:67], a[80:83], v[72:75]
  ds_read_b64_tr_b16 a[104:105], v199 offset:43008
  v_mul_u32_u24 v13, 7168, v13
  v_mfma_f32_16x16x32_bf16 v[72:75], a[4:7], a[84:87], v[72:75]
  buffer_load_dwordx4 v205, s[36:39], s62 offen offset:0 sc1 lds
  v_lshl_add_u32 v12, v12, 4, v13
  v_mfma_f32_16x16x32_bf16 v[72:75], a[24:27], a[88:91], v[72:75]
  ds_read_b64_tr_b16 a[106:107], v199 offset:49152
  v_add_u32 v5, s48, v12
  v_mfma_f32_16x16x32_bf16 v[68:71], a[20:23], a[88:91], v[68:71]
  ds_read_b64_tr_b16 a[108:109], v199 offset:44032
  v_mfma_f32_16x16x32_bf16 v[68:71], a[0:3], a[84:87], v[68:71]
  ds_read_b64_tr_b16 a[110:111], v199 offset:50176
  v_mfma_f32_16x16x32_bf16 v[68:71], a[60:63], a[80:83], v[68:71]
  s_waitcnt lgkmcnt(4)
  buffer_load_dwordx4 v205, s[36:39], s62 offen offset:1024 sc1 lds
  s_add_u32 m0, s65, 63488
  v_mfma_f32_16x16x32_bf16 v[84:87], a[92:95], a[0:3], v[84:87]
  s_sub_u32 s48, s48, 1024
  ds_read_b64_tr_b16 a[112:113], v199 offset:45056
  v_mfma_f32_16x16x32_bf16 v[84:87], a[96:99], a[20:23], v[84:87]
  v_add_u32 v12, 192, v10
  v_mul_u32_u24 v13, 4682, v12
  v_mfma_f32_16x16x32_bf16 v[84:87], a[100:103], a[40:43], v[84:87]
  ds_read_b64_tr_b16 a[114:115], v199 offset:51200
  v_lshrrev_b32 v13, 16, v13
  v_mfma_f32_16x16x32_bf16 v[88:91], a[100:103], a[44:47], v[88:91]
  buffer_load_dword v206, s[36:39], s62 offen sc1 lds
  s_mov_b32 s61, 4132864
  v_mfma_f32_16x16x32_bf16 v[88:91], a[96:99], a[24:27], v[88:91]
  s_add_u32 m0, s63, 64512
  ds_read_b128 a[60:63], v209 offset:12288
  v_mul_i32_i24 v14, -14, v13
  v_mfma_f32_16x16x32_bf16 v[88:91], a[92:95], a[4:7], v[88:91]
  ds_read_b64_tr_b16 a[80:81], v200 offset:0
  v_add3_u32 v12, v12, v14, s49
  v_mfma_f32_16x16x32_bf16 v[92:95], a[92:95], a[8:11], v[92:95]
  ds_read_b128 a[64:67], v209 offset:13312
  v_mfma_f32_16x16x32_bf16 v[92:95], a[96:99], a[28:31], v[92:95]
  buffer_load_dwordx4 v202, s[8:11], s61 offen offset:0 lds
  v_mfma_f32_16x16x32_bf16 v[92:95], a[100:103], a[48:51], v[92:95]
  ds_read_b64_tr_b16 a[82:83], v200 offset:6144
  v_mfma_f32_16x16x32_bf16 v[96:99], a[100:103], a[52:55], v[96:99]
  ds_read_b128 a[68:71], v209 offset:14336
  v_add_u32 v14, -14, v12
  v_mfma_f32_16x16x32_bf16 v[96:99], a[96:99], a[32:35], v[96:99]
  ds_read_b64_tr_b16 a[84:85], v200 offset:1024
  v_min_u32 v12, v12, v14
  v_mfma_f32_16x16x32_bf16 v[96:99], a[92:95], a[12:15], v[96:99]
  s_waitcnt lgkmcnt(6)
  buffer_load_dwordx4 v203, s[8:11], s61 offen offset:1024 lds
  v_mul_u32_u24 v13, 7168, v13
  v_mfma_f32_16x16x32_bf16 v[112:115], a[104:107], a[12:15], v[112:115]
  ds_read_b128 a[72:75], v209 offset:15360
  v_lshl_add_u32 v12, v12, 4, v13
  v_mfma_f32_16x16x32_bf16 v[112:115], a[108:111], a[32:35], v[112:115]
  ds_read_b128 a[76:79], v212 offset:20480
  v_add_u32 v6, s48, v12
  v_mfma_f32_16x16x32_bf16 v[112:115], a[112:115], a[52:55], v[112:115]
  ds_read_b64_tr_b16 a[86:87], v200 offset:7168
  v_mfma_f32_16x16x32_bf16 v[108:111], a[112:115], a[48:51], v[108:111]
  buffer_load_dwordx4 v204, s[8:11], s61 offen offset:2048 lds
  s_mov_b32 s62, 47104
  v_mfma_f32_16x16x32_bf16 v[108:111], a[108:111], a[28:31], v[108:111]
  s_add_u32 m0, s64, 76800
  ds_read_b64_tr_b16 a[88:89], v200 offset:2048
  v_mfma_f32_16x16x32_bf16 v[108:111], a[104:107], a[8:11], v[108:111]
  s_sub_u32 s48, s48, -3072
  ds_read_b64_tr_b16 a[90:91], v200 offset:8192
  v_mfma_f32_16x16x32_bf16 v[104:107], a[104:107], a[4:7], v[104:107]
  v_add_u32 v12, 256, v10
  v_mul_u32_u24 v13, 4682, v12
  v_mfma_f32_16x16x32_bf16 v[104:107], a[108:111], a[24:27], v[104:107]
  buffer_load_dwordx4 v205, s[36:39], s62 offen offset:0 sc1 lds
  v_lshrrev_b32 v13, 16, v13
  v_mfma_f32_16x16x32_bf16 v[104:107], a[112:115], a[44:47], v[104:107]
  ds_read_b64_tr_b16 a[92:93], v201 offset:0
  v_mul_i32_i24 v14, -14, v13
  v_mfma_f32_16x16x32_bf16 v[100:103], a[112:115], a[40:43], v[100:103]
  ds_read_b64_tr_b16 a[94:95], v201 offset:6144
  v_add3_u32 v12, v12, v14, s49
  v_mfma_f32_16x16x32_bf16 v[100:103], a[108:111], a[20:23], v[100:103]
  v_mfma_f32_16x16x32_bf16 v[100:103], a[104:107], a[0:3], v[100:103]
  s_waitcnt lgkmcnt(2)
  buffer_load_dwordx4 v205, s[36:39], s62 offen offset:1024 sc1 lds
  s_add_u32 m0, s65, 84992
  v_mfma_f32_16x16x32_bf16 v[20:23], a[80:83], a[20:23], v[20:23]
  ds_read_b64_tr_b16 a[96:97], v201 offset:1024
  v_mfma_f32_16x16x32_bf16 v[20:23], a[84:87], a[40:43], v[20:23]
  ds_read_b64_tr_b16 a[98:99], v201 offset:7168
  v_mfma_f32_16x16x32_bf16 v[20:23], a[88:91], a[60:63], v[20:23]
  s_waitcnt vmcnt(11)
  s_barrier
  v_add_u32 v14, -14, v12
  v_mfma_f32_16x16x32_bf16 v[24:27], a[88:91], a[64:67], v[24:27]
  buffer_load_dword v206, s[36:39], s62 offen sc1 lds
  s_mov_b32 s61, 4325376
  v_mfma_f32_16x16x32_bf16 v[24:27], a[84:87], a[44:47], v[24:27]
  s_add_u32 m0, s63, 86016
  ds_read_b64_tr_b16 a[100:101], v201 offset:2048
  v_min_u32 v12, v12, v14
  v_mfma_f32_16x16x32_bf16 v[24:27], a[80:83], a[24:27], v[24:27]
  ds_read_b64_tr_b16 a[102:103], v201 offset:8192
  v_mul_u32_u24 v13, 7168, v13
  v_mfma_f32_16x16x32_bf16 v[28:31], a[80:83], a[28:31], v[28:31]
  ds_read_b128 a[0:3], v207 offset:12288
  v_lshl_add_u32 v12, v12, 4, v13
  v_mfma_f32_16x16x32_bf16 v[28:31], a[84:87], a[48:51], v[28:31]
  buffer_load_dwordx4 v202, s[8:11], s61 offen offset:0 lds
  v_add_u32 v7, s48, v12
  v_mfma_f32_16x16x32_bf16 v[28:31], a[88:91], a[68:71], v[28:31]
  ds_read_b64_tr_b16 a[104:105], v196 offset:0
  v_mfma_f32_16x16x32_bf16 v[32:35], a[88:91], a[72:75], v[32:35]
  ds_read_b128 a[4:7], v207 offset:13312
  v_mfma_f32_16x16x32_bf16 v[32:35], a[84:87], a[52:55], v[32:35]
  s_sub_u32 s48, s48, 1024
  ds_read_b64_tr_b16 a[106:107], v196 offset:6144
  v_mfma_f32_16x16x32_bf16 v[32:35], a[80:83], a[32:35], v[32:35]
  buffer_load_dwordx4 v203, s[8:11], s61 offen offset:1024 lds
  v_mfma_f32_16x16x32_bf16 v[116:119], a[80:83], a[36:39], v[116:119]
  ds_read_b128 a[8:11], v207 offset:14336
  v_add_u32 v12, 320, v10
  v_mfma_f32_16x16x32_bf16 v[116:119], a[84:87], a[56:59], v[116:119]
  ds_read_b64_tr_b16 a[108:109], v196 offset:1024
  v_mul_u32_u24 v13, 4682, v12
  v_mfma_f32_16x16x32_bf16 v[116:119], a[88:91], a[76:79], v[116:119]
  s_waitcnt lgkmcnt(6)
  ds_read_b128 a[12:15], v207 offset:15360
  v_lshrrev_b32 v13, 16, v13
  v_mfma_f32_16x16x32_bf16 v[48:51], a[92:95], a[32:35], v[48:51]
  buffer_load_dwordx4 v204, s[8:11], s61 offen offset:2048 lds
  s_mov_b32 s62, 49152
  v_mfma_f32_16x16x32_bf16 v[48:51], a[96:99], a[52:55], v[48:51]
  s_add_u32 m0, s64, 98304
  ds_read_b128 a[16:19], v210 offset:20480
  v_mul_i32_i24 v14, -14, v13
  v_mfma_f32_16x16x32_bf16 v[48:51], a[100:103], a[72:75], v[48:51]
  ds_read_b64_tr_b16 a[110:111], v196 offset:7168
  v_add3_u32 v12, v12, v14, s49
  v_mfma_f32_16x16x32_bf16 v[44:47], a[100:103], a[68:71], v[44:47]
  ds_read_b64_tr_b16 a[112:113], v196 offset:2048
  v_mfma_f32_16x16x32_bf16 v[44:47], a[96:99], a[48:51], v[44:47]
  buffer_load_dwordx4 v205, s[36:39], s62 offen offset:0 sc1 lds
  v_mfma_f32_16x16x32_bf16 v[44:47], a[92:95], a[28:31], v[44:47]
  ds_read_b64_tr_b16 a[114:115], v196 offset:8192
  v_add_u32 v14, -14, v12
  v_mfma_f32_16x16x32_bf16 v[40:43], a[92:95], a[24:27], v[40:43]
  v_min_u32 v12, v12, v14
  v_mul_u32_u24 v13, 7168, v13
  v_mfma_f32_16x16x32_bf16 v[40:43], a[96:99], a[44:47], v[40:43]
  ds_read_b64_tr_b16 a[80:81], v197 offset:0
  v_lshl_add_u32 v12, v12, 4, v13
  v_mfma_f32_16x16x32_bf16 v[40:43], a[100:103], a[64:67], v[40:43]
  buffer_load_dwordx4 v205, s[36:39], s62 offen offset:1024 sc1 lds
  s_add_u32 m0, s65, 106496
  v_mfma_f32_16x16x32_bf16 v[36:39], a[100:103], a[60:63], v[36:39]
  ds_read_b64_tr_b16 a[82:83], v197 offset:6144
  v_add_u32 v8, s48, v12
  v_mfma_f32_16x16x32_bf16 v[36:39], a[96:99], a[40:43], v[36:39]
  v_mfma_f32_16x16x32_bf16 v[36:39], a[92:95], a[20:23], v[36:39]
  s_waitcnt lgkmcnt(2)
  ds_read_b64_tr_b16 a[84:85], v197 offset:1024
  v_mfma_f32_16x16x32_bf16 v[52:55], a[40:43], a[104:107], v[52:55]
  buffer_load_dword v206, s[36:39], s62 offen sc1 lds
  s_mov_b32 s61, 4524032
  v_mfma_f32_16x16x32_bf16 v[52:55], a[60:63], a[108:111], v[52:55]
  s_add_u32 m0, s63, 107520
  ds_read_b64_tr_b16 a[86:87], v197 offset:7168
  s_sub_u32 s48, s48, 1024
  v_mfma_f32_16x16x32_bf16 v[52:55], a[0:3], a[112:115], v[52:55]
  v_add_u32 v12, 384, v10
  v_mul_u32_u24 v13, 4682, v12
  v_mfma_f32_16x16x32_bf16 v[56:59], a[4:7], a[112:115], v[56:59]
  ds_read_b64_tr_b16 a[88:89], v197 offset:2048
  v_lshrrev_b32 v13, 16, v13
  v_mfma_f32_16x16x32_bf16 v[56:59], a[64:67], a[108:111], v[56:59]
  buffer_load_dwordx4 v202, s[8:11], s61 offen offset:0 lds
  v_mul_i32_i24 v14, -14, v13
  v_mfma_f32_16x16x32_bf16 v[56:59], a[44:47], a[104:107], v[56:59]
  ds_read_b64_tr_b16 a[90:91], v197 offset:8192
  v_add3_u32 v12, v12, v14, s49
  v_mfma_f32_16x16x32_bf16 v[60:63], a[48:51], a[104:107], v[60:63]
  ds_read_b128 a[20:23], v207 offset:33792
  v_mfma_f32_16x16x32_bf16 v[60:63], a[68:71], a[108:111], v[60:63]
  ds_read_b64_tr_b16 a[92:93], v196 offset:21504
  v_mfma_f32_16x16x32_bf16 v[60:63], a[8:11], a[112:115], v[60:63]
  buffer_load_dwordx4 v203, s[8:11], s61 offen offset:1024 lds
  v_mfma_f32_16x16x32_bf16 v[64:67], a[12:15], a[112:115], v[64:67]
  ds_read_b128 a[24:27], v207 offset:34816
  v_mfma_f32_16x16x32_bf16 v[64:67], a[72:75], a[108:111], v[64:67]
  ds_read_b64_tr_b16 a[94:95], v196 offset:27648
  v_add_u32 v14, -14, v12
  v_mfma_f32_16x16x32_bf16 v[64:67], a[52:55], a[104:107], v[64:67]
  ds_read_b128 a[28:31], v207 offset:35840
  v_min_u32 v12, v12, v14
  v_mfma_f32_16x16x32_bf16 v[120:123], a[56:59], a[104:107], v[120:123]
  buffer_load_dwordx4 v204, s[8:11], s61 offen offset:2048 lds
  s_mov_b32 s62, 51200
  v_mfma_f32_16x16x32_bf16 v[120:123], a[76:79], a[108:111], v[120:123]
  s_add_u32 m0, s64, 119808
  ds_read_b64_tr_b16 a[96:97], v196 offset:22528
  v_mul_u32_u24 v13, 7168, v13
  v_mfma_f32_16x16x32_bf16 v[120:123], a[16:19], a[112:115], v[120:123]
  s_waitcnt lgkmcnt(6)
  ds_read_b128 a[32:35], v207 offset:36864
  v_lshl_add_u32 v12, v12, 4, v13
  v_mfma_f32_16x16x32_bf16 v[80:83], a[52:55], a[80:83], v[80:83]
  ds_read_b64_tr_b16 a[98:99], v196 offset:28672
  v_add_u32 v9, s48, v12
  v_mfma_f32_16x16x32_bf16 v[80:83], a[72:75], a[84:87], v[80:83]
  buffer_load_dwordx4 v205, s[36:39], s62 offen offset:0 sc1 lds
  v_mfma_f32_16x16x32_bf16 v[80:83], a[12:15], a[88:91], v[80:83]
  ds_read_b128 a[36:39], v210 offset:41984
  v_mfma_f32_16x16x32_bf16 v[76:79], a[8:11], a[88:91], v[76:79]
  s_sub_u32 s48, s48, 1024
  ds_read_b64_tr_b16 a[100:101], v196 offset:23552
  v_mfma_f32_16x16x32_bf16 v[76:79], a[68:71], a[84:87], v[76:79]
  ds_read_b64_tr_b16 a[102:103], v196 offset:29696
  v_mfma_f32_16x16x32_bf16 v[76:79], a[48:51], a[80:83], v[76:79]
  s_and_b32 s48, s58, 1
  buffer_load_dwordx4 v205, s[36:39], s62 offen offset:1024 sc1 lds
  s_add_u32 m0, s65, 128000
  v_mfma_f32_16x16x32_bf16 v[72:75], a[44:47], a[80:83], v[72:75]
  s_lshl_b32 s48, s48, 7
  ds_read_b64_tr_b16 a[104:105], v197 offset:21504
  s_and_b32 s49, s58, 6
  v_mfma_f32_16x16x32_bf16 v[72:75], a[64:67], a[84:87], v[72:75]
  s_add_u32 s48, s48, s49
  ds_read_b64_tr_b16 a[106:107], v197 offset:27648
  v_mfma_f32_16x16x32_bf16 v[72:75], a[4:7], a[88:91], v[72:75]
  ds_read_b64_tr_b16 a[108:109], v197 offset:22528
  v_mfma_f32_16x16x32_bf16 v[68:71], a[0:3], a[88:91], v[68:71]
  buffer_load_dword v206, s[36:39], s62 offen sc1 lds
  v_mfma_f32_16x16x32_bf16 v[68:71], a[60:63], a[84:87], v[68:71]
  s_mov_b32 s61, 4722688
  s_add_u32 m0, s63, 129024
  ds_read_b64_tr_b16 a[110:111], v197 offset:28672
  v_mfma_f32_16x16x32_bf16 v[68:71], a[40:43], a[80:83], v[68:71]
  s_waitcnt vmcnt(12) lgkmcnt(4)
  s_barrier
  v_bfe_u32 v12, v10, 1, 4
  v_mfma_f32_16x16x32_bf16 v[84:87], a[92:95], a[60:63], v[84:87]
  ds_read_b64_tr_b16 a[112:113], v197 offset:23552
  v_and_b32 v13, 1, v10
  v_mfma_f32_16x16x32_bf16 v[84:87], a[96:99], a[0:3], v[84:87]
  buffer_load_dwordx4 v202, s[8:11], s61 offen offset:0 lds
  v_lshl_add_u32 v12, v12, 3, v13
  v_mfma_f32_16x16x32_bf16 v[84:87], a[100:103], a[20:23], v[84:87]
  ds_read_b64_tr_b16 a[114:115], v197 offset:29696
  v_add_lshl_u32 v251, v12, s48, 7
  v_mfma_f32_16x16x32_bf16 v[88:91], a[100:103], a[24:27], v[88:91]
  ds_read_b128 a[40:43], v207 offset:55296
  v_mfma_f32_16x16x32_bf16 v[88:91], a[96:99], a[4:7], v[88:91]
  ds_read_b64_tr_b16 a[80:81], v196 offset:43008
  v_mfma_f32_16x16x32_bf16 v[88:91], a[92:95], a[64:67], v[88:91]
  ds_read_b128 a[44:47], v207 offset:56320
  v_mfma_f32_16x16x32_bf16 v[92:95], a[92:95], a[68:71], v[92:95]
  buffer_load_dwordx4 v203, s[8:11], s61 offen offset:1024 lds
  v_add_u32 v251, 98304, v251
  v_mfma_f32_16x16x32_bf16 v[92:95], a[96:99], a[8:11], v[92:95]
  ds_read_b64_tr_b16 a[82:83], v196 offset:49152
  v_and_b32 v12, 7, v10
  v_mfma_f32_16x16x32_bf16 v[92:95], a[100:103], a[28:31], v[92:95]
  ds_read_b128 a[48:51], v207 offset:57344
  v_lshlrev_b32 v12, 5, v12
  v_mfma_f32_16x16x32_bf16 v[96:99], a[100:103], a[32:35], v[96:99]
  s_and_b32 s48, s2, 31
  ds_read_b64_tr_b16 a[84:85], v196 offset:44032
  v_add_lshl_u32 v12, v12, s48, 7
  v_mfma_f32_16x16x32_bf16 v[96:99], a[96:99], a[12:15], v[96:99]
  ds_read_b128 a[52:55], v207 offset:58368
  v_cmp_gt_u32 vcc, 32, v10
  v_mfma_f32_16x16x32_bf16 v[96:99], a[92:95], a[72:75], v[96:99]
  s_waitcnt lgkmcnt(7)
  buffer_load_dwordx4 v204, s[8:11], s61 offen offset:2048 lds
  s_mov_b32 s62, 53248
  v_mfma_f32_16x16x32_bf16 v[112:115], a[104:107], a[72:75], v[112:115]
  s_add_u32 m0, s64, 141312
  ds_read_b128 a[56:59], v210 offset:63488
  s_nop 1
  v_mfma_f32_16x16x32_bf16 v[112:115], a[108:111], a[12:15], v[112:115]
  ds_read_b64_tr_b16 a[86:87], v196 offset:50176
  v_cndmask_b32 v251, v12, v251, vcc
  v_mfma_f32_16x16x32_bf16 v[112:115], a[112:115], a[32:35], v[112:115]
  ds_read_b64_tr_b16 a[88:89], v196 offset:45056
  v_mfma_f32_16x16x32_bf16 v[108:111], a[112:115], a[28:31], v[108:111]
  buffer_load_dwordx4 v205, s[36:39], s62 offen offset:0 sc1 lds
  v_mfma_f32_16x16x32_bf16 v[108:111], a[108:111], a[8:11], v[108:111]
  ds_read_b64_tr_b16 a[90:91], v196 offset:51200
  v_mfma_f32_16x16x32_bf16 v[108:111], a[104:107], a[68:71], v[108:111]
  v_mfma_f32_16x16x32_bf16 v[104:107], a[104:107], a[64:67], v[104:107]
  v_mfma_f32_16x16x32_bf16 v[104:107], a[108:111], a[4:7], v[104:107]
  buffer_load_dwordx4 v205, s[36:39], s62 offen offset:1024 sc1 lds
  s_add_u32 m0, s65, 149504
  v_mfma_f32_16x16x32_bf16 v[104:107], a[112:115], a[24:27], v[104:107]
  ds_read_b64_tr_b16 a[92:93], v197 offset:43008
  v_mfma_f32_16x16x32_bf16 v[100:103], a[112:115], a[20:23], v[100:103]
  ds_read_b64_tr_b16 a[94:95], v197 offset:49152
  v_mfma_f32_16x16x32_bf16 v[100:103], a[108:111], a[0:3], v[100:103]
  v_mfma_f32_16x16x32_bf16 v[100:103], a[104:107], a[60:63], v[100:103]
  s_waitcnt lgkmcnt(2)
  buffer_load_dword v206, s[36:39], s62 offen sc1 lds
  s_mov_b32 s61, 4915200
  v_mfma_f32_16x16x32_bf16 v[20:23], a[80:83], a[0:3], v[20:23]
  s_add_u32 m0, s63, 0
  ds_read_b64_tr_b16 a[96:97], v197 offset:44032
  v_mfma_f32_16x16x32_bf16 v[20:23], a[84:87], a[20:23], v[20:23]
  ds_read_b64_tr_b16 a[98:99], v197 offset:50176
  v_mfma_f32_16x16x32_bf16 v[20:23], a[88:91], a[40:43], v[20:23]
  v_mfma_f32_16x16x32_bf16 v[24:27], a[88:91], a[44:47], v[24:27]
  buffer_load_dwordx4 v202, s[8:11], s61 offen offset:0 lds
  v_mfma_f32_16x16x32_bf16 v[24:27], a[84:87], a[24:27], v[24:27]
  ds_read_b64_tr_b16 a[100:101], v197 offset:45056
  v_mfma_f32_16x16x32_bf16 v[24:27], a[80:83], a[4:7], v[24:27]
  ds_read_b64_tr_b16 a[102:103], v197 offset:51200
  v_mfma_f32_16x16x32_bf16 v[28:31], a[80:83], a[8:11], v[28:31]
  ds_read_b128 a[60:63], v208 offset:12288
  v_mfma_f32_16x16x32_bf16 v[28:31], a[84:87], a[28:31], v[28:31]
  buffer_load_dwordx4 v203, s[8:11], s61 offen offset:1024 lds
  v_mfma_f32_16x16x32_bf16 v[28:31], a[88:91], a[48:51], v[28:31]
  ds_read_b64_tr_b16 a[104:105], v198 offset:0
  v_mfma_f32_16x16x32_bf16 v[32:35], a[88:91], a[52:55], v[32:35]
  ds_read_b128 a[64:67], v208 offset:13312
  v_mfma_f32_16x16x32_bf16 v[32:35], a[84:87], a[32:35], v[32:35]
  ds_read_b64_tr_b16 a[106:107], v198 offset:6144
  v_mfma_f32_16x16x32_bf16 v[32:35], a[80:83], a[12:15], v[32:35]
  buffer_load_dwordx4 v204, s[8:11], s61 offen offset:2048 lds
  s_mov_b32 s62, 55296
  v_mfma_f32_16x16x32_bf16 v[116:119], a[80:83], a[16:19], v[116:119]
  s_add_u32 m0, s64, 12288
  ds_read_b128 a[68:71], v208 offset:14336
  v_mfma_f32_16x16x32_bf16 v[116:119], a[84:87], a[36:39], v[116:119]
  ds_read_b64_tr_b16 a[108:109], v198 offset:1024
  v_mfma_f32_16x16x32_bf16 v[116:119], a[88:91], a[56:59], v[116:119]
  s_waitcnt lgkmcnt(6)
  ds_read_b128 a[72:75], v208 offset:15360
  v_mfma_f32_16x16x32_bf16 v[48:51], a[92:95], a[12:15], v[48:51]
  buffer_load_dwordx4 v205, s[36:39], s62 offen offset:0 sc1 lds
  v_mfma_f32_16x16x32_bf16 v[48:51], a[96:99], a[32:35], v[48:51]
  ds_read_b128 a[76:79], v211 offset:20480
  v_mfma_f32_16x16x32_bf16 v[48:51], a[100:103], a[52:55], v[48:51]
  ds_read_b64_tr_b16 a[110:111], v198 offset:7168
  v_mfma_f32_16x16x32_bf16 v[44:47], a[100:103], a[48:51], v[44:47]
  ds_read_b64_tr_b16 a[112:113], v198 offset:2048
  v_mfma_f32_16x16x32_bf16 v[44:47], a[96:99], a[28:31], v[44:47]
  buffer_load_dwordx4 v205, s[36:39], s62 offen offset:1024 sc1 lds
  s_add_u32 m0, s65, 20480
  v_mfma_f32_16x16x32_bf16 v[44:47], a[92:95], a[8:11], v[44:47]
  ds_read_b64_tr_b16 a[114:115], v198 offset:8192
  v_mfma_f32_16x16x32_bf16 v[40:43], a[92:95], a[4:7], v[40:43]
  v_mfma_f32_16x16x32_bf16 v[40:43], a[96:99], a[24:27], v[40:43]
  ds_read_b64_tr_b16 a[80:81], v199 offset:0
  v_mfma_f32_16x16x32_bf16 v[40:43], a[100:103], a[44:47], v[40:43]
  buffer_load_dword v206, s[36:39], s62 offen sc1 lds
  v_mfma_f32_16x16x32_bf16 v[36:39], a[100:103], a[40:43], v[36:39]
  ds_read_b64_tr_b16 a[82:83], v199 offset:6144
  v_mfma_f32_16x16x32_bf16 v[36:39], a[96:99], a[20:23], v[36:39]
  v_mfma_f32_16x16x32_bf16 v[36:39], a[92:95], a[0:3], v[36:39]
  s_waitcnt lgkmcnt(2)
  ds_read_b64_tr_b16 a[84:85], v199 offset:1024
  v_mfma_f32_16x16x32_bf16 v[52:55], a[20:23], a[104:107], v[52:55]
  v_mfma_f32_16x16x32_bf16 v[52:55], a[40:43], a[108:111], v[52:55]
  s_mov_b32 s61, 5113856
  s_add_u32 m0, s63, 21504
  ds_read_b64_tr_b16 a[86:87], v199 offset:7168
  v_mfma_f32_16x16x32_bf16 v[52:55], a[60:63], a[112:115], v[52:55]
  s_waitcnt vmcnt(12)
  s_barrier
  v_mfma_f32_16x16x32_bf16 v[56:59], a[64:67], a[112:115], v[56:59]
  ds_read_b64_tr_b16 a[88:89], v199 offset:2048
  v_mfma_f32_16x16x32_bf16 v[56:59], a[44:47], a[108:111], v[56:59]
  buffer_load_dwordx4 v202, s[8:11], s61 offen offset:0 lds
  v_mfma_f32_16x16x32_bf16 v[56:59], a[24:27], a[104:107], v[56:59]
  ds_read_b64_tr_b16 a[90:91], v199 offset:8192
  v_mfma_f32_16x16x32_bf16 v[60:63], a[28:31], a[104:107], v[60:63]
  ds_read_b128 a[0:3], v208 offset:33792
  v_mfma_f32_16x16x32_bf16 v[60:63], a[48:51], a[108:111], v[60:63]
  ds_read_b64_tr_b16 a[92:93], v198 offset:21504
  v_mfma_f32_16x16x32_bf16 v[60:63], a[68:71], a[112:115], v[60:63]
  ds_read_b128 a[4:7], v208 offset:34816
  v_mfma_f32_16x16x32_bf16 v[64:67], a[72:75], a[112:115], v[64:67]
  buffer_load_dwordx4 v203, s[8:11], s61 offen offset:1024 lds
  v_mfma_f32_16x16x32_bf16 v[64:67], a[52:55], a[108:111], v[64:67]
  ds_read_b64_tr_b16 a[94:95], v198 offset:27648
  v_mfma_f32_16x16x32_bf16 v[64:67], a[32:35], a[104:107], v[64:67]
  ds_read_b128 a[8:11], v208 offset:35840
  v_mfma_f32_16x16x32_bf16 v[120:123], a[36:39], a[104:107], v[120:123]
  ds_read_b64_tr_b16 a[96:97], v198 offset:22528
  v_mfma_f32_16x16x32_bf16 v[120:123], a[56:59], a[108:111], v[120:123]
  ds_read_b128 a[12:15], v208 offset:36864
  v_mfma_f32_16x16x32_bf16 v[120:123], a[76:79], a[112:115], v[120:123]
  s_waitcnt lgkmcnt(7)
  buffer_load_dwordx4 v204, s[8:11], s61 offen offset:2048 lds
  s_mov_b32 s62, 57344
  v_mfma_f32_16x16x32_bf16 v[80:83], a[32:35], a[80:83], v[80:83]
  s_add_u32 m0, s64, 33792
  ds_read_b64_tr_b16 a[98:99], v198 offset:28672
  v_mfma_f32_16x16x32_bf16 v[80:83], a[52:55], a[84:87], v[80:83]
  ds_read_b128 a[16:19], v211 offset:41984
  v_mfma_f32_16x16x32_bf16 v[80:83], a[72:75], a[88:91], v[80:83]
  ds_read_b64_tr_b16 a[100:101], v198 offset:23552
  v_mfma_f32_16x16x32_bf16 v[76:79], a[68:71], a[88:91], v[76:79]
  buffer_load_dwordx4 v205, s[36:39], s62 offen offset:0 sc1 lds
  v_mfma_f32_16x16x32_bf16 v[76:79], a[48:51], a[84:87], v[76:79]
  ds_read_b64_tr_b16 a[102:103], v198 offset:29696
  v_mfma_f32_16x16x32_bf16 v[76:79], a[28:31], a[80:83], v[76:79]
  ds_read_b64_tr_b16 a[104:105], v199 offset:21504
  v_mfma_f32_16x16x32_bf16 v[72:75], a[24:27], a[80:83], v[72:75]
  ds_read_b64_tr_b16 a[106:107], v199 offset:27648
  v_mfma_f32_16x16x32_bf16 v[72:75], a[44:47], a[84:87], v[72:75]
  buffer_load_dwordx4 v205, s[36:39], s62 offen offset:1024 sc1 lds
  s_add_u32 m0, s65, 41984
  v_mfma_f32_16x16x32_bf16 v[72:75], a[64:67], a[88:91], v[72:75]
  ds_read_b64_tr_b16 a[108:109], v199 offset:22528
  v_mfma_f32_16x16x32_bf16 v[68:71], a[60:63], a[88:91], v[68:71]
  s_lshr_b32 s68, s2, 3
  s_lshl2_add_u32 s68, s68, s44
  s_bfe_u32 s69, s2, 0x20001
  v_mfma_f32_16x16x32_bf16 v[68:71], a[40:43], a[84:87], v[68:71]
  s_lshl_b32 s69, s69, 7
  s_add_u32 s69, s69, s68
  s_lshl_b32 s69, s69, 13
  v_mfma_f32_16x16x32_bf16 v[68:71], a[20:23], a[80:83], v[68:71]
  s_waitcnt lgkmcnt(3)
  s_lshl_b32 s68, s68, 14
  s_bitcmp1_b32 s2, 0
  v_mfma_f32_16x16x32_bf16 v[84:87], a[92:95], a[40:43], v[84:87]
  s_cselect_b32 s68, s68, 1073741824
  s_cselect_b32 s69, s69, 1073741824
  buffer_load_dword v206, s[36:39], s62 offen sc1 lds
  v_mfma_f32_16x16x32_bf16 v[84:87], a[96:99], a[60:63], v[84:87]
  s_mov_b32 s61, 5312512
  s_add_u32 m0, s63, 43008
  ds_read_b64_tr_b16 a[110:111], v199 offset:28672
  v_mfma_f32_16x16x32_bf16 v[84:87], a[100:103], a[0:3], v[84:87]
  ds_read_b64_tr_b16 a[112:113], v199 offset:23552
  v_and_b32 v214, 15, v10
  v_mfma_f32_16x16x32_bf16 v[88:91], a[100:103], a[4:7], v[88:91]
  ds_read_b64_tr_b16 a[114:115], v199 offset:29696
  v_lshlrev_b32 v214, 10, v214
  v_mfma_f32_16x16x32_bf16 v[88:91], a[96:99], a[64:67], v[88:91]
  buffer_load_dwordx4 v202, s[8:11], s61 offen offset:0 lds
  v_mfma_f32_16x16x32_bf16 v[88:91], a[92:95], a[44:47], v[88:91]
Ha0_1:
  s_cbranch_execz Ha0_2
  ds_read_b128 a[20:23], v208 offset:55296
  v_mfma_f32_16x16x32_bf16 v[92:95], a[92:95], a[48:51], v[92:95]
  ds_read_b64_tr_b16 a[80:81], v198 offset:43008
  v_mfma_f32_16x16x32_bf16 v[92:95], a[96:99], a[68:71], v[92:95]
  ds_read_b128 a[24:27], v208 offset:56320
  v_mfma_f32_16x16x32_bf16 v[92:95], a[100:103], a[8:11], v[92:95]
  buffer_load_dwordx4 v203, s[8:11], s61 offen offset:1024 lds
  v_mfma_f32_16x16x32_bf16 v[96:99], a[100:103], a[12:15], v[96:99]
  ds_read_b64_tr_b16 a[82:83], v198 offset:49152
  v_mfma_f32_16x16x32_bf16 v[96:99], a[96:99], a[72:75], v[96:99]
  ds_read_b128 a[28:31], v208 offset:57344
  v_mfma_f32_16x16x32_bf16 v[96:99], a[92:95], a[52:55], v[96:99]
  s_waitcnt lgkmcnt(5)
  ds_read_b64_tr_b16 a[84:85], v198 offset:44032
  v_mfma_f32_16x16x32_bf16 v[112:115], a[104:107], a[52:55], v[112:115]
  ds_read_b128 a[32:35], v208 offset:58368
  v_mfma_f32_16x16x32_bf16 v[112:115], a[108:111], a[72:75], v[112:115]
  buffer_load_dwordx4 v204, s[8:11], s61 offen offset:2048 lds
  s_mov_b32 s62, 59392
  v_mfma_f32_16x16x32_bf16 v[112:115], a[112:115], a[12:15], v[112:115]
  s_add_u32 m0, s64, 55296
  ds_read_b128 a[36:39], v211 offset:63488
  v_mfma_f32_16x16x32_bf16 v[108:111], a[112:115], a[8:11], v[108:111]
  ds_read_b64_tr_b16 a[86:87], v198 offset:50176
  v_mfma_f32_16x16x32_bf16 v[108:111], a[108:111], a[68:71], v[108:111]
  ds_read_b64_tr_b16 a[88:89], v198 offset:45056
  v_mfma_f32_16x16x32_bf16 v[108:111], a[104:107], a[48:51], v[108:111]
  buffer_load_dwordx4 v205, s[36:39], s62 offen offset:0 sc1 lds
  v_mfma_f32_16x16x32_bf16 v[104:107], a[104:107], a[44:47], v[104:107]
  ds_read_b64_tr_b16 a[90:91], v198 offset:51200
  v_mfma_f32_16x16x32_bf16 v[104:107], a[108:111], a[64:67], v[104:107]
  ds_read_b64_tr_b16 a[92:93], v199 offset:43008
  v_mfma_f32_16x16x32_bf16 v[104:107], a[112:115], a[4:7], v[104:107]
  v_mfma_f32_16x16x32_bf16 v[100:103], a[112:115], a[0:3], v[100:103]
  buffer_load_dwordx4 v205, s[36:39], s62 offen offset:1024 sc1 lds
  s_add_u32 m0, s65, 63488
  v_mfma_f32_16x16x32_bf16 v[100:103], a[108:111], a[60:63], v[100:103]
  ds_read_b64_tr_b16 a[94:95], v199 offset:49152
  v_mfma_f32_16x16x32_bf16 v[100:103], a[104:107], a[40:43], v[100:103]
  s_waitcnt lgkmcnt(2)
  ds_read_b64_tr_b16 a[96:97], v199 offset:44032
  v_mfma_f32_16x16x32_bf16 v[20:23], a[80:83], a[60:63], v[20:23]
  v_mfma_f32_16x16x32_bf16 v[20:23], a[84:87], a[0:3], v[20:23]
  buffer_load_dword v206, s[36:39], s62 offen sc1 lds
  s_mov_b32 s61, 5505024
  v_mfma_f32_16x16x32_bf16 v[20:23], a[88:91], a[20:23], v[20:23]
  s_waitcnt vmcnt(12)
  s_barrier
  s_add_u32 m0, s63, 64512
  v_mfma_f32_16x16x32_bf16 v[24:27], a[88:91], a[24:27], v[24:27]
  ds_read_b64_tr_b16 a[98:99], v199 offset:50176
  v_mfma_f32_16x16x32_bf16 v[24:27], a[84:87], a[4:7], v[24:27]
  ds_read_b64_tr_b16 a[100:101], v199 offset:45056
  v_mfma_f32_16x16x32_bf16 v[24:27], a[80:83], a[64:67], v[24:27]
  buffer_load_dword a252, v214, s[12:15], s68 offen offset:384
  v_and_b32 v214, 0x1fff, v214
  v_mfma_f32_16x16x32_bf16 v[28:31], a[80:83], a[68:71], v[28:31]
  ds_read_b64_tr_b16 a[102:103], v199 offset:51200
  v_mfma_f32_16x16x32_bf16 v[28:31], a[84:87], a[8:11], v[28:31]
  ds_read_b128 a[40:43], v209 offset:12288
  v_mfma_f32_16x16x32_bf16 v[28:31], a[88:91], a[28:31], v[28:31]
  ds_read_b64_tr_b16 a[104:105], v200 offset:0
  v_mfma_f32_16x16x32_bf16 v[32:35], a[88:91], a[32:35], v[32:35]
  buffer_load_dwordx4 v202, s[8:11], s61 offen offset:0 lds
  v_mfma_f32_16x16x32_bf16 v[32:35], a[84:87], a[12:15], v[32:35]
  ds_read_b128 a[44:47], v209 offset:13312
  v_mfma_f32_16x16x32_bf16 v[32:35], a[80:83], a[72:75], v[32:35]
  ds_read_b64_tr_b16 a[106:107], v200 offset:6144
  v_mfma_f32_16x16x32_bf16 v[116:119], a[80:83], a[76:79], v[116:119]
  ds_read_b128 a[48:51], v209 offset:14336
  v_mfma_f32_16x16x32_bf16 v[116:119], a[84:87], a[16:19], v[116:119]
  buffer_load_dword a252, v214, s[4:7], s69 offen offset:384
  v_mfma_f32_16x16x32_bf16 v[116:119], a[88:91], a[36:39], v[116:119]
  s_waitcnt lgkmcnt(5)
  ds_read_b64_tr_b16 a[108:109], v200 offset:1024
  v_mfma_f32_16x16x32_bf16 v[48:51], a[92:95], a[72:75], v[48:51]
  ds_read_b128 a[52:55], v209 offset:15360
  v_mfma_f32_16x16x32_bf16 v[48:51], a[96:99], a[12:15], v[48:51]
  ds_read_b128 a[56:59], v212 offset:20480
  v_mfma_f32_16x16x32_bf16 v[48:51], a[100:103], a[32:35], v[48:51]
  buffer_load_dwordx4 v203, s[8:11], s61 offen offset:1024 lds
  v_mfma_f32_16x16x32_bf16 v[44:47], a[100:103], a[28:31], v[44:47]
  ds_read_b64_tr_b16 a[110:111], v200 offset:7168
  v_mfma_f32_16x16x32_bf16 v[44:47], a[96:99], a[8:11], v[44:47]
  ds_read_b64_tr_b16 a[112:113], v200 offset:2048
  v_mfma_f32_16x16x32_bf16 v[44:47], a[92:95], a[68:71], v[44:47]
  ds_read_b64_tr_b16 a[114:115], v200 offset:8192
  v_mfma_f32_16x16x32_bf16 v[40:43], a[92:95], a[64:67], v[40:43]
  buffer_load_dwordx4 v204, s[8:11], s61 offen offset:2048 lds
  s_mov_b32 s62, 61440
  v_mfma_f32_16x16x32_bf16 v[40:43], a[96:99], a[4:7], v[40:43]
  s_add_u32 m0, s64, 76800
  ds_read_b64_tr_b16 a[80:81], v201 offset:0
  v_mfma_f32_16x16x32_bf16 v[40:43], a[100:103], a[24:27], v[40:43]
  v_mfma_f32_16x16x32_bf16 v[36:39], a[100:103], a[20:23], v[36:39]
  ds_read_b64_tr_b16 a[82:83], v201 offset:6144
  v_mfma_f32_16x16x32_bf16 v[36:39], a[96:99], a[0:3], v[36:39]
  buffer_load_dwordx4 v205, s[36:39], s62 offen offset:0 sc1 lds
  v_mfma_f32_16x16x32_bf16 v[36:39], a[92:95], a[60:63], v[36:39]
  s_waitcnt lgkmcnt(2)
  ds_read_b64_tr_b16 a[84:85], v201 offset:1024
  v_mfma_f32_16x16x32_bf16 v[52:55], a[0:3], a[104:107], v[52:55]
  v_mfma_f32_16x16x32_bf16 v[52:55], a[20:23], a[108:111], v[52:55]
  ds_read_b64_tr_b16 a[86:87], v201 offset:7168
  v_mfma_f32_16x16x32_bf16 v[52:55], a[40:43], a[112:115], v[52:55]
  buffer_load_dwordx4 v205, s[36:39], s62 offen offset:1024 sc1 lds
  s_add_u32 m0, s65, 84992
  v_mfma_f32_16x16x32_bf16 v[56:59], a[44:47], a[112:115], v[56:59]
  ds_read_b64_tr_b16 a[88:89], v201 offset:2048
  v_mfma_f32_16x16x32_bf16 v[56:59], a[24:27], a[108:111], v[56:59]
  v_mfma_f32_16x16x32_bf16 v[56:59], a[4:7], a[104:107], v[56:59]
  ds_read_b64_tr_b16 a[90:91], v201 offset:8192
  v_mfma_f32_16x16x32_bf16 v[60:63], a[8:11], a[104:107], v[60:63]
  buffer_load_dword v206, s[36:39], s62 offen sc1 lds
  s_mov_b32 s61, 5703680
  v_mfma_f32_16x16x32_bf16 v[60:63], a[28:31], a[108:111], v[60:63]
  s_add_u32 m0, s63, 86016
  ds_read_b128 a[60:63], v207 offset:12288
  v_mfma_f32_16x16x32_bf16 v[60:63], a[48:51], a[112:115], v[60:63]
  ds_read_b64_tr_b16 a[92:93], v196 offset:0
  v_mfma_f32_16x16x32_bf16 v[64:67], a[52:55], a[112:115], v[64:67]
  ds_read_b128 a[64:67], v207 offset:13312
  v_mfma_f32_16x16x32_bf16 v[64:67], a[32:35], a[108:111], v[64:67]
  buffer_load_dwordx4 v202, s[8:11], s61 offen offset:0 lds
  v_mfma_f32_16x16x32_bf16 v[64:67], a[12:15], a[104:107], v[64:67]
  ds_read_b64_tr_b16 a[94:95], v196 offset:6144
  v_mfma_f32_16x16x32_bf16 v[120:123], a[16:19], a[104:107], v[120:123]
  ds_read_b128 a[68:71], v207 offset:14336
  v_mfma_f32_16x16x32_bf16 v[120:123], a[36:39], a[108:111], v[120:123]
  ds_read_b64_tr_b16 a[96:97], v196 offset:1024
  v_mfma_f32_16x16x32_bf16 v[120:123], a[56:59], a[112:115], v[120:123]
  s_waitcnt lgkmcnt(6)
  buffer_load_dwordx4 v203, s[8:11], s61 offen offset:1024 lds
  v_mfma_f32_16x16x32_bf16 v[80:83], a[12:15], a[80:83], v[80:83]
  ds_read_b128 a[72:75], v207 offset:15360
  v_mfma_f32_16x16x32_bf16 v[80:83], a[32:35], a[84:87], v[80:83]
  ds_read_b64_tr_b16 a[98:99], v196 offset:7168
  v_mfma_f32_16x16x32_bf16 v[80:83], a[52:55], a[88:91], v[80:83]
  ds_read_b128 a[76:79], v210 offset:20480
  v_mfma_f32_16x16x32_bf16 v[76:79], a[48:51], a[88:91], v[76:79]
  buffer_load_dwordx4 v204, s[8:11], s61 offen offset:2048 lds
  s_mov_b32 s62, 63488
  v_mfma_f32_16x16x32_bf16 v[76:79], a[28:31], a[84:87], v[76:79]
  s_add_u32 m0, s64, 98304
  ds_read_b64_tr_b16 a[100:101], v196 offset:2048
  v_mfma_f32_16x16x32_bf16 v[76:79], a[8:11], a[80:83], v[76:79]
  ds_read_b64_tr_b16 a[102:103], v196 offset:8192
  v_mfma_f32_16x16x32_bf16 v[72:75], a[4:7], a[80:83], v[72:75]
  ds_read_b64_tr_b16 a[104:105], v197 offset:0
  v_mfma_f32_16x16x32_bf16 v[72:75], a[24:27], a[84:87], v[72:75]
  buffer_load_dwordx4 v205, s[36:39], s62 offen offset:0 sc1 lds
  v_mfma_f32_16x16x32_bf16 v[72:75], a[44:47], a[88:91], v[72:75]
  ds_read_b64_tr_b16 a[106:107], v197 offset:6144
  v_mfma_f32_16x16x32_bf16 v[68:71], a[40:43], a[88:91], v[68:71]
  ds_read_b64_tr_b16 a[108:109], v197 offset:1024
  v_mfma_f32_16x16x32_bf16 v[68:71], a[20:23], a[84:87], v[68:71]
  ds_read_b64_tr_b16 a[110:111], v197 offset:7168
  v_mfma_f32_16x16x32_bf16 v[68:71], a[0:3], a[80:83], v[68:71]
  s_waitcnt vmcnt(12) lgkmcnt(4)
  s_barrier
  buffer_load_dwordx4 v205, s[36:39], s62 offen offset:1024 sc1 lds
  v_mfma_f32_16x16x32_bf16 v[84:87], a[92:95], a[20:23], v[84:87]
  s_add_u32 m0, s65, 106496
  ds_read_b64_tr_b16 a[112:113], v197 offset:2048
  v_mfma_f32_16x16x32_bf16 v[84:87], a[96:99], a[40:43], v[84:87]
  v_mfma_f32_16x16x32_bf16 v[84:87], a[100:103], a[60:63], v[84:87]
  ds_read_b64_tr_b16 a[114:115], v197 offset:8192
  v_mfma_f32_16x16x32_bf16 v[88:91], a[100:103], a[64:67], v[88:91]
  buffer_load_dword v206, s[36:39], s62 offen sc1 lds
  s_mov_b32 s61, 5902336
  v_mfma_f32_16x16x32_bf16 v[88:91], a[96:99], a[44:47], v[88:91]
  s_add_u32 m0, s63, 107520
  ds_read_b128 a[0:3], v207 offset:33792
  v_mfma_f32_16x16x32_bf16 v[88:91], a[92:95], a[24:27], v[88:91]
  ds_read_b64_tr_b16 a[80:81], v196 offset:21504
  v_mfma_f32_16x16x32_bf16 v[92:95], a[92:95], a[28:31], v[92:95]
  ds_read_b128 a[4:7], v207 offset:34816
  v_mfma_f32_16x16x32_bf16 v[92:95], a[96:99], a[48:51], v[92:95]
  buffer_load_dwordx4 v202, s[8:11], s61 offen offset:0 lds
  v_mfma_f32_16x16x32_bf16 v[92:95], a[100:103], a[68:71], v[92:95]
  ds_read_b64_tr_b16 a[82:83], v196 offset:27648
  v_mfma_f32_16x16x32_bf16 v[96:99], a[100:103], a[72:75], v[96:99]
  ds_read_b128 a[8:11], v207 offset:35840
  v_mfma_f32_16x16x32_bf16 v[96:99], a[96:99], a[52:55], v[96:99]
  ds_read_b64_tr_b16 a[84:85], v196 offset:22528
  v_mfma_f32_16x16x32_bf16 v[96:99], a[92:95], a[32:35], v[96:99]
  s_waitcnt lgkmcnt(6)
  buffer_load_dwordx4 v203, s[8:11], s61 offen offset:1024 lds
  s_mov_b32 s61, 6094848
  v_mfma_f32_16x16x32_bf16 v[112:115], a[104:107], a[32:35], v[112:115]
  s_add_u32 m0, s63, 129024
  ds_read_b128 a[12:15], v207 offset:36864
  v_mfma_f32_16x16x32_bf16 v[112:115], a[108:111], a[52:55], v[112:115]
  ds_read_b128 a[16:19], v210 offset:41984
  v_mfma_f32_16x16x32_bf16 v[112:115], a[112:115], a[72:75], v[112:115]
  ds_read_b64_tr_b16 a[86:87], v196 offset:28672
  v_mfma_f32_16x16x32_bf16 v[108:111], a[112:115], a[68:71], v[108:111]
  buffer_load_dwordx4 v202, s[8:11], s61 offen offset:0 lds
  s_nop 0
  v_mfma_f32_16x16x32_bf16 v[108:111], a[108:111], a[48:51], v[108:111]
  s_bfe_u32 s66, s2, 0x30004
  s_and_b32 s67, s2, 3
  s_lshl3_add_u32 s66, s67, s66
  v_mfma_f32_16x16x32_bf16 v[108:111], a[104:107], a[28:31], v[108:111]
  s_lshl2_add_u32 s66, s66, s44
  s_mul_i32 s66, s66, 98304
  s_and_b32 s67, s51, 0x3800
  v_mfma_f32_16x16x32_bf16 v[104:107], a[104:107], a[24:27], v[104:107]
  s_add_u32 s66, s66, s67
  s_and_b32 s67, s2, 8
  s_lshl_b32 s67, s67, 7
  v_mfma_f32_16x16x32_bf16 v[104:107], a[108:111], a[44:47], v[104:107]
  s_add_u32 s66, s66, s67
  ds_read_b64_tr_b16 a[88:89], v196 offset:23552
  v_and_b32 v215, 7, v10
  v_mfma_f32_16x16x32_bf16 v[104:107], a[112:115], a[64:67], v[104:107]
  ds_read_b64_tr_b16 a[90:91], v196 offset:29696
  v_mul_u32_u24 v215, 12288, v215
  v_mfma_f32_16x16x32_bf16 v[100:103], a[112:115], a[60:63], v[100:103]
  buffer_load_dword a252, v215, s[28:31], s66 offen offset:384
  v_mfma_f32_16x16x32_bf16 v[100:103], a[108:111], a[40:43], v[100:103]
  ds_read_b64_tr_b16 a[92:93], v197 offset:21504
  v_mfma_f32_16x16x32_bf16 v[100:103], a[104:107], a[20:23], v[100:103]
  s_waitcnt lgkmcnt(1)
  ds_read_b64_tr_b16 a[94:95], v197 offset:27648
  v_mfma_f32_16x16x32_bf16 v[20:23], a[80:83], a[40:43], v[20:23]
  ds_read_b64_tr_b16 a[96:97], v197 offset:22528
  v_mfma_f32_16x16x32_bf16 v[20:23], a[84:87], a[60:63], v[20:23]
  buffer_load_dwordx4 v[136:139], v176, s[28:31], s51 offen nt
  s_add_u32 s51, s51, 12288
  v_mfma_f32_16x16x32_bf16 v[20:23], a[88:91], a[0:3], v[20:23]
  ds_read_b64_tr_b16 a[98:99], v197 offset:28672
  v_mfma_f32_16x16x32_bf16 v[24:27], a[88:91], a[4:7], v[24:27]
  ds_read_b64_tr_b16 a[100:101], v197 offset:23552
  v_mfma_f32_16x16x32_bf16 v[24:27], a[84:87], a[64:67], v[24:27]
  v_mfma_f32_16x16x32_bf16 v[24:27], a[80:83], a[44:47], v[24:27]
  buffer_load_dwordx4 v[140:143], v176, s[28:31], s51 offen nt
  s_add_u32 s51, s51, 12288
  v_mfma_f32_16x16x32_bf16 v[28:31], a[80:83], a[48:51], v[28:31]
  ds_read_b64_tr_b16 a[102:103], v197 offset:29696
  v_mfma_f32_16x16x32_bf16 v[28:31], a[84:87], a[68:71], v[28:31]
  ds_read_b128 a[20:23], v207 offset:55296
  v_mfma_f32_16x16x32_bf16 v[28:31], a[88:91], a[8:11], v[28:31]
  ds_read_b64_tr_b16 a[104:105], v196 offset:43008
  v_mfma_f32_16x16x32_bf16 v[32:35], a[88:91], a[12:15], v[32:35]
  buffer_load_dwordx4 v[144:147], v176, s[28:31], s51 offen nt
  s_add_u32 s51, s51, 12288
  v_mfma_f32_16x16x32_bf16 v[32:35], a[84:87], a[72:75], v[32:35]
  ds_read_b128 a[24:27], v207 offset:56320
  v_mfma_f32_16x16x32_bf16 v[32:35], a[80:83], a[52:55], v[32:35]
  ds_read_b64_tr_b16 a[106:107], v196 offset:49152
  v_mfma_f32_16x16x32_bf16 v[116:119], a[80:83], a[56:59], v[116:119]
  ds_read_b128 a[28:31], v207 offset:57344
  v_mfma_f32_16x16x32_bf16 v[116:119], a[84:87], a[76:79], v[116:119]
  buffer_load_dwordx4 v[148:151], v176, s[28:31], s51 offen nt
  s_add_u32 s51, s51, 12288
  v_mfma_f32_16x16x32_bf16 v[116:119], a[88:91], a[16:19], v[116:119]
  s_waitcnt lgkmcnt(5)
  ds_read_b64_tr_b16 a[108:109], v196 offset:44032
  v_mfma_f32_16x16x32_bf16 v[48:51], a[92:95], a[52:55], v[48:51]
  ds_read_b128 a[32:35], v207 offset:58368
  v_mfma_f32_16x16x32_bf16 v[48:51], a[96:99], a[72:75], v[48:51]
  ds_read_b128 a[36:39], v210 offset:63488
  v_mfma_f32_16x16x32_bf16 v[48:51], a[100:103], a[12:15], v[48:51]
  buffer_load_dwordx4 v[152:155], v176, s[28:31], s51 offen nt
  s_add_u32 s51, s51, 12288
  v_mfma_f32_16x16x32_bf16 v[44:47], a[100:103], a[8:11], v[44:47]
  ds_read_b64_tr_b16 a[110:111], v196 offset:50176
  v_mfma_f32_16x16x32_bf16 v[44:47], a[96:99], a[68:71], v[44:47]
  ds_read_b64_tr_b16 a[112:113], v196 offset:45056
  v_mfma_f32_16x16x32_bf16 v[44:47], a[92:95], a[48:51], v[44:47]
  ds_read_b64_tr_b16 a[114:115], v196 offset:51200
  v_mfma_f32_16x16x32_bf16 v[40:43], a[92:95], a[44:47], v[40:43]
  buffer_load_dwordx4 v[156:159], v176, s[28:31], s51 offen nt
  s_add_u32 s51, s51, 12288
  v_mfma_f32_16x16x32_bf16 v[40:43], a[96:99], a[64:67], v[40:43]
  ds_read_b64_tr_b16 a[80:81], v197 offset:43008
  v_mfma_f32_16x16x32_bf16 v[40:43], a[100:103], a[4:7], v[40:43]
  v_mfma_f32_16x16x32_bf16 v[36:39], a[100:103], a[0:3], v[36:39]
  ds_read_b64_tr_b16 a[82:83], v197 offset:49152
  v_mfma_f32_16x16x32_bf16 v[36:39], a[96:99], a[60:63], v[36:39]
  buffer_load_dwordx4 v[160:163], v176, s[28:31], s51 offen nt
  s_add_u32 s51, s51, 12288
  v_mfma_f32_16x16x32_bf16 v[36:39], a[92:95], a[40:43], v[36:39]
  s_waitcnt lgkmcnt(2)
  ds_read_b64_tr_b16 a[84:85], v197 offset:44032
  v_mfma_f32_16x16x32_bf16 v[52:55], a[60:63], a[104:107], v[52:55]
  v_mfma_f32_16x16x32_bf16 v[52:55], a[0:3], a[108:111], v[52:55]
  ds_read_b64_tr_b16 a[86:87], v197 offset:50176
  v_mfma_f32_16x16x32_bf16 v[52:55], a[20:23], a[112:115], v[52:55]
  s_waitcnt vmcnt(11)
  s_barrier
  buffer_load_dwordx4 v[164:167], v176, s[28:31], s51 offen nt
  v_mfma_f32_16x16x32_bf16 v[56:59], a[24:27], a[112:115], v[56:59]
  ds_read_b64_tr_b16 a[88:89], v197 offset:45056
  v_lshrrev_b32 v215, 2, v10
  v_mfma_f32_16x16x32_bf16 v[56:59], a[4:7], a[108:111], v[56:59]
  v_min_u32 v215, (XEND-G3S)/4096, v215
  v_and_b32 v213, 3, v10
  v_mfma_f32_16x16x32_bf16 v[56:59], a[64:67], a[104:107], v[56:59]
  ds_read_b64_tr_b16 a[90:91], v197 offset:51200
  v_lshlrev_b32 v213, 7, v213
  v_mfma_f32_16x16x32_bf16 v[60:63], a[68:71], a[104:107], v[60:63]
  ds_read_b128 a[40:43], v208 offset:12288
  v_lshl_add_u32 v215, v215, 12, v213
  v_mfma_f32_16x16x32_bf16 v[60:63], a[8:11], a[108:111], v[60:63]
  s_add_u32 s94, s92, AL-adaLN_cond__sliding_local_dilated__swiglu_ffn__prompt_kernel+((G3S-AL+4095)/4096)*4096
  s_addc_u32 s95, s93, 0
  global_load_dword a252, v215, s[94:95]
  v_mfma_f32_16x16x32_bf16 v[60:63], a[28:31], a[112:115], v[60:63]
  s_and_b32 s66, s44, 1
  s_lshl1_add_u32 s66, s2, s66
  s_mul_i32 s66, s66, 2688
  v_mfma_f32_16x16x32_bf16 v[64:67], a[32:35], a[112:115], v[64:67]
  ds_read_b64_tr_b16 a[92:93], v198 offset:0
  v_min_u32 v215, 20, v10
  v_mfma_f32_16x16x32_bf16 v[64:67], a[12:15], a[108:111], v[64:67]
  ds_read_b128 a[44:47], v208 offset:13312
  v_lshlrev_b32 v215, 7, v215
  v_mfma_f32_16x16x32_bf16 v[64:67], a[72:75], a[104:107], v[64:67]
  buffer_load_dword a252, v215, s[16:19], s66 offen
  v_mfma_f32_16x16x32_bf16 v[120:123], a[76:79], a[104:107], v[120:123]
  ds_read_b64_tr_b16 a[94:95], v198 offset:6144
  v_mfma_f32_16x16x32_bf16 v[120:123], a[16:19], a[108:111], v[120:123]
  ds_read_b128 a[48:51], v208 offset:14336
  v_mfma_f32_16x16x32_bf16 v[120:123], a[36:39], a[112:115], v[120:123]
  s_waitcnt lgkmcnt(5)
  ds_read_b64_tr_b16 a[96:97], v198 offset:1024
  v_mfma_f32_16x16x32_bf16 v[80:83], a[72:75], a[80:83], v[80:83]
  ds_read_b128 a[52:55], v208 offset:15360
  v_mfma_f32_16x16x32_bf16 v[80:83], a[12:15], a[84:87], v[80:83]
  ds_read_b64_tr_b16 a[98:99], v198 offset:7168
  v_mfma_f32_16x16x32_bf16 v[80:83], a[32:35], a[88:91], v[80:83]
  ds_read_b128 a[56:59], v211 offset:20480
  v_mfma_f32_16x16x32_bf16 v[76:79], a[28:31], a[88:91], v[76:79]
  ds_read_b64_tr_b16 a[100:101], v198 offset:2048
  v_mfma_f32_16x16x32_bf16 v[76:79], a[8:11], a[84:87], v[76:79]
  ds_read_b64_tr_b16 a[102:103], v198 offset:8192
  v_mfma_f32_16x16x32_bf16 v[76:79], a[68:71], a[80:83], v[76:79]
  ds_read_b64_tr_b16 a[104:105], v199 offset:0
  v_mfma_f32_16x16x32_bf16 v[72:75], a[64:67], a[80:83], v[72:75]
  ds_read_b64_tr_b16 a[106:107], v199 offset:6144
  v_mfma_f32_16x16x32_bf16 v[72:75], a[4:7], a[84:87], v[72:75]
  v_mfma_f32_16x16x32_bf16 v[72:75], a[24:27], a[88:91], v[72:75]
  ds_read_b64_tr_b16 a[108:109], v199 offset:1024
  v_mfma_f32_16x16x32_bf16 v[68:71], a[20:23], a[88:91], v[68:71]
  v_mfma_f32_16x16x32_bf16 v[68:71], a[0:3], a[84:87], v[68:71]
  ds_read_b64_tr_b16 a[110:111], v199 offset:7168
  v_mfma_f32_16x16x32_bf16 v[68:71], a[60:63], a[80:83], v[68:71]
  s_waitcnt lgkmcnt(4)
  v_mfma_f32_16x16x32_bf16 v[84:87], a[92:95], a[0:3], v[84:87]
  ds_read_b64_tr_b16 a[112:113], v199 offset:2048
  v_mfma_f32_16x16x32_bf16 v[84:87], a[96:99], a[20:23], v[84:87]
  v_mfma_f32_16x16x32_bf16 v[84:87], a[100:103], a[40:43], v[84:87]
  ds_read_b64_tr_b16 a[114:115], v199 offset:8192
  v_mfma_f32_16x16x32_bf16 v[88:91], a[100:103], a[44:47], v[88:91]
  ds_read_b128 a[60:63], v208 offset:33792
  v_mfma_f32_16x16x32_bf16 v[88:91], a[96:99], a[24:27], v[88:91]
  ds_read_b64_tr_b16 a[80:81], v198 offset:21504
  v_mfma_f32_16x16x32_bf16 v[88:91], a[92:95], a[4:7], v[88:91]
  ds_read_b128 a[64:67], v208 offset:34816
  v_mfma_f32_16x16x32_bf16 v[92:95], a[92:95], a[8:11], v[92:95]
  ds_read_b64_tr_b16 a[82:83], v198 offset:27648
  v_mfma_f32_16x16x32_bf16 v[92:95], a[96:99], a[28:31], v[92:95]
  ds_read_b128 a[68:71], v208 offset:35840
  v_mfma_f32_16x16x32_bf16 v[92:95], a[100:103], a[48:51], v[92:95]
  ds_read_b64_tr_b16 a[84:85], v198 offset:22528
  v_mfma_f32_16x16x32_bf16 v[96:99], a[100:103], a[52:55], v[96:99]
  ds_read_b128 a[72:75], v208 offset:36864
  v_mfma_f32_16x16x32_bf16 v[96:99], a[96:99], a[32:35], v[96:99]
  ds_read_b128 a[76:79], v211 offset:41984
  v_mfma_f32_16x16x32_bf16 v[96:99], a[92:95], a[12:15], v[96:99]
  s_waitcnt lgkmcnt(8)
  ds_read_b64_tr_b16 a[86:87], v198 offset:28672
  v_mfma_f32_16x16x32_bf16 v[112:115], a[104:107], a[12:15], v[112:115]
  v_mfma_f32_16x16x32_bf16 v[112:115], a[108:111], a[32:35], v[112:115]
  ds_read_b64_tr_b16 a[88:89], v198 offset:23552
  v_mfma_f32_16x16x32_bf16 v[112:115], a[112:115], a[52:55], v[112:115]
  v_mfma_f32_16x16x32_bf16 v[108:111], a[112:115], a[48:51], v[108:111]
  ds_read_b64_tr_b16 a[90:91], v198 offset:29696
  v_mfma_f32_16x16x32_bf16 v[108:111], a[108:111], a[28:31], v[108:111]
  v_mfma_f32_16x16x32_bf16 v[108:111], a[104:107], a[8:11], v[108:111]
  v_mfma_f32_16x16x32_bf16 v[104:107], a[104:107], a[4:7], v[104:107]
  v_mfma_f32_16x16x32_bf16 v[104:107], a[108:111], a[24:27], v[104:107]
  ds_read_b64_tr_b16 a[92:93], v199 offset:21504
  v_mfma_f32_16x16x32_bf16 v[104:107], a[112:115], a[44:47], v[104:107]
  v_mfma_f32_16x16x32_bf16 v[100:103], a[112:115], a[40:43], v[100:103]
  ds_read_b64_tr_b16 a[94:95], v199 offset:27648
  v_mfma_f32_16x16x32_bf16 v[100:103], a[108:111], a[20:23], v[100:103]
  v_mfma_f32_16x16x32_bf16 v[100:103], a[104:107], a[0:3], v[100:103]
  s_waitcnt lgkmcnt(2)
  ds_read_b64_tr_b16 a[96:97], v199 offset:22528
  v_mfma_f32_16x16x32_bf16 v[20:23], a[80:83], a[20:23], v[20:23]
  v_mfma_f32_16x16x32_bf16 v[20:23], a[84:87], a[40:43], v[20:23]
  ds_read_b64_tr_b16 a[98:99], v199 offset:28672
  v_mfma_f32_16x16x32_bf16 v[20:23], a[88:91], a[60:63], v[20:23]
  s_waitcnt vmcnt(11)
  s_barrier
  v_mfma_f32_16x16x32_bf16 v[24:27], a[88:91], a[64:67], v[24:27]
  ds_read_b64_tr_b16 a[100:101], v199 offset:23552
  v_mfma_f32_16x16x32_bf16 v[24:27], a[84:87], a[44:47], v[24:27]
  v_mfma_f32_16x16x32_bf16 v[24:27], a[80:83], a[24:27], v[24:27]
  ds_read_b64_tr_b16 a[102:103], v199 offset:29696
  v_mfma_f32_16x16x32_bf16 v[28:31], a[80:83], a[28:31], v[28:31]
  v_mfma_f32_16x16x32_bf16 v[28:31], a[84:87], a[48:51], v[28:31]
  ds_read_b64_tr_b16 a[104:105], v198 offset:43008
  v_mfma_f32_16x16x32_bf16 v[28:31], a[88:91], a[68:71], v[28:31]
  v_mfma_f32_16x16x32_bf16 v[32:35], a[88:91], a[72:75], v[32:35]
  ds_read_b64_tr_b16 a[106:107], v198 offset:49152
  v_mfma_f32_16x16x32_bf16 v[32:35], a[84:87], a[52:55], v[32:35]
  v_mfma_f32_16x16x32_bf16 v[32:35], a[80:83], a[32:35], v[32:35]
  v_mfma_f32_16x16x32_bf16 v[116:119], a[80:83], a[36:39], v[116:119]
  ds_read_b64_tr_b16 a[108:109], v198 offset:44032
  v_mfma_f32_16x16x32_bf16 v[116:119], a[84:87], a[56:59], v[116:119]
  v_mfma_f32_16x16x32_bf16 v[116:119], a[88:91], a[76:79], v[116:119]
  s_waitcnt lgkmcnt(3)
  ds_read_b64_tr_b16 a[110:111], v198 offset:50176
  v_mfma_f32_16x16x32_bf16 v[48:51], a[92:95], a[32:35], v[48:51]
  v_mfma_f32_16x16x32_bf16 v[48:51], a[96:99], a[52:55], v[48:51]
  v_mfma_f32_16x16x32_bf16 v[48:51], a[100:103], a[72:75], v[48:51]
  ds_read_b64_tr_b16 a[112:113], v199 offset:43008
  v_mfma_f32_16x16x32_bf16 v[44:47], a[100:103], a[68:71], v[44:47]
  v_mfma_f32_16x16x32_bf16 v[44:47], a[96:99], a[48:51], v[44:47]
  ds_read_b64_tr_b16 a[114:115], v199 offset:49152
  v_mfma_f32_16x16x32_bf16 v[44:47], a[92:95], a[28:31], v[44:47]
  v_mfma_f32_16x16x32_bf16 v[40:43], a[92:95], a[24:27], v[40:43]
  ds_read_b64_tr_b16 a[80:81], v199 offset:44032
  v_mfma_f32_16x16x32_bf16 v[40:43], a[96:99], a[44:47], v[40:43]
  v_cvt_pk_bf16_f32 v116, v116, v117
  v_cvt_pk_bf16_f32 v117, v118, v119
  v_mfma_f32_16x16x32_bf16 v[40:43], a[100:103], a[64:67], v[40:43]
  ds_read_b64_tr_b16 a[82:83], v199 offset:50176
  v_mfma_f32_16x16x32_bf16 v[36:39], a[100:103], a[60:63], v[36:39]
  ds_write_b64 v224, v[116:117]
  v_cvt_pk_bf16_f32 v32, v32, v33
  v_mfma_f32_16x16x32_bf16 v[36:39], a[96:99], a[40:43], v[36:39]
  ds_read_b64_tr_b16 a[84:85], v200 offset:0
  v_cvt_pk_bf16_f32 v33, v34, v35
  v_mfma_f32_16x16x32_bf16 v[36:39], a[92:95], a[20:23], v[36:39]
  s_waitcnt lgkmcnt(6)
  v_cvt_pk_bf16_f32 v34, v48, v49
  v_cvt_pk_bf16_f32 v35, v50, v51
  v_mfma_f32_16x16x32_bf16 v[52:55], a[40:43], a[104:107], v[52:55]
  ds_read_b64_tr_b16 a[86:87], v200 offset:6144
  v_mfma_f32_16x16x32_bf16 v[52:55], a[60:63], a[108:111], v[52:55]
  ds_write_b64 v222, v[32:33]
  v_mfma_f32_16x16x32_bf16 v[56:59], a[64:67], a[108:111], v[56:59]
  ds_read_b64_tr_b16 a[88:89], v201 offset:0
  v_mfma_f32_16x16x32_bf16 v[56:59], a[44:47], a[104:107], v[56:59]
  ds_write_b64 v223, v[34:35]
  v_cvt_pk_bf16_f32 v28, v28, v29
  v_mfma_f32_16x16x32_bf16 v[60:63], a[48:51], a[104:107], v[60:63]
  ds_read_b64_tr_b16 a[90:91], v201 offset:6144
  v_cvt_pk_bf16_f32 v29, v30, v31
  v_mfma_f32_16x16x32_bf16 v[60:63], a[68:71], a[108:111], v[60:63]
  v_cvt_pk_bf16_f32 v30, v44, v45
  v_cvt_pk_bf16_f32 v31, v46, v47
  v_mfma_f32_16x16x32_bf16 v[64:67], a[72:75], a[108:111], v[64:67]
  v_cvt_pk_bf16_f32 v24, v24, v25
  v_cvt_pk_bf16_f32 v25, v26, v27
  v_mfma_f32_16x16x32_bf16 v[64:67], a[52:55], a[104:107], v[64:67]
  v_cvt_pk_bf16_f32 v26, v40, v41
  v_cvt_pk_bf16_f32 v27, v42, v43
  v_mfma_f32_16x16x32_bf16 v[120:123], a[56:59], a[104:107], v[120:123]
  v_cvt_pk_bf16_f32 v20, v20, v21
  v_cvt_pk_bf16_f32 v21, v22, v23
  v_mfma_f32_16x16x32_bf16 v[120:123], a[76:79], a[108:111], v[120:123]
  s_waitcnt lgkmcnt(7)
  v_cvt_pk_bf16_f32 v22, v36, v37
  v_cvt_pk_bf16_f32 v23, v38, v39
  v_mfma_f32_16x16x32_bf16 v[80:83], a[52:55], a[112:115], v[80:83]
  v_cvt_pk_bf16_f32 v55, v54, v55
  v_cvt_pk_bf16_f32 v54, v52, v53
  v_mfma_f32_16x16x32_bf16 v[80:83], a[72:75], a[80:83], v[80:83]
  v_cvt_pk_bf16_f32 v56, v56, v57
  v_cvt_pk_bf16_f32 v57, v58, v59
  v_mfma_f32_16x16x32_bf16 v[76:79], a[68:71], a[80:83], v[76:79]
  v_cvt_pk_bf16_f32 v58, v60, v61
  v_cvt_pk_bf16_f32 v59, v62, v63
  v_mfma_f32_16x16x32_bf16 v[76:79], a[48:51], a[112:115], v[76:79]
  v_mfma_f32_16x16x32_bf16 v[72:75], a[44:47], a[112:115], v[72:75]
  v_cvt_pk_bf16_f32 v60, v64, v65
  v_cvt_pk_bf16_f32 v61, v66, v67
  v_mfma_f32_16x16x32_bf16 v[72:75], a[64:67], a[80:83], v[72:75]
  v_mfma_f32_16x16x32_bf16 v[68:71], a[60:63], a[80:83], v[68:71]
  v_cvt_pk_bf16_f32 v120, v120, v121
  v_cvt_pk_bf16_f32 v121, v122, v123
  v_mfma_f32_16x16x32_bf16 v[68:71], a[40:43], a[112:115], v[68:71]
  s_waitcnt lgkmcnt(4)
  ds_write_b64 v222, v[60:61] offset:1024
  v_mfma_f32_16x16x32_bf16 v[84:87], a[84:87], a[60:63], v[84:87]
  ds_write_b64 v224, v[120:121] offset:1024
  v_mfma_f32_16x16x32_bf16 v[88:91], a[84:87], a[64:67], v[88:91]
  v_mfma_f32_16x16x32_bf16 v[92:95], a[84:87], a[68:71], v[92:95]
  v_mfma_f32_16x16x32_bf16 v[96:99], a[84:87], a[72:75], v[96:99]
  s_waitcnt lgkmcnt(2)
  v_mfma_f32_16x16x32_bf16 v[112:115], a[88:91], a[72:75], v[112:115]
  v_mfma_f32_16x16x32_bf16 v[108:111], a[88:91], a[68:71], v[108:111]
  v_mfma_f32_16x16x32_bf16 v[104:107], a[88:91], a[64:67], v[104:107]
  v_cvt_pk_bf16_f32 v71, v70, v71
  v_cvt_pk_bf16_f32 v70, v68, v69
  v_mfma_f32_16x16x32_bf16 v[100:103], a[88:91], a[60:63], v[100:103]
  v_cvt_pk_bf16_f32 v72, v72, v73
  v_cvt_pk_bf16_f32 v73, v74, v75
  v_cvt_pk_bf16_f32 v74, v76, v77
  v_cvt_pk_bf16_f32 v75, v78, v79
  v_cvt_pk_bf16_f32 v76, v80, v81
  v_cvt_pk_bf16_f32 v77, v82, v83
  ds_write_b64 v223, v[76:77] offset:1024
  s_waitcnt lgkmcnt(0)
  s_barrier
  ds_read_b64 v[124:125], v225
  ds_read_b64 v[126:127], v226
  ds_read_b64 v[52:53], v227 offset:1024
  ds_read_b64 v[68:69], v227 offset:1032
  v_cvt_pk_bf16_f32 v96, v96, v97
  v_cvt_pk_bf16_f32 v97, v98, v99
  v_cvt_pk_bf16_f32 v98, v112, v113
  v_cvt_pk_bf16_f32 v99, v114, v115
  v_cvt_pk_bf16_f32 v92, v92, v93
  v_cvt_pk_bf16_f32 v93, v94, v95
  v_cvt_pk_bf16_f32 v94, v108, v109
  v_cvt_pk_bf16_f32 v95, v110, v111
  v_mfma_f32_16x16x32_bf16 v[112:115], v[32:35], v[96:99], 0
  v_mfma_f32_16x16x32_bf16 v[48:51], v[28:31], v[96:99], 0
  v_cvt_pk_bf16_f32 v88, v88, v89
  s_mov_b32 s50, 0
  s_add_u32 m0, s70, 0
  s_nop 0
  buffer_load_dwordx4 v216, s[12:15], s50 offen offset:0 lds
  v_cvt_pk_bf16_f32 v89, v90, v91
  v_cvt_pk_bf16_f32 v90, v104, v105
  v_cvt_pk_bf16_f32 v91, v106, v107
  v_mfma_f32_16x16x32_bf16 v[108:111], v[28:31], v[92:95], 0
  v_mfma_f32_16x16x32_bf16 v[44:47], v[24:27], v[92:95], 0
  v_cvt_pk_bf16_f32 v84, v84, v85
  v_cvt_pk_bf16_f32 v85, v86, v87
  v_cvt_pk_bf16_f32 v86, v100, v101
  v_cvt_pk_bf16_f32 v87, v102, v103
  buffer_load_dwordx4 v217, s[12:15], s50 offen offset:1024 lds
  v_mfma_f32_16x16x32_bf16 v[104:107], v[24:27], v[88:91], 0
Ha1_1:
  s_cbranch_execz Ra
  v_mfma_f32_16x16x32_bf16 v[40:43], v[20:23], v[88:91], 0
  s_cmp_eq_u32 s57, 0
  s_cselect_b64 s[66:67], s[78:79], 0
  s_cselect_b64 s[68:69], s[80:81], 0
  s_waitcnt lgkmcnt(2)
  v_mfma_f32_16x16x32_bf16 v[100:103], v[20:23], v[84:87], 0
  v_mfma_f32_16x16x32_bf16 v[36:39], v[124:127], v[84:87], 0
  s_cmp_eq_u32 s59, 0
  s_cbranch_scc1 F_sw
  v_swap_b32 v54, v70
  v_swap_b32 v55, v71
  v_swap_b32 v56, v72
  v_swap_b32 v57, v73
  v_swap_b32 v58, v74
  v_swap_b32 v59, v75
  v_swap_b32 v60, v76
  v_swap_b32 v61, v77
F_sw:
  v_mov_b32 v12, 0xcfa8965f
  buffer_load_dwordx4 v218, s[12:15], s50 offen offset:2048 lds
  v_mov_b32 v14, 0x3e8293ee
  v_cndmask_b32 v194, v112, v113, s[76:77]
  v_cndmask_b32 v195, v114, v115, s[76:77]
  v_cndmask_b32 v192, v48, v49, s[76:77]
  v_cndmask_b32 v193, v50, v51, s[76:77]
  v_cndmask_b32 v190, v108, v109, s[76:77]
  v_cndmask_b32 v191, v110, v111, s[76:77]
  v_cndmask_b32 v188, v44, v45, s[76:77]
  v_cndmask_b32 v189, v46, v47, s[76:77]
  buffer_load_dwordx4 v219, s[12:15], s50 offen offset:3072 lds
  v_cndmask_b32 v186, v104, v105, s[76:77]
  v_cndmask_b32 v187, v106, v107, s[76:77]
  v_cndmask_b32 v184, v40, v41, s[76:77]
  v_cndmask_b32 v185, v42, v43, s[76:77]
  v_cndmask_b32 v182, v100, v101, s[76:77]
  v_cndmask_b32 v183, v102, v103, s[76:77]
  v_cndmask_b32 v180, v36, v37, s[76:77]
  v_cndmask_b32 v181, v38, v39, s[76:77]
  v_cndmask_b32 v192, v194, v192, s[78:79]
  s_mov_b32 s50, 262144
  s_add_u32 m0, s70, 16384
  s_nop 0
  buffer_load_dwordx4 v216, s[12:15], s50 offen offset:0 lds
  v_cndmask_b32 v193, v195, v193, s[80:81]
  v_cndmask_b32 v188, v190, v188, s[78:79]
  v_cndmask_b32 v189, v191, v189, s[80:81]
  v_cndmask_b32 v184, v186, v184, s[78:79]
  v_cndmask_b32 v185, v187, v185, s[80:81]
  v_cndmask_b32 v180, v182, v180, s[78:79]
  v_cndmask_b32 v181, v183, v181, s[80:81]
  v_cndmask_b32 v180, v180, v12, s[66:67]
  v_cndmask_b32 v181, v181, v12, s[68:69]
  buffer_load_dwordx4 v217, s[12:15], s50 offen offset:1024 lds
  v_max_f32 v194, v192, v193
  v_max_f32 v195, v192, v193
  v_max_f32 v190, v188, v189
  v_max_f32 v191, v188, v189
  v_max_f32 v186, v184, v185
  v_max_f32 v187, v184, v185
  v_max_f32 v182, v180, v181
  v_max_f32 v183, v180, v181
  v_permlane16_swap_b32 v194, v195
  buffer_load_dwordx4 v218, s[12:15], s50 offen offset:2048 lds
  v_permlane16_swap_b32 v190, v191
  v_permlane16_swap_b32 v186, v187
  v_permlane16_swap_b32 v182, v183
  v_max_f32 v194, v194, v195
  v_max_f32 v190, v190, v191
  v_max_f32 v186, v186, v187
  v_max_f32 v182, v182, v183
  v_mov_b32 v195, v194
  v_mov_b32 v191, v190
  buffer_load_dwordx4 v219, s[12:15], s50 offen offset:3072 lds
  v_mov_b32 v187, v186
  v_mov_b32 v183, v182
  v_permlane32_swap_b32 v194, v195
  v_permlane32_swap_b32 v190, v191
  v_permlane32_swap_b32 v186, v187
  v_permlane32_swap_b32 v182, v183
  v_max_f32 v194, v194, v195
  v_max_f32 v190, v190, v191
  v_max_f32 v186, v186, v187
  s_mov_b32 s50, 524288
  s_add_u32 m0, s70, 32768
  s_nop 0
  buffer_load_dwordx4 v216, s[12:15], s50 offen offset:0 lds
  v_max_f32 v182, v182, v183
  v_mul_f32 v194, 0xbe8293ee, v194
  v_mul_f32 v190, 0xbe8293ee, v190
  v_mul_f32 v186, 0xbe8293ee, v186
  v_mul_f32 v182, 0xbe8293ee, v182
  v_pk_fma_f32 v[192:193], v[192:193], v[14:15], v[194:195] op_sel_hi:[1,0,0]
  v_pk_fma_f32 v[188:189], v[188:189], v[14:15], v[190:191] op_sel_hi:[1,0,0]
  v_pk_fma_f32 v[184:185], v[184:185], v[14:15], v[186:187] op_sel_hi:[1,0,0]
  v_pk_fma_f32 v[180:181], v[180:181], v[14:15], v[182:183] op_sel_hi:[1,0,0]
  buffer_load_dwordx4 v217, s[12:15], s50 offen offset:1024 lds
  v_exp_f32 v192, v192
  v_exp_f32 v193, v193
  v_exp_f32 v188, v188
  v_exp_f32 v189, v189
  v_exp_f32 v184, v184
  v_exp_f32 v185, v185
  v_exp_f32 v180, v180
  v_exp_f32 v181, v181
  v_add_f32 v194, v192, v193
  buffer_load_dwordx4 v218, s[12:15], s50 offen offset:2048 lds
  v_add_f32 v195, v192, v193
  v_add_f32 v190, v188, v189
  v_add_f32 v191, v188, v189
  v_add_f32 v186, v184, v185
  v_add_f32 v187, v184, v185
  v_add_f32 v182, v180, v181
  v_add_f32 v183, v180, v181
  v_permlane16_swap_b32 v194, v195
  v_permlane16_swap_b32 v190, v191
  buffer_load_dwordx4 v219, s[12:15], s50 offen offset:3072 lds
  v_permlane16_swap_b32 v186, v187
  v_permlane16_swap_b32 v182, v183
  v_add_f32 v194, v194, v195
  v_add_f32 v190, v190, v191
  v_add_f32 v186, v186, v187
  v_add_f32 v182, v182, v183
  v_mov_b32 v195, v194
  v_mov_b32 v191, v190
  v_mov_b32 v187, v186
  s_mov_b32 s50, 786432
  s_add_u32 m0, s70, 49152
  s_nop 0
  buffer_load_dwordx4 v216, s[12:15], s50 offen offset:0 lds
  v_mov_b32 v183, v182
  v_permlane32_swap_b32 v194, v195
  v_permlane32_swap_b32 v190, v191
  v_permlane32_swap_b32 v186, v187
  v_permlane32_swap_b32 v182, v183
  v_add_f32 v194, v194, v195
  v_add_f32 v190, v190, v191
  v_add_f32 v186, v186, v187
  v_add_f32 v182, v182, v183
  buffer_load_dwordx4 v217, s[12:15], s50 offen offset:1024 lds
  v_rcp_f32 v194, v194
  v_rcp_f32 v190, v190
  v_rcp_f32 v186, v186
  v_rcp_f32 v182, v182
  v_pk_mul_f32 v[192:193], v[192:193], v[194:195] op_sel_hi:[1,0]
  v_pk_mul_f32 v[188:189], v[188:189], v[190:191] op_sel_hi:[1,0]
  v_pk_mul_f32 v[184:185], v[184:185], v[186:187] op_sel_hi:[1,0]
  v_pk_mul_f32 v[180:181], v[180:181], v[182:183] op_sel_hi:[1,0]
  v_cvt_pk_bf16_f32 v192, v192, v193
  v_cvt_pk_bf16_f32 v188, v188, v189
  v_cvt_pk_bf16_f32 v184, v184, v185
  v_cvt_pk_bf16_f32 v180, v180, v181
  s_waitcnt lgkmcnt(0)
  v_perm_b32 v48, v192, v192, v228
  v_perm_b32 v49, v192, v192, v229
  v_perm_b32 v50, v192, v192, v230
  v_perm_b32 v51, v192, v192, v231
  v_perm_b32 v44, v188, v188, v228
  v_perm_b32 v45, v188, v188, v229
  v_perm_b32 v46, v188, v188, v230
  v_perm_b32 v47, v188, v188, v231
  v_mfma_f32_16x16x32_bf16 v[32:35], v[58:61], v[48:51], 0
  v_mfma_f32_16x16x32_bf16 v[96:99], v[74:77], v[48:51], 0
  v_perm_b32 v40, v184, v184, v228
  v_perm_b32 v41, v184, v184, v229
  v_perm_b32 v42, v184, v184, v230
  v_perm_b32 v43, v184, v184, v231
  v_mfma_f32_16x16x32_bf16 v[28:31], v[56:59], v[44:47], 0
  v_mfma_f32_16x16x32_bf16 v[92:95], v[72:75], v[44:47], 0
  v_perm_b32 v36, v180, v180, v228
  v_perm_b32 v37, v180, v180, v229
  v_perm_b32 v38, v180, v180, v230
  v_perm_b32 v39, v180, v180, v231
  v_mfma_f32_16x16x32_bf16 v[24:27], v[54:57], v[40:43], 0
  v_mfma_f32_16x16x32_bf16 v[88:91], v[70:73], v[40:43], 0
  s_nop 0
  v_mfma_f32_16x16x32_bf16 v[20:23], v[52:55], v[36:39], 0
  v_mfma_f32_16x16x32_bf16 v[84:87], v[68:71], v[36:39], 0
  v_cvt_pk_bf16_f32 v192, v32, v33
  v_cvt_pk_bf16_f32 v193, v34, v35
  v_cvt_pk_bf16_f32 v194, v96, v97
  v_cvt_pk_bf16_f32 v195, v98, v99
  buffer_store_dwordx4 v[192:195], v0, s[36:39], s72 offen offset:1024 sc1
  v_cvt_pk_bf16_f32 v188, v28, v29
  v_cvt_pk_bf16_f32 v189, v30, v31
  v_cvt_pk_bf16_f32 v190, v92, v93
  v_cvt_pk_bf16_f32 v191, v94, v95
  buffer_store_dwordx4 v[188:191], v0, s[36:39], s72 offen offset:0 sc1
  v_cvt_pk_bf16_f32 v184, v24, v25
  v_cvt_pk_bf16_f32 v185, v26, v27
  v_cvt_pk_bf16_f32 v186, v88, v89
  v_cvt_pk_bf16_f32 v187, v90, v91
  buffer_store_dwordx4 v[184:187], v0, s[36:39], s71 offen offset:1024 sc1
  v_cvt_pk_bf16_f32 v180, v20, v21
  v_cvt_pk_bf16_f32 v181, v22, v23
  v_cvt_pk_bf16_f32 v182, v84, v85
  v_cvt_pk_bf16_f32 v183, v86, v87
  buffer_store_dwordx4 v[180:183], v0, s[36:39], s71 offen offset:0 sc1
  s_waitcnt vmcnt(20)
  v_lshlrev_b32 v60, 16, v136
  v_and_b32 v61, 0xffff0000, v136
  v_lshlrev_b32 v62, 16, v137
  v_and_b32 v63, 0xffff0000, v137
  v_pk_mul_f32 v[52:53], v[60:61], v[168:169] op_sel_hi:[1,0]
  v_pk_mul_f32 v[54:55], v[62:63], v[168:169] op_sel_hi:[1,0]
  v_lshlrev_b32 v60, 16, v138
  v_and_b32 v61, 0xffff0000, v138
  v_lshlrev_b32 v62, 16, v139
  v_and_b32 v63, 0xffff0000, v139
  v_pk_mul_f32 v[56:57], v[60:61], v[168:169] op_sel_hi:[1,0]
  v_pk_mul_f32 v[58:59], v[62:63], v[168:169] op_sel_hi:[1,0]
  buffer_load_dwordx4 v218, s[12:15], s50 offen offset:2048 lds
  v_lshlrev_b32 v60, 16, v140
  v_and_b32 v61, 0xffff0000, v140
  v_lshlrev_b32 v62, 16, v141
  v_and_b32 v63, 0xffff0000, v141
  v_pk_fma_f32 v[52:53], v[60:61], v[168:169], v[52:53] op_sel:[0,1,0] op_sel_hi:[1,1,1]
  v_pk_fma_f32 v[54:55], v[62:63], v[168:169], v[54:55] op_sel:[0,1,0] op_sel_hi:[1,1,1]
  v_lshlrev_b32 v60, 16, v142
  v_and_b32 v61, 0xffff0000, v142
  v_lshlrev_b32 v62, 16, v143
  v_and_b32 v63, 0xffff0000, v143
  v_pk_fma_f32 v[56:57], v[60:61], v[168:169], v[56:57] op_sel:[0,1,0] op_sel_hi:[1,1,1]
  v_pk_fma_f32 v[58:59], v[62:63], v[168:169], v[58:59] op_sel:[0,1,0] op_sel_hi:[1,1,1]
  buffer_load_dwordx4 v219, s[12:15], s50 offen offset:3072 lds
  v_lshlrev_b32 v60, 16, v144
  v_and_b32 v61, 0xffff0000, v144
  v_lshlrev_b32 v62, 16, v145
  v_and_b32 v63, 0xffff0000, v145
  v_pk_fma_f32 v[52:53], v[60:61], v[170:171], v[52:53] op_sel:[0,0,0] op_sel_hi:[1,0,1]
  v_pk_fma_f32 v[54:55], v[62:63], v[170:171], v[54:55] op_sel:[0,0,0] op_sel_hi:[1,0,1]
  v_lshlrev_b32 v60, 16, v146
  v_and_b32 v61, 0xffff0000, v146
  v_lshlrev_b32 v62, 16, v147
  v_and_b32 v63, 0xffff0000, v147
  v_pk_fma_f32 v[56:57], v[60:61], v[170:171], v[56:57] op_sel:[0,0,0] op_sel_hi:[1,0,1]
  v_pk_fma_f32 v[58:59], v[62:63], v[170:171], v[58:59] op_sel:[0,0,0] op_sel_hi:[1,0,1]
  s_mov_b32 s50, 1048576
  s_add_u32 m0, s70, 65536
  s_nop 0
  buffer_load_dwordx4 v216, s[12:15], s50 offen offset:0 lds
  v_lshlrev_b32 v60, 16, v148
  v_and_b32 v61, 0xffff0000, v148
  v_lshlrev_b32 v62, 16, v149
  v_and_b32 v63, 0xffff0000, v149
  v_pk_fma_f32 v[52:53], v[60:61], v[170:171], v[52:53] op_sel:[0,1,0] op_sel_hi:[1,1,1]
  v_pk_fma_f32 v[54:55], v[62:63], v[170:171], v[54:55] op_sel:[0,1,0] op_sel_hi:[1,1,1]
  v_lshlrev_b32 v60, 16, v150
  v_and_b32 v61, 0xffff0000, v150
  v_lshlrev_b32 v62, 16, v151
  v_and_b32 v63, 0xffff0000, v151
  v_pk_fma_f32 v[56:57], v[60:61], v[170:171], v[56:57] op_sel:[0,1,0] op_sel_hi:[1,1,1]
  v_pk_fma_f32 v[58:59], v[62:63], v[170:171], v[58:59] op_sel:[0,1,0] op_sel_hi:[1,1,1]
  buffer_load_dwordx4 v217, s[12:15], s50 offen offset:1024 lds
  v_lshlrev_b32 v60, 16, v152
  v_and_b32 v61, 0xffff0000, v152
  v_lshlrev_b32 v62, 16, v153
  v_and_b32 v63, 0xffff0000, v153
  v_pk_fma_f32 v[52:53], v[60:61], v[172:173], v[52:53] op_sel:[0,0,0] op_sel_hi:[1,0,1]
  v_pk_fma_f32 v[54:55], v[62:63], v[172:173], v[54:55] op_sel:[0,0,0] op_sel_hi:[1,0,1]
  v_lshlrev_b32 v60, 16, v154
  v_and_b32 v61, 0xffff0000, v154
  v_lshlrev_b32 v62, 16, v155
  v_and_b32 v63, 0xffff0000, v155
  v_pk_fma_f32 v[56:57], v[60:61], v[172:173], v[56:57] op_sel:[0,0,0] op_sel_hi:[1,0,1]
  v_pk_fma_f32 v[58:59], v[62:63], v[172:173], v[58:59] op_sel:[0,0,0] op_sel_hi:[1,0,1]
  buffer_load_dwordx4 v218, s[12:15], s50 offen offset:2048 lds
  v_lshlrev_b32 v60, 16, v156
  v_and_b32 v61, 0xffff0000, v156
  v_lshlrev_b32 v62, 16, v157
  v_and_b32 v63, 0xffff0000, v157
  v_pk_fma_f32 v[52:53], v[60:61], v[172:173], v[52:53] op_sel:[0,1,0] op_sel_hi:[1,1,1]
  v_pk_fma_f32 v[54:55], v[62:63], v[172:173], v[54:55] op_sel:[0,1,0] op_sel_hi:[1,1,1]
  v_lshlrev_b32 v60, 16, v158
  v_and_b32 v61, 0xffff0000, v158
  v_lshlrev_b32 v62, 16, v159
  v_and_b32 v63, 0xffff0000, v159
  v_pk_fma_f32 v[56:57], v[60:61], v[172:173], v[56:57] op_sel:[0,1,0] op_sel_hi:[1,1,1]
  v_pk_fma_f32 v[58:59], v[62:63], v[172:173], v[58:59] op_sel:[0,1,0] op_sel_hi:[1,1,1]
  buffer_load_dwordx4 v219, s[12:15], s50 offen offset:3072 lds
  v_lshlrev_b32 v60, 16, v160
  v_and_b32 v61, 0xffff0000, v160
  v_lshlrev_b32 v62, 16, v161
  v_and_b32 v63, 0xffff0000, v161
  v_pk_fma_f32 v[52:53], v[60:61], v[174:175], v[52:53] op_sel:[0,0,0] op_sel_hi:[1,0,1]
  v_pk_fma_f32 v[54:55], v[62:63], v[174:175], v[54:55] op_sel:[0,0,0] op_sel_hi:[1,0,1]
  v_lshlrev_b32 v60, 16, v162
  v_and_b32 v61, 0xffff0000, v162
  v_lshlrev_b32 v62, 16, v163
  v_and_b32 v63, 0xffff0000, v163
  v_pk_fma_f32 v[56:57], v[60:61], v[174:175], v[56:57] op_sel:[0,0,0] op_sel_hi:[1,0,1]
  v_pk_fma_f32 v[58:59], v[62:63], v[174:175], v[58:59] op_sel:[0,0,0] op_sel_hi:[1,0,1]
  v_lshlrev_b32 v60, 16, v164
  v_and_b32 v61, 0xffff0000, v164
  v_lshlrev_b32 v62, 16, v165
  v_and_b32 v63, 0xffff0000, v165
  v_pk_fma_f32 v[52:53], v[60:61], v[174:175], v[52:53] op_sel:[0,1,0] op_sel_hi:[1,1,1]
  v_pk_fma_f32 v[54:55], v[62:63], v[174:175], v[54:55] op_sel:[0,1,0] op_sel_hi:[1,1,1]
  v_lshlrev_b32 v60, 16, v166
  v_and_b32 v61, 0xffff0000, v166
  v_lshlrev_b32 v62, 16, v167
  v_and_b32 v63, 0xffff0000, v167
  v_pk_fma_f32 v[56:57], v[60:61], v[174:175], v[56:57] op_sel:[0,1,0] op_sel_hi:[1,1,1]
  v_pk_fma_f32 v[58:59], v[62:63], v[174:175], v[58:59] op_sel:[0,1,0] op_sel_hi:[1,1,1]
  s_nop 0
  v_permlane32_swap_b32 v52, v56
  v_permlane32_swap_b32 v53, v57
  v_permlane32_swap_b32 v54, v58
  v_permlane32_swap_b32 v55, v59
  v_add_f32 v52, v52, v56
  v_add_f32 v53, v53, v57
  v_add_f32 v54, v54, v58
  v_add_f32 v55, v55, v59
  s_nop 0
  v_permlane16_swap_b32 v52, v54
  v_permlane16_swap_b32 v53, v55
  v_add_f32 v52, v52, v54
  v_add_f32 v53, v53, v55
  v_add_u32 v60, 162816, v178
  v_add_f32_dpp v52, v52, v52 row_ror:8 row_mask:0xf bank_mask:0xf
  v_add_f32_dpp v53, v53, v53 row_ror:8 row_mask:0xf bank_mask:0xf
  ds_write_b64 v177, v[52:53]
  v_mov_b32 v12, s3
  s_waitcnt vmcnt(6) lgkmcnt(0)
  s_barrier
  s_mov_b64 exec, 1
  buffer_store_dword v12, v0, s[36:39], s45 offen sc1
  s_mov_b64 exec, -1
  ds_read_b32 v52, v60 offset:0
  ds_read_b32 v53, v60 offset:256
  ds_read_b32 v54, v60 offset:512
  ds_read_b32 v55, v60 offset:768
  s_cmp_eq_u32 s44, 1
  s_cselect_b32 s49, s56, 1073741824
  s_lshl_b32 s45, s2, 7
  s_add_u32 s45, s45, 5341184
  s_cmp_eq_u32 s44, 0
  s_cselect_b32 s45, s45, 1073741824
  s_waitcnt lgkmcnt(0)
  v_add_f32 v52, v52, v53
  v_add_f32 v54, v54, v55
  v_add_f32 v52, v52, v54
  buffer_store_dword v52, v178, s[36:39], s49 offen sc1
  s_mov_b32 s50, 1310720
  s_add_u32 m0, s70, 81920
  s_nop 0
  buffer_load_dwordx4 v216, s[12:15], s50 offen offset:0 lds
  buffer_load_dwordx4 v217, s[12:15], s50 offen offset:1024 lds
  buffer_load_dwordx4 v218, s[12:15], s50 offen offset:2048 lds
  buffer_load_dwordx4 v219, s[12:15], s50 offen offset:3072 lds
  s_mov_b32 s50, 1572864
  s_add_u32 m0, s70, 98304
  s_nop 0
  buffer_load_dwordx4 v216, s[12:15], s50 offen offset:0 lds
  buffer_load_dwordx4 v217, s[12:15], s50 offen offset:1024 lds
  buffer_load_dwordx4 v218, s[12:15], s50 offen offset:2048 lds
  buffer_load_dwordx4 v219, s[12:15], s50 offen offset:3072 lds
  s_mov_b32 s50, 1835008
  s_add_u32 m0, s70, 114688
  s_nop 0
  buffer_load_dwordx4 v216, s[12:15], s50 offen offset:0 lds
  buffer_load_dwordx4 v217, s[12:15], s50 offen offset:1024 lds
  buffer_load_dwordx4 v218, s[12:15], s50 offen offset:2048 lds
  buffer_load_dwordx4 v219, s[12:15], s50 offen offset:3072 lds
  s_add_u32 m0, s70, 131072
  s_nop 0
  buffer_load_dwordx4 v220, s[4:7], s55 offen offset:0 lds
  buffer_load_dwordx4 v221, s[4:7], s55 offen offset:1024 lds
  s_add_u32 m0, s70, 133120
  s_add_u32 s48, s55, 32768
  buffer_load_dwordx4 v220, s[4:7], s48 offen offset:0 lds
  buffer_load_dwordx4 v221, s[4:7], s48 offen offset:1024 lds
  ds_read_b64_tr_b16 a[80:81], v232 offset:0
  ds_read_b64_tr_b16 a[82:83], v232 offset:2048
  ds_read_b64_tr_b16 a[84:85], v232 offset:4096
  ds_read_b64_tr_b16 a[86:87], v232 offset:6144
  ds_read_b64_tr_b16 a[88:89], v233 offset:0
  ds_read_b64_tr_b16 a[90:91], v233 offset:2048
  ds_read_b64_tr_b16 a[92:93], v233 offset:4096
  ds_read_b64_tr_b16 a[94:95], v233 offset:6144
  ds_read_b64_tr_b16 a[96:97], v234 offset:0
  ds_read_b64_tr_b16 a[98:99], v234 offset:2048
  ds_read_b64_tr_b16 a[100:101], v234 offset:4096
  ds_read_b64_tr_b16 a[102:103], v234 offset:6144
  ds_read_b64_tr_b16 a[104:105], v235 offset:0
  ds_read_b64_tr_b16 a[106:107], v235 offset:2048
  ds_read_b64_tr_b16 a[108:109], v235 offset:4096
  ds_read_b64_tr_b16 a[110:111], v235 offset:6144
  ds_read_b64_tr_b16 a[112:113], v232 offset:8192
  ds_read_b64_tr_b16 a[114:115], v232 offset:10240
  ds_read_b64_tr_b16 a[116:117], v232 offset:12288
  ds_read_b64_tr_b16 a[118:119], v232 offset:14336
  ds_read_b64_tr_b16 a[120:121], v233 offset:8192
  ds_read_b64_tr_b16 a[122:123], v233 offset:10240
  ds_read_b64_tr_b16 a[124:125], v233 offset:12288
  ds_read_b64_tr_b16 a[126:127], v233 offset:14336
  ds_read_b64_tr_b16 a[128:129], v234 offset:8192
  ds_read_b64_tr_b16 a[130:131], v234 offset:10240
  ds_read_b64_tr_b16 a[132:133], v234 offset:12288
  ds_read_b64_tr_b16 a[134:135], v234 offset:14336
  ds_read_b64_tr_b16 a[136:137], v235 offset:8192
  ds_read_b64_tr_b16 a[138:139], v235 offset:10240
  ds_read_b64_tr_b16 a[140:141], v235 offset:12288
  ds_read_b64_tr_b16 a[142:143], v235 offset:14336
  s_cmp_lg_u32 s44, 0
  s_cbranch_scc1 SM3x
  s_mov_b32 s46, 60000
  s_mov_b32 s47, 5242880
SM3:
  buffer_load_dword v13, v250, s[36:39], s47 offen sc1
  s_sub_u32 s46, s46, 1
  s_cmp_eq_u32 s46, 0
  s_waitcnt vmcnt(0)
  s_cbranch_scc1 SM3x
  v_cmp_ne_u32 vcc, s3, v13
  s_nop 4
  s_cbranch_vccnz SM3
SM3x:
  s_waitcnt vmcnt(0)
  s_barrier
  buffer_load_dwordx4 a[0:3], v244, s[36:39], 0 offen offset:0 sc1
  buffer_load_dwordx4 a[8:11], v244, s[36:39], 0 offen offset:2048 sc1
  buffer_load_dwordx4 a[4:7], v244, s[36:39], 0 offen offset:1024 sc1
  buffer_load_dwordx4 a[12:15], v244, s[36:39], 0 offen offset:3072 sc1
  s_mov_b32 s50, 4096
  buffer_load_dwordx4 a[16:19], v244, s[36:39], s50 offen offset:0 sc1
  buffer_load_dwordx4 a[20:23], v244, s[36:39], s50 offen offset:1024 sc1
  buffer_load_dwordx4 a[24:27], v244, s[36:39], s50 offen offset:2048 sc1
  buffer_load_dwordx4 a[28:31], v244, s[36:39], s50 offen offset:3072 sc1
  ds_read_b64_tr_b16 a[144:145], v232 offset:16384
  ds_read_b64_tr_b16 a[146:147], v232 offset:18432
  ds_read_b64_tr_b16 a[148:149], v232 offset:20480
  ds_read_b64_tr_b16 a[150:151], v232 offset:22528
  ds_read_b64_tr_b16 a[152:153], v233 offset:16384
  ds_read_b64_tr_b16 a[154:155], v233 offset:18432
  ds_read_b64_tr_b16 a[156:157], v233 offset:20480
  ds_read_b64_tr_b16 a[158:159], v233 offset:22528
  ds_read_b64_tr_b16 a[160:161], v234 offset:16384
  ds_read_b64_tr_b16 a[162:163], v234 offset:18432
  ds_read_b64_tr_b16 a[164:165], v234 offset:20480
  ds_read_b64_tr_b16 a[166:167], v234 offset:22528
  ds_read_b64_tr_b16 a[168:169], v235 offset:16384
  ds_read_b64_tr_b16 a[170:171], v235 offset:18432
  ds_read_b64_tr_b16 a[172:173], v235 offset:20480
  ds_read_b64_tr_b16 a[174:175], v235 offset:22528
  ds_read_b64_tr_b16 a[176:177], v232 offset:24576
  ds_read_b64_tr_b16 a[178:179], v232 offset:26624
  ds_read_b64_tr_b16 a[180:181], v232 offset:28672
  ds_read_b64_tr_b16 a[182:183], v232 offset:30720
  ds_read_b64_tr_b16 a[184:185], v233 offset:24576
  ds_read_b64_tr_b16 a[186:187], v233 offset:26624
  ds_read_b64_tr_b16 a[188:189], v233 offset:28672
  ds_read_b64_tr_b16 a[190:191], v233 offset:30720
  ds_read_b64_tr_b16 a[192:193], v234 offset:24576
  ds_read_b64_tr_b16 a[194:195], v234 offset:26624
  ds_read_b64_tr_b16 a[196:197], v234 offset:28672
  ds_read_b64_tr_b16 a[198:199], v234 offset:30720
  ds_read_b64_tr_b16 a[200:201], v235 offset:24576
  ds_read_b64_tr_b16 a[202:203], v235 offset:26624
  ds_read_b64_tr_b16 a[204:205], v235 offset:28672
  ds_read_b64_tr_b16 a[206:207], v235 offset:30720
  ds_read_b64_tr_b16 a[208:209], v232 offset:32768
  ds_read_b64_tr_b16 a[210:211], v232 offset:34816
  ds_read_b64_tr_b16 a[212:213], v232 offset:36864
  ds_read_b64_tr_b16 a[214:215], v232 offset:38912
  ds_read_b64_tr_b16 a[216:217], v233 offset:32768
  ds_read_b64_tr_b16 a[218:219], v233 offset:34816
  ds_read_b64_tr_b16 a[220:221], v233 offset:36864
  ds_read_b64_tr_b16 a[222:223], v233 offset:38912
  ds_read_b64 v[116:117], v240 offset:0
  ds_read_b64 v[118:119], v241 offset:0
  ds_read_b64 v[120:121], v242 offset:0
  ds_read_b64 v[122:123], v243 offset:0
  ds_read_b64 v[124:125], v240 offset:2048
  ds_read_b64 v[126:127], v241 offset:2048
  ds_read_b64 v[128:129], v242 offset:2048
  ds_read_b64 v[130:131], v243 offset:2048
  v_lshrrev_b32 v13, 4, v10
  v_cmp_eq_u32 vcc, 2, v13
  s_add_u32 s51, s73, 4096
  s_nop 0
  v_cndmask_b32 v13, 0, 1.0, vcc
  s_waitcnt lgkmcnt(0)
  v_lshlrev_b32 v52, 16, v116
  v_and_b32 v53, 0xffff0000, v116
  v_lshlrev_b32 v54, 16, v117
  v_and_b32 v55, 0xffff0000, v117
  v_lshlrev_b32 v56, 16, v118
  v_and_b32 v57, 0xffff0000, v118
  v_lshlrev_b32 v58, 16, v119
  v_and_b32 v59, 0xffff0000, v119
  v_lshlrev_b32 v60, 16, v120
  v_and_b32 v61, 0xffff0000, v120
  v_lshlrev_b32 v62, 16, v121
  v_and_b32 v63, 0xffff0000, v121
  v_lshlrev_b32 v64, 16, v122
  v_and_b32 v65, 0xffff0000, v122
  v_lshlrev_b32 v66, 16, v123
  v_and_b32 v67, 0xffff0000, v123
  v_lshlrev_b32 v68, 16, v124
  v_and_b32 v69, 0xffff0000, v124
  v_lshlrev_b32 v70, 16, v125
  v_and_b32 v71, 0xffff0000, v125
  v_lshlrev_b32 v72, 16, v126
  v_and_b32 v73, 0xffff0000, v126
  v_lshlrev_b32 v74, 16, v127
  v_and_b32 v75, 0xffff0000, v127
  v_lshlrev_b32 v76, 16, v128
  v_and_b32 v77, 0xffff0000, v128
  v_lshlrev_b32 v78, 16, v129
  v_and_b32 v79, 0xffff0000, v129
  v_lshlrev_b32 v80, 16, v130
  v_and_b32 v81, 0xffff0000, v130
  v_lshlrev_b32 v82, 16, v131
  v_and_b32 v83, 0xffff0000, v131
  s_waitcnt vmcnt(7) lgkmcnt(15)
  v_mfma_f32_16x16x32_bf16 v[20:23], a[80:83], a[0:3], 0
  s_waitcnt vmcnt(6)
  s_mov_b32 s50, 8192
  buffer_load_dwordx4 a[32:35], v244, s[36:39], s50 offen offset:0 sc1
  v_mfma_f32_16x16x32_bf16 v[20:23], a[84:87], a[8:11], v[20:23]
  s_waitcnt vmcnt(5)
  v_mfma_f32_16x16x32_bf16 v[24:27], a[84:87], a[12:15], 0
  s_waitcnt vmcnt(6)
  buffer_load_dwordx4 a[36:39], v244, s[36:39], s50 offen offset:1024 sc1
  v_mfma_f32_16x16x32_bf16 v[24:27], a[80:83], a[4:7], v[24:27]
  s_waitcnt lgkmcnt(15)
  ds_read_b64_tr_b16 a[80:81], v234 offset:32768
  ds_read_b64_tr_b16 a[82:83], v234 offset:34816
  v_mfma_f32_16x16x32_bf16 v[32:35], a[88:91], a[4:7], 0
  ds_read_b64_tr_b16 a[84:85], v234 offset:36864
  ds_read_b64_tr_b16 a[86:87], v234 offset:38912
  v_mfma_f32_16x16x32_bf16 v[32:35], a[92:95], a[12:15], v[32:35]
  buffer_load_dwordx4 a[40:43], v244, s[36:39], s50 offen offset:2048 sc1
  v_mfma_f32_16x16x32_bf16 v[28:31], a[92:95], a[8:11], 0
  buffer_load_dwordx4 a[44:47], v244, s[36:39], s50 offen offset:3072 sc1
  v_mfma_f32_16x16x32_bf16 v[28:31], a[88:91], a[0:3], v[28:31]
  s_waitcnt lgkmcnt(15)
  s_mov_b32 s50, 12288
  ds_read_b64_tr_b16 a[88:89], v235 offset:32768
  v_mfma_f32_16x16x32_bf16 v[36:39], a[96:99], a[0:3], 0
  ds_read_b64_tr_b16 a[90:91], v235 offset:34816
  ds_read_b64_tr_b16 a[92:93], v235 offset:36864
  v_mfma_f32_16x16x32_bf16 v[36:39], a[100:103], a[8:11], v[36:39]
  buffer_load_dwordx4 a[48:51], v244, s[36:39], s50 offen offset:0 sc1
  ds_read_b64_tr_b16 a[94:95], v235 offset:38912
  v_mfma_f32_16x16x32_bf16 v[40:43], a[100:103], a[12:15], 0
  buffer_load_dwordx4 a[52:55], v244, s[36:39], s50 offen offset:1024 sc1
  v_mfma_f32_16x16x32_bf16 v[40:43], a[96:99], a[4:7], v[40:43]
  s_waitcnt lgkmcnt(15)
  ds_read_b64_tr_b16 a[96:97], v232 offset:40960
  ds_read_b64_tr_b16 a[98:99], v232 offset:43008
  v_mfma_f32_16x16x32_bf16 v[48:51], a[104:107], a[4:7], 0
  s_mov_b32 s49, 0
  buffer_load_dwordx4 a[56:59], v244, s[36:39], s50 offen offset:2048 sc1
  ds_read_b64_tr_b16 a[100:101], v232 offset:45056
  v_mfma_f32_16x16x32_bf16 v[48:51], a[108:111], a[12:15], v[48:51]
  buffer_load_dwordx4 v[156:159], v249, s[36:39], s49 offen sc1
  s_mov_b32 s49, 24576
  v_mfma_f32_16x16x32_bf16 v[44:47], a[108:111], a[8:11], 0
  buffer_load_dwordx4 v[160:163], v249, s[36:39], s49 offen sc1
  s_mov_b32 s49, 49152
  v_mfma_f32_16x16x32_bf16 v[44:47], a[104:107], a[0:3], v[44:47]
  s_waitcnt vmcnt(9) lgkmcnt(15)
  buffer_load_dwordx4 v[164:167], v249, s[36:39], s49 offen sc1
  s_mov_b32 s49, 73728
  v_mfma_f32_16x16x32_bf16 v[20:23], a[112:115], a[16:19], v[20:23]
  buffer_load_dwordx4 v[168:171], v249, s[36:39], s49 offen sc1
  buffer_load_dwordx4 a[60:63], v244, s[36:39], s50 offen offset:3072 sc1
  v_mfma_f32_16x16x32_bf16 v[20:23], a[116:119], a[24:27], v[20:23]
  s_mov_b32 s50, 16384
  ds_read_b64_tr_b16 a[102:103], v232 offset:47104
  ds_read_b64_tr_b16 a[104:105], v233 offset:40960
  v_mfma_f32_16x16x32_bf16 v[24:27], a[116:119], a[28:31], v[24:27]
  buffer_load_dwordx4 a[64:67], v244, s[36:39], s50 offen offset:0 sc1
  ds_read_b64_tr_b16 a[106:107], v233 offset:43008
  v_mfma_f32_16x16x32_bf16 v[24:27], a[112:115], a[20:23], v[24:27]
  s_waitcnt lgkmcnt(15)
  ds_read_b64_tr_b16 a[108:109], v233 offset:45056
  buffer_load_dwordx4 a[68:71], v244, s[36:39], s50 offen offset:1024 sc1
  v_mfma_f32_16x16x32_bf16 v[32:35], a[120:123], a[20:23], v[32:35]
  ds_read_b64_tr_b16 a[110:111], v233 offset:47104
  buffer_load_dwordx4 a[72:75], v244, s[36:39], s50 offen offset:2048 sc1
  v_mfma_f32_16x16x32_bf16 v[32:35], a[124:127], a[28:31], v[32:35]
  ds_read_b64_tr_b16 a[112:113], v234 offset:40960
  ds_read_b64_tr_b16 a[114:115], v234 offset:43008
  v_mfma_f32_16x16x32_bf16 v[28:31], a[124:127], a[24:27], v[28:31]
  buffer_load_dwordx4 a[76:79], v244, s[36:39], s50 offen offset:3072 sc1
  v_mfma_f32_16x16x32_bf16 v[28:31], a[120:123], a[16:19], v[28:31]
  s_waitcnt lgkmcnt(15)
  s_mov_b32 s50, 20480
  ds_read_b64_tr_b16 a[116:117], v234 offset:45056
  v_mfma_f32_16x16x32_bf16 v[36:39], a[128:131], a[16:19], v[36:39]
  buffer_load_dwordx4 a[0:3], v244, s[36:39], s50 offen offset:0 sc1
  ds_read_b64_tr_b16 a[118:119], v234 offset:47104
  v_mfma_f32_16x16x32_bf16 v[36:39], a[132:135], a[24:27], v[36:39]
  ds_read_b64_tr_b16 a[120:121], v235 offset:40960
  v_mfma_f32_16x16x32_bf16 v[40:43], a[132:135], a[28:31], v[40:43]
  buffer_load_dwordx4 a[4:7], v244, s[36:39], s50 offen offset:1024 sc1
  ds_read_b64_tr_b16 a[122:123], v235 offset:43008
  v_mfma_f32_16x16x32_bf16 v[40:43], a[128:131], a[20:23], v[40:43]
  s_waitcnt lgkmcnt(15)
  v_mfma_f32_16x16x32_bf16 v[48:51], a[136:139], a[20:23], v[48:51]
  buffer_load_dwordx4 a[8:11], v244, s[36:39], s50 offen offset:2048 sc1
  ds_read_b64_tr_b16 a[124:125], v235 offset:45056
  v_mfma_f32_16x16x32_bf16 v[48:51], a[140:143], a[28:31], v[48:51]
  ds_read_b64_tr_b16 a[126:127], v235 offset:47104
  v_mfma_f32_16x16x32_bf16 v[44:47], a[140:143], a[24:27], v[44:47]
Ha2_1:
  s_cbranch_execz Ra
  buffer_load_dwordx4 a[12:15], v244, s[36:39], s50 offen offset:3072 sc1
  ds_read_b64_tr_b16 a[128:129], v232 offset:49152
  v_mfma_f32_16x16x32_bf16 v[44:47], a[136:139], a[16:19], v[44:47]
  s_waitcnt vmcnt(16) lgkmcnt(15)
  v_mfma_f32_16x16x32_bf16 v[20:23], a[144:147], a[32:35], v[20:23]
  s_mov_b32 s50, 24576
  ds_read_b64_tr_b16 a[130:131], v232 offset:51200
  v_mfma_f32_16x16x32_bf16 v[20:23], a[148:151], a[40:43], v[20:23]
  buffer_load_dwordx4 a[16:19], v244, s[36:39], s50 offen offset:0 sc1
  ds_read_b64_tr_b16 a[132:133], v232 offset:53248
  v_mfma_f32_16x16x32_bf16 v[24:27], a[148:151], a[44:47], v[24:27]
  ds_read_b64_tr_b16 a[134:135], v232 offset:55296
  v_mfma_f32_16x16x32_bf16 v[24:27], a[144:147], a[36:39], v[24:27]
  s_waitcnt lgkmcnt(15)
  ds_read_b64_tr_b16 a[136:137], v233 offset:49152
  v_mfma_f32_16x16x32_bf16 v[32:35], a[152:155], a[36:39], v[32:35]
  v_mfma_f32_16x16x32_bf16 v[32:35], a[156:159], a[44:47], v[32:35]
  buffer_load_dwordx4 a[20:23], v244, s[36:39], s50 offen offset:1024 sc1
  ds_read_b64_tr_b16 a[138:139], v233 offset:51200
  v_mfma_f32_16x16x32_bf16 v[28:31], a[156:159], a[40:43], v[28:31]
  ds_read_b64_tr_b16 a[140:141], v233 offset:53248
  v_mfma_f32_16x16x32_bf16 v[28:31], a[152:155], a[32:35], v[28:31]
  s_waitcnt lgkmcnt(15)
  ds_read_b64_tr_b16 a[142:143], v233 offset:55296
  v_mfma_f32_16x16x32_bf16 v[36:39], a[160:163], a[32:35], v[36:39]
  v_mfma_f32_16x16x32_bf16 v[36:39], a[164:167], a[40:43], v[36:39]
  buffer_load_dwordx4 a[24:27], v244, s[36:39], s50 offen offset:2048 sc1
  ds_read_b64_tr_b16 a[144:145], v234 offset:49152
  v_mfma_f32_16x16x32_bf16 v[40:43], a[164:167], a[44:47], v[40:43]
  ds_read_b64_tr_b16 a[146:147], v234 offset:51200
  v_mfma_f32_16x16x32_bf16 v[40:43], a[160:163], a[36:39], v[40:43]
  s_waitcnt lgkmcnt(15)
  ds_read_b64_tr_b16 a[148:149], v234 offset:53248
  v_mfma_f32_16x16x32_bf16 v[48:51], a[168:171], a[36:39], v[48:51]
  ds_read_b64_tr_b16 a[150:151], v234 offset:55296
  v_mfma_f32_16x16x32_bf16 v[48:51], a[172:175], a[44:47], v[48:51]
  buffer_load_dwordx4 a[28:31], v244, s[36:39], s50 offen offset:3072 sc1
  v_mfma_f32_16x16x32_bf16 v[44:47], a[172:175], a[40:43], v[44:47]
  ds_read_b64_tr_b16 a[152:153], v235 offset:49152
  v_mfma_f32_16x16x32_bf16 v[44:47], a[168:171], a[32:35], v[44:47]
  s_waitcnt vmcnt(12) lgkmcnt(15)
  ds_read_b64_tr_b16 a[154:155], v235 offset:51200
  v_mfma_f32_16x16x32_bf16 v[20:23], a[176:179], a[48:51], v[20:23]
  s_mov_b32 s50, 28672
  ds_read_b64_tr_b16 a[156:157], v235 offset:53248
  v_mfma_f32_16x16x32_bf16 v[20:23], a[180:183], a[56:59], v[20:23]
  buffer_load_dwordx4 a[32:35], v244, s[36:39], s50 offen offset:0 sc1
  v_mfma_f32_16x16x32_bf16 v[24:27], a[180:183], a[60:63], v[24:27]
  ds_read_b64_tr_b16 a[158:159], v235 offset:55296
  v_mfma_f32_16x16x32_bf16 v[24:27], a[176:179], a[52:55], v[24:27]
  s_waitcnt lgkmcnt(15)
  ds_read_b64_tr_b16 a[160:161], v232 offset:57344
  v_mfma_f32_16x16x32_bf16 v[32:35], a[184:187], a[52:55], v[32:35]
  ds_read_b64_tr_b16 a[162:163], v232 offset:59392
  v_mfma_f32_16x16x32_bf16 v[32:35], a[188:191], a[60:63], v[32:35]
  buffer_load_dwordx4 a[36:39], v244, s[36:39], s50 offen offset:1024 sc1
  ds_read_b64_tr_b16 a[164:165], v232 offset:61440
  v_mfma_f32_16x16x32_bf16 v[28:31], a[188:191], a[56:59], v[28:31]
  v_mfma_f32_16x16x32_bf16 v[28:31], a[184:187], a[48:51], v[28:31]
  s_waitcnt lgkmcnt(15)
  ds_read_b64_tr_b16 a[166:167], v232 offset:63488
  v_mfma_f32_16x16x32_bf16 v[36:39], a[192:195], a[48:51], v[36:39]
  ds_read_b64_tr_b16 a[168:169], v233 offset:57344
  v_mfma_f32_16x16x32_bf16 v[36:39], a[196:199], a[56:59], v[36:39]
  buffer_load_dwordx4 a[40:43], v244, s[36:39], s50 offen offset:2048 sc1
  ds_read_b64_tr_b16 a[170:171], v233 offset:59392
  v_mfma_f32_16x16x32_bf16 v[40:43], a[196:199], a[60:63], v[40:43]
  v_mfma_f32_16x16x32_bf16 v[40:43], a[192:195], a[52:55], v[40:43]
  s_waitcnt lgkmcnt(15)
  ds_read_b64_tr_b16 a[172:173], v233 offset:61440
  v_mfma_f32_16x16x32_bf16 v[48:51], a[200:203], a[52:55], v[48:51]
  ds_read_b64_tr_b16 a[174:175], v233 offset:63488
  v_mfma_f32_16x16x32_bf16 v[48:51], a[204:207], a[60:63], v[48:51]
  buffer_load_dwordx4 a[44:47], v244, s[36:39], s50 offen offset:3072 sc1
  ds_read_b64_tr_b16 a[176:177], v234 offset:57344
  v_mfma_f32_16x16x32_bf16 v[44:47], a[204:207], a[56:59], v[44:47]
  ds_read_b64_tr_b16 a[178:179], v234 offset:59392
  v_mfma_f32_16x16x32_bf16 v[44:47], a[200:203], a[48:51], v[44:47]
  s_waitcnt vmcnt(12) lgkmcnt(15)
  v_mfma_f32_16x16x32_bf16 v[20:23], a[208:211], a[64:67], v[20:23]
  s_mov_b32 s50, 32768
  ds_read_b64_tr_b16 a[180:181], v234 offset:61440
  v_mfma_f32_16x16x32_bf16 v[20:23], a[212:215], a[72:75], v[20:23]
  buffer_load_dwordx4 a[48:51], v244, s[36:39], s50 offen offset:0 sc1
  ds_read_b64_tr_b16 a[182:183], v234 offset:63488
  v_mfma_f32_16x16x32_bf16 v[24:27], a[212:215], a[76:79], v[24:27]
  ds_read_b64_tr_b16 a[184:185], v235 offset:57344
  v_mfma_f32_16x16x32_bf16 v[24:27], a[208:211], a[68:71], v[24:27]
  s_waitcnt lgkmcnt(15)
  ds_read_b64_tr_b16 a[186:187], v235 offset:59392
  v_mfma_f32_16x16x32_bf16 v[32:35], a[216:219], a[68:71], v[32:35]
  v_mfma_f32_16x16x32_bf16 v[32:35], a[220:223], a[76:79], v[32:35]
  buffer_load_dwordx4 a[52:55], v244, s[36:39], s50 offen offset:1024 sc1
  ds_read_b64_tr_b16 a[188:189], v235 offset:61440
  v_mfma_f32_16x16x32_bf16 v[28:31], a[220:223], a[72:75], v[28:31]
  ds_read_b64_tr_b16 a[190:191], v235 offset:63488
  v_mfma_f32_16x16x32_bf16 v[28:31], a[216:219], a[64:67], v[28:31]
  s_waitcnt lgkmcnt(15)
  ds_read_b64_tr_b16 a[192:193], v236 offset:0
  v_mfma_f32_16x16x32_bf16 v[36:39], a[80:83], a[64:67], v[36:39]
  v_mfma_f32_16x16x32_bf16 v[36:39], a[84:87], a[72:75], v[36:39]
  buffer_load_dwordx4 a[56:59], v244, s[36:39], s50 offen offset:2048 sc1
  ds_read_b64_tr_b16 a[194:195], v236 offset:2048
  v_mfma_f32_16x16x32_bf16 v[40:43], a[84:87], a[76:79], v[40:43]
  ds_read_b64_tr_b16 a[196:197], v236 offset:4096
  v_mfma_f32_16x16x32_bf16 v[40:43], a[80:83], a[68:71], v[40:43]
  s_waitcnt lgkmcnt(15)
  ds_read_b64_tr_b16 a[198:199], v236 offset:6144
  v_mfma_f32_16x16x32_bf16 v[48:51], a[88:91], a[68:71], v[48:51]
  ds_read_b64_tr_b16 a[200:201], v237 offset:0
  v_mfma_f32_16x16x32_bf16 v[48:51], a[92:95], a[76:79], v[48:51]
  buffer_load_dwordx4 a[60:63], v244, s[36:39], s50 offen offset:3072 sc1
  v_mfma_f32_16x16x32_bf16 v[44:47], a[92:95], a[72:75], v[44:47]
  ds_read_b64_tr_b16 a[202:203], v237 offset:2048
  v_mfma_f32_16x16x32_bf16 v[44:47], a[88:91], a[64:67], v[44:47]
  s_waitcnt vmcnt(12) lgkmcnt(15)
  ds_read_b64_tr_b16 a[204:205], v237 offset:4096
  v_mfma_f32_16x16x32_bf16 v[20:23], a[96:99], a[0:3], v[20:23]
  s_mov_b32 s50, 36864
  ds_read_b64_tr_b16 a[206:207], v237 offset:6144
  v_mfma_f32_16x16x32_bf16 v[20:23], a[100:103], a[8:11], v[20:23]
  buffer_load_dwordx4 a[64:67], v244, s[36:39], s50 offen offset:0 sc1
  v_mfma_f32_16x16x32_bf16 v[24:27], a[100:103], a[12:15], v[24:27]
  ds_read_b64_tr_b16 a[208:209], v238 offset:0
  v_mfma_f32_16x16x32_bf16 v[24:27], a[96:99], a[4:7], v[24:27]
  s_waitcnt lgkmcnt(15)
  ds_read_b64_tr_b16 a[210:211], v238 offset:2048
  v_mfma_f32_16x16x32_bf16 v[32:35], a[104:107], a[4:7], v[32:35]
  ds_read_b64_tr_b16 a[212:213], v238 offset:4096
  v_mfma_f32_16x16x32_bf16 v[32:35], a[108:111], a[12:15], v[32:35]
  buffer_load_dwordx4 a[68:71], v244, s[36:39], s50 offen offset:1024 sc1
  ds_read_b64_tr_b16 a[214:215], v238 offset:6144
  v_mfma_f32_16x16x32_bf16 v[28:31], a[108:111], a[8:11], v[28:31]
  v_mfma_f32_16x16x32_bf16 v[28:31], a[104:107], a[0:3], v[28:31]
  s_waitcnt lgkmcnt(15)
  ds_read_b64_tr_b16 a[216:217], v239 offset:0
  v_mfma_f32_16x16x32_bf16 v[36:39], a[112:115], a[0:3], v[36:39]
  s_waitcnt vmcnt(23)
  ds_read_b64_tr_b16 a[218:219], v239 offset:2048
  v_max_u32 v15, v156, v157
  v_mfma_f32_16x16x32_bf16 v[36:39], a[116:119], a[8:11], v[36:39]
  buffer_load_dwordx4 a[72:75], v244, s[36:39], s50 offen offset:2048 sc1
  ds_read_b64_tr_b16 a[220:221], v239 offset:4096
  v_mfma_f32_16x16x32_bf16 v[40:43], a[116:119], a[12:15], v[40:43]
  v_max3_u32 v15, v15, v158, v159
  v_max3_u32 v15, v15, v160, v161
  v_mfma_f32_16x16x32_bf16 v[40:43], a[112:115], a[4:7], v[40:43]
  s_waitcnt lgkmcnt(15)
  ds_read_b64_tr_b16 a[222:223], v239 offset:6144
  v_max3_u32 v15, v15, v162, v163
  v_mfma_f32_16x16x32_bf16 v[48:51], a[120:123], a[4:7], v[48:51]
  ds_read_b64_tr_b16 a[80:81], v236 offset:8192
  v_max3_u32 v15, v15, v164, v165
  v_mfma_f32_16x16x32_bf16 v[48:51], a[124:127], a[12:15], v[48:51]
  buffer_load_dwordx4 a[76:79], v244, s[36:39], s50 offen offset:3072 sc1
  ds_read_b64_tr_b16 a[82:83], v236 offset:10240
  v_mfma_f32_16x16x32_bf16 v[44:47], a[124:127], a[8:11], v[44:47]
  ds_read_b64_tr_b16 a[84:85], v236 offset:12288
  v_max3_u32 v15, v15, v166, v167
  v_mfma_f32_16x16x32_bf16 v[44:47], a[120:123], a[0:3], v[44:47]
  s_waitcnt vmcnt(12) lgkmcnt(15)
  v_max3_u32 v15, v15, v168, v169
  v_max3_u32 v15, v15, v170, v171
  v_mfma_f32_16x16x32_bf16 v[20:23], a[128:131], a[16:19], v[20:23]
  s_mov_b32 s50, 40960
  ds_read_b64_tr_b16 a[86:87], v236 offset:14336
  v_mfma_f32_16x16x32_bf16 v[20:23], a[132:135], a[24:27], v[20:23]
  buffer_load_dwordx4 a[0:3], v244, s[36:39], s50 offen offset:0 sc1
  ds_read_b64_tr_b16 a[88:89], v237 offset:8192
  v_mfma_f32_16x16x32_bf16 v[24:27], a[132:135], a[28:31], v[24:27]
  ds_read_b64_tr_b16 a[90:91], v237 offset:10240
  v_mfma_f32_16x16x32_bf16 v[24:27], a[128:131], a[20:23], v[24:27]
  s_waitcnt lgkmcnt(15)
  v_cmp_eq_u32 vcc, -1, v15
  s_nop 4
  s_cbranch_vccnz CK4s
CK4x:
  v_mfma_f32_16x16x32_bf16 v[32:35], a[136:139], a[20:23], v[32:35]
  ds_read_b64_tr_b16 a[92:93], v237 offset:12288
  v_add_f32 v156, v156, v164
  v_mfma_f32_16x16x32_bf16 v[32:35], a[140:143], a[28:31], v[32:35]
  buffer_load_dwordx4 a[4:7], v244, s[36:39], s50 offen offset:1024 sc1
  ds_read_b64_tr_b16 a[94:95], v237 offset:14336
  v_mfma_f32_16x16x32_bf16 v[28:31], a[140:143], a[24:27], v[28:31]
  ds_read_b64_tr_b16 a[96:97], v238 offset:8192
  v_add_f32 v157, v157, v165
  v_mfma_f32_16x16x32_bf16 v[28:31], a[136:139], a[16:19], v[28:31]
  s_waitcnt lgkmcnt(15)
  ds_read_b64_tr_b16 a[98:99], v238 offset:10240
  v_add_f32 v158, v158, v166
  v_mfma_f32_16x16x32_bf16 v[36:39], a[144:147], a[16:19], v[36:39]
  v_add_f32 v159, v159, v167
  v_add_f32 v160, v160, v168
  v_mfma_f32_16x16x32_bf16 v[36:39], a[148:151], a[24:27], v[36:39]
  buffer_load_dwordx4 a[8:11], v244, s[36:39], s50 offen offset:2048 sc1
  ds_read_b64_tr_b16 a[100:101], v238 offset:12288
  v_mfma_f32_16x16x32_bf16 v[40:43], a[148:151], a[28:31], v[40:43]
  ds_read_b64_tr_b16 a[102:103], v238 offset:14336
  v_add_f32 v161, v161, v169
  v_mfma_f32_16x16x32_bf16 v[40:43], a[144:147], a[20:23], v[40:43]
  s_waitcnt lgkmcnt(15)
  ds_read_b64_tr_b16 a[104:105], v239 offset:8192
  v_add_f32 v162, v162, v170
  v_mfma_f32_16x16x32_bf16 v[48:51], a[152:155], a[20:23], v[48:51]
  v_add_f32 v163, v163, v171
  v_add_f32 v156, v156, v160
  v_mfma_f32_16x16x32_bf16 v[48:51], a[156:159], a[28:31], v[48:51]
  buffer_load_dwordx4 a[12:15], v244, s[36:39], s50 offen offset:3072 sc1
  ds_read_b64_tr_b16 a[106:107], v239 offset:10240
  v_mfma_f32_16x16x32_bf16 v[44:47], a[156:159], a[24:27], v[44:47]
  ds_read_b64_tr_b16 a[108:109], v239 offset:12288
  v_add_f32 v157, v157, v161
  v_mfma_f32_16x16x32_bf16 v[44:47], a[152:155], a[16:19], v[44:47]
  s_waitcnt vmcnt(12) lgkmcnt(15)
  ds_read_b64_tr_b16 a[110:111], v239 offset:14336
  v_add_f32 v158, v158, v162
  v_mfma_f32_16x16x32_bf16 v[20:23], a[160:163], a[32:35], v[20:23]
  s_mov_b32 s50, 45056
  ds_read_b64_tr_b16 a[112:113], v236 offset:16384
  v_add_f32 v159, v159, v163
  v_mfma_f32_16x16x32_bf16 v[20:23], a[164:167], a[40:43], v[20:23]
  buffer_load_dwordx4 a[16:19], v244, s[36:39], s50 offen offset:0 sc1
  v_cvt_pk_bf16_f32 v160, v156, v157
  v_mfma_f32_16x16x32_bf16 v[24:27], a[164:167], a[44:47], v[24:27]
  ds_read_b64_tr_b16 a[114:115], v236 offset:18432
  v_lshlrev_b32 v156, 16, v160
  v_mfma_f32_16x16x32_bf16 v[24:27], a[160:163], a[36:39], v[24:27]
  s_waitcnt lgkmcnt(15)
  ds_read_b64_tr_b16 a[116:117], v236 offset:20480
  v_and_b32 v157, 0xffff0000, v160
  v_mfma_f32_16x16x32_bf16 v[32:35], a[168:171], a[36:39], v[32:35]
  ds_read_b64_tr_b16 a[118:119], v236 offset:22528
  v_cvt_pk_bf16_f32 v161, v158, v159
  v_mfma_f32_16x16x32_bf16 v[32:35], a[172:175], a[44:47], v[32:35]
  buffer_load_dwordx4 a[20:23], v244, s[36:39], s50 offen offset:1024 sc1
  v_lshlrev_b32 v158, 16, v161
  v_mfma_f32_16x16x32_bf16 v[28:31], a[172:175], a[40:43], v[28:31]
  ds_read_b64_tr_b16 a[120:121], v237 offset:16384
  v_and_b32 v159, 0xffff0000, v161
  v_mfma_f32_16x16x32_bf16 v[28:31], a[168:171], a[32:35], v[28:31]
  s_waitcnt lgkmcnt(15)
  ds_read_b64_tr_b16 a[122:123], v237 offset:18432
  v_add_f32 v156, v13, v156
  v_mfma_f32_16x16x32_bf16 v[36:39], a[176:179], a[32:35], v[36:39]
  ds_read_b64_tr_b16 a[124:125], v237 offset:20480
  v_add_f32 v157, v13, v157
  v_mfma_f32_16x16x32_bf16 v[36:39], a[180:183], a[40:43], v[36:39]
  buffer_load_dwordx4 a[24:27], v244, s[36:39], s50 offen offset:2048 sc1
  ds_read_b64_tr_b16 a[126:127], v237 offset:22528
  v_mfma_f32_16x16x32_bf16 v[40:43], a[180:183], a[44:47], v[40:43]
  v_add_f32 v158, v13, v158
  v_add_f32 v159, v13, v159
  v_mfma_f32_16x16x32_bf16 v[40:43], a[176:179], a[36:39], v[40:43]
  s_waitcnt lgkmcnt(15)
  ds_read_b64_tr_b16 a[128:129], v238 offset:16384
  v_cvt_pk_bf16_f32 v160, v156, v157
  v_mfma_f32_16x16x32_bf16 v[48:51], a[184:187], a[36:39], v[48:51]
  ds_read_b64_tr_b16 a[130:131], v238 offset:18432
  v_lshlrev_b32 v156, 16, v160
  v_mfma_f32_16x16x32_bf16 v[48:51], a[188:191], a[44:47], v[48:51]
  buffer_load_dwordx4 a[28:31], v244, s[36:39], s50 offen offset:3072 sc1
  ds_read_b64_tr_b16 a[132:133], v238 offset:20480
  v_mfma_f32_16x16x32_bf16 v[44:47], a[188:191], a[40:43], v[44:47]
  ds_read_b64_tr_b16 a[134:135], v238 offset:22528
  v_and_b32 v157, 0xffff0000, v160
  v_mfma_f32_16x16x32_bf16 v[44:47], a[184:187], a[32:35], v[44:47]
  s_waitcnt vmcnt(12) lgkmcnt(15)
  v_cvt_pk_bf16_f32 v161, v158, v159
  v_lshlrev_b32 v158, 16, v161
  v_mfma_f32_16x16x32_bf16 v[20:23], a[192:195], a[48:51], v[20:23]
  s_mov_b32 s50, 49152
  ds_read_b64_tr_b16 a[136:137], v239 offset:16384
  v_and_b32 v159, 0xffff0000, v161
  v_mfma_f32_16x16x32_bf16 v[20:23], a[196:199], a[56:59], v[20:23]
  ds_write_b128 v247, v[156:159]
  ds_read_b128 v[84:87], v245 offset:0
  v_mfma_f32_16x16x32_bf16 v[24:27], a[196:199], a[60:63], v[24:27]
  ds_read_b128 v[100:103], v245 offset:512
  ds_read_b128 v[88:91], v245 offset:64
  v_mfma_f32_16x16x32_bf16 v[24:27], a[192:195], a[52:55], v[24:27]
  s_waitcnt lgkmcnt(15)
  ds_read_b128 v[104:107], v245 offset:576
  ds_read_b128 v[92:95], v245 offset:128
  v_mfma_f32_16x16x32_bf16 v[32:35], a[200:203], a[52:55], v[32:35]
  ds_read_b128 v[108:111], v245 offset:640
  ds_read_b128 v[96:99], v245 offset:192
  v_mfma_f32_16x16x32_bf16 v[32:35], a[204:207], a[60:63], v[32:35]
  ds_read_b128 v[112:115], v245 offset:704
  ds_read_b128 v[116:119], v246 offset:512
  v_mfma_f32_16x16x32_bf16 v[28:31], a[204:207], a[56:59], v[28:31]
  ds_read_b128 v[120:123], v246 offset:576
  ds_read_b128 v[124:127], v246 offset:640
  v_mfma_f32_16x16x32_bf16 v[28:31], a[200:203], a[48:51], v[28:31]
  s_waitcnt lgkmcnt(15)
  ds_read_b128 v[128:131], v246 offset:704
  buffer_load_dwordx4 a[32:35], v244, s[36:39], s50 offen offset:0 sc1
  v_mfma_f32_16x16x32_bf16 v[36:39], a[208:211], a[48:51], v[36:39]
  ds_read_b64_tr_b16 a[138:139], v239 offset:18432
  ds_read_b64_tr_b16 a[140:141], v239 offset:20480
  v_mfma_f32_16x16x32_bf16 v[36:39], a[212:215], a[56:59], v[36:39]
  ds_read_b64_tr_b16 a[142:143], v239 offset:22528
  buffer_load_dwordx4 a[36:39], v244, s[36:39], s50 offen offset:1024 sc1
  v_mfma_f32_16x16x32_bf16 v[40:43], a[212:215], a[60:63], v[40:43]
  ds_read_b64_tr_b16 a[144:145], v236 offset:24576
  ds_read_b64_tr_b16 a[146:147], v236 offset:26624
  v_mfma_f32_16x16x32_bf16 v[40:43], a[208:211], a[52:55], v[40:43]
  s_waitcnt lgkmcnt(15)
  ds_read_b64_tr_b16 a[148:149], v236 offset:28672
  buffer_load_dwordx4 a[40:43], v244, s[36:39], s50 offen offset:2048 sc1
  v_mfma_f32_16x16x32_bf16 v[48:51], a[216:219], a[52:55], v[48:51]
  ds_read_b64_tr_b16 a[150:151], v236 offset:30720
  ds_read_b64_tr_b16 a[152:153], v237 offset:24576
  v_mfma_f32_16x16x32_bf16 v[48:51], a[220:223], a[60:63], v[48:51]
  ds_read_b64_tr_b16 a[154:155], v237 offset:26624
  buffer_load_dwordx4 a[44:47], v244, s[36:39], s50 offen offset:3072 sc1
  v_mfma_f32_16x16x32_bf16 v[44:47], a[220:223], a[56:59], v[44:47]
  ds_read_b64_tr_b16 a[156:157], v237 offset:28672
  ds_read_b64_tr_b16 a[158:159], v237 offset:30720
  v_mfma_f32_16x16x32_bf16 v[44:47], a[216:219], a[48:51], v[44:47]
  s_waitcnt vmcnt(12) lgkmcnt(15)
  ds_read_b64_tr_b16 a[160:161], v238 offset:24576
  v_accvgpr_write_b32 a248, v156
  v_mfma_f32_16x16x32_bf16 v[20:23], a[80:83], a[64:67], v[20:23]
  s_mov_b32 s50, 53248
  ds_read_b64_tr_b16 a[162:163], v238 offset:26624
  v_accvgpr_write_b32 a249, v157
  v_mfma_f32_16x16x32_bf16 v[20:23], a[84:87], a[72:75], v[20:23]
  buffer_load_dwordx4 a[48:51], v244, s[36:39], s50 offen offset:0 sc1
  v_accvgpr_write_b32 a250, v158
  v_mfma_f32_16x16x32_bf16 v[24:27], a[84:87], a[76:79], v[24:27]
  ds_read_b64_tr_b16 a[164:165], v238 offset:28672
  v_accvgpr_write_b32 a251, v159
  v_mfma_f32_16x16x32_bf16 v[24:27], a[80:83], a[68:71], v[24:27]
  s_waitcnt lgkmcnt(14)
  ds_read_b64_tr_b16 a[166:167], v238 offset:30720
  v_mfma_f32_16x16x32_bf16 v[32:35], a[88:91], a[68:71], v[32:35]
  ds_read_b64_tr_b16 a[168:169], v239 offset:24576
  v_cvt_pk_bf16_f32 v148, v116, v117
  v_mfma_f32_16x16x32_bf16 v[32:35], a[92:95], a[76:79], v[32:35]
  buffer_load_dwordx4 a[52:55], v244, s[36:39], s50 offen offset:1024 sc1
  v_cvt_pk_bf16_f32 v149, v118, v119
  v_mfma_f32_16x16x32_bf16 v[28:31], a[92:95], a[72:75], v[28:31]
  ds_read_b64_tr_b16 a[170:171], v239 offset:26624
  v_cvt_pk_bf16_f32 v150, v120, v121
  v_mfma_f32_16x16x32_bf16 v[28:31], a[88:91], a[64:67], v[28:31]
  s_waitcnt lgkmcnt(15)
  ds_read_b64_tr_b16 a[172:173], v239 offset:28672
  v_cvt_pk_bf16_f32 v151, v122, v123
  v_mfma_f32_16x16x32_bf16 v[36:39], a[96:99], a[64:67], v[36:39]
  ds_read_b64_tr_b16 a[174:175], v239 offset:30720
  v_cvt_pk_bf16_f32 v152, v124, v125
  v_mfma_f32_16x16x32_bf16 v[36:39], a[100:103], a[72:75], v[36:39]
  buffer_load_dwordx4 a[56:59], v244, s[36:39], s50 offen offset:2048 sc1
  ds_read_b64_tr_b16 a[176:177], v236 offset:32768
  v_mfma_f32_16x16x32_bf16 v[40:43], a[100:103], a[76:79], v[40:43]
  v_cvt_pk_bf16_f32 v153, v126, v127
  v_cvt_pk_bf16_f32 v154, v128, v129
  v_mfma_f32_16x16x32_bf16 v[40:43], a[96:99], a[68:71], v[40:43]
  s_waitcnt lgkmcnt(15)
  ds_read_b64_tr_b16 a[178:179], v236 offset:34816
  v_cvt_pk_bf16_f32 v155, v130, v131
  v_mfma_f32_16x16x32_bf16 v[48:51], a[104:107], a[68:71], v[48:51]
  buffer_store_dwordx4 v[148:151], v0, s[36:39], s75 offen offset:0 sc1
  buffer_store_dwordx4 v[152:155], v0, s[36:39], s75 offen offset:1024 sc1
  v_mfma_f32_16x16x32_bf16 v[48:51], a[108:111], a[76:79], v[48:51]
  ds_read_b64_tr_b16 a[180:181], v236 offset:36864
  buffer_load_dwordx4 a[60:63], v244, s[36:39], s50 offen offset:3072 sc1
  v_mfma_f32_16x16x32_bf16 v[44:47], a[108:111], a[72:75], v[44:47]
  ds_read_b64_tr_b16 a[182:183], v236 offset:38912
  v_mfma_f32_16x16x32_bf16 v[44:47], a[104:107], a[64:67], v[44:47]
  s_waitcnt vmcnt(14) lgkmcnt(15)
  ds_read_b64_tr_b16 a[184:185], v237 offset:32768
  v_mfma_f32_16x16x32_bf16 v[20:23], a[112:115], a[0:3], v[20:23]
  s_mov_b32 s50, 57344
  ds_read_b64_tr_b16 a[186:187], v237 offset:34816
  v_mfma_f32_16x16x32_bf16 v[20:23], a[116:119], a[8:11], v[20:23]
  buffer_load_dwordx4 a[64:67], v244, s[36:39], s50 offen offset:0 sc1
  ds_read_b64_tr_b16 a[188:189], v237 offset:36864
  v_mfma_f32_16x16x32_bf16 v[24:27], a[116:119], a[12:15], v[24:27]
  ds_read_b64_tr_b16 a[190:191], v237 offset:38912
  v_mfma_f32_16x16x32_bf16 v[24:27], a[112:115], a[4:7], v[24:27]
  s_waitcnt lgkmcnt(15)
  v_mfma_f32_16x16x32_bf16 v[32:35], a[120:123], a[4:7], v[32:35]
  ds_read_b64_tr_b16 a[192:193], v238 offset:32768
  v_mfma_f32_16x16x32_bf16 v[32:35], a[124:127], a[12:15], v[32:35]
  buffer_load_dwordx4 a[68:71], v244, s[36:39], s50 offen offset:1024 sc1
  ds_read_b64_tr_b16 a[194:195], v238 offset:34816
  v_mfma_f32_16x16x32_bf16 v[28:31], a[124:127], a[8:11], v[28:31]
  ds_read_b64_tr_b16 a[196:197], v238 offset:36864
  v_mfma_f32_16x16x32_bf16 v[28:31], a[120:123], a[0:3], v[28:31]
  s_waitcnt lgkmcnt(15)
  v_mfma_f32_16x16x32_bf16 v[36:39], a[128:131], a[0:3], v[36:39]
  ds_read_b64_tr_b16 a[198:199], v238 offset:38912
  v_mfma_f32_16x16x32_bf16 v[36:39], a[132:135], a[8:11], v[36:39]
  buffer_load_dwordx4 a[72:75], v244, s[36:39], s50 offen offset:2048 sc1
  ds_read_b64_tr_b16 a[200:201], v239 offset:32768
  v_mfma_f32_16x16x32_bf16 v[40:43], a[132:135], a[12:15], v[40:43]
  ds_read_b64_tr_b16 a[202:203], v239 offset:34816
  v_mfma_f32_16x16x32_bf16 v[40:43], a[128:131], a[4:7], v[40:43]
  s_waitcnt lgkmcnt(15)
  ds_read_b64_tr_b16 a[204:205], v239 offset:36864
  v_mfma_f32_16x16x32_bf16 v[48:51], a[136:139], a[4:7], v[48:51]
  v_mfma_f32_16x16x32_bf16 v[48:51], a[140:143], a[12:15], v[48:51]
  buffer_load_dwordx4 a[76:79], v244, s[36:39], s50 offen offset:3072 sc1
  ds_read_b64_tr_b16 a[206:207], v239 offset:38912
  v_mfma_f32_16x16x32_bf16 v[44:47], a[140:143], a[8:11], v[44:47]
  ds_read_b64_tr_b16 a[208:209], v236 offset:40960
  v_mfma_f32_16x16x32_bf16 v[44:47], a[136:139], a[0:3], v[44:47]
  s_waitcnt vmcnt(14) lgkmcnt(15)
  ds_read_b64_tr_b16 a[210:211], v236 offset:43008
  v_mfma_f32_16x16x32_bf16 v[20:23], a[144:147], a[16:19], v[20:23]
  s_mov_b32 s50, 61440
  v_mfma_f32_16x16x32_bf16 v[20:23], a[148:151], a[24:27], v[20:23]
  buffer_load_dwordx4 a[0:3], v244, s[36:39], s50 offen offset:0 sc1
  ds_read_b64_tr_b16 a[212:213], v236 offset:45056
  v_mfma_f32_16x16x32_bf16 v[24:27], a[148:151], a[28:31], v[24:27]
  ds_read_b64_tr_b16 a[214:215], v236 offset:47104
  v_mfma_f32_16x16x32_bf16 v[24:27], a[144:147], a[20:23], v[24:27]
  s_waitcnt lgkmcnt(15)
  ds_read_b64_tr_b16 a[216:217], v237 offset:40960
  v_mfma_f32_16x16x32_bf16 v[32:35], a[152:155], a[20:23], v[32:35]
  ds_read_b64_tr_b16 a[218:219], v237 offset:43008
  v_mfma_f32_16x16x32_bf16 v[32:35], a[156:159], a[28:31], v[32:35]
  buffer_load_dwordx4 a[4:7], v244, s[36:39], s50 offen offset:1024 sc1
  v_mfma_f32_16x16x32_bf16 v[28:31], a[156:159], a[24:27], v[28:31]
  ds_read_b64_tr_b16 a[220:221], v237 offset:45056
  v_mfma_f32_16x16x32_bf16 v[28:31], a[152:155], a[16:19], v[28:31]
  s_waitcnt lgkmcnt(15)
  ds_read_b64_tr_b16 a[222:223], v237 offset:47104
  v_mfma_f32_16x16x32_bf16 v[36:39], a[160:163], a[16:19], v[36:39]
  ds_read_b64_tr_b16 a[80:81], v238 offset:40960
  v_mfma_f32_16x16x32_bf16 v[36:39], a[164:167], a[24:27], v[36:39]
  buffer_load_dwordx4 a[8:11], v244, s[36:39], s50 offen offset:2048 sc1
  ds_read_b64_tr_b16 a[82:83], v238 offset:43008
  v_mfma_f32_16x16x32_bf16 v[40:43], a[164:167], a[28:31], v[40:43]
  v_mfma_f32_16x16x32_bf16 v[40:43], a[160:163], a[20:23], v[40:43]
  s_waitcnt lgkmcnt(15)
  ds_read_b64_tr_b16 a[84:85], v238 offset:45056
  v_mfma_f32_16x16x32_bf16 v[48:51], a[168:171], a[20:23], v[48:51]
  ds_read_b64_tr_b16 a[86:87], v238 offset:47104
  v_mfma_f32_16x16x32_bf16 v[48:51], a[172:175], a[28:31], v[48:51]
  buffer_load_dwordx4 a[12:15], v244, s[36:39], s50 offen offset:3072 sc1
  ds_read_b64_tr_b16 a[88:89], v239 offset:40960
  v_mfma_f32_16x16x32_bf16 v[44:47], a[172:175], a[24:27], v[44:47]
  v_mfma_f32_16x16x32_bf16 v[44:47], a[168:171], a[16:19], v[44:47]
  s_waitcnt vmcnt(14) lgkmcnt(15)
  ds_read_b64_tr_b16 a[90:91], v239 offset:43008
  v_mfma_f32_16x16x32_bf16 v[20:23], a[176:179], a[32:35], v[20:23]
  ds_read_b64_tr_b16 a[92:93], v239 offset:45056
  v_mfma_f32_16x16x32_bf16 v[20:23], a[180:183], a[40:43], v[20:23]
  ds_read_b64_tr_b16 a[94:95], v239 offset:47104
  v_mfma_f32_16x16x32_bf16 v[24:27], a[180:183], a[44:47], v[24:27]
  ds_read_b64_tr_b16 a[96:97], v236 offset:49152
  v_mfma_f32_16x16x32_bf16 v[24:27], a[176:179], a[36:39], v[24:27]
  s_waitcnt lgkmcnt(15)
  v_mfma_f32_16x16x32_bf16 v[32:35], a[184:187], a[36:39], v[32:35]
  ds_read_b64_tr_b16 a[98:99], v236 offset:51200
  v_mfma_f32_16x16x32_bf16 v[32:35], a[188:191], a[44:47], v[32:35]
  ds_read_b64_tr_b16 a[100:101], v236 offset:53248
  v_mfma_f32_16x16x32_bf16 v[28:31], a[188:191], a[40:43], v[28:31]
  ds_read_b64_tr_b16 a[102:103], v236 offset:55296
  v_mfma_f32_16x16x32_bf16 v[28:31], a[184:187], a[32:35], v[28:31]
  s_waitcnt lgkmcnt(15)
  v_mfma_f32_16x16x32_bf16 v[36:39], a[192:195], a[32:35], v[36:39]
  ds_read_b64_tr_b16 a[104:105], v237 offset:49152
  v_mfma_f32_16x16x32_bf16 v[36:39], a[196:199], a[40:43], v[36:39]
  ds_read_b64_tr_b16 a[106:107], v237 offset:51200
  v_mfma_f32_16x16x32_bf16 v[40:43], a[196:199], a[44:47], v[40:43]
  ds_read_b64_tr_b16 a[108:109], v237 offset:53248
  v_mfma_f32_16x16x32_bf16 v[40:43], a[192:195], a[36:39], v[40:43]
  s_waitcnt lgkmcnt(15)
  ds_read_b64_tr_b16 a[110:111], v237 offset:55296
  v_mfma_f32_16x16x32_bf16 v[48:51], a[200:203], a[36:39], v[48:51]
  v_mfma_f32_16x16x32_bf16 v[48:51], a[204:207], a[44:47], v[48:51]
  ds_read_b64_tr_b16 a[112:113], v238 offset:49152
  v_mfma_f32_16x16x32_bf16 v[44:47], a[204:207], a[40:43], v[44:47]
  ds_read_b64_tr_b16 a[114:115], v238 offset:51200
  v_mfma_f32_16x16x32_bf16 v[44:47], a[200:203], a[32:35], v[44:47]
  s_waitcnt vmcnt(8) lgkmcnt(15)
  ds_read_b64_tr_b16 a[116:117], v238 offset:53248
  v_mfma_f32_16x16x32_bf16 v[20:23], a[208:211], a[48:51], v[20:23]
  v_mfma_f32_16x16x32_bf16 v[20:23], a[212:215], a[56:59], v[20:23]
  ds_read_b64_tr_b16 a[118:119], v238 offset:55296
  v_mfma_f32_16x16x32_bf16 v[24:27], a[212:215], a[60:63], v[24:27]
  ds_read_b64_tr_b16 a[120:121], v239 offset:49152
  v_mfma_f32_16x16x32_bf16 v[24:27], a[208:211], a[52:55], v[24:27]
  s_waitcnt lgkmcnt(15)
  ds_read_b64_tr_b16 a[122:123], v239 offset:51200
  v_mfma_f32_16x16x32_bf16 v[32:35], a[216:219], a[52:55], v[32:35]
  ds_read_b64_tr_b16 a[124:125], v239 offset:53248
  v_mfma_f32_16x16x32_bf16 v[32:35], a[220:223], a[60:63], v[32:35]
  v_mfma_f32_16x16x32_bf16 v[28:31], a[220:223], a[56:59], v[28:31]
  ds_read_b64_tr_b16 a[126:127], v239 offset:55296
  v_mfma_f32_16x16x32_bf16 v[28:31], a[216:219], a[48:51], v[28:31]
  s_waitcnt lgkmcnt(15)
  ds_read_b64_tr_b16 a[128:129], v236 offset:57344
  v_mfma_f32_16x16x32_bf16 v[36:39], a[80:83], a[48:51], v[36:39]
  ds_read_b64_tr_b16 a[130:131], v236 offset:59392
  v_mfma_f32_16x16x32_bf16 v[36:39], a[84:87], a[56:59], v[36:39]
  v_mfma_f32_16x16x32_bf16 v[40:43], a[84:87], a[60:63], v[40:43]
  ds_read_b64_tr_b16 a[132:133], v236 offset:61440
  v_mfma_f32_16x16x32_bf16 v[40:43], a[80:83], a[52:55], v[40:43]
  s_waitcnt lgkmcnt(15)
  ds_read_b64_tr_b16 a[134:135], v236 offset:63488
  v_mfma_f32_16x16x32_bf16 v[48:51], a[88:91], a[52:55], v[48:51]
  ds_read_b64_tr_b16 a[136:137], v237 offset:57344
  v_mfma_f32_16x16x32_bf16 v[48:51], a[92:95], a[60:63], v[48:51]
  ds_read_b64_tr_b16 a[138:139], v237 offset:59392
  v_mfma_f32_16x16x32_bf16 v[44:47], a[92:95], a[56:59], v[44:47]
  v_mfma_f32_16x16x32_bf16 v[44:47], a[88:91], a[48:51], v[44:47]
  s_waitcnt vmcnt(4) lgkmcnt(15)
  ds_read_b64_tr_b16 a[140:141], v237 offset:61440
  v_mfma_f32_16x16x32_bf16 v[20:23], a[96:99], a[64:67], v[20:23]
  ds_read_b64_tr_b16 a[142:143], v237 offset:63488
  v_mfma_f32_16x16x32_bf16 v[20:23], a[100:103], a[72:75], v[20:23]
  ds_read_b64_tr_b16 a[144:145], v238 offset:57344
  v_mfma_f32_16x16x32_bf16 v[24:27], a[100:103], a[76:79], v[24:27]
  v_mfma_f32_16x16x32_bf16 v[24:27], a[96:99], a[68:71], v[24:27]
  s_waitcnt lgkmcnt(15)
  ds_read_b64_tr_b16 a[146:147], v238 offset:59392
  v_mfma_f32_16x16x32_bf16 v[32:35], a[104:107], a[68:71], v[32:35]
  ds_read_b64_tr_b16 a[148:149], v238 offset:61440
  v_mfma_f32_16x16x32_bf16 v[32:35], a[108:111], a[76:79], v[32:35]
  ds_read_b64_tr_b16 a[150:151], v238 offset:63488
  v_mfma_f32_16x16x32_bf16 v[28:31], a[108:111], a[72:75], v[28:31]
  ds_read_b64_tr_b16 a[152:153], v239 offset:57344
  v_mfma_f32_16x16x32_bf16 v[28:31], a[104:107], a[64:67], v[28:31]
  s_waitcnt lgkmcnt(15)
  v_mfma_f32_16x16x32_bf16 v[36:39], a[112:115], a[64:67], v[36:39]
  ds_read_b64_tr_b16 a[154:155], v239 offset:59392
  v_mfma_f32_16x16x32_bf16 v[36:39], a[116:119], a[72:75], v[36:39]
  ds_read_b64_tr_b16 a[156:157], v239 offset:61440
  v_mfma_f32_16x16x32_bf16 v[40:43], a[116:119], a[76:79], v[40:43]
  ds_read_b64_tr_b16 a[158:159], v239 offset:63488
  v_mfma_f32_16x16x32_bf16 v[40:43], a[112:115], a[68:71], v[40:43]
  s_waitcnt lgkmcnt(15)
  v_mfma_f32_16x16x32_bf16 v[48:51], a[120:123], a[68:71], v[48:51]
  v_mfma_f32_16x16x32_bf16 v[48:51], a[124:127], a[76:79], v[48:51]
  v_mfma_f32_16x16x32_bf16 v[44:47], a[124:127], a[72:75], v[44:47]
  v_mfma_f32_16x16x32_bf16 v[44:47], a[120:123], a[64:67], v[44:47]
  s_waitcnt vmcnt(0) lgkmcnt(12)
  v_mfma_f32_16x16x32_bf16 v[20:23], a[128:131], a[0:3], v[20:23]
  v_mfma_f32_16x16x32_bf16 v[20:23], a[132:135], a[8:11], v[20:23]
  v_mfma_f32_16x16x32_bf16 v[24:27], a[132:135], a[12:15], v[24:27]
  v_mfma_f32_16x16x32_bf16 v[24:27], a[128:131], a[4:7], v[24:27]
  s_waitcnt lgkmcnt(8)
  v_mfma_f32_16x16x32_bf16 v[32:35], a[136:139], a[4:7], v[32:35]
  v_mfma_f32_16x16x32_bf16 v[32:35], a[140:143], a[12:15], v[32:35]
  v_mfma_f32_16x16x32_bf16 v[28:31], a[140:143], a[8:11], v[28:31]
  v_mfma_f32_16x16x32_bf16 v[28:31], a[136:139], a[0:3], v[28:31]
  s_waitcnt lgkmcnt(4)
  v_mfma_f32_16x16x32_bf16 v[36:39], a[144:147], a[0:3], v[36:39]
  v_mfma_f32_16x16x32_bf16 v[36:39], a[148:151], a[8:11], v[36:39]
Ha0_2:
  s_cbranch_execz Ra
  v_mfma_f32_16x16x32_bf16 v[40:43], a[148:151], a[12:15], v[40:43]
  v_mfma_f32_16x16x32_bf16 v[40:43], a[144:147], a[4:7], v[40:43]
  s_waitcnt lgkmcnt(0)
  v_mfma_f32_16x16x32_bf16 v[48:51], a[152:155], a[4:7], v[48:51]
  v_mfma_f32_16x16x32_bf16 v[48:51], a[156:159], a[12:15], v[48:51]
  v_mfma_f32_16x16x32_bf16 v[44:47], a[156:159], a[8:11], v[44:47]
  v_mfma_f32_16x16x32_bf16 v[44:47], a[152:155], a[0:3], v[44:47]
  s_waitcnt lgkmcnt(0)
  s_nop 2
  v_pk_fma_f32 v[52:53], v[84:85], v[20:21], v[52:53]
  v_pk_fma_f32 v[54:55], v[86:87], v[22:23], v[54:55]
  v_pk_fma_f32 v[56:57], v[88:89], v[28:29], v[56:57]
  v_pk_fma_f32 v[58:59], v[90:91], v[30:31], v[58:59]
  v_pk_mul_f32 v[20:21], v[52:53], v[100:101]
  v_pk_mul_f32 v[22:23], v[54:55], v[102:103]
  v_pk_mul_f32 v[28:29], v[56:57], v[104:105]
  v_pk_mul_f32 v[30:31], v[58:59], v[106:107]
  v_cvt_pk_bf16_f32 v132, v20, v21
  v_cvt_pk_bf16_f32 v133, v22, v23
  v_cvt_pk_bf16_f32 v134, v28, v29
  v_cvt_pk_bf16_f32 v135, v30, v31
  buffer_store_dwordx4 v[132:135], v0, s[36:39], s73 offen offset:0 sc1
  v_pk_fma_f32 v[68:69], v[84:85], v[24:25], v[68:69]
  v_pk_fma_f32 v[70:71], v[86:87], v[26:27], v[70:71]
  v_pk_fma_f32 v[72:73], v[88:89], v[32:33], v[72:73]
  v_pk_fma_f32 v[74:75], v[90:91], v[34:35], v[74:75]
  v_pk_mul_f32 v[24:25], v[68:69], v[100:101]
  v_pk_mul_f32 v[26:27], v[70:71], v[102:103]
  v_pk_mul_f32 v[32:33], v[72:73], v[104:105]
  v_pk_mul_f32 v[34:35], v[74:75], v[106:107]
  v_cvt_pk_bf16_f32 v140, v24, v25
  v_cvt_pk_bf16_f32 v141, v26, v27
  v_cvt_pk_bf16_f32 v142, v32, v33
  v_cvt_pk_bf16_f32 v143, v34, v35
  buffer_store_dwordx4 v[140:143], v0, s[36:39], s73 offen offset:1024 sc1
  v_pk_fma_f32 v[60:61], v[92:93], v[36:37], v[60:61]
  v_pk_fma_f32 v[62:63], v[94:95], v[38:39], v[62:63]
  v_pk_fma_f32 v[64:65], v[96:97], v[44:45], v[64:65]
  v_pk_fma_f32 v[66:67], v[98:99], v[46:47], v[66:67]
  v_pk_mul_f32 v[36:37], v[60:61], v[108:109]
  v_pk_mul_f32 v[38:39], v[62:63], v[110:111]
  v_pk_mul_f32 v[44:45], v[64:65], v[112:113]
  v_pk_mul_f32 v[46:47], v[66:67], v[114:115]
  v_cvt_pk_bf16_f32 v136, v36, v37
  v_cvt_pk_bf16_f32 v137, v38, v39
  v_cvt_pk_bf16_f32 v138, v44, v45
  v_cvt_pk_bf16_f32 v139, v46, v47
  buffer_store_dwordx4 v[136:139], v0, s[36:39], s51 offen offset:0 sc1
  v_pk_fma_f32 v[76:77], v[92:93], v[40:41], v[76:77]
  v_pk_fma_f32 v[78:79], v[94:95], v[42:43], v[78:79]
  v_pk_fma_f32 v[80:81], v[96:97], v[48:49], v[80:81]
  v_pk_fma_f32 v[82:83], v[98:99], v[50:51], v[82:83]
  v_pk_mul_f32 v[40:41], v[76:77], v[108:109]
  v_pk_mul_f32 v[42:43], v[78:79], v[110:111]
  v_pk_mul_f32 v[48:49], v[80:81], v[112:113]
  v_pk_mul_f32 v[50:51], v[82:83], v[114:115]
  v_cvt_pk_bf16_f32 v144, v40, v41
  v_cvt_pk_bf16_f32 v145, v42, v43
  v_cvt_pk_bf16_f32 v146, v48, v49
  v_cvt_pk_bf16_f32 v147, v50, v51
  buffer_store_dwordx4 v[144:147], v0, s[36:39], s51 offen offset:1024 sc1
  v_pk_mul_f32 v[30:31], v[52:53], v[52:53]
  v_pk_mul_f32 v[34:35], v[68:69], v[68:69]
  v_pk_fma_f32 v[30:31], v[54:55], v[54:55], v[30:31]
  v_pk_add_f32 v[28:29], v[54:55], v[52:53]
  v_pk_fma_f32 v[34:35], v[70:71], v[70:71], v[34:35]
  v_pk_add_f32 v[32:33], v[70:71], v[68:69]
  v_pk_fma_f32 v[30:31], v[56:57], v[56:57], v[30:31]
  v_pk_add_f32 v[28:29], v[56:57], v[28:29]
  v_pk_fma_f32 v[34:35], v[72:73], v[72:73], v[34:35]
  v_pk_add_f32 v[32:33], v[72:73], v[32:33]
  v_pk_fma_f32 v[30:31], v[58:59], v[58:59], v[30:31]
  v_pk_add_f32 v[28:29], v[58:59], v[28:29]
  v_pk_fma_f32 v[34:35], v[74:75], v[74:75], v[34:35]
  v_pk_add_f32 v[32:33], v[74:75], v[32:33]
  v_pk_fma_f32 v[30:31], v[60:61], v[60:61], v[30:31]
  v_pk_add_f32 v[28:29], v[60:61], v[28:29]
  v_pk_fma_f32 v[34:35], v[76:77], v[76:77], v[34:35]
  v_pk_add_f32 v[32:33], v[76:77], v[32:33]
  v_pk_fma_f32 v[30:31], v[62:63], v[62:63], v[30:31]
  v_pk_add_f32 v[28:29], v[62:63], v[28:29]
  v_pk_fma_f32 v[34:35], v[78:79], v[78:79], v[34:35]
  v_pk_add_f32 v[32:33], v[78:79], v[32:33]
  v_pk_fma_f32 v[30:31], v[64:65], v[64:65], v[30:31]
  v_pk_add_f32 v[28:29], v[64:65], v[28:29]
  v_pk_fma_f32 v[34:35], v[80:81], v[80:81], v[34:35]
  v_pk_add_f32 v[32:33], v[80:81], v[32:33]
  v_pk_fma_f32 v[30:31], v[66:67], v[66:67], v[30:31]
  v_pk_add_f32 v[28:29], v[66:67], v[28:29]
  v_pk_fma_f32 v[34:35], v[82:83], v[82:83], v[34:35]
  v_pk_add_f32 v[32:33], v[82:83], v[32:33]
  v_add_f32 v20, v28, v29
  v_add_f32 v21, v30, v31
  v_add_f32 v22, v32, v33
  v_add_f32 v23, v34, v35
  v_mov_b32 v24, v20
  v_mov_b32 v25, v21
  v_mov_b32 v26, v22
  v_mov_b32 v27, v23
  v_permlane16_swap_b32 v20, v24
  v_permlane16_swap_b32 v21, v25
  v_permlane16_swap_b32 v22, v26
  v_permlane16_swap_b32 v23, v27
  v_pk_add_f32 v[20:21], v[20:21], v[24:25]
  v_pk_add_f32 v[22:23], v[22:23], v[26:27]
  v_mov_b32 v24, v20
  v_mov_b32 v25, v21
  v_mov_b32 v26, v22
  v_mov_b32 v27, v23
  v_permlane32_swap_b32 v20, v24
  v_permlane32_swap_b32 v21, v25
  v_permlane32_swap_b32 v22, v26
  v_permlane32_swap_b32 v23, v27
  v_pk_add_f32 v[20:21], v[20:21], v[24:25]
  v_pk_add_f32 v[22:23], v[22:23], v[26:27]
  s_mov_b64 exec, 0xffff
  buffer_store_dwordx4 v[20:23], v0, s[36:39], s74 offen sc1
  s_mov_b64 exec, -1
  v_cvt_pk_bf16_f32 v116, v52, v53
  v_cvt_pk_bf16_f32 v117, v54, v55
  v_cvt_pk_bf16_f32 v118, v56, v57
  v_cvt_pk_bf16_f32 v119, v58, v59
  v_cvt_pk_bf16_f32 v120, v60, v61
  v_cvt_pk_bf16_f32 v121, v62, v63
  v_cvt_pk_bf16_f32 v122, v64, v65
  v_cvt_pk_bf16_f32 v123, v66, v67
  v_cvt_pk_bf16_f32 v124, v68, v69
  v_cvt_pk_bf16_f32 v125, v70, v71
  v_cvt_pk_bf16_f32 v126, v72, v73
  v_cvt_pk_bf16_f32 v127, v74, v75
  v_cvt_pk_bf16_f32 v128, v76, v77
  v_cvt_pk_bf16_f32 v129, v78, v79
  v_cvt_pk_bf16_f32 v130, v80, v81
  v_cvt_pk_bf16_f32 v131, v82, v83
  v_accvgpr_write_b32 a232, v116
  v_accvgpr_write_b32 a233, v117
  v_accvgpr_write_b32 a234, v118
  v_accvgpr_write_b32 a235, v119
  v_accvgpr_write_b32 a236, v120
  v_accvgpr_write_b32 a237, v121
  v_accvgpr_write_b32 a238, v122
  v_accvgpr_write_b32 a239, v123
  v_accvgpr_write_b32 a240, v124
  v_accvgpr_write_b32 a241, v125
  v_accvgpr_write_b32 a242, v126
  v_accvgpr_write_b32 a243, v127
  v_accvgpr_write_b32 a244, v128
  v_accvgpr_write_b32 a245, v129
  v_accvgpr_write_b32 a246, v130
  v_accvgpr_write_b32 a247, v131
  v_mov_b32 v12, s3
  s_waitcnt vmcnt(0) lgkmcnt(0)
  s_barrier
  s_mov_b64 exec, 1
  buffer_store_dword v12, v0, s[36:39], s45 offen sc1
  s_mov_b64 exec, -1
  s_bfe_u32 s56, s82, 0x40000
  s_mul_i32 s56, s56, 458752
  s_add_u32 m0, s84, 0
  s_nop 0
  buffer_load_dwordx4 v3, s[16:19], s56 offen offset:0 lds
  buffer_load_dwordx4 v4, s[16:19], s56 offen offset:1024 lds
  buffer_load_dwordx4 v5, s[16:19], s56 offen offset:2048 lds
  buffer_load_dwordx4 v6, s[16:19], s56 offen offset:3072 lds
  s_add_u32 m0, s84, 4096
  s_nop 0
  buffer_load_dwordx4 v7, s[16:19], s56 offen offset:0 lds
  buffer_load_dwordx4 v8, s[16:19], s56 offen offset:1024 lds
  buffer_load_dwordx4 v9, s[16:19], s56 offen offset:2048 lds
  s_bfe_u32 s56, s82, 0x40004
  s_mul_i32 s56, s56, 458752
  s_add_u32 m0, s84, 28672
  s_nop 0
  buffer_load_dwordx4 v3, s[16:19], s56 offen offset:0 lds
  buffer_load_dwordx4 v4, s[16:19], s56 offen offset:1024 lds
  buffer_load_dwordx4 v5, s[16:19], s56 offen offset:2048 lds
  buffer_load_dwordx4 v6, s[16:19], s56 offen offset:3072 lds
  s_add_u32 m0, s84, 32768
  s_nop 0
  buffer_load_dwordx4 v7, s[16:19], s56 offen offset:0 lds
  buffer_load_dwordx4 v8, s[16:19], s56 offen offset:1024 lds
  buffer_load_dwordx4 v9, s[16:19], s56 offen offset:2048 lds
  s_bfe_u32 s57, s82, 0x40000
  s_lshl_b32 s57, s57, 13
  s_add_u32 s57, s57, s85
  s_lshl2_add_u32 s48, s2, s44
  s_cmp_eq_u32 s48, 1
  s_cbranch_scc1 CKSs
CKSx:
  s_mov_b64 exec, 0
  s_cmp_eq_u32 s44, 1
  s_cbranch_scc1 Hb0
  s_cmp_eq_u32 s44, 2
  s_cbranch_scc1 Hb1
  s_cmp_eq_u32 s44, 3
  s_cbranch_scc1 Hb2
Rb:
  s_mov_b64 exec, -1
G3S:
  s_cmp_lg_u32 s44, 0
  s_cbranch_scc1 SM5x
  s_mov_b32 s46, 60000
  s_mov_b32 s47, 5242880
SM5:
  buffer_load_dword v13, v251, s[36:39], s47 offen sc1
  s_sub_u32 s46, s46, 1
  s_cmp_eq_u32 s46, 0
  s_waitcnt vmcnt(0)
  s_cbranch_scc1 SM5x
  v_cmp_ne_u32 vcc, s3, v13
  s_nop 4
  s_cbranch_vccnz SM5
SM5x:
  s_waitcnt vmcnt(7)
  s_barrier
  buffer_load_dwordx4 a[0:3], v0, s[36:39], s57 offen offset:0 sc1
  buffer_load_dwordx4 a[4:7], v0, s[36:39], s57 offen offset:1024 sc1
  buffer_load_dwordx4 a[8:11], v0, s[36:39], s57 offen offset:2048 sc1
  buffer_load_dwordx4 a[12:15], v0, s[36:39], s57 offen offset:3072 sc1
  s_add_u32 s57, s57, 4096
  buffer_load_dwordx4 a[16:19], v0, s[36:39], s57 offen offset:0 sc1
  buffer_load_dwordx4 a[20:23], v0, s[36:39], s57 offen offset:1024 sc1
  buffer_load_dwordx4 a[24:27], v0, s[36:39], s57 offen offset:2048 sc1
  buffer_load_dwordx4 a[28:31], v0, s[36:39], s57 offen offset:3072 sc1
  ds_read_b64_tr_b16 a[128:129], v1 offset:0
  ds_read_b64_tr_b16 a[130:131], v1 offset:3584
  ds_read_b64_tr_b16 a[132:133], v1 offset:7168
  ds_read_b64_tr_b16 a[134:135], v1 offset:10752
  ds_read_b64_tr_b16 a[136:137], v1 offset:32
  ds_read_b64_tr_b16 a[138:139], v1 offset:3616
  ds_read_b64_tr_b16 a[140:141], v1 offset:7200
  ds_read_b64_tr_b16 a[142:143], v1 offset:10784
  ds_read_b64_tr_b16 a[144:145], v1 offset:64
  ds_read_b64_tr_b16 a[146:147], v1 offset:3648
  ds_read_b64_tr_b16 a[148:149], v1 offset:7232
  ds_read_b64_tr_b16 a[150:151], v1 offset:10816
  ds_read_b64_tr_b16 a[152:153], v1 offset:96
  ds_read_b64_tr_b16 a[154:155], v1 offset:3680
  ds_read_b64_tr_b16 a[156:157], v1 offset:7264
  ds_read_b64_tr_b16 a[158:159], v1 offset:10848
  s_waitcnt vmcnt(7) lgkmcnt(8)
  v_mfma_f32_16x16x32_bf16 v[32:35], a[128:131], a[0:3], 0
  s_waitcnt vmcnt(3)
  s_bfe_u32 s57, s82, 0x40004
  s_lshl_b32 s57, s57, 13
  v_mfma_f32_16x16x32_bf16 v[32:35], a[132:135], a[16:19], v[32:35]
  s_waitcnt vmcnt(2)
  s_add_u32 s57, s57, s85
  buffer_load_dwordx4 a[32:35], v0, s[36:39], s57 offen offset:0 sc1
  v_mfma_f32_16x16x32_bf16 v[36:39], a[132:135], a[20:23], 0
  s_waitcnt vmcnt(7)
  ds_read_b64_tr_b16 a[160:161], v1 offset:128
  v_mfma_f32_16x16x32_bf16 v[36:39], a[128:131], a[4:7], v[36:39]
  s_waitcnt vmcnt(6)
  ds_read_b64_tr_b16 a[162:163], v1 offset:3712
  v_mfma_f32_16x16x32_bf16 v[40:43], a[128:131], a[8:11], 0
  s_waitcnt vmcnt(2)
  ds_read_b64_tr_b16 a[164:165], v1 offset:7296
  v_mfma_f32_16x16x32_bf16 v[40:43], a[132:135], a[24:27], v[40:43]
  s_waitcnt vmcnt(1)
  v_mfma_f32_16x16x32_bf16 v[44:47], a[132:135], a[28:31], 0
  s_waitcnt vmcnt(5)
  buffer_load_dwordx4 a[36:39], v0, s[36:39], s57 offen offset:1024 sc1
  v_mfma_f32_16x16x32_bf16 v[44:47], a[128:131], a[12:15], v[44:47]
  ds_read_b64_tr_b16 a[166:167], v1 offset:10880
  v_mfma_f32_16x16x32_bf16 v[60:63], a[136:139], a[12:15], 0
  ds_read_b64_tr_b16 a[168:169], v1 offset:160
  v_mfma_f32_16x16x32_bf16 v[60:63], a[140:143], a[28:31], v[60:63]
  v_mfma_f32_16x16x32_bf16 v[56:59], a[140:143], a[24:27], 0
  ds_read_b64_tr_b16 a[170:171], v1 offset:3744
  v_mfma_f32_16x16x32_bf16 v[56:59], a[136:139], a[8:11], v[56:59]
  buffer_load_dwordx4 a[40:43], v0, s[36:39], s57 offen offset:2048 sc1
  v_mfma_f32_16x16x32_bf16 v[52:55], a[136:139], a[4:7], 0
  ds_read_b64_tr_b16 a[172:173], v1 offset:7328
  v_mfma_f32_16x16x32_bf16 v[52:55], a[140:143], a[20:23], v[52:55]
  v_mfma_f32_16x16x32_bf16 v[48:51], a[140:143], a[16:19], 0
  ds_read_b64_tr_b16 a[174:175], v1 offset:10912
  v_mfma_f32_16x16x32_bf16 v[48:51], a[136:139], a[0:3], v[48:51]
  s_waitcnt lgkmcnt(8)
  v_mfma_f32_16x16x32_bf16 v[64:67], a[144:147], a[0:3], 0
  buffer_load_dwordx4 a[44:47], v0, s[36:39], s57 offen offset:3072 sc1
  s_bfe_u32 s56, s82, 0x40008
  v_mfma_f32_16x16x32_bf16 v[64:67], a[148:151], a[16:19], v[64:67]
  s_mul_i32 s56, s56, 458752
  s_add_u32 m0, s84, 57344
  ds_read_b64_tr_b16 a[128:129], v1 offset:192
  v_mfma_f32_16x16x32_bf16 v[68:71], a[148:151], a[20:23], 0
  ds_read_b64_tr_b16 a[130:131], v1 offset:3776
  v_mfma_f32_16x16x32_bf16 v[68:71], a[144:147], a[4:7], v[68:71]
  v_mfma_f32_16x16x32_bf16 v[72:75], a[144:147], a[8:11], 0
  ds_read_b64_tr_b16 a[132:133], v1 offset:7360
  v_mfma_f32_16x16x32_bf16 v[72:75], a[148:151], a[24:27], v[72:75]
  buffer_load_dwordx4 v3, s[16:19], s56 offen offset:0 lds
  s_add_u32 s57, s57, 4096
  v_mfma_f32_16x16x32_bf16 v[76:79], a[148:151], a[28:31], 0
  ds_read_b64_tr_b16 a[134:135], v1 offset:10944
  v_mfma_f32_16x16x32_bf16 v[76:79], a[144:147], a[12:15], v[76:79]
  v_mfma_f32_16x16x32_bf16 v[92:95], a[152:155], a[12:15], 0
  ds_read_b64_tr_b16 a[136:137], v1 offset:14336
  v_mfma_f32_16x16x32_bf16 v[92:95], a[156:159], a[28:31], v[92:95]
  v_mfma_f32_16x16x32_bf16 v[88:91], a[156:159], a[24:27], 0
  buffer_load_dwordx4 a[48:51], v0, s[36:39], s57 offen offset:0 sc1
  v_mfma_f32_16x16x32_bf16 v[88:91], a[152:155], a[8:11], v[88:91]
  ds_read_b64_tr_b16 a[138:139], v1 offset:17920
  v_mfma_f32_16x16x32_bf16 v[84:87], a[152:155], a[4:7], 0
  ds_read_b64_tr_b16 a[140:141], v1 offset:21504
  v_mfma_f32_16x16x32_bf16 v[84:87], a[156:159], a[20:23], v[84:87]
  v_mfma_f32_16x16x32_bf16 v[80:83], a[156:159], a[16:19], 0
  ds_read_b64_tr_b16 a[142:143], v1 offset:25088
  v_mfma_f32_16x16x32_bf16 v[80:83], a[152:155], a[0:3], v[80:83]
  s_waitcnt lgkmcnt(8)
  buffer_load_dwordx4 v4, s[16:19], s56 offen offset:1024 lds
  v_mfma_f32_16x16x32_bf16 v[96:99], a[160:163], a[0:3], 0
  ds_read_b64_tr_b16 a[144:145], v1 offset:14368
  v_mfma_f32_16x16x32_bf16 v[96:99], a[164:167], a[16:19], v[96:99]
  v_mfma_f32_16x16x32_bf16 v[100:103], a[164:167], a[20:23], 0
  ds_read_b64_tr_b16 a[146:147], v1 offset:17952
  v_mfma_f32_16x16x32_bf16 v[100:103], a[160:163], a[4:7], v[100:103]
  v_mfma_f32_16x16x32_bf16 v[104:107], a[160:163], a[8:11], 0
  buffer_load_dwordx4 a[52:55], v0, s[36:39], s57 offen offset:1024 sc1
  v_mfma_f32_16x16x32_bf16 v[104:107], a[164:167], a[24:27], v[104:107]
  ds_read_b64_tr_b16 a[148:149], v1 offset:21536
  v_mfma_f32_16x16x32_bf16 v[108:111], a[164:167], a[28:31], 0
  ds_read_b64_tr_b16 a[150:151], v1 offset:25120
  v_mfma_f32_16x16x32_bf16 v[108:111], a[160:163], a[12:15], v[108:111]
  v_mfma_f32_16x16x32_bf16 v[124:127], a[168:171], a[12:15], 0
  s_bfe_u32 s59, s82, 0x40018
  s_lshl4_add_u32 s59, s58, s59
  s_lshl_b32 s59, s59, 11
  v_mfma_f32_16x16x32_bf16 v[124:127], a[172:175], a[28:31], v[124:127]
  s_add_u32 s59, s59, 5767168
  buffer_load_dwordx4 v5, s[16:19], s56 offen offset:2048 lds
  s_lshr_b32 s76, s44, 1
  v_mfma_f32_16x16x32_bf16 v[120:123], a[172:175], a[24:27], 0
  s_mul_i32 s76, s76, 14336
  ds_read_b64_tr_b16 a[152:153], v1 offset:14400
  s_and_b32 s77, s44, 1
  v_mfma_f32_16x16x32_bf16 v[120:123], a[168:171], a[8:11], v[120:123]
  s_lshl_b32 s77, s77, 7
  ds_read_b64_tr_b16 a[154:155], v1 offset:17984
  s_add_u32 s76, s76, s77
  v_mfma_f32_16x16x32_bf16 v[116:119], a[168:171], a[4:7], 0
  ds_read_b64_tr_b16 a[156:157], v1 offset:21568
  v_add_u32 v31, s76, v1
  v_mfma_f32_16x16x32_bf16 v[116:119], a[172:175], a[20:23], v[116:119]
  s_lshl_b32 s61, s2, 15
  s_lshl1_add_u32 s61, s70, s61
  s_xor_b32 s63, s61, 32768
  v_mfma_f32_16x16x32_bf16 v[112:115], a[172:175], a[16:19], 0
  s_add_u32 s61, s61, 41943040
  buffer_load_dwordx4 a[56:59], v0, s[36:39], s57 offen offset:2048 sc1
  s_add_u32 s62, s61, 4096
  v_mfma_f32_16x16x32_bf16 v[112:115], a[168:171], a[0:3], v[112:115]
  s_waitcnt lgkmcnt(7)
  ds_read_b64_tr_b16 a[158:159], v1 offset:25152
  s_add_u32 s63, s63, 41943040
  v_mfma_f32_16x16x32_bf16 v[128:131], a[128:131], a[0:3], 0
  s_add_u32 s64, s63, 4096
  ds_read_b64_tr_b16 a[160:161], v1 offset:14432
  v_mfma_f32_16x16x32_bf16 v[128:131], a[132:135], a[16:19], v[128:131]
  v_mfma_f32_16x16x32_bf16 v[132:135], a[132:135], a[20:23], 0
  ds_read_b64_tr_b16 a[162:163], v1 offset:18016
  v_mfma_f32_16x16x32_bf16 v[132:135], a[128:131], a[4:7], v[132:135]
  buffer_load_dwordx4 v6, s[16:19], s56 offen offset:3072 lds
  v_mfma_f32_16x16x32_bf16 v[136:139], a[128:131], a[8:11], 0
  ds_read_b64_tr_b16 a[164:165], v1 offset:21600
  v_mfma_f32_16x16x32_bf16 v[136:139], a[132:135], a[24:27], v[136:139]
  v_mfma_f32_16x16x32_bf16 v[140:143], a[132:135], a[28:31], 0
  ds_read_b64_tr_b16 a[166:167], v1 offset:25184
  v_mfma_f32_16x16x32_bf16 v[140:143], a[128:131], a[12:15], v[140:143]
  v_mfma_f32_16x16x32_bf16 v[156:159], a[136:139], a[12:15], 0
  buffer_load_dwordx4 a[60:63], v0, s[36:39], s57 offen offset:3072 sc1
  s_add_u32 m0, s84, 61440
  v_mfma_f32_16x16x32_bf16 v[156:159], a[140:143], a[28:31], v[156:159]
  ds_read_b64_tr_b16 a[168:169], v1 offset:14464
  v_mfma_f32_16x16x32_bf16 v[152:155], a[140:143], a[24:27], 0
  ds_read_b64_tr_b16 a[170:171], v1 offset:18048
  v_mfma_f32_16x16x32_bf16 v[152:155], a[136:139], a[8:11], v[152:155]
  v_mfma_f32_16x16x32_bf16 v[148:151], a[136:139], a[4:7], 0
  ds_read_b64_tr_b16 a[172:173], v1 offset:21632
  v_mfma_f32_16x16x32_bf16 v[148:151], a[140:143], a[20:23], v[148:151]
  buffer_load_dwordx4 v7, s[16:19], s56 offen offset:0 lds
  s_bfe_u32 s57, s82, 0x40008
  v_mfma_f32_16x16x32_bf16 v[144:147], a[140:143], a[16:19], 0
  s_lshl_b32 s57, s57, 13
  s_add_u32 s57, s57, s85
  ds_read_b64_tr_b16 a[174:175], v1 offset:25216
  v_mfma_f32_16x16x32_bf16 v[144:147], a[136:139], a[0:3], v[144:147]
  s_waitcnt lgkmcnt(8)
  v_mfma_f32_16x16x32_bf16 v[160:163], a[144:147], a[0:3], 0
  ds_read_b64_tr_b16 a[128:129], v1 offset:14496
  v_mfma_f32_16x16x32_bf16 v[160:163], a[148:151], a[16:19], v[160:163]
  v_mfma_f32_16x16x32_bf16 v[164:167], a[148:151], a[20:23], 0
  buffer_load_dwordx4 a[64:67], v0, s[36:39], s57 offen offset:0 sc1
  v_mfma_f32_16x16x32_bf16 v[164:167], a[144:147], a[4:7], v[164:167]
  ds_read_b64_tr_b16 a[130:131], v1 offset:18080
  v_mfma_f32_16x16x32_bf16 v[168:171], a[144:147], a[8:11], 0
  ds_read_b64_tr_b16 a[132:133], v1 offset:21664
  v_mfma_f32_16x16x32_bf16 v[168:171], a[148:151], a[24:27], v[168:171]
  v_mfma_f32_16x16x32_bf16 v[172:175], a[148:151], a[28:31], 0
  ds_read_b64_tr_b16 a[134:135], v1 offset:25248
  v_mfma_f32_16x16x32_bf16 v[172:175], a[144:147], a[12:15], v[172:175]
  s_waitcnt vmcnt(22)
  s_barrier
  buffer_load_dwordx4 v8, s[16:19], s56 offen offset:1024 lds
  v_mfma_f32_16x16x32_bf16 v[188:191], a[152:155], a[12:15], 0
  ds_read_b64_tr_b16 a[136:137], v1 offset:14528
  v_mfma_f32_16x16x32_bf16 v[188:191], a[156:159], a[28:31], v[188:191]
  v_mfma_f32_16x16x32_bf16 v[184:187], a[156:159], a[24:27], 0
  ds_read_b64_tr_b16 a[138:139], v1 offset:18112
  v_mfma_f32_16x16x32_bf16 v[184:187], a[152:155], a[8:11], v[184:187]
  v_mfma_f32_16x16x32_bf16 v[180:183], a[152:155], a[4:7], 0
  buffer_load_dwordx4 a[68:71], v0, s[36:39], s57 offen offset:1024 sc1
  v_mfma_f32_16x16x32_bf16 v[180:183], a[156:159], a[20:23], v[180:183]
  ds_read_b64_tr_b16 a[140:141], v1 offset:21696
  v_mfma_f32_16x16x32_bf16 v[176:179], a[156:159], a[16:19], 0
  ds_read_b64_tr_b16 a[142:143], v1 offset:25280
  v_mfma_f32_16x16x32_bf16 v[176:179], a[152:155], a[0:3], v[176:179]
  s_waitcnt lgkmcnt(8)
  v_mfma_f32_16x16x32_bf16 v[192:195], a[160:163], a[0:3], 0
  ds_read_b64_tr_b16 a[144:145], v1 offset:28672
  v_mfma_f32_16x16x32_bf16 v[192:195], a[164:167], a[16:19], v[192:195]
  v_mfma_f32_16x16x32_bf16 v[196:199], a[164:167], a[20:23], 0
  ds_read_b64_tr_b16 a[146:147], v1 offset:32256
  v_mfma_f32_16x16x32_bf16 v[196:199], a[160:163], a[4:7], v[196:199]
  v_mfma_f32_16x16x32_bf16 v[200:203], a[160:163], a[8:11], 0
  ds_read_b64_tr_b16 a[148:149], v1 offset:35840
  v_mfma_f32_16x16x32_bf16 v[200:203], a[164:167], a[24:27], v[200:203]
  v_mfma_f32_16x16x32_bf16 v[204:207], a[164:167], a[28:31], 0
  buffer_load_dwordx4 v9, s[16:19], s56 offen offset:2048 lds
  v_mfma_f32_16x16x32_bf16 v[204:207], a[160:163], a[12:15], v[204:207]
  ds_read_b64_tr_b16 a[150:151], v1 offset:39424
  v_mfma_f32_16x16x32_bf16 v[220:223], a[168:171], a[12:15], 0
  ds_read_b64_tr_b16 a[152:153], v1 offset:28704
  v_mfma_f32_16x16x32_bf16 v[220:223], a[172:175], a[28:31], v[220:223]
  v_mfma_f32_16x16x32_bf16 v[216:219], a[172:175], a[24:27], 0
  ds_read_b64_tr_b16 a[154:155], v1 offset:32288
  v_mfma_f32_16x16x32_bf16 v[216:219], a[168:171], a[8:11], v[216:219]
  buffer_load_dwordx4 a[72:75], v0, s[36:39], s57 offen offset:2048 sc1
  v_mfma_f32_16x16x32_bf16 v[212:215], a[168:171], a[4:7], 0
  ds_read_b64_tr_b16 a[156:157], v1 offset:35872
  v_mfma_f32_16x16x32_bf16 v[212:215], a[172:175], a[20:23], v[212:215]
  v_mfma_f32_16x16x32_bf16 v[208:211], a[172:175], a[16:19], 0
  ds_read_b64_tr_b16 a[158:159], v1 offset:39456
  v_mfma_f32_16x16x32_bf16 v[208:211], a[168:171], a[0:3], v[208:211]
  s_waitcnt lgkmcnt(8)
  v_mfma_f32_16x16x32_bf16 v[224:227], a[128:131], a[0:3], 0
  ds_read_b64_tr_b16 a[160:161], v1 offset:28736
  v_mfma_f32_16x16x32_bf16 v[224:227], a[132:135], a[16:19], v[224:227]
  v_mfma_f32_16x16x32_bf16 v[228:231], a[132:135], a[20:23], 0
  ds_read_b64_tr_b16 a[162:163], v1 offset:32320
  v_mfma_f32_16x16x32_bf16 v[228:231], a[128:131], a[4:7], v[228:231]
  v_mfma_f32_16x16x32_bf16 v[232:235], a[128:131], a[8:11], 0
  ds_read_b64_tr_b16 a[164:165], v1 offset:35904
  v_mfma_f32_16x16x32_bf16 v[232:235], a[132:135], a[24:27], v[232:235]
  buffer_load_dwordx4 a[76:79], v0, s[36:39], s57 offen offset:3072 sc1
  v_mfma_f32_16x16x32_bf16 v[236:239], a[132:135], a[28:31], 0
  ds_read_b64_tr_b16 a[166:167], v1 offset:39488
  v_mfma_f32_16x16x32_bf16 v[236:239], a[128:131], a[12:15], v[236:239]
  v_mfma_f32_16x16x32_bf16 v[252:255], a[136:139], a[12:15], 0
  ds_read_b64_tr_b16 a[168:169], v1 offset:28768
  v_mfma_f32_16x16x32_bf16 v[252:255], a[140:143], a[28:31], v[252:255]
  s_bfe_u32 s56, s82, 0x4000c
  s_mul_i32 s56, s56, 458752
  s_add_u32 m0, s84, 86016
  v_mfma_f32_16x16x32_bf16 v[248:251], a[140:143], a[24:27], 0
  ds_read_b64_tr_b16 a[170:171], v1 offset:32352
  v_mfma_f32_16x16x32_bf16 v[248:251], a[136:139], a[8:11], v[248:251]
  v_mfma_f32_16x16x32_bf16 v[244:247], a[136:139], a[4:7], 0
  ds_read_b64_tr_b16 a[172:173], v1 offset:35936
  v_mfma_f32_16x16x32_bf16 v[244:247], a[140:143], a[20:23], v[244:247]
  buffer_load_dwordx4 v3, s[16:19], s56 offen offset:0 lds
  v_mfma_f32_16x16x32_bf16 v[240:243], a[140:143], a[16:19], 0
  ds_read_b64_tr_b16 a[174:175], v1 offset:39520
  v_mfma_f32_16x16x32_bf16 v[240:243], a[136:139], a[0:3], v[240:243]
  s_waitcnt vmcnt(8) lgkmcnt(8)
  v_mfma_f32_16x16x32_bf16 v[32:35], a[144:147], a[32:35], v[32:35]
  s_add_u32 s57, s57, 4096
  ds_read_b64_tr_b16 a[128:129], v1 offset:28800
  v_mfma_f32_16x16x32_bf16 v[32:35], a[148:151], a[48:51], v[32:35]
  v_mfma_f32_16x16x32_bf16 v[36:39], a[148:151], a[52:55], v[36:39]
  ds_read_b64_tr_b16 a[130:131], v1 offset:32384
  v_mfma_f32_16x16x32_bf16 v[36:39], a[144:147], a[36:39], v[36:39]
  v_mfma_f32_16x16x32_bf16 v[40:43], a[144:147], a[40:43], v[40:43]
  buffer_load_dwordx4 a[80:83], v0, s[36:39], s57 offen offset:0 sc1
  v_mfma_f32_16x16x32_bf16 v[40:43], a[148:151], a[56:59], v[40:43]
  ds_read_b64_tr_b16 a[132:133], v1 offset:35968
  v_mfma_f32_16x16x32_bf16 v[44:47], a[148:151], a[60:63], v[44:47]
  ds_read_b64_tr_b16 a[134:135], v1 offset:39552
  v_mfma_f32_16x16x32_bf16 v[44:47], a[144:147], a[44:47], v[44:47]
  v_mfma_f32_16x16x32_bf16 v[60:63], a[152:155], a[44:47], v[60:63]
  ds_read_b64_tr_b16 a[136:137], v1 offset:28832
  v_mfma_f32_16x16x32_bf16 v[60:63], a[156:159], a[60:63], v[60:63]
  v_mfma_f32_16x16x32_bf16 v[56:59], a[156:159], a[56:59], v[56:59]
  ds_read_b64_tr_b16 a[138:139], v1 offset:32416
  v_mfma_f32_16x16x32_bf16 v[56:59], a[152:155], a[40:43], v[56:59]
  buffer_load_dwordx4 v4, s[16:19], s56 offen offset:1024 lds
  v_mfma_f32_16x16x32_bf16 v[52:55], a[152:155], a[36:39], v[52:55]
  ds_read_b64_tr_b16 a[140:141], v1 offset:36000
  v_mfma_f32_16x16x32_bf16 v[52:55], a[156:159], a[52:55], v[52:55]
  v_mfma_f32_16x16x32_bf16 v[48:51], a[156:159], a[48:51], v[48:51]
  ds_read_b64_tr_b16 a[142:143], v1 offset:39584
  v_mfma_f32_16x16x32_bf16 v[48:51], a[152:155], a[32:35], v[48:51]
  s_waitcnt lgkmcnt(8)
  v_mfma_f32_16x16x32_bf16 v[64:67], a[160:163], a[32:35], v[64:67]
  ds_read_b64_tr_b16 a[144:145], v1 offset:28864
  v_mfma_f32_16x16x32_bf16 v[64:67], a[164:167], a[48:51], v[64:67]
  v_mfma_f32_16x16x32_bf16 v[68:71], a[164:167], a[52:55], v[68:71]
  ds_read_b64_tr_b16 a[146:147], v1 offset:32448
  v_mfma_f32_16x16x32_bf16 v[68:71], a[160:163], a[36:39], v[68:71]
  buffer_load_dwordx4 a[84:87], v0, s[36:39], s57 offen offset:1024 sc1
  v_mfma_f32_16x16x32_bf16 v[72:75], a[160:163], a[40:43], v[72:75]
  ds_read_b64_tr_b16 a[148:149], v1 offset:36032
  v_mfma_f32_16x16x32_bf16 v[72:75], a[164:167], a[56:59], v[72:75]
  v_mfma_f32_16x16x32_bf16 v[76:79], a[164:167], a[60:63], v[76:79]
  ds_read_b64_tr_b16 a[150:151], v1 offset:39616
  v_mfma_f32_16x16x32_bf16 v[76:79], a[160:163], a[44:47], v[76:79]
  v_mfma_f32_16x16x32_bf16 v[92:95], a[168:171], a[44:47], v[92:95]
  ds_read_b64_tr_b16 a[152:153], v1 offset:43008
  v_mfma_f32_16x16x32_bf16 v[92:95], a[172:175], a[60:63], v[92:95]
  v_mfma_f32_16x16x32_bf16 v[88:91], a[172:175], a[56:59], v[88:91]
  buffer_load_dwordx4 v5, s[16:19], s56 offen offset:2048 lds
  v_mfma_f32_16x16x32_bf16 v[88:91], a[168:171], a[40:43], v[88:91]
  ds_read_b64_tr_b16 a[154:155], v1 offset:46592
  v_mfma_f32_16x16x32_bf16 v[84:87], a[168:171], a[36:39], v[84:87]
  ds_read_b64_tr_b16 a[156:157], v1 offset:50176
  v_mfma_f32_16x16x32_bf16 v[84:87], a[172:175], a[52:55], v[84:87]
  v_mfma_f32_16x16x32_bf16 v[80:83], a[172:175], a[48:51], v[80:83]
  ds_read_b64_tr_b16 a[158:159], v1 offset:53760
  v_mfma_f32_16x16x32_bf16 v[80:83], a[168:171], a[32:35], v[80:83]
  s_waitcnt lgkmcnt(8)
  v_mfma_f32_16x16x32_bf16 v[96:99], a[128:131], a[32:35], v[96:99]
  ds_read_b64_tr_b16 a[160:161], v1 offset:43040
  v_mfma_f32_16x16x32_bf16 v[96:99], a[132:135], a[48:51], v[96:99]
  v_mfma_f32_16x16x32_bf16 v[100:103], a[132:135], a[52:55], v[100:103]
  buffer_load_dwordx4 a[88:91], v0, s[36:39], s57 offen offset:2048 sc1
  v_mfma_f32_16x16x32_bf16 v[100:103], a[128:131], a[36:39], v[100:103]
  ds_read_b64_tr_b16 a[162:163], v1 offset:46624
  v_mfma_f32_16x16x32_bf16 v[104:107], a[128:131], a[40:43], v[104:107]
  ds_read_b64_tr_b16 a[164:165], v1 offset:50208
  v_mfma_f32_16x16x32_bf16 v[104:107], a[132:135], a[56:59], v[104:107]
  v_mfma_f32_16x16x32_bf16 v[108:111], a[132:135], a[60:63], v[108:111]
  ds_read_b64_tr_b16 a[166:167], v1 offset:53792
  v_mfma_f32_16x16x32_bf16 v[108:111], a[128:131], a[44:47], v[108:111]
  v_mfma_f32_16x16x32_bf16 v[124:127], a[136:139], a[44:47], v[124:127]
  ds_read_b64_tr_b16 a[168:169], v1 offset:43072
  v_mfma_f32_16x16x32_bf16 v[124:127], a[140:143], a[60:63], v[124:127]
  buffer_load_dwordx4 v6, s[16:19], s56 offen offset:3072 lds
  v_mfma_f32_16x16x32_bf16 v[120:123], a[140:143], a[56:59], v[120:123]
  ds_read_b64_tr_b16 a[170:171], v1 offset:46656
  v_mfma_f32_16x16x32_bf16 v[120:123], a[136:139], a[40:43], v[120:123]
  v_mfma_f32_16x16x32_bf16 v[116:119], a[136:139], a[36:39], v[116:119]
  ds_read_b64_tr_b16 a[172:173], v1 offset:50240
  v_mfma_f32_16x16x32_bf16 v[116:119], a[140:143], a[52:55], v[116:119]
  v_mfma_f32_16x16x32_bf16 v[112:115], a[140:143], a[48:51], v[112:115]
  ds_read_b64_tr_b16 a[174:175], v1 offset:53824
  v_mfma_f32_16x16x32_bf16 v[112:115], a[136:139], a[32:35], v[112:115]
  s_waitcnt lgkmcnt(8)
  v_mfma_f32_16x16x32_bf16 v[128:131], a[144:147], a[32:35], v[128:131]
  ds_read_b64_tr_b16 a[128:129], v1 offset:43104
  v_mfma_f32_16x16x32_bf16 v[128:131], a[148:151], a[48:51], v[128:131]
  buffer_load_dwordx4 a[92:95], v0, s[36:39], s57 offen offset:3072 sc1
  v_mfma_f32_16x16x32_bf16 v[132:135], a[148:151], a[52:55], v[132:135]
Hb0:
  s_cbranch_execz Hb0_1
  ds_read_b64_tr_b16 a[130:131], v1 offset:46688
  v_mfma_f32_16x16x32_bf16 v[132:135], a[144:147], a[36:39], v[132:135]
  v_mfma_f32_16x16x32_bf16 v[136:139], a[144:147], a[40:43], v[136:139]
  s_add_u32 m0, s84, 90112
  ds_read_b64_tr_b16 a[132:133], v1 offset:50272
  v_mfma_f32_16x16x32_bf16 v[136:139], a[148:151], a[56:59], v[136:139]
  v_mfma_f32_16x16x32_bf16 v[140:143], a[148:151], a[60:63], v[140:143]
  ds_read_b64_tr_b16 a[134:135], v1 offset:53856
  v_mfma_f32_16x16x32_bf16 v[140:143], a[144:147], a[44:47], v[140:143]
  v_mfma_f32_16x16x32_bf16 v[156:159], a[152:155], a[44:47], v[156:159]
  buffer_load_dwordx4 v7, s[16:19], s56 offen offset:0 lds
  s_bfe_u32 s57, s82, 0x4000c
  v_mfma_f32_16x16x32_bf16 v[156:159], a[156:159], a[60:63], v[156:159]
  s_lshl_b32 s57, s57, 13
  s_add_u32 s57, s57, s85
  ds_read_b64_tr_b16 a[136:137], v1 offset:43136
  v_mfma_f32_16x16x32_bf16 v[152:155], a[156:159], a[56:59], v[152:155]
  ds_read_b64_tr_b16 a[138:139], v1 offset:46720
  v_mfma_f32_16x16x32_bf16 v[152:155], a[152:155], a[40:43], v[152:155]
  v_mfma_f32_16x16x32_bf16 v[148:151], a[152:155], a[36:39], v[148:151]
  ds_read_b64_tr_b16 a[140:141], v1 offset:50304
  v_mfma_f32_16x16x32_bf16 v[148:151], a[156:159], a[52:55], v[148:151]
  buffer_load_dwordx4 a[96:99], v0, s[36:39], s57 offen offset:0 sc1
  v_mfma_f32_16x16x32_bf16 v[144:147], a[156:159], a[48:51], v[144:147]
  ds_read_b64_tr_b16 a[142:143], v1 offset:53888
  v_mfma_f32_16x16x32_bf16 v[144:147], a[152:155], a[32:35], v[144:147]
  s_waitcnt lgkmcnt(8)
  v_mfma_f32_16x16x32_bf16 v[160:163], a[160:163], a[32:35], v[160:163]
  ds_read_b64_tr_b16 a[144:145], v1 offset:43168
  v_mfma_f32_16x16x32_bf16 v[160:163], a[164:167], a[48:51], v[160:163]
  v_mfma_f32_16x16x32_bf16 v[164:167], a[164:167], a[52:55], v[164:167]
  ds_read_b64_tr_b16 a[146:147], v1 offset:46752
  v_mfma_f32_16x16x32_bf16 v[164:167], a[160:163], a[36:39], v[164:167]
  v_mfma_f32_16x16x32_bf16 v[168:171], a[160:163], a[40:43], v[168:171]
  ds_read_b64_tr_b16 a[148:149], v1 offset:50336
  v_mfma_f32_16x16x32_bf16 v[168:171], a[164:167], a[56:59], v[168:171]
  v_mfma_f32_16x16x32_bf16 v[172:175], a[164:167], a[60:63], v[172:175]
  ds_read_b64_tr_b16 a[150:151], v1 offset:53920
  v_mfma_f32_16x16x32_bf16 v[172:175], a[160:163], a[44:47], v[172:175]
  s_waitcnt vmcnt(12)
  s_barrier
  buffer_load_dwordx4 v8, s[16:19], s56 offen offset:1024 lds
  v_mfma_f32_16x16x32_bf16 v[188:191], a[168:171], a[44:47], v[188:191]
  ds_read_b64_tr_b16 a[152:153], v1 offset:43200
  v_mfma_f32_16x16x32_bf16 v[188:191], a[172:175], a[60:63], v[188:191]
  v_mfma_f32_16x16x32_bf16 v[184:187], a[172:175], a[56:59], v[184:187]
  ds_read_b64_tr_b16 a[154:155], v1 offset:46784
  v_mfma_f32_16x16x32_bf16 v[184:187], a[168:171], a[40:43], v[184:187]
  v_mfma_f32_16x16x32_bf16 v[180:183], a[168:171], a[36:39], v[180:183]
  buffer_load_dwordx4 a[100:103], v0, s[36:39], s57 offen offset:1024 sc1
  v_mfma_f32_16x16x32_bf16 v[180:183], a[172:175], a[52:55], v[180:183]
  ds_read_b64_tr_b16 a[156:157], v1 offset:50368
  v_mfma_f32_16x16x32_bf16 v[176:179], a[172:175], a[48:51], v[176:179]
  ds_read_b64_tr_b16 a[158:159], v1 offset:53952
  v_mfma_f32_16x16x32_bf16 v[176:179], a[168:171], a[32:35], v[176:179]
  s_waitcnt lgkmcnt(8)
  v_mfma_f32_16x16x32_bf16 v[192:195], a[128:131], a[32:35], v[192:195]
  ds_read_b64_tr_b16 a[160:161], v2 offset:0
  v_mfma_f32_16x16x32_bf16 v[192:195], a[132:135], a[48:51], v[192:195]
  v_mfma_f32_16x16x32_bf16 v[196:199], a[132:135], a[52:55], v[196:199]
  ds_read_b64_tr_b16 a[162:163], v2 offset:3584
  v_mfma_f32_16x16x32_bf16 v[196:199], a[128:131], a[36:39], v[196:199]
  v_mfma_f32_16x16x32_bf16 v[200:203], a[128:131], a[40:43], v[200:203]
  ds_read_b64_tr_b16 a[164:165], v2 offset:7168
  v_mfma_f32_16x16x32_bf16 v[200:203], a[132:135], a[56:59], v[200:203]
  v_mfma_f32_16x16x32_bf16 v[204:207], a[132:135], a[60:63], v[204:207]
  buffer_load_dwordx4 v9, s[16:19], s56 offen offset:2048 lds
  v_mfma_f32_16x16x32_bf16 v[204:207], a[128:131], a[44:47], v[204:207]
  ds_read_b64_tr_b16 a[166:167], v2 offset:10752
  v_mfma_f32_16x16x32_bf16 v[220:223], a[136:139], a[44:47], v[220:223]
  ds_read_b64_tr_b16 a[168:169], v2 offset:32
  v_mfma_f32_16x16x32_bf16 v[220:223], a[140:143], a[60:63], v[220:223]
  v_mfma_f32_16x16x32_bf16 v[216:219], a[140:143], a[56:59], v[216:219]
  ds_read_b64_tr_b16 a[170:171], v2 offset:3616
  v_mfma_f32_16x16x32_bf16 v[216:219], a[136:139], a[40:43], v[216:219]
  buffer_load_dwordx4 a[104:107], v0, s[36:39], s57 offen offset:2048 sc1
  v_mfma_f32_16x16x32_bf16 v[212:215], a[136:139], a[36:39], v[212:215]
  ds_read_b64_tr_b16 a[172:173], v2 offset:7200
  v_mfma_f32_16x16x32_bf16 v[212:215], a[140:143], a[52:55], v[212:215]
  v_mfma_f32_16x16x32_bf16 v[208:211], a[140:143], a[48:51], v[208:211]
  ds_read_b64_tr_b16 a[174:175], v2 offset:10784
  v_mfma_f32_16x16x32_bf16 v[208:211], a[136:139], a[32:35], v[208:211]
  s_waitcnt lgkmcnt(8)
  v_mfma_f32_16x16x32_bf16 v[224:227], a[144:147], a[32:35], v[224:227]
  ds_read_b64_tr_b16 a[128:129], v2 offset:64
  v_mfma_f32_16x16x32_bf16 v[224:227], a[148:151], a[48:51], v[224:227]
  v_mfma_f32_16x16x32_bf16 v[228:231], a[148:151], a[52:55], v[228:231]
  ds_read_b64_tr_b16 a[130:131], v2 offset:3648
  v_mfma_f32_16x16x32_bf16 v[228:231], a[144:147], a[36:39], v[228:231]
  v_mfma_f32_16x16x32_bf16 v[232:235], a[144:147], a[40:43], v[232:235]
  ds_read_b64_tr_b16 a[132:133], v2 offset:7232
  v_mfma_f32_16x16x32_bf16 v[232:235], a[148:151], a[56:59], v[232:235]
  buffer_load_dwordx4 a[108:111], v0, s[36:39], s57 offen offset:3072 sc1
  v_mfma_f32_16x16x32_bf16 v[236:239], a[148:151], a[60:63], v[236:239]
  ds_read_b64_tr_b16 a[134:135], v2 offset:10816
  v_mfma_f32_16x16x32_bf16 v[236:239], a[144:147], a[44:47], v[236:239]
  v_mfma_f32_16x16x32_bf16 v[252:255], a[152:155], a[44:47], v[252:255]
  ds_read_b64_tr_b16 a[136:137], v2 offset:96
  v_mfma_f32_16x16x32_bf16 v[252:255], a[156:159], a[60:63], v[252:255]
  s_bfe_u32 s56, s82, 0x40010
  s_mul_i32 s56, s56, 458752
  s_add_u32 m0, s84, 0
  v_mfma_f32_16x16x32_bf16 v[248:251], a[156:159], a[56:59], v[248:251]
  ds_read_b64_tr_b16 a[138:139], v2 offset:3680
  v_mfma_f32_16x16x32_bf16 v[248:251], a[152:155], a[40:43], v[248:251]
  v_mfma_f32_16x16x32_bf16 v[244:247], a[152:155], a[36:39], v[244:247]
  ds_read_b64_tr_b16 a[140:141], v2 offset:7264
  v_mfma_f32_16x16x32_bf16 v[244:247], a[156:159], a[52:55], v[244:247]
  buffer_load_dwordx4 v3, s[16:19], s56 offen offset:0 lds
  v_mfma_f32_16x16x32_bf16 v[240:243], a[156:159], a[48:51], v[240:243]
  ds_read_b64_tr_b16 a[142:143], v2 offset:10848
  v_mfma_f32_16x16x32_bf16 v[240:243], a[152:155], a[32:35], v[240:243]
  s_waitcnt vmcnt(8) lgkmcnt(8)
  v_mfma_f32_16x16x32_bf16 v[32:35], a[160:163], a[64:67], v[32:35]
  s_add_u32 s57, s57, 4096
  ds_read_b64_tr_b16 a[144:145], v2 offset:128
  v_mfma_f32_16x16x32_bf16 v[32:35], a[164:167], a[80:83], v[32:35]
  v_mfma_f32_16x16x32_bf16 v[36:39], a[164:167], a[84:87], v[36:39]
  ds_read_b64_tr_b16 a[146:147], v2 offset:3712
  v_mfma_f32_16x16x32_bf16 v[36:39], a[160:163], a[68:71], v[36:39]
  v_mfma_f32_16x16x32_bf16 v[40:43], a[160:163], a[72:75], v[40:43]
  buffer_load_dwordx4 a[112:115], v0, s[36:39], s57 offen offset:0 sc1
  v_mfma_f32_16x16x32_bf16 v[40:43], a[164:167], a[88:91], v[40:43]
  ds_read_b64_tr_b16 a[148:149], v2 offset:7296
  v_mfma_f32_16x16x32_bf16 v[44:47], a[164:167], a[92:95], v[44:47]
  ds_read_b64_tr_b16 a[150:151], v2 offset:10880
  v_mfma_f32_16x16x32_bf16 v[44:47], a[160:163], a[76:79], v[44:47]
  v_mfma_f32_16x16x32_bf16 v[60:63], a[168:171], a[76:79], v[60:63]
  ds_read_b64_tr_b16 a[152:153], v2 offset:160
  v_mfma_f32_16x16x32_bf16 v[60:63], a[172:175], a[92:95], v[60:63]
  v_mfma_f32_16x16x32_bf16 v[56:59], a[172:175], a[88:91], v[56:59]
  ds_read_b64_tr_b16 a[154:155], v2 offset:3744
  v_mfma_f32_16x16x32_bf16 v[56:59], a[168:171], a[72:75], v[56:59]
  buffer_load_dwordx4 v4, s[16:19], s56 offen offset:1024 lds
  v_mfma_f32_16x16x32_bf16 v[52:55], a[168:171], a[68:71], v[52:55]
  ds_read_b64_tr_b16 a[156:157], v2 offset:7328
  v_mfma_f32_16x16x32_bf16 v[52:55], a[172:175], a[84:87], v[52:55]
  v_mfma_f32_16x16x32_bf16 v[48:51], a[172:175], a[80:83], v[48:51]
  ds_read_b64_tr_b16 a[158:159], v2 offset:10912
  v_mfma_f32_16x16x32_bf16 v[48:51], a[168:171], a[64:67], v[48:51]
  s_waitcnt lgkmcnt(8)
  v_mfma_f32_16x16x32_bf16 v[64:67], a[128:131], a[64:67], v[64:67]
  ds_read_b64_tr_b16 a[160:161], v2 offset:192
  v_mfma_f32_16x16x32_bf16 v[64:67], a[132:135], a[80:83], v[64:67]
  v_mfma_f32_16x16x32_bf16 v[68:71], a[132:135], a[84:87], v[68:71]
  ds_read_b64_tr_b16 a[162:163], v2 offset:3776
  v_mfma_f32_16x16x32_bf16 v[68:71], a[128:131], a[68:71], v[68:71]
  buffer_load_dwordx4 a[116:119], v0, s[36:39], s57 offen offset:1024 sc1
  v_mfma_f32_16x16x32_bf16 v[72:75], a[128:131], a[72:75], v[72:75]
  ds_read_b64_tr_b16 a[164:165], v2 offset:7360
  v_mfma_f32_16x16x32_bf16 v[72:75], a[132:135], a[88:91], v[72:75]
  v_mfma_f32_16x16x32_bf16 v[76:79], a[132:135], a[92:95], v[76:79]
  ds_read_b64_tr_b16 a[166:167], v2 offset:10944
  v_mfma_f32_16x16x32_bf16 v[76:79], a[128:131], a[76:79], v[76:79]
  v_mfma_f32_16x16x32_bf16 v[92:95], a[136:139], a[76:79], v[92:95]
  ds_read_b64_tr_b16 a[168:169], v2 offset:14336
  v_mfma_f32_16x16x32_bf16 v[92:95], a[140:143], a[92:95], v[92:95]
  v_mfma_f32_16x16x32_bf16 v[88:91], a[140:143], a[88:91], v[88:91]
  buffer_load_dwordx4 v5, s[16:19], s56 offen offset:2048 lds
  v_mfma_f32_16x16x32_bf16 v[88:91], a[136:139], a[72:75], v[88:91]
  ds_read_b64_tr_b16 a[170:171], v2 offset:17920
  v_mfma_f32_16x16x32_bf16 v[84:87], a[136:139], a[68:71], v[84:87]
  ds_read_b64_tr_b16 a[172:173], v2 offset:21504
  v_mfma_f32_16x16x32_bf16 v[84:87], a[140:143], a[84:87], v[84:87]
  v_mfma_f32_16x16x32_bf16 v[80:83], a[140:143], a[80:83], v[80:83]
  ds_read_b64_tr_b16 a[174:175], v2 offset:25088
  v_mfma_f32_16x16x32_bf16 v[80:83], a[136:139], a[64:67], v[80:83]
  s_waitcnt lgkmcnt(8)
  v_mfma_f32_16x16x32_bf16 v[96:99], a[144:147], a[64:67], v[96:99]
  ds_read_b64_tr_b16 a[128:129], v2 offset:14368
  v_mfma_f32_16x16x32_bf16 v[96:99], a[148:151], a[80:83], v[96:99]
  v_mfma_f32_16x16x32_bf16 v[100:103], a[148:151], a[84:87], v[100:103]
  buffer_load_dwordx4 a[120:123], v0, s[36:39], s57 offen offset:2048 sc1
  v_mfma_f32_16x16x32_bf16 v[100:103], a[144:147], a[68:71], v[100:103]
  ds_read_b64_tr_b16 a[130:131], v2 offset:17952
  v_mfma_f32_16x16x32_bf16 v[104:107], a[144:147], a[72:75], v[104:107]
  ds_read_b64_tr_b16 a[132:133], v2 offset:21536
  v_mfma_f32_16x16x32_bf16 v[104:107], a[148:151], a[88:91], v[104:107]
  v_mfma_f32_16x16x32_bf16 v[108:111], a[148:151], a[92:95], v[108:111]
  ds_read_b64_tr_b16 a[134:135], v2 offset:25120
  v_mfma_f32_16x16x32_bf16 v[108:111], a[144:147], a[76:79], v[108:111]
  v_mfma_f32_16x16x32_bf16 v[124:127], a[152:155], a[76:79], v[124:127]
  ds_read_b64_tr_b16 a[136:137], v2 offset:14400
  v_mfma_f32_16x16x32_bf16 v[124:127], a[156:159], a[92:95], v[124:127]
  buffer_load_dwordx4 v6, s[16:19], s56 offen offset:3072 lds
  v_mfma_f32_16x16x32_bf16 v[120:123], a[156:159], a[88:91], v[120:123]
  ds_read_b64_tr_b16 a[138:139], v2 offset:17984
  v_mfma_f32_16x16x32_bf16 v[120:123], a[152:155], a[72:75], v[120:123]
  v_mfma_f32_16x16x32_bf16 v[116:119], a[152:155], a[68:71], v[116:119]
  ds_read_b64_tr_b16 a[140:141], v2 offset:21568
  v_mfma_f32_16x16x32_bf16 v[116:119], a[156:159], a[84:87], v[116:119]
  v_mfma_f32_16x16x32_bf16 v[112:115], a[156:159], a[80:83], v[112:115]
  ds_read_b64_tr_b16 a[142:143], v2 offset:25152
  v_mfma_f32_16x16x32_bf16 v[112:115], a[152:155], a[64:67], v[112:115]
  s_waitcnt lgkmcnt(8)
  v_mfma_f32_16x16x32_bf16 v[128:131], a[160:163], a[64:67], v[128:131]
  ds_read_b64_tr_b16 a[144:145], v2 offset:14432
  v_mfma_f32_16x16x32_bf16 v[128:131], a[164:167], a[80:83], v[128:131]
  buffer_load_dwordx4 a[124:127], v0, s[36:39], s57 offen offset:3072 sc1
  v_mfma_f32_16x16x32_bf16 v[132:135], a[164:167], a[84:87], v[132:135]
  ds_read_b64_tr_b16 a[146:147], v2 offset:18016
  v_mfma_f32_16x16x32_bf16 v[132:135], a[160:163], a[68:71], v[132:135]
  v_mfma_f32_16x16x32_bf16 v[136:139], a[160:163], a[72:75], v[136:139]
  s_add_u32 m0, s84, 4096
  ds_read_b64_tr_b16 a[148:149], v2 offset:21600
  v_mfma_f32_16x16x32_bf16 v[136:139], a[164:167], a[88:91], v[136:139]
  v_mfma_f32_16x16x32_bf16 v[140:143], a[164:167], a[92:95], v[140:143]
  ds_read_b64_tr_b16 a[150:151], v2 offset:25184
  v_mfma_f32_16x16x32_bf16 v[140:143], a[160:163], a[76:79], v[140:143]
  v_mfma_f32_16x16x32_bf16 v[156:159], a[168:171], a[76:79], v[156:159]
  buffer_load_dwordx4 v7, s[16:19], s56 offen offset:0 lds
  s_bfe_u32 s57, s82, 0x40010
  v_mfma_f32_16x16x32_bf16 v[156:159], a[172:175], a[92:95], v[156:159]
  s_lshl_b32 s57, s57, 13
  s_add_u32 s57, s57, s85
  ds_read_b64_tr_b16 a[152:153], v2 offset:14464
  v_mfma_f32_16x16x32_bf16 v[152:155], a[172:175], a[88:91], v[152:155]
  ds_read_b64_tr_b16 a[154:155], v2 offset:18048
  v_mfma_f32_16x16x32_bf16 v[152:155], a[168:171], a[72:75], v[152:155]
  v_mfma_f32_16x16x32_bf16 v[148:151], a[168:171], a[68:71], v[148:151]
  ds_read_b64_tr_b16 a[156:157], v2 offset:21632
  v_mfma_f32_16x16x32_bf16 v[148:151], a[172:175], a[84:87], v[148:151]
  buffer_load_dwordx4 a[0:3], v0, s[36:39], s57 offen offset:0 sc1
  v_mfma_f32_16x16x32_bf16 v[144:147], a[172:175], a[80:83], v[144:147]
  ds_read_b64_tr_b16 a[158:159], v2 offset:25216
  v_mfma_f32_16x16x32_bf16 v[144:147], a[168:171], a[64:67], v[144:147]
  s_waitcnt lgkmcnt(8)
  v_mfma_f32_16x16x32_bf16 v[160:163], a[128:131], a[64:67], v[160:163]
  ds_read_b64_tr_b16 a[160:161], v2 offset:14496
  v_mfma_f32_16x16x32_bf16 v[160:163], a[132:135], a[80:83], v[160:163]
  v_mfma_f32_16x16x32_bf16 v[164:167], a[132:135], a[84:87], v[164:167]
  ds_read_b64_tr_b16 a[162:163], v2 offset:18080
  v_mfma_f32_16x16x32_bf16 v[164:167], a[128:131], a[68:71], v[164:167]
  v_mfma_f32_16x16x32_bf16 v[168:171], a[128:131], a[72:75], v[168:171]
  ds_read_b64_tr_b16 a[164:165], v2 offset:21664
  v_mfma_f32_16x16x32_bf16 v[168:171], a[132:135], a[88:91], v[168:171]
  v_mfma_f32_16x16x32_bf16 v[172:175], a[132:135], a[92:95], v[172:175]
  ds_read_b64_tr_b16 a[166:167], v2 offset:25248
  v_mfma_f32_16x16x32_bf16 v[172:175], a[128:131], a[76:79], v[172:175]
  s_waitcnt vmcnt(12)
  s_barrier
  buffer_load_dwordx4 v8, s[16:19], s56 offen offset:1024 lds
  v_mfma_f32_16x16x32_bf16 v[188:191], a[136:139], a[76:79], v[188:191]
  ds_read_b64_tr_b16 a[168:169], v2 offset:14528
  v_mfma_f32_16x16x32_bf16 v[188:191], a[140:143], a[92:95], v[188:191]
  v_mfma_f32_16x16x32_bf16 v[184:187], a[140:143], a[88:91], v[184:187]
  ds_read_b64_tr_b16 a[170:171], v2 offset:18112
  v_mfma_f32_16x16x32_bf16 v[184:187], a[136:139], a[72:75], v[184:187]
  v_mfma_f32_16x16x32_bf16 v[180:183], a[136:139], a[68:71], v[180:183]
  buffer_load_dwordx4 a[4:7], v0, s[36:39], s57 offen offset:1024 sc1
  v_mfma_f32_16x16x32_bf16 v[180:183], a[140:143], a[84:87], v[180:183]
  ds_read_b64_tr_b16 a[172:173], v2 offset:21696
  v_mfma_f32_16x16x32_bf16 v[176:179], a[140:143], a[80:83], v[176:179]
  ds_read_b64_tr_b16 a[174:175], v2 offset:25280
  v_mfma_f32_16x16x32_bf16 v[176:179], a[136:139], a[64:67], v[176:179]
  s_waitcnt lgkmcnt(8)
  v_mfma_f32_16x16x32_bf16 v[192:195], a[144:147], a[64:67], v[192:195]
  ds_read_b64_tr_b16 a[128:129], v2 offset:28672
  v_mfma_f32_16x16x32_bf16 v[192:195], a[148:151], a[80:83], v[192:195]
  v_mfma_f32_16x16x32_bf16 v[196:199], a[148:151], a[84:87], v[196:199]
  ds_read_b64_tr_b16 a[130:131], v2 offset:32256
  v_mfma_f32_16x16x32_bf16 v[196:199], a[144:147], a[68:71], v[196:199]
  v_mfma_f32_16x16x32_bf16 v[200:203], a[144:147], a[72:75], v[200:203]
  ds_read_b64_tr_b16 a[132:133], v2 offset:35840
  v_mfma_f32_16x16x32_bf16 v[200:203], a[148:151], a[88:91], v[200:203]
  v_mfma_f32_16x16x32_bf16 v[204:207], a[148:151], a[92:95], v[204:207]
  buffer_load_dwordx4 v9, s[16:19], s56 offen offset:2048 lds
  v_mfma_f32_16x16x32_bf16 v[204:207], a[144:147], a[76:79], v[204:207]
  ds_read_b64_tr_b16 a[134:135], v2 offset:39424
  v_mfma_f32_16x16x32_bf16 v[220:223], a[152:155], a[76:79], v[220:223]
  ds_read_b64_tr_b16 a[136:137], v2 offset:28704
  v_mfma_f32_16x16x32_bf16 v[220:223], a[156:159], a[92:95], v[220:223]
  v_mfma_f32_16x16x32_bf16 v[216:219], a[156:159], a[88:91], v[216:219]
  ds_read_b64_tr_b16 a[138:139], v2 offset:32288
  v_mfma_f32_16x16x32_bf16 v[216:219], a[152:155], a[72:75], v[216:219]
  buffer_load_dwordx4 a[8:11], v0, s[36:39], s57 offen offset:2048 sc1
  v_mfma_f32_16x16x32_bf16 v[212:215], a[152:155], a[68:71], v[212:215]
  ds_read_b64_tr_b16 a[140:141], v2 offset:35872
  v_mfma_f32_16x16x32_bf16 v[212:215], a[156:159], a[84:87], v[212:215]
  v_mfma_f32_16x16x32_bf16 v[208:211], a[156:159], a[80:83], v[208:211]
  ds_read_b64_tr_b16 a[142:143], v2 offset:39456
  v_mfma_f32_16x16x32_bf16 v[208:211], a[152:155], a[64:67], v[208:211]
  s_waitcnt lgkmcnt(8)
  v_mfma_f32_16x16x32_bf16 v[224:227], a[160:163], a[64:67], v[224:227]
  ds_read_b64_tr_b16 a[144:145], v2 offset:28736
  v_mfma_f32_16x16x32_bf16 v[224:227], a[164:167], a[80:83], v[224:227]
  v_mfma_f32_16x16x32_bf16 v[228:231], a[164:167], a[84:87], v[228:231]
  ds_read_b64_tr_b16 a[146:147], v2 offset:32320
  v_mfma_f32_16x16x32_bf16 v[228:231], a[160:163], a[68:71], v[228:231]
  v_mfma_f32_16x16x32_bf16 v[232:235], a[160:163], a[72:75], v[232:235]
  ds_read_b64_tr_b16 a[148:149], v2 offset:35904
  v_mfma_f32_16x16x32_bf16 v[232:235], a[164:167], a[88:91], v[232:235]
  buffer_load_dwordx4 a[12:15], v0, s[36:39], s57 offen offset:3072 sc1
  v_mfma_f32_16x16x32_bf16 v[236:239], a[164:167], a[92:95], v[236:239]
  ds_read_b64_tr_b16 a[150:151], v2 offset:39488
  v_mfma_f32_16x16x32_bf16 v[236:239], a[160:163], a[76:79], v[236:239]
  v_mfma_f32_16x16x32_bf16 v[252:255], a[168:171], a[76:79], v[252:255]
  ds_read_b64_tr_b16 a[152:153], v2 offset:28768
  v_mfma_f32_16x16x32_bf16 v[252:255], a[172:175], a[92:95], v[252:255]
  s_bfe_u32 s56, s82, 0x40014
  s_mul_i32 s56, s56, 458752
  s_add_u32 m0, s84, 28672
  v_mfma_f32_16x16x32_bf16 v[248:251], a[172:175], a[88:91], v[248:251]
  ds_read_b64_tr_b16 a[154:155], v2 offset:32352
  v_mfma_f32_16x16x32_bf16 v[248:251], a[168:171], a[72:75], v[248:251]
  v_mfma_f32_16x16x32_bf16 v[244:247], a[168:171], a[68:71], v[244:247]
  ds_read_b64_tr_b16 a[156:157], v2 offset:35936
  v_mfma_f32_16x16x32_bf16 v[244:247], a[172:175], a[84:87], v[244:247]
  buffer_load_dwordx4 v3, s[16:19], s56 offen offset:0 lds
  v_mfma_f32_16x16x32_bf16 v[240:243], a[172:175], a[80:83], v[240:243]
  ds_read_b64_tr_b16 a[158:159], v2 offset:39520
  v_mfma_f32_16x16x32_bf16 v[240:243], a[168:171], a[64:67], v[240:243]
  s_waitcnt vmcnt(8) lgkmcnt(8)
  v_mfma_f32_16x16x32_bf16 v[32:35], a[128:131], a[96:99], v[32:35]
  s_add_u32 s57, s57, 4096
  ds_read_b64_tr_b16 a[160:161], v2 offset:28800
  v_mfma_f32_16x16x32_bf16 v[32:35], a[132:135], a[112:115], v[32:35]
  v_mfma_f32_16x16x32_bf16 v[36:39], a[132:135], a[116:119], v[36:39]
  ds_read_b64_tr_b16 a[162:163], v2 offset:32384
  v_mfma_f32_16x16x32_bf16 v[36:39], a[128:131], a[100:103], v[36:39]
  v_mfma_f32_16x16x32_bf16 v[40:43], a[128:131], a[104:107], v[40:43]
  buffer_load_dwordx4 a[16:19], v0, s[36:39], s57 offen offset:0 sc1
  v_mfma_f32_16x16x32_bf16 v[40:43], a[132:135], a[120:123], v[40:43]
  ds_read_b64_tr_b16 a[164:165], v2 offset:35968
  v_mfma_f32_16x16x32_bf16 v[44:47], a[132:135], a[124:127], v[44:47]
  ds_read_b64_tr_b16 a[166:167], v2 offset:39552
  v_mfma_f32_16x16x32_bf16 v[44:47], a[128:131], a[108:111], v[44:47]
  v_mfma_f32_16x16x32_bf16 v[60:63], a[136:139], a[108:111], v[60:63]
  ds_read_b64_tr_b16 a[168:169], v2 offset:28832
  v_mfma_f32_16x16x32_bf16 v[60:63], a[140:143], a[124:127], v[60:63]
  v_mfma_f32_16x16x32_bf16 v[56:59], a[140:143], a[120:123], v[56:59]
  ds_read_b64_tr_b16 a[170:171], v2 offset:32416
  v_mfma_f32_16x16x32_bf16 v[56:59], a[136:139], a[104:107], v[56:59]
  buffer_load_dwordx4 v4, s[16:19], s56 offen offset:1024 lds
  v_mfma_f32_16x16x32_bf16 v[52:55], a[136:139], a[100:103], v[52:55]
  ds_read_b64_tr_b16 a[172:173], v2 offset:36000
  v_mfma_f32_16x16x32_bf16 v[52:55], a[140:143], a[116:119], v[52:55]
  v_mfma_f32_16x16x32_bf16 v[48:51], a[140:143], a[112:115], v[48:51]
  ds_read_b64_tr_b16 a[174:175], v2 offset:39584
  v_mfma_f32_16x16x32_bf16 v[48:51], a[136:139], a[96:99], v[48:51]
  s_waitcnt lgkmcnt(8)
  v_mfma_f32_16x16x32_bf16 v[64:67], a[144:147], a[96:99], v[64:67]
  ds_read_b64_tr_b16 a[128:129], v2 offset:28864
  v_mfma_f32_16x16x32_bf16 v[64:67], a[148:151], a[112:115], v[64:67]
  v_mfma_f32_16x16x32_bf16 v[68:71], a[148:151], a[116:119], v[68:71]
  ds_read_b64_tr_b16 a[130:131], v2 offset:32448
  v_mfma_f32_16x16x32_bf16 v[68:71], a[144:147], a[100:103], v[68:71]
  buffer_load_dwordx4 a[20:23], v0, s[36:39], s57 offen offset:1024 sc1
  v_mfma_f32_16x16x32_bf16 v[72:75], a[144:147], a[104:107], v[72:75]
  ds_read_b64_tr_b16 a[132:133], v2 offset:36032
  v_mfma_f32_16x16x32_bf16 v[72:75], a[148:151], a[120:123], v[72:75]
  v_mfma_f32_16x16x32_bf16 v[76:79], a[148:151], a[124:127], v[76:79]
  ds_read_b64_tr_b16 a[134:135], v2 offset:39616
  v_mfma_f32_16x16x32_bf16 v[76:79], a[144:147], a[108:111], v[76:79]
  v_mfma_f32_16x16x32_bf16 v[92:95], a[152:155], a[108:111], v[92:95]
  ds_read_b64_tr_b16 a[136:137], v2 offset:43008
  v_mfma_f32_16x16x32_bf16 v[92:95], a[156:159], a[124:127], v[92:95]
  v_mfma_f32_16x16x32_bf16 v[88:91], a[156:159], a[120:123], v[88:91]
  buffer_load_dwordx4 v5, s[16:19], s56 offen offset:2048 lds
  v_mfma_f32_16x16x32_bf16 v[88:91], a[152:155], a[104:107], v[88:91]
  ds_read_b64_tr_b16 a[138:139], v2 offset:46592
  v_mfma_f32_16x16x32_bf16 v[84:87], a[152:155], a[100:103], v[84:87]
  ds_read_b64_tr_b16 a[140:141], v2 offset:50176
  v_mfma_f32_16x16x32_bf16 v[84:87], a[156:159], a[116:119], v[84:87]
  v_mfma_f32_16x16x32_bf16 v[80:83], a[156:159], a[112:115], v[80:83]
  ds_read_b64_tr_b16 a[142:143], v2 offset:53760
  v_mfma_f32_16x16x32_bf16 v[80:83], a[152:155], a[96:99], v[80:83]
  s_waitcnt lgkmcnt(8)
  v_mfma_f32_16x16x32_bf16 v[96:99], a[160:163], a[96:99], v[96:99]
  ds_read_b64_tr_b16 a[144:145], v2 offset:43040
  v_mfma_f32_16x16x32_bf16 v[96:99], a[164:167], a[112:115], v[96:99]
  v_mfma_f32_16x16x32_bf16 v[100:103], a[164:167], a[116:119], v[100:103]
  buffer_load_dwordx4 a[24:27], v0, s[36:39], s57 offen offset:2048 sc1
  v_mfma_f32_16x16x32_bf16 v[100:103], a[160:163], a[100:103], v[100:103]
  ds_read_b64_tr_b16 a[146:147], v2 offset:46624
  v_mfma_f32_16x16x32_bf16 v[104:107], a[160:163], a[104:107], v[104:107]
  ds_read_b64_tr_b16 a[148:149], v2 offset:50208
  v_mfma_f32_16x16x32_bf16 v[104:107], a[164:167], a[120:123], v[104:107]
  v_mfma_f32_16x16x32_bf16 v[108:111], a[164:167], a[124:127], v[108:111]
  ds_read_b64_tr_b16 a[150:151], v2 offset:53792
  v_mfma_f32_16x16x32_bf16 v[108:111], a[160:163], a[108:111], v[108:111]
  v_mfma_f32_16x16x32_bf16 v[124:127], a[168:171], a[108:111], v[124:127]
  ds_read_b64_tr_b16 a[152:153], v2 offset:43072
  v_mfma_f32_16x16x32_bf16 v[124:127], a[172:175], a[124:127], v[124:127]
  buffer_load_dwordx4 v6, s[16:19], s56 offen offset:3072 lds
  v_mfma_f32_16x16x32_bf16 v[120:123], a[172:175], a[120:123], v[120:123]
  ds_read_b64_tr_b16 a[154:155], v2 offset:46656
  v_mfma_f32_16x16x32_bf16 v[120:123], a[168:171], a[104:107], v[120:123]
  v_mfma_f32_16x16x32_bf16 v[116:119], a[168:171], a[100:103], v[116:119]
  ds_read_b64_tr_b16 a[156:157], v2 offset:50240
  v_mfma_f32_16x16x32_bf16 v[116:119], a[172:175], a[116:119], v[116:119]
  v_mfma_f32_16x16x32_bf16 v[112:115], a[172:175], a[112:115], v[112:115]
  ds_read_b64_tr_b16 a[158:159], v2 offset:53824
  v_mfma_f32_16x16x32_bf16 v[112:115], a[168:171], a[96:99], v[112:115]
  s_waitcnt lgkmcnt(8)
  v_mfma_f32_16x16x32_bf16 v[128:131], a[128:131], a[96:99], v[128:131]
  ds_read_b64_tr_b16 a[160:161], v2 offset:43104
  v_mfma_f32_16x16x32_bf16 v[128:131], a[132:135], a[112:115], v[128:131]
  buffer_load_dwordx4 a[28:31], v0, s[36:39], s57 offen offset:3072 sc1
  v_mfma_f32_16x16x32_bf16 v[132:135], a[132:135], a[116:119], v[132:135]
  ds_read_b64_tr_b16 a[162:163], v2 offset:46688
  v_mfma_f32_16x16x32_bf16 v[132:135], a[128:131], a[100:103], v[132:135]
  v_mfma_f32_16x16x32_bf16 v[136:139], a[128:131], a[104:107], v[136:139]
  s_add_u32 m0, s84, 32768
  ds_read_b64_tr_b16 a[164:165], v2 offset:50272
  v_mfma_f32_16x16x32_bf16 v[136:139], a[132:135], a[120:123], v[136:139]
  v_mfma_f32_16x16x32_bf16 v[140:143], a[132:135], a[124:127], v[140:143]
  ds_read_b64_tr_b16 a[166:167], v2 offset:53856
  v_mfma_f32_16x16x32_bf16 v[140:143], a[128:131], a[108:111], v[140:143]
  v_mfma_f32_16x16x32_bf16 v[156:159], a[136:139], a[108:111], v[156:159]
  buffer_load_dwordx4 v7, s[16:19], s56 offen offset:0 lds
  s_bfe_u32 s57, s82, 0x40014
  v_mfma_f32_16x16x32_bf16 v[156:159], a[140:143], a[124:127], v[156:159]
  s_lshl_b32 s57, s57, 13
  s_add_u32 s57, s57, s85
  ds_read_b64_tr_b16 a[168:169], v2 offset:43136
  v_mfma_f32_16x16x32_bf16 v[152:155], a[140:143], a[120:123], v[152:155]
  ds_read_b64_tr_b16 a[170:171], v2 offset:46720
  v_mfma_f32_16x16x32_bf16 v[152:155], a[136:139], a[104:107], v[152:155]
  v_mfma_f32_16x16x32_bf16 v[148:151], a[136:139], a[100:103], v[148:151]
  ds_read_b64_tr_b16 a[172:173], v2 offset:50304
  v_mfma_f32_16x16x32_bf16 v[148:151], a[140:143], a[116:119], v[148:151]
  buffer_load_dwordx4 a[32:35], v0, s[36:39], s57 offen offset:0 sc1
  v_mfma_f32_16x16x32_bf16 v[144:147], a[140:143], a[112:115], v[144:147]
  ds_read_b64_tr_b16 a[174:175], v2 offset:53888
  v_mfma_f32_16x16x32_bf16 v[144:147], a[136:139], a[96:99], v[144:147]
  s_waitcnt lgkmcnt(8)
  v_mfma_f32_16x16x32_bf16 v[160:163], a[144:147], a[96:99], v[160:163]
  ds_read_b64_tr_b16 a[128:129], v2 offset:43168
  v_mfma_f32_16x16x32_bf16 v[160:163], a[148:151], a[112:115], v[160:163]
  v_mfma_f32_16x16x32_bf16 v[164:167], a[148:151], a[116:119], v[164:167]
  ds_read_b64_tr_b16 a[130:131], v2 offset:46752
  v_mfma_f32_16x16x32_bf16 v[164:167], a[144:147], a[100:103], v[164:167]
  v_mfma_f32_16x16x32_bf16 v[168:171], a[144:147], a[104:107], v[168:171]
  ds_read_b64_tr_b16 a[132:133], v2 offset:50336
  v_mfma_f32_16x16x32_bf16 v[168:171], a[148:151], a[120:123], v[168:171]
  v_mfma_f32_16x16x32_bf16 v[172:175], a[148:151], a[124:127], v[172:175]
  ds_read_b64_tr_b16 a[134:135], v2 offset:53920
  v_mfma_f32_16x16x32_bf16 v[172:175], a[144:147], a[108:111], v[172:175]
  s_waitcnt vmcnt(12)
  s_barrier
  buffer_load_dwordx4 v8, s[16:19], s56 offen offset:1024 lds
  v_mfma_f32_16x16x32_bf16 v[188:191], a[152:155], a[108:111], v[188:191]
  ds_read_b64_tr_b16 a[136:137], v2 offset:43200
  v_mfma_f32_16x16x32_bf16 v[188:191], a[156:159], a[124:127], v[188:191]
  v_mfma_f32_16x16x32_bf16 v[184:187], a[156:159], a[120:123], v[184:187]
  ds_read_b64_tr_b16 a[138:139], v2 offset:46784
  v_mfma_f32_16x16x32_bf16 v[184:187], a[152:155], a[104:107], v[184:187]
  v_mfma_f32_16x16x32_bf16 v[180:183], a[152:155], a[100:103], v[180:183]
  buffer_load_dwordx4 a[36:39], v0, s[36:39], s57 offen offset:1024 sc1
  v_mfma_f32_16x16x32_bf16 v[180:183], a[156:159], a[116:119], v[180:183]
  ds_read_b64_tr_b16 a[140:141], v2 offset:50368
  v_mfma_f32_16x16x32_bf16 v[176:179], a[156:159], a[112:115], v[176:179]
  ds_read_b64_tr_b16 a[142:143], v2 offset:53952
  v_mfma_f32_16x16x32_bf16 v[176:179], a[152:155], a[96:99], v[176:179]
  s_waitcnt lgkmcnt(8)
  v_mfma_f32_16x16x32_bf16 v[192:195], a[160:163], a[96:99], v[192:195]
  ds_read_b64_tr_b16 a[144:145], v1 offset:0
  v_mfma_f32_16x16x32_bf16 v[192:195], a[164:167], a[112:115], v[192:195]
  v_mfma_f32_16x16x32_bf16 v[196:199], a[164:167], a[116:119], v[196:199]
  ds_read_b64_tr_b16 a[146:147], v1 offset:3584
  v_mfma_f32_16x16x32_bf16 v[196:199], a[160:163], a[100:103], v[196:199]
  v_mfma_f32_16x16x32_bf16 v[200:203], a[160:163], a[104:107], v[200:203]
  ds_read_b64_tr_b16 a[148:149], v1 offset:7168
  v_mfma_f32_16x16x32_bf16 v[200:203], a[164:167], a[120:123], v[200:203]
  v_mfma_f32_16x16x32_bf16 v[204:207], a[164:167], a[124:127], v[204:207]
  buffer_load_dwordx4 v9, s[16:19], s56 offen offset:2048 lds
  v_mfma_f32_16x16x32_bf16 v[204:207], a[160:163], a[108:111], v[204:207]
  ds_read_b64_tr_b16 a[150:151], v1 offset:10752
  v_mfma_f32_16x16x32_bf16 v[220:223], a[168:171], a[108:111], v[220:223]
  ds_read_b64_tr_b16 a[152:153], v1 offset:32
  v_mfma_f32_16x16x32_bf16 v[220:223], a[172:175], a[124:127], v[220:223]
  v_mfma_f32_16x16x32_bf16 v[216:219], a[172:175], a[120:123], v[216:219]
  ds_read_b64_tr_b16 a[154:155], v1 offset:3616
  v_mfma_f32_16x16x32_bf16 v[216:219], a[168:171], a[104:107], v[216:219]
  buffer_load_dwordx4 a[40:43], v0, s[36:39], s57 offen offset:2048 sc1
  v_mfma_f32_16x16x32_bf16 v[212:215], a[168:171], a[100:103], v[212:215]
  ds_read_b64_tr_b16 a[156:157], v1 offset:7200
  v_mfma_f32_16x16x32_bf16 v[212:215], a[172:175], a[116:119], v[212:215]
  v_mfma_f32_16x16x32_bf16 v[208:211], a[172:175], a[112:115], v[208:211]
  ds_read_b64_tr_b16 a[158:159], v1 offset:10784
  v_mfma_f32_16x16x32_bf16 v[208:211], a[168:171], a[96:99], v[208:211]
  s_waitcnt lgkmcnt(8)
  v_mfma_f32_16x16x32_bf16 v[224:227], a[128:131], a[96:99], v[224:227]
  ds_read_b64_tr_b16 a[160:161], v1 offset:64
  v_mfma_f32_16x16x32_bf16 v[224:227], a[132:135], a[112:115], v[224:227]
  v_mfma_f32_16x16x32_bf16 v[228:231], a[132:135], a[116:119], v[228:231]
  ds_read_b64_tr_b16 a[162:163], v1 offset:3648
  v_mfma_f32_16x16x32_bf16 v[228:231], a[128:131], a[100:103], v[228:231]
  v_mfma_f32_16x16x32_bf16 v[232:235], a[128:131], a[104:107], v[232:235]
  ds_read_b64_tr_b16 a[164:165], v1 offset:7232
  v_mfma_f32_16x16x32_bf16 v[232:235], a[132:135], a[120:123], v[232:235]
  buffer_load_dwordx4 a[44:47], v0, s[36:39], s57 offen offset:3072 sc1
  v_mfma_f32_16x16x32_bf16 v[236:239], a[132:135], a[124:127], v[236:239]
  ds_read_b64_tr_b16 a[166:167], v1 offset:10816
  v_mfma_f32_16x16x32_bf16 v[236:239], a[128:131], a[108:111], v[236:239]
  v_mfma_f32_16x16x32_bf16 v[252:255], a[136:139], a[108:111], v[252:255]
  ds_read_b64_tr_b16 a[168:169], v1 offset:96
  v_mfma_f32_16x16x32_bf16 v[252:255], a[140:143], a[124:127], v[252:255]
  s_bfe_u32 s56, s82, 0x40018
  s_mul_i32 s56, s56, 458752
  s_add_u32 m0, s84, 57344
  v_mfma_f32_16x16x32_bf16 v[248:251], a[140:143], a[120:123], v[248:251]
  ds_read_b64_tr_b16 a[170:171], v1 offset:3680
  v_mfma_f32_16x16x32_bf16 v[248:251], a[136:139], a[104:107], v[248:251]
  v_mfma_f32_16x16x32_bf16 v[244:247], a[136:139], a[100:103], v[244:247]
  ds_read_b64_tr_b16 a[172:173], v1 offset:7264
  v_mfma_f32_16x16x32_bf16 v[244:247], a[140:143], a[116:119], v[244:247]
  buffer_load_dwordx4 v3, s[16:19], s56 offen offset:0 lds
  v_mfma_f32_16x16x32_bf16 v[240:243], a[140:143], a[112:115], v[240:243]
  ds_read_b64_tr_b16 a[174:175], v1 offset:10848
  v_mfma_f32_16x16x32_bf16 v[240:243], a[136:139], a[96:99], v[240:243]
  s_waitcnt vmcnt(8) lgkmcnt(8)
  v_mfma_f32_16x16x32_bf16 v[32:35], a[144:147], a[0:3], v[32:35]
  s_add_u32 s57, s57, 4096
  ds_read_b64_tr_b16 a[128:129], v1 offset:128
  v_mfma_f32_16x16x32_bf16 v[32:35], a[148:151], a[16:19], v[32:35]
  v_mfma_f32_16x16x32_bf16 v[36:39], a[148:151], a[20:23], v[36:39]
  ds_read_b64_tr_b16 a[130:131], v1 offset:3712
  v_mfma_f32_16x16x32_bf16 v[36:39], a[144:147], a[4:7], v[36:39]
  v_mfma_f32_16x16x32_bf16 v[40:43], a[144:147], a[8:11], v[40:43]
  buffer_load_dwordx4 a[48:51], v0, s[36:39], s57 offen offset:0 sc1
  v_mfma_f32_16x16x32_bf16 v[40:43], a[148:151], a[24:27], v[40:43]
  ds_read_b64_tr_b16 a[132:133], v1 offset:7296
  v_mfma_f32_16x16x32_bf16 v[44:47], a[148:151], a[28:31], v[44:47]
  ds_read_b64_tr_b16 a[134:135], v1 offset:10880
  v_mfma_f32_16x16x32_bf16 v[44:47], a[144:147], a[12:15], v[44:47]
Hb1:
  s_cbranch_execz Hb1_1
  v_mfma_f32_16x16x32_bf16 v[60:63], a[152:155], a[12:15], v[60:63]
  ds_read_b64_tr_b16 a[136:137], v1 offset:160
  v_mfma_f32_16x16x32_bf16 v[60:63], a[156:159], a[28:31], v[60:63]
  v_mfma_f32_16x16x32_bf16 v[56:59], a[156:159], a[24:27], v[56:59]
  ds_read_b64_tr_b16 a[138:139], v1 offset:3744
  v_mfma_f32_16x16x32_bf16 v[56:59], a[152:155], a[8:11], v[56:59]
  buffer_load_dwordx4 v4, s[16:19], s56 offen offset:1024 lds
  v_mfma_f32_16x16x32_bf16 v[52:55], a[152:155], a[4:7], v[52:55]
  ds_read_b64_tr_b16 a[140:141], v1 offset:7328
  v_mfma_f32_16x16x32_bf16 v[52:55], a[156:159], a[20:23], v[52:55]
  v_mfma_f32_16x16x32_bf16 v[48:51], a[156:159], a[16:19], v[48:51]
  ds_read_b64_tr_b16 a[142:143], v1 offset:10912
  v_mfma_f32_16x16x32_bf16 v[48:51], a[152:155], a[0:3], v[48:51]
  s_waitcnt lgkmcnt(8)
  v_mfma_f32_16x16x32_bf16 v[64:67], a[160:163], a[0:3], v[64:67]
  ds_read_b64_tr_b16 a[144:145], v1 offset:192
  v_mfma_f32_16x16x32_bf16 v[64:67], a[164:167], a[16:19], v[64:67]
  v_mfma_f32_16x16x32_bf16 v[68:71], a[164:167], a[20:23], v[68:71]
  ds_read_b64_tr_b16 a[146:147], v1 offset:3776
  v_mfma_f32_16x16x32_bf16 v[68:71], a[160:163], a[4:7], v[68:71]
  buffer_load_dwordx4 a[52:55], v0, s[36:39], s57 offen offset:1024 sc1
  v_mfma_f32_16x16x32_bf16 v[72:75], a[160:163], a[8:11], v[72:75]
  ds_read_b64_tr_b16 a[148:149], v1 offset:7360
  v_mfma_f32_16x16x32_bf16 v[72:75], a[164:167], a[24:27], v[72:75]
  v_mfma_f32_16x16x32_bf16 v[76:79], a[164:167], a[28:31], v[76:79]
  ds_read_b64_tr_b16 a[150:151], v1 offset:10944
  v_mfma_f32_16x16x32_bf16 v[76:79], a[160:163], a[12:15], v[76:79]
  v_mfma_f32_16x16x32_bf16 v[92:95], a[168:171], a[12:15], v[92:95]
  ds_read_b64_tr_b16 a[152:153], v1 offset:14336
  v_mfma_f32_16x16x32_bf16 v[92:95], a[172:175], a[28:31], v[92:95]
  v_mfma_f32_16x16x32_bf16 v[88:91], a[172:175], a[24:27], v[88:91]
  buffer_load_dwordx4 v5, s[16:19], s56 offen offset:2048 lds
  v_mfma_f32_16x16x32_bf16 v[88:91], a[168:171], a[8:11], v[88:91]
  ds_read_b64_tr_b16 a[154:155], v1 offset:17920
  v_mfma_f32_16x16x32_bf16 v[84:87], a[168:171], a[4:7], v[84:87]
  ds_read_b64_tr_b16 a[156:157], v1 offset:21504
  v_mfma_f32_16x16x32_bf16 v[84:87], a[172:175], a[20:23], v[84:87]
  v_mfma_f32_16x16x32_bf16 v[80:83], a[172:175], a[16:19], v[80:83]
  ds_read_b64_tr_b16 a[158:159], v1 offset:25088
  v_mfma_f32_16x16x32_bf16 v[80:83], a[168:171], a[0:3], v[80:83]
  s_waitcnt lgkmcnt(8)
  v_mfma_f32_16x16x32_bf16 v[96:99], a[128:131], a[0:3], v[96:99]
  ds_read_b64_tr_b16 a[160:161], v1 offset:14368
  v_mfma_f32_16x16x32_bf16 v[96:99], a[132:135], a[16:19], v[96:99]
  v_mfma_f32_16x16x32_bf16 v[100:103], a[132:135], a[20:23], v[100:103]
  buffer_load_dwordx4 a[56:59], v0, s[36:39], s57 offen offset:2048 sc1
  v_mfma_f32_16x16x32_bf16 v[100:103], a[128:131], a[4:7], v[100:103]
  ds_read_b64_tr_b16 a[162:163], v1 offset:17952
  v_mfma_f32_16x16x32_bf16 v[104:107], a[128:131], a[8:11], v[104:107]
  ds_read_b64_tr_b16 a[164:165], v1 offset:21536
  v_mfma_f32_16x16x32_bf16 v[104:107], a[132:135], a[24:27], v[104:107]
  v_mfma_f32_16x16x32_bf16 v[108:111], a[132:135], a[28:31], v[108:111]
  ds_read_b64_tr_b16 a[166:167], v1 offset:25120
  v_mfma_f32_16x16x32_bf16 v[108:111], a[128:131], a[12:15], v[108:111]
  v_mfma_f32_16x16x32_bf16 v[124:127], a[136:139], a[12:15], v[124:127]
  ds_read_b64_tr_b16 a[168:169], v1 offset:14400
  v_mfma_f32_16x16x32_bf16 v[124:127], a[140:143], a[28:31], v[124:127]
  buffer_load_dwordx4 v6, s[16:19], s56 offen offset:3072 lds
  v_mfma_f32_16x16x32_bf16 v[120:123], a[140:143], a[24:27], v[120:123]
  ds_read_b64_tr_b16 a[170:171], v1 offset:17984
  v_mfma_f32_16x16x32_bf16 v[120:123], a[136:139], a[8:11], v[120:123]
  v_mfma_f32_16x16x32_bf16 v[116:119], a[136:139], a[4:7], v[116:119]
  ds_read_b64_tr_b16 a[172:173], v1 offset:21568
  v_mfma_f32_16x16x32_bf16 v[116:119], a[140:143], a[20:23], v[116:119]
  v_mfma_f32_16x16x32_bf16 v[112:115], a[140:143], a[16:19], v[112:115]
  ds_read_b64_tr_b16 a[174:175], v1 offset:25152
  v_mfma_f32_16x16x32_bf16 v[112:115], a[136:139], a[0:3], v[112:115]
  s_waitcnt lgkmcnt(8)
  v_mfma_f32_16x16x32_bf16 v[128:131], a[144:147], a[0:3], v[128:131]
  ds_read_b64_tr_b16 a[128:129], v1 offset:14432
  v_mfma_f32_16x16x32_bf16 v[128:131], a[148:151], a[16:19], v[128:131]
  buffer_load_dwordx4 a[60:63], v0, s[36:39], s57 offen offset:3072 sc1
  v_mfma_f32_16x16x32_bf16 v[132:135], a[148:151], a[20:23], v[132:135]
  ds_read_b64_tr_b16 a[130:131], v1 offset:18016
  v_mfma_f32_16x16x32_bf16 v[132:135], a[144:147], a[4:7], v[132:135]
  v_mfma_f32_16x16x32_bf16 v[136:139], a[144:147], a[8:11], v[136:139]
  s_add_u32 m0, s84, 61440
  ds_read_b64_tr_b16 a[132:133], v1 offset:21600
  v_mfma_f32_16x16x32_bf16 v[136:139], a[148:151], a[24:27], v[136:139]
  v_mfma_f32_16x16x32_bf16 v[140:143], a[148:151], a[28:31], v[140:143]
  ds_read_b64_tr_b16 a[134:135], v1 offset:25184
  v_mfma_f32_16x16x32_bf16 v[140:143], a[144:147], a[12:15], v[140:143]
  v_mfma_f32_16x16x32_bf16 v[156:159], a[152:155], a[12:15], v[156:159]
  buffer_load_dwordx4 v7, s[16:19], s56 offen offset:0 lds
  s_bfe_u32 s57, s82, 0x40018
  v_mfma_f32_16x16x32_bf16 v[156:159], a[156:159], a[28:31], v[156:159]
  s_lshl_b32 s57, s57, 13
  s_add_u32 s57, s57, s85
  ds_read_b64_tr_b16 a[136:137], v1 offset:14464
  v_mfma_f32_16x16x32_bf16 v[152:155], a[156:159], a[24:27], v[152:155]
  ds_read_b64_tr_b16 a[138:139], v1 offset:18048
  v_mfma_f32_16x16x32_bf16 v[152:155], a[152:155], a[8:11], v[152:155]
  v_mfma_f32_16x16x32_bf16 v[148:151], a[152:155], a[4:7], v[148:151]
  ds_read_b64_tr_b16 a[140:141], v1 offset:21632
  v_mfma_f32_16x16x32_bf16 v[148:151], a[156:159], a[20:23], v[148:151]
  buffer_load_dwordx4 a[64:67], v0, s[36:39], s57 offen offset:0 sc1
  v_mfma_f32_16x16x32_bf16 v[144:147], a[156:159], a[16:19], v[144:147]
  ds_read_b64_tr_b16 a[142:143], v1 offset:25216
  v_mfma_f32_16x16x32_bf16 v[144:147], a[152:155], a[0:3], v[144:147]
  s_waitcnt lgkmcnt(8)
  v_mfma_f32_16x16x32_bf16 v[160:163], a[160:163], a[0:3], v[160:163]
  ds_read_b64_tr_b16 a[144:145], v1 offset:14496
  v_mfma_f32_16x16x32_bf16 v[160:163], a[164:167], a[16:19], v[160:163]
  v_mfma_f32_16x16x32_bf16 v[164:167], a[164:167], a[20:23], v[164:167]
  ds_read_b64_tr_b16 a[146:147], v1 offset:18080
  v_mfma_f32_16x16x32_bf16 v[164:167], a[160:163], a[4:7], v[164:167]
  v_mfma_f32_16x16x32_bf16 v[168:171], a[160:163], a[8:11], v[168:171]
  ds_read_b64_tr_b16 a[148:149], v1 offset:21664
  v_mfma_f32_16x16x32_bf16 v[168:171], a[164:167], a[24:27], v[168:171]
  v_mfma_f32_16x16x32_bf16 v[172:175], a[164:167], a[28:31], v[172:175]
  ds_read_b64_tr_b16 a[150:151], v1 offset:25248
  v_mfma_f32_16x16x32_bf16 v[172:175], a[160:163], a[12:15], v[172:175]
  s_waitcnt vmcnt(12)
  s_barrier
  buffer_load_dwordx4 v8, s[16:19], s56 offen offset:1024 lds
  v_mfma_f32_16x16x32_bf16 v[188:191], a[168:171], a[12:15], v[188:191]
  ds_read_b64_tr_b16 a[152:153], v1 offset:14528
  v_mfma_f32_16x16x32_bf16 v[188:191], a[172:175], a[28:31], v[188:191]
  v_mfma_f32_16x16x32_bf16 v[184:187], a[172:175], a[24:27], v[184:187]
  ds_read_b64_tr_b16 a[154:155], v1 offset:18112
  v_mfma_f32_16x16x32_bf16 v[184:187], a[168:171], a[8:11], v[184:187]
  v_mfma_f32_16x16x32_bf16 v[180:183], a[168:171], a[4:7], v[180:183]
  buffer_load_dwordx4 a[68:71], v0, s[36:39], s57 offen offset:1024 sc1
  v_mfma_f32_16x16x32_bf16 v[180:183], a[172:175], a[20:23], v[180:183]
  ds_read_b64_tr_b16 a[156:157], v1 offset:21696
  v_mfma_f32_16x16x32_bf16 v[176:179], a[172:175], a[16:19], v[176:179]
  ds_read_b64_tr_b16 a[158:159], v1 offset:25280
  v_mfma_f32_16x16x32_bf16 v[176:179], a[168:171], a[0:3], v[176:179]
  s_waitcnt lgkmcnt(8)
  v_mfma_f32_16x16x32_bf16 v[192:195], a[128:131], a[0:3], v[192:195]
  ds_read_b64_tr_b16 a[160:161], v1 offset:28672
  v_mfma_f32_16x16x32_bf16 v[192:195], a[132:135], a[16:19], v[192:195]
  v_mfma_f32_16x16x32_bf16 v[196:199], a[132:135], a[20:23], v[196:199]
  ds_read_b64_tr_b16 a[162:163], v1 offset:32256
  v_mfma_f32_16x16x32_bf16 v[196:199], a[128:131], a[4:7], v[196:199]
  v_mfma_f32_16x16x32_bf16 v[200:203], a[128:131], a[8:11], v[200:203]
  ds_read_b64_tr_b16 a[164:165], v1 offset:35840
  v_mfma_f32_16x16x32_bf16 v[200:203], a[132:135], a[24:27], v[200:203]
  v_mfma_f32_16x16x32_bf16 v[204:207], a[132:135], a[28:31], v[204:207]
  buffer_load_dwordx4 v9, s[16:19], s56 offen offset:2048 lds
  v_mfma_f32_16x16x32_bf16 v[204:207], a[128:131], a[12:15], v[204:207]
  ds_read_b64_tr_b16 a[166:167], v1 offset:39424
  v_mfma_f32_16x16x32_bf16 v[220:223], a[136:139], a[12:15], v[220:223]
  ds_read_b64_tr_b16 a[168:169], v1 offset:28704
  v_mfma_f32_16x16x32_bf16 v[220:223], a[140:143], a[28:31], v[220:223]
  v_mfma_f32_16x16x32_bf16 v[216:219], a[140:143], a[24:27], v[216:219]
  ds_read_b64_tr_b16 a[170:171], v1 offset:32288
  v_mfma_f32_16x16x32_bf16 v[216:219], a[136:139], a[8:11], v[216:219]
  buffer_load_dwordx4 a[72:75], v0, s[36:39], s57 offen offset:2048 sc1
  v_mfma_f32_16x16x32_bf16 v[212:215], a[136:139], a[4:7], v[212:215]
  ds_read_b64_tr_b16 a[172:173], v1 offset:35872
  v_mfma_f32_16x16x32_bf16 v[212:215], a[140:143], a[20:23], v[212:215]
  v_mfma_f32_16x16x32_bf16 v[208:211], a[140:143], a[16:19], v[208:211]
  ds_read_b64_tr_b16 a[174:175], v1 offset:39456
  v_mfma_f32_16x16x32_bf16 v[208:211], a[136:139], a[0:3], v[208:211]
  s_waitcnt lgkmcnt(8)
  v_mfma_f32_16x16x32_bf16 v[224:227], a[144:147], a[0:3], v[224:227]
  ds_read_b64_tr_b16 a[128:129], v1 offset:28736
  v_mfma_f32_16x16x32_bf16 v[224:227], a[148:151], a[16:19], v[224:227]
  v_mfma_f32_16x16x32_bf16 v[228:231], a[148:151], a[20:23], v[228:231]
  ds_read_b64_tr_b16 a[130:131], v1 offset:32320
  v_mfma_f32_16x16x32_bf16 v[228:231], a[144:147], a[4:7], v[228:231]
  v_mfma_f32_16x16x32_bf16 v[232:235], a[144:147], a[8:11], v[232:235]
  ds_read_b64_tr_b16 a[132:133], v1 offset:35904
  v_mfma_f32_16x16x32_bf16 v[232:235], a[148:151], a[24:27], v[232:235]
  buffer_load_dwordx4 a[76:79], v0, s[36:39], s57 offen offset:3072 sc1
  v_mfma_f32_16x16x32_bf16 v[236:239], a[148:151], a[28:31], v[236:239]
  ds_read_b64_tr_b16 a[134:135], v1 offset:39488
  v_mfma_f32_16x16x32_bf16 v[236:239], a[144:147], a[12:15], v[236:239]
  v_mfma_f32_16x16x32_bf16 v[252:255], a[152:155], a[12:15], v[252:255]
  ds_read_b64_tr_b16 a[136:137], v1 offset:28768
  v_mfma_f32_16x16x32_bf16 v[252:255], a[156:159], a[28:31], v[252:255]
  s_bfe_u32 s56, s82, 0x4001c
  s_mul_i32 s56, s56, 458752
  s_add_u32 m0, s84, 86016
  v_mfma_f32_16x16x32_bf16 v[248:251], a[156:159], a[24:27], v[248:251]
  buffer_load_dwordx4 a[208:211], v0, s[36:39], s59 offen offset:0 sc1
  v_add_u32 v31, 57344, v31
  v_mfma_f32_16x16x32_bf16 v[248:251], a[152:155], a[8:11], v[248:251]
  ds_read_b64_tr_b16 a[138:139], v1 offset:32352
  v_mfma_f32_16x16x32_bf16 v[244:247], a[152:155], a[4:7], v[244:247]
  ds_read_b64_tr_b16 a[140:141], v1 offset:35936
  v_mfma_f32_16x16x32_bf16 v[244:247], a[156:159], a[20:23], v[244:247]
  v_mfma_f32_16x16x32_bf16 v[240:243], a[156:159], a[16:19], v[240:243]
  ds_read_b64_tr_b16 a[142:143], v1 offset:39520
  v_mfma_f32_16x16x32_bf16 v[240:243], a[152:155], a[0:3], v[240:243]
  s_waitcnt vmcnt(8) lgkmcnt(8)
  buffer_load_dwordx4 a[212:215], v0, s[36:39], s59 offen offset:1024 sc1
  v_mfma_f32_16x16x32_bf16 v[32:35], a[160:163], a[32:35], v[32:35]
  ds_read_b64_tr_b16 a[144:145], v1 offset:28800
  v_mfma_f32_16x16x32_bf16 v[32:35], a[164:167], a[48:51], v[32:35]
  v_mfma_f32_16x16x32_bf16 v[36:39], a[164:167], a[52:55], v[36:39]
  ds_read_b64_tr_b16 a[146:147], v1 offset:32384
  v_mfma_f32_16x16x32_bf16 v[36:39], a[160:163], a[36:39], v[36:39]
  v_mfma_f32_16x16x32_bf16 v[40:43], a[160:163], a[40:43], v[40:43]
  buffer_load_dwordx4 v3, s[16:19], s56 offen offset:0 lds
  s_add_u32 s57, s57, 4096
  v_mfma_f32_16x16x32_bf16 v[40:43], a[164:167], a[56:59], v[40:43]
  ds_read_b64_tr_b16 a[148:149], v1 offset:35968
  v_mfma_f32_16x16x32_bf16 v[44:47], a[164:167], a[60:63], v[44:47]
  ds_read_b64_tr_b16 a[150:151], v1 offset:39552
  v_mfma_f32_16x16x32_bf16 v[44:47], a[160:163], a[44:47], v[44:47]
  v_mfma_f32_16x16x32_bf16 v[60:63], a[168:171], a[44:47], v[60:63]
  ds_read_b64_tr_b16 a[152:153], v1 offset:28832
  v_mfma_f32_16x16x32_bf16 v[60:63], a[172:175], a[60:63], v[60:63]
  buffer_load_dwordx4 a[80:83], v0, s[36:39], s57 offen offset:0 sc1
  v_mfma_f32_16x16x32_bf16 v[56:59], a[172:175], a[56:59], v[56:59]
  ds_read_b64_tr_b16 a[154:155], v1 offset:32416
  v_mfma_f32_16x16x32_bf16 v[56:59], a[168:171], a[40:43], v[56:59]
  v_mfma_f32_16x16x32_bf16 v[52:55], a[168:171], a[36:39], v[52:55]
  ds_read_b64_tr_b16 a[156:157], v1 offset:36000
  v_mfma_f32_16x16x32_bf16 v[52:55], a[172:175], a[52:55], v[52:55]
  v_mfma_f32_16x16x32_bf16 v[48:51], a[172:175], a[48:51], v[48:51]
  buffer_load_dwordx4 v4, s[16:19], s56 offen offset:1024 lds
  v_mfma_f32_16x16x32_bf16 v[48:51], a[168:171], a[32:35], v[48:51]
  s_waitcnt lgkmcnt(7)
  ds_read_b64_tr_b16 a[158:159], v1 offset:39584
  v_mfma_f32_16x16x32_bf16 v[64:67], a[128:131], a[32:35], v[64:67]
  ds_read_b64_tr_b16 a[160:161], v1 offset:28864
  v_mfma_f32_16x16x32_bf16 v[64:67], a[132:135], a[48:51], v[64:67]
  v_mfma_f32_16x16x32_bf16 v[68:71], a[132:135], a[52:55], v[68:71]
  ds_read_b64_tr_b16 a[162:163], v1 offset:32448
  v_mfma_f32_16x16x32_bf16 v[68:71], a[128:131], a[36:39], v[68:71]
  buffer_load_dwordx4 a[84:87], v0, s[36:39], s57 offen offset:1024 sc1
  v_mfma_f32_16x16x32_bf16 v[72:75], a[128:131], a[40:43], v[72:75]
  ds_read_b64_tr_b16 a[164:165], v1 offset:36032
  v_mfma_f32_16x16x32_bf16 v[72:75], a[132:135], a[56:59], v[72:75]
  v_mfma_f32_16x16x32_bf16 v[76:79], a[132:135], a[60:63], v[76:79]
  ds_read_b64_tr_b16 a[166:167], v1 offset:39616
  v_mfma_f32_16x16x32_bf16 v[76:79], a[128:131], a[44:47], v[76:79]
  v_mfma_f32_16x16x32_bf16 v[92:95], a[136:139], a[44:47], v[92:95]
  ds_read_b64_tr_b16 a[168:169], v1 offset:43008
  v_mfma_f32_16x16x32_bf16 v[92:95], a[140:143], a[60:63], v[92:95]
  v_mfma_f32_16x16x32_bf16 v[88:91], a[140:143], a[56:59], v[88:91]
  buffer_load_dwordx4 v5, s[16:19], s56 offen offset:2048 lds
  v_mfma_f32_16x16x32_bf16 v[88:91], a[136:139], a[40:43], v[88:91]
  ds_read_b64_tr_b16 a[170:171], v1 offset:46592
  v_mfma_f32_16x16x32_bf16 v[84:87], a[136:139], a[36:39], v[84:87]
  ds_read_b64_tr_b16 a[172:173], v1 offset:50176
  v_mfma_f32_16x16x32_bf16 v[84:87], a[140:143], a[52:55], v[84:87]
  v_mfma_f32_16x16x32_bf16 v[80:83], a[140:143], a[48:51], v[80:83]
  ds_read_b64_tr_b16 a[174:175], v1 offset:53760
  v_mfma_f32_16x16x32_bf16 v[80:83], a[136:139], a[32:35], v[80:83]
  s_waitcnt lgkmcnt(8)
  v_mfma_f32_16x16x32_bf16 v[96:99], a[144:147], a[32:35], v[96:99]
  ds_read_b64_tr_b16 a[128:129], v1 offset:43040
  v_mfma_f32_16x16x32_bf16 v[96:99], a[148:151], a[48:51], v[96:99]
  v_mfma_f32_16x16x32_bf16 v[100:103], a[148:151], a[52:55], v[100:103]
  buffer_load_dwordx4 a[88:91], v0, s[36:39], s57 offen offset:2048 sc1
  v_mfma_f32_16x16x32_bf16 v[100:103], a[144:147], a[36:39], v[100:103]
  ds_read_b64_tr_b16 a[130:131], v1 offset:46624
  v_mfma_f32_16x16x32_bf16 v[104:107], a[144:147], a[40:43], v[104:107]
  ds_read_b64_tr_b16 a[132:133], v1 offset:50208
  v_mfma_f32_16x16x32_bf16 v[104:107], a[148:151], a[56:59], v[104:107]
  v_mfma_f32_16x16x32_bf16 v[108:111], a[148:151], a[60:63], v[108:111]
  ds_read_b64_tr_b16 a[134:135], v1 offset:53792
  v_mfma_f32_16x16x32_bf16 v[108:111], a[144:147], a[44:47], v[108:111]
  v_mfma_f32_16x16x32_bf16 v[124:127], a[152:155], a[44:47], v[124:127]
  ds_read_b64_tr_b16 a[136:137], v1 offset:43072
  v_mfma_f32_16x16x32_bf16 v[124:127], a[156:159], a[60:63], v[124:127]
  buffer_load_dwordx4 v6, s[16:19], s56 offen offset:3072 lds
  v_mfma_f32_16x16x32_bf16 v[120:123], a[156:159], a[56:59], v[120:123]
  ds_read_b64_tr_b16 a[138:139], v1 offset:46656
  v_mfma_f32_16x16x32_bf16 v[120:123], a[152:155], a[40:43], v[120:123]
  v_mfma_f32_16x16x32_bf16 v[116:119], a[152:155], a[36:39], v[116:119]
  ds_read_b64_tr_b16 a[140:141], v1 offset:50240
  v_mfma_f32_16x16x32_bf16 v[116:119], a[156:159], a[52:55], v[116:119]
  v_mfma_f32_16x16x32_bf16 v[112:115], a[156:159], a[48:51], v[112:115]
  ds_read_b64_tr_b16 a[142:143], v1 offset:53824
  v_mfma_f32_16x16x32_bf16 v[112:115], a[152:155], a[32:35], v[112:115]
  s_waitcnt lgkmcnt(8)
  v_mfma_f32_16x16x32_bf16 v[128:131], a[160:163], a[32:35], v[128:131]
  ds_read_b64_tr_b16 a[144:145], v1 offset:43104
  v_mfma_f32_16x16x32_bf16 v[128:131], a[164:167], a[48:51], v[128:131]
  buffer_load_dwordx4 a[92:95], v0, s[36:39], s57 offen offset:3072 sc1
  v_mfma_f32_16x16x32_bf16 v[132:135], a[164:167], a[52:55], v[132:135]
  ds_read_b64_tr_b16 a[146:147], v1 offset:46688
  v_mfma_f32_16x16x32_bf16 v[132:135], a[160:163], a[36:39], v[132:135]
  v_mfma_f32_16x16x32_bf16 v[136:139], a[160:163], a[40:43], v[136:139]
  s_add_u32 m0, s84, 90112
  ds_read_b64_tr_b16 a[148:149], v1 offset:50272
  v_mfma_f32_16x16x32_bf16 v[136:139], a[164:167], a[56:59], v[136:139]
  v_mfma_f32_16x16x32_bf16 v[140:143], a[164:167], a[60:63], v[140:143]
  ds_read_b64_tr_b16 a[150:151], v1 offset:53856
  v_mfma_f32_16x16x32_bf16 v[140:143], a[160:163], a[44:47], v[140:143]
  v_mfma_f32_16x16x32_bf16 v[156:159], a[168:171], a[44:47], v[156:159]
  buffer_load_dwordx4 v7, s[16:19], s56 offen offset:0 lds
  s_bfe_u32 s57, s82, 0x4001c
  v_mfma_f32_16x16x32_bf16 v[156:159], a[172:175], a[60:63], v[156:159]
  s_lshl_b32 s57, s57, 13
  s_add_u32 s57, s57, s85
  ds_read_b64_tr_b16 a[152:153], v1 offset:43136
  v_mfma_f32_16x16x32_bf16 v[152:155], a[172:175], a[56:59], v[152:155]
  ds_read_b64_tr_b16 a[154:155], v1 offset:46720
  v_mfma_f32_16x16x32_bf16 v[152:155], a[168:171], a[40:43], v[152:155]
  v_mfma_f32_16x16x32_bf16 v[148:151], a[168:171], a[36:39], v[148:151]
  ds_read_b64_tr_b16 a[156:157], v1 offset:50304
  v_mfma_f32_16x16x32_bf16 v[148:151], a[172:175], a[52:55], v[148:151]
  buffer_load_dwordx4 a[96:99], v0, s[36:39], s57 offen offset:0 sc1
  v_mfma_f32_16x16x32_bf16 v[144:147], a[172:175], a[48:51], v[144:147]
  ds_read_b64_tr_b16 a[158:159], v1 offset:53888
  v_mfma_f32_16x16x32_bf16 v[144:147], a[168:171], a[32:35], v[144:147]
  s_waitcnt lgkmcnt(8)
  v_mfma_f32_16x16x32_bf16 v[160:163], a[128:131], a[32:35], v[160:163]
  ds_read_b64_tr_b16 a[160:161], v1 offset:43168
  v_mfma_f32_16x16x32_bf16 v[160:163], a[132:135], a[48:51], v[160:163]
  v_mfma_f32_16x16x32_bf16 v[164:167], a[132:135], a[52:55], v[164:167]
  ds_read_b64_tr_b16 a[162:163], v1 offset:46752
  v_mfma_f32_16x16x32_bf16 v[164:167], a[128:131], a[36:39], v[164:167]
  v_mfma_f32_16x16x32_bf16 v[168:171], a[128:131], a[40:43], v[168:171]
  ds_read_b64_tr_b16 a[164:165], v1 offset:50336
  v_mfma_f32_16x16x32_bf16 v[168:171], a[132:135], a[56:59], v[168:171]
  v_mfma_f32_16x16x32_bf16 v[172:175], a[132:135], a[60:63], v[172:175]
  ds_read_b64_tr_b16 a[166:167], v1 offset:53920
  v_mfma_f32_16x16x32_bf16 v[172:175], a[128:131], a[44:47], v[172:175]
  s_waitcnt vmcnt(14)
  s_barrier
  buffer_load_dwordx4 v8, s[16:19], s56 offen offset:1024 lds
  v_mfma_f32_16x16x32_bf16 v[188:191], a[136:139], a[44:47], v[188:191]
  ds_read_b64_tr_b16 a[168:169], v1 offset:43200
  v_mfma_f32_16x16x32_bf16 v[188:191], a[140:143], a[60:63], v[188:191]
  v_mfma_f32_16x16x32_bf16 v[184:187], a[140:143], a[56:59], v[184:187]
  ds_read_b64_tr_b16 a[170:171], v1 offset:46784
  v_mfma_f32_16x16x32_bf16 v[184:187], a[136:139], a[40:43], v[184:187]
  v_mfma_f32_16x16x32_bf16 v[180:183], a[136:139], a[36:39], v[180:183]
  buffer_load_dwordx4 a[100:103], v0, s[36:39], s57 offen offset:1024 sc1
  v_mfma_f32_16x16x32_bf16 v[180:183], a[140:143], a[52:55], v[180:183]
  ds_read_b64_tr_b16 a[172:173], v1 offset:50368
  v_mfma_f32_16x16x32_bf16 v[176:179], a[140:143], a[48:51], v[176:179]
  ds_read_b64_tr_b16 a[174:175], v1 offset:53952
  v_mfma_f32_16x16x32_bf16 v[176:179], a[136:139], a[32:35], v[176:179]
  s_waitcnt lgkmcnt(8)
  v_mfma_f32_16x16x32_bf16 v[192:195], a[144:147], a[32:35], v[192:195]
  ds_read_b64_tr_b16 a[128:129], v2 offset:0
  v_mfma_f32_16x16x32_bf16 v[192:195], a[148:151], a[48:51], v[192:195]
  v_mfma_f32_16x16x32_bf16 v[196:199], a[148:151], a[52:55], v[196:199]
  ds_read_b64_tr_b16 a[130:131], v2 offset:3584
  v_mfma_f32_16x16x32_bf16 v[196:199], a[144:147], a[36:39], v[196:199]
  v_mfma_f32_16x16x32_bf16 v[200:203], a[144:147], a[40:43], v[200:203]
  ds_read_b64_tr_b16 a[132:133], v2 offset:7168
  v_mfma_f32_16x16x32_bf16 v[200:203], a[148:151], a[56:59], v[200:203]
  ds_read_b64_tr_b16 a[176:177], v31 offset:0
  v_mfma_f32_16x16x32_bf16 v[204:207], a[148:151], a[60:63], v[204:207]
  buffer_load_dwordx4 v9, s[16:19], s56 offen offset:2048 lds
  v_mfma_f32_16x16x32_bf16 v[204:207], a[144:147], a[44:47], v[204:207]
  ds_read_b64_tr_b16 a[134:135], v2 offset:10752
  v_mfma_f32_16x16x32_bf16 v[220:223], a[152:155], a[44:47], v[220:223]
  ds_read_b64_tr_b16 a[136:137], v2 offset:32
  v_mfma_f32_16x16x32_bf16 v[220:223], a[156:159], a[60:63], v[220:223]
  ds_read_b64_tr_b16 a[178:179], v31 offset:3584
  v_mfma_f32_16x16x32_bf16 v[216:219], a[156:159], a[56:59], v[216:219]
  ds_read_b64_tr_b16 a[138:139], v2 offset:3616
  v_mfma_f32_16x16x32_bf16 v[216:219], a[152:155], a[40:43], v[216:219]
  buffer_load_dwordx4 a[104:107], v0, s[36:39], s57 offen offset:2048 sc1
  v_mfma_f32_16x16x32_bf16 v[212:215], a[152:155], a[36:39], v[212:215]
  ds_read_b64_tr_b16 a[140:141], v2 offset:7200
  v_mfma_f32_16x16x32_bf16 v[212:215], a[156:159], a[52:55], v[212:215]
  ds_read_b64_tr_b16 a[180:181], v31 offset:7168
  v_mfma_f32_16x16x32_bf16 v[208:211], a[156:159], a[48:51], v[208:211]
  ds_read_b64_tr_b16 a[142:143], v2 offset:10784
  v_mfma_f32_16x16x32_bf16 v[208:211], a[152:155], a[32:35], v[208:211]
  s_waitcnt lgkmcnt(11)
  ds_read_b64_tr_b16 a[182:183], v31 offset:10752
  v_mfma_f32_16x16x32_bf16 v[224:227], a[160:163], a[32:35], v[224:227]
  ds_read_b64_tr_b16 a[144:145], v2 offset:64
  v_mfma_f32_16x16x32_bf16 v[224:227], a[164:167], a[48:51], v[224:227]
  ds_read_b64_tr_b16 a[184:185], v31 offset:32
  v_mfma_f32_16x16x32_bf16 v[228:231], a[164:167], a[52:55], v[228:231]
  ds_read_b64_tr_b16 a[146:147], v2 offset:3648
  v_mfma_f32_16x16x32_bf16 v[228:231], a[160:163], a[36:39], v[228:231]
  ds_read_b64_tr_b16 a[186:187], v31 offset:3616
  v_mfma_f32_16x16x32_bf16 v[232:235], a[160:163], a[40:43], v[232:235]
  ds_read_b64_tr_b16 a[148:149], v2 offset:7232
  v_mfma_f32_16x16x32_bf16 v[232:235], a[164:167], a[56:59], v[232:235]
  buffer_load_dwordx4 a[108:111], v0, s[36:39], s57 offen offset:3072 sc1
  v_mfma_f32_16x16x32_bf16 v[236:239], a[164:167], a[60:63], v[236:239]
  ds_read_b64_tr_b16 a[150:151], v2 offset:10816
  v_mfma_f32_16x16x32_bf16 v[236:239], a[160:163], a[44:47], v[236:239]
  ds_read_b64_tr_b16 a[188:189], v31 offset:7200
  v_mfma_f32_16x16x32_bf16 v[252:255], a[168:171], a[44:47], v[252:255]
  ds_read_b64_tr_b16 a[152:153], v2 offset:96
  v_mfma_f32_16x16x32_bf16 v[252:255], a[172:175], a[60:63], v[252:255]
  s_bfe_u32 s56, s83, 0x40000
  s_mul_i32 s56, s56, 458752
  s_add_u32 m0, s84, 0
  v_mfma_f32_16x16x32_bf16 v[248:251], a[172:175], a[56:59], v[248:251]
  ds_read_b64_tr_b16 a[154:155], v2 offset:3680
  v_mfma_f32_16x16x32_bf16 v[248:251], a[168:171], a[40:43], v[248:251]
  ds_read_b64_tr_b16 a[190:191], v31 offset:10784
  v_mfma_f32_16x16x32_bf16 v[244:247], a[168:171], a[36:39], v[244:247]
  ds_read_b64_tr_b16 a[156:157], v2 offset:7264
  v_mfma_f32_16x16x32_bf16 v[244:247], a[172:175], a[52:55], v[244:247]
  buffer_load_dwordx4 v3, s[16:19], s56 offen offset:0 lds
  v_mfma_f32_16x16x32_bf16 v[240:243], a[172:175], a[48:51], v[240:243]
  ds_read_b64_tr_b16 a[158:159], v2 offset:10848
  v_mfma_f32_16x16x32_bf16 v[240:243], a[168:171], a[32:35], v[240:243]
  s_waitcnt vmcnt(8) lgkmcnt(13)
  ds_read_b64_tr_b16 a[192:193], v31 offset:64
  v_mfma_f32_16x16x32_bf16 v[32:35], a[128:131], a[64:67], v[32:35]
  s_add_u32 s57, s57, 4096
  ds_read_b64_tr_b16 a[194:195], v31 offset:3648
  v_mfma_f32_16x16x32_bf16 v[32:35], a[132:135], a[80:83], v[32:35]
  ds_read_b64_tr_b16 a[196:197], v31 offset:7232
  v_mfma_f32_16x16x32_bf16 v[36:39], a[132:135], a[84:87], v[36:39]
  ds_read_b64_tr_b16 a[198:199], v31 offset:10816
  v_mfma_f32_16x16x32_bf16 v[36:39], a[128:131], a[68:71], v[36:39]
  ds_read_b64_tr_b16 a[200:201], v31 offset:96
  v_mfma_f32_16x16x32_bf16 v[40:43], a[128:131], a[72:75], v[40:43]
  buffer_load_dwordx4 a[112:115], v0, s[36:39], s57 offen offset:0 sc1
  v_mfma_f32_16x16x32_bf16 v[40:43], a[132:135], a[88:91], v[40:43]
  ds_read_b64_tr_b16 a[202:203], v31 offset:3680
  v_mfma_f32_16x16x32_bf16 v[44:47], a[132:135], a[92:95], v[44:47]
  ds_read_b64_tr_b16 a[204:205], v31 offset:7264
  v_mfma_f32_16x16x32_bf16 v[44:47], a[128:131], a[76:79], v[44:47]
  ds_read_b64_tr_b16 a[206:207], v31 offset:10848
  v_mfma_f32_16x16x32_bf16 v[60:63], a[136:139], a[76:79], v[60:63]
  ds_read_b64_tr_b16 a[160:161], v2 offset:128
  v_mfma_f32_16x16x32_bf16 v[60:63], a[140:143], a[92:95], v[60:63]
  v_mfma_f32_16x16x32_bf16 v[56:59], a[140:143], a[88:91], v[56:59]
  ds_read_b64_tr_b16 a[162:163], v2 offset:3712
  v_mfma_f32_16x16x32_bf16 v[56:59], a[136:139], a[72:75], v[56:59]
  buffer_load_dwordx4 v4, s[16:19], s56 offen offset:1024 lds
  v_mfma_f32_16x16x32_bf16 v[52:55], a[136:139], a[68:71], v[52:55]
  ds_read_b64_tr_b16 a[164:165], v2 offset:7296
  v_mfma_f32_16x16x32_bf16 v[52:55], a[140:143], a[84:87], v[52:55]
  v_mfma_f32_16x16x32_bf16 v[48:51], a[140:143], a[80:83], v[48:51]
  ds_read_b64_tr_b16 a[166:167], v2 offset:10880
  v_mfma_f32_16x16x32_bf16 v[48:51], a[136:139], a[64:67], v[48:51]
  s_waitcnt lgkmcnt(12)
  v_mfma_f32_16x16x32_bf16 v[64:67], a[144:147], a[64:67], v[64:67]
  ds_read_b64_tr_b16 a[168:169], v2 offset:160
  v_mfma_f32_16x16x32_bf16 v[64:67], a[148:151], a[80:83], v[64:67]
  v_mfma_f32_16x16x32_bf16 v[68:71], a[148:151], a[84:87], v[68:71]
  ds_read_b64_tr_b16 a[170:171], v2 offset:3744
  v_mfma_f32_16x16x32_bf16 v[68:71], a[144:147], a[68:71], v[68:71]
  buffer_load_dwordx4 a[116:119], v0, s[36:39], s57 offen offset:1024 sc1
  v_mfma_f32_16x16x32_bf16 v[72:75], a[144:147], a[72:75], v[72:75]
  ds_read_b64_tr_b16 a[172:173], v2 offset:7328
  v_mfma_f32_16x16x32_bf16 v[72:75], a[148:151], a[88:91], v[72:75]
  v_mfma_f32_16x16x32_bf16 v[76:79], a[148:151], a[92:95], v[76:79]
  ds_read_b64_tr_b16 a[174:175], v2 offset:10912
  v_mfma_f32_16x16x32_bf16 v[76:79], a[144:147], a[76:79], v[76:79]
  v_mfma_f32_16x16x32_bf16 v[92:95], a[152:155], a[76:79], v[92:95]
  ds_read_b64_tr_b16 a[128:129], v2 offset:192
  v_mfma_f32_16x16x32_bf16 v[92:95], a[156:159], a[92:95], v[92:95]
  v_mfma_f32_16x16x32_bf16 v[88:91], a[156:159], a[88:91], v[88:91]
  buffer_load_dwordx4 v5, s[16:19], s56 offen offset:2048 lds
  v_mfma_f32_16x16x32_bf16 v[88:91], a[152:155], a[72:75], v[88:91]
  ds_read_b64_tr_b16 a[130:131], v2 offset:3776
  v_mfma_f32_16x16x32_bf16 v[84:87], a[152:155], a[68:71], v[84:87]
  ds_read_b64_tr_b16 a[132:133], v2 offset:7360
  v_mfma_f32_16x16x32_bf16 v[84:87], a[156:159], a[84:87], v[84:87]
  v_mfma_f32_16x16x32_bf16 v[80:83], a[156:159], a[80:83], v[80:83]
  ds_read_b64_tr_b16 a[134:135], v2 offset:10944
  v_mfma_f32_16x16x32_bf16 v[80:83], a[152:155], a[64:67], v[80:83]
  s_waitcnt vmcnt(20) lgkmcnt(12)
  v_mfma_f32_16x16x32_bf16 a[216:219], a[176:179], a[208:211], 0
  ds_read_b64_tr_b16 a[136:137], v2 offset:14336
  v_mfma_f32_16x16x32_bf16 a[216:219], a[180:183], a[212:215], a[216:219]
  v_mfma_f32_16x16x32_bf16 a[220:223], a[184:187], a[208:211], 0
  buffer_load_dwordx4 a[120:123], v0, s[36:39], s57 offen offset:2048 sc1
  v_mfma_f32_16x16x32_bf16 a[220:223], a[188:191], a[212:215], a[220:223]
  ds_read_b64_tr_b16 a[138:139], v2 offset:17920
  v_mfma_f32_16x16x32_bf16 a[224:227], a[192:195], a[208:211], 0
  ds_read_b64_tr_b16 a[140:141], v2 offset:21504
  v_mfma_f32_16x16x32_bf16 a[224:227], a[196:199], a[212:215], a[224:227]
  v_mfma_f32_16x16x32_bf16 a[228:231], a[200:203], a[208:211], 0
  ds_read_b64_tr_b16 a[142:143], v2 offset:25088
  v_mfma_f32_16x16x32_bf16 a[228:231], a[204:207], a[212:215], a[228:231]
  s_waitcnt lgkmcnt(8)
  v_mfma_f32_16x16x32_bf16 v[96:99], a[160:163], a[64:67], v[96:99]
  ds_read_b64_tr_b16 a[144:145], v2 offset:14368
  v_mfma_f32_16x16x32_bf16 v[96:99], a[164:167], a[80:83], v[96:99]
  buffer_load_dwordx4 v6, s[16:19], s56 offen offset:3072 lds
  v_mfma_f32_16x16x32_bf16 v[100:103], a[164:167], a[84:87], v[100:103]
  s_lshl2_add_u32 s76, s58, s44
  ds_read_b64_tr_b16 a[146:147], v2 offset:17952
  s_lshl_b32 s76, s76, 13
  v_mfma_f32_16x16x32_bf16 v[100:103], a[160:163], a[68:71], v[100:103]
  s_add_u32 s76, s76, 262144
  s_add_u32 s77, s76, 4096
  v_mfma_f32_16x16x32_bf16 v[104:107], a[160:163], a[72:75], v[104:107]
  ds_read_b64_tr_b16 a[148:149], v2 offset:21536
  v_mfma_f32_16x16x32_bf16 v[104:107], a[164:167], a[88:91], v[104:107]
  v_mfma_f32_16x16x32_bf16 v[108:111], a[164:167], a[92:95], v[108:111]
  ds_read_b64_tr_b16 a[150:151], v2 offset:25120
  v_mfma_f32_16x16x32_bf16 v[108:111], a[160:163], a[76:79], v[108:111]
  buffer_load_dwordx4 a[176:179], v0, s[36:39], s76 offen offset:0 sc1
  v_mfma_f32_16x16x32_bf16 v[124:127], a[168:171], a[76:79], v[124:127]
  ds_read_b64_tr_b16 a[152:153], v2 offset:14400
  v_mfma_f32_16x16x32_bf16 v[124:127], a[172:175], a[92:95], v[124:127]
  v_mfma_f32_16x16x32_bf16 v[120:123], a[172:175], a[88:91], v[120:123]
  ds_read_b64_tr_b16 a[154:155], v2 offset:17984
  v_mfma_f32_16x16x32_bf16 v[120:123], a[168:171], a[72:75], v[120:123]
  v_mfma_f32_16x16x32_bf16 v[116:119], a[168:171], a[68:71], v[116:119]
  buffer_load_dwordx4 a[124:127], v0, s[36:39], s57 offen offset:3072 sc1
  s_add_u32 m0, s84, 4096
  v_mfma_f32_16x16x32_bf16 v[116:119], a[172:175], a[84:87], v[116:119]
  ds_read_b64_tr_b16 a[156:157], v2 offset:21568
  v_mfma_f32_16x16x32_bf16 v[112:115], a[172:175], a[80:83], v[112:115]
  ds_read_b64_tr_b16 a[158:159], v2 offset:25152
  v_mfma_f32_16x16x32_bf16 v[112:115], a[168:171], a[64:67], v[112:115]
  s_waitcnt lgkmcnt(8)
  v_mfma_f32_16x16x32_bf16 v[128:131], a[128:131], a[64:67], v[128:131]
  ds_read_b64_tr_b16 a[160:161], v2 offset:14432
  v_mfma_f32_16x16x32_bf16 v[128:131], a[132:135], a[80:83], v[128:131]
  buffer_load_dwordx4 v7, s[16:19], s56 offen offset:0 lds
  s_bfe_u32 s57, s83, 0x40000
  v_mfma_f32_16x16x32_bf16 v[132:135], a[132:135], a[84:87], v[132:135]
  s_lshl_b32 s57, s57, 13
  s_add_u32 s57, s57, s85
  ds_read_b64_tr_b16 a[162:163], v2 offset:18016
  v_mfma_f32_16x16x32_bf16 v[132:135], a[128:131], a[68:71], v[132:135]
  v_mfma_f32_16x16x32_bf16 v[136:139], a[128:131], a[72:75], v[136:139]
  ds_read_b64_tr_b16 a[164:165], v2 offset:21600
  v_mfma_f32_16x16x32_bf16 v[136:139], a[132:135], a[88:91], v[136:139]
  v_mfma_f32_16x16x32_bf16 v[140:143], a[132:135], a[92:95], v[140:143]
  buffer_load_dwordx4 a[0:3], v0, s[36:39], s57 offen offset:0 sc1
  v_mfma_f32_16x16x32_bf16 v[140:143], a[128:131], a[76:79], v[140:143]
  ds_read_b64_tr_b16 a[166:167], v2 offset:25184
  v_mfma_f32_16x16x32_bf16 v[156:159], a[136:139], a[76:79], v[156:159]
  ds_read_b64_tr_b16 a[168:169], v2 offset:14464
  v_mfma_f32_16x16x32_bf16 v[156:159], a[140:143], a[92:95], v[156:159]
  v_mfma_f32_16x16x32_bf16 v[152:155], a[140:143], a[88:91], v[152:155]
  ds_read_b64_tr_b16 a[170:171], v2 offset:18048
  v_mfma_f32_16x16x32_bf16 v[152:155], a[136:139], a[72:75], v[152:155]
Hb2:
  s_cbranch_execz Hb2_1
  buffer_load_dwordx4 a[180:183], v0, s[36:39], s76 offen offset:1024 sc1
  v_mfma_f32_16x16x32_bf16 v[148:151], a[136:139], a[68:71], v[148:151]
  ds_read_b64_tr_b16 a[172:173], v2 offset:21632
  v_mfma_f32_16x16x32_bf16 v[148:151], a[140:143], a[84:87], v[148:151]
  v_mfma_f32_16x16x32_bf16 v[144:147], a[140:143], a[80:83], v[144:147]
  ds_read_b64_tr_b16 a[174:175], v2 offset:25216
  v_mfma_f32_16x16x32_bf16 v[144:147], a[136:139], a[64:67], v[144:147]
  s_waitcnt lgkmcnt(8)
  v_mfma_f32_16x16x32_bf16 v[160:163], a[144:147], a[64:67], v[160:163]
  buffer_load_dwordx4 v8, s[16:19], s56 offen offset:1024 lds
  v_mfma_f32_16x16x32_bf16 v[160:163], a[148:151], a[80:83], v[160:163]
  ds_read_b64_tr_b16 a[128:129], v2 offset:14496
  v_mfma_f32_16x16x32_bf16 v[164:167], a[148:151], a[84:87], v[164:167]
  ds_read_b64_tr_b16 a[130:131], v2 offset:18080
  v_mfma_f32_16x16x32_bf16 v[164:167], a[144:147], a[68:71], v[164:167]
  v_mfma_f32_16x16x32_bf16 v[168:171], a[144:147], a[72:75], v[168:171]
  ds_read_b64_tr_b16 a[132:133], v2 offset:21664
  v_mfma_f32_16x16x32_bf16 v[168:171], a[148:151], a[88:91], v[168:171]
  buffer_load_dwordx4 a[4:7], v0, s[36:39], s57 offen offset:1024 sc1
  v_mfma_f32_16x16x32_bf16 v[172:175], a[148:151], a[92:95], v[172:175]
  ds_read_b64_tr_b16 a[134:135], v2 offset:25248
  v_mfma_f32_16x16x32_bf16 v[172:175], a[144:147], a[76:79], v[172:175]
  s_waitcnt vmcnt(16)
  s_barrier
  v_mfma_f32_16x16x32_bf16 v[188:191], a[152:155], a[76:79], v[188:191]
  ds_read_b64_tr_b16 a[136:137], v2 offset:14528
  v_mfma_f32_16x16x32_bf16 v[188:191], a[156:159], a[92:95], v[188:191]
  v_mfma_f32_16x16x32_bf16 v[184:187], a[156:159], a[88:91], v[184:187]
  ds_read_b64_tr_b16 a[138:139], v2 offset:18112
  v_mfma_f32_16x16x32_bf16 v[184:187], a[152:155], a[72:75], v[184:187]
  buffer_load_dwordx4 a[184:187], v0, s[36:39], s76 offen offset:2048 sc1
  v_mfma_f32_16x16x32_bf16 v[180:183], a[152:155], a[68:71], v[180:183]
  ds_read_b64_tr_b16 a[140:141], v2 offset:21696
  v_mfma_f32_16x16x32_bf16 v[180:183], a[156:159], a[84:87], v[180:183]
  v_mfma_f32_16x16x32_bf16 v[176:179], a[156:159], a[80:83], v[176:179]
  ds_read_b64_tr_b16 a[142:143], v2 offset:25280
  v_mfma_f32_16x16x32_bf16 v[176:179], a[152:155], a[64:67], v[176:179]
  s_waitcnt lgkmcnt(8)
  v_mfma_f32_16x16x32_bf16 v[192:195], a[160:163], a[64:67], v[192:195]
  buffer_load_dwordx4 v9, s[16:19], s56 offen offset:2048 lds
  v_mfma_f32_16x16x32_bf16 v[192:195], a[164:167], a[80:83], v[192:195]
  ds_read_b64_tr_b16 a[144:145], v2 offset:28672
  v_mfma_f32_16x16x32_bf16 v[196:199], a[164:167], a[84:87], v[196:199]
  ds_read_b64_tr_b16 a[146:147], v2 offset:32256
  v_mfma_f32_16x16x32_bf16 v[196:199], a[160:163], a[68:71], v[196:199]
  v_mfma_f32_16x16x32_bf16 v[200:203], a[160:163], a[72:75], v[200:203]
  ds_read_b64_tr_b16 a[148:149], v2 offset:35840
  v_mfma_f32_16x16x32_bf16 v[200:203], a[164:167], a[88:91], v[200:203]
  buffer_load_dwordx4 a[8:11], v0, s[36:39], s57 offen offset:2048 sc1
  v_mfma_f32_16x16x32_bf16 v[204:207], a[164:167], a[92:95], v[204:207]
  ds_read_b64_tr_b16 a[150:151], v2 offset:39424
  v_mfma_f32_16x16x32_bf16 v[204:207], a[160:163], a[76:79], v[204:207]
  v_mfma_f32_16x16x32_bf16 v[220:223], a[168:171], a[76:79], v[220:223]
  ds_read_b64_tr_b16 a[152:153], v2 offset:28704
  v_mfma_f32_16x16x32_bf16 v[220:223], a[172:175], a[92:95], v[220:223]
  buffer_load_dwordx4 a[188:191], v0, s[36:39], s76 offen offset:3072 sc1
  v_mfma_f32_16x16x32_bf16 v[216:219], a[172:175], a[88:91], v[216:219]
  ds_read_b64_tr_b16 a[154:155], v2 offset:32288
  v_mfma_f32_16x16x32_bf16 v[216:219], a[168:171], a[72:75], v[216:219]
  v_mfma_f32_16x16x32_bf16 v[212:215], a[168:171], a[68:71], v[212:215]
  ds_read_b64_tr_b16 a[156:157], v2 offset:35872
  v_mfma_f32_16x16x32_bf16 v[212:215], a[172:175], a[84:87], v[212:215]
  v_mfma_f32_16x16x32_bf16 v[208:211], a[172:175], a[80:83], v[208:211]
  buffer_load_dwordx4 a[12:15], v0, s[36:39], s57 offen offset:3072 sc1
  v_mfma_f32_16x16x32_bf16 v[208:211], a[168:171], a[64:67], v[208:211]
  s_waitcnt lgkmcnt(7)
  ds_read_b64_tr_b16 a[158:159], v2 offset:39456
  v_mfma_f32_16x16x32_bf16 v[224:227], a[128:131], a[64:67], v[224:227]
  ds_read_b64_tr_b16 a[160:161], v2 offset:28736
  v_mfma_f32_16x16x32_bf16 v[224:227], a[132:135], a[80:83], v[224:227]
  s_bfe_u32 s56, s83, 0x40004
  s_mul_i32 s56, s56, 458752
  s_add_u32 m0, s84, 28672
  v_mfma_f32_16x16x32_bf16 v[228:231], a[132:135], a[84:87], v[228:231]
  buffer_load_dwordx4 a[192:195], v0, s[36:39], s77 offen offset:0 sc1
  v_mfma_f32_16x16x32_bf16 v[228:231], a[128:131], a[68:71], v[228:231]
  ds_read_b64_tr_b16 a[162:163], v2 offset:32320
  v_mfma_f32_16x16x32_bf16 v[232:235], a[128:131], a[72:75], v[232:235]
  ds_read_b64_tr_b16 a[164:165], v2 offset:35904
  v_mfma_f32_16x16x32_bf16 v[232:235], a[132:135], a[88:91], v[232:235]
  v_mfma_f32_16x16x32_bf16 v[236:239], a[132:135], a[92:95], v[236:239]
  ds_read_b64_tr_b16 a[166:167], v2 offset:39488
  v_mfma_f32_16x16x32_bf16 v[236:239], a[128:131], a[76:79], v[236:239]
  buffer_load_dwordx4 v3, s[16:19], s56 offen offset:0 lds
  v_mfma_f32_16x16x32_bf16 v[252:255], a[136:139], a[76:79], v[252:255]
  ds_read_b64_tr_b16 a[168:169], v2 offset:28768
  v_mfma_f32_16x16x32_bf16 v[252:255], a[140:143], a[92:95], v[252:255]
  v_mfma_f32_16x16x32_bf16 v[248:251], a[140:143], a[88:91], v[248:251]
  ds_read_b64_tr_b16 a[170:171], v2 offset:32352
  v_mfma_f32_16x16x32_bf16 v[248:251], a[136:139], a[72:75], v[248:251]
  buffer_load_dwordx4 a[196:199], v0, s[36:39], s77 offen offset:1024 sc1
  v_mfma_f32_16x16x32_bf16 v[244:247], a[136:139], a[68:71], v[244:247]
  ds_read_b64_tr_b16 a[172:173], v2 offset:35936
  v_mfma_f32_16x16x32_bf16 v[244:247], a[140:143], a[84:87], v[244:247]
  v_mfma_f32_16x16x32_bf16 v[240:243], a[140:143], a[80:83], v[240:243]
  ds_read_b64_tr_b16 a[174:175], v2 offset:39520
  v_mfma_f32_16x16x32_bf16 v[240:243], a[136:139], a[64:67], v[240:243]
  s_waitcnt vmcnt(13) lgkmcnt(8)
  v_mfma_f32_16x16x32_bf16 v[32:35], a[144:147], a[96:99], v[32:35]
  s_add_u32 s57, s57, 4096
  ds_read_b64_tr_b16 a[128:129], v2 offset:28800
  v_mfma_f32_16x16x32_bf16 v[32:35], a[148:151], a[112:115], v[32:35]
  buffer_load_dwordx4 a[200:203], v0, s[36:39], s77 offen offset:2048 sc1
  v_mfma_f32_16x16x32_bf16 v[36:39], a[148:151], a[116:119], v[36:39]
  ds_read_b64_tr_b16 a[130:131], v2 offset:32384
  v_mfma_f32_16x16x32_bf16 v[36:39], a[144:147], a[100:103], v[36:39]
  v_mfma_f32_16x16x32_bf16 v[40:43], a[144:147], a[104:107], v[40:43]
  ds_read_b64_tr_b16 a[132:133], v2 offset:35968
  v_mfma_f32_16x16x32_bf16 v[40:43], a[148:151], a[120:123], v[40:43]
  v_mfma_f32_16x16x32_bf16 v[44:47], a[148:151], a[124:127], v[44:47]
  buffer_load_dwordx4 a[16:19], v0, s[36:39], s57 offen offset:0 sc1
  v_mfma_f32_16x16x32_bf16 v[44:47], a[144:147], a[108:111], v[44:47]
  ds_read_b64_tr_b16 a[134:135], v2 offset:39552
  v_mfma_f32_16x16x32_bf16 v[60:63], a[152:155], a[108:111], v[60:63]
  ds_read_b64_tr_b16 a[136:137], v2 offset:28832
  v_mfma_f32_16x16x32_bf16 v[60:63], a[156:159], a[124:127], v[60:63]
  v_mfma_f32_16x16x32_bf16 v[56:59], a[156:159], a[120:123], v[56:59]
  ds_read_b64_tr_b16 a[138:139], v2 offset:32416
  v_mfma_f32_16x16x32_bf16 v[56:59], a[152:155], a[104:107], v[56:59]
  buffer_load_dwordx4 v4, s[16:19], s56 offen offset:1024 lds
  v_mfma_f32_16x16x32_bf16 v[52:55], a[152:155], a[100:103], v[52:55]
  ds_read_b64_tr_b16 a[140:141], v2 offset:36000
  v_mfma_f32_16x16x32_bf16 v[52:55], a[156:159], a[116:119], v[52:55]
  buffer_load_dwordx4 a[204:207], v0, s[36:39], s77 offen offset:3072 sc1
  v_mfma_f32_16x16x32_bf16 v[48:51], a[156:159], a[112:115], v[48:51]
  ds_read_b64_tr_b16 a[142:143], v2 offset:39584
  v_mfma_f32_16x16x32_bf16 v[48:51], a[152:155], a[96:99], v[48:51]
  s_waitcnt lgkmcnt(8)
  v_mfma_f32_16x16x32_bf16 v[64:67], a[160:163], a[96:99], v[64:67]
  ds_read_b64_tr_b16 a[144:145], v2 offset:28864
  v_mfma_f32_16x16x32_bf16 v[64:67], a[164:167], a[112:115], v[64:67]
  v_mfma_f32_16x16x32_bf16 v[68:71], a[164:167], a[116:119], v[68:71]
  ds_read_b64_tr_b16 a[146:147], v2 offset:32448
  v_mfma_f32_16x16x32_bf16 v[68:71], a[160:163], a[100:103], v[68:71]
  buffer_load_dwordx4 a[20:23], v0, s[36:39], s57 offen offset:1024 sc1
  v_mfma_f32_16x16x32_bf16 v[72:75], a[160:163], a[104:107], v[72:75]
  ds_read_b64_tr_b16 a[148:149], v2 offset:36032
  v_mfma_f32_16x16x32_bf16 v[72:75], a[164:167], a[120:123], v[72:75]
  v_mfma_f32_16x16x32_bf16 v[76:79], a[164:167], a[124:127], v[76:79]
  ds_read_b64_tr_b16 a[150:151], v2 offset:39616
  v_mfma_f32_16x16x32_bf16 v[76:79], a[160:163], a[108:111], v[76:79]
  v_mfma_f32_16x16x32_bf16 v[92:95], a[168:171], a[108:111], v[92:95]
  ds_read_b64_tr_b16 a[152:153], v2 offset:43008
  v_mfma_f32_16x16x32_bf16 v[92:95], a[172:175], a[124:127], v[92:95]
  v_mfma_f32_16x16x32_bf16 v[88:91], a[172:175], a[120:123], v[88:91]
  buffer_load_dwordx4 v5, s[16:19], s56 offen offset:2048 lds
  v_mfma_f32_16x16x32_bf16 v[88:91], a[168:171], a[104:107], v[88:91]
  ds_read_b64_tr_b16 a[154:155], v2 offset:46592
  v_mfma_f32_16x16x32_bf16 v[84:87], a[168:171], a[100:103], v[84:87]
  ds_read_b64_tr_b16 a[156:157], v2 offset:50176
  v_mfma_f32_16x16x32_bf16 v[84:87], a[172:175], a[116:119], v[84:87]
  v_mfma_f32_16x16x32_bf16 v[80:83], a[172:175], a[112:115], v[80:83]
  ds_read_b64_tr_b16 a[158:159], v2 offset:53760
  v_mfma_f32_16x16x32_bf16 v[80:83], a[168:171], a[96:99], v[80:83]
  s_waitcnt lgkmcnt(8)
  v_mfma_f32_16x16x32_bf16 v[96:99], a[128:131], a[96:99], v[96:99]
  ds_read_b64_tr_b16 a[160:161], v2 offset:43040
  v_mfma_f32_16x16x32_bf16 v[96:99], a[132:135], a[112:115], v[96:99]
  v_mfma_f32_16x16x32_bf16 v[100:103], a[132:135], a[116:119], v[100:103]
  buffer_load_dwordx4 a[24:27], v0, s[36:39], s57 offen offset:2048 sc1
  v_mfma_f32_16x16x32_bf16 v[100:103], a[128:131], a[100:103], v[100:103]
  ds_read_b64_tr_b16 a[162:163], v2 offset:46624
  v_mfma_f32_16x16x32_bf16 v[104:107], a[128:131], a[104:107], v[104:107]
  ds_read_b64_tr_b16 a[164:165], v2 offset:50208
  v_mfma_f32_16x16x32_bf16 v[104:107], a[132:135], a[120:123], v[104:107]
  v_mfma_f32_16x16x32_bf16 v[108:111], a[132:135], a[124:127], v[108:111]
  ds_read_b64_tr_b16 a[166:167], v2 offset:53792
  v_mfma_f32_16x16x32_bf16 v[108:111], a[128:131], a[108:111], v[108:111]
  v_mfma_f32_16x16x32_bf16 v[124:127], a[136:139], a[108:111], v[124:127]
  ds_read_b64_tr_b16 a[168:169], v2 offset:43072
  v_mfma_f32_16x16x32_bf16 v[124:127], a[140:143], a[124:127], v[124:127]
  buffer_load_dwordx4 v6, s[16:19], s56 offen offset:3072 lds
  v_mfma_f32_16x16x32_bf16 v[120:123], a[140:143], a[120:123], v[120:123]
  ds_read_b64_tr_b16 a[170:171], v2 offset:46656
  v_mfma_f32_16x16x32_bf16 v[120:123], a[136:139], a[104:107], v[120:123]
  v_mfma_f32_16x16x32_bf16 v[116:119], a[136:139], a[100:103], v[116:119]
  ds_read_b64_tr_b16 a[172:173], v2 offset:50240
  v_mfma_f32_16x16x32_bf16 v[116:119], a[140:143], a[116:119], v[116:119]
  v_mfma_f32_16x16x32_bf16 v[112:115], a[140:143], a[112:115], v[112:115]
  ds_read_b64_tr_b16 a[174:175], v2 offset:53824
  v_mfma_f32_16x16x32_bf16 v[112:115], a[136:139], a[96:99], v[112:115]
  s_waitcnt lgkmcnt(8)
  v_mfma_f32_16x16x32_bf16 v[128:131], a[144:147], a[96:99], v[128:131]
  ds_read_b64_tr_b16 a[128:129], v2 offset:43104
  v_mfma_f32_16x16x32_bf16 v[128:131], a[148:151], a[112:115], v[128:131]
  buffer_load_dwordx4 a[28:31], v0, s[36:39], s57 offen offset:3072 sc1
  v_mfma_f32_16x16x32_bf16 v[132:135], a[148:151], a[116:119], v[132:135]
  ds_read_b64_tr_b16 a[130:131], v2 offset:46688
  v_mfma_f32_16x16x32_bf16 v[132:135], a[144:147], a[100:103], v[132:135]
  v_mfma_f32_16x16x32_bf16 v[136:139], a[144:147], a[104:107], v[136:139]
  s_add_u32 m0, s84, 32768
  ds_read_b64_tr_b16 a[132:133], v2 offset:50272
  v_mfma_f32_16x16x32_bf16 v[136:139], a[148:151], a[120:123], v[136:139]
  v_mfma_f32_16x16x32_bf16 v[140:143], a[148:151], a[124:127], v[140:143]
  ds_read_b64_tr_b16 a[134:135], v2 offset:53856
  v_mfma_f32_16x16x32_bf16 v[140:143], a[144:147], a[108:111], v[140:143]
  v_mfma_f32_16x16x32_bf16 v[156:159], a[152:155], a[108:111], v[156:159]
  buffer_load_dwordx4 v7, s[16:19], s56 offen offset:0 lds
  s_bfe_u32 s57, s83, 0x40004
  v_mfma_f32_16x16x32_bf16 v[156:159], a[156:159], a[124:127], v[156:159]
  s_lshl_b32 s57, s57, 13
  s_add_u32 s57, s57, s85
  ds_read_b64_tr_b16 a[136:137], v2 offset:43136
  v_mfma_f32_16x16x32_bf16 v[152:155], a[156:159], a[120:123], v[152:155]
  ds_read_b64_tr_b16 a[138:139], v2 offset:46720
  v_mfma_f32_16x16x32_bf16 v[152:155], a[152:155], a[104:107], v[152:155]
  v_mfma_f32_16x16x32_bf16 v[148:151], a[152:155], a[100:103], v[148:151]
  ds_read_b64_tr_b16 a[140:141], v2 offset:50304
  v_mfma_f32_16x16x32_bf16 v[148:151], a[156:159], a[116:119], v[148:151]
  buffer_load_dwordx4 a[32:35], v0, s[36:39], s57 offen offset:0 sc1
  v_mfma_f32_16x16x32_bf16 v[144:147], a[156:159], a[112:115], v[144:147]
  ds_read_b64_tr_b16 a[142:143], v2 offset:53888
  v_mfma_f32_16x16x32_bf16 v[144:147], a[152:155], a[96:99], v[144:147]
  s_waitcnt lgkmcnt(8)
  v_mfma_f32_16x16x32_bf16 v[160:163], a[160:163], a[96:99], v[160:163]
  s_waitcnt vmcnt(7)
  ds_read_b64_tr_b16 a[144:145], v2 offset:43168
  v_accvgpr_read_b32 v22, a176
  v_mfma_f32_16x16x32_bf16 v[160:163], a[164:167], a[112:115], v[160:163]
  v_accvgpr_read_b32 v23, a177
  v_accvgpr_read_b32 v24, a178
  v_mfma_f32_16x16x32_bf16 v[164:167], a[164:167], a[116:119], v[164:167]
  ds_read_b64_tr_b16 a[146:147], v2 offset:46752
  v_accvgpr_read_b32 v25, a179
  v_mfma_f32_16x16x32_bf16 v[164:167], a[160:163], a[100:103], v[164:167]
  v_accvgpr_read_b32 v26, a180
  v_accvgpr_read_b32 v27, a181
  v_mfma_f32_16x16x32_bf16 v[168:171], a[160:163], a[104:107], v[168:171]
  ds_read_b64_tr_b16 a[148:149], v2 offset:50336
  v_accvgpr_read_b32 v28, a182
  v_mfma_f32_16x16x32_bf16 v[168:171], a[164:167], a[120:123], v[168:171]
  v_accvgpr_read_b32 v29, a183
  v_add_f32 v22, v22, v26
  v_mfma_f32_16x16x32_bf16 v[172:175], a[164:167], a[124:127], v[172:175]
  ds_read_b64_tr_b16 a[150:151], v2 offset:53920
  v_add_f32 v23, v23, v27
  v_mfma_f32_16x16x32_bf16 v[172:175], a[160:163], a[108:111], v[172:175]
  s_waitcnt vmcnt(17)
  s_barrier
  buffer_load_dwordx4 v8, s[16:19], s56 offen offset:1024 lds
  v_add_f32 v24, v24, v28
  v_mfma_f32_16x16x32_bf16 v[188:191], a[168:171], a[108:111], v[188:191]
  ds_read_b64_tr_b16 a[152:153], v2 offset:43200
  v_add_f32 v25, v25, v29
  v_mfma_f32_16x16x32_bf16 v[188:191], a[172:175], a[124:127], v[188:191]
  v_accvgpr_read_b32 v26, a184
  v_accvgpr_read_b32 v27, a185
  v_mfma_f32_16x16x32_bf16 v[184:187], a[172:175], a[120:123], v[184:187]
  ds_read_b64_tr_b16 a[154:155], v2 offset:46784
  v_accvgpr_read_b32 v28, a186
  v_mfma_f32_16x16x32_bf16 v[184:187], a[168:171], a[104:107], v[184:187]
  v_accvgpr_read_b32 v29, a187
  v_add_f32 v22, v22, v26
  v_mfma_f32_16x16x32_bf16 v[180:183], a[168:171], a[100:103], v[180:183]
  buffer_load_dwordx4 a[36:39], v0, s[36:39], s57 offen offset:1024 sc1
  v_add_f32 v23, v23, v27
  v_mfma_f32_16x16x32_bf16 v[180:183], a[172:175], a[116:119], v[180:183]
  ds_read_b64_tr_b16 a[156:157], v2 offset:50368
  v_add_f32 v24, v24, v28
  v_mfma_f32_16x16x32_bf16 v[176:179], a[172:175], a[112:115], v[176:179]
  ds_read_b64_tr_b16 a[158:159], v2 offset:53952
  v_add_f32 v25, v25, v29
  v_mfma_f32_16x16x32_bf16 v[176:179], a[168:171], a[96:99], v[176:179]
  s_waitcnt lgkmcnt(8)
  v_accvgpr_read_b32 v26, a188
  v_accvgpr_read_b32 v27, a189
  v_mfma_f32_16x16x32_bf16 v[192:195], a[128:131], a[96:99], v[192:195]
  ds_read_b64_tr_b16 a[160:161], v1 offset:0
  v_accvgpr_read_b32 v28, a190
  v_mfma_f32_16x16x32_bf16 v[192:195], a[132:135], a[112:115], v[192:195]
  v_accvgpr_read_b32 v29, a191
  v_add_f32 v22, v22, v26
  v_mfma_f32_16x16x32_bf16 v[196:199], a[132:135], a[116:119], v[196:199]
  ds_read_b64_tr_b16 a[162:163], v1 offset:3584
  v_add_f32 v23, v23, v27
  v_mfma_f32_16x16x32_bf16 v[196:199], a[128:131], a[100:103], v[196:199]
  v_add_f32 v24, v24, v28
  v_add_f32 v25, v25, v29
  v_mfma_f32_16x16x32_bf16 v[200:203], a[128:131], a[104:107], v[200:203]
  ds_read_b64_tr_b16 a[164:165], v1 offset:7168
  v_mov_b32 v26, v22
  v_mfma_f32_16x16x32_bf16 v[200:203], a[132:135], a[120:123], v[200:203]
  v_mov_b32 v27, v23
  v_mov_b32 v28, v24
  v_mfma_f32_16x16x32_bf16 v[204:207], a[132:135], a[124:127], v[204:207]
  buffer_load_dwordx4 v9, s[16:19], s56 offen offset:2048 lds
  v_mov_b32 v29, v25
  v_mfma_f32_16x16x32_bf16 v[204:207], a[128:131], a[108:111], v[204:207]
  ds_read_b64_tr_b16 a[166:167], v1 offset:10752
  v_permlane16_swap_b32 v22, v26
  v_mfma_f32_16x16x32_bf16 v[220:223], a[136:139], a[108:111], v[220:223]
  ds_read_b64_tr_b16 a[168:169], v1 offset:32
  v_permlane16_swap_b32 v23, v27
  v_mfma_f32_16x16x32_bf16 v[220:223], a[140:143], a[124:127], v[220:223]
  v_permlane16_swap_b32 v24, v28
  v_permlane16_swap_b32 v25, v29
  v_mfma_f32_16x16x32_bf16 v[216:219], a[140:143], a[120:123], v[216:219]
  s_add_u32 s59, s59, 16384
  ds_read_b64_tr_b16 a[170:171], v1 offset:3616
  v_add_f32 v22, v22, v26
  v_mfma_f32_16x16x32_bf16 v[216:219], a[136:139], a[104:107], v[216:219]
  buffer_load_dwordx4 a[40:43], v0, s[36:39], s57 offen offset:2048 sc1
  v_add_f32 v23, v23, v27
  v_mfma_f32_16x16x32_bf16 v[212:215], a[136:139], a[100:103], v[212:215]
  ds_read_b64_tr_b16 a[172:173], v1 offset:7200
  v_add_f32 v24, v24, v28
  v_mfma_f32_16x16x32_bf16 v[212:215], a[140:143], a[116:119], v[212:215]
  v_add_f32 v25, v25, v29
  v_mov_b32 v26, v22
  v_mfma_f32_16x16x32_bf16 v[208:211], a[140:143], a[112:115], v[208:211]
  ds_read_b64_tr_b16 a[174:175], v1 offset:10784
  v_mov_b32 v27, v23
  v_mfma_f32_16x16x32_bf16 v[208:211], a[136:139], a[96:99], v[208:211]
  s_waitcnt lgkmcnt(8)
  v_mov_b32 v28, v24
  v_mov_b32 v29, v25
  v_mfma_f32_16x16x32_bf16 v[224:227], a[144:147], a[96:99], v[224:227]
  buffer_load_dwordx4 a[208:211], v0, s[36:39], s59 offen offset:0 sc1
  v_permlane32_swap_b32 v22, v26
  v_mfma_f32_16x16x32_bf16 v[224:227], a[148:151], a[112:115], v[224:227]
  ds_read_b64_tr_b16 a[128:129], v1 offset:64
  v_permlane32_swap_b32 v23, v27
  v_mfma_f32_16x16x32_bf16 v[228:231], a[148:151], a[116:119], v[228:231]
  ds_read_b64_tr_b16 a[130:131], v1 offset:3648
  v_permlane32_swap_b32 v24, v28
  v_mfma_f32_16x16x32_bf16 v[228:231], a[144:147], a[100:103], v[228:231]
  v_permlane32_swap_b32 v25, v29
  v_add_f32 v22, v22, v26
  v_mfma_f32_16x16x32_bf16 v[232:235], a[144:147], a[104:107], v[232:235]
  ds_read_b64_tr_b16 a[132:133], v1 offset:7232
  v_add_f32 v23, v23, v27
  v_mfma_f32_16x16x32_bf16 v[232:235], a[148:151], a[120:123], v[232:235]
  buffer_load_dwordx4 a[212:215], v0, s[36:39], s59 offen offset:1024 sc1
  v_add_f32 v24, v24, v28
  v_mfma_f32_16x16x32_bf16 v[236:239], a[148:151], a[124:127], v[236:239]
  ds_read_b64_tr_b16 a[134:135], v1 offset:10816
  v_add_f32 v25, v25, v29
  v_mfma_f32_16x16x32_bf16 v[236:239], a[144:147], a[108:111], v[236:239]
  v_mul_f32 v22, 0x3a800000, v22
  v_mul_f32 v23, 0x3a800000, v23
  v_mfma_f32_16x16x32_bf16 v[252:255], a[152:155], a[108:111], v[252:255]
  ds_read_b64_tr_b16 a[136:137], v1 offset:96
  v_fma_f32 v23, -v22, v22, v23
  v_mfma_f32_16x16x32_bf16 v[252:255], a[156:159], a[124:127], v[252:255]
  v_max_f32 v23, 0, v23
  v_cvt_pk_bf16_f32 v23, v23, v23
  v_mfma_f32_16x16x32_bf16 v[248:251], a[156:159], a[120:123], v[248:251]
  buffer_load_dwordx4 a[44:47], v0, s[36:39], s57 offen offset:3072 sc1
  s_bfe_u32 s56, s83, 0x40008
  v_mfma_f32_16x16x32_bf16 v[248:251], a[152:155], a[104:107], v[248:251]
  s_mul_i32 s56, s56, 458752
  s_add_u32 m0, s84, 57344
  ds_read_b64_tr_b16 a[138:139], v1 offset:3680
  v_mfma_f32_16x16x32_bf16 v[244:247], a[152:155], a[100:103], v[244:247]
  ds_read_b64_tr_b16 a[140:141], v1 offset:7264
  v_lshlrev_b32 v23, 16, v23
  v_mfma_f32_16x16x32_bf16 v[244:247], a[156:159], a[116:119], v[244:247]
  v_add_f32 v23, 0x3727c5ac, v23
  v_cvt_pk_bf16_f32 v23, v23, v23
  v_mfma_f32_16x16x32_bf16 v[240:243], a[156:159], a[112:115], v[240:243]
  ds_read_b64_tr_b16 a[142:143], v1 offset:10848
  v_lshlrev_b32 v23, 16, v23
  v_mfma_f32_16x16x32_bf16 v[240:243], a[152:155], a[96:99], v[240:243]
  s_waitcnt vmcnt(9) lgkmcnt(8)
  buffer_load_dwordx4 v3, s[16:19], s56 offen offset:0 lds
  v_mfma_f32_16x16x32_bf16 v[32:35], a[160:163], a[0:3], v[32:35]
  s_add_u32 s57, s57, 4096
  ds_read_b64_tr_b16 a[144:145], v1 offset:128
  v_mfma_f32_16x16x32_bf16 v[32:35], a[164:167], a[16:19], v[32:35]
  s_barrier
  v_sqrt_f32 v23, v23
  v_mfma_f32_16x16x32_bf16 v[36:39], a[164:167], a[20:23], v[36:39]
  s_nop 0
  ds_read_b64_tr_b16 a[146:147], v1 offset:3712
  v_cvt_pk_bf16_f32 v12, -v22, v23
  v_mfma_f32_16x16x32_bf16 v[36:39], a[160:163], a[4:7], v[36:39]
  v_and_b32 v23, 0xffff0000, v12
  v_mfma_f32_16x16x32_bf16 v[40:43], a[160:163], a[8:11], v[40:43]
  buffer_load_dwordx4 a[48:51], v0, s[36:39], s57 offen offset:0 sc1
  v_mfma_f32_16x16x32_bf16 v[40:43], a[164:167], a[24:27], v[40:43]
  ds_read_b64_tr_b16 a[148:149], v1 offset:7296
  v_mfma_f32_16x16x32_bf16 v[44:47], a[164:167], a[28:31], v[44:47]
  ds_read_b64_tr_b16 a[150:151], v1 offset:10880
  v_mfma_f32_16x16x32_bf16 v[44:47], a[160:163], a[12:15], v[44:47]
  v_rcp_f32 v10, v23
  v_mfma_f32_16x16x32_bf16 v[60:63], a[168:171], a[12:15], v[60:63]
  ds_read_b64_tr_b16 a[152:153], v1 offset:160
  v_mul_f32 v11, v23, v23
  v_mfma_f32_16x16x32_bf16 v[60:63], a[172:175], a[28:31], v[60:63]
  v_mul_f32 v10, 0xbfb8aa3b, v10
  v_mul_f32 v24, 0x3a800000, v24
  v_mfma_f32_16x16x32_bf16 v[56:59], a[172:175], a[24:27], v[56:59]
  ds_read_b64_tr_b16 a[154:155], v1 offset:3744
  v_mul_f32 v25, 0x3a800000, v25
  v_mfma_f32_16x16x32_bf16 v[56:59], a[168:171], a[8:11], v[56:59]
  buffer_load_dwordx4 v4, s[16:19], s56 offen offset:1024 lds
  v_fma_f32 v25, -v24, v24, v25
  v_mfma_f32_16x16x32_bf16 v[52:55], a[168:171], a[4:7], v[52:55]
  ds_read_b64_tr_b16 a[156:157], v1 offset:7328
  v_max_f32 v25, 0, v25
  v_mfma_f32_16x16x32_bf16 v[52:55], a[172:175], a[20:23], v[52:55]
  v_cvt_pk_bf16_f32 v25, v25, v25
  v_lshlrev_b32 v25, 16, v25
  v_mfma_f32_16x16x32_bf16 v[48:51], a[172:175], a[16:19], v[48:51]
  ds_read_b64_tr_b16 a[158:159], v1 offset:10912
  v_add_f32 v25, 0x3727c5ac, v25
  v_mfma_f32_16x16x32_bf16 v[48:51], a[168:171], a[0:3], v[48:51]
  s_waitcnt lgkmcnt(8)
  v_cvt_pk_bf16_f32 v25, v25, v25
  v_lshlrev_b32 v25, 16, v25
  v_mfma_f32_16x16x32_bf16 v[64:67], a[128:131], a[0:3], v[64:67]
  ds_read_b64_tr_b16 a[160:161], v1 offset:192
  v_mfma_f32_16x16x32_bf16 v[64:67], a[132:135], a[16:19], v[64:67]
  v_sqrt_f32 v25, v25
  v_mfma_f32_16x16x32_bf16 v[68:71], a[132:135], a[20:23], v[68:71]
  s_nop 0
  ds_read_b64_tr_b16 a[162:163], v1 offset:3776
  v_cvt_pk_bf16_f32 v15, -v24, v25
  v_mfma_f32_16x16x32_bf16 v[68:71], a[128:131], a[4:7], v[68:71]
  buffer_load_dwordx4 a[52:55], v0, s[36:39], s57 offen offset:1024 sc1
  v_and_b32 v25, 0xffff0000, v15
  v_mfma_f32_16x16x32_bf16 v[72:75], a[128:131], a[8:11], v[72:75]
  ds_read_b64_tr_b16 a[164:165], v1 offset:7360
  v_mfma_f32_16x16x32_bf16 v[72:75], a[132:135], a[24:27], v[72:75]
  v_rcp_f32 v13, v25
  v_mfma_f32_16x16x32_bf16 v[76:79], a[132:135], a[28:31], v[76:79]
  ds_read_b64_tr_b16 a[166:167], v1 offset:10944
  v_mul_f32 v14, v25, v25
  v_mfma_f32_16x16x32_bf16 v[76:79], a[128:131], a[12:15], v[76:79]
  v_mul_f32 v13, 0xbfb8aa3b, v13
  v_accvgpr_read_b32 v22, a192
  v_mfma_f32_16x16x32_bf16 v[92:95], a[136:139], a[12:15], v[92:95]
  ds_read_b64_tr_b16 a[168:169], v1 offset:14336
  v_accvgpr_read_b32 v23, a193
  v_mfma_f32_16x16x32_bf16 v[92:95], a[140:143], a[28:31], v[92:95]
  v_accvgpr_read_b32 v24, a194
  v_accvgpr_read_b32 v25, a195
  v_mfma_f32_16x16x32_bf16 v[88:91], a[140:143], a[24:27], v[88:91]
  buffer_load_dwordx4 v5, s[16:19], s56 offen offset:2048 lds
  v_accvgpr_read_b32 v26, a196
  v_mfma_f32_16x16x32_bf16 v[88:91], a[136:139], a[8:11], v[88:91]
  ds_read_b64_tr_b16 a[170:171], v1 offset:17920
  v_accvgpr_read_b32 v27, a197
  v_mfma_f32_16x16x32_bf16 v[84:87], a[136:139], a[4:7], v[84:87]
  ds_read_b64_tr_b16 a[172:173], v1 offset:21504
  v_accvgpr_read_b32 v28, a198
  v_mfma_f32_16x16x32_bf16 v[84:87], a[140:143], a[20:23], v[84:87]
  v_accvgpr_read_b32 v29, a199
  v_add_f32 v22, v22, v26
  v_mfma_f32_16x16x32_bf16 v[80:83], a[140:143], a[16:19], v[80:83]
  ds_read_b64_tr_b16 a[174:175], v1 offset:25088
  v_add_f32 v23, v23, v27
  v_mfma_f32_16x16x32_bf16 v[80:83], a[136:139], a[0:3], v[80:83]
  s_waitcnt lgkmcnt(8)
  v_add_f32 v24, v24, v28
  v_add_f32 v25, v25, v29
  v_mfma_f32_16x16x32_bf16 v[96:99], a[144:147], a[0:3], v[96:99]
  ds_read_b64_tr_b16 a[128:129], v1 offset:14368
  v_accvgpr_read_b32 v26, a200
  v_mfma_f32_16x16x32_bf16 v[96:99], a[148:151], a[16:19], v[96:99]
  v_accvgpr_read_b32 v27, a201
  v_accvgpr_read_b32 v28, a202
  v_mfma_f32_16x16x32_bf16 v[100:103], a[148:151], a[20:23], v[100:103]
  buffer_load_dwordx4 a[56:59], v0, s[36:39], s57 offen offset:2048 sc1
  v_accvgpr_read_b32 v29, a203
  v_mfma_f32_16x16x32_bf16 v[100:103], a[144:147], a[4:7], v[100:103]
  ds_read_b64_tr_b16 a[130:131], v1 offset:17952
  v_add_f32 v22, v22, v26
  v_mfma_f32_16x16x32_bf16 v[104:107], a[144:147], a[8:11], v[104:107]
  ds_read_b64_tr_b16 a[132:133], v1 offset:21536
  v_add_f32 v23, v23, v27
  v_mfma_f32_16x16x32_bf16 v[104:107], a[148:151], a[24:27], v[104:107]
  v_add_f32 v24, v24, v28
  v_add_f32 v25, v25, v29
  v_mfma_f32_16x16x32_bf16 v[108:111], a[148:151], a[28:31], v[108:111]
  ds_read_b64_tr_b16 a[134:135], v1 offset:25120
  v_accvgpr_read_b32 v26, a204
  v_mfma_f32_16x16x32_bf16 v[108:111], a[144:147], a[12:15], v[108:111]
  v_accvgpr_read_b32 v27, a205
  v_accvgpr_read_b32 v28, a206
  v_mfma_f32_16x16x32_bf16 v[124:127], a[152:155], a[12:15], v[124:127]
  ds_read_b64_tr_b16 a[136:137], v1 offset:14400
  v_accvgpr_read_b32 v29, a207
  v_mfma_f32_16x16x32_bf16 v[124:127], a[156:159], a[28:31], v[124:127]
  buffer_load_dwordx4 v6, s[16:19], s56 offen offset:3072 lds
  v_add_f32 v22, v22, v26
  v_mfma_f32_16x16x32_bf16 v[120:123], a[156:159], a[24:27], v[120:123]
  ds_read_b64_tr_b16 a[138:139], v1 offset:17984
  v_add_f32 v23, v23, v27
  v_mfma_f32_16x16x32_bf16 v[120:123], a[152:155], a[8:11], v[120:123]
  v_add_f32 v24, v24, v28
  v_add_f32 v25, v25, v29
  v_mfma_f32_16x16x32_bf16 v[116:119], a[152:155], a[4:7], v[116:119]
  ds_read_b64_tr_b16 a[140:141], v1 offset:21568
  v_mov_b32 v26, v22
  v_mfma_f32_16x16x32_bf16 v[116:119], a[156:159], a[20:23], v[116:119]
  v_mov_b32 v27, v23
  v_mov_b32 v28, v24
  v_mfma_f32_16x16x32_bf16 v[112:115], a[156:159], a[16:19], v[112:115]
  ds_read_b64_tr_b16 a[142:143], v1 offset:25152
  v_mov_b32 v29, v25
  v_mfma_f32_16x16x32_bf16 v[112:115], a[152:155], a[0:3], v[112:115]
  s_waitcnt lgkmcnt(8)
  v_permlane16_swap_b32 v22, v26
  v_permlane16_swap_b32 v23, v27
  v_mfma_f32_16x16x32_bf16 v[128:131], a[160:163], a[0:3], v[128:131]
  ds_read_b64_tr_b16 a[144:145], v1 offset:14432
  v_permlane16_swap_b32 v24, v28
  v_mfma_f32_16x16x32_bf16 v[128:131], a[164:167], a[16:19], v[128:131]
  buffer_load_dwordx4 a[60:63], v0, s[36:39], s57 offen offset:3072 sc1
  v_permlane16_swap_b32 v25, v29
  v_mfma_f32_16x16x32_bf16 v[132:135], a[164:167], a[20:23], v[132:135]
  s_add_u32 m0, s84, 61440
  ds_read_b64_tr_b16 a[146:147], v1 offset:18016
  v_add_f32 v22, v22, v26
  v_mfma_f32_16x16x32_bf16 v[132:135], a[160:163], a[4:7], v[132:135]
  v_add_f32 v23, v23, v27
  v_add_f32 v24, v24, v28
  v_mfma_f32_16x16x32_bf16 v[136:139], a[160:163], a[8:11], v[136:139]
  ds_read_b64_tr_b16 a[148:149], v1 offset:21600
  v_add_f32 v25, v25, v29
  v_mfma_f32_16x16x32_bf16 v[136:139], a[164:167], a[24:27], v[136:139]
  v_mov_b32 v26, v22
  v_mov_b32 v27, v23
  v_mfma_f32_16x16x32_bf16 v[140:143], a[164:167], a[28:31], v[140:143]
  buffer_load_dwordx4 v7, s[16:19], s56 offen offset:0 lds
  s_bfe_u32 s57, s83, 0x40008
  v_mfma_f32_16x16x32_bf16 v[140:143], a[160:163], a[12:15], v[140:143]
  s_lshl_b32 s57, s57, 13
  s_add_u32 s57, s57, s85
  ds_read_b64_tr_b16 a[150:151], v1 offset:25184
  v_mfma_f32_16x16x32_bf16 v[156:159], a[168:171], a[12:15], v[156:159]
  ds_read_b64_tr_b16 a[152:153], v1 offset:14464
  v_mov_b32 v28, v24
  v_mfma_f32_16x16x32_bf16 v[156:159], a[172:175], a[28:31], v[156:159]
  v_mov_b32 v29, v25
  v_permlane32_swap_b32 v22, v26
  v_mfma_f32_16x16x32_bf16 v[152:155], a[172:175], a[24:27], v[152:155]
  ds_read_b64_tr_b16 a[154:155], v1 offset:18048
  v_permlane32_swap_b32 v23, v27
  v_mfma_f32_16x16x32_bf16 v[152:155], a[168:171], a[8:11], v[152:155]
  buffer_load_dwordx4 a[64:67], v0, s[36:39], s57 offen offset:0 sc1
  v_permlane32_swap_b32 v24, v28
  v_mfma_f32_16x16x32_bf16 v[148:151], a[168:171], a[4:7], v[148:151]
  ds_read_b64_tr_b16 a[156:157], v1 offset:21632
  v_permlane32_swap_b32 v25, v29
  v_mfma_f32_16x16x32_bf16 v[148:151], a[172:175], a[20:23], v[148:151]
  v_add_f32 v22, v22, v26
  v_add_f32 v23, v23, v27
  v_mfma_f32_16x16x32_bf16 v[144:147], a[172:175], a[16:19], v[144:147]
  ds_read_b64_tr_b16 a[158:159], v1 offset:25216
  v_add_f32 v24, v24, v28
  v_mfma_f32_16x16x32_bf16 v[144:147], a[168:171], a[0:3], v[144:147]
  s_waitcnt lgkmcnt(8)
  v_add_f32 v25, v25, v29
  v_mul_f32 v22, 0x3a800000, v22
  v_mfma_f32_16x16x32_bf16 v[160:163], a[128:131], a[0:3], v[160:163]
  ds_read_b64_tr_b16 a[160:161], v1 offset:14496
  v_mul_f32 v23, 0x3a800000, v23
  v_mfma_f32_16x16x32_bf16 v[160:163], a[132:135], a[16:19], v[160:163]
  v_fma_f32 v23, -v22, v22, v23
  v_max_f32 v23, 0, v23
  v_mfma_f32_16x16x32_bf16 v[164:167], a[132:135], a[20:23], v[164:167]
  buffer_load_dwordx4 v8, s[16:19], s56 offen offset:1024 lds
  v_cvt_pk_bf16_f32 v23, v23, v23
  v_mfma_f32_16x16x32_bf16 v[164:167], a[128:131], a[4:7], v[164:167]
  ds_read_b64_tr_b16 a[162:163], v1 offset:18080
  v_lshlrev_b32 v23, 16, v23
  v_mfma_f32_16x16x32_bf16 v[168:171], a[128:131], a[8:11], v[168:171]
Hb0_1:
  s_cbranch_execz Hb0_2
  ds_read_b64_tr_b16 a[164:165], v1 offset:21664
  v_add_f32 v23, 0x3727c5ac, v23
  v_mfma_f32_16x16x32_bf16 v[168:171], a[132:135], a[24:27], v[168:171]
  v_cvt_pk_bf16_f32 v23, v23, v23
  v_lshlrev_b32 v23, 16, v23
  v_mfma_f32_16x16x32_bf16 v[172:175], a[132:135], a[28:31], v[172:175]
  ds_read_b64_tr_b16 a[166:167], v1 offset:25248
  v_mfma_f32_16x16x32_bf16 v[172:175], a[128:131], a[12:15], v[172:175]
  s_waitcnt vmcnt(15)
  s_barrier
  buffer_load_dwordx4 a[68:71], v0, s[36:39], s57 offen offset:1024 sc1
  v_mfma_f32_16x16x32_bf16 v[188:191], a[136:139], a[12:15], v[188:191]
  ds_read_b64_tr_b16 a[168:169], v1 offset:14528
  v_mfma_f32_16x16x32_bf16 v[188:191], a[140:143], a[28:31], v[188:191]
  v_sqrt_f32 v23, v23
  v_mfma_f32_16x16x32_bf16 v[184:187], a[140:143], a[24:27], v[184:187]
  s_nop 0
  ds_read_b64_tr_b16 a[170:171], v1 offset:18112
  v_cvt_pk_bf16_f32 v18, -v22, v23
  v_mfma_f32_16x16x32_bf16 v[184:187], a[136:139], a[8:11], v[184:187]
  v_and_b32 v23, 0xffff0000, v18
  v_mfma_f32_16x16x32_bf16 v[180:183], a[136:139], a[4:7], v[180:183]
  ds_read_b64_tr_b16 a[172:173], v1 offset:21696
  v_mfma_f32_16x16x32_bf16 v[180:183], a[140:143], a[20:23], v[180:183]
  v_rcp_f32 v16, v23
  v_mfma_f32_16x16x32_bf16 v[176:179], a[140:143], a[16:19], v[176:179]
  buffer_load_dwordx4 v9, s[16:19], s56 offen offset:2048 lds
  v_mul_f32 v17, v23, v23
  v_mfma_f32_16x16x32_bf16 v[176:179], a[136:139], a[0:3], v[176:179]
  s_waitcnt lgkmcnt(7)
  ds_read_b64_tr_b16 a[174:175], v1 offset:25280
  v_mul_f32 v16, 0xbfb8aa3b, v16
  v_mfma_f32_16x16x32_bf16 v[192:195], a[144:147], a[0:3], v[192:195]
  ds_read_b64_tr_b16 a[128:129], v1 offset:28672
  v_mul_f32 v24, 0x3a800000, v24
  v_mfma_f32_16x16x32_bf16 v[192:195], a[148:151], a[16:19], v[192:195]
  v_mul_f32 v25, 0x3a800000, v25
  v_fma_f32 v25, -v24, v24, v25
  v_mfma_f32_16x16x32_bf16 v[196:199], a[148:151], a[20:23], v[196:199]
  ds_read_b64_tr_b16 a[130:131], v1 offset:32256
  v_max_f32 v25, 0, v25
  v_mfma_f32_16x16x32_bf16 v[196:199], a[144:147], a[4:7], v[196:199]
  v_cvt_pk_bf16_f32 v25, v25, v25
  v_lshlrev_b32 v25, 16, v25
  v_mfma_f32_16x16x32_bf16 v[200:203], a[144:147], a[8:11], v[200:203]
  ds_read_b64_tr_b16 a[132:133], v1 offset:35840
  v_add_f32 v25, 0x3727c5ac, v25
  v_mfma_f32_16x16x32_bf16 v[200:203], a[148:151], a[24:27], v[200:203]
  v_cvt_pk_bf16_f32 v25, v25, v25
  v_lshlrev_b32 v25, 16, v25
  v_mfma_f32_16x16x32_bf16 v[204:207], a[148:151], a[28:31], v[204:207]
  buffer_load_dwordx4 a[72:75], v0, s[36:39], s57 offen offset:2048 sc1
  v_mfma_f32_16x16x32_bf16 v[204:207], a[144:147], a[12:15], v[204:207]
  ds_read_b64_tr_b16 a[134:135], v1 offset:39424
  v_mfma_f32_16x16x32_bf16 v[220:223], a[152:155], a[12:15], v[220:223]
  ds_read_b64_tr_b16 a[136:137], v1 offset:28704
  v_mfma_f32_16x16x32_bf16 v[220:223], a[156:159], a[28:31], v[220:223]
  v_sqrt_f32 v25, v25
  v_mfma_f32_16x16x32_bf16 v[216:219], a[156:159], a[24:27], v[216:219]
  s_nop 0
  ds_read_b64_tr_b16 a[138:139], v1 offset:32288
  v_cvt_pk_bf16_f32 v21, -v24, v25
  v_mfma_f32_16x16x32_bf16 v[216:219], a[152:155], a[8:11], v[216:219]
  v_and_b32 v25, 0xffff0000, v21
  v_mfma_f32_16x16x32_bf16 v[212:215], a[152:155], a[4:7], v[212:215]
  s_bfe_u32 s56, s83, 0x4000c
  s_mul_i32 s56, s56, 458752
  s_add_u32 m0, s84, 86016
  v_mfma_f32_16x16x32_bf16 v[212:215], a[156:159], a[20:23], v[212:215]
  ds_read_b64_tr_b16 a[140:141], v1 offset:35872
  v_mfma_f32_16x16x32_bf16 v[208:211], a[156:159], a[16:19], v[208:211]
  ds_read_b64_tr_b16 a[142:143], v1 offset:39456
  v_mfma_f32_16x16x32_bf16 v[208:211], a[152:155], a[0:3], v[208:211]
  s_waitcnt lgkmcnt(8)
  v_rcp_f32 v19, v25
  v_mfma_f32_16x16x32_bf16 v[224:227], a[160:163], a[0:3], v[224:227]
  buffer_load_dwordx4 v3, s[16:19], s56 offen offset:0 lds
  v_mul_f32 v20, v25, v25
  v_mfma_f32_16x16x32_bf16 v[224:227], a[164:167], a[16:19], v[224:227]
  v_mul_f32 v19, 0xbfb8aa3b, v19
  v_add_u32 v31, -28672, v31
  v_mfma_f32_16x16x32_bf16 v[228:231], a[164:167], a[20:23], v[228:231]
  ds_read_b64_tr_b16 a[176:177], v31 offset:0
  v_mfma_f32_16x16x32_bf16 v[228:231], a[160:163], a[4:7], v[228:231]
  ds_read_b64_tr_b16 a[178:179], v31 offset:3584
  v_mfma_f32_16x16x32_bf16 v[232:235], a[160:163], a[8:11], v[232:235]
  ds_read_b64_tr_b16 a[180:181], v31 offset:7168
  v_mfma_f32_16x16x32_bf16 v[232:235], a[164:167], a[24:27], v[232:235]
  buffer_load_dwordx4 a[76:79], v0, s[36:39], s57 offen offset:3072 sc1
  v_mfma_f32_16x16x32_bf16 v[236:239], a[164:167], a[28:31], v[236:239]
  ds_read_b64_tr_b16 a[182:183], v31 offset:10752
  v_mfma_f32_16x16x32_bf16 v[236:239], a[160:163], a[12:15], v[236:239]
  ds_read_b64_tr_b16 a[184:185], v31 offset:32
  v_mfma_f32_16x16x32_bf16 v[252:255], a[168:171], a[12:15], v[252:255]
  ds_read_b64_tr_b16 a[144:145], v1 offset:28736
  v_mfma_f32_16x16x32_bf16 v[252:255], a[172:175], a[28:31], v[252:255]
  ds_read_b64_tr_b16 a[186:187], v31 offset:3616
  v_mfma_f32_16x16x32_bf16 v[248:251], a[172:175], a[24:27], v[248:251]
  ds_read_b64_tr_b16 a[146:147], v1 offset:32320
  v_mfma_f32_16x16x32_bf16 v[248:251], a[168:171], a[8:11], v[248:251]
  ds_read_b64_tr_b16 a[188:189], v31 offset:7200
  v_mfma_f32_16x16x32_bf16 v[244:247], a[168:171], a[4:7], v[244:247]
  buffer_load_dwordx4 v4, s[16:19], s56 offen offset:1024 lds
  v_mfma_f32_16x16x32_bf16 v[244:247], a[172:175], a[20:23], v[244:247]
  ds_read_b64_tr_b16 a[148:149], v1 offset:35904
  v_mfma_f32_16x16x32_bf16 v[240:243], a[172:175], a[16:19], v[240:243]
  s_add_u32 s57, s57, 4096
  ds_read_b64_tr_b16 a[150:151], v1 offset:39488
  v_mfma_f32_16x16x32_bf16 v[240:243], a[168:171], a[0:3], v[240:243]
  s_waitcnt vmcnt(9) lgkmcnt(11)
  ds_read_b64_tr_b16 a[190:191], v31 offset:10784
  v_mfma_f32_16x16x32_bf16 v[32:35], a[128:131], a[32:35], v[32:35]
  ds_read_b64_tr_b16 a[152:153], v1 offset:28768
  v_mfma_f32_16x16x32_bf16 v[32:35], a[132:135], a[48:51], v[32:35]
  s_barrier
  ds_read_b64_tr_b16 a[192:193], v31 offset:64
  v_mfma_f32_16x16x32_bf16 v[36:39], a[132:135], a[52:55], v[36:39]
  buffer_load_dwordx4 a[80:83], v0, s[36:39], s57 offen offset:0 sc1
  v_mfma_f32_16x16x32_bf16 v[36:39], a[128:131], a[36:39], v[36:39]
  ds_read_b64_tr_b16 a[154:155], v1 offset:32352
  v_mfma_f32_16x16x32_bf16 v[40:43], a[128:131], a[40:43], v[40:43]
  ds_read_b64_tr_b16 a[156:157], v1 offset:35936
  v_mfma_f32_16x16x32_bf16 v[40:43], a[132:135], a[56:59], v[40:43]
  ds_read_b64_tr_b16 a[194:195], v31 offset:3648
  v_mfma_f32_16x16x32_bf16 v[44:47], a[132:135], a[60:63], v[44:47]
  ds_read_b64_tr_b16 a[196:197], v31 offset:7232
  ds_read_b64_tr_b16 a[198:199], v31 offset:10816
  ds_read_b64_tr_b16 a[200:201], v31 offset:96
  ds_read_b64_tr_b16 a[202:203], v31 offset:3680
  ds_read_b64_tr_b16 a[204:205], v31 offset:7264
  ds_read_b64_tr_b16 a[206:207], v31 offset:10848
  v_mfma_f32_16x16x32_bf16 v[44:47], a[128:131], a[44:47], v[44:47]
  ds_read_b64_tr_b16 a[158:159], v1 offset:39520
  v_lshrrev_b32 v22, 4, v0
  v_mfma_f32_16x16x32_bf16 v[60:63], a[136:139], a[44:47], v[60:63]
  buffer_load_dwordx4 v5, s[16:19], s56 offen offset:2048 lds
  v_and_b32 v23, 14, v22
  v_mfma_f32_16x16x32_bf16 v[60:63], a[140:143], a[60:63], v[60:63]
  ds_read_b64_tr_b16 a[160:161], v1 offset:28800
  v_lshlrev_b32 v23, 27, v23
  v_mfma_f32_16x16x32_bf16 v[56:59], a[140:143], a[56:59], v[56:59]
  ds_read_b64_tr_b16 a[162:163], v1 offset:32384
  v_and_b32 v24, 1, v22
  v_mfma_f32_16x16x32_bf16 v[56:59], a[136:139], a[40:43], v[56:59]
  v_lshl_add_u32 v23, v24, 9, v23
  v_and_b32 v22, 0x30, v22
  v_mfma_f32_16x16x32_bf16 v[52:55], a[136:139], a[36:39], v[52:55]
  ds_read_b64_tr_b16 a[164:165], v1 offset:35968
  v_add_u32 v22, v22, v23
  v_mfma_f32_16x16x32_bf16 v[52:55], a[140:143], a[52:55], v[52:55]
  s_lshl3_add_u32 s76, s60, s58
  buffer_load_dwordx4 a[84:87], v0, s[36:39], s57 offen offset:1024 sc1
  s_lshr_b32 s77, s44, 1
  v_mfma_f32_16x16x32_bf16 v[48:51], a[140:143], a[48:51], v[48:51]
  s_lshl1_add_u32 s76, s76, s77
  ds_read_b64_tr_b16 a[166:167], v1 offset:39552
  s_and_b32 s77, s44, 1
  v_mfma_f32_16x16x32_bf16 v[48:51], a[136:139], a[32:35], v[48:51]
  s_waitcnt vmcnt(21) lgkmcnt(5)
  s_lshl2_add_u32 s76, s76, s77
  s_lshl_b32 s76, s76, 8
  v_mfma_f32_16x16x32_bf16 a[216:219], a[176:179], a[208:211], a[216:219]
  s_add_u32 s76, s76, 524288
  ds_read_b64_tr_b16 a[168:169], v1 offset:28832
  v_mfma_f32_16x16x32_bf16 a[216:219], a[180:183], a[212:215], a[216:219]
  v_mfma_f32_16x16x32_bf16 a[220:223], a[184:187], a[208:211], a[220:223]
  ds_read_b64_tr_b16 a[170:171], v1 offset:32416
  v_mfma_f32_16x16x32_bf16 a[220:223], a[188:191], a[212:215], a[220:223]
  v_mfma_f32_16x16x32_bf16 a[224:227], a[192:195], a[208:211], a[224:227]
  buffer_load_dwordx4 v6, s[16:19], s56 offen offset:3072 lds
  v_mfma_f32_16x16x32_bf16 a[224:227], a[196:199], a[212:215], a[224:227]
  ds_read_b64_tr_b16 a[172:173], v1 offset:36000
  v_mfma_f32_16x16x32_bf16 a[228:231], a[200:203], a[208:211], a[228:231]
  ds_read_b64_tr_b16 a[174:175], v1 offset:39584
  v_mfma_f32_16x16x32_bf16 a[228:231], a[204:207], a[212:215], a[228:231]
  s_waitcnt lgkmcnt(8)
  v_mfma_f32_16x16x32_bf16 v[64:67], a[144:147], a[32:35], v[64:67]
  ds_read_b64_tr_b16 a[128:129], v1 offset:28864
  v_mfma_f32_16x16x32_bf16 v[64:67], a[148:151], a[48:51], v[64:67]
  buffer_load_dwordx4 a[88:91], v0, s[36:39], s57 offen offset:2048 sc1
  v_mfma_f32_16x16x32_bf16 v[68:71], a[148:151], a[52:55], v[68:71]
  ds_read_b64_tr_b16 a[130:131], v1 offset:32448
  v_mfma_f32_16x16x32_bf16 v[68:71], a[144:147], a[36:39], v[68:71]
  s_add_u32 m0, s84, 90112
  v_mfma_f32_16x16x32_bf16 v[72:75], a[144:147], a[40:43], v[72:75]
  ds_read_b64_tr_b16 a[132:133], v1 offset:36032
  v_mfma_f32_16x16x32_bf16 v[72:75], a[148:151], a[56:59], v[72:75]
  v_mfma_f32_16x16x32_bf16 v[76:79], a[148:151], a[60:63], v[76:79]
  ds_read_b64_tr_b16 a[134:135], v1 offset:39616
  v_mfma_f32_16x16x32_bf16 v[76:79], a[144:147], a[44:47], v[76:79]
  buffer_load_dwordx4 v7, s[16:19], s56 offen offset:0 lds
  v_mfma_f32_16x16x32_bf16 v[92:95], a[152:155], a[44:47], v[92:95]
  ds_read_b64_tr_b16 a[136:137], v1 offset:43008
  v_mfma_f32_16x16x32_bf16 v[92:95], a[156:159], a[60:63], v[92:95]
  v_mfma_f32_16x16x32_bf16 v[88:91], a[156:159], a[56:59], v[88:91]
  ds_read_b64_tr_b16 a[138:139], v1 offset:46592
  v_mfma_f32_16x16x32_bf16 v[88:91], a[152:155], a[40:43], v[88:91]
  v_mfma_f32_16x16x32_bf16 v[84:87], a[152:155], a[36:39], v[84:87]
  buffer_load_dwordx4 a[92:95], v0, s[36:39], s57 offen offset:3072 sc1
  s_bfe_u32 s57, s83, 0x4000c
  v_mfma_f32_16x16x32_bf16 v[84:87], a[156:159], a[52:55], v[84:87]
  s_lshl_b32 s57, s57, 13
  s_add_u32 s57, s57, s85
  ds_read_b64_tr_b16 a[140:141], v1 offset:50176
  v_mfma_f32_16x16x32_bf16 v[80:83], a[156:159], a[48:51], v[80:83]
  ds_read_b64_tr_b16 a[142:143], v1 offset:53760
  v_mfma_f32_16x16x32_bf16 v[80:83], a[152:155], a[32:35], v[80:83]
  s_waitcnt lgkmcnt(8)
  v_mfma_f32_16x16x32_bf16 v[96:99], a[160:163], a[32:35], v[96:99]
  ds_read_b64_tr_b16 a[144:145], v1 offset:43040
  v_mfma_f32_16x16x32_bf16 v[96:99], a[164:167], a[48:51], v[96:99]
  buffer_load_dwordx4 a[96:99], v0, s[36:39], s57 offen offset:0 sc1
  v_mfma_f32_16x16x32_bf16 v[100:103], a[164:167], a[52:55], v[100:103]
  buffer_store_dwordx4 a[216:219], v22, s[36:39], s76 offen offset:0 sc1
  v_mfma_f32_16x16x32_bf16 v[100:103], a[160:163], a[36:39], v[100:103]
  ds_read_b64_tr_b16 a[146:147], v1 offset:46624
  v_mfma_f32_16x16x32_bf16 v[104:107], a[160:163], a[40:43], v[104:107]
  ds_read_b64_tr_b16 a[148:149], v1 offset:50208
  v_mfma_f32_16x16x32_bf16 v[104:107], a[164:167], a[56:59], v[104:107]
  v_mfma_f32_16x16x32_bf16 v[108:111], a[164:167], a[60:63], v[108:111]
  buffer_store_dwordx4 a[220:223], v22, s[36:39], s76 offen offset:64 sc1
  v_mfma_f32_16x16x32_bf16 v[108:111], a[160:163], a[44:47], v[108:111]
  ds_read_b64_tr_b16 a[150:151], v1 offset:53792
  v_mfma_f32_16x16x32_bf16 v[124:127], a[168:171], a[44:47], v[124:127]
  ds_read_b64_tr_b16 a[152:153], v1 offset:43072
  v_mfma_f32_16x16x32_bf16 v[124:127], a[172:175], a[60:63], v[124:127]
  v_mfma_f32_16x16x32_bf16 v[120:123], a[172:175], a[56:59], v[120:123]
  buffer_store_dwordx4 a[224:227], v22, s[36:39], s76 offen offset:128 sc1
  v_mfma_f32_16x16x32_bf16 v[120:123], a[168:171], a[40:43], v[120:123]
  ds_read_b64_tr_b16 a[154:155], v1 offset:46656
  v_mfma_f32_16x16x32_bf16 v[116:119], a[168:171], a[36:39], v[116:119]
  ds_read_b64_tr_b16 a[156:157], v1 offset:50240
  v_mfma_f32_16x16x32_bf16 v[116:119], a[172:175], a[52:55], v[116:119]
  v_mfma_f32_16x16x32_bf16 v[112:115], a[172:175], a[48:51], v[112:115]
  buffer_store_dwordx4 a[228:231], v22, s[36:39], s76 offen offset:192 sc1
  s_lshl_b32 s77, s60, 14
  v_mfma_f32_16x16x32_bf16 v[112:115], a[168:171], a[32:35], v[112:115]
  s_waitcnt lgkmcnt(7)
  ds_read_b64_tr_b16 a[158:159], v1 offset:53824
  s_lshl_b32 s78, s44, 9
  v_mfma_f32_16x16x32_bf16 v[128:131], a[128:131], a[32:35], v[128:131]
  s_add_u32 s77, s77, s78
  ds_read_b64_tr_b16 a[160:161], v1 offset:43104
  s_add_u32 s77, s77, 524288
  v_mfma_f32_16x16x32_bf16 v[128:131], a[132:135], a[48:51], v[128:131]
  s_lshr_b32 s78, s44, 1
  s_lshl_b32 s78, s78, 8
  s_and_b32 s65, s44, 1
  v_mfma_f32_16x16x32_bf16 v[132:135], a[132:135], a[52:55], v[132:135]
  s_add_u32 s78, s78, s65
  ds_read_b64_tr_b16 a[162:163], v1 offset:46688
  s_lshl3_add_u32 s78, s78, 159744
  v_mfma_f32_16x16x32_bf16 v[132:135], a[128:131], a[36:39], v[132:135]
  buffer_load_dwordx4 v8, s[16:19], s56 offen offset:1024 lds
  v_and_b32 v24, 0x1f0, v0
  v_mfma_f32_16x16x32_bf16 v[136:139], a[128:131], a[40:43], v[136:139]
  ds_read_b64_tr_b16 a[164:165], v1 offset:50272
  v_min_u32 v24, 432, v24
  v_mfma_f32_16x16x32_bf16 v[136:139], a[132:135], a[56:59], v[136:139]
  v_and_b32 v26, 0x200, v0
  v_lshl_add_u32 v25, v26, 4, v24
  v_mfma_f32_16x16x32_bf16 v[140:143], a[132:135], a[60:63], v[140:143]
  ds_read_b64_tr_b16 a[166:167], v1 offset:53856
  v_lshrrev_b32 v26, 4, v26
  v_mfma_f32_16x16x32_bf16 v[140:143], a[128:131], a[44:47], v[140:143]
  v_lshl_add_u32 v24, v24, 2, v26
  v_add_u32 v24, s78, v24
  v_mfma_f32_16x16x32_bf16 v[156:159], a[136:139], a[44:47], v[156:159]
  s_lshl2_add_u32 s65, s58, s44
  buffer_load_dwordx4 a[100:103], v0, s[36:39], s57 offen offset:1024 sc1
  s_lshl_b32 s65, s65, 19
  v_mfma_f32_16x16x32_bf16 v[156:159], a[140:143], a[60:63], v[156:159]
  s_mul_i32 s66, s60, 7
  ds_read_b64_tr_b16 a[168:169], v1 offset:43136
  s_and_b32 s78, s60, 1
  v_mfma_f32_16x16x32_bf16 v[152:155], a[140:143], a[56:59], v[152:155]
  s_add_u32 s66, s66, s78
  ds_read_b64_tr_b16 a[170:171], v1 offset:46720
  s_lshl_b32 s66, s66, 10
  v_mfma_f32_16x16x32_bf16 v[152:155], a[136:139], a[40:43], v[152:155]
  s_add_u32 s65, s65, s66
  s_add_u32 s67, s65, 19922944
  s_mul_i32 s78, s78, 8184
  v_mfma_f32_16x16x32_bf16 v[148:151], a[136:139], a[36:39], v[148:151]
  s_sub_u32 s65, s67, s78
  ds_read_b64_tr_b16 a[172:173], v1 offset:50304
  s_add_u32 s65, s65, 6144
  v_mfma_f32_16x16x32_bf16 v[148:151], a[140:143], a[52:55], v[148:151]
  s_add_u32 s66, s65, 262144
  buffer_load_dwordx4 v9, s[16:19], s56 offen offset:2048 lds
  s_lshl_b32 s45, s2, 7
  v_mfma_f32_16x16x32_bf16 v[144:147], a[140:143], a[48:51], v[144:147]
  s_add_u32 s45, s45, 5373952
  ds_read_b64_tr_b16 a[174:175], v1 offset:53888
  s_cmp_eq_u32 s44, 0
  v_mfma_f32_16x16x32_bf16 v[144:147], a[136:139], a[32:35], v[144:147]
  s_waitcnt lgkmcnt(8)
  s_cselect_b32 s45, s45, 1073741824
  s_add_u32 s76, s77, 4096
  v_mfma_f32_16x16x32_bf16 v[160:163], a[144:147], a[32:35], v[160:163]
  ds_read_b64_tr_b16 a[128:129], v1 offset:43168
  v_mfma_f32_16x16x32_bf16 v[160:163], a[148:151], a[48:51], v[160:163]
  v_mfma_f32_16x16x32_bf16 v[164:167], a[148:151], a[52:55], v[164:167]
  buffer_load_dwordx4 a[104:107], v0, s[36:39], s57 offen offset:2048 sc1
  v_mfma_f32_16x16x32_bf16 v[164:167], a[144:147], a[36:39], v[164:167]
  ds_read_b64_tr_b16 a[130:131], v1 offset:46752
  v_mfma_f32_16x16x32_bf16 v[168:171], a[144:147], a[40:43], v[168:171]
  ds_read_b64_tr_b16 a[132:133], v1 offset:50336
  v_mfma_f32_16x16x32_bf16 v[168:171], a[148:151], a[56:59], v[168:171]
  v_mfma_f32_16x16x32_bf16 v[172:175], a[148:151], a[60:63], v[172:175]
  ds_read_b64_tr_b16 a[134:135], v1 offset:53920
  v_mfma_f32_16x16x32_bf16 v[172:175], a[144:147], a[44:47], v[172:175]
  s_waitcnt vmcnt(20)
  s_barrier
  buffer_load_dwordx4 a[108:111], v0, s[36:39], s57 offen offset:3072 sc1
  s_bfe_u32 s56, s83, 0x40010
  v_mfma_f32_16x16x32_bf16 v[188:191], a[152:155], a[44:47], v[188:191]
  s_mul_i32 s56, s56, 458752
  s_add_u32 m0, s84, 0
  ds_read_b64_tr_b16 a[136:137], v1 offset:43200
  v_mfma_f32_16x16x32_bf16 v[188:191], a[156:159], a[60:63], v[188:191]
  v_mfma_f32_16x16x32_bf16 v[184:187], a[156:159], a[56:59], v[184:187]
  ds_read_b64_tr_b16 a[138:139], v1 offset:46784
  v_mfma_f32_16x16x32_bf16 v[184:187], a[152:155], a[40:43], v[184:187]
  v_mfma_f32_16x16x32_bf16 v[180:183], a[152:155], a[36:39], v[180:183]
  buffer_load_dwordx4 v3, s[16:19], s56 offen offset:0 lds
  s_add_u32 s57, s57, 4096
  v_mfma_f32_16x16x32_bf16 v[180:183], a[156:159], a[52:55], v[180:183]
  ds_read_b64_tr_b16 a[140:141], v1 offset:50368
  v_mfma_f32_16x16x32_bf16 v[176:179], a[156:159], a[48:51], v[176:179]
  ds_read_b64_tr_b16 a[142:143], v1 offset:53952
  v_mfma_f32_16x16x32_bf16 v[176:179], a[152:155], a[32:35], v[176:179]
  s_waitcnt lgkmcnt(8)
  v_mfma_f32_16x16x32_bf16 v[192:195], a[160:163], a[32:35], v[192:195]
  ds_read_b64_tr_b16 a[144:145], v2 offset:0
  v_mfma_f32_16x16x32_bf16 v[192:195], a[164:167], a[48:51], v[192:195]
  buffer_load_dwordx4 a[112:115], v0, s[36:39], s57 offen offset:0 sc1
  v_mfma_f32_16x16x32_bf16 v[196:199], a[164:167], a[52:55], v[196:199]
  ds_read_b64_tr_b16 a[146:147], v2 offset:3584
  v_mfma_f32_16x16x32_bf16 v[196:199], a[160:163], a[36:39], v[196:199]
  v_mfma_f32_16x16x32_bf16 v[200:203], a[160:163], a[40:43], v[200:203]
  ds_read_b64_tr_b16 a[148:149], v2 offset:7168
  v_mfma_f32_16x16x32_bf16 v[200:203], a[164:167], a[56:59], v[200:203]
  v_mfma_f32_16x16x32_bf16 v[204:207], a[164:167], a[60:63], v[204:207]
  buffer_load_dwordx4 v4, s[16:19], s56 offen offset:1024 lds
  v_mfma_f32_16x16x32_bf16 v[204:207], a[160:163], a[44:47], v[204:207]
  ds_read_b64_tr_b16 a[150:151], v2 offset:10752
  v_mfma_f32_16x16x32_bf16 v[220:223], a[168:171], a[44:47], v[220:223]
  ds_read_b64_tr_b16 a[152:153], v2 offset:32
  v_mfma_f32_16x16x32_bf16 v[220:223], a[172:175], a[60:63], v[220:223]
  v_mfma_f32_16x16x32_bf16 v[216:219], a[172:175], a[56:59], v[216:219]
  ds_read_b64_tr_b16 a[154:155], v2 offset:3616
  v_mfma_f32_16x16x32_bf16 v[216:219], a[168:171], a[40:43], v[216:219]
  buffer_load_dwordx4 a[116:119], v0, s[36:39], s57 offen offset:1024 sc1
  v_mfma_f32_16x16x32_bf16 v[212:215], a[168:171], a[36:39], v[212:215]
  ds_read_b64_tr_b16 a[156:157], v2 offset:7200
  v_mfma_f32_16x16x32_bf16 v[212:215], a[172:175], a[52:55], v[212:215]
  v_mfma_f32_16x16x32_bf16 v[208:211], a[172:175], a[48:51], v[208:211]
  ds_read_b64_tr_b16 a[158:159], v2 offset:10784
  v_mfma_f32_16x16x32_bf16 v[208:211], a[168:171], a[32:35], v[208:211]
  s_waitcnt lgkmcnt(8)
  v_mfma_f32_16x16x32_bf16 v[224:227], a[128:131], a[32:35], v[224:227]
  buffer_load_dwordx4 a[120:123], v0, s[36:39], s57 offen offset:2048 sc1
  v_mfma_f32_16x16x32_bf16 v[224:227], a[132:135], a[48:51], v[224:227]
  ds_read_b64_tr_b16 a[160:161], v2 offset:64
  v_mfma_f32_16x16x32_bf16 v[228:231], a[132:135], a[52:55], v[228:231]
  ds_read_b64_tr_b16 a[162:163], v2 offset:3648
  v_mfma_f32_16x16x32_bf16 v[228:231], a[128:131], a[36:39], v[228:231]
  v_mfma_f32_16x16x32_bf16 v[232:235], a[128:131], a[40:43], v[232:235]
  ds_read_b64_tr_b16 a[164:165], v2 offset:7232
  v_mfma_f32_16x16x32_bf16 v[232:235], a[132:135], a[56:59], v[232:235]
  buffer_load_dwordx4 v5, s[16:19], s56 offen offset:2048 lds
  v_mfma_f32_16x16x32_bf16 v[236:239], a[132:135], a[60:63], v[236:239]
  ds_read_b64_tr_b16 a[166:167], v2 offset:10816
  v_mfma_f32_16x16x32_bf16 v[236:239], a[128:131], a[44:47], v[236:239]
  v_mfma_f32_16x16x32_bf16 v[252:255], a[136:139], a[44:47], v[252:255]
  ds_read_b64_tr_b16 a[168:169], v2 offset:96
  v_mfma_f32_16x16x32_bf16 v[252:255], a[140:143], a[60:63], v[252:255]
  v_mfma_f32_16x16x32_bf16 v[248:251], a[140:143], a[56:59], v[248:251]
  buffer_load_dwordx4 a[124:127], v0, s[36:39], s57 offen offset:3072 sc1
  v_mfma_f32_16x16x32_bf16 v[248:251], a[136:139], a[40:43], v[248:251]
  ds_read_b64_tr_b16 a[170:171], v2 offset:3680
  v_mfma_f32_16x16x32_bf16 v[244:247], a[136:139], a[36:39], v[244:247]
  ds_read_b64_tr_b16 a[172:173], v2 offset:7264
  v_mfma_f32_16x16x32_bf16 v[244:247], a[140:143], a[52:55], v[244:247]
  v_mfma_f32_16x16x32_bf16 v[240:243], a[140:143], a[48:51], v[240:243]
  ds_read_b64_tr_b16 a[174:175], v2 offset:10848
  v_mfma_f32_16x16x32_bf16 v[240:243], a[136:139], a[32:35], v[240:243]
  s_waitcnt vmcnt(17) lgkmcnt(8)
  buffer_load_dwordx4 v6, s[16:19], s56 offen offset:3072 lds
  s_bfe_u32 s57, s83, 0x40010
  v_mfma_f32_16x16x32_bf16 v[32:35], a[144:147], a[64:67], v[32:35]
  s_lshl_b32 s57, s57, 13
  s_add_u32 s57, s57, s85
  ds_read_b64_tr_b16 a[128:129], v2 offset:128
  v_mfma_f32_16x16x32_bf16 v[32:35], a[148:151], a[80:83], v[32:35]
  s_barrier
  v_mfma_f32_16x16x32_bf16 v[36:39], a[148:151], a[84:87], v[36:39]
  ds_read_b64_tr_b16 a[130:131], v2 offset:3712
  v_mfma_f32_16x16x32_bf16 v[36:39], a[144:147], a[68:71], v[36:39]
  v_mfma_f32_16x16x32_bf16 v[40:43], a[144:147], a[72:75], v[40:43]
  buffer_load_dwordx4 a[0:3], v0, s[36:39], s57 offen offset:0 sc1
  v_mfma_f32_16x16x32_bf16 v[40:43], a[148:151], a[88:91], v[40:43]
  s_add_u32 m0, s84, 4096
  ds_read_b64_tr_b16 a[132:133], v2 offset:7296
  v_mfma_f32_16x16x32_bf16 v[44:47], a[148:151], a[92:95], v[44:47]
  ds_read_b64_tr_b16 a[134:135], v2 offset:10880
  v_mfma_f32_16x16x32_bf16 v[44:47], a[144:147], a[76:79], v[44:47]
  v_mfma_f32_16x16x32_bf16 v[60:63], a[152:155], a[76:79], v[60:63]
  ds_read_b64_tr_b16 a[136:137], v2 offset:160
  v_mfma_f32_16x16x32_bf16 v[60:63], a[156:159], a[92:95], v[60:63]
  buffer_load_dwordx4 v7, s[16:19], s56 offen offset:0 lds
  v_mfma_f32_16x16x32_bf16 v[56:59], a[156:159], a[88:91], v[56:59]
  ds_read_b64_tr_b16 a[138:139], v2 offset:3744
  v_mfma_f32_16x16x32_bf16 v[56:59], a[152:155], a[72:75], v[56:59]
  v_mfma_f32_16x16x32_bf16 v[52:55], a[152:155], a[68:71], v[52:55]
  ds_read_b64_tr_b16 a[140:141], v2 offset:7328
  v_mfma_f32_16x16x32_bf16 v[52:55], a[156:159], a[84:87], v[52:55]
  v_mfma_f32_16x16x32_bf16 v[48:51], a[156:159], a[80:83], v[48:51]
  buffer_load_dwordx4 a[4:7], v0, s[36:39], s57 offen offset:1024 sc1
  v_mfma_f32_16x16x32_bf16 v[48:51], a[152:155], a[64:67], v[48:51]
  s_waitcnt lgkmcnt(7)
  ds_read_b64_tr_b16 a[142:143], v2 offset:10912
  v_mfma_f32_16x16x32_bf16 v[64:67], a[160:163], a[64:67], v[64:67]
  ds_read_b64_tr_b16 a[144:145], v2 offset:192
  v_mfma_f32_16x16x32_bf16 v[64:67], a[164:167], a[80:83], v[64:67]
  v_mfma_f32_16x16x32_bf16 v[68:71], a[164:167], a[84:87], v[68:71]
  ds_read_b64_tr_b16 a[146:147], v2 offset:3776
  v_mfma_f32_16x16x32_bf16 v[68:71], a[160:163], a[68:71], v[68:71]
  v_mfma_f32_16x16x32_bf16 v[72:75], a[160:163], a[72:75], v[72:75]
  buffer_load_dwordx4 a[8:11], v0, s[36:39], s57 offen offset:2048 sc1
  v_mfma_f32_16x16x32_bf16 v[72:75], a[164:167], a[88:91], v[72:75]
  ds_read_b64_tr_b16 a[148:149], v2 offset:7360
  v_mfma_f32_16x16x32_bf16 v[76:79], a[164:167], a[92:95], v[76:79]
  ds_read_b64_tr_b16 a[150:151], v2 offset:10944
  v_mfma_f32_16x16x32_bf16 v[76:79], a[160:163], a[76:79], v[76:79]
  v_mfma_f32_16x16x32_bf16 v[92:95], a[168:171], a[76:79], v[92:95]
  ds_read_b64_tr_b16 a[152:153], v2 offset:14336
  v_mfma_f32_16x16x32_bf16 v[92:95], a[172:175], a[92:95], v[92:95]
  buffer_load_dwordx4 v8, s[16:19], s56 offen offset:1024 lds
  v_mfma_f32_16x16x32_bf16 v[88:91], a[172:175], a[88:91], v[88:91]
  ds_read_b64_tr_b16 a[154:155], v2 offset:17920
  v_mfma_f32_16x16x32_bf16 v[88:91], a[168:171], a[72:75], v[88:91]
  v_mfma_f32_16x16x32_bf16 v[84:87], a[168:171], a[68:71], v[84:87]
  ds_read_b64_tr_b16 a[156:157], v2 offset:21504
  v_mfma_f32_16x16x32_bf16 v[84:87], a[172:175], a[84:87], v[84:87]
  v_mfma_f32_16x16x32_bf16 v[80:83], a[172:175], a[80:83], v[80:83]
  buffer_load_dwordx4 a[12:15], v0, s[36:39], s57 offen offset:3072 sc1
  v_mfma_f32_16x16x32_bf16 v[80:83], a[168:171], a[64:67], v[80:83]
  s_waitcnt lgkmcnt(7)
  ds_read_b64_tr_b16 a[158:159], v2 offset:25088
  v_mfma_f32_16x16x32_bf16 v[96:99], a[128:131], a[64:67], v[96:99]
  ds_read_b64_tr_b16 a[160:161], v2 offset:14368
  v_mfma_f32_16x16x32_bf16 v[96:99], a[132:135], a[80:83], v[96:99]
  v_mfma_f32_16x16x32_bf16 v[100:103], a[132:135], a[84:87], v[100:103]
  ds_read_b64_tr_b16 a[162:163], v2 offset:17952
  v_mfma_f32_16x16x32_bf16 v[100:103], a[128:131], a[68:71], v[100:103]
  buffer_load_dwordx4 v9, s[16:19], s56 offen offset:2048 lds
  v_mfma_f32_16x16x32_bf16 v[104:107], a[128:131], a[72:75], v[104:107]
  s_add_u32 s57, s57, 4096
  ds_read_b64_tr_b16 a[164:165], v2 offset:21536
  v_mfma_f32_16x16x32_bf16 v[104:107], a[132:135], a[88:91], v[104:107]
  v_mfma_f32_16x16x32_bf16 v[108:111], a[132:135], a[92:95], v[108:111]
  ds_read_b64_tr_b16 a[166:167], v2 offset:25120
  v_mfma_f32_16x16x32_bf16 v[108:111], a[128:131], a[76:79], v[108:111]
  v_mfma_f32_16x16x32_bf16 v[124:127], a[136:139], a[76:79], v[124:127]
  buffer_load_dwordx4 a[16:19], v0, s[36:39], s57 offen offset:0 sc1
  v_mfma_f32_16x16x32_bf16 v[124:127], a[140:143], a[92:95], v[124:127]
  ds_read_b64_tr_b16 a[168:169], v2 offset:14400
  v_mfma_f32_16x16x32_bf16 v[120:123], a[140:143], a[88:91], v[120:123]
  ds_read_b64_tr_b16 a[170:171], v2 offset:17984
  v_mfma_f32_16x16x32_bf16 v[120:123], a[136:139], a[72:75], v[120:123]
  v_mfma_f32_16x16x32_bf16 v[116:119], a[136:139], a[68:71], v[116:119]
  ds_read_b64_tr_b16 a[172:173], v2 offset:21568
  v_mfma_f32_16x16x32_bf16 v[116:119], a[140:143], a[84:87], v[116:119]
  v_mfma_f32_16x16x32_bf16 v[112:115], a[140:143], a[80:83], v[112:115]
  ds_read_b64_tr_b16 a[174:175], v2 offset:25152
  v_mfma_f32_16x16x32_bf16 v[112:115], a[136:139], a[64:67], v[112:115]
  s_waitcnt lgkmcnt(8)
  v_mfma_f32_16x16x32_bf16 v[128:131], a[144:147], a[64:67], v[128:131]
  ds_read_b64_tr_b16 a[128:129], v2 offset:14432
  v_mfma_f32_16x16x32_bf16 v[128:131], a[148:151], a[80:83], v[128:131]
  v_mfma_f32_16x16x32_bf16 v[132:135], a[148:151], a[84:87], v[132:135]
  buffer_load_dwordx4 a[20:23], v0, s[36:39], s57 offen offset:1024 sc1
  s_bfe_u32 s56, s83, 0x40014
  v_mfma_f32_16x16x32_bf16 v[132:135], a[144:147], a[68:71], v[132:135]
  s_mul_i32 s56, s56, 458752
  s_add_u32 m0, s84, 28672
  ds_read_b64_tr_b16 a[130:131], v2 offset:18016
  v_mfma_f32_16x16x32_bf16 v[136:139], a[144:147], a[72:75], v[136:139]
  ds_read_b64_tr_b16 a[132:133], v2 offset:21600
  v_mfma_f32_16x16x32_bf16 v[136:139], a[148:151], a[88:91], v[136:139]
  v_mfma_f32_16x16x32_bf16 v[140:143], a[148:151], a[92:95], v[140:143]
  ds_read_b64_tr_b16 a[134:135], v2 offset:25184
  v_mfma_f32_16x16x32_bf16 v[140:143], a[144:147], a[76:79], v[140:143]
  buffer_load_dwordx4 v3, s[16:19], s56 offen offset:0 lds
  v_mfma_f32_16x16x32_bf16 v[156:159], a[152:155], a[76:79], v[156:159]
  ds_read_b64_tr_b16 a[136:137], v2 offset:14464
  v_mfma_f32_16x16x32_bf16 v[156:159], a[156:159], a[92:95], v[156:159]
  v_mfma_f32_16x16x32_bf16 v[152:155], a[156:159], a[88:91], v[152:155]
  ds_read_b64_tr_b16 a[138:139], v2 offset:18048
  v_mfma_f32_16x16x32_bf16 v[152:155], a[152:155], a[72:75], v[152:155]
  v_mfma_f32_16x16x32_bf16 v[148:151], a[152:155], a[68:71], v[148:151]
  buffer_load_dwordx4 a[24:27], v0, s[36:39], s57 offen offset:2048 sc1
  v_mfma_f32_16x16x32_bf16 v[148:151], a[156:159], a[84:87], v[148:151]
  ds_read_b64_tr_b16 a[140:141], v2 offset:21632
  v_mfma_f32_16x16x32_bf16 v[144:147], a[156:159], a[80:83], v[144:147]
  ds_read_b64_tr_b16 a[142:143], v2 offset:25216
  v_mfma_f32_16x16x32_bf16 v[144:147], a[152:155], a[64:67], v[144:147]
  s_waitcnt lgkmcnt(8)
  v_mfma_f32_16x16x32_bf16 v[160:163], a[160:163], a[64:67], v[160:163]
  ds_read_b64_tr_b16 a[144:145], v2 offset:14496
  v_mfma_f32_16x16x32_bf16 v[160:163], a[164:167], a[80:83], v[160:163]
  buffer_load_dwordx4 v4, s[16:19], s56 offen offset:1024 lds
  v_mfma_f32_16x16x32_bf16 v[164:167], a[164:167], a[84:87], v[164:167]
  ds_read_b64_tr_b16 a[146:147], v2 offset:18080
  v_mfma_f32_16x16x32_bf16 v[164:167], a[160:163], a[68:71], v[164:167]
  v_mfma_f32_16x16x32_bf16 v[168:171], a[160:163], a[72:75], v[168:171]
  ds_read_b64_tr_b16 a[148:149], v2 offset:21664
  v_mfma_f32_16x16x32_bf16 v[168:171], a[164:167], a[88:91], v[168:171]
  v_mfma_f32_16x16x32_bf16 v[172:175], a[164:167], a[92:95], v[172:175]
  buffer_load_dwordx4 a[28:31], v0, s[36:39], s57 offen offset:3072 sc1
  v_mfma_f32_16x16x32_bf16 v[172:175], a[160:163], a[76:79], v[172:175]
  s_waitcnt vmcnt(23)
  s_barrier
  ds_read_b64_tr_b16 a[150:151], v2 offset:25248
  v_mfma_f32_16x16x32_bf16 v[188:191], a[168:171], a[76:79], v[188:191]
  ds_read_b64_tr_b16 a[152:153], v2 offset:14528
  v_mfma_f32_16x16x32_bf16 v[188:191], a[172:175], a[92:95], v[188:191]
  v_mfma_f32_16x16x32_bf16 v[184:187], a[172:175], a[88:91], v[184:187]
  ds_read_b64_tr_b16 a[154:155], v2 offset:18112
  v_mfma_f32_16x16x32_bf16 v[184:187], a[168:171], a[72:75], v[184:187]
  buffer_load_dwordx4 v5, s[16:19], s56 offen offset:2048 lds
  s_bfe_u32 s57, s83, 0x40014
  v_mfma_f32_16x16x32_bf16 v[180:183], a[168:171], a[68:71], v[180:183]
  s_lshl_b32 s57, s57, 13
  s_add_u32 s57, s57, s85
  ds_read_b64_tr_b16 a[156:157], v2 offset:21696
  v_mfma_f32_16x16x32_bf16 v[180:183], a[172:175], a[84:87], v[180:183]
  v_mfma_f32_16x16x32_bf16 v[176:179], a[172:175], a[80:83], v[176:179]
  ds_read_b64_tr_b16 a[158:159], v2 offset:25280
  v_mfma_f32_16x16x32_bf16 v[176:179], a[168:171], a[64:67], v[176:179]
  s_waitcnt lgkmcnt(8)
  v_mfma_f32_16x16x32_bf16 v[192:195], a[128:131], a[64:67], v[192:195]
  buffer_load_dwordx4 a[32:35], v0, s[36:39], s57 offen offset:0 sc1
  v_mfma_f32_16x16x32_bf16 v[192:195], a[132:135], a[80:83], v[192:195]
  ds_read_b64_tr_b16 a[160:161], v2 offset:28672
  v_mfma_f32_16x16x32_bf16 v[196:199], a[132:135], a[84:87], v[196:199]
Hb1_1:
  s_cbranch_execz Hb1_2
  ds_read_b64_tr_b16 a[162:163], v2 offset:32256
  v_mfma_f32_16x16x32_bf16 v[196:199], a[128:131], a[68:71], v[196:199]
  v_mfma_f32_16x16x32_bf16 v[200:203], a[128:131], a[72:75], v[200:203]
  ds_read_b64_tr_b16 a[164:165], v2 offset:35840
  v_mfma_f32_16x16x32_bf16 v[200:203], a[132:135], a[88:91], v[200:203]
  buffer_load_dwordx4 a[36:39], v0, s[36:39], s57 offen offset:1024 sc1
  v_mfma_f32_16x16x32_bf16 v[204:207], a[132:135], a[92:95], v[204:207]
  ds_read_b64_tr_b16 a[166:167], v2 offset:39424
  v_mfma_f32_16x16x32_bf16 v[204:207], a[128:131], a[76:79], v[204:207]
  v_mfma_f32_16x16x32_bf16 v[220:223], a[136:139], a[76:79], v[220:223]
  ds_read_b64_tr_b16 a[168:169], v2 offset:28704
  v_mfma_f32_16x16x32_bf16 v[220:223], a[140:143], a[92:95], v[220:223]
  v_mfma_f32_16x16x32_bf16 v[216:219], a[140:143], a[88:91], v[216:219]
  buffer_load_dwordx4 v6, s[16:19], s56 offen offset:3072 lds
  v_mfma_f32_16x16x32_bf16 v[216:219], a[136:139], a[72:75], v[216:219]
  ds_read_b64_tr_b16 a[170:171], v2 offset:32288
  v_mfma_f32_16x16x32_bf16 v[212:215], a[136:139], a[68:71], v[212:215]
  ds_read_b64_tr_b16 a[172:173], v2 offset:35872
  v_mfma_f32_16x16x32_bf16 v[212:215], a[140:143], a[84:87], v[212:215]
  v_mfma_f32_16x16x32_bf16 v[208:211], a[140:143], a[80:83], v[208:211]
  ds_read_b64_tr_b16 a[174:175], v2 offset:39456
  v_mfma_f32_16x16x32_bf16 v[208:211], a[136:139], a[64:67], v[208:211]
  s_waitcnt lgkmcnt(8)
  buffer_load_dwordx4 a[40:43], v0, s[36:39], s57 offen offset:2048 sc1
  s_add_u32 m0, s84, 32768
  v_mfma_f32_16x16x32_bf16 v[224:227], a[144:147], a[64:67], v[224:227]
  ds_read_b64_tr_b16 a[128:129], v2 offset:28736
  v_mfma_f32_16x16x32_bf16 v[224:227], a[148:151], a[80:83], v[224:227]
  v_mfma_f32_16x16x32_bf16 v[228:231], a[148:151], a[84:87], v[228:231]
  ds_read_b64_tr_b16 a[130:131], v2 offset:32320
  v_mfma_f32_16x16x32_bf16 v[228:231], a[144:147], a[68:71], v[228:231]
  v_mfma_f32_16x16x32_bf16 v[232:235], a[144:147], a[72:75], v[232:235]
  buffer_load_dwordx4 v7, s[16:19], s56 offen offset:0 lds
  v_mfma_f32_16x16x32_bf16 v[232:235], a[148:151], a[88:91], v[232:235]
  ds_read_b64_tr_b16 a[132:133], v2 offset:35904
  v_mfma_f32_16x16x32_bf16 v[236:239], a[148:151], a[92:95], v[236:239]
  ds_read_b64_tr_b16 a[134:135], v2 offset:39488
  v_mfma_f32_16x16x32_bf16 v[236:239], a[144:147], a[76:79], v[236:239]
  v_mfma_f32_16x16x32_bf16 v[252:255], a[152:155], a[76:79], v[252:255]
  ds_read_b64_tr_b16 a[136:137], v2 offset:28768
  v_mfma_f32_16x16x32_bf16 v[252:255], a[156:159], a[92:95], v[252:255]
  buffer_load_dwordx4 a[44:47], v0, s[36:39], s57 offen offset:3072 sc1
  v_mfma_f32_16x16x32_bf16 v[248:251], a[156:159], a[88:91], v[248:251]
  ds_read_b64_tr_b16 a[138:139], v2 offset:32352
  v_mfma_f32_16x16x32_bf16 v[248:251], a[152:155], a[72:75], v[248:251]
  v_mfma_f32_16x16x32_bf16 v[244:247], a[152:155], a[68:71], v[244:247]
  ds_read_b64_tr_b16 a[140:141], v2 offset:35936
  v_mfma_f32_16x16x32_bf16 v[244:247], a[156:159], a[84:87], v[244:247]
  v_mfma_f32_16x16x32_bf16 v[240:243], a[156:159], a[80:83], v[240:243]
  ds_read_b64_tr_b16 a[142:143], v2 offset:39520
  v_mfma_f32_16x16x32_bf16 v[240:243], a[152:155], a[64:67], v[240:243]
  s_waitcnt vmcnt(21) lgkmcnt(8)
  buffer_load_dwordx4 v8, s[16:19], s56 offen offset:1024 lds
  s_add_u32 s57, s57, 4096
  v_mfma_f32_16x16x32_bf16 v[32:35], a[160:163], a[96:99], v[32:35]
  ds_read_b64_tr_b16 a[144:145], v2 offset:28800
  v_mfma_f32_16x16x32_bf16 v[32:35], a[164:167], a[112:115], v[32:35]
  s_barrier
  v_mfma_f32_16x16x32_bf16 v[36:39], a[164:167], a[116:119], v[36:39]
  ds_read_b64_tr_b16 a[146:147], v2 offset:32384
  v_mfma_f32_16x16x32_bf16 v[36:39], a[160:163], a[100:103], v[36:39]
  v_mfma_f32_16x16x32_bf16 v[40:43], a[160:163], a[104:107], v[40:43]
  buffer_load_dwordx4 a[48:51], v0, s[36:39], s57 offen offset:0 sc1
  v_mfma_f32_16x16x32_bf16 v[40:43], a[164:167], a[120:123], v[40:43]
  ds_read_b64_tr_b16 a[148:149], v2 offset:35968
  v_mfma_f32_16x16x32_bf16 v[44:47], a[164:167], a[124:127], v[44:47]
  ds_read_b64_tr_b16 a[150:151], v2 offset:39552
  v_mfma_f32_16x16x32_bf16 v[44:47], a[160:163], a[108:111], v[44:47]
  v_mfma_f32_16x16x32_bf16 v[60:63], a[168:171], a[108:111], v[60:63]
  ds_read_b64_tr_b16 a[152:153], v2 offset:28832
  v_mfma_f32_16x16x32_bf16 v[60:63], a[172:175], a[124:127], v[60:63]
  v_mfma_f32_16x16x32_bf16 v[56:59], a[172:175], a[120:123], v[56:59]
  ds_read_b64_tr_b16 a[154:155], v2 offset:32416
  v_mfma_f32_16x16x32_bf16 v[56:59], a[168:171], a[104:107], v[56:59]
  buffer_load_dwordx4 v9, s[16:19], s56 offen offset:2048 lds
  v_mfma_f32_16x16x32_bf16 v[52:55], a[168:171], a[100:103], v[52:55]
  ds_read_b64_tr_b16 a[156:157], v2 offset:36000
  v_mfma_f32_16x16x32_bf16 v[52:55], a[172:175], a[116:119], v[52:55]
  v_mfma_f32_16x16x32_bf16 v[48:51], a[172:175], a[112:115], v[48:51]
  ds_read_b64_tr_b16 a[158:159], v2 offset:39584
  v_mfma_f32_16x16x32_bf16 v[48:51], a[168:171], a[96:99], v[48:51]
  s_waitcnt lgkmcnt(8)
  v_mfma_f32_16x16x32_bf16 v[64:67], a[128:131], a[96:99], v[64:67]
  buffer_load_dwordx4 a[52:55], v0, s[36:39], s57 offen offset:1024 sc1
  v_mfma_f32_16x16x32_bf16 v[64:67], a[132:135], a[112:115], v[64:67]
  ds_read_b64_tr_b16 a[160:161], v2 offset:28864
  v_mfma_f32_16x16x32_bf16 v[68:71], a[132:135], a[116:119], v[68:71]
  ds_read_b64_tr_b16 a[162:163], v2 offset:32448
  v_mfma_f32_16x16x32_bf16 v[68:71], a[128:131], a[100:103], v[68:71]
  v_mfma_f32_16x16x32_bf16 v[72:75], a[128:131], a[104:107], v[72:75]
  ds_read_b64_tr_b16 a[164:165], v2 offset:36032
  v_mfma_f32_16x16x32_bf16 v[72:75], a[132:135], a[120:123], v[72:75]
  v_mfma_f32_16x16x32_bf16 v[76:79], a[132:135], a[124:127], v[76:79]
  buffer_load_dwordx4 a[56:59], v0, s[36:39], s57 offen offset:2048 sc1
  v_mfma_f32_16x16x32_bf16 v[76:79], a[128:131], a[108:111], v[76:79]
  ds_read_b64_tr_b16 a[166:167], v2 offset:39616
  v_mfma_f32_16x16x32_bf16 v[92:95], a[136:139], a[108:111], v[92:95]
  s_bfe_u32 s56, s83, 0x40018
  s_mul_i32 s56, s56, 458752
  s_add_u32 m0, s84, 57344
  v_mfma_f32_16x16x32_bf16 v[92:95], a[140:143], a[124:127], v[92:95]
  ds_read_b64_tr_b16 a[168:169], v2 offset:43008
  v_mfma_f32_16x16x32_bf16 v[88:91], a[140:143], a[120:123], v[88:91]
  ds_read_b64_tr_b16 a[170:171], v2 offset:46592
  v_mfma_f32_16x16x32_bf16 v[88:91], a[136:139], a[104:107], v[88:91]
  v_mfma_f32_16x16x32_bf16 v[84:87], a[136:139], a[100:103], v[84:87]
  buffer_load_dwordx4 v3, s[16:19], s56 offen offset:0 lds
  v_mfma_f32_16x16x32_bf16 v[84:87], a[140:143], a[116:119], v[84:87]
  ds_read_b64_tr_b16 a[172:173], v2 offset:50176
  v_mfma_f32_16x16x32_bf16 v[80:83], a[140:143], a[112:115], v[80:83]
  ds_read_b64_tr_b16 a[174:175], v2 offset:53760
  v_mfma_f32_16x16x32_bf16 v[80:83], a[136:139], a[96:99], v[80:83]
  s_waitcnt lgkmcnt(8)
  v_mfma_f32_16x16x32_bf16 v[96:99], a[144:147], a[96:99], v[96:99]
  ds_read_b64_tr_b16 a[128:129], v2 offset:43040
  v_mfma_f32_16x16x32_bf16 v[96:99], a[148:151], a[112:115], v[96:99]
  buffer_load_dwordx4 a[60:63], v0, s[36:39], s57 offen offset:3072 sc1
  s_bfe_u32 s57, s83, 0x40018
  v_mfma_f32_16x16x32_bf16 v[100:103], a[148:151], a[116:119], v[100:103]
  s_lshl_b32 s57, s57, 13
  s_add_u32 s57, s57, s85
  ds_read_b64_tr_b16 a[130:131], v2 offset:46624
  v_mfma_f32_16x16x32_bf16 v[100:103], a[144:147], a[100:103], v[100:103]
  v_mfma_f32_16x16x32_bf16 v[104:107], a[144:147], a[104:107], v[104:107]
  buffer_load_dwordx4 a[208:211], v25, s[36:39], s77 offen offset:0 sc1
  v_mfma_f32_16x16x32_bf16 v[104:107], a[148:151], a[120:123], v[104:107]
  ds_read_b64_tr_b16 a[132:133], v2 offset:50208
  v_mfma_f32_16x16x32_bf16 v[108:111], a[148:151], a[124:127], v[108:111]
  ds_read_b64_tr_b16 a[134:135], v2 offset:53792
  v_mfma_f32_16x16x32_bf16 v[108:111], a[144:147], a[108:111], v[108:111]
  v_mfma_f32_16x16x32_bf16 v[124:127], a[152:155], a[108:111], v[124:127]
  ds_read_b64_tr_b16 a[136:137], v2 offset:43072
  v_mfma_f32_16x16x32_bf16 v[124:127], a[156:159], a[124:127], v[124:127]
  buffer_load_dwordx4 a[212:215], v25, s[36:39], s77 offen offset:2048 sc1
  v_mfma_f32_16x16x32_bf16 v[120:123], a[156:159], a[120:123], v[120:123]
  ds_read_b64_tr_b16 a[138:139], v2 offset:46656
  v_mfma_f32_16x16x32_bf16 v[120:123], a[152:155], a[104:107], v[120:123]
  v_mfma_f32_16x16x32_bf16 v[116:119], a[152:155], a[100:103], v[116:119]
  ds_read_b64_tr_b16 a[140:141], v2 offset:50240
  v_mfma_f32_16x16x32_bf16 v[116:119], a[156:159], a[116:119], v[116:119]
  v_mfma_f32_16x16x32_bf16 v[112:115], a[156:159], a[112:115], v[112:115]
  buffer_load_dwordx4 a[216:219], v25, s[36:39], s76 offen offset:0 sc1
  v_mfma_f32_16x16x32_bf16 v[112:115], a[152:155], a[96:99], v[112:115]
  s_waitcnt lgkmcnt(7)
  ds_read_b64_tr_b16 a[142:143], v2 offset:53824
  v_mfma_f32_16x16x32_bf16 v[128:131], a[160:163], a[96:99], v[128:131]
  ds_read_b64_tr_b16 a[144:145], v2 offset:43104
  v_mfma_f32_16x16x32_bf16 v[128:131], a[164:167], a[112:115], v[128:131]
  v_mfma_f32_16x16x32_bf16 v[132:135], a[164:167], a[116:119], v[132:135]
  ds_read_b64_tr_b16 a[146:147], v2 offset:46688
  v_mfma_f32_16x16x32_bf16 v[132:135], a[160:163], a[100:103], v[132:135]
  buffer_load_dwordx4 a[220:223], v25, s[36:39], s76 offen offset:2048 sc1
  v_mfma_f32_16x16x32_bf16 v[136:139], a[160:163], a[104:107], v[136:139]
  ds_read_b64_tr_b16 a[148:149], v2 offset:50272
  v_mfma_f32_16x16x32_bf16 v[136:139], a[164:167], a[120:123], v[136:139]
  v_mfma_f32_16x16x32_bf16 v[140:143], a[164:167], a[124:127], v[140:143]
  ds_read_b64_tr_b16 a[150:151], v2 offset:53856
  v_mfma_f32_16x16x32_bf16 v[140:143], a[160:163], a[108:111], v[140:143]
  v_mfma_f32_16x16x32_bf16 v[156:159], a[168:171], a[108:111], v[156:159]
  buffer_load_dwordx4 a[64:67], v0, s[36:39], s57 offen offset:0 sc1
  v_mfma_f32_16x16x32_bf16 v[156:159], a[172:175], a[124:127], v[156:159]
  ds_read_b64_tr_b16 a[152:153], v2 offset:43136
  v_mfma_f32_16x16x32_bf16 v[152:155], a[172:175], a[120:123], v[152:155]
  ds_read_b64_tr_b16 a[154:155], v2 offset:46720
  v_mfma_f32_16x16x32_bf16 v[152:155], a[168:171], a[104:107], v[152:155]
  v_mfma_f32_16x16x32_bf16 v[148:151], a[168:171], a[100:103], v[148:151]
  ds_read_b64_tr_b16 a[156:157], v2 offset:50304
  v_mfma_f32_16x16x32_bf16 v[148:151], a[172:175], a[116:119], v[148:151]
  buffer_load_dwordx4 v4, s[16:19], s56 offen offset:1024 lds
  v_mfma_f32_16x16x32_bf16 v[144:147], a[172:175], a[112:115], v[144:147]
  ds_read_b64_tr_b16 a[158:159], v2 offset:53888
  v_mfma_f32_16x16x32_bf16 v[144:147], a[168:171], a[96:99], v[144:147]
  s_waitcnt lgkmcnt(8)
  v_mfma_f32_16x16x32_bf16 v[160:163], a[128:131], a[96:99], v[160:163]
  ds_read_b64_tr_b16 a[160:161], v2 offset:43168
  v_mfma_f32_16x16x32_bf16 v[160:163], a[132:135], a[112:115], v[160:163]
  v_mfma_f32_16x16x32_bf16 v[164:167], a[132:135], a[116:119], v[164:167]
  buffer_load_dwordx4 a[68:71], v0, s[36:39], s57 offen offset:1024 sc1
  v_mfma_f32_16x16x32_bf16 v[164:167], a[128:131], a[100:103], v[164:167]
  ds_read_b64_tr_b16 a[162:163], v2 offset:46752
  v_mfma_f32_16x16x32_bf16 v[168:171], a[128:131], a[104:107], v[168:171]
  ds_read_b64_tr_b16 a[164:165], v2 offset:50336
  v_mfma_f32_16x16x32_bf16 v[168:171], a[132:135], a[120:123], v[168:171]
  v_mfma_f32_16x16x32_bf16 v[172:175], a[132:135], a[124:127], v[172:175]
  ds_read_b64_tr_b16 a[166:167], v2 offset:53920
  v_mfma_f32_16x16x32_bf16 v[172:175], a[128:131], a[108:111], v[172:175]
  s_waitcnt vmcnt(27)
  s_barrier
  buffer_load_dwordx4 v5, s[16:19], s56 offen offset:2048 lds
  v_mfma_f32_16x16x32_bf16 v[188:191], a[136:139], a[108:111], v[188:191]
  ds_read_b64_tr_b16 a[168:169], v2 offset:43200
  v_mfma_f32_16x16x32_bf16 v[188:191], a[140:143], a[124:127], v[188:191]
  v_mfma_f32_16x16x32_bf16 v[184:187], a[140:143], a[120:123], v[184:187]
  ds_read_b64_tr_b16 a[170:171], v2 offset:46784
  v_mfma_f32_16x16x32_bf16 v[184:187], a[136:139], a[104:107], v[184:187]
  v_mfma_f32_16x16x32_bf16 v[180:183], a[136:139], a[100:103], v[180:183]
  buffer_load_dwordx4 a[72:75], v0, s[36:39], s57 offen offset:2048 sc1
  v_mfma_f32_16x16x32_bf16 v[180:183], a[140:143], a[116:119], v[180:183]
  ds_read_b64_tr_b16 a[172:173], v2 offset:50368
  v_mfma_f32_16x16x32_bf16 v[176:179], a[140:143], a[112:115], v[176:179]
  ds_read_b64_tr_b16 a[174:175], v2 offset:53952
  v_mfma_f32_16x16x32_bf16 v[176:179], a[136:139], a[96:99], v[176:179]
  s_waitcnt lgkmcnt(8)
  v_mfma_f32_16x16x32_bf16 v[192:195], a[144:147], a[96:99], v[192:195]
  ds_read_b64_tr_b16 a[128:129], v1 offset:0
  v_mfma_f32_16x16x32_bf16 v[192:195], a[148:151], a[112:115], v[192:195]
  buffer_load_dwordx4 v6, s[16:19], s56 offen offset:3072 lds
  v_mfma_f32_16x16x32_bf16 v[196:199], a[148:151], a[116:119], v[196:199]
  ds_read_b64_tr_b16 a[130:131], v1 offset:3584
  v_mfma_f32_16x16x32_bf16 v[196:199], a[144:147], a[100:103], v[196:199]
  v_mfma_f32_16x16x32_bf16 v[200:203], a[144:147], a[104:107], v[200:203]
  ds_read_b64_tr_b16 a[132:133], v1 offset:7168
  v_mfma_f32_16x16x32_bf16 v[200:203], a[148:151], a[120:123], v[200:203]
  v_mfma_f32_16x16x32_bf16 v[204:207], a[148:151], a[124:127], v[204:207]
  buffer_load_dwordx4 a[76:79], v0, s[36:39], s57 offen offset:3072 sc1
  s_add_u32 m0, s84, 61440
  v_mfma_f32_16x16x32_bf16 v[204:207], a[144:147], a[108:111], v[204:207]
  ds_read_b64_tr_b16 a[134:135], v1 offset:10752
  v_mfma_f32_16x16x32_bf16 v[220:223], a[152:155], a[108:111], v[220:223]
  ds_read_b64_tr_b16 a[136:137], v1 offset:32
  v_mfma_f32_16x16x32_bf16 v[220:223], a[156:159], a[124:127], v[220:223]
  v_mfma_f32_16x16x32_bf16 v[216:219], a[156:159], a[120:123], v[216:219]
  ds_read_b64_tr_b16 a[138:139], v1 offset:3616
  v_mfma_f32_16x16x32_bf16 v[216:219], a[152:155], a[104:107], v[216:219]
  buffer_load_dwordx4 v7, s[16:19], s56 offen offset:0 lds
  s_add_u32 s57, s57, 4096
  v_mfma_f32_16x16x32_bf16 v[212:215], a[152:155], a[100:103], v[212:215]
  ds_read_b64_tr_b16 a[140:141], v1 offset:7200
  v_mfma_f32_16x16x32_bf16 v[212:215], a[156:159], a[116:119], v[212:215]
  v_mfma_f32_16x16x32_bf16 v[208:211], a[156:159], a[112:115], v[208:211]
  ds_read_b64_tr_b16 a[142:143], v1 offset:10784
  v_mfma_f32_16x16x32_bf16 v[208:211], a[152:155], a[96:99], v[208:211]
  s_waitcnt lgkmcnt(8)
  v_mfma_f32_16x16x32_bf16 v[224:227], a[160:163], a[96:99], v[224:227]
  buffer_load_dwordx4 a[80:83], v0, s[36:39], s57 offen offset:0 sc1
  v_mfma_f32_16x16x32_bf16 v[224:227], a[164:167], a[112:115], v[224:227]
  ds_read_b64_tr_b16 a[144:145], v1 offset:64
  v_mfma_f32_16x16x32_bf16 v[228:231], a[164:167], a[116:119], v[228:231]
  ds_read_b64_tr_b16 a[146:147], v1 offset:3648
  v_mfma_f32_16x16x32_bf16 v[228:231], a[160:163], a[100:103], v[228:231]
  v_mfma_f32_16x16x32_bf16 v[232:235], a[160:163], a[104:107], v[232:235]
  ds_read_b64_tr_b16 a[148:149], v1 offset:7232
  v_mfma_f32_16x16x32_bf16 v[232:235], a[164:167], a[120:123], v[232:235]
  buffer_load_dwordx4 a[84:87], v0, s[36:39], s57 offen offset:1024 sc1
  v_mfma_f32_16x16x32_bf16 v[236:239], a[164:167], a[124:127], v[236:239]
  ds_read_b64_tr_b16 a[150:151], v1 offset:10816
  v_mfma_f32_16x16x32_bf16 v[236:239], a[160:163], a[108:111], v[236:239]
  v_mfma_f32_16x16x32_bf16 v[252:255], a[168:171], a[108:111], v[252:255]
  ds_read_b64_tr_b16 a[152:153], v1 offset:96
  v_mfma_f32_16x16x32_bf16 v[252:255], a[172:175], a[124:127], v[252:255]
  v_mfma_f32_16x16x32_bf16 v[248:251], a[172:175], a[120:123], v[248:251]
  buffer_load_dwordx4 v8, s[16:19], s56 offen offset:1024 lds
  v_mfma_f32_16x16x32_bf16 v[248:251], a[168:171], a[104:107], v[248:251]
  ds_read_b64_tr_b16 a[154:155], v1 offset:3680
  v_mfma_f32_16x16x32_bf16 v[244:247], a[168:171], a[100:103], v[244:247]
  ds_read_b64_tr_b16 a[156:157], v1 offset:7264
  v_mfma_f32_16x16x32_bf16 v[244:247], a[172:175], a[116:119], v[244:247]
  v_mfma_f32_16x16x32_bf16 v[240:243], a[172:175], a[112:115], v[240:243]
  ds_read_b64_tr_b16 a[158:159], v1 offset:10848
  v_mfma_f32_16x16x32_bf16 v[240:243], a[168:171], a[96:99], v[240:243]
  s_waitcnt vmcnt(29) lgkmcnt(8)
  buffer_load_dwordx4 a[88:91], v0, s[36:39], s57 offen offset:2048 sc1
  v_mfma_f32_16x16x32_bf16 v[32:35], a[128:131], a[0:3], v[32:35]
  ds_read_b64_tr_b16 a[160:161], v1 offset:128
  v_mfma_f32_16x16x32_bf16 v[32:35], a[132:135], a[16:19], v[32:35]
  s_waitcnt vmcnt(20)
  s_barrier
  v_mfma_f32_16x16x32_bf16 v[36:39], a[132:135], a[20:23], v[36:39]
  ds_read_b64_tr_b16 a[162:163], v1 offset:3712
  v_mfma_f32_16x16x32_bf16 v[36:39], a[128:131], a[4:7], v[36:39]
  v_mfma_f32_16x16x32_bf16 v[40:43], a[128:131], a[8:11], v[40:43]
  buffer_load_dwordx4 v9, s[16:19], s56 offen offset:2048 lds
  v_mfma_f32_16x16x32_bf16 v[40:43], a[132:135], a[24:27], v[40:43]
  ds_read_b64_tr_b16 a[164:165], v1 offset:7296
  v_mfma_f32_16x16x32_bf16 v[44:47], a[132:135], a[28:31], v[44:47]
  ds_read_b64_tr_b16 a[166:167], v1 offset:10880
  v_mfma_f32_16x16x32_bf16 v[44:47], a[128:131], a[12:15], v[44:47]
  v_mfma_f32_16x16x32_bf16 v[60:63], a[136:139], a[12:15], v[60:63]
  ds_read_b64_tr_b16 a[168:169], v1 offset:160
  v_mfma_f32_16x16x32_bf16 v[60:63], a[140:143], a[28:31], v[60:63]
  buffer_load_dwordx4 a[92:95], v0, s[36:39], s57 offen offset:3072 sc1
  s_bfe_u32 s57, s83, 0x4001c
  v_mfma_f32_16x16x32_bf16 v[56:59], a[140:143], a[24:27], v[56:59]
  s_lshl_b32 s57, s57, 13
  s_add_u32 s57, s57, s85
  ds_read_b64_tr_b16 a[170:171], v1 offset:3744
  v_mfma_f32_16x16x32_bf16 v[56:59], a[136:139], a[8:11], v[56:59]
  v_mfma_f32_16x16x32_bf16 v[52:55], a[136:139], a[4:7], v[52:55]
  ds_read_b64_tr_b16 a[172:173], v1 offset:7328
  v_mfma_f32_16x16x32_bf16 v[52:55], a[140:143], a[20:23], v[52:55]
  s_waitcnt vmcnt(14)
  v_accvgpr_read_b32 v26, a208
  v_accvgpr_read_b32 v27, a209
  v_mfma_f32_16x16x32_bf16 v[48:51], a[140:143], a[16:19], v[48:51]
  buffer_load_dwordx4 a[96:99], v0, s[36:39], s57 offen offset:0 sc1
  s_bfe_u32 s56, s83, 0x4001c
  v_mfma_f32_16x16x32_bf16 v[48:51], a[136:139], a[0:3], v[48:51]
  s_waitcnt lgkmcnt(7)
  s_mul_i32 s56, s56, 458752
  s_add_u32 m0, s84, 86016
  v_mfma_f32_16x16x32_bf16 v[64:67], a[144:147], a[0:3], v[64:67]
  ds_read_b64_tr_b16 a[174:175], v1 offset:10912
  v_accvgpr_read_b32 v28, a210
  v_mfma_f32_16x16x32_bf16 v[64:67], a[148:151], a[16:19], v[64:67]
  ds_read_b64_tr_b16 a[128:129], v1 offset:192
  v_accvgpr_read_b32 v29, a211
  v_mfma_f32_16x16x32_bf16 v[68:71], a[148:151], a[20:23], v[68:71]
  ds_read_b64_tr_b16 a[130:131], v1 offset:3776
  v_max_u32 v31, v26, v27
  v_mfma_f32_16x16x32_bf16 v[68:71], a[144:147], a[4:7], v[68:71]
  buffer_load_dwordx4 v3, s[16:19], s56 offen offset:0 lds
  v_max3_u32 v31, v31, v28, v29
  v_mfma_f32_16x16x32_bf16 v[72:75], a[144:147], a[8:11], v[72:75]
  ds_read_b64_tr_b16 a[132:133], v1 offset:7360
  v_accvgpr_read_b32 v22, a212
  v_mfma_f32_16x16x32_bf16 v[72:75], a[148:151], a[24:27], v[72:75]
  v_accvgpr_read_b32 v23, a213
  v_max3_u32 v31, v31, v22, v23
  v_mfma_f32_16x16x32_bf16 v[76:79], a[148:151], a[28:31], v[76:79]
  ds_read_b64_tr_b16 a[134:135], v1 offset:10944
  v_add_f32 v26, v26, v22
  v_mfma_f32_16x16x32_bf16 v[76:79], a[144:147], a[12:15], v[76:79]
  v_add_f32 v27, v27, v23
  v_accvgpr_read_b32 v22, a214
  v_mfma_f32_16x16x32_bf16 v[92:95], a[152:155], a[12:15], v[92:95]
  buffer_load_dwordx4 a[100:103], v0, s[36:39], s57 offen offset:1024 sc1
  v_accvgpr_read_b32 v23, a215
  v_mfma_f32_16x16x32_bf16 v[92:95], a[156:159], a[28:31], v[92:95]
  ds_read_b64_tr_b16 a[136:137], v1 offset:14336
  v_max3_u32 v31, v31, v22, v23
  v_mfma_f32_16x16x32_bf16 v[88:91], a[156:159], a[24:27], v[88:91]
  ds_read_b64_tr_b16 a[138:139], v1 offset:17920
  v_add_f32 v28, v28, v22
  v_mfma_f32_16x16x32_bf16 v[88:91], a[152:155], a[8:11], v[88:91]
  v_add_f32 v29, v29, v23
  v_accvgpr_read_b32 v22, a216
  v_mfma_f32_16x16x32_bf16 v[84:87], a[152:155], a[4:7], v[84:87]
  ds_read_b64_tr_b16 a[140:141], v1 offset:21504
  v_accvgpr_read_b32 v23, a217
  v_mfma_f32_16x16x32_bf16 v[84:87], a[156:159], a[20:23], v[84:87]
  buffer_load_dwordx4 v4, s[16:19], s56 offen offset:1024 lds
  v_max3_u32 v31, v31, v22, v23
  v_mfma_f32_16x16x32_bf16 v[80:83], a[156:159], a[16:19], v[80:83]
  ds_read_b64_tr_b16 a[142:143], v1 offset:25088
  v_add_f32 v26, v26, v22
  v_mfma_f32_16x16x32_bf16 v[80:83], a[152:155], a[0:3], v[80:83]
  s_waitcnt lgkmcnt(8)
  v_add_f32 v27, v27, v23
  v_accvgpr_read_b32 v22, a218
  v_mfma_f32_16x16x32_bf16 v[96:99], a[160:163], a[0:3], v[96:99]
  ds_read_b64_tr_b16 a[144:145], v1 offset:14368
  v_accvgpr_read_b32 v23, a219
  v_mfma_f32_16x16x32_bf16 v[96:99], a[164:167], a[16:19], v[96:99]
  v_max3_u32 v31, v31, v22, v23
  v_add_f32 v28, v28, v22
  v_mfma_f32_16x16x32_bf16 v[100:103], a[164:167], a[20:23], v[100:103]
  buffer_load_dwordx4 a[104:107], v0, s[36:39], s57 offen offset:2048 sc1
  v_add_f32 v29, v29, v23
  v_mfma_f32_16x16x32_bf16 v[100:103], a[160:163], a[4:7], v[100:103]
  ds_read_b64_tr_b16 a[146:147], v1 offset:17952
  v_accvgpr_read_b32 v22, a220
  v_mfma_f32_16x16x32_bf16 v[104:107], a[160:163], a[8:11], v[104:107]
  ds_read_b64_tr_b16 a[148:149], v1 offset:21536
  v_accvgpr_read_b32 v23, a221
  v_mfma_f32_16x16x32_bf16 v[104:107], a[164:167], a[24:27], v[104:107]
  v_max3_u32 v31, v31, v22, v23
  v_add_f32 v26, v26, v22
  v_mfma_f32_16x16x32_bf16 v[108:111], a[164:167], a[28:31], v[108:111]
  ds_read_b64_tr_b16 a[150:151], v1 offset:25120
  v_add_f32 v27, v27, v23
  v_mfma_f32_16x16x32_bf16 v[108:111], a[160:163], a[12:15], v[108:111]
  buffer_load_dwordx4 v5, s[16:19], s56 offen offset:2048 lds
  v_accvgpr_read_b32 v22, a222
  v_mfma_f32_16x16x32_bf16 v[124:127], a[168:171], a[12:15], v[124:127]
  ds_read_b64_tr_b16 a[152:153], v1 offset:14400
  v_accvgpr_read_b32 v23, a223
  v_mfma_f32_16x16x32_bf16 v[124:127], a[172:175], a[28:31], v[124:127]
  v_max3_u32 v31, v31, v22, v23
  v_add_f32 v28, v28, v22
  v_mfma_f32_16x16x32_bf16 v[120:123], a[172:175], a[24:27], v[120:123]
  ds_read_b64_tr_b16 a[154:155], v1 offset:17984
  v_add_f32 v29, v29, v23
  v_mfma_f32_16x16x32_bf16 v[120:123], a[168:171], a[8:11], v[120:123]
  v_cmp_eq_u32 vcc, -1, v31
  s_nop 4
  s_cbranch_vccnz CK6s
CK6x:
  v_mfma_f32_16x16x32_bf16 v[116:119], a[168:171], a[4:7], v[116:119]
  s_nop 0
  buffer_load_dwordx4 a[108:111], v0, s[36:39], s57 offen offset:3072 sc1
  v_permlane32_swap_b32 v26, v28
  v_mfma_f32_16x16x32_bf16 v[116:119], a[172:175], a[20:23], v[116:119]
  ds_read_b64_tr_b16 a[156:157], v1 offset:21568
  v_permlane32_swap_b32 v27, v29
  v_mfma_f32_16x16x32_bf16 v[112:115], a[172:175], a[16:19], v[112:115]
  ds_read_b64_tr_b16 a[158:159], v1 offset:25152
  v_add_f32 v26, v26, v28
  v_mfma_f32_16x16x32_bf16 v[112:115], a[168:171], a[0:3], v[112:115]
  s_waitcnt lgkmcnt(8)
  v_add_f32 v27, v27, v29
  v_cvt_pk_bf16_f32 v25, v26, v26
  v_mfma_f32_16x16x32_bf16 v[128:131], a[128:131], a[0:3], v[128:131]
  ds_read_b64_tr_b16 a[160:161], v1 offset:14432
  v_lshlrev_b32 v25, 16, v25
  v_mfma_f32_16x16x32_bf16 v[128:131], a[132:135], a[16:19], v[128:131]
  buffer_load_dwordx4 v6, s[16:19], s56 offen offset:3072 lds
  s_add_u32 s57, s57, 4096
  v_mfma_f32_16x16x32_bf16 v[132:135], a[132:135], a[20:23], v[132:135]
  ds_read_b64_tr_b16 a[162:163], v1 offset:18016
  v_sub_f32 v30, v26, v25
  v_mfma_f32_16x16x32_bf16 v[132:135], a[128:131], a[4:7], v[132:135]
  v_cvt_pk_bf16_f32 v22, v26, v30
  v_and_b32 v25, 0xffff0000, v22
  v_mfma_f32_16x16x32_bf16 v[136:139], a[128:131], a[8:11], v[136:139]
  ds_read_b64_tr_b16 a[164:165], v1 offset:21600
  v_sub_f32 v30, v30, v25
  v_mfma_f32_16x16x32_bf16 v[136:139], a[132:135], a[24:27], v[136:139]
  v_cvt_pk_bf16_f32 v23, v30, 0
  v_mfma_f32_16x16x32_bf16 v[140:143], a[132:135], a[28:31], v[140:143]
  buffer_load_dwordx4 a[112:115], v0, s[36:39], s57 offen offset:0 sc1
  s_add_u32 m0, s84, 90112
  v_mfma_f32_16x16x32_bf16 v[140:143], a[128:131], a[12:15], v[140:143]
  ds_read_b64_tr_b16 a[166:167], v1 offset:25184
  v_mfma_f32_16x16x32_bf16 v[156:159], a[136:139], a[12:15], v[156:159]
  ds_read_b64_tr_b16 a[168:169], v1 offset:14464
  v_mfma_f32_16x16x32_bf16 v[156:159], a[140:143], a[28:31], v[156:159]
  ds_write_b64 v24, v[22:23] offset:0
  v_cvt_pk_bf16_f32 v25, v27, v27
  v_mfma_f32_16x16x32_bf16 v[152:155], a[140:143], a[24:27], v[152:155]
  ds_read_b64_tr_b16 a[170:171], v1 offset:18048
  v_lshlrev_b32 v25, 16, v25
  v_mfma_f32_16x16x32_bf16 v[152:155], a[136:139], a[8:11], v[152:155]
  buffer_load_dwordx4 v7, s[16:19], s56 offen offset:0 lds
  v_sub_f32 v30, v27, v25
  v_mfma_f32_16x16x32_bf16 v[148:151], a[136:139], a[4:7], v[148:151]
  ds_read_b64_tr_b16 a[172:173], v1 offset:21632
  v_cvt_pk_bf16_f32 v28, v27, v30
  v_mfma_f32_16x16x32_bf16 v[148:151], a[140:143], a[20:23], v[148:151]
  v_and_b32 v25, 0xffff0000, v28
  v_sub_f32 v30, v30, v25
  v_mfma_f32_16x16x32_bf16 v[144:147], a[140:143], a[16:19], v[144:147]
  ds_read_b64_tr_b16 a[174:175], v1 offset:25216
  v_cvt_pk_bf16_f32 v29, v30, 0
  v_mfma_f32_16x16x32_bf16 v[144:147], a[136:139], a[0:3], v[144:147]
  s_waitcnt lgkmcnt(9)
  ds_write_b64 v24, v[28:29] offset:16
  s_waitcnt lgkmcnt(0)
  v_mfma_f32_16x16x32_bf16 v[160:163], a[144:147], a[0:3], v[160:163]
  buffer_load_dwordx4 a[116:119], v0, s[36:39], s57 offen offset:1024 sc1
  v_mfma_f32_16x16x32_bf16 v[160:163], a[148:151], a[16:19], v[160:163]
  s_lshl_b32 s68, s44, 8
  ds_read_b64_tr_b16 a[128:129], v1 offset:14496
  s_add_u32 s68, s68, s2
  v_mfma_f32_16x16x32_bf16 v[164:167], a[148:151], a[20:23], v[164:167]
  s_mul_i32 s68, s68, 7168
  ds_read_b64_tr_b16 a[130:131], v1 offset:18080
  v_mfma_f32_16x16x32_bf16 v[164:167], a[144:147], a[4:7], v[164:167]
  v_mfma_f32_16x16x32_bf16 v[168:171], a[144:147], a[8:11], v[168:171]
  ds_read_b64_tr_b16 a[132:133], v1 offset:21664
  v_mfma_f32_16x16x32_bf16 v[168:171], a[148:151], a[24:27], v[168:171]
  buffer_load_dwordx4 v8, s[16:19], s56 offen offset:1024 lds
  v_mfma_f32_16x16x32_bf16 v[172:175], a[148:151], a[28:31], v[172:175]
  ds_read_b64_tr_b16 a[134:135], v1 offset:25248
  v_mfma_f32_16x16x32_bf16 v[172:175], a[144:147], a[12:15], v[172:175]
  v_mfma_f32_16x16x32_bf16 v[188:191], a[152:155], a[12:15], v[188:191]
  ds_read_b64_tr_b16 a[136:137], v1 offset:14528
  v_mfma_f32_16x16x32_bf16 v[188:191], a[156:159], a[28:31], v[188:191]
  v_mfma_f32_16x16x32_bf16 v[184:187], a[156:159], a[24:27], v[184:187]
  buffer_load_dwordx4 a[120:123], v0, s[36:39], s57 offen offset:2048 sc1
  v_mfma_f32_16x16x32_bf16 v[184:187], a[152:155], a[8:11], v[184:187]
  ds_read_b64_tr_b16 a[138:139], v1 offset:18112
  v_mfma_f32_16x16x32_bf16 v[180:183], a[152:155], a[4:7], v[180:183]
  ds_read_b64_tr_b16 a[140:141], v1 offset:21696
  v_mfma_f32_16x16x32_bf16 v[180:183], a[156:159], a[20:23], v[180:183]
  v_mfma_f32_16x16x32_bf16 v[176:179], a[156:159], a[16:19], v[176:179]
  ds_read_b64_tr_b16 a[142:143], v1 offset:25280
  v_mfma_f32_16x16x32_bf16 v[176:179], a[152:155], a[0:3], v[176:179]
  s_waitcnt lgkmcnt(9)
  buffer_load_dwordx4 v9, s[16:19], s56 offen offset:2048 lds
  v_mfma_f32_16x16x32_bf16 v[192:195], a[160:163], a[0:3], v[192:195]
  ds_read_b64_tr_b16 a[144:145], v1 offset:28864
  v_mfma_f32_16x16x32_bf16 v[192:195], a[164:167], a[16:19], v[192:195]
  v_mfma_f32_16x16x32_bf16 v[196:199], a[164:167], a[20:23], v[196:199]
  ds_read_b64_tr_b16 a[146:147], v1 offset:32448
  v_mfma_f32_16x16x32_bf16 v[196:199], a[160:163], a[4:7], v[196:199]
  v_mfma_f32_16x16x32_bf16 v[200:203], a[160:163], a[8:11], v[200:203]
  buffer_load_dwordx4 a[124:127], v0, s[36:39], s57 offen offset:3072 sc1
  v_mfma_f32_16x16x32_bf16 v[200:203], a[164:167], a[24:27], v[200:203]
  ds_read_b64_tr_b16 a[148:149], v1 offset:36032
  v_mfma_f32_16x16x32_bf16 v[204:207], a[164:167], a[28:31], v[204:207]
  ds_read_b64_tr_b16 a[150:151], v1 offset:39616
  v_mfma_f32_16x16x32_bf16 v[204:207], a[160:163], a[12:15], v[204:207]
  s_waitcnt vmcnt(16)
  s_barrier
  v_mfma_f32_16x16x32_bf16 v[220:223], a[168:171], a[12:15], v[220:223]
  ds_read_b64_tr_b16 a[152:153], v1 offset:43200
  v_mfma_f32_16x16x32_bf16 v[220:223], a[172:175], a[28:31], v[220:223]
  v_mfma_f32_16x16x32_bf16 v[216:219], a[172:175], a[24:27], v[216:219]
  ds_read_b64_tr_b16 a[154:155], v1 offset:46784
  v_mfma_f32_16x16x32_bf16 v[216:219], a[168:171], a[8:11], v[216:219]
  v_mfma_f32_16x16x32_bf16 v[212:215], a[168:171], a[4:7], v[212:215]
  ds_read_b64_tr_b16 a[156:157], v1 offset:50368
  v_mfma_f32_16x16x32_bf16 v[212:215], a[172:175], a[20:23], v[212:215]
  v_mfma_f32_16x16x32_bf16 v[208:211], a[172:175], a[16:19], v[208:211]
  ds_read_b64_tr_b16 a[158:159], v1 offset:53952
  v_mfma_f32_16x16x32_bf16 v[208:211], a[168:171], a[0:3], v[208:211]
  s_waitcnt lgkmcnt(8)
  v_mfma_f32_16x16x32_bf16 v[224:227], a[128:131], a[0:3], v[224:227]
  ds_read_b64_tr_b16 a[160:161], v2 offset:192
  v_mfma_f32_16x16x32_bf16 v[224:227], a[132:135], a[16:19], v[224:227]
  v_mfma_f32_16x16x32_bf16 v[228:231], a[132:135], a[20:23], v[228:231]
  ds_read_b64_tr_b16 a[162:163], v2 offset:3776
  v_mfma_f32_16x16x32_bf16 v[228:231], a[128:131], a[4:7], v[228:231]
  v_mfma_f32_16x16x32_bf16 v[232:235], a[128:131], a[8:11], v[232:235]
  ds_read_b64_tr_b16 a[164:165], v2 offset:7360
  v_mfma_f32_16x16x32_bf16 v[232:235], a[132:135], a[24:27], v[232:235]
  v_mfma_f32_16x16x32_bf16 v[236:239], a[132:135], a[28:31], v[236:239]
  ds_read_b64_tr_b16 a[166:167], v2 offset:10944
  v_mfma_f32_16x16x32_bf16 v[236:239], a[128:131], a[12:15], v[236:239]
  v_mfma_f32_16x16x32_bf16 v[252:255], a[136:139], a[12:15], v[252:255]
  ds_read_b64_tr_b16 a[168:169], v2 offset:14528
  v_mfma_f32_16x16x32_bf16 v[252:255], a[140:143], a[28:31], v[252:255]
  v_mfma_f32_16x16x32_bf16 v[248:251], a[140:143], a[24:27], v[248:251]
  ds_read_b64_tr_b16 a[170:171], v2 offset:18112
  v_mfma_f32_16x16x32_bf16 v[248:251], a[136:139], a[8:11], v[248:251]
  v_mfma_f32_16x16x32_bf16 v[244:247], a[136:139], a[4:7], v[244:247]
  ds_read_b64_tr_b16 a[172:173], v2 offset:21696
  v_mfma_f32_16x16x32_bf16 v[244:247], a[140:143], a[20:23], v[244:247]
  v_mfma_f32_16x16x32_bf16 v[240:243], a[140:143], a[16:19], v[240:243]
  ds_read_b64_tr_b16 a[174:175], v2 offset:25280
  v_mfma_f32_16x16x32_bf16 v[240:243], a[136:139], a[0:3], v[240:243]
  s_waitcnt vmcnt(1) lgkmcnt(8)
  s_barrier
  v_mfma_f32_16x16x32_bf16 v[128:131], a[144:147], a[32:35], v[128:131]
  v_and_b32 v31, 0xf0, v0
  v_add_u32 v31, 159744, v31
  v_mfma_f32_16x16x32_bf16 v[128:131], a[148:151], a[48:51], v[128:131]
  s_barrier
  v_cmp_gt_u32 vcc, 0x100, v0
  s_mov_b32 s76, 0x01000100
  v_mfma_f32_16x16x32_bf16 v[132:135], a[148:151], a[52:55], v[132:135]
  s_mov_b32 s77, 0x03020302
  v_cndmask_b32 v12, 0, v12, vcc
  v_perm_b32 v22, v12, v12, s76
  v_mfma_f32_16x16x32_bf16 v[132:135], a[144:147], a[36:39], v[132:135]
Hb2_1:
  s_cbranch_execz Hb2_2
  v_min_u32 v3, 880, v0
  v_lshlrev_b32 v3, 3, v3
  v_mfma_f32_16x16x32_bf16 v[136:139], a[144:147], a[40:43], v[136:139]
  buffer_load_dword a252, v3, s[24:27], s68 offen
  v_and_b32 v23, 0xffff, v12
  v_mfma_f32_16x16x32_bf16 v[136:139], a[148:151], a[56:59], v[136:139]
  v_perm_b32 v24, v12, v12, s77
  v_lshrrev_b32 v25, 16, v12
  v_mfma_f32_16x16x32_bf16 v[140:143], a[148:151], a[60:63], v[140:143]
  v_accvgpr_write_b32 a0, v22
  v_accvgpr_write_b32 a1, v23
  v_mfma_f32_16x16x32_bf16 v[140:143], a[144:147], a[44:47], v[140:143]
  v_accvgpr_write_b32 a2, v24
  v_accvgpr_write_b32 a3, v25
  v_mfma_f32_16x16x32_bf16 v[252:255], a[152:155], a[44:47], v[252:255]
  ds_read_b64_tr_b16 a[128:129], v2 offset:28864
  v_cndmask_b32 v15, 0, v15, vcc
  v_mfma_f32_16x16x32_bf16 v[252:255], a[156:159], a[60:63], v[252:255]
  v_perm_b32 v26, v15, v15, s76
  v_and_b32 v27, 0xffff, v15
  v_mfma_f32_16x16x32_bf16 v[248:251], a[156:159], a[56:59], v[248:251]
  ds_read_b64_tr_b16 a[130:131], v2 offset:32448
  v_perm_b32 v28, v15, v15, s77
  v_mfma_f32_16x16x32_bf16 v[248:251], a[152:155], a[40:43], v[248:251]
  v_lshrrev_b32 v29, 16, v15
  v_accvgpr_write_b32 a4, v26
  v_mfma_f32_16x16x32_bf16 v[244:247], a[152:155], a[36:39], v[244:247]
  ds_read_b64_tr_b16 a[132:133], v2 offset:36032
  v_accvgpr_write_b32 a5, v27
  v_mfma_f32_16x16x32_bf16 v[244:247], a[156:159], a[52:55], v[244:247]
  ds_read_b128 a[16:19], v31 offset:1536
  v_accvgpr_write_b32 a6, v28
  v_mfma_f32_16x16x32_bf16 v[240:243], a[156:159], a[48:51], v[240:243]
  ds_read_b128 a[20:23], v31 offset:3584
  v_accvgpr_write_b32 a7, v29
  v_mfma_f32_16x16x32_bf16 v[240:243], a[152:155], a[32:35], v[240:243]
  s_waitcnt vmcnt(16) lgkmcnt(5)
  ds_read_b64_tr_b16 a[134:135], v2 offset:39616
  v_cndmask_b32 v18, 0, v18, vcc
  v_mfma_f32_16x16x32_bf16 v[128:131], a[160:163], a[64:67], v[128:131]
  ds_read_b64_tr_b16 a[136:137], v2 offset:43200
  v_perm_b32 v22, v18, v18, s76
  v_mfma_f32_16x16x32_bf16 v[128:131], a[164:167], a[80:83], v[128:131]
  v_and_b32 v23, 0xffff, v18
  v_perm_b32 v24, v18, v18, s77
  v_mfma_f32_16x16x32_bf16 v[132:135], a[164:167], a[84:87], v[132:135]
  ds_read_b64_tr_b16 a[138:139], v2 offset:46784
  v_lshrrev_b32 v25, 16, v18
  v_mfma_f32_16x16x32_bf16 v[132:135], a[160:163], a[68:71], v[132:135]
  v_accvgpr_write_b32 a8, v22
  v_accvgpr_write_b32 a9, v23
  v_mfma_f32_16x16x32_bf16 v[136:139], a[160:163], a[72:75], v[136:139]
  ds_read_b64_tr_b16 a[140:141], v2 offset:50368
  v_accvgpr_write_b32 a10, v24
  v_mfma_f32_16x16x32_bf16 v[136:139], a[164:167], a[88:91], v[136:139]
  v_accvgpr_write_b32 a11, v25
  v_cndmask_b32 v21, 0, v21, vcc
  v_mfma_f32_16x16x32_bf16 v[140:143], a[164:167], a[92:95], v[140:143]
  ds_read_b64_tr_b16 a[142:143], v2 offset:53952
  v_perm_b32 v26, v21, v21, s76
  v_mfma_f32_16x16x32_bf16 v[140:143], a[160:163], a[76:79], v[140:143]
  v_and_b32 v27, 0xffff, v21
  v_perm_b32 v28, v21, v21, s77
  v_mfma_f32_16x16x32_bf16 v[252:255], a[168:171], a[76:79], v[252:255]
  ds_read_b64_tr_b16 a[144:145], v1 offset:28672
  v_lshrrev_b32 v29, 16, v21
  v_mfma_f32_16x16x32_bf16 v[252:255], a[172:175], a[92:95], v[252:255]
  v_accvgpr_write_b32 a12, v26
  v_accvgpr_write_b32 a13, v27
  v_mfma_f32_16x16x32_bf16 v[248:251], a[172:175], a[88:91], v[248:251]
  ds_read_b64_tr_b16 a[146:147], v1 offset:32256
  v_accvgpr_write_b32 a14, v28
  v_mfma_f32_16x16x32_bf16 v[248:251], a[168:171], a[72:75], v[248:251]
  v_accvgpr_write_b32 a15, v29
  v_mfma_f32_16x16x32_bf16 v[244:247], a[168:171], a[68:71], v[244:247]
  ds_read_b64_tr_b16 a[148:149], v1 offset:35840
  v_mfma_f32_16x16x32_bf16 v[244:247], a[172:175], a[84:87], v[244:247]
  v_mfma_f32_16x16x32_bf16 v[240:243], a[172:175], a[80:83], v[240:243]
  ds_read_b64_tr_b16 a[150:151], v1 offset:39424
  v_mov_b32 v9, s3
  v_mfma_f32_16x16x32_bf16 v[240:243], a[168:171], a[64:67], v[240:243]
  s_waitcnt lgkmcnt(9)
  v_mfma_f32_16x16x32_bf16 v[128:131], a[16:19], a[0:3], v[128:131]
  v_mfma_f32_16x16x32_bf16 v[132:135], a[16:19], a[4:7], v[132:135]
  v_mfma_f32_16x16x32_bf16 v[136:139], a[16:19], a[8:11], v[136:139]
  v_mfma_f32_16x16x32_bf16 v[140:143], a[16:19], a[12:15], v[140:143]
  v_mfma_f32_16x16x32_bf16 v[240:243], a[20:23], a[0:3], v[240:243]
  v_mfma_f32_16x16x32_bf16 v[244:247], a[20:23], a[4:7], v[244:247]
  v_mfma_f32_16x16x32_bf16 v[248:251], a[20:23], a[8:11], v[248:251]
  v_mfma_f32_16x16x32_bf16 v[252:255], a[20:23], a[12:15], v[252:255]
  s_waitcnt vmcnt(1) lgkmcnt(4)
  v_mfma_f32_16x16x32_bf16 v[128:131], a[128:131], a[96:99], v[128:131]
  ds_read_b128 a[24:27], v31 offset:0
  v_mfma_f32_16x16x32_bf16 v[128:131], a[132:135], a[112:115], v[128:131]
  ds_read_b64_tr_b16 a[152:153], v1 offset:43008
  v_mfma_f32_16x16x32_bf16 v[132:135], a[132:135], a[116:119], v[132:135]
  ds_read_b128 a[28:31], v31 offset:2048
  v_mfma_f32_16x16x32_bf16 v[132:135], a[128:131], a[100:103], v[132:135]
  ds_read_b64_tr_b16 a[154:155], v1 offset:46592
  v_mfma_f32_16x16x32_bf16 v[136:139], a[128:131], a[104:107], v[136:139]
  ds_read_b64_tr_b16 a[156:157], v1 offset:50176
  v_mfma_f32_16x16x32_bf16 v[136:139], a[132:135], a[120:123], v[136:139]
  v_mfma_f32_16x16x32_bf16 v[140:143], a[132:135], a[124:127], v[140:143]
  ds_read_b64_tr_b16 a[158:159], v1 offset:53760
  v_mfma_f32_16x16x32_bf16 v[140:143], a[128:131], a[108:111], v[140:143]
  v_mfma_f32_16x16x32_bf16 v[252:255], a[136:139], a[108:111], v[252:255]
  ds_read_b64_tr_b16 a[160:161], v2 offset:0
  v_mul_f32 v22, v10, v128
  v_mul_f32 v23, v10, v129
  v_mul_f32 v24, v10, v130
  v_mfma_f32_16x16x32_bf16 v[252:255], a[140:143], a[124:127], v[252:255]
  v_mul_f32 v25, v10, v131
  v_exp_f32 v22, v22
  v_mul_f32 v26, v13, v132
  v_mfma_f32_16x16x32_bf16 v[248:251], a[140:143], a[120:123], v[248:251]
  ds_read_b64_tr_b16 a[162:163], v2 offset:3584
  v_exp_f32 v23, v23
  v_mul_f32 v27, v13, v133
  v_mfma_f32_16x16x32_bf16 v[248:251], a[136:139], a[104:107], v[248:251]
  v_exp_f32 v24, v24
  v_mul_f32 v28, v13, v134
  v_mfma_f32_16x16x32_bf16 v[244:247], a[136:139], a[100:103], v[244:247]
  ds_read_b64_tr_b16 a[164:165], v2 offset:7168
  v_exp_f32 v25, v25
  v_mul_f32 v29, v13, v135
  v_mfma_f32_16x16x32_bf16 v[244:247], a[140:143], a[116:119], v[244:247]
  v_exp_f32 v26, v26
  v_fma_f32 v22, v22, v11, v11
  v_mfma_f32_16x16x32_bf16 v[240:243], a[140:143], a[112:115], v[240:243]
  ds_read_b64_tr_b16 a[166:167], v2 offset:10752
  v_exp_f32 v27, v27
  v_fma_f32 v23, v23, v11, v11
  v_mfma_f32_16x16x32_bf16 v[240:243], a[136:139], a[96:99], v[240:243]
  s_waitcnt lgkmcnt(4)
  v_exp_f32 v28, v28
  v_fma_f32 v24, v24, v11, v11
  v_mfma_f32_16x16x32_bf16 v[32:35], a[144:147], a[32:35], v[32:35]
  ds_read_b64_tr_b16 a[168:169], v2 offset:14336
  v_exp_f32 v29, v29
  v_fma_f32 v25, v25, v11, v11
  v_mfma_f32_16x16x32_bf16 v[32:35], a[148:151], a[48:51], v[32:35]
  v_rcp_f32 v22, v22
  v_fma_f32 v26, v26, v14, v14
  v_mfma_f32_16x16x32_bf16 v[36:39], a[148:151], a[52:55], v[36:39]
  ds_read_b64_tr_b16 a[170:171], v2 offset:17920
  v_rcp_f32 v23, v23
  v_fma_f32 v27, v27, v14, v14
  v_mfma_f32_16x16x32_bf16 v[36:39], a[144:147], a[36:39], v[36:39]
  v_rcp_f32 v24, v24
  v_fma_f32 v28, v28, v14, v14
  v_mfma_f32_16x16x32_bf16 v[40:43], a[144:147], a[40:43], v[40:43]
  ds_read_b64_tr_b16 a[172:173], v2 offset:21504
  v_rcp_f32 v25, v25
  v_fma_f32 v29, v29, v14, v14
  v_mfma_f32_16x16x32_bf16 v[40:43], a[148:151], a[56:59], v[40:43]
  v_rcp_f32 v26, v26
  v_mul_f32 v240, v128, v240
  v_mfma_f32_16x16x32_bf16 v[44:47], a[148:151], a[60:63], v[44:47]
  ds_read_b64_tr_b16 a[174:175], v2 offset:25088
  v_rcp_f32 v27, v27
  v_mul_f32 v241, v129, v241
  v_mfma_f32_16x16x32_bf16 v[44:47], a[144:147], a[44:47], v[44:47]
  s_waitcnt lgkmcnt(11)
  v_rcp_f32 v28, v28
  v_mul_f32 v242, v130, v242
  v_mfma_f32_16x16x32_bf16 v[32:35], a[24:27], a[0:3], v[32:35]
  ds_read_b64_tr_b16 a[128:129], v2 offset:28672
  v_rcp_f32 v29, v29
  v_mul_f32 v243, v131, v243
  v_mfma_f32_16x16x32_bf16 v[36:39], a[24:27], a[4:7], v[36:39]
  v_mul_f32 v240, v240, v22
  v_mul_f32 v241, v241, v23
  v_mul_f32 v242, v242, v24
  v_mul_f32 v243, v243, v25
  v_mfma_f32_16x16x32_bf16 v[40:43], a[24:27], a[8:11], v[40:43]
  ds_read_b64_tr_b16 a[130:131], v2 offset:32256
  v_mul_f32 v22, v16, v136
  v_mul_f32 v23, v16, v137
  v_mul_f32 v24, v16, v138
  v_mfma_f32_16x16x32_bf16 v[44:47], a[24:27], a[12:15], v[44:47]
  v_mul_f32 v25, v16, v139
  v_exp_f32 v22, v22
  v_mul_f32 v244, v132, v244
  v_mfma_f32_16x16x32_bf16 v[144:147], a[28:31], a[0:3], v[144:147]
  ds_read_b64_tr_b16 a[132:133], v2 offset:35840
  v_exp_f32 v23, v23
  v_mul_f32 v245, v133, v245
  v_mfma_f32_16x16x32_bf16 v[148:151], a[28:31], a[4:7], v[148:151]
  v_exp_f32 v24, v24
  v_mul_f32 v246, v134, v246
  v_mfma_f32_16x16x32_bf16 v[152:155], a[28:31], a[8:11], v[152:155]
  ds_read_b64_tr_b16 a[134:135], v2 offset:39424
  v_exp_f32 v25, v25
  v_mul_f32 v247, v135, v247
  v_mfma_f32_16x16x32_bf16 v[156:159], a[28:31], a[12:15], v[156:159]
  v_mul_f32 v244, v244, v26
  v_mul_f32 v245, v245, v27
  v_mul_f32 v246, v246, v28
  v_mul_f32 v247, v247, v29
  v_mfma_f32_16x16x32_bf16 v[156:159], a[152:155], a[44:47], v[156:159]
  ds_read_b64_tr_b16 a[136:137], v2 offset:43008
  v_cvt_pk_bf16_f32 v128, v240, v241
  v_cvt_pk_bf16_f32 v129, v242, v243
  v_mfma_f32_16x16x32_bf16 v[156:159], a[156:159], a[60:63], v[156:159]
  buffer_store_dwordx2 v[128:129], v0, s[36:39], s65 offen offset:0 sc1
  v_mul_f32 v26, v19, v140
  v_mul_f32 v27, v19, v141
  v_mul_f32 v28, v19, v142
  v_mfma_f32_16x16x32_bf16 v[152:155], a[156:159], a[56:59], v[152:155]
  ds_read_b64_tr_b16 a[138:139], v2 offset:46592
  v_mul_f32 v29, v19, v143
  v_exp_f32 v26, v26
  v_mfma_f32_16x16x32_bf16 v[152:155], a[152:155], a[40:43], v[152:155]
  v_fma_f32 v22, v22, v17, v17
  v_exp_f32 v27, v27
  v_fma_f32 v23, v23, v17, v17
  v_mfma_f32_16x16x32_bf16 v[148:151], a[152:155], a[36:39], v[148:151]
  ds_read_b64_tr_b16 a[140:141], v2 offset:50176
  v_exp_f32 v28, v28
  v_fma_f32 v24, v24, v17, v17
  v_mfma_f32_16x16x32_bf16 v[148:151], a[156:159], a[52:55], v[148:151]
  v_exp_f32 v29, v29
  v_fma_f32 v25, v25, v17, v17
  v_cvt_pk_bf16_f32 v132, v244, v245
  v_mfma_f32_16x16x32_bf16 v[144:147], a[156:159], a[48:51], v[144:147]
  ds_read_b64_tr_b16 a[142:143], v2 offset:53760
  v_cvt_pk_bf16_f32 v133, v246, v247
  v_mfma_f32_16x16x32_bf16 v[144:147], a[152:155], a[32:35], v[144:147]
  s_waitcnt lgkmcnt(8)
  buffer_store_dwordx2 v[132:133], v0, s[36:39], s65 offen offset:1024 sc1
  v_rcp_f32 v22, v22
  v_fma_f32 v26, v26, v20, v20
  v_mfma_f32_16x16x32_bf16 v[32:35], a[160:163], a[64:67], v[32:35]
  ds_read_b64_tr_b16 a[144:145], v1 offset:28704
  v_rcp_f32 v23, v23
  v_fma_f32 v27, v27, v20, v20
  v_mfma_f32_16x16x32_bf16 v[32:35], a[164:167], a[80:83], v[32:35]
  v_rcp_f32 v24, v24
  v_fma_f32 v28, v28, v20, v20
  v_mfma_f32_16x16x32_bf16 v[36:39], a[164:167], a[84:87], v[36:39]
  ds_read_b64_tr_b16 a[146:147], v1 offset:32288
  v_rcp_f32 v25, v25
  v_fma_f32 v29, v29, v20, v20
  v_mfma_f32_16x16x32_bf16 v[36:39], a[160:163], a[68:71], v[36:39]
  v_rcp_f32 v26, v26
  v_mul_f32 v248, v136, v248
  v_mfma_f32_16x16x32_bf16 v[40:43], a[160:163], a[72:75], v[40:43]
  ds_read_b64_tr_b16 a[148:149], v1 offset:35872
  v_rcp_f32 v27, v27
  v_mul_f32 v249, v137, v249
  v_mfma_f32_16x16x32_bf16 v[40:43], a[164:167], a[88:91], v[40:43]
  v_rcp_f32 v28, v28
  v_mul_f32 v250, v138, v250
  v_mfma_f32_16x16x32_bf16 v[44:47], a[164:167], a[92:95], v[44:47]
  ds_read_b64_tr_b16 a[150:151], v1 offset:39456
  v_rcp_f32 v29, v29
  v_mul_f32 v251, v139, v251
  v_mfma_f32_16x16x32_bf16 v[44:47], a[160:163], a[76:79], v[44:47]
  v_mul_f32 v248, v248, v22
  v_mul_f32 v249, v249, v23
  v_mul_f32 v250, v250, v24
  v_mul_f32 v251, v251, v25
  v_mfma_f32_16x16x32_bf16 v[156:159], a[168:171], a[76:79], v[156:159]
  v_mul_f32 v252, v140, v252
  v_mul_f32 v253, v141, v253
  v_mul_f32 v254, v142, v254
  v_mul_f32 v255, v143, v255
  v_mfma_f32_16x16x32_bf16 v[156:159], a[172:175], a[92:95], v[156:159]
  v_cvt_pk_bf16_f32 v136, v248, v249
  v_cvt_pk_bf16_f32 v137, v250, v251
  v_mfma_f32_16x16x32_bf16 v[152:155], a[172:175], a[88:91], v[152:155]
  buffer_store_dwordx2 v[136:137], v0, s[36:39], s66 offen offset:0 sc1
  v_mul_f32 v252, v252, v26
  v_mul_f32 v253, v253, v27
  v_mul_f32 v254, v254, v28
  v_mfma_f32_16x16x32_bf16 v[152:155], a[168:171], a[72:75], v[152:155]
  v_mul_f32 v255, v255, v29
  v_cvt_pk_bf16_f32 v140, v252, v253
  v_cvt_pk_bf16_f32 v141, v254, v255
  v_mfma_f32_16x16x32_bf16 v[148:151], a[168:171], a[68:71], v[148:151]
  buffer_store_dwordx2 v[140:141], v0, s[36:39], s66 offen offset:1024 sc1
  s_mov_b32 s65, s67
  s_add_u32 s66, s67, 262144
  v_mfma_f32_16x16x32_bf16 v[148:151], a[172:175], a[84:87], v[148:151]
  v_lshrrev_b32 v128, 4, v0
  s_add_u32 s87, s52, s54
  s_and_b32 s87, s87, 3
  s_and_b32 s90, s2, 1
  v_mfma_f32_16x16x32_bf16 v[144:147], a[172:175], a[80:83], v[144:147]
  s_lshl_b32 s89, s53, 7
  s_lshl3_add_u32 s89, s70, s89
  s_mul_i32 s88, s90, 3670016
  s_add_u32 s89, s89, s88
  s_lshr_b32 s88, s44, 1
  v_mfma_f32_16x16x32_bf16 v[144:147], a[168:171], a[64:67], v[144:147]
  s_waitcnt lgkmcnt(4)
  s_mul_i32 s88, s88, 196608
  v_bfe_u32 v129, v128, 4, 2
  v_bfe_u32 v130, v128, 1, 2
  v_xor_b32 v129, v129, v130
  v_mfma_f32_16x16x32_bf16 v[32:35], a[128:131], a[96:99], v[32:35]
  ds_read_b128 a[16:19], v31 offset:256
  v_lshlrev_b32 v129, 5, v129
  v_and_b32 v130, 1, v128
  v_lshl_add_u32 v129, v130, 4, v129
  v_mfma_f32_16x16x32_bf16 v[32:35], a[132:135], a[112:115], v[32:35]
  ds_read_b64_tr_b16 a[152:153], v1 offset:43040
  v_lshrrev_b32 v130, 3, v128
  v_lshlrev_b32 v130, 11, v130
  s_sub_u32 s24, s24, 2048
  v_mfma_f32_16x16x32_bf16 v[36:39], a[132:135], a[116:119], v[36:39]
  s_subb_u32 s25, s25, 0
  s_mov_b32 s26, 7342080
  ds_read_b128 a[20:23], v31 offset:2304
  v_add3_u32 v129, v129, v130, s89
  v_add_u32 v133, 2048, v129
  v_mfma_f32_16x16x32_bf16 v[36:39], a[128:131], a[100:103], v[36:39]
  ds_read_b64_tr_b16 a[154:155], v1 offset:46624
  v_add_u32 v134, 17408, v129
  v_xor_b32 v135, 128, v129
  v_add_u32 v136, 15360, v135
  v_mfma_f32_16x16x32_bf16 v[40:43], a[128:131], a[104:107], v[40:43]
  ds_read_b64_tr_b16 a[156:157], v1 offset:50208
  v_and_b32 v129, 7, v128
  v_lshrrev_b32 v131, 4, v128
  v_xor_b32 v129, v129, v131
  v_mfma_f32_16x16x32_bf16 v[40:43], a[132:135], a[120:123], v[40:43]
  v_lshl_add_u32 v252, v129, 4, v130
  v_xor_b32 v253, 64, v252
  v_add_u32 v253, 16384, v253
  s_lshl2_add_u32 s89, s52, s44
  v_mfma_f32_16x16x32_bf16 v[44:47], a[132:135], a[124:127], v[44:47]
  s_lshl_b32 s89, s89, 18
  s_mul_i32 s91, s90, 114688
  s_add_u32 s89, s89, s91
  s_add_u32 s89, s89, 19922944
  ds_read_b64_tr_b16 a[158:159], v1 offset:53792
  v_mfma_f32_16x16x32_bf16 v[44:47], a[128:131], a[108:111], v[44:47]
  v_add_u32 v137, s89, v0
  v_bfe_u32 v129, v128, 3, 2
  v_lshlrev_b32 v129, 5, v129
  v_and_b32 v130, 3, v128
  v_mfma_f32_16x16x32_bf16 v[156:159], a[136:139], a[108:111], v[156:159]
  ds_read_b64_tr_b16 a[160:161], v2 offset:32
  v_lshl_add_u32 v129, v130, 3, v129
  v_lshrrev_b32 v130, 2, v128
  v_lshl_add_u32 v240, v130, 7, v129
  v_mfma_f32_16x16x32_bf16 v[156:159], a[140:143], a[124:127], v[156:159]
  v_xor_b32 v241, 32, v240
  v_xor_b32 v242, 64, v240
  v_xor_b32 v243, 96, v240
  v_xor_b32 v244, 65536, v240
  v_mfma_f32_16x16x32_bf16 v[152:155], a[140:143], a[120:123], v[152:155]
  ds_read_b64_tr_b16 a[162:163], v2 offset:3616
  v_xor_b32 v245, 65568, v240
  v_xor_b32 v246, 65600, v240
  v_xor_b32 v247, 65632, v240
  v_mfma_f32_16x16x32_bf16 v[152:155], a[136:139], a[104:107], v[152:155]
  v_xor_b32 v248, 131072, v240
  v_xor_b32 v249, 131104, v240
  v_xor_b32 v250, 131136, v240
  v_xor_b32 v251, 131168, v240
  v_mfma_f32_16x16x32_bf16 v[148:151], a[136:139], a[100:103], v[148:151]
  s_lshr_b32 s89, s52, 1
  s_lshl_b32 s89, s89, 5
  s_lshl2_add_u32 s89, s90, s89
  ds_read_b64_tr_b16 a[164:165], v2 offset:7200
  v_and_b32 v129, 3, v128
  v_mfma_f32_16x16x32_bf16 v[148:151], a[140:143], a[116:119], v[148:151]
  v_bfe_u32 v130, v128, 2, 2
  v_lshl_add_u32 v129, v129, 3, v130
  v_add_lshl_u32 v138, v129, s89, 7
  s_mov_b32 s91, 5373952
  v_mfma_f32_16x16x32_bf16 v[144:147], a[140:143], a[112:115], v[144:147]
  ds_read_b64_tr_b16 a[166:167], v2 offset:10784
  v_mul_f32 v22, v10, v32
  v_mul_f32 v23, v10, v33
  v_mul_f32 v24, v10, v34
  v_mfma_f32_16x16x32_bf16 v[144:147], a[136:139], a[96:99], v[144:147]
  s_waitcnt lgkmcnt(4)
  v_mul_f32 v25, v10, v35
  v_exp_f32 v22, v22
  v_mul_f32 v26, v13, v36
  v_mfma_f32_16x16x32_bf16 v[48:51], a[144:147], a[32:35], v[48:51]
  ds_read_b64_tr_b16 a[168:169], v2 offset:14368
  v_exp_f32 v23, v23
  v_mul_f32 v27, v13, v37
  v_mfma_f32_16x16x32_bf16 v[48:51], a[148:151], a[48:51], v[48:51]
  v_exp_f32 v24, v24
  v_mul_f32 v28, v13, v38
  v_mfma_f32_16x16x32_bf16 v[52:55], a[148:151], a[52:55], v[52:55]
  ds_read_b64_tr_b16 a[170:171], v2 offset:17952
  v_exp_f32 v25, v25
  v_mul_f32 v29, v13, v39
  v_mfma_f32_16x16x32_bf16 v[52:55], a[144:147], a[36:39], v[52:55]
  v_exp_f32 v26, v26
  v_fma_f32 v22, v22, v11, v11
  v_mfma_f32_16x16x32_bf16 v[56:59], a[144:147], a[40:43], v[56:59]
  ds_read_b64_tr_b16 a[172:173], v2 offset:21536
  v_exp_f32 v27, v27
  v_fma_f32 v23, v23, v11, v11
  v_mfma_f32_16x16x32_bf16 v[56:59], a[148:151], a[56:59], v[56:59]
  v_exp_f32 v28, v28
  v_fma_f32 v24, v24, v11, v11
  v_mfma_f32_16x16x32_bf16 v[60:63], a[148:151], a[60:63], v[60:63]
  ds_read_b64_tr_b16 a[174:175], v2 offset:25120
  v_exp_f32 v29, v29
  v_fma_f32 v25, v25, v11, v11
  v_mfma_f32_16x16x32_bf16 v[60:63], a[144:147], a[44:47], v[60:63]
  s_waitcnt lgkmcnt(11)
  v_rcp_f32 v22, v22
  v_fma_f32 v26, v26, v14, v14
  v_mfma_f32_16x16x32_bf16 v[48:51], a[16:19], a[0:3], v[48:51]
  ds_read_b64_tr_b16 a[128:129], v2 offset:28704
  v_rcp_f32 v23, v23
  v_fma_f32 v27, v27, v14, v14
  v_mfma_f32_16x16x32_bf16 v[52:55], a[16:19], a[4:7], v[52:55]
  v_rcp_f32 v24, v24
  v_fma_f32 v28, v28, v14, v14
  v_mfma_f32_16x16x32_bf16 v[56:59], a[16:19], a[8:11], v[56:59]
  ds_read_b64_tr_b16 a[130:131], v2 offset:32288
  v_rcp_f32 v25, v25
  v_fma_f32 v29, v29, v14, v14
  v_mfma_f32_16x16x32_bf16 v[60:63], a[16:19], a[12:15], v[60:63]
  v_rcp_f32 v26, v26
  v_mul_f32 v144, v32, v144
  v_mfma_f32_16x16x32_bf16 v[160:163], a[20:23], a[0:3], v[160:163]
  ds_read_b64_tr_b16 a[132:133], v2 offset:35872
  v_rcp_f32 v27, v27
  v_mul_f32 v145, v33, v145
  v_mfma_f32_16x16x32_bf16 v[164:167], a[20:23], a[4:7], v[164:167]
  v_rcp_f32 v28, v28
  v_mul_f32 v146, v34, v146
  v_mfma_f32_16x16x32_bf16 v[168:171], a[20:23], a[8:11], v[168:171]
  ds_read_b64_tr_b16 a[134:135], v2 offset:39456
  v_rcp_f32 v29, v29
  v_mul_f32 v147, v35, v147
  v_mfma_f32_16x16x32_bf16 v[172:175], a[20:23], a[12:15], v[172:175]
  v_mul_f32 v144, v144, v22
  v_mul_f32 v145, v145, v23
  v_mul_f32 v146, v146, v24
  v_mul_f32 v147, v147, v25
  v_mfma_f32_16x16x32_bf16 v[172:175], a[152:155], a[44:47], v[172:175]
  ds_read_b64_tr_b16 a[136:137], v2 offset:43040
  v_mul_f32 v22, v16, v40
  v_mul_f32 v23, v16, v41
  v_mul_f32 v24, v16, v42
  v_mul_f32 v25, v16, v43
  v_mfma_f32_16x16x32_bf16 v[172:175], a[156:159], a[60:63], v[172:175]
  v_exp_f32 v22, v22
  v_mul_f32 v148, v36, v148
  v_mfma_f32_16x16x32_bf16 v[168:171], a[156:159], a[56:59], v[168:171]
  ds_read_b64_tr_b16 a[138:139], v2 offset:46624
  v_exp_f32 v23, v23
  v_mul_f32 v149, v37, v149
  v_mfma_f32_16x16x32_bf16 v[168:171], a[152:155], a[40:43], v[168:171]
  v_exp_f32 v24, v24
  v_mul_f32 v150, v38, v150
  v_mfma_f32_16x16x32_bf16 v[164:167], a[152:155], a[36:39], v[164:167]
  ds_read_b64_tr_b16 a[140:141], v2 offset:50208
  v_exp_f32 v25, v25
  v_mul_f32 v151, v39, v151
  v_mfma_f32_16x16x32_bf16 v[164:167], a[156:159], a[52:55], v[164:167]
  v_mul_f32 v148, v148, v26
  v_mul_f32 v149, v149, v27
  v_mul_f32 v150, v150, v28
  v_mul_f32 v151, v151, v29
  v_mfma_f32_16x16x32_bf16 v[160:163], a[156:159], a[48:51], v[160:163]
  ds_read_b64_tr_b16 a[142:143], v2 offset:53792
  v_cvt_pk_bf16_f32 v32, v144, v145
  v_cvt_pk_bf16_f32 v33, v146, v147
  v_mul_f32 v26, v19, v44
  v_mfma_f32_16x16x32_bf16 v[160:163], a[152:155], a[32:35], v[160:163]
  s_waitcnt lgkmcnt(8)
  v_mul_f32 v27, v19, v45
  v_mul_f32 v28, v19, v46
  v_mul_f32 v29, v19, v47
  v_mfma_f32_16x16x32_bf16 v[48:51], a[160:163], a[64:67], v[48:51]
  ds_read_b64_tr_b16 a[144:145], v1 offset:28736
  v_exp_f32 v26, v26
  v_fma_f32 v22, v22, v17, v17
  v_mfma_f32_16x16x32_bf16 v[48:51], a[164:167], a[80:83], v[48:51]
  v_exp_f32 v27, v27
  v_fma_f32 v23, v23, v17, v17
  v_mfma_f32_16x16x32_bf16 v[52:55], a[164:167], a[84:87], v[52:55]
  ds_read_b64_tr_b16 a[146:147], v1 offset:32320
  v_exp_f32 v28, v28
  v_fma_f32 v24, v24, v17, v17
  v_mfma_f32_16x16x32_bf16 v[52:55], a[160:163], a[68:71], v[52:55]
  v_exp_f32 v29, v29
  v_fma_f32 v25, v25, v17, v17
  v_cvt_pk_bf16_f32 v36, v148, v149
  v_mfma_f32_16x16x32_bf16 v[56:59], a[160:163], a[72:75], v[56:59]
  ds_read_b64_tr_b16 a[148:149], v1 offset:35904
  v_cvt_pk_bf16_f32 v37, v150, v151
  v_rcp_f32 v22, v22
  v_mfma_f32_16x16x32_bf16 v[56:59], a[164:167], a[88:91], v[56:59]
  v_fma_f32 v26, v26, v20, v20
  v_rcp_f32 v23, v23
  v_fma_f32 v27, v27, v20, v20
  v_mfma_f32_16x16x32_bf16 v[60:63], a[164:167], a[92:95], v[60:63]
  ds_read_b64_tr_b16 a[150:151], v1 offset:39488
  v_rcp_f32 v24, v24
  v_fma_f32 v28, v28, v20, v20
  v_mfma_f32_16x16x32_bf16 v[60:63], a[160:163], a[76:79], v[60:63]
  v_rcp_f32 v25, v25
  v_fma_f32 v29, v29, v20, v20
  v_mfma_f32_16x16x32_bf16 v[172:175], a[168:171], a[76:79], v[172:175]
  v_rcp_f32 v26, v26
  v_mul_f32 v152, v40, v152
  v_mfma_f32_16x16x32_bf16 v[172:175], a[172:175], a[92:95], v[172:175]
  v_rcp_f32 v27, v27
  v_mul_f32 v153, v41, v153
  v_mfma_f32_16x16x32_bf16 v[168:171], a[172:175], a[88:91], v[168:171]
  v_rcp_f32 v28, v28
  v_mul_f32 v154, v42, v154
  v_mfma_f32_16x16x32_bf16 v[168:171], a[168:171], a[72:75], v[168:171]
  v_rcp_f32 v29, v29
  v_mul_f32 v155, v43, v155
  v_mul_f32 v152, v152, v22
  v_mfma_f32_16x16x32_bf16 v[164:167], a[168:171], a[68:71], v[164:167]
  v_mul_f32 v153, v153, v23
  v_mul_f32 v154, v154, v24
  v_mul_f32 v155, v155, v25
  v_mul_f32 v156, v44, v156
  v_mfma_f32_16x16x32_bf16 v[164:167], a[172:175], a[84:87], v[164:167]
  v_mul_f32 v157, v45, v157
  v_mul_f32 v158, v46, v158
  v_mul_f32 v159, v47, v159
  v_cvt_pk_bf16_f32 v40, v152, v153
  v_mfma_f32_16x16x32_bf16 v[160:163], a[172:175], a[80:83], v[160:163]
  v_cvt_pk_bf16_f32 v41, v154, v155
  v_mul_f32 v156, v156, v26
  v_mul_f32 v157, v157, v27
  v_mul_f32 v158, v158, v28
  v_mfma_f32_16x16x32_bf16 v[160:163], a[168:171], a[64:67], v[160:163]
  s_waitcnt lgkmcnt(4)
  v_mul_f32 v159, v159, v29
  v_cvt_pk_bf16_f32 v44, v156, v157
  v_cvt_pk_bf16_f32 v45, v158, v159
  v_mfma_f32_16x16x32_bf16 v[48:51], a[128:131], a[96:99], v[48:51]
  ds_read_b128 a[24:27], v31 offset:512
  v_mfma_f32_16x16x32_bf16 v[48:51], a[132:135], a[112:115], v[48:51]
  ds_read_b64_tr_b16 a[152:153], v1 offset:43072
  v_mfma_f32_16x16x32_bf16 v[52:55], a[132:135], a[116:119], v[52:55]
  ds_read_b128 a[28:31], v31 offset:2560
  v_mfma_f32_16x16x32_bf16 v[52:55], a[128:131], a[100:103], v[52:55]
  ds_read_b64_tr_b16 a[154:155], v1 offset:46656
  v_mfma_f32_16x16x32_bf16 v[56:59], a[128:131], a[104:107], v[56:59]
  ds_read_b64_tr_b16 a[156:157], v1 offset:50240
  v_mfma_f32_16x16x32_bf16 v[56:59], a[132:135], a[120:123], v[56:59]
  v_mfma_f32_16x16x32_bf16 v[60:63], a[132:135], a[124:127], v[60:63]
  ds_read_b64_tr_b16 a[158:159], v1 offset:53824
  v_mfma_f32_16x16x32_bf16 v[60:63], a[128:131], a[108:111], v[60:63]
  v_mfma_f32_16x16x32_bf16 v[172:175], a[136:139], a[108:111], v[172:175]
  ds_read_b64_tr_b16 a[160:161], v2 offset:64
  v_mul_f32 v22, v10, v48
  v_mul_f32 v23, v10, v49
  v_mul_f32 v24, v10, v50
  v_mfma_f32_16x16x32_bf16 v[172:175], a[140:143], a[124:127], v[172:175]
  v_mul_f32 v25, v10, v51
  v_exp_f32 v22, v22
  v_mul_f32 v26, v13, v52
  v_mfma_f32_16x16x32_bf16 v[168:171], a[140:143], a[120:123], v[168:171]
  ds_read_b64_tr_b16 a[162:163], v2 offset:3648
  v_exp_f32 v23, v23
  v_mul_f32 v27, v13, v53
  v_mfma_f32_16x16x32_bf16 v[168:171], a[136:139], a[104:107], v[168:171]
  v_exp_f32 v24, v24
  v_mul_f32 v28, v13, v54
  v_mfma_f32_16x16x32_bf16 v[164:167], a[136:139], a[100:103], v[164:167]
  ds_read_b64_tr_b16 a[164:165], v2 offset:7232
  v_exp_f32 v25, v25
  v_mul_f32 v29, v13, v55
  v_mfma_f32_16x16x32_bf16 v[164:167], a[140:143], a[116:119], v[164:167]
  v_exp_f32 v26, v26
  v_fma_f32 v22, v22, v11, v11
  v_mfma_f32_16x16x32_bf16 v[160:163], a[140:143], a[112:115], v[160:163]
  ds_read_b64_tr_b16 a[166:167], v2 offset:10816
  v_exp_f32 v27, v27
  v_fma_f32 v23, v23, v11, v11
  v_mfma_f32_16x16x32_bf16 v[160:163], a[136:139], a[96:99], v[160:163]
  s_waitcnt lgkmcnt(4)
  v_exp_f32 v28, v28
  v_fma_f32 v24, v24, v11, v11
  v_mfma_f32_16x16x32_bf16 v[64:67], a[144:147], a[32:35], v[64:67]
  ds_read_b64_tr_b16 a[168:169], v2 offset:14400
  v_exp_f32 v29, v29
  v_fma_f32 v25, v25, v11, v11
  v_mfma_f32_16x16x32_bf16 v[64:67], a[148:151], a[48:51], v[64:67]
  v_rcp_f32 v22, v22
  v_fma_f32 v26, v26, v14, v14
  v_mfma_f32_16x16x32_bf16 v[68:71], a[148:151], a[52:55], v[68:71]
  ds_read_b64_tr_b16 a[170:171], v2 offset:17984
  v_rcp_f32 v23, v23
  v_fma_f32 v27, v27, v14, v14
  v_mfma_f32_16x16x32_bf16 v[68:71], a[144:147], a[36:39], v[68:71]
  v_rcp_f32 v24, v24
  v_fma_f32 v28, v28, v14, v14
  v_mfma_f32_16x16x32_bf16 v[72:75], a[144:147], a[40:43], v[72:75]
  ds_read_b64_tr_b16 a[172:173], v2 offset:21568
  v_rcp_f32 v25, v25
  v_fma_f32 v29, v29, v14, v14
  v_mfma_f32_16x16x32_bf16 v[72:75], a[148:151], a[56:59], v[72:75]
  v_rcp_f32 v26, v26
  v_mul_f32 v160, v48, v160
  v_mfma_f32_16x16x32_bf16 v[76:79], a[148:151], a[60:63], v[76:79]
  ds_read_b64_tr_b16 a[174:175], v2 offset:25152
  v_rcp_f32 v27, v27
  v_mul_f32 v161, v49, v161
  v_mfma_f32_16x16x32_bf16 v[76:79], a[144:147], a[44:47], v[76:79]
  s_waitcnt vmcnt(0) lgkmcnt(11)
  s_barrier
  v_rcp_f32 v28, v28
  v_mfma_f32_16x16x32_bf16 v[64:67], a[24:27], a[0:3], v[64:67]
  s_mov_b64 exec, 1
  buffer_store_dword v9, v0, s[36:39], s45 offen sc1
  s_mov_b64 exec, -1
  s_add_u32 s45, s45, 32768
  v_mfma_f32_16x16x32_bf16 v[68:71], a[24:27], a[4:7], v[68:71]
  ds_read_b64_tr_b16 a[128:129], v2 offset:28736
  v_mul_f32 v162, v50, v162
  v_rcp_f32 v29, v29
  v_mfma_f32_16x16x32_bf16 v[72:75], a[24:27], a[8:11], v[72:75]
  ds_read_b64_tr_b16 a[130:131], v2 offset:32320
  v_mul_f32 v163, v51, v163
  v_mul_f32 v160, v160, v22
  v_mul_f32 v161, v161, v23
  v_mfma_f32_16x16x32_bf16 v[76:79], a[24:27], a[12:15], v[76:79]
  v_mul_f32 v162, v162, v24
  v_mul_f32 v163, v163, v25
  v_mul_f32 v22, v16, v56
  v_mul_f32 v23, v16, v57
  v_mfma_f32_16x16x32_bf16 v[176:179], a[28:31], a[0:3], v[176:179]
  ds_read_b64_tr_b16 a[132:133], v2 offset:35904
  v_mul_f32 v24, v16, v58
  v_mul_f32 v25, v16, v59
  v_mfma_f32_16x16x32_bf16 v[180:183], a[28:31], a[4:7], v[180:183]
Hb0_2:
  s_cbranch_execz Hb0_3
  v_exp_f32 v22, v22
  v_mul_f32 v164, v52, v164
  v_mfma_f32_16x16x32_bf16 v[184:187], a[28:31], a[8:11], v[184:187]
  ds_read_b64_tr_b16 a[134:135], v2 offset:39488
  v_exp_f32 v23, v23
  v_mul_f32 v165, v53, v165
  v_mfma_f32_16x16x32_bf16 v[188:191], a[28:31], a[12:15], v[188:191]
  v_exp_f32 v24, v24
  v_mul_f32 v166, v54, v166
  v_mfma_f32_16x16x32_bf16 v[188:191], a[152:155], a[44:47], v[188:191]
  ds_read_b64_tr_b16 a[136:137], v2 offset:43072
  v_exp_f32 v25, v25
  v_mul_f32 v167, v55, v167
  v_mfma_f32_16x16x32_bf16 v[188:191], a[156:159], a[60:63], v[188:191]
  v_mul_f32 v164, v164, v26
  v_mul_f32 v165, v165, v27
  v_mul_f32 v166, v166, v28
  v_mul_f32 v167, v167, v29
  v_mfma_f32_16x16x32_bf16 v[184:187], a[156:159], a[56:59], v[184:187]
  ds_read_b64_tr_b16 a[138:139], v2 offset:46656
  v_cvt_pk_bf16_f32 v34, v160, v161
  v_cvt_pk_bf16_f32 v35, v162, v163
  v_mfma_f32_16x16x32_bf16 v[184:187], a[152:155], a[40:43], v[184:187]
  buffer_store_dwordx4 v[32:35], v0, s[36:39], s65 offen offset:0 sc1
  v_mul_f32 v26, v19, v60
  v_mul_f32 v27, v19, v61
  v_mul_f32 v28, v19, v62
  v_mfma_f32_16x16x32_bf16 v[180:183], a[152:155], a[36:39], v[180:183]
  ds_read_b64_tr_b16 a[140:141], v2 offset:50240
  v_mul_f32 v29, v19, v63
  v_exp_f32 v26, v26
  v_mfma_f32_16x16x32_bf16 v[180:183], a[156:159], a[52:55], v[180:183]
  v_fma_f32 v22, v22, v17, v17
  v_exp_f32 v27, v27
  v_fma_f32 v23, v23, v17, v17
  v_mfma_f32_16x16x32_bf16 v[176:179], a[156:159], a[48:51], v[176:179]
  ds_read_b64_tr_b16 a[142:143], v2 offset:53824
  v_exp_f32 v28, v28
  v_fma_f32 v24, v24, v17, v17
  v_mfma_f32_16x16x32_bf16 v[176:179], a[152:155], a[32:35], v[176:179]
  s_waitcnt lgkmcnt(8)
  v_exp_f32 v29, v29
  v_fma_f32 v25, v25, v17, v17
  v_cvt_pk_bf16_f32 v38, v164, v165
  v_mfma_f32_16x16x32_bf16 v[64:67], a[160:163], a[64:67], v[64:67]
  ds_read_b64_tr_b16 a[144:145], v1 offset:28768
  v_cvt_pk_bf16_f32 v39, v166, v167
  v_mfma_f32_16x16x32_bf16 v[64:67], a[164:167], a[80:83], v[64:67]
  buffer_store_dwordx4 v[36:39], v0, s[36:39], s65 offen offset:1024 sc1
  v_rcp_f32 v22, v22
  v_fma_f32 v26, v26, v20, v20
  v_mfma_f32_16x16x32_bf16 v[68:71], a[164:167], a[84:87], v[68:71]
  ds_read_b64_tr_b16 a[146:147], v1 offset:32352
  v_rcp_f32 v23, v23
  v_fma_f32 v27, v27, v20, v20
  v_mfma_f32_16x16x32_bf16 v[68:71], a[160:163], a[68:71], v[68:71]
  v_rcp_f32 v24, v24
  v_fma_f32 v28, v28, v20, v20
  v_mfma_f32_16x16x32_bf16 v[72:75], a[160:163], a[72:75], v[72:75]
  ds_read_b64_tr_b16 a[148:149], v1 offset:35936
  v_rcp_f32 v25, v25
  v_fma_f32 v29, v29, v20, v20
  v_mfma_f32_16x16x32_bf16 v[72:75], a[164:167], a[88:91], v[72:75]
  v_rcp_f32 v26, v26
  v_mul_f32 v168, v56, v168
  v_mfma_f32_16x16x32_bf16 v[76:79], a[164:167], a[92:95], v[76:79]
  ds_read_b64_tr_b16 a[150:151], v1 offset:39520
  v_rcp_f32 v27, v27
  v_mul_f32 v169, v57, v169
  v_mfma_f32_16x16x32_bf16 v[76:79], a[160:163], a[76:79], v[76:79]
  v_rcp_f32 v28, v28
  v_mul_f32 v170, v58, v170
  v_mfma_f32_16x16x32_bf16 v[188:191], a[168:171], a[76:79], v[188:191]
  v_rcp_f32 v29, v29
  v_mul_f32 v171, v59, v171
  v_mul_f32 v168, v168, v22
  v_mfma_f32_16x16x32_bf16 v[188:191], a[172:175], a[92:95], v[188:191]
  v_mul_f32 v169, v169, v23
  v_mul_f32 v170, v170, v24
  v_mul_f32 v171, v171, v25
  v_mul_f32 v172, v60, v172
  v_mfma_f32_16x16x32_bf16 v[184:187], a[172:175], a[88:91], v[184:187]
  v_mul_f32 v173, v61, v173
  v_mul_f32 v174, v62, v174
  v_mul_f32 v175, v63, v175
  v_cvt_pk_bf16_f32 v42, v168, v169
  v_mfma_f32_16x16x32_bf16 v[184:187], a[168:171], a[72:75], v[184:187]
  v_cvt_pk_bf16_f32 v43, v170, v171
  v_mfma_f32_16x16x32_bf16 v[180:183], a[168:171], a[68:71], v[180:183]
  buffer_store_dwordx4 v[40:43], v0, s[36:39], s66 offen offset:0 sc1
  v_mul_f32 v172, v172, v26
  v_mul_f32 v173, v173, v27
  v_mul_f32 v174, v174, v28
  v_mfma_f32_16x16x32_bf16 v[180:183], a[172:175], a[84:87], v[180:183]
  v_mul_f32 v175, v175, v29
  v_cvt_pk_bf16_f32 v46, v172, v173
  v_cvt_pk_bf16_f32 v47, v174, v175
  v_mfma_f32_16x16x32_bf16 v[176:179], a[172:175], a[80:83], v[176:179]
  buffer_store_dwordx4 v[44:47], v0, s[36:39], s66 offen offset:1024 sc1
  s_add_u32 s65, s65, 2048
  s_add_u32 s66, s66, 2048
  v_mfma_f32_16x16x32_bf16 v[176:179], a[168:171], a[64:67], v[176:179]
  s_waitcnt lgkmcnt(4)
  v_mfma_f32_16x16x32_bf16 v[64:67], a[128:131], a[96:99], v[64:67]
  ds_read_b128 a[16:19], v31 offset:768
  v_mfma_f32_16x16x32_bf16 v[64:67], a[132:135], a[112:115], v[64:67]
  ds_read_b64_tr_b16 a[152:153], v1 offset:43104
  v_mfma_f32_16x16x32_bf16 v[68:71], a[132:135], a[116:119], v[68:71]
  ds_read_b128 a[20:23], v31 offset:2816
  v_mfma_f32_16x16x32_bf16 v[68:71], a[128:131], a[100:103], v[68:71]
  ds_read_b64_tr_b16 a[154:155], v1 offset:46688
  v_mfma_f32_16x16x32_bf16 v[72:75], a[128:131], a[104:107], v[72:75]
  ds_read_b64_tr_b16 a[156:157], v1 offset:50272
  v_mfma_f32_16x16x32_bf16 v[72:75], a[132:135], a[120:123], v[72:75]
  v_mfma_f32_16x16x32_bf16 v[76:79], a[132:135], a[124:127], v[76:79]
  ds_read_b64_tr_b16 a[158:159], v1 offset:53856
  v_mfma_f32_16x16x32_bf16 v[76:79], a[128:131], a[108:111], v[76:79]
  v_mfma_f32_16x16x32_bf16 v[188:191], a[136:139], a[108:111], v[188:191]
  s_mov_b32 s69, 3
  s_lshl_b32 s50, s69, 16
  s_lshl1_add_u32 s50, s88, s50
  s_add_u32 m0, s70, 114688
  ds_read_b64_tr_b16 a[160:161], v2 offset:96
  v_mfma_f32_16x16x32_bf16 v[188:191], a[140:143], a[124:127], v[188:191]
  v_mul_f32 v22, v10, v64
  v_mul_f32 v23, v10, v65
  v_mul_f32 v24, v10, v66
  v_mul_f32 v25, v10, v67
  v_mfma_f32_16x16x32_bf16 v[184:187], a[140:143], a[120:123], v[184:187]
  ds_read_b64_tr_b16 a[162:163], v2 offset:3680
  v_exp_f32 v22, v22
  v_mul_f32 v26, v13, v68
  v_mfma_f32_16x16x32_bf16 v[184:187], a[136:139], a[104:107], v[184:187]
  v_exp_f32 v23, v23
  v_mul_f32 v27, v13, v69
  v_mfma_f32_16x16x32_bf16 v[180:183], a[136:139], a[100:103], v[180:183]
  buffer_load_dwordx4 v133, s[24:27], s50 offen offset:0 lds
  v_exp_f32 v24, v24
  v_mul_f32 v28, v13, v70
  v_mfma_f32_16x16x32_bf16 v[180:183], a[140:143], a[116:119], v[180:183]
  ds_read_b64_tr_b16 a[164:165], v2 offset:7264
  v_exp_f32 v25, v25
  v_mul_f32 v29, v13, v71
  v_mfma_f32_16x16x32_bf16 v[176:179], a[140:143], a[112:115], v[176:179]
  ds_read_b64_tr_b16 a[166:167], v2 offset:10848
  v_exp_f32 v26, v26
  v_fma_f32 v22, v22, v11, v11
  v_mfma_f32_16x16x32_bf16 v[176:179], a[136:139], a[96:99], v[176:179]
  s_waitcnt lgkmcnt(4)
  v_exp_f32 v27, v27
  v_fma_f32 v23, v23, v11, v11
  v_mfma_f32_16x16x32_bf16 v[80:83], a[144:147], a[32:35], v[80:83]
  ds_read_b64_tr_b16 a[168:169], v2 offset:14432
  v_exp_f32 v28, v28
  v_fma_f32 v24, v24, v11, v11
  v_mfma_f32_16x16x32_bf16 v[80:83], a[148:151], a[48:51], v[80:83]
  buffer_load_dwordx4 v134, s[24:27], s50 offen offset:1024 lds
  v_exp_f32 v29, v29
  v_fma_f32 v25, v25, v11, v11
  v_mfma_f32_16x16x32_bf16 v[84:87], a[148:151], a[52:55], v[84:87]
  ds_read_b64_tr_b16 a[170:171], v2 offset:18016
  v_rcp_f32 v22, v22
  v_fma_f32 v26, v26, v14, v14
  v_mfma_f32_16x16x32_bf16 v[84:87], a[144:147], a[36:39], v[84:87]
  v_rcp_f32 v23, v23
  v_fma_f32 v27, v27, v14, v14
  v_mfma_f32_16x16x32_bf16 v[88:91], a[144:147], a[40:43], v[88:91]
  ds_read_b64_tr_b16 a[172:173], v2 offset:21600
  v_rcp_f32 v24, v24
  v_fma_f32 v28, v28, v14, v14
  v_mfma_f32_16x16x32_bf16 v[88:91], a[148:151], a[56:59], v[88:91]
  v_rcp_f32 v25, v25
  v_fma_f32 v29, v29, v14, v14
  v_mfma_f32_16x16x32_bf16 v[92:95], a[148:151], a[60:63], v[92:95]
  buffer_load_dwordx4 v135, s[24:27], s50 offen offset:2048 lds
  v_rcp_f32 v26, v26
  v_mul_f32 v176, v64, v176
  v_mfma_f32_16x16x32_bf16 v[92:95], a[144:147], a[44:47], v[92:95]
  s_waitcnt lgkmcnt(10)
  ds_read_b64_tr_b16 a[174:175], v2 offset:25184
  v_rcp_f32 v27, v27
  v_mul_f32 v177, v65, v177
  v_mfma_f32_16x16x32_bf16 v[80:83], a[16:19], a[0:3], v[80:83]
  ds_read_b64_tr_b16 a[128:129], v2 offset:28768
  v_rcp_f32 v28, v28
  v_mul_f32 v178, v66, v178
  v_mfma_f32_16x16x32_bf16 v[84:87], a[16:19], a[4:7], v[84:87]
  v_rcp_f32 v29, v29
  v_mul_f32 v179, v67, v179
  v_mul_f32 v176, v176, v22
  v_mfma_f32_16x16x32_bf16 v[88:91], a[16:19], a[8:11], v[88:91]
  ds_read_b64_tr_b16 a[130:131], v2 offset:32352
  v_mul_f32 v177, v177, v23
  v_mul_f32 v178, v178, v24
  v_mul_f32 v179, v179, v25
  v_mfma_f32_16x16x32_bf16 v[92:95], a[16:19], a[12:15], v[92:95]
  buffer_load_dwordx4 v136, s[24:27], s50 offen offset:3072 lds
  v_mul_f32 v22, v16, v72
  v_mul_f32 v23, v16, v73
  v_mul_f32 v24, v16, v74
  v_mfma_f32_16x16x32_bf16 v[192:195], a[20:23], a[0:3], v[192:195]
  s_mov_b32 s71, 17
  s_lshl_b32 s50, s71, 16
  s_lshl1_add_u32 s50, s88, s50
  s_add_u32 m0, s70, 131072
  ds_read_b64_tr_b16 a[132:133], v2 offset:35936
  v_mfma_f32_16x16x32_bf16 v[196:199], a[20:23], a[4:7], v[196:199]
  v_mul_f32 v25, v16, v75
  v_exp_f32 v22, v22
  v_mul_f32 v180, v68, v180
  v_mfma_f32_16x16x32_bf16 v[200:203], a[20:23], a[8:11], v[200:203]
  ds_read_b64_tr_b16 a[134:135], v2 offset:39520
  v_exp_f32 v23, v23
  v_mul_f32 v181, v69, v181
  v_mfma_f32_16x16x32_bf16 v[204:207], a[20:23], a[12:15], v[204:207]
  v_exp_f32 v24, v24
  v_mul_f32 v182, v70, v182
  v_mfma_f32_16x16x32_bf16 v[204:207], a[152:155], a[44:47], v[204:207]
  buffer_load_dwordx4 v133, s[24:27], s50 offen offset:0 lds
  v_exp_f32 v25, v25
  v_mul_f32 v183, v71, v183
  v_mfma_f32_16x16x32_bf16 v[204:207], a[156:159], a[60:63], v[204:207]
  ds_read_b64_tr_b16 a[136:137], v2 offset:43104
  v_mul_f32 v180, v180, v26
  v_mul_f32 v181, v181, v27
  v_mul_f32 v182, v182, v28
  v_mfma_f32_16x16x32_bf16 v[200:203], a[156:159], a[56:59], v[200:203]
  ds_read_b64_tr_b16 a[138:139], v2 offset:46688
  v_mul_f32 v183, v183, v29
  v_cvt_pk_bf16_f32 v64, v176, v177
  v_cvt_pk_bf16_f32 v65, v178, v179
  v_mfma_f32_16x16x32_bf16 v[200:203], a[152:155], a[40:43], v[200:203]
  v_mul_f32 v26, v19, v76
  v_mul_f32 v27, v19, v77
  v_mul_f32 v28, v19, v78
  v_mul_f32 v29, v19, v79
  v_mfma_f32_16x16x32_bf16 v[196:199], a[152:155], a[36:39], v[196:199]
  ds_read_b64_tr_b16 a[140:141], v2 offset:50272
  v_exp_f32 v26, v26
  v_fma_f32 v22, v22, v17, v17
  v_mfma_f32_16x16x32_bf16 v[196:199], a[156:159], a[52:55], v[196:199]
  buffer_load_dwordx4 v134, s[24:27], s50 offen offset:1024 lds
  v_exp_f32 v27, v27
  v_fma_f32 v23, v23, v17, v17
  v_mfma_f32_16x16x32_bf16 v[192:195], a[156:159], a[48:51], v[192:195]
  ds_read_b64_tr_b16 a[142:143], v2 offset:53856
  v_exp_f32 v28, v28
  v_fma_f32 v24, v24, v17, v17
  v_mfma_f32_16x16x32_bf16 v[192:195], a[152:155], a[32:35], v[192:195]
  s_waitcnt lgkmcnt(8)
  v_exp_f32 v29, v29
  v_fma_f32 v25, v25, v17, v17
  v_cvt_pk_bf16_f32 v68, v180, v181
  v_mfma_f32_16x16x32_bf16 v[80:83], a[160:163], a[64:67], v[80:83]
  ds_read_b64_tr_b16 a[144:145], v1 offset:28800
  v_cvt_pk_bf16_f32 v69, v182, v183
  v_rcp_f32 v22, v22
  v_mfma_f32_16x16x32_bf16 v[80:83], a[164:167], a[80:83], v[80:83]
  v_fma_f32 v26, v26, v20, v20
  v_rcp_f32 v23, v23
  v_fma_f32 v27, v27, v20, v20
  v_mfma_f32_16x16x32_bf16 v[84:87], a[164:167], a[84:87], v[84:87]
  buffer_load_dwordx4 v135, s[24:27], s50 offen offset:2048 lds
  v_rcp_f32 v24, v24
  v_fma_f32 v28, v28, v20, v20
  v_mfma_f32_16x16x32_bf16 v[84:87], a[160:163], a[68:71], v[84:87]
  ds_read_b64_tr_b16 a[146:147], v1 offset:32384
  v_rcp_f32 v25, v25
  v_fma_f32 v29, v29, v20, v20
  v_mfma_f32_16x16x32_bf16 v[88:91], a[160:163], a[72:75], v[88:91]
  ds_read_b64_tr_b16 a[148:149], v1 offset:35968
  v_rcp_f32 v26, v26
  v_mul_f32 v184, v72, v184
  v_mfma_f32_16x16x32_bf16 v[88:91], a[164:167], a[88:91], v[88:91]
  v_rcp_f32 v27, v27
  v_mul_f32 v185, v73, v185
  v_mfma_f32_16x16x32_bf16 v[92:95], a[164:167], a[92:95], v[92:95]
  ds_read_b64_tr_b16 a[150:151], v1 offset:39552
  v_rcp_f32 v28, v28
  v_mul_f32 v186, v74, v186
  v_mfma_f32_16x16x32_bf16 v[92:95], a[160:163], a[76:79], v[92:95]
  buffer_load_dwordx4 v136, s[24:27], s50 offen offset:3072 lds
  v_rcp_f32 v29, v29
  v_mul_f32 v187, v75, v187
  v_mfma_f32_16x16x32_bf16 v[204:207], a[168:171], a[76:79], v[204:207]
  s_mov_b32 s72, 31
  s_lshl_b32 s50, s72, 16
  s_lshl1_add_u32 s50, s88, s50
  s_add_u32 m0, s70, 0
  v_mul_f32 v184, v184, v22
  v_mfma_f32_16x16x32_bf16 v[204:207], a[172:175], a[92:95], v[204:207]
  v_mul_f32 v185, v185, v23
  v_mul_f32 v186, v186, v24
  v_mul_f32 v187, v187, v25
  v_mul_f32 v188, v76, v188
  v_mfma_f32_16x16x32_bf16 v[200:203], a[172:175], a[88:91], v[200:203]
  v_mul_f32 v189, v77, v189
  v_mul_f32 v190, v78, v190
  v_mul_f32 v191, v79, v191
  v_cvt_pk_bf16_f32 v72, v184, v185
  v_mfma_f32_16x16x32_bf16 v[200:203], a[168:171], a[72:75], v[200:203]
  v_cvt_pk_bf16_f32 v73, v186, v187
  v_mul_f32 v188, v188, v26
  v_mul_f32 v189, v189, v27
  v_mul_f32 v190, v190, v28
  v_mfma_f32_16x16x32_bf16 v[196:199], a[168:171], a[68:71], v[196:199]
  buffer_load_dwordx4 v133, s[24:27], s50 offen offset:0 lds
  v_mul_f32 v191, v191, v29
  v_cvt_pk_bf16_f32 v76, v188, v189
  v_cvt_pk_bf16_f32 v77, v190, v191
  v_mfma_f32_16x16x32_bf16 v[196:199], a[172:175], a[84:87], v[196:199]
  v_mfma_f32_16x16x32_bf16 v[192:195], a[172:175], a[80:83], v[192:195]
  v_mfma_f32_16x16x32_bf16 v[192:195], a[168:171], a[64:67], v[192:195]
  s_waitcnt lgkmcnt(4)
  v_mfma_f32_16x16x32_bf16 v[80:83], a[128:131], a[96:99], v[80:83]
  ds_read_b128 a[24:27], v31 offset:1024
  v_mfma_f32_16x16x32_bf16 v[80:83], a[132:135], a[112:115], v[80:83]
  ds_read_b64_tr_b16 a[152:153], v1 offset:43136
  v_mfma_f32_16x16x32_bf16 v[84:87], a[132:135], a[116:119], v[84:87]
  buffer_load_dwordx4 v134, s[24:27], s50 offen offset:1024 lds
  v_mfma_f32_16x16x32_bf16 v[84:87], a[128:131], a[100:103], v[84:87]
  ds_read_b128 a[28:31], v31 offset:3072
  v_mfma_f32_16x16x32_bf16 v[88:91], a[128:131], a[104:107], v[88:91]
  ds_read_b64_tr_b16 a[154:155], v1 offset:46720
  v_mfma_f32_16x16x32_bf16 v[88:91], a[132:135], a[120:123], v[88:91]
  ds_read_b64_tr_b16 a[156:157], v1 offset:50304
  v_mfma_f32_16x16x32_bf16 v[92:95], a[132:135], a[124:127], v[92:95]
  buffer_load_dwordx4 v135, s[24:27], s50 offen offset:2048 lds
  v_mfma_f32_16x16x32_bf16 v[92:95], a[128:131], a[108:111], v[92:95]
  ds_read_b64_tr_b16 a[158:159], v1 offset:53888
  v_mfma_f32_16x16x32_bf16 v[204:207], a[136:139], a[108:111], v[204:207]
  ds_read_b64_tr_b16 a[160:161], v2 offset:128
  v_mul_f32 v22, v10, v80
  v_mul_f32 v23, v10, v81
  v_mul_f32 v24, v10, v82
  v_mfma_f32_16x16x32_bf16 v[204:207], a[140:143], a[124:127], v[204:207]
  v_mul_f32 v25, v10, v83
  v_exp_f32 v22, v22
  v_mul_f32 v26, v13, v84
  v_mfma_f32_16x16x32_bf16 v[200:203], a[140:143], a[120:123], v[200:203]
  ds_read_b64_tr_b16 a[162:163], v2 offset:3712
  v_exp_f32 v23, v23
  v_mul_f32 v27, v13, v85
  v_mfma_f32_16x16x32_bf16 v[200:203], a[136:139], a[104:107], v[200:203]
  s_waitcnt vmcnt(11)
  s_barrier
  buffer_load_dwordx4 v136, s[24:27], s50 offen offset:3072 lds
  v_exp_f32 v24, v24
  v_mfma_f32_16x16x32_bf16 v[196:199], a[136:139], a[100:103], v[196:199]
  s_mov_b64 exec, 1
  buffer_store_dword v9, v0, s[36:39], s45 offen sc1
  s_mov_b64 exec, -1
  s_add_u32 s45, s45, 32768
  v_mfma_f32_16x16x32_bf16 v[196:199], a[140:143], a[116:119], v[196:199]
  ds_read_b64_tr_b16 a[164:165], v2 offset:7296
  v_mul_f32 v28, v13, v86
  v_exp_f32 v25, v25
  v_mfma_f32_16x16x32_bf16 v[192:195], a[140:143], a[112:115], v[192:195]
  ds_read_b64_tr_b16 a[166:167], v2 offset:10880
  v_mul_f32 v29, v13, v87
  v_exp_f32 v26, v26
  v_mfma_f32_16x16x32_bf16 v[192:195], a[136:139], a[96:99], v[192:195]
  s_waitcnt lgkmcnt(4)
  v_fma_f32 v22, v22, v11, v11
  v_exp_f32 v27, v27
  v_fma_f32 v23, v23, v11, v11
  v_mfma_f32_16x16x32_bf16 v[96:99], a[144:147], a[32:35], v[96:99]
  ds_read_b64_tr_b16 a[168:169], v2 offset:14464
  v_exp_f32 v28, v28
  v_fma_f32 v24, v24, v11, v11
  v_mfma_f32_16x16x32_bf16 v[96:99], a[148:151], a[48:51], v[96:99]
  v_exp_f32 v29, v29
  v_fma_f32 v25, v25, v11, v11
  v_mfma_f32_16x16x32_bf16 v[100:103], a[148:151], a[52:55], v[100:103]
  buffer_load_dword v139, v138, s[36:39], s91 offen sc1
  v_rcp_f32 v22, v22
  v_fma_f32 v26, v26, v14, v14
  v_mfma_f32_16x16x32_bf16 v[100:103], a[144:147], a[36:39], v[100:103]
  ds_read_b64_tr_b16 a[170:171], v2 offset:18048
  v_rcp_f32 v23, v23
  v_fma_f32 v27, v27, v14, v14
  v_mfma_f32_16x16x32_bf16 v[104:107], a[144:147], a[40:43], v[104:107]
  ds_read_b64_tr_b16 a[172:173], v2 offset:21632
  v_rcp_f32 v24, v24
  v_fma_f32 v28, v28, v14, v14
  v_mfma_f32_16x16x32_bf16 v[104:107], a[148:151], a[56:59], v[104:107]
  v_rcp_f32 v25, v25
  v_fma_f32 v29, v29, v14, v14
  v_mfma_f32_16x16x32_bf16 v[108:111], a[148:151], a[60:63], v[108:111]
  ds_read_b64_tr_b16 a[174:175], v2 offset:25216
  v_rcp_f32 v26, v26
  v_mul_f32 v192, v80, v192
  v_mfma_f32_16x16x32_bf16 v[108:111], a[144:147], a[44:47], v[108:111]
  s_waitcnt lgkmcnt(11)
  v_rcp_f32 v27, v27
  v_mul_f32 v193, v81, v193
  v_mfma_f32_16x16x32_bf16 v[96:99], a[24:27], a[0:3], v[96:99]
  ds_read_b64_tr_b16 a[128:129], v2 offset:28800
  v_rcp_f32 v28, v28
  v_mul_f32 v194, v82, v194
  v_mfma_f32_16x16x32_bf16 v[100:103], a[24:27], a[4:7], v[100:103]
  v_rcp_f32 v29, v29
  v_mul_f32 v195, v83, v195
  v_mul_f32 v192, v192, v22
  v_mfma_f32_16x16x32_bf16 v[104:107], a[24:27], a[8:11], v[104:107]
  ds_read_b64_tr_b16 a[130:131], v2 offset:32384
  v_mul_f32 v193, v193, v23
  v_mul_f32 v194, v194, v24
  v_mul_f32 v195, v195, v25
  v_mfma_f32_16x16x32_bf16 v[108:111], a[24:27], a[12:15], v[108:111]
  v_mul_f32 v22, v16, v88
  v_mul_f32 v23, v16, v89
  v_mul_f32 v24, v16, v90
  v_mul_f32 v25, v16, v91
  v_mfma_f32_16x16x32_bf16 v[208:211], a[28:31], a[0:3], v[208:211]
  ds_read_b64_tr_b16 a[132:133], v2 offset:35968
  v_exp_f32 v22, v22
  v_mul_f32 v196, v84, v196
  v_mfma_f32_16x16x32_bf16 v[212:215], a[28:31], a[4:7], v[212:215]
  v_exp_f32 v23, v23
  v_mul_f32 v197, v85, v197
  v_mfma_f32_16x16x32_bf16 v[216:219], a[28:31], a[8:11], v[216:219]
  ds_read_b64_tr_b16 a[134:135], v2 offset:39552
  v_exp_f32 v24, v24
  v_mul_f32 v198, v86, v198
  v_mfma_f32_16x16x32_bf16 v[220:223], a[28:31], a[12:15], v[220:223]
  v_exp_f32 v25, v25
  v_mul_f32 v199, v87, v199
  v_mul_f32 v196, v196, v26
  v_mfma_f32_16x16x32_bf16 v[220:223], a[152:155], a[44:47], v[220:223]
  ds_read_b64_tr_b16 a[136:137], v2 offset:43136
  v_mul_f32 v197, v197, v27
  v_mul_f32 v198, v198, v28
  v_mul_f32 v199, v199, v29
  v_mfma_f32_16x16x32_bf16 v[220:223], a[156:159], a[60:63], v[220:223]
  v_cvt_pk_bf16_f32 v66, v192, v193
  v_cvt_pk_bf16_f32 v67, v194, v195
  v_mfma_f32_16x16x32_bf16 v[216:219], a[156:159], a[56:59], v[216:219]
  ds_read_b64_tr_b16 a[138:139], v2 offset:46720
  v_mfma_f32_16x16x32_bf16 v[216:219], a[152:155], a[40:43], v[216:219]
  buffer_store_dwordx4 v[64:67], v0, s[36:39], s65 offen offset:0 sc1
  v_mul_f32 v26, v19, v92
  v_mul_f32 v27, v19, v93
  v_mul_f32 v28, v19, v94
  v_mfma_f32_16x16x32_bf16 v[212:215], a[152:155], a[36:39], v[212:215]
  ds_read_b64_tr_b16 a[140:141], v2 offset:50304
  v_mul_f32 v29, v19, v95
  v_exp_f32 v26, v26
  v_mfma_f32_16x16x32_bf16 v[212:215], a[156:159], a[52:55], v[212:215]
  v_fma_f32 v22, v22, v17, v17
  v_exp_f32 v27, v27
  v_fma_f32 v23, v23, v17, v17
  v_mfma_f32_16x16x32_bf16 v[208:211], a[156:159], a[48:51], v[208:211]
  ds_read_b64_tr_b16 a[142:143], v2 offset:53888
  v_exp_f32 v28, v28
  v_fma_f32 v24, v24, v17, v17
  v_mfma_f32_16x16x32_bf16 v[208:211], a[152:155], a[32:35], v[208:211]
  s_waitcnt lgkmcnt(8)
  v_exp_f32 v29, v29
  v_fma_f32 v25, v25, v17, v17
  v_cvt_pk_bf16_f32 v70, v196, v197
  v_mfma_f32_16x16x32_bf16 v[96:99], a[160:163], a[64:67], v[96:99]
  ds_read_b64_tr_b16 a[144:145], v1 offset:28832
  v_cvt_pk_bf16_f32 v71, v198, v199
  v_mfma_f32_16x16x32_bf16 v[96:99], a[164:167], a[80:83], v[96:99]
  buffer_store_dwordx4 v[68:71], v0, s[36:39], s65 offen offset:1024 sc1
  v_rcp_f32 v22, v22
  v_fma_f32 v26, v26, v20, v20
  v_mfma_f32_16x16x32_bf16 v[100:103], a[164:167], a[84:87], v[100:103]
  ds_read_b64_tr_b16 a[146:147], v1 offset:32416
  v_rcp_f32 v23, v23
  v_fma_f32 v27, v27, v20, v20
  v_mfma_f32_16x16x32_bf16 v[100:103], a[160:163], a[68:71], v[100:103]
  v_rcp_f32 v24, v24
  v_fma_f32 v28, v28, v20, v20
  v_mfma_f32_16x16x32_bf16 v[104:107], a[160:163], a[72:75], v[104:107]
  ds_read_b64_tr_b16 a[148:149], v1 offset:36000
  v_rcp_f32 v25, v25
  v_fma_f32 v29, v29, v20, v20
  v_mfma_f32_16x16x32_bf16 v[104:107], a[164:167], a[88:91], v[104:107]
  v_rcp_f32 v26, v26
  v_mul_f32 v200, v88, v200
  v_mfma_f32_16x16x32_bf16 v[108:111], a[164:167], a[92:95], v[108:111]
  ds_read_b64_tr_b16 a[150:151], v1 offset:39584
  v_rcp_f32 v27, v27
  v_mul_f32 v201, v89, v201
  v_mfma_f32_16x16x32_bf16 v[108:111], a[160:163], a[76:79], v[108:111]
  v_rcp_f32 v28, v28
  v_mul_f32 v202, v90, v202
  v_mfma_f32_16x16x32_bf16 v[220:223], a[168:171], a[76:79], v[220:223]
  v_rcp_f32 v29, v29
  v_mul_f32 v203, v91, v203
  v_mul_f32 v200, v200, v22
  v_mfma_f32_16x16x32_bf16 v[220:223], a[172:175], a[92:95], v[220:223]
  v_mul_f32 v201, v201, v23
  v_mul_f32 v202, v202, v24
  v_mul_f32 v203, v203, v25
  v_mul_f32 v204, v92, v204
  v_mfma_f32_16x16x32_bf16 v[216:219], a[172:175], a[88:91], v[216:219]
  s_waitcnt vmcnt(2)
  v_cmp_ne_u32 vcc, s3, v139
  s_nop 4
  s_cbranch_vccnz CK7s
CK7x:
  v_mfma_f32_16x16x32_bf16 v[216:219], a[168:171], a[72:75], v[216:219]
  s_lshl_b32 s51, s69, 11
  s_add_u32 s91, s91, 32768
  buffer_load_dwordx4 a[216:219], v137, s[36:39], s51 offen offset:0 sc1
  v_mul_f32 v205, v93, v205
  v_mul_f32 v206, v94, v206
  v_mfma_f32_16x16x32_bf16 v[212:215], a[168:171], a[68:71], v[212:215]
  v_mul_f32 v207, v95, v207
  v_cvt_pk_bf16_f32 v74, v200, v201
  v_cvt_pk_bf16_f32 v75, v202, v203
  v_mfma_f32_16x16x32_bf16 v[212:215], a[172:175], a[84:87], v[212:215]
  buffer_store_dwordx4 v[72:75], v0, s[36:39], s66 offen offset:0 sc1
  v_mul_f32 v204, v204, v26
  v_mul_f32 v205, v205, v27
  v_mul_f32 v206, v206, v28
  v_mfma_f32_16x16x32_bf16 v[208:211], a[172:175], a[80:83], v[208:211]
  v_mul_f32 v207, v207, v29
  v_cvt_pk_bf16_f32 v78, v204, v205
  v_cvt_pk_bf16_f32 v79, v206, v207
  v_mfma_f32_16x16x32_bf16 v[208:211], a[168:171], a[64:67], v[208:211]
  s_waitcnt lgkmcnt(4)
  buffer_load_dwordx4 a[220:223], v137, s[36:39], s51 offen offset:1024 sc1
  s_add_u32 s51, s51, 12288
  v_mfma_f32_16x16x32_bf16 v[96:99], a[128:131], a[96:99], v[96:99]
  ds_read_b128 a[16:19], v31 offset:1280
  v_mfma_f32_16x16x32_bf16 v[96:99], a[132:135], a[112:115], v[96:99]
  ds_read_b64_tr_b16 a[152:153], v1 offset:43168
  v_mfma_f32_16x16x32_bf16 v[100:103], a[132:135], a[116:119], v[100:103]
  buffer_load_dwordx4 a[224:227], v137, s[36:39], s51 offen offset:2048 sc1
  v_mfma_f32_16x16x32_bf16 v[100:103], a[128:131], a[100:103], v[100:103]
  ds_read_b128 a[20:23], v31 offset:3328
  v_mfma_f32_16x16x32_bf16 v[104:107], a[128:131], a[104:107], v[104:107]
  ds_read_b64_tr_b16 a[154:155], v1 offset:46752
  v_mfma_f32_16x16x32_bf16 v[104:107], a[132:135], a[120:123], v[104:107]
  buffer_load_dwordx4 a[228:231], v137, s[36:39], s51 offen offset:3072 sc1
  v_mfma_f32_16x16x32_bf16 v[108:111], a[132:135], a[124:127], v[108:111]
  ds_read_b64_tr_b16 a[156:157], v1 offset:50336
  v_mfma_f32_16x16x32_bf16 v[108:111], a[128:131], a[108:111], v[108:111]
  ds_read_b64_tr_b16 a[158:159], v1 offset:53920
  v_mfma_f32_16x16x32_bf16 v[220:223], a[136:139], a[108:111], v[220:223]
  ds_read_b64_tr_b16 a[160:161], v2 offset:160
  v_mfma_f32_16x16x32_bf16 v[220:223], a[140:143], a[124:127], v[220:223]
  buffer_store_dwordx4 v[76:79], v0, s[36:39], s66 offen offset:1024 sc1
  s_add_u32 s65, s65, 2048
  s_add_u32 s66, s66, 2048
  v_mul_f32 v22, v10, v96
  v_mfma_f32_16x16x32_bf16 v[216:219], a[140:143], a[120:123], v[216:219]
  ds_read_b64_tr_b16 a[162:163], v2 offset:3744
  v_mul_f32 v23, v10, v97
  v_mul_f32 v24, v10, v98
  v_mul_f32 v25, v10, v99
  v_mfma_f32_16x16x32_bf16 v[216:219], a[136:139], a[104:107], v[216:219]
  v_exp_f32 v22, v22
  v_mul_f32 v26, v13, v100
  v_mfma_f32_16x16x32_bf16 v[212:215], a[136:139], a[100:103], v[212:215]
  ds_read_b64_tr_b16 a[164:165], v2 offset:7328
  v_exp_f32 v23, v23
  v_mul_f32 v27, v13, v101
  v_mfma_f32_16x16x32_bf16 v[212:215], a[140:143], a[116:119], v[212:215]
  v_exp_f32 v24, v24
  v_mul_f32 v28, v13, v102
  v_mfma_f32_16x16x32_bf16 v[208:211], a[140:143], a[112:115], v[208:211]
  ds_read_b64_tr_b16 a[166:167], v2 offset:10912
  v_exp_f32 v25, v25
  v_mul_f32 v29, v13, v103
  v_mfma_f32_16x16x32_bf16 v[208:211], a[136:139], a[96:99], v[208:211]
  s_waitcnt lgkmcnt(4)
  v_exp_f32 v26, v26
  v_fma_f32 v22, v22, v11, v11
  v_mfma_f32_16x16x32_bf16 v[112:115], a[144:147], a[32:35], v[112:115]
  ds_read_b64_tr_b16 a[168:169], v2 offset:14496
  v_exp_f32 v27, v27
  v_fma_f32 v23, v23, v11, v11
  v_mfma_f32_16x16x32_bf16 v[112:115], a[148:151], a[48:51], v[112:115]
  v_exp_f32 v28, v28
  v_fma_f32 v24, v24, v11, v11
  v_mfma_f32_16x16x32_bf16 v[116:119], a[148:151], a[52:55], v[116:119]
  ds_read_b64_tr_b16 a[170:171], v2 offset:18080
  v_exp_f32 v29, v29
  v_fma_f32 v25, v25, v11, v11
  v_mfma_f32_16x16x32_bf16 v[116:119], a[144:147], a[36:39], v[116:119]
  v_rcp_f32 v22, v22
  v_fma_f32 v26, v26, v14, v14
  v_mfma_f32_16x16x32_bf16 v[120:123], a[144:147], a[40:43], v[120:123]
  ds_read_b64_tr_b16 a[172:173], v2 offset:21664
  v_rcp_f32 v23, v23
  v_fma_f32 v27, v27, v14, v14
  v_mfma_f32_16x16x32_bf16 v[120:123], a[148:151], a[56:59], v[120:123]
  v_rcp_f32 v24, v24
  v_fma_f32 v28, v28, v14, v14
  v_mfma_f32_16x16x32_bf16 v[124:127], a[148:151], a[60:63], v[124:127]
  ds_read_b64_tr_b16 a[174:175], v2 offset:25248
  v_rcp_f32 v25, v25
  v_fma_f32 v29, v29, v14, v14
  v_mfma_f32_16x16x32_bf16 v[124:127], a[144:147], a[44:47], v[124:127]
  s_waitcnt lgkmcnt(11)
  v_rcp_f32 v26, v26
  v_mul_f32 v208, v96, v208
  v_mfma_f32_16x16x32_bf16 v[112:115], a[16:19], a[0:3], v[112:115]
  ds_read_b64_tr_b16 a[128:129], v2 offset:28832
  v_rcp_f32 v27, v27
  v_mul_f32 v209, v97, v209
  v_mfma_f32_16x16x32_bf16 v[116:119], a[16:19], a[4:7], v[116:119]
  v_rcp_f32 v28, v28
  v_mul_f32 v210, v98, v210
  v_mfma_f32_16x16x32_bf16 v[120:123], a[16:19], a[8:11], v[120:123]
  ds_read_b64_tr_b16 a[130:131], v2 offset:32416
  v_rcp_f32 v29, v29
  v_mul_f32 v211, v99, v211
  v_mfma_f32_16x16x32_bf16 v[124:127], a[16:19], a[12:15], v[124:127]
  v_mul_f32 v208, v208, v22
  v_mul_f32 v209, v209, v23
  v_mul_f32 v210, v210, v24
  v_mul_f32 v211, v211, v25
  v_mfma_f32_16x16x32_bf16 v[224:227], a[20:23], a[0:3], v[224:227]
  ds_read_b64_tr_b16 a[132:133], v2 offset:36000
  v_mul_f32 v22, v16, v104
  v_mul_f32 v23, v16, v105
  v_mul_f32 v24, v16, v106
  v_mfma_f32_16x16x32_bf16 v[228:231], a[20:23], a[4:7], v[228:231]
  s_lshl_b32 s51, s71, 11
  v_mul_f32 v25, v16, v107
  v_exp_f32 v22, v22
  v_mul_f32 v212, v100, v212
  v_mfma_f32_16x16x32_bf16 v[232:235], a[20:23], a[8:11], v[232:235]
  ds_read_b64_tr_b16 a[134:135], v2 offset:39584
  v_exp_f32 v23, v23
  v_mul_f32 v213, v101, v213
  v_mfma_f32_16x16x32_bf16 v[236:239], a[20:23], a[12:15], v[236:239]
  v_exp_f32 v24, v24
  v_mul_f32 v214, v102, v214
  v_mfma_f32_16x16x32_bf16 v[236:239], a[152:155], a[44:47], v[236:239]
  ds_read_b64_tr_b16 a[136:137], v2 offset:43168
  v_exp_f32 v25, v25
  v_mul_f32 v215, v103, v215
  v_mfma_f32_16x16x32_bf16 v[236:239], a[156:159], a[60:63], v[236:239]
  buffer_load_dwordx4 a[0:3], v137, s[36:39], s51 offen offset:0 sc1
  v_mul_f32 v212, v212, v26
  v_mul_f32 v213, v213, v27
  v_mul_f32 v214, v214, v28
  v_mfma_f32_16x16x32_bf16 v[232:235], a[156:159], a[56:59], v[232:235]
  ds_read_b64_tr_b16 a[138:139], v2 offset:46752
  v_mul_f32 v215, v215, v29
  v_cvt_pk_bf16_f32 v96, v208, v209
  v_cvt_pk_bf16_f32 v97, v210, v211
  v_mfma_f32_16x16x32_bf16 v[232:235], a[152:155], a[40:43], v[232:235]
  v_mul_f32 v26, v19, v108
  v_mul_f32 v27, v19, v109
  v_mul_f32 v28, v19, v110
  v_mul_f32 v29, v19, v111
  v_mfma_f32_16x16x32_bf16 v[228:231], a[152:155], a[36:39], v[228:231]
Hb1_2:
  s_cbranch_execz Hb1_3
  buffer_load_dwordx4 a[4:7], v137, s[36:39], s51 offen offset:1024 sc1
  s_add_u32 s51, s51, 12288
  v_exp_f32 v26, v26
  v_mfma_f32_16x16x32_bf16 v[228:231], a[156:159], a[52:55], v[228:231]
  ds_read_b64_tr_b16 a[140:141], v2 offset:50336
  v_fma_f32 v22, v22, v17, v17
  v_exp_f32 v27, v27
  v_mfma_f32_16x16x32_bf16 v[224:227], a[156:159], a[48:51], v[224:227]
  ds_read_b64_tr_b16 a[142:143], v2 offset:53920
  v_fma_f32 v23, v23, v17, v17
  v_exp_f32 v28, v28
  v_mfma_f32_16x16x32_bf16 v[224:227], a[152:155], a[32:35], v[224:227]
  s_waitcnt lgkmcnt(8)
  buffer_load_dwordx4 a[8:11], v137, s[36:39], s51 offen offset:2048 sc1
  v_fma_f32 v24, v24, v17, v17
  v_exp_f32 v29, v29
  v_mfma_f32_16x16x32_bf16 v[112:115], a[160:163], a[64:67], v[112:115]
  v_fma_f32 v25, v25, v17, v17
  v_cvt_pk_bf16_f32 v100, v212, v213
  v_cvt_pk_bf16_f32 v101, v214, v215
  v_mfma_f32_16x16x32_bf16 v[112:115], a[164:167], a[80:83], v[112:115]
  v_rcp_f32 v22, v22
  v_fma_f32 v26, v26, v20, v20
  v_mfma_f32_16x16x32_bf16 v[116:119], a[164:167], a[84:87], v[116:119]
  buffer_load_dwordx4 a[12:15], v137, s[36:39], s51 offen offset:3072 sc1
  s_lshl_b32 s51, s72, 11
  v_rcp_f32 v23, v23
  v_mfma_f32_16x16x32_bf16 v[116:119], a[160:163], a[68:71], v[116:119]
  v_fma_f32 v27, v27, v20, v20
  v_rcp_f32 v24, v24
  v_fma_f32 v28, v28, v20, v20
  v_mfma_f32_16x16x32_bf16 v[120:123], a[160:163], a[72:75], v[120:123]
  v_rcp_f32 v25, v25
  v_fma_f32 v29, v29, v20, v20
  v_mfma_f32_16x16x32_bf16 v[120:123], a[164:167], a[88:91], v[120:123]
  buffer_load_dwordx4 a[16:19], v137, s[36:39], s51 offen offset:0 sc1
  v_rcp_f32 v26, v26
  v_mul_f32 v216, v104, v216
  v_mfma_f32_16x16x32_bf16 v[124:127], a[164:167], a[92:95], v[124:127]
  v_rcp_f32 v27, v27
  v_mul_f32 v217, v105, v217
  v_mfma_f32_16x16x32_bf16 v[124:127], a[160:163], a[76:79], v[124:127]
  s_waitcnt vmcnt(15)
  s_barrier
  v_rcp_f32 v28, v28
  v_mul_f32 v218, v106, v218
  v_mfma_f32_16x16x32_bf16 v[236:239], a[168:171], a[76:79], v[236:239]
  buffer_load_dwordx4 a[20:23], v137, s[36:39], s51 offen offset:1024 sc1
  s_add_u32 s51, s51, 12288
  v_rcp_f32 v29, v29
  v_mfma_f32_16x16x32_bf16 v[236:239], a[172:175], a[92:95], v[236:239]
  v_mul_f32 v219, v107, v219
  v_mul_f32 v216, v216, v22
  v_mul_f32 v217, v217, v23
  v_mul_f32 v218, v218, v24
  v_mfma_f32_16x16x32_bf16 v[232:235], a[172:175], a[88:91], v[232:235]
  buffer_load_dword v139, v138, s[36:39], s91 offen sc1
  v_mul_f32 v219, v219, v25
  v_mul_f32 v220, v108, v220
  v_mul_f32 v221, v109, v221
  v_mfma_f32_16x16x32_bf16 v[232:235], a[168:171], a[72:75], v[232:235]
  v_mul_f32 v222, v110, v222
  v_mul_f32 v223, v111, v223
  v_cvt_pk_bf16_f32 v104, v216, v217
  v_cvt_pk_bf16_f32 v105, v218, v219
  v_mfma_f32_16x16x32_bf16 v[228:231], a[168:171], a[68:71], v[228:231]
  buffer_load_dwordx4 a[24:27], v137, s[36:39], s51 offen offset:2048 sc1
  v_mul_f32 v220, v220, v26
  v_mul_f32 v221, v221, v27
  v_mul_f32 v222, v222, v28
  v_mfma_f32_16x16x32_bf16 v[228:231], a[172:175], a[84:87], v[228:231]
  v_mul_f32 v223, v223, v29
  v_cvt_pk_bf16_f32 v108, v220, v221
  v_cvt_pk_bf16_f32 v109, v222, v223
  v_mfma_f32_16x16x32_bf16 v[224:227], a[172:175], a[80:83], v[224:227]
  buffer_load_dwordx4 a[28:31], v137, s[36:39], s51 offen offset:3072 sc1
  v_mfma_f32_16x16x32_bf16 v[224:227], a[168:171], a[64:67], v[224:227]
  s_waitcnt lgkmcnt(0)
  v_mfma_f32_16x16x32_bf16 v[112:115], a[128:131], a[96:99], v[112:115]
  s_barrier
  ds_read_b64_tr_b16 a[176:177], v244 offset:49152
  v_mfma_f32_16x16x32_bf16 v[112:115], a[132:135], a[112:115], v[112:115]
  ds_read_b64_tr_b16 a[178:179], v244 offset:53248
  v_mfma_f32_16x16x32_bf16 v[116:119], a[132:135], a[116:119], v[116:119]
  ds_read_b64_tr_b16 a[180:181], v244 offset:57344
  v_mfma_f32_16x16x32_bf16 v[116:119], a[128:131], a[100:103], v[116:119]
  ds_read_b64_tr_b16 a[182:183], v244 offset:61440
  v_mfma_f32_16x16x32_bf16 v[120:123], a[128:131], a[104:107], v[120:123]
  ds_read_b64_tr_b16 a[184:185], v245 offset:49152
  v_mfma_f32_16x16x32_bf16 v[120:123], a[132:135], a[120:123], v[120:123]
  ds_read_b64_tr_b16 a[186:187], v245 offset:53248
  v_mfma_f32_16x16x32_bf16 v[124:127], a[132:135], a[124:127], v[124:127]
  s_mov_b32 s73, 45
  s_lshl_b32 s50, s73, 16
  s_lshl1_add_u32 s50, s88, s50
  s_add_u32 m0, s70, 16384
  ds_read_b64_tr_b16 a[188:189], v245 offset:57344
  v_mfma_f32_16x16x32_bf16 v[124:127], a[128:131], a[108:111], v[124:127]
  ds_read_b64_tr_b16 a[190:191], v245 offset:61440
  v_mfma_f32_16x16x32_bf16 v[236:239], a[136:139], a[108:111], v[236:239]
  ds_read_b64_tr_b16 a[192:193], v246 offset:49152
  v_mul_f32 v22, v10, v112
  v_mul_f32 v23, v10, v113
  v_mul_f32 v24, v10, v114
  v_mfma_f32_16x16x32_bf16 v[236:239], a[140:143], a[124:127], v[236:239]
  ds_read_b64_tr_b16 a[194:195], v246 offset:53248
  v_mul_f32 v25, v10, v115
  v_exp_f32 v22, v22
  v_mfma_f32_16x16x32_bf16 v[232:235], a[140:143], a[120:123], v[232:235]
  buffer_load_dwordx4 v133, s[24:27], s50 offen offset:0 lds
  ds_read_b64_tr_b16 a[196:197], v246 offset:57344
  v_mul_f32 v26, v13, v116
  v_mfma_f32_16x16x32_bf16 v[232:235], a[136:139], a[104:107], v[232:235]
  ds_read_b64_tr_b16 a[198:199], v246 offset:61440
  v_exp_f32 v23, v23
  v_mul_f32 v27, v13, v117
  v_mfma_f32_16x16x32_bf16 v[228:231], a[136:139], a[100:103], v[228:231]
  s_lshl_b32 s51, s73, 11
  ds_read_b64_tr_b16 a[200:201], v247 offset:49152
  v_exp_f32 v24, v24
  v_mul_f32 v28, v13, v118
  v_mfma_f32_16x16x32_bf16 v[228:231], a[140:143], a[116:119], v[228:231]
  ds_read_b64_tr_b16 a[202:203], v247 offset:53248
  v_exp_f32 v25, v25
  v_mul_f32 v29, v13, v119
  v_mfma_f32_16x16x32_bf16 v[224:227], a[140:143], a[112:115], v[224:227]
  ds_read_b64_tr_b16 a[204:205], v247 offset:57344
  v_exp_f32 v26, v26
  v_fma_f32 v22, v22, v11, v11
  v_mfma_f32_16x16x32_bf16 v[224:227], a[136:139], a[96:99], v[224:227]
  s_waitcnt vmcnt(11) lgkmcnt(11)
  ds_read_b64_tr_b16 a[206:207], v247 offset:61440
  v_exp_f32 v27, v27
  v_fma_f32 v23, v23, v11, v11
  v_mfma_f32_16x16x32_bf16 v[32:35], a[176:179], a[216:219], 0
  buffer_load_dwordx4 a[32:35], v137, s[36:39], s51 offen offset:0 sc1
  ds_read_b64_tr_b16 a[208:209], v244 offset:51200
  v_exp_f32 v28, v28
  v_mfma_f32_16x16x32_bf16 v[32:35], a[180:183], a[224:227], v[32:35]
  ds_read_b64_tr_b16 a[210:211], v244 offset:55296
  v_fma_f32 v24, v24, v11, v11
  v_exp_f32 v29, v29
  v_mfma_f32_16x16x32_bf16 v[36:39], a[180:183], a[228:231], 0
  buffer_load_dwordx4 v134, s[24:27], s50 offen offset:1024 lds
  ds_read_b64_tr_b16 a[212:213], v244 offset:59392
  v_fma_f32 v25, v25, v11, v11
  v_mfma_f32_16x16x32_bf16 v[36:39], a[176:179], a[220:223], v[36:39]
  s_waitcnt lgkmcnt(11)
  ds_read_b64_tr_b16 a[214:215], v244 offset:63488
  v_rcp_f32 v22, v22
  v_fma_f32 v26, v26, v14, v14
  v_mfma_f32_16x16x32_bf16 v[44:47], a[184:187], a[220:223], 0
  ds_read_b64_tr_b16 a[176:177], v245 offset:51200
  v_rcp_f32 v23, v23
  v_fma_f32 v27, v27, v14, v14
  v_mfma_f32_16x16x32_bf16 v[44:47], a[188:191], a[228:231], v[44:47]
  buffer_load_dwordx4 a[36:39], v137, s[36:39], s51 offen offset:1024 sc1
  ds_read_b64_tr_b16 a[178:179], v245 offset:55296
  v_rcp_f32 v24, v24
  v_mfma_f32_16x16x32_bf16 v[40:43], a[188:191], a[224:227], 0
  ds_read_b64_tr_b16 a[180:181], v245 offset:59392
  v_fma_f32 v28, v28, v14, v14
  v_rcp_f32 v25, v25
  v_mfma_f32_16x16x32_bf16 v[40:43], a[184:187], a[216:219], v[40:43]
  s_waitcnt lgkmcnt(11)
  ds_read_b64_tr_b16 a[182:183], v245 offset:63488
  v_fma_f32 v29, v29, v14, v14
  v_rcp_f32 v26, v26
  v_mfma_f32_16x16x32_bf16 v[48:51], a[192:195], a[216:219], 0
  ds_read_b64_tr_b16 a[184:185], v246 offset:51200
  v_mul_f32 v224, v112, v224
  v_rcp_f32 v27, v27
  v_mfma_f32_16x16x32_bf16 v[48:51], a[196:199], a[224:227], v[48:51]
  buffer_load_dwordx4 v135, s[24:27], s50 offen offset:2048 lds
  s_add_u32 s51, s51, 12288
  ds_read_b64_tr_b16 a[186:187], v246 offset:55296
  v_mul_f32 v225, v113, v225
  v_mfma_f32_16x16x32_bf16 v[52:55], a[196:199], a[228:231], 0
  ds_read_b64_tr_b16 a[188:189], v246 offset:59392
  v_rcp_f32 v28, v28
  v_mul_f32 v226, v114, v226
  v_mfma_f32_16x16x32_bf16 v[52:55], a[192:195], a[220:223], v[52:55]
  s_waitcnt lgkmcnt(11)
  ds_read_b64_tr_b16 a[190:191], v246 offset:63488
  v_rcp_f32 v29, v29
  v_mul_f32 v227, v115, v227
  v_mfma_f32_16x16x32_bf16 v[60:63], a[200:203], a[220:223], 0
  ds_read_b64_tr_b16 a[192:193], v247 offset:51200
  v_mul_f32 v224, v224, v22
  v_mul_f32 v225, v225, v23
  v_mul_f32 v226, v226, v24
  v_mfma_f32_16x16x32_bf16 v[60:63], a[204:207], a[228:231], v[60:63]
  buffer_load_dwordx4 a[40:43], v137, s[36:39], s51 offen offset:2048 sc1
  ds_read_b64_tr_b16 a[194:195], v247 offset:55296
  v_mul_f32 v227, v227, v25
  v_mul_f32 v22, v16, v120
  v_mfma_f32_16x16x32_bf16 v[56:59], a[204:207], a[224:227], 0
  ds_read_b64_tr_b16 a[196:197], v247 offset:59392
  v_mul_f32 v23, v16, v121
  v_mul_f32 v24, v16, v122
  v_mul_f32 v25, v16, v123
  v_mfma_f32_16x16x32_bf16 v[56:59], a[200:203], a[216:219], v[56:59]
  s_waitcnt lgkmcnt(11)
  ds_read_b64_tr_b16 a[198:199], v247 offset:63488
  v_exp_f32 v22, v22
  v_mul_f32 v228, v116, v228
  v_mfma_f32_16x16x32_bf16 v[144:147], a[208:211], a[216:219], 0
  buffer_load_dwordx4 v136, s[24:27], s50 offen offset:3072 lds
  ds_read_b64_tr_b16 a[200:201], v248 offset:0
  v_exp_f32 v23, v23
  v_mfma_f32_16x16x32_bf16 v[144:147], a[212:215], a[224:227], v[144:147]
  ds_read_b64_tr_b16 a[202:203], v248 offset:4096
  v_mul_f32 v229, v117, v229
  v_exp_f32 v24, v24
  v_mfma_f32_16x16x32_bf16 v[148:151], a[212:215], a[228:231], 0
  ds_read_b64_tr_b16 a[204:205], v248 offset:8192
  v_mul_f32 v230, v118, v230
  v_exp_f32 v25, v25
  v_mfma_f32_16x16x32_bf16 v[148:151], a[208:211], a[220:223], v[148:151]
  s_waitcnt lgkmcnt(11)
  ds_read_b64_tr_b16 a[206:207], v248 offset:12288
  v_mul_f32 v231, v119, v231
  v_mul_f32 v228, v228, v26
  v_mul_f32 v229, v229, v27
  v_mfma_f32_16x16x32_bf16 v[156:159], a[176:179], a[220:223], 0
  buffer_load_dwordx4 a[44:47], v137, s[36:39], s51 offen offset:3072 sc1
  s_mov_b32 s74, 0
  s_lshl_b32 s50, s74, 16
  s_add_u32 s50, s50, s88
  v_mfma_f32_16x16x32_bf16 v[156:159], a[180:183], a[228:231], v[156:159]
  s_add_u32 m0, s70, 32768
  ds_read_b64_tr_b16 a[208:209], v249 offset:0
  ds_read_b64_tr_b16 a[210:211], v249 offset:4096
  v_mul_f32 v230, v230, v28
  v_mul_f32 v231, v231, v29
  v_mfma_f32_16x16x32_bf16 v[152:155], a[180:183], a[224:227], 0
  ds_read_b64_tr_b16 a[212:213], v249 offset:8192
  v_cvt_pk_bf16_f32 v98, v224, v225
  v_cvt_pk_bf16_f32 v99, v226, v227
  v_mfma_f32_16x16x32_bf16 v[152:155], a[176:179], a[216:219], v[152:155]
  s_waitcnt lgkmcnt(11)
  ds_read_b64_tr_b16 a[214:215], v249 offset:12288
  buffer_store_dwordx4 v[96:99], v0, s[36:39], s65 offen offset:0 sc1
  v_mul_f32 v26, v19, v124
  v_mul_f32 v27, v19, v125
  v_mfma_f32_16x16x32_bf16 v[160:163], a[184:187], a[216:219], 0
  ds_read_b64_tr_b16 a[176:177], v250 offset:0
  v_mul_f32 v28, v19, v126
  v_mul_f32 v29, v19, v127
  v_mfma_f32_16x16x32_bf16 v[160:163], a[188:191], a[224:227], v[160:163]
  buffer_load_dwordx4 v133, s[24:27], s50 offen offset:0 lds
  s_waitcnt vmcnt(12)
  v_cmp_ne_u32 vcc, s3, v139
  s_nop 4
  s_cbranch_vccnz CK8s
CK8x:
  v_mfma_f32_16x16x32_bf16 v[164:167], a[188:191], a[228:231], 0
  s_lshl_b32 s51, s74, 11
  s_add_u32 s91, s91, 32768
  ds_read_b64_tr_b16 a[178:179], v250 offset:4096
  ds_read_b64_tr_b16 a[180:181], v250 offset:8192
  v_mfma_f32_16x16x32_bf16 v[164:167], a[184:187], a[220:223], v[164:167]
  s_waitcnt lgkmcnt(11)
  ds_read_b64_tr_b16 a[182:183], v250 offset:12288
  v_exp_f32 v26, v26
  v_fma_f32 v22, v22, v17, v17
  v_mfma_f32_16x16x32_bf16 v[172:175], a[192:195], a[220:223], 0
  buffer_load_dwordx4 a[48:51], v137, s[36:39], s51 offen offset:0 sc1
  ds_read_b64_tr_b16 a[184:185], v251 offset:0
  v_exp_f32 v27, v27
  v_mfma_f32_16x16x32_bf16 v[172:175], a[196:199], a[228:231], v[172:175]
  ds_read_b64_tr_b16 a[186:187], v251 offset:4096
  v_fma_f32 v23, v23, v17, v17
  v_exp_f32 v28, v28
  v_mfma_f32_16x16x32_bf16 v[168:171], a[196:199], a[224:227], 0
  ds_read_b64_tr_b16 a[188:189], v251 offset:8192
  v_fma_f32 v24, v24, v17, v17
  v_exp_f32 v29, v29
  v_mfma_f32_16x16x32_bf16 v[168:171], a[192:195], a[216:219], v[168:171]
  s_waitcnt vmcnt(16) lgkmcnt(11)
  ds_read_b64_tr_b16 a[190:191], v251 offset:12288
  v_fma_f32 v25, v25, v17, v17
  v_cvt_pk_bf16_f32 v102, v228, v229
  v_cvt_pk_bf16_f32 v103, v230, v231
  v_mfma_f32_16x16x32_bf16 v[32:35], a[200:203], a[0:3], v[32:35]
  buffer_load_dwordx4 v134, s[24:27], s50 offen offset:1024 lds
  ds_read_b64_tr_b16 a[192:193], v248 offset:2048
  v_mfma_f32_16x16x32_bf16 v[32:35], a[204:207], a[8:11], v[32:35]
  ds_read_b64_tr_b16 a[194:195], v248 offset:6144
  v_mfma_f32_16x16x32_bf16 v[36:39], a[204:207], a[12:15], v[36:39]
  ds_read_b64_tr_b16 a[196:197], v248 offset:10240
  buffer_store_dwordx4 v[100:103], v0, s[36:39], s65 offen offset:1024 sc1
  v_rcp_f32 v22, v22
  v_mfma_f32_16x16x32_bf16 v[36:39], a[200:203], a[4:7], v[36:39]
  s_waitcnt lgkmcnt(11)
  ds_read_b64_tr_b16 a[198:199], v248 offset:14336
  v_fma_f32 v26, v26, v20, v20
  v_rcp_f32 v23, v23
  v_mfma_f32_16x16x32_bf16 v[44:47], a[208:211], a[4:7], v[44:47]
  buffer_load_dwordx4 a[52:55], v137, s[36:39], s51 offen offset:1024 sc1
  ds_read_b64_tr_b16 a[200:201], v249 offset:2048
  v_fma_f32 v27, v27, v20, v20
  v_mfma_f32_16x16x32_bf16 v[44:47], a[212:215], a[12:15], v[44:47]
  ds_read_b64_tr_b16 a[202:203], v249 offset:6144
  v_rcp_f32 v24, v24
  v_fma_f32 v28, v28, v20, v20
  v_mfma_f32_16x16x32_bf16 v[40:43], a[212:215], a[8:11], v[40:43]
  ds_read_b64_tr_b16 a[204:205], v249 offset:10240
  v_rcp_f32 v25, v25
  v_fma_f32 v29, v29, v20, v20
  v_mfma_f32_16x16x32_bf16 v[40:43], a[208:211], a[0:3], v[40:43]
  s_waitcnt lgkmcnt(11)
  buffer_load_dwordx4 v135, s[24:27], s50 offen offset:2048 lds
  s_add_u32 s51, s51, 6144
  ds_read_b64_tr_b16 a[206:207], v249 offset:14336
  v_mfma_f32_16x16x32_bf16 v[48:51], a[176:179], a[0:3], v[48:51]
  ds_read_b64_tr_b16 a[208:209], v250 offset:2048
  v_rcp_f32 v26, v26
  v_mul_f32 v232, v120, v232
  v_mfma_f32_16x16x32_bf16 v[48:51], a[180:183], a[8:11], v[48:51]
  ds_read_b64_tr_b16 a[210:211], v250 offset:6144
  v_rcp_f32 v27, v27
  v_mul_f32 v233, v121, v233
  v_mfma_f32_16x16x32_bf16 v[52:55], a[180:183], a[12:15], v[52:55]
  ds_read_b64_tr_b16 a[212:213], v250 offset:10240
  v_rcp_f32 v28, v28
  v_mul_f32 v234, v122, v234
  v_mfma_f32_16x16x32_bf16 v[52:55], a[176:179], a[4:7], v[52:55]
  s_waitcnt lgkmcnt(11)
  buffer_load_dwordx4 a[56:59], v137, s[36:39], s51 offen offset:2048 sc1
  ds_read_b64_tr_b16 a[214:215], v250 offset:14336
  v_rcp_f32 v29, v29
  v_mfma_f32_16x16x32_bf16 v[60:63], a[184:187], a[4:7], v[60:63]
  ds_read_b64_tr_b16 a[176:177], v251 offset:2048
  v_mul_f32 v235, v123, v235
  v_mul_f32 v232, v232, v22
  v_mul_f32 v233, v233, v23
  v_mfma_f32_16x16x32_bf16 v[60:63], a[188:191], a[12:15], v[60:63]
  ds_read_b64_tr_b16 a[178:179], v251 offset:6144
  v_mul_f32 v234, v234, v24
  v_mul_f32 v235, v235, v25
  v_mul_f32 v236, v124, v236
  v_mfma_f32_16x16x32_bf16 v[56:59], a[188:191], a[8:11], v[56:59]
  ds_read_b64_tr_b16 a[180:181], v251 offset:10240
  v_mul_f32 v237, v125, v237
  v_mul_f32 v238, v126, v238
  v_mul_f32 v239, v127, v239
  v_mfma_f32_16x16x32_bf16 v[56:59], a[184:187], a[0:3], v[56:59]
  s_waitcnt lgkmcnt(11)
  buffer_load_dwordx4 v136, s[24:27], s50 offen offset:3072 lds
  ds_read_b64_tr_b16 a[182:183], v251 offset:14336
  v_cvt_pk_bf16_f32 v106, v232, v233
  v_cvt_pk_bf16_f32 v107, v234, v235
  v_mfma_f32_16x16x32_bf16 v[144:147], a[192:195], a[0:3], v[144:147]
  ds_read_b64_tr_b16 a[184:185], v240 offset:0
  v_mfma_f32_16x16x32_bf16 v[144:147], a[196:199], a[8:11], v[144:147]
  ds_read_b64_tr_b16 a[186:187], v240 offset:4096
  buffer_store_dwordx4 v[104:107], v0, s[36:39], s66 offen offset:0 sc1
  v_mul_f32 v236, v236, v26
  v_mul_f32 v237, v237, v27
  v_mfma_f32_16x16x32_bf16 v[148:151], a[196:199], a[12:15], v[148:151]
  ds_read_b64_tr_b16 a[188:189], v240 offset:8192
  v_mul_f32 v238, v238, v28
  v_mul_f32 v239, v239, v29
  v_cvt_pk_bf16_f32 v110, v236, v237
  v_mfma_f32_16x16x32_bf16 v[148:151], a[192:195], a[4:7], v[148:151]
  s_waitcnt lgkmcnt(11)
  buffer_load_dwordx4 a[60:63], v137, s[36:39], s51 offen offset:3072 sc1
  s_cmp_eq_u32 s87, 1
  s_cselect_b32 s75, 35, 7
  s_lshl_b32 s50, s75, 16
  v_mfma_f32_16x16x32_bf16 v[156:159], a[200:203], a[4:7], v[156:159]
  s_add_u32 s50, s50, s88
  s_add_u32 m0, s70, 49152
  ds_read_b64_tr_b16 a[190:191], v240 offset:12288
  ds_read_b64_tr_b16 a[192:193], v241 offset:0
  v_cvt_pk_bf16_f32 v111, v238, v239
  v_mfma_f32_16x16x32_bf16 v[156:159], a[204:207], a[12:15], v[156:159]
  ds_read_b64_tr_b16 a[194:195], v241 offset:4096
  buffer_store_dwordx4 v[108:111], v0, s[36:39], s66 offen offset:1024 sc1
  v_mfma_f32_16x16x32_bf16 v[152:155], a[204:207], a[8:11], v[152:155]
  ds_read_b64_tr_b16 a[196:197], v241 offset:8192
  v_mfma_f32_16x16x32_bf16 v[152:155], a[200:203], a[0:3], v[152:155]
  s_waitcnt lgkmcnt(11)
  buffer_load_dwordx4 v133, s[24:27], s50 offen offset:0 lds
  s_lshl_b32 s51, s75, 11
  ds_read_b64_tr_b16 a[198:199], v241 offset:12288
  v_mfma_f32_16x16x32_bf16 v[160:163], a[208:211], a[0:3], v[160:163]
  ds_read_b64_tr_b16 a[200:201], v242 offset:0
  v_mfma_f32_16x16x32_bf16 v[160:163], a[212:215], a[8:11], v[160:163]
  ds_read_b64_tr_b16 a[202:203], v242 offset:4096
  v_mfma_f32_16x16x32_bf16 v[164:167], a[212:215], a[12:15], v[164:167]
  buffer_load_dwordx4 a[64:67], v137, s[36:39], s51 offen offset:0 sc1
  ds_read_b64_tr_b16 a[204:205], v242 offset:8192
  v_mfma_f32_16x16x32_bf16 v[164:167], a[208:211], a[4:7], v[164:167]
  s_waitcnt lgkmcnt(11)
  ds_read_b64_tr_b16 a[206:207], v242 offset:12288
  v_mfma_f32_16x16x32_bf16 v[172:175], a[176:179], a[4:7], v[172:175]
  ds_read_b64_tr_b16 a[208:209], v243 offset:0
  v_mfma_f32_16x16x32_bf16 v[172:175], a[180:183], a[12:15], v[172:175]
  ds_read_b64_tr_b16 a[210:211], v243 offset:4096
  v_mfma_f32_16x16x32_bf16 v[168:171], a[180:183], a[8:11], v[168:171]
  buffer_load_dwordx4 v134, s[24:27], s50 offen offset:1024 lds
  ds_read_b64_tr_b16 a[212:213], v243 offset:8192
  v_mfma_f32_16x16x32_bf16 v[168:171], a[176:179], a[0:3], v[168:171]
  s_waitcnt vmcnt(23) lgkmcnt(11)
  ds_read_b64_tr_b16 a[214:215], v243 offset:12288
  v_mfma_f32_16x16x32_bf16 v[32:35], a[184:187], a[16:19], v[32:35]
  ds_read_b64_tr_b16 a[176:177], v240 offset:2048
  v_mfma_f32_16x16x32_bf16 v[32:35], a[188:191], a[24:27], v[32:35]
  ds_read_b64_tr_b16 a[178:179], v240 offset:6144
  v_mfma_f32_16x16x32_bf16 v[36:39], a[188:191], a[28:31], v[36:39]
  buffer_load_dwordx4 a[68:71], v137, s[36:39], s51 offen offset:1024 sc1
  ds_read_b64_tr_b16 a[180:181], v240 offset:10240
  v_mfma_f32_16x16x32_bf16 v[36:39], a[184:187], a[20:23], v[36:39]
  s_waitcnt lgkmcnt(11)
  ds_read_b64_tr_b16 a[182:183], v240 offset:14336
  v_mfma_f32_16x16x32_bf16 v[44:47], a[192:195], a[20:23], v[44:47]
  ds_read_b64_tr_b16 a[184:185], v241 offset:2048
  v_mfma_f32_16x16x32_bf16 v[44:47], a[196:199], a[28:31], v[44:47]
  ds_read_b64_tr_b16 a[186:187], v241 offset:6144
  v_mfma_f32_16x16x32_bf16 v[40:43], a[196:199], a[24:27], v[40:43]
  buffer_load_dwordx4 v135, s[24:27], s50 offen offset:2048 lds
  s_add_u32 s51, s51, 6144
  v_mfma_f32_16x16x32_bf16 v[40:43], a[192:195], a[16:19], v[40:43]
  s_waitcnt vmcnt(18) lgkmcnt(10)
  s_barrier
  ds_read_b64_tr_b16 a[188:189], v241 offset:10240
  v_mfma_f32_16x16x32_bf16 v[48:51], a[200:203], a[16:19], v[48:51]
  ds_read_b64_tr_b16 a[190:191], v241 offset:14336
  ds_read_b64_tr_b16 a[192:193], v242 offset:2048
  v_mfma_f32_16x16x32_bf16 v[48:51], a[204:207], a[24:27], v[48:51]
  buffer_load_dwordx4 a[72:75], v137, s[36:39], s51 offen offset:2048 sc1
  ds_read_b64_tr_b16 a[194:195], v242 offset:6144
  v_mfma_f32_16x16x32_bf16 v[52:55], a[204:207], a[28:31], v[52:55]
  ds_read_b64_tr_b16 a[196:197], v242 offset:10240
  v_mfma_f32_16x16x32_bf16 v[52:55], a[200:203], a[20:23], v[52:55]
  s_waitcnt lgkmcnt(11)
  ds_read_b64_tr_b16 a[198:199], v242 offset:14336
  v_mfma_f32_16x16x32_bf16 v[60:63], a[208:211], a[20:23], v[60:63]
  ds_read_b64_tr_b16 a[200:201], v243 offset:2048
  v_mfma_f32_16x16x32_bf16 v[60:63], a[212:215], a[28:31], v[60:63]
  buffer_load_dwordx4 v136, s[24:27], s50 offen offset:3072 lds
  ds_read_b64_tr_b16 a[202:203], v243 offset:6144
  v_mfma_f32_16x16x32_bf16 v[56:59], a[212:215], a[24:27], v[56:59]
  ds_read_b64_tr_b16 a[204:205], v243 offset:10240
  v_mfma_f32_16x16x32_bf16 v[56:59], a[208:211], a[16:19], v[56:59]
  s_waitcnt lgkmcnt(11)
  ds_read_b64_tr_b16 a[206:207], v243 offset:14336
  v_mfma_f32_16x16x32_bf16 v[144:147], a[176:179], a[16:19], v[144:147]
  ds_read_b64_tr_b16 a[208:209], v240 offset:16384
  v_mfma_f32_16x16x32_bf16 v[144:147], a[180:183], a[24:27], v[144:147]
  buffer_load_dwordx4 a[76:79], v137, s[36:39], s51 offen offset:3072 sc1
  s_cmp_eq_u32 s87, 2
  v_mfma_f32_16x16x32_bf16 v[148:151], a[180:183], a[28:31], v[148:151]
  s_cselect_b32 s79, 42, 14
  s_lshl_b32 s50, s79, 16
  s_add_u32 s50, s50, s88
  v_mfma_f32_16x16x32_bf16 v[148:151], a[176:179], a[20:23], v[148:151]
  s_waitcnt lgkmcnt(9)
  s_add_u32 m0, s70, 65536
  ds_read_b64_tr_b16 a[210:211], v240 offset:20480
  v_mfma_f32_16x16x32_bf16 v[156:159], a[184:187], a[20:23], v[156:159]
  ds_read_b64_tr_b16 a[212:213], v240 offset:24576
  ds_read_b64_tr_b16 a[214:215], v240 offset:28672
  v_mfma_f32_16x16x32_bf16 v[156:159], a[188:191], a[28:31], v[156:159]
  ds_read_b64_tr_b16 a[176:177], v241 offset:16384
  buffer_load_dwordx4 v133, s[24:27], s50 offen offset:0 lds
  v_mfma_f32_16x16x32_bf16 v[152:155], a[188:191], a[24:27], v[152:155]
  s_lshl_b32 s51, s79, 11
  ds_read_b64_tr_b16 a[178:179], v241 offset:20480
  ds_read_b64_tr_b16 a[180:181], v241 offset:24576
  v_mfma_f32_16x16x32_bf16 v[152:155], a[184:187], a[16:19], v[152:155]
  s_waitcnt lgkmcnt(11)
  ds_read_b64_tr_b16 a[182:183], v241 offset:28672
  v_mfma_f32_16x16x32_bf16 v[160:163], a[192:195], a[16:19], v[160:163]
  ds_read_b64_tr_b16 a[184:185], v242 offset:16384
  v_mfma_f32_16x16x32_bf16 v[160:163], a[196:199], a[24:27], v[160:163]
  buffer_load_dwordx4 a[80:83], v137, s[36:39], s51 offen offset:0 sc1
  ds_read_b64_tr_b16 a[186:187], v242 offset:20480
  v_mfma_f32_16x16x32_bf16 v[164:167], a[196:199], a[28:31], v[164:167]
  ds_read_b64_tr_b16 a[188:189], v242 offset:24576
  v_mfma_f32_16x16x32_bf16 v[164:167], a[192:195], a[20:23], v[164:167]
  s_waitcnt lgkmcnt(11)
  ds_read_b64_tr_b16 a[190:191], v242 offset:28672
  v_mfma_f32_16x16x32_bf16 v[172:175], a[200:203], a[20:23], v[172:175]
  buffer_load_dwordx4 v134, s[24:27], s50 offen offset:1024 lds
  ds_read_b64_tr_b16 a[192:193], v243 offset:16384
  v_mfma_f32_16x16x32_bf16 v[172:175], a[204:207], a[28:31], v[172:175]
  ds_read_b64_tr_b16 a[194:195], v243 offset:20480
  v_mfma_f32_16x16x32_bf16 v[168:171], a[204:207], a[24:27], v[168:171]
  ds_read_b64_tr_b16 a[196:197], v243 offset:24576
  v_mfma_f32_16x16x32_bf16 v[168:171], a[200:203], a[16:19], v[168:171]
  s_waitcnt vmcnt(23) lgkmcnt(11)
  ds_read_b64_tr_b16 a[198:199], v243 offset:28672
  v_mfma_f32_16x16x32_bf16 v[32:35], a[208:211], a[32:35], v[32:35]
  buffer_load_dwordx4 a[84:87], v137, s[36:39], s51 offen offset:1024 sc1
  ds_read_b64_tr_b16 a[200:201], v240 offset:18432
  v_mfma_f32_16x16x32_bf16 v[32:35], a[212:215], a[40:43], v[32:35]
  ds_read_b64_tr_b16 a[202:203], v240 offset:22528
  v_mfma_f32_16x16x32_bf16 v[36:39], a[212:215], a[44:47], v[36:39]
  ds_read_b64_tr_b16 a[204:205], v240 offset:26624
  v_mfma_f32_16x16x32_bf16 v[36:39], a[208:211], a[36:39], v[36:39]
  s_waitcnt lgkmcnt(11)
  ds_read_b64_tr_b16 a[206:207], v240 offset:30720
  v_mfma_f32_16x16x32_bf16 v[44:47], a[176:179], a[36:39], v[44:47]
  buffer_load_dwordx4 v135, s[24:27], s50 offen offset:2048 lds
  s_add_u32 s51, s51, 6144
  v_mfma_f32_16x16x32_bf16 v[44:47], a[180:183], a[44:47], v[44:47]
  ds_read_b64_tr_b16 a[208:209], v241 offset:18432
  ds_read_b64_tr_b16 a[210:211], v241 offset:22528
  v_mfma_f32_16x16x32_bf16 v[40:43], a[180:183], a[40:43], v[40:43]
  s_waitcnt vmcnt(13)
  ds_read_b64_tr_b16 a[212:213], v241 offset:26624
  v_mfma_f32_16x16x32_bf16 v[40:43], a[176:179], a[32:35], v[40:43]
  s_waitcnt vmcnt(16) lgkmcnt(11)
  s_barrier
  ds_read_b64_tr_b16 a[214:215], v241 offset:30720
  v_mfma_f32_16x16x32_bf16 v[48:51], a[184:187], a[32:35], v[48:51]
  s_mov_b64 exec, 1
  buffer_store_dword v9, v0, s[36:39], s45 offen sc1
  s_mov_b64 exec, -1
  v_mfma_f32_16x16x32_bf16 v[48:51], a[188:191], a[40:43], v[48:51]
  s_add_u32 s45, s45, 32768
  buffer_load_dwordx4 a[88:91], v137, s[36:39], s51 offen offset:2048 sc1
  ds_read_b64_tr_b16 a[176:177], v242 offset:18432
  v_mfma_f32_16x16x32_bf16 v[52:55], a[188:191], a[44:47], v[52:55]
  ds_read_b64_tr_b16 a[178:179], v242 offset:22528
  ds_read_b64_tr_b16 a[180:181], v242 offset:26624
  v_mfma_f32_16x16x32_bf16 v[52:55], a[184:187], a[36:39], v[52:55]
  s_waitcnt lgkmcnt(11)
  ds_read_b64_tr_b16 a[182:183], v242 offset:30720
  v_mfma_f32_16x16x32_bf16 v[60:63], a[192:195], a[36:39], v[60:63]
  buffer_load_dwordx4 v136, s[24:27], s50 offen offset:3072 lds
  ds_read_b64_tr_b16 a[184:185], v243 offset:18432
  v_mfma_f32_16x16x32_bf16 v[60:63], a[196:199], a[44:47], v[60:63]
  ds_read_b64_tr_b16 a[186:187], v243 offset:22528
  v_mfma_f32_16x16x32_bf16 v[56:59], a[196:199], a[40:43], v[56:59]
  ds_read_b64_tr_b16 a[188:189], v243 offset:26624
  v_mfma_f32_16x16x32_bf16 v[56:59], a[192:195], a[32:35], v[56:59]
  s_waitcnt lgkmcnt(11)
  buffer_load_dwordx4 a[92:95], v137, s[36:39], s51 offen offset:3072 sc1
  s_cmp_eq_u32 s87, 3
  v_mfma_f32_16x16x32_bf16 v[144:147], a[200:203], a[32:35], v[144:147]
  s_cselect_b32 s80, 49, 21
  s_lshl_b32 s50, s80, 16
  s_add_u32 s50, s50, s88
  v_mfma_f32_16x16x32_bf16 v[144:147], a[204:207], a[40:43], v[144:147]
  s_add_u32 m0, s70, 81920
  ds_read_b64_tr_b16 a[190:191], v243 offset:30720
  ds_read_b64_tr_b16 a[192:193], v240 offset:32768
  v_mfma_f32_16x16x32_bf16 v[148:151], a[204:207], a[44:47], v[148:151]
  ds_read_b64_tr_b16 a[194:195], v240 offset:36864
  ds_read_b64_tr_b16 a[196:197], v240 offset:40960
  v_mfma_f32_16x16x32_bf16 v[148:151], a[200:203], a[36:39], v[148:151]
  s_waitcnt lgkmcnt(11)
  buffer_load_dwordx4 v133, s[24:27], s50 offen offset:0 lds
  s_lshl_b32 s51, s80, 11
  v_mfma_f32_16x16x32_bf16 v[156:159], a[208:211], a[36:39], v[156:159]
  ds_read_b64_tr_b16 a[198:199], v240 offset:45056
  ds_read_b64_tr_b16 a[200:201], v241 offset:32768
  v_mfma_f32_16x16x32_bf16 v[156:159], a[212:215], a[44:47], v[156:159]
  ds_read_b64_tr_b16 a[202:203], v241 offset:36864
  v_mfma_f32_16x16x32_bf16 v[152:155], a[212:215], a[40:43], v[152:155]
  ds_read_b64_tr_b16 a[204:205], v241 offset:40960
  v_mfma_f32_16x16x32_bf16 v[152:155], a[208:211], a[32:35], v[152:155]
  s_waitcnt lgkmcnt(11)
  buffer_load_dwordx4 a[96:99], v137, s[36:39], s51 offen offset:0 sc1
  ds_read_b64_tr_b16 a[206:207], v241 offset:45056
  v_mfma_f32_16x16x32_bf16 v[160:163], a[176:179], a[32:35], v[160:163]
  ds_read_b64_tr_b16 a[208:209], v242 offset:32768
  v_mfma_f32_16x16x32_bf16 v[160:163], a[180:183], a[40:43], v[160:163]
  ds_read_b64_tr_b16 a[210:211], v242 offset:36864
  v_mfma_f32_16x16x32_bf16 v[164:167], a[180:183], a[44:47], v[164:167]
  ds_read_b64_tr_b16 a[212:213], v242 offset:40960
  v_mfma_f32_16x16x32_bf16 v[164:167], a[176:179], a[36:39], v[164:167]
  s_waitcnt lgkmcnt(11)
  buffer_load_dwordx4 v134, s[24:27], s50 offen offset:1024 lds
  ds_read_b64_tr_b16 a[214:215], v242 offset:45056
  v_mfma_f32_16x16x32_bf16 v[172:175], a[184:187], a[36:39], v[172:175]
  ds_read_b64_tr_b16 a[176:177], v243 offset:32768
  v_mfma_f32_16x16x32_bf16 v[172:175], a[188:191], a[44:47], v[172:175]
  ds_read_b64_tr_b16 a[178:179], v243 offset:36864
  v_mfma_f32_16x16x32_bf16 v[168:171], a[188:191], a[40:43], v[168:171]
  ds_read_b64_tr_b16 a[180:181], v243 offset:40960
  v_mfma_f32_16x16x32_bf16 v[168:171], a[184:187], a[32:35], v[168:171]
  s_waitcnt vmcnt(21) lgkmcnt(11)
  buffer_load_dwordx4 a[100:103], v137, s[36:39], s51 offen offset:1024 sc1
  ds_read_b64_tr_b16 a[182:183], v243 offset:45056
  v_mfma_f32_16x16x32_bf16 v[32:35], a[192:195], a[48:51], v[32:35]
  ds_read_b64_tr_b16 a[184:185], v240 offset:34816
  v_mfma_f32_16x16x32_bf16 v[32:35], a[196:199], a[56:59], v[32:35]
  ds_read_b64_tr_b16 a[186:187], v240 offset:38912
  v_mfma_f32_16x16x32_bf16 v[36:39], a[196:199], a[60:63], v[36:39]
  buffer_load_dwordx4 v135, s[24:27], s50 offen offset:2048 lds
  s_add_u32 s51, s51, 6144
  v_mfma_f32_16x16x32_bf16 v[36:39], a[192:195], a[52:55], v[36:39]
  s_waitcnt lgkmcnt(10)
  ds_read_b64_tr_b16 a[188:189], v240 offset:43008
  ds_read_b64_tr_b16 a[190:191], v240 offset:47104
  v_mfma_f32_16x16x32_bf16 v[44:47], a[200:203], a[52:55], v[44:47]
  ds_read_b64_tr_b16 a[192:193], v241 offset:34816
  v_mfma_f32_16x16x32_bf16 v[44:47], a[204:207], a[60:63], v[44:47]
Hb2_2:
  s_cbranch_execz Hb2_3
  ds_read_b64_tr_b16 a[194:195], v241 offset:38912
  v_mfma_f32_16x16x32_bf16 v[40:43], a[204:207], a[56:59], v[40:43]
  buffer_load_dwordx4 a[104:107], v137, s[36:39], s51 offen offset:2048 sc1
  ds_read_b64_tr_b16 a[196:197], v241 offset:43008
  v_mfma_f32_16x16x32_bf16 v[40:43], a[200:203], a[48:51], v[40:43]
  s_waitcnt vmcnt(16) lgkmcnt(11)
  s_barrier
  ds_read_b64_tr_b16 a[198:199], v241 offset:47104
  v_mfma_f32_16x16x32_bf16 v[48:51], a[208:211], a[48:51], v[48:51]
  ds_read_b64_tr_b16 a[200:201], v242 offset:34816
  v_mfma_f32_16x16x32_bf16 v[48:51], a[212:215], a[56:59], v[48:51]
  ds_read_b64_tr_b16 a[202:203], v242 offset:38912
  v_mfma_f32_16x16x32_bf16 v[52:55], a[212:215], a[60:63], v[52:55]
  buffer_load_dwordx4 v136, s[24:27], s50 offen offset:3072 lds
  ds_read_b64_tr_b16 a[204:205], v242 offset:43008
  v_mfma_f32_16x16x32_bf16 v[52:55], a[208:211], a[52:55], v[52:55]
  s_waitcnt lgkmcnt(11)
  ds_read_b64_tr_b16 a[206:207], v242 offset:47104
  v_mfma_f32_16x16x32_bf16 v[60:63], a[176:179], a[52:55], v[60:63]
  ds_read_b64_tr_b16 a[208:209], v243 offset:34816
  v_mfma_f32_16x16x32_bf16 v[60:63], a[180:183], a[60:63], v[60:63]
  ds_read_b64_tr_b16 a[210:211], v243 offset:38912
  v_mfma_f32_16x16x32_bf16 v[56:59], a[180:183], a[56:59], v[56:59]
  buffer_load_dwordx4 a[108:111], v137, s[36:39], s51 offen offset:3072 sc1
  s_mov_b32 s81, 28
  v_mfma_f32_16x16x32_bf16 v[56:59], a[176:179], a[48:51], v[56:59]
  s_waitcnt lgkmcnt(10)
  s_lshl_b32 s50, s81, 16
  s_add_u32 s50, s50, s88
  v_mfma_f32_16x16x32_bf16 v[144:147], a[184:187], a[48:51], v[144:147]
  s_add_u32 m0, s70, 98304
  ds_read_b64_tr_b16 a[212:213], v243 offset:43008
  ds_read_b64_tr_b16 a[214:215], v243 offset:47104
  v_mfma_f32_16x16x32_bf16 v[144:147], a[188:191], a[56:59], v[144:147]
  ds_read_b64_tr_b16 a[176:177], v240 offset:49152
  ds_read_b64_tr_b16 a[178:179], v240 offset:53248
  v_mfma_f32_16x16x32_bf16 v[148:151], a[188:191], a[60:63], v[148:151]
  buffer_load_dwordx4 v133, s[24:27], s50 offen offset:0 lds
  s_lshl_b32 s51, s81, 11
  v_mfma_f32_16x16x32_bf16 v[148:151], a[184:187], a[52:55], v[148:151]
  s_waitcnt lgkmcnt(10)
  ds_read_b64_tr_b16 a[180:181], v240 offset:57344
  ds_read_b64_tr_b16 a[182:183], v240 offset:61440
  v_mfma_f32_16x16x32_bf16 v[156:159], a[192:195], a[52:55], v[156:159]
  ds_read_b64_tr_b16 a[184:185], v241 offset:49152
  v_mfma_f32_16x16x32_bf16 v[156:159], a[196:199], a[60:63], v[156:159]
  ds_read_b64_tr_b16 a[186:187], v241 offset:53248
  v_mfma_f32_16x16x32_bf16 v[152:155], a[196:199], a[56:59], v[152:155]
  s_add_u32 s76, s70, 16384
  buffer_load_dwordx4 a[112:115], v137, s[36:39], s51 offen offset:0 sc1
  ds_read_b64_tr_b16 a[188:189], v241 offset:57344
  v_mfma_f32_16x16x32_bf16 v[152:155], a[192:195], a[48:51], v[152:155]
  s_waitcnt lgkmcnt(11)
  ds_read_b64_tr_b16 a[190:191], v241 offset:61440
  v_and_b32 v129, 15, v128
  v_mfma_f32_16x16x32_bf16 v[160:163], a[200:203], a[48:51], v[160:163]
  ds_read_b64_tr_b16 a[192:193], v242 offset:49152
  v_lshrrev_b32 v131, 1, v129
  v_mfma_f32_16x16x32_bf16 v[160:163], a[204:207], a[56:59], v[160:163]
  buffer_load_dwordx4 v134, s[24:27], s50 offen offset:1024 lds
  ds_read_b64_tr_b16 a[194:195], v242 offset:53248
  v_mfma_f32_16x16x32_bf16 v[164:167], a[204:207], a[60:63], v[164:167]
  ds_read_b64_tr_b16 a[196:197], v242 offset:57344
  v_lshrrev_b32 v130, 5, v128
  v_mfma_f32_16x16x32_bf16 v[164:167], a[200:203], a[52:55], v[164:167]
  s_waitcnt lgkmcnt(11)
  ds_read_b64_tr_b16 a[198:199], v242 offset:61440
  v_xor_b32 v131, v131, v130
  v_mfma_f32_16x16x32_bf16 v[172:175], a[208:211], a[52:55], v[172:175]
  ds_read_b64_tr_b16 a[200:201], v243 offset:49152
  v_lshlrev_b32 v131, 4, v131
  v_mfma_f32_16x16x32_bf16 v[172:175], a[212:215], a[60:63], v[172:175]
  buffer_load_dwordx4 a[116:119], v137, s[36:39], s51 offen offset:1024 sc1
  ds_read_b64_tr_b16 a[202:203], v243 offset:53248
  v_mfma_f32_16x16x32_bf16 v[168:171], a[212:215], a[56:59], v[168:171]
  ds_read_b64_tr_b16 a[204:205], v243 offset:57344
  v_lshl_add_u32 v131, v129, 7, v131
  v_mfma_f32_16x16x32_bf16 v[168:171], a[208:211], a[48:51], v[168:171]
  s_waitcnt vmcnt(21) lgkmcnt(11)
  ds_read_b64_tr_b16 a[206:207], v243 offset:61440
  v_bfe_u32 v130, v128, 4, 1
  v_mfma_f32_16x16x32_bf16 v[32:35], a[176:179], a[64:67], v[32:35]
  ds_read_b64_tr_b16 a[208:209], v240 offset:51200
  v_lshl_add_u32 v131, v130, 3, v131
  v_mfma_f32_16x16x32_bf16 v[32:35], a[180:183], a[72:75], v[32:35]
  buffer_load_dwordx4 v135, s[24:27], s50 offen offset:2048 lds
  s_add_u32 s51, s51, 6144
  v_mfma_f32_16x16x32_bf16 v[36:39], a[180:183], a[76:79], v[36:39]
  ds_read_b64_tr_b16 a[210:211], v240 offset:55296
  ds_read_b64_tr_b16 a[212:213], v240 offset:59392
  v_mfma_f32_16x16x32_bf16 v[36:39], a[176:179], a[68:71], v[36:39]
  s_waitcnt lgkmcnt(11)
  ds_read_b64_tr_b16 a[214:215], v240 offset:63488
  v_add_u32 v140, s76, v131
  v_mfma_f32_16x16x32_bf16 v[44:47], a[184:187], a[68:71], v[44:47]
  ds_read_b64_tr_b16 a[176:177], v241 offset:51200
  v_xor_b32 v141, 32, v140
  v_mfma_f32_16x16x32_bf16 v[44:47], a[188:191], a[76:79], v[44:47]
  buffer_load_dwordx4 a[120:123], v137, s[36:39], s51 offen offset:2048 sc1
  ds_read_b64_tr_b16 a[178:179], v241 offset:55296
  v_mfma_f32_16x16x32_bf16 v[40:43], a[188:191], a[72:75], v[40:43]
  ds_read_b64_tr_b16 a[180:181], v241 offset:59392
  v_xor_b32 v142, 64, v140
  v_mfma_f32_16x16x32_bf16 v[40:43], a[184:187], a[64:67], v[40:43]
  s_waitcnt vmcnt(15) lgkmcnt(11)
  s_barrier
  ds_read_b64_tr_b16 a[182:183], v241 offset:63488
  v_mfma_f32_16x16x32_bf16 v[48:51], a[192:195], a[64:67], v[48:51]
  ds_read_b64_tr_b16 a[184:185], v242 offset:51200
  v_xor_b32 v143, 96, v140
  v_mfma_f32_16x16x32_bf16 v[48:51], a[196:199], a[72:75], v[48:51]
  buffer_load_dwordx4 v136, s[24:27], s50 offen offset:3072 lds
  ds_read_b64_tr_b16 a[186:187], v242 offset:55296
  v_mfma_f32_16x16x32_bf16 v[52:55], a[196:199], a[76:79], v[52:55]
  ds_read_b64_tr_b16 a[188:189], v242 offset:59392
  v_add_u32 v254, s76, v0
  v_mfma_f32_16x16x32_bf16 v[52:55], a[192:195], a[68:71], v[52:55]
  s_waitcnt lgkmcnt(11)
  ds_read_b64_tr_b16 a[190:191], v242 offset:63488
  s_lshl_b32 s76, s44, 10
  v_mfma_f32_16x16x32_bf16 v[60:63], a[200:203], a[68:71], v[60:63]
  s_add_u32 s76, s76, 151552
  buffer_load_dwordx4 a[124:127], v137, s[36:39], s51 offen offset:3072 sc1
  s_cmp_eq_u32 s87, 1
  v_mfma_f32_16x16x32_bf16 v[60:63], a[204:207], a[76:79], v[60:63]
  s_cselect_b32 s86, 7, 35
  s_lshl_b32 s50, s86, 16
  s_add_u32 s50, s50, s88
  v_mfma_f32_16x16x32_bf16 v[56:59], a[204:207], a[72:75], v[56:59]
  s_add_u32 m0, s70, 114688
  ds_read_b64_tr_b16 a[192:193], v243 offset:51200
  ds_read_b64_tr_b16 a[194:195], v243 offset:55296
  v_mfma_f32_16x16x32_bf16 v[56:59], a[200:203], a[64:67], v[56:59]
  s_waitcnt lgkmcnt(10)
  ds_read_b64_tr_b16 a[196:197], v243 offset:59392
  ds_read_b64_tr_b16 a[198:199], v243 offset:63488
  v_mfma_f32_16x16x32_bf16 v[144:147], a[208:211], a[64:67], v[144:147]
  buffer_load_dwordx4 v133, s[24:27], s50 offen offset:0 lds
  s_lshl_b32 s51, s86, 11
  v_mfma_f32_16x16x32_bf16 v[144:147], a[212:215], a[72:75], v[144:147]
  ds_read_b64_tr_b16 a[200:201], v244 offset:0
  ds_read_b64_tr_b16 a[202:203], v244 offset:4096
  v_mfma_f32_16x16x32_bf16 v[148:151], a[212:215], a[76:79], v[148:151]
  ds_read_b64_tr_b16 a[204:205], v244 offset:8192
  v_add_u32 v129, s76, v0
  v_mfma_f32_16x16x32_bf16 v[148:151], a[208:211], a[68:71], v[148:151]
  s_waitcnt lgkmcnt(11)
  ds_read_b64_tr_b16 a[206:207], v244 offset:12288
  v_lshrrev_b32 v130, 4, v128
  v_mfma_f32_16x16x32_bf16 v[156:159], a[176:179], a[68:71], v[156:159]
  buffer_load_dwordx4 a[216:219], v137, s[36:39], s51 offen offset:0 sc1
  ds_read_b64_tr_b16 a[208:209], v245 offset:0
  v_mfma_f32_16x16x32_bf16 v[156:159], a[180:183], a[76:79], v[156:159]
  ds_read_b64_tr_b16 a[210:211], v245 offset:4096
  v_lshl_add_u32 v130, v130, 4, s76
  v_mfma_f32_16x16x32_bf16 v[152:155], a[180:183], a[72:75], v[152:155]
  ds_read_b64_tr_b16 a[212:213], v245 offset:8192
  ds_write_b128 v129, a[248:251]
  v_mfma_f32_16x16x32_bf16 v[152:155], a[176:179], a[64:67], v[152:155]
  s_waitcnt lgkmcnt(12)
  ds_read_b64_tr_b16 a[214:215], v245 offset:12288
  ds_read_b128 v[176:179], v130 offset:768
  v_mfma_f32_16x16x32_bf16 v[160:163], a[184:187], a[64:67], v[160:163]
  buffer_load_dwordx4 v134, s[24:27], s50 offen offset:1024 lds
  ds_read_b64_tr_b16 a[176:177], v246 offset:0
  v_mfma_f32_16x16x32_bf16 v[160:163], a[188:191], a[72:75], v[160:163]
  ds_read_b64_tr_b16 a[178:179], v246 offset:4096
  ds_read_b128 v[180:183], v130 offset:832
  v_mfma_f32_16x16x32_bf16 v[164:167], a[188:191], a[76:79], v[164:167]
  ds_read_b64_tr_b16 a[180:181], v246 offset:8192
  ds_read_b128 v[184:187], v130 offset:896
  v_mfma_f32_16x16x32_bf16 v[164:167], a[184:187], a[68:71], v[164:167]
  s_waitcnt lgkmcnt(15)
  ds_read_b64_tr_b16 a[182:183], v246 offset:12288
  ds_read_b128 v[188:191], v130 offset:960
  v_mfma_f32_16x16x32_bf16 v[172:175], a[192:195], a[68:71], v[172:175]
  buffer_load_dwordx4 a[220:223], v137, s[36:39], s51 offen offset:1024 sc1
  ds_read_b64_tr_b16 a[184:185], v247 offset:0
  v_mfma_f32_16x16x32_bf16 v[172:175], a[196:199], a[76:79], v[172:175]
  ds_read_b64_tr_b16 a[186:187], v247 offset:4096
  v_accvgpr_read_b32 v131, a232
  v_mfma_f32_16x16x32_bf16 v[168:171], a[196:199], a[72:75], v[168:171]
  ds_read_b64_tr_b16 a[188:189], v247 offset:8192
  v_lshlrev_b32 v64, 16, v131
  v_mfma_f32_16x16x32_bf16 v[168:171], a[192:195], a[64:67], v[168:171]
  s_waitcnt vmcnt(20) lgkmcnt(15)
  buffer_load_dwordx4 v135, s[24:27], s50 offen offset:2048 lds
  s_add_u32 s51, s51, 6144
  v_mfma_f32_16x16x32_bf16 v[32:35], a[200:203], a[80:83], v[32:35]
  ds_read_b64_tr_b16 a[190:191], v247 offset:12288
  ds_read_b64_tr_b16 a[192:193], v244 offset:2048
  v_mfma_f32_16x16x32_bf16 v[32:35], a[204:207], a[88:91], v[32:35]
  ds_read_b64_tr_b16 a[194:195], v244 offset:6144
  v_and_b32 v65, 0xffff0000, v131
  v_mfma_f32_16x16x32_bf16 v[36:39], a[204:207], a[92:95], v[36:39]
  ds_read_b64_tr_b16 a[196:197], v244 offset:10240
  v_accvgpr_read_b32 v131, a233
  v_mfma_f32_16x16x32_bf16 v[36:39], a[200:203], a[84:87], v[36:39]
  s_waitcnt lgkmcnt(15)
  buffer_load_dwordx4 a[224:227], v137, s[36:39], s51 offen offset:2048 sc1
  ds_read_b64_tr_b16 a[198:199], v244 offset:14336
  v_mfma_f32_16x16x32_bf16 v[44:47], a[208:211], a[84:87], v[44:47]
  ds_read_b64_tr_b16 a[200:201], v245 offset:2048
  v_lshlrev_b32 v66, 16, v131
  v_mfma_f32_16x16x32_bf16 v[44:47], a[212:215], a[92:95], v[44:47]
  ds_read_b64_tr_b16 a[202:203], v245 offset:6144
  v_and_b32 v67, 0xffff0000, v131
  v_mfma_f32_16x16x32_bf16 v[40:43], a[212:215], a[88:91], v[40:43]
  ds_read_b64_tr_b16 a[204:205], v245 offset:10240
  v_accvgpr_read_b32 v131, a234
  v_mfma_f32_16x16x32_bf16 v[40:43], a[208:211], a[80:83], v[40:43]
  s_waitcnt vmcnt(15) lgkmcnt(12)
  s_barrier
  buffer_load_dwordx4 v136, s[24:27], s50 offen offset:3072 lds
  v_mfma_f32_16x16x32_bf16 v[48:51], a[176:179], a[80:83], v[48:51]
  ds_read_b64_tr_b16 a[206:207], v245 offset:14336
  ds_read_b64_tr_b16 a[208:209], v246 offset:2048
  v_mfma_f32_16x16x32_bf16 v[48:51], a[180:183], a[88:91], v[48:51]
  ds_read_b64_tr_b16 a[210:211], v246 offset:6144
  v_lshlrev_b32 v68, 16, v131
  v_mfma_f32_16x16x32_bf16 v[52:55], a[180:183], a[92:95], v[52:55]
  ds_read_b64_tr_b16 a[212:213], v246 offset:10240
  v_and_b32 v69, 0xffff0000, v131
  v_mfma_f32_16x16x32_bf16 v[52:55], a[176:179], a[84:87], v[52:55]
  s_waitcnt lgkmcnt(11)
  buffer_load_dwordx4 a[228:231], v137, s[36:39], s51 offen offset:3072 sc1
  s_cmp_eq_u32 s87, 2
  v_mfma_f32_16x16x32_bf16 v[60:63], a[184:187], a[84:87], v[60:63]
  s_cselect_b32 s69, 14, 42
  s_lshl_b32 s50, s69, 16
  s_add_u32 s50, s50, s88
  v_mfma_f32_16x16x32_bf16 v[60:63], a[188:191], a[92:95], v[60:63]
  s_add_u32 m0, s70, 131072
  ds_read_b64_tr_b16 a[214:215], v246 offset:14336
  ds_read_b64_tr_b16 a[176:177], v247 offset:2048
  v_mfma_f32_16x16x32_bf16 v[56:59], a[188:191], a[88:91], v[56:59]
  ds_read_b64_tr_b16 a[178:179], v247 offset:6144
  ds_read_b64_tr_b16 a[180:181], v247 offset:10240
  v_mfma_f32_16x16x32_bf16 v[56:59], a[184:187], a[80:83], v[56:59]
  s_waitcnt lgkmcnt(11)
  buffer_load_dwordx4 v133, s[24:27], s50 offen offset:0 lds
  s_lshl_b32 s51, s69, 11
  v_mfma_f32_16x16x32_bf16 v[144:147], a[192:195], a[80:83], v[144:147]
  ds_read_b64_tr_b16 a[182:183], v247 offset:14336
  ds_read_b64_tr_b16 a[184:185], v244 offset:16384
  v_mfma_f32_16x16x32_bf16 v[144:147], a[196:199], a[88:91], v[144:147]
  ds_read_b64_tr_b16 a[186:187], v244 offset:20480
  v_accvgpr_read_b32 v131, a235
  v_mfma_f32_16x16x32_bf16 v[148:151], a[196:199], a[92:95], v[148:151]
  buffer_load_dwordx4 a[0:3], v137, s[36:39], s51 offen offset:0 sc1
  ds_read_b64_tr_b16 a[188:189], v244 offset:24576
  v_mfma_f32_16x16x32_bf16 v[148:151], a[192:195], a[84:87], v[148:151]
  s_waitcnt lgkmcnt(11)
  ds_read_b64_tr_b16 a[190:191], v244 offset:28672
  v_lshlrev_b32 v70, 16, v131
  v_mfma_f32_16x16x32_bf16 v[156:159], a[200:203], a[84:87], v[156:159]
  ds_read_b64_tr_b16 a[192:193], v245 offset:16384
  v_and_b32 v71, 0xffff0000, v131
  v_mfma_f32_16x16x32_bf16 v[156:159], a[204:207], a[92:95], v[156:159]
  ds_read_b64_tr_b16 a[194:195], v245 offset:20480
  v_accvgpr_read_b32 v131, a236
  v_mfma_f32_16x16x32_bf16 v[152:155], a[204:207], a[88:91], v[152:155]
  buffer_load_dwordx4 v134, s[24:27], s50 offen offset:1024 lds
  ds_read_b64_tr_b16 a[196:197], v245 offset:24576
  v_mfma_f32_16x16x32_bf16 v[152:155], a[200:203], a[80:83], v[152:155]
  s_waitcnt lgkmcnt(11)
  ds_read_b64_tr_b16 a[198:199], v245 offset:28672
  v_lshlrev_b32 v72, 16, v131
  v_mfma_f32_16x16x32_bf16 v[160:163], a[208:211], a[80:83], v[160:163]
  ds_read_b64_tr_b16 a[200:201], v246 offset:16384
  v_and_b32 v73, 0xffff0000, v131
  v_mfma_f32_16x16x32_bf16 v[160:163], a[212:215], a[88:91], v[160:163]
  ds_read_b64_tr_b16 a[202:203], v246 offset:20480
  v_accvgpr_read_b32 v131, a237
  v_mfma_f32_16x16x32_bf16 v[164:167], a[212:215], a[92:95], v[164:167]
  buffer_load_dword v139, v138, s[36:39], s91 offen sc1
  ds_read_b64_tr_b16 a[204:205], v246 offset:24576
  v_mfma_f32_16x16x32_bf16 v[164:167], a[208:211], a[84:87], v[164:167]
  s_waitcnt lgkmcnt(11)
  ds_read_b64_tr_b16 a[206:207], v246 offset:28672
  v_lshlrev_b32 v74, 16, v131
  v_mfma_f32_16x16x32_bf16 v[172:175], a[176:179], a[84:87], v[172:175]
  ds_read_b64_tr_b16 a[208:209], v247 offset:16384
  v_and_b32 v75, 0xffff0000, v131
  v_mfma_f32_16x16x32_bf16 v[172:175], a[180:183], a[92:95], v[172:175]
  buffer_load_dwordx4 a[4:7], v137, s[36:39], s51 offen offset:1024 sc1
  ds_read_b64_tr_b16 a[210:211], v247 offset:20480
  v_mfma_f32_16x16x32_bf16 v[168:171], a[180:183], a[88:91], v[168:171]
  ds_read_b64_tr_b16 a[212:213], v247 offset:24576
  v_accvgpr_read_b32 v131, a238
  v_mfma_f32_16x16x32_bf16 v[168:171], a[176:179], a[80:83], v[168:171]
  s_waitcnt vmcnt(21) lgkmcnt(11)
  ds_read_b64_tr_b16 a[214:215], v247 offset:28672
  v_lshlrev_b32 v76, 16, v131
  v_mfma_f32_16x16x32_bf16 v[32:35], a[184:187], a[96:99], v[32:35]
  buffer_load_dwordx4 v135, s[24:27], s50 offen offset:2048 lds
  s_add_u32 s51, s51, 6144
  v_mfma_f32_16x16x32_bf16 v[32:35], a[188:191], a[104:107], v[32:35]
  ds_read_b64_tr_b16 a[176:177], v244 offset:18432
  ds_read_b64_tr_b16 a[178:179], v244 offset:22528
  v_mfma_f32_16x16x32_bf16 v[36:39], a[188:191], a[108:111], v[36:39]
  ds_read_b64_tr_b16 a[180:181], v244 offset:26624
  v_and_b32 v77, 0xffff0000, v131
  v_mfma_f32_16x16x32_bf16 v[36:39], a[184:187], a[100:103], v[36:39]
  s_waitcnt lgkmcnt(11)
  buffer_load_dwordx4 a[8:11], v137, s[36:39], s51 offen offset:2048 sc1
  ds_read_b64_tr_b16 a[182:183], v244 offset:30720
  v_mfma_f32_16x16x32_bf16 v[44:47], a[192:195], a[100:103], v[44:47]
  ds_read_b64_tr_b16 a[184:185], v245 offset:18432
  v_accvgpr_read_b32 v131, a239
  v_mfma_f32_16x16x32_bf16 v[44:47], a[196:199], a[108:111], v[44:47]
  ds_read_b64_tr_b16 a[186:187], v245 offset:22528
  v_lshlrev_b32 v78, 16, v131
  v_mfma_f32_16x16x32_bf16 v[40:43], a[196:199], a[104:107], v[40:43]
  buffer_load_dwordx4 v136, s[24:27], s50 offen offset:3072 lds
  ds_read_b64_tr_b16 a[188:189], v245 offset:26624
  v_mfma_f32_16x16x32_bf16 v[40:43], a[192:195], a[96:99], v[40:43]
  s_waitcnt vmcnt(17) lgkmcnt(11)
  s_barrier
  ds_read_b64_tr_b16 a[190:191], v245 offset:30720
  v_mfma_f32_16x16x32_bf16 v[48:51], a[200:203], a[96:99], v[48:51]
  ds_read_b64_tr_b16 a[192:193], v246 offset:18432
  v_and_b32 v79, 0xffff0000, v131
  v_mfma_f32_16x16x32_bf16 v[48:51], a[204:207], a[104:107], v[48:51]
  buffer_load_dwordx4 a[12:15], v137, s[36:39], s51 offen offset:3072 sc1
  s_cmp_eq_u32 s87, 3
  v_mfma_f32_16x16x32_bf16 v[52:55], a[204:207], a[108:111], v[52:55]
  s_cselect_b32 s71, 21, 49
  s_lshl_b32 s50, s71, 16
  s_add_u32 s50, s50, s88
  v_mfma_f32_16x16x32_bf16 v[52:55], a[200:203], a[100:103], v[52:55]
  s_waitcnt lgkmcnt(9)
  s_add_u32 m0, s70, 0
  ds_read_b64_tr_b16 a[194:195], v246 offset:22528
  v_mfma_f32_16x16x32_bf16 v[60:63], a[208:211], a[100:103], v[60:63]
  ds_read_b64_tr_b16 a[196:197], v246 offset:26624
  ds_read_b64_tr_b16 a[198:199], v246 offset:30720
  v_mfma_f32_16x16x32_bf16 v[60:63], a[212:215], a[108:111], v[60:63]
  ds_read_b64_tr_b16 a[200:201], v247 offset:18432
  buffer_load_dwordx4 v133, s[24:27], s50 offen offset:0 lds
  v_mfma_f32_16x16x32_bf16 v[56:59], a[212:215], a[104:107], v[56:59]
  s_lshl_b32 s51, s71, 11
  ds_read_b64_tr_b16 a[202:203], v247 offset:22528
  ds_read_b64_tr_b16 a[204:205], v247 offset:26624
  v_mfma_f32_16x16x32_bf16 v[56:59], a[208:211], a[96:99], v[56:59]
  s_waitcnt lgkmcnt(11)
  ds_read_b64_tr_b16 a[206:207], v247 offset:30720
  v_accvgpr_read_b32 v131, a240
  v_mfma_f32_16x16x32_bf16 v[144:147], a[176:179], a[96:99], v[144:147]
  ds_read_b64_tr_b16 a[208:209], v244 offset:32768
  v_lshlrev_b32 v80, 16, v131
  v_mfma_f32_16x16x32_bf16 v[144:147], a[180:183], a[104:107], v[144:147]
  buffer_load_dwordx4 a[16:19], v137, s[36:39], s51 offen offset:0 sc1
  ds_read_b64_tr_b16 a[210:211], v244 offset:36864
  v_mfma_f32_16x16x32_bf16 v[148:151], a[180:183], a[108:111], v[148:151]
  ds_read_b64_tr_b16 a[212:213], v244 offset:40960
  v_and_b32 v81, 0xffff0000, v131
  v_mfma_f32_16x16x32_bf16 v[148:151], a[176:179], a[100:103], v[148:151]
  s_waitcnt lgkmcnt(11)
  ds_read_b64_tr_b16 a[214:215], v244 offset:45056
  v_accvgpr_read_b32 v131, a241
  v_mfma_f32_16x16x32_bf16 v[156:159], a[184:187], a[100:103], v[156:159]
  ds_read_b64_tr_b16 a[176:177], v245 offset:32768
  v_lshlrev_b32 v82, 16, v131
  v_mfma_f32_16x16x32_bf16 v[156:159], a[188:191], a[108:111], v[156:159]
  buffer_load_dwordx4 v134, s[24:27], s50 offen offset:1024 lds
  ds_read_b64_tr_b16 a[178:179], v245 offset:36864
  v_mfma_f32_16x16x32_bf16 v[152:155], a[188:191], a[104:107], v[152:155]
  ds_read_b64_tr_b16 a[180:181], v245 offset:40960
  v_and_b32 v83, 0xffff0000, v131
  v_mfma_f32_16x16x32_bf16 v[152:155], a[184:187], a[96:99], v[152:155]
  s_waitcnt lgkmcnt(11)
  ds_read_b64_tr_b16 a[182:183], v245 offset:45056
  v_accvgpr_read_b32 v131, a242
  v_mfma_f32_16x16x32_bf16 v[160:163], a[192:195], a[96:99], v[160:163]
  buffer_load_dwordx4 a[20:23], v137, s[36:39], s51 offen offset:1024 sc1
  ds_read_b64_tr_b16 a[184:185], v246 offset:32768
  v_mfma_f32_16x16x32_bf16 v[160:163], a[196:199], a[104:107], v[160:163]
  ds_read_b64_tr_b16 a[186:187], v246 offset:36864
  v_lshlrev_b32 v84, 16, v131
  v_mfma_f32_16x16x32_bf16 v[164:167], a[196:199], a[108:111], v[164:167]
  ds_read_b64_tr_b16 a[188:189], v246 offset:40960
  v_and_b32 v85, 0xffff0000, v131
  v_mfma_f32_16x16x32_bf16 v[164:167], a[192:195], a[100:103], v[164:167]
  s_waitcnt lgkmcnt(11)
  ds_read_b64_tr_b16 a[190:191], v246 offset:45056
  v_accvgpr_read_b32 v131, a243
  v_mfma_f32_16x16x32_bf16 v[172:175], a[200:203], a[100:103], v[172:175]
  buffer_load_dwordx4 v135, s[24:27], s50 offen offset:2048 lds
  s_add_u32 s51, s51, 6144
  v_mfma_f32_16x16x32_bf16 v[172:175], a[204:207], a[108:111], v[172:175]
  ds_read_b64_tr_b16 a[192:193], v247 offset:32768
  ds_read_b64_tr_b16 a[194:195], v247 offset:36864
  v_mfma_f32_16x16x32_bf16 v[168:171], a[204:207], a[104:107], v[168:171]
  ds_read_b64_tr_b16 a[196:197], v247 offset:40960
  v_lshlrev_b32 v86, 16, v131
  v_mfma_f32_16x16x32_bf16 v[168:171], a[200:203], a[96:99], v[168:171]
  s_waitcnt vmcnt(22) lgkmcnt(11)
  ds_read_b64_tr_b16 a[198:199], v247 offset:45056
  v_and_b32 v87, 0xffff0000, v131
  v_mfma_f32_16x16x32_bf16 v[32:35], a[208:211], a[112:115], v[32:35]
  buffer_load_dwordx4 a[24:27], v137, s[36:39], s51 offen offset:2048 sc1
  ds_read_b64_tr_b16 a[200:201], v244 offset:34816
  v_mfma_f32_16x16x32_bf16 v[32:35], a[212:215], a[120:123], v[32:35]
  ds_read_b64_tr_b16 a[202:203], v244 offset:38912
  v_accvgpr_read_b32 v131, a244
  v_mfma_f32_16x16x32_bf16 v[36:39], a[212:215], a[124:127], v[36:39]
  ds_read_b64_tr_b16 a[204:205], v244 offset:43008
  v_lshlrev_b32 v88, 16, v131
  v_mfma_f32_16x16x32_bf16 v[36:39], a[208:211], a[116:119], v[36:39]
  s_waitcnt lgkmcnt(11)
  ds_read_b64_tr_b16 a[206:207], v244 offset:47104
  v_and_b32 v89, 0xffff0000, v131
  v_mfma_f32_16x16x32_bf16 v[44:47], a[176:179], a[116:119], v[44:47]
  buffer_load_dwordx4 v136, s[24:27], s50 offen offset:3072 lds
  ds_read_b64_tr_b16 a[208:209], v245 offset:34816
  v_mfma_f32_16x16x32_bf16 v[44:47], a[180:183], a[124:127], v[44:47]
  ds_read_b64_tr_b16 a[210:211], v245 offset:38912
  v_accvgpr_read_b32 v131, a245
  v_mfma_f32_16x16x32_bf16 v[40:43], a[180:183], a[120:123], v[40:43]
  ds_read_b64_tr_b16 a[212:213], v245 offset:43008
  v_lshlrev_b32 v90, 16, v131
  v_mfma_f32_16x16x32_bf16 v[40:43], a[176:179], a[112:115], v[40:43]
  s_waitcnt vmcnt(17) lgkmcnt(11)
  s_barrier
  ds_read_b64_tr_b16 a[214:215], v245 offset:47104
  v_mfma_f32_16x16x32_bf16 v[48:51], a[184:187], a[112:115], v[48:51]
  buffer_load_dwordx4 a[28:31], v137, s[36:39], s51 offen offset:3072 sc1
  s_mov_b32 s72, 1
  v_mfma_f32_16x16x32_bf16 v[48:51], a[188:191], a[120:123], v[48:51]
  s_lshl_b32 s50, s72, 16
  s_add_u32 m0, s70, 16384
  ds_read_b64_tr_b16 a[176:177], v246 offset:34816
  v_mfma_f32_16x16x32_bf16 v[52:55], a[188:191], a[124:127], v[52:55]
  ds_read_b64_tr_b16 a[178:179], v246 offset:38912
  ds_read_b64_tr_b16 a[180:181], v246 offset:43008
  v_mfma_f32_16x16x32_bf16 v[52:55], a[184:187], a[116:119], v[52:55]
  s_waitcnt lgkmcnt(11)
  buffer_load_dwordx4 v133, s[24:27], s50 offen offset:0 lds
  ds_read_b64_tr_b16 a[182:183], v246 offset:47104
  v_mfma_f32_16x16x32_bf16 v[60:63], a[192:195], a[116:119], v[60:63]
  s_waitcnt vmcnt(14)
  v_cmp_ne_u32 vcc, s3, v139
  s_nop 4
  s_cbranch_vccnz CK9s
CK9x:
  v_mfma_f32_16x16x32_bf16 v[60:63], a[196:199], a[124:127], v[60:63]
  s_lshl_b32 s51, s72, 11
  s_add_u32 s91, s91, 32768
  ds_read_b64_tr_b16 a[184:185], v247 offset:34816
  v_mfma_f32_16x16x32_bf16 v[56:59], a[196:199], a[120:123], v[56:59]
  ds_read_b64_tr_b16 a[186:187], v247 offset:38912
  ds_read_b64_tr_b16 a[188:189], v247 offset:43008
  v_mfma_f32_16x16x32_bf16 v[56:59], a[192:195], a[112:115], v[56:59]
  s_waitcnt lgkmcnt(11)
  buffer_load_dwordx4 a[32:35], v137, s[36:39], s51 offen offset:0 sc1
  ds_read_b64_tr_b16 a[190:191], v247 offset:47104
  v_mfma_f32_16x16x32_bf16 v[144:147], a[200:203], a[112:115], v[144:147]
  ds_read_b64_tr_b16 a[192:193], v244 offset:49152
  v_and_b32 v91, 0xffff0000, v131
  v_mfma_f32_16x16x32_bf16 v[144:147], a[204:207], a[120:123], v[144:147]
  ds_read_b64_tr_b16 a[194:195], v244 offset:53248
  v_accvgpr_read_b32 v131, a246
  v_mfma_f32_16x16x32_bf16 v[148:151], a[204:207], a[124:127], v[148:151]
  ds_read_b64_tr_b16 a[196:197], v244 offset:57344
  v_lshlrev_b32 v92, 16, v131
  v_mfma_f32_16x16x32_bf16 v[148:151], a[200:203], a[116:119], v[148:151]
  s_waitcnt lgkmcnt(11)
  buffer_load_dwordx4 v134, s[24:27], s50 offen offset:1024 lds
  ds_read_b64_tr_b16 a[198:199], v244 offset:61440
  v_mfma_f32_16x16x32_bf16 v[156:159], a[208:211], a[116:119], v[156:159]
  ds_read_b64_tr_b16 a[200:201], v245 offset:49152
  v_and_b32 v93, 0xffff0000, v131
  v_mfma_f32_16x16x32_bf16 v[156:159], a[212:215], a[124:127], v[156:159]
  ds_read_b64_tr_b16 a[202:203], v245 offset:53248
  v_accvgpr_read_b32 v131, a247
  v_mfma_f32_16x16x32_bf16 v[152:155], a[212:215], a[120:123], v[152:155]
  ds_read_b64_tr_b16 a[204:205], v245 offset:57344
  v_lshlrev_b32 v94, 16, v131
  v_mfma_f32_16x16x32_bf16 v[152:155], a[208:211], a[112:115], v[152:155]
  s_waitcnt lgkmcnt(11)
  buffer_load_dwordx4 a[36:39], v137, s[36:39], s51 offen offset:1024 sc1
  ds_read_b64_tr_b16 a[206:207], v245 offset:61440
  v_mfma_f32_16x16x32_bf16 v[160:163], a[176:179], a[112:115], v[160:163]
  ds_read_b64_tr_b16 a[208:209], v246 offset:49152
  v_and_b32 v95, 0xffff0000, v131
  v_mfma_f32_16x16x32_bf16 v[160:163], a[180:183], a[120:123], v[160:163]
  s_add_u32 s49, s55, 32768
  ds_read_b64_tr_b16 a[210:211], v246 offset:53248
  s_lshl_b32 s76, s2, 5
  v_mfma_f32_16x16x32_bf16 v[164:167], a[180:183], a[124:127], v[164:167]
  s_add_u32 s76, s76, s44
  ds_read_b64_tr_b16 a[212:213], v246 offset:57344
  s_lshl2_add_u32 s76, s76, 5472256
  v_mfma_f32_16x16x32_bf16 v[164:167], a[176:179], a[116:119], v[164:167]
  s_waitcnt lgkmcnt(11)
  buffer_load_dwordx4 v135, s[24:27], s50 offen offset:2048 lds
  ds_read_b64_tr_b16 a[214:215], v246 offset:61440
  v_mfma_f32_16x16x32_bf16 v[172:175], a[184:187], a[116:119], v[172:175]
  s_xor_b32 s77, s76, 128
  ds_read_b64_tr_b16 a[176:177], v247 offset:49152
  v_mov_b32 v132, 0
  v_mfma_f32_16x16x32_bf16 v[172:175], a[188:191], a[124:127], v[172:175]
  ds_read_b64_tr_b16 a[178:179], v247 offset:53248
  v_mfma_f32_16x16x32_bf16 v[168:171], a[188:191], a[120:123], v[168:171]
  ds_read_b64_tr_b16 a[180:181], v247 offset:57344
  v_mfma_f32_16x16x32_bf16 v[168:171], a[184:187], a[112:115], v[168:171]
  s_waitcnt vmcnt(22) lgkmcnt(11)
  buffer_load_dwordx4 a[40:43], v137, s[36:39], s51 offen offset:2048 sc1
  ds_read_b64_tr_b16 a[182:183], v247 offset:61440
  v_mfma_f32_16x16x32_bf16 v[32:35], a[192:195], a[216:219], v[32:35]
  ds_read_b64_tr_b16 a[184:185], v244 offset:51200
  v_mfma_f32_16x16x32_bf16 v[32:35], a[196:199], a[224:227], v[32:35]
  ds_read_b64_tr_b16 a[186:187], v244 offset:55296
  v_mfma_f32_16x16x32_bf16 v[36:39], a[196:199], a[228:231], v[36:39]
  buffer_load_dwordx4 v136, s[24:27], s50 offen offset:3072 lds
  ds_read_b64_tr_b16 a[188:189], v244 offset:59392
  v_mfma_f32_16x16x32_bf16 v[36:39], a[192:195], a[220:223], v[36:39]
  s_waitcnt lgkmcnt(11)
  ds_read_b64_tr_b16 a[190:191], v244 offset:63488
  v_mfma_f32_16x16x32_bf16 v[44:47], a[200:203], a[220:223], v[44:47]
  ds_read_b64_tr_b16 a[192:193], v245 offset:51200
  v_mfma_f32_16x16x32_bf16 v[44:47], a[204:207], a[228:231], v[44:47]
  ds_read_b64_tr_b16 a[194:195], v245 offset:55296
  v_mfma_f32_16x16x32_bf16 v[40:43], a[204:207], a[224:227], v[40:43]
  buffer_load_dwordx4 a[44:47], v137, s[36:39], s51 offen offset:3072 sc1
  s_cmp_eq_u32 s87, 1
  v_mfma_f32_16x16x32_bf16 v[40:43], a[200:203], a[216:219], v[40:43]
  s_waitcnt vmcnt(17) lgkmcnt(10)
  s_barrier
  s_cselect_b32 s73, 19, 5
  v_mfma_f32_16x16x32_bf16 v[48:51], a[208:211], a[216:219], v[48:51]
  s_lshl_b32 s50, s73, 16
  s_add_u32 m0, s70, 32768
  ds_read_b64_tr_b16 a[196:197], v245 offset:59392
  v_mfma_f32_16x16x32_bf16 v[48:51], a[212:215], a[224:227], v[48:51]
  ds_read_b64_tr_b16 a[198:199], v245 offset:63488
  ds_read_b64_tr_b16 a[200:201], v246 offset:51200
  v_mfma_f32_16x16x32_bf16 v[52:55], a[212:215], a[228:231], v[52:55]
  ds_read_b64_tr_b16 a[202:203], v246 offset:55296
  buffer_load_dwordx4 v133, s[24:27], s50 offen offset:0 lds
  v_mfma_f32_16x16x32_bf16 v[52:55], a[208:211], a[220:223], v[52:55]
  s_waitcnt lgkmcnt(10)
  s_lshl_b32 s51, s73, 11
  ds_read_b64_tr_b16 a[204:205], v246 offset:59392
  v_mfma_f32_16x16x32_bf16 v[60:63], a[176:179], a[220:223], v[60:63]
  ds_read_b64_tr_b16 a[206:207], v246 offset:63488
  ds_read_b64_tr_b16 a[208:209], v247 offset:51200
  v_mfma_f32_16x16x32_bf16 v[60:63], a[180:183], a[228:231], v[60:63]
  ds_read_b64_tr_b16 a[210:211], v247 offset:55296
  v_mfma_f32_16x16x32_bf16 v[56:59], a[180:183], a[224:227], v[56:59]
  buffer_load_dwordx4 a[48:51], v137, s[36:39], s51 offen offset:0 sc1
  ds_read_b64_tr_b16 a[212:213], v247 offset:59392
  v_mfma_f32_16x16x32_bf16 v[56:59], a[176:179], a[216:219], v[56:59]
  s_waitcnt lgkmcnt(11)
  ds_read_b64_tr_b16 a[214:215], v247 offset:63488
  v_mfma_f32_16x16x32_bf16 v[144:147], a[184:187], a[216:219], v[144:147]
  ds_read_b64_tr_b16 a[176:177], v248 offset:0
  v_mfma_f32_16x16x32_bf16 v[144:147], a[188:191], a[224:227], v[144:147]
  ds_read_b64_tr_b16 a[178:179], v248 offset:4096
  v_mfma_f32_16x16x32_bf16 v[148:151], a[188:191], a[228:231], v[148:151]
  buffer_load_dwordx4 v134, s[24:27], s50 offen offset:1024 lds
  ds_read_b64_tr_b16 a[180:181], v248 offset:8192
  v_mfma_f32_16x16x32_bf16 v[148:151], a[184:187], a[220:223], v[148:151]
  s_waitcnt lgkmcnt(11)
  ds_read_b64_tr_b16 a[182:183], v248 offset:12288
  v_mfma_f32_16x16x32_bf16 v[156:159], a[192:195], a[220:223], v[156:159]
Hb0_3:
  s_cbranch_execz Rb
  ds_read_b64_tr_b16 a[184:185], v249 offset:0
  v_mfma_f32_16x16x32_bf16 v[156:159], a[196:199], a[228:231], v[156:159]
  buffer_load_dwordx4 a[52:55], v137, s[36:39], s51 offen offset:1024 sc1
  ds_read_b64_tr_b16 a[186:187], v249 offset:4096
  v_mfma_f32_16x16x32_bf16 v[152:155], a[196:199], a[224:227], v[152:155]
  ds_read_b64_tr_b16 a[188:189], v249 offset:8192
  v_mfma_f32_16x16x32_bf16 v[152:155], a[192:195], a[216:219], v[152:155]
  s_waitcnt lgkmcnt(11)
  ds_read_b64_tr_b16 a[190:191], v249 offset:12288
  v_mfma_f32_16x16x32_bf16 v[160:163], a[200:203], a[216:219], v[160:163]
  ds_read_b64_tr_b16 a[192:193], v250 offset:0
  v_mfma_f32_16x16x32_bf16 v[160:163], a[204:207], a[224:227], v[160:163]
  buffer_load_dwordx4 v135, s[24:27], s50 offen offset:2048 lds
  ds_read_b64_tr_b16 a[194:195], v250 offset:4096
  v_mfma_f32_16x16x32_bf16 v[164:167], a[204:207], a[228:231], v[164:167]
  ds_read_b64_tr_b16 a[196:197], v250 offset:8192
  v_mfma_f32_16x16x32_bf16 v[164:167], a[200:203], a[220:223], v[164:167]
  s_waitcnt lgkmcnt(11)
  ds_read_b64_tr_b16 a[198:199], v250 offset:12288
  v_mfma_f32_16x16x32_bf16 v[172:175], a[208:211], a[220:223], v[172:175]
  ds_read_b64_tr_b16 a[200:201], v251 offset:0
  v_mfma_f32_16x16x32_bf16 v[172:175], a[212:215], a[228:231], v[172:175]
  buffer_load_dwordx4 a[56:59], v137, s[36:39], s51 offen offset:2048 sc1
  ds_read_b64_tr_b16 a[202:203], v251 offset:4096
  v_mfma_f32_16x16x32_bf16 v[168:171], a[212:215], a[224:227], v[168:171]
  ds_read_b64_tr_b16 a[204:205], v251 offset:8192
  v_mfma_f32_16x16x32_bf16 v[168:171], a[208:211], a[216:219], v[168:171]
  s_waitcnt vmcnt(22) lgkmcnt(11)
  ds_read_b64_tr_b16 a[206:207], v251 offset:12288
  v_mfma_f32_16x16x32_bf16 v[32:35], a[176:179], a[0:3], v[32:35]
  ds_read_b64_tr_b16 a[208:209], v248 offset:2048
  v_mfma_f32_16x16x32_bf16 v[32:35], a[180:183], a[8:11], v[32:35]
  buffer_load_dwordx4 v136, s[24:27], s50 offen offset:3072 lds
  ds_read_b64_tr_b16 a[210:211], v248 offset:6144
  v_mfma_f32_16x16x32_bf16 v[36:39], a[180:183], a[12:15], v[36:39]
  ds_read_b64_tr_b16 a[212:213], v248 offset:10240
  v_mfma_f32_16x16x32_bf16 v[36:39], a[176:179], a[4:7], v[36:39]
  s_waitcnt lgkmcnt(11)
  ds_read_b64_tr_b16 a[214:215], v248 offset:14336
  v_mfma_f32_16x16x32_bf16 v[44:47], a[184:187], a[4:7], v[44:47]
  ds_read_b64_tr_b16 a[176:177], v249 offset:2048
  v_mfma_f32_16x16x32_bf16 v[44:47], a[188:191], a[12:15], v[44:47]
  buffer_load_dwordx4 a[60:63], v137, s[36:39], s51 offen offset:3072 sc1
  s_cmp_eq_u32 s87, 2
  v_mfma_f32_16x16x32_bf16 v[40:43], a[188:191], a[8:11], v[40:43]
  s_cselect_b32 s74, 22, 8
  s_lshl_b32 s50, s74, 16
  s_add_u32 m0, s70, 49152
  v_mfma_f32_16x16x32_bf16 v[40:43], a[184:187], a[0:3], v[40:43]
  s_waitcnt vmcnt(17) lgkmcnt(9)
  s_barrier
  ds_read_b64_tr_b16 a[178:179], v249 offset:6144
  v_mfma_f32_16x16x32_bf16 v[48:51], a[192:195], a[0:3], v[48:51]
  ds_read_b64_tr_b16 a[180:181], v249 offset:10240
  ds_read_b64_tr_b16 a[182:183], v249 offset:14336
  v_mfma_f32_16x16x32_bf16 v[48:51], a[196:199], a[8:11], v[48:51]
  buffer_load_dwordx4 v133, s[24:27], s50 offen offset:0 lds
  s_lshl_b32 s51, s74, 11
  v_mfma_f32_16x16x32_bf16 v[52:55], a[196:199], a[12:15], v[52:55]
  ds_read_b64_tr_b16 a[184:185], v250 offset:2048
  ds_read_b64_tr_b16 a[186:187], v250 offset:6144
  v_mfma_f32_16x16x32_bf16 v[52:55], a[192:195], a[4:7], v[52:55]
  s_waitcnt lgkmcnt(10)
  ds_read_b64_tr_b16 a[188:189], v250 offset:10240
  ds_read_b64_tr_b16 a[190:191], v250 offset:14336
  v_mfma_f32_16x16x32_bf16 v[60:63], a[200:203], a[4:7], v[60:63]
  buffer_load_dwordx4 a[64:67], v137, s[36:39], s51 offen offset:0 sc1
  ds_read_b64_tr_b16 a[192:193], v251 offset:2048
  v_mfma_f32_16x16x32_bf16 v[60:63], a[204:207], a[12:15], v[60:63]
  ds_read_b64_tr_b16 a[194:195], v251 offset:6144
  v_mfma_f32_16x16x32_bf16 v[56:59], a[204:207], a[8:11], v[56:59]
  ds_read_b64_tr_b16 a[196:197], v251 offset:10240
  v_mfma_f32_16x16x32_bf16 v[56:59], a[200:203], a[0:3], v[56:59]
  s_waitcnt lgkmcnt(11)
  ds_read_b64_tr_b16 a[198:199], v251 offset:14336
  v_mfma_f32_16x16x32_bf16 v[144:147], a[208:211], a[0:3], v[144:147]
  buffer_load_dwordx4 v134, s[24:27], s50 offen offset:1024 lds
  ds_read_b64_tr_b16 a[200:201], v240 offset:0
  v_mfma_f32_16x16x32_bf16 v[144:147], a[212:215], a[8:11], v[144:147]
  ds_read_b64_tr_b16 a[202:203], v240 offset:4096
  v_mfma_f32_16x16x32_bf16 v[148:151], a[212:215], a[12:15], v[148:151]
  ds_read_b64_tr_b16 a[204:205], v240 offset:8192
  v_mfma_f32_16x16x32_bf16 v[148:151], a[208:211], a[4:7], v[148:151]
  s_waitcnt lgkmcnt(11)
  ds_read_b64_tr_b16 a[206:207], v240 offset:12288
  v_mfma_f32_16x16x32_bf16 v[156:159], a[176:179], a[4:7], v[156:159]
  buffer_load_dwordx4 a[68:71], v137, s[36:39], s51 offen offset:1024 sc1
  ds_read_b64_tr_b16 a[208:209], v241 offset:0
  v_mfma_f32_16x16x32_bf16 v[156:159], a[180:183], a[12:15], v[156:159]
  ds_read_b64_tr_b16 a[210:211], v241 offset:4096
  v_mfma_f32_16x16x32_bf16 v[152:155], a[180:183], a[8:11], v[152:155]
  ds_read_b64_tr_b16 a[212:213], v241 offset:8192
  v_mfma_f32_16x16x32_bf16 v[152:155], a[176:179], a[0:3], v[152:155]
  s_waitcnt lgkmcnt(11)
  ds_read_b64_tr_b16 a[214:215], v241 offset:12288
  v_mfma_f32_16x16x32_bf16 v[160:163], a[184:187], a[0:3], v[160:163]
  buffer_load_dwordx4 v135, s[24:27], s50 offen offset:2048 lds
  ds_read_b64_tr_b16 a[176:177], v242 offset:0
  v_mfma_f32_16x16x32_bf16 v[160:163], a[188:191], a[8:11], v[160:163]
  ds_read_b64_tr_b16 a[178:179], v242 offset:4096
  v_mfma_f32_16x16x32_bf16 v[164:167], a[188:191], a[12:15], v[164:167]
  ds_read_b64_tr_b16 a[180:181], v242 offset:8192
  v_mfma_f32_16x16x32_bf16 v[164:167], a[184:187], a[4:7], v[164:167]
  s_waitcnt lgkmcnt(11)
  buffer_load_dwordx4 a[72:75], v137, s[36:39], s51 offen offset:2048 sc1
  ds_read_b64_tr_b16 a[182:183], v242 offset:12288
  v_mfma_f32_16x16x32_bf16 v[172:175], a[192:195], a[4:7], v[172:175]
  ds_read_b64_tr_b16 a[184:185], v243 offset:0
  v_mfma_f32_16x16x32_bf16 v[172:175], a[196:199], a[12:15], v[172:175]
  ds_read_b64_tr_b16 a[186:187], v243 offset:4096
  v_mfma_f32_16x16x32_bf16 v[168:171], a[196:199], a[8:11], v[168:171]
  ds_read_b64_tr_b16 a[188:189], v243 offset:8192
  v_mfma_f32_16x16x32_bf16 v[168:171], a[192:195], a[0:3], v[168:171]
  s_waitcnt vmcnt(22) lgkmcnt(11)
  buffer_load_dwordx4 v136, s[24:27], s50 offen offset:3072 lds
  ds_read_b64_tr_b16 a[190:191], v243 offset:12288
  v_mfma_f32_16x16x32_bf16 v[32:35], a[200:203], a[16:19], v[32:35]
  ds_read_b64_tr_b16 a[192:193], v240 offset:2048
  v_mfma_f32_16x16x32_bf16 v[32:35], a[204:207], a[24:27], v[32:35]
  ds_read_b64_tr_b16 a[194:195], v240 offset:6144
  v_mfma_f32_16x16x32_bf16 v[36:39], a[204:207], a[28:31], v[36:39]
  ds_read_b64_tr_b16 a[196:197], v240 offset:10240
  v_mfma_f32_16x16x32_bf16 v[36:39], a[200:203], a[20:23], v[36:39]
  s_waitcnt lgkmcnt(11)
  buffer_load_dwordx4 a[76:79], v137, s[36:39], s51 offen offset:3072 sc1
  s_cmp_eq_u32 s87, 3
  v_mfma_f32_16x16x32_bf16 v[44:47], a[208:211], a[20:23], v[44:47]
  s_cselect_b32 s75, 26, 12
  s_lshl_b32 s50, s75, 16
  s_add_u32 m0, s70, 65536
  v_mfma_f32_16x16x32_bf16 v[44:47], a[212:215], a[28:31], v[44:47]
  ds_read_b64_tr_b16 a[198:199], v240 offset:14336
  ds_read_b64_tr_b16 a[200:201], v241 offset:2048
  v_mfma_f32_16x16x32_bf16 v[40:43], a[212:215], a[24:27], v[40:43]
  ds_read_b64_tr_b16 a[202:203], v241 offset:6144
  ds_read_b64_tr_b16 a[204:205], v241 offset:10240
  v_mfma_f32_16x16x32_bf16 v[40:43], a[208:211], a[16:19], v[40:43]
  s_waitcnt vmcnt(17) lgkmcnt(11)
  s_barrier
  buffer_load_dwordx4 v133, s[24:27], s50 offen offset:0 lds
  v_mfma_f32_16x16x32_bf16 v[48:51], a[176:179], a[16:19], v[48:51]
  s_lshl_b32 s51, s75, 11
  ds_read_b64_tr_b16 a[206:207], v241 offset:14336
  ds_read_b64_tr_b16 a[208:209], v242 offset:2048
  v_mfma_f32_16x16x32_bf16 v[48:51], a[180:183], a[24:27], v[48:51]
  ds_read_b64_tr_b16 a[210:211], v242 offset:6144
  v_mfma_f32_16x16x32_bf16 v[52:55], a[180:183], a[28:31], v[52:55]
  ds_read_b64_tr_b16 a[212:213], v242 offset:10240
  v_mfma_f32_16x16x32_bf16 v[52:55], a[176:179], a[20:23], v[52:55]
  s_waitcnt lgkmcnt(11)
  buffer_load_dwordx4 a[80:83], v137, s[36:39], s51 offen offset:0 sc1
  ds_read_b64_tr_b16 a[214:215], v242 offset:14336
  v_mfma_f32_16x16x32_bf16 v[60:63], a[184:187], a[20:23], v[60:63]
  ds_read_b64_tr_b16 a[176:177], v243 offset:2048
  v_mfma_f32_16x16x32_bf16 v[60:63], a[188:191], a[28:31], v[60:63]
  ds_read_b64_tr_b16 a[178:179], v243 offset:6144
  v_mfma_f32_16x16x32_bf16 v[56:59], a[188:191], a[24:27], v[56:59]
  buffer_load_dwordx4 v134, s[24:27], s50 offen offset:1024 lds
  ds_read_b64_tr_b16 a[180:181], v243 offset:10240
  v_mfma_f32_16x16x32_bf16 v[56:59], a[184:187], a[16:19], v[56:59]
  s_waitcnt lgkmcnt(11)
  ds_read_b64_tr_b16 a[182:183], v243 offset:14336
  v_mfma_f32_16x16x32_bf16 v[144:147], a[192:195], a[16:19], v[144:147]
  ds_read_b64_tr_b16 a[184:185], v240 offset:16384
  v_mfma_f32_16x16x32_bf16 v[144:147], a[196:199], a[24:27], v[144:147]
  ds_read_b64_tr_b16 a[186:187], v240 offset:20480
  v_mfma_f32_16x16x32_bf16 v[148:151], a[196:199], a[28:31], v[148:151]
  buffer_load_dwordx4 a[84:87], v137, s[36:39], s51 offen offset:1024 sc1
  ds_read_b64_tr_b16 a[188:189], v240 offset:24576
  v_mfma_f32_16x16x32_bf16 v[148:151], a[192:195], a[20:23], v[148:151]
  s_waitcnt lgkmcnt(11)
  ds_read_b64_tr_b16 a[190:191], v240 offset:28672
  v_mfma_f32_16x16x32_bf16 v[156:159], a[200:203], a[20:23], v[156:159]
  ds_read_b64_tr_b16 a[192:193], v241 offset:16384
  v_mfma_f32_16x16x32_bf16 v[156:159], a[204:207], a[28:31], v[156:159]
  ds_read_b64_tr_b16 a[194:195], v241 offset:20480
  v_mfma_f32_16x16x32_bf16 v[152:155], a[204:207], a[24:27], v[152:155]
  buffer_load_dwordx4 v135, s[24:27], s50 offen offset:2048 lds
  ds_read_b64_tr_b16 a[196:197], v241 offset:24576
  v_mfma_f32_16x16x32_bf16 v[152:155], a[200:203], a[16:19], v[152:155]
  s_waitcnt lgkmcnt(11)
  ds_read_b64_tr_b16 a[198:199], v241 offset:28672
  v_mfma_f32_16x16x32_bf16 v[160:163], a[208:211], a[16:19], v[160:163]
  ds_read_b64_tr_b16 a[200:201], v242 offset:16384
  v_mfma_f32_16x16x32_bf16 v[160:163], a[212:215], a[24:27], v[160:163]
  ds_read_b64_tr_b16 a[202:203], v242 offset:20480
  v_mfma_f32_16x16x32_bf16 v[164:167], a[212:215], a[28:31], v[164:167]
  buffer_load_dwordx4 a[88:91], v137, s[36:39], s51 offen offset:2048 sc1
  ds_read_b64_tr_b16 a[204:205], v242 offset:24576
  v_mfma_f32_16x16x32_bf16 v[164:167], a[208:211], a[20:23], v[164:167]
  s_waitcnt lgkmcnt(11)
  ds_read_b64_tr_b16 a[206:207], v242 offset:28672
  v_mfma_f32_16x16x32_bf16 v[172:175], a[176:179], a[20:23], v[172:175]
  ds_read_b64_tr_b16 a[208:209], v243 offset:16384
  v_mfma_f32_16x16x32_bf16 v[172:175], a[180:183], a[28:31], v[172:175]
  ds_read_b64_tr_b16 a[210:211], v243 offset:20480
  v_mfma_f32_16x16x32_bf16 v[168:171], a[180:183], a[24:27], v[168:171]
  buffer_load_dwordx4 v136, s[24:27], s50 offen offset:3072 lds
  ds_read_b64_tr_b16 a[212:213], v243 offset:24576
  v_mfma_f32_16x16x32_bf16 v[168:171], a[176:179], a[16:19], v[168:171]
  s_waitcnt vmcnt(23) lgkmcnt(11)
  ds_read_b64_tr_b16 a[214:215], v243 offset:28672
  v_mfma_f32_16x16x32_bf16 v[32:35], a[184:187], a[32:35], v[32:35]
  ds_read_b64_tr_b16 a[176:177], v240 offset:18432
  v_mfma_f32_16x16x32_bf16 v[32:35], a[188:191], a[40:43], v[32:35]
  buffer_load_dwordx4 a[92:95], v137, s[36:39], s51 offen offset:3072 sc1
  s_cmp_eq_u32 s87, 0
  v_mfma_f32_16x16x32_bf16 v[36:39], a[188:191], a[44:47], v[36:39]
  s_cselect_b32 s79, 29, 15
  s_lshl_b32 s50, s79, 16
  s_add_u32 m0, s70, 81920
  v_mfma_f32_16x16x32_bf16 v[36:39], a[184:187], a[36:39], v[36:39]
  s_waitcnt lgkmcnt(9)
  ds_read_b64_tr_b16 a[178:179], v240 offset:22528
  ds_read_b64_tr_b16 a[180:181], v240 offset:26624
  v_mfma_f32_16x16x32_bf16 v[44:47], a[192:195], a[36:39], v[44:47]
  ds_read_b64_tr_b16 a[182:183], v240 offset:30720
  ds_read_b64_tr_b16 a[184:185], v241 offset:18432
  v_mfma_f32_16x16x32_bf16 v[44:47], a[196:199], a[44:47], v[44:47]
  buffer_load_dwordx4 v133, s[24:27], s50 offen offset:0 lds
  s_lshl_b32 s51, s79, 11
  v_mfma_f32_16x16x32_bf16 v[40:43], a[196:199], a[40:43], v[40:43]
  ds_read_b64_tr_b16 a[186:187], v241 offset:22528
  ds_read_b64_tr_b16 a[188:189], v241 offset:26624
  v_mfma_f32_16x16x32_bf16 v[40:43], a[192:195], a[32:35], v[40:43]
  s_waitcnt vmcnt(18) lgkmcnt(11)
  s_barrier
  ds_read_b64_tr_b16 a[190:191], v241 offset:30720
  v_mfma_f32_16x16x32_bf16 v[48:51], a[200:203], a[32:35], v[48:51]
  ds_read_b64_tr_b16 a[192:193], v242 offset:18432
  v_mfma_f32_16x16x32_bf16 v[48:51], a[204:207], a[40:43], v[48:51]
  buffer_load_dwordx4 a[96:99], v137, s[36:39], s51 offen offset:0 sc1
  ds_read_b64_tr_b16 a[194:195], v242 offset:22528
  v_mfma_f32_16x16x32_bf16 v[52:55], a[204:207], a[44:47], v[52:55]
  ds_read_b64_tr_b16 a[196:197], v242 offset:26624
  v_mfma_f32_16x16x32_bf16 v[52:55], a[200:203], a[36:39], v[52:55]
  s_waitcnt lgkmcnt(11)
  ds_read_b64_tr_b16 a[198:199], v242 offset:30720
  v_mfma_f32_16x16x32_bf16 v[60:63], a[208:211], a[36:39], v[60:63]
  ds_read_b64_tr_b16 a[200:201], v243 offset:18432
  v_mfma_f32_16x16x32_bf16 v[60:63], a[212:215], a[44:47], v[60:63]
  buffer_load_dwordx4 v134, s[24:27], s50 offen offset:1024 lds
  ds_read_b64_tr_b16 a[202:203], v243 offset:22528
  v_mfma_f32_16x16x32_bf16 v[56:59], a[212:215], a[40:43], v[56:59]
  ds_read_b64_tr_b16 a[204:205], v243 offset:26624
  v_mfma_f32_16x16x32_bf16 v[56:59], a[208:211], a[32:35], v[56:59]
  s_waitcnt lgkmcnt(11)
  ds_read_b64_tr_b16 a[206:207], v243 offset:30720
  v_mfma_f32_16x16x32_bf16 v[144:147], a[176:179], a[32:35], v[144:147]
  ds_read_b64_tr_b16 a[208:209], v240 offset:32768
  v_mfma_f32_16x16x32_bf16 v[144:147], a[180:183], a[40:43], v[144:147]
  buffer_load_dwordx4 a[100:103], v137, s[36:39], s51 offen offset:1024 sc1
  ds_read_b64_tr_b16 a[210:211], v240 offset:36864
  v_mfma_f32_16x16x32_bf16 v[148:151], a[180:183], a[44:47], v[148:151]
  ds_read_b64_tr_b16 a[212:213], v240 offset:40960
  v_mfma_f32_16x16x32_bf16 v[148:151], a[176:179], a[36:39], v[148:151]
  s_waitcnt lgkmcnt(11)
  ds_read_b64_tr_b16 a[214:215], v240 offset:45056
  v_mfma_f32_16x16x32_bf16 v[156:159], a[184:187], a[36:39], v[156:159]
  buffer_load_dwordx4 v135, s[24:27], s50 offen offset:2048 lds
  ds_read_b64_tr_b16 a[176:177], v241 offset:32768
  v_mfma_f32_16x16x32_bf16 v[156:159], a[188:191], a[44:47], v[156:159]
  ds_read_b64_tr_b16 a[178:179], v241 offset:36864
  v_mfma_f32_16x16x32_bf16 v[152:155], a[188:191], a[40:43], v[152:155]
  ds_read_b64_tr_b16 a[180:181], v241 offset:40960
  v_mfma_f32_16x16x32_bf16 v[152:155], a[184:187], a[32:35], v[152:155]
  s_waitcnt lgkmcnt(11)
  ds_read_b64_tr_b16 a[182:183], v241 offset:45056
  v_mfma_f32_16x16x32_bf16 v[160:163], a[192:195], a[32:35], v[160:163]
  buffer_load_dwordx4 a[104:107], v137, s[36:39], s51 offen offset:2048 sc1
  ds_read_b64_tr_b16 a[184:185], v242 offset:32768
  v_mfma_f32_16x16x32_bf16 v[160:163], a[196:199], a[40:43], v[160:163]
  ds_read_b64_tr_b16 a[186:187], v242 offset:36864
  v_mfma_f32_16x16x32_bf16 v[164:167], a[196:199], a[44:47], v[164:167]
  ds_read_b64_tr_b16 a[188:189], v242 offset:40960
  v_mfma_f32_16x16x32_bf16 v[164:167], a[192:195], a[36:39], v[164:167]
  s_waitcnt lgkmcnt(11)
  ds_read_b64_tr_b16 a[190:191], v242 offset:45056
  v_mfma_f32_16x16x32_bf16 v[172:175], a[200:203], a[36:39], v[172:175]
  buffer_load_dwordx4 v136, s[24:27], s50 offen offset:3072 lds
  ds_read_b64_tr_b16 a[192:193], v243 offset:32768
  v_mfma_f32_16x16x32_bf16 v[172:175], a[204:207], a[44:47], v[172:175]
  ds_read_b64_tr_b16 a[194:195], v243 offset:36864
  v_mfma_f32_16x16x32_bf16 v[168:171], a[204:207], a[40:43], v[168:171]
  ds_read_b64_tr_b16 a[196:197], v243 offset:40960
  v_mfma_f32_16x16x32_bf16 v[168:171], a[200:203], a[32:35], v[168:171]
  s_waitcnt vmcnt(23) lgkmcnt(11)
  ds_read_b64_tr_b16 a[198:199], v243 offset:45056
  v_mfma_f32_16x16x32_bf16 v[32:35], a[208:211], a[48:51], v[32:35]
  buffer_load_dwordx4 a[108:111], v137, s[36:39], s51 offen offset:3072 sc1
  s_cmp_eq_u32 s87, 1
  v_mfma_f32_16x16x32_bf16 v[32:35], a[212:215], a[56:59], v[32:35]
  s_cselect_b32 s80, 33, 19
  s_lshl_b32 s50, s80, 16
  s_add_u32 m0, s70, 98304
  v_mfma_f32_16x16x32_bf16 v[36:39], a[212:215], a[60:63], v[36:39]
  ds_read_b64_tr_b16 a[200:201], v240 offset:34816
  ds_read_b64_tr_b16 a[202:203], v240 offset:38912
  v_mfma_f32_16x16x32_bf16 v[36:39], a[208:211], a[52:55], v[36:39]
  s_waitcnt lgkmcnt(10)
  ds_read_b64_tr_b16 a[204:205], v240 offset:43008
  ds_read_b64_tr_b16 a[206:207], v240 offset:47104
  v_mfma_f32_16x16x32_bf16 v[44:47], a[176:179], a[52:55], v[44:47]
  buffer_load_dwordx4 v133, s[24:27], s50 offen offset:0 lds
  s_lshl_b32 s51, s80, 11
  v_mfma_f32_16x16x32_bf16 v[44:47], a[180:183], a[60:63], v[44:47]
  ds_read_b64_tr_b16 a[208:209], v241 offset:34816
  ds_read_b64_tr_b16 a[210:211], v241 offset:38912
  v_mfma_f32_16x16x32_bf16 v[40:43], a[180:183], a[56:59], v[40:43]
  ds_read_b64_tr_b16 a[212:213], v241 offset:43008
  v_mfma_f32_16x16x32_bf16 v[40:43], a[176:179], a[48:51], v[40:43]
  s_waitcnt vmcnt(18) lgkmcnt(11)
  s_barrier
  ds_read_b64_tr_b16 a[214:215], v241 offset:47104
  v_mfma_f32_16x16x32_bf16 v[48:51], a[184:187], a[48:51], v[48:51]
  buffer_load_dwordx4 a[112:115], v137, s[36:39], s51 offen offset:0 sc1
  ds_read_b64_tr_b16 a[176:177], v242 offset:34816
  v_mfma_f32_16x16x32_bf16 v[48:51], a[188:191], a[56:59], v[48:51]
  ds_read_b64_tr_b16 a[178:179], v242 offset:38912
  v_mfma_f32_16x16x32_bf16 v[52:55], a[188:191], a[60:63], v[52:55]
  ds_read_b64_tr_b16 a[180:181], v242 offset:43008
  v_mfma_f32_16x16x32_bf16 v[52:55], a[184:187], a[52:55], v[52:55]
  s_waitcnt lgkmcnt(11)
  buffer_load_dwordx4 v134, s[24:27], s50 offen offset:1024 lds
  ds_read_b64_tr_b16 a[182:183], v242 offset:47104
  v_mfma_f32_16x16x32_bf16 v[60:63], a[192:195], a[52:55], v[60:63]
  ds_read_b64_tr_b16 a[184:185], v243 offset:34816
  v_mfma_f32_16x16x32_bf16 v[60:63], a[196:199], a[60:63], v[60:63]
  ds_read_b64_tr_b16 a[186:187], v243 offset:38912
  v_mfma_f32_16x16x32_bf16 v[56:59], a[196:199], a[56:59], v[56:59]
  ds_read_b64_tr_b16 a[188:189], v243 offset:43008
  v_mfma_f32_16x16x32_bf16 v[56:59], a[192:195], a[48:51], v[56:59]
  s_waitcnt lgkmcnt(11)
  buffer_load_dwordx4 a[116:119], v137, s[36:39], s51 offen offset:1024 sc1
  ds_read_b64_tr_b16 a[190:191], v243 offset:47104
  v_mfma_f32_16x16x32_bf16 v[144:147], a[200:203], a[48:51], v[144:147]
  ds_read_b64_tr_b16 a[192:193], v240 offset:49152
  v_mfma_f32_16x16x32_bf16 v[144:147], a[204:207], a[56:59], v[144:147]
  ds_read_b64_tr_b16 a[194:195], v240 offset:53248
  v_mfma_f32_16x16x32_bf16 v[148:151], a[204:207], a[60:63], v[148:151]
  ds_read_b64_tr_b16 a[196:197], v240 offset:57344
  v_mfma_f32_16x16x32_bf16 v[148:151], a[200:203], a[52:55], v[148:151]
  s_waitcnt lgkmcnt(11)
  buffer_load_dwordx4 v135, s[24:27], s50 offen offset:2048 lds
  ds_read_b64_tr_b16 a[198:199], v240 offset:61440
  v_mfma_f32_16x16x32_bf16 v[156:159], a[208:211], a[52:55], v[156:159]
  ds_read_b64_tr_b16 a[200:201], v241 offset:49152
  v_mfma_f32_16x16x32_bf16 v[156:159], a[212:215], a[60:63], v[156:159]
  ds_read_b64_tr_b16 a[202:203], v241 offset:53248
  v_mfma_f32_16x16x32_bf16 v[152:155], a[212:215], a[56:59], v[152:155]
  ds_read_b64_tr_b16 a[204:205], v241 offset:57344
  v_mfma_f32_16x16x32_bf16 v[152:155], a[208:211], a[48:51], v[152:155]
  s_waitcnt lgkmcnt(11)
  buffer_load_dwordx4 a[120:123], v137, s[36:39], s51 offen offset:2048 sc1
  ds_read_b64_tr_b16 a[206:207], v241 offset:61440
  v_mfma_f32_16x16x32_bf16 v[160:163], a[176:179], a[48:51], v[160:163]
  ds_read_b64_tr_b16 a[208:209], v242 offset:49152
  v_mfma_f32_16x16x32_bf16 v[160:163], a[180:183], a[56:59], v[160:163]
  ds_read_b64_tr_b16 a[210:211], v242 offset:53248
  v_mfma_f32_16x16x32_bf16 v[164:167], a[180:183], a[60:63], v[164:167]
  ds_read_b64_tr_b16 a[212:213], v242 offset:57344
  v_mfma_f32_16x16x32_bf16 v[164:167], a[176:179], a[52:55], v[164:167]
  s_waitcnt lgkmcnt(11)
  buffer_load_dwordx4 v136, s[24:27], s50 offen offset:3072 lds
  ds_read_b64_tr_b16 a[214:215], v242 offset:61440
  v_mfma_f32_16x16x32_bf16 v[172:175], a[184:187], a[52:55], v[172:175]
  ds_read_b64_tr_b16 a[176:177], v243 offset:49152
  v_mfma_f32_16x16x32_bf16 v[172:175], a[188:191], a[60:63], v[172:175]
  ds_read_b64_tr_b16 a[178:179], v243 offset:53248
  v_mfma_f32_16x16x32_bf16 v[168:171], a[188:191], a[56:59], v[168:171]
  buffer_load_dwordx4 a[124:127], v137, s[36:39], s51 offen offset:3072 sc1
  s_cmp_eq_u32 s87, 2
  v_mfma_f32_16x16x32_bf16 v[168:171], a[184:187], a[48:51], v[168:171]
  s_waitcnt vmcnt(24) lgkmcnt(10)
  s_cselect_b32 s81, 36, 22
  s_lshl_b32 s50, s81, 16
  v_mfma_f32_16x16x32_bf16 v[32:35], a[192:195], a[64:67], v[32:35]
  s_add_u32 m0, s70, 114688
  ds_read_b64_tr_b16 a[180:181], v243 offset:57344
  ds_read_b64_tr_b16 a[182:183], v243 offset:61440
  v_mfma_f32_16x16x32_bf16 v[32:35], a[196:199], a[72:75], v[32:35]
  ds_read_b64_tr_b16 a[184:185], v240 offset:51200
  ds_read_b64_tr_b16 a[186:187], v240 offset:55296
  v_mfma_f32_16x16x32_bf16 v[36:39], a[196:199], a[76:79], v[36:39]
  buffer_load_dwordx4 v133, s[24:27], s50 offen offset:0 lds
  s_lshl_b32 s51, s81, 11
  v_mfma_f32_16x16x32_bf16 v[36:39], a[192:195], a[68:71], v[36:39]
  s_waitcnt lgkmcnt(10)
  ds_read_b64_tr_b16 a[188:189], v240 offset:59392
  ds_read_b64_tr_b16 a[190:191], v240 offset:63488
  v_mfma_f32_16x16x32_bf16 v[44:47], a[200:203], a[68:71], v[44:47]
  ds_read_b64_tr_b16 a[192:193], v241 offset:51200
  v_mfma_f32_16x16x32_bf16 v[44:47], a[204:207], a[76:79], v[44:47]
  ds_read_b64_tr_b16 a[194:195], v241 offset:55296
  v_mfma_f32_16x16x32_bf16 v[40:43], a[204:207], a[72:75], v[40:43]
  buffer_load_dwordx4 a[216:219], v137, s[36:39], s51 offen offset:0 sc1
  ds_read_b64_tr_b16 a[196:197], v241 offset:59392
  v_mfma_f32_16x16x32_bf16 v[40:43], a[200:203], a[64:67], v[40:43]
  s_waitcnt vmcnt(19) lgkmcnt(11)
  s_barrier
  ds_read_b64_tr_b16 a[198:199], v241 offset:63488
  v_mfma_f32_16x16x32_bf16 v[48:51], a[208:211], a[64:67], v[48:51]
  ds_read_b64_tr_b16 a[200:201], v242 offset:51200
  v_mfma_f32_16x16x32_bf16 v[48:51], a[212:215], a[72:75], v[48:51]
  ds_read_b64_tr_b16 a[202:203], v242 offset:55296
  v_mfma_f32_16x16x32_bf16 v[52:55], a[212:215], a[76:79], v[52:55]
  buffer_load_dwordx4 v134, s[24:27], s50 offen offset:1024 lds
  ds_read_b64_tr_b16 a[204:205], v242 offset:59392
  v_mfma_f32_16x16x32_bf16 v[52:55], a[208:211], a[68:71], v[52:55]
  s_waitcnt lgkmcnt(11)
  ds_read_b64_tr_b16 a[206:207], v242 offset:63488
  v_mfma_f32_16x16x32_bf16 v[60:63], a[176:179], a[68:71], v[60:63]
  ds_read_b64_tr_b16 a[208:209], v243 offset:51200
  v_mfma_f32_16x16x32_bf16 v[60:63], a[180:183], a[76:79], v[60:63]
  ds_read_b64_tr_b16 a[210:211], v243 offset:55296
  v_mfma_f32_16x16x32_bf16 v[56:59], a[180:183], a[72:75], v[56:59]
  buffer_load_dwordx4 a[220:223], v137, s[36:39], s51 offen offset:1024 sc1
  ds_read_b64_tr_b16 a[212:213], v243 offset:59392
  v_mfma_f32_16x16x32_bf16 v[56:59], a[176:179], a[64:67], v[56:59]
  s_waitcnt lgkmcnt(11)
  ds_read_b64_tr_b16 a[214:215], v243 offset:63488
  v_mfma_f32_16x16x32_bf16 v[144:147], a[184:187], a[64:67], v[144:147]
  ds_read_b64_tr_b16 a[176:177], v244 offset:0
  v_mfma_f32_16x16x32_bf16 v[144:147], a[188:191], a[72:75], v[144:147]
  buffer_load_dwordx4 v135, s[24:27], s50 offen offset:2048 lds
  ds_read_b64_tr_b16 a[178:179], v244 offset:4096
  v_mfma_f32_16x16x32_bf16 v[148:151], a[188:191], a[76:79], v[148:151]
  ds_read_b64_tr_b16 a[180:181], v244 offset:8192
  v_mfma_f32_16x16x32_bf16 v[148:151], a[184:187], a[68:71], v[148:151]
  s_waitcnt lgkmcnt(11)
  ds_read_b64_tr_b16 a[182:183], v244 offset:12288
  v_mfma_f32_16x16x32_bf16 v[156:159], a[192:195], a[68:71], v[156:159]
  ds_read_b64_tr_b16 a[184:185], v245 offset:0
  v_mfma_f32_16x16x32_bf16 v[156:159], a[196:199], a[76:79], v[156:159]
  buffer_load_dwordx4 a[224:227], v137, s[36:39], s51 offen offset:2048 sc1
  ds_read_b64_tr_b16 a[186:187], v245 offset:4096
  v_mfma_f32_16x16x32_bf16 v[152:155], a[196:199], a[72:75], v[152:155]
  ds_read_b64_tr_b16 a[188:189], v245 offset:8192
  v_mfma_f32_16x16x32_bf16 v[152:155], a[192:195], a[64:67], v[152:155]
  s_waitcnt lgkmcnt(11)
  ds_read_b64_tr_b16 a[190:191], v245 offset:12288
  v_mfma_f32_16x16x32_bf16 v[160:163], a[200:203], a[64:67], v[160:163]
  ds_read_b64_tr_b16 a[192:193], v246 offset:0
  v_mfma_f32_16x16x32_bf16 v[160:163], a[204:207], a[72:75], v[160:163]
  buffer_load_dwordx4 v136, s[24:27], s50 offen offset:3072 lds
  ds_read_b64_tr_b16 a[194:195], v246 offset:4096
  v_mfma_f32_16x16x32_bf16 v[164:167], a[204:207], a[76:79], v[164:167]
  ds_read_b64_tr_b16 a[196:197], v246 offset:8192
  v_mfma_f32_16x16x32_bf16 v[164:167], a[200:203], a[68:71], v[164:167]
  s_waitcnt lgkmcnt(11)
  ds_read_b64_tr_b16 a[198:199], v246 offset:12288
  v_mfma_f32_16x16x32_bf16 v[172:175], a[208:211], a[68:71], v[172:175]
  ds_read_b64_tr_b16 a[200:201], v247 offset:0
  v_mfma_f32_16x16x32_bf16 v[172:175], a[212:215], a[76:79], v[172:175]
  buffer_load_dwordx4 a[228:231], v137, s[36:39], s51 offen offset:3072 sc1
  s_cmp_eq_u32 s87, 3
  v_mfma_f32_16x16x32_bf16 v[168:171], a[212:215], a[72:75], v[168:171]
  s_cselect_b32 s86, 40, 26
  s_lshl_b32 s50, s86, 16
  s_add_u32 m0, s70, 131072
  v_mfma_f32_16x16x32_bf16 v[168:171], a[208:211], a[64:67], v[168:171]
  s_waitcnt vmcnt(24) lgkmcnt(9)
  ds_read_b64_tr_b16 a[202:203], v247 offset:4096
  ds_read_b64_tr_b16 a[204:205], v247 offset:8192
  v_mfma_f32_16x16x32_bf16 v[32:35], a[176:179], a[80:83], v[32:35]
  ds_read_b64_tr_b16 a[206:207], v247 offset:12288
  ds_read_b64_tr_b16 a[208:209], v244 offset:2048
  v_mfma_f32_16x16x32_bf16 v[32:35], a[180:183], a[88:91], v[32:35]
  buffer_load_dwordx4 v133, s[24:27], s50 offen offset:0 lds
  s_lshl_b32 s51, s86, 11
  v_mfma_f32_16x16x32_bf16 v[36:39], a[180:183], a[92:95], v[36:39]
  ds_read_b64_tr_b16 a[210:211], v244 offset:6144
  ds_read_b64_tr_b16 a[212:213], v244 offset:10240
  v_mfma_f32_16x16x32_bf16 v[36:39], a[176:179], a[84:87], v[36:39]
  s_waitcnt lgkmcnt(11)
  ds_read_b64_tr_b16 a[214:215], v244 offset:14336
  v_mfma_f32_16x16x32_bf16 v[44:47], a[184:187], a[84:87], v[44:47]
  buffer_load_dwordx4 a[0:3], v137, s[36:39], s51 offen offset:0 sc1
  ds_read_b64_tr_b16 a[176:177], v245 offset:2048
  v_mfma_f32_16x16x32_bf16 v[44:47], a[188:191], a[92:95], v[44:47]
  ds_read_b64_tr_b16 a[178:179], v245 offset:6144
  v_mfma_f32_16x16x32_bf16 v[40:43], a[188:191], a[88:91], v[40:43]
  ds_read_b64_tr_b16 a[180:181], v245 offset:10240
  v_mfma_f32_16x16x32_bf16 v[40:43], a[184:187], a[80:83], v[40:43]
  s_waitcnt vmcnt(19) lgkmcnt(11)
  s_barrier
  ds_read_b64_tr_b16 a[182:183], v245 offset:14336
  v_mfma_f32_16x16x32_bf16 v[48:51], a[192:195], a[80:83], v[48:51]
  buffer_load_dwordx4 v134, s[24:27], s50 offen offset:1024 lds
  ds_read_b64_tr_b16 a[184:185], v246 offset:2048
  v_mfma_f32_16x16x32_bf16 v[48:51], a[196:199], a[88:91], v[48:51]
  ds_read_b64_tr_b16 a[186:187], v246 offset:6144
  v_mfma_f32_16x16x32_bf16 v[52:55], a[196:199], a[92:95], v[52:55]
  ds_read_b64_tr_b16 a[188:189], v246 offset:10240
  v_mfma_f32_16x16x32_bf16 v[52:55], a[192:195], a[84:87], v[52:55]
  s_waitcnt lgkmcnt(11)
  ds_read_b64_tr_b16 a[190:191], v246 offset:14336
  v_mfma_f32_16x16x32_bf16 v[60:63], a[200:203], a[84:87], v[60:63]
  buffer_load_dwordx4 a[4:7], v137, s[36:39], s51 offen offset:1024 sc1
  ds_read_b64_tr_b16 a[192:193], v247 offset:2048
  v_mfma_f32_16x16x32_bf16 v[60:63], a[204:207], a[92:95], v[60:63]
  ds_read_b64_tr_b16 a[194:195], v247 offset:6144
  v_mfma_f32_16x16x32_bf16 v[56:59], a[204:207], a[88:91], v[56:59]
  ds_read_b64_tr_b16 a[196:197], v247 offset:10240
  v_mfma_f32_16x16x32_bf16 v[56:59], a[200:203], a[80:83], v[56:59]
  s_waitcnt lgkmcnt(11)
  ds_read_b64_tr_b16 a[198:199], v247 offset:14336
  v_mfma_f32_16x16x32_bf16 v[144:147], a[208:211], a[80:83], v[144:147]
  buffer_load_dwordx4 v135, s[24:27], s50 offen offset:2048 lds
  ds_read_b64_tr_b16 a[200:201], v244 offset:16384
  v_mfma_f32_16x16x32_bf16 v[144:147], a[212:215], a[88:91], v[144:147]
  ds_read_b64_tr_b16 a[202:203], v244 offset:20480
  v_mfma_f32_16x16x32_bf16 v[148:151], a[212:215], a[92:95], v[148:151]
  ds_read_b64_tr_b16 a[204:205], v244 offset:24576
  v_mfma_f32_16x16x32_bf16 v[148:151], a[208:211], a[84:87], v[148:151]
  s_waitcnt lgkmcnt(11)
  ds_read_b64_tr_b16 a[206:207], v244 offset:28672
  v_mfma_f32_16x16x32_bf16 v[156:159], a[176:179], a[84:87], v[156:159]
  buffer_load_dwordx4 a[8:11], v137, s[36:39], s51 offen offset:2048 sc1
  ds_read_b64_tr_b16 a[208:209], v245 offset:16384
  v_mfma_f32_16x16x32_bf16 v[156:159], a[180:183], a[92:95], v[156:159]
  ds_read_b64_tr_b16 a[210:211], v245 offset:20480
  v_mfma_f32_16x16x32_bf16 v[152:155], a[180:183], a[88:91], v[152:155]
  ds_read_b64_tr_b16 a[212:213], v245 offset:24576
  v_mfma_f32_16x16x32_bf16 v[152:155], a[176:179], a[80:83], v[152:155]
  s_waitcnt lgkmcnt(11)
  buffer_load_dwordx4 v136, s[24:27], s50 offen offset:3072 lds
  ds_read_b64_tr_b16 a[214:215], v245 offset:28672
  v_mfma_f32_16x16x32_bf16 v[160:163], a[184:187], a[80:83], v[160:163]
  ds_read_b64_tr_b16 a[176:177], v246 offset:16384
  v_mfma_f32_16x16x32_bf16 v[160:163], a[188:191], a[88:91], v[160:163]
  ds_read_b64_tr_b16 a[178:179], v246 offset:20480
  v_mfma_f32_16x16x32_bf16 v[164:167], a[188:191], a[92:95], v[164:167]
  ds_read_b64_tr_b16 a[180:181], v246 offset:24576
  v_mfma_f32_16x16x32_bf16 v[164:167], a[184:187], a[84:87], v[164:167]
  s_waitcnt lgkmcnt(11)
  buffer_load_dwordx4 a[12:15], v137, s[36:39], s51 offen offset:3072 sc1
  s_cmp_eq_u32 s87, 0
  v_mfma_f32_16x16x32_bf16 v[172:175], a[192:195], a[84:87], v[172:175]
  s_cselect_b32 s69, 43, 29
  s_lshl_b32 s50, s69, 16
  s_add_u32 m0, s70, 0
  v_mfma_f32_16x16x32_bf16 v[172:175], a[196:199], a[92:95], v[172:175]
  ds_read_b64_tr_b16 a[182:183], v246 offset:28672
  ds_read_b64_tr_b16 a[184:185], v247 offset:16384
  v_mfma_f32_16x16x32_bf16 v[168:171], a[196:199], a[88:91], v[168:171]
  ds_read_b64_tr_b16 a[186:187], v247 offset:20480
  ds_read_b64_tr_b16 a[188:189], v247 offset:24576
  v_mfma_f32_16x16x32_bf16 v[168:171], a[192:195], a[80:83], v[168:171]
  s_waitcnt vmcnt(24) lgkmcnt(11)
  buffer_load_dwordx4 v133, s[24:27], s50 offen offset:0 lds
  s_lshl_b32 s51, s69, 11
  v_mfma_f32_16x16x32_bf16 v[32:35], a[200:203], a[96:99], v[32:35]
  ds_read_b64_tr_b16 a[190:191], v247 offset:28672
  ds_read_b64_tr_b16 a[192:193], v244 offset:18432
  v_mfma_f32_16x16x32_bf16 v[32:35], a[204:207], a[104:107], v[32:35]
Hb1_3:
  s_cbranch_execz Rb
  ds_read_b64_tr_b16 a[194:195], v244 offset:22528
  v_mfma_f32_16x16x32_bf16 v[36:39], a[204:207], a[108:111], v[36:39]
  ds_read_b64_tr_b16 a[196:197], v244 offset:26624
  v_mfma_f32_16x16x32_bf16 v[36:39], a[200:203], a[100:103], v[36:39]
  s_waitcnt lgkmcnt(11)
  buffer_load_dwordx4 a[16:19], v137, s[36:39], s51 offen offset:0 sc1
  ds_read_b64_tr_b16 a[198:199], v244 offset:30720
  v_mfma_f32_16x16x32_bf16 v[44:47], a[208:211], a[100:103], v[44:47]
  ds_read_b64_tr_b16 a[200:201], v245 offset:18432
  v_mfma_f32_16x16x32_bf16 v[44:47], a[212:215], a[108:111], v[44:47]
  ds_read_b64_tr_b16 a[202:203], v245 offset:22528
  v_mfma_f32_16x16x32_bf16 v[40:43], a[212:215], a[104:107], v[40:43]
  ds_read_b64_tr_b16 a[204:205], v245 offset:26624
  v_mfma_f32_16x16x32_bf16 v[40:43], a[208:211], a[96:99], v[40:43]
  s_waitcnt vmcnt(19) lgkmcnt(11)
  s_barrier
  buffer_load_dwordx4 v134, s[24:27], s50 offen offset:1024 lds
  v_mfma_f32_16x16x32_bf16 v[48:51], a[176:179], a[96:99], v[48:51]
  ds_read_b64_tr_b16 a[206:207], v245 offset:30720
  ds_read_b64_tr_b16 a[208:209], v246 offset:18432
  v_mfma_f32_16x16x32_bf16 v[48:51], a[180:183], a[104:107], v[48:51]
  ds_read_b64_tr_b16 a[210:211], v246 offset:22528
  v_mfma_f32_16x16x32_bf16 v[52:55], a[180:183], a[108:111], v[52:55]
  buffer_load_dwordx4 a[20:23], v137, s[36:39], s51 offen offset:1024 sc1
  ds_read_b64_tr_b16 a[212:213], v246 offset:26624
  v_mfma_f32_16x16x32_bf16 v[52:55], a[176:179], a[100:103], v[52:55]
  s_waitcnt lgkmcnt(11)
  ds_read_b64_tr_b16 a[214:215], v246 offset:30720
  v_mfma_f32_16x16x32_bf16 v[60:63], a[184:187], a[100:103], v[60:63]
  ds_read_b64_tr_b16 a[176:177], v247 offset:18432
  v_mfma_f32_16x16x32_bf16 v[60:63], a[188:191], a[108:111], v[60:63]
  ds_read_b64_tr_b16 a[178:179], v247 offset:22528
  v_mfma_f32_16x16x32_bf16 v[56:59], a[188:191], a[104:107], v[56:59]
  buffer_load_dwordx4 v135, s[24:27], s50 offen offset:2048 lds
  ds_read_b64_tr_b16 a[180:181], v247 offset:26624
  v_mfma_f32_16x16x32_bf16 v[56:59], a[184:187], a[96:99], v[56:59]
  s_waitcnt lgkmcnt(11)
  ds_read_b64_tr_b16 a[182:183], v247 offset:30720
  v_mfma_f32_16x16x32_bf16 v[144:147], a[192:195], a[96:99], v[144:147]
  ds_read_b64_tr_b16 a[184:185], v244 offset:32768
  v_mfma_f32_16x16x32_bf16 v[144:147], a[196:199], a[104:107], v[144:147]
  ds_read_b64_tr_b16 a[186:187], v244 offset:36864
  v_mfma_f32_16x16x32_bf16 v[148:151], a[196:199], a[108:111], v[148:151]
  buffer_load_dwordx4 a[24:27], v137, s[36:39], s51 offen offset:2048 sc1
  ds_read_b64_tr_b16 a[188:189], v244 offset:40960
  v_mfma_f32_16x16x32_bf16 v[148:151], a[192:195], a[100:103], v[148:151]
  s_waitcnt lgkmcnt(11)
  ds_read_b64_tr_b16 a[190:191], v244 offset:45056
  v_mfma_f32_16x16x32_bf16 v[156:159], a[200:203], a[100:103], v[156:159]
  ds_read_b64_tr_b16 a[192:193], v245 offset:32768
  v_mfma_f32_16x16x32_bf16 v[156:159], a[204:207], a[108:111], v[156:159]
  ds_read_b64_tr_b16 a[194:195], v245 offset:36864
  v_mfma_f32_16x16x32_bf16 v[152:155], a[204:207], a[104:107], v[152:155]
  buffer_load_dwordx4 v136, s[24:27], s50 offen offset:3072 lds
  ds_read_b64_tr_b16 a[196:197], v245 offset:40960
  v_mfma_f32_16x16x32_bf16 v[152:155], a[200:203], a[96:99], v[152:155]
  s_waitcnt lgkmcnt(11)
  ds_read_b64_tr_b16 a[198:199], v245 offset:45056
  v_mfma_f32_16x16x32_bf16 v[160:163], a[208:211], a[96:99], v[160:163]
  ds_read_b64_tr_b16 a[200:201], v246 offset:32768
  v_mfma_f32_16x16x32_bf16 v[160:163], a[212:215], a[104:107], v[160:163]
  ds_read_b64_tr_b16 a[202:203], v246 offset:36864
  v_mfma_f32_16x16x32_bf16 v[164:167], a[212:215], a[108:111], v[164:167]
  buffer_load_dwordx4 a[28:31], v137, s[36:39], s51 offen offset:3072 sc1
  s_cmp_eq_u32 s87, 1
  v_mfma_f32_16x16x32_bf16 v[164:167], a[208:211], a[100:103], v[164:167]
  s_waitcnt lgkmcnt(10)
  s_cselect_b32 s71, 47, 33
  s_lshl_b32 s51, s71, 11
  v_mfma_f32_16x16x32_bf16 v[172:175], a[176:179], a[100:103], v[172:175]
  ds_read_b64_tr_b16 a[204:205], v246 offset:40960
  ds_read_b64_tr_b16 a[206:207], v246 offset:45056
  v_mfma_f32_16x16x32_bf16 v[172:175], a[180:183], a[108:111], v[172:175]
  ds_read_b64_tr_b16 a[208:209], v247 offset:32768
  buffer_load_dwordx4 a[32:35], v137, s[36:39], s51 offen offset:0 sc1
  v_mfma_f32_16x16x32_bf16 v[168:171], a[180:183], a[104:107], v[168:171]
  ds_read_b64_tr_b16 a[210:211], v247 offset:36864
  ds_read_b64_tr_b16 a[212:213], v247 offset:40960
  v_mfma_f32_16x16x32_bf16 v[168:171], a[176:179], a[96:99], v[168:171]
  s_waitcnt vmcnt(25) lgkmcnt(11)
  ds_read_b64_tr_b16 a[214:215], v247 offset:45056
  v_mfma_f32_16x16x32_bf16 v[32:35], a[184:187], a[112:115], v[32:35]
  ds_read_b64_tr_b16 a[176:177], v244 offset:34816
  v_mfma_f32_16x16x32_bf16 v[32:35], a[188:191], a[120:123], v[32:35]
  buffer_load_dwordx4 a[36:39], v137, s[36:39], s51 offen offset:1024 sc1
  s_lshl_b32 s50, s71, 16
  v_mfma_f32_16x16x32_bf16 v[36:39], a[188:191], a[124:127], v[36:39]
  s_add_u32 m0, s70, 16384
  ds_read_b64_tr_b16 a[178:179], v244 offset:38912
  ds_read_b64_tr_b16 a[180:181], v244 offset:43008
  v_mfma_f32_16x16x32_bf16 v[36:39], a[184:187], a[116:119], v[36:39]
  s_waitcnt lgkmcnt(11)
  ds_read_b64_tr_b16 a[182:183], v244 offset:47104
  v_mfma_f32_16x16x32_bf16 v[44:47], a[192:195], a[116:119], v[44:47]
  ds_read_b64_tr_b16 a[184:185], v245 offset:34816
  v_mfma_f32_16x16x32_bf16 v[44:47], a[196:199], a[124:127], v[44:47]
  buffer_load_dwordx4 v135, s[24:27], s50 offen offset:2048 lds
  ds_read_b64_tr_b16 a[186:187], v245 offset:38912
  v_mfma_f32_16x16x32_bf16 v[40:43], a[196:199], a[120:123], v[40:43]
  ds_read_b64_tr_b16 a[188:189], v245 offset:43008
  v_mfma_f32_16x16x32_bf16 v[40:43], a[192:195], a[112:115], v[40:43]
  s_waitcnt vmcnt(20) lgkmcnt(11)
  s_barrier
  ds_read_b64_tr_b16 a[190:191], v245 offset:47104
  v_mfma_f32_16x16x32_bf16 v[48:51], a[200:203], a[112:115], v[48:51]
  ds_read_b64_tr_b16 a[192:193], v246 offset:34816
  v_mfma_f32_16x16x32_bf16 v[48:51], a[204:207], a[120:123], v[48:51]
  buffer_load_dwordx4 a[40:43], v137, s[36:39], s51 offen offset:2048 sc1
  ds_read_b64_tr_b16 a[194:195], v246 offset:38912
  v_mfma_f32_16x16x32_bf16 v[52:55], a[204:207], a[124:127], v[52:55]
  ds_read_b64_tr_b16 a[196:197], v246 offset:43008
  v_mfma_f32_16x16x32_bf16 v[52:55], a[200:203], a[116:119], v[52:55]
  s_waitcnt lgkmcnt(11)
  ds_read_b64_tr_b16 a[198:199], v246 offset:47104
  v_mfma_f32_16x16x32_bf16 v[60:63], a[208:211], a[116:119], v[60:63]
  ds_read_b64_tr_b16 a[200:201], v247 offset:34816
  v_mfma_f32_16x16x32_bf16 v[60:63], a[212:215], a[124:127], v[60:63]
  buffer_load_dwordx4 v136, s[24:27], s50 offen offset:3072 lds
  ds_read_b64_tr_b16 a[202:203], v247 offset:38912
  v_mfma_f32_16x16x32_bf16 v[56:59], a[212:215], a[120:123], v[56:59]
  ds_read_b64_tr_b16 a[204:205], v247 offset:43008
  v_mfma_f32_16x16x32_bf16 v[56:59], a[208:211], a[112:115], v[56:59]
  s_waitcnt lgkmcnt(11)
  ds_read_b64_tr_b16 a[206:207], v247 offset:47104
  v_mfma_f32_16x16x32_bf16 v[144:147], a[176:179], a[112:115], v[144:147]
  ds_read_b64_tr_b16 a[208:209], v244 offset:49152
  v_mfma_f32_16x16x32_bf16 v[144:147], a[180:183], a[120:123], v[144:147]
  buffer_load_dwordx4 a[44:47], v137, s[36:39], s51 offen offset:3072 sc1
  s_cmp_eq_u32 s87, 2
  v_mfma_f32_16x16x32_bf16 v[148:151], a[180:183], a[124:127], v[148:151]
  s_cselect_b32 s72, 50, 36
  s_lshl_b32 s51, s72, 11
  ds_read_b64_tr_b16 a[210:211], v244 offset:53248
  v_mfma_f32_16x16x32_bf16 v[148:151], a[176:179], a[116:119], v[148:151]
  s_waitcnt lgkmcnt(10)
  ds_read_b64_tr_b16 a[212:213], v244 offset:57344
  ds_read_b64_tr_b16 a[214:215], v244 offset:61440
  v_mfma_f32_16x16x32_bf16 v[156:159], a[184:187], a[116:119], v[156:159]
  buffer_load_dwordx4 a[48:51], v137, s[36:39], s51 offen offset:0 sc1
  ds_read_b64_tr_b16 a[176:177], v245 offset:49152
  v_mfma_f32_16x16x32_bf16 v[156:159], a[188:191], a[124:127], v[156:159]
  ds_read_b64_tr_b16 a[178:179], v245 offset:53248
  v_mfma_f32_16x16x32_bf16 v[152:155], a[188:191], a[120:123], v[152:155]
  ds_read_b64_tr_b16 a[180:181], v245 offset:57344
  v_mfma_f32_16x16x32_bf16 v[152:155], a[184:187], a[112:115], v[152:155]
  s_waitcnt lgkmcnt(11)
  ds_read_b64_tr_b16 a[182:183], v245 offset:61440
  v_mfma_f32_16x16x32_bf16 v[160:163], a[192:195], a[112:115], v[160:163]
  buffer_load_dwordx4 a[52:55], v137, s[36:39], s51 offen offset:1024 sc1
  s_lshl_b32 s50, s72, 16
  v_mfma_f32_16x16x32_bf16 v[160:163], a[196:199], a[120:123], v[160:163]
  s_add_u32 m0, s70, 32768
  ds_read_b64_tr_b16 a[184:185], v246 offset:49152
  ds_read_b64_tr_b16 a[186:187], v246 offset:53248
  v_mfma_f32_16x16x32_bf16 v[164:167], a[196:199], a[124:127], v[164:167]
  ds_read_b64_tr_b16 a[188:189], v246 offset:57344
  v_mfma_f32_16x16x32_bf16 v[164:167], a[192:195], a[116:119], v[164:167]
  s_waitcnt lgkmcnt(11)
  ds_read_b64_tr_b16 a[190:191], v246 offset:61440
  v_mfma_f32_16x16x32_bf16 v[172:175], a[200:203], a[116:119], v[172:175]
  buffer_load_dwordx4 v135, s[24:27], s50 offen offset:2048 lds
  ds_read_b64_tr_b16 a[192:193], v247 offset:49152
  v_mfma_f32_16x16x32_bf16 v[172:175], a[204:207], a[124:127], v[172:175]
  ds_read_b64_tr_b16 a[194:195], v247 offset:53248
  v_mfma_f32_16x16x32_bf16 v[168:171], a[204:207], a[120:123], v[168:171]
  ds_read_b64_tr_b16 a[196:197], v247 offset:57344
  v_mfma_f32_16x16x32_bf16 v[168:171], a[200:203], a[112:115], v[168:171]
  s_waitcnt vmcnt(25) lgkmcnt(11)
  ds_read_b64_tr_b16 a[198:199], v247 offset:61440
  v_mfma_f32_16x16x32_bf16 v[32:35], a[208:211], a[216:219], v[32:35]
  buffer_load_dwordx4 a[56:59], v137, s[36:39], s51 offen offset:2048 sc1
  ds_read_b64_tr_b16 a[200:201], v244 offset:51200
  v_mfma_f32_16x16x32_bf16 v[32:35], a[212:215], a[224:227], v[32:35]
  ds_read_b64_tr_b16 a[202:203], v244 offset:55296
  v_mfma_f32_16x16x32_bf16 v[36:39], a[212:215], a[228:231], v[36:39]
  ds_read_b64_tr_b16 a[204:205], v244 offset:59392
  v_mfma_f32_16x16x32_bf16 v[36:39], a[208:211], a[220:223], v[36:39]
  s_waitcnt lgkmcnt(11)
  ds_read_b64_tr_b16 a[206:207], v244 offset:63488
  v_mfma_f32_16x16x32_bf16 v[44:47], a[176:179], a[220:223], v[44:47]
  buffer_load_dwordx4 v136, s[24:27], s50 offen offset:3072 lds
  ds_read_b64_tr_b16 a[208:209], v245 offset:51200
  v_mfma_f32_16x16x32_bf16 v[44:47], a[180:183], a[228:231], v[44:47]
  ds_read_b64_tr_b16 a[210:211], v245 offset:55296
  v_mfma_f32_16x16x32_bf16 v[40:43], a[180:183], a[224:227], v[40:43]
  ds_read_b64_tr_b16 a[212:213], v245 offset:59392
  v_mfma_f32_16x16x32_bf16 v[40:43], a[176:179], a[216:219], v[40:43]
  s_waitcnt vmcnt(20) lgkmcnt(11)
  s_barrier
  buffer_load_dwordx4 a[60:63], v137, s[36:39], s51 offen offset:3072 sc1
  v_mfma_f32_16x16x32_bf16 v[48:51], a[184:187], a[216:219], v[48:51]
  s_cmp_eq_u32 s87, 3
  s_cselect_b32 s73, 54, 40
  s_lshl_b32 s51, s73, 11
  v_mfma_f32_16x16x32_bf16 v[48:51], a[188:191], a[224:227], v[48:51]
  ds_read_b64_tr_b16 a[214:215], v245 offset:63488
  ds_read_b64_tr_b16 a[176:177], v246 offset:51200
  v_mfma_f32_16x16x32_bf16 v[52:55], a[188:191], a[228:231], v[52:55]
  ds_read_b64_tr_b16 a[178:179], v246 offset:55296
  ds_read_b64_tr_b16 a[180:181], v246 offset:59392
  v_mfma_f32_16x16x32_bf16 v[52:55], a[184:187], a[220:223], v[52:55]
  s_waitcnt lgkmcnt(11)
  buffer_load_dwordx4 a[64:67], v137, s[36:39], s51 offen offset:0 sc1
  ds_read_b64_tr_b16 a[182:183], v246 offset:63488
  v_mfma_f32_16x16x32_bf16 v[60:63], a[192:195], a[220:223], v[60:63]
  ds_read_b64_tr_b16 a[184:185], v247 offset:51200
  v_mfma_f32_16x16x32_bf16 v[60:63], a[196:199], a[228:231], v[60:63]
  ds_read_b64_tr_b16 a[186:187], v247 offset:55296
  v_mfma_f32_16x16x32_bf16 v[56:59], a[196:199], a[224:227], v[56:59]
  ds_read_b64_tr_b16 a[188:189], v247 offset:59392
  v_mfma_f32_16x16x32_bf16 v[56:59], a[192:195], a[216:219], v[56:59]
  s_waitcnt lgkmcnt(11)
  buffer_load_dwordx4 a[68:71], v137, s[36:39], s51 offen offset:1024 sc1
  s_lshl_b32 s50, s73, 16
  v_mfma_f32_16x16x32_bf16 v[144:147], a[200:203], a[216:219], v[144:147]
  s_add_u32 m0, s70, 49152
  ds_read_b64_tr_b16 a[190:191], v247 offset:63488
  ds_read_b64_tr_b16 a[192:193], v248 offset:0
  v_mfma_f32_16x16x32_bf16 v[144:147], a[204:207], a[224:227], v[144:147]
  ds_read_b64_tr_b16 a[194:195], v248 offset:4096
  v_mfma_f32_16x16x32_bf16 v[148:151], a[204:207], a[228:231], v[148:151]
  ds_read_b64_tr_b16 a[196:197], v248 offset:8192
  v_mfma_f32_16x16x32_bf16 v[148:151], a[200:203], a[220:223], v[148:151]
  s_waitcnt lgkmcnt(11)
  buffer_load_dwordx4 v135, s[24:27], s50 offen offset:2048 lds
  ds_read_b64_tr_b16 a[198:199], v248 offset:12288
  v_mfma_f32_16x16x32_bf16 v[156:159], a[208:211], a[220:223], v[156:159]
  ds_read_b64_tr_b16 a[200:201], v249 offset:0
  v_mfma_f32_16x16x32_bf16 v[156:159], a[212:215], a[228:231], v[156:159]
  ds_read_b64_tr_b16 a[202:203], v249 offset:4096
  v_mfma_f32_16x16x32_bf16 v[152:155], a[212:215], a[224:227], v[152:155]
  ds_read_b64_tr_b16 a[204:205], v249 offset:8192
  v_mfma_f32_16x16x32_bf16 v[152:155], a[208:211], a[216:219], v[152:155]
  s_waitcnt lgkmcnt(11)
  buffer_load_dwordx4 a[72:75], v137, s[36:39], s51 offen offset:2048 sc1
  ds_read_b64_tr_b16 a[206:207], v249 offset:12288
  v_mfma_f32_16x16x32_bf16 v[160:163], a[176:179], a[216:219], v[160:163]
  ds_read_b64_tr_b16 a[208:209], v250 offset:0
  v_mfma_f32_16x16x32_bf16 v[160:163], a[180:183], a[224:227], v[160:163]
  ds_read_b64_tr_b16 a[210:211], v250 offset:4096
  v_mfma_f32_16x16x32_bf16 v[164:167], a[180:183], a[228:231], v[164:167]
  buffer_load_dwordx4 v136, s[24:27], s50 offen offset:3072 lds
  ds_read_b64_tr_b16 a[212:213], v250 offset:8192
  v_mfma_f32_16x16x32_bf16 v[164:167], a[176:179], a[220:223], v[164:167]
  s_waitcnt lgkmcnt(11)
  ds_read_b64_tr_b16 a[214:215], v250 offset:12288
  v_mfma_f32_16x16x32_bf16 v[172:175], a[184:187], a[220:223], v[172:175]
  ds_read_b64_tr_b16 a[176:177], v251 offset:0
  v_mfma_f32_16x16x32_bf16 v[172:175], a[188:191], a[228:231], v[172:175]
  ds_read_b64_tr_b16 a[178:179], v251 offset:4096
  v_mfma_f32_16x16x32_bf16 v[168:171], a[188:191], a[224:227], v[168:171]
  buffer_load_dwordx4 a[76:79], v137, s[36:39], s51 offen offset:3072 sc1
  s_cmp_eq_u32 s87, 0
  v_mfma_f32_16x16x32_bf16 v[168:171], a[184:187], a[216:219], v[168:171]
  s_waitcnt vmcnt(26) lgkmcnt(10)
  s_cselect_b32 s74, 15, 43
  s_lshl_b32 s51, s74, 11
  v_mfma_f32_16x16x32_bf16 v[32:35], a[192:195], a[0:3], v[32:35]
  ds_read_b64_tr_b16 a[180:181], v251 offset:8192
  ds_read_b64_tr_b16 a[182:183], v251 offset:12288
  v_mfma_f32_16x16x32_bf16 v[32:35], a[196:199], a[8:11], v[32:35]
  ds_read_b64_tr_b16 a[184:185], v248 offset:2048
  ds_read_b64_tr_b16 a[186:187], v248 offset:6144
  v_mfma_f32_16x16x32_bf16 v[36:39], a[196:199], a[12:15], v[36:39]
  buffer_load_dwordx4 a[80:83], v137, s[36:39], s51 offen offset:0 sc1
  ds_read_b64_tr_b16 a[188:189], v248 offset:10240
  v_mfma_f32_16x16x32_bf16 v[36:39], a[192:195], a[4:7], v[36:39]
  s_waitcnt lgkmcnt(11)
  ds_read_b64_tr_b16 a[190:191], v248 offset:14336
  v_mfma_f32_16x16x32_bf16 v[44:47], a[200:203], a[4:7], v[44:47]
  ds_read_b64_tr_b16 a[192:193], v249 offset:2048
  v_mfma_f32_16x16x32_bf16 v[44:47], a[204:207], a[12:15], v[44:47]
  ds_read_b64_tr_b16 a[194:195], v249 offset:6144
  v_mfma_f32_16x16x32_bf16 v[40:43], a[204:207], a[8:11], v[40:43]
  buffer_load_dwordx4 a[84:87], v137, s[36:39], s51 offen offset:1024 sc1
  s_lshl_b32 s50, s74, 16
  v_mfma_f32_16x16x32_bf16 v[40:43], a[200:203], a[0:3], v[40:43]
  s_waitcnt vmcnt(21) lgkmcnt(10)
  s_barrier
  s_add_u32 m0, s70, 65536
  v_mfma_f32_16x16x32_bf16 v[48:51], a[208:211], a[0:3], v[48:51]
  ds_read_b64_tr_b16 a[196:197], v249 offset:10240
  ds_read_b64_tr_b16 a[198:199], v249 offset:14336
  v_mfma_f32_16x16x32_bf16 v[48:51], a[212:215], a[8:11], v[48:51]
  ds_read_b64_tr_b16 a[200:201], v250 offset:2048
  ds_read_b64_tr_b16 a[202:203], v250 offset:6144
  v_mfma_f32_16x16x32_bf16 v[52:55], a[212:215], a[12:15], v[52:55]
  buffer_load_dwordx4 v135, s[24:27], s50 offen offset:2048 lds
  ds_read_b64_tr_b16 a[204:205], v250 offset:10240
  v_mfma_f32_16x16x32_bf16 v[52:55], a[208:211], a[4:7], v[52:55]
  s_waitcnt lgkmcnt(11)
  ds_read_b64_tr_b16 a[206:207], v250 offset:14336
  v_mfma_f32_16x16x32_bf16 v[60:63], a[176:179], a[4:7], v[60:63]
  ds_read_b64_tr_b16 a[208:209], v251 offset:2048
  v_mfma_f32_16x16x32_bf16 v[60:63], a[180:183], a[12:15], v[60:63]
  buffer_load_dwordx4 a[88:91], v137, s[36:39], s51 offen offset:2048 sc1
  ds_read_b64_tr_b16 a[210:211], v251 offset:6144
  v_mfma_f32_16x16x32_bf16 v[56:59], a[180:183], a[8:11], v[56:59]
  ds_read_b64_tr_b16 a[212:213], v251 offset:10240
  v_mfma_f32_16x16x32_bf16 v[56:59], a[176:179], a[0:3], v[56:59]
  s_waitcnt lgkmcnt(11)
  ds_read_b64_tr_b16 a[214:215], v251 offset:14336
  v_mfma_f32_16x16x32_bf16 v[144:147], a[184:187], a[0:3], v[144:147]
  ds_read_b64_tr_b16 a[176:177], v240 offset:0
  v_mfma_f32_16x16x32_bf16 v[144:147], a[188:191], a[8:11], v[144:147]
  buffer_load_dwordx4 v136, s[24:27], s50 offen offset:3072 lds
  ds_read_b64_tr_b16 a[178:179], v240 offset:4096
  v_mfma_f32_16x16x32_bf16 v[148:151], a[188:191], a[12:15], v[148:151]
  ds_read_b64_tr_b16 a[180:181], v240 offset:8192
  v_mfma_f32_16x16x32_bf16 v[148:151], a[184:187], a[4:7], v[148:151]
  s_waitcnt lgkmcnt(11)
  ds_read_b64_tr_b16 a[182:183], v240 offset:12288
  v_mfma_f32_16x16x32_bf16 v[156:159], a[192:195], a[4:7], v[156:159]
  ds_read_b64_tr_b16 a[184:185], v241 offset:0
  v_mfma_f32_16x16x32_bf16 v[156:159], a[196:199], a[12:15], v[156:159]
  buffer_load_dwordx4 a[92:95], v137, s[36:39], s51 offen offset:3072 sc1
  s_cmp_eq_u32 s87, 1
  v_mfma_f32_16x16x32_bf16 v[152:155], a[196:199], a[8:11], v[152:155]
  s_cselect_b32 s75, 5, 47
  s_lshl_b32 s51, s75, 11
  ds_read_b64_tr_b16 a[186:187], v241 offset:4096
  v_mfma_f32_16x16x32_bf16 v[152:155], a[192:195], a[0:3], v[152:155]
  s_waitcnt lgkmcnt(10)
  ds_read_b64_tr_b16 a[188:189], v241 offset:8192
  ds_read_b64_tr_b16 a[190:191], v241 offset:12288
  v_mfma_f32_16x16x32_bf16 v[160:163], a[200:203], a[0:3], v[160:163]
  ds_read_b64_tr_b16 a[192:193], v242 offset:0
  v_mfma_f32_16x16x32_bf16 v[160:163], a[204:207], a[8:11], v[160:163]
  buffer_load_dwordx4 a[96:99], v137, s[36:39], s51 offen offset:0 sc1
  ds_read_b64_tr_b16 a[194:195], v242 offset:4096
  v_mfma_f32_16x16x32_bf16 v[164:167], a[204:207], a[12:15], v[164:167]
  ds_read_b64_tr_b16 a[196:197], v242 offset:8192
  v_mfma_f32_16x16x32_bf16 v[164:167], a[200:203], a[4:7], v[164:167]
  s_waitcnt lgkmcnt(11)
  ds_read_b64_tr_b16 a[198:199], v242 offset:12288
  v_mfma_f32_16x16x32_bf16 v[172:175], a[208:211], a[4:7], v[172:175]
  ds_read_b64_tr_b16 a[200:201], v243 offset:0
  v_mfma_f32_16x16x32_bf16 v[172:175], a[212:215], a[12:15], v[172:175]
  buffer_load_dwordx4 a[100:103], v137, s[36:39], s51 offen offset:1024 sc1
  s_lshl_b32 s50, s75, 16
  v_mfma_f32_16x16x32_bf16 v[168:171], a[212:215], a[8:11], v[168:171]
  s_add_u32 m0, s70, 81920
  ds_read_b64_tr_b16 a[202:203], v243 offset:4096
  ds_read_b64_tr_b16 a[204:205], v243 offset:8192
  v_mfma_f32_16x16x32_bf16 v[168:171], a[208:211], a[0:3], v[168:171]
  s_waitcnt vmcnt(26) lgkmcnt(11)
  ds_read_b64_tr_b16 a[206:207], v243 offset:12288
  v_mfma_f32_16x16x32_bf16 v[32:35], a[176:179], a[16:19], v[32:35]
  buffer_load_dwordx4 v135, s[24:27], s50 offen offset:2048 lds
  ds_read_b64_tr_b16 a[208:209], v240 offset:2048
  v_mfma_f32_16x16x32_bf16 v[32:35], a[180:183], a[24:27], v[32:35]
  ds_read_b64_tr_b16 a[210:211], v240 offset:6144
  v_mfma_f32_16x16x32_bf16 v[36:39], a[180:183], a[28:31], v[36:39]
  ds_read_b64_tr_b16 a[212:213], v240 offset:10240
  v_mfma_f32_16x16x32_bf16 v[36:39], a[176:179], a[20:23], v[36:39]
  s_waitcnt lgkmcnt(11)
  ds_read_b64_tr_b16 a[214:215], v240 offset:14336
  v_mfma_f32_16x16x32_bf16 v[44:47], a[184:187], a[20:23], v[44:47]
  buffer_load_dwordx4 a[104:107], v137, s[36:39], s51 offen offset:2048 sc1
  ds_read_b64_tr_b16 a[176:177], v241 offset:2048
  v_mfma_f32_16x16x32_bf16 v[44:47], a[188:191], a[28:31], v[44:47]
  ds_read_b64_tr_b16 a[178:179], v241 offset:6144
  v_mfma_f32_16x16x32_bf16 v[40:43], a[188:191], a[24:27], v[40:43]
  ds_read_b64_tr_b16 a[180:181], v241 offset:10240
  v_mfma_f32_16x16x32_bf16 v[40:43], a[184:187], a[16:19], v[40:43]
  s_waitcnt vmcnt(23) lgkmcnt(11)
  s_barrier
  ds_read_b64_tr_b16 a[182:183], v241 offset:14336
  v_mfma_f32_16x16x32_bf16 v[48:51], a[192:195], a[16:19], v[48:51]
  buffer_load_dwordx4 v136, s[24:27], s50 offen offset:3072 lds
  ds_read_b64_tr_b16 a[184:185], v242 offset:2048
  v_mfma_f32_16x16x32_bf16 v[48:51], a[196:199], a[24:27], v[48:51]
  ds_read_b64_tr_b16 a[186:187], v242 offset:6144
  v_mfma_f32_16x16x32_bf16 v[52:55], a[196:199], a[28:31], v[52:55]
  ds_read_b64_tr_b16 a[188:189], v242 offset:10240
  v_mfma_f32_16x16x32_bf16 v[52:55], a[192:195], a[20:23], v[52:55]
  s_waitcnt lgkmcnt(11)
  ds_read_b64_tr_b16 a[190:191], v242 offset:14336
  v_mfma_f32_16x16x32_bf16 v[60:63], a[200:203], a[20:23], v[60:63]
  buffer_load_dwordx4 a[108:111], v137, s[36:39], s51 offen offset:3072 sc1
  s_cmp_eq_u32 s87, 2
  v_mfma_f32_16x16x32_bf16 v[60:63], a[204:207], a[28:31], v[60:63]
  s_cselect_b32 s79, 8, 50
  s_lshl_b32 s51, s79, 11
  ds_read_b64_tr_b16 a[192:193], v243 offset:2048
  v_mfma_f32_16x16x32_bf16 v[56:59], a[204:207], a[24:27], v[56:59]
  ds_read_b64_tr_b16 a[194:195], v243 offset:6144
  ds_read_b64_tr_b16 a[196:197], v243 offset:10240
  v_mfma_f32_16x16x32_bf16 v[56:59], a[200:203], a[16:19], v[56:59]
  s_waitcnt lgkmcnt(11)
  ds_read_b64_tr_b16 a[198:199], v243 offset:14336
  v_mfma_f32_16x16x32_bf16 v[144:147], a[208:211], a[16:19], v[144:147]
  buffer_load_dwordx4 a[112:115], v137, s[36:39], s51 offen offset:0 sc1
  ds_read_b64_tr_b16 a[200:201], v240 offset:18432
  v_mfma_f32_16x16x32_bf16 v[144:147], a[212:215], a[24:27], v[144:147]
  ds_read_b64_tr_b16 a[202:203], v240 offset:22528
  v_mfma_f32_16x16x32_bf16 v[148:151], a[212:215], a[28:31], v[148:151]
  ds_read_b64_tr_b16 a[204:205], v240 offset:26624
  v_mfma_f32_16x16x32_bf16 v[148:151], a[208:211], a[20:23], v[148:151]
  s_waitcnt lgkmcnt(11)
  buffer_load_dwordx4 a[116:119], v137, s[36:39], s51 offen offset:1024 sc1
  s_lshl_b32 s50, s79, 16
  v_mfma_f32_16x16x32_bf16 v[156:159], a[176:179], a[20:23], v[156:159]
  s_add_u32 m0, s70, 98304
  ds_read_b64_tr_b16 a[206:207], v240 offset:30720
  ds_read_b64_tr_b16 a[208:209], v241 offset:18432
  v_mfma_f32_16x16x32_bf16 v[156:159], a[180:183], a[28:31], v[156:159]
  ds_read_b64_tr_b16 a[210:211], v241 offset:22528
  v_mfma_f32_16x16x32_bf16 v[152:155], a[180:183], a[24:27], v[152:155]
  ds_read_b64_tr_b16 a[212:213], v241 offset:26624
  v_mfma_f32_16x16x32_bf16 v[152:155], a[176:179], a[16:19], v[152:155]
  s_waitcnt vmcnt(21) lgkmcnt(11)
  s_barrier
  buffer_load_dwordx4 v135, s[24:27], s50 offen offset:2048 lds
  v_mfma_f32_16x16x32_bf16 v[160:163], a[184:187], a[16:19], v[160:163]
  ds_read_b64_tr_b16 a[214:215], v241 offset:30720
  ds_read_b64_tr_b16 a[176:177], v242 offset:18432
  v_mfma_f32_16x16x32_bf16 v[160:163], a[188:191], a[24:27], v[160:163]
  ds_read_b64_tr_b16 a[178:179], v242 offset:22528
  v_mfma_f32_16x16x32_bf16 v[164:167], a[188:191], a[28:31], v[164:167]
  ds_read_b64_tr_b16 a[180:181], v242 offset:26624
  v_mfma_f32_16x16x32_bf16 v[164:167], a[184:187], a[20:23], v[164:167]
  s_waitcnt lgkmcnt(11)
  buffer_load_dwordx4 a[120:123], v137, s[36:39], s51 offen offset:2048 sc1
  ds_read_b64_tr_b16 a[182:183], v242 offset:30720
  v_mfma_f32_16x16x32_bf16 v[172:175], a[192:195], a[20:23], v[172:175]
  ds_read_b64_tr_b16 a[184:185], v243 offset:18432
  v_mfma_f32_16x16x32_bf16 v[172:175], a[196:199], a[28:31], v[172:175]
  ds_read_b64_tr_b16 a[186:187], v243 offset:22528
  v_mfma_f32_16x16x32_bf16 v[168:171], a[196:199], a[24:27], v[168:171]
  ds_read_b64_tr_b16 a[188:189], v243 offset:26624
  v_mfma_f32_16x16x32_bf16 v[168:171], a[192:195], a[16:19], v[168:171]
  s_waitcnt vmcnt(28) lgkmcnt(11)
  buffer_load_dwordx4 v136, s[24:27], s50 offen offset:3072 lds
  ds_read_b64_tr_b16 a[190:191], v243 offset:30720
  v_mfma_f32_16x16x32_bf16 v[144:147], a[200:203], a[32:35], v[144:147]
  ds_read_b64_tr_b16 a[192:193], v240 offset:34816
  v_mfma_f32_16x16x32_bf16 v[144:147], a[204:207], a[40:43], v[144:147]
  ds_read_b64_tr_b16 a[194:195], v240 offset:38912
  v_mfma_f32_16x16x32_bf16 v[148:151], a[204:207], a[44:47], v[148:151]
  ds_read_b64_tr_b16 a[196:197], v240 offset:43008
  v_mfma_f32_16x16x32_bf16 v[148:151], a[200:203], a[36:39], v[148:151]
  s_waitcnt lgkmcnt(11)
  buffer_load_dwordx4 a[124:127], v137, s[36:39], s51 offen offset:3072 sc1
  s_cmp_eq_u32 s87, 3
  v_mfma_f32_16x16x32_bf16 v[156:159], a[208:211], a[36:39], v[156:159]
  s_cselect_b32 s80, 12, 54
  s_lshl_b32 s51, s80, 11
  ds_read_b64_tr_b16 a[198:199], v240 offset:47104
  v_mfma_f32_16x16x32_bf16 v[156:159], a[212:215], a[44:47], v[156:159]
  ds_read_b64_tr_b16 a[200:201], v241 offset:34816
  ds_read_b64_tr_b16 a[202:203], v241 offset:38912
  v_mfma_f32_16x16x32_bf16 v[152:155], a[212:215], a[40:43], v[152:155]
  buffer_load_dwordx4 a[216:219], v137, s[36:39], s51 offen offset:0 sc1
  ds_read_b64_tr_b16 a[204:205], v241 offset:43008
  v_mfma_f32_16x16x32_bf16 v[152:155], a[208:211], a[32:35], v[152:155]
  s_waitcnt vmcnt(20) lgkmcnt(11)
  s_barrier
  ds_read_b64_tr_b16 a[206:207], v241 offset:47104
  v_mfma_f32_16x16x32_bf16 v[160:163], a[176:179], a[32:35], v[160:163]
  ds_read_b64_tr_b16 a[208:209], v242 offset:34816
  v_mfma_f32_16x16x32_bf16 v[160:163], a[180:183], a[40:43], v[160:163]
  ds_read_b64_tr_b16 a[210:211], v242 offset:38912
  v_mfma_f32_16x16x32_bf16 v[164:167], a[180:183], a[44:47], v[164:167]
  buffer_load_dwordx4 a[220:223], v137, s[36:39], s51 offen offset:1024 sc1
  s_lshl_b32 s50, s80, 16
  v_mfma_f32_16x16x32_bf16 v[164:167], a[176:179], a[36:39], v[164:167]
  s_waitcnt lgkmcnt(10)
  s_add_u32 m0, s70, 114688
  ds_read_b64_tr_b16 a[212:213], v242 offset:43008
  v_mfma_f32_16x16x32_bf16 v[172:175], a[184:187], a[36:39], v[172:175]
  ds_read_b64_tr_b16 a[214:215], v242 offset:47104
  ds_read_b64_tr_b16 a[176:177], v243 offset:34816
  v_mfma_f32_16x16x32_bf16 v[172:175], a[188:191], a[44:47], v[172:175]
  ds_read_b64_tr_b16 a[178:179], v243 offset:38912
  v_mfma_f32_16x16x32_bf16 v[168:171], a[188:191], a[40:43], v[168:171]
  buffer_load_dwordx4 v135, s[24:27], s50 offen offset:2048 lds
  ds_read_b64_tr_b16 a[180:181], v243 offset:43008
  v_mfma_f32_16x16x32_bf16 v[168:171], a[184:187], a[32:35], v[168:171]
  s_waitcnt vmcnt(27) lgkmcnt(11)
  ds_read_b64_tr_b16 a[182:183], v243 offset:47104
  v_mfma_f32_16x16x32_bf16 v[144:147], a[192:195], a[48:51], v[144:147]
  ds_read_b64_tr_b16 a[184:185], v240 offset:51200
  v_mfma_f32_16x16x32_bf16 v[144:147], a[196:199], a[56:59], v[144:147]
  ds_read_b64_tr_b16 a[186:187], v240 offset:55296
  v_mfma_f32_16x16x32_bf16 v[148:151], a[196:199], a[60:63], v[148:151]
  buffer_load_dwordx4 a[224:227], v137, s[36:39], s51 offen offset:2048 sc1
  ds_read_b64_tr_b16 a[188:189], v240 offset:59392
  v_mfma_f32_16x16x32_bf16 v[148:151], a[192:195], a[52:55], v[148:151]
  s_waitcnt lgkmcnt(11)
  ds_read_b64_tr_b16 a[190:191], v240 offset:63488
  v_mfma_f32_16x16x32_bf16 v[156:159], a[200:203], a[52:55], v[156:159]
  ds_read_b64_tr_b16 a[192:193], v241 offset:51200
  v_mfma_f32_16x16x32_bf16 v[156:159], a[204:207], a[60:63], v[156:159]
  ds_read_b64_tr_b16 a[194:195], v241 offset:55296
  v_mfma_f32_16x16x32_bf16 v[152:155], a[204:207], a[56:59], v[152:155]
  buffer_load_dwordx4 v136, s[24:27], s50 offen offset:3072 lds
  ds_read_b64_tr_b16 a[196:197], v241 offset:59392
  v_mfma_f32_16x16x32_bf16 v[152:155], a[200:203], a[48:51], v[152:155]
  s_waitcnt vmcnt(18) lgkmcnt(11)
  s_barrier
  ds_read_b64_tr_b16 a[198:199], v241 offset:63488
  v_mfma_f32_16x16x32_bf16 v[160:163], a[208:211], a[48:51], v[160:163]
  ds_read_b64_tr_b16 a[200:201], v242 offset:51200
  v_mfma_f32_16x16x32_bf16 v[160:163], a[212:215], a[56:59], v[160:163]
  ds_read_b64_tr_b16 a[202:203], v242 offset:55296
  v_mfma_f32_16x16x32_bf16 v[164:167], a[212:215], a[60:63], v[164:167]
  buffer_load_dwordx4 a[228:231], v137, s[36:39], s51 offen offset:3072 sc1
  s_lshl_b32 s50, s71, 16
  v_mfma_f32_16x16x32_bf16 v[164:167], a[208:211], a[52:55], v[164:167]
  s_waitcnt lgkmcnt(10)
  s_add_u32 m0, s70, 16384
  ds_read_b64_tr_b16 a[204:205], v242 offset:59392
  v_mfma_f32_16x16x32_bf16 v[172:175], a[176:179], a[52:55], v[172:175]
  ds_read_b64_tr_b16 a[206:207], v242 offset:63488
  ds_read_b64_tr_b16 a[208:209], v243 offset:51200
  v_mfma_f32_16x16x32_bf16 v[172:175], a[180:183], a[60:63], v[172:175]
  ds_read_b64_tr_b16 a[210:211], v243 offset:55296
  v_mfma_f32_16x16x32_bf16 v[168:171], a[180:183], a[56:59], v[168:171]
  buffer_load_dwordx4 v133, s[24:27], s50 offen offset:0 lds
  ds_read_b64_tr_b16 a[212:213], v243 offset:59392
  v_mfma_f32_16x16x32_bf16 v[168:171], a[176:179], a[48:51], v[168:171]
  s_waitcnt vmcnt(25) lgkmcnt(11)
  ds_read_b64_tr_b16 a[214:215], v243 offset:63488
  v_mfma_f32_16x16x32_bf16 v[144:147], a[184:187], a[64:67], v[144:147]
  ds_read_b64_tr_b16 a[176:177], v244 offset:2048
  v_mfma_f32_16x16x32_bf16 v[144:147], a[188:191], a[72:75], v[144:147]
  ds_read_b64_tr_b16 a[178:179], v244 offset:6144
  v_mfma_f32_16x16x32_bf16 v[148:151], a[188:191], a[76:79], v[148:151]
  buffer_load_dwordx4 v134, s[24:27], s50 offen offset:1024 lds
  s_lshl_b32 s50, s72, 16
  v_mfma_f32_16x16x32_bf16 v[148:151], a[184:187], a[68:71], v[148:151]
  s_waitcnt lgkmcnt(10)
  s_add_u32 m0, s70, 32768
  ds_read_b64_tr_b16 a[180:181], v244 offset:10240
  v_mfma_f32_16x16x32_bf16 v[156:159], a[192:195], a[68:71], v[156:159]
  ds_read_b64_tr_b16 a[182:183], v244 offset:14336
  ds_read_b64_tr_b16 a[184:185], v245 offset:2048
  v_mfma_f32_16x16x32_bf16 v[156:159], a[196:199], a[76:79], v[156:159]
  ds_read_b64_tr_b16 a[186:187], v245 offset:6144
  v_mfma_f32_16x16x32_bf16 v[152:155], a[196:199], a[72:75], v[152:155]
  buffer_load_dwordx4 v133, s[24:27], s50 offen offset:0 lds
  ds_read_b64_tr_b16 a[188:189], v245 offset:10240
  v_mfma_f32_16x16x32_bf16 v[152:155], a[192:195], a[64:67], v[152:155]
  s_waitcnt vmcnt(16) lgkmcnt(11)
  s_barrier
  ds_read_b64_tr_b16 a[190:191], v245 offset:14336
  v_mfma_f32_16x16x32_bf16 v[160:163], a[200:203], a[64:67], v[160:163]
  ds_read_b64_tr_b16 a[192:193], v246 offset:2048
  v_mfma_f32_16x16x32_bf16 v[160:163], a[204:207], a[72:75], v[160:163]
  ds_read_b64_tr_b16 a[194:195], v246 offset:6144
  v_mfma_f32_16x16x32_bf16 v[164:167], a[204:207], a[76:79], v[164:167]
  buffer_load_dwordx4 v134, s[24:27], s50 offen offset:1024 lds
  s_lshl_b32 s50, s73, 16
  v_mfma_f32_16x16x32_bf16 v[164:167], a[200:203], a[68:71], v[164:167]
  s_waitcnt lgkmcnt(10)
  s_add_u32 m0, s70, 49152
  ds_read_b64_tr_b16 a[196:197], v246 offset:10240
  v_mfma_f32_16x16x32_bf16 v[172:175], a[208:211], a[68:71], v[172:175]
Hb2_3:
  s_cbranch_execz Rb
  ds_read_b64_tr_b16 a[198:199], v246 offset:14336
  ds_read_b64_tr_b16 a[200:201], v247 offset:2048
  v_mfma_f32_16x16x32_bf16 v[172:175], a[212:215], a[76:79], v[172:175]
  ds_read_b64_tr_b16 a[202:203], v247 offset:6144
  v_mfma_f32_16x16x32_bf16 v[168:171], a[212:215], a[72:75], v[168:171]
  buffer_load_dwordx4 v133, s[24:27], s50 offen offset:0 lds
  ds_read_b64_tr_b16 a[204:205], v247 offset:10240
  v_mfma_f32_16x16x32_bf16 v[168:171], a[208:211], a[64:67], v[168:171]
  s_waitcnt vmcnt(23) lgkmcnt(11)
  ds_read_b64_tr_b16 a[206:207], v247 offset:14336
  v_mfma_f32_16x16x32_bf16 v[144:147], a[176:179], a[80:83], v[144:147]
  ds_read_b64_tr_b16 a[208:209], v244 offset:18432
  v_mfma_f32_16x16x32_bf16 v[144:147], a[180:183], a[88:91], v[144:147]
  ds_read_b64_tr_b16 a[210:211], v244 offset:22528
  v_mfma_f32_16x16x32_bf16 v[148:151], a[180:183], a[92:95], v[148:151]
  buffer_load_dwordx4 v134, s[24:27], s50 offen offset:1024 lds
  s_lshl_b32 s50, s74, 16
  v_mfma_f32_16x16x32_bf16 v[148:151], a[176:179], a[84:87], v[148:151]
  s_waitcnt lgkmcnt(10)
  s_add_u32 m0, s70, 65536
  ds_read_b64_tr_b16 a[212:213], v244 offset:26624
  v_mfma_f32_16x16x32_bf16 v[156:159], a[184:187], a[84:87], v[156:159]
  ds_read_b64_tr_b16 a[214:215], v244 offset:30720
  ds_read_b64_tr_b16 a[176:177], v245 offset:18432
  v_mfma_f32_16x16x32_bf16 v[156:159], a[188:191], a[92:95], v[156:159]
  ds_read_b64_tr_b16 a[178:179], v245 offset:22528
  v_mfma_f32_16x16x32_bf16 v[152:155], a[188:191], a[88:91], v[152:155]
  buffer_load_dwordx4 v133, s[24:27], s50 offen offset:0 lds
  ds_read_b64_tr_b16 a[180:181], v245 offset:26624
  v_mfma_f32_16x16x32_bf16 v[152:155], a[184:187], a[80:83], v[152:155]
  s_waitcnt vmcnt(14) lgkmcnt(11)
  s_barrier
  ds_read_b64_tr_b16 a[182:183], v245 offset:30720
  v_mfma_f32_16x16x32_bf16 v[160:163], a[192:195], a[80:83], v[160:163]
  ds_read_b64_tr_b16 a[184:185], v246 offset:18432
  v_mfma_f32_16x16x32_bf16 v[160:163], a[196:199], a[88:91], v[160:163]
  ds_read_b64_tr_b16 a[186:187], v246 offset:22528
  v_mfma_f32_16x16x32_bf16 v[164:167], a[196:199], a[92:95], v[164:167]
  buffer_load_dwordx4 v134, s[24:27], s50 offen offset:1024 lds
  s_lshl_b32 s50, s75, 16
  v_mfma_f32_16x16x32_bf16 v[164:167], a[192:195], a[84:87], v[164:167]
  s_waitcnt lgkmcnt(10)
  s_add_u32 m0, s70, 81920
  ds_read_b64_tr_b16 a[188:189], v246 offset:26624
  v_mfma_f32_16x16x32_bf16 v[172:175], a[200:203], a[84:87], v[172:175]
  ds_read_b64_tr_b16 a[190:191], v246 offset:30720
  ds_read_b64_tr_b16 a[192:193], v247 offset:18432
  v_mfma_f32_16x16x32_bf16 v[172:175], a[204:207], a[92:95], v[172:175]
  ds_read_b64_tr_b16 a[194:195], v247 offset:22528
  v_mfma_f32_16x16x32_bf16 v[168:171], a[204:207], a[88:91], v[168:171]
  buffer_load_dwordx4 v133, s[24:27], s50 offen offset:0 lds
  ds_read_b64_tr_b16 a[196:197], v247 offset:26624
  v_mfma_f32_16x16x32_bf16 v[168:171], a[200:203], a[80:83], v[168:171]
  s_waitcnt vmcnt(21) lgkmcnt(11)
  ds_read_b64_tr_b16 a[198:199], v247 offset:30720
  v_mfma_f32_16x16x32_bf16 v[144:147], a[208:211], a[96:99], v[144:147]
  ds_read_b64_tr_b16 a[200:201], v244 offset:34816
  v_mfma_f32_16x16x32_bf16 v[144:147], a[212:215], a[104:107], v[144:147]
  ds_read_b64_tr_b16 a[202:203], v244 offset:38912
  v_mfma_f32_16x16x32_bf16 v[148:151], a[212:215], a[108:111], v[148:151]
  buffer_load_dwordx4 v134, s[24:27], s50 offen offset:1024 lds
  s_lshl_b32 s50, s79, 16
  v_mfma_f32_16x16x32_bf16 v[148:151], a[208:211], a[100:103], v[148:151]
  s_waitcnt lgkmcnt(10)
  s_add_u32 m0, s70, 98304
  ds_read_b64_tr_b16 a[204:205], v244 offset:43008
  v_mfma_f32_16x16x32_bf16 v[156:159], a[176:179], a[100:103], v[156:159]
  ds_read_b64_tr_b16 a[206:207], v244 offset:47104
  ds_read_b64_tr_b16 a[208:209], v245 offset:34816
  v_mfma_f32_16x16x32_bf16 v[156:159], a[180:183], a[108:111], v[156:159]
  ds_read_b64_tr_b16 a[210:211], v245 offset:38912
  v_mfma_f32_16x16x32_bf16 v[152:155], a[180:183], a[104:107], v[152:155]
  buffer_load_dwordx4 v133, s[24:27], s50 offen offset:0 lds
  ds_read_b64_tr_b16 a[212:213], v245 offset:43008
  v_mfma_f32_16x16x32_bf16 v[152:155], a[176:179], a[96:99], v[152:155]
  s_waitcnt vmcnt(12) lgkmcnt(11)
  s_barrier
  ds_read_b64_tr_b16 a[214:215], v245 offset:47104
  v_mfma_f32_16x16x32_bf16 v[160:163], a[184:187], a[96:99], v[160:163]
  ds_read_b64_tr_b16 a[176:177], v246 offset:34816
  v_mfma_f32_16x16x32_bf16 v[160:163], a[188:191], a[104:107], v[160:163]
  ds_read_b64_tr_b16 a[178:179], v246 offset:38912
  v_mfma_f32_16x16x32_bf16 v[164:167], a[188:191], a[108:111], v[164:167]
  buffer_load_dwordx4 v134, s[24:27], s50 offen offset:1024 lds
  s_lshl_b32 s50, s80, 16
  v_mfma_f32_16x16x32_bf16 v[164:167], a[184:187], a[100:103], v[164:167]
  s_waitcnt lgkmcnt(10)
  s_add_u32 m0, s70, 114688
  ds_read_b64_tr_b16 a[180:181], v246 offset:43008
  v_mfma_f32_16x16x32_bf16 v[172:175], a[192:195], a[100:103], v[172:175]
  ds_read_b64_tr_b16 a[182:183], v246 offset:47104
  ds_read_b64_tr_b16 a[184:185], v247 offset:34816
  v_mfma_f32_16x16x32_bf16 v[172:175], a[196:199], a[108:111], v[172:175]
  ds_read_b64_tr_b16 a[186:187], v247 offset:38912
  v_mfma_f32_16x16x32_bf16 v[168:171], a[196:199], a[104:107], v[168:171]
  buffer_load_dwordx4 v133, s[24:27], s50 offen offset:0 lds
  ds_read_b64_tr_b16 a[188:189], v247 offset:43008
  v_mfma_f32_16x16x32_bf16 v[168:171], a[192:195], a[96:99], v[168:171]
  s_waitcnt vmcnt(19) lgkmcnt(11)
  ds_read_b64_tr_b16 a[190:191], v247 offset:47104
  v_mfma_f32_16x16x32_bf16 v[144:147], a[200:203], a[112:115], v[144:147]
  ds_read_b64_tr_b16 a[192:193], v244 offset:51200
  v_mfma_f32_16x16x32_bf16 v[144:147], a[204:207], a[120:123], v[144:147]
  ds_read_b64_tr_b16 a[194:195], v244 offset:55296
  v_mfma_f32_16x16x32_bf16 v[148:151], a[204:207], a[124:127], v[148:151]
  buffer_load_dwordx4 v134, s[24:27], s50 offen offset:1024 lds
  ds_read_b64_tr_b16 a[196:197], v244 offset:59392
  v_mfma_f32_16x16x32_bf16 v[148:151], a[200:203], a[116:119], v[148:151]
  s_waitcnt lgkmcnt(11)
  ds_read_b64_tr_b16 a[198:199], v244 offset:63488
  v_mfma_f32_16x16x32_bf16 v[156:159], a[208:211], a[116:119], v[156:159]
  ds_read_b64_tr_b16 a[200:201], v245 offset:51200
  v_mfma_f32_16x16x32_bf16 v[156:159], a[212:215], a[124:127], v[156:159]
  ds_read_b64_tr_b16 a[202:203], v245 offset:55296
  v_mfma_f32_16x16x32_bf16 v[152:155], a[212:215], a[120:123], v[152:155]
  ds_read_b64_tr_b16 a[204:205], v245 offset:59392
  v_mfma_f32_16x16x32_bf16 v[152:155], a[208:211], a[112:115], v[152:155]
  s_waitcnt vmcnt(12) lgkmcnt(11)
  s_barrier
  ds_read_b64_tr_b16 a[206:207], v245 offset:63488
  v_mfma_f32_16x16x32_bf16 v[160:163], a[176:179], a[112:115], v[160:163]
  ds_read_b64_tr_b16 a[208:209], v246 offset:51200
  v_mfma_f32_16x16x32_bf16 v[160:163], a[180:183], a[120:123], v[160:163]
  ds_read_b64_tr_b16 a[210:211], v246 offset:55296
  v_mfma_f32_16x16x32_bf16 v[164:167], a[180:183], a[124:127], v[164:167]
  ds_read_b64_tr_b16 a[212:213], v246 offset:59392
  v_mfma_f32_16x16x32_bf16 v[164:167], a[176:179], a[116:119], v[164:167]
  s_waitcnt lgkmcnt(11)
  ds_read_b64_tr_b16 a[214:215], v246 offset:63488
  v_mfma_f32_16x16x32_bf16 v[172:175], a[184:187], a[116:119], v[172:175]
  ds_read_b64_tr_b16 a[176:177], v247 offset:51200
  v_mfma_f32_16x16x32_bf16 v[172:175], a[188:191], a[124:127], v[172:175]
  ds_read_b64_tr_b16 a[178:179], v247 offset:55296
  v_mfma_f32_16x16x32_bf16 v[168:171], a[188:191], a[120:123], v[168:171]
  ds_read_b64_tr_b16 a[180:181], v247 offset:59392
  v_mfma_f32_16x16x32_bf16 v[168:171], a[184:187], a[112:115], v[168:171]
  s_waitcnt vmcnt(14) lgkmcnt(11)
  ds_read_b64_tr_b16 a[182:183], v247 offset:63488
  v_mfma_f32_16x16x32_bf16 v[144:147], a[192:195], a[216:219], v[144:147]
  ds_read_b64_tr_b16 a[184:185], v240 offset:16384
  v_mfma_f32_16x16x32_bf16 v[144:147], a[196:199], a[224:227], v[144:147]
  ds_read_b64_tr_b16 a[186:187], v240 offset:20480
  v_mfma_f32_16x16x32_bf16 v[148:151], a[196:199], a[228:231], v[148:151]
  ds_read_b64_tr_b16 a[188:189], v240 offset:24576
  v_mfma_f32_16x16x32_bf16 v[148:151], a[192:195], a[220:223], v[148:151]
  s_waitcnt lgkmcnt(11)
  ds_read_b64_tr_b16 a[190:191], v240 offset:28672
  v_mfma_f32_16x16x32_bf16 v[156:159], a[200:203], a[220:223], v[156:159]
  ds_read_b64_tr_b16 a[192:193], v241 offset:16384
  v_mfma_f32_16x16x32_bf16 v[156:159], a[204:207], a[228:231], v[156:159]
  ds_read_b64_tr_b16 a[194:195], v241 offset:20480
  v_mfma_f32_16x16x32_bf16 v[152:155], a[204:207], a[224:227], v[152:155]
  ds_read_b64_tr_b16 a[196:197], v241 offset:24576
  v_mfma_f32_16x16x32_bf16 v[152:155], a[200:203], a[216:219], v[152:155]
  s_waitcnt vmcnt(10) lgkmcnt(11)
  s_barrier
  ds_read_b64_tr_b16 a[198:199], v241 offset:28672
  v_mfma_f32_16x16x32_bf16 v[160:163], a[208:211], a[216:219], v[160:163]
  ds_read_b64_tr_b16 a[200:201], v242 offset:16384
  buffer_store_dwordx4 v[144:147], v0, s[36:39], s61 offen offset:0 sc1
  v_mfma_f32_16x16x32_bf16 v[160:163], a[212:215], a[224:227], v[160:163]
  buffer_store_dwordx4 v[148:151], v0, s[36:39], s61 offen offset:1024 sc1
  ds_read_b64_tr_b16 a[202:203], v242 offset:20480
  v_mfma_f32_16x16x32_bf16 v[164:167], a[212:215], a[228:231], v[164:167]
  ds_read_b64_tr_b16 a[204:205], v242 offset:24576
  v_mfma_f32_16x16x32_bf16 v[164:167], a[208:211], a[220:223], v[164:167]
  s_waitcnt lgkmcnt(11)
  ds_read_b64_tr_b16 a[206:207], v242 offset:28672
  v_mfma_f32_16x16x32_bf16 v[172:175], a[176:179], a[220:223], v[172:175]
  ds_read_b64_tr_b16 a[208:209], v243 offset:16384
  buffer_store_dwordx4 v[152:155], v0, s[36:39], s61 offen offset:2048 sc1
  v_mfma_f32_16x16x32_bf16 v[172:175], a[180:183], a[228:231], v[172:175]
  buffer_store_dwordx4 v[156:159], v0, s[36:39], s61 offen offset:3072 sc1
  ds_read_b64_tr_b16 a[210:211], v243 offset:20480
  v_mfma_f32_16x16x32_bf16 v[168:171], a[180:183], a[224:227], v[168:171]
  ds_read_b64_tr_b16 a[212:213], v243 offset:24576
  v_mfma_f32_16x16x32_bf16 v[168:171], a[176:179], a[216:219], v[168:171]
  s_waitcnt lgkmcnt(11)
  ds_read_b64_tr_b16 a[214:215], v243 offset:28672
  v_mfma_f32_16x16x32_bf16 v[32:35], a[184:187], a[32:35], v[32:35]
  ds_read_b64_tr_b16 a[176:177], v240 offset:32768
  buffer_store_dwordx4 v[160:163], v0, s[36:39], s62 offen offset:0 sc1
  v_mfma_f32_16x16x32_bf16 v[32:35], a[188:191], a[40:43], v[32:35]
  buffer_store_dwordx4 v[164:167], v0, s[36:39], s62 offen offset:1024 sc1
  ds_read_b64_tr_b16 a[178:179], v240 offset:36864
  v_mfma_f32_16x16x32_bf16 v[36:39], a[188:191], a[44:47], v[36:39]
  ds_read_b64_tr_b16 a[180:181], v240 offset:40960
  v_mfma_f32_16x16x32_bf16 v[36:39], a[184:187], a[36:39], v[36:39]
  s_waitcnt lgkmcnt(11)
  ds_read_b64_tr_b16 a[182:183], v240 offset:45056
  v_mfma_f32_16x16x32_bf16 v[44:47], a[192:195], a[36:39], v[44:47]
  ds_read_b64_tr_b16 a[184:185], v241 offset:32768
  buffer_store_dwordx4 v[168:171], v0, s[36:39], s62 offen offset:2048 sc1
  v_mfma_f32_16x16x32_bf16 v[44:47], a[196:199], a[44:47], v[44:47]
  buffer_store_dwordx4 v[172:175], v0, s[36:39], s62 offen offset:3072 sc1
  ds_read_b64_tr_b16 a[186:187], v241 offset:36864
  v_mfma_f32_16x16x32_bf16 v[40:43], a[196:199], a[40:43], v[40:43]
  ds_read_b64_tr_b16 a[188:189], v241 offset:40960
  v_mfma_f32_16x16x32_bf16 v[40:43], a[192:195], a[32:35], v[40:43]
  s_waitcnt vmcnt(16) lgkmcnt(11)
  s_barrier
  ds_read_b64_tr_b16 a[190:191], v241 offset:45056
  v_mfma_f32_16x16x32_bf16 v[48:51], a[200:203], a[32:35], v[48:51]
  ds_read_b64_tr_b16 a[192:193], v242 offset:32768
  v_mfma_f32_16x16x32_bf16 v[48:51], a[204:207], a[40:43], v[48:51]
  ds_read_b64_tr_b16 a[194:195], v242 offset:36864
  v_mfma_f32_16x16x32_bf16 v[52:55], a[204:207], a[44:47], v[52:55]
  ds_read_b64_tr_b16 a[196:197], v242 offset:40960
  v_mfma_f32_16x16x32_bf16 v[52:55], a[200:203], a[36:39], v[52:55]
  s_waitcnt lgkmcnt(11)
  ds_read_b64_tr_b16 a[198:199], v242 offset:45056
  v_mfma_f32_16x16x32_bf16 v[60:63], a[208:211], a[36:39], v[60:63]
  ds_read_b64_tr_b16 a[200:201], v243 offset:32768
  v_mfma_f32_16x16x32_bf16 v[60:63], a[212:215], a[44:47], v[60:63]
  ds_read_b64_tr_b16 a[202:203], v243 offset:36864
  v_mfma_f32_16x16x32_bf16 v[56:59], a[212:215], a[40:43], v[56:59]
  ds_read_b64_tr_b16 a[204:205], v243 offset:40960
  v_mfma_f32_16x16x32_bf16 v[56:59], a[208:211], a[32:35], v[56:59]
  s_waitcnt lgkmcnt(11)
  ds_read_b64_tr_b16 a[206:207], v243 offset:45056
  v_mfma_f32_16x16x32_bf16 v[32:35], a[176:179], a[48:51], v[32:35]
  ds_read_b64_tr_b16 a[208:209], v240 offset:49152
  v_mfma_f32_16x16x32_bf16 v[32:35], a[180:183], a[56:59], v[32:35]
  ds_read_b64_tr_b16 a[210:211], v240 offset:53248
  v_mfma_f32_16x16x32_bf16 v[36:39], a[180:183], a[60:63], v[36:39]
  ds_read_b64_tr_b16 a[212:213], v240 offset:57344
  v_mfma_f32_16x16x32_bf16 v[36:39], a[176:179], a[52:55], v[36:39]
  s_waitcnt lgkmcnt(11)
  ds_read_b64_tr_b16 a[214:215], v240 offset:61440
  v_mfma_f32_16x16x32_bf16 v[44:47], a[184:187], a[52:55], v[44:47]
  ds_read_b64_tr_b16 a[176:177], v241 offset:49152
  v_mfma_f32_16x16x32_bf16 v[44:47], a[188:191], a[60:63], v[44:47]
  ds_read_b64_tr_b16 a[178:179], v241 offset:53248
  v_mfma_f32_16x16x32_bf16 v[40:43], a[188:191], a[56:59], v[40:43]
  ds_read_b64_tr_b16 a[180:181], v241 offset:57344
  v_mfma_f32_16x16x32_bf16 v[40:43], a[184:187], a[48:51], v[40:43]
  s_waitcnt vmcnt(14) lgkmcnt(11)
  s_barrier
  ds_read_b64_tr_b16 a[182:183], v241 offset:61440
  v_mfma_f32_16x16x32_bf16 v[48:51], a[192:195], a[48:51], v[48:51]
  ds_read_b64_tr_b16 a[184:185], v242 offset:49152
  v_mfma_f32_16x16x32_bf16 v[48:51], a[196:199], a[56:59], v[48:51]
  ds_read_b64_tr_b16 a[186:187], v242 offset:53248
  v_mfma_f32_16x16x32_bf16 v[52:55], a[196:199], a[60:63], v[52:55]
  ds_read_b64_tr_b16 a[188:189], v242 offset:57344
  v_mfma_f32_16x16x32_bf16 v[52:55], a[192:195], a[52:55], v[52:55]
  s_waitcnt lgkmcnt(11)
  ds_read_b64_tr_b16 a[190:191], v242 offset:61440
  v_mfma_f32_16x16x32_bf16 v[60:63], a[200:203], a[52:55], v[60:63]
  ds_read_b64_tr_b16 a[192:193], v243 offset:49152
  v_mfma_f32_16x16x32_bf16 v[60:63], a[204:207], a[60:63], v[60:63]
  ds_read_b64_tr_b16 a[194:195], v243 offset:53248
  v_mfma_f32_16x16x32_bf16 v[56:59], a[204:207], a[56:59], v[56:59]
  ds_read_b64_tr_b16 a[196:197], v243 offset:57344
  v_mfma_f32_16x16x32_bf16 v[56:59], a[200:203], a[48:51], v[56:59]
  s_waitcnt lgkmcnt(11)
  ds_read_b64_tr_b16 a[198:199], v243 offset:61440
  v_mfma_f32_16x16x32_bf16 v[32:35], a[208:211], a[64:67], v[32:35]
  ds_read_b64_tr_b16 a[200:201], v244 offset:0
  v_mfma_f32_16x16x32_bf16 v[32:35], a[212:215], a[72:75], v[32:35]
  ds_read_b64_tr_b16 a[202:203], v244 offset:4096
  v_mfma_f32_16x16x32_bf16 v[36:39], a[212:215], a[76:79], v[36:39]
  ds_read_b64_tr_b16 a[204:205], v244 offset:8192
  v_mfma_f32_16x16x32_bf16 v[36:39], a[208:211], a[68:71], v[36:39]
  s_waitcnt lgkmcnt(11)
  ds_read_b64_tr_b16 a[206:207], v244 offset:12288
  v_mfma_f32_16x16x32_bf16 v[44:47], a[176:179], a[68:71], v[44:47]
  ds_read_b64_tr_b16 a[208:209], v245 offset:0
  v_mfma_f32_16x16x32_bf16 v[44:47], a[180:183], a[76:79], v[44:47]
  ds_read_b64_tr_b16 a[210:211], v245 offset:4096
  v_mfma_f32_16x16x32_bf16 v[40:43], a[180:183], a[72:75], v[40:43]
  ds_read_b64_tr_b16 a[212:213], v245 offset:8192
  v_mfma_f32_16x16x32_bf16 v[40:43], a[176:179], a[64:67], v[40:43]
  s_waitcnt vmcnt(12) lgkmcnt(11)
  s_barrier
  ds_read_b64_tr_b16 a[214:215], v245 offset:12288
  v_mfma_f32_16x16x32_bf16 v[48:51], a[184:187], a[64:67], v[48:51]
  ds_read_b64_tr_b16 a[176:177], v246 offset:0
  v_mfma_f32_16x16x32_bf16 v[48:51], a[188:191], a[72:75], v[48:51]
  ds_read_b64_tr_b16 a[178:179], v246 offset:4096
  v_mfma_f32_16x16x32_bf16 v[52:55], a[188:191], a[76:79], v[52:55]
  ds_read_b64_tr_b16 a[180:181], v246 offset:8192
  v_mfma_f32_16x16x32_bf16 v[52:55], a[184:187], a[68:71], v[52:55]
  s_waitcnt lgkmcnt(11)
  ds_read_b64_tr_b16 a[182:183], v246 offset:12288
  v_mfma_f32_16x16x32_bf16 v[60:63], a[192:195], a[68:71], v[60:63]
  ds_read_b64_tr_b16 a[184:185], v247 offset:0
  v_mfma_f32_16x16x32_bf16 v[60:63], a[196:199], a[76:79], v[60:63]
  ds_read_b64_tr_b16 a[186:187], v247 offset:4096
  v_mfma_f32_16x16x32_bf16 v[56:59], a[196:199], a[72:75], v[56:59]
  ds_read_b64_tr_b16 a[188:189], v247 offset:8192
  v_mfma_f32_16x16x32_bf16 v[56:59], a[192:195], a[64:67], v[56:59]
  s_waitcnt lgkmcnt(11)
  ds_read_b64_tr_b16 a[190:191], v247 offset:12288
  v_mfma_f32_16x16x32_bf16 v[32:35], a[200:203], a[80:83], v[32:35]
  ds_read_b64_tr_b16 a[192:193], v244 offset:16384
  v_mfma_f32_16x16x32_bf16 v[32:35], a[204:207], a[88:91], v[32:35]
  ds_read_b64_tr_b16 a[194:195], v244 offset:20480
  v_mfma_f32_16x16x32_bf16 v[36:39], a[204:207], a[92:95], v[36:39]
  ds_read_b64_tr_b16 a[196:197], v244 offset:24576
  v_mfma_f32_16x16x32_bf16 v[36:39], a[200:203], a[84:87], v[36:39]
  s_waitcnt lgkmcnt(11)
  ds_read_b64_tr_b16 a[198:199], v244 offset:28672
  v_mfma_f32_16x16x32_bf16 v[44:47], a[208:211], a[84:87], v[44:47]
  ds_read_b64_tr_b16 a[200:201], v245 offset:16384
  v_mfma_f32_16x16x32_bf16 v[44:47], a[212:215], a[92:95], v[44:47]
  ds_read_b64_tr_b16 a[202:203], v245 offset:20480
  v_mfma_f32_16x16x32_bf16 v[40:43], a[212:215], a[88:91], v[40:43]
  ds_read_b64_tr_b16 a[204:205], v245 offset:24576
  v_mfma_f32_16x16x32_bf16 v[40:43], a[208:211], a[80:83], v[40:43]
  s_waitcnt vmcnt(10) lgkmcnt(11)
  s_barrier
  ds_read_b64_tr_b16 a[206:207], v245 offset:28672
  v_mfma_f32_16x16x32_bf16 v[48:51], a[176:179], a[80:83], v[48:51]
  ds_read_b64_tr_b16 a[208:209], v246 offset:16384
  v_mfma_f32_16x16x32_bf16 v[48:51], a[180:183], a[88:91], v[48:51]
  ds_read_b64_tr_b16 a[210:211], v246 offset:20480
  v_mfma_f32_16x16x32_bf16 v[52:55], a[180:183], a[92:95], v[52:55]
  ds_read_b64_tr_b16 a[212:213], v246 offset:24576
  v_mfma_f32_16x16x32_bf16 v[52:55], a[176:179], a[84:87], v[52:55]
  s_waitcnt lgkmcnt(11)
  ds_read_b64_tr_b16 a[214:215], v246 offset:28672
  v_mfma_f32_16x16x32_bf16 v[60:63], a[184:187], a[84:87], v[60:63]
  ds_read_b64_tr_b16 a[176:177], v247 offset:16384
  v_mfma_f32_16x16x32_bf16 v[60:63], a[188:191], a[92:95], v[60:63]
  ds_read_b64_tr_b16 a[178:179], v247 offset:20480
  v_mfma_f32_16x16x32_bf16 v[56:59], a[188:191], a[88:91], v[56:59]
  s_waitcnt vmcnt(0)
  ds_read_b64_tr_b16 a[180:181], v247 offset:24576
  buffer_load_dword v139, v132, s[36:39], s77 offen sc1
  v_mfma_f32_16x16x32_bf16 v[56:59], a[184:187], a[80:83], v[56:59]
  s_waitcnt lgkmcnt(11)
  ds_read_b64_tr_b16 a[182:183], v247 offset:28672
  s_mov_b64 exec, 1
  buffer_store_dword v9, v0, s[36:39], s76 offen sc1
  s_mov_b64 exec, -1
  v_mfma_f32_16x16x32_bf16 v[32:35], a[192:195], a[96:99], v[32:35]
  ds_read_b64_tr_b16 a[184:185], v244 offset:32768
  v_mfma_f32_16x16x32_bf16 v[32:35], a[196:199], a[104:107], v[32:35]
  ds_read_b64_tr_b16 a[186:187], v244 offset:36864
  v_mfma_f32_16x16x32_bf16 v[36:39], a[196:199], a[108:111], v[36:39]
  ds_read_b64_tr_b16 a[188:189], v244 offset:40960
  v_mfma_f32_16x16x32_bf16 v[36:39], a[192:195], a[100:103], v[36:39]
  s_waitcnt lgkmcnt(11)
  ds_read_b64_tr_b16 a[190:191], v244 offset:45056
  v_mfma_f32_16x16x32_bf16 v[44:47], a[200:203], a[100:103], v[44:47]
  ds_read_b64_tr_b16 a[192:193], v245 offset:32768
  v_mfma_f32_16x16x32_bf16 v[44:47], a[204:207], a[108:111], v[44:47]
  ds_read_b64_tr_b16 a[194:195], v245 offset:36864
  v_mfma_f32_16x16x32_bf16 v[40:43], a[204:207], a[104:107], v[40:43]
  ds_read_b64_tr_b16 a[196:197], v245 offset:40960
  v_mfma_f32_16x16x32_bf16 v[40:43], a[200:203], a[96:99], v[40:43]
  s_waitcnt vmcnt(10) lgkmcnt(11)
  s_barrier
  ds_read_b64_tr_b16 a[198:199], v245 offset:45056
  v_mfma_f32_16x16x32_bf16 v[48:51], a[208:211], a[96:99], v[48:51]
  ds_read_b64_tr_b16 a[200:201], v246 offset:32768
  v_mfma_f32_16x16x32_bf16 v[48:51], a[212:215], a[104:107], v[48:51]
  ds_read_b64_tr_b16 a[202:203], v246 offset:36864
  v_mfma_f32_16x16x32_bf16 v[52:55], a[212:215], a[108:111], v[52:55]
  ds_read_b64_tr_b16 a[204:205], v246 offset:40960
  v_mfma_f32_16x16x32_bf16 v[52:55], a[208:211], a[100:103], v[52:55]
  s_waitcnt lgkmcnt(11)
  ds_read_b64_tr_b16 a[206:207], v246 offset:45056
  v_mfma_f32_16x16x32_bf16 v[60:63], a[176:179], a[100:103], v[60:63]
  ds_read_b64_tr_b16 a[208:209], v247 offset:32768
  v_mfma_f32_16x16x32_bf16 v[60:63], a[180:183], a[108:111], v[60:63]
  ds_read_b64_tr_b16 a[210:211], v247 offset:36864
  v_mfma_f32_16x16x32_bf16 v[56:59], a[180:183], a[104:107], v[56:59]
  ds_read_b64_tr_b16 a[212:213], v247 offset:40960
  v_mfma_f32_16x16x32_bf16 v[56:59], a[176:179], a[96:99], v[56:59]
  s_waitcnt lgkmcnt(11)
  ds_read_b64_tr_b16 a[214:215], v247 offset:45056
  v_mfma_f32_16x16x32_bf16 v[32:35], a[184:187], a[112:115], v[32:35]
  ds_read_b64_tr_b16 a[176:177], v244 offset:49152
  v_mfma_f32_16x16x32_bf16 v[32:35], a[188:191], a[120:123], v[32:35]
  ds_read_b64_tr_b16 a[178:179], v244 offset:53248
  v_mfma_f32_16x16x32_bf16 v[36:39], a[188:191], a[124:127], v[36:39]
  ds_read_b64_tr_b16 a[180:181], v244 offset:57344
  v_mfma_f32_16x16x32_bf16 v[36:39], a[184:187], a[116:119], v[36:39]
  s_waitcnt lgkmcnt(11)
  ds_read_b64_tr_b16 a[182:183], v244 offset:61440
  v_mfma_f32_16x16x32_bf16 v[44:47], a[192:195], a[116:119], v[44:47]
  ds_read_b64_tr_b16 a[184:185], v245 offset:49152
  v_mfma_f32_16x16x32_bf16 v[44:47], a[196:199], a[124:127], v[44:47]
  ds_read_b64_tr_b16 a[186:187], v245 offset:53248
  v_mfma_f32_16x16x32_bf16 v[40:43], a[196:199], a[120:123], v[40:43]
  s_waitcnt vmcnt(1)
  ds_read_b64_tr_b16 a[188:189], v245 offset:57344
  v_readfirstlane_b32 s78, v139
  v_mfma_f32_16x16x32_bf16 v[40:43], a[192:195], a[112:115], v[40:43]
  s_waitcnt lgkmcnt(11)
  ds_read_b64_tr_b16 a[190:191], v245 offset:61440
  s_nop 0
  v_mfma_f32_16x16x32_bf16 v[48:51], a[200:203], a[112:115], v[48:51]
  s_cmp_eq_u32 s78, s3
  ds_read_b64_tr_b16 a[192:193], v246 offset:49152
  s_cselect_b32 s89, s63, 1073741824
  v_mfma_f32_16x16x32_bf16 v[48:51], a[204:207], a[120:123], v[48:51]
  s_cselect_b32 s90, s64, 1073741824
  ds_read_b64_tr_b16 a[194:195], v246 offset:53248
  buffer_load_dwordx4 v[96:99], v0, s[36:39], s89 offen offset:0 sc1
  v_mfma_f32_16x16x32_bf16 v[52:55], a[204:207], a[124:127], v[52:55]
  ds_read_b64_tr_b16 a[196:197], v246 offset:57344
  v_mfma_f32_16x16x32_bf16 v[52:55], a[200:203], a[116:119], v[52:55]
  s_waitcnt lgkmcnt(11)
  ds_read_b64_tr_b16 a[198:199], v246 offset:61440
  v_mfma_f32_16x16x32_bf16 v[60:63], a[208:211], a[116:119], v[60:63]
  ds_read_b64_tr_b16 a[200:201], v247 offset:49152
  buffer_load_dwordx4 v[100:103], v0, s[36:39], s89 offen offset:1024 sc1
  v_mfma_f32_16x16x32_bf16 v[60:63], a[212:215], a[124:127], v[60:63]
  ds_read_b64_tr_b16 a[202:203], v247 offset:53248
  v_mfma_f32_16x16x32_bf16 v[56:59], a[212:215], a[120:123], v[56:59]
  ds_read_b64_tr_b16 a[204:205], v247 offset:57344
  v_mfma_f32_16x16x32_bf16 v[56:59], a[208:211], a[112:115], v[56:59]
  s_waitcnt lgkmcnt(11)
  buffer_load_dwordx4 v[104:107], v0, s[36:39], s89 offen offset:2048 sc1
  ds_read_b64_tr_b16 a[206:207], v247 offset:61440
  v_mfma_f32_16x16x32_bf16 v[32:35], a[176:179], a[216:219], v[32:35]
  v_mfma_f32_16x16x32_bf16 v[32:35], a[180:183], a[224:227], v[32:35]
  buffer_load_dwordx4 v[108:111], v0, s[36:39], s89 offen offset:3072 sc1
  v_mfma_f32_16x16x32_bf16 v[36:39], a[180:183], a[228:231], v[36:39]
  v_mfma_f32_16x16x32_bf16 v[36:39], a[176:179], a[220:223], v[36:39]
  s_waitcnt lgkmcnt(8)
  buffer_load_dwordx4 v[112:115], v0, s[36:39], s90 offen offset:0 sc1
  v_mfma_f32_16x16x32_bf16 v[44:47], a[184:187], a[220:223], v[44:47]
  v_mfma_f32_16x16x32_bf16 v[44:47], a[188:191], a[228:231], v[44:47]
  buffer_load_dwordx4 v[116:119], v0, s[36:39], s90 offen offset:1024 sc1
  v_mfma_f32_16x16x32_bf16 v[40:43], a[188:191], a[224:227], v[40:43]
  v_mfma_f32_16x16x32_bf16 v[40:43], a[184:187], a[216:219], v[40:43]
  s_waitcnt lgkmcnt(4)
  buffer_load_dwordx4 v[120:123], v0, s[36:39], s90 offen offset:2048 sc1
  v_mfma_f32_16x16x32_bf16 v[48:51], a[192:195], a[216:219], v[48:51]
  v_mfma_f32_16x16x32_bf16 v[48:51], a[196:199], a[224:227], v[48:51]
  buffer_load_dwordx4 v[124:127], v0, s[36:39], s90 offen offset:3072 sc1
  v_mfma_f32_16x16x32_bf16 v[52:55], a[196:199], a[228:231], v[52:55]
  v_mfma_f32_16x16x32_bf16 v[52:55], a[192:195], a[220:223], v[52:55]
  s_waitcnt lgkmcnt(0)
  v_mfma_f32_16x16x32_bf16 v[60:63], a[200:203], a[220:223], v[60:63]
  v_mfma_f32_16x16x32_bf16 v[60:63], a[204:207], a[228:231], v[60:63]
  v_mfma_f32_16x16x32_bf16 v[56:59], a[204:207], a[224:227], v[56:59]
  v_mfma_f32_16x16x32_bf16 v[56:59], a[200:203], a[216:219], v[56:59]
  s_cmp_eq_u32 s78, s3
  s_cbranch_scc0 CKXs
CKXx:
  v_pk_fma_f32 v[64:65], v[176:177], v[32:33], v[64:65]
  v_pk_fma_f32 v[66:67], v[178:179], v[34:35], v[66:67]
  v_pk_fma_f32 v[80:81], v[176:177], v[36:37], v[80:81]
  v_pk_fma_f32 v[82:83], v[178:179], v[38:39], v[82:83]
  v_pk_fma_f32 v[68:69], v[180:181], v[40:41], v[68:69]
  v_pk_fma_f32 v[70:71], v[182:183], v[42:43], v[70:71]
  v_pk_fma_f32 v[84:85], v[180:181], v[44:45], v[84:85]
  v_pk_fma_f32 v[86:87], v[182:183], v[46:47], v[86:87]
  v_pk_fma_f32 v[72:73], v[184:185], v[48:49], v[72:73]
  v_pk_fma_f32 v[74:75], v[186:187], v[50:51], v[74:75]
  v_pk_fma_f32 v[88:89], v[184:185], v[52:53], v[88:89]
  v_pk_fma_f32 v[90:91], v[186:187], v[54:55], v[90:91]
  v_pk_fma_f32 v[76:77], v[188:189], v[56:57], v[76:77]
  v_pk_fma_f32 v[78:79], v[190:191], v[58:59], v[78:79]
  v_pk_fma_f32 v[92:93], v[188:189], v[60:61], v[92:93]
  v_pk_fma_f32 v[94:95], v[190:191], v[62:63], v[94:95]
  s_waitcnt vmcnt(7)
  v_pk_fma_f32 v[64:65], v[176:177], v[96:97], v[64:65]
  v_pk_fma_f32 v[66:67], v[178:179], v[98:99], v[66:67]
  v_cvt_pk_bf16_f32 v192, v64, v65
  v_cvt_pk_bf16_f32 v193, v66, v67
  ds_write_b64 v140, v[192:193] offset:0
  s_waitcnt vmcnt(6)
  v_pk_fma_f32 v[80:81], v[176:177], v[100:101], v[80:81]
  v_pk_fma_f32 v[82:83], v[178:179], v[102:103], v[82:83]
  v_cvt_pk_bf16_f32 v200, v80, v81
  v_cvt_pk_bf16_f32 v201, v82, v83
  ds_write_b64 v140, v[200:201] offset:2048
  s_waitcnt vmcnt(5)
  v_pk_fma_f32 v[68:69], v[180:181], v[104:105], v[68:69]
  v_pk_fma_f32 v[70:71], v[182:183], v[106:107], v[70:71]
  v_cvt_pk_bf16_f32 v194, v68, v69
  v_cvt_pk_bf16_f32 v195, v70, v71
  ds_write_b64 v141, v[194:195] offset:0
  s_waitcnt vmcnt(4)
  v_pk_fma_f32 v[84:85], v[180:181], v[108:109], v[84:85]
  v_pk_fma_f32 v[86:87], v[182:183], v[110:111], v[86:87]
  v_cvt_pk_bf16_f32 v202, v84, v85
  v_cvt_pk_bf16_f32 v203, v86, v87
  ds_write_b64 v141, v[202:203] offset:2048
  s_waitcnt vmcnt(3)
  v_pk_fma_f32 v[72:73], v[184:185], v[112:113], v[72:73]
  v_pk_fma_f32 v[74:75], v[186:187], v[114:115], v[74:75]
  v_cvt_pk_bf16_f32 v196, v72, v73
  v_cvt_pk_bf16_f32 v197, v74, v75
  ds_write_b64 v142, v[196:197] offset:0
  s_waitcnt vmcnt(2)
  v_pk_fma_f32 v[88:89], v[184:185], v[116:117], v[88:89]
  v_pk_fma_f32 v[90:91], v[186:187], v[118:119], v[90:91]
  v_cvt_pk_bf16_f32 v204, v88, v89
  v_cvt_pk_bf16_f32 v205, v90, v91
  ds_write_b64 v142, v[204:205] offset:2048
  s_waitcnt vmcnt(1)
  v_pk_fma_f32 v[76:77], v[188:189], v[120:121], v[76:77]
  v_pk_fma_f32 v[78:79], v[190:191], v[122:123], v[78:79]
  v_cvt_pk_bf16_f32 v198, v76, v77
  v_cvt_pk_bf16_f32 v199, v78, v79
  ds_write_b64 v143, v[198:199] offset:0
  s_waitcnt vmcnt(0)
  v_pk_fma_f32 v[92:93], v[188:189], v[124:125], v[92:93]
  v_pk_fma_f32 v[94:95], v[190:191], v[126:127], v[94:95]
  v_cvt_pk_bf16_f32 v206, v92, v93
  v_cvt_pk_bf16_f32 v207, v94, v95
  ds_write_b64 v143, v[206:207] offset:2048
  ds_read_b128 v[64:67], v254 offset:0
  ds_read_b128 v[68:71], v254 offset:1024
  ds_read_b128 v[72:75], v254 offset:2048
  ds_read_b128 v[76:79], v254 offset:3072
  s_waitcnt lgkmcnt(3)
  buffer_store_dwordx4 v[64:67], v252, s[32:35], s55 offen
  s_waitcnt lgkmcnt(2)
  buffer_store_dwordx4 v[68:71], v253, s[32:35], s55 offen
  s_waitcnt lgkmcnt(1)
  buffer_store_dwordx4 v[72:75], v252, s[32:35], s49 offen
  s_waitcnt lgkmcnt(0)
  buffer_store_dwordx4 v[76:79], v253, s[32:35], s49 offen
XEND:
  s_endpgm
CK4s:
  s_mov_b32 s46, 30000
CK4:
  s_mov_b32 s49, 0
  buffer_load_dwordx4 v[156:159], v249, s[36:39], s49 offen sc1
  s_mov_b32 s49, 24576
  buffer_load_dwordx4 v[160:163], v249, s[36:39], s49 offen sc1
  s_mov_b32 s49, 49152
  buffer_load_dwordx4 v[164:167], v249, s[36:39], s49 offen sc1
  s_mov_b32 s49, 73728
  buffer_load_dwordx4 v[168:171], v249, s[36:39], s49 offen sc1
  s_sub_u32 s46, s46, 1
  s_waitcnt vmcnt(0)
  v_max_u32 v15, v156, v157
  v_max3_u32 v15, v15, v158, v159
  v_max3_u32 v15, v15, v160, v161
  v_max3_u32 v15, v15, v162, v163
  v_max3_u32 v15, v15, v164, v165
  v_max3_u32 v15, v15, v166, v167
  v_max3_u32 v15, v15, v168, v169
  v_max3_u32 v15, v15, v170, v171
  s_cmp_eq_u32 s46, 0
  s_cbranch_scc1 CK4x
  v_cmp_eq_u32 vcc, -1, v15
  s_nop 4
  s_cbranch_vccnz CK4
  s_branch CK4x
CKSs:
  s_mov_b32 s46, 30000
  v_lshlrev_b32 v14, 3, v0
CKS:
  s_mov_b32 s48, 5242880
  buffer_load_dword v16, v14, s[36:39], s48 offen sc1
  s_mov_b32 s48, 5251072
  buffer_load_dword v17, v14, s[36:39], s48 offen sc1
  s_mov_b32 s48, 5259264
  buffer_load_dword v18, v14, s[36:39], s48 offen sc1
  s_mov_b32 s48, 5267456
  buffer_load_dword v19, v14, s[36:39], s48 offen sc1
  s_sub_u32 s46, s46, 1
  s_cmp_eq_u32 s46, 0
  s_waitcnt vmcnt(0)
  s_cbranch_scc1 CKSy
  v_xor_b32 v15, s3, v16
  v_bitop3_b32 v15, v15, v17, s3 bitop3:0xf6
  v_bitop3_b32 v15, v15, v18, s3 bitop3:0xf6
  v_bitop3_b32 v15, v15, v19, s3 bitop3:0xf6
  v_cmp_ne_u32 vcc, 0, v15
  s_nop 4
  s_cbranch_vccnz CKS
CKSy:
  s_mov_b32 s48, 5505024
  s_mov_b64 exec, 1
  buffer_store_dword v12, v0, s[36:39], s48 offen sc1
  s_mov_b64 exec, -1
  s_branch CKSx
CK6s:
  s_mov_b32 s46, 30000
CK6:
  buffer_load_dwordx4 a[208:211], v25, s[36:39], s77 offen offset:0 sc1
  buffer_load_dwordx4 a[212:215], v25, s[36:39], s77 offen offset:2048 sc1
  buffer_load_dwordx4 a[216:219], v25, s[36:39], s76 offen offset:0 sc1
  buffer_load_dwordx4 a[220:223], v25, s[36:39], s76 offen offset:2048 sc1
  s_sub_u32 s46, s46, 1
  s_waitcnt vmcnt(0)
  v_accvgpr_read_b32 v26, a208
  v_accvgpr_read_b32 v27, a209
  v_accvgpr_read_b32 v28, a210
  v_accvgpr_read_b32 v29, a211
  v_max_u32 v31, v26, v27
  v_max3_u32 v31, v31, v28, v29
  v_accvgpr_read_b32 v22, a212
  v_accvgpr_read_b32 v23, a213
  v_max3_u32 v31, v31, v22, v23
  v_add_f32 v26, v26, v22
  v_add_f32 v27, v27, v23
  v_accvgpr_read_b32 v22, a214
  v_accvgpr_read_b32 v23, a215
  v_max3_u32 v31, v31, v22, v23
  v_add_f32 v28, v28, v22
  v_add_f32 v29, v29, v23
  v_accvgpr_read_b32 v22, a216
  v_accvgpr_read_b32 v23, a217
  v_max3_u32 v31, v31, v22, v23
  v_add_f32 v26, v26, v22
  v_add_f32 v27, v27, v23
  v_accvgpr_read_b32 v22, a218
  v_accvgpr_read_b32 v23, a219
  v_max3_u32 v31, v31, v22, v23
  v_add_f32 v28, v28, v22
  v_add_f32 v29, v29, v23
  v_accvgpr_read_b32 v22, a220
  v_accvgpr_read_b32 v23, a221
  v_max3_u32 v31, v31, v22, v23
  v_add_f32 v26, v26, v22
  v_add_f32 v27, v27, v23
  v_accvgpr_read_b32 v22, a222
  v_accvgpr_read_b32 v23, a223
  v_max3_u32 v31, v31, v22, v23
  v_add_f32 v28, v28, v22
  v_add_f32 v29, v29, v23
  s_cmp_eq_u32 s46, 0
  s_cbranch_scc1 CK6x
  v_cmp_eq_u32 vcc, -1, v31
  s_nop 4
  s_cbranch_vccnz CK6
  s_branch CK6x
CK7s:
  s_mov_b32 s46, 60000
CK7:
  buffer_load_dword v139, v138, s[36:39], s91 offen sc1
  s_sub_u32 s46, s46, 1
  s_cmp_eq_u32 s46, 0
  s_waitcnt vmcnt(0)
  s_cbranch_scc1 CK7x
  v_cmp_ne_u32 vcc, s3, v139
  s_nop 4
  s_cbranch_vccnz CK7
  s_branch CK7x
CK8s:
  s_mov_b32 s46, 60000
CK8:
  buffer_load_dword v139, v138, s[36:39], s91 offen sc1
  s_sub_u32 s46, s46, 1
  s_cmp_eq_u32 s46, 0
  s_waitcnt vmcnt(0)
  s_cbranch_scc1 CK8x
  v_cmp_ne_u32 vcc, s3, v139
  s_nop 4
  s_cbranch_vccnz CK8
  s_branch CK8x
CK9s:
  s_mov_b32 s46, 60000
CK9:
  buffer_load_dword v139, v138, s[36:39], s91 offen sc1
  s_sub_u32 s46, s46, 1
  s_cmp_eq_u32 s46, 0
  s_waitcnt vmcnt(0)
  s_cbranch_scc1 CK9x
  v_cmp_ne_u32 vcc, s3, v139
  s_nop 4
  s_cbranch_vccnz CK9
  s_branch CK9x
CKXs:
  s_mov_b32 s46, 60000
CKX:
  buffer_load_dword v139, v132, s[36:39], s77 offen sc1
  s_sub_u32 s46, s46, 1
  s_cmp_eq_u32 s46, 0
  s_waitcnt vmcnt(0)
  s_cbranch_scc1 CKXy
  v_cmp_ne_u32 vcc, s3, v139
  s_nop 4
  s_cbranch_vccnz CKX
CKXy:
  buffer_load_dwordx4 v[96:99], v0, s[36:39], s63 offen offset:0 sc1
  buffer_load_dwordx4 v[100:103], v0, s[36:39], s63 offen offset:1024 sc1
  buffer_load_dwordx4 v[104:107], v0, s[36:39], s63 offen offset:2048 sc1
  buffer_load_dwordx4 v[108:111], v0, s[36:39], s63 offen offset:3072 sc1
  buffer_load_dwordx4 v[112:115], v0, s[36:39], s64 offen offset:0 sc1
  buffer_load_dwordx4 v[116:119], v0, s[36:39], s64 offen offset:1024 sc1
  buffer_load_dwordx4 v[120:123], v0, s[36:39], s64 offen offset:2048 sc1
  buffer_load_dwordx4 v[124:127], v0, s[36:39], s64 offen offset:3072 sc1
  s_branch CKXx
code_end:
.fill 2048, 4, 0xBF800000
.section .rodata,"a"
.p2align 6
.amdhsa_kernel adaLN_cond__sliding_local_dilated__swiglu_ffn__prompt_kernel
  .amdhsa_next_free_vgpr 512
  .amdhsa_next_free_sgpr 102
  .amdhsa_accum_offset 256
  .amdhsa_group_segment_fixed_size 0
  .amdhsa_kernarg_size 96
  .amdhsa_user_sgpr_count 2
  .amdhsa_user_sgpr_kernarg_segment_ptr 1
  .amdhsa_system_sgpr_workgroup_id_x 1
  .amdhsa_float_denorm_mode_32 3
.end_amdhsa_kernel
```

```asm
; @launch grid=(256,1,1) block=(256,1,1) lds=163840
.amdgcn_target "amdgcn-amd-amdhsa--gfx950"
.text
.globl adaLN_cond__sliding_local_dilated__swiglu_ffn__prompt_kernel
.type adaLN_cond__sliding_local_dilated__swiglu_ffn__prompt_kernel,@function
.p2align 12
.p2align 8
adaLN_cond__sliding_local_dilated__swiglu_ffn__prompt_kernel:
  s_cmp_ge_u32 s2, 256
  s_cbranch_scc1 XEND
  s_load_dwordx2 s[36:37], s[0:1], 88
  s_load_dwordx2 s[40:41], s[0:1], 56
  s_load_dwordx2 s[28:29], s[0:1], 64
  s_load_dwordx2 s[4:5], s[0:1], 0
  s_load_dwordx2 s[8:9], s[0:1], 8
  s_load_dwordx2 s[12:13], s[0:1], 16
  s_load_dwordx2 s[16:17], s[0:1], 32
  s_load_dwordx2 s[20:21], s[0:1], 40
  s_load_dwordx2 s[24:25], s[0:1], 48
  s_load_dwordx2 s[32:33], s[0:1], 72
  v_lshrrev_b32 v1, 6, v0
  v_and_b32 v10, 63, v0
  v_readfirstlane_b32 s44, v1
  v_lshlrev_b32 v0, 4, v10
  s_mov_b32 s38, 50331648
  s_mov_b32 s39, 0x20000
  s_mov_b32 s42, 2048
  s_mov_b32 s43, 0x20000
  s_mov_b32 s30, 12582912
  s_mov_b32 s31, 0x20000
  s_mov_b32 s6, 4194304
  s_mov_b32 s7, 0x20000
  s_mov_b32 s10, 6291456
  s_mov_b32 s11, 0x20000
  s_mov_b32 s14, 2097152
  s_mov_b32 s15, 0x20000
  s_mov_b32 s18, 7340032
  s_mov_b32 s19, 0x20000
  s_mov_b32 s22, 7340032
  s_mov_b32 s23, 0x20000
  s_mov_b32 s26, 7340032
  s_mov_b32 s27, 0x20000
  s_mov_b32 s34, 4194304
  s_mov_b32 s35, 0x20000
  s_and_b32 s48, s2, 3
  s_lshl2_add_u32 s48, s48, s44
  s_lshl_b32 s48, s48, 6
  v_and_b32 v176, 0x38, v10
  v_add_u32 v176, s48, v176
  v_lshlrev_b32 v177, 1, v176
  v_mul_u32_u24 v176, 12288, v176
  v_and_b32 v12, 7, v10
  v_lshl_add_u32 v176, v12, 4, v176
  v_mov_b32 v178, 0
  s_bfe_u32 s51, s2, 0x40003
  s_and_b32 s49, s2, 4
  s_lshl2_add_u32 s51, s49, s51
  s_and_b32 s49, s2, 128
  s_lshl2_add_u32 s51, s51, s49
  s_lshl_b32 s51, s51, 5
  s_mov_b32 s49, s51
  s_mov_b32 s50, 5505024
  v_lshrrev_b32 v13, 3, v10
  v_lshlrev_b32 v132, 11, v12
  v_lshl_add_u32 v132, v13, 4, v132
  s_and_b32 s48, s2, 127
  s_lshl_b32 s48, s48, 6
  s_add_u32 s48, s48, s44
  s_lshl_b32 s48, s48, 9
  s_cmp_lt_u32 s2, 128
  s_waitcnt lgkmcnt(0)
  buffer_load_dwordx4 v[188:191], v177, s[40:43], 0 offen
  s_cbranch_scc0 F_x
  buffer_load_dwordx4 v[136:139], v176, s[28:31], s49 offen nt
  s_add_u32 s49, s49, 12288
  buffer_load_dwordx4 v[140:143], v176, s[28:31], s49 offen nt
  s_add_u32 s49, s49, 12288
  buffer_load_dwordx4 v[144:147], v176, s[28:31], s49 offen nt
  s_add_u32 s49, s49, 12288
  buffer_load_dwordx4 v[148:151], v176, s[28:31], s49 offen nt
  s_add_u32 s49, s49, 12288
  buffer_load_dwordx4 v[152:155], v176, s[28:31], s49 offen nt
  s_add_u32 s49, s49, 12288
  buffer_load_dwordx4 v[156:159], v176, s[28:31], s49 offen nt
  s_add_u32 s49, s49, 12288
  buffer_load_dwordx4 v[160:163], v176, s[28:31], s49 offen nt
  s_add_u32 s49, s49, 12288
  buffer_load_dwordx4 v[164:167], v176, s[28:31], s49 offen nt
F_x:
  buffer_load_dword v195, v178, s[36:39], s50 offen sc1
  s_mov_b32 s50, s48
  s_getpc_b64 s[92:93]
PC0:
  s_sub_u32 s92, s92, PC0-adaLN_cond__sliding_local_dilated__swiglu_ffn__prompt_kernel
  s_subb_u32 s93, s93, 0
  s_cmp_lt_u32 s2, 128
  s_cbranch_scc1 F_ct
  s_bfe_u32 s48, s2, 0x30004
  s_and_b32 s49, s2, 3
  s_lshl3_add_u32 s48, s49, s48
  s_mul_i32 s48, s48, 393216
  s_and_b32 s49, s2, 4
  s_lshl_b32 s49, s49, 9
  s_add_u32 s48, s48, s49
  s_and_b32 s49, s2, 8
  s_lshl_b32 s49, s49, 7
  s_add_u32 s48, s48, s49
  s_cmp_lt_u32 s44, 1
  s_cselect_b32 s48, s48, 1073741824
  v_and_b32 v19, 31, v10
  v_mul_u32_u24 v19, 12288, v19
  buffer_load_dword a252, v19, s[28:31], s48 offen offset:384
  s_bfe_u32 s48, s2, 0x40003
  s_cmp_lt_u32 s48, (code_end-adaLN_cond__sliding_local_dilated__swiglu_ffn__prompt_kernel)/8192+1
  s_cselect_b32 s49, 3, 4
  s_lshl_b32 s48, s48, 13
  v_lshl_add_u32 v19, v0, 3, s48
  s_cmp_eq_u32 s44, s49
  s_cselect_b32 s49, -1, 0
  v_and_b32 v19, s49, v19
  global_load_dword a252, v19, s[92:93]
  s_bfe_u32 s48, s2, 0x20003
  s_mul_i32 s48, s48, 24576
  s_lshr_b32 s49, s2, 5
  s_lshl3_add_u32 s49, s44, s49
  s_cmp_eq_u32 s49, 15
  s_cselect_b32 s48, s48, 1073741824
  v_lshlrev_b32 v19, 3, v0
  buffer_load_dword a252, v19, s[36:39], s48 offen sc1
F_ct:
  s_and_b32 s48, s2, 7
  s_lshr_b32 s49, s2, 3
  s_and_b32 s58, s48, 3
  s_lshl_b32 s58, s58, 2
  s_and_b32 s57, s49, 3
  s_add_u32 s58, s58, s57
  s_lshr_b32 s57, s48, 2
  s_lshl_b32 s57, s57, 3
  s_lshr_b32 s49, s49, 2
  s_add_u32 s57, s57, s49
  s_lshr_b32 s59, s44, 1
  s_and_b32 s60, s44, 1
  s_mul_i32 s63, s44, 3072
  s_lshl_b32 s64, s44, 11
  s_lshl_b32 s65, s44, 8
  v_bfe_u32 v14, v10, 4, 2
  v_bfe_u32 v15, v10, 1, 2
  v_xor_b32 v14, v14, v15
  v_lshlrev_b32 v14, 5, v14
  v_and_b32 v15, 1, v10
  v_lshl_add_u32 v213, v15, 4, v14
  s_lshl_b32 s48, s58, 7
  s_mul_i32 s49, s44, 49152
  s_add_u32 s48, s48, s49
  v_mul_u32_u24 v14, 6144, v13
  v_add3_u32 v202, v14, v213, s48
  v_add_u32 v203, 195584, v202
  v_add_u32 v204, 391168, v202
  v_bfe_u32 v14, v10, 3, 2
  v_lshlrev_b32 v14, 5, v14
  v_and_b32 v15, 3, v10
  v_lshl_add_u32 v214, v15, 3, v14
  v_bfe_u32 v14, v10, 2, 3
  v_lshrrev_b32 v15, 5, v10
  v_mul_u32_u24 v15, 24, v15
  v_add_lshl_u32 v14, v14, v15, 7
  s_lshl_b32 s48, s60, 1
  s_add_u32 s48, s48, s59
  s_lshl_b32 s48, s48, 5
  v_xor_b32 v15, s48, v214
  v_add_u32 v196, v14, v15
  v_xor_b32 v197, 32, v196
  v_add_u32 v198, 64512, v196
  v_add_u32 v199, 64512, v197
  v_add_u32 v200, 129024, v196
  v_add_u32 v201, 129024, v197
  s_lshl_b32 s48, s57, 2
  s_add_u32 s49, s48, s44
  s_lshl_b32 s49, s49, 16
  s_add_u32 s49, s49, 1048576
  v_add_u32 v205, s49, v0
  s_max_u32 s48, s48, 1
  s_lshl_b32 s48, s48, 16
  s_add_u32 s48, s48, 984064
  s_add_u32 s48, s48, s65
  v_lshl_add_u32 v206, v10, 2, s48
  s_lshl_b32 s48, s59, 12
  v_add_u32 v210, 0, v0
  v_add_u32 v207, s48, v210
  v_add_u32 v211, 64512, v0
  v_add_u32 v208, s48, v211
  v_add_u32 v212, 129024, v0
  v_add_u32 v209, s48, v212
  s_lshl3_add_u32 s48, s57, 127
  v_min_u32 v215, 8, v10
  v_add_u32 v215, s48, v215
  v_max_u32 v215, 0x80, v215
  v_lshlrev_b32 v215, 7, v215
  v_lshlrev_b32 v18, 5, v12
  v_lshrrev_b32 v19, 4, v10
  v_lshl_add_u32 v18, v19, 3, v18
  s_add_u32 s48, s65, 162816
  v_add_u32 v177, s48, v18
  v_lshlrev_b32 v178, 2, v10
  s_and_b32 s49, s2, 3
  s_mul_i32 s56, s49, 24576
  s_lshl1_add_u32 s56, s51, s56
  s_add_u32 s51, s51, 4096
  s_cmp_lt_u32 s2, 128
  s_cbranch_scc1 F_cw
  s_waitcnt vmcnt(4)
F_cw:
  s_waitcnt vmcnt(9)
  v_lshlrev_b32 v168, 16, v188
  v_and_b32 v169, 0xffff0000, v188
  v_lshlrev_b32 v170, 16, v189
  v_and_b32 v171, 0xffff0000, v189
  v_lshlrev_b32 v172, 16, v190
  v_and_b32 v173, 0xffff0000, v190
  v_lshlrev_b32 v174, 16, v191
  v_and_b32 v175, 0xffff0000, v191
  v_mul_f32 v180, 0xbfb8aa3b, v168
  v_mul_f32 v181, 0xbfb8aa3b, v169
  v_mul_f32 v182, 0xbfb8aa3b, v170
  v_mul_f32 v183, 0xbfb8aa3b, v171
  v_mul_f32 v184, 0xbfb8aa3b, v172
  v_mul_f32 v185, 0xbfb8aa3b, v173
  v_mul_f32 v186, 0xbfb8aa3b, v174
  v_mul_f32 v187, 0xbfb8aa3b, v175
  v_exp_f32 v180, v180
  v_exp_f32 v181, v181
  v_exp_f32 v182, v182
  v_exp_f32 v183, v183
  v_exp_f32 v184, v184
  v_exp_f32 v185, v185
  v_exp_f32 v186, v186
  v_exp_f32 v187, v187
  v_add_f32 v180, 1.0, v180
  v_add_f32 v181, 1.0, v181
  v_add_f32 v182, 1.0, v182
  v_add_f32 v183, 1.0, v183
  v_add_f32 v184, 1.0, v184
  v_add_f32 v185, 1.0, v185
  v_add_f32 v186, 1.0, v186
  v_add_f32 v187, 1.0, v187
  v_rcp_f32 v180, v180
  v_rcp_f32 v181, v181
  v_rcp_f32 v182, v182
  v_rcp_f32 v183, v183
  v_rcp_f32 v184, v184
  v_rcp_f32 v185, v185
  v_rcp_f32 v186, v186
  v_rcp_f32 v187, v187
  v_mul_f32 v168, v168, v180
  v_mul_f32 v169, v169, v181
  v_mul_f32 v170, v170, v182
  v_mul_f32 v171, v171, v183
  v_mul_f32 v172, v172, v184
  v_mul_f32 v173, v173, v185
  v_mul_f32 v174, v174, v186
  v_mul_f32 v175, v175, v187
  v_cvt_pk_bf16_f32 v192, v168, v169
  v_lshlrev_b32 v168, 16, v192
  v_and_b32 v169, 0xffff0000, v192
  v_cvt_pk_bf16_f32 v192, v170, v171
  v_lshlrev_b32 v170, 16, v192
  v_and_b32 v171, 0xffff0000, v192
  v_cvt_pk_bf16_f32 v192, v172, v173
  v_lshlrev_b32 v172, 16, v192
  v_and_b32 v173, 0xffff0000, v192
  v_cvt_pk_bf16_f32 v192, v174, v175
  v_lshlrev_b32 v174, 16, v192
  v_and_b32 v175, 0xffff0000, v192
  s_cmp_lt_u32 s2, 128
  s_cbranch_scc1 F_xl1
  buffer_load_dwordx4 v[136:139], v132, s[4:7], s50 offen offset:0
  buffer_load_dwordx4 v[140:143], v132, s[4:7], s50 offen offset:128
  buffer_load_dwordx4 v[144:147], v132, s[4:7], s50 offen offset:256
  buffer_load_dwordx4 v[148:151], v132, s[4:7], s50 offen offset:384
  s_add_u32 s50, s50, 16384
  buffer_load_dwordx4 v[152:155], v132, s[4:7], s50 offen offset:0
  buffer_load_dwordx4 v[156:159], v132, s[4:7], s50 offen offset:128
  buffer_load_dwordx4 v[160:163], v132, s[4:7], s50 offen offset:256
  buffer_load_dwordx4 v[164:167], v132, s[4:7], s50 offen offset:384
F_xl1:
  s_cmp_lt_u32 s2, 128
  s_cbranch_scc0 AL
  s_waitcnt vmcnt(8)
  v_lshlrev_b32 v188, 16, v136
  v_and_b32 v189, 0xffff0000, v136
  v_lshlrev_b32 v190, 16, v137
  v_and_b32 v191, 0xffff0000, v137
  v_pk_mul_f32 v[180:181], v[188:189], v[168:169] op_sel_hi:[1,0]
  v_pk_mul_f32 v[182:183], v[190:191], v[168:169] op_sel_hi:[1,0]
  v_lshlrev_b32 v188, 16, v138
  v_and_b32 v189, 0xffff0000, v138
  v_lshlrev_b32 v190, 16, v139
  v_and_b32 v191, 0xffff0000, v139
  v_pk_mul_f32 v[184:185], v[188:189], v[168:169] op_sel_hi:[1,0]
  v_pk_mul_f32 v[186:187], v[190:191], v[168:169] op_sel_hi:[1,0]
  s_waitcnt vmcnt(7)
  v_lshlrev_b32 v188, 16, v140
  v_and_b32 v189, 0xffff0000, v140
  v_lshlrev_b32 v190, 16, v141
  v_and_b32 v191, 0xffff0000, v141
  v_pk_fma_f32 v[180:181], v[188:189], v[168:169], v[180:181] op_sel:[0,1,0] op_sel_hi:[1,1,1]
  v_pk_fma_f32 v[182:183], v[190:191], v[168:169], v[182:183] op_sel:[0,1,0] op_sel_hi:[1,1,1]
  v_lshlrev_b32 v188, 16, v142
  v_and_b32 v189, 0xffff0000, v142
  v_lshlrev_b32 v190, 16, v143
  v_and_b32 v191, 0xffff0000, v143
  v_pk_fma_f32 v[184:185], v[188:189], v[168:169], v[184:185] op_sel:[0,1,0] op_sel_hi:[1,1,1]
  v_pk_fma_f32 v[186:187], v[190:191], v[168:169], v[186:187] op_sel:[0,1,0] op_sel_hi:[1,1,1]
  s_waitcnt vmcnt(6)
  v_lshlrev_b32 v188, 16, v144
  v_and_b32 v189, 0xffff0000, v144
  v_lshlrev_b32 v190, 16, v145
  v_and_b32 v191, 0xffff0000, v145
  v_pk_fma_f32 v[180:181], v[188:189], v[170:171], v[180:181] op_sel:[0,0,0] op_sel_hi:[1,0,1]
  v_pk_fma_f32 v[182:183], v[190:191], v[170:171], v[182:183] op_sel:[0,0,0] op_sel_hi:[1,0,1]
  v_lshlrev_b32 v188, 16, v146
  v_and_b32 v189, 0xffff0000, v146
  v_lshlrev_b32 v190, 16, v147
  v_and_b32 v191, 0xffff0000, v147
  v_pk_fma_f32 v[184:185], v[188:189], v[170:171], v[184:185] op_sel:[0,0,0] op_sel_hi:[1,0,1]
  v_pk_fma_f32 v[186:187], v[190:191], v[170:171], v[186:187] op_sel:[0,0,0] op_sel_hi:[1,0,1]
  s_waitcnt vmcnt(5)
  v_lshlrev_b32 v188, 16, v148
  v_and_b32 v189, 0xffff0000, v148
  v_lshlrev_b32 v190, 16, v149
  v_and_b32 v191, 0xffff0000, v149
  v_pk_fma_f32 v[180:181], v[188:189], v[170:171], v[180:181] op_sel:[0,1,0] op_sel_hi:[1,1,1]
  v_pk_fma_f32 v[182:183], v[190:191], v[170:171], v[182:183] op_sel:[0,1,0] op_sel_hi:[1,1,1]
  v_lshlrev_b32 v188, 16, v150
  v_and_b32 v189, 0xffff0000, v150
  v_lshlrev_b32 v190, 16, v151
  v_and_b32 v191, 0xffff0000, v151
  v_pk_fma_f32 v[184:185], v[188:189], v[170:171], v[184:185] op_sel:[0,1,0] op_sel_hi:[1,1,1]
  v_pk_fma_f32 v[186:187], v[190:191], v[170:171], v[186:187] op_sel:[0,1,0] op_sel_hi:[1,1,1]
  s_waitcnt vmcnt(4)
  v_lshlrev_b32 v188, 16, v152
  v_and_b32 v189, 0xffff0000, v152
  v_lshlrev_b32 v190, 16, v153
  v_and_b32 v191, 0xffff0000, v153
  v_pk_fma_f32 v[180:181], v[188:189], v[172:173], v[180:181] op_sel:[0,0,0] op_sel_hi:[1,0,1]
  v_pk_fma_f32 v[182:183], v[190:191], v[172:173], v[182:183] op_sel:[0,0,0] op_sel_hi:[1,0,1]
  v_lshlrev_b32 v188, 16, v154
  v_and_b32 v189, 0xffff0000, v154
  v_lshlrev_b32 v190, 16, v155
  v_and_b32 v191, 0xffff0000, v155
  v_pk_fma_f32 v[184:185], v[188:189], v[172:173], v[184:185] op_sel:[0,0,0] op_sel_hi:[1,0,1]
  v_pk_fma_f32 v[186:187], v[190:191], v[172:173], v[186:187] op_sel:[0,0,0] op_sel_hi:[1,0,1]
  s_waitcnt vmcnt(3)
  v_lshlrev_b32 v188, 16, v156
  v_and_b32 v189, 0xffff0000, v156
  v_lshlrev_b32 v190, 16, v157
  v_and_b32 v191, 0xffff0000, v157
  v_pk_fma_f32 v[180:181], v[188:189], v[172:173], v[180:181] op_sel:[0,1,0] op_sel_hi:[1,1,1]
  v_pk_fma_f32 v[182:183], v[190:191], v[172:173], v[182:183] op_sel:[0,1,0] op_sel_hi:[1,1,1]
  v_lshlrev_b32 v188, 16, v158
  v_and_b32 v189, 0xffff0000, v158
  v_lshlrev_b32 v190, 16, v159
  v_and_b32 v191, 0xffff0000, v159
  v_pk_fma_f32 v[184:185], v[188:189], v[172:173], v[184:185] op_sel:[0,1,0] op_sel_hi:[1,1,1]
  v_pk_fma_f32 v[186:187], v[190:191], v[172:173], v[186:187] op_sel:[0,1,0] op_sel_hi:[1,1,1]
  s_waitcnt vmcnt(2)
  v_lshlrev_b32 v188, 16, v160
  v_and_b32 v189, 0xffff0000, v160
  v_lshlrev_b32 v190, 16, v161
  v_and_b32 v191, 0xffff0000, v161
  v_pk_fma_f32 v[180:181], v[188:189], v[174:175], v[180:181] op_sel:[0,0,0] op_sel_hi:[1,0,1]
  v_pk_fma_f32 v[182:183], v[190:191], v[174:175], v[182:183] op_sel:[0,0,0] op_sel_hi:[1,0,1]
  v_lshlrev_b32 v188, 16, v162
  v_and_b32 v189, 0xffff0000, v162
  v_lshlrev_b32 v190, 16, v163
  v_and_b32 v191, 0xffff0000, v163
  v_pk_fma_f32 v[184:185], v[188:189], v[174:175], v[184:185] op_sel:[0,0,0] op_sel_hi:[1,0,1]
  v_pk_fma_f32 v[186:187], v[190:191], v[174:175], v[186:187] op_sel:[0,0,0] op_sel_hi:[1,0,1]
  s_waitcnt vmcnt(1)
  v_lshlrev_b32 v188, 16, v164
  v_and_b32 v189, 0xffff0000, v164
  v_lshlrev_b32 v190, 16, v165
  v_and_b32 v191, 0xffff0000, v165
  v_pk_fma_f32 v[180:181], v[188:189], v[174:175], v[180:181] op_sel:[0,1,0] op_sel_hi:[1,1,1]
  v_pk_fma_f32 v[182:183], v[190:191], v[174:175], v[182:183] op_sel:[0,1,0] op_sel_hi:[1,1,1]
  v_lshlrev_b32 v188, 16, v166
  v_and_b32 v189, 0xffff0000, v166
  v_lshlrev_b32 v190, 16, v167
  v_and_b32 v191, 0xffff0000, v167
  v_pk_fma_f32 v[184:185], v[188:189], v[174:175], v[184:185] op_sel:[0,1,0] op_sel_hi:[1,1,1]
  v_pk_fma_f32 v[186:187], v[190:191], v[174:175], v[186:187] op_sel:[0,1,0] op_sel_hi:[1,1,1]
  s_nop 0
  v_permlane32_swap_b32 v180, v184
  v_permlane32_swap_b32 v181, v185
  v_permlane32_swap_b32 v182, v186
  v_permlane32_swap_b32 v183, v187
  v_add_f32 v180, v180, v184
  v_add_f32 v181, v181, v185
  v_add_f32 v182, v182, v186
  v_add_f32 v183, v183, v187
  s_nop 0
  v_permlane16_swap_b32 v180, v182
  v_permlane16_swap_b32 v181, v183
  v_add_f32 v180, v180, v182
  v_add_f32 v181, v181, v183
  v_add_u32 v188, 162816, v178
  v_add_f32_dpp v180, v180, v180 row_ror:8 row_mask:0xf bank_mask:0xf
  v_add_f32_dpp v181, v181, v181 row_ror:8 row_mask:0xf bank_mask:0xf
  ds_write_b64 v177, v[180:181]
  v_and_b32 v184, 3, v10
  v_lshlrev_b32 v184, 3, v184
  s_cmp_eq_u32 s44, 0
  s_cselect_b32 s48, s56, 1073741824
  s_waitcnt lgkmcnt(0)
  s_barrier
  ds_read_b32 v180, v188 offset:0
  ds_read_b32 v181, v188 offset:256
  ds_read_b32 v182, v188 offset:512
  ds_read_b32 v183, v188 offset:768
  s_waitcnt vmcnt(0)
  v_readfirstlane_b32 s3, v195
  s_lshl_b32 s45, s2, 7
  s_add_u32 s45, s45, 5242880
  s_cmp_eq_u32 s44, 0
  s_cselect_b32 s45, s45, 1073741824
  s_mul_i32 s3, s3, 0x9e3779b1
  s_add_u32 s3, s3, 0x7f4a7c15
  s_and_b32 s70, s2, 7
  s_bfe_u32 s49, s2, 0x20003
  s_lshl2_add_u32 s70, s70, s49
  s_lshr_b32 s49, s2, 5
  s_lshl3_add_u32 s70, s70, s49
  s_lshl1_add_u32 s70, s70, s44
  s_lshl_b32 s70, s70, 10
  s_add_u32 s70, s70, 524288
  s_add_u32 s56, s56, 8192
  s_cmp_lt_u32 s44, 2
  s_cselect_b32 s70, s70, 1073741824
  s_cmp_eq_u32 s44, 2
  s_cselect_b32 s71, s56, 1073741824
  v_bfe_u32 v184, s3, v184, 8
  v_mov_b32 v185, 0xffffff00
  s_waitcnt lgkmcnt(0)
  v_add_f32 v180, v180, v181
  v_add_f32 v182, v182, v183
  v_add_f32 v180, v180, v182
  v_add_u32 v180, 0x80, v180
  v_and_or_b32 v180, v180, v185, v184
  buffer_store_dword v180, v178, s[36:39], s48 offen sc1
  v_mov_b32 v184, -1
  v_mov_b32 v185, -1
  v_mov_b32 v186, -1
  v_mov_b32 v187, -1
  buffer_store_dwordx4 v[184:187], v0, s[36:39], s70 offen sc1
  buffer_store_dword v184, v178, s[36:39], s71 offen sc1
  s_lshl_b32 s48, s44, 7
  s_add_u32 s48, s48, s2
  s_lshl_b32 s48, s48, 13
  v_lshlrev_b32 v14, 3, v0
  s_mov_b32 s50, s48
  buffer_load_dword a252, v14, s[8:11], s50 offen
  s_mov_b32 s55, 0x20000
  s_sub_u32 s49, s48, 2097152
  s_add_u32 s48, s48, 4194304
  s_cmp_ge_u32 s44, 2
  s_cselect_b64 s[52:53], s[12:13], s[8:9]
  s_cselect_b32 s54, s14, s10
  s_cselect_b32 s48, s49, s48
  v_mov_b32 v12, s3
  s_waitcnt vmcnt(1)
  s_barrier
  s_mov_b64 exec, 1
  buffer_store_dword v12, v0, s[36:39], s45 offen sc1
  s_mov_b64 exec, -1
  s_waitcnt vmcnt(1)
  s_lshr_b32 s49, s2, 3
  s_mul_i32 s49, s49, 393216
  s_add_u32 s49, s49, s64
  s_and_b32 s50, s2, 2
  s_lshl_b32 s50, s50, 9
  s_add_u32 s49, s49, s50
  s_and_b32 s50, s2, 1
  s_lshl2_add_u32 s50, s50, s44
  s_cmp_lt_u32 s50, 3
  s_cselect_b32 s49, s49, 1073741824
  v_min_u32 v15, 63, v10
  v_mul_u32_u24 v15, 6144, v15
  buffer_load_dword a252, v15, s[8:11], s49 offen offset:384
  buffer_load_dword a252, v14, s[52:55], s48 offen
  s_branch J2
.p2align 12
AL:
  s_waitcnt vmcnt(8)
  v_readfirstlane_b32 s3, v195
  s_lshl_b32 s45, s2, 7
  s_add_u32 s45, s45, 5242880
  s_cmp_eq_u32 s44, 0
  s_cselect_b32 s45, s45, 1073741824
  s_mul_i32 s3, s3, 0x9e3779b1
  s_add_u32 s3, s3, 0x7f4a7c15
  s_and_b32 s70, s2, 7
  s_bfe_u32 s49, s2, 0x20003
  s_lshl2_add_u32 s70, s70, s49
  s_lshr_b32 s49, s2, 5
  s_lshl3_add_u32 s70, s70, s49
  s_lshl1_add_u32 s70, s70, s44
  s_lshl_b32 s70, s70, 10
  s_add_u32 s70, s70, 524288
  s_add_u32 s56, s56, 8192
  s_cmp_lt_u32 s44, 2
  s_cselect_b32 s70, s70, 1073741824
  s_cmp_eq_u32 s44, 2
  s_cselect_b32 s71, s56, 1073741824
  s_add_u32 s48, s64, 150528
  v_add_u32 v14, s48, v0
  v_lshl_add_u32 v15, v13, 5, s48
  v_lshlrev_b32 v17, 6, v12
  v_add_u32 v17, 158720, v17
  s_lshl_b32 s48, s44, 4
  v_add_u32 v16, s48, v17
  v_bfe_u32 v18, v10, 3, 1
  v_lshlrev_b32 v132, 9, v18
  v_bfe_u32 v18, v10, 4, 1
  v_lshl_add_u32 v132, v18, 8, v132
  v_lshrrev_b32 v18, 5, v10
  v_lshl_add_u32 v132, v18, 11, v132
  v_lshl_add_u32 v132, v12, 4, v132
  s_bfe_u32 s50, s2, 0x60001
  s_lshl2_add_u32 s50, s50, s44
  s_lshl_b32 s50, s50, 4
  s_and_b32 s48, s2, 1
  s_add_u32 s50, s50, s48
  s_lshl_b32 s50, s50, 10
  s_add_u32 s50, s50, 1048576
  s_bfe_u32 s66, s3, 0x80000
  s_bfe_u32 s67, s3, 0x80008
  s_bfe_u32 s68, s3, 0x80010
  s_bfe_u32 s69, s3, 0x80018
  s_waitcnt vmcnt(7)
  v_lshlrev_b32 v20, 16, v136
  v_and_b32 v21, 0xffff0000, v136
  v_lshlrev_b32 v22, 16, v137
  v_and_b32 v23, 0xffff0000, v137
  v_lshlrev_b32 v24, 16, v138
  v_and_b32 v25, 0xffff0000, v138
  v_lshlrev_b32 v26, 16, v139
  v_and_b32 v27, 0xffff0000, v139
  v_pk_mul_f32 v[126:127], v[20:21], v[20:21]
  v_pk_mul_f32 v[130:131], v[22:23], v[22:23]
  v_pk_fma_f32 v[126:127], v[24:25], v[24:25], v[126:127]
  v_pk_add_f32 v[124:125], v[24:25], v[20:21]
  v_pk_fma_f32 v[130:131], v[26:27], v[26:27], v[130:131]
  v_pk_add_f32 v[128:129], v[26:27], v[22:23]
  s_waitcnt vmcnt(6)
  v_lshlrev_b32 v28, 16, v140
  v_and_b32 v29, 0xffff0000, v140
  v_lshlrev_b32 v30, 16, v141
  v_and_b32 v31, 0xffff0000, v141
  v_lshlrev_b32 v32, 16, v142
  v_and_b32 v33, 0xffff0000, v142
  v_lshlrev_b32 v34, 16, v143
  v_and_b32 v35, 0xffff0000, v143
  v_pk_fma_f32 v[126:127], v[28:29], v[28:29], v[126:127]
  v_pk_add_f32 v[124:125], v[28:29], v[124:125]
  v_pk_fma_f32 v[130:131], v[30:31], v[30:31], v[130:131]
  v_pk_add_f32 v[128:129], v[30:31], v[128:129]
  v_pk_fma_f32 v[126:127], v[32:33], v[32:33], v[126:127]
  v_pk_add_f32 v[124:125], v[32:33], v[124:125]
  v_pk_fma_f32 v[130:131], v[34:35], v[34:35], v[130:131]
  v_pk_add_f32 v[128:129], v[34:35], v[128:129]
  s_waitcnt vmcnt(5)
  v_lshlrev_b32 v36, 16, v144
  v_and_b32 v37, 0xffff0000, v144
  v_lshlrev_b32 v38, 16, v145
  v_and_b32 v39, 0xffff0000, v145
  v_lshlrev_b32 v40, 16, v146
  v_and_b32 v41, 0xffff0000, v146
  v_lshlrev_b32 v42, 16, v147
  v_and_b32 v43, 0xffff0000, v147
  v_pk_fma_f32 v[126:127], v[36:37], v[36:37], v[126:127]
  v_pk_add_f32 v[124:125], v[36:37], v[124:125]
  v_pk_fma_f32 v[130:131], v[38:39], v[38:39], v[130:131]
  v_pk_add_f32 v[128:129], v[38:39], v[128:129]
  v_pk_fma_f32 v[126:127], v[40:41], v[40:41], v[126:127]
  v_pk_add_f32 v[124:125], v[40:41], v[124:125]
  v_pk_fma_f32 v[130:131], v[42:43], v[42:43], v[130:131]
  v_pk_add_f32 v[128:129], v[42:43], v[128:129]
  s_waitcnt vmcnt(4)
  v_lshlrev_b32 v44, 16, v148
  v_and_b32 v45, 0xffff0000, v148
  v_lshlrev_b32 v46, 16, v149
  v_and_b32 v47, 0xffff0000, v149
  v_lshlrev_b32 v48, 16, v150
  v_and_b32 v49, 0xffff0000, v150
  v_lshlrev_b32 v50, 16, v151
  v_and_b32 v51, 0xffff0000, v151
  v_pk_fma_f32 v[126:127], v[44:45], v[44:45], v[126:127]
  v_pk_add_f32 v[124:125], v[44:45], v[124:125]
  v_pk_fma_f32 v[130:131], v[46:47], v[46:47], v[130:131]
  v_pk_add_f32 v[128:129], v[46:47], v[128:129]
  v_pk_fma_f32 v[126:127], v[48:49], v[48:49], v[126:127]
  v_pk_add_f32 v[124:125], v[48:49], v[124:125]
  v_pk_fma_f32 v[130:131], v[50:51], v[50:51], v[130:131]
  v_pk_add_f32 v[128:129], v[50:51], v[128:129]
  v_pk_add_f32 v[124:125], v[124:125], v[128:129]
  v_pk_add_f32 v[126:127], v[126:127], v[130:131]
  v_add_f32 v180, v124, v125
  v_add_f32 v181, v126, v127
  s_waitcnt vmcnt(3)
  v_lshlrev_b32 v52, 16, v152
  v_and_b32 v53, 0xffff0000, v152
  v_lshlrev_b32 v54, 16, v153
  v_and_b32 v55, 0xffff0000, v153
  v_lshlrev_b32 v56, 16, v154
  v_and_b32 v57, 0xffff0000, v154
  v_lshlrev_b32 v58, 16, v155
  v_and_b32 v59, 0xffff0000, v155
  v_pk_mul_f32 v[126:127], v[52:53], v[52:53]
  v_pk_mul_f32 v[130:131], v[54:55], v[54:55]
  v_pk_fma_f32 v[126:127], v[56:57], v[56:57], v[126:127]
  v_pk_add_f32 v[124:125], v[56:57], v[52:53]
  v_pk_fma_f32 v[130:131], v[58:59], v[58:59], v[130:131]
  v_pk_add_f32 v[128:129], v[58:59], v[54:55]
  s_waitcnt vmcnt(2)
  v_lshlrev_b32 v60, 16, v156
  v_and_b32 v61, 0xffff0000, v156
  v_lshlrev_b32 v62, 16, v157
  v_and_b32 v63, 0xffff0000, v157
  v_lshlrev_b32 v64, 16, v158
  v_and_b32 v65, 0xffff0000, v158
  v_lshlrev_b32 v66, 16, v159
  v_and_b32 v67, 0xffff0000, v159
  v_pk_fma_f32 v[126:127], v[60:61], v[60:61], v[126:127]
  v_pk_add_f32 v[124:125], v[60:61], v[124:125]
  v_pk_fma_f32 v[130:131], v[62:63], v[62:63], v[130:131]
  v_pk_add_f32 v[128:129], v[62:63], v[128:129]
  v_pk_fma_f32 v[126:127], v[64:65], v[64:65], v[126:127]
  v_pk_add_f32 v[124:125], v[64:65], v[124:125]
  v_pk_fma_f32 v[130:131], v[66:67], v[66:67], v[130:131]
  v_pk_add_f32 v[128:129], v[66:67], v[128:129]
  s_waitcnt vmcnt(1)
  v_lshlrev_b32 v68, 16, v160
  v_and_b32 v69, 0xffff0000, v160
  v_lshlrev_b32 v70, 16, v161
  v_and_b32 v71, 0xffff0000, v161
  v_lshlrev_b32 v72, 16, v162
  v_and_b32 v73, 0xffff0000, v162
  v_lshlrev_b32 v74, 16, v163
  v_and_b32 v75, 0xffff0000, v163
  v_pk_fma_f32 v[126:127], v[68:69], v[68:69], v[126:127]
  v_pk_add_f32 v[124:125], v[68:69], v[124:125]
  v_pk_fma_f32 v[130:131], v[70:71], v[70:71], v[130:131]
  v_pk_add_f32 v[128:129], v[70:71], v[128:129]
  v_pk_fma_f32 v[126:127], v[72:73], v[72:73], v[126:127]
  v_pk_add_f32 v[124:125], v[72:73], v[124:125]
  v_pk_fma_f32 v[130:131], v[74:75], v[74:75], v[130:131]
  v_pk_add_f32 v[128:129], v[74:75], v[128:129]
  s_waitcnt vmcnt(0)
  v_lshlrev_b32 v76, 16, v164
  v_and_b32 v77, 0xffff0000, v164
  v_lshlrev_b32 v78, 16, v165
  v_and_b32 v79, 0xffff0000, v165
  v_lshlrev_b32 v80, 16, v166
  v_and_b32 v81, 0xffff0000, v166
  v_lshlrev_b32 v82, 16, v167
  v_and_b32 v83, 0xffff0000, v167
  v_pk_fma_f32 v[126:127], v[76:77], v[76:77], v[126:127]
  v_pk_add_f32 v[124:125], v[76:77], v[124:125]
  v_pk_fma_f32 v[130:131], v[78:79], v[78:79], v[130:131]
  v_pk_add_f32 v[128:129], v[78:79], v[128:129]
  v_pk_fma_f32 v[126:127], v[80:81], v[80:81], v[126:127]
  v_pk_add_f32 v[124:125], v[80:81], v[124:125]
  v_pk_fma_f32 v[130:131], v[82:83], v[82:83], v[130:131]
  v_pk_add_f32 v[128:129], v[82:83], v[128:129]
  v_pk_add_f32 v[124:125], v[124:125], v[128:129]
  v_pk_add_f32 v[126:127], v[126:127], v[130:131]
  v_add_f32 v182, v124, v125
  v_add_f32 v183, v126, v127
  s_nop 0
  v_add_f32_dpp v188, v180, v180 row_ror:8 row_mask:0xf bank_mask:0xf
  v_add_f32_dpp v189, v181, v181 row_ror:8 row_mask:0xf bank_mask:0xf
  v_add_f32_dpp v190, v182, v182 row_ror:8 row_mask:0xf bank_mask:0xf
  v_add_f32_dpp v191, v183, v183 row_ror:8 row_mask:0xf bank_mask:0xf
  v_mov_b32 v180, v188
  v_mov_b32 v181, v189
  v_mov_b32 v182, v190
  v_mov_b32 v183, v191
  v_permlane16_swap_b32 v188, v180
  v_permlane16_swap_b32 v189, v181
  v_permlane16_swap_b32 v190, v182
  v_permlane16_swap_b32 v191, v183
  v_pk_add_f32 v[188:189], v[188:189], v[180:181]
  v_pk_add_f32 v[190:191], v[190:191], v[182:183]
  v_mov_b32 v180, v188
  v_mov_b32 v181, v189
  v_mov_b32 v182, v190
  v_mov_b32 v183, v191
  v_permlane32_swap_b32 v188, v180
  v_permlane32_swap_b32 v189, v181
  v_permlane32_swap_b32 v190, v182
  v_permlane32_swap_b32 v191, v183
  v_pk_add_f32 v[188:189], v[188:189], v[180:181]
  v_pk_add_f32 v[190:191], v[190:191], v[182:183]
  ds_write_b128 v16, v[188:191]
  s_waitcnt lgkmcnt(0)
  s_barrier
  ds_read_b128 v[136:139], v17 offset:0
  ds_read_b128 v[140:143], v17 offset:16
  ds_read_b128 v[144:147], v17 offset:32
  ds_read_b128 v[148:151], v17 offset:48
  s_lshl_b32 s49, s44, 10
  buffer_load_dwordx4 v[220:223], v0, s[36:39], s49 offen sc1
  s_add_u32 s49, s49, 4096
  buffer_load_dwordx4 v[84:87], v0, s[36:39], s49 offen sc1
  s_add_u32 s49, s49, 20480
  buffer_load_dwordx4 v[224:227], v0, s[36:39], s49 offen sc1
  s_add_u32 s49, s49, 4096
  buffer_load_dwordx4 v[88:91], v0, s[36:39], s49 offen sc1
  s_add_u32 s49, s49, 20480
  buffer_load_dwordx4 v[228:231], v0, s[36:39], s49 offen sc1
  s_add_u32 s49, s49, 4096
  buffer_load_dwordx4 v[92:95], v0, s[36:39], s49 offen sc1
  s_add_u32 s49, s49, 20480
  buffer_load_dwordx4 v[232:235], v0, s[36:39], s49 offen sc1
  s_add_u32 s49, s49, 4096
  buffer_load_dwordx4 v[96:99], v0, s[36:39], s49 offen sc1
  s_waitcnt lgkmcnt(0)
  v_pk_add_f32 v[136:137], v[136:137], v[144:145]
  v_pk_add_f32 v[138:139], v[138:139], v[146:147]
  v_pk_add_f32 v[140:141], v[140:141], v[148:149]
  v_pk_add_f32 v[142:143], v[142:143], v[150:151]
  v_pk_add_f32 v[136:137], v[136:137], v[140:141]
  v_pk_add_f32 v[138:139], v[138:139], v[142:143]
  v_mul_f32 v188, 0x3a800000, v136
  v_mul_f32 v189, 0x3a800000, v137
  v_mul_f32 v190, 0x3a800000, v138
  v_mul_f32 v191, 0x3a800000, v139
  v_fma_f32 v189, -v188, v188, v189
  v_fma_f32 v191, -v190, v190, v191
  v_max_f32 v189, 0, v189
  v_max_f32 v191, 0, v191
  v_cvt_pk_bf16_f32 v189, v189, v189
  v_cvt_pk_bf16_f32 v191, v191, v191
  v_lshlrev_b32 v189, 16, v189
  v_lshlrev_b32 v191, 16, v191
  v_add_f32 v189, 0x3727c5ac, v189
  v_add_f32 v191, 0x3727c5ac, v191
  v_cvt_pk_bf16_f32 v189, v189, v189
  v_cvt_pk_bf16_f32 v191, v191, v191
  v_lshlrev_b32 v189, 16, v189
  v_lshlrev_b32 v191, 16, v191
  v_sqrt_f32 v189, v189
  v_sqrt_f32 v191, v191
  v_cvt_pk_bf16_f32 v188, v188, v188
  v_cvt_pk_bf16_f32 v190, v190, v190
  v_lshlrev_b32 v188, 16, v188
  v_lshlrev_b32 v190, 16, v190
  v_cvt_pk_bf16_f32 v189, v189, v189
  v_cvt_pk_bf16_f32 v191, v191, v191
  v_lshlrev_b32 v189, 16, v189
  v_lshlrev_b32 v191, 16, v191
  v_rcp_f32 v189, v189
  v_rcp_f32 v191, v191
  v_mul_f32 v188, -v188, v189
  v_mul_f32 v190, -v190, v191
  v_pk_fma_f32 v[20:21], v[20:21], v[188:189], v[188:189] op_sel:[0,1,0] op_sel_hi:[1,1,0]
  v_pk_fma_f32 v[22:23], v[22:23], v[188:189], v[188:189] op_sel:[0,1,0] op_sel_hi:[1,1,0]
  v_pk_fma_f32 v[24:25], v[24:25], v[188:189], v[188:189] op_sel:[0,1,0] op_sel_hi:[1,1,0]
  v_pk_fma_f32 v[26:27], v[26:27], v[188:189], v[188:189] op_sel:[0,1,0] op_sel_hi:[1,1,0]
  v_pk_fma_f32 v[28:29], v[28:29], v[188:189], v[188:189] op_sel:[0,1,0] op_sel_hi:[1,1,0]
  v_pk_fma_f32 v[30:31], v[30:31], v[188:189], v[188:189] op_sel:[0,1,0] op_sel_hi:[1,1,0]
  v_pk_fma_f32 v[32:33], v[32:33], v[188:189], v[188:189] op_sel:[0,1,0] op_sel_hi:[1,1,0]
  v_pk_fma_f32 v[34:35], v[34:35], v[188:189], v[188:189] op_sel:[0,1,0] op_sel_hi:[1,1,0]
  v_pk_fma_f32 v[36:37], v[36:37], v[188:189], v[188:189] op_sel:[0,1,0] op_sel_hi:[1,1,0]
  v_pk_fma_f32 v[38:39], v[38:39], v[188:189], v[188:189] op_sel:[0,1,0] op_sel_hi:[1,1,0]
  v_pk_fma_f32 v[40:41], v[40:41], v[188:189], v[188:189] op_sel:[0,1,0] op_sel_hi:[1,1,0]
  v_pk_fma_f32 v[42:43], v[42:43], v[188:189], v[188:189] op_sel:[0,1,0] op_sel_hi:[1,1,0]
  v_pk_fma_f32 v[44:45], v[44:45], v[188:189], v[188:189] op_sel:[0,1,0] op_sel_hi:[1,1,0]
  v_pk_fma_f32 v[46:47], v[46:47], v[188:189], v[188:189] op_sel:[0,1,0] op_sel_hi:[1,1,0]
  v_pk_fma_f32 v[48:49], v[48:49], v[188:189], v[188:189] op_sel:[0,1,0] op_sel_hi:[1,1,0]
  v_pk_fma_f32 v[50:51], v[50:51], v[188:189], v[188:189] op_sel:[0,1,0] op_sel_hi:[1,1,0]
  v_pk_fma_f32 v[52:53], v[52:53], v[190:191], v[190:191] op_sel:[0,1,0] op_sel_hi:[1,1,0]
  v_pk_fma_f32 v[54:55], v[54:55], v[190:191], v[190:191] op_sel:[0,1,0] op_sel_hi:[1,1,0]
  v_pk_fma_f32 v[56:57], v[56:57], v[190:191], v[190:191] op_sel:[0,1,0] op_sel_hi:[1,1,0]
  v_pk_fma_f32 v[58:59], v[58:59], v[190:191], v[190:191] op_sel:[0,1,0] op_sel_hi:[1,1,0]
  v_pk_fma_f32 v[60:61], v[60:61], v[190:191], v[190:191] op_sel:[0,1,0] op_sel_hi:[1,1,0]
  v_pk_fma_f32 v[62:63], v[62:63], v[190:191], v[190:191] op_sel:[0,1,0] op_sel_hi:[1,1,0]
  v_pk_fma_f32 v[64:65], v[64:65], v[190:191], v[190:191] op_sel:[0,1,0] op_sel_hi:[1,1,0]
  v_pk_fma_f32 v[66:67], v[66:67], v[190:191], v[190:191] op_sel:[0,1,0] op_sel_hi:[1,1,0]
  v_pk_fma_f32 v[68:69], v[68:69], v[190:191], v[190:191] op_sel:[0,1,0] op_sel_hi:[1,1,0]
  v_pk_fma_f32 v[70:71], v[70:71], v[190:191], v[190:191] op_sel:[0,1,0] op_sel_hi:[1,1,0]
  v_pk_fma_f32 v[72:73], v[72:73], v[190:191], v[190:191] op_sel:[0,1,0] op_sel_hi:[1,1,0]
  v_pk_fma_f32 v[74:75], v[74:75], v[190:191], v[190:191] op_sel:[0,1,0] op_sel_hi:[1,1,0]
  v_pk_fma_f32 v[76:77], v[76:77], v[190:191], v[190:191] op_sel:[0,1,0] op_sel_hi:[1,1,0]
  v_pk_fma_f32 v[78:79], v[78:79], v[190:191], v[190:191] op_sel:[0,1,0] op_sel_hi:[1,1,0]
  v_pk_fma_f32 v[80:81], v[80:81], v[190:191], v[190:191] op_sel:[0,1,0] op_sel_hi:[1,1,0]
  v_pk_fma_f32 v[82:83], v[82:83], v[190:191], v[190:191] op_sel:[0,1,0] op_sel_hi:[1,1,0]
  s_mov_b32 s46, 30000
  s_branch PLC
PLP:
  s_lshl_b32 s49, s44, 10
  buffer_load_dwordx4 v[220:223], v0, s[36:39], s49 offen sc1
  s_add_u32 s49, s49, 4096
  buffer_load_dwordx4 v[84:87], v0, s[36:39], s49 offen sc1
  s_add_u32 s49, s49, 20480
  buffer_load_dwordx4 v[224:227], v0, s[36:39], s49 offen sc1
  s_add_u32 s49, s49, 4096
  buffer_load_dwordx4 v[88:91], v0, s[36:39], s49 offen sc1
  s_add_u32 s49, s49, 20480
  buffer_load_dwordx4 v[228:231], v0, s[36:39], s49 offen sc1
  s_add_u32 s49, s49, 4096
  buffer_load_dwordx4 v[92:95], v0, s[36:39], s49 offen sc1
  s_add_u32 s49, s49, 20480
  buffer_load_dwordx4 v[232:235], v0, s[36:39], s49 offen sc1
  s_add_u32 s49, s49, 4096
  buffer_load_dwordx4 v[96:99], v0, s[36:39], s49 offen sc1
PLC:
  s_waitcnt vmcnt(7)
  v_xor_b32 v220, s66, v220
  v_xor_b32 v221, s67, v221
  v_xor_b32 v222, s68, v222
  v_xor_b32 v223, s69, v223
  v_or3_b32 v184, 0, v220, v221
  v_or3_b32 v184, v184, v222, v223
  s_waitcnt vmcnt(6)
  v_xor_b32 v84, s66, v84
  v_xor_b32 v85, s67, v85
  v_xor_b32 v86, s68, v86
  v_xor_b32 v87, s69, v87
  v_or3_b32 v184, v184, v84, v85
  v_or3_b32 v184, v184, v86, v87
  s_waitcnt vmcnt(5)
  v_xor_b32 v224, s66, v224
  v_xor_b32 v225, s67, v225
  v_xor_b32 v226, s68, v226
  v_xor_b32 v227, s69, v227
  v_or3_b32 v184, v184, v224, v225
  v_or3_b32 v184, v184, v226, v227
  s_waitcnt vmcnt(4)
  v_xor_b32 v88, s66, v88
  v_xor_b32 v89, s67, v89
  v_xor_b32 v90, s68, v90
  v_xor_b32 v91, s69, v91
  v_or3_b32 v184, v184, v88, v89
  v_or3_b32 v184, v184, v90, v91
  s_waitcnt vmcnt(3)
  v_xor_b32 v228, s66, v228
  v_xor_b32 v229, s67, v229
  v_xor_b32 v230, s68, v230
  v_xor_b32 v231, s69, v231
  v_or3_b32 v184, v184, v228, v229
  v_or3_b32 v184, v184, v230, v231
  s_waitcnt vmcnt(2)
  v_xor_b32 v92, s66, v92
  v_xor_b32 v93, s67, v93
  v_xor_b32 v94, s68, v94
  v_xor_b32 v95, s69, v95
  v_or3_b32 v184, v184, v92, v93
  v_or3_b32 v184, v184, v94, v95
  s_waitcnt vmcnt(1)
  v_xor_b32 v232, s66, v232
  v_xor_b32 v233, s67, v233
  v_xor_b32 v234, s68, v234
  v_xor_b32 v235, s69, v235
  v_or3_b32 v184, v184, v232, v233
  v_or3_b32 v184, v184, v234, v235
  s_waitcnt vmcnt(0)
  v_xor_b32 v96, s66, v96
  v_xor_b32 v97, s67, v97
  v_xor_b32 v98, s68, v98
  v_xor_b32 v99, s69, v99
  v_or3_b32 v184, v184, v96, v97
  v_or3_b32 v184, v184, v98, v99
  v_and_b32 v184, 0xff, v184
  v_cmp_ne_u32 vcc, 0, v184
  s_sub_u32 s46, s46, 1
  s_cmp_eq_u32 s46, 0
  s_cbranch_scc1 PLX
  s_nop 1
  s_cbranch_vccnz PLP
PLX:
  v_mov_b32 v180, -1
  v_mov_b32 v181, -1
  v_mov_b32 v182, -1
  v_mov_b32 v183, -1
  buffer_store_dwordx4 v[180:183], v0, s[36:39], s70 offen sc1
  buffer_store_dword v180, v178, s[36:39], s71 offen sc1
  v_pk_add_f32 v[84:85], v[84:85], v[92:93]
  v_pk_add_f32 v[220:221], v[220:221], v[228:229]
  v_pk_add_f32 v[86:87], v[86:87], v[94:95]
  v_pk_add_f32 v[222:223], v[222:223], v[230:231]
  v_pk_add_f32 v[88:89], v[88:89], v[96:97]
  v_pk_add_f32 v[224:225], v[224:225], v[232:233]
  v_pk_add_f32 v[90:91], v[90:91], v[98:99]
  v_pk_add_f32 v[226:227], v[226:227], v[234:235]
  v_pk_add_f32 v[84:85], v[84:85], v[88:89]
  v_pk_add_f32 v[220:221], v[220:221], v[224:225]
  v_pk_add_f32 v[86:87], v[86:87], v[90:91]
  v_pk_add_f32 v[222:223], v[222:223], v[226:227]
  v_cvt_pk_bf16_f32 v184, v220, v221
  v_lshlrev_b32 v220, 16, v184
  v_and_b32 v221, 0xffff0000, v184
  v_cvt_pk_bf16_f32 v184, v222, v223
  v_lshlrev_b32 v222, 16, v184
  v_and_b32 v223, 0xffff0000, v184
  ds_write_b128 v14, v[220:223] offset:1024
  v_cvt_pk_bf16_f32 v184, v84, v85
  v_lshlrev_b32 v84, 16, v184
  v_and_b32 v85, 0xffff0000, v184
  v_pk_add_f32 v[84:85], v[84:85], 1.0 op_sel_hi:[1,0]
  v_cvt_pk_bf16_f32 v184, v84, v85
  v_lshlrev_b32 v84, 16, v184
  v_and_b32 v85, 0xffff0000, v184
  v_cvt_pk_bf16_f32 v184, v86, v87
  v_lshlrev_b32 v86, 16, v184
  v_and_b32 v87, 0xffff0000, v184
  v_pk_add_f32 v[86:87], v[86:87], 1.0 op_sel_hi:[1,0]
  v_cvt_pk_bf16_f32 v184, v86, v87
  v_lshlrev_b32 v86, 16, v184
  v_and_b32 v87, 0xffff0000, v184
  ds_write_b128 v14, v[84:87]
  ds_read_b128 v[220:223], v15 offset:1024
  ds_read_b128 v[84:87], v15 offset:0
  ds_read_b128 v[224:227], v15 offset:1040
  ds_read_b128 v[88:91], v15 offset:16
  ds_read_b128 v[228:231], v15 offset:1280
  ds_read_b128 v[92:95], v15 offset:256
  ds_read_b128 v[232:235], v15 offset:1296
  ds_read_b128 v[96:99], v15 offset:272
  ds_read_b128 v[236:239], v15 offset:1536
  ds_read_b128 v[100:103], v15 offset:512
  ds_read_b128 v[240:243], v15 offset:1552
  ds_read_b128 v[104:107], v15 offset:528
  ds_read_b128 v[244:247], v15 offset:1792
  ds_read_b128 v[108:111], v15 offset:768
  ds_read_b128 v[248:251], v15 offset:1808
  ds_read_b128 v[112:115], v15 offset:784
  s_waitcnt lgkmcnt(12)
  v_pk_fma_f32 v[20:21], v[20:21], v[84:85], v[220:221]
  v_pk_fma_f32 v[22:23], v[22:23], v[86:87], v[222:223]
  v_pk_fma_f32 v[24:25], v[24:25], v[88:89], v[224:225]
  v_pk_fma_f32 v[26:27], v[26:27], v[90:91], v[226:227]
  v_pk_fma_f32 v[52:53], v[52:53], v[84:85], v[220:221]
  v_pk_fma_f32 v[54:55], v[54:55], v[86:87], v[222:223]
  v_pk_fma_f32 v[56:57], v[56:57], v[88:89], v[224:225]
  v_pk_fma_f32 v[58:59], v[58:59], v[90:91], v[226:227]
  v_cvt_pk_bf16_f32 v136, v20, v21
  v_cvt_pk_bf16_f32 v137, v22, v23
  v_cvt_pk_bf16_f32 v138, v24, v25
  v_cvt_pk_bf16_f32 v139, v26, v27
  v_cvt_pk_bf16_f32 v152, v52, v53
  v_cvt_pk_bf16_f32 v153, v54, v55
  v_cvt_pk_bf16_f32 v154, v56, v57
  v_cvt_pk_bf16_f32 v155, v58, v59
  v_permlane16_swap_b32 v136, v138
  v_permlane16_swap_b32 v137, v139
  v_permlane16_swap_b32 v152, v154
  v_permlane16_swap_b32 v153, v155
  buffer_store_dwordx4 v[136:139], v132, s[36:39], s50 offen offset:0 sc1
  buffer_store_dwordx4 v[152:155], v132, s[36:39], s50 offen offset:128 sc1
  s_add_u32 s50, s50, 4096
  s_waitcnt lgkmcnt(8)
  v_pk_fma_f32 v[28:29], v[28:29], v[92:93], v[228:229]
  v_pk_fma_f32 v[30:31], v[30:31], v[94:95], v[230:231]
  v_pk_fma_f32 v[32:33], v[32:33], v[96:97], v[232:233]
  v_pk_fma_f32 v[34:35], v[34:35], v[98:99], v[234:235]
  v_pk_fma_f32 v[60:61], v[60:61], v[92:93], v[228:229]
  v_pk_fma_f32 v[62:63], v[62:63], v[94:95], v[230:231]
  v_pk_fma_f32 v[64:65], v[64:65], v[96:97], v[232:233]
  v_pk_fma_f32 v[66:67], v[66:67], v[98:99], v[234:235]
  v_cvt_pk_bf16_f32 v140, v28, v29
  v_cvt_pk_bf16_f32 v141, v30, v31
  v_cvt_pk_bf16_f32 v142, v32, v33
  v_cvt_pk_bf16_f32 v143, v34, v35
  v_cvt_pk_bf16_f32 v156, v60, v61
  v_cvt_pk_bf16_f32 v157, v62, v63
  v_cvt_pk_bf16_f32 v158, v64, v65
  v_cvt_pk_bf16_f32 v159, v66, v67
  v_permlane16_swap_b32 v140, v142
  v_permlane16_swap_b32 v141, v143
  v_permlane16_swap_b32 v156, v158
  v_permlane16_swap_b32 v157, v159
  buffer_store_dwordx4 v[140:143], v132, s[36:39], s50 offen offset:0 sc1
  buffer_store_dwordx4 v[156:159], v132, s[36:39], s50 offen offset:128 sc1
  s_add_u32 s50, s50, 4096
  s_waitcnt lgkmcnt(4)
  v_pk_fma_f32 v[36:37], v[36:37], v[100:101], v[236:237]
  v_pk_fma_f32 v[38:39], v[38:39], v[102:103], v[238:239]
  v_pk_fma_f32 v[40:41], v[40:41], v[104:105], v[240:241]
  v_pk_fma_f32 v[42:43], v[42:43], v[106:107], v[242:243]
  v_pk_fma_f32 v[68:69], v[68:69], v[100:101], v[236:237]
  v_pk_fma_f32 v[70:71], v[70:71], v[102:103], v[238:239]
  v_pk_fma_f32 v[72:73], v[72:73], v[104:105], v[240:241]
  v_pk_fma_f32 v[74:75], v[74:75], v[106:107], v[242:243]
  v_cvt_pk_bf16_f32 v144, v36, v37
  v_cvt_pk_bf16_f32 v145, v38, v39
  v_cvt_pk_bf16_f32 v146, v40, v41
  v_cvt_pk_bf16_f32 v147, v42, v43
  v_cvt_pk_bf16_f32 v160, v68, v69
  v_cvt_pk_bf16_f32 v161, v70, v71
  v_cvt_pk_bf16_f32 v162, v72, v73
  v_cvt_pk_bf16_f32 v163, v74, v75
  v_permlane16_swap_b32 v144, v146
  v_permlane16_swap_b32 v145, v147
  v_permlane16_swap_b32 v160, v162
  v_permlane16_swap_b32 v161, v163
  buffer_store_dwordx4 v[144:147], v132, s[36:39], s50 offen offset:0 sc1
  buffer_store_dwordx4 v[160:163], v132, s[36:39], s50 offen offset:128 sc1
  s_add_u32 s50, s50, 4096
  s_waitcnt lgkmcnt(0)
  v_pk_fma_f32 v[44:45], v[44:45], v[108:109], v[244:245]
  v_pk_fma_f32 v[46:47], v[46:47], v[110:111], v[246:247]
  v_pk_fma_f32 v[48:49], v[48:49], v[112:113], v[248:249]
  v_pk_fma_f32 v[50:51], v[50:51], v[114:115], v[250:251]
  v_pk_fma_f32 v[76:77], v[76:77], v[108:109], v[244:245]
  v_pk_fma_f32 v[78:79], v[78:79], v[110:111], v[246:247]
  v_pk_fma_f32 v[80:81], v[80:81], v[112:113], v[248:249]
  v_pk_fma_f32 v[82:83], v[82:83], v[114:115], v[250:251]
  v_cvt_pk_bf16_f32 v148, v44, v45
  v_cvt_pk_bf16_f32 v149, v46, v47
  v_cvt_pk_bf16_f32 v150, v48, v49
  v_cvt_pk_bf16_f32 v151, v50, v51
  v_cvt_pk_bf16_f32 v164, v76, v77
  v_cvt_pk_bf16_f32 v165, v78, v79
  v_cvt_pk_bf16_f32 v166, v80, v81
  v_cvt_pk_bf16_f32 v167, v82, v83
  v_permlane16_swap_b32 v148, v150
  v_permlane16_swap_b32 v149, v151
  v_permlane16_swap_b32 v164, v166
  v_permlane16_swap_b32 v165, v167
  buffer_store_dwordx4 v[148:151], v132, s[36:39], s50 offen offset:0 sc1
  buffer_store_dwordx4 v[164:167], v132, s[36:39], s50 offen offset:128 sc1
  v_mov_b32 v12, s3
  s_waitcnt vmcnt(0) lgkmcnt(0)
  s_barrier
  s_mov_b64 exec, 1
  buffer_store_dword v12, v0, s[36:39], s45 offen sc1
  s_mov_b64 exec, -1
J2:
  s_mov_b32 s61, 0
  s_add_u32 m0, s63, 21504
  s_nop 0
  buffer_load_dwordx4 v202, s[8:11], s61 offen offset:0 lds
  s_mov_b32 s61, 2048
  s_add_u32 m0, s63, 43008
  s_nop 0
  buffer_load_dwordx4 v202, s[8:11], s61 offen offset:0 lds
  buffer_load_dwordx4 v203, s[8:11], s61 offen offset:1024 lds
  s_mov_b32 s61, 4096
  s_add_u32 m0, s63, 64512
  s_nop 0
  buffer_load_dwordx4 v202, s[8:11], s61 offen offset:0 lds
  buffer_load_dwordx4 v203, s[8:11], s61 offen offset:1024 lds
  buffer_load_dwordx4 v204, s[8:11], s61 offen offset:2048 lds
  s_mov_b32 s61, 196608
  s_add_u32 m0, s63, 86016
  s_nop 0
  buffer_load_dwordx4 v202, s[8:11], s61 offen offset:0 lds
  buffer_load_dwordx4 v203, s[8:11], s61 offen offset:1024 lds
  buffer_load_dwordx4 v204, s[8:11], s61 offen offset:2048 lds
  s_mov_b32 s61, 395264
  s_add_u32 m0, s63, 107520
  s_nop 0
  buffer_load_dwordx4 v202, s[8:11], s61 offen offset:0 lds
  buffer_load_dwordx4 v203, s[8:11], s61 offen offset:1024 lds
  buffer_load_dwordx4 v204, s[8:11], s61 offen offset:2048 lds
  s_mov_b32 s61, 593920
  s_add_u32 m0, s63, 129024
  s_nop 0
  buffer_load_dwordx4 v202, s[8:11], s61 offen offset:0 lds
  buffer_load_dwordx4 v203, s[8:11], s61 offen offset:1024 lds
  buffer_load_dwordx4 v204, s[8:11], s61 offen offset:2048 lds
  s_mov_b32 s61, 786432
  s_add_u32 m0, s63, 0
  s_nop 0
  buffer_load_dwordx4 v202, s[8:11], s61 offen offset:0 lds
  buffer_load_dwordx4 v203, s[8:11], s61 offen offset:1024 lds
  buffer_load_dwordx4 v204, s[8:11], s61 offen offset:2048 lds
  s_mov_b64 exec, 0
  s_cmp_eq_u32 s44, 1
  s_cbranch_scc1 Ha0
  s_cmp_eq_u32 s44, 2
  s_cbranch_scc1 Ha1
  s_cmp_eq_u32 s44, 3
  s_cbranch_scc1 Ha2
Ra:
  s_mov_b64 exec, -1
  s_cmp_lg_u32 s44, 0
  s_cbranch_scc1 SM2x
  s_mov_b32 s46, 60000
  s_mov_b32 s47, 5242880
SM2:
  buffer_load_dword v12, v215, s[36:39], s47 offen sc1
  s_sub_u32 s46, s46, 1
  s_cmp_eq_u32 s46, 0
  s_waitcnt vmcnt(0)
  s_cbranch_scc1 SM2x
  v_cmp_ne_u32 vcc, s3, v12
  s_nop 4
  s_cbranch_vccnz SM2
SM2x:
  s_barrier
  s_mov_b32 s62, 0
  s_add_u32 m0, s64, 33792
  s_nop 0
  buffer_load_dwordx4 v205, s[36:39], s62 offen offset:0 sc1 lds
  buffer_load_dwordx4 v205, s[36:39], s62 offen offset:1024 sc1 lds
  s_add_u32 m0, s65, 41984
  s_nop 0
  buffer_load_dword v206, s[36:39], s62 offen sc1 lds
  s_mov_b32 s62, 2048
  s_add_u32 m0, s64, 55296
  s_nop 0
  buffer_load_dwordx4 v205, s[36:39], s62 offen offset:0 sc1 lds
  buffer_load_dwordx4 v205, s[36:39], s62 offen offset:1024 sc1 lds
  s_add_u32 m0, s65, 63488
  s_nop 0
  buffer_load_dword v206, s[36:39], s62 offen sc1 lds
  s_mov_b32 s62, 4096
  s_add_u32 m0, s64, 76800
  s_nop 0
  buffer_load_dwordx4 v205, s[36:39], s62 offen offset:0 sc1 lds
  buffer_load_dwordx4 v205, s[36:39], s62 offen offset:1024 sc1 lds
  s_add_u32 m0, s65, 84992
  s_nop 0
  buffer_load_dword v206, s[36:39], s62 offen sc1 lds
  s_mov_b32 s62, 6144
Ha0:
  s_cbranch_execz Ha0_1
  s_add_u32 m0, s64, 98304
  s_nop 0
  buffer_load_dwordx4 v205, s[36:39], s62 offen offset:0 sc1 lds
  buffer_load_dwordx4 v205, s[36:39], s62 offen offset:1024 sc1 lds
  s_add_u32 m0, s65, 106496
  s_nop 0
  buffer_load_dword v206, s[36:39], s62 offen sc1 lds
  s_waitcnt vmcnt(6)
  s_barrier
  ds_read_b64_tr_b16 a[80:81], v196 offset:21504
  ds_read_b64_tr_b16 a[82:83], v196 offset:27648
  ds_read_b64_tr_b16 a[84:85], v197 offset:21504
  ds_read_b64_tr_b16 a[86:87], v197 offset:27648
  ds_read_b64_tr_b16 a[88:89], v196 offset:43008
  ds_read_b64_tr_b16 a[90:91], v196 offset:49152
  ds_read_b64_tr_b16 a[92:93], v196 offset:44032
  ds_read_b64_tr_b16 a[94:95], v196 offset:50176
  ds_read_b64_tr_b16 a[96:97], v197 offset:43008
  ds_read_b128 a[0:3], v207 offset:33792
  ds_read_b128 a[4:7], v207 offset:34816
  ds_read_b128 a[8:11], v207 offset:35840
  ds_read_b128 a[12:15], v207 offset:36864
  ds_read_b128 a[16:19], v210 offset:41984
  s_waitcnt lgkmcnt(0)
  v_mfma_f32_16x16x32_bf16 v[84:87], a[80:83], a[0:3], 0
  s_mov_b32 s62, 8192
  ds_read_b128 a[20:23], v207 offset:55296
  s_add_u32 m0, s64, 119808
  v_mfma_f32_16x16x32_bf16 v[88:91], a[80:83], a[4:7], 0
  s_waitcnt vmcnt(3)
  s_barrier
  ds_read_b128 a[24:27], v207 offset:56320
  v_mfma_f32_16x16x32_bf16 v[92:95], a[80:83], a[8:11], 0
  ds_read_b128 a[28:31], v207 offset:57344
  v_mfma_f32_16x16x32_bf16 v[96:99], a[80:83], a[12:15], 0
  s_waitcnt lgkmcnt(13)
  ds_read_b128 a[32:35], v207 offset:58368
  v_mfma_f32_16x16x32_bf16 v[112:115], a[84:87], a[12:15], 0
  ds_read_b128 a[36:39], v210 offset:63488
  v_mfma_f32_16x16x32_bf16 v[108:111], a[84:87], a[8:11], 0
  buffer_load_dwordx4 v205, s[36:39], s62 offen offset:0 sc1 lds
  v_mfma_f32_16x16x32_bf16 v[104:107], a[84:87], a[4:7], 0
  ds_read_b64_tr_b16 a[98:99], v197 offset:49152
  v_mfma_f32_16x16x32_bf16 v[100:103], a[84:87], a[0:3], 0
  s_waitcnt lgkmcnt(1)
  ds_read_b64_tr_b16 a[100:101], v197 offset:44032
  v_mfma_f32_16x16x32_bf16 v[20:23], a[88:91], a[0:3], 0
  ds_read_b64_tr_b16 a[102:103], v197 offset:50176
  v_mfma_f32_16x16x32_bf16 v[20:23], a[92:95], a[20:23], v[20:23]
  buffer_load_dwordx4 v205, s[36:39], s62 offen offset:1024 sc1 lds
  s_add_u32 m0, s65, 128000
  v_mfma_f32_16x16x32_bf16 v[24:27], a[92:95], a[24:27], 0
  ds_read_b128 a[40:43], v208 offset:12288
  v_mfma_f32_16x16x32_bf16 v[24:27], a[88:91], a[4:7], v[24:27]
  ds_read_b64_tr_b16 a[104:105], v198 offset:0
  v_mfma_f32_16x16x32_bf16 v[28:31], a[88:91], a[8:11], 0
  ds_read_b128 a[44:47], v208 offset:13312
  v_mfma_f32_16x16x32_bf16 v[28:31], a[92:95], a[28:31], v[28:31]
  buffer_load_dword v206, s[36:39], s62 offen sc1 lds
  s_mov_b32 s62, 10240
  v_mfma_f32_16x16x32_bf16 v[32:35], a[92:95], a[32:35], 0
  s_add_u32 m0, s64, 141312
  ds_read_b64_tr_b16 a[106:107], v198 offset:6144
  v_mfma_f32_16x16x32_bf16 v[32:35], a[88:91], a[12:15], v[32:35]
  ds_read_b128 a[48:51], v208 offset:14336
  v_mfma_f32_16x16x32_bf16 v[116:119], a[88:91], a[16:19], 0
  ds_read_b64_tr_b16 a[108:109], v198 offset:1024
  v_mfma_f32_16x16x32_bf16 v[116:119], a[92:95], a[36:39], v[116:119]
  s_waitcnt lgkmcnt(6)
  ds_read_b128 a[52:55], v208 offset:15360
  v_mfma_f32_16x16x32_bf16 v[48:51], a[96:99], a[12:15], 0
  buffer_load_dwordx4 v205, s[36:39], s62 offen offset:0 sc1 lds
  v_mfma_f32_16x16x32_bf16 v[48:51], a[100:103], a[32:35], v[48:51]
  ds_read_b128 a[56:59], v211 offset:20480
  v_mfma_f32_16x16x32_bf16 v[44:47], a[100:103], a[28:31], 0
  ds_read_b64_tr_b16 a[110:111], v198 offset:7168
  v_mfma_f32_16x16x32_bf16 v[44:47], a[96:99], a[8:11], v[44:47]
  ds_read_b64_tr_b16 a[112:113], v198 offset:2048
  v_mfma_f32_16x16x32_bf16 v[40:43], a[96:99], a[4:7], 0
  buffer_load_dwordx4 v205, s[36:39], s62 offen offset:1024 sc1 lds
  s_add_u32 m0, s65, 149504
  v_mfma_f32_16x16x32_bf16 v[40:43], a[100:103], a[24:27], v[40:43]
  ds_read_b64_tr_b16 a[114:115], v198 offset:8192
  v_mfma_f32_16x16x32_bf16 v[36:39], a[100:103], a[20:23], 0
  ds_read_b64_tr_b16 a[80:81], v199 offset:0
  v_mfma_f32_16x16x32_bf16 v[36:39], a[96:99], a[0:3], v[36:39]
  s_waitcnt lgkmcnt(1)
  ds_read_b64_tr_b16 a[82:83], v199 offset:6144
  v_mfma_f32_16x16x32_bf16 v[52:55], a[0:3], a[104:107], 0
  buffer_load_dword v206, s[36:39], s62 offen sc1 lds
  s_mov_b32 s62, 12288
  v_mfma_f32_16x16x32_bf16 v[52:55], a[20:23], a[108:111], v[52:55]
  s_add_u32 m0, s64, 12288
  ds_read_b64_tr_b16 a[84:85], v199 offset:1024
  v_mfma_f32_16x16x32_bf16 v[52:55], a[40:43], a[112:115], v[52:55]
  s_waitcnt vmcnt(6)
  s_barrier
  ds_read_b64_tr_b16 a[86:87], v199 offset:7168
  v_mfma_f32_16x16x32_bf16 v[56:59], a[44:47], a[112:115], 0
  ds_read_b64_tr_b16 a[88:89], v199 offset:2048
  v_mfma_f32_16x16x32_bf16 v[56:59], a[24:27], a[108:111], v[56:59]
  buffer_load_dwordx4 v205, s[36:39], s62 offen offset:0 sc1 lds
  v_mfma_f32_16x16x32_bf16 v[56:59], a[4:7], a[104:107], v[56:59]
  ds_read_b64_tr_b16 a[90:91], v199 offset:8192
  v_mfma_f32_16x16x32_bf16 v[60:63], a[8:11], a[104:107], 0
  ds_read_b128 a[60:63], v208 offset:33792
  v_mfma_f32_16x16x32_bf16 v[60:63], a[28:31], a[108:111], v[60:63]
  ds_read_b64_tr_b16 a[92:93], v198 offset:21504
  v_mfma_f32_16x16x32_bf16 v[60:63], a[48:51], a[112:115], v[60:63]
  buffer_load_dwordx4 v205, s[36:39], s62 offen offset:1024 sc1 lds
  s_add_u32 m0, s65, 20480
  v_mfma_f32_16x16x32_bf16 v[64:67], a[52:55], a[112:115], 0
  ds_read_b128 a[64:67], v208 offset:34816
  v_mfma_f32_16x16x32_bf16 v[64:67], a[32:35], a[108:111], v[64:67]
  ds_read_b64_tr_b16 a[94:95], v198 offset:27648
  v_mfma_f32_16x16x32_bf16 v[64:67], a[12:15], a[104:107], v[64:67]
  ds_read_b128 a[68:71], v208 offset:35840
  v_mfma_f32_16x16x32_bf16 v[120:123], a[16:19], a[104:107], 0
  buffer_load_dword v206, s[36:39], s62 offen sc1 lds
  s_mov_b32 s61, 985088
  v_mfma_f32_16x16x32_bf16 v[120:123], a[36:39], a[108:111], v[120:123]
  s_add_u32 m0, s63, 21504
  ds_read_b64_tr_b16 a[96:97], v198 offset:22528
  v_mfma_f32_16x16x32_bf16 v[120:123], a[56:59], a[112:115], v[120:123]
  s_waitcnt lgkmcnt(6)
  ds_read_b128 a[72:75], v208 offset:36864
  v_mfma_f32_16x16x32_bf16 v[80:83], a[12:15], a[80:83], 0
  ds_read_b64_tr_b16 a[98:99], v198 offset:28672
  v_mfma_f32_16x16x32_bf16 v[80:83], a[32:35], a[84:87], v[80:83]
  buffer_load_dwordx4 v202, s[8:11], s61 offen offset:0 lds
  v_mfma_f32_16x16x32_bf16 v[80:83], a[52:55], a[88:91], v[80:83]
  ds_read_b128 a[76:79], v211 offset:41984
  v_mfma_f32_16x16x32_bf16 v[76:79], a[48:51], a[88:91], 0
  ds_read_b64_tr_b16 a[100:101], v198 offset:23552
  v_mfma_f32_16x16x32_bf16 v[76:79], a[28:31], a[84:87], v[76:79]
  ds_read_b64_tr_b16 a[102:103], v198 offset:29696
  v_mfma_f32_16x16x32_bf16 v[76:79], a[8:11], a[80:83], v[76:79]
  buffer_load_dwordx4 v203, s[8:11], s61 offen offset:1024 lds
  v_mfma_f32_16x16x32_bf16 v[72:75], a[4:7], a[80:83], 0
  ds_read_b64_tr_b16 a[104:105], v199 offset:21504
  v_mfma_f32_16x16x32_bf16 v[72:75], a[24:27], a[84:87], v[72:75]
  ds_read_b64_tr_b16 a[106:107], v199 offset:27648
  v_mfma_f32_16x16x32_bf16 v[72:75], a[44:47], a[88:91], v[72:75]
  ds_read_b64_tr_b16 a[108:109], v199 offset:22528
  v_mfma_f32_16x16x32_bf16 v[68:71], a[40:43], a[88:91], 0
  buffer_load_dwordx4 v204, s[8:11], s61 offen offset:2048 lds
  s_mov_b32 s62, 14336
  v_mfma_f32_16x16x32_bf16 v[68:71], a[20:23], a[84:87], v[68:71]
  s_add_u32 m0, s64, 33792
  ds_read_b64_tr_b16 a[110:111], v199 offset:28672
  v_mfma_f32_16x16x32_bf16 v[68:71], a[0:3], a[80:83], v[68:71]
  s_waitcnt vmcnt(9) lgkmcnt(4)
  s_barrier
  v_mfma_f32_16x16x32_bf16 v[84:87], a[92:95], a[20:23], v[84:87]
  ds_read_b64_tr_b16 a[112:113], v199 offset:23552
  v_mfma_f32_16x16x32_bf16 v[84:87], a[96:99], a[40:43], v[84:87]
  buffer_load_dwordx4 v205, s[36:39], s62 offen offset:0 sc1 lds
  v_mfma_f32_16x16x32_bf16 v[84:87], a[100:103], a[60:63], v[84:87]
  ds_read_b64_tr_b16 a[114:115], v199 offset:29696
  v_mfma_f32_16x16x32_bf16 v[88:91], a[100:103], a[64:67], v[88:91]
  ds_read_b128 a[0:3], v208 offset:55296
  v_mfma_f32_16x16x32_bf16 v[88:91], a[96:99], a[44:47], v[88:91]
  ds_read_b64_tr_b16 a[80:81], v198 offset:43008
  v_mfma_f32_16x16x32_bf16 v[88:91], a[92:95], a[24:27], v[88:91]
  buffer_load_dwordx4 v205, s[36:39], s62 offen offset:1024 sc1 lds
  s_add_u32 m0, s65, 41984
  v_mfma_f32_16x16x32_bf16 v[92:95], a[92:95], a[28:31], v[92:95]
  ds_read_b128 a[4:7], v208 offset:56320
  v_mfma_f32_16x16x32_bf16 v[92:95], a[96:99], a[48:51], v[92:95]
  ds_read_b64_tr_b16 a[82:83], v198 offset:49152
  v_mfma_f32_16x16x32_bf16 v[92:95], a[100:103], a[68:71], v[92:95]
  ds_read_b128 a[8:11], v208 offset:57344
  v_mfma_f32_16x16x32_bf16 v[96:99], a[100:103], a[72:75], v[96:99]
  buffer_load_dword v206, s[36:39], s62 offen sc1 lds
  s_mov_b32 s61, 1183744
  v_mfma_f32_16x16x32_bf16 v[96:99], a[96:99], a[52:55], v[96:99]
  s_add_u32 m0, s63, 43008
  ds_read_b64_tr_b16 a[84:85], v198 offset:44032
  v_mfma_f32_16x16x32_bf16 v[96:99], a[92:95], a[32:35], v[96:99]
  s_waitcnt lgkmcnt(6)
  ds_read_b128 a[12:15], v208 offset:58368
  v_mfma_f32_16x16x32_bf16 v[112:115], a[104:107], a[32:35], v[112:115]
  ds_read_b128 a[16:19], v211 offset:63488
  v_mfma_f32_16x16x32_bf16 v[112:115], a[108:111], a[52:55], v[112:115]
  buffer_load_dwordx4 v202, s[8:11], s61 offen offset:0 lds
  v_mfma_f32_16x16x32_bf16 v[112:115], a[112:115], a[72:75], v[112:115]
  ds_read_b64_tr_b16 a[86:87], v198 offset:50176
  v_mfma_f32_16x16x32_bf16 v[108:111], a[112:115], a[68:71], v[108:111]
  ds_read_b64_tr_b16 a[88:89], v198 offset:45056
  v_mfma_f32_16x16x32_bf16 v[108:111], a[108:111], a[48:51], v[108:111]
  ds_read_b64_tr_b16 a[90:91], v198 offset:51200
  v_mfma_f32_16x16x32_bf16 v[108:111], a[104:107], a[28:31], v[108:111]
  buffer_load_dwordx4 v203, s[8:11], s61 offen offset:1024 lds
  v_mfma_f32_16x16x32_bf16 v[104:107], a[104:107], a[24:27], v[104:107]
  v_mfma_f32_16x16x32_bf16 v[104:107], a[108:111], a[44:47], v[104:107]
  ds_read_b64_tr_b16 a[92:93], v199 offset:43008
  v_mfma_f32_16x16x32_bf16 v[104:107], a[112:115], a[64:67], v[104:107]
  v_mfma_f32_16x16x32_bf16 v[100:103], a[112:115], a[60:63], v[100:103]
  buffer_load_dwordx4 v204, s[8:11], s61 offen offset:2048 lds
  s_mov_b32 s62, 16384
  v_mfma_f32_16x16x32_bf16 v[100:103], a[108:111], a[40:43], v[100:103]
  s_add_u32 m0, s64, 55296
  ds_read_b64_tr_b16 a[94:95], v199 offset:49152
  v_mfma_f32_16x16x32_bf16 v[100:103], a[104:107], a[20:23], v[100:103]
  s_waitcnt lgkmcnt(2)
  ds_read_b64_tr_b16 a[96:97], v199 offset:44032
  v_mfma_f32_16x16x32_bf16 v[20:23], a[80:83], a[40:43], v[20:23]
  v_mfma_f32_16x16x32_bf16 v[20:23], a[84:87], a[60:63], v[20:23]
  buffer_load_dwordx4 v205, s[36:39], s62 offen offset:0 sc1 lds
  v_mfma_f32_16x16x32_bf16 v[20:23], a[88:91], a[0:3], v[20:23]
  s_waitcnt vmcnt(13)
  s_barrier
  ds_read_b64_tr_b16 a[98:99], v199 offset:50176
  v_mfma_f32_16x16x32_bf16 v[24:27], a[88:91], a[4:7], v[24:27]
  ds_read_b64_tr_b16 a[100:101], v199 offset:45056
  v_mfma_f32_16x16x32_bf16 v[24:27], a[84:87], a[64:67], v[24:27]
  v_mfma_f32_16x16x32_bf16 v[24:27], a[80:83], a[44:47], v[24:27]
  buffer_load_dwordx4 v205, s[36:39], s62 offen offset:1024 sc1 lds
  s_add_u32 m0, s65, 63488
  v_mfma_f32_16x16x32_bf16 v[28:31], a[80:83], a[48:51], v[28:31]
  ds_read_b64_tr_b16 a[102:103], v199 offset:51200
  v_mfma_f32_16x16x32_bf16 v[28:31], a[84:87], a[68:71], v[28:31]
  ds_read_b128 a[20:23], v209 offset:12288
  v_mfma_f32_16x16x32_bf16 v[28:31], a[88:91], a[8:11], v[28:31]
  ds_read_b64_tr_b16 a[104:105], v200 offset:0
  v_mfma_f32_16x16x32_bf16 v[32:35], a[88:91], a[12:15], v[32:35]
  buffer_load_dword v206, s[36:39], s62 offen sc1 lds
  s_mov_b32 s61, 1376256
  v_mfma_f32_16x16x32_bf16 v[32:35], a[84:87], a[72:75], v[32:35]
  s_add_u32 m0, s63, 64512
  ds_read_b128 a[24:27], v209 offset:13312
  v_mfma_f32_16x16x32_bf16 v[32:35], a[80:83], a[52:55], v[32:35]
  ds_read_b64_tr_b16 a[106:107], v200 offset:6144
  v_mfma_f32_16x16x32_bf16 v[116:119], a[80:83], a[56:59], v[116:119]
  ds_read_b128 a[28:31], v209 offset:14336
  v_mfma_f32_16x16x32_bf16 v[116:119], a[84:87], a[76:79], v[116:119]
  buffer_load_dwordx4 v202, s[8:11], s61 offen offset:0 lds
  v_mfma_f32_16x16x32_bf16 v[116:119], a[88:91], a[16:19], v[116:119]
  s_waitcnt lgkmcnt(5)
  ds_read_b64_tr_b16 a[108:109], v200 offset:1024
  v_mfma_f32_16x16x32_bf16 v[48:51], a[92:95], a[52:55], v[48:51]
  ds_read_b128 a[32:35], v209 offset:15360
  v_mfma_f32_16x16x32_bf16 v[48:51], a[96:99], a[72:75], v[48:51]
  ds_read_b128 a[36:39], v212 offset:20480
  v_mfma_f32_16x16x32_bf16 v[48:51], a[100:103], a[12:15], v[48:51]
  buffer_load_dwordx4 v203, s[8:11], s61 offen offset:1024 lds
  v_mfma_f32_16x16x32_bf16 v[44:47], a[100:103], a[8:11], v[44:47]
  ds_read_b64_tr_b16 a[110:111], v200 offset:7168
  v_mfma_f32_16x16x32_bf16 v[44:47], a[96:99], a[68:71], v[44:47]
  ds_read_b64_tr_b16 a[112:113], v200 offset:2048
  v_mfma_f32_16x16x32_bf16 v[44:47], a[92:95], a[48:51], v[44:47]
  ds_read_b64_tr_b16 a[114:115], v200 offset:8192
  v_mfma_f32_16x16x32_bf16 v[40:43], a[92:95], a[44:47], v[40:43]
  buffer_load_dwordx4 v204, s[8:11], s61 offen offset:2048 lds
  s_mov_b32 s62, 18432
  v_mfma_f32_16x16x32_bf16 v[40:43], a[96:99], a[64:67], v[40:43]
  s_add_u32 m0, s64, 76800
  ds_read_b64_tr_b16 a[80:81], v201 offset:0
  v_mfma_f32_16x16x32_bf16 v[40:43], a[100:103], a[4:7], v[40:43]
  s_bfe_u32 s54, s2, 0x30003
  s_xor_b32 s54, s54, 1
  s_and_b32 s48, s2, 1
  v_mfma_f32_16x16x32_bf16 v[36:39], a[100:103], a[0:3], v[36:39]
  s_lshl1_add_u32 s53, s54, s48
  ds_read_b64_tr_b16 a[82:83], v201 offset:6144
  v_mfma_f32_16x16x32_bf16 v[36:39], a[96:99], a[60:63], v[36:39]
  buffer_load_dwordx4 v205, s[36:39], s62 offen offset:0 sc1 lds
  v_mfma_f32_16x16x32_bf16 v[36:39], a[92:95], a[40:43], v[36:39]
  s_waitcnt lgkmcnt(2)
  ds_read_b64_tr_b16 a[84:85], v201 offset:1024
  v_mfma_f32_16x16x32_bf16 v[52:55], a[60:63], a[104:107], v[52:55]
  v_mfma_f32_16x16x32_bf16 v[52:55], a[0:3], a[108:111], v[52:55]
  ds_read_b64_tr_b16 a[86:87], v201 offset:7168
  v_mfma_f32_16x16x32_bf16 v[52:55], a[20:23], a[112:115], v[52:55]
  s_waitcnt vmcnt(16)
  s_barrier
  buffer_load_dwordx4 v205, s[36:39], s62 offen offset:1024 sc1 lds
  v_mfma_f32_16x16x32_bf16 v[56:59], a[24:27], a[112:115], v[56:59]
  s_add_u32 m0, s65, 84992
  ds_read_b64_tr_b16 a[88:89], v201 offset:2048
  s_bfe_u32 s52, s2, 0x20001
  v_mfma_f32_16x16x32_bf16 v[56:59], a[4:7], a[108:111], v[56:59]
  s_lshr_b32 s49, s2, 6
  s_lshl2_add_u32 s52, s52, s49
  s_lshl_b32 s70, s44, 12
  v_mfma_f32_16x16x32_bf16 v[56:59], a[64:67], a[104:107], v[56:59]
  ds_read_b64_tr_b16 a[90:91], v201 offset:8192
  v_mfma_f32_16x16x32_bf16 v[60:63], a[68:71], a[104:107], v[60:63]
  buffer_load_dword v206, s[36:39], s62 offen sc1 lds
  s_mov_b32 s61, 1574912
  v_mfma_f32_16x16x32_bf16 v[60:63], a[8:11], a[108:111], v[60:63]
  s_add_u32 m0, s63, 86016
  ds_read_b128 a[40:43], v207 offset:12288
  v_mfma_f32_16x16x32_bf16 v[60:63], a[28:31], a[112:115], v[60:63]
  s_lshl_b32 s48, s53, 7
  ds_read_b64_tr_b16 a[92:93], v196 offset:0
  s_lshl_b32 s49, s44, 16
  v_mfma_f32_16x16x32_bf16 v[64:67], a[32:35], a[112:115], v[64:67]
  s_add_u32 s48, s48, s49
  ds_read_b128 a[44:47], v207 offset:13312
  v_lshrrev_b32 v12, 3, v10
  v_mfma_f32_16x16x32_bf16 v[64:67], a[12:15], a[108:111], v[64:67]
  buffer_load_dwordx4 v202, s[8:11], s61 offen offset:0 lds
  v_lshlrev_b32 v12, 11, v12
  v_mfma_f32_16x16x32_bf16 v[64:67], a[72:75], a[104:107], v[64:67]
  ds_read_b64_tr_b16 a[94:95], v196 offset:6144
  v_add3_u32 v216, v12, v213, s48
  v_mfma_f32_16x16x32_bf16 v[120:123], a[76:79], a[104:107], v[120:123]
  ds_read_b128 a[48:51], v207 offset:14336
  v_mfma_f32_16x16x32_bf16 v[120:123], a[16:19], a[108:111], v[120:123]
  ds_read_b64_tr_b16 a[96:97], v196 offset:1024
  v_mfma_f32_16x16x32_bf16 v[120:123], a[36:39], a[112:115], v[120:123]
  s_waitcnt lgkmcnt(6)
  buffer_load_dwordx4 v203, s[8:11], s61 offen offset:1024 lds
  v_mfma_f32_16x16x32_bf16 v[80:83], a[72:75], a[80:83], v[80:83]
  ds_read_b128 a[52:55], v207 offset:15360
  v_mfma_f32_16x16x32_bf16 v[80:83], a[12:15], a[84:87], v[80:83]
  ds_read_b64_tr_b16 a[98:99], v196 offset:7168
  v_mfma_f32_16x16x32_bf16 v[80:83], a[32:35], a[88:91], v[80:83]
  ds_read_b128 a[56:59], v210 offset:20480
  v_mfma_f32_16x16x32_bf16 v[76:79], a[28:31], a[88:91], v[76:79]
  buffer_load_dwordx4 v204, s[8:11], s61 offen offset:2048 lds
  s_mov_b32 s62, 20480
  v_mfma_f32_16x16x32_bf16 v[76:79], a[8:11], a[84:87], v[76:79]
  s_add_u32 m0, s64, 98304
  ds_read_b64_tr_b16 a[100:101], v196 offset:2048
  v_add_u32 v217, 15360, v216
  v_mfma_f32_16x16x32_bf16 v[76:79], a[68:71], a[80:83], v[76:79]
  ds_read_b64_tr_b16 a[102:103], v196 offset:8192
  v_add_u32 v218, 30720, v216
  v_mfma_f32_16x16x32_bf16 v[72:75], a[64:67], a[80:83], v[72:75]
  ds_read_b64_tr_b16 a[104:105], v197 offset:0
  v_add_u32 v219, 46080, v216
  v_mfma_f32_16x16x32_bf16 v[72:75], a[4:7], a[84:87], v[72:75]
  buffer_load_dwordx4 v205, s[36:39], s62 offen offset:0 sc1 lds
  v_mfma_f32_16x16x32_bf16 v[72:75], a[24:27], a[88:91], v[72:75]
  s_lshl_b32 s55, s52, 18
  ds_read_b64_tr_b16 a[106:107], v197 offset:6144
  s_add_u32 s55, s55, s48
  v_mfma_f32_16x16x32_bf16 v[68:71], a[20:23], a[88:91], v[68:71]
  ds_read_b64_tr_b16 a[108:109], v197 offset:1024
  v_mfma_f32_16x16x32_bf16 v[68:71], a[0:3], a[84:87], v[68:71]
  ds_read_b64_tr_b16 a[110:111], v197 offset:7168
  v_mfma_f32_16x16x32_bf16 v[68:71], a[60:63], a[80:83], v[68:71]
  s_waitcnt vmcnt(16) lgkmcnt(4)
  s_barrier
  buffer_load_dwordx4 v205, s[36:39], s62 offen offset:1024 sc1 lds
  v_mfma_f32_16x16x32_bf16 v[84:87], a[92:95], a[0:3], v[84:87]
  s_add_u32 m0, s65, 106496
  ds_read_b64_tr_b16 a[112:113], v197 offset:2048
  v_and_b32 v13, 7, v10
  v_mfma_f32_16x16x32_bf16 v[84:87], a[96:99], a[20:23], v[84:87]
  v_lshrrev_b32 v14, 4, v10
  v_xor_b32 v13, v13, v14
  v_mfma_f32_16x16x32_bf16 v[84:87], a[100:103], a[40:43], v[84:87]
  ds_read_b64_tr_b16 a[114:115], v197 offset:8192
  v_lshl_add_u32 v220, v13, 4, v12
  v_mfma_f32_16x16x32_bf16 v[88:91], a[100:103], a[44:47], v[88:91]
  buffer_load_dword v206, s[36:39], s62 offen sc1 lds
  s_mov_b32 s61, 1773568
  v_mfma_f32_16x16x32_bf16 v[88:91], a[96:99], a[24:27], v[88:91]
  s_add_u32 m0, s63, 107520
  ds_read_b128 a[60:63], v207 offset:33792
  v_xor_b32 v221, 64, v220
  v_mfma_f32_16x16x32_bf16 v[88:91], a[92:95], a[4:7], v[88:91]
  ds_read_b64_tr_b16 a[80:81], v196 offset:21504
  v_add_u32 v221, 15360, v221
  v_mfma_f32_16x16x32_bf16 v[92:95], a[92:95], a[8:11], v[92:95]
  ds_read_b128 a[64:67], v207 offset:34816
  v_mfma_f32_16x16x32_bf16 v[92:95], a[96:99], a[28:31], v[92:95]
  buffer_load_dwordx4 v202, s[8:11], s61 offen offset:0 lds
  v_mfma_f32_16x16x32_bf16 v[92:95], a[100:103], a[48:51], v[92:95]
  s_lshl_b32 s48, s44, 10
  ds_read_b64_tr_b16 a[82:83], v196 offset:27648
  s_add_u32 s48, s48, 147456
  v_mfma_f32_16x16x32_bf16 v[96:99], a[100:103], a[52:55], v[96:99]
  ds_read_b128 a[68:71], v207 offset:35840
  v_add_u32 v247, s48, v0
  v_mfma_f32_16x16x32_bf16 v[96:99], a[96:99], a[32:35], v[96:99]
  ds_read_b64_tr_b16 a[84:85], v196 offset:22528
  v_lshl_add_u32 v245, v14, 4, s48
  v_mfma_f32_16x16x32_bf16 v[96:99], a[92:95], a[12:15], v[96:99]
  s_waitcnt lgkmcnt(6)
  buffer_load_dwordx4 v203, s[8:11], s61 offen offset:1024 lds
  v_and_b32 v12, 1, v10
  v_mfma_f32_16x16x32_bf16 v[112:115], a[104:107], a[12:15], v[112:115]
  ds_read_b128 a[72:75], v207 offset:36864
  v_lshlrev_b32 v12, 8, v12
  v_mfma_f32_16x16x32_bf16 v[112:115], a[108:111], a[32:35], v[112:115]
  ds_read_b128 a[76:79], v210 offset:41984
  v_sub_u32 v246, v245, v12
  v_mfma_f32_16x16x32_bf16 v[112:115], a[112:115], a[52:55], v[112:115]
  ds_read_b64_tr_b16 a[86:87], v196 offset:28672
  v_mfma_f32_16x16x32_bf16 v[108:111], a[112:115], a[48:51], v[108:111]
  buffer_load_dwordx4 v204, s[8:11], s61 offen offset:2048 lds
  s_mov_b32 s62, 22528
  v_mfma_f32_16x16x32_bf16 v[108:111], a[108:111], a[28:31], v[108:111]
  s_add_u32 m0, s64, 119808
  ds_read_b64_tr_b16 a[88:89], v196 offset:23552
  v_mfma_f32_16x16x32_bf16 v[108:111], a[104:107], a[8:11], v[108:111]
  ds_read_b64_tr_b16 a[90:91], v196 offset:29696
  v_mfma_f32_16x16x32_bf16 v[104:107], a[104:107], a[4:7], v[104:107]
  v_mfma_f32_16x16x32_bf16 v[104:107], a[108:111], a[24:27], v[104:107]
  buffer_load_dwordx4 v205, s[36:39], s62 offen offset:0 sc1 lds
  v_mfma_f32_16x16x32_bf16 v[104:107], a[112:115], a[44:47], v[104:107]
  s_lshl_b32 s48, s53, 7
  ds_read_b64_tr_b16 a[92:93], v197 offset:21504
  v_and_b32 v13, 0xf0, v0
  v_mfma_f32_16x16x32_bf16 v[100:103], a[112:115], a[40:43], v[100:103]
  ds_read_b64_tr_b16 a[94:95], v197 offset:27648
  v_lshl_add_u32 v13, v14, 12, v13
  v_mfma_f32_16x16x32_bf16 v[100:103], a[108:111], a[20:23], v[100:103]
  s_lshl1_add_u32 s48, s48, 8192
  v_add_u32 v249, s48, v13
  v_mfma_f32_16x16x32_bf16 v[100:103], a[104:107], a[0:3], v[100:103]
  s_waitcnt lgkmcnt(2)
  buffer_load_dwordx4 v205, s[36:39], s62 offen offset:1024 sc1 lds
  s_add_u32 m0, s65, 128000
  v_mfma_f32_16x16x32_bf16 v[20:23], a[80:83], a[20:23], v[20:23]
  ds_read_b64_tr_b16 a[96:97], v197 offset:22528
  v_mfma_f32_16x16x32_bf16 v[20:23], a[84:87], a[40:43], v[20:23]
  ds_read_b64_tr_b16 a[98:99], v197 offset:28672
  v_mfma_f32_16x16x32_bf16 v[20:23], a[88:91], a[60:63], v[20:23]
  s_waitcnt vmcnt(17)
  s_barrier
  v_mfma_f32_16x16x32_bf16 v[24:27], a[88:91], a[64:67], v[24:27]
  buffer_load_dword v206, s[36:39], s62 offen sc1 lds
  s_mov_b32 s61, 1966080
  v_mfma_f32_16x16x32_bf16 v[24:27], a[84:87], a[44:47], v[24:27]
  s_add_u32 m0, s63, 129024
  ds_read_b64_tr_b16 a[100:101], v197 offset:23552
  v_lshrrev_b32 v12, 2, v10
  v_mfma_f32_16x16x32_bf16 v[24:27], a[80:83], a[24:27], v[24:27]
  ds_read_b64_tr_b16 a[102:103], v197 offset:29696
  v_lshl_add_u32 v232, v12, 7, v214
  v_mfma_f32_16x16x32_bf16 v[28:31], a[80:83], a[28:31], v[28:31]
  ds_read_b128 a[0:3], v207 offset:55296
  v_mfma_f32_16x16x32_bf16 v[28:31], a[84:87], a[48:51], v[28:31]
  buffer_load_dwordx4 v202, s[8:11], s61 offen offset:0 lds
  v_xor_b32 v233, 32, v232
  v_mfma_f32_16x16x32_bf16 v[28:31], a[88:91], a[68:71], v[28:31]
  ds_read_b64_tr_b16 a[104:105], v196 offset:43008
  v_xor_b32 v234, 64, v232
  v_mfma_f32_16x16x32_bf16 v[32:35], a[88:91], a[72:75], v[32:35]
  ds_read_b128 a[4:7], v207 offset:56320
  v_mfma_f32_16x16x32_bf16 v[32:35], a[84:87], a[52:55], v[32:35]
  ds_read_b64_tr_b16 a[106:107], v196 offset:49152
  v_xor_b32 v235, 96, v232
  v_mfma_f32_16x16x32_bf16 v[32:35], a[80:83], a[32:35], v[32:35]
  buffer_load_dwordx4 v203, s[8:11], s61 offen offset:1024 lds
  v_mfma_f32_16x16x32_bf16 v[116:119], a[80:83], a[36:39], v[116:119]
  ds_read_b128 a[8:11], v207 offset:57344
  v_xor_b32 v236, 65536, v232
  v_mfma_f32_16x16x32_bf16 v[116:119], a[84:87], a[56:59], v[116:119]
  ds_read_b64_tr_b16 a[108:109], v196 offset:44032
  v_xor_b32 v237, 65568, v232
  v_mfma_f32_16x16x32_bf16 v[116:119], a[88:91], a[76:79], v[116:119]
  s_waitcnt lgkmcnt(6)
  ds_read_b128 a[12:15], v207 offset:58368
  v_mfma_f32_16x16x32_bf16 v[48:51], a[92:95], a[32:35], v[48:51]
  buffer_load_dwordx4 v204, s[8:11], s61 offen offset:2048 lds
  s_mov_b32 s62, 24576
  v_mfma_f32_16x16x32_bf16 v[48:51], a[96:99], a[52:55], v[48:51]
  s_add_u32 m0, s64, 141312
  ds_read_b128 a[16:19], v210 offset:63488
  v_xor_b32 v238, 65600, v232
  v_mfma_f32_16x16x32_bf16 v[48:51], a[100:103], a[72:75], v[48:51]
  ds_read_b64_tr_b16 a[110:111], v196 offset:50176
  v_xor_b32 v239, 65632, v232
  v_mfma_f32_16x16x32_bf16 v[44:47], a[100:103], a[68:71], v[44:47]
  s_add_u32 s48, s70, 131072
  ds_read_b64_tr_b16 a[112:113], v196 offset:45056
  v_and_b32 v12, 15, v10
  v_mfma_f32_16x16x32_bf16 v[44:47], a[96:99], a[48:51], v[44:47]
  buffer_load_dwordx4 v205, s[36:39], s62 offen offset:0 sc1 lds
  v_lshrrev_b32 v14, 1, v12
  v_mfma_f32_16x16x32_bf16 v[44:47], a[92:95], a[28:31], v[44:47]
  ds_read_b64_tr_b16 a[114:115], v196 offset:51200
  v_lshrrev_b32 v13, 5, v10
  v_mfma_f32_16x16x32_bf16 v[40:43], a[92:95], a[24:27], v[40:43]
  v_xor_b32 v14, v14, v13
  v_lshlrev_b32 v14, 4, v14
  v_mfma_f32_16x16x32_bf16 v[40:43], a[96:99], a[44:47], v[40:43]
  ds_read_b64_tr_b16 a[80:81], v197 offset:43008
  v_lshl_add_u32 v14, v12, 7, v14
  v_mfma_f32_16x16x32_bf16 v[40:43], a[100:103], a[64:67], v[40:43]
  buffer_load_dwordx4 v205, s[36:39], s62 offen offset:1024 sc1 lds
  s_add_u32 m0, s65, 149504
  v_mfma_f32_16x16x32_bf16 v[36:39], a[100:103], a[60:63], v[36:39]
  ds_read_b64_tr_b16 a[82:83], v197 offset:49152
  v_bfe_u32 v13, v10, 4, 1
  v_mfma_f32_16x16x32_bf16 v[36:39], a[96:99], a[40:43], v[36:39]
  v_lshl_add_u32 v14, v13, 3, v14
  v_add_u32 v240, s48, v14
  v_mfma_f32_16x16x32_bf16 v[36:39], a[92:95], a[20:23], v[36:39]
  s_waitcnt lgkmcnt(2)
  ds_read_b64_tr_b16 a[84:85], v197 offset:44032
  v_xor_b32 v241, 32, v240
  v_mfma_f32_16x16x32_bf16 v[52:55], a[40:43], a[104:107], v[52:55]
  buffer_load_dword v206, s[36:39], s62 offen sc1 lds
  s_mov_b32 s61, 2164736
  v_mfma_f32_16x16x32_bf16 v[52:55], a[60:63], a[108:111], v[52:55]
  s_add_u32 m0, s63, 0
  ds_read_b64_tr_b16 a[86:87], v197 offset:50176
  v_xor_b32 v242, 64, v240
  v_mfma_f32_16x16x32_bf16 v[52:55], a[0:3], a[112:115], v[52:55]
  s_waitcnt vmcnt(18)
  s_barrier
  v_xor_b32 v243, 96, v240
  v_mfma_f32_16x16x32_bf16 v[56:59], a[4:7], a[112:115], v[56:59]
  ds_read_b64_tr_b16 a[88:89], v197 offset:45056
  v_mfma_f32_16x16x32_bf16 v[56:59], a[64:67], a[108:111], v[56:59]
  buffer_load_dwordx4 v202, s[8:11], s61 offen offset:0 lds
  v_mfma_f32_16x16x32_bf16 v[56:59], a[44:47], a[104:107], v[56:59]
  ds_read_b64_tr_b16 a[90:91], v197 offset:51200
  v_mfma_f32_16x16x32_bf16 v[60:63], a[48:51], a[104:107], v[60:63]
  ds_read_b128 a[20:23], v208 offset:12288
  v_mfma_f32_16x16x32_bf16 v[60:63], a[68:71], a[108:111], v[60:63]
  ds_read_b64_tr_b16 a[92:93], v198 offset:0
  v_mfma_f32_16x16x32_bf16 v[60:63], a[8:11], a[112:115], v[60:63]
  buffer_load_dwordx4 v203, s[8:11], s61 offen offset:1024 lds
  v_mfma_f32_16x16x32_bf16 v[64:67], a[12:15], a[112:115], v[64:67]
  ds_read_b128 a[24:27], v208 offset:13312
  v_mfma_f32_16x16x32_bf16 v[64:67], a[72:75], a[108:111], v[64:67]
  ds_read_b64_tr_b16 a[94:95], v198 offset:6144
  v_mfma_f32_16x16x32_bf16 v[64:67], a[52:55], a[104:107], v[64:67]
  ds_read_b128 a[28:31], v208 offset:14336
  v_mfma_f32_16x16x32_bf16 v[120:123], a[56:59], a[104:107], v[120:123]
  s_lshl2_add_u32 s48, s52, s44
  buffer_load_dwordx4 v204, s[8:11], s61 offen offset:2048 lds
  s_mov_b32 s62, 26624
  v_mfma_f32_16x16x32_bf16 v[120:123], a[76:79], a[108:111], v[120:123]
  s_add_u32 m0, s64, 12288
  ds_read_b64_tr_b16 a[96:97], v198 offset:1024
  s_lshl_b32 s49, s48, 16
  v_mfma_f32_16x16x32_bf16 v[120:123], a[16:19], a[112:115], v[120:123]
  s_waitcnt lgkmcnt(6)
  ds_read_b128 a[32:35], v208 offset:15360
  s_add_u32 s49, s49, 7340032
  v_mfma_f32_16x16x32_bf16 v[80:83], a[52:55], a[80:83], v[80:83]
  ds_read_b64_tr_b16 a[98:99], v198 offset:7168
  v_add_u32 v244, s49, v0
  v_mfma_f32_16x16x32_bf16 v[80:83], a[72:75], a[84:87], v[80:83]
  buffer_load_dwordx4 v205, s[36:39], s62 offen offset:0 sc1 lds
  v_mfma_f32_16x16x32_bf16 v[80:83], a[12:15], a[88:91], v[80:83]
Ha1:
  s_cbranch_execz Ha1_1
  ds_read_b128 a[36:39], v211 offset:20480
  v_mfma_f32_16x16x32_bf16 v[76:79], a[8:11], a[88:91], v[76:79]
  s_lshl4_add_u32 s74, s48, s53
  ds_read_b64_tr_b16 a[100:101], v198 offset:2048
  s_lshl_b32 s74, s74, 8
  v_mfma_f32_16x16x32_bf16 v[76:79], a[68:71], a[84:87], v[76:79]
  s_add_u32 s74, s74, 262144
  ds_read_b64_tr_b16 a[102:103], v198 offset:8192
  v_mfma_f32_16x16x32_bf16 v[76:79], a[48:51], a[80:83], v[76:79]
  buffer_load_dwordx4 v205, s[36:39], s62 offen offset:1024 sc1 lds
  s_add_u32 m0, s65, 20480
  v_mfma_f32_16x16x32_bf16 v[72:75], a[44:47], a[80:83], v[72:75]
  ds_read_b64_tr_b16 a[104:105], v199 offset:0
  v_mfma_f32_16x16x32_bf16 v[72:75], a[64:67], a[84:87], v[72:75]
  ds_read_b64_tr_b16 a[106:107], v199 offset:6144
  v_mfma_f32_16x16x32_bf16 v[72:75], a[4:7], a[88:91], v[72:75]
  s_lshr_b32 s73, s48, 1
  ds_read_b64_tr_b16 a[108:109], v199 offset:1024
  s_lshl_b32 s73, s73, 5
  v_mfma_f32_16x16x32_bf16 v[68:71], a[0:3], a[88:91], v[68:71]
  s_add_u32 s73, s73, s53
  buffer_load_dword v206, s[36:39], s62 offen sc1 lds
  s_mov_b32 s61, 2363392
  v_mfma_f32_16x16x32_bf16 v[68:71], a[60:63], a[84:87], v[68:71]
  s_add_u32 m0, s63, 21504
  ds_read_b64_tr_b16 a[110:111], v199 offset:7168
  s_and_b32 s49, s48, 1
  v_mfma_f32_16x16x32_bf16 v[68:71], a[40:43], a[80:83], v[68:71]
  s_waitcnt vmcnt(12) lgkmcnt(4)
  s_barrier
  s_lshl1_add_u32 s73, s73, s49
  v_mfma_f32_16x16x32_bf16 v[84:87], a[92:95], a[60:63], v[84:87]
  s_lshl_b32 s73, s73, 11
  ds_read_b64_tr_b16 a[112:113], v199 offset:2048
  s_add_u32 s73, s73, 36700160
  v_mfma_f32_16x16x32_bf16 v[84:87], a[96:99], a[0:3], v[84:87]
  buffer_load_dwordx4 v202, s[8:11], s61 offen offset:0 lds
  v_mfma_f32_16x16x32_bf16 v[84:87], a[100:103], a[20:23], v[84:87]
  ds_read_b64_tr_b16 a[114:115], v199 offset:8192
  v_mfma_f32_16x16x32_bf16 v[88:91], a[100:103], a[24:27], v[88:91]
  ds_read_b128 a[40:43], v208 offset:33792
  v_mfma_f32_16x16x32_bf16 v[88:91], a[96:99], a[4:7], v[88:91]
  ds_read_b64_tr_b16 a[80:81], v198 offset:21504
  v_mfma_f32_16x16x32_bf16 v[88:91], a[92:95], a[64:67], v[88:91]
  buffer_load_dwordx4 v203, s[8:11], s61 offen offset:1024 lds
  v_mfma_f32_16x16x32_bf16 v[92:95], a[92:95], a[68:71], v[92:95]
  ds_read_b128 a[44:47], v208 offset:34816
  v_mfma_f32_16x16x32_bf16 v[92:95], a[96:99], a[8:11], v[92:95]
  s_lshl2_add_u32 s75, s48, s53
  ds_read_b64_tr_b16 a[82:83], v198 offset:27648
  s_lshl_b32 s75, s75, 10
  v_mfma_f32_16x16x32_bf16 v[92:95], a[100:103], a[28:31], v[92:95]
  s_add_u32 s75, s75, 5767168
  ds_read_b128 a[48:51], v208 offset:35840
  s_and_b32 s48, s48, 7
  v_mfma_f32_16x16x32_bf16 v[96:99], a[100:103], a[32:35], v[96:99]
  s_cselect_b32 s75, 1073741824, s75
  buffer_load_dwordx4 v204, s[8:11], s61 offen offset:2048 lds
  s_mov_b32 s62, 28672
  v_mfma_f32_16x16x32_bf16 v[96:99], a[96:99], a[12:15], v[96:99]
  s_add_u32 m0, s64, 33792
  ds_read_b64_tr_b16 a[84:85], v198 offset:22528
  v_mfma_f32_16x16x32_bf16 v[96:99], a[92:95], a[72:75], v[96:99]
  s_waitcnt lgkmcnt(6)
  ds_read_b128 a[52:55], v208 offset:36864
  v_mfma_f32_16x16x32_bf16 v[112:115], a[104:107], a[72:75], v[112:115]
  ds_read_b128 a[56:59], v211 offset:41984
  v_mfma_f32_16x16x32_bf16 v[112:115], a[108:111], a[12:15], v[112:115]
  buffer_load_dwordx4 v205, s[36:39], s62 offen offset:0 sc1 lds
  v_mfma_f32_16x16x32_bf16 v[112:115], a[112:115], a[32:35], v[112:115]
  ds_read_b64_tr_b16 a[86:87], v198 offset:28672
  v_mfma_f32_16x16x32_bf16 v[108:111], a[112:115], a[28:31], v[108:111]
  s_and_b32 s48, s52, 7
  ds_read_b64_tr_b16 a[88:89], v198 offset:23552
  s_lshl_b32 s48, s48, 5
  v_mfma_f32_16x16x32_bf16 v[108:111], a[108:111], a[8:11], v[108:111]
  s_lshr_b32 s49, s52, 3
  ds_read_b64_tr_b16 a[90:91], v198 offset:29696
  s_lshl2_add_u32 s48, s49, s48
  v_mfma_f32_16x16x32_bf16 v[108:111], a[104:107], a[68:71], v[108:111]
  buffer_load_dwordx4 v205, s[36:39], s62 offen offset:1024 sc1 lds
  s_add_u32 m0, s65, 41984
  v_mfma_f32_16x16x32_bf16 v[104:107], a[104:107], a[64:67], v[104:107]
  v_mfma_f32_16x16x32_bf16 v[104:107], a[108:111], a[4:7], v[104:107]
  ds_read_b64_tr_b16 a[92:93], v199 offset:21504
  v_mfma_f32_16x16x32_bf16 v[104:107], a[112:115], a[24:27], v[104:107]
  v_mfma_f32_16x16x32_bf16 v[100:103], a[112:115], a[20:23], v[100:103]
  buffer_load_dword v206, s[36:39], s62 offen sc1 lds
  s_mov_b32 s61, 2555904
  v_mfma_f32_16x16x32_bf16 v[100:103], a[108:111], a[0:3], v[100:103]
  s_add_u32 m0, s63, 43008
  ds_read_b64_tr_b16 a[94:95], v199 offset:27648
  v_and_b32 v12, 3, v10
  v_mfma_f32_16x16x32_bf16 v[100:103], a[104:107], a[60:63], v[100:103]
  s_waitcnt lgkmcnt(2)
  ds_read_b64_tr_b16 a[96:97], v199 offset:22528
  v_bfe_u32 v13, v10, 2, 2
  v_mfma_f32_16x16x32_bf16 v[20:23], a[80:83], a[0:3], v[20:23]
  v_lshl_add_u32 v12, v12, 3, v13
  v_add_lshl_u32 v250, v12, s48, 7
  v_mfma_f32_16x16x32_bf16 v[20:23], a[84:87], a[20:23], v[20:23]
  buffer_load_dwordx4 v202, s[8:11], s61 offen offset:0 lds
  v_mfma_f32_16x16x32_bf16 v[20:23], a[88:91], a[40:43], v[20:23]
  ds_read_b64_tr_b16 a[98:99], v199 offset:28672
  v_mfma_f32_16x16x32_bf16 v[24:27], a[88:91], a[44:47], v[24:27]
  ds_read_b64_tr_b16 a[100:101], v199 offset:23552
  v_mfma_f32_16x16x32_bf16 v[24:27], a[84:87], a[24:27], v[24:27]
  v_add_u32 v250, 32768, v250
  v_and_b32 v12, 7, v10
  v_mfma_f32_16x16x32_bf16 v[24:27], a[80:83], a[4:7], v[24:27]
  buffer_load_dwordx4 v203, s[8:11], s61 offen offset:1024 lds
  v_and_b32 v13, 8, v10
  v_mfma_f32_16x16x32_bf16 v[28:31], a[80:83], a[8:11], v[28:31]
  ds_read_b64_tr_b16 a[102:103], v199 offset:29696
  v_lshl_add_u32 v12, v13, 4, v12
  v_mfma_f32_16x16x32_bf16 v[28:31], a[84:87], a[28:31], v[28:31]
  s_lshl_b32 s48, s53, 3
  ds_read_b128 a[60:63], v208 offset:55296
  v_add_lshl_u32 v12, v12, s48, 7
  v_mfma_f32_16x16x32_bf16 v[28:31], a[88:91], a[48:51], v[28:31]
  ds_read_b64_tr_b16 a[104:105], v198 offset:43008
  v_cmp_gt_u32 vcc, 16, v10
  v_mfma_f32_16x16x32_bf16 v[32:35], a[88:91], a[52:55], v[32:35]
  s_nop 1
  buffer_load_dwordx4 v204, s[8:11], s61 offen offset:2048 lds
  s_mov_b32 s62, 30720
  v_mfma_f32_16x16x32_bf16 v[32:35], a[84:87], a[32:35], v[32:35]
  s_add_u32 m0, s64, 55296
  ds_read_b128 a[64:67], v208 offset:56320
  v_cndmask_b32 v250, v12, v250, vcc
  v_mfma_f32_16x16x32_bf16 v[32:35], a[80:83], a[12:15], v[32:35]
  ds_read_b64_tr_b16 a[106:107], v198 offset:49152
  v_mfma_f32_16x16x32_bf16 v[116:119], a[80:83], a[16:19], v[116:119]
  ds_read_b128 a[68:71], v208 offset:57344
  v_mfma_f32_16x16x32_bf16 v[116:119], a[84:87], a[36:39], v[116:119]
  buffer_load_dwordx4 v205, s[36:39], s62 offen offset:0 sc1 lds
  v_mfma_f32_16x16x32_bf16 v[116:119], a[88:91], a[56:59], v[116:119]
  s_waitcnt lgkmcnt(5)
  ds_read_b64_tr_b16 a[108:109], v198 offset:44032
  v_mfma_f32_16x16x32_bf16 v[48:51], a[92:95], a[12:15], v[48:51]
  ds_read_b128 a[72:75], v208 offset:58368
  v_mfma_f32_16x16x32_bf16 v[48:51], a[96:99], a[32:35], v[48:51]
  ds_read_b128 a[76:79], v211 offset:63488
  v_mfma_f32_16x16x32_bf16 v[48:51], a[100:103], a[52:55], v[48:51]
  buffer_load_dwordx4 v205, s[36:39], s62 offen offset:1024 sc1 lds
  s_add_u32 m0, s65, 63488
  v_mfma_f32_16x16x32_bf16 v[44:47], a[100:103], a[48:51], v[44:47]
  s_lshl_b32 s48, s59, 3
  ds_read_b64_tr_b16 a[110:111], v198 offset:50176
  s_add_u32 s48, s48, 150528
  v_mfma_f32_16x16x32_bf16 v[44:47], a[96:99], a[28:31], v[44:47]
  ds_read_b64_tr_b16 a[112:113], v198 offset:45056
  v_add_u32 v12, s48, v0
  v_mfma_f32_16x16x32_bf16 v[44:47], a[92:95], a[8:11], v[44:47]
  ds_read_b64_tr_b16 a[114:115], v198 offset:51200
  v_add_u32 v222, s64, v12
  v_mfma_f32_16x16x32_bf16 v[40:43], a[92:95], a[4:7], v[40:43]
  buffer_load_dword v206, s[36:39], s62 offen sc1 lds
  v_xor_b32 v223, 8, v222
  v_mfma_f32_16x16x32_bf16 v[40:43], a[96:99], a[24:27], v[40:43]
  ds_read_b64_tr_b16 a[80:81], v199 offset:43008
  v_mfma_f32_16x16x32_bf16 v[40:43], a[100:103], a[44:47], v[40:43]
  v_mfma_f32_16x16x32_bf16 v[36:39], a[100:103], a[40:43], v[36:39]
  ds_read_b64_tr_b16 a[82:83], v199 offset:49152
  v_mfma_f32_16x16x32_bf16 v[36:39], a[96:99], a[20:23], v[36:39]
  v_mfma_f32_16x16x32_bf16 v[36:39], a[92:95], a[0:3], v[36:39]
  s_waitcnt lgkmcnt(2)
  ds_read_b64_tr_b16 a[84:85], v199 offset:44032
  s_lshl_b32 s48, s60, 11
  v_mfma_f32_16x16x32_bf16 v[52:55], a[20:23], a[104:107], v[52:55]
  s_add_u32 s48, s48, 8192
  v_add_u32 v224, s48, v12
  s_lshl_b32 s48, s59, 13
  v_mfma_f32_16x16x32_bf16 v[52:55], a[40:43], a[108:111], v[52:55]
  s_mov_b32 s61, 2754560
  s_add_u32 m0, s63, 64512
  ds_read_b64_tr_b16 a[86:87], v199 offset:50176
  v_mfma_f32_16x16x32_bf16 v[52:55], a[60:63], a[112:115], v[52:55]
  s_waitcnt vmcnt(12)
  s_barrier
  v_subrev_u32 v225, s48, v224
  v_mfma_f32_16x16x32_bf16 v[56:59], a[64:67], a[112:115], v[56:59]
  ds_read_b64_tr_b16 a[88:89], v199 offset:45056
  v_xor_b32 v226, 8, v225
  v_mfma_f32_16x16x32_bf16 v[56:59], a[44:47], a[108:111], v[56:59]
  buffer_load_dwordx4 v202, s[8:11], s61 offen offset:0 lds
  v_and_b32 v227, -9, v225
  v_mfma_f32_16x16x32_bf16 v[56:59], a[24:27], a[104:107], v[56:59]
  ds_read_b64_tr_b16 a[90:91], v199 offset:51200
  v_mfma_f32_16x16x32_bf16 v[60:63], a[28:31], a[104:107], v[60:63]
  ds_read_b128 a[0:3], v209 offset:12288
  v_mfma_f32_16x16x32_bf16 v[60:63], a[48:51], a[108:111], v[60:63]
  ds_read_b64_tr_b16 a[92:93], v200 offset:0
  v_mfma_f32_16x16x32_bf16 v[60:63], a[68:71], a[112:115], v[60:63]
  ds_read_b128 a[4:7], v209 offset:13312
  v_mfma_f32_16x16x32_bf16 v[64:67], a[72:75], a[112:115], v[64:67]
  buffer_load_dwordx4 v203, s[8:11], s61 offen offset:1024 lds
  v_mfma_f32_16x16x32_bf16 v[64:67], a[52:55], a[108:111], v[64:67]
  ds_read_b64_tr_b16 a[94:95], v200 offset:6144
  v_mfma_f32_16x16x32_bf16 v[64:67], a[32:35], a[104:107], v[64:67]
  s_mov_b32 s76, 0xaaaaaaaa
  ds_read_b128 a[8:11], v209 offset:14336
  s_mov_b32 s77, 0xaaaaaaaa
  v_mfma_f32_16x16x32_bf16 v[120:123], a[36:39], a[104:107], v[120:123]
  s_mov_b32 s78, 0x000f0000
  ds_read_b64_tr_b16 a[96:97], v200 offset:1024
  s_mov_b32 s79, 0x0fff00ff
  v_mfma_f32_16x16x32_bf16 v[120:123], a[56:59], a[108:111], v[120:123]
  s_mov_b32 s80, 0x003f0003
  ds_read_b128 a[12:15], v209 offset:15360
  s_mov_b32 s81, 0x3fff03ff
  v_mfma_f32_16x16x32_bf16 v[120:123], a[76:79], a[112:115], v[120:123]
  s_waitcnt lgkmcnt(7)
  buffer_load_dwordx4 v204, s[8:11], s61 offen offset:2048 lds
  s_mov_b32 s62, 32768
  v_mfma_f32_16x16x32_bf16 v[80:83], a[32:35], a[80:83], v[80:83]
  s_add_u32 m0, s64, 76800
  ds_read_b64_tr_b16 a[98:99], v200 offset:7168
  v_mfma_f32_16x16x32_bf16 v[80:83], a[52:55], a[84:87], v[80:83]
  ds_read_b128 a[16:19], v212 offset:20480
  v_mfma_f32_16x16x32_bf16 v[80:83], a[72:75], a[88:91], v[80:83]
  ds_read_b64_tr_b16 a[100:101], v200 offset:2048
  v_mfma_f32_16x16x32_bf16 v[76:79], a[68:71], a[88:91], v[76:79]
  buffer_load_dwordx4 v205, s[36:39], s62 offen offset:0 sc1 lds
  v_mfma_f32_16x16x32_bf16 v[76:79], a[48:51], a[84:87], v[76:79]
  ds_read_b64_tr_b16 a[102:103], v200 offset:8192
  v_mfma_f32_16x16x32_bf16 v[76:79], a[28:31], a[80:83], v[76:79]
  ds_read_b64_tr_b16 a[104:105], v201 offset:0
  v_mov_b32 v12, 0x0c0c0100
  v_mfma_f32_16x16x32_bf16 v[72:75], a[24:27], a[80:83], v[72:75]
  ds_read_b64_tr_b16 a[106:107], v201 offset:6144
  v_mov_b32 v13, 0x01000c0c
  v_mfma_f32_16x16x32_bf16 v[72:75], a[44:47], a[84:87], v[72:75]
  buffer_load_dwordx4 v205, s[36:39], s62 offen offset:1024 sc1 lds
  s_add_u32 m0, s65, 84992
  v_mfma_f32_16x16x32_bf16 v[72:75], a[64:67], a[88:91], v[72:75]
  ds_read_b64_tr_b16 a[108:109], v201 offset:1024
  v_cndmask_b32 v12, v12, v13, s[76:77]
  v_mfma_f32_16x16x32_bf16 v[68:71], a[60:63], a[88:91], v[68:71]
  v_mov_b32 v14, 0x0c0c0c0c
  v_cndmask_b32 v228, v14, v12, s[78:79]
  v_mfma_f32_16x16x32_bf16 v[68:71], a[40:43], a[84:87], v[68:71]
  ds_read_b64_tr_b16 a[110:111], v201 offset:7168
  v_cndmask_b32 v230, v12, v14, s[78:79]
  v_mfma_f32_16x16x32_bf16 v[68:71], a[20:23], a[80:83], v[68:71]
  s_waitcnt lgkmcnt(4)
  buffer_load_dword v206, s[36:39], s62 offen sc1 lds
  s_mov_b32 s61, 2953216
  v_mfma_f32_16x16x32_bf16 v[84:87], a[92:95], a[40:43], v[84:87]
  s_add_u32 m0, s63, 86016
  ds_read_b64_tr_b16 a[112:113], v201 offset:2048
  v_mfma_f32_16x16x32_bf16 v[84:87], a[96:99], a[60:63], v[84:87]
  v_mfma_f32_16x16x32_bf16 v[84:87], a[100:103], a[0:3], v[84:87]
  ds_read_b64_tr_b16 a[114:115], v201 offset:8192
  v_mfma_f32_16x16x32_bf16 v[88:91], a[100:103], a[4:7], v[88:91]
  buffer_load_dwordx4 v202, s[8:11], s61 offen offset:0 lds
  v_mov_b32 v12, 0x0c0c0302
  v_mfma_f32_16x16x32_bf16 v[88:91], a[96:99], a[64:67], v[88:91]
  ds_read_b128 a[20:23], v207 offset:12288
  v_mov_b32 v13, 0x03020c0c
  v_mfma_f32_16x16x32_bf16 v[88:91], a[92:95], a[44:47], v[88:91]
  ds_read_b64_tr_b16 a[80:81], v196 offset:0
  v_cndmask_b32 v12, v12, v13, s[76:77]
  v_mfma_f32_16x16x32_bf16 v[92:95], a[92:95], a[48:51], v[92:95]
  ds_read_b128 a[24:27], v207 offset:13312
  v_cndmask_b32 v229, v14, v12, s[80:81]
  v_mfma_f32_16x16x32_bf16 v[92:95], a[96:99], a[68:71], v[92:95]
  buffer_load_dwordx4 v203, s[8:11], s61 offen offset:1024 lds
  v_cndmask_b32 v231, v12, v14, s[80:81]
  v_mfma_f32_16x16x32_bf16 v[92:95], a[100:103], a[8:11], v[92:95]
  ds_read_b64_tr_b16 a[82:83], v196 offset:6144
  v_mfma_f32_16x16x32_bf16 v[96:99], a[100:103], a[12:15], v[96:99]
  ds_read_b128 a[28:31], v207 offset:14336
  v_mfma_f32_16x16x32_bf16 v[96:99], a[96:99], a[72:75], v[96:99]
  ds_read_b64_tr_b16 a[84:85], v196 offset:1024
  v_mfma_f32_16x16x32_bf16 v[96:99], a[92:95], a[52:55], v[96:99]
  s_waitcnt lgkmcnt(6)
  ds_read_b128 a[32:35], v207 offset:15360
  s_lshl1_add_u32 s48, s57, s59
  v_mfma_f32_16x16x32_bf16 v[112:115], a[104:107], a[52:55], v[112:115]
  s_lshl_b32 s71, s48, 17
  buffer_load_dwordx4 v204, s[8:11], s61 offen offset:2048 lds
  s_mov_b32 s62, 34816
  v_mfma_f32_16x16x32_bf16 v[112:115], a[108:111], a[72:75], v[112:115]
  s_add_u32 m0, s64, 98304
  ds_read_b128 a[36:39], v210 offset:20480
  s_lshl1_add_u32 s48, s58, s60
  v_mfma_f32_16x16x32_bf16 v[112:115], a[112:115], a[12:15], v[112:115]
  s_lshl_b32 s48, s48, 11
  ds_read_b64_tr_b16 a[86:87], v196 offset:7168
  v_mfma_f32_16x16x32_bf16 v[108:111], a[112:115], a[8:11], v[108:111]
  ds_read_b64_tr_b16 a[88:89], v196 offset:2048
  v_mfma_f32_16x16x32_bf16 v[108:111], a[108:111], a[68:71], v[108:111]
  buffer_load_dwordx4 v205, s[36:39], s62 offen offset:0 sc1 lds
  v_mfma_f32_16x16x32_bf16 v[108:111], a[104:107], a[48:51], v[108:111]
  s_add_u32 s71, s71, s48
  ds_read_b64_tr_b16 a[90:91], v196 offset:8192
  s_add_u32 s71, s71, 7340032
  v_mfma_f32_16x16x32_bf16 v[104:107], a[104:107], a[44:47], v[104:107]
  s_add_u32 s72, s71, 65536
  s_or_b32 s57, s57, s59
  v_mfma_f32_16x16x32_bf16 v[104:107], a[108:111], a[64:67], v[104:107]
  ds_read_b64_tr_b16 a[92:93], v197 offset:0
  v_mfma_f32_16x16x32_bf16 v[104:107], a[112:115], a[4:7], v[104:107]
  buffer_load_dwordx4 v205, s[36:39], s62 offen offset:1024 sc1 lds
  s_add_u32 m0, s65, 106496
  v_mfma_f32_16x16x32_bf16 v[100:103], a[112:115], a[0:3], v[100:103]
  ds_read_b64_tr_b16 a[94:95], v197 offset:6144
  v_mfma_f32_16x16x32_bf16 v[100:103], a[108:111], a[60:63], v[100:103]
  v_mfma_f32_16x16x32_bf16 v[100:103], a[104:107], a[40:43], v[100:103]
  s_waitcnt lgkmcnt(2)
  ds_read_b64_tr_b16 a[96:97], v197 offset:1024
  v_mfma_f32_16x16x32_bf16 v[20:23], a[80:83], a[60:63], v[20:23]
  s_lshl_b32 s45, s2, 7
  buffer_load_dword v206, s[36:39], s62 offen sc1 lds
  s_add_u32 s45, s45, 5275648
  v_mfma_f32_16x16x32_bf16 v[20:23], a[84:87], a[0:3], v[20:23]
  s_mov_b32 s61, 3145728
  s_add_u32 m0, s63, 107520
  ds_read_b64_tr_b16 a[98:99], v197 offset:7168
  v_mfma_f32_16x16x32_bf16 v[20:23], a[88:91], a[20:23], v[20:23]
  s_waitcnt vmcnt(12)
  s_barrier
  s_cmp_eq_u32 s44, 0
  v_mfma_f32_16x16x32_bf16 v[24:27], a[88:91], a[24:27], v[24:27]
  s_cselect_b32 s45, s45, 1073741824
  ds_read_b64_tr_b16 a[100:101], v197 offset:2048
  v_mfma_f32_16x16x32_bf16 v[24:27], a[84:87], a[4:7], v[24:27]
  buffer_load_dwordx4 v202, s[8:11], s61 offen offset:0 lds
  v_mfma_f32_16x16x32_bf16 v[24:27], a[80:83], a[64:67], v[24:27]
  ds_read_b64_tr_b16 a[102:103], v197 offset:8192
  v_mfma_f32_16x16x32_bf16 v[28:31], a[80:83], a[68:71], v[28:31]
  s_lshr_b32 s49, s2, 3
  ds_read_b128 a[40:43], v207 offset:33792
  s_and_b32 s60, s49, 3
  v_mfma_f32_16x16x32_bf16 v[28:31], a[84:87], a[8:11], v[28:31]
  s_lshr_b32 s58, s49, 2
  ds_read_b64_tr_b16 a[104:105], v196 offset:21504
  s_lshl1_add_u32 s49, s60, s58
  v_mfma_f32_16x16x32_bf16 v[28:31], a[88:91], a[28:31], v[28:31]
  s_and_b32 s49, s49, 7
  ds_read_b128 a[44:47], v207 offset:34816
  s_and_b32 s48, s2, 7
  v_mfma_f32_16x16x32_bf16 v[32:35], a[88:91], a[32:35], v[32:35]
  s_lshl2_add_u32 s60, s48, s60
  buffer_load_dwordx4 v203, s[8:11], s61 offen offset:1024 lds
  v_mfma_f32_16x16x32_bf16 v[32:35], a[84:87], a[12:15], v[32:35]
  ds_read_b64_tr_b16 a[106:107], v196 offset:27648
  v_mfma_f32_16x16x32_bf16 v[32:35], a[80:83], a[72:75], v[32:35]
  ds_read_b128 a[48:51], v207 offset:35840
  v_mfma_f32_16x16x32_bf16 v[116:119], a[80:83], a[76:79], v[116:119]
  ds_read_b64_tr_b16 a[108:109], v196 offset:22528
  v_mfma_f32_16x16x32_bf16 v[116:119], a[84:87], a[16:19], v[116:119]
  ds_read_b128 a[52:55], v207 offset:36864
  v_mfma_f32_16x16x32_bf16 v[116:119], a[88:91], a[36:39], v[116:119]
  s_waitcnt lgkmcnt(7)
  buffer_load_dwordx4 v204, s[8:11], s61 offen offset:2048 lds
  s_mov_b32 s62, 36864
  v_mfma_f32_16x16x32_bf16 v[48:51], a[92:95], a[72:75], v[48:51]
  s_add_u32 m0, s64, 119808
  ds_read_b128 a[56:59], v210 offset:41984
  v_mfma_f32_16x16x32_bf16 v[48:51], a[96:99], a[12:15], v[48:51]
  ds_read_b64_tr_b16 a[110:111], v196 offset:28672
  v_mfma_f32_16x16x32_bf16 v[48:51], a[100:103], a[32:35], v[48:51]
  s_mov_b32 s82, 0xd0643521
  ds_read_b64_tr_b16 a[112:113], v196 offset:23552
  s_mov_b32 s83, 0xfecba987
  v_mfma_f32_16x16x32_bf16 v[44:47], a[100:103], a[28:31], v[44:47]
  buffer_load_dwordx4 v205, s[36:39], s62 offen offset:0 sc1 lds
  v_mfma_f32_16x16x32_bf16 v[44:47], a[96:99], a[8:11], v[44:47]
  ds_read_b64_tr_b16 a[114:115], v196 offset:29696
  v_mfma_f32_16x16x32_bf16 v[44:47], a[92:95], a[68:71], v[44:47]
  s_cmp_eq_u32 s49, 1
  s_cselect_b32 s82, 0x71546320, s82
  s_cselect_b32 s83, 0xfdcba89e, s83
  v_mfma_f32_16x16x32_bf16 v[40:43], a[92:95], a[64:67], v[40:43]
  v_mfma_f32_16x16x32_bf16 v[40:43], a[96:99], a[4:7], v[40:43]
  buffer_load_dwordx4 v205, s[36:39], s62 offen offset:1024 sc1 lds
  s_add_u32 m0, s65, 128000
  v_mfma_f32_16x16x32_bf16 v[40:43], a[100:103], a[24:27], v[40:43]
  ds_read_b64_tr_b16 a[80:81], v197 offset:21504
  v_mfma_f32_16x16x32_bf16 v[36:39], a[100:103], a[20:23], v[36:39]
  ds_read_b64_tr_b16 a[82:83], v197 offset:27648
  v_mfma_f32_16x16x32_bf16 v[36:39], a[96:99], a[0:3], v[36:39]
  s_cmp_eq_u32 s49, 2
  s_cselect_b32 s82, 0x62574310, s82
  s_cselect_b32 s83, 0xfedcb9a8, s83
  v_mfma_f32_16x16x32_bf16 v[36:39], a[92:95], a[60:63], v[36:39]
  s_waitcnt lgkmcnt(2)
  buffer_load_dword v206, s[36:39], s62 offen sc1 lds
  s_mov_b32 s61, 3344384
  v_mfma_f32_16x16x32_bf16 v[52:55], a[0:3], a[104:107], v[52:55]
  s_add_u32 m0, s63, 129024
  ds_read_b64_tr_b16 a[84:85], v197 offset:22528
  v_mfma_f32_16x16x32_bf16 v[52:55], a[20:23], a[108:111], v[52:55]
  ds_read_b64_tr_b16 a[86:87], v197 offset:28672
  v_mfma_f32_16x16x32_bf16 v[52:55], a[40:43], a[112:115], v[52:55]
  v_mfma_f32_16x16x32_bf16 v[56:59], a[44:47], a[112:115], v[56:59]
  s_cmp_eq_u32 s49, 3
  buffer_load_dwordx4 v202, s[8:11], s61 offen offset:0 lds
  s_cselect_b32 s82, 0x63854210, s82
  v_mfma_f32_16x16x32_bf16 v[56:59], a[24:27], a[108:111], v[56:59]
  s_cselect_b32 s83, 0xfedca9b7, s83
  ds_read_b64_tr_b16 a[88:89], v197 offset:23552
  v_mfma_f32_16x16x32_bf16 v[56:59], a[4:7], a[104:107], v[56:59]
  ds_read_b64_tr_b16 a[90:91], v197 offset:29696
  v_mfma_f32_16x16x32_bf16 v[60:63], a[8:11], a[104:107], v[60:63]
  ds_read_b128 a[60:63], v207 offset:55296
  v_mfma_f32_16x16x32_bf16 v[60:63], a[28:31], a[108:111], v[60:63]
  buffer_load_dwordx4 v203, s[8:11], s61 offen offset:1024 lds
  v_mfma_f32_16x16x32_bf16 v[60:63], a[48:51], a[112:115], v[60:63]
  s_cmp_eq_u32 s49, 4
  ds_read_b64_tr_b16 a[92:93], v196 offset:43008
  s_cselect_b32 s82, 0x64953210, s82
  v_mfma_f32_16x16x32_bf16 v[64:67], a[52:55], a[112:115], v[64:67]
  s_cselect_b32 s83, 0xfedba8c7, s83
  ds_read_b128 a[64:67], v207 offset:56320
  v_mfma_f32_16x16x32_bf16 v[64:67], a[32:35], a[108:111], v[64:67]
  ds_read_b64_tr_b16 a[94:95], v196 offset:49152
  v_mfma_f32_16x16x32_bf16 v[64:67], a[12:15], a[104:107], v[64:67]
  buffer_load_dwordx4 v204, s[8:11], s61 offen offset:2048 lds
  s_mov_b32 s62, 38912
  v_mfma_f32_16x16x32_bf16 v[120:123], a[16:19], a[104:107], v[120:123]
  s_add_u32 m0, s64, 141312
  ds_read_b128 a[68:71], v207 offset:57344
  v_mfma_f32_16x16x32_bf16 v[120:123], a[36:39], a[108:111], v[120:123]
  s_cmp_eq_u32 s49, 5
  ds_read_b64_tr_b16 a[96:97], v196 offset:44032
  s_cselect_b32 s82, 0x65a43210, s82
  v_mfma_f32_16x16x32_bf16 v[120:123], a[56:59], a[112:115], v[120:123]
  s_waitcnt lgkmcnt(6)
  ds_read_b128 a[72:75], v207 offset:58368
  s_cselect_b32 s83, 0xfecb98d7, s83
  v_mfma_f32_16x16x32_bf16 v[80:83], a[12:15], a[80:83], v[80:83]
  buffer_load_dwordx4 v205, s[36:39], s62 offen offset:0 sc1 lds
  v_mfma_f32_16x16x32_bf16 v[80:83], a[32:35], a[84:87], v[80:83]
  ds_read_b64_tr_b16 a[98:99], v196 offset:50176
  v_mfma_f32_16x16x32_bf16 v[80:83], a[52:55], a[88:91], v[80:83]
  s_cmp_eq_u32 s49, 6
  ds_read_b128 a[76:79], v210 offset:63488
  s_cselect_b32 s82, 0xb6543210, s82
  v_mfma_f32_16x16x32_bf16 v[76:79], a[48:51], a[88:91], v[76:79]
  s_cselect_b32 s83, 0xfdca98e7, s83
  ds_read_b64_tr_b16 a[100:101], v196 offset:45056
  v_mfma_f32_16x16x32_bf16 v[76:79], a[28:31], a[84:87], v[76:79]
  buffer_load_dwordx4 v205, s[36:39], s62 offen offset:1024 sc1 lds
  s_add_u32 m0, s65, 149504
  v_mfma_f32_16x16x32_bf16 v[76:79], a[8:11], a[80:83], v[76:79]
  ds_read_b64_tr_b16 a[102:103], v196 offset:51200
  v_mfma_f32_16x16x32_bf16 v[72:75], a[4:7], a[80:83], v[72:75]
  ds_read_b64_tr_b16 a[104:105], v197 offset:43008
  v_mfma_f32_16x16x32_bf16 v[72:75], a[24:27], a[84:87], v[72:75]
  s_cmp_eq_u32 s49, 7
  ds_read_b64_tr_b16 a[106:107], v197 offset:49152
  s_cselect_b32 s82, 0xc7543210, s82
  v_mfma_f32_16x16x32_bf16 v[72:75], a[44:47], a[88:91], v[72:75]
  s_cselect_b32 s83, 0xedba98f6, s83
  buffer_load_dword v206, s[36:39], s62 offen sc1 lds
  v_mfma_f32_16x16x32_bf16 v[68:71], a[40:43], a[88:91], v[68:71]
  ds_read_b64_tr_b16 a[108:109], v197 offset:44032
  v_mfma_f32_16x16x32_bf16 v[68:71], a[20:23], a[84:87], v[68:71]
  s_mov_b32 s61, 3543040
  s_add_u32 m0, s63, 0
  ds_read_b64_tr_b16 a[110:111], v197 offset:50176
  v_mfma_f32_16x16x32_bf16 v[68:71], a[0:3], a[80:83], v[68:71]
  s_waitcnt vmcnt(12) lgkmcnt(4)
  s_barrier
  v_mfma_f32_16x16x32_bf16 v[84:87], a[92:95], a[20:23], v[84:87]
  s_mul_i32 s84, s44, 7168
  ds_read_b64_tr_b16 a[112:113], v197 offset:45056
  s_lshl2_add_u32 s85, s58, s44
  v_mfma_f32_16x16x32_bf16 v[84:87], a[96:99], a[40:43], v[84:87]
  s_lshl_b32 s85, s85, 17
  buffer_load_dwordx4 v202, s[8:11], s61 offen offset:0 lds
  s_add_u32 s85, s85, 36700160
  v_mfma_f32_16x16x32_bf16 v[84:87], a[100:103], a[60:63], v[84:87]
  ds_read_b64_tr_b16 a[114:115], v197 offset:51200
  v_mfma_f32_16x16x32_bf16 v[88:91], a[100:103], a[64:67], v[88:91]
  ds_read_b128 a[0:3], v208 offset:12288
  v_mfma_f32_16x16x32_bf16 v[88:91], a[96:99], a[44:47], v[88:91]
  ds_read_b64_tr_b16 a[80:81], v198 offset:0
  v_mfma_f32_16x16x32_bf16 v[88:91], a[92:95], a[24:27], v[88:91]
  ds_read_b128 a[4:7], v208 offset:13312
  v_mfma_f32_16x16x32_bf16 v[92:95], a[92:95], a[28:31], v[92:95]
  s_cmp_ge_u32 s44, 2
  buffer_load_dwordx4 v203, s[8:11], s61 offen offset:1024 lds
  s_cselect_b64 s[16:17], s[20:21], s[16:17]
  v_mfma_f32_16x16x32_bf16 v[92:95], a[96:99], a[48:51], v[92:95]
  ds_read_b64_tr_b16 a[82:83], v198 offset:6144
  v_mfma_f32_16x16x32_bf16 v[92:95], a[100:103], a[68:71], v[92:95]
  ds_read_b128 a[8:11], v208 offset:14336
  v_mfma_f32_16x16x32_bf16 v[96:99], a[100:103], a[72:75], v[96:99]
  ds_read_b64_tr_b16 a[84:85], v198 offset:1024
  v_mfma_f32_16x16x32_bf16 v[96:99], a[96:99], a[52:55], v[96:99]
  ds_read_b128 a[12:15], v208 offset:15360
  v_lshrrev_b32 v12, 2, v10
  v_mfma_f32_16x16x32_bf16 v[96:99], a[92:95], a[32:35], v[96:99]
  s_waitcnt lgkmcnt(7)
  buffer_load_dwordx4 v204, s[8:11], s61 offen offset:2048 lds
  s_mov_b32 s62, 40960
  v_mfma_f32_16x16x32_bf16 v[112:115], a[104:107], a[32:35], v[112:115]
  s_add_u32 m0, s64, 12288
  ds_read_b128 a[16:19], v211 offset:20480
  v_mul_u32_u24 v12, 224, v12
  v_mfma_f32_16x16x32_bf16 v[112:115], a[108:111], a[52:55], v[112:115]
  ds_read_b64_tr_b16 a[86:87], v198 offset:7168
  v_and_b32 v13, 3, v10
  v_mfma_f32_16x16x32_bf16 v[112:115], a[112:115], a[72:75], v[112:115]
  ds_read_b64_tr_b16 a[88:89], v198 offset:2048
  v_lshl_add_u32 v1, v13, 3, v12
  v_mfma_f32_16x16x32_bf16 v[108:111], a[112:115], a[68:71], v[108:111]
  buffer_load_dwordx4 v205, s[36:39], s62 offen offset:0 sc1 lds
  v_add_u32 v2, 57344, v1
  v_mfma_f32_16x16x32_bf16 v[108:111], a[108:111], a[48:51], v[108:111]
  ds_read_b64_tr_b16 a[90:91], v198 offset:8192
  v_mfma_f32_16x16x32_bf16 v[108:111], a[104:107], a[28:31], v[108:111]
  v_mfma_f32_16x16x32_bf16 v[104:107], a[104:107], a[24:27], v[104:107]
  s_mul_i32 s48, s60, 224
  s_and_b32 s49, s44, 1
  s_mul_i32 s49, s49, 458752
  v_mfma_f32_16x16x32_bf16 v[104:107], a[108:111], a[44:47], v[104:107]
  s_add_u32 s48, s48, s49
  buffer_load_dwordx4 v205, s[36:39], s62 offen offset:1024 sc1 lds
  s_add_u32 m0, s65, 20480
  v_mfma_f32_16x16x32_bf16 v[104:107], a[112:115], a[64:67], v[104:107]
  s_and_b32 s49, s60, 1
  ds_read_b64_tr_b16 a[92:93], v199 offset:0
  s_lshl_b32 s49, s49, 1
  v_mfma_f32_16x16x32_bf16 v[100:103], a[112:115], a[60:63], v[100:103]
  ds_read_b64_tr_b16 a[94:95], v199 offset:6144
  v_mfma_f32_16x16x32_bf16 v[100:103], a[108:111], a[40:43], v[100:103]
  v_mfma_f32_16x16x32_bf16 v[100:103], a[104:107], a[20:23], v[100:103]
  s_waitcnt lgkmcnt(2)
  buffer_load_dword v206, s[36:39], s62 offen sc1 lds
  s_mov_b32 s61, 3735552
  v_mfma_f32_16x16x32_bf16 v[20:23], a[80:83], a[40:43], v[20:23]
  s_add_u32 m0, s63, 21504
  ds_read_b64_tr_b16 a[96:97], v199 offset:1024
  v_mfma_f32_16x16x32_bf16 v[20:23], a[84:87], a[60:63], v[20:23]
  ds_read_b64_tr_b16 a[98:99], v199 offset:7168
  v_mfma_f32_16x16x32_bf16 v[20:23], a[88:91], a[0:3], v[20:23]
  v_mfma_f32_16x16x32_bf16 v[24:27], a[88:91], a[4:7], v[24:27]
  buffer_load_dwordx4 v202, s[8:11], s61 offen offset:0 lds
  v_add_u32 v12, 0, v10
  v_mfma_f32_16x16x32_bf16 v[24:27], a[84:87], a[64:67], v[24:27]
  ds_read_b64_tr_b16 a[100:101], v199 offset:2048
  v_mul_u32_u24 v13, 4682, v12
  v_mfma_f32_16x16x32_bf16 v[24:27], a[80:83], a[44:47], v[24:27]
  ds_read_b64_tr_b16 a[102:103], v199 offset:8192
  v_lshrrev_b32 v13, 16, v13
  v_mfma_f32_16x16x32_bf16 v[28:31], a[80:83], a[48:51], v[28:31]
  ds_read_b128 a[20:23], v208 offset:33792
  v_mul_i32_i24 v14, -14, v13
  v_mfma_f32_16x16x32_bf16 v[28:31], a[84:87], a[68:71], v[28:31]
  buffer_load_dwordx4 v203, s[8:11], s61 offen offset:1024 lds
  v_add3_u32 v12, v12, v14, s49
  v_mfma_f32_16x16x32_bf16 v[28:31], a[88:91], a[8:11], v[28:31]
Ha2:
  s_cbranch_execz Ha2_1
  ds_read_b64_tr_b16 a[104:105], v198 offset:21504
  v_mfma_f32_16x16x32_bf16 v[32:35], a[88:91], a[12:15], v[32:35]
  ds_read_b128 a[24:27], v208 offset:34816
  v_mfma_f32_16x16x32_bf16 v[32:35], a[84:87], a[72:75], v[32:35]
  ds_read_b64_tr_b16 a[106:107], v198 offset:27648
  v_mfma_f32_16x16x32_bf16 v[32:35], a[80:83], a[52:55], v[32:35]
  buffer_load_dwordx4 v204, s[8:11], s61 offen offset:2048 lds
  s_mov_b32 s62, 43008
  v_mfma_f32_16x16x32_bf16 v[116:119], a[80:83], a[56:59], v[116:119]
  s_add_u32 m0, s64, 33792
  ds_read_b128 a[28:31], v208 offset:35840
  v_add_u32 v14, -14, v12
  v_mfma_f32_16x16x32_bf16 v[116:119], a[84:87], a[76:79], v[116:119]
  ds_read_b64_tr_b16 a[108:109], v198 offset:22528
  v_min_u32 v12, v12, v14
  v_mfma_f32_16x16x32_bf16 v[116:119], a[88:91], a[16:19], v[116:119]
  s_waitcnt lgkmcnt(6)
  ds_read_b128 a[32:35], v208 offset:36864
  v_mul_u32_u24 v13, 7168, v13
  v_mfma_f32_16x16x32_bf16 v[48:51], a[92:95], a[52:55], v[48:51]
  buffer_load_dwordx4 v205, s[36:39], s62 offen offset:0 sc1 lds
  v_lshl_add_u32 v12, v12, 4, v13
  v_mfma_f32_16x16x32_bf16 v[48:51], a[96:99], a[72:75], v[48:51]
  ds_read_b128 a[36:39], v211 offset:41984
  v_add_u32 v3, s48, v12
  v_mfma_f32_16x16x32_bf16 v[48:51], a[100:103], a[12:15], v[48:51]
  ds_read_b64_tr_b16 a[110:111], v198 offset:28672
  v_mfma_f32_16x16x32_bf16 v[44:47], a[100:103], a[8:11], v[44:47]
  ds_read_b64_tr_b16 a[112:113], v198 offset:23552
  v_mfma_f32_16x16x32_bf16 v[44:47], a[96:99], a[68:71], v[44:47]
  s_sub_u32 s48, s48, 1024
  buffer_load_dwordx4 v205, s[36:39], s62 offen offset:1024 sc1 lds
  s_add_u32 m0, s65, 41984
  v_mfma_f32_16x16x32_bf16 v[44:47], a[92:95], a[48:51], v[44:47]
  ds_read_b64_tr_b16 a[114:115], v198 offset:29696
  v_mfma_f32_16x16x32_bf16 v[40:43], a[92:95], a[44:47], v[40:43]
  v_add_u32 v12, 64, v10
  v_mul_u32_u24 v13, 4682, v12
  v_mfma_f32_16x16x32_bf16 v[40:43], a[96:99], a[64:67], v[40:43]
  ds_read_b64_tr_b16 a[80:81], v199 offset:21504
  v_lshrrev_b32 v13, 16, v13
  v_mfma_f32_16x16x32_bf16 v[40:43], a[100:103], a[4:7], v[40:43]
  buffer_load_dword v206, s[36:39], s62 offen sc1 lds
  v_mul_i32_i24 v14, -14, v13
  v_mfma_f32_16x16x32_bf16 v[36:39], a[100:103], a[0:3], v[36:39]
  ds_read_b64_tr_b16 a[82:83], v199 offset:27648
  v_add3_u32 v12, v12, v14, s49
  v_mfma_f32_16x16x32_bf16 v[36:39], a[96:99], a[60:63], v[36:39]
  v_mfma_f32_16x16x32_bf16 v[36:39], a[92:95], a[40:43], v[36:39]
  s_waitcnt lgkmcnt(2)
  ds_read_b64_tr_b16 a[84:85], v199 offset:22528
  v_mfma_f32_16x16x32_bf16 v[52:55], a[60:63], a[104:107], v[52:55]
  v_mfma_f32_16x16x32_bf16 v[52:55], a[0:3], a[108:111], v[52:55]
  s_mov_b32 s61, 3934208
  s_add_u32 m0, s63, 43008
  ds_read_b64_tr_b16 a[86:87], v199 offset:28672
  v_mfma_f32_16x16x32_bf16 v[52:55], a[20:23], a[112:115], v[52:55]
  s_waitcnt vmcnt(12)
  s_barrier
  v_add_u32 v14, -14, v12
  v_mfma_f32_16x16x32_bf16 v[56:59], a[24:27], a[112:115], v[56:59]
  ds_read_b64_tr_b16 a[88:89], v199 offset:23552
  v_min_u32 v12, v12, v14
  v_mfma_f32_16x16x32_bf16 v[56:59], a[4:7], a[108:111], v[56:59]
  buffer_load_dwordx4 v202, s[8:11], s61 offen offset:0 lds
  v_mul_u32_u24 v13, 7168, v13
  v_mfma_f32_16x16x32_bf16 v[56:59], a[64:67], a[104:107], v[56:59]
  ds_read_b64_tr_b16 a[90:91], v199 offset:29696
  v_lshl_add_u32 v12, v12, 4, v13
  v_mfma_f32_16x16x32_bf16 v[60:63], a[68:71], a[104:107], v[60:63]
  ds_read_b128 a[40:43], v208 offset:55296
  v_add_u32 v4, s48, v12
  v_mfma_f32_16x16x32_bf16 v[60:63], a[8:11], a[108:111], v[60:63]
  ds_read_b64_tr_b16 a[92:93], v198 offset:43008
  v_mfma_f32_16x16x32_bf16 v[60:63], a[28:31], a[112:115], v[60:63]
  ds_read_b128 a[44:47], v208 offset:56320
  v_mfma_f32_16x16x32_bf16 v[64:67], a[32:35], a[112:115], v[64:67]
  buffer_load_dwordx4 v203, s[8:11], s61 offen offset:1024 lds
  v_mfma_f32_16x16x32_bf16 v[64:67], a[12:15], a[108:111], v[64:67]
  s_sub_u32 s48, s48, 1024
  ds_read_b64_tr_b16 a[94:95], v198 offset:49152
  v_mfma_f32_16x16x32_bf16 v[64:67], a[72:75], a[104:107], v[64:67]
  ds_read_b128 a[48:51], v208 offset:57344
  v_mfma_f32_16x16x32_bf16 v[120:123], a[76:79], a[104:107], v[120:123]
  ds_read_b64_tr_b16 a[96:97], v198 offset:44032
  v_add_u32 v12, 128, v10
  v_mfma_f32_16x16x32_bf16 v[120:123], a[16:19], a[108:111], v[120:123]
  ds_read_b128 a[52:55], v208 offset:58368
  v_mul_u32_u24 v13, 4682, v12
  v_mfma_f32_16x16x32_bf16 v[120:123], a[36:39], a[112:115], v[120:123]
  s_waitcnt lgkmcnt(7)
  buffer_load_dwordx4 v204, s[8:11], s61 offen offset:2048 lds
  s_mov_b32 s62, 45056
  v_mfma_f32_16x16x32_bf16 v[80:83], a[72:75], a[80:83], v[80:83]
  s_add_u32 m0, s64, 55296
  ds_read_b64_tr_b16 a[98:99], v198 offset:50176
  v_lshrrev_b32 v13, 16, v13
  v_mfma_f32_16x16x32_bf16 v[80:83], a[12:15], a[84:87], v[80:83]
  ds_read_b128 a[56:59], v211 offset:63488
  v_mul_i32_i24 v14, -14, v13
  v_mfma_f32_16x16x32_bf16 v[80:83], a[32:35], a[88:91], v[80:83]
  ds_read_b64_tr_b16 a[100:101], v198 offset:45056
  v_add3_u32 v12, v12, v14, s49
  v_mfma_f32_16x16x32_bf16 v[76:79], a[28:31], a[88:91], v[76:79]
  buffer_load_dwordx4 v205, s[36:39], s62 offen offset:0 sc1 lds
  v_mfma_f32_16x16x32_bf16 v[76:79], a[8:11], a[84:87], v[76:79]
  ds_read_b64_tr_b16 a[102:103], v198 offset:51200
  v_mfma_f32_16x16x32_bf16 v[76:79], a[68:71], a[80:83], v[76:79]
  ds_read_b64_tr_b16 a[104:105], v199 offset:43008
  v_add_u32 v14, -14, v12
  v_mfma_f32_16x16x32_bf16 v[72:75], a[64:67], a[80:83], v[72:75]
  ds_read_b64_tr_b16 a[106:107], v199 offset:49152
  v_min_u32 v12, v12, v14
  v_mfma_f32_16x16x32_bf16 v[72:75], a[4:7], a[84:87], v[72:75]
  buffer_load_dwordx4 v205, s[36:39], s62 offen offset:1024 sc1 lds
  s_add_u32 m0, s65, 63488
  v_mfma_f32_16x16x32_bf16 v[72:75], a[24:27], a[88:91], v[72:75]
  ds_read_b64_tr_b16 a[108:109], v199 offset:44032
  v_mul_u32_u24 v13, 7168, v13
  v_mfma_f32_16x16x32_bf16 v[68:71], a[20:23], a[88:91], v[68:71]
  v_lshl_add_u32 v12, v12, 4, v13
  v_add_u32 v5, s48, v12
  v_mfma_f32_16x16x32_bf16 v[68:71], a[0:3], a[84:87], v[68:71]
  ds_read_b64_tr_b16 a[110:111], v199 offset:50176
  v_mfma_f32_16x16x32_bf16 v[68:71], a[60:63], a[80:83], v[68:71]
  s_waitcnt lgkmcnt(4)
  buffer_load_dword v206, s[36:39], s62 offen sc1 lds
  s_mov_b32 s61, 4132864
  v_mfma_f32_16x16x32_bf16 v[84:87], a[92:95], a[0:3], v[84:87]
  s_add_u32 m0, s63, 64512
  ds_read_b64_tr_b16 a[112:113], v199 offset:45056
  v_mfma_f32_16x16x32_bf16 v[84:87], a[96:99], a[20:23], v[84:87]
  s_sub_u32 s48, s48, 1024
  v_mfma_f32_16x16x32_bf16 v[84:87], a[100:103], a[40:43], v[84:87]
  ds_read_b64_tr_b16 a[114:115], v199 offset:51200
  v_add_u32 v12, 192, v10
  v_mfma_f32_16x16x32_bf16 v[88:91], a[100:103], a[44:47], v[88:91]
  buffer_load_dwordx4 v202, s[8:11], s61 offen offset:0 lds
  v_mul_u32_u24 v13, 4682, v12
  v_mfma_f32_16x16x32_bf16 v[88:91], a[96:99], a[24:27], v[88:91]
  ds_read_b128 a[60:63], v209 offset:12288
  v_lshrrev_b32 v13, 16, v13
  v_mfma_f32_16x16x32_bf16 v[88:91], a[92:95], a[4:7], v[88:91]
  ds_read_b64_tr_b16 a[80:81], v200 offset:0
  v_mul_i32_i24 v14, -14, v13
  v_mfma_f32_16x16x32_bf16 v[92:95], a[92:95], a[8:11], v[92:95]
  ds_read_b128 a[64:67], v209 offset:13312
  v_add3_u32 v12, v12, v14, s49
  v_mfma_f32_16x16x32_bf16 v[92:95], a[96:99], a[28:31], v[92:95]
  buffer_load_dwordx4 v203, s[8:11], s61 offen offset:1024 lds
  v_mfma_f32_16x16x32_bf16 v[92:95], a[100:103], a[48:51], v[92:95]
  ds_read_b64_tr_b16 a[82:83], v200 offset:6144
  v_mfma_f32_16x16x32_bf16 v[96:99], a[100:103], a[52:55], v[96:99]
  ds_read_b128 a[68:71], v209 offset:14336
  v_mfma_f32_16x16x32_bf16 v[96:99], a[96:99], a[32:35], v[96:99]
  ds_read_b64_tr_b16 a[84:85], v200 offset:1024
  v_add_u32 v14, -14, v12
  v_mfma_f32_16x16x32_bf16 v[96:99], a[92:95], a[12:15], v[96:99]
  s_waitcnt lgkmcnt(6)
  ds_read_b128 a[72:75], v209 offset:15360
  v_min_u32 v12, v12, v14
  v_mfma_f32_16x16x32_bf16 v[112:115], a[104:107], a[12:15], v[112:115]
  buffer_load_dwordx4 v204, s[8:11], s61 offen offset:2048 lds
  s_mov_b32 s62, 47104
  v_mfma_f32_16x16x32_bf16 v[112:115], a[108:111], a[32:35], v[112:115]
  s_add_u32 m0, s64, 76800
  ds_read_b128 a[76:79], v212 offset:20480
  v_mul_u32_u24 v13, 7168, v13
  v_mfma_f32_16x16x32_bf16 v[112:115], a[112:115], a[52:55], v[112:115]
  ds_read_b64_tr_b16 a[86:87], v200 offset:7168
  v_lshl_add_u32 v12, v12, 4, v13
  v_mfma_f32_16x16x32_bf16 v[108:111], a[112:115], a[48:51], v[108:111]
  ds_read_b64_tr_b16 a[88:89], v200 offset:2048
  v_add_u32 v6, s48, v12
  v_mfma_f32_16x16x32_bf16 v[108:111], a[108:111], a[28:31], v[108:111]
  buffer_load_dwordx4 v205, s[36:39], s62 offen offset:0 sc1 lds
  v_mfma_f32_16x16x32_bf16 v[108:111], a[104:107], a[8:11], v[108:111]
  ds_read_b64_tr_b16 a[90:91], v200 offset:8192
  v_mfma_f32_16x16x32_bf16 v[104:107], a[104:107], a[4:7], v[104:107]
  s_sub_u32 s48, s48, -3072
  v_mfma_f32_16x16x32_bf16 v[104:107], a[108:111], a[24:27], v[104:107]
  ds_read_b64_tr_b16 a[92:93], v201 offset:0
  v_mfma_f32_16x16x32_bf16 v[104:107], a[112:115], a[44:47], v[104:107]
  buffer_load_dwordx4 v205, s[36:39], s62 offen offset:1024 sc1 lds
  s_add_u32 m0, s65, 84992
  v_mfma_f32_16x16x32_bf16 v[100:103], a[112:115], a[40:43], v[100:103]
  ds_read_b64_tr_b16 a[94:95], v201 offset:6144
  v_add_u32 v12, 256, v10
  v_mfma_f32_16x16x32_bf16 v[100:103], a[108:111], a[20:23], v[100:103]
  v_mul_u32_u24 v13, 4682, v12
  v_lshrrev_b32 v13, 16, v13
  v_mfma_f32_16x16x32_bf16 v[100:103], a[104:107], a[0:3], v[100:103]
  s_waitcnt lgkmcnt(2)
  ds_read_b64_tr_b16 a[96:97], v201 offset:1024
  v_mul_i32_i24 v14, -14, v13
  v_mfma_f32_16x16x32_bf16 v[20:23], a[80:83], a[20:23], v[20:23]
  buffer_load_dword v206, s[36:39], s62 offen sc1 lds
  v_add3_u32 v12, v12, v14, s49
  v_mfma_f32_16x16x32_bf16 v[20:23], a[84:87], a[40:43], v[20:23]
  s_mov_b32 s61, 4325376
  s_add_u32 m0, s63, 86016
  ds_read_b64_tr_b16 a[98:99], v201 offset:7168
  v_mfma_f32_16x16x32_bf16 v[20:23], a[88:91], a[60:63], v[20:23]
  s_waitcnt vmcnt(12)
  s_barrier
  v_mfma_f32_16x16x32_bf16 v[24:27], a[88:91], a[64:67], v[24:27]
  ds_read_b64_tr_b16 a[100:101], v201 offset:2048
  v_mfma_f32_16x16x32_bf16 v[24:27], a[84:87], a[44:47], v[24:27]
  buffer_load_dwordx4 v202, s[8:11], s61 offen offset:0 lds
  v_add_u32 v14, -14, v12
  v_mfma_f32_16x16x32_bf16 v[24:27], a[80:83], a[24:27], v[24:27]
  ds_read_b64_tr_b16 a[102:103], v201 offset:8192
  v_min_u32 v12, v12, v14
  v_mfma_f32_16x16x32_bf16 v[28:31], a[80:83], a[28:31], v[28:31]
  ds_read_b128 a[0:3], v207 offset:12288
  v_mul_u32_u24 v13, 7168, v13
  v_mfma_f32_16x16x32_bf16 v[28:31], a[84:87], a[48:51], v[28:31]
  ds_read_b64_tr_b16 a[104:105], v196 offset:0
  v_lshl_add_u32 v12, v12, 4, v13
  v_mfma_f32_16x16x32_bf16 v[28:31], a[88:91], a[68:71], v[28:31]
  ds_read_b128 a[4:7], v207 offset:13312
  v_add_u32 v7, s48, v12
  v_mfma_f32_16x16x32_bf16 v[32:35], a[88:91], a[72:75], v[32:35]
  buffer_load_dwordx4 v203, s[8:11], s61 offen offset:1024 lds
  v_mfma_f32_16x16x32_bf16 v[32:35], a[84:87], a[52:55], v[32:35]
  ds_read_b64_tr_b16 a[106:107], v196 offset:6144
  v_mfma_f32_16x16x32_bf16 v[32:35], a[80:83], a[32:35], v[32:35]
  ds_read_b128 a[8:11], v207 offset:14336
  v_mfma_f32_16x16x32_bf16 v[116:119], a[80:83], a[36:39], v[116:119]
  s_sub_u32 s48, s48, 1024
  ds_read_b64_tr_b16 a[108:109], v196 offset:1024
  v_mfma_f32_16x16x32_bf16 v[116:119], a[84:87], a[56:59], v[116:119]
  ds_read_b128 a[12:15], v207 offset:15360
  v_add_u32 v12, 320, v10
  v_mfma_f32_16x16x32_bf16 v[116:119], a[88:91], a[76:79], v[116:119]
  s_waitcnt lgkmcnt(7)
  buffer_load_dwordx4 v204, s[8:11], s61 offen offset:2048 lds
  s_mov_b32 s62, 49152
  v_mfma_f32_16x16x32_bf16 v[48:51], a[92:95], a[32:35], v[48:51]
  s_add_u32 m0, s64, 98304
  ds_read_b128 a[16:19], v210 offset:20480
  v_mul_u32_u24 v13, 4682, v12
  v_mfma_f32_16x16x32_bf16 v[48:51], a[96:99], a[52:55], v[48:51]
  ds_read_b64_tr_b16 a[110:111], v196 offset:7168
  v_lshrrev_b32 v13, 16, v13
  v_mfma_f32_16x16x32_bf16 v[48:51], a[100:103], a[72:75], v[48:51]
  ds_read_b64_tr_b16 a[112:113], v196 offset:2048
  v_mul_i32_i24 v14, -14, v13
  v_mfma_f32_16x16x32_bf16 v[44:47], a[100:103], a[68:71], v[44:47]
  buffer_load_dwordx4 v205, s[36:39], s62 offen offset:0 sc1 lds
  v_add3_u32 v12, v12, v14, s49
  v_mfma_f32_16x16x32_bf16 v[44:47], a[96:99], a[48:51], v[44:47]
  ds_read_b64_tr_b16 a[114:115], v196 offset:8192
  v_mfma_f32_16x16x32_bf16 v[44:47], a[92:95], a[28:31], v[44:47]
  v_mfma_f32_16x16x32_bf16 v[40:43], a[92:95], a[24:27], v[40:43]
  v_add_u32 v14, -14, v12
  v_min_u32 v12, v12, v14
  v_mfma_f32_16x16x32_bf16 v[40:43], a[96:99], a[44:47], v[40:43]
  buffer_load_dwordx4 v205, s[36:39], s62 offen offset:1024 sc1 lds
  s_add_u32 m0, s65, 106496
  v_mfma_f32_16x16x32_bf16 v[40:43], a[100:103], a[64:67], v[40:43]
  ds_read_b64_tr_b16 a[80:81], v197 offset:0
  v_mul_u32_u24 v13, 7168, v13
  v_mfma_f32_16x16x32_bf16 v[36:39], a[100:103], a[60:63], v[36:39]
  ds_read_b64_tr_b16 a[82:83], v197 offset:6144
  v_lshl_add_u32 v12, v12, 4, v13
  v_mfma_f32_16x16x32_bf16 v[36:39], a[96:99], a[40:43], v[36:39]
  v_add_u32 v8, s48, v12
  v_mfma_f32_16x16x32_bf16 v[36:39], a[92:95], a[20:23], v[36:39]
  s_waitcnt lgkmcnt(2)
  buffer_load_dword v206, s[36:39], s62 offen sc1 lds
  s_mov_b32 s61, 4524032
  v_mfma_f32_16x16x32_bf16 v[52:55], a[40:43], a[104:107], v[52:55]
  s_add_u32 m0, s63, 107520
  ds_read_b64_tr_b16 a[84:85], v197 offset:1024
  v_mfma_f32_16x16x32_bf16 v[52:55], a[60:63], a[108:111], v[52:55]
  ds_read_b64_tr_b16 a[86:87], v197 offset:7168
  v_mfma_f32_16x16x32_bf16 v[52:55], a[0:3], a[112:115], v[52:55]
  s_sub_u32 s48, s48, 1024
  v_mfma_f32_16x16x32_bf16 v[56:59], a[4:7], a[112:115], v[56:59]
  buffer_load_dwordx4 v202, s[8:11], s61 offen offset:0 lds
  v_mfma_f32_16x16x32_bf16 v[56:59], a[64:67], a[108:111], v[56:59]
  ds_read_b64_tr_b16 a[88:89], v197 offset:2048
  v_add_u32 v12, 384, v10
  v_mfma_f32_16x16x32_bf16 v[56:59], a[44:47], a[104:107], v[56:59]
  ds_read_b64_tr_b16 a[90:91], v197 offset:8192
  v_mul_u32_u24 v13, 4682, v12
  v_mfma_f32_16x16x32_bf16 v[60:63], a[48:51], a[104:107], v[60:63]
  ds_read_b128 a[20:23], v207 offset:33792
  v_lshrrev_b32 v13, 16, v13
  v_mfma_f32_16x16x32_bf16 v[60:63], a[68:71], a[108:111], v[60:63]
  buffer_load_dwordx4 v203, s[8:11], s61 offen offset:1024 lds
  v_mul_i32_i24 v14, -14, v13
  v_mfma_f32_16x16x32_bf16 v[60:63], a[8:11], a[112:115], v[60:63]
  ds_read_b64_tr_b16 a[92:93], v196 offset:21504
  v_add3_u32 v12, v12, v14, s49
  v_mfma_f32_16x16x32_bf16 v[64:67], a[12:15], a[112:115], v[64:67]
  ds_read_b128 a[24:27], v207 offset:34816
  v_mfma_f32_16x16x32_bf16 v[64:67], a[72:75], a[108:111], v[64:67]
  ds_read_b64_tr_b16 a[94:95], v196 offset:27648
  v_mfma_f32_16x16x32_bf16 v[64:67], a[52:55], a[104:107], v[64:67]
  buffer_load_dwordx4 v204, s[8:11], s61 offen offset:2048 lds
  s_mov_b32 s62, 51200
  v_mfma_f32_16x16x32_bf16 v[120:123], a[56:59], a[104:107], v[120:123]
  s_add_u32 m0, s64, 119808
  ds_read_b128 a[28:31], v207 offset:35840
  v_add_u32 v14, -14, v12
  v_mfma_f32_16x16x32_bf16 v[120:123], a[76:79], a[108:111], v[120:123]
  ds_read_b64_tr_b16 a[96:97], v196 offset:22528
  v_min_u32 v12, v12, v14
  v_mfma_f32_16x16x32_bf16 v[120:123], a[16:19], a[112:115], v[120:123]
  s_waitcnt lgkmcnt(6)
  ds_read_b128 a[32:35], v207 offset:36864
  v_mul_u32_u24 v13, 7168, v13
  v_mfma_f32_16x16x32_bf16 v[80:83], a[52:55], a[80:83], v[80:83]
  buffer_load_dwordx4 v205, s[36:39], s62 offen offset:0 sc1 lds
  v_lshl_add_u32 v12, v12, 4, v13
  v_mfma_f32_16x16x32_bf16 v[80:83], a[72:75], a[84:87], v[80:83]
  ds_read_b64_tr_b16 a[98:99], v196 offset:28672
  v_add_u32 v9, s48, v12
  v_mfma_f32_16x16x32_bf16 v[80:83], a[12:15], a[88:91], v[80:83]
  ds_read_b128 a[36:39], v210 offset:41984
  v_mfma_f32_16x16x32_bf16 v[76:79], a[8:11], a[88:91], v[76:79]
  ds_read_b64_tr_b16 a[100:101], v196 offset:23552
  v_mfma_f32_16x16x32_bf16 v[76:79], a[68:71], a[84:87], v[76:79]
  buffer_load_dwordx4 v205, s[36:39], s62 offen offset:1024 sc1 lds
  s_add_u32 m0, s65, 128000
  v_mfma_f32_16x16x32_bf16 v[76:79], a[48:51], a[80:83], v[76:79]
  s_sub_u32 s48, s48, 1024
  ds_read_b64_tr_b16 a[102:103], v196 offset:29696
  v_mfma_f32_16x16x32_bf16 v[72:75], a[44:47], a[80:83], v[72:75]
  ds_read_b64_tr_b16 a[104:105], v197 offset:21504
  v_mfma_f32_16x16x32_bf16 v[72:75], a[64:67], a[84:87], v[72:75]
  s_and_b32 s48, s58, 1
  ds_read_b64_tr_b16 a[106:107], v197 offset:27648
  s_lshl_b32 s48, s48, 7
  v_mfma_f32_16x16x32_bf16 v[72:75], a[4:7], a[88:91], v[72:75]
  s_and_b32 s49, s58, 6
  buffer_load_dword v206, s[36:39], s62 offen sc1 lds
  s_add_u32 s48, s48, s49
  v_mfma_f32_16x16x32_bf16 v[68:71], a[0:3], a[88:91], v[68:71]
  ds_read_b64_tr_b16 a[108:109], v197 offset:22528
  v_mfma_f32_16x16x32_bf16 v[68:71], a[60:63], a[84:87], v[68:71]
  s_mov_b32 s61, 4722688
  s_add_u32 m0, s63, 129024
  ds_read_b64_tr_b16 a[110:111], v197 offset:28672
  v_mfma_f32_16x16x32_bf16 v[68:71], a[40:43], a[80:83], v[68:71]
  s_waitcnt vmcnt(12) lgkmcnt(4)
  s_barrier
  v_mfma_f32_16x16x32_bf16 v[84:87], a[92:95], a[60:63], v[84:87]
  ds_read_b64_tr_b16 a[112:113], v197 offset:23552
  v_mfma_f32_16x16x32_bf16 v[84:87], a[96:99], a[0:3], v[84:87]
  buffer_load_dwordx4 v202, s[8:11], s61 offen offset:0 lds
  v_bfe_u32 v12, v10, 1, 4
  v_mfma_f32_16x16x32_bf16 v[84:87], a[100:103], a[20:23], v[84:87]
  ds_read_b64_tr_b16 a[114:115], v197 offset:29696
  v_and_b32 v13, 1, v10
  v_mfma_f32_16x16x32_bf16 v[88:91], a[100:103], a[24:27], v[88:91]
  ds_read_b128 a[40:43], v207 offset:55296
  v_lshl_add_u32 v12, v12, 3, v13
  v_mfma_f32_16x16x32_bf16 v[88:91], a[96:99], a[4:7], v[88:91]
  ds_read_b64_tr_b16 a[80:81], v196 offset:43008
  v_add_lshl_u32 v251, v12, s48, 7
  v_mfma_f32_16x16x32_bf16 v[88:91], a[92:95], a[64:67], v[88:91]
  ds_read_b128 a[44:47], v207 offset:56320
  v_mfma_f32_16x16x32_bf16 v[92:95], a[92:95], a[68:71], v[92:95]
  buffer_load_dwordx4 v203, s[8:11], s61 offen offset:1024 lds
  v_mfma_f32_16x16x32_bf16 v[92:95], a[96:99], a[8:11], v[92:95]
  ds_read_b64_tr_b16 a[82:83], v196 offset:49152
  v_add_u32 v251, 98304, v251
  v_mfma_f32_16x16x32_bf16 v[92:95], a[100:103], a[28:31], v[92:95]
  ds_read_b128 a[48:51], v207 offset:57344
  v_and_b32 v12, 7, v10
  v_mfma_f32_16x16x32_bf16 v[96:99], a[100:103], a[32:35], v[96:99]
  ds_read_b64_tr_b16 a[84:85], v196 offset:44032
  v_lshlrev_b32 v12, 5, v12
  v_mfma_f32_16x16x32_bf16 v[96:99], a[96:99], a[12:15], v[96:99]
  s_and_b32 s48, s2, 31
  ds_read_b128 a[52:55], v207 offset:58368
  v_add_lshl_u32 v12, v12, s48, 7
  v_mfma_f32_16x16x32_bf16 v[96:99], a[92:95], a[72:75], v[96:99]
  s_waitcnt lgkmcnt(7)
  buffer_load_dwordx4 v204, s[8:11], s61 offen offset:2048 lds
  s_mov_b32 s62, 53248
  v_mfma_f32_16x16x32_bf16 v[112:115], a[104:107], a[72:75], v[112:115]
  s_add_u32 m0, s64, 141312
  ds_read_b128 a[56:59], v210 offset:63488
  v_cmp_gt_u32 vcc, 32, v10
  v_mfma_f32_16x16x32_bf16 v[112:115], a[108:111], a[12:15], v[112:115]
  s_nop 1
  ds_read_b64_tr_b16 a[86:87], v196 offset:50176
  v_cndmask_b32 v251, v12, v251, vcc
  v_mfma_f32_16x16x32_bf16 v[112:115], a[112:115], a[32:35], v[112:115]
  ds_read_b64_tr_b16 a[88:89], v196 offset:45056
  v_mfma_f32_16x16x32_bf16 v[108:111], a[112:115], a[28:31], v[108:111]
  buffer_load_dwordx4 v205, s[36:39], s62 offen offset:0 sc1 lds
  v_mfma_f32_16x16x32_bf16 v[108:111], a[108:111], a[8:11], v[108:111]
  ds_read_b64_tr_b16 a[90:91], v196 offset:51200
  v_mfma_f32_16x16x32_bf16 v[108:111], a[104:107], a[68:71], v[108:111]
  v_mfma_f32_16x16x32_bf16 v[104:107], a[104:107], a[64:67], v[104:107]
  v_mfma_f32_16x16x32_bf16 v[104:107], a[108:111], a[4:7], v[104:107]
  buffer_load_dwordx4 v205, s[36:39], s62 offen offset:1024 sc1 lds
  s_add_u32 m0, s65, 149504
  v_mfma_f32_16x16x32_bf16 v[104:107], a[112:115], a[24:27], v[104:107]
  ds_read_b64_tr_b16 a[92:93], v197 offset:43008
  v_mfma_f32_16x16x32_bf16 v[100:103], a[112:115], a[20:23], v[100:103]
  ds_read_b64_tr_b16 a[94:95], v197 offset:49152
  v_mfma_f32_16x16x32_bf16 v[100:103], a[108:111], a[0:3], v[100:103]
  v_mfma_f32_16x16x32_bf16 v[100:103], a[104:107], a[60:63], v[100:103]
  s_waitcnt lgkmcnt(2)
  buffer_load_dword v206, s[36:39], s62 offen sc1 lds
  s_mov_b32 s61, 4915200
  v_mfma_f32_16x16x32_bf16 v[20:23], a[80:83], a[0:3], v[20:23]
  s_add_u32 m0, s63, 0
  ds_read_b64_tr_b16 a[96:97], v197 offset:44032
  v_mfma_f32_16x16x32_bf16 v[20:23], a[84:87], a[20:23], v[20:23]
  ds_read_b64_tr_b16 a[98:99], v197 offset:50176
  v_mfma_f32_16x16x32_bf16 v[20:23], a[88:91], a[40:43], v[20:23]
  v_mfma_f32_16x16x32_bf16 v[24:27], a[88:91], a[44:47], v[24:27]
  buffer_load_dwordx4 v202, s[8:11], s61 offen offset:0 lds
  v_mfma_f32_16x16x32_bf16 v[24:27], a[84:87], a[24:27], v[24:27]
  ds_read_b64_tr_b16 a[100:101], v197 offset:45056
  v_mfma_f32_16x16x32_bf16 v[24:27], a[80:83], a[4:7], v[24:27]
  ds_read_b64_tr_b16 a[102:103], v197 offset:51200
  v_mfma_f32_16x16x32_bf16 v[28:31], a[80:83], a[8:11], v[28:31]
  ds_read_b128 a[60:63], v208 offset:12288
  v_mfma_f32_16x16x32_bf16 v[28:31], a[84:87], a[28:31], v[28:31]
  buffer_load_dwordx4 v203, s[8:11], s61 offen offset:1024 lds
  v_mfma_f32_16x16x32_bf16 v[28:31], a[88:91], a[48:51], v[28:31]
  ds_read_b64_tr_b16 a[104:105], v198 offset:0
  v_mfma_f32_16x16x32_bf16 v[32:35], a[88:91], a[52:55], v[32:35]
  ds_read_b128 a[64:67], v208 offset:13312
  v_mfma_f32_16x16x32_bf16 v[32:35], a[84:87], a[32:35], v[32:35]
  ds_read_b64_tr_b16 a[106:107], v198 offset:6144
  v_mfma_f32_16x16x32_bf16 v[32:35], a[80:83], a[12:15], v[32:35]
  buffer_load_dwordx4 v204, s[8:11], s61 offen offset:2048 lds
  s_mov_b32 s62, 55296
  v_mfma_f32_16x16x32_bf16 v[116:119], a[80:83], a[16:19], v[116:119]
  s_add_u32 m0, s64, 12288
  ds_read_b128 a[68:71], v208 offset:14336
  v_mfma_f32_16x16x32_bf16 v[116:119], a[84:87], a[36:39], v[116:119]
  ds_read_b64_tr_b16 a[108:109], v198 offset:1024
  v_mfma_f32_16x16x32_bf16 v[116:119], a[88:91], a[56:59], v[116:119]
  s_waitcnt lgkmcnt(6)
  ds_read_b128 a[72:75], v208 offset:15360
  v_mfma_f32_16x16x32_bf16 v[48:51], a[92:95], a[12:15], v[48:51]
  buffer_load_dwordx4 v205, s[36:39], s62 offen offset:0 sc1 lds
  v_mfma_f32_16x16x32_bf16 v[48:51], a[96:99], a[32:35], v[48:51]
  ds_read_b128 a[76:79], v211 offset:20480
  v_mfma_f32_16x16x32_bf16 v[48:51], a[100:103], a[52:55], v[48:51]
  ds_read_b64_tr_b16 a[110:111], v198 offset:7168
  v_mfma_f32_16x16x32_bf16 v[44:47], a[100:103], a[48:51], v[44:47]
  ds_read_b64_tr_b16 a[112:113], v198 offset:2048
  v_mfma_f32_16x16x32_bf16 v[44:47], a[96:99], a[28:31], v[44:47]
  buffer_load_dwordx4 v205, s[36:39], s62 offen offset:1024 sc1 lds
  s_add_u32 m0, s65, 20480
  v_mfma_f32_16x16x32_bf16 v[44:47], a[92:95], a[8:11], v[44:47]
  ds_read_b64_tr_b16 a[114:115], v198 offset:8192
  v_mfma_f32_16x16x32_bf16 v[40:43], a[92:95], a[4:7], v[40:43]
  v_mfma_f32_16x16x32_bf16 v[40:43], a[96:99], a[24:27], v[40:43]
  ds_read_b64_tr_b16 a[80:81], v199 offset:0
  v_mfma_f32_16x16x32_bf16 v[40:43], a[100:103], a[44:47], v[40:43]
  buffer_load_dword v206, s[36:39], s62 offen sc1 lds
  v_mfma_f32_16x16x32_bf16 v[36:39], a[100:103], a[40:43], v[36:39]
  ds_read_b64_tr_b16 a[82:83], v199 offset:6144
  v_mfma_f32_16x16x32_bf16 v[36:39], a[96:99], a[20:23], v[36:39]
  v_mfma_f32_16x16x32_bf16 v[36:39], a[92:95], a[0:3], v[36:39]
  s_waitcnt lgkmcnt(2)
  ds_read_b64_tr_b16 a[84:85], v199 offset:1024
  v_mfma_f32_16x16x32_bf16 v[52:55], a[20:23], a[104:107], v[52:55]
  v_mfma_f32_16x16x32_bf16 v[52:55], a[40:43], a[108:111], v[52:55]
  s_mov_b32 s61, 5113856
  s_add_u32 m0, s63, 21504
  ds_read_b64_tr_b16 a[86:87], v199 offset:7168
  v_mfma_f32_16x16x32_bf16 v[52:55], a[60:63], a[112:115], v[52:55]
  s_waitcnt vmcnt(12)
  s_barrier
  v_mfma_f32_16x16x32_bf16 v[56:59], a[64:67], a[112:115], v[56:59]
  ds_read_b64_tr_b16 a[88:89], v199 offset:2048
  v_mfma_f32_16x16x32_bf16 v[56:59], a[44:47], a[108:111], v[56:59]
  buffer_load_dwordx4 v202, s[8:11], s61 offen offset:0 lds
  v_mfma_f32_16x16x32_bf16 v[56:59], a[24:27], a[104:107], v[56:59]
  ds_read_b64_tr_b16 a[90:91], v199 offset:8192
  v_mfma_f32_16x16x32_bf16 v[60:63], a[28:31], a[104:107], v[60:63]
  ds_read_b128 a[0:3], v208 offset:33792
  v_mfma_f32_16x16x32_bf16 v[60:63], a[48:51], a[108:111], v[60:63]
  ds_read_b64_tr_b16 a[92:93], v198 offset:21504
  v_mfma_f32_16x16x32_bf16 v[60:63], a[68:71], a[112:115], v[60:63]
  ds_read_b128 a[4:7], v208 offset:34816
  v_mfma_f32_16x16x32_bf16 v[64:67], a[72:75], a[112:115], v[64:67]
  buffer_load_dwordx4 v203, s[8:11], s61 offen offset:1024 lds
  v_mfma_f32_16x16x32_bf16 v[64:67], a[52:55], a[108:111], v[64:67]
  ds_read_b64_tr_b16 a[94:95], v198 offset:27648
  v_mfma_f32_16x16x32_bf16 v[64:67], a[32:35], a[104:107], v[64:67]
  ds_read_b128 a[8:11], v208 offset:35840
  v_mfma_f32_16x16x32_bf16 v[120:123], a[36:39], a[104:107], v[120:123]
  ds_read_b64_tr_b16 a[96:97], v198 offset:22528
  v_mfma_f32_16x16x32_bf16 v[120:123], a[56:59], a[108:111], v[120:123]
  ds_read_b128 a[12:15], v208 offset:36864
  v_mfma_f32_16x16x32_bf16 v[120:123], a[76:79], a[112:115], v[120:123]
  s_waitcnt lgkmcnt(7)
  buffer_load_dwordx4 v204, s[8:11], s61 offen offset:2048 lds
  s_mov_b32 s62, 57344
  v_mfma_f32_16x16x32_bf16 v[80:83], a[32:35], a[80:83], v[80:83]
  s_add_u32 m0, s64, 33792
  ds_read_b64_tr_b16 a[98:99], v198 offset:28672
  v_mfma_f32_16x16x32_bf16 v[80:83], a[52:55], a[84:87], v[80:83]
  ds_read_b128 a[16:19], v211 offset:41984
  v_mfma_f32_16x16x32_bf16 v[80:83], a[72:75], a[88:91], v[80:83]
  ds_read_b64_tr_b16 a[100:101], v198 offset:23552
  v_mfma_f32_16x16x32_bf16 v[76:79], a[68:71], a[88:91], v[76:79]
  buffer_load_dwordx4 v205, s[36:39], s62 offen offset:0 sc1 lds
  v_mfma_f32_16x16x32_bf16 v[76:79], a[48:51], a[84:87], v[76:79]
  ds_read_b64_tr_b16 a[102:103], v198 offset:29696
  v_mfma_f32_16x16x32_bf16 v[76:79], a[28:31], a[80:83], v[76:79]
  ds_read_b64_tr_b16 a[104:105], v199 offset:21504
  v_mfma_f32_16x16x32_bf16 v[72:75], a[24:27], a[80:83], v[72:75]
  ds_read_b64_tr_b16 a[106:107], v199 offset:27648
  v_mfma_f32_16x16x32_bf16 v[72:75], a[44:47], a[84:87], v[72:75]
  buffer_load_dwordx4 v205, s[36:39], s62 offen offset:1024 sc1 lds
  s_add_u32 m0, s65, 41984
  v_mfma_f32_16x16x32_bf16 v[72:75], a[64:67], a[88:91], v[72:75]
  ds_read_b64_tr_b16 a[108:109], v199 offset:22528
  v_mfma_f32_16x16x32_bf16 v[68:71], a[60:63], a[88:91], v[68:71]
  s_lshr_b32 s68, s2, 3
  s_lshl2_add_u32 s68, s68, s44
  s_bfe_u32 s69, s2, 0x20001
  v_mfma_f32_16x16x32_bf16 v[68:71], a[40:43], a[84:87], v[68:71]
  s_lshl_b32 s69, s69, 7
  s_add_u32 s69, s69, s68
  s_lshl_b32 s69, s69, 13
  v_mfma_f32_16x16x32_bf16 v[68:71], a[20:23], a[80:83], v[68:71]
  s_waitcnt lgkmcnt(3)
  s_lshl_b32 s68, s68, 14
  s_bitcmp1_b32 s2, 0
  v_mfma_f32_16x16x32_bf16 v[84:87], a[92:95], a[40:43], v[84:87]
  s_cselect_b32 s68, s68, 1073741824
  s_cselect_b32 s69, s69, 1073741824
  buffer_load_dword v206, s[36:39], s62 offen sc1 lds
  v_mfma_f32_16x16x32_bf16 v[84:87], a[96:99], a[60:63], v[84:87]
  s_mov_b32 s61, 5312512
  s_add_u32 m0, s63, 43008
  ds_read_b64_tr_b16 a[110:111], v199 offset:28672
  v_mfma_f32_16x16x32_bf16 v[84:87], a[100:103], a[0:3], v[84:87]
  ds_read_b64_tr_b16 a[112:113], v199 offset:23552
  v_and_b32 v214, 15, v10
  v_mfma_f32_16x16x32_bf16 v[88:91], a[100:103], a[4:7], v[88:91]
  ds_read_b64_tr_b16 a[114:115], v199 offset:29696
  v_lshlrev_b32 v214, 10, v214
  v_mfma_f32_16x16x32_bf16 v[88:91], a[96:99], a[64:67], v[88:91]
  buffer_load_dwordx4 v202, s[8:11], s61 offen offset:0 lds
  v_mfma_f32_16x16x32_bf16 v[88:91], a[92:95], a[44:47], v[88:91]
Ha0_1:
  s_cbranch_execz Ha0_2
  ds_read_b128 a[20:23], v208 offset:55296
  v_mfma_f32_16x16x32_bf16 v[92:95], a[92:95], a[48:51], v[92:95]
  ds_read_b64_tr_b16 a[80:81], v198 offset:43008
  v_mfma_f32_16x16x32_bf16 v[92:95], a[96:99], a[68:71], v[92:95]
  ds_read_b128 a[24:27], v208 offset:56320
  v_mfma_f32_16x16x32_bf16 v[92:95], a[100:103], a[8:11], v[92:95]
  buffer_load_dwordx4 v203, s[8:11], s61 offen offset:1024 lds
  v_mfma_f32_16x16x32_bf16 v[96:99], a[100:103], a[12:15], v[96:99]
  ds_read_b64_tr_b16 a[82:83], v198 offset:49152
  v_mfma_f32_16x16x32_bf16 v[96:99], a[96:99], a[72:75], v[96:99]
  ds_read_b128 a[28:31], v208 offset:57344
  v_mfma_f32_16x16x32_bf16 v[96:99], a[92:95], a[52:55], v[96:99]
  s_waitcnt lgkmcnt(5)
  ds_read_b64_tr_b16 a[84:85], v198 offset:44032
  v_mfma_f32_16x16x32_bf16 v[112:115], a[104:107], a[52:55], v[112:115]
  ds_read_b128 a[32:35], v208 offset:58368
  v_mfma_f32_16x16x32_bf16 v[112:115], a[108:111], a[72:75], v[112:115]
  buffer_load_dwordx4 v204, s[8:11], s61 offen offset:2048 lds
  s_mov_b32 s62, 59392
  v_mfma_f32_16x16x32_bf16 v[112:115], a[112:115], a[12:15], v[112:115]
  s_add_u32 m0, s64, 55296
  ds_read_b128 a[36:39], v211 offset:63488
  v_mfma_f32_16x16x32_bf16 v[108:111], a[112:115], a[8:11], v[108:111]
  ds_read_b64_tr_b16 a[86:87], v198 offset:50176
  v_mfma_f32_16x16x32_bf16 v[108:111], a[108:111], a[68:71], v[108:111]
  ds_read_b64_tr_b16 a[88:89], v198 offset:45056
  v_mfma_f32_16x16x32_bf16 v[108:111], a[104:107], a[48:51], v[108:111]
  buffer_load_dwordx4 v205, s[36:39], s62 offen offset:0 sc1 lds
  v_mfma_f32_16x16x32_bf16 v[104:107], a[104:107], a[44:47], v[104:107]
  ds_read_b64_tr_b16 a[90:91], v198 offset:51200
  v_mfma_f32_16x16x32_bf16 v[104:107], a[108:111], a[64:67], v[104:107]
  ds_read_b64_tr_b16 a[92:93], v199 offset:43008
  v_mfma_f32_16x16x32_bf16 v[104:107], a[112:115], a[4:7], v[104:107]
  v_mfma_f32_16x16x32_bf16 v[100:103], a[112:115], a[0:3], v[100:103]
  buffer_load_dwordx4 v205, s[36:39], s62 offen offset:1024 sc1 lds
  s_add_u32 m0, s65, 63488
  v_mfma_f32_16x16x32_bf16 v[100:103], a[108:111], a[60:63], v[100:103]
  ds_read_b64_tr_b16 a[94:95], v199 offset:49152
  v_mfma_f32_16x16x32_bf16 v[100:103], a[104:107], a[40:43], v[100:103]
  s_waitcnt lgkmcnt(2)
  ds_read_b64_tr_b16 a[96:97], v199 offset:44032
  v_mfma_f32_16x16x32_bf16 v[20:23], a[80:83], a[60:63], v[20:23]
  v_mfma_f32_16x16x32_bf16 v[20:23], a[84:87], a[0:3], v[20:23]
  buffer_load_dword v206, s[36:39], s62 offen sc1 lds
  s_mov_b32 s61, 5505024
  v_mfma_f32_16x16x32_bf16 v[20:23], a[88:91], a[20:23], v[20:23]
  s_waitcnt vmcnt(12)
  s_barrier
  s_add_u32 m0, s63, 64512
  v_mfma_f32_16x16x32_bf16 v[24:27], a[88:91], a[24:27], v[24:27]
  ds_read_b64_tr_b16 a[98:99], v199 offset:50176
  v_mfma_f32_16x16x32_bf16 v[24:27], a[84:87], a[4:7], v[24:27]
  ds_read_b64_tr_b16 a[100:101], v199 offset:45056
  v_mfma_f32_16x16x32_bf16 v[24:27], a[80:83], a[64:67], v[24:27]
  buffer_load_dword a252, v214, s[12:15], s68 offen offset:384
  v_and_b32 v214, 0x1fff, v214
  v_mfma_f32_16x16x32_bf16 v[28:31], a[80:83], a[68:71], v[28:31]
  ds_read_b64_tr_b16 a[102:103], v199 offset:51200
  v_mfma_f32_16x16x32_bf16 v[28:31], a[84:87], a[8:11], v[28:31]
  ds_read_b128 a[40:43], v209 offset:12288
  v_mfma_f32_16x16x32_bf16 v[28:31], a[88:91], a[28:31], v[28:31]
  ds_read_b64_tr_b16 a[104:105], v200 offset:0
  v_mfma_f32_16x16x32_bf16 v[32:35], a[88:91], a[32:35], v[32:35]
  buffer_load_dwordx4 v202, s[8:11], s61 offen offset:0 lds
  v_mfma_f32_16x16x32_bf16 v[32:35], a[84:87], a[12:15], v[32:35]
  ds_read_b128 a[44:47], v209 offset:13312
  v_mfma_f32_16x16x32_bf16 v[32:35], a[80:83], a[72:75], v[32:35]
  ds_read_b64_tr_b16 a[106:107], v200 offset:6144
  v_mfma_f32_16x16x32_bf16 v[116:119], a[80:83], a[76:79], v[116:119]
  ds_read_b128 a[48:51], v209 offset:14336
  v_mfma_f32_16x16x32_bf16 v[116:119], a[84:87], a[16:19], v[116:119]
  buffer_load_dword a252, v214, s[4:7], s69 offen offset:384
  v_mfma_f32_16x16x32_bf16 v[116:119], a[88:91], a[36:39], v[116:119]
  s_waitcnt lgkmcnt(5)
  ds_read_b64_tr_b16 a[108:109], v200 offset:1024
  v_mfma_f32_16x16x32_bf16 v[48:51], a[92:95], a[72:75], v[48:51]
  ds_read_b128 a[52:55], v209 offset:15360
  v_mfma_f32_16x16x32_bf16 v[48:51], a[96:99], a[12:15], v[48:51]
  ds_read_b128 a[56:59], v212 offset:20480
  v_mfma_f32_16x16x32_bf16 v[48:51], a[100:103], a[32:35], v[48:51]
  buffer_load_dwordx4 v203, s[8:11], s61 offen offset:1024 lds
  v_mfma_f32_16x16x32_bf16 v[44:47], a[100:103], a[28:31], v[44:47]
  ds_read_b64_tr_b16 a[110:111], v200 offset:7168
  v_mfma_f32_16x16x32_bf16 v[44:47], a[96:99], a[8:11], v[44:47]
  ds_read_b64_tr_b16 a[112:113], v200 offset:2048
  v_mfma_f32_16x16x32_bf16 v[44:47], a[92:95], a[68:71], v[44:47]
  ds_read_b64_tr_b16 a[114:115], v200 offset:8192
  v_mfma_f32_16x16x32_bf16 v[40:43], a[92:95], a[64:67], v[40:43]
  buffer_load_dwordx4 v204, s[8:11], s61 offen offset:2048 lds
  s_mov_b32 s62, 61440
  v_mfma_f32_16x16x32_bf16 v[40:43], a[96:99], a[4:7], v[40:43]
  s_add_u32 m0, s64, 76800
  ds_read_b64_tr_b16 a[80:81], v201 offset:0
  v_mfma_f32_16x16x32_bf16 v[40:43], a[100:103], a[24:27], v[40:43]
  v_mfma_f32_16x16x32_bf16 v[36:39], a[100:103], a[20:23], v[36:39]
  ds_read_b64_tr_b16 a[82:83], v201 offset:6144
  v_mfma_f32_16x16x32_bf16 v[36:39], a[96:99], a[0:3], v[36:39]
  buffer_load_dwordx4 v205, s[36:39], s62 offen offset:0 sc1 lds
  v_mfma_f32_16x16x32_bf16 v[36:39], a[92:95], a[60:63], v[36:39]
  s_waitcnt lgkmcnt(2)
  ds_read_b64_tr_b16 a[84:85], v201 offset:1024
  v_mfma_f32_16x16x32_bf16 v[52:55], a[0:3], a[104:107], v[52:55]
  v_mfma_f32_16x16x32_bf16 v[52:55], a[20:23], a[108:111], v[52:55]
  ds_read_b64_tr_b16 a[86:87], v201 offset:7168
  v_mfma_f32_16x16x32_bf16 v[52:55], a[40:43], a[112:115], v[52:55]
  buffer_load_dwordx4 v205, s[36:39], s62 offen offset:1024 sc1 lds
  s_add_u32 m0, s65, 84992
  v_mfma_f32_16x16x32_bf16 v[56:59], a[44:47], a[112:115], v[56:59]
  ds_read_b64_tr_b16 a[88:89], v201 offset:2048
  v_mfma_f32_16x16x32_bf16 v[56:59], a[24:27], a[108:111], v[56:59]
  v_mfma_f32_16x16x32_bf16 v[56:59], a[4:7], a[104:107], v[56:59]
  ds_read_b64_tr_b16 a[90:91], v201 offset:8192
  v_mfma_f32_16x16x32_bf16 v[60:63], a[8:11], a[104:107], v[60:63]
  buffer_load_dword v206, s[36:39], s62 offen sc1 lds
  s_mov_b32 s61, 5703680
  v_mfma_f32_16x16x32_bf16 v[60:63], a[28:31], a[108:111], v[60:63]
  s_add_u32 m0, s63, 86016
  ds_read_b128 a[60:63], v207 offset:12288
  v_mfma_f32_16x16x32_bf16 v[60:63], a[48:51], a[112:115], v[60:63]
  ds_read_b64_tr_b16 a[92:93], v196 offset:0
  v_mfma_f32_16x16x32_bf16 v[64:67], a[52:55], a[112:115], v[64:67]
  ds_read_b128 a[64:67], v207 offset:13312
  v_mfma_f32_16x16x32_bf16 v[64:67], a[32:35], a[108:111], v[64:67]
  buffer_load_dwordx4 v202, s[8:11], s61 offen offset:0 lds
  v_mfma_f32_16x16x32_bf16 v[64:67], a[12:15], a[104:107], v[64:67]
  ds_read_b64_tr_b16 a[94:95], v196 offset:6144
  v_mfma_f32_16x16x32_bf16 v[120:123], a[16:19], a[104:107], v[120:123]
  ds_read_b128 a[68:71], v207 offset:14336
  v_mfma_f32_16x16x32_bf16 v[120:123], a[36:39], a[108:111], v[120:123]
  ds_read_b64_tr_b16 a[96:97], v196 offset:1024
  v_mfma_f32_16x16x32_bf16 v[120:123], a[56:59], a[112:115], v[120:123]
  s_waitcnt lgkmcnt(6)
  buffer_load_dwordx4 v203, s[8:11], s61 offen offset:1024 lds
  v_mfma_f32_16x16x32_bf16 v[80:83], a[12:15], a[80:83], v[80:83]
  ds_read_b128 a[72:75], v207 offset:15360
  v_mfma_f32_16x16x32_bf16 v[80:83], a[32:35], a[84:87], v[80:83]
  ds_read_b64_tr_b16 a[98:99], v196 offset:7168
  v_mfma_f32_16x16x32_bf16 v[80:83], a[52:55], a[88:91], v[80:83]
  ds_read_b128 a[76:79], v210 offset:20480
  v_mfma_f32_16x16x32_bf16 v[76:79], a[48:51], a[88:91], v[76:79]
  buffer_load_dwordx4 v204, s[8:11], s61 offen offset:2048 lds
  s_mov_b32 s62, 63488
  v_mfma_f32_16x16x32_bf16 v[76:79], a[28:31], a[84:87], v[76:79]
  s_add_u32 m0, s64, 98304
  ds_read_b64_tr_b16 a[100:101], v196 offset:2048
  v_mfma_f32_16x16x32_bf16 v[76:79], a[8:11], a[80:83], v[76:79]
  ds_read_b64_tr_b16 a[102:103], v196 offset:8192
  v_mfma_f32_16x16x32_bf16 v[72:75], a[4:7], a[80:83], v[72:75]
  ds_read_b64_tr_b16 a[104:105], v197 offset:0
  v_mfma_f32_16x16x32_bf16 v[72:75], a[24:27], a[84:87], v[72:75]
  buffer_load_dwordx4 v205, s[36:39], s62 offen offset:0 sc1 lds
  v_mfma_f32_16x16x32_bf16 v[72:75], a[44:47], a[88:91], v[72:75]
  ds_read_b64_tr_b16 a[106:107], v197 offset:6144
  v_mfma_f32_16x16x32_bf16 v[68:71], a[40:43], a[88:91], v[68:71]
  ds_read_b64_tr_b16 a[108:109], v197 offset:1024
  v_mfma_f32_16x16x32_bf16 v[68:71], a[20:23], a[84:87], v[68:71]
  ds_read_b64_tr_b16 a[110:111], v197 offset:7168
  v_mfma_f32_16x16x32_bf16 v[68:71], a[0:3], a[80:83], v[68:71]
  s_waitcnt vmcnt(12) lgkmcnt(4)
  s_barrier
  buffer_load_dwordx4 v205, s[36:39], s62 offen offset:1024 sc1 lds
  v_mfma_f32_16x16x32_bf16 v[84:87], a[92:95], a[20:23], v[84:87]
  s_add_u32 m0, s65, 106496
  ds_read_b64_tr_b16 a[112:113], v197 offset:2048
  v_mfma_f32_16x16x32_bf16 v[84:87], a[96:99], a[40:43], v[84:87]
  v_mfma_f32_16x16x32_bf16 v[84:87], a[100:103], a[60:63], v[84:87]
  ds_read_b64_tr_b16 a[114:115], v197 offset:8192
  v_mfma_f32_16x16x32_bf16 v[88:91], a[100:103], a[64:67], v[88:91]
  buffer_load_dword v206, s[36:39], s62 offen sc1 lds
  s_mov_b32 s61, 5902336
  v_mfma_f32_16x16x32_bf16 v[88:91], a[96:99], a[44:47], v[88:91]
  s_add_u32 m0, s63, 107520
  ds_read_b128 a[0:3], v207 offset:33792
  v_mfma_f32_16x16x32_bf16 v[88:91], a[92:95], a[24:27], v[88:91]
  ds_read_b64_tr_b16 a[80:81], v196 offset:21504
  v_mfma_f32_16x16x32_bf16 v[92:95], a[92:95], a[28:31], v[92:95]
  ds_read_b128 a[4:7], v207 offset:34816
  v_mfma_f32_16x16x32_bf16 v[92:95], a[96:99], a[48:51], v[92:95]
  buffer_load_dwordx4 v202, s[8:11], s61 offen offset:0 lds
  v_mfma_f32_16x16x32_bf16 v[92:95], a[100:103], a[68:71], v[92:95]
  ds_read_b64_tr_b16 a[82:83], v196 offset:27648
  v_mfma_f32_16x16x32_bf16 v[96:99], a[100:103], a[72:75], v[96:99]
  ds_read_b128 a[8:11], v207 offset:35840
  v_mfma_f32_16x16x32_bf16 v[96:99], a[96:99], a[52:55], v[96:99]
  ds_read_b64_tr_b16 a[84:85], v196 offset:22528
  v_mfma_f32_16x16x32_bf16 v[96:99], a[92:95], a[32:35], v[96:99]
  s_waitcnt lgkmcnt(6)
  buffer_load_dwordx4 v203, s[8:11], s61 offen offset:1024 lds
  s_mov_b32 s61, 6094848
  v_mfma_f32_16x16x32_bf16 v[112:115], a[104:107], a[32:35], v[112:115]
  s_add_u32 m0, s63, 129024
  ds_read_b128 a[12:15], v207 offset:36864
  v_mfma_f32_16x16x32_bf16 v[112:115], a[108:111], a[52:55], v[112:115]
  ds_read_b128 a[16:19], v210 offset:41984
  v_mfma_f32_16x16x32_bf16 v[112:115], a[112:115], a[72:75], v[112:115]
  ds_read_b64_tr_b16 a[86:87], v196 offset:28672
  v_mfma_f32_16x16x32_bf16 v[108:111], a[112:115], a[68:71], v[108:111]
  buffer_load_dwordx4 v202, s[8:11], s61 offen offset:0 lds
  s_nop 0
  v_mfma_f32_16x16x32_bf16 v[108:111], a[108:111], a[48:51], v[108:111]
  s_bfe_u32 s66, s2, 0x30004
  s_and_b32 s67, s2, 3
  s_lshl3_add_u32 s66, s67, s66
  v_mfma_f32_16x16x32_bf16 v[108:111], a[104:107], a[28:31], v[108:111]
  s_lshl2_add_u32 s66, s66, s44
  s_mul_i32 s66, s66, 98304
  s_and_b32 s67, s51, 0x3800
  v_mfma_f32_16x16x32_bf16 v[104:107], a[104:107], a[24:27], v[104:107]
  s_add_u32 s66, s66, s67
  s_and_b32 s67, s2, 8
  s_lshl_b32 s67, s67, 7
  v_mfma_f32_16x16x32_bf16 v[104:107], a[108:111], a[44:47], v[104:107]
  s_add_u32 s66, s66, s67
  ds_read_b64_tr_b16 a[88:89], v196 offset:23552
  v_and_b32 v215, 7, v10
  v_mfma_f32_16x16x32_bf16 v[104:107], a[112:115], a[64:67], v[104:107]
  ds_read_b64_tr_b16 a[90:91], v196 offset:29696
  v_mul_u32_u24 v215, 12288, v215
  v_mfma_f32_16x16x32_bf16 v[100:103], a[112:115], a[60:63], v[100:103]
  buffer_load_dword a252, v215, s[28:31], s66 offen offset:384
  v_mfma_f32_16x16x32_bf16 v[100:103], a[108:111], a[40:43], v[100:103]
  ds_read_b64_tr_b16 a[92:93], v197 offset:21504
  v_mfma_f32_16x16x32_bf16 v[100:103], a[104:107], a[20:23], v[100:103]
  s_waitcnt lgkmcnt(1)
  ds_read_b64_tr_b16 a[94:95], v197 offset:27648
  v_mfma_f32_16x16x32_bf16 v[20:23], a[80:83], a[40:43], v[20:23]
  ds_read_b64_tr_b16 a[96:97], v197 offset:22528
  v_mfma_f32_16x16x32_bf16 v[20:23], a[84:87], a[60:63], v[20:23]
  buffer_load_dwordx4 v[136:139], v176, s[28:31], s51 offen nt
  s_add_u32 s51, s51, 12288
  v_mfma_f32_16x16x32_bf16 v[20:23], a[88:91], a[0:3], v[20:23]
  ds_read_b64_tr_b16 a[98:99], v197 offset:28672
  v_mfma_f32_16x16x32_bf16 v[24:27], a[88:91], a[4:7], v[24:27]
  ds_read_b64_tr_b16 a[100:101], v197 offset:23552
  v_mfma_f32_16x16x32_bf16 v[24:27], a[84:87], a[64:67], v[24:27]
  v_mfma_f32_16x16x32_bf16 v[24:27], a[80:83], a[44:47], v[24:27]
  buffer_load_dwordx4 v[140:143], v176, s[28:31], s51 offen nt
  s_add_u32 s51, s51, 12288
  v_mfma_f32_16x16x32_bf16 v[28:31], a[80:83], a[48:51], v[28:31]
  ds_read_b64_tr_b16 a[102:103], v197 offset:29696
  v_mfma_f32_16x16x32_bf16 v[28:31], a[84:87], a[68:71], v[28:31]
  ds_read_b128 a[20:23], v207 offset:55296
  v_mfma_f32_16x16x32_bf16 v[28:31], a[88:91], a[8:11], v[28:31]
  ds_read_b64_tr_b16 a[104:105], v196 offset:43008
  v_mfma_f32_16x16x32_bf16 v[32:35], a[88:91], a[12:15], v[32:35]
  buffer_load_dwordx4 v[144:147], v176, s[28:31], s51 offen nt
  s_add_u32 s51, s51, 12288
  v_mfma_f32_16x16x32_bf16 v[32:35], a[84:87], a[72:75], v[32:35]
  ds_read_b128 a[24:27], v207 offset:56320
  v_mfma_f32_16x16x32_bf16 v[32:35], a[80:83], a[52:55], v[32:35]
  ds_read_b64_tr_b16 a[106:107], v196 offset:49152
  v_mfma_f32_16x16x32_bf16 v[116:119], a[80:83], a[56:59], v[116:119]
  ds_read_b128 a[28:31], v207 offset:57344
  v_mfma_f32_16x16x32_bf16 v[116:119], a[84:87], a[76:79], v[116:119]
  buffer_load_dwordx4 v[148:151], v176, s[28:31], s51 offen nt
  s_add_u32 s51, s51, 12288
  v_mfma_f32_16x16x32_bf16 v[116:119], a[88:91], a[16:19], v[116:119]
  s_waitcnt lgkmcnt(5)
  ds_read_b64_tr_b16 a[108:109], v196 offset:44032
  v_mfma_f32_16x16x32_bf16 v[48:51], a[92:95], a[52:55], v[48:51]
  ds_read_b128 a[32:35], v207 offset:58368
  v_mfma_f32_16x16x32_bf16 v[48:51], a[96:99], a[72:75], v[48:51]
  ds_read_b128 a[36:39], v210 offset:63488
  v_mfma_f32_16x16x32_bf16 v[48:51], a[100:103], a[12:15], v[48:51]
  buffer_load_dwordx4 v[152:155], v176, s[28:31], s51 offen nt
  s_add_u32 s51, s51, 12288
  v_mfma_f32_16x16x32_bf16 v[44:47], a[100:103], a[8:11], v[44:47]
  ds_read_b64_tr_b16 a[110:111], v196 offset:50176
  v_mfma_f32_16x16x32_bf16 v[44:47], a[96:99], a[68:71], v[44:47]
  ds_read_b64_tr_b16 a[112:113], v196 offset:45056
  v_mfma_f32_16x16x32_bf16 v[44:47], a[92:95], a[48:51], v[44:47]
  ds_read_b64_tr_b16 a[114:115], v196 offset:51200
  v_mfma_f32_16x16x32_bf16 v[40:43], a[92:95], a[44:47], v[40:43]
  buffer_load_dwordx4 v[156:159], v176, s[28:31], s51 offen nt
  s_add_u32 s51, s51, 12288
  v_mfma_f32_16x16x32_bf16 v[40:43], a[96:99], a[64:67], v[40:43]
  ds_read_b64_tr_b16 a[80:81], v197 offset:43008
  v_mfma_f32_16x16x32_bf16 v[40:43], a[100:103], a[4:7], v[40:43]
  v_mfma_f32_16x16x32_bf16 v[36:39], a[100:103], a[0:3], v[36:39]
  ds_read_b64_tr_b16 a[82:83], v197 offset:49152
  v_mfma_f32_16x16x32_bf16 v[36:39], a[96:99], a[60:63], v[36:39]
  buffer_load_dwordx4 v[160:163], v176, s[28:31], s51 offen nt
  s_add_u32 s51, s51, 12288
  v_mfma_f32_16x16x32_bf16 v[36:39], a[92:95], a[40:43], v[36:39]
  s_waitcnt lgkmcnt(2)
  ds_read_b64_tr_b16 a[84:85], v197 offset:44032
  v_mfma_f32_16x16x32_bf16 v[52:55], a[60:63], a[104:107], v[52:55]
  v_mfma_f32_16x16x32_bf16 v[52:55], a[0:3], a[108:111], v[52:55]
  ds_read_b64_tr_b16 a[86:87], v197 offset:50176
  v_mfma_f32_16x16x32_bf16 v[52:55], a[20:23], a[112:115], v[52:55]
  s_waitcnt vmcnt(11)
  s_barrier
  buffer_load_dwordx4 v[164:167], v176, s[28:31], s51 offen nt
  v_mfma_f32_16x16x32_bf16 v[56:59], a[24:27], a[112:115], v[56:59]
  ds_read_b64_tr_b16 a[88:89], v197 offset:45056
  v_lshrrev_b32 v215, 2, v10
  v_mfma_f32_16x16x32_bf16 v[56:59], a[4:7], a[108:111], v[56:59]
  v_min_u32 v215, (XEND-G3S)/4096, v215
  v_and_b32 v213, 3, v10
  v_mfma_f32_16x16x32_bf16 v[56:59], a[64:67], a[104:107], v[56:59]
  ds_read_b64_tr_b16 a[90:91], v197 offset:51200
  v_lshlrev_b32 v213, 7, v213
  v_mfma_f32_16x16x32_bf16 v[60:63], a[68:71], a[104:107], v[60:63]
  ds_read_b128 a[40:43], v208 offset:12288
  v_lshl_add_u32 v215, v215, 12, v213
  v_mfma_f32_16x16x32_bf16 v[60:63], a[8:11], a[108:111], v[60:63]
  s_add_u32 s94, s92, AL-adaLN_cond__sliding_local_dilated__swiglu_ffn__prompt_kernel+((G3S-AL+4095)/4096)*4096
  s_addc_u32 s95, s93, 0
  global_load_dword a252, v215, s[94:95]
  v_mfma_f32_16x16x32_bf16 v[60:63], a[28:31], a[112:115], v[60:63]
  s_lshl_b32 s66, s2, 7
  s_add_u32 s66, s66, 5242880
  s_cmp_eq_u32 s44, 2
  v_mfma_f32_16x16x32_bf16 v[64:67], a[32:35], a[112:115], v[64:67]
  s_cselect_b32 s66, s66, 1073741824
  ds_read_b64_tr_b16 a[92:93], v198 offset:0
  v_and_b32 v215, 7, v10
  v_mfma_f32_16x16x32_bf16 v[64:67], a[12:15], a[108:111], v[64:67]
  ds_read_b128 a[44:47], v208 offset:13312
  v_lshlrev_b32 v215, 15, v215
  v_mfma_f32_16x16x32_bf16 v[64:67], a[72:75], a[104:107], v[64:67]
  buffer_load_dword a252, v215, s[36:39], s66 offen sc1
  s_and_b32 s66, s44, 1
  v_mfma_f32_16x16x32_bf16 v[120:123], a[76:79], a[104:107], v[120:123]
  s_lshl1_add_u32 s66, s2, s66
  s_mul_i32 s66, s66, 35
  ds_read_b64_tr_b16 a[94:95], v198 offset:6144
  v_mfma_f32_16x16x32_bf16 v[120:123], a[16:19], a[108:111], v[120:123]
  ds_read_b128 a[48:51], v208 offset:14336
  v_min_u32 v215, 34, v10
  v_mfma_f32_16x16x32_bf16 v[120:123], a[36:39], a[112:115], v[120:123]
  s_waitcnt lgkmcnt(5)
  ds_read_b64_tr_b16 a[96:97], v198 offset:1024
  v_add_u32 v215, s66, v215
  v_mfma_f32_16x16x32_bf16 v[80:83], a[72:75], a[80:83], v[80:83]
  ds_read_b128 a[52:55], v208 offset:15360
  v_lshrrev_b32 v213, 8, v215
  v_mfma_f32_16x16x32_bf16 v[80:83], a[12:15], a[84:87], v[80:83]
  ds_read_b64_tr_b16 a[98:99], v198 offset:7168
  v_mul_u32_u24 v213, 9363, v213
  v_mfma_f32_16x16x32_bf16 v[80:83], a[32:35], a[88:91], v[80:83]
  ds_read_b128 a[56:59], v211 offset:20480
  v_lshrrev_b32 v213, 16, v213
  v_mfma_f32_16x16x32_bf16 v[76:79], a[28:31], a[88:91], v[76:79]
  ds_read_b64_tr_b16 a[100:101], v198 offset:2048
  v_mul_u32_u24 v213, 1792, v213
  v_mfma_f32_16x16x32_bf16 v[76:79], a[8:11], a[84:87], v[76:79]
  ds_read_b64_tr_b16 a[102:103], v198 offset:8192
  v_add_lshl_u32 v215, v215, v213, 7
  v_mfma_f32_16x16x32_bf16 v[76:79], a[68:71], a[80:83], v[76:79]
  buffer_load_dword a252, v215, s[16:19], 0 offen
  v_mfma_f32_16x16x32_bf16 v[72:75], a[64:67], a[80:83], v[72:75]
  ds_read_b64_tr_b16 a[104:105], v199 offset:0
  v_mfma_f32_16x16x32_bf16 v[72:75], a[4:7], a[84:87], v[72:75]
  ds_read_b64_tr_b16 a[106:107], v199 offset:6144
  v_mfma_f32_16x16x32_bf16 v[72:75], a[24:27], a[88:91], v[72:75]
  ds_read_b64_tr_b16 a[108:109], v199 offset:1024
  v_mfma_f32_16x16x32_bf16 v[68:71], a[20:23], a[88:91], v[68:71]
  v_mfma_f32_16x16x32_bf16 v[68:71], a[0:3], a[84:87], v[68:71]
  ds_read_b64_tr_b16 a[110:111], v199 offset:7168
  v_mfma_f32_16x16x32_bf16 v[68:71], a[60:63], a[80:83], v[68:71]
  s_waitcnt lgkmcnt(4)
  v_mfma_f32_16x16x32_bf16 v[84:87], a[92:95], a[0:3], v[84:87]
  ds_read_b64_tr_b16 a[112:113], v199 offset:2048
  v_mfma_f32_16x16x32_bf16 v[84:87], a[96:99], a[20:23], v[84:87]
  v_mfma_f32_16x16x32_bf16 v[84:87], a[100:103], a[40:43], v[84:87]
  ds_read_b64_tr_b16 a[114:115], v199 offset:8192
  v_mfma_f32_16x16x32_bf16 v[88:91], a[100:103], a[44:47], v[88:91]
  ds_read_b128 a[60:63], v208 offset:33792
  v_mfma_f32_16x16x32_bf16 v[88:91], a[96:99], a[24:27], v[88:91]
  ds_read_b64_tr_b16 a[80:81], v198 offset:21504
  v_mfma_f32_16x16x32_bf16 v[88:91], a[92:95], a[4:7], v[88:91]
  ds_read_b128 a[64:67], v208 offset:34816
  v_mfma_f32_16x16x32_bf16 v[92:95], a[92:95], a[8:11], v[92:95]
  ds_read_b64_tr_b16 a[82:83], v198 offset:27648
  v_mfma_f32_16x16x32_bf16 v[92:95], a[96:99], a[28:31], v[92:95]
  ds_read_b128 a[68:71], v208 offset:35840
  v_mfma_f32_16x16x32_bf16 v[92:95], a[100:103], a[48:51], v[92:95]
  ds_read_b64_tr_b16 a[84:85], v198 offset:22528
  v_mfma_f32_16x16x32_bf16 v[96:99], a[100:103], a[52:55], v[96:99]
  ds_read_b128 a[72:75], v208 offset:36864
  v_mfma_f32_16x16x32_bf16 v[96:99], a[96:99], a[32:35], v[96:99]
  ds_read_b128 a[76:79], v211 offset:41984
  v_mfma_f32_16x16x32_bf16 v[96:99], a[92:95], a[12:15], v[96:99]
  s_waitcnt lgkmcnt(8)
  ds_read_b64_tr_b16 a[86:87], v198 offset:28672
  v_mfma_f32_16x16x32_bf16 v[112:115], a[104:107], a[12:15], v[112:115]
  v_mfma_f32_16x16x32_bf16 v[112:115], a[108:111], a[32:35], v[112:115]
  ds_read_b64_tr_b16 a[88:89], v198 offset:23552
  v_mfma_f32_16x16x32_bf16 v[112:115], a[112:115], a[52:55], v[112:115]
  v_mfma_f32_16x16x32_bf16 v[108:111], a[112:115], a[48:51], v[108:111]
  ds_read_b64_tr_b16 a[90:91], v198 offset:29696
  v_mfma_f32_16x16x32_bf16 v[108:111], a[108:111], a[28:31], v[108:111]
  v_mfma_f32_16x16x32_bf16 v[108:111], a[104:107], a[8:11], v[108:111]
  v_mfma_f32_16x16x32_bf16 v[104:107], a[104:107], a[4:7], v[104:107]
  v_mfma_f32_16x16x32_bf16 v[104:107], a[108:111], a[24:27], v[104:107]
  ds_read_b64_tr_b16 a[92:93], v199 offset:21504
  v_mfma_f32_16x16x32_bf16 v[104:107], a[112:115], a[44:47], v[104:107]
  v_mfma_f32_16x16x32_bf16 v[100:103], a[112:115], a[40:43], v[100:103]
  ds_read_b64_tr_b16 a[94:95], v199 offset:27648
  v_mfma_f32_16x16x32_bf16 v[100:103], a[108:111], a[20:23], v[100:103]
  v_mfma_f32_16x16x32_bf16 v[100:103], a[104:107], a[0:3], v[100:103]
  s_waitcnt lgkmcnt(2)
  ds_read_b64_tr_b16 a[96:97], v199 offset:22528
  v_mfma_f32_16x16x32_bf16 v[20:23], a[80:83], a[20:23], v[20:23]
  v_mfma_f32_16x16x32_bf16 v[20:23], a[84:87], a[40:43], v[20:23]
  ds_read_b64_tr_b16 a[98:99], v199 offset:28672
  v_mfma_f32_16x16x32_bf16 v[20:23], a[88:91], a[60:63], v[20:23]
  s_waitcnt vmcnt(12)
  s_barrier
  v_mfma_f32_16x16x32_bf16 v[24:27], a[88:91], a[64:67], v[24:27]
  ds_read_b64_tr_b16 a[100:101], v199 offset:23552
  v_mfma_f32_16x16x32_bf16 v[24:27], a[84:87], a[44:47], v[24:27]
  v_mfma_f32_16x16x32_bf16 v[24:27], a[80:83], a[24:27], v[24:27]
  ds_read_b64_tr_b16 a[102:103], v199 offset:29696
  v_mfma_f32_16x16x32_bf16 v[28:31], a[80:83], a[28:31], v[28:31]
  v_mfma_f32_16x16x32_bf16 v[28:31], a[84:87], a[48:51], v[28:31]
  ds_read_b64_tr_b16 a[104:105], v198 offset:43008
  v_mfma_f32_16x16x32_bf16 v[28:31], a[88:91], a[68:71], v[28:31]
  v_mfma_f32_16x16x32_bf16 v[32:35], a[88:91], a[72:75], v[32:35]
  ds_read_b64_tr_b16 a[106:107], v198 offset:49152
  v_mfma_f32_16x16x32_bf16 v[32:35], a[84:87], a[52:55], v[32:35]
  v_mfma_f32_16x16x32_bf16 v[32:35], a[80:83], a[32:35], v[32:35]
  v_mfma_f32_16x16x32_bf16 v[116:119], a[80:83], a[36:39], v[116:119]
  ds_read_b64_tr_b16 a[108:109], v198 offset:44032
  v_mfma_f32_16x16x32_bf16 v[116:119], a[84:87], a[56:59], v[116:119]
  v_mfma_f32_16x16x32_bf16 v[116:119], a[88:91], a[76:79], v[116:119]
  s_waitcnt lgkmcnt(3)
  ds_read_b64_tr_b16 a[110:111], v198 offset:50176
  v_mfma_f32_16x16x32_bf16 v[48:51], a[92:95], a[32:35], v[48:51]
  v_mfma_f32_16x16x32_bf16 v[48:51], a[96:99], a[52:55], v[48:51]
  v_mfma_f32_16x16x32_bf16 v[48:51], a[100:103], a[72:75], v[48:51]
  ds_read_b64_tr_b16 a[112:113], v199 offset:43008
  v_mfma_f32_16x16x32_bf16 v[44:47], a[100:103], a[68:71], v[44:47]
  v_mfma_f32_16x16x32_bf16 v[44:47], a[96:99], a[48:51], v[44:47]
  ds_read_b64_tr_b16 a[114:115], v199 offset:49152
  v_mfma_f32_16x16x32_bf16 v[44:47], a[92:95], a[28:31], v[44:47]
  v_mfma_f32_16x16x32_bf16 v[40:43], a[92:95], a[24:27], v[40:43]
  ds_read_b64_tr_b16 a[80:81], v199 offset:44032
  v_mfma_f32_16x16x32_bf16 v[40:43], a[96:99], a[44:47], v[40:43]
  v_cvt_pk_bf16_f32 v116, v116, v117
  v_cvt_pk_bf16_f32 v117, v118, v119
  v_mfma_f32_16x16x32_bf16 v[40:43], a[100:103], a[64:67], v[40:43]
  ds_read_b64_tr_b16 a[82:83], v199 offset:50176
  v_mfma_f32_16x16x32_bf16 v[36:39], a[100:103], a[60:63], v[36:39]
  ds_write_b64 v224, v[116:117]
  v_cvt_pk_bf16_f32 v32, v32, v33
  v_mfma_f32_16x16x32_bf16 v[36:39], a[96:99], a[40:43], v[36:39]
  ds_read_b64_tr_b16 a[84:85], v200 offset:0
  v_cvt_pk_bf16_f32 v33, v34, v35
  v_mfma_f32_16x16x32_bf16 v[36:39], a[92:95], a[20:23], v[36:39]
  s_waitcnt lgkmcnt(6)
  v_cvt_pk_bf16_f32 v34, v48, v49
  v_cvt_pk_bf16_f32 v35, v50, v51
  v_mfma_f32_16x16x32_bf16 v[52:55], a[40:43], a[104:107], v[52:55]
  ds_read_b64_tr_b16 a[86:87], v200 offset:6144
  v_mfma_f32_16x16x32_bf16 v[52:55], a[60:63], a[108:111], v[52:55]
  ds_write_b64 v222, v[32:33]
  v_mfma_f32_16x16x32_bf16 v[56:59], a[64:67], a[108:111], v[56:59]
  ds_read_b64_tr_b16 a[88:89], v201 offset:0
  v_mfma_f32_16x16x32_bf16 v[56:59], a[44:47], a[104:107], v[56:59]
  ds_write_b64 v223, v[34:35]
  v_cvt_pk_bf16_f32 v28, v28, v29
  v_mfma_f32_16x16x32_bf16 v[60:63], a[48:51], a[104:107], v[60:63]
  ds_read_b64_tr_b16 a[90:91], v201 offset:6144
  v_cvt_pk_bf16_f32 v29, v30, v31
  v_mfma_f32_16x16x32_bf16 v[60:63], a[68:71], a[108:111], v[60:63]
  v_cvt_pk_bf16_f32 v30, v44, v45
  v_cvt_pk_bf16_f32 v31, v46, v47
  v_mfma_f32_16x16x32_bf16 v[64:67], a[72:75], a[108:111], v[64:67]
  v_cvt_pk_bf16_f32 v24, v24, v25
  v_cvt_pk_bf16_f32 v25, v26, v27
  v_mfma_f32_16x16x32_bf16 v[64:67], a[52:55], a[104:107], v[64:67]
  v_cvt_pk_bf16_f32 v26, v40, v41
  v_cvt_pk_bf16_f32 v27, v42, v43
  v_mfma_f32_16x16x32_bf16 v[120:123], a[56:59], a[104:107], v[120:123]
  v_cvt_pk_bf16_f32 v20, v20, v21
  v_cvt_pk_bf16_f32 v21, v22, v23
  v_mfma_f32_16x16x32_bf16 v[120:123], a[76:79], a[108:111], v[120:123]
  s_waitcnt lgkmcnt(7)
  v_cvt_pk_bf16_f32 v22, v36, v37
  v_cvt_pk_bf16_f32 v23, v38, v39
  v_mfma_f32_16x16x32_bf16 v[80:83], a[52:55], a[112:115], v[80:83]
  v_cvt_pk_bf16_f32 v55, v54, v55
  v_cvt_pk_bf16_f32 v54, v52, v53
  v_mfma_f32_16x16x32_bf16 v[80:83], a[72:75], a[80:83], v[80:83]
  v_cvt_pk_bf16_f32 v56, v56, v57
  v_cvt_pk_bf16_f32 v57, v58, v59
  v_mfma_f32_16x16x32_bf16 v[76:79], a[68:71], a[80:83], v[76:79]
  v_cvt_pk_bf16_f32 v58, v60, v61
  v_cvt_pk_bf16_f32 v59, v62, v63
  v_mfma_f32_16x16x32_bf16 v[76:79], a[48:51], a[112:115], v[76:79]
  v_mfma_f32_16x16x32_bf16 v[72:75], a[44:47], a[112:115], v[72:75]
  v_cvt_pk_bf16_f32 v60, v64, v65
  v_cvt_pk_bf16_f32 v61, v66, v67
  v_mfma_f32_16x16x32_bf16 v[72:75], a[64:67], a[80:83], v[72:75]
  v_mfma_f32_16x16x32_bf16 v[68:71], a[60:63], a[80:83], v[68:71]
  v_cvt_pk_bf16_f32 v120, v120, v121
  v_cvt_pk_bf16_f32 v121, v122, v123
  v_mfma_f32_16x16x32_bf16 v[68:71], a[40:43], a[112:115], v[68:71]
  s_waitcnt lgkmcnt(4)
  ds_write_b64 v222, v[60:61] offset:1024
  v_mfma_f32_16x16x32_bf16 v[84:87], a[84:87], a[60:63], v[84:87]
  ds_write_b64 v224, v[120:121] offset:1024
  v_mfma_f32_16x16x32_bf16 v[88:91], a[84:87], a[64:67], v[88:91]
  v_mfma_f32_16x16x32_bf16 v[92:95], a[84:87], a[68:71], v[92:95]
  v_mfma_f32_16x16x32_bf16 v[96:99], a[84:87], a[72:75], v[96:99]
  s_waitcnt lgkmcnt(2)
  v_mfma_f32_16x16x32_bf16 v[112:115], a[88:91], a[72:75], v[112:115]
  v_mfma_f32_16x16x32_bf16 v[108:111], a[88:91], a[68:71], v[108:111]
  v_mfma_f32_16x16x32_bf16 v[104:107], a[88:91], a[64:67], v[104:107]
  v_cvt_pk_bf16_f32 v71, v70, v71
  v_cvt_pk_bf16_f32 v70, v68, v69
  v_mfma_f32_16x16x32_bf16 v[100:103], a[88:91], a[60:63], v[100:103]
  v_cvt_pk_bf16_f32 v72, v72, v73
  v_cvt_pk_bf16_f32 v73, v74, v75
  v_cvt_pk_bf16_f32 v74, v76, v77
  v_cvt_pk_bf16_f32 v75, v78, v79
  v_cvt_pk_bf16_f32 v76, v80, v81
  v_cvt_pk_bf16_f32 v77, v82, v83
  ds_write_b64 v223, v[76:77] offset:1024
  s_waitcnt lgkmcnt(0)
  s_barrier
  ds_read_b64 v[124:125], v225
  ds_read_b64 v[126:127], v226
  ds_read_b64 v[52:53], v227 offset:1024
  ds_read_b64 v[68:69], v227 offset:1032
  v_cvt_pk_bf16_f32 v96, v96, v97
  v_cvt_pk_bf16_f32 v97, v98, v99
  v_cvt_pk_bf16_f32 v98, v112, v113
  v_cvt_pk_bf16_f32 v99, v114, v115
  v_cvt_pk_bf16_f32 v92, v92, v93
  v_cvt_pk_bf16_f32 v93, v94, v95
  v_cvt_pk_bf16_f32 v94, v108, v109
  v_cvt_pk_bf16_f32 v95, v110, v111
  v_mfma_f32_16x16x32_bf16 v[112:115], v[32:35], v[96:99], 0
  v_mfma_f32_16x16x32_bf16 v[48:51], v[28:31], v[96:99], 0
Ha1_1:
  s_cbranch_execz Ra
  v_cvt_pk_bf16_f32 v88, v88, v89
  s_mov_b32 s50, 0
  s_add_u32 m0, s70, 81920
  s_nop 0
  buffer_load_dwordx4 v216, s[12:15], s50 offen offset:0 lds
  v_cvt_pk_bf16_f32 v89, v90, v91
  v_cvt_pk_bf16_f32 v90, v104, v105
  v_cvt_pk_bf16_f32 v91, v106, v107
  v_mfma_f32_16x16x32_bf16 v[108:111], v[28:31], v[92:95], 0
  v_mfma_f32_16x16x32_bf16 v[44:47], v[24:27], v[92:95], 0
  v_cvt_pk_bf16_f32 v84, v84, v85
  v_cvt_pk_bf16_f32 v85, v86, v87
  v_cvt_pk_bf16_f32 v86, v100, v101
  v_cvt_pk_bf16_f32 v87, v102, v103
  buffer_load_dwordx4 v217, s[12:15], s50 offen offset:1024 lds
  v_mfma_f32_16x16x32_bf16 v[104:107], v[24:27], v[88:91], 0
  v_mfma_f32_16x16x32_bf16 v[40:43], v[20:23], v[88:91], 0
  s_cmp_eq_u32 s57, 0
  s_cselect_b64 s[66:67], s[78:79], 0
  s_cselect_b64 s[68:69], s[80:81], 0
  s_waitcnt lgkmcnt(2)
  v_mfma_f32_16x16x32_bf16 v[100:103], v[20:23], v[84:87], 0
  v_mfma_f32_16x16x32_bf16 v[36:39], v[124:127], v[84:87], 0
  s_cmp_eq_u32 s59, 0
  s_cbranch_scc1 F_sw
  v_swap_b32 v54, v70
  v_swap_b32 v55, v71
  v_swap_b32 v56, v72
  v_swap_b32 v57, v73
  v_swap_b32 v58, v74
  v_swap_b32 v59, v75
  v_swap_b32 v60, v76
  v_swap_b32 v61, v77
F_sw:
  v_mov_b32 v12, 0xcfa8965f
  buffer_load_dwordx4 v218, s[12:15], s50 offen offset:2048 lds
  v_mov_b32 v14, 0x3e8293ee
  v_cndmask_b32 v194, v112, v113, s[76:77]
  v_cndmask_b32 v195, v114, v115, s[76:77]
  v_cndmask_b32 v192, v48, v49, s[76:77]
  v_cndmask_b32 v193, v50, v51, s[76:77]
  v_cndmask_b32 v190, v108, v109, s[76:77]
  v_cndmask_b32 v191, v110, v111, s[76:77]
  v_cndmask_b32 v188, v44, v45, s[76:77]
  v_cndmask_b32 v189, v46, v47, s[76:77]
  buffer_load_dwordx4 v219, s[12:15], s50 offen offset:3072 lds
  v_cndmask_b32 v186, v104, v105, s[76:77]
  v_cndmask_b32 v187, v106, v107, s[76:77]
  v_cndmask_b32 v184, v40, v41, s[76:77]
  v_cndmask_b32 v185, v42, v43, s[76:77]
  v_cndmask_b32 v182, v100, v101, s[76:77]
  v_cndmask_b32 v183, v102, v103, s[76:77]
  v_cndmask_b32 v180, v36, v37, s[76:77]
  v_cndmask_b32 v181, v38, v39, s[76:77]
  v_cndmask_b32 v192, v194, v192, s[78:79]
  s_mov_b32 s50, 262144
  s_add_u32 m0, s70, 98304
  s_nop 0
  buffer_load_dwordx4 v216, s[12:15], s50 offen offset:0 lds
  v_cndmask_b32 v193, v195, v193, s[80:81]
  v_cndmask_b32 v188, v190, v188, s[78:79]
  v_cndmask_b32 v189, v191, v189, s[80:81]
  v_cndmask_b32 v184, v186, v184, s[78:79]
  v_cndmask_b32 v185, v187, v185, s[80:81]
  v_cndmask_b32 v180, v182, v180, s[78:79]
  v_cndmask_b32 v181, v183, v181, s[80:81]
  v_cndmask_b32 v180, v180, v12, s[66:67]
  v_cndmask_b32 v181, v181, v12, s[68:69]
  buffer_load_dwordx4 v217, s[12:15], s50 offen offset:1024 lds
  v_max_f32 v194, v192, v193
  v_max_f32 v195, v192, v193
  v_max_f32 v190, v188, v189
  v_max_f32 v191, v188, v189
  v_max_f32 v186, v184, v185
  v_max_f32 v187, v184, v185
  v_max_f32 v182, v180, v181
  v_max_f32 v183, v180, v181
  v_permlane16_swap_b32 v194, v195
  buffer_load_dwordx4 v218, s[12:15], s50 offen offset:2048 lds
  v_permlane16_swap_b32 v190, v191
  v_permlane16_swap_b32 v186, v187
  v_permlane16_swap_b32 v182, v183
  v_max_f32 v194, v194, v195
  v_max_f32 v190, v190, v191
  v_max_f32 v186, v186, v187
  v_max_f32 v182, v182, v183
  v_mov_b32 v195, v194
  v_mov_b32 v191, v190
  buffer_load_dwordx4 v219, s[12:15], s50 offen offset:3072 lds
  v_mov_b32 v187, v186
  v_mov_b32 v183, v182
  v_permlane32_swap_b32 v194, v195
  v_permlane32_swap_b32 v190, v191
  v_permlane32_swap_b32 v186, v187
  v_permlane32_swap_b32 v182, v183
  v_max_f32 v194, v194, v195
  v_max_f32 v190, v190, v191
  v_max_f32 v186, v186, v187
  s_mov_b32 s50, 524288
  s_add_u32 m0, s70, 0
  s_nop 0
  buffer_load_dwordx4 v216, s[12:15], s50 offen offset:0 lds
  v_max_f32 v182, v182, v183
  v_mul_f32 v194, 0xbe8293ee, v194
  v_mul_f32 v190, 0xbe8293ee, v190
  v_mul_f32 v186, 0xbe8293ee, v186
  v_mul_f32 v182, 0xbe8293ee, v182
  v_pk_fma_f32 v[192:193], v[192:193], v[14:15], v[194:195] op_sel_hi:[1,0,0]
  v_pk_fma_f32 v[188:189], v[188:189], v[14:15], v[190:191] op_sel_hi:[1,0,0]
  v_pk_fma_f32 v[184:185], v[184:185], v[14:15], v[186:187] op_sel_hi:[1,0,0]
  v_pk_fma_f32 v[180:181], v[180:181], v[14:15], v[182:183] op_sel_hi:[1,0,0]
  buffer_load_dwordx4 v217, s[12:15], s50 offen offset:1024 lds
  v_exp_f32 v192, v192
  v_exp_f32 v193, v193
  v_exp_f32 v188, v188
  v_exp_f32 v189, v189
  v_exp_f32 v184, v184
  v_exp_f32 v185, v185
  v_exp_f32 v180, v180
  v_exp_f32 v181, v181
  v_add_f32 v194, v192, v193
  buffer_load_dwordx4 v218, s[12:15], s50 offen offset:2048 lds
  v_add_f32 v195, v192, v193
  v_add_f32 v190, v188, v189
  v_add_f32 v191, v188, v189
  v_add_f32 v186, v184, v185
  v_add_f32 v187, v184, v185
  v_add_f32 v182, v180, v181
  v_add_f32 v183, v180, v181
  v_permlane16_swap_b32 v194, v195
  v_permlane16_swap_b32 v190, v191
  buffer_load_dwordx4 v219, s[12:15], s50 offen offset:3072 lds
  v_permlane16_swap_b32 v186, v187
  v_permlane16_swap_b32 v182, v183
  v_add_f32 v194, v194, v195
  v_add_f32 v190, v190, v191
  v_add_f32 v186, v186, v187
  v_add_f32 v182, v182, v183
  v_mov_b32 v195, v194
  v_mov_b32 v191, v190
  v_mov_b32 v187, v186
  s_mov_b32 s50, 786432
  s_add_u32 m0, s70, 16384
  s_nop 0
  buffer_load_dwordx4 v216, s[12:15], s50 offen offset:0 lds
  v_mov_b32 v183, v182
  v_permlane32_swap_b32 v194, v195
  v_permlane32_swap_b32 v190, v191
  v_permlane32_swap_b32 v186, v187
  v_permlane32_swap_b32 v182, v183
  v_add_f32 v194, v194, v195
  v_add_f32 v190, v190, v191
  v_add_f32 v186, v186, v187
  v_add_f32 v182, v182, v183
  buffer_load_dwordx4 v217, s[12:15], s50 offen offset:1024 lds
  v_rcp_f32 v194, v194
  v_rcp_f32 v190, v190
  v_rcp_f32 v186, v186
  v_rcp_f32 v182, v182
  v_pk_mul_f32 v[192:193], v[192:193], v[194:195] op_sel_hi:[1,0]
  v_pk_mul_f32 v[188:189], v[188:189], v[190:191] op_sel_hi:[1,0]
  v_pk_mul_f32 v[184:185], v[184:185], v[186:187] op_sel_hi:[1,0]
  v_pk_mul_f32 v[180:181], v[180:181], v[182:183] op_sel_hi:[1,0]
  v_cvt_pk_bf16_f32 v192, v192, v193
  v_cvt_pk_bf16_f32 v188, v188, v189
  v_cvt_pk_bf16_f32 v184, v184, v185
  v_cvt_pk_bf16_f32 v180, v180, v181
  s_waitcnt lgkmcnt(0)
  v_perm_b32 v48, v192, v192, v228
  v_perm_b32 v49, v192, v192, v229
  v_perm_b32 v50, v192, v192, v230
  v_perm_b32 v51, v192, v192, v231
  v_perm_b32 v44, v188, v188, v228
  v_perm_b32 v45, v188, v188, v229
  v_perm_b32 v46, v188, v188, v230
  v_perm_b32 v47, v188, v188, v231
  v_mfma_f32_16x16x32_bf16 v[32:35], v[58:61], v[48:51], 0
  v_mfma_f32_16x16x32_bf16 v[96:99], v[74:77], v[48:51], 0
  v_perm_b32 v40, v184, v184, v228
  v_perm_b32 v41, v184, v184, v229
  v_perm_b32 v42, v184, v184, v230
  v_perm_b32 v43, v184, v184, v231
  v_mfma_f32_16x16x32_bf16 v[28:31], v[56:59], v[44:47], 0
  v_mfma_f32_16x16x32_bf16 v[92:95], v[72:75], v[44:47], 0
  v_perm_b32 v36, v180, v180, v228
  v_perm_b32 v37, v180, v180, v229
  v_perm_b32 v38, v180, v180, v230
  v_perm_b32 v39, v180, v180, v231
  v_mfma_f32_16x16x32_bf16 v[24:27], v[54:57], v[40:43], 0
  v_mfma_f32_16x16x32_bf16 v[88:91], v[70:73], v[40:43], 0
  s_nop 0
  v_mfma_f32_16x16x32_bf16 v[20:23], v[52:55], v[36:39], 0
  v_mfma_f32_16x16x32_bf16 v[84:87], v[68:71], v[36:39], 0
  v_cvt_pk_bf16_f32 v192, v32, v33
  v_cvt_pk_bf16_f32 v193, v34, v35
  v_cvt_pk_bf16_f32 v194, v96, v97
  v_cvt_pk_bf16_f32 v195, v98, v99
  buffer_store_dwordx4 v[192:195], v0, s[36:39], s72 offen offset:1024 sc1
  v_cvt_pk_bf16_f32 v188, v28, v29
  v_cvt_pk_bf16_f32 v189, v30, v31
  v_cvt_pk_bf16_f32 v190, v92, v93
  v_cvt_pk_bf16_f32 v191, v94, v95
  buffer_store_dwordx4 v[188:191], v0, s[36:39], s72 offen offset:0 sc1
  v_cvt_pk_bf16_f32 v184, v24, v25
  v_cvt_pk_bf16_f32 v185, v26, v27
  v_cvt_pk_bf16_f32 v186, v88, v89
  v_cvt_pk_bf16_f32 v187, v90, v91
  buffer_store_dwordx4 v[184:187], v0, s[36:39], s71 offen offset:1024 sc1
  v_cvt_pk_bf16_f32 v180, v20, v21
  v_cvt_pk_bf16_f32 v181, v22, v23
  v_cvt_pk_bf16_f32 v182, v84, v85
  v_cvt_pk_bf16_f32 v183, v86, v87
  buffer_store_dwordx4 v[180:183], v0, s[36:39], s71 offen offset:0 sc1
  s_waitcnt vmcnt(21)
  v_lshlrev_b32 v60, 16, v136
  v_and_b32 v61, 0xffff0000, v136
  v_lshlrev_b32 v62, 16, v137
  v_and_b32 v63, 0xffff0000, v137
  v_pk_mul_f32 v[52:53], v[60:61], v[168:169] op_sel_hi:[1,0]
  v_pk_mul_f32 v[54:55], v[62:63], v[168:169] op_sel_hi:[1,0]
  v_lshlrev_b32 v60, 16, v138
  v_and_b32 v61, 0xffff0000, v138
  v_lshlrev_b32 v62, 16, v139
  v_and_b32 v63, 0xffff0000, v139
  v_pk_mul_f32 v[56:57], v[60:61], v[168:169] op_sel_hi:[1,0]
  v_pk_mul_f32 v[58:59], v[62:63], v[168:169] op_sel_hi:[1,0]
  buffer_load_dwordx4 v218, s[12:15], s50 offen offset:2048 lds
  v_lshlrev_b32 v60, 16, v140
  v_and_b32 v61, 0xffff0000, v140
  v_lshlrev_b32 v62, 16, v141
  v_and_b32 v63, 0xffff0000, v141
  v_pk_fma_f32 v[52:53], v[60:61], v[168:169], v[52:53] op_sel:[0,1,0] op_sel_hi:[1,1,1]
  v_pk_fma_f32 v[54:55], v[62:63], v[168:169], v[54:55] op_sel:[0,1,0] op_sel_hi:[1,1,1]
  v_lshlrev_b32 v60, 16, v142
  v_and_b32 v61, 0xffff0000, v142
  v_lshlrev_b32 v62, 16, v143
  v_and_b32 v63, 0xffff0000, v143
  v_pk_fma_f32 v[56:57], v[60:61], v[168:169], v[56:57] op_sel:[0,1,0] op_sel_hi:[1,1,1]
  v_pk_fma_f32 v[58:59], v[62:63], v[168:169], v[58:59] op_sel:[0,1,0] op_sel_hi:[1,1,1]
  buffer_load_dwordx4 v219, s[12:15], s50 offen offset:3072 lds
  v_lshlrev_b32 v60, 16, v144
  v_and_b32 v61, 0xffff0000, v144
  v_lshlrev_b32 v62, 16, v145
  v_and_b32 v63, 0xffff0000, v145
  v_pk_fma_f32 v[52:53], v[60:61], v[170:171], v[52:53] op_sel:[0,0,0] op_sel_hi:[1,0,1]
  v_pk_fma_f32 v[54:55], v[62:63], v[170:171], v[54:55] op_sel:[0,0,0] op_sel_hi:[1,0,1]
  v_lshlrev_b32 v60, 16, v146
  v_and_b32 v61, 0xffff0000, v146
  v_lshlrev_b32 v62, 16, v147
  v_and_b32 v63, 0xffff0000, v147
  v_pk_fma_f32 v[56:57], v[60:61], v[170:171], v[56:57] op_sel:[0,0,0] op_sel_hi:[1,0,1]
  v_pk_fma_f32 v[58:59], v[62:63], v[170:171], v[58:59] op_sel:[0,0,0] op_sel_hi:[1,0,1]
  s_mov_b32 s50, 1048576
  s_add_u32 m0, s70, 32768
  s_nop 0
  buffer_load_dwordx4 v216, s[12:15], s50 offen offset:0 lds
  v_lshlrev_b32 v60, 16, v148
  v_and_b32 v61, 0xffff0000, v148
  v_lshlrev_b32 v62, 16, v149
  v_and_b32 v63, 0xffff0000, v149
  v_pk_fma_f32 v[52:53], v[60:61], v[170:171], v[52:53] op_sel:[0,1,0] op_sel_hi:[1,1,1]
  v_pk_fma_f32 v[54:55], v[62:63], v[170:171], v[54:55] op_sel:[0,1,0] op_sel_hi:[1,1,1]
  v_lshlrev_b32 v60, 16, v150
  v_and_b32 v61, 0xffff0000, v150
  v_lshlrev_b32 v62, 16, v151
  v_and_b32 v63, 0xffff0000, v151
  v_pk_fma_f32 v[56:57], v[60:61], v[170:171], v[56:57] op_sel:[0,1,0] op_sel_hi:[1,1,1]
  v_pk_fma_f32 v[58:59], v[62:63], v[170:171], v[58:59] op_sel:[0,1,0] op_sel_hi:[1,1,1]
  buffer_load_dwordx4 v217, s[12:15], s50 offen offset:1024 lds
  v_lshlrev_b32 v60, 16, v152
  v_and_b32 v61, 0xffff0000, v152
  v_lshlrev_b32 v62, 16, v153
  v_and_b32 v63, 0xffff0000, v153
  v_pk_fma_f32 v[52:53], v[60:61], v[172:173], v[52:53] op_sel:[0,0,0] op_sel_hi:[1,0,1]
  v_pk_fma_f32 v[54:55], v[62:63], v[172:173], v[54:55] op_sel:[0,0,0] op_sel_hi:[1,0,1]
  v_lshlrev_b32 v60, 16, v154
  v_and_b32 v61, 0xffff0000, v154
  v_lshlrev_b32 v62, 16, v155
  v_and_b32 v63, 0xffff0000, v155
  v_pk_fma_f32 v[56:57], v[60:61], v[172:173], v[56:57] op_sel:[0,0,0] op_sel_hi:[1,0,1]
  v_pk_fma_f32 v[58:59], v[62:63], v[172:173], v[58:59] op_sel:[0,0,0] op_sel_hi:[1,0,1]
  buffer_load_dwordx4 v218, s[12:15], s50 offen offset:2048 lds
  v_lshlrev_b32 v60, 16, v156
  v_and_b32 v61, 0xffff0000, v156
  v_lshlrev_b32 v62, 16, v157
  v_and_b32 v63, 0xffff0000, v157
  v_pk_fma_f32 v[52:53], v[60:61], v[172:173], v[52:53] op_sel:[0,1,0] op_sel_hi:[1,1,1]
  v_pk_fma_f32 v[54:55], v[62:63], v[172:173], v[54:55] op_sel:[0,1,0] op_sel_hi:[1,1,1]
  v_lshlrev_b32 v60, 16, v158
  v_and_b32 v61, 0xffff0000, v158
  v_lshlrev_b32 v62, 16, v159
  v_and_b32 v63, 0xffff0000, v159
  v_pk_fma_f32 v[56:57], v[60:61], v[172:173], v[56:57] op_sel:[0,1,0] op_sel_hi:[1,1,1]
  v_pk_fma_f32 v[58:59], v[62:63], v[172:173], v[58:59] op_sel:[0,1,0] op_sel_hi:[1,1,1]
  buffer_load_dwordx4 v219, s[12:15], s50 offen offset:3072 lds
  v_lshlrev_b32 v60, 16, v160
  v_and_b32 v61, 0xffff0000, v160
  v_lshlrev_b32 v62, 16, v161
  v_and_b32 v63, 0xffff0000, v161
  v_pk_fma_f32 v[52:53], v[60:61], v[174:175], v[52:53] op_sel:[0,0,0] op_sel_hi:[1,0,1]
  v_pk_fma_f32 v[54:55], v[62:63], v[174:175], v[54:55] op_sel:[0,0,0] op_sel_hi:[1,0,1]
  v_lshlrev_b32 v60, 16, v162
  v_and_b32 v61, 0xffff0000, v162
  v_lshlrev_b32 v62, 16, v163
  v_and_b32 v63, 0xffff0000, v163
  v_pk_fma_f32 v[56:57], v[60:61], v[174:175], v[56:57] op_sel:[0,0,0] op_sel_hi:[1,0,1]
  v_pk_fma_f32 v[58:59], v[62:63], v[174:175], v[58:59] op_sel:[0,0,0] op_sel_hi:[1,0,1]
  v_lshlrev_b32 v60, 16, v164
  v_and_b32 v61, 0xffff0000, v164
  v_lshlrev_b32 v62, 16, v165
  v_and_b32 v63, 0xffff0000, v165
  v_pk_fma_f32 v[52:53], v[60:61], v[174:175], v[52:53] op_sel:[0,1,0] op_sel_hi:[1,1,1]
  v_pk_fma_f32 v[54:55], v[62:63], v[174:175], v[54:55] op_sel:[0,1,0] op_sel_hi:[1,1,1]
  v_lshlrev_b32 v60, 16, v166
  v_and_b32 v61, 0xffff0000, v166
  v_lshlrev_b32 v62, 16, v167
  v_and_b32 v63, 0xffff0000, v167
  v_pk_fma_f32 v[56:57], v[60:61], v[174:175], v[56:57] op_sel:[0,1,0] op_sel_hi:[1,1,1]
  v_pk_fma_f32 v[58:59], v[62:63], v[174:175], v[58:59] op_sel:[0,1,0] op_sel_hi:[1,1,1]
  s_nop 0
  v_permlane32_swap_b32 v52, v56
  v_permlane32_swap_b32 v53, v57
  v_permlane32_swap_b32 v54, v58
  v_permlane32_swap_b32 v55, v59
  v_add_f32 v52, v52, v56
  v_add_f32 v53, v53, v57
  v_add_f32 v54, v54, v58
  v_add_f32 v55, v55, v59
  s_nop 0
  v_permlane16_swap_b32 v52, v54
  v_permlane16_swap_b32 v53, v55
  v_add_f32 v52, v52, v54
  v_add_f32 v53, v53, v55
  v_add_u32 v60, 162816, v178
  v_add_f32_dpp v52, v52, v52 row_ror:8 row_mask:0xf bank_mask:0xf
  v_add_f32_dpp v53, v53, v53 row_ror:8 row_mask:0xf bank_mask:0xf
  ds_write_b64 v177, v[52:53]
  v_mov_b32 v12, s3
  s_waitcnt vmcnt(6) lgkmcnt(0)
  s_barrier
  s_mov_b64 exec, 1
  buffer_store_dword v12, v0, s[36:39], s45 offen sc1
  s_mov_b64 exec, -1
  ds_read_b32 v52, v60 offset:0
  ds_read_b32 v53, v60 offset:256
  ds_read_b32 v54, v60 offset:512
  ds_read_b32 v55, v60 offset:768
  s_cmp_eq_u32 s44, 1
  s_cselect_b32 s49, s56, 1073741824
  s_lshl_b32 s45, s2, 7
  s_add_u32 s45, s45, 5341184
  s_cmp_eq_u32 s44, 0
  s_cselect_b32 s45, s45, 1073741824
  s_waitcnt lgkmcnt(0)
  v_add_f32 v52, v52, v53
  v_add_f32 v54, v54, v55
  v_add_f32 v52, v52, v54
  buffer_store_dword v52, v178, s[36:39], s49 offen sc1
  s_mov_b32 s50, 1310720
  s_add_u32 m0, s70, 49152
  s_nop 0
  buffer_load_dwordx4 v216, s[12:15], s50 offen offset:0 lds
  buffer_load_dwordx4 v217, s[12:15], s50 offen offset:1024 lds
  buffer_load_dwordx4 v218, s[12:15], s50 offen offset:2048 lds
  buffer_load_dwordx4 v219, s[12:15], s50 offen offset:3072 lds
  s_mov_b32 s50, 1572864
  s_add_u32 m0, s70, 65536
  s_nop 0
  buffer_load_dwordx4 v216, s[12:15], s50 offen offset:0 lds
  buffer_load_dwordx4 v217, s[12:15], s50 offen offset:1024 lds
  buffer_load_dwordx4 v218, s[12:15], s50 offen offset:2048 lds
  buffer_load_dwordx4 v219, s[12:15], s50 offen offset:3072 lds
  s_mov_b32 s50, 1835008
  s_add_u32 m0, s70, 114688
  s_nop 0
  buffer_load_dwordx4 v216, s[12:15], s50 offen offset:0 lds
  buffer_load_dwordx4 v217, s[12:15], s50 offen offset:1024 lds
  buffer_load_dwordx4 v218, s[12:15], s50 offen offset:2048 lds
  buffer_load_dwordx4 v219, s[12:15], s50 offen offset:3072 lds
  s_add_u32 m0, s70, 131072
  s_nop 0
  buffer_load_dwordx4 v220, s[4:7], s55 offen offset:0 lds
  buffer_load_dwordx4 v221, s[4:7], s55 offen offset:1024 lds
  s_add_u32 m0, s70, 133120
  s_add_u32 s48, s55, 32768
  buffer_load_dwordx4 v220, s[4:7], s48 offen offset:0 lds
  buffer_load_dwordx4 v221, s[4:7], s48 offen offset:1024 lds
  ds_read_b64_tr_b16 a[176:177], v236 offset:16384
  ds_read_b64_tr_b16 a[178:179], v236 offset:18432
  ds_read_b64_tr_b16 a[180:181], v236 offset:20480
  ds_read_b64_tr_b16 a[182:183], v236 offset:22528
  ds_read_b64_tr_b16 a[184:185], v237 offset:16384
  ds_read_b64_tr_b16 a[186:187], v237 offset:18432
  ds_read_b64_tr_b16 a[188:189], v237 offset:20480
  ds_read_b64_tr_b16 a[190:191], v237 offset:22528
  ds_read_b64_tr_b16 a[192:193], v238 offset:16384
  ds_read_b64_tr_b16 a[194:195], v238 offset:18432
  ds_read_b64_tr_b16 a[196:197], v238 offset:20480
  ds_read_b64_tr_b16 a[198:199], v238 offset:22528
  ds_read_b64_tr_b16 a[200:201], v239 offset:16384
  ds_read_b64_tr_b16 a[202:203], v239 offset:18432
  ds_read_b64_tr_b16 a[204:205], v239 offset:20480
  ds_read_b64_tr_b16 a[206:207], v239 offset:22528
  ds_read_b64_tr_b16 a[208:209], v236 offset:24576
  ds_read_b64_tr_b16 a[210:211], v236 offset:26624
  ds_read_b64_tr_b16 a[212:213], v236 offset:28672
  ds_read_b64_tr_b16 a[214:215], v236 offset:30720
  ds_read_b64_tr_b16 a[216:217], v237 offset:24576
  ds_read_b64_tr_b16 a[218:219], v237 offset:26624
  ds_read_b64_tr_b16 a[220:221], v237 offset:28672
  ds_read_b64_tr_b16 a[222:223], v237 offset:30720
  ds_read_b64_tr_b16 a[224:225], v238 offset:24576
  ds_read_b64_tr_b16 a[226:227], v238 offset:26624
  ds_read_b64_tr_b16 a[228:229], v238 offset:28672
  ds_read_b64_tr_b16 a[230:231], v238 offset:30720
  s_mov_b64 exec, 0
  s_cmp_eq_u32 s44, 1
  s_cbranch_scc1 Hc0
  s_cmp_eq_u32 s44, 2
  s_cbranch_scc1 Hc1
  s_cmp_eq_u32 s44, 3
  s_cbranch_scc1 Hc2
Rc:
  s_mov_b64 exec, -1
  s_cmp_lg_u32 s44, 0
  s_cbranch_scc1 SM3x
  s_mov_b32 s46, 60000
  s_mov_b32 s47, 5242880
SM3:
  buffer_load_dword v13, v250, s[36:39], s47 offen sc1
  s_sub_u32 s46, s46, 1
  s_cmp_eq_u32 s46, 0
  s_waitcnt vmcnt(0)
  s_cbranch_scc1 SM3x
  v_cmp_ne_u32 vcc, s3, v13
  s_nop 4
  s_cbranch_vccnz SM3
SM3x:
  s_waitcnt vmcnt(0)
  s_barrier
  buffer_load_dwordx4 a[0:3], v244, s[36:39], 0 offen offset:0 sc1
  buffer_load_dwordx4 a[8:11], v244, s[36:39], 0 offen offset:2048 sc1
  buffer_load_dwordx4 a[4:7], v244, s[36:39], 0 offen offset:1024 sc1
  buffer_load_dwordx4 a[12:15], v244, s[36:39], 0 offen offset:3072 sc1
  s_mov_b32 s50, 4096
  buffer_load_dwordx4 a[16:19], v244, s[36:39], s50 offen offset:0 sc1
  buffer_load_dwordx4 a[20:23], v244, s[36:39], s50 offen offset:1024 sc1
  buffer_load_dwordx4 a[24:27], v244, s[36:39], s50 offen offset:2048 sc1
  buffer_load_dwordx4 a[28:31], v244, s[36:39], s50 offen offset:3072 sc1
  ds_read_b64 v[116:117], v240 offset:0
  ds_read_b64 v[118:119], v241 offset:0
  ds_read_b64 v[120:121], v242 offset:0
  ds_read_b64 v[122:123], v243 offset:0
  ds_read_b64 v[124:125], v240 offset:2048
  ds_read_b64 v[126:127], v241 offset:2048
  ds_read_b64 v[128:129], v242 offset:2048
  ds_read_b64 v[130:131], v243 offset:2048
  v_lshrrev_b32 v13, 4, v10
  v_cmp_eq_u32 vcc, 2, v13
  s_add_u32 s51, s73, 65536
  v_mov_b32 v12, s3
  v_cndmask_b32 v13, 0, 1.0, vcc
  s_waitcnt lgkmcnt(0)
  v_lshlrev_b32 v52, 16, v116
  v_and_b32 v53, 0xffff0000, v116
  v_lshlrev_b32 v54, 16, v117
  v_and_b32 v55, 0xffff0000, v117
  v_lshlrev_b32 v56, 16, v118
  v_and_b32 v57, 0xffff0000, v118
  v_lshlrev_b32 v58, 16, v119
  v_and_b32 v59, 0xffff0000, v119
  v_lshlrev_b32 v60, 16, v120
  v_and_b32 v61, 0xffff0000, v120
  v_lshlrev_b32 v62, 16, v121
  v_and_b32 v63, 0xffff0000, v121
  v_lshlrev_b32 v64, 16, v122
  v_and_b32 v65, 0xffff0000, v122
  v_lshlrev_b32 v66, 16, v123
  v_and_b32 v67, 0xffff0000, v123
  v_lshlrev_b32 v68, 16, v124
  v_and_b32 v69, 0xffff0000, v124
  v_lshlrev_b32 v70, 16, v125
  v_and_b32 v71, 0xffff0000, v125
  v_lshlrev_b32 v72, 16, v126
  v_and_b32 v73, 0xffff0000, v126
  v_lshlrev_b32 v74, 16, v127
  v_and_b32 v75, 0xffff0000, v127
  v_lshlrev_b32 v76, 16, v128
  v_and_b32 v77, 0xffff0000, v128
  v_lshlrev_b32 v78, 16, v129
  v_and_b32 v79, 0xffff0000, v129
  v_lshlrev_b32 v80, 16, v130
  v_and_b32 v81, 0xffff0000, v130
  v_lshlrev_b32 v82, 16, v131
  v_and_b32 v83, 0xffff0000, v131
  s_waitcnt vmcnt(7) lgkmcnt(15)
  v_mfma_f32_16x16x32_bf16 v[20:23], a[176:179], a[0:3], 0
  s_waitcnt vmcnt(6)
  s_mov_b32 s50, 8192
  buffer_load_dwordx4 a[32:35], v244, s[36:39], s50 offen offset:0 sc1
  v_mfma_f32_16x16x32_bf16 v[20:23], a[180:183], a[8:11], v[20:23]
  s_waitcnt vmcnt(5)
  v_mfma_f32_16x16x32_bf16 v[24:27], a[180:183], a[12:15], 0
  s_waitcnt vmcnt(6)
  buffer_load_dwordx4 a[36:39], v244, s[36:39], s50 offen offset:1024 sc1
  v_mfma_f32_16x16x32_bf16 v[24:27], a[176:179], a[4:7], v[24:27]
  s_waitcnt lgkmcnt(15)
  ds_read_b64_tr_b16 a[176:177], v239 offset:24576
  ds_read_b64_tr_b16 a[178:179], v239 offset:26624
  v_mfma_f32_16x16x32_bf16 v[32:35], a[184:187], a[4:7], 0
  ds_read_b64_tr_b16 a[180:181], v239 offset:28672
  ds_read_b64_tr_b16 a[182:183], v239 offset:30720
  v_mfma_f32_16x16x32_bf16 v[32:35], a[188:191], a[12:15], v[32:35]
  buffer_load_dwordx4 a[40:43], v244, s[36:39], s50 offen offset:2048 sc1
  v_mfma_f32_16x16x32_bf16 v[28:31], a[188:191], a[8:11], 0
  buffer_load_dwordx4 a[44:47], v244, s[36:39], s50 offen offset:3072 sc1
  v_mfma_f32_16x16x32_bf16 v[28:31], a[184:187], a[0:3], v[28:31]
  s_waitcnt lgkmcnt(15)
  s_mov_b32 s50, 12288
  ds_read_b64_tr_b16 a[184:185], v236 offset:32768
  v_mfma_f32_16x16x32_bf16 v[36:39], a[192:195], a[0:3], 0
  ds_read_b64_tr_b16 a[186:187], v236 offset:34816
  ds_read_b64_tr_b16 a[188:189], v236 offset:36864
  v_mfma_f32_16x16x32_bf16 v[36:39], a[196:199], a[8:11], v[36:39]
  ds_read_b64_tr_b16 a[190:191], v236 offset:38912
  buffer_load_dwordx4 a[48:51], v244, s[36:39], s50 offen offset:0 sc1
  v_mfma_f32_16x16x32_bf16 v[40:43], a[196:199], a[12:15], 0
  buffer_load_dwordx4 a[52:55], v244, s[36:39], s50 offen offset:1024 sc1
  v_mfma_f32_16x16x32_bf16 v[40:43], a[192:195], a[4:7], v[40:43]
  s_waitcnt lgkmcnt(15)
  ds_read_b64_tr_b16 a[192:193], v237 offset:32768
  ds_read_b64_tr_b16 a[194:195], v237 offset:34816
  v_mfma_f32_16x16x32_bf16 v[48:51], a[200:203], a[4:7], 0
  s_mov_b32 s49, 0
  ds_read_b64_tr_b16 a[196:197], v237 offset:36864
  ds_read_b64_tr_b16 a[198:199], v237 offset:38912
  v_mfma_f32_16x16x32_bf16 v[48:51], a[204:207], a[12:15], v[48:51]
  buffer_load_dwordx4 a[56:59], v244, s[36:39], s50 offen offset:2048 sc1
  buffer_load_dwordx4 v[156:159], v249, s[36:39], s49 offen sc1
  v_mfma_f32_16x16x32_bf16 v[44:47], a[204:207], a[8:11], 0
  s_mov_b32 s49, 24576
  buffer_load_dwordx4 v[160:163], v249, s[36:39], s49 offen sc1
  s_mov_b32 s49, 49152
  v_mfma_f32_16x16x32_bf16 v[44:47], a[200:203], a[0:3], v[44:47]
  s_waitcnt vmcnt(9) lgkmcnt(15)
  buffer_load_dwordx4 v[164:167], v249, s[36:39], s49 offen sc1
  s_mov_b32 s49, 73728
  v_mfma_f32_16x16x32_bf16 v[20:23], a[208:211], a[16:19], v[20:23]
  buffer_load_dwordx4 v[168:171], v249, s[36:39], s49 offen sc1
  buffer_load_dwordx4 a[60:63], v244, s[36:39], s50 offen offset:3072 sc1
  v_mfma_f32_16x16x32_bf16 v[20:23], a[212:215], a[24:27], v[20:23]
  s_mov_b32 s50, 16384
  ds_read_b64_tr_b16 a[200:201], v238 offset:32768
  ds_read_b64_tr_b16 a[202:203], v238 offset:34816
  v_mfma_f32_16x16x32_bf16 v[24:27], a[212:215], a[28:31], v[24:27]
  ds_read_b64_tr_b16 a[204:205], v238 offset:36864
  ds_read_b64_tr_b16 a[206:207], v238 offset:38912
  v_mfma_f32_16x16x32_bf16 v[24:27], a[208:211], a[20:23], v[24:27]
  s_waitcnt lgkmcnt(15)
  buffer_load_dwordx4 a[64:67], v244, s[36:39], s50 offen offset:0 sc1
  buffer_load_dwordx4 a[68:71], v244, s[36:39], s50 offen offset:1024 sc1
  v_mfma_f32_16x16x32_bf16 v[32:35], a[216:219], a[20:23], v[32:35]
  ds_read_b64_tr_b16 a[208:209], v239 offset:32768
  ds_read_b64_tr_b16 a[210:211], v239 offset:34816
  v_mfma_f32_16x16x32_bf16 v[32:35], a[220:223], a[28:31], v[32:35]
  ds_read_b64_tr_b16 a[212:213], v239 offset:36864
  ds_read_b64_tr_b16 a[214:215], v239 offset:38912
  v_mfma_f32_16x16x32_bf16 v[28:31], a[220:223], a[24:27], v[28:31]
  buffer_load_dwordx4 a[72:75], v244, s[36:39], s50 offen offset:2048 sc1
  buffer_load_dwordx4 a[76:79], v244, s[36:39], s50 offen offset:3072 sc1
  v_mfma_f32_16x16x32_bf16 v[28:31], a[216:219], a[16:19], v[28:31]
  s_waitcnt lgkmcnt(15)
  s_mov_b32 s50, 20480
  ds_read_b64_tr_b16 a[216:217], v236 offset:40960
  v_mfma_f32_16x16x32_bf16 v[36:39], a[224:227], a[16:19], v[36:39]
  ds_read_b64_tr_b16 a[218:219], v236 offset:43008
  ds_read_b64_tr_b16 a[220:221], v236 offset:45056
  v_mfma_f32_16x16x32_bf16 v[36:39], a[228:231], a[24:27], v[36:39]
  ds_read_b64_tr_b16 a[222:223], v236 offset:47104
  buffer_load_dwordx4 a[80:83], v244, s[36:39], s50 offen offset:0 sc1
  v_mfma_f32_16x16x32_bf16 v[40:43], a[228:231], a[28:31], v[40:43]
  buffer_load_dwordx4 a[84:87], v244, s[36:39], s50 offen offset:1024 sc1
  v_mfma_f32_16x16x32_bf16 v[40:43], a[224:227], a[20:23], v[40:43]
  s_waitcnt lgkmcnt(15)
  ds_read_b64_tr_b16 a[224:225], v237 offset:40960
  ds_read_b64_tr_b16 a[226:227], v237 offset:43008
  v_mfma_f32_16x16x32_bf16 v[48:51], a[176:179], a[20:23], v[48:51]
  ds_read_b64_tr_b16 a[228:229], v237 offset:45056
  ds_read_b64_tr_b16 a[230:231], v237 offset:47104
  v_mfma_f32_16x16x32_bf16 v[48:51], a[180:183], a[28:31], v[48:51]
  buffer_load_dwordx4 a[88:91], v244, s[36:39], s50 offen offset:2048 sc1
  v_mfma_f32_16x16x32_bf16 v[44:47], a[180:183], a[24:27], v[44:47]
  buffer_load_dwordx4 a[92:95], v244, s[36:39], s50 offen offset:3072 sc1
  v_mfma_f32_16x16x32_bf16 v[44:47], a[176:179], a[16:19], v[44:47]
  s_waitcnt vmcnt(16) lgkmcnt(15)
  s_mov_b32 s50, 24576
  ds_read_b64_tr_b16 a[176:177], v238 offset:40960
  v_mfma_f32_16x16x32_bf16 v[20:23], a[184:187], a[32:35], v[20:23]
  ds_read_b64_tr_b16 a[178:179], v238 offset:43008
  ds_read_b64_tr_b16 a[180:181], v238 offset:45056
  v_mfma_f32_16x16x32_bf16 v[20:23], a[188:191], a[40:43], v[20:23]
  buffer_load_dwordx4 a[96:99], v244, s[36:39], s50 offen offset:0 sc1
  ds_read_b64_tr_b16 a[182:183], v238 offset:47104
  v_mfma_f32_16x16x32_bf16 v[24:27], a[188:191], a[44:47], v[24:27]
  buffer_load_dwordx4 a[100:103], v244, s[36:39], s50 offen offset:1024 sc1
  v_mfma_f32_16x16x32_bf16 v[24:27], a[184:187], a[36:39], v[24:27]
  s_waitcnt lgkmcnt(15)
  ds_read_b64_tr_b16 a[184:185], v239 offset:40960
  ds_read_b64_tr_b16 a[186:187], v239 offset:43008
  v_mfma_f32_16x16x32_bf16 v[32:35], a[192:195], a[36:39], v[32:35]
  ds_read_b64_tr_b16 a[188:189], v239 offset:45056
  buffer_load_dwordx4 a[104:107], v244, s[36:39], s50 offen offset:2048 sc1
  v_mfma_f32_16x16x32_bf16 v[32:35], a[196:199], a[44:47], v[32:35]
  ds_read_b64_tr_b16 a[190:191], v239 offset:47104
  v_mfma_f32_16x16x32_bf16 v[28:31], a[196:199], a[40:43], v[28:31]
  buffer_load_dwordx4 a[108:111], v244, s[36:39], s50 offen offset:3072 sc1
  v_mfma_f32_16x16x32_bf16 v[28:31], a[192:195], a[32:35], v[28:31]
  s_waitcnt lgkmcnt(15)
  s_mov_b32 s50, 28672
  ds_read_b64_tr_b16 a[192:193], v232 offset:0
  v_mfma_f32_16x16x32_bf16 v[36:39], a[200:203], a[32:35], v[36:39]
Ha2_1:
  s_cbranch_execz Ra
  ds_read_b64_tr_b16 a[194:195], v232 offset:2048
  ds_read_b64_tr_b16 a[196:197], v232 offset:4096
  v_mfma_f32_16x16x32_bf16 v[36:39], a[204:207], a[40:43], v[36:39]
  buffer_load_dwordx4 a[112:115], v244, s[36:39], s50 offen offset:0 sc1
  ds_read_b64_tr_b16 a[198:199], v232 offset:6144
  v_mfma_f32_16x16x32_bf16 v[40:43], a[204:207], a[44:47], v[40:43]
  buffer_load_dwordx4 a[116:119], v244, s[36:39], s50 offen offset:1024 sc1
  v_mfma_f32_16x16x32_bf16 v[40:43], a[200:203], a[36:39], v[40:43]
  s_waitcnt lgkmcnt(15)
  ds_read_b64_tr_b16 a[200:201], v233 offset:0
  ds_read_b64_tr_b16 a[202:203], v233 offset:2048
  v_mfma_f32_16x16x32_bf16 v[48:51], a[208:211], a[36:39], v[48:51]
  ds_read_b64_tr_b16 a[204:205], v233 offset:4096
  buffer_load_dwordx4 a[120:123], v244, s[36:39], s50 offen offset:2048 sc1
  v_mfma_f32_16x16x32_bf16 v[48:51], a[212:215], a[44:47], v[48:51]
  ds_read_b64_tr_b16 a[206:207], v233 offset:6144
  v_mfma_f32_16x16x32_bf16 v[44:47], a[212:215], a[40:43], v[44:47]
  buffer_load_dwordx4 a[124:127], v244, s[36:39], s50 offen offset:3072 sc1
  v_mfma_f32_16x16x32_bf16 v[44:47], a[208:211], a[32:35], v[44:47]
  s_waitcnt vmcnt(16) lgkmcnt(15)
  ds_read_b64_tr_b16 a[208:209], v234 offset:0
  ds_read_b64_tr_b16 a[210:211], v234 offset:2048
  v_mfma_f32_16x16x32_bf16 v[20:23], a[216:219], a[48:51], v[20:23]
  s_mov_b32 s50, 32768
  ds_read_b64_tr_b16 a[212:213], v234 offset:4096
  ds_read_b64_tr_b16 a[214:215], v234 offset:6144
  v_mfma_f32_16x16x32_bf16 v[20:23], a[220:223], a[56:59], v[20:23]
  buffer_load_dwordx4 a[128:131], v244, s[36:39], s50 offen offset:0 sc1
  v_mfma_f32_16x16x32_bf16 v[24:27], a[220:223], a[60:63], v[24:27]
  v_mfma_f32_16x16x32_bf16 v[24:27], a[216:219], a[52:55], v[24:27]
  s_waitcnt lgkmcnt(15)
  ds_read_b64_tr_b16 a[216:217], v235 offset:0
  ds_read_b64_tr_b16 a[218:219], v235 offset:2048
  v_mfma_f32_16x16x32_bf16 v[32:35], a[224:227], a[52:55], v[32:35]
  ds_read_b64_tr_b16 a[220:221], v235 offset:4096
  ds_read_b64_tr_b16 a[222:223], v235 offset:6144
  v_mfma_f32_16x16x32_bf16 v[32:35], a[228:231], a[60:63], v[32:35]
  buffer_load_dwordx4 a[132:135], v244, s[36:39], s50 offen offset:1024 sc1
  v_mfma_f32_16x16x32_bf16 v[28:31], a[228:231], a[56:59], v[28:31]
  v_mfma_f32_16x16x32_bf16 v[28:31], a[224:227], a[48:51], v[28:31]
  s_waitcnt lgkmcnt(15)
  ds_read_b64_tr_b16 a[224:225], v232 offset:8192
  ds_read_b64_tr_b16 a[226:227], v232 offset:10240
  v_mfma_f32_16x16x32_bf16 v[36:39], a[176:179], a[48:51], v[36:39]
  ds_read_b64_tr_b16 a[228:229], v232 offset:12288
  ds_read_b64_tr_b16 a[230:231], v232 offset:14336
  v_mfma_f32_16x16x32_bf16 v[36:39], a[180:183], a[56:59], v[36:39]
  buffer_load_dwordx4 a[136:139], v244, s[36:39], s50 offen offset:2048 sc1
  v_mfma_f32_16x16x32_bf16 v[40:43], a[180:183], a[60:63], v[40:43]
  v_mfma_f32_16x16x32_bf16 v[40:43], a[176:179], a[52:55], v[40:43]
  s_waitcnt lgkmcnt(15)
  ds_read_b64_tr_b16 a[176:177], v233 offset:8192
  ds_read_b64_tr_b16 a[178:179], v233 offset:10240
  v_mfma_f32_16x16x32_bf16 v[48:51], a[184:187], a[52:55], v[48:51]
  ds_read_b64_tr_b16 a[180:181], v233 offset:12288
  v_mfma_f32_16x16x32_bf16 v[48:51], a[188:191], a[60:63], v[48:51]
  buffer_load_dwordx4 a[140:143], v244, s[36:39], s50 offen offset:3072 sc1
  ds_read_b64_tr_b16 a[182:183], v233 offset:14336
  v_mfma_f32_16x16x32_bf16 v[44:47], a[188:191], a[56:59], v[44:47]
  v_mfma_f32_16x16x32_bf16 v[44:47], a[184:187], a[48:51], v[44:47]
  s_waitcnt vmcnt(16) lgkmcnt(15)
  ds_read_b64_tr_b16 a[184:185], v234 offset:8192
  ds_read_b64_tr_b16 a[186:187], v234 offset:10240
  v_mfma_f32_16x16x32_bf16 v[20:23], a[192:195], a[64:67], v[20:23]
  s_mov_b32 s50, 36864
  ds_read_b64_tr_b16 a[188:189], v234 offset:12288
  v_mfma_f32_16x16x32_bf16 v[20:23], a[196:199], a[72:75], v[20:23]
  buffer_load_dwordx4 a[144:147], v244, s[36:39], s50 offen offset:0 sc1
  ds_read_b64_tr_b16 a[190:191], v234 offset:14336
  v_mfma_f32_16x16x32_bf16 v[24:27], a[196:199], a[76:79], v[24:27]
  v_mfma_f32_16x16x32_bf16 v[24:27], a[192:195], a[68:71], v[24:27]
  s_waitcnt lgkmcnt(15)
  ds_read_b64_tr_b16 a[192:193], v235 offset:8192
  ds_read_b64_tr_b16 a[194:195], v235 offset:10240
  v_mfma_f32_16x16x32_bf16 v[32:35], a[200:203], a[68:71], v[32:35]
  ds_read_b64_tr_b16 a[196:197], v235 offset:12288
  v_mfma_f32_16x16x32_bf16 v[32:35], a[204:207], a[76:79], v[32:35]
  buffer_load_dwordx4 a[148:151], v244, s[36:39], s50 offen offset:1024 sc1
  ds_read_b64_tr_b16 a[198:199], v235 offset:14336
  v_mfma_f32_16x16x32_bf16 v[28:31], a[204:207], a[72:75], v[28:31]
  v_mfma_f32_16x16x32_bf16 v[28:31], a[200:203], a[64:67], v[28:31]
  s_waitcnt lgkmcnt(15)
  ds_read_b64_tr_b16 a[200:201], v232 offset:16384
  ds_read_b64_tr_b16 a[202:203], v232 offset:18432
  v_mfma_f32_16x16x32_bf16 v[36:39], a[208:211], a[64:67], v[36:39]
  ds_read_b64_tr_b16 a[204:205], v232 offset:20480
  v_mfma_f32_16x16x32_bf16 v[36:39], a[212:215], a[72:75], v[36:39]
  buffer_load_dwordx4 a[152:155], v244, s[36:39], s50 offen offset:2048 sc1
  ds_read_b64_tr_b16 a[206:207], v232 offset:22528
  v_mfma_f32_16x16x32_bf16 v[40:43], a[212:215], a[76:79], v[40:43]
  v_mfma_f32_16x16x32_bf16 v[40:43], a[208:211], a[68:71], v[40:43]
  s_waitcnt lgkmcnt(15)
  ds_read_b64_tr_b16 a[208:209], v233 offset:16384
  ds_read_b64_tr_b16 a[210:211], v233 offset:18432
  v_mfma_f32_16x16x32_bf16 v[48:51], a[216:219], a[68:71], v[48:51]
  ds_read_b64_tr_b16 a[212:213], v233 offset:20480
  v_mfma_f32_16x16x32_bf16 v[48:51], a[220:223], a[76:79], v[48:51]
  buffer_load_dwordx4 a[156:159], v244, s[36:39], s50 offen offset:3072 sc1
  ds_read_b64_tr_b16 a[214:215], v233 offset:22528
  v_mfma_f32_16x16x32_bf16 v[44:47], a[220:223], a[72:75], v[44:47]
  v_mfma_f32_16x16x32_bf16 v[44:47], a[216:219], a[64:67], v[44:47]
  s_waitcnt vmcnt(16) lgkmcnt(15)
  ds_read_b64_tr_b16 a[216:217], v234 offset:16384
  ds_read_b64_tr_b16 a[218:219], v234 offset:18432
  v_mfma_f32_16x16x32_bf16 v[20:23], a[224:227], a[80:83], v[20:23]
  s_mov_b32 s50, 40960
  ds_read_b64_tr_b16 a[220:221], v234 offset:20480
  v_mfma_f32_16x16x32_bf16 v[20:23], a[228:231], a[88:91], v[20:23]
  buffer_load_dwordx4 a[160:163], v244, s[36:39], s50 offen offset:0 sc1
  ds_read_b64_tr_b16 a[222:223], v234 offset:22528
  v_mfma_f32_16x16x32_bf16 v[24:27], a[228:231], a[92:95], v[24:27]
  v_mfma_f32_16x16x32_bf16 v[24:27], a[224:227], a[84:87], v[24:27]
  s_waitcnt lgkmcnt(15)
  ds_read_b64_tr_b16 a[224:225], v235 offset:16384
  ds_read_b64_tr_b16 a[226:227], v235 offset:18432
  v_mfma_f32_16x16x32_bf16 v[32:35], a[176:179], a[84:87], v[32:35]
  ds_read_b64_tr_b16 a[228:229], v235 offset:20480
  v_mfma_f32_16x16x32_bf16 v[32:35], a[180:183], a[92:95], v[32:35]
  buffer_load_dwordx4 a[164:167], v244, s[36:39], s50 offen offset:1024 sc1
  ds_read_b64_tr_b16 a[230:231], v235 offset:22528
  v_mfma_f32_16x16x32_bf16 v[28:31], a[180:183], a[88:91], v[28:31]
  v_mfma_f32_16x16x32_bf16 v[28:31], a[176:179], a[80:83], v[28:31]
  s_waitcnt lgkmcnt(15)
  ds_read_b64_tr_b16 a[176:177], v232 offset:24576
  ds_read_b64_tr_b16 a[178:179], v232 offset:26624
  v_mfma_f32_16x16x32_bf16 v[36:39], a[184:187], a[80:83], v[36:39]
  s_waitcnt vmcnt(27)
  v_max_u32 v15, v156, v157
  v_max3_u32 v15, v15, v158, v159
  v_mfma_f32_16x16x32_bf16 v[36:39], a[188:191], a[88:91], v[36:39]
  buffer_load_dwordx4 a[168:171], v244, s[36:39], s50 offen offset:2048 sc1
  ds_read_b64_tr_b16 a[180:181], v232 offset:28672
  v_mfma_f32_16x16x32_bf16 v[40:43], a[188:191], a[92:95], v[40:43]
  ds_read_b64_tr_b16 a[182:183], v232 offset:30720
  v_max3_u32 v15, v15, v160, v161
  v_mfma_f32_16x16x32_bf16 v[40:43], a[184:187], a[84:87], v[40:43]
  s_waitcnt lgkmcnt(15)
  ds_read_b64_tr_b16 a[184:185], v233 offset:24576
  v_max3_u32 v15, v15, v162, v163
  v_mfma_f32_16x16x32_bf16 v[48:51], a[192:195], a[84:87], v[48:51]
  ds_read_b64_tr_b16 a[186:187], v233 offset:26624
  v_max3_u32 v15, v15, v164, v165
  v_mfma_f32_16x16x32_bf16 v[48:51], a[196:199], a[92:95], v[48:51]
  buffer_load_dwordx4 a[172:175], v244, s[36:39], s50 offen offset:3072 sc1
  ds_read_b64_tr_b16 a[188:189], v233 offset:28672
  v_mfma_f32_16x16x32_bf16 v[44:47], a[196:199], a[88:91], v[44:47]
  ds_read_b64_tr_b16 a[190:191], v233 offset:30720
  v_max3_u32 v15, v15, v166, v167
  v_mfma_f32_16x16x32_bf16 v[44:47], a[192:195], a[80:83], v[44:47]
  s_waitcnt vmcnt(16) lgkmcnt(15)
  ds_read_b64_tr_b16 a[192:193], v234 offset:24576
  v_max3_u32 v15, v15, v168, v169
  v_mfma_f32_16x16x32_bf16 v[20:23], a[200:203], a[96:99], v[20:23]
  s_mov_b32 s50, 45056
  ds_read_b64_tr_b16 a[194:195], v234 offset:26624
  v_max3_u32 v15, v15, v170, v171
  v_mfma_f32_16x16x32_bf16 v[20:23], a[204:207], a[104:107], v[20:23]
  buffer_load_dwordx4 a[0:3], v244, s[36:39], s50 offen offset:0 sc1
  ds_read_b64_tr_b16 a[196:197], v234 offset:28672
  v_mfma_f32_16x16x32_bf16 v[24:27], a[204:207], a[108:111], v[24:27]
  ds_read_b64_tr_b16 a[198:199], v234 offset:30720
  v_mfma_f32_16x16x32_bf16 v[24:27], a[200:203], a[100:103], v[24:27]
  s_waitcnt lgkmcnt(15)
  ds_read_b64_tr_b16 a[200:201], v235 offset:24576
  v_mfma_f32_16x16x32_bf16 v[32:35], a[208:211], a[100:103], v[32:35]
  ds_read_b64_tr_b16 a[202:203], v235 offset:26624
  v_mfma_f32_16x16x32_bf16 v[32:35], a[212:215], a[108:111], v[32:35]
  buffer_load_dwordx4 a[4:7], v244, s[36:39], s50 offen offset:1024 sc1
  ds_read_b64_tr_b16 a[204:205], v235 offset:28672
  v_mfma_f32_16x16x32_bf16 v[28:31], a[212:215], a[104:107], v[28:31]
  ds_read_b64_tr_b16 a[206:207], v235 offset:30720
  v_mfma_f32_16x16x32_bf16 v[28:31], a[208:211], a[96:99], v[28:31]
  s_waitcnt lgkmcnt(15)
  ds_read_b64_tr_b16 a[208:209], v232 offset:32768
  v_mfma_f32_16x16x32_bf16 v[36:39], a[216:219], a[96:99], v[36:39]
  ds_read_b64_tr_b16 a[210:211], v232 offset:34816
  v_mfma_f32_16x16x32_bf16 v[36:39], a[220:223], a[104:107], v[36:39]
  buffer_load_dwordx4 a[8:11], v244, s[36:39], s50 offen offset:2048 sc1
  ds_read_b64_tr_b16 a[212:213], v232 offset:36864
  v_mfma_f32_16x16x32_bf16 v[40:43], a[220:223], a[108:111], v[40:43]
  v_cmp_eq_u32 vcc, -1, v15
  s_nop 4
  s_cbranch_vccnz CK4s
CK4x:
  v_mfma_f32_16x16x32_bf16 v[40:43], a[216:219], a[100:103], v[40:43]
  s_waitcnt lgkmcnt(15)
  ds_read_b64_tr_b16 a[214:215], v232 offset:38912
  ds_read_b64_tr_b16 a[216:217], v233 offset:32768
  v_mfma_f32_16x16x32_bf16 v[48:51], a[224:227], a[100:103], v[48:51]
  ds_read_b64_tr_b16 a[218:219], v233 offset:34816
  v_add_f32 v156, v156, v164
  v_mfma_f32_16x16x32_bf16 v[48:51], a[228:231], a[108:111], v[48:51]
  buffer_load_dwordx4 a[12:15], v244, s[36:39], s50 offen offset:3072 sc1
  ds_read_b64_tr_b16 a[220:221], v233 offset:36864
  v_mfma_f32_16x16x32_bf16 v[44:47], a[228:231], a[104:107], v[44:47]
  ds_read_b64_tr_b16 a[222:223], v233 offset:38912
  v_add_f32 v157, v157, v165
  v_add_f32 v158, v158, v166
  v_add_f32 v159, v159, v167
  v_mfma_f32_16x16x32_bf16 v[44:47], a[224:227], a[96:99], v[44:47]
  s_waitcnt vmcnt(16) lgkmcnt(15)
  ds_read_b64_tr_b16 a[224:225], v232 offset:40960
  v_add_f32 v160, v160, v168
  v_add_f32 v161, v161, v169
  v_add_f32 v162, v162, v170
  v_mfma_f32_16x16x32_bf16 v[20:23], a[176:179], a[112:115], v[20:23]
  s_mov_b32 s50, 49152
  ds_read_b64_tr_b16 a[226:227], v232 offset:43008
  v_add_f32 v163, v163, v171
  v_add_f32 v156, v156, v160
  v_add_f32 v157, v157, v161
  v_mfma_f32_16x16x32_bf16 v[20:23], a[180:183], a[120:123], v[20:23]
  buffer_load_dwordx4 a[16:19], v244, s[36:39], s50 offen offset:0 sc1
  ds_read_b64_tr_b16 a[228:229], v232 offset:45056
  v_add_f32 v158, v158, v162
  v_add_f32 v159, v159, v163
  v_mfma_f32_16x16x32_bf16 v[24:27], a[180:183], a[124:127], v[24:27]
  ds_read_b64_tr_b16 a[230:231], v232 offset:47104
  v_cvt_pk_bf16_f32 v160, v156, v157
  v_lshlrev_b32 v156, 16, v160
  v_and_b32 v157, 0xffff0000, v160
  v_mfma_f32_16x16x32_bf16 v[24:27], a[176:179], a[116:119], v[24:27]
  s_waitcnt lgkmcnt(15)
  ds_read_b64_tr_b16 a[176:177], v233 offset:40960
  v_cvt_pk_bf16_f32 v161, v158, v159
  v_lshlrev_b32 v158, 16, v161
  v_and_b32 v159, 0xffff0000, v161
  v_mfma_f32_16x16x32_bf16 v[32:35], a[184:187], a[116:119], v[32:35]
  ds_read_b64_tr_b16 a[178:179], v233 offset:43008
  v_add_f32 v156, v13, v156
  v_add_f32 v157, v13, v157
  v_add_f32 v158, v13, v158
  v_mfma_f32_16x16x32_bf16 v[32:35], a[188:191], a[124:127], v[32:35]
  buffer_load_dwordx4 a[20:23], v244, s[36:39], s50 offen offset:1024 sc1
  v_add_f32 v159, v13, v159
  v_cvt_pk_bf16_f32 v160, v156, v157
  v_lshlrev_b32 v156, 16, v160
  v_mfma_f32_16x16x32_bf16 v[28:31], a[188:191], a[120:123], v[28:31]
  ds_read_b64_tr_b16 a[180:181], v233 offset:45056
  v_and_b32 v157, 0xffff0000, v160
  v_cvt_pk_bf16_f32 v161, v158, v159
  v_lshlrev_b32 v158, 16, v161
  v_mfma_f32_16x16x32_bf16 v[28:31], a[184:187], a[112:115], v[28:31]
  s_waitcnt lgkmcnt(15)
  ds_read_b64_tr_b16 a[182:183], v233 offset:47104
  v_and_b32 v159, 0xffff0000, v161
  v_mfma_f32_16x16x32_bf16 v[36:39], a[192:195], a[112:115], v[36:39]
  ds_write_b128 v247, v[156:159]
  ds_read_b128 v[84:87], v245 offset:0
  v_mfma_f32_16x16x32_bf16 v[36:39], a[196:199], a[120:123], v[36:39]
  ds_read_b128 v[100:103], v245 offset:512
  ds_read_b128 v[88:91], v245 offset:64
  v_mfma_f32_16x16x32_bf16 v[40:43], a[196:199], a[124:127], v[40:43]
  ds_read_b128 v[104:107], v245 offset:576
  ds_read_b128 v[92:95], v245 offset:128
  v_mfma_f32_16x16x32_bf16 v[40:43], a[192:195], a[116:119], v[40:43]
  s_waitcnt lgkmcnt(15)
  ds_read_b128 v[108:111], v245 offset:640
  ds_read_b128 v[96:99], v245 offset:192
  v_mfma_f32_16x16x32_bf16 v[48:51], a[200:203], a[116:119], v[48:51]
  ds_read_b128 v[112:115], v245 offset:704
  ds_read_b128 v[116:119], v246 offset:512
  v_mfma_f32_16x16x32_bf16 v[48:51], a[204:207], a[124:127], v[48:51]
  ds_read_b128 v[120:123], v246 offset:576
  ds_read_b128 v[124:127], v246 offset:640
  v_mfma_f32_16x16x32_bf16 v[44:47], a[204:207], a[120:123], v[44:47]
  ds_read_b128 v[128:131], v246 offset:704
  ds_read_b64_tr_b16 a[184:185], v232 offset:49152
  v_accvgpr_write_b32 a248, v156
  v_accvgpr_write_b32 a249, v157
  v_mfma_f32_16x16x32_bf16 v[44:47], a[200:203], a[112:115], v[44:47]
  s_waitcnt vmcnt(14) lgkmcnt(15)
  buffer_load_dwordx4 a[24:27], v244, s[36:39], s50 offen offset:2048 sc1
  ds_read_b64_tr_b16 a[186:187], v232 offset:51200
  v_accvgpr_write_b32 a250, v158
  v_accvgpr_write_b32 a251, v159
  v_mfma_f32_16x16x32_bf16 v[20:23], a[208:211], a[128:131], v[20:23]
  ds_read_b64_tr_b16 a[188:189], v232 offset:53248
  ds_read_b64_tr_b16 a[190:191], v232 offset:55296
  v_mfma_f32_16x16x32_bf16 v[20:23], a[212:215], a[136:139], v[20:23]
  ds_read_b64_tr_b16 a[192:193], v233 offset:49152
  buffer_load_dwordx4 a[28:31], v244, s[36:39], s50 offen offset:3072 sc1
  s_mov_b32 s50, 53248
  v_mfma_f32_16x16x32_bf16 v[24:27], a[212:215], a[140:143], v[24:27]
  ds_read_b64_tr_b16 a[194:195], v233 offset:51200
  ds_read_b64_tr_b16 a[196:197], v233 offset:53248
  v_mfma_f32_16x16x32_bf16 v[24:27], a[208:211], a[132:135], v[24:27]
  s_waitcnt lgkmcnt(15)
  ds_read_b64_tr_b16 a[198:199], v233 offset:55296
  ds_read_b64_tr_b16 a[200:201], v232 offset:57344
  v_mfma_f32_16x16x32_bf16 v[32:35], a[216:219], a[132:135], v[32:35]
  buffer_load_dwordx4 a[32:35], v244, s[36:39], s50 offen offset:0 sc1
  ds_read_b64_tr_b16 a[202:203], v232 offset:59392
  v_mfma_f32_16x16x32_bf16 v[32:35], a[220:223], a[140:143], v[32:35]
  ds_read_b64_tr_b16 a[204:205], v232 offset:61440
  buffer_load_dwordx4 a[36:39], v244, s[36:39], s50 offen offset:1024 sc1
  v_mfma_f32_16x16x32_bf16 v[28:31], a[220:223], a[136:139], v[28:31]
  ds_read_b64_tr_b16 a[206:207], v232 offset:63488
  ds_read_b64_tr_b16 a[208:209], v233 offset:57344
  v_mfma_f32_16x16x32_bf16 v[28:31], a[216:219], a[128:131], v[28:31]
  s_waitcnt vmcnt(14) lgkmcnt(15)
  buffer_load_dwordx4 a[40:43], v244, s[36:39], s50 offen offset:2048 sc1
  ds_read_b64_tr_b16 a[210:211], v233 offset:59392
  v_mfma_f32_16x16x32_bf16 v[20:23], a[224:227], a[144:147], v[20:23]
  ds_read_b64_tr_b16 a[212:213], v233 offset:61440
  buffer_load_dwordx4 a[44:47], v244, s[36:39], s50 offen offset:3072 sc1
  s_mov_b32 s50, 57344
  v_mfma_f32_16x16x32_bf16 v[20:23], a[228:231], a[152:155], v[20:23]
  s_waitcnt lgkmcnt(15)
  ds_read_b64_tr_b16 a[214:215], v233 offset:63488
  ds_read_b64_tr_b16 a[216:217], v236 offset:0
  v_cvt_pk_bf16_f32 v148, v116, v117
  v_cvt_pk_bf16_f32 v149, v118, v119
  v_mfma_f32_16x16x32_bf16 v[24:27], a[228:231], a[156:159], v[24:27]
  buffer_load_dwordx4 a[48:51], v244, s[36:39], s50 offen offset:0 sc1
  ds_read_b64_tr_b16 a[218:219], v236 offset:2048
  v_cvt_pk_bf16_f32 v150, v120, v121
  v_cvt_pk_bf16_f32 v151, v122, v123
  v_mfma_f32_16x16x32_bf16 v[24:27], a[224:227], a[148:151], v[24:27]
  s_waitcnt lgkmcnt(15)
  ds_read_b64_tr_b16 a[220:221], v236 offset:4096
  buffer_load_dwordx4 a[52:55], v244, s[36:39], s50 offen offset:1024 sc1
  v_cvt_pk_bf16_f32 v152, v124, v125
  v_cvt_pk_bf16_f32 v153, v126, v127
  v_mfma_f32_16x16x32_bf16 v[32:35], a[176:179], a[148:151], v[32:35]
  ds_read_b64_tr_b16 a[222:223], v236 offset:6144
  ds_read_b64_tr_b16 a[224:225], v237 offset:0
  v_cvt_pk_bf16_f32 v154, v128, v129
  v_cvt_pk_bf16_f32 v155, v130, v131
  v_mfma_f32_16x16x32_bf16 v[32:35], a[180:183], a[156:159], v[32:35]
  buffer_load_dwordx4 a[56:59], v244, s[36:39], s50 offen offset:2048 sc1
  ds_read_b64_tr_b16 a[226:227], v237 offset:2048
  v_mfma_f32_16x16x32_bf16 v[28:31], a[180:183], a[152:155], v[28:31]
  ds_read_b64_tr_b16 a[228:229], v237 offset:4096
  v_mfma_f32_16x16x32_bf16 v[28:31], a[176:179], a[144:147], v[28:31]
  s_waitcnt vmcnt(15) lgkmcnt(15)
  buffer_load_dwordx4 a[60:63], v244, s[36:39], s50 offen offset:3072 sc1
  ds_read_b64_tr_b16 a[230:231], v237 offset:6144
  v_mfma_f32_16x16x32_bf16 v[20:23], a[184:187], a[160:163], v[20:23]
  s_mov_b32 s50, 61440
  ds_read_b64_tr_b16 a[176:177], v236 offset:8192
  v_mfma_f32_16x16x32_bf16 v[20:23], a[188:191], a[168:171], v[20:23]
  buffer_load_dwordx4 a[64:67], v244, s[36:39], s50 offen offset:0 sc1
  ds_read_b64_tr_b16 a[178:179], v236 offset:10240
  v_mfma_f32_16x16x32_bf16 v[24:27], a[188:191], a[172:175], v[24:27]
  ds_read_b64_tr_b16 a[180:181], v236 offset:12288
  v_mfma_f32_16x16x32_bf16 v[24:27], a[184:187], a[164:167], v[24:27]
  s_waitcnt lgkmcnt(15)
  buffer_load_dwordx4 a[68:71], v244, s[36:39], s50 offen offset:1024 sc1
  v_mfma_f32_16x16x32_bf16 v[32:35], a[192:195], a[164:167], v[32:35]
  ds_read_b64_tr_b16 a[182:183], v236 offset:14336
  v_mfma_f32_16x16x32_bf16 v[32:35], a[196:199], a[172:175], v[32:35]
  buffer_load_dwordx4 a[72:75], v244, s[36:39], s50 offen offset:2048 sc1
  ds_read_b64_tr_b16 a[184:185], v237 offset:8192
  v_mfma_f32_16x16x32_bf16 v[28:31], a[196:199], a[168:171], v[28:31]
  ds_read_b64_tr_b16 a[186:187], v237 offset:10240
  v_mfma_f32_16x16x32_bf16 v[28:31], a[192:195], a[160:163], v[28:31]
  s_waitcnt vmcnt(15) lgkmcnt(15)
  buffer_load_dwordx4 a[76:79], v244, s[36:39], s50 offen offset:3072 sc1
  ds_read_b64_tr_b16 a[188:189], v237 offset:12288
  v_mfma_f32_16x16x32_bf16 v[20:23], a[200:203], a[0:3], v[20:23]
  ds_read_b64_tr_b16 a[190:191], v237 offset:14336
  v_mfma_f32_16x16x32_bf16 v[20:23], a[204:207], a[8:11], v[20:23]
  ds_read_b64_tr_b16 a[192:193], v236 offset:49152
  v_mfma_f32_16x16x32_bf16 v[24:27], a[204:207], a[12:15], v[24:27]
  ds_read_b64_tr_b16 a[194:195], v236 offset:51200
  v_mfma_f32_16x16x32_bf16 v[24:27], a[200:203], a[4:7], v[24:27]
  s_waitcnt lgkmcnt(15)
  ds_read_b64_tr_b16 a[196:197], v236 offset:53248
  v_mfma_f32_16x16x32_bf16 v[32:35], a[208:211], a[4:7], v[32:35]
  ds_read_b64_tr_b16 a[198:199], v236 offset:55296
  v_mfma_f32_16x16x32_bf16 v[32:35], a[212:215], a[12:15], v[32:35]
  ds_read_b64_tr_b16 a[200:201], v237 offset:49152
  v_mfma_f32_16x16x32_bf16 v[28:31], a[212:215], a[8:11], v[28:31]
  ds_read_b64_tr_b16 a[202:203], v237 offset:51200
  v_mfma_f32_16x16x32_bf16 v[28:31], a[208:211], a[0:3], v[28:31]
  s_waitcnt vmcnt(12) lgkmcnt(15)
  ds_read_b64_tr_b16 a[204:205], v237 offset:53248
  v_mfma_f32_16x16x32_bf16 v[20:23], a[216:219], a[16:19], v[20:23]
  ds_read_b64_tr_b16 a[206:207], v237 offset:55296
  v_mfma_f32_16x16x32_bf16 v[20:23], a[220:223], a[24:27], v[20:23]
  ds_read_b64_tr_b16 a[208:209], v236 offset:57344
  v_mfma_f32_16x16x32_bf16 v[24:27], a[220:223], a[28:31], v[24:27]
  ds_read_b64_tr_b16 a[210:211], v236 offset:59392
  v_mfma_f32_16x16x32_bf16 v[24:27], a[216:219], a[20:23], v[24:27]
  s_waitcnt lgkmcnt(15)
  ds_read_b64_tr_b16 a[212:213], v236 offset:61440
  v_mfma_f32_16x16x32_bf16 v[32:35], a[224:227], a[20:23], v[32:35]
  ds_read_b64_tr_b16 a[214:215], v236 offset:63488
  v_mfma_f32_16x16x32_bf16 v[32:35], a[228:231], a[28:31], v[32:35]
  ds_read_b64_tr_b16 a[216:217], v237 offset:57344
  v_mfma_f32_16x16x32_bf16 v[28:31], a[228:231], a[24:27], v[28:31]
  ds_read_b64_tr_b16 a[218:219], v237 offset:59392
  v_mfma_f32_16x16x32_bf16 v[28:31], a[224:227], a[16:19], v[28:31]
  s_waitcnt vmcnt(8) lgkmcnt(15)
  ds_read_b64_tr_b16 a[220:221], v237 offset:61440
  v_mfma_f32_16x16x32_bf16 v[20:23], a[176:179], a[32:35], v[20:23]
  ds_read_b64_tr_b16 a[222:223], v237 offset:63488
  v_mfma_f32_16x16x32_bf16 v[20:23], a[180:183], a[40:43], v[20:23]
  ds_read_b64_tr_b16 a[224:225], v234 offset:32768
  v_mfma_f32_16x16x32_bf16 v[24:27], a[180:183], a[44:47], v[24:27]
  ds_read_b64_tr_b16 a[226:227], v234 offset:34816
  v_mfma_f32_16x16x32_bf16 v[24:27], a[176:179], a[36:39], v[24:27]
  s_waitcnt lgkmcnt(15)
  ds_read_b64_tr_b16 a[228:229], v234 offset:36864
  v_mfma_f32_16x16x32_bf16 v[32:35], a[184:187], a[36:39], v[32:35]
  ds_read_b64_tr_b16 a[230:231], v234 offset:38912
  v_mfma_f32_16x16x32_bf16 v[32:35], a[188:191], a[44:47], v[32:35]
  ds_read_b64_tr_b16 a[176:177], v235 offset:32768
  v_mfma_f32_16x16x32_bf16 v[28:31], a[188:191], a[40:43], v[28:31]
  ds_read_b64_tr_b16 a[178:179], v235 offset:34816
  v_mfma_f32_16x16x32_bf16 v[28:31], a[184:187], a[32:35], v[28:31]
  s_waitcnt vmcnt(4) lgkmcnt(15)
  ds_read_b64_tr_b16 a[180:181], v235 offset:36864
  v_mfma_f32_16x16x32_bf16 v[20:23], a[192:195], a[48:51], v[20:23]
  v_mfma_f32_16x16x32_bf16 v[20:23], a[196:199], a[56:59], v[20:23]
  ds_read_b64_tr_b16 a[182:183], v235 offset:38912
  v_mfma_f32_16x16x32_bf16 v[24:27], a[196:199], a[60:63], v[24:27]
  ds_read_b64_tr_b16 a[184:185], v234 offset:40960
  v_mfma_f32_16x16x32_bf16 v[24:27], a[192:195], a[52:55], v[24:27]
  s_waitcnt lgkmcnt(15)
  ds_read_b64_tr_b16 a[186:187], v234 offset:43008
  v_mfma_f32_16x16x32_bf16 v[32:35], a[200:203], a[52:55], v[32:35]
  ds_read_b64_tr_b16 a[188:189], v234 offset:45056
  v_mfma_f32_16x16x32_bf16 v[32:35], a[204:207], a[60:63], v[32:35]
  ds_read_b64_tr_b16 a[190:191], v234 offset:47104
  v_mfma_f32_16x16x32_bf16 v[28:31], a[204:207], a[56:59], v[28:31]
  ds_read_b64_tr_b16 a[192:193], v235 offset:40960
  v_mfma_f32_16x16x32_bf16 v[28:31], a[200:203], a[48:51], v[28:31]
  s_waitcnt vmcnt(0) lgkmcnt(15)
  ds_read_b64_tr_b16 a[194:195], v235 offset:43008
  v_mfma_f32_16x16x32_bf16 v[20:23], a[208:211], a[64:67], v[20:23]
  ds_read_b64_tr_b16 a[196:197], v235 offset:45056
  v_mfma_f32_16x16x32_bf16 v[20:23], a[212:215], a[72:75], v[20:23]
  ds_read_b64_tr_b16 a[198:199], v235 offset:47104
  v_mfma_f32_16x16x32_bf16 v[24:27], a[212:215], a[76:79], v[24:27]
  ds_read_b64_tr_b16 a[200:201], v234 offset:49152
  v_mfma_f32_16x16x32_bf16 v[24:27], a[208:211], a[68:71], v[24:27]
  s_waitcnt lgkmcnt(15)
  ds_read_b64_tr_b16 a[202:203], v234 offset:51200
  v_mfma_f32_16x16x32_bf16 v[32:35], a[216:219], a[68:71], v[32:35]
  ds_read_b64_tr_b16 a[204:205], v234 offset:53248
  v_mfma_f32_16x16x32_bf16 v[32:35], a[220:223], a[76:79], v[32:35]
  ds_read_b64_tr_b16 a[206:207], v234 offset:55296
  v_mfma_f32_16x16x32_bf16 v[28:31], a[220:223], a[72:75], v[28:31]
  ds_read_b64_tr_b16 a[208:209], v235 offset:49152
  v_mfma_f32_16x16x32_bf16 v[28:31], a[216:219], a[64:67], v[28:31]
  s_waitcnt lgkmcnt(15)
  ds_read_b64_tr_b16 a[210:211], v235 offset:51200
  v_mfma_f32_16x16x32_bf16 v[36:39], a[224:227], a[128:131], v[36:39]
  s_waitcnt lgkmcnt(15)
  s_nop 3
  v_pk_fma_f32 v[68:69], v[84:85], v[24:25], v[68:69]
  v_pk_fma_f32 v[70:71], v[86:87], v[26:27], v[70:71]
  v_pk_fma_f32 v[72:73], v[88:89], v[32:33], v[72:73]
  v_pk_fma_f32 v[74:75], v[90:91], v[34:35], v[74:75]
  v_pk_mul_f32 v[24:25], v[68:69], v[100:101]
  v_pk_mul_f32 v[26:27], v[70:71], v[102:103]
  v_pk_mul_f32 v[32:33], v[72:73], v[104:105]
  v_pk_mul_f32 v[34:35], v[74:75], v[106:107]
  v_cvt_pk_bf16_f32 v140, v24, v25
  v_cvt_pk_bf16_f32 v141, v26, v27
  v_cvt_pk_bf16_f32 v142, v32, v33
  v_cvt_pk_bf16_f32 v143, v34, v35
  buffer_store_dwordx4 v[140:143], v0, s[36:39], s73 offen offset:1024 sc1
  v_pk_fma_f32 v[52:53], v[84:85], v[20:21], v[52:53]
  v_pk_fma_f32 v[54:55], v[86:87], v[22:23], v[54:55]
  v_pk_fma_f32 v[56:57], v[88:89], v[28:29], v[56:57]
  v_pk_fma_f32 v[58:59], v[90:91], v[30:31], v[58:59]
  v_pk_mul_f32 v[20:21], v[52:53], v[100:101]
  v_pk_mul_f32 v[22:23], v[54:55], v[102:103]
  v_pk_mul_f32 v[28:29], v[56:57], v[104:105]
  v_pk_mul_f32 v[30:31], v[58:59], v[106:107]
  v_cvt_pk_bf16_f32 v132, v20, v21
  v_cvt_pk_bf16_f32 v133, v22, v23
  v_cvt_pk_bf16_f32 v134, v28, v29
  v_cvt_pk_bf16_f32 v135, v30, v31
  buffer_store_dwordx4 v[132:135], v0, s[36:39], s73 offen offset:0 sc1
  ds_read_b64_tr_b16 a[212:213], v235 offset:53248
  v_mfma_f32_16x16x32_bf16 v[36:39], a[228:231], a[136:139], v[36:39]
  ds_read_b64_tr_b16 a[214:215], v235 offset:55296
  v_mfma_f32_16x16x32_bf16 v[40:43], a[228:231], a[140:143], v[40:43]
  ds_read_b64_tr_b16 a[216:217], v234 offset:57344
  v_mfma_f32_16x16x32_bf16 v[40:43], a[224:227], a[132:135], v[40:43]
  s_waitcnt lgkmcnt(15)
  ds_read_b64_tr_b16 a[218:219], v234 offset:59392
  v_mfma_f32_16x16x32_bf16 v[48:51], a[176:179], a[132:135], v[48:51]
  ds_read_b64_tr_b16 a[220:221], v234 offset:61440
  v_mfma_f32_16x16x32_bf16 v[48:51], a[180:183], a[140:143], v[48:51]
  ds_read_b64_tr_b16 a[222:223], v234 offset:63488
  v_mfma_f32_16x16x32_bf16 v[44:47], a[180:183], a[136:139], v[44:47]
  ds_read_b64_tr_b16 a[224:225], v235 offset:57344
  v_mfma_f32_16x16x32_bf16 v[44:47], a[176:179], a[128:131], v[44:47]
  s_waitcnt lgkmcnt(15)
  ds_read_b64_tr_b16 a[226:227], v235 offset:59392
  v_mfma_f32_16x16x32_bf16 v[36:39], a[184:187], a[144:147], v[36:39]
  ds_read_b64_tr_b16 a[228:229], v235 offset:61440
  buffer_store_dwordx4 v[148:151], v0, s[36:39], s75 offen sc1
  v_mfma_f32_16x16x32_bf16 v[36:39], a[188:191], a[152:155], v[36:39]
  s_add_u32 s75, s75, 16384
  buffer_store_dwordx4 v[152:155], v0, s[36:39], s75 offen sc1
  ds_read_b64_tr_b16 a[230:231], v235 offset:63488
  v_mfma_f32_16x16x32_bf16 v[40:43], a[188:191], a[156:159], v[40:43]
  ds_read_b64_tr_b16 a[176:177], v238 offset:0
  v_mfma_f32_16x16x32_bf16 v[40:43], a[184:187], a[148:151], v[40:43]
  s_waitcnt lgkmcnt(15)
  ds_read_b64_tr_b16 a[178:179], v238 offset:2048
  v_mfma_f32_16x16x32_bf16 v[48:51], a[192:195], a[148:151], v[48:51]
  ds_read_b64_tr_b16 a[180:181], v238 offset:4096
  v_mfma_f32_16x16x32_bf16 v[48:51], a[196:199], a[156:159], v[48:51]
  ds_read_b64_tr_b16 a[182:183], v238 offset:6144
  v_mfma_f32_16x16x32_bf16 v[44:47], a[196:199], a[152:155], v[44:47]
  v_mfma_f32_16x16x32_bf16 v[44:47], a[192:195], a[144:147], v[44:47]
  s_waitcnt lgkmcnt(15)
  ds_read_b64_tr_b16 a[184:185], v239 offset:0
  v_mfma_f32_16x16x32_bf16 v[36:39], a[200:203], a[160:163], v[36:39]
  ds_read_b64_tr_b16 a[186:187], v239 offset:2048
  v_mfma_f32_16x16x32_bf16 v[36:39], a[204:207], a[168:171], v[36:39]
  ds_read_b64_tr_b16 a[188:189], v239 offset:4096
  v_mfma_f32_16x16x32_bf16 v[40:43], a[204:207], a[172:175], v[40:43]
  ds_read_b64_tr_b16 a[190:191], v239 offset:6144
  v_mfma_f32_16x16x32_bf16 v[40:43], a[200:203], a[164:167], v[40:43]
  s_waitcnt lgkmcnt(15)
  ds_read_b64_tr_b16 a[192:193], v238 offset:8192
  v_mfma_f32_16x16x32_bf16 v[48:51], a[208:211], a[164:167], v[48:51]
  ds_read_b64_tr_b16 a[194:195], v238 offset:10240
  v_mfma_f32_16x16x32_bf16 v[48:51], a[212:215], a[172:175], v[48:51]
  ds_read_b64_tr_b16 a[196:197], v238 offset:12288
  v_mfma_f32_16x16x32_bf16 v[44:47], a[212:215], a[168:171], v[44:47]
  ds_read_b64_tr_b16 a[198:199], v238 offset:14336
  v_mfma_f32_16x16x32_bf16 v[44:47], a[208:211], a[160:163], v[44:47]
  s_waitcnt lgkmcnt(15)
  ds_read_b64_tr_b16 a[200:201], v239 offset:8192
  v_mfma_f32_16x16x32_bf16 v[36:39], a[216:219], a[0:3], v[36:39]
  ds_read_b64_tr_b16 a[202:203], v239 offset:10240
  v_mfma_f32_16x16x32_bf16 v[36:39], a[220:223], a[8:11], v[36:39]
  ds_read_b64_tr_b16 a[204:205], v239 offset:12288
  v_mfma_f32_16x16x32_bf16 v[40:43], a[220:223], a[12:15], v[40:43]
  ds_read_b64_tr_b16 a[206:207], v239 offset:14336
  v_mfma_f32_16x16x32_bf16 v[40:43], a[216:219], a[4:7], v[40:43]
  s_waitcnt lgkmcnt(15)
  s_bfe_u32 s56, s82, 0x30000
  s_lshl_b32 s56, s56, 2
  v_mfma_f32_16x16x32_bf16 v[48:51], a[224:227], a[4:7], v[48:51]
  s_bitcmp1_b32 s82, 3
  s_addc_u32 s56, s56, 0
  s_mul_i32 s56, s56, 229376
  v_mfma_f32_16x16x32_bf16 v[48:51], a[228:231], a[12:15], v[48:51]
  s_waitcnt vmcnt(2)
  s_barrier
  s_add_u32 m0, s84, 86016
  v_mfma_f32_16x16x32_bf16 v[44:47], a[228:231], a[8:11], v[44:47]
  s_mov_b64 exec, 1
  buffer_store_dword v12, v0, s[36:39], s45 offen sc1
  s_mov_b64 exec, -1
  v_mfma_f32_16x16x32_bf16 v[44:47], a[224:227], a[0:3], v[44:47]
  s_waitcnt lgkmcnt(12)
Ha0_2:
  s_cbranch_execz Ra
  ds_read_b64_tr_b16 a[208:209], v238 offset:49152
  ds_read_b64_tr_b16 a[210:211], v238 offset:51200
  v_mfma_f32_16x16x32_bf16 v[36:39], a[176:179], a[16:19], v[36:39]
  s_add_u32 s45, s45, -32768
  ds_read_b64_tr_b16 a[212:213], v238 offset:53248
  ds_read_b64_tr_b16 a[214:215], v238 offset:55296
  v_mfma_f32_16x16x32_bf16 v[36:39], a[180:183], a[24:27], v[36:39]
  ds_read_b64_tr_b16 a[216:217], v239 offset:49152
  buffer_load_dwordx4 v3, s[16:19], s56 offen offset:0 lds
  v_mfma_f32_16x16x32_bf16 v[40:43], a[180:183], a[28:31], v[40:43]
  ds_read_b64_tr_b16 a[218:219], v239 offset:51200
  ds_read_b64_tr_b16 a[220:221], v239 offset:53248
  v_mfma_f32_16x16x32_bf16 v[40:43], a[176:179], a[20:23], v[40:43]
  s_waitcnt lgkmcnt(15)
  ds_read_b64_tr_b16 a[222:223], v239 offset:55296
  buffer_load_dwordx4 v4, s[16:19], s56 offen offset:1024 lds
  v_mfma_f32_16x16x32_bf16 v[48:51], a[184:187], a[20:23], v[48:51]
  ds_read_b64_tr_b16 a[224:225], v238 offset:57344
  ds_read_b64_tr_b16 a[226:227], v238 offset:59392
  v_mfma_f32_16x16x32_bf16 v[48:51], a[188:191], a[28:31], v[48:51]
  ds_read_b64_tr_b16 a[228:229], v238 offset:61440
  v_mfma_f32_16x16x32_bf16 v[44:47], a[188:191], a[24:27], v[44:47]
  buffer_load_dwordx4 v5, s[16:19], s56 offen offset:2048 lds
  ds_read_b64_tr_b16 a[230:231], v238 offset:63488
  v_mfma_f32_16x16x32_bf16 v[44:47], a[184:187], a[16:19], v[44:47]
  s_waitcnt lgkmcnt(15)
  ds_read_b64_tr_b16 a[176:177], v239 offset:57344
  v_mfma_f32_16x16x32_bf16 v[36:39], a[192:195], a[32:35], v[36:39]
  ds_read_b64_tr_b16 a[178:179], v239 offset:59392
  v_mfma_f32_16x16x32_bf16 v[36:39], a[196:199], a[40:43], v[36:39]
  buffer_load_dwordx4 v6, s[16:19], s56 offen offset:3072 lds
  s_add_u32 m0, s84, 90112
  v_mfma_f32_16x16x32_bf16 v[40:43], a[196:199], a[44:47], v[40:43]
  ds_read_b64_tr_b16 a[180:181], v239 offset:61440
  ds_read_b64_tr_b16 a[182:183], v239 offset:63488
  v_mfma_f32_16x16x32_bf16 v[40:43], a[192:195], a[36:39], v[40:43]
  s_waitcnt lgkmcnt(15)
  v_mfma_f32_16x16x32_bf16 v[48:51], a[200:203], a[36:39], v[48:51]
  buffer_load_dwordx4 v7, s[16:19], s56 offen offset:0 lds
  v_mfma_f32_16x16x32_bf16 v[48:51], a[204:207], a[44:47], v[48:51]
  v_mfma_f32_16x16x32_bf16 v[44:47], a[204:207], a[40:43], v[44:47]
  v_mfma_f32_16x16x32_bf16 v[44:47], a[200:203], a[32:35], v[44:47]
  s_waitcnt lgkmcnt(12)
  buffer_load_dwordx4 v8, s[16:19], s56 offen offset:1024 lds
  v_mfma_f32_16x16x32_bf16 v[36:39], a[208:211], a[48:51], v[36:39]
  v_mfma_f32_16x16x32_bf16 v[36:39], a[212:215], a[56:59], v[36:39]
  v_mfma_f32_16x16x32_bf16 v[40:43], a[212:215], a[60:63], v[40:43]
  buffer_load_dwordx4 v9, s[16:19], s56 offen offset:2048 lds
  s_bfe_u32 s56, s82, 0x30004
  v_mfma_f32_16x16x32_bf16 v[40:43], a[208:211], a[52:55], v[40:43]
  s_waitcnt lgkmcnt(8)
  s_lshl_b32 s56, s56, 2
  s_bitcmp1_b32 s82, 7
  v_mfma_f32_16x16x32_bf16 v[48:51], a[216:219], a[52:55], v[48:51]
  s_addc_u32 s56, s56, 0
  s_mul_i32 s56, s56, 229376
  s_add_u32 m0, s84, 0
  v_mfma_f32_16x16x32_bf16 v[48:51], a[220:223], a[60:63], v[48:51]
  buffer_load_dwordx4 v3, s[16:19], s56 offen offset:0 lds
  v_mfma_f32_16x16x32_bf16 v[44:47], a[220:223], a[56:59], v[44:47]
  v_mfma_f32_16x16x32_bf16 v[44:47], a[216:219], a[48:51], v[44:47]
  s_waitcnt lgkmcnt(4)
  v_mfma_f32_16x16x32_bf16 v[36:39], a[224:227], a[64:67], v[36:39]
  buffer_load_dwordx4 v4, s[16:19], s56 offen offset:1024 lds
  v_mfma_f32_16x16x32_bf16 v[36:39], a[228:231], a[72:75], v[36:39]
  v_mfma_f32_16x16x32_bf16 v[40:43], a[228:231], a[76:79], v[40:43]
  v_mfma_f32_16x16x32_bf16 v[40:43], a[224:227], a[68:71], v[40:43]
  s_waitcnt lgkmcnt(0)
  buffer_load_dwordx4 v5, s[16:19], s56 offen offset:2048 lds
  v_mfma_f32_16x16x32_bf16 v[48:51], a[176:179], a[68:71], v[48:51]
  v_mfma_f32_16x16x32_bf16 v[48:51], a[180:183], a[76:79], v[48:51]
  v_mfma_f32_16x16x32_bf16 v[44:47], a[180:183], a[72:75], v[44:47]
  v_mfma_f32_16x16x32_bf16 v[44:47], a[176:179], a[64:67], v[44:47]
  s_bfe_u32 s57, s82, 0x40000
  s_lshl_b32 s57, s57, 13
  s_add_u32 s57, s57, s85
  s_nop 0
  v_pk_fma_f32 v[76:77], v[92:93], v[40:41], v[76:77]
  v_pk_fma_f32 v[78:79], v[94:95], v[42:43], v[78:79]
  v_pk_fma_f32 v[80:81], v[96:97], v[48:49], v[80:81]
  v_pk_fma_f32 v[82:83], v[98:99], v[50:51], v[82:83]
  buffer_load_dwordx4 v6, s[16:19], s56 offen offset:3072 lds
  v_pk_mul_f32 v[40:41], v[76:77], v[108:109]
  v_pk_mul_f32 v[42:43], v[78:79], v[110:111]
  v_pk_mul_f32 v[48:49], v[80:81], v[112:113]
  v_pk_mul_f32 v[50:51], v[82:83], v[114:115]
  s_add_u32 m0, s84, 4096
  s_nop 0
  buffer_load_dwordx4 v7, s[16:19], s56 offen offset:0 lds
  v_cvt_pk_bf16_f32 v144, v40, v41
  v_cvt_pk_bf16_f32 v145, v42, v43
  v_cvt_pk_bf16_f32 v146, v48, v49
  v_cvt_pk_bf16_f32 v147, v50, v51
  buffer_load_dwordx4 v8, s[16:19], s56 offen offset:1024 lds
  v_pk_fma_f32 v[60:61], v[92:93], v[36:37], v[60:61]
  v_pk_fma_f32 v[62:63], v[94:95], v[38:39], v[62:63]
  v_pk_fma_f32 v[64:65], v[96:97], v[44:45], v[64:65]
  v_pk_fma_f32 v[66:67], v[98:99], v[46:47], v[66:67]
  buffer_load_dwordx4 v9, s[16:19], s56 offen offset:2048 lds
  v_pk_mul_f32 v[36:37], v[60:61], v[108:109]
  v_pk_mul_f32 v[38:39], v[62:63], v[110:111]
  v_pk_mul_f32 v[44:45], v[64:65], v[112:113]
  v_pk_mul_f32 v[46:47], v[66:67], v[114:115]
  v_cvt_pk_bf16_f32 v136, v36, v37
  v_cvt_pk_bf16_f32 v137, v38, v39
  v_cvt_pk_bf16_f32 v138, v44, v45
  v_cvt_pk_bf16_f32 v139, v46, v47
  s_lshl2_add_u32 s48, s2, s44
  s_cmp_eq_u32 s48, 1
  s_cbranch_scc1 CKSs
CKSx:
  s_mov_b64 exec, 0
  s_cmp_eq_u32 s44, 1
  s_cbranch_scc1 Hb0
  s_cmp_eq_u32 s44, 2
  s_cbranch_scc1 Hb1
  s_cmp_eq_u32 s44, 3
  s_cbranch_scc1 Hb2
Rb:
  s_mov_b64 exec, -1
G3S:
  s_cmp_lg_u32 s44, 0
  s_cbranch_scc1 SM5x
  s_mov_b32 s46, 60000
  s_mov_b32 s47, 5242880
SM5:
  buffer_load_dword v13, v251, s[36:39], s47 offen sc1
  s_sub_u32 s46, s46, 1
  s_cmp_eq_u32 s46, 0
  s_waitcnt vmcnt(0)
  s_cbranch_scc1 SM5x
  v_cmp_ne_u32 vcc, s3, v13
  s_nop 4
  s_cbranch_vccnz SM5
SM5x:
  s_waitcnt vmcnt(7)
  s_barrier
  buffer_load_dwordx4 a[0:3], v0, s[36:39], s57 offen offset:0 sc1
  buffer_load_dwordx4 a[4:7], v0, s[36:39], s57 offen offset:1024 sc1
  buffer_load_dwordx4 a[8:11], v0, s[36:39], s57 offen offset:2048 sc1
  buffer_load_dwordx4 a[12:15], v0, s[36:39], s57 offen offset:3072 sc1
  s_add_u32 s57, s57, 4096
  buffer_load_dwordx4 a[16:19], v0, s[36:39], s57 offen offset:0 sc1
  buffer_load_dwordx4 a[20:23], v0, s[36:39], s57 offen offset:1024 sc1
  buffer_load_dwordx4 a[24:27], v0, s[36:39], s57 offen offset:2048 sc1
  buffer_load_dwordx4 a[28:31], v0, s[36:39], s57 offen offset:3072 sc1
  buffer_store_dwordx4 v[144:147], v0, s[36:39], s51 offen offset:1024 sc1
  buffer_store_dwordx4 v[136:139], v0, s[36:39], s51 offen offset:0 sc1
  v_pk_mul_f32 v[30:31], v[52:53], v[52:53]
  v_pk_mul_f32 v[34:35], v[68:69], v[68:69]
  v_pk_fma_f32 v[30:31], v[54:55], v[54:55], v[30:31]
  v_pk_add_f32 v[28:29], v[54:55], v[52:53]
  v_pk_fma_f32 v[34:35], v[70:71], v[70:71], v[34:35]
  v_pk_add_f32 v[32:33], v[70:71], v[68:69]
  v_pk_fma_f32 v[30:31], v[56:57], v[56:57], v[30:31]
  v_pk_add_f32 v[28:29], v[56:57], v[28:29]
  v_pk_fma_f32 v[34:35], v[72:73], v[72:73], v[34:35]
  v_pk_add_f32 v[32:33], v[72:73], v[32:33]
  v_pk_fma_f32 v[30:31], v[58:59], v[58:59], v[30:31]
  v_pk_add_f32 v[28:29], v[58:59], v[28:29]
  v_pk_fma_f32 v[34:35], v[74:75], v[74:75], v[34:35]
  v_pk_add_f32 v[32:33], v[74:75], v[32:33]
  v_pk_fma_f32 v[30:31], v[60:61], v[60:61], v[30:31]
  v_pk_add_f32 v[28:29], v[60:61], v[28:29]
  v_pk_fma_f32 v[34:35], v[76:77], v[76:77], v[34:35]
  v_pk_add_f32 v[32:33], v[76:77], v[32:33]
  v_pk_fma_f32 v[30:31], v[62:63], v[62:63], v[30:31]
  v_pk_add_f32 v[28:29], v[62:63], v[28:29]
  v_pk_fma_f32 v[34:35], v[78:79], v[78:79], v[34:35]
  v_pk_add_f32 v[32:33], v[78:79], v[32:33]
  v_pk_fma_f32 v[30:31], v[64:65], v[64:65], v[30:31]
  v_pk_add_f32 v[28:29], v[64:65], v[28:29]
  v_pk_fma_f32 v[34:35], v[80:81], v[80:81], v[34:35]
  v_pk_add_f32 v[32:33], v[80:81], v[32:33]
  v_pk_fma_f32 v[30:31], v[66:67], v[66:67], v[30:31]
  v_pk_add_f32 v[28:29], v[66:67], v[28:29]
  v_pk_fma_f32 v[34:35], v[82:83], v[82:83], v[34:35]
  v_pk_add_f32 v[32:33], v[82:83], v[32:33]
  v_add_f32 v20, v28, v29
  v_add_f32 v21, v30, v31
  v_add_f32 v22, v32, v33
  v_add_f32 v23, v34, v35
  v_mov_b32 v24, v20
  v_mov_b32 v25, v21
  v_mov_b32 v26, v22
  v_mov_b32 v27, v23
  v_permlane16_swap_b32 v20, v24
  v_permlane16_swap_b32 v21, v25
  v_permlane16_swap_b32 v22, v26
  v_permlane16_swap_b32 v23, v27
  v_pk_add_f32 v[20:21], v[20:21], v[24:25]
  v_pk_add_f32 v[22:23], v[22:23], v[26:27]
  v_mov_b32 v24, v20
  v_mov_b32 v25, v21
  v_mov_b32 v26, v22
  v_mov_b32 v27, v23
  v_permlane32_swap_b32 v20, v24
  v_permlane32_swap_b32 v21, v25
  v_permlane32_swap_b32 v22, v26
  v_permlane32_swap_b32 v23, v27
  v_pk_add_f32 v[20:21], v[20:21], v[24:25]
  v_pk_add_f32 v[22:23], v[22:23], v[26:27]
  s_mov_b64 exec, 0xffff
  buffer_store_dwordx4 v[20:23], v0, s[36:39], s74 offen sc1
  s_mov_b64 exec, -1
  v_cvt_pk_bf16_f32 v116, v52, v53
  v_cvt_pk_bf16_f32 v117, v54, v55
  v_cvt_pk_bf16_f32 v118, v56, v57
  v_cvt_pk_bf16_f32 v119, v58, v59
  v_cvt_pk_bf16_f32 v120, v60, v61
  v_cvt_pk_bf16_f32 v121, v62, v63
  v_cvt_pk_bf16_f32 v122, v64, v65
  v_cvt_pk_bf16_f32 v123, v66, v67
  v_cvt_pk_bf16_f32 v124, v68, v69
  v_cvt_pk_bf16_f32 v125, v70, v71
  v_cvt_pk_bf16_f32 v126, v72, v73
  v_cvt_pk_bf16_f32 v127, v74, v75
  v_cvt_pk_bf16_f32 v128, v76, v77
  v_cvt_pk_bf16_f32 v129, v78, v79
  v_cvt_pk_bf16_f32 v130, v80, v81
  v_cvt_pk_bf16_f32 v131, v82, v83
  v_accvgpr_write_b32 a232, v116
  v_accvgpr_write_b32 a233, v117
  v_accvgpr_write_b32 a234, v118
  v_accvgpr_write_b32 a235, v119
  v_accvgpr_write_b32 a236, v120
  v_accvgpr_write_b32 a237, v121
  v_accvgpr_write_b32 a238, v122
  v_accvgpr_write_b32 a239, v123
  v_accvgpr_write_b32 a240, v124
  v_accvgpr_write_b32 a241, v125
  v_accvgpr_write_b32 a242, v126
  v_accvgpr_write_b32 a243, v127
  v_accvgpr_write_b32 a244, v128
  v_accvgpr_write_b32 a245, v129
  v_accvgpr_write_b32 a246, v130
  v_accvgpr_write_b32 a247, v131
  v_and_b32 v30, 0x7fff, v251
  ds_read_b64_tr_b16 a[128:129], v2 offset:28672
  ds_read_b64_tr_b16 a[130:131], v2 offset:32256
  ds_read_b64_tr_b16 a[132:133], v2 offset:28704
  ds_read_b64_tr_b16 a[134:135], v2 offset:32288
  ds_read_b64_tr_b16 a[136:137], v2 offset:28736
  ds_read_b64_tr_b16 a[138:139], v2 offset:32320
  ds_read_b64_tr_b16 a[140:141], v2 offset:28768
  ds_read_b64_tr_b16 a[142:143], v2 offset:32352
  ds_read_b64_tr_b16 a[144:145], v2 offset:28800
  ds_read_b64_tr_b16 a[146:147], v2 offset:32384
  ds_read_b64_tr_b16 a[148:149], v2 offset:28832
  ds_read_b64_tr_b16 a[150:151], v2 offset:32416
  ds_read_b64_tr_b16 a[152:153], v2 offset:35840
  ds_read_b64_tr_b16 a[154:155], v2 offset:39424
  ds_read_b64_tr_b16 a[156:157], v2 offset:35872
  ds_read_b64_tr_b16 a[158:159], v2 offset:39456
  s_waitcnt vmcnt(10) lgkmcnt(12)
  v_mfma_f32_16x16x32_bf16 v[32:35], a[128:131], a[0:3], 0
  s_waitcnt vmcnt(9)
  s_bfe_u32 s57, s82, 0x40004
  s_lshl_b32 s57, s57, 13
  v_mfma_f32_16x16x32_bf16 v[36:39], a[128:131], a[4:7], 0
  s_waitcnt vmcnt(8)
  s_add_u32 s57, s57, s85
  buffer_load_dwordx4 a[32:35], v0, s[36:39], s57 offen offset:0 sc1
  v_mfma_f32_16x16x32_bf16 v[40:43], a[128:131], a[8:11], 0
  s_waitcnt vmcnt(8)
  ds_read_b64_tr_b16 a[160:161], v2 offset:35904
  v_mfma_f32_16x16x32_bf16 v[44:47], a[128:131], a[12:15], 0
  ds_read_b64_tr_b16 a[162:163], v2 offset:39488
  v_mfma_f32_16x16x32_bf16 v[60:63], a[132:135], a[12:15], 0
  ds_read_b64_tr_b16 a[164:165], v2 offset:35936
  v_mfma_f32_16x16x32_bf16 v[56:59], a[132:135], a[8:11], 0
  v_mfma_f32_16x16x32_bf16 v[52:55], a[132:135], a[4:7], 0
  buffer_load_dwordx4 a[36:39], v0, s[36:39], s57 offen offset:1024 sc1
  v_mfma_f32_16x16x32_bf16 v[48:51], a[132:135], a[0:3], 0
  s_waitcnt lgkmcnt(11)
  ds_read_b64_tr_b16 a[166:167], v2 offset:39520
  v_mfma_f32_16x16x32_bf16 v[64:67], a[136:139], a[0:3], 0
  ds_read_b64_tr_b16 a[168:169], v2 offset:35968
  v_mfma_f32_16x16x32_bf16 v[68:71], a[136:139], a[4:7], 0
  v_mfma_f32_16x16x32_bf16 v[72:75], a[136:139], a[8:11], 0
  s_mov_b32 s68, 5308416
  ds_read_b64_tr_b16 a[170:171], v2 offset:39552
  v_mfma_f32_16x16x32_bf16 v[76:79], a[136:139], a[12:15], 0
  buffer_load_dwordx4 a[40:43], v0, s[36:39], s57 offen offset:2048 sc1
  v_mfma_f32_16x16x32_bf16 v[92:95], a[140:143], a[12:15], 0
  ds_read_b64_tr_b16 a[172:173], v2 offset:36000
  v_mfma_f32_16x16x32_bf16 v[88:91], a[140:143], a[8:11], 0
  v_mfma_f32_16x16x32_bf16 v[84:87], a[140:143], a[4:7], 0
  ds_read_b64_tr_b16 a[174:175], v2 offset:39584
  v_mfma_f32_16x16x32_bf16 v[80:83], a[140:143], a[0:3], 0
  s_waitcnt lgkmcnt(12)
  v_mfma_f32_16x16x32_bf16 v[96:99], a[144:147], a[0:3], 0
  buffer_load_dwordx4 a[44:47], v0, s[36:39], s57 offen offset:3072 sc1
  s_bfe_u32 s56, s82, 0x30008
  v_mfma_f32_16x16x32_bf16 v[100:103], a[144:147], a[4:7], 0
  s_lshl_b32 s56, s56, 2
  s_bitcmp1_b32 s82, 11
  s_addc_u32 s56, s56, 0
  v_mfma_f32_16x16x32_bf16 v[104:107], a[144:147], a[8:11], 0
  s_mul_i32 s56, s56, 229376
  s_add_u32 m0, s84, 28672
  ds_read_b64_tr_b16 a[128:129], v2 offset:28864
  v_mfma_f32_16x16x32_bf16 v[108:111], a[144:147], a[12:15], 0
  ds_read_b64_tr_b16 a[130:131], v2 offset:32448
  v_mfma_f32_16x16x32_bf16 v[124:127], a[148:151], a[12:15], 0
  ds_read_b64_tr_b16 a[132:133], v2 offset:36032
  v_mfma_f32_16x16x32_bf16 v[120:123], a[148:151], a[8:11], 0
  buffer_load_dwordx4 v3, s[16:19], s56 offen offset:0 lds
  s_add_u32 s57, s57, 4096
  v_mfma_f32_16x16x32_bf16 v[116:119], a[148:151], a[4:7], 0
  ds_read_b64_tr_b16 a[134:135], v2 offset:39616
  v_mfma_f32_16x16x32_bf16 v[112:115], a[148:151], a[0:3], 0
  s_waitcnt vmcnt(8) lgkmcnt(12)
  v_mfma_f32_16x16x32_bf16 v[32:35], a[152:155], a[16:19], v[32:35]
  ds_read_b64_tr_b16 a[136:137], v2 offset:43008
  v_mfma_f32_16x16x32_bf16 v[36:39], a[152:155], a[20:23], v[36:39]
  v_mfma_f32_16x16x32_bf16 v[40:43], a[152:155], a[24:27], v[40:43]
  buffer_load_dwordx4 a[48:51], v0, s[36:39], s57 offen offset:0 sc1
  v_mfma_f32_16x16x32_bf16 v[44:47], a[152:155], a[28:31], v[44:47]
  ds_read_b64_tr_b16 a[138:139], v2 offset:46592
  v_mfma_f32_16x16x32_bf16 v[60:63], a[156:159], a[28:31], v[60:63]
  ds_read_b64_tr_b16 a[140:141], v2 offset:50176
  v_mfma_f32_16x16x32_bf16 v[56:59], a[156:159], a[24:27], v[56:59]
  v_mfma_f32_16x16x32_bf16 v[52:55], a[156:159], a[20:23], v[52:55]
  ds_read_b64_tr_b16 a[142:143], v2 offset:53760
  v_mfma_f32_16x16x32_bf16 v[48:51], a[156:159], a[16:19], v[48:51]
  s_waitcnt lgkmcnt(12)
  buffer_load_dwordx4 v4, s[16:19], s56 offen offset:1024 lds
  v_mfma_f32_16x16x32_bf16 v[64:67], a[160:163], a[16:19], v[64:67]
  ds_read_b64_tr_b16 a[144:145], v2 offset:43040
  v_mfma_f32_16x16x32_bf16 v[68:71], a[160:163], a[20:23], v[68:71]
  v_mfma_f32_16x16x32_bf16 v[72:75], a[160:163], a[24:27], v[72:75]
  ds_read_b64_tr_b16 a[146:147], v2 offset:46624
  v_mfma_f32_16x16x32_bf16 v[76:79], a[160:163], a[28:31], v[76:79]
  v_mfma_f32_16x16x32_bf16 v[92:95], a[164:167], a[28:31], v[92:95]
  buffer_load_dwordx4 a[52:55], v0, s[36:39], s57 offen offset:1024 sc1
  v_mfma_f32_16x16x32_bf16 v[88:91], a[164:167], a[24:27], v[88:91]
  ds_read_b64_tr_b16 a[148:149], v2 offset:50208
  v_mfma_f32_16x16x32_bf16 v[84:87], a[164:167], a[20:23], v[84:87]
  ds_read_b64_tr_b16 a[150:151], v2 offset:53792
  v_mfma_f32_16x16x32_bf16 v[80:83], a[164:167], a[16:19], v[80:83]
  s_waitcnt lgkmcnt(12)
  v_mfma_f32_16x16x32_bf16 v[96:99], a[168:171], a[16:19], v[96:99]
  s_bfe_u32 s59, s82, 0x40018
  s_lshl4_add_u32 s59, s58, s59
  s_lshl_b32 s59, s59, 11
  v_mfma_f32_16x16x32_bf16 v[100:103], a[168:171], a[20:23], v[100:103]
  s_add_u32 s59, s59, 5767168
  buffer_load_dwordx4 v5, s[16:19], s56 offen offset:2048 lds
  s_lshr_b32 s76, s44, 1
  v_mfma_f32_16x16x32_bf16 v[104:107], a[168:171], a[24:27], v[104:107]
  s_mul_i32 s76, s76, 14336
  ds_read_b64_tr_b16 a[152:153], v2 offset:43072
  s_and_b32 s77, s44, 1
  v_mfma_f32_16x16x32_bf16 v[108:111], a[168:171], a[28:31], v[108:111]
  s_lshl_b32 s77, s77, 7
  ds_read_b64_tr_b16 a[154:155], v2 offset:46656
  s_add_u32 s76, s76, s77
  v_mfma_f32_16x16x32_bf16 v[124:127], a[172:175], a[28:31], v[124:127]
  ds_read_b64_tr_b16 a[156:157], v2 offset:50240
  v_add_u32 v31, s76, v1
  v_mfma_f32_16x16x32_bf16 v[120:123], a[172:175], a[24:27], v[120:123]
  s_lshl_b32 s61, s2, 15
  s_lshl1_add_u32 s61, s70, s61
  s_xor_b32 s63, s61, 32768
  v_mfma_f32_16x16x32_bf16 v[116:119], a[172:175], a[20:23], v[116:119]
  s_add_u32 s61, s61, 41943040
  buffer_load_dwordx4 a[56:59], v0, s[36:39], s57 offen offset:2048 sc1
  s_add_u32 s62, s61, 4096
  v_mfma_f32_16x16x32_bf16 v[112:115], a[172:175], a[16:19], v[112:115]
  s_waitcnt lgkmcnt(7)
  ds_read_b64_tr_b16 a[158:159], v2 offset:53824
  s_add_u32 s63, s63, 41943040
  v_mfma_f32_16x16x32_bf16 v[128:131], a[128:131], a[0:3], 0
  s_add_u32 s64, s63, 4096
  ds_read_b64_tr_b16 a[160:161], v2 offset:43104
  v_mfma_f32_16x16x32_bf16 v[128:131], a[132:135], a[16:19], v[128:131]
  v_mfma_f32_16x16x32_bf16 v[132:135], a[132:135], a[20:23], 0
  ds_read_b64_tr_b16 a[162:163], v2 offset:46688
  v_mfma_f32_16x16x32_bf16 v[132:135], a[128:131], a[4:7], v[132:135]
  buffer_load_dwordx4 v6, s[16:19], s56 offen offset:3072 lds
  v_mfma_f32_16x16x32_bf16 v[136:139], a[128:131], a[8:11], 0
  ds_read_b64_tr_b16 a[164:165], v2 offset:50272
  v_mfma_f32_16x16x32_bf16 v[136:139], a[132:135], a[24:27], v[136:139]
  v_mfma_f32_16x16x32_bf16 v[140:143], a[132:135], a[28:31], 0
  ds_read_b64_tr_b16 a[166:167], v2 offset:53856
  v_mfma_f32_16x16x32_bf16 v[140:143], a[128:131], a[12:15], v[140:143]
  v_mfma_f32_16x16x32_bf16 v[156:159], a[136:139], a[12:15], 0
  buffer_load_dwordx4 a[60:63], v0, s[36:39], s57 offen offset:3072 sc1
  s_add_u32 m0, s84, 32768
  v_mfma_f32_16x16x32_bf16 v[156:159], a[140:143], a[28:31], v[156:159]
  ds_read_b64_tr_b16 a[168:169], v2 offset:43136
  v_mfma_f32_16x16x32_bf16 v[152:155], a[140:143], a[24:27], 0
  ds_read_b64_tr_b16 a[170:171], v2 offset:46720
  v_mfma_f32_16x16x32_bf16 v[152:155], a[136:139], a[8:11], v[152:155]
  v_mfma_f32_16x16x32_bf16 v[148:151], a[136:139], a[4:7], 0
  ds_read_b64_tr_b16 a[172:173], v2 offset:50304
  v_mfma_f32_16x16x32_bf16 v[148:151], a[140:143], a[20:23], v[148:151]
  buffer_load_dwordx4 v7, s[16:19], s56 offen offset:0 lds
  s_bfe_u32 s57, s82, 0x40008
  v_mfma_f32_16x16x32_bf16 v[144:147], a[140:143], a[16:19], 0
  s_lshl_b32 s57, s57, 13
  s_add_u32 s57, s57, s85
  ds_read_b64_tr_b16 a[174:175], v2 offset:53888
  v_mfma_f32_16x16x32_bf16 v[144:147], a[136:139], a[0:3], v[144:147]
  s_waitcnt lgkmcnt(8)
  v_mfma_f32_16x16x32_bf16 v[160:163], a[144:147], a[0:3], 0
  ds_read_b64_tr_b16 a[128:129], v2 offset:43168
  v_mfma_f32_16x16x32_bf16 v[160:163], a[148:151], a[16:19], v[160:163]
  s_waitcnt vmcnt(13)
  s_barrier
  v_mfma_f32_16x16x32_bf16 v[164:167], a[148:151], a[20:23], 0
  buffer_load_dwordx4 a[64:67], v0, s[36:39], s57 offen offset:0 sc1
  v_mfma_f32_16x16x32_bf16 v[164:167], a[144:147], a[4:7], v[164:167]
  s_mov_b64 exec, 1
  buffer_store_dword v12, v0, s[36:39], s45 offen sc1
  s_mov_b64 exec, -1
  v_mfma_f32_16x16x32_bf16 v[168:171], a[144:147], a[8:11], 0
  ds_read_b64_tr_b16 a[130:131], v2 offset:46752
  v_mfma_f32_16x16x32_bf16 v[168:171], a[148:151], a[24:27], v[168:171]
  ds_read_b64_tr_b16 a[132:133], v2 offset:50336
  v_mfma_f32_16x16x32_bf16 v[172:175], a[148:151], a[28:31], 0
  ds_read_b64_tr_b16 a[134:135], v2 offset:53920
  v_mfma_f32_16x16x32_bf16 v[172:175], a[144:147], a[12:15], v[172:175]
  s_waitcnt vmcnt(26)
  s_barrier
  buffer_load_dwordx4 v8, s[16:19], s56 offen offset:1024 lds
  v_mfma_f32_16x16x32_bf16 v[188:191], a[152:155], a[12:15], 0
  ds_read_b64_tr_b16 a[136:137], v2 offset:43200
  v_mfma_f32_16x16x32_bf16 v[188:191], a[156:159], a[28:31], v[188:191]
  v_mfma_f32_16x16x32_bf16 v[184:187], a[156:159], a[24:27], 0
  ds_read_b64_tr_b16 a[138:139], v2 offset:46784
  v_mfma_f32_16x16x32_bf16 v[184:187], a[152:155], a[8:11], v[184:187]
  v_mfma_f32_16x16x32_bf16 v[180:183], a[152:155], a[4:7], 0
  buffer_load_dwordx4 a[68:71], v0, s[36:39], s57 offen offset:1024 sc1
  v_mfma_f32_16x16x32_bf16 v[180:183], a[156:159], a[20:23], v[180:183]
  ds_read_b64_tr_b16 a[140:141], v2 offset:50368
  v_mfma_f32_16x16x32_bf16 v[176:179], a[156:159], a[16:19], 0
  ds_read_b64_tr_b16 a[142:143], v2 offset:53952
  v_mfma_f32_16x16x32_bf16 v[176:179], a[152:155], a[0:3], v[176:179]
  s_waitcnt lgkmcnt(8)
  v_mfma_f32_16x16x32_bf16 v[192:195], a[160:163], a[0:3], 0
  ds_read_b64_tr_b16 a[144:145], v1 offset:0
  v_mfma_f32_16x16x32_bf16 v[192:195], a[164:167], a[16:19], v[192:195]
  v_mfma_f32_16x16x32_bf16 v[196:199], a[164:167], a[20:23], 0
  ds_read_b64_tr_b16 a[146:147], v1 offset:3584
  v_mfma_f32_16x16x32_bf16 v[196:199], a[160:163], a[4:7], v[196:199]
  v_mfma_f32_16x16x32_bf16 v[200:203], a[160:163], a[8:11], 0
  ds_read_b64_tr_b16 a[148:149], v1 offset:7168
  v_mfma_f32_16x16x32_bf16 v[200:203], a[164:167], a[24:27], v[200:203]
  v_mfma_f32_16x16x32_bf16 v[204:207], a[164:167], a[28:31], 0
  buffer_load_dwordx4 v9, s[16:19], s56 offen offset:2048 lds
  v_mfma_f32_16x16x32_bf16 v[204:207], a[160:163], a[12:15], v[204:207]
  ds_read_b64_tr_b16 a[150:151], v1 offset:10752
  v_mfma_f32_16x16x32_bf16 v[220:223], a[168:171], a[12:15], 0
  ds_read_b64_tr_b16 a[152:153], v1 offset:32
  v_mfma_f32_16x16x32_bf16 v[220:223], a[172:175], a[28:31], v[220:223]
  v_mfma_f32_16x16x32_bf16 v[216:219], a[172:175], a[24:27], 0
  ds_read_b64_tr_b16 a[154:155], v1 offset:3616
  v_mfma_f32_16x16x32_bf16 v[216:219], a[168:171], a[8:11], v[216:219]
  buffer_load_dwordx4 a[72:75], v0, s[36:39], s57 offen offset:2048 sc1
  v_mfma_f32_16x16x32_bf16 v[212:215], a[168:171], a[4:7], 0
  ds_read_b64_tr_b16 a[156:157], v1 offset:7200
  v_mfma_f32_16x16x32_bf16 v[212:215], a[172:175], a[20:23], v[212:215]
  v_mfma_f32_16x16x32_bf16 v[208:211], a[172:175], a[16:19], 0
  ds_read_b64_tr_b16 a[158:159], v1 offset:10784
  v_mfma_f32_16x16x32_bf16 v[208:211], a[168:171], a[0:3], v[208:211]
  s_waitcnt lgkmcnt(8)
  v_mfma_f32_16x16x32_bf16 v[224:227], a[128:131], a[0:3], 0
  ds_read_b64_tr_b16 a[160:161], v1 offset:64
  v_mfma_f32_16x16x32_bf16 v[224:227], a[132:135], a[16:19], v[224:227]
  v_mfma_f32_16x16x32_bf16 v[228:231], a[132:135], a[20:23], 0
  ds_read_b64_tr_b16 a[162:163], v1 offset:3648
  v_mfma_f32_16x16x32_bf16 v[228:231], a[128:131], a[4:7], v[228:231]
  v_mfma_f32_16x16x32_bf16 v[232:235], a[128:131], a[8:11], 0
  ds_read_b64_tr_b16 a[164:165], v1 offset:7232
  v_mfma_f32_16x16x32_bf16 v[232:235], a[132:135], a[24:27], v[232:235]
  buffer_load_dwordx4 a[76:79], v0, s[36:39], s57 offen offset:3072 sc1
  v_mfma_f32_16x16x32_bf16 v[236:239], a[132:135], a[28:31], 0
  ds_read_b64_tr_b16 a[166:167], v1 offset:10816
  v_mfma_f32_16x16x32_bf16 v[236:239], a[128:131], a[12:15], v[236:239]
  v_mfma_f32_16x16x32_bf16 v[252:255], a[136:139], a[12:15], 0
  ds_read_b64_tr_b16 a[168:169], v1 offset:96
  v_mfma_f32_16x16x32_bf16 v[252:255], a[140:143], a[28:31], v[252:255]
  s_bfe_u32 s56, s82, 0x3000c
  s_lshl_b32 s56, s56, 2
  s_bitcmp1_b32 s82, 15
  v_mfma_f32_16x16x32_bf16 v[248:251], a[140:143], a[24:27], 0
  s_addc_u32 s56, s56, 0
  s_mul_i32 s56, s56, 229376
  s_add_u32 m0, s84, 57344
  v_mfma_f32_16x16x32_bf16 v[248:251], a[136:139], a[8:11], v[248:251]
  ds_read_b64_tr_b16 a[170:171], v1 offset:3680
  v_mfma_f32_16x16x32_bf16 v[244:247], a[136:139], a[4:7], 0
  ds_read_b64_tr_b16 a[172:173], v1 offset:7264
  v_mfma_f32_16x16x32_bf16 v[244:247], a[140:143], a[20:23], v[244:247]
  buffer_load_dwordx4 v3, s[16:19], s56 offen offset:0 lds
  v_mfma_f32_16x16x32_bf16 v[240:243], a[140:143], a[16:19], 0
  ds_read_b64_tr_b16 a[174:175], v1 offset:10848
  v_mfma_f32_16x16x32_bf16 v[240:243], a[136:139], a[0:3], v[240:243]
  s_waitcnt vmcnt(9) lgkmcnt(8)
  v_mfma_f32_16x16x32_bf16 v[32:35], a[144:147], a[32:35], v[32:35]
  s_add_u32 s57, s57, 4096
  ds_read_b64_tr_b16 a[128:129], v1 offset:128
  v_mfma_f32_16x16x32_bf16 v[32:35], a[148:151], a[48:51], v[32:35]
  v_mfma_f32_16x16x32_bf16 v[36:39], a[148:151], a[52:55], v[36:39]
  ds_read_b64_tr_b16 a[130:131], v1 offset:3712
  v_mfma_f32_16x16x32_bf16 v[36:39], a[144:147], a[36:39], v[36:39]
  v_mfma_f32_16x16x32_bf16 v[40:43], a[144:147], a[40:43], v[40:43]
  buffer_load_dwordx4 a[80:83], v0, s[36:39], s57 offen offset:0 sc1
  v_mfma_f32_16x16x32_bf16 v[40:43], a[148:151], a[56:59], v[40:43]
  ds_read_b64_tr_b16 a[132:133], v1 offset:7296
  v_mfma_f32_16x16x32_bf16 v[44:47], a[148:151], a[60:63], v[44:47]
  ds_read_b64_tr_b16 a[134:135], v1 offset:10880
  v_mfma_f32_16x16x32_bf16 v[44:47], a[144:147], a[44:47], v[44:47]
  v_mfma_f32_16x16x32_bf16 v[60:63], a[152:155], a[44:47], v[60:63]
  ds_read_b64_tr_b16 a[136:137], v1 offset:160
  v_mfma_f32_16x16x32_bf16 v[60:63], a[156:159], a[60:63], v[60:63]
  v_mfma_f32_16x16x32_bf16 v[56:59], a[156:159], a[56:59], v[56:59]
  ds_read_b64_tr_b16 a[138:139], v1 offset:3744
  v_mfma_f32_16x16x32_bf16 v[56:59], a[152:155], a[40:43], v[56:59]
  buffer_load_dwordx4 v4, s[16:19], s56 offen offset:1024 lds
  v_mfma_f32_16x16x32_bf16 v[52:55], a[152:155], a[36:39], v[52:55]
  ds_read_b64_tr_b16 a[140:141], v1 offset:7328
  v_mfma_f32_16x16x32_bf16 v[52:55], a[156:159], a[52:55], v[52:55]
  v_mfma_f32_16x16x32_bf16 v[48:51], a[156:159], a[48:51], v[48:51]
  ds_read_b64_tr_b16 a[142:143], v1 offset:10912
  v_mfma_f32_16x16x32_bf16 v[48:51], a[152:155], a[32:35], v[48:51]
  s_waitcnt lgkmcnt(8)
  v_mfma_f32_16x16x32_bf16 v[64:67], a[160:163], a[32:35], v[64:67]
  ds_read_b64_tr_b16 a[144:145], v1 offset:192
  v_mfma_f32_16x16x32_bf16 v[64:67], a[164:167], a[48:51], v[64:67]
  v_mfma_f32_16x16x32_bf16 v[68:71], a[164:167], a[52:55], v[68:71]
  ds_read_b64_tr_b16 a[146:147], v1 offset:3776
  v_mfma_f32_16x16x32_bf16 v[68:71], a[160:163], a[36:39], v[68:71]
  buffer_load_dwordx4 a[84:87], v0, s[36:39], s57 offen offset:1024 sc1
  v_mfma_f32_16x16x32_bf16 v[72:75], a[160:163], a[40:43], v[72:75]
  ds_read_b64_tr_b16 a[148:149], v1 offset:7360
  v_mfma_f32_16x16x32_bf16 v[72:75], a[164:167], a[56:59], v[72:75]
  v_mfma_f32_16x16x32_bf16 v[76:79], a[164:167], a[60:63], v[76:79]
  ds_read_b64_tr_b16 a[150:151], v1 offset:10944
  v_mfma_f32_16x16x32_bf16 v[76:79], a[160:163], a[44:47], v[76:79]
  v_mfma_f32_16x16x32_bf16 v[92:95], a[168:171], a[44:47], v[92:95]
  ds_read_b64_tr_b16 a[152:153], v1 offset:14336
  v_mfma_f32_16x16x32_bf16 v[92:95], a[172:175], a[60:63], v[92:95]
  v_mfma_f32_16x16x32_bf16 v[88:91], a[172:175], a[56:59], v[88:91]
  buffer_load_dwordx4 v5, s[16:19], s56 offen offset:2048 lds
  v_mfma_f32_16x16x32_bf16 v[88:91], a[168:171], a[40:43], v[88:91]
  ds_read_b64_tr_b16 a[154:155], v1 offset:17920
  v_mfma_f32_16x16x32_bf16 v[84:87], a[168:171], a[36:39], v[84:87]
  ds_read_b64_tr_b16 a[156:157], v1 offset:21504
  v_mfma_f32_16x16x32_bf16 v[84:87], a[172:175], a[52:55], v[84:87]
  v_mfma_f32_16x16x32_bf16 v[80:83], a[172:175], a[48:51], v[80:83]
  ds_read_b64_tr_b16 a[158:159], v1 offset:25088
  v_mfma_f32_16x16x32_bf16 v[80:83], a[168:171], a[32:35], v[80:83]
  s_waitcnt lgkmcnt(8)
  v_mfma_f32_16x16x32_bf16 v[96:99], a[128:131], a[32:35], v[96:99]
  ds_read_b64_tr_b16 a[160:161], v1 offset:14368
  v_mfma_f32_16x16x32_bf16 v[96:99], a[132:135], a[48:51], v[96:99]
  v_mfma_f32_16x16x32_bf16 v[100:103], a[132:135], a[52:55], v[100:103]
  buffer_load_dwordx4 a[88:91], v0, s[36:39], s57 offen offset:2048 sc1
  v_mfma_f32_16x16x32_bf16 v[100:103], a[128:131], a[36:39], v[100:103]
Hc0:
  s_cbranch_execz Hc0_1
  ds_read_b64_tr_b16 a[162:163], v1 offset:17952
  v_mfma_f32_16x16x32_bf16 v[104:107], a[128:131], a[40:43], v[104:107]
  ds_read_b64_tr_b16 a[164:165], v1 offset:21536
  v_mfma_f32_16x16x32_bf16 v[104:107], a[132:135], a[56:59], v[104:107]
  v_mfma_f32_16x16x32_bf16 v[108:111], a[132:135], a[60:63], v[108:111]
  ds_read_b64_tr_b16 a[166:167], v1 offset:25120
  v_mfma_f32_16x16x32_bf16 v[108:111], a[128:131], a[44:47], v[108:111]
  v_mfma_f32_16x16x32_bf16 v[124:127], a[136:139], a[44:47], v[124:127]
  ds_read_b64_tr_b16 a[168:169], v1 offset:14400
  v_mfma_f32_16x16x32_bf16 v[124:127], a[140:143], a[60:63], v[124:127]
  buffer_load_dwordx4 v6, s[16:19], s56 offen offset:3072 lds
  v_mfma_f32_16x16x32_bf16 v[120:123], a[140:143], a[56:59], v[120:123]
  ds_read_b64_tr_b16 a[170:171], v1 offset:17984
  v_mfma_f32_16x16x32_bf16 v[120:123], a[136:139], a[40:43], v[120:123]
  v_mfma_f32_16x16x32_bf16 v[116:119], a[136:139], a[36:39], v[116:119]
  ds_read_b64_tr_b16 a[172:173], v1 offset:21568
  v_mfma_f32_16x16x32_bf16 v[116:119], a[140:143], a[52:55], v[116:119]
  v_mfma_f32_16x16x32_bf16 v[112:115], a[140:143], a[48:51], v[112:115]
  ds_read_b64_tr_b16 a[174:175], v1 offset:25152
  v_mfma_f32_16x16x32_bf16 v[112:115], a[136:139], a[32:35], v[112:115]
  s_waitcnt lgkmcnt(8)
  v_mfma_f32_16x16x32_bf16 v[128:131], a[144:147], a[32:35], v[128:131]
  ds_read_b64_tr_b16 a[128:129], v1 offset:14432
  v_mfma_f32_16x16x32_bf16 v[128:131], a[148:151], a[48:51], v[128:131]
  buffer_load_dwordx4 a[92:95], v0, s[36:39], s57 offen offset:3072 sc1
  v_mfma_f32_16x16x32_bf16 v[132:135], a[148:151], a[52:55], v[132:135]
  ds_read_b64_tr_b16 a[130:131], v1 offset:18016
  v_mfma_f32_16x16x32_bf16 v[132:135], a[144:147], a[36:39], v[132:135]
  v_mfma_f32_16x16x32_bf16 v[136:139], a[144:147], a[40:43], v[136:139]
  s_add_u32 m0, s84, 61440
  ds_read_b64_tr_b16 a[132:133], v1 offset:21600
  v_mfma_f32_16x16x32_bf16 v[136:139], a[148:151], a[56:59], v[136:139]
  v_mfma_f32_16x16x32_bf16 v[140:143], a[148:151], a[60:63], v[140:143]
  ds_read_b64_tr_b16 a[134:135], v1 offset:25184
  v_mfma_f32_16x16x32_bf16 v[140:143], a[144:147], a[44:47], v[140:143]
  v_mfma_f32_16x16x32_bf16 v[156:159], a[152:155], a[44:47], v[156:159]
  buffer_load_dwordx4 v7, s[16:19], s56 offen offset:0 lds
  s_bfe_u32 s57, s82, 0x4000c
  v_mfma_f32_16x16x32_bf16 v[156:159], a[156:159], a[60:63], v[156:159]
  s_lshl_b32 s57, s57, 13
  s_add_u32 s57, s57, s85
  ds_read_b64_tr_b16 a[136:137], v1 offset:14464
  v_mfma_f32_16x16x32_bf16 v[152:155], a[156:159], a[56:59], v[152:155]
  ds_read_b64_tr_b16 a[138:139], v1 offset:18048
  v_mfma_f32_16x16x32_bf16 v[152:155], a[152:155], a[40:43], v[152:155]
  v_mfma_f32_16x16x32_bf16 v[148:151], a[152:155], a[36:39], v[148:151]
  ds_read_b64_tr_b16 a[140:141], v1 offset:21632
  v_mfma_f32_16x16x32_bf16 v[148:151], a[156:159], a[52:55], v[148:151]
  buffer_load_dwordx4 a[96:99], v0, s[36:39], s57 offen offset:0 sc1
  v_mfma_f32_16x16x32_bf16 v[144:147], a[156:159], a[48:51], v[144:147]
  ds_read_b64_tr_b16 a[142:143], v1 offset:25216
  v_mfma_f32_16x16x32_bf16 v[144:147], a[152:155], a[32:35], v[144:147]
  s_waitcnt lgkmcnt(8)
  v_mfma_f32_16x16x32_bf16 v[160:163], a[160:163], a[32:35], v[160:163]
  ds_read_b64_tr_b16 a[144:145], v1 offset:14496
  v_mfma_f32_16x16x32_bf16 v[160:163], a[164:167], a[48:51], v[160:163]
  v_mfma_f32_16x16x32_bf16 v[164:167], a[164:167], a[52:55], v[164:167]
  ds_read_b64_tr_b16 a[146:147], v1 offset:18080
  v_mfma_f32_16x16x32_bf16 v[164:167], a[160:163], a[36:39], v[164:167]
  v_mfma_f32_16x16x32_bf16 v[168:171], a[160:163], a[40:43], v[168:171]
  ds_read_b64_tr_b16 a[148:149], v1 offset:21664
  v_mfma_f32_16x16x32_bf16 v[168:171], a[164:167], a[56:59], v[168:171]
  v_mfma_f32_16x16x32_bf16 v[172:175], a[164:167], a[60:63], v[172:175]
  ds_read_b64_tr_b16 a[150:151], v1 offset:25248
  v_mfma_f32_16x16x32_bf16 v[172:175], a[160:163], a[44:47], v[172:175]
  s_waitcnt vmcnt(12)
  s_barrier
  buffer_load_dwordx4 v8, s[16:19], s56 offen offset:1024 lds
  v_mfma_f32_16x16x32_bf16 v[188:191], a[168:171], a[44:47], v[188:191]
  ds_read_b64_tr_b16 a[152:153], v1 offset:14528
  v_mfma_f32_16x16x32_bf16 v[188:191], a[172:175], a[60:63], v[188:191]
  v_mfma_f32_16x16x32_bf16 v[184:187], a[172:175], a[56:59], v[184:187]
  ds_read_b64_tr_b16 a[154:155], v1 offset:18112
  v_mfma_f32_16x16x32_bf16 v[184:187], a[168:171], a[40:43], v[184:187]
  v_mfma_f32_16x16x32_bf16 v[180:183], a[168:171], a[36:39], v[180:183]
  buffer_load_dwordx4 a[100:103], v0, s[36:39], s57 offen offset:1024 sc1
  v_mfma_f32_16x16x32_bf16 v[180:183], a[172:175], a[52:55], v[180:183]
  ds_read_b64_tr_b16 a[156:157], v1 offset:21696
  v_mfma_f32_16x16x32_bf16 v[176:179], a[172:175], a[48:51], v[176:179]
  ds_read_b64_tr_b16 a[158:159], v1 offset:25280
  v_mfma_f32_16x16x32_bf16 v[176:179], a[168:171], a[32:35], v[176:179]
  s_waitcnt lgkmcnt(8)
  v_mfma_f32_16x16x32_bf16 v[192:195], a[128:131], a[32:35], v[192:195]
  ds_read_b64_tr_b16 a[160:161], v1 offset:28672
  v_mfma_f32_16x16x32_bf16 v[192:195], a[132:135], a[48:51], v[192:195]
  v_mfma_f32_16x16x32_bf16 v[196:199], a[132:135], a[52:55], v[196:199]
  ds_read_b64_tr_b16 a[162:163], v1 offset:32256
  v_mfma_f32_16x16x32_bf16 v[196:199], a[128:131], a[36:39], v[196:199]
  v_mfma_f32_16x16x32_bf16 v[200:203], a[128:131], a[40:43], v[200:203]
  ds_read_b64_tr_b16 a[164:165], v1 offset:35840
  v_mfma_f32_16x16x32_bf16 v[200:203], a[132:135], a[56:59], v[200:203]
  v_mfma_f32_16x16x32_bf16 v[204:207], a[132:135], a[60:63], v[204:207]
  buffer_load_dwordx4 v9, s[16:19], s56 offen offset:2048 lds
  v_mfma_f32_16x16x32_bf16 v[204:207], a[128:131], a[44:47], v[204:207]
  ds_read_b64_tr_b16 a[166:167], v1 offset:39424
  v_mfma_f32_16x16x32_bf16 v[220:223], a[136:139], a[44:47], v[220:223]
  ds_read_b64_tr_b16 a[168:169], v1 offset:28704
  v_mfma_f32_16x16x32_bf16 v[220:223], a[140:143], a[60:63], v[220:223]
  v_mfma_f32_16x16x32_bf16 v[216:219], a[140:143], a[56:59], v[216:219]
  ds_read_b64_tr_b16 a[170:171], v1 offset:32288
  v_mfma_f32_16x16x32_bf16 v[216:219], a[136:139], a[40:43], v[216:219]
  buffer_load_dwordx4 a[104:107], v0, s[36:39], s57 offen offset:2048 sc1
  v_mfma_f32_16x16x32_bf16 v[212:215], a[136:139], a[36:39], v[212:215]
  ds_read_b64_tr_b16 a[172:173], v1 offset:35872
  v_mfma_f32_16x16x32_bf16 v[212:215], a[140:143], a[52:55], v[212:215]
  v_mfma_f32_16x16x32_bf16 v[208:211], a[140:143], a[48:51], v[208:211]
  ds_read_b64_tr_b16 a[174:175], v1 offset:39456
  v_mfma_f32_16x16x32_bf16 v[208:211], a[136:139], a[32:35], v[208:211]
  s_waitcnt lgkmcnt(8)
  v_mfma_f32_16x16x32_bf16 v[224:227], a[144:147], a[32:35], v[224:227]
  ds_read_b64_tr_b16 a[128:129], v1 offset:28736
  v_mfma_f32_16x16x32_bf16 v[224:227], a[148:151], a[48:51], v[224:227]
  v_mfma_f32_16x16x32_bf16 v[228:231], a[148:151], a[52:55], v[228:231]
  ds_read_b64_tr_b16 a[130:131], v1 offset:32320
  v_mfma_f32_16x16x32_bf16 v[228:231], a[144:147], a[36:39], v[228:231]
  v_mfma_f32_16x16x32_bf16 v[232:235], a[144:147], a[40:43], v[232:235]
  ds_read_b64_tr_b16 a[132:133], v1 offset:35904
  v_mfma_f32_16x16x32_bf16 v[232:235], a[148:151], a[56:59], v[232:235]
  buffer_load_dwordx4 a[108:111], v0, s[36:39], s57 offen offset:3072 sc1
  v_mfma_f32_16x16x32_bf16 v[236:239], a[148:151], a[60:63], v[236:239]
  ds_read_b64_tr_b16 a[134:135], v1 offset:39488
  v_mfma_f32_16x16x32_bf16 v[236:239], a[144:147], a[44:47], v[236:239]
  v_mfma_f32_16x16x32_bf16 v[252:255], a[152:155], a[44:47], v[252:255]
  ds_read_b64_tr_b16 a[136:137], v1 offset:28768
  v_mfma_f32_16x16x32_bf16 v[252:255], a[156:159], a[60:63], v[252:255]
  s_bfe_u32 s56, s82, 0x30010
  s_lshl_b32 s56, s56, 2
  s_bitcmp1_b32 s82, 19
  v_mfma_f32_16x16x32_bf16 v[248:251], a[156:159], a[56:59], v[248:251]
  s_addc_u32 s56, s56, 0
  s_mul_i32 s56, s56, 229376
  s_add_u32 m0, s84, 86016
  v_mfma_f32_16x16x32_bf16 v[248:251], a[152:155], a[40:43], v[248:251]
  ds_read_b64_tr_b16 a[138:139], v1 offset:32352
  v_mfma_f32_16x16x32_bf16 v[244:247], a[152:155], a[36:39], v[244:247]
  ds_read_b64_tr_b16 a[140:141], v1 offset:35936
  v_mfma_f32_16x16x32_bf16 v[244:247], a[156:159], a[52:55], v[244:247]
  buffer_load_dwordx4 v3, s[16:19], s56 offen offset:0 lds
  v_mfma_f32_16x16x32_bf16 v[240:243], a[156:159], a[48:51], v[240:243]
  ds_read_b64_tr_b16 a[142:143], v1 offset:39520
  v_mfma_f32_16x16x32_bf16 v[240:243], a[152:155], a[32:35], v[240:243]
  s_waitcnt vmcnt(8) lgkmcnt(8)
  v_mfma_f32_16x16x32_bf16 v[32:35], a[160:163], a[64:67], v[32:35]
  s_add_u32 s57, s57, 4096
  ds_read_b64_tr_b16 a[144:145], v1 offset:28800
  v_mfma_f32_16x16x32_bf16 v[32:35], a[164:167], a[80:83], v[32:35]
  v_mfma_f32_16x16x32_bf16 v[36:39], a[164:167], a[84:87], v[36:39]
  ds_read_b64_tr_b16 a[146:147], v1 offset:32384
  v_mfma_f32_16x16x32_bf16 v[36:39], a[160:163], a[68:71], v[36:39]
  v_mfma_f32_16x16x32_bf16 v[40:43], a[160:163], a[72:75], v[40:43]
  buffer_load_dwordx4 a[112:115], v0, s[36:39], s57 offen offset:0 sc1
  v_mfma_f32_16x16x32_bf16 v[40:43], a[164:167], a[88:91], v[40:43]
  ds_read_b64_tr_b16 a[148:149], v1 offset:35968
  v_mfma_f32_16x16x32_bf16 v[44:47], a[164:167], a[92:95], v[44:47]
  ds_read_b64_tr_b16 a[150:151], v1 offset:39552
  v_mfma_f32_16x16x32_bf16 v[44:47], a[160:163], a[76:79], v[44:47]
  v_mfma_f32_16x16x32_bf16 v[60:63], a[168:171], a[76:79], v[60:63]
  ds_read_b64_tr_b16 a[152:153], v1 offset:28832
  v_mfma_f32_16x16x32_bf16 v[60:63], a[172:175], a[92:95], v[60:63]
  v_mfma_f32_16x16x32_bf16 v[56:59], a[172:175], a[88:91], v[56:59]
  ds_read_b64_tr_b16 a[154:155], v1 offset:32416
  v_mfma_f32_16x16x32_bf16 v[56:59], a[168:171], a[72:75], v[56:59]
  buffer_load_dwordx4 v4, s[16:19], s56 offen offset:1024 lds
  v_mfma_f32_16x16x32_bf16 v[52:55], a[168:171], a[68:71], v[52:55]
  ds_read_b64_tr_b16 a[156:157], v1 offset:36000
  v_mfma_f32_16x16x32_bf16 v[52:55], a[172:175], a[84:87], v[52:55]
  v_mfma_f32_16x16x32_bf16 v[48:51], a[172:175], a[80:83], v[48:51]
  ds_read_b64_tr_b16 a[158:159], v1 offset:39584
  v_mfma_f32_16x16x32_bf16 v[48:51], a[168:171], a[64:67], v[48:51]
  s_waitcnt lgkmcnt(8)
  v_mfma_f32_16x16x32_bf16 v[64:67], a[128:131], a[64:67], v[64:67]
  ds_read_b64_tr_b16 a[160:161], v1 offset:28864
  v_mfma_f32_16x16x32_bf16 v[64:67], a[132:135], a[80:83], v[64:67]
  v_mfma_f32_16x16x32_bf16 v[68:71], a[132:135], a[84:87], v[68:71]
  ds_read_b64_tr_b16 a[162:163], v1 offset:32448
  v_mfma_f32_16x16x32_bf16 v[68:71], a[128:131], a[68:71], v[68:71]
  buffer_load_dwordx4 a[116:119], v0, s[36:39], s57 offen offset:1024 sc1
  v_mfma_f32_16x16x32_bf16 v[72:75], a[128:131], a[72:75], v[72:75]
  ds_read_b64_tr_b16 a[164:165], v1 offset:36032
  v_mfma_f32_16x16x32_bf16 v[72:75], a[132:135], a[88:91], v[72:75]
  v_mfma_f32_16x16x32_bf16 v[76:79], a[132:135], a[92:95], v[76:79]
  ds_read_b64_tr_b16 a[166:167], v1 offset:39616
  v_mfma_f32_16x16x32_bf16 v[76:79], a[128:131], a[76:79], v[76:79]
  v_mfma_f32_16x16x32_bf16 v[92:95], a[136:139], a[76:79], v[92:95]
  ds_read_b64_tr_b16 a[168:169], v1 offset:43008
  v_mfma_f32_16x16x32_bf16 v[92:95], a[140:143], a[92:95], v[92:95]
  v_mfma_f32_16x16x32_bf16 v[88:91], a[140:143], a[88:91], v[88:91]
  buffer_load_dwordx4 v5, s[16:19], s56 offen offset:2048 lds
  v_mfma_f32_16x16x32_bf16 v[88:91], a[136:139], a[72:75], v[88:91]
  ds_read_b64_tr_b16 a[170:171], v1 offset:46592
  v_mfma_f32_16x16x32_bf16 v[84:87], a[136:139], a[68:71], v[84:87]
  ds_read_b64_tr_b16 a[172:173], v1 offset:50176
  v_mfma_f32_16x16x32_bf16 v[84:87], a[140:143], a[84:87], v[84:87]
  v_mfma_f32_16x16x32_bf16 v[80:83], a[140:143], a[80:83], v[80:83]
  ds_read_b64_tr_b16 a[174:175], v1 offset:53760
  v_mfma_f32_16x16x32_bf16 v[80:83], a[136:139], a[64:67], v[80:83]
  s_waitcnt lgkmcnt(8)
  v_mfma_f32_16x16x32_bf16 v[96:99], a[144:147], a[64:67], v[96:99]
  ds_read_b64_tr_b16 a[128:129], v1 offset:43040
  v_mfma_f32_16x16x32_bf16 v[96:99], a[148:151], a[80:83], v[96:99]
  v_mfma_f32_16x16x32_bf16 v[100:103], a[148:151], a[84:87], v[100:103]
  buffer_load_dwordx4 a[120:123], v0, s[36:39], s57 offen offset:2048 sc1
  v_mfma_f32_16x16x32_bf16 v[100:103], a[144:147], a[68:71], v[100:103]
  ds_read_b64_tr_b16 a[130:131], v1 offset:46624
  v_mfma_f32_16x16x32_bf16 v[104:107], a[144:147], a[72:75], v[104:107]
  ds_read_b64_tr_b16 a[132:133], v1 offset:50208
  v_mfma_f32_16x16x32_bf16 v[104:107], a[148:151], a[88:91], v[104:107]
  v_mfma_f32_16x16x32_bf16 v[108:111], a[148:151], a[92:95], v[108:111]
  ds_read_b64_tr_b16 a[134:135], v1 offset:53792
  v_mfma_f32_16x16x32_bf16 v[108:111], a[144:147], a[76:79], v[108:111]
  v_mfma_f32_16x16x32_bf16 v[124:127], a[152:155], a[76:79], v[124:127]
  ds_read_b64_tr_b16 a[136:137], v1 offset:43072
  v_mfma_f32_16x16x32_bf16 v[124:127], a[156:159], a[92:95], v[124:127]
  buffer_load_dwordx4 v6, s[16:19], s56 offen offset:3072 lds
  v_mfma_f32_16x16x32_bf16 v[120:123], a[156:159], a[88:91], v[120:123]
  ds_read_b64_tr_b16 a[138:139], v1 offset:46656
  v_mfma_f32_16x16x32_bf16 v[120:123], a[152:155], a[72:75], v[120:123]
  v_mfma_f32_16x16x32_bf16 v[116:119], a[152:155], a[68:71], v[116:119]
  ds_read_b64_tr_b16 a[140:141], v1 offset:50240
  v_mfma_f32_16x16x32_bf16 v[116:119], a[156:159], a[84:87], v[116:119]
  v_mfma_f32_16x16x32_bf16 v[112:115], a[156:159], a[80:83], v[112:115]
  ds_read_b64_tr_b16 a[142:143], v1 offset:53824
  v_mfma_f32_16x16x32_bf16 v[112:115], a[152:155], a[64:67], v[112:115]
  s_waitcnt lgkmcnt(8)
  v_mfma_f32_16x16x32_bf16 v[128:131], a[160:163], a[64:67], v[128:131]
  ds_read_b64_tr_b16 a[144:145], v1 offset:43104
  v_mfma_f32_16x16x32_bf16 v[128:131], a[164:167], a[80:83], v[128:131]
  buffer_load_dwordx4 a[124:127], v0, s[36:39], s57 offen offset:3072 sc1
  v_mfma_f32_16x16x32_bf16 v[132:135], a[164:167], a[84:87], v[132:135]
  ds_read_b64_tr_b16 a[146:147], v1 offset:46688
  v_mfma_f32_16x16x32_bf16 v[132:135], a[160:163], a[68:71], v[132:135]
  v_mfma_f32_16x16x32_bf16 v[136:139], a[160:163], a[72:75], v[136:139]
  s_add_u32 m0, s84, 90112
  ds_read_b64_tr_b16 a[148:149], v1 offset:50272
  v_mfma_f32_16x16x32_bf16 v[136:139], a[164:167], a[88:91], v[136:139]
  v_mfma_f32_16x16x32_bf16 v[140:143], a[164:167], a[92:95], v[140:143]
  ds_read_b64_tr_b16 a[150:151], v1 offset:53856
  v_mfma_f32_16x16x32_bf16 v[140:143], a[160:163], a[76:79], v[140:143]
  v_mfma_f32_16x16x32_bf16 v[156:159], a[168:171], a[76:79], v[156:159]
  buffer_load_dwordx4 v7, s[16:19], s56 offen offset:0 lds
  s_bfe_u32 s57, s82, 0x40010
  v_mfma_f32_16x16x32_bf16 v[156:159], a[172:175], a[92:95], v[156:159]
  s_lshl_b32 s57, s57, 13
  s_add_u32 s57, s57, s85
  ds_read_b64_tr_b16 a[152:153], v1 offset:43136
  v_mfma_f32_16x16x32_bf16 v[152:155], a[172:175], a[88:91], v[152:155]
  ds_read_b64_tr_b16 a[154:155], v1 offset:46720
  v_mfma_f32_16x16x32_bf16 v[152:155], a[168:171], a[72:75], v[152:155]
  v_mfma_f32_16x16x32_bf16 v[148:151], a[168:171], a[68:71], v[148:151]
  ds_read_b64_tr_b16 a[156:157], v1 offset:50304
  v_mfma_f32_16x16x32_bf16 v[148:151], a[172:175], a[84:87], v[148:151]
  buffer_load_dwordx4 a[0:3], v0, s[36:39], s57 offen offset:0 sc1
  v_mfma_f32_16x16x32_bf16 v[144:147], a[172:175], a[80:83], v[144:147]
  ds_read_b64_tr_b16 a[158:159], v1 offset:53888
  v_mfma_f32_16x16x32_bf16 v[144:147], a[168:171], a[64:67], v[144:147]
  s_waitcnt lgkmcnt(8)
  v_mfma_f32_16x16x32_bf16 v[160:163], a[128:131], a[64:67], v[160:163]
  ds_read_b64_tr_b16 a[160:161], v1 offset:43168
  v_mfma_f32_16x16x32_bf16 v[160:163], a[132:135], a[80:83], v[160:163]
  v_mfma_f32_16x16x32_bf16 v[164:167], a[132:135], a[84:87], v[164:167]
  ds_read_b64_tr_b16 a[162:163], v1 offset:46752
  v_mfma_f32_16x16x32_bf16 v[164:167], a[128:131], a[68:71], v[164:167]
  v_mfma_f32_16x16x32_bf16 v[168:171], a[128:131], a[72:75], v[168:171]
  ds_read_b64_tr_b16 a[164:165], v1 offset:50336
  v_mfma_f32_16x16x32_bf16 v[168:171], a[132:135], a[88:91], v[168:171]
  v_mfma_f32_16x16x32_bf16 v[172:175], a[132:135], a[92:95], v[172:175]
  ds_read_b64_tr_b16 a[166:167], v1 offset:53920
  v_mfma_f32_16x16x32_bf16 v[172:175], a[128:131], a[76:79], v[172:175]
  s_waitcnt vmcnt(12)
  s_barrier
  buffer_load_dwordx4 v8, s[16:19], s56 offen offset:1024 lds
  v_mfma_f32_16x16x32_bf16 v[188:191], a[136:139], a[76:79], v[188:191]
  ds_read_b64_tr_b16 a[168:169], v1 offset:43200
  v_mfma_f32_16x16x32_bf16 v[188:191], a[140:143], a[92:95], v[188:191]
  v_mfma_f32_16x16x32_bf16 v[184:187], a[140:143], a[88:91], v[184:187]
  ds_read_b64_tr_b16 a[170:171], v1 offset:46784
  v_mfma_f32_16x16x32_bf16 v[184:187], a[136:139], a[72:75], v[184:187]
  v_mfma_f32_16x16x32_bf16 v[180:183], a[136:139], a[68:71], v[180:183]
  buffer_load_dwordx4 a[4:7], v0, s[36:39], s57 offen offset:1024 sc1
  v_mfma_f32_16x16x32_bf16 v[180:183], a[140:143], a[84:87], v[180:183]
  ds_read_b64_tr_b16 a[172:173], v1 offset:50368
  v_mfma_f32_16x16x32_bf16 v[176:179], a[140:143], a[80:83], v[176:179]
  ds_read_b64_tr_b16 a[174:175], v1 offset:53952
  v_mfma_f32_16x16x32_bf16 v[176:179], a[136:139], a[64:67], v[176:179]
  s_waitcnt lgkmcnt(8)
  v_mfma_f32_16x16x32_bf16 v[192:195], a[144:147], a[64:67], v[192:195]
  ds_read_b64_tr_b16 a[128:129], v2 offset:0
  v_mfma_f32_16x16x32_bf16 v[192:195], a[148:151], a[80:83], v[192:195]
  v_mfma_f32_16x16x32_bf16 v[196:199], a[148:151], a[84:87], v[196:199]
  ds_read_b64_tr_b16 a[130:131], v2 offset:3584
  v_mfma_f32_16x16x32_bf16 v[196:199], a[144:147], a[68:71], v[196:199]
  v_mfma_f32_16x16x32_bf16 v[200:203], a[144:147], a[72:75], v[200:203]
  ds_read_b64_tr_b16 a[132:133], v2 offset:7168
  v_mfma_f32_16x16x32_bf16 v[200:203], a[148:151], a[88:91], v[200:203]
  v_mfma_f32_16x16x32_bf16 v[204:207], a[148:151], a[92:95], v[204:207]
  buffer_load_dwordx4 v9, s[16:19], s56 offen offset:2048 lds
  v_mfma_f32_16x16x32_bf16 v[204:207], a[144:147], a[76:79], v[204:207]
  ds_read_b64_tr_b16 a[134:135], v2 offset:10752
  v_mfma_f32_16x16x32_bf16 v[220:223], a[152:155], a[76:79], v[220:223]
  ds_read_b64_tr_b16 a[136:137], v2 offset:32
  v_mfma_f32_16x16x32_bf16 v[220:223], a[156:159], a[92:95], v[220:223]
  v_mfma_f32_16x16x32_bf16 v[216:219], a[156:159], a[88:91], v[216:219]
  ds_read_b64_tr_b16 a[138:139], v2 offset:3616
  v_mfma_f32_16x16x32_bf16 v[216:219], a[152:155], a[72:75], v[216:219]
  buffer_load_dwordx4 a[8:11], v0, s[36:39], s57 offen offset:2048 sc1
  v_mfma_f32_16x16x32_bf16 v[212:215], a[152:155], a[68:71], v[212:215]
  ds_read_b64_tr_b16 a[140:141], v2 offset:7200
  v_mfma_f32_16x16x32_bf16 v[212:215], a[156:159], a[84:87], v[212:215]
  v_mfma_f32_16x16x32_bf16 v[208:211], a[156:159], a[80:83], v[208:211]
  ds_read_b64_tr_b16 a[142:143], v2 offset:10784
  v_mfma_f32_16x16x32_bf16 v[208:211], a[152:155], a[64:67], v[208:211]
  s_waitcnt lgkmcnt(8)
  v_mfma_f32_16x16x32_bf16 v[224:227], a[160:163], a[64:67], v[224:227]
  buffer_load_dword v29, v30, s[36:39], s68 offen sc1
  v_mfma_f32_16x16x32_bf16 v[224:227], a[164:167], a[80:83], v[224:227]
  ds_read_b64_tr_b16 a[144:145], v2 offset:64
  v_mfma_f32_16x16x32_bf16 v[228:231], a[164:167], a[84:87], v[228:231]
  ds_read_b64_tr_b16 a[146:147], v2 offset:3648
  v_mfma_f32_16x16x32_bf16 v[228:231], a[160:163], a[68:71], v[228:231]
  v_mfma_f32_16x16x32_bf16 v[232:235], a[160:163], a[72:75], v[232:235]
  ds_read_b64_tr_b16 a[148:149], v2 offset:7232
  v_mfma_f32_16x16x32_bf16 v[232:235], a[164:167], a[88:91], v[232:235]
  buffer_load_dwordx4 a[12:15], v0, s[36:39], s57 offen offset:3072 sc1
  v_mfma_f32_16x16x32_bf16 v[236:239], a[164:167], a[92:95], v[236:239]
  ds_read_b64_tr_b16 a[150:151], v2 offset:10816
  v_mfma_f32_16x16x32_bf16 v[236:239], a[160:163], a[76:79], v[236:239]
  v_mfma_f32_16x16x32_bf16 v[252:255], a[168:171], a[76:79], v[252:255]
  ds_read_b64_tr_b16 a[152:153], v2 offset:96
  v_mfma_f32_16x16x32_bf16 v[252:255], a[172:175], a[92:95], v[252:255]
  s_bfe_u32 s56, s82, 0x30014
  s_lshl_b32 s56, s56, 2
  s_bitcmp1_b32 s82, 23
  v_mfma_f32_16x16x32_bf16 v[248:251], a[172:175], a[88:91], v[248:251]
  s_addc_u32 s56, s56, 0
  s_mul_i32 s56, s56, 229376
  s_add_u32 m0, s84, 0
  v_mfma_f32_16x16x32_bf16 v[248:251], a[168:171], a[72:75], v[248:251]
  ds_read_b64_tr_b16 a[154:155], v2 offset:3680
  v_mfma_f32_16x16x32_bf16 v[244:247], a[168:171], a[68:71], v[244:247]
  ds_read_b64_tr_b16 a[156:157], v2 offset:7264
  v_mfma_f32_16x16x32_bf16 v[244:247], a[172:175], a[84:87], v[244:247]
  buffer_load_dwordx4 v3, s[16:19], s56 offen offset:0 lds
  v_mfma_f32_16x16x32_bf16 v[240:243], a[172:175], a[80:83], v[240:243]
  ds_read_b64_tr_b16 a[158:159], v2 offset:10848
  v_mfma_f32_16x16x32_bf16 v[240:243], a[168:171], a[64:67], v[240:243]
  s_waitcnt vmcnt(9) lgkmcnt(8)
  v_mfma_f32_16x16x32_bf16 v[32:35], a[128:131], a[96:99], v[32:35]
  s_add_u32 s57, s57, 4096
  ds_read_b64_tr_b16 a[160:161], v2 offset:128
  v_mfma_f32_16x16x32_bf16 v[32:35], a[132:135], a[112:115], v[32:35]
  v_mfma_f32_16x16x32_bf16 v[36:39], a[132:135], a[116:119], v[36:39]
  ds_read_b64_tr_b16 a[162:163], v2 offset:3712
  v_mfma_f32_16x16x32_bf16 v[36:39], a[128:131], a[100:103], v[36:39]
  v_mfma_f32_16x16x32_bf16 v[40:43], a[128:131], a[104:107], v[40:43]
  buffer_load_dwordx4 a[16:19], v0, s[36:39], s57 offen offset:0 sc1
  v_mfma_f32_16x16x32_bf16 v[40:43], a[132:135], a[120:123], v[40:43]
  ds_read_b64_tr_b16 a[164:165], v2 offset:7296
  v_mfma_f32_16x16x32_bf16 v[44:47], a[132:135], a[124:127], v[44:47]
  ds_read_b64_tr_b16 a[166:167], v2 offset:10880
  v_mfma_f32_16x16x32_bf16 v[44:47], a[128:131], a[108:111], v[44:47]
  v_mfma_f32_16x16x32_bf16 v[60:63], a[136:139], a[108:111], v[60:63]
  ds_read_b64_tr_b16 a[168:169], v2 offset:160
  v_mfma_f32_16x16x32_bf16 v[60:63], a[140:143], a[124:127], v[60:63]
  v_mfma_f32_16x16x32_bf16 v[56:59], a[140:143], a[120:123], v[56:59]
  ds_read_b64_tr_b16 a[170:171], v2 offset:3744
  v_mfma_f32_16x16x32_bf16 v[56:59], a[136:139], a[104:107], v[56:59]
  buffer_load_dwordx4 v4, s[16:19], s56 offen offset:1024 lds
  v_mfma_f32_16x16x32_bf16 v[52:55], a[136:139], a[100:103], v[52:55]
  ds_read_b64_tr_b16 a[172:173], v2 offset:7328
  v_mfma_f32_16x16x32_bf16 v[52:55], a[140:143], a[116:119], v[52:55]
  v_mfma_f32_16x16x32_bf16 v[48:51], a[140:143], a[112:115], v[48:51]
  ds_read_b64_tr_b16 a[174:175], v2 offset:10912
  v_mfma_f32_16x16x32_bf16 v[48:51], a[136:139], a[96:99], v[48:51]
  s_waitcnt lgkmcnt(8)
  v_mfma_f32_16x16x32_bf16 v[64:67], a[144:147], a[96:99], v[64:67]
  ds_read_b64_tr_b16 a[128:129], v2 offset:192
  v_mfma_f32_16x16x32_bf16 v[64:67], a[148:151], a[112:115], v[64:67]
  v_mfma_f32_16x16x32_bf16 v[68:71], a[148:151], a[116:119], v[68:71]
  ds_read_b64_tr_b16 a[130:131], v2 offset:3776
  v_mfma_f32_16x16x32_bf16 v[68:71], a[144:147], a[100:103], v[68:71]
  buffer_load_dwordx4 a[20:23], v0, s[36:39], s57 offen offset:1024 sc1
  v_mfma_f32_16x16x32_bf16 v[72:75], a[144:147], a[104:107], v[72:75]
  ds_read_b64_tr_b16 a[132:133], v2 offset:7360
  v_mfma_f32_16x16x32_bf16 v[72:75], a[148:151], a[120:123], v[72:75]
  v_mfma_f32_16x16x32_bf16 v[76:79], a[148:151], a[124:127], v[76:79]
  ds_read_b64_tr_b16 a[134:135], v2 offset:10944
  v_mfma_f32_16x16x32_bf16 v[76:79], a[144:147], a[108:111], v[76:79]
  v_mfma_f32_16x16x32_bf16 v[92:95], a[152:155], a[108:111], v[92:95]
  ds_read_b64_tr_b16 a[136:137], v2 offset:14336
  v_mfma_f32_16x16x32_bf16 v[92:95], a[156:159], a[124:127], v[92:95]
  v_mfma_f32_16x16x32_bf16 v[88:91], a[156:159], a[120:123], v[88:91]
  buffer_load_dwordx4 v5, s[16:19], s56 offen offset:2048 lds
  v_mfma_f32_16x16x32_bf16 v[88:91], a[152:155], a[104:107], v[88:91]
  ds_read_b64_tr_b16 a[138:139], v2 offset:17920
  v_mfma_f32_16x16x32_bf16 v[84:87], a[152:155], a[100:103], v[84:87]
  ds_read_b64_tr_b16 a[140:141], v2 offset:21504
  v_mfma_f32_16x16x32_bf16 v[84:87], a[156:159], a[116:119], v[84:87]
  v_mfma_f32_16x16x32_bf16 v[80:83], a[156:159], a[112:115], v[80:83]
  ds_read_b64_tr_b16 a[142:143], v2 offset:25088
  v_mfma_f32_16x16x32_bf16 v[80:83], a[152:155], a[96:99], v[80:83]
  s_waitcnt lgkmcnt(8)
  v_mfma_f32_16x16x32_bf16 v[96:99], a[160:163], a[96:99], v[96:99]
  ds_read_b64_tr_b16 a[144:145], v2 offset:14368
  v_mfma_f32_16x16x32_bf16 v[96:99], a[164:167], a[112:115], v[96:99]
  v_mfma_f32_16x16x32_bf16 v[100:103], a[164:167], a[116:119], v[100:103]
  buffer_load_dwordx4 a[24:27], v0, s[36:39], s57 offen offset:2048 sc1
  v_mfma_f32_16x16x32_bf16 v[100:103], a[160:163], a[100:103], v[100:103]
  ds_read_b64_tr_b16 a[146:147], v2 offset:17952
  v_mfma_f32_16x16x32_bf16 v[104:107], a[160:163], a[104:107], v[104:107]
  ds_read_b64_tr_b16 a[148:149], v2 offset:21536
  v_mfma_f32_16x16x32_bf16 v[104:107], a[164:167], a[120:123], v[104:107]
  v_mfma_f32_16x16x32_bf16 v[108:111], a[164:167], a[124:127], v[108:111]
  ds_read_b64_tr_b16 a[150:151], v2 offset:25120
  v_mfma_f32_16x16x32_bf16 v[108:111], a[160:163], a[108:111], v[108:111]
  v_mfma_f32_16x16x32_bf16 v[124:127], a[168:171], a[108:111], v[124:127]
  ds_read_b64_tr_b16 a[152:153], v2 offset:14400
  v_mfma_f32_16x16x32_bf16 v[124:127], a[172:175], a[124:127], v[124:127]
  buffer_load_dwordx4 v6, s[16:19], s56 offen offset:3072 lds
  v_mfma_f32_16x16x32_bf16 v[120:123], a[172:175], a[120:123], v[120:123]
  ds_read_b64_tr_b16 a[154:155], v2 offset:17984
  v_mfma_f32_16x16x32_bf16 v[120:123], a[168:171], a[104:107], v[120:123]
  v_mfma_f32_16x16x32_bf16 v[116:119], a[168:171], a[100:103], v[116:119]
  ds_read_b64_tr_b16 a[156:157], v2 offset:21568
  v_mfma_f32_16x16x32_bf16 v[116:119], a[172:175], a[116:119], v[116:119]
  v_mfma_f32_16x16x32_bf16 v[112:115], a[172:175], a[112:115], v[112:115]
  ds_read_b64_tr_b16 a[158:159], v2 offset:25152
  v_mfma_f32_16x16x32_bf16 v[112:115], a[168:171], a[96:99], v[112:115]
  s_waitcnt lgkmcnt(8)
  v_mfma_f32_16x16x32_bf16 v[128:131], a[128:131], a[96:99], v[128:131]
  ds_read_b64_tr_b16 a[160:161], v2 offset:14432
  v_mfma_f32_16x16x32_bf16 v[128:131], a[132:135], a[112:115], v[128:131]
  buffer_load_dwordx4 a[28:31], v0, s[36:39], s57 offen offset:3072 sc1
  v_mfma_f32_16x16x32_bf16 v[132:135], a[132:135], a[116:119], v[132:135]
  s_waitcnt vmcnt(9)
  v_cmp_ne_u32 vcc, s3, v29
  s_nop 4
  s_cbranch_vccnz CK6s
CK6x:
  v_mfma_f32_16x16x32_bf16 v[132:135], a[128:131], a[100:103], v[132:135]
  ds_read_b64_tr_b16 a[162:163], v2 offset:18016
  v_mfma_f32_16x16x32_bf16 v[136:139], a[128:131], a[104:107], v[136:139]
  s_add_u32 m0, s84, 4096
  ds_read_b64_tr_b16 a[164:165], v2 offset:21600
  v_mfma_f32_16x16x32_bf16 v[136:139], a[132:135], a[120:123], v[136:139]
  v_mfma_f32_16x16x32_bf16 v[140:143], a[132:135], a[124:127], v[140:143]
  ds_read_b64_tr_b16 a[166:167], v2 offset:25184
  v_mfma_f32_16x16x32_bf16 v[140:143], a[128:131], a[108:111], v[140:143]
  v_mfma_f32_16x16x32_bf16 v[156:159], a[136:139], a[108:111], v[156:159]
  buffer_load_dwordx4 v7, s[16:19], s56 offen offset:0 lds
  s_bfe_u32 s57, s82, 0x40014
  v_mfma_f32_16x16x32_bf16 v[156:159], a[140:143], a[124:127], v[156:159]
  s_lshl_b32 s57, s57, 13
  s_add_u32 s57, s57, s85
  ds_read_b64_tr_b16 a[168:169], v2 offset:14464
  v_mfma_f32_16x16x32_bf16 v[152:155], a[140:143], a[120:123], v[152:155]
  ds_read_b64_tr_b16 a[170:171], v2 offset:18048
  v_mfma_f32_16x16x32_bf16 v[152:155], a[136:139], a[104:107], v[152:155]
  v_mfma_f32_16x16x32_bf16 v[148:151], a[136:139], a[100:103], v[148:151]
  ds_read_b64_tr_b16 a[172:173], v2 offset:21632
  v_mfma_f32_16x16x32_bf16 v[148:151], a[140:143], a[116:119], v[148:151]
  buffer_load_dwordx4 a[32:35], v0, s[36:39], s57 offen offset:0 sc1
  v_mfma_f32_16x16x32_bf16 v[144:147], a[140:143], a[112:115], v[144:147]
  ds_read_b64_tr_b16 a[174:175], v2 offset:25216
  v_mfma_f32_16x16x32_bf16 v[144:147], a[136:139], a[96:99], v[144:147]
  s_waitcnt lgkmcnt(8)
  v_mfma_f32_16x16x32_bf16 v[160:163], a[144:147], a[96:99], v[160:163]
  ds_read_b64_tr_b16 a[128:129], v2 offset:14496
  v_mfma_f32_16x16x32_bf16 v[160:163], a[148:151], a[112:115], v[160:163]
  v_mfma_f32_16x16x32_bf16 v[164:167], a[148:151], a[116:119], v[164:167]
  ds_read_b64_tr_b16 a[130:131], v2 offset:18080
  v_mfma_f32_16x16x32_bf16 v[164:167], a[144:147], a[100:103], v[164:167]
  v_mfma_f32_16x16x32_bf16 v[168:171], a[144:147], a[104:107], v[168:171]
  ds_read_b64_tr_b16 a[132:133], v2 offset:21664
  v_mfma_f32_16x16x32_bf16 v[168:171], a[148:151], a[120:123], v[168:171]
  v_mfma_f32_16x16x32_bf16 v[172:175], a[148:151], a[124:127], v[172:175]
  ds_read_b64_tr_b16 a[134:135], v2 offset:25248
  v_mfma_f32_16x16x32_bf16 v[172:175], a[144:147], a[108:111], v[172:175]
  s_waitcnt vmcnt(13)
  s_barrier
  buffer_load_dwordx4 v8, s[16:19], s56 offen offset:1024 lds
  v_mfma_f32_16x16x32_bf16 v[188:191], a[152:155], a[108:111], v[188:191]
  ds_read_b64_tr_b16 a[136:137], v2 offset:14528
  v_mfma_f32_16x16x32_bf16 v[188:191], a[156:159], a[124:127], v[188:191]
  v_mfma_f32_16x16x32_bf16 v[184:187], a[156:159], a[120:123], v[184:187]
  ds_read_b64_tr_b16 a[138:139], v2 offset:18112
  v_mfma_f32_16x16x32_bf16 v[184:187], a[152:155], a[104:107], v[184:187]
  v_mfma_f32_16x16x32_bf16 v[180:183], a[152:155], a[100:103], v[180:183]
  buffer_load_dwordx4 a[36:39], v0, s[36:39], s57 offen offset:1024 sc1
  v_mfma_f32_16x16x32_bf16 v[180:183], a[156:159], a[116:119], v[180:183]
  ds_read_b64_tr_b16 a[140:141], v2 offset:21696
  v_mfma_f32_16x16x32_bf16 v[176:179], a[156:159], a[112:115], v[176:179]
  ds_read_b64_tr_b16 a[142:143], v2 offset:25280
  v_mfma_f32_16x16x32_bf16 v[176:179], a[152:155], a[96:99], v[176:179]
  s_waitcnt lgkmcnt(8)
  v_mfma_f32_16x16x32_bf16 v[192:195], a[160:163], a[96:99], v[192:195]
  ds_read_b64_tr_b16 a[144:145], v2 offset:28672
  v_mfma_f32_16x16x32_bf16 v[192:195], a[164:167], a[112:115], v[192:195]
  v_mfma_f32_16x16x32_bf16 v[196:199], a[164:167], a[116:119], v[196:199]
  ds_read_b64_tr_b16 a[146:147], v2 offset:32256
  v_mfma_f32_16x16x32_bf16 v[196:199], a[160:163], a[100:103], v[196:199]
  v_mfma_f32_16x16x32_bf16 v[200:203], a[160:163], a[104:107], v[200:203]
  ds_read_b64_tr_b16 a[148:149], v2 offset:35840
  v_mfma_f32_16x16x32_bf16 v[200:203], a[164:167], a[120:123], v[200:203]
  v_mfma_f32_16x16x32_bf16 v[204:207], a[164:167], a[124:127], v[204:207]
  buffer_load_dwordx4 v9, s[16:19], s56 offen offset:2048 lds
  v_mfma_f32_16x16x32_bf16 v[204:207], a[160:163], a[108:111], v[204:207]
  ds_read_b64_tr_b16 a[150:151], v2 offset:39424
  v_mfma_f32_16x16x32_bf16 v[220:223], a[168:171], a[108:111], v[220:223]
  ds_read_b64_tr_b16 a[152:153], v2 offset:28704
  v_mfma_f32_16x16x32_bf16 v[220:223], a[172:175], a[124:127], v[220:223]
  v_mfma_f32_16x16x32_bf16 v[216:219], a[172:175], a[120:123], v[216:219]
  ds_read_b64_tr_b16 a[154:155], v2 offset:32288
  v_mfma_f32_16x16x32_bf16 v[216:219], a[168:171], a[104:107], v[216:219]
  buffer_load_dwordx4 a[40:43], v0, s[36:39], s57 offen offset:2048 sc1
  v_mfma_f32_16x16x32_bf16 v[212:215], a[168:171], a[100:103], v[212:215]
  ds_read_b64_tr_b16 a[156:157], v2 offset:35872
  v_mfma_f32_16x16x32_bf16 v[212:215], a[172:175], a[116:119], v[212:215]
  v_mfma_f32_16x16x32_bf16 v[208:211], a[172:175], a[112:115], v[208:211]
  ds_read_b64_tr_b16 a[158:159], v2 offset:39456
  v_mfma_f32_16x16x32_bf16 v[208:211], a[168:171], a[96:99], v[208:211]
  s_waitcnt lgkmcnt(8)
  v_mfma_f32_16x16x32_bf16 v[224:227], a[128:131], a[96:99], v[224:227]
  ds_read_b64_tr_b16 a[160:161], v2 offset:28736
  v_mfma_f32_16x16x32_bf16 v[224:227], a[132:135], a[112:115], v[224:227]
  v_mfma_f32_16x16x32_bf16 v[228:231], a[132:135], a[116:119], v[228:231]
  ds_read_b64_tr_b16 a[162:163], v2 offset:32320
  v_mfma_f32_16x16x32_bf16 v[228:231], a[128:131], a[100:103], v[228:231]
  v_mfma_f32_16x16x32_bf16 v[232:235], a[128:131], a[104:107], v[232:235]
  ds_read_b64_tr_b16 a[164:165], v2 offset:35904
  v_mfma_f32_16x16x32_bf16 v[232:235], a[132:135], a[120:123], v[232:235]
  buffer_load_dwordx4 a[44:47], v0, s[36:39], s57 offen offset:3072 sc1
  v_mfma_f32_16x16x32_bf16 v[236:239], a[132:135], a[124:127], v[236:239]
Hc1:
  s_cbranch_execz Hc1_1
  ds_read_b64_tr_b16 a[166:167], v2 offset:39488
  v_mfma_f32_16x16x32_bf16 v[236:239], a[128:131], a[108:111], v[236:239]
  v_mfma_f32_16x16x32_bf16 v[252:255], a[136:139], a[108:111], v[252:255]
  ds_read_b64_tr_b16 a[168:169], v2 offset:28768
  v_mfma_f32_16x16x32_bf16 v[252:255], a[140:143], a[124:127], v[252:255]
  s_bfe_u32 s56, s82, 0x30018
  s_lshl_b32 s56, s56, 2
  s_bitcmp1_b32 s82, 27
  v_mfma_f32_16x16x32_bf16 v[248:251], a[140:143], a[120:123], v[248:251]
  s_addc_u32 s56, s56, 0
  s_mul_i32 s56, s56, 229376
  s_add_u32 m0, s84, 28672
  v_mfma_f32_16x16x32_bf16 v[248:251], a[136:139], a[104:107], v[248:251]
  ds_read_b64_tr_b16 a[170:171], v2 offset:32352
  v_mfma_f32_16x16x32_bf16 v[244:247], a[136:139], a[100:103], v[244:247]
  ds_read_b64_tr_b16 a[172:173], v2 offset:35936
  v_mfma_f32_16x16x32_bf16 v[244:247], a[140:143], a[116:119], v[244:247]
  buffer_load_dwordx4 v3, s[16:19], s56 offen offset:0 lds
  v_mfma_f32_16x16x32_bf16 v[240:243], a[140:143], a[112:115], v[240:243]
  ds_read_b64_tr_b16 a[174:175], v2 offset:39520
  v_mfma_f32_16x16x32_bf16 v[240:243], a[136:139], a[96:99], v[240:243]
  s_waitcnt vmcnt(8) lgkmcnt(8)
  v_mfma_f32_16x16x32_bf16 v[32:35], a[144:147], a[0:3], v[32:35]
  s_add_u32 s57, s57, 4096
  ds_read_b64_tr_b16 a[128:129], v2 offset:28800
  v_mfma_f32_16x16x32_bf16 v[32:35], a[148:151], a[16:19], v[32:35]
  v_mfma_f32_16x16x32_bf16 v[36:39], a[148:151], a[20:23], v[36:39]
  ds_read_b64_tr_b16 a[130:131], v2 offset:32384
  v_mfma_f32_16x16x32_bf16 v[36:39], a[144:147], a[4:7], v[36:39]
  v_mfma_f32_16x16x32_bf16 v[40:43], a[144:147], a[8:11], v[40:43]
  buffer_load_dwordx4 a[48:51], v0, s[36:39], s57 offen offset:0 sc1
  v_mfma_f32_16x16x32_bf16 v[40:43], a[148:151], a[24:27], v[40:43]
  ds_read_b64_tr_b16 a[132:133], v2 offset:35968
  v_mfma_f32_16x16x32_bf16 v[44:47], a[148:151], a[28:31], v[44:47]
  ds_read_b64_tr_b16 a[134:135], v2 offset:39552
  v_mfma_f32_16x16x32_bf16 v[44:47], a[144:147], a[12:15], v[44:47]
  v_mfma_f32_16x16x32_bf16 v[60:63], a[152:155], a[12:15], v[60:63]
  ds_read_b64_tr_b16 a[136:137], v2 offset:28832
  v_mfma_f32_16x16x32_bf16 v[60:63], a[156:159], a[28:31], v[60:63]
  v_mfma_f32_16x16x32_bf16 v[56:59], a[156:159], a[24:27], v[56:59]
  ds_read_b64_tr_b16 a[138:139], v2 offset:32416
  v_mfma_f32_16x16x32_bf16 v[56:59], a[152:155], a[8:11], v[56:59]
  buffer_load_dwordx4 v4, s[16:19], s56 offen offset:1024 lds
  v_mfma_f32_16x16x32_bf16 v[52:55], a[152:155], a[4:7], v[52:55]
  ds_read_b64_tr_b16 a[140:141], v2 offset:36000
  v_mfma_f32_16x16x32_bf16 v[52:55], a[156:159], a[20:23], v[52:55]
  v_mfma_f32_16x16x32_bf16 v[48:51], a[156:159], a[16:19], v[48:51]
  ds_read_b64_tr_b16 a[142:143], v2 offset:39584
  v_mfma_f32_16x16x32_bf16 v[48:51], a[152:155], a[0:3], v[48:51]
  s_waitcnt lgkmcnt(8)
  v_mfma_f32_16x16x32_bf16 v[64:67], a[160:163], a[0:3], v[64:67]
  ds_read_b64_tr_b16 a[144:145], v2 offset:28864
  v_mfma_f32_16x16x32_bf16 v[64:67], a[164:167], a[16:19], v[64:67]
  v_mfma_f32_16x16x32_bf16 v[68:71], a[164:167], a[20:23], v[68:71]
  ds_read_b64_tr_b16 a[146:147], v2 offset:32448
  v_mfma_f32_16x16x32_bf16 v[68:71], a[160:163], a[4:7], v[68:71]
  buffer_load_dwordx4 a[52:55], v0, s[36:39], s57 offen offset:1024 sc1
  v_mfma_f32_16x16x32_bf16 v[72:75], a[160:163], a[8:11], v[72:75]
  ds_read_b64_tr_b16 a[148:149], v2 offset:36032
  v_mfma_f32_16x16x32_bf16 v[72:75], a[164:167], a[24:27], v[72:75]
  v_mfma_f32_16x16x32_bf16 v[76:79], a[164:167], a[28:31], v[76:79]
  ds_read_b64_tr_b16 a[150:151], v2 offset:39616
  v_mfma_f32_16x16x32_bf16 v[76:79], a[160:163], a[12:15], v[76:79]
  v_mfma_f32_16x16x32_bf16 v[92:95], a[168:171], a[12:15], v[92:95]
  ds_read_b64_tr_b16 a[152:153], v2 offset:43008
  v_mfma_f32_16x16x32_bf16 v[92:95], a[172:175], a[28:31], v[92:95]
  v_mfma_f32_16x16x32_bf16 v[88:91], a[172:175], a[24:27], v[88:91]
  buffer_load_dwordx4 v5, s[16:19], s56 offen offset:2048 lds
  v_mfma_f32_16x16x32_bf16 v[88:91], a[168:171], a[8:11], v[88:91]
  ds_read_b64_tr_b16 a[154:155], v2 offset:46592
  v_mfma_f32_16x16x32_bf16 v[84:87], a[168:171], a[4:7], v[84:87]
  ds_read_b64_tr_b16 a[156:157], v2 offset:50176
  v_mfma_f32_16x16x32_bf16 v[84:87], a[172:175], a[20:23], v[84:87]
  v_mfma_f32_16x16x32_bf16 v[80:83], a[172:175], a[16:19], v[80:83]
  ds_read_b64_tr_b16 a[158:159], v2 offset:53760
  v_mfma_f32_16x16x32_bf16 v[80:83], a[168:171], a[0:3], v[80:83]
  s_waitcnt lgkmcnt(8)
  v_mfma_f32_16x16x32_bf16 v[96:99], a[128:131], a[0:3], v[96:99]
  ds_read_b64_tr_b16 a[160:161], v2 offset:43040
  v_mfma_f32_16x16x32_bf16 v[96:99], a[132:135], a[16:19], v[96:99]
  v_mfma_f32_16x16x32_bf16 v[100:103], a[132:135], a[20:23], v[100:103]
  buffer_load_dwordx4 a[56:59], v0, s[36:39], s57 offen offset:2048 sc1
  v_mfma_f32_16x16x32_bf16 v[100:103], a[128:131], a[4:7], v[100:103]
  ds_read_b64_tr_b16 a[162:163], v2 offset:46624
  v_mfma_f32_16x16x32_bf16 v[104:107], a[128:131], a[8:11], v[104:107]
  ds_read_b64_tr_b16 a[164:165], v2 offset:50208
  v_mfma_f32_16x16x32_bf16 v[104:107], a[132:135], a[24:27], v[104:107]
  v_mfma_f32_16x16x32_bf16 v[108:111], a[132:135], a[28:31], v[108:111]
  ds_read_b64_tr_b16 a[166:167], v2 offset:53792
  v_mfma_f32_16x16x32_bf16 v[108:111], a[128:131], a[12:15], v[108:111]
  v_mfma_f32_16x16x32_bf16 v[124:127], a[136:139], a[12:15], v[124:127]
  ds_read_b64_tr_b16 a[168:169], v2 offset:43072
  v_mfma_f32_16x16x32_bf16 v[124:127], a[140:143], a[28:31], v[124:127]
  buffer_load_dwordx4 v6, s[16:19], s56 offen offset:3072 lds
  v_mfma_f32_16x16x32_bf16 v[120:123], a[140:143], a[24:27], v[120:123]
  ds_read_b64_tr_b16 a[170:171], v2 offset:46656
  v_mfma_f32_16x16x32_bf16 v[120:123], a[136:139], a[8:11], v[120:123]
  v_mfma_f32_16x16x32_bf16 v[116:119], a[136:139], a[4:7], v[116:119]
  ds_read_b64_tr_b16 a[172:173], v2 offset:50240
  v_mfma_f32_16x16x32_bf16 v[116:119], a[140:143], a[20:23], v[116:119]
  v_mfma_f32_16x16x32_bf16 v[112:115], a[140:143], a[16:19], v[112:115]
  ds_read_b64_tr_b16 a[174:175], v2 offset:53824
  v_mfma_f32_16x16x32_bf16 v[112:115], a[136:139], a[0:3], v[112:115]
  s_waitcnt lgkmcnt(8)
  v_mfma_f32_16x16x32_bf16 v[128:131], a[144:147], a[0:3], v[128:131]
  ds_read_b64_tr_b16 a[128:129], v2 offset:43104
  v_mfma_f32_16x16x32_bf16 v[128:131], a[148:151], a[16:19], v[128:131]
  buffer_load_dwordx4 a[60:63], v0, s[36:39], s57 offen offset:3072 sc1
  v_mfma_f32_16x16x32_bf16 v[132:135], a[148:151], a[20:23], v[132:135]
  ds_read_b64_tr_b16 a[130:131], v2 offset:46688
  v_mfma_f32_16x16x32_bf16 v[132:135], a[144:147], a[4:7], v[132:135]
  v_mfma_f32_16x16x32_bf16 v[136:139], a[144:147], a[8:11], v[136:139]
  s_add_u32 m0, s84, 32768
  ds_read_b64_tr_b16 a[132:133], v2 offset:50272
  v_mfma_f32_16x16x32_bf16 v[136:139], a[148:151], a[24:27], v[136:139]
  v_mfma_f32_16x16x32_bf16 v[140:143], a[148:151], a[28:31], v[140:143]
  ds_read_b64_tr_b16 a[134:135], v2 offset:53856
  v_mfma_f32_16x16x32_bf16 v[140:143], a[144:147], a[12:15], v[140:143]
  v_mfma_f32_16x16x32_bf16 v[156:159], a[152:155], a[12:15], v[156:159]
  buffer_load_dwordx4 v7, s[16:19], s56 offen offset:0 lds
  s_bfe_u32 s57, s82, 0x40018
  v_mfma_f32_16x16x32_bf16 v[156:159], a[156:159], a[28:31], v[156:159]
  s_lshl_b32 s57, s57, 13
  s_add_u32 s57, s57, s85
  ds_read_b64_tr_b16 a[136:137], v2 offset:43136
  v_mfma_f32_16x16x32_bf16 v[152:155], a[156:159], a[24:27], v[152:155]
  ds_read_b64_tr_b16 a[138:139], v2 offset:46720
  v_mfma_f32_16x16x32_bf16 v[152:155], a[152:155], a[8:11], v[152:155]
  v_mfma_f32_16x16x32_bf16 v[148:151], a[152:155], a[4:7], v[148:151]
  ds_read_b64_tr_b16 a[140:141], v2 offset:50304
  v_mfma_f32_16x16x32_bf16 v[148:151], a[156:159], a[20:23], v[148:151]
  buffer_load_dwordx4 a[64:67], v0, s[36:39], s57 offen offset:0 sc1
  v_mfma_f32_16x16x32_bf16 v[144:147], a[156:159], a[16:19], v[144:147]
  ds_read_b64_tr_b16 a[142:143], v2 offset:53888
  v_mfma_f32_16x16x32_bf16 v[144:147], a[152:155], a[0:3], v[144:147]
  s_waitcnt lgkmcnt(8)
  v_mfma_f32_16x16x32_bf16 v[160:163], a[160:163], a[0:3], v[160:163]
  ds_read_b64_tr_b16 a[144:145], v2 offset:43168
  v_mfma_f32_16x16x32_bf16 v[160:163], a[164:167], a[16:19], v[160:163]
  v_mfma_f32_16x16x32_bf16 v[164:167], a[164:167], a[20:23], v[164:167]
  ds_read_b64_tr_b16 a[146:147], v2 offset:46752
  v_mfma_f32_16x16x32_bf16 v[164:167], a[160:163], a[4:7], v[164:167]
  v_mfma_f32_16x16x32_bf16 v[168:171], a[160:163], a[8:11], v[168:171]
  ds_read_b64_tr_b16 a[148:149], v2 offset:50336
  v_mfma_f32_16x16x32_bf16 v[168:171], a[164:167], a[24:27], v[168:171]
  v_mfma_f32_16x16x32_bf16 v[172:175], a[164:167], a[28:31], v[172:175]
  ds_read_b64_tr_b16 a[150:151], v2 offset:53920
  v_mfma_f32_16x16x32_bf16 v[172:175], a[160:163], a[12:15], v[172:175]
  s_waitcnt vmcnt(12)
  s_barrier
  buffer_load_dwordx4 v8, s[16:19], s56 offen offset:1024 lds
  v_mfma_f32_16x16x32_bf16 v[188:191], a[168:171], a[12:15], v[188:191]
  ds_read_b64_tr_b16 a[152:153], v2 offset:43200
  v_mfma_f32_16x16x32_bf16 v[188:191], a[172:175], a[28:31], v[188:191]
  v_mfma_f32_16x16x32_bf16 v[184:187], a[172:175], a[24:27], v[184:187]
  ds_read_b64_tr_b16 a[154:155], v2 offset:46784
  v_mfma_f32_16x16x32_bf16 v[184:187], a[168:171], a[8:11], v[184:187]
  v_mfma_f32_16x16x32_bf16 v[180:183], a[168:171], a[4:7], v[180:183]
  buffer_load_dwordx4 a[68:71], v0, s[36:39], s57 offen offset:1024 sc1
  v_mfma_f32_16x16x32_bf16 v[180:183], a[172:175], a[20:23], v[180:183]
  ds_read_b64_tr_b16 a[156:157], v2 offset:50368
  v_mfma_f32_16x16x32_bf16 v[176:179], a[172:175], a[16:19], v[176:179]
  ds_read_b64_tr_b16 a[158:159], v2 offset:53952
  v_mfma_f32_16x16x32_bf16 v[176:179], a[168:171], a[0:3], v[176:179]
  s_waitcnt lgkmcnt(8)
  v_mfma_f32_16x16x32_bf16 v[192:195], a[128:131], a[0:3], v[192:195]
  ds_read_b64_tr_b16 a[160:161], v1 offset:0
  v_mfma_f32_16x16x32_bf16 v[192:195], a[132:135], a[16:19], v[192:195]
  v_mfma_f32_16x16x32_bf16 v[196:199], a[132:135], a[20:23], v[196:199]
  ds_read_b64_tr_b16 a[162:163], v1 offset:3584
  v_mfma_f32_16x16x32_bf16 v[196:199], a[128:131], a[4:7], v[196:199]
  v_mfma_f32_16x16x32_bf16 v[200:203], a[128:131], a[8:11], v[200:203]
  ds_read_b64_tr_b16 a[164:165], v1 offset:7168
  v_mfma_f32_16x16x32_bf16 v[200:203], a[132:135], a[24:27], v[200:203]
  v_mfma_f32_16x16x32_bf16 v[204:207], a[132:135], a[28:31], v[204:207]
  buffer_load_dwordx4 v9, s[16:19], s56 offen offset:2048 lds
  v_mfma_f32_16x16x32_bf16 v[204:207], a[128:131], a[12:15], v[204:207]
  ds_read_b64_tr_b16 a[166:167], v1 offset:10752
  v_mfma_f32_16x16x32_bf16 v[220:223], a[136:139], a[12:15], v[220:223]
  ds_read_b64_tr_b16 a[168:169], v1 offset:32
  v_mfma_f32_16x16x32_bf16 v[220:223], a[140:143], a[28:31], v[220:223]
  v_mfma_f32_16x16x32_bf16 v[216:219], a[140:143], a[24:27], v[216:219]
  ds_read_b64_tr_b16 a[170:171], v1 offset:3616
  v_mfma_f32_16x16x32_bf16 v[216:219], a[136:139], a[8:11], v[216:219]
  buffer_load_dwordx4 a[72:75], v0, s[36:39], s57 offen offset:2048 sc1
  v_mfma_f32_16x16x32_bf16 v[212:215], a[136:139], a[4:7], v[212:215]
  ds_read_b64_tr_b16 a[172:173], v1 offset:7200
  v_mfma_f32_16x16x32_bf16 v[212:215], a[140:143], a[20:23], v[212:215]
  v_mfma_f32_16x16x32_bf16 v[208:211], a[140:143], a[16:19], v[208:211]
  ds_read_b64_tr_b16 a[174:175], v1 offset:10784
  v_mfma_f32_16x16x32_bf16 v[208:211], a[136:139], a[0:3], v[208:211]
  s_waitcnt lgkmcnt(8)
  v_mfma_f32_16x16x32_bf16 v[224:227], a[144:147], a[0:3], v[224:227]
  ds_read_b64_tr_b16 a[128:129], v1 offset:64
  v_mfma_f32_16x16x32_bf16 v[224:227], a[148:151], a[16:19], v[224:227]
  v_mfma_f32_16x16x32_bf16 v[228:231], a[148:151], a[20:23], v[228:231]
  ds_read_b64_tr_b16 a[130:131], v1 offset:3648
  v_mfma_f32_16x16x32_bf16 v[228:231], a[144:147], a[4:7], v[228:231]
  v_mfma_f32_16x16x32_bf16 v[232:235], a[144:147], a[8:11], v[232:235]
  ds_read_b64_tr_b16 a[132:133], v1 offset:7232
  v_mfma_f32_16x16x32_bf16 v[232:235], a[148:151], a[24:27], v[232:235]
  buffer_load_dwordx4 a[76:79], v0, s[36:39], s57 offen offset:3072 sc1
  v_mfma_f32_16x16x32_bf16 v[236:239], a[148:151], a[28:31], v[236:239]
  ds_read_b64_tr_b16 a[134:135], v1 offset:10816
  v_mfma_f32_16x16x32_bf16 v[236:239], a[144:147], a[12:15], v[236:239]
  v_mfma_f32_16x16x32_bf16 v[252:255], a[152:155], a[12:15], v[252:255]
  ds_read_b64_tr_b16 a[136:137], v1 offset:96
  v_mfma_f32_16x16x32_bf16 v[252:255], a[156:159], a[28:31], v[252:255]
  s_bfe_u32 s56, s82, 0x3001c
  s_lshl_b32 s56, s56, 2
  s_bitcmp1_b32 s82, 31
  v_mfma_f32_16x16x32_bf16 v[248:251], a[156:159], a[24:27], v[248:251]
  s_addc_u32 s56, s56, 0
  s_mul_i32 s56, s56, 229376
  s_add_u32 m0, s84, 57344
  v_mfma_f32_16x16x32_bf16 v[248:251], a[152:155], a[8:11], v[248:251]
  buffer_load_dwordx4 a[208:211], v0, s[36:39], s59 offen offset:0 sc1
  v_add_u32 v31, 28672, v31
  v_mfma_f32_16x16x32_bf16 v[244:247], a[152:155], a[4:7], v[244:247]
  ds_read_b64_tr_b16 a[138:139], v1 offset:3680
  v_mfma_f32_16x16x32_bf16 v[244:247], a[156:159], a[20:23], v[244:247]
  ds_read_b64_tr_b16 a[140:141], v1 offset:7264
  v_mfma_f32_16x16x32_bf16 v[240:243], a[156:159], a[16:19], v[240:243]
  ds_read_b64_tr_b16 a[142:143], v1 offset:10848
  v_mfma_f32_16x16x32_bf16 v[240:243], a[152:155], a[0:3], v[240:243]
  s_waitcnt vmcnt(8) lgkmcnt(8)
  v_mfma_f32_16x16x32_bf16 v[32:35], a[160:163], a[32:35], v[32:35]
  buffer_load_dwordx4 a[212:215], v0, s[36:39], s59 offen offset:1024 sc1
  v_mfma_f32_16x16x32_bf16 v[32:35], a[164:167], a[48:51], v[32:35]
  ds_read_b64_tr_b16 a[144:145], v1 offset:128
  v_mfma_f32_16x16x32_bf16 v[36:39], a[164:167], a[52:55], v[36:39]
  ds_read_b64_tr_b16 a[146:147], v1 offset:3712
  v_mfma_f32_16x16x32_bf16 v[36:39], a[160:163], a[36:39], v[36:39]
  v_mfma_f32_16x16x32_bf16 v[40:43], a[160:163], a[40:43], v[40:43]
  ds_read_b64_tr_b16 a[148:149], v1 offset:7296
  v_mfma_f32_16x16x32_bf16 v[40:43], a[164:167], a[56:59], v[40:43]
  buffer_load_dwordx4 v3, s[16:19], s56 offen offset:0 lds
  s_add_u32 s57, s57, 4096
  v_mfma_f32_16x16x32_bf16 v[44:47], a[164:167], a[60:63], v[44:47]
  ds_read_b64_tr_b16 a[150:151], v1 offset:10880
  v_mfma_f32_16x16x32_bf16 v[44:47], a[160:163], a[44:47], v[44:47]
  v_mfma_f32_16x16x32_bf16 v[60:63], a[168:171], a[44:47], v[60:63]
  ds_read_b64_tr_b16 a[152:153], v1 offset:160
  v_mfma_f32_16x16x32_bf16 v[60:63], a[172:175], a[60:63], v[60:63]
  v_mfma_f32_16x16x32_bf16 v[56:59], a[172:175], a[56:59], v[56:59]
  buffer_load_dwordx4 a[80:83], v0, s[36:39], s57 offen offset:0 sc1
  v_mfma_f32_16x16x32_bf16 v[56:59], a[168:171], a[40:43], v[56:59]
  ds_read_b64_tr_b16 a[154:155], v1 offset:3744
  v_mfma_f32_16x16x32_bf16 v[52:55], a[168:171], a[36:39], v[52:55]
  ds_read_b64_tr_b16 a[156:157], v1 offset:7328
  v_mfma_f32_16x16x32_bf16 v[52:55], a[172:175], a[52:55], v[52:55]
  v_mfma_f32_16x16x32_bf16 v[48:51], a[172:175], a[48:51], v[48:51]
  ds_read_b64_tr_b16 a[158:159], v1 offset:10912
  v_mfma_f32_16x16x32_bf16 v[48:51], a[168:171], a[32:35], v[48:51]
  s_waitcnt lgkmcnt(8)
  buffer_load_dwordx4 v4, s[16:19], s56 offen offset:1024 lds
  v_mfma_f32_16x16x32_bf16 v[64:67], a[128:131], a[32:35], v[64:67]
  ds_read_b64_tr_b16 a[160:161], v1 offset:192
  v_mfma_f32_16x16x32_bf16 v[64:67], a[132:135], a[48:51], v[64:67]
  v_mfma_f32_16x16x32_bf16 v[68:71], a[132:135], a[52:55], v[68:71]
  ds_read_b64_tr_b16 a[162:163], v1 offset:3776
  v_mfma_f32_16x16x32_bf16 v[68:71], a[128:131], a[36:39], v[68:71]
  v_mfma_f32_16x16x32_bf16 v[72:75], a[128:131], a[40:43], v[72:75]
  buffer_load_dwordx4 a[84:87], v0, s[36:39], s57 offen offset:1024 sc1
  v_mfma_f32_16x16x32_bf16 v[72:75], a[132:135], a[56:59], v[72:75]
  ds_read_b64_tr_b16 a[164:165], v1 offset:7360
  v_mfma_f32_16x16x32_bf16 v[76:79], a[132:135], a[60:63], v[76:79]
  ds_read_b64_tr_b16 a[166:167], v1 offset:10944
  v_mfma_f32_16x16x32_bf16 v[76:79], a[128:131], a[44:47], v[76:79]
  v_mfma_f32_16x16x32_bf16 v[92:95], a[136:139], a[44:47], v[92:95]
  ds_read_b64_tr_b16 a[168:169], v1 offset:14336
  v_mfma_f32_16x16x32_bf16 v[92:95], a[140:143], a[60:63], v[92:95]
  v_mfma_f32_16x16x32_bf16 v[88:91], a[140:143], a[56:59], v[88:91]
  buffer_load_dwordx4 v5, s[16:19], s56 offen offset:2048 lds
  v_mfma_f32_16x16x32_bf16 v[88:91], a[136:139], a[40:43], v[88:91]
  ds_read_b64_tr_b16 a[170:171], v1 offset:17920
  v_mfma_f32_16x16x32_bf16 v[84:87], a[136:139], a[36:39], v[84:87]
  ds_read_b64_tr_b16 a[172:173], v1 offset:21504
  v_mfma_f32_16x16x32_bf16 v[84:87], a[140:143], a[52:55], v[84:87]
  v_mfma_f32_16x16x32_bf16 v[80:83], a[140:143], a[48:51], v[80:83]
  ds_read_b64_tr_b16 a[174:175], v1 offset:25088
  v_mfma_f32_16x16x32_bf16 v[80:83], a[136:139], a[32:35], v[80:83]
  s_waitcnt lgkmcnt(8)
  v_mfma_f32_16x16x32_bf16 v[96:99], a[144:147], a[32:35], v[96:99]
  ds_read_b64_tr_b16 a[128:129], v1 offset:14368
  v_mfma_f32_16x16x32_bf16 v[96:99], a[148:151], a[48:51], v[96:99]
  v_mfma_f32_16x16x32_bf16 v[100:103], a[148:151], a[52:55], v[100:103]
  buffer_load_dwordx4 a[88:91], v0, s[36:39], s57 offen offset:2048 sc1
  v_mfma_f32_16x16x32_bf16 v[100:103], a[144:147], a[36:39], v[100:103]
  ds_read_b64_tr_b16 a[130:131], v1 offset:17952
  v_mfma_f32_16x16x32_bf16 v[104:107], a[144:147], a[40:43], v[104:107]
  ds_read_b64_tr_b16 a[132:133], v1 offset:21536
  v_mfma_f32_16x16x32_bf16 v[104:107], a[148:151], a[56:59], v[104:107]
  v_mfma_f32_16x16x32_bf16 v[108:111], a[148:151], a[60:63], v[108:111]
  ds_read_b64_tr_b16 a[134:135], v1 offset:25120
  v_mfma_f32_16x16x32_bf16 v[108:111], a[144:147], a[44:47], v[108:111]
  v_mfma_f32_16x16x32_bf16 v[124:127], a[152:155], a[44:47], v[124:127]
  ds_read_b64_tr_b16 a[136:137], v1 offset:14400
  v_mfma_f32_16x16x32_bf16 v[124:127], a[156:159], a[60:63], v[124:127]
  buffer_load_dwordx4 v6, s[16:19], s56 offen offset:3072 lds
  v_mfma_f32_16x16x32_bf16 v[120:123], a[156:159], a[56:59], v[120:123]
  ds_read_b64_tr_b16 a[138:139], v1 offset:17984
  v_mfma_f32_16x16x32_bf16 v[120:123], a[152:155], a[40:43], v[120:123]
  v_mfma_f32_16x16x32_bf16 v[116:119], a[152:155], a[36:39], v[116:119]
  ds_read_b64_tr_b16 a[140:141], v1 offset:21568
  v_mfma_f32_16x16x32_bf16 v[116:119], a[156:159], a[52:55], v[116:119]
  v_mfma_f32_16x16x32_bf16 v[112:115], a[156:159], a[48:51], v[112:115]
  ds_read_b64_tr_b16 a[142:143], v1 offset:25152
  v_mfma_f32_16x16x32_bf16 v[112:115], a[152:155], a[32:35], v[112:115]
  s_waitcnt lgkmcnt(8)
  v_mfma_f32_16x16x32_bf16 v[128:131], a[160:163], a[32:35], v[128:131]
  ds_read_b64_tr_b16 a[144:145], v1 offset:14432
  v_mfma_f32_16x16x32_bf16 v[128:131], a[164:167], a[48:51], v[128:131]
  buffer_load_dwordx4 a[92:95], v0, s[36:39], s57 offen offset:3072 sc1
  v_mfma_f32_16x16x32_bf16 v[132:135], a[164:167], a[52:55], v[132:135]
  ds_read_b64_tr_b16 a[146:147], v1 offset:18016
  v_mfma_f32_16x16x32_bf16 v[132:135], a[160:163], a[36:39], v[132:135]
  v_mfma_f32_16x16x32_bf16 v[136:139], a[160:163], a[40:43], v[136:139]
  s_add_u32 m0, s84, 61440
  ds_read_b64_tr_b16 a[148:149], v1 offset:21600
  v_mfma_f32_16x16x32_bf16 v[136:139], a[164:167], a[56:59], v[136:139]
  v_mfma_f32_16x16x32_bf16 v[140:143], a[164:167], a[60:63], v[140:143]
  ds_read_b64_tr_b16 a[150:151], v1 offset:25184
  v_mfma_f32_16x16x32_bf16 v[140:143], a[160:163], a[44:47], v[140:143]
  v_mfma_f32_16x16x32_bf16 v[156:159], a[168:171], a[44:47], v[156:159]
  buffer_load_dwordx4 v7, s[16:19], s56 offen offset:0 lds
  s_bfe_u32 s57, s82, 0x4001c
  v_mfma_f32_16x16x32_bf16 v[156:159], a[172:175], a[60:63], v[156:159]
  s_lshl_b32 s57, s57, 13
  s_add_u32 s57, s57, s85
  ds_read_b64_tr_b16 a[152:153], v1 offset:14464
  v_mfma_f32_16x16x32_bf16 v[152:155], a[172:175], a[56:59], v[152:155]
  ds_read_b64_tr_b16 a[154:155], v1 offset:18048
  v_mfma_f32_16x16x32_bf16 v[152:155], a[168:171], a[40:43], v[152:155]
  v_mfma_f32_16x16x32_bf16 v[148:151], a[168:171], a[36:39], v[148:151]
  ds_read_b64_tr_b16 a[156:157], v1 offset:21632
  v_mfma_f32_16x16x32_bf16 v[148:151], a[172:175], a[52:55], v[148:151]
  buffer_load_dwordx4 a[96:99], v0, s[36:39], s57 offen offset:0 sc1
  v_mfma_f32_16x16x32_bf16 v[144:147], a[172:175], a[48:51], v[144:147]
  ds_read_b64_tr_b16 a[158:159], v1 offset:25216
  v_mfma_f32_16x16x32_bf16 v[144:147], a[168:171], a[32:35], v[144:147]
  s_waitcnt lgkmcnt(8)
  v_mfma_f32_16x16x32_bf16 v[160:163], a[128:131], a[32:35], v[160:163]
  ds_read_b64_tr_b16 a[160:161], v1 offset:14496
  v_mfma_f32_16x16x32_bf16 v[160:163], a[132:135], a[48:51], v[160:163]
  v_mfma_f32_16x16x32_bf16 v[164:167], a[132:135], a[52:55], v[164:167]
  ds_read_b64_tr_b16 a[162:163], v1 offset:18080
  v_mfma_f32_16x16x32_bf16 v[164:167], a[128:131], a[36:39], v[164:167]
  v_mfma_f32_16x16x32_bf16 v[168:171], a[128:131], a[40:43], v[168:171]
  ds_read_b64_tr_b16 a[164:165], v1 offset:21664
  v_mfma_f32_16x16x32_bf16 v[168:171], a[132:135], a[56:59], v[168:171]
  v_mfma_f32_16x16x32_bf16 v[172:175], a[132:135], a[60:63], v[172:175]
  ds_read_b64_tr_b16 a[166:167], v1 offset:25248
  v_mfma_f32_16x16x32_bf16 v[172:175], a[128:131], a[44:47], v[172:175]
  s_waitcnt vmcnt(14)
  s_barrier
  buffer_load_dwordx4 v8, s[16:19], s56 offen offset:1024 lds
  v_mfma_f32_16x16x32_bf16 v[188:191], a[136:139], a[44:47], v[188:191]
  ds_read_b64_tr_b16 a[168:169], v1 offset:14528
  v_mfma_f32_16x16x32_bf16 v[188:191], a[140:143], a[60:63], v[188:191]
  v_mfma_f32_16x16x32_bf16 v[184:187], a[140:143], a[56:59], v[184:187]
  ds_read_b64_tr_b16 a[170:171], v1 offset:18112
  v_mfma_f32_16x16x32_bf16 v[184:187], a[136:139], a[40:43], v[184:187]
  v_mfma_f32_16x16x32_bf16 v[180:183], a[136:139], a[36:39], v[180:183]
  buffer_load_dwordx4 a[100:103], v0, s[36:39], s57 offen offset:1024 sc1
  v_mfma_f32_16x16x32_bf16 v[180:183], a[140:143], a[52:55], v[180:183]
  ds_read_b64_tr_b16 a[172:173], v1 offset:21696
  v_mfma_f32_16x16x32_bf16 v[176:179], a[140:143], a[48:51], v[176:179]
  ds_read_b64_tr_b16 a[174:175], v1 offset:25280
  v_mfma_f32_16x16x32_bf16 v[176:179], a[136:139], a[32:35], v[176:179]
  s_waitcnt lgkmcnt(8)
  v_mfma_f32_16x16x32_bf16 v[192:195], a[144:147], a[32:35], v[192:195]
  ds_read_b64_tr_b16 a[128:129], v1 offset:28672
  v_mfma_f32_16x16x32_bf16 v[192:195], a[148:151], a[48:51], v[192:195]
  v_mfma_f32_16x16x32_bf16 v[196:199], a[148:151], a[52:55], v[196:199]
  ds_read_b64_tr_b16 a[130:131], v1 offset:32256
  v_mfma_f32_16x16x32_bf16 v[196:199], a[144:147], a[36:39], v[196:199]
  v_mfma_f32_16x16x32_bf16 v[200:203], a[144:147], a[40:43], v[200:203]
  ds_read_b64_tr_b16 a[132:133], v1 offset:35840
  v_mfma_f32_16x16x32_bf16 v[200:203], a[148:151], a[56:59], v[200:203]
  ds_read_b64_tr_b16 a[176:177], v31 offset:0
  v_mfma_f32_16x16x32_bf16 v[204:207], a[148:151], a[60:63], v[204:207]
  buffer_load_dwordx4 v9, s[16:19], s56 offen offset:2048 lds
  v_mfma_f32_16x16x32_bf16 v[204:207], a[144:147], a[44:47], v[204:207]
  ds_read_b64_tr_b16 a[134:135], v1 offset:39424
  v_mfma_f32_16x16x32_bf16 v[220:223], a[152:155], a[44:47], v[220:223]
  ds_read_b64_tr_b16 a[136:137], v1 offset:28704
  v_mfma_f32_16x16x32_bf16 v[220:223], a[156:159], a[60:63], v[220:223]
  ds_read_b64_tr_b16 a[178:179], v31 offset:3584
  v_mfma_f32_16x16x32_bf16 v[216:219], a[156:159], a[56:59], v[216:219]
  ds_read_b64_tr_b16 a[138:139], v1 offset:32288
  v_mfma_f32_16x16x32_bf16 v[216:219], a[152:155], a[40:43], v[216:219]
  buffer_load_dwordx4 a[104:107], v0, s[36:39], s57 offen offset:2048 sc1
  v_mfma_f32_16x16x32_bf16 v[212:215], a[152:155], a[36:39], v[212:215]
  ds_read_b64_tr_b16 a[140:141], v1 offset:35872
  v_mfma_f32_16x16x32_bf16 v[212:215], a[156:159], a[52:55], v[212:215]
  ds_read_b64_tr_b16 a[180:181], v31 offset:7168
  v_mfma_f32_16x16x32_bf16 v[208:211], a[156:159], a[48:51], v[208:211]
  ds_read_b64_tr_b16 a[142:143], v1 offset:39456
  v_mfma_f32_16x16x32_bf16 v[208:211], a[152:155], a[32:35], v[208:211]
  s_waitcnt lgkmcnt(11)
  ds_read_b64_tr_b16 a[182:183], v31 offset:10752
  v_mfma_f32_16x16x32_bf16 v[224:227], a[160:163], a[32:35], v[224:227]
  ds_read_b64_tr_b16 a[144:145], v1 offset:28736
  v_mfma_f32_16x16x32_bf16 v[224:227], a[164:167], a[48:51], v[224:227]
  ds_read_b64_tr_b16 a[184:185], v31 offset:32
  v_mfma_f32_16x16x32_bf16 v[228:231], a[164:167], a[52:55], v[228:231]
  ds_read_b64_tr_b16 a[146:147], v1 offset:32320
  v_mfma_f32_16x16x32_bf16 v[228:231], a[160:163], a[36:39], v[228:231]
  ds_read_b64_tr_b16 a[186:187], v31 offset:3616
  v_mfma_f32_16x16x32_bf16 v[232:235], a[160:163], a[40:43], v[232:235]
  ds_read_b64_tr_b16 a[148:149], v1 offset:35904
  v_mfma_f32_16x16x32_bf16 v[232:235], a[164:167], a[56:59], v[232:235]
  buffer_load_dwordx4 a[108:111], v0, s[36:39], s57 offen offset:3072 sc1
  v_mfma_f32_16x16x32_bf16 v[236:239], a[164:167], a[60:63], v[236:239]
  ds_read_b64_tr_b16 a[150:151], v1 offset:39488
  v_mfma_f32_16x16x32_bf16 v[236:239], a[160:163], a[44:47], v[236:239]
  ds_read_b64_tr_b16 a[188:189], v31 offset:7200
  v_mfma_f32_16x16x32_bf16 v[252:255], a[168:171], a[44:47], v[252:255]
  ds_read_b64_tr_b16 a[152:153], v1 offset:28768
  v_mfma_f32_16x16x32_bf16 v[252:255], a[172:175], a[60:63], v[252:255]
  s_bfe_u32 s56, s83, 0x30000
  s_lshl_b32 s56, s56, 2
  s_bitcmp1_b32 s83, 3
  v_mfma_f32_16x16x32_bf16 v[248:251], a[172:175], a[56:59], v[248:251]
  s_addc_u32 s56, s56, 0
  s_mul_i32 s56, s56, 229376
  s_add_u32 m0, s84, 86016
  v_mfma_f32_16x16x32_bf16 v[248:251], a[168:171], a[40:43], v[248:251]
  ds_read_b64_tr_b16 a[154:155], v1 offset:32352
  v_mfma_f32_16x16x32_bf16 v[244:247], a[168:171], a[36:39], v[244:247]
  ds_read_b64_tr_b16 a[156:157], v1 offset:35936
  v_mfma_f32_16x16x32_bf16 v[244:247], a[172:175], a[52:55], v[244:247]
  buffer_load_dwordx4 v3, s[16:19], s56 offen offset:0 lds
  v_mfma_f32_16x16x32_bf16 v[240:243], a[172:175], a[48:51], v[240:243]
  ds_read_b64_tr_b16 a[158:159], v1 offset:39520
  v_mfma_f32_16x16x32_bf16 v[240:243], a[168:171], a[32:35], v[240:243]
  s_waitcnt vmcnt(8) lgkmcnt(12)
  ds_read_b64_tr_b16 a[190:191], v31 offset:10784
  v_mfma_f32_16x16x32_bf16 v[32:35], a[128:131], a[64:67], v[32:35]
  s_add_u32 s57, s57, 4096
  ds_read_b64_tr_b16 a[192:193], v31 offset:64
  v_mfma_f32_16x16x32_bf16 v[32:35], a[132:135], a[80:83], v[32:35]
  ds_read_b64_tr_b16 a[194:195], v31 offset:3648
  v_mfma_f32_16x16x32_bf16 v[36:39], a[132:135], a[84:87], v[36:39]
  ds_read_b64_tr_b16 a[196:197], v31 offset:7232
  v_mfma_f32_16x16x32_bf16 v[36:39], a[128:131], a[68:71], v[36:39]
  ds_read_b64_tr_b16 a[198:199], v31 offset:10816
  v_mfma_f32_16x16x32_bf16 v[40:43], a[128:131], a[72:75], v[40:43]
  buffer_load_dwordx4 a[112:115], v0, s[36:39], s57 offen offset:0 sc1
  v_mfma_f32_16x16x32_bf16 v[40:43], a[132:135], a[88:91], v[40:43]
  ds_read_b64_tr_b16 a[200:201], v31 offset:96
  v_mfma_f32_16x16x32_bf16 v[44:47], a[132:135], a[92:95], v[44:47]
  ds_read_b64_tr_b16 a[202:203], v31 offset:3680
  v_mfma_f32_16x16x32_bf16 v[44:47], a[128:131], a[76:79], v[44:47]
  ds_read_b64_tr_b16 a[204:205], v31 offset:7264
  v_mfma_f32_16x16x32_bf16 v[60:63], a[136:139], a[76:79], v[60:63]
  ds_read_b64_tr_b16 a[160:161], v1 offset:28800
  v_mfma_f32_16x16x32_bf16 v[60:63], a[140:143], a[92:95], v[60:63]
  ds_read_b64_tr_b16 a[206:207], v31 offset:10848
  v_mfma_f32_16x16x32_bf16 v[56:59], a[140:143], a[88:91], v[56:59]
  ds_read_b64_tr_b16 a[162:163], v1 offset:32384
  v_mfma_f32_16x16x32_bf16 v[56:59], a[136:139], a[72:75], v[56:59]
  buffer_load_dwordx4 v4, s[16:19], s56 offen offset:1024 lds
  v_mfma_f32_16x16x32_bf16 v[52:55], a[136:139], a[68:71], v[52:55]
  ds_read_b64_tr_b16 a[164:165], v1 offset:35968
  v_mfma_f32_16x16x32_bf16 v[52:55], a[140:143], a[84:87], v[52:55]
  v_mfma_f32_16x16x32_bf16 v[48:51], a[140:143], a[80:83], v[48:51]
  ds_read_b64_tr_b16 a[166:167], v1 offset:39552
  v_mfma_f32_16x16x32_bf16 v[48:51], a[136:139], a[64:67], v[48:51]
  s_waitcnt lgkmcnt(13)
  v_mfma_f32_16x16x32_bf16 v[64:67], a[144:147], a[64:67], v[64:67]
  ds_read_b64_tr_b16 a[168:169], v1 offset:28832
  v_mfma_f32_16x16x32_bf16 v[64:67], a[148:151], a[80:83], v[64:67]
  v_mfma_f32_16x16x32_bf16 v[68:71], a[148:151], a[84:87], v[68:71]
  ds_read_b64_tr_b16 a[170:171], v1 offset:32416
  v_mfma_f32_16x16x32_bf16 v[68:71], a[144:147], a[68:71], v[68:71]
  buffer_load_dwordx4 a[116:119], v0, s[36:39], s57 offen offset:1024 sc1
  v_mfma_f32_16x16x32_bf16 v[72:75], a[144:147], a[72:75], v[72:75]
  ds_read_b64_tr_b16 a[172:173], v1 offset:36000
  v_mfma_f32_16x16x32_bf16 v[72:75], a[148:151], a[88:91], v[72:75]
  v_mfma_f32_16x16x32_bf16 v[76:79], a[148:151], a[92:95], v[76:79]
  ds_read_b64_tr_b16 a[174:175], v1 offset:39584
  v_mfma_f32_16x16x32_bf16 v[76:79], a[144:147], a[76:79], v[76:79]
  v_mfma_f32_16x16x32_bf16 v[92:95], a[152:155], a[76:79], v[92:95]
  ds_read_b64_tr_b16 a[128:129], v1 offset:28864
  v_mfma_f32_16x16x32_bf16 v[92:95], a[156:159], a[92:95], v[92:95]
  v_mfma_f32_16x16x32_bf16 v[88:91], a[156:159], a[88:91], v[88:91]
  buffer_load_dwordx4 v5, s[16:19], s56 offen offset:2048 lds
  v_mfma_f32_16x16x32_bf16 v[88:91], a[152:155], a[72:75], v[88:91]
  ds_read_b64_tr_b16 a[130:131], v1 offset:32448
  v_mfma_f32_16x16x32_bf16 v[84:87], a[152:155], a[68:71], v[84:87]
  ds_read_b64_tr_b16 a[132:133], v1 offset:36032
  v_mfma_f32_16x16x32_bf16 v[84:87], a[156:159], a[84:87], v[84:87]
  v_mfma_f32_16x16x32_bf16 v[80:83], a[156:159], a[80:83], v[80:83]
  ds_read_b64_tr_b16 a[134:135], v1 offset:39616
  v_mfma_f32_16x16x32_bf16 v[80:83], a[152:155], a[64:67], v[80:83]
  s_waitcnt vmcnt(20) lgkmcnt(11)
  v_mfma_f32_16x16x32_bf16 a[216:219], a[176:179], a[208:211], 0
  ds_read_b64_tr_b16 a[136:137], v1 offset:43008
  v_mfma_f32_16x16x32_bf16 a[216:219], a[180:183], a[212:215], a[216:219]
  v_mfma_f32_16x16x32_bf16 a[220:223], a[184:187], a[208:211], 0
  buffer_load_dwordx4 a[120:123], v0, s[36:39], s57 offen offset:2048 sc1
  v_mfma_f32_16x16x32_bf16 a[220:223], a[188:191], a[212:215], a[220:223]
  ds_read_b64_tr_b16 a[138:139], v1 offset:46592
  v_mfma_f32_16x16x32_bf16 a[224:227], a[192:195], a[208:211], 0
  ds_read_b64_tr_b16 a[140:141], v1 offset:50176
  v_mfma_f32_16x16x32_bf16 a[224:227], a[196:199], a[212:215], a[224:227]
  v_mfma_f32_16x16x32_bf16 a[228:231], a[200:203], a[208:211], 0
  ds_read_b64_tr_b16 a[142:143], v1 offset:53760
  v_mfma_f32_16x16x32_bf16 a[228:231], a[204:207], a[212:215], a[228:231]
  s_waitcnt lgkmcnt(8)
  v_mfma_f32_16x16x32_bf16 v[96:99], a[160:163], a[64:67], v[96:99]
  ds_read_b64_tr_b16 a[144:145], v1 offset:43040
  v_mfma_f32_16x16x32_bf16 v[96:99], a[164:167], a[80:83], v[96:99]
  buffer_load_dwordx4 v6, s[16:19], s56 offen offset:3072 lds
  v_mfma_f32_16x16x32_bf16 v[100:103], a[164:167], a[84:87], v[100:103]
  s_lshl2_add_u32 s76, s58, s44
  ds_read_b64_tr_b16 a[146:147], v1 offset:46624
  s_lshl_b32 s76, s76, 13
  v_mfma_f32_16x16x32_bf16 v[100:103], a[160:163], a[68:71], v[100:103]
  s_add_u32 s76, s76, 262144
  s_add_u32 s77, s76, 4096
  v_mfma_f32_16x16x32_bf16 v[104:107], a[160:163], a[72:75], v[104:107]
  ds_read_b64_tr_b16 a[148:149], v1 offset:50208
  v_mfma_f32_16x16x32_bf16 v[104:107], a[164:167], a[88:91], v[104:107]
  v_mfma_f32_16x16x32_bf16 v[108:111], a[164:167], a[92:95], v[108:111]
  ds_read_b64_tr_b16 a[150:151], v1 offset:53792
  v_mfma_f32_16x16x32_bf16 v[108:111], a[160:163], a[76:79], v[108:111]
  buffer_load_dwordx4 a[176:179], v0, s[36:39], s76 offen offset:0 sc1
  v_mfma_f32_16x16x32_bf16 v[124:127], a[168:171], a[76:79], v[124:127]
Hc2:
  s_cbranch_execz Hc2_1
  ds_read_b64_tr_b16 a[152:153], v1 offset:43072
  v_mfma_f32_16x16x32_bf16 v[124:127], a[172:175], a[92:95], v[124:127]
  v_mfma_f32_16x16x32_bf16 v[120:123], a[172:175], a[88:91], v[120:123]
  ds_read_b64_tr_b16 a[154:155], v1 offset:46656
  v_mfma_f32_16x16x32_bf16 v[120:123], a[168:171], a[72:75], v[120:123]
  v_mfma_f32_16x16x32_bf16 v[116:119], a[168:171], a[68:71], v[116:119]
  buffer_load_dwordx4 a[124:127], v0, s[36:39], s57 offen offset:3072 sc1
  s_add_u32 m0, s84, 90112
  v_mfma_f32_16x16x32_bf16 v[116:119], a[172:175], a[84:87], v[116:119]
  ds_read_b64_tr_b16 a[156:157], v1 offset:50240
  v_mfma_f32_16x16x32_bf16 v[112:115], a[172:175], a[80:83], v[112:115]
  ds_read_b64_tr_b16 a[158:159], v1 offset:53824
  v_mfma_f32_16x16x32_bf16 v[112:115], a[168:171], a[64:67], v[112:115]
  s_waitcnt lgkmcnt(8)
  v_mfma_f32_16x16x32_bf16 v[128:131], a[128:131], a[64:67], v[128:131]
  ds_read_b64_tr_b16 a[160:161], v1 offset:43104
  v_mfma_f32_16x16x32_bf16 v[128:131], a[132:135], a[80:83], v[128:131]
  buffer_load_dwordx4 v7, s[16:19], s56 offen offset:0 lds
  s_bfe_u32 s57, s83, 0x40000
  v_mfma_f32_16x16x32_bf16 v[132:135], a[132:135], a[84:87], v[132:135]
  s_lshl_b32 s57, s57, 13
  s_add_u32 s57, s57, s85
  ds_read_b64_tr_b16 a[162:163], v1 offset:46688
  v_mfma_f32_16x16x32_bf16 v[132:135], a[128:131], a[68:71], v[132:135]
  v_mfma_f32_16x16x32_bf16 v[136:139], a[128:131], a[72:75], v[136:139]
  ds_read_b64_tr_b16 a[164:165], v1 offset:50272
  v_mfma_f32_16x16x32_bf16 v[136:139], a[132:135], a[88:91], v[136:139]
  v_mfma_f32_16x16x32_bf16 v[140:143], a[132:135], a[92:95], v[140:143]
  buffer_load_dwordx4 a[0:3], v0, s[36:39], s57 offen offset:0 sc1
  v_mfma_f32_16x16x32_bf16 v[140:143], a[128:131], a[76:79], v[140:143]
  ds_read_b64_tr_b16 a[166:167], v1 offset:53856
  v_mfma_f32_16x16x32_bf16 v[156:159], a[136:139], a[76:79], v[156:159]
  ds_read_b64_tr_b16 a[168:169], v1 offset:43136
  v_mfma_f32_16x16x32_bf16 v[156:159], a[140:143], a[92:95], v[156:159]
  v_mfma_f32_16x16x32_bf16 v[152:155], a[140:143], a[88:91], v[152:155]
  ds_read_b64_tr_b16 a[170:171], v1 offset:46720
  v_mfma_f32_16x16x32_bf16 v[152:155], a[136:139], a[72:75], v[152:155]
  buffer_load_dwordx4 a[180:183], v0, s[36:39], s76 offen offset:1024 sc1
  v_mfma_f32_16x16x32_bf16 v[148:151], a[136:139], a[68:71], v[148:151]
  ds_read_b64_tr_b16 a[172:173], v1 offset:50304
  v_mfma_f32_16x16x32_bf16 v[148:151], a[140:143], a[84:87], v[148:151]
  v_mfma_f32_16x16x32_bf16 v[144:147], a[140:143], a[80:83], v[144:147]
  ds_read_b64_tr_b16 a[174:175], v1 offset:53888
  v_mfma_f32_16x16x32_bf16 v[144:147], a[136:139], a[64:67], v[144:147]
  s_waitcnt lgkmcnt(8)
  v_mfma_f32_16x16x32_bf16 v[160:163], a[144:147], a[64:67], v[160:163]
  buffer_load_dwordx4 v8, s[16:19], s56 offen offset:1024 lds
  v_mfma_f32_16x16x32_bf16 v[160:163], a[148:151], a[80:83], v[160:163]
  ds_read_b64_tr_b16 a[128:129], v1 offset:43168
  v_mfma_f32_16x16x32_bf16 v[164:167], a[148:151], a[84:87], v[164:167]
  ds_read_b64_tr_b16 a[130:131], v1 offset:46752
  v_mfma_f32_16x16x32_bf16 v[164:167], a[144:147], a[68:71], v[164:167]
  v_mfma_f32_16x16x32_bf16 v[168:171], a[144:147], a[72:75], v[168:171]
  ds_read_b64_tr_b16 a[132:133], v1 offset:50336
  v_mfma_f32_16x16x32_bf16 v[168:171], a[148:151], a[88:91], v[168:171]
  buffer_load_dwordx4 a[4:7], v0, s[36:39], s57 offen offset:1024 sc1
  v_mfma_f32_16x16x32_bf16 v[172:175], a[148:151], a[92:95], v[172:175]
  ds_read_b64_tr_b16 a[134:135], v1 offset:53920
  v_mfma_f32_16x16x32_bf16 v[172:175], a[144:147], a[76:79], v[172:175]
  s_waitcnt vmcnt(16)
  s_barrier
  v_mfma_f32_16x16x32_bf16 v[188:191], a[152:155], a[76:79], v[188:191]
  ds_read_b64_tr_b16 a[136:137], v1 offset:43200
  v_mfma_f32_16x16x32_bf16 v[188:191], a[156:159], a[92:95], v[188:191]
  v_mfma_f32_16x16x32_bf16 v[184:187], a[156:159], a[88:91], v[184:187]
  ds_read_b64_tr_b16 a[138:139], v1 offset:46784
  v_mfma_f32_16x16x32_bf16 v[184:187], a[152:155], a[72:75], v[184:187]
  buffer_load_dwordx4 a[184:187], v0, s[36:39], s76 offen offset:2048 sc1
  v_mfma_f32_16x16x32_bf16 v[180:183], a[152:155], a[68:71], v[180:183]
  ds_read_b64_tr_b16 a[140:141], v1 offset:50368
  v_mfma_f32_16x16x32_bf16 v[180:183], a[156:159], a[84:87], v[180:183]
  v_mfma_f32_16x16x32_bf16 v[176:179], a[156:159], a[80:83], v[176:179]
  ds_read_b64_tr_b16 a[142:143], v1 offset:53952
  v_mfma_f32_16x16x32_bf16 v[176:179], a[152:155], a[64:67], v[176:179]
  s_waitcnt lgkmcnt(8)
  v_mfma_f32_16x16x32_bf16 v[192:195], a[160:163], a[64:67], v[192:195]
  buffer_load_dwordx4 v9, s[16:19], s56 offen offset:2048 lds
  v_mfma_f32_16x16x32_bf16 v[192:195], a[164:167], a[80:83], v[192:195]
  ds_read_b64_tr_b16 a[144:145], v2 offset:0
  v_mfma_f32_16x16x32_bf16 v[196:199], a[164:167], a[84:87], v[196:199]
  ds_read_b64_tr_b16 a[146:147], v2 offset:3584
  v_mfma_f32_16x16x32_bf16 v[196:199], a[160:163], a[68:71], v[196:199]
  v_mfma_f32_16x16x32_bf16 v[200:203], a[160:163], a[72:75], v[200:203]
  ds_read_b64_tr_b16 a[148:149], v2 offset:7168
  v_mfma_f32_16x16x32_bf16 v[200:203], a[164:167], a[88:91], v[200:203]
  buffer_load_dwordx4 a[8:11], v0, s[36:39], s57 offen offset:2048 sc1
  v_mfma_f32_16x16x32_bf16 v[204:207], a[164:167], a[92:95], v[204:207]
  ds_read_b64_tr_b16 a[150:151], v2 offset:10752
  v_mfma_f32_16x16x32_bf16 v[204:207], a[160:163], a[76:79], v[204:207]
  v_mfma_f32_16x16x32_bf16 v[220:223], a[168:171], a[76:79], v[220:223]
  ds_read_b64_tr_b16 a[152:153], v2 offset:32
  v_mfma_f32_16x16x32_bf16 v[220:223], a[172:175], a[92:95], v[220:223]
  buffer_load_dwordx4 a[188:191], v0, s[36:39], s76 offen offset:3072 sc1
  v_mfma_f32_16x16x32_bf16 v[216:219], a[172:175], a[88:91], v[216:219]
  ds_read_b64_tr_b16 a[154:155], v2 offset:3616
  v_mfma_f32_16x16x32_bf16 v[216:219], a[168:171], a[72:75], v[216:219]
  v_mfma_f32_16x16x32_bf16 v[212:215], a[168:171], a[68:71], v[212:215]
  ds_read_b64_tr_b16 a[156:157], v2 offset:7200
  v_mfma_f32_16x16x32_bf16 v[212:215], a[172:175], a[84:87], v[212:215]
  v_mfma_f32_16x16x32_bf16 v[208:211], a[172:175], a[80:83], v[208:211]
  buffer_load_dwordx4 a[12:15], v0, s[36:39], s57 offen offset:3072 sc1
  v_mfma_f32_16x16x32_bf16 v[208:211], a[168:171], a[64:67], v[208:211]
  s_waitcnt lgkmcnt(7)
  ds_read_b64_tr_b16 a[158:159], v2 offset:10784
  v_mfma_f32_16x16x32_bf16 v[224:227], a[128:131], a[64:67], v[224:227]
  ds_read_b64_tr_b16 a[160:161], v2 offset:64
  v_mfma_f32_16x16x32_bf16 v[224:227], a[132:135], a[80:83], v[224:227]
  s_bfe_u32 s56, s83, 0x30004
  s_lshl_b32 s56, s56, 2
  s_bitcmp1_b32 s83, 7
  v_mfma_f32_16x16x32_bf16 v[228:231], a[132:135], a[84:87], v[228:231]
  buffer_load_dwordx4 a[192:195], v0, s[36:39], s77 offen offset:0 sc1
  s_addc_u32 s56, s56, 0
  v_mfma_f32_16x16x32_bf16 v[228:231], a[128:131], a[68:71], v[228:231]
  s_mul_i32 s56, s56, 229376
  s_add_u32 m0, s84, 0
  ds_read_b64_tr_b16 a[162:163], v2 offset:3648
  v_mfma_f32_16x16x32_bf16 v[232:235], a[128:131], a[72:75], v[232:235]
  ds_read_b64_tr_b16 a[164:165], v2 offset:7232
  v_mfma_f32_16x16x32_bf16 v[232:235], a[132:135], a[88:91], v[232:235]
  v_mfma_f32_16x16x32_bf16 v[236:239], a[132:135], a[92:95], v[236:239]
  ds_read_b64_tr_b16 a[166:167], v2 offset:10816
  v_mfma_f32_16x16x32_bf16 v[236:239], a[128:131], a[76:79], v[236:239]
  buffer_load_dwordx4 v3, s[16:19], s56 offen offset:0 lds
  v_mfma_f32_16x16x32_bf16 v[252:255], a[136:139], a[76:79], v[252:255]
  ds_read_b64_tr_b16 a[168:169], v2 offset:96
  v_mfma_f32_16x16x32_bf16 v[252:255], a[140:143], a[92:95], v[252:255]
  v_mfma_f32_16x16x32_bf16 v[248:251], a[140:143], a[88:91], v[248:251]
  ds_read_b64_tr_b16 a[170:171], v2 offset:3680
  v_mfma_f32_16x16x32_bf16 v[248:251], a[136:139], a[72:75], v[248:251]
  buffer_load_dwordx4 a[196:199], v0, s[36:39], s77 offen offset:1024 sc1
  v_mfma_f32_16x16x32_bf16 v[244:247], a[136:139], a[68:71], v[244:247]
  ds_read_b64_tr_b16 a[172:173], v2 offset:7264
  v_mfma_f32_16x16x32_bf16 v[244:247], a[140:143], a[84:87], v[244:247]
  v_mfma_f32_16x16x32_bf16 v[240:243], a[140:143], a[80:83], v[240:243]
  ds_read_b64_tr_b16 a[174:175], v2 offset:10848
  v_mfma_f32_16x16x32_bf16 v[240:243], a[136:139], a[64:67], v[240:243]
  s_waitcnt vmcnt(13) lgkmcnt(8)
  v_mfma_f32_16x16x32_bf16 v[32:35], a[144:147], a[96:99], v[32:35]
  s_add_u32 s57, s57, 4096
  ds_read_b64_tr_b16 a[128:129], v2 offset:128
  v_mfma_f32_16x16x32_bf16 v[32:35], a[148:151], a[112:115], v[32:35]
  buffer_load_dwordx4 a[200:203], v0, s[36:39], s77 offen offset:2048 sc1
  v_mfma_f32_16x16x32_bf16 v[36:39], a[148:151], a[116:119], v[36:39]
  ds_read_b64_tr_b16 a[130:131], v2 offset:3712
  v_mfma_f32_16x16x32_bf16 v[36:39], a[144:147], a[100:103], v[36:39]
  v_mfma_f32_16x16x32_bf16 v[40:43], a[144:147], a[104:107], v[40:43]
  ds_read_b64_tr_b16 a[132:133], v2 offset:7296
  v_mfma_f32_16x16x32_bf16 v[40:43], a[148:151], a[120:123], v[40:43]
  v_mfma_f32_16x16x32_bf16 v[44:47], a[148:151], a[124:127], v[44:47]
  buffer_load_dwordx4 a[16:19], v0, s[36:39], s57 offen offset:0 sc1
  v_mfma_f32_16x16x32_bf16 v[44:47], a[144:147], a[108:111], v[44:47]
  ds_read_b64_tr_b16 a[134:135], v2 offset:10880
  v_mfma_f32_16x16x32_bf16 v[60:63], a[152:155], a[108:111], v[60:63]
  ds_read_b64_tr_b16 a[136:137], v2 offset:160
  v_mfma_f32_16x16x32_bf16 v[60:63], a[156:159], a[124:127], v[60:63]
  v_mfma_f32_16x16x32_bf16 v[56:59], a[156:159], a[120:123], v[56:59]
  ds_read_b64_tr_b16 a[138:139], v2 offset:3744
  v_mfma_f32_16x16x32_bf16 v[56:59], a[152:155], a[104:107], v[56:59]
  buffer_load_dwordx4 v4, s[16:19], s56 offen offset:1024 lds
  v_mfma_f32_16x16x32_bf16 v[52:55], a[152:155], a[100:103], v[52:55]
  ds_read_b64_tr_b16 a[140:141], v2 offset:7328
  v_mfma_f32_16x16x32_bf16 v[52:55], a[156:159], a[116:119], v[52:55]
  buffer_load_dwordx4 a[204:207], v0, s[36:39], s77 offen offset:3072 sc1
  v_mfma_f32_16x16x32_bf16 v[48:51], a[156:159], a[112:115], v[48:51]
  ds_read_b64_tr_b16 a[142:143], v2 offset:10912
  v_mfma_f32_16x16x32_bf16 v[48:51], a[152:155], a[96:99], v[48:51]
  s_waitcnt lgkmcnt(8)
  v_mfma_f32_16x16x32_bf16 v[64:67], a[160:163], a[96:99], v[64:67]
  ds_read_b64_tr_b16 a[144:145], v2 offset:192
  v_mfma_f32_16x16x32_bf16 v[64:67], a[164:167], a[112:115], v[64:67]
  v_mfma_f32_16x16x32_bf16 v[68:71], a[164:167], a[116:119], v[68:71]
  ds_read_b64_tr_b16 a[146:147], v2 offset:3776
  v_mfma_f32_16x16x32_bf16 v[68:71], a[160:163], a[100:103], v[68:71]
  buffer_load_dwordx4 a[20:23], v0, s[36:39], s57 offen offset:1024 sc1
  v_mfma_f32_16x16x32_bf16 v[72:75], a[160:163], a[104:107], v[72:75]
  ds_read_b64_tr_b16 a[148:149], v2 offset:7360
  v_mfma_f32_16x16x32_bf16 v[72:75], a[164:167], a[120:123], v[72:75]
  v_mfma_f32_16x16x32_bf16 v[76:79], a[164:167], a[124:127], v[76:79]
  ds_read_b64_tr_b16 a[150:151], v2 offset:10944
  v_mfma_f32_16x16x32_bf16 v[76:79], a[160:163], a[108:111], v[76:79]
  v_mfma_f32_16x16x32_bf16 v[92:95], a[168:171], a[108:111], v[92:95]
  ds_read_b64_tr_b16 a[152:153], v2 offset:14336
  v_mfma_f32_16x16x32_bf16 v[92:95], a[172:175], a[124:127], v[92:95]
  v_mfma_f32_16x16x32_bf16 v[88:91], a[172:175], a[120:123], v[88:91]
  buffer_load_dwordx4 v5, s[16:19], s56 offen offset:2048 lds
  v_mfma_f32_16x16x32_bf16 v[88:91], a[168:171], a[104:107], v[88:91]
  ds_read_b64_tr_b16 a[154:155], v2 offset:17920
  v_mfma_f32_16x16x32_bf16 v[84:87], a[168:171], a[100:103], v[84:87]
  ds_read_b64_tr_b16 a[156:157], v2 offset:21504
  v_mfma_f32_16x16x32_bf16 v[84:87], a[172:175], a[116:119], v[84:87]
  v_mfma_f32_16x16x32_bf16 v[80:83], a[172:175], a[112:115], v[80:83]
  ds_read_b64_tr_b16 a[158:159], v2 offset:25088
  v_mfma_f32_16x16x32_bf16 v[80:83], a[168:171], a[96:99], v[80:83]
  s_waitcnt lgkmcnt(8)
  v_mfma_f32_16x16x32_bf16 v[96:99], a[128:131], a[96:99], v[96:99]
  ds_read_b64_tr_b16 a[160:161], v2 offset:14368
  v_mfma_f32_16x16x32_bf16 v[96:99], a[132:135], a[112:115], v[96:99]
  v_mfma_f32_16x16x32_bf16 v[100:103], a[132:135], a[116:119], v[100:103]
  buffer_load_dwordx4 a[24:27], v0, s[36:39], s57 offen offset:2048 sc1
  v_mfma_f32_16x16x32_bf16 v[100:103], a[128:131], a[100:103], v[100:103]
  ds_read_b64_tr_b16 a[162:163], v2 offset:17952
  v_mfma_f32_16x16x32_bf16 v[104:107], a[128:131], a[104:107], v[104:107]
  ds_read_b64_tr_b16 a[164:165], v2 offset:21536
  v_mfma_f32_16x16x32_bf16 v[104:107], a[132:135], a[120:123], v[104:107]
  v_mfma_f32_16x16x32_bf16 v[108:111], a[132:135], a[124:127], v[108:111]
  ds_read_b64_tr_b16 a[166:167], v2 offset:25120
  v_mfma_f32_16x16x32_bf16 v[108:111], a[128:131], a[108:111], v[108:111]
  v_mfma_f32_16x16x32_bf16 v[124:127], a[136:139], a[108:111], v[124:127]
  ds_read_b64_tr_b16 a[168:169], v2 offset:14400
  v_mfma_f32_16x16x32_bf16 v[124:127], a[140:143], a[124:127], v[124:127]
  buffer_load_dwordx4 v6, s[16:19], s56 offen offset:3072 lds
  v_mfma_f32_16x16x32_bf16 v[120:123], a[140:143], a[120:123], v[120:123]
  ds_read_b64_tr_b16 a[170:171], v2 offset:17984
  v_mfma_f32_16x16x32_bf16 v[120:123], a[136:139], a[104:107], v[120:123]
  v_mfma_f32_16x16x32_bf16 v[116:119], a[136:139], a[100:103], v[116:119]
  ds_read_b64_tr_b16 a[172:173], v2 offset:21568
  v_mfma_f32_16x16x32_bf16 v[116:119], a[140:143], a[116:119], v[116:119]
  v_mfma_f32_16x16x32_bf16 v[112:115], a[140:143], a[112:115], v[112:115]
  ds_read_b64_tr_b16 a[174:175], v2 offset:25152
  v_mfma_f32_16x16x32_bf16 v[112:115], a[136:139], a[96:99], v[112:115]
  s_waitcnt lgkmcnt(8)
  v_mfma_f32_16x16x32_bf16 v[128:131], a[144:147], a[96:99], v[128:131]
  ds_read_b64_tr_b16 a[128:129], v2 offset:14432
  v_mfma_f32_16x16x32_bf16 v[128:131], a[148:151], a[112:115], v[128:131]
  buffer_load_dwordx4 a[28:31], v0, s[36:39], s57 offen offset:3072 sc1
  v_mfma_f32_16x16x32_bf16 v[132:135], a[148:151], a[116:119], v[132:135]
  ds_read_b64_tr_b16 a[130:131], v2 offset:18016
  v_mfma_f32_16x16x32_bf16 v[132:135], a[144:147], a[100:103], v[132:135]
  v_mfma_f32_16x16x32_bf16 v[136:139], a[144:147], a[104:107], v[136:139]
  s_add_u32 m0, s84, 4096
  ds_read_b64_tr_b16 a[132:133], v2 offset:21600
  v_mfma_f32_16x16x32_bf16 v[136:139], a[148:151], a[120:123], v[136:139]
  v_mfma_f32_16x16x32_bf16 v[140:143], a[148:151], a[124:127], v[140:143]
  ds_read_b64_tr_b16 a[134:135], v2 offset:25184
  v_mfma_f32_16x16x32_bf16 v[140:143], a[144:147], a[108:111], v[140:143]
  v_mfma_f32_16x16x32_bf16 v[156:159], a[152:155], a[108:111], v[156:159]
  buffer_load_dwordx4 v7, s[16:19], s56 offen offset:0 lds
  s_bfe_u32 s57, s83, 0x40004
  v_mfma_f32_16x16x32_bf16 v[156:159], a[156:159], a[124:127], v[156:159]
  s_lshl_b32 s57, s57, 13
  s_add_u32 s57, s57, s85
  ds_read_b64_tr_b16 a[136:137], v2 offset:14464
  v_mfma_f32_16x16x32_bf16 v[152:155], a[156:159], a[120:123], v[152:155]
  ds_read_b64_tr_b16 a[138:139], v2 offset:18048
  v_mfma_f32_16x16x32_bf16 v[152:155], a[152:155], a[104:107], v[152:155]
  v_mfma_f32_16x16x32_bf16 v[148:151], a[152:155], a[100:103], v[148:151]
  ds_read_b64_tr_b16 a[140:141], v2 offset:21632
  v_mfma_f32_16x16x32_bf16 v[148:151], a[156:159], a[116:119], v[148:151]
  buffer_load_dwordx4 a[32:35], v0, s[36:39], s57 offen offset:0 sc1
  v_mfma_f32_16x16x32_bf16 v[144:147], a[156:159], a[112:115], v[144:147]
  ds_read_b64_tr_b16 a[142:143], v2 offset:25216
  v_mfma_f32_16x16x32_bf16 v[144:147], a[152:155], a[96:99], v[144:147]
  s_waitcnt lgkmcnt(8)
  v_mfma_f32_16x16x32_bf16 v[160:163], a[160:163], a[96:99], v[160:163]
  s_waitcnt vmcnt(7)
  ds_read_b64_tr_b16 a[144:145], v2 offset:14496
  v_accvgpr_read_b32 v22, a176
  v_mfma_f32_16x16x32_bf16 v[160:163], a[164:167], a[112:115], v[160:163]
  v_accvgpr_read_b32 v23, a177
  v_accvgpr_read_b32 v24, a178
  v_mfma_f32_16x16x32_bf16 v[164:167], a[164:167], a[116:119], v[164:167]
  ds_read_b64_tr_b16 a[146:147], v2 offset:18080
  v_accvgpr_read_b32 v25, a179
  v_mfma_f32_16x16x32_bf16 v[164:167], a[160:163], a[100:103], v[164:167]
  v_accvgpr_read_b32 v26, a180
  v_accvgpr_read_b32 v27, a181
  v_mfma_f32_16x16x32_bf16 v[168:171], a[160:163], a[104:107], v[168:171]
  ds_read_b64_tr_b16 a[148:149], v2 offset:21664
  v_accvgpr_read_b32 v28, a182
  v_mfma_f32_16x16x32_bf16 v[168:171], a[164:167], a[120:123], v[168:171]
  v_accvgpr_read_b32 v29, a183
  v_add_f32 v22, v22, v26
  v_mfma_f32_16x16x32_bf16 v[172:175], a[164:167], a[124:127], v[172:175]
  ds_read_b64_tr_b16 a[150:151], v2 offset:25248
  v_add_f32 v23, v23, v27
  v_mfma_f32_16x16x32_bf16 v[172:175], a[160:163], a[108:111], v[172:175]
  s_waitcnt vmcnt(17)
  s_barrier
  buffer_load_dwordx4 v8, s[16:19], s56 offen offset:1024 lds
  v_add_f32 v24, v24, v28
  v_mfma_f32_16x16x32_bf16 v[188:191], a[168:171], a[108:111], v[188:191]
  ds_read_b64_tr_b16 a[152:153], v2 offset:14528
  v_add_f32 v25, v25, v29
  v_mfma_f32_16x16x32_bf16 v[188:191], a[172:175], a[124:127], v[188:191]
  v_accvgpr_read_b32 v26, a184
  v_accvgpr_read_b32 v27, a185
  v_mfma_f32_16x16x32_bf16 v[184:187], a[172:175], a[120:123], v[184:187]
  ds_read_b64_tr_b16 a[154:155], v2 offset:18112
  v_accvgpr_read_b32 v28, a186
  v_mfma_f32_16x16x32_bf16 v[184:187], a[168:171], a[104:107], v[184:187]
  v_accvgpr_read_b32 v29, a187
  v_add_f32 v22, v22, v26
  v_mfma_f32_16x16x32_bf16 v[180:183], a[168:171], a[100:103], v[180:183]
  buffer_load_dwordx4 a[36:39], v0, s[36:39], s57 offen offset:1024 sc1
  v_add_f32 v23, v23, v27
  v_mfma_f32_16x16x32_bf16 v[180:183], a[172:175], a[116:119], v[180:183]
  ds_read_b64_tr_b16 a[156:157], v2 offset:21696
  v_add_f32 v24, v24, v28
  v_mfma_f32_16x16x32_bf16 v[176:179], a[172:175], a[112:115], v[176:179]
  ds_read_b64_tr_b16 a[158:159], v2 offset:25280
  v_add_f32 v25, v25, v29
  v_mfma_f32_16x16x32_bf16 v[176:179], a[168:171], a[96:99], v[176:179]
  s_waitcnt lgkmcnt(8)
  v_accvgpr_read_b32 v26, a188
  v_accvgpr_read_b32 v27, a189
  v_mfma_f32_16x16x32_bf16 v[192:195], a[128:131], a[96:99], v[192:195]
  ds_read_b64_tr_b16 a[160:161], v2 offset:28672
  v_accvgpr_read_b32 v28, a190
  v_mfma_f32_16x16x32_bf16 v[192:195], a[132:135], a[112:115], v[192:195]
  v_accvgpr_read_b32 v29, a191
  v_add_f32 v22, v22, v26
  v_mfma_f32_16x16x32_bf16 v[196:199], a[132:135], a[116:119], v[196:199]
  ds_read_b64_tr_b16 a[162:163], v2 offset:32256
  v_add_f32 v23, v23, v27
  v_mfma_f32_16x16x32_bf16 v[196:199], a[128:131], a[100:103], v[196:199]
  v_add_f32 v24, v24, v28
  v_add_f32 v25, v25, v29
  v_mfma_f32_16x16x32_bf16 v[200:203], a[128:131], a[104:107], v[200:203]
  ds_read_b64_tr_b16 a[164:165], v2 offset:35840
  v_mov_b32 v26, v22
  v_mfma_f32_16x16x32_bf16 v[200:203], a[132:135], a[120:123], v[200:203]
  v_mov_b32 v27, v23
  v_mov_b32 v28, v24
  v_mfma_f32_16x16x32_bf16 v[204:207], a[132:135], a[124:127], v[204:207]
  buffer_load_dwordx4 v9, s[16:19], s56 offen offset:2048 lds
  v_mov_b32 v29, v25
  v_mfma_f32_16x16x32_bf16 v[204:207], a[128:131], a[108:111], v[204:207]
  ds_read_b64_tr_b16 a[166:167], v2 offset:39424
  v_permlane16_swap_b32 v22, v26
  v_mfma_f32_16x16x32_bf16 v[220:223], a[136:139], a[108:111], v[220:223]
  ds_read_b64_tr_b16 a[168:169], v2 offset:28704
  v_permlane16_swap_b32 v23, v27
  v_mfma_f32_16x16x32_bf16 v[220:223], a[140:143], a[124:127], v[220:223]
  v_permlane16_swap_b32 v24, v28
  v_permlane16_swap_b32 v25, v29
  v_mfma_f32_16x16x32_bf16 v[216:219], a[140:143], a[120:123], v[216:219]
  s_add_u32 s59, s59, 16384
  ds_read_b64_tr_b16 a[170:171], v2 offset:32288
  v_add_f32 v22, v22, v26
  v_mfma_f32_16x16x32_bf16 v[216:219], a[136:139], a[104:107], v[216:219]
  buffer_load_dwordx4 a[40:43], v0, s[36:39], s57 offen offset:2048 sc1
  v_add_f32 v23, v23, v27
  v_mfma_f32_16x16x32_bf16 v[212:215], a[136:139], a[100:103], v[212:215]
  ds_read_b64_tr_b16 a[172:173], v2 offset:35872
  v_add_f32 v24, v24, v28
  v_mfma_f32_16x16x32_bf16 v[212:215], a[140:143], a[116:119], v[212:215]
  v_add_f32 v25, v25, v29
  v_mov_b32 v26, v22
  v_mfma_f32_16x16x32_bf16 v[208:211], a[140:143], a[112:115], v[208:211]
  ds_read_b64_tr_b16 a[174:175], v2 offset:39456
  v_mov_b32 v27, v23
  v_mfma_f32_16x16x32_bf16 v[208:211], a[136:139], a[96:99], v[208:211]
  s_waitcnt lgkmcnt(8)
  v_mov_b32 v28, v24
  v_mov_b32 v29, v25
  v_mfma_f32_16x16x32_bf16 v[224:227], a[144:147], a[96:99], v[224:227]
  buffer_load_dwordx4 a[208:211], v0, s[36:39], s59 offen offset:0 sc1
  v_permlane32_swap_b32 v22, v26
  v_mfma_f32_16x16x32_bf16 v[224:227], a[148:151], a[112:115], v[224:227]
  ds_read_b64_tr_b16 a[128:129], v2 offset:28736
  v_permlane32_swap_b32 v23, v27
  v_mfma_f32_16x16x32_bf16 v[228:231], a[148:151], a[116:119], v[228:231]
  ds_read_b64_tr_b16 a[130:131], v2 offset:32320
  v_permlane32_swap_b32 v24, v28
  v_mfma_f32_16x16x32_bf16 v[228:231], a[144:147], a[100:103], v[228:231]
  v_permlane32_swap_b32 v25, v29
  v_add_f32 v22, v22, v26
  v_mfma_f32_16x16x32_bf16 v[232:235], a[144:147], a[104:107], v[232:235]
  ds_read_b64_tr_b16 a[132:133], v2 offset:35904
  v_add_f32 v23, v23, v27
  v_mfma_f32_16x16x32_bf16 v[232:235], a[148:151], a[120:123], v[232:235]
  buffer_load_dwordx4 a[212:215], v0, s[36:39], s59 offen offset:1024 sc1
  v_add_f32 v24, v24, v28
  v_mfma_f32_16x16x32_bf16 v[236:239], a[148:151], a[124:127], v[236:239]
  ds_read_b64_tr_b16 a[134:135], v2 offset:39488
  v_add_f32 v25, v25, v29
  v_mfma_f32_16x16x32_bf16 v[236:239], a[144:147], a[108:111], v[236:239]
  v_mul_f32 v22, 0x3a800000, v22
  v_mul_f32 v23, 0x3a800000, v23
  v_mfma_f32_16x16x32_bf16 v[252:255], a[152:155], a[108:111], v[252:255]
  ds_read_b64_tr_b16 a[136:137], v2 offset:28768
  v_fma_f32 v23, -v22, v22, v23
  v_mfma_f32_16x16x32_bf16 v[252:255], a[156:159], a[124:127], v[252:255]
  v_max_f32 v23, 0, v23
  v_cvt_pk_bf16_f32 v23, v23, v23
  v_mfma_f32_16x16x32_bf16 v[248:251], a[156:159], a[120:123], v[248:251]
  buffer_load_dwordx4 a[44:47], v0, s[36:39], s57 offen offset:3072 sc1
  s_bfe_u32 s56, s83, 0x30008
  v_mfma_f32_16x16x32_bf16 v[248:251], a[152:155], a[104:107], v[248:251]
  s_lshl_b32 s56, s56, 2
  s_bitcmp1_b32 s83, 11
  s_addc_u32 s56, s56, 0
  v_mfma_f32_16x16x32_bf16 v[244:247], a[152:155], a[100:103], v[244:247]
  s_mul_i32 s56, s56, 229376
  s_add_u32 m0, s84, 28672
  ds_read_b64_tr_b16 a[138:139], v2 offset:32352
  v_mfma_f32_16x16x32_bf16 v[244:247], a[156:159], a[116:119], v[244:247]
  ds_read_b64_tr_b16 a[140:141], v2 offset:35936
  v_lshlrev_b32 v23, 16, v23
  v_mfma_f32_16x16x32_bf16 v[240:243], a[156:159], a[112:115], v[240:243]
  ds_read_b64_tr_b16 a[142:143], v2 offset:39520
  v_add_f32 v23, 0x3727c5ac, v23
  v_mfma_f32_16x16x32_bf16 v[240:243], a[152:155], a[96:99], v[240:243]
  s_waitcnt vmcnt(9) lgkmcnt(8)
  buffer_load_dwordx4 v3, s[16:19], s56 offen offset:0 lds
  v_cvt_pk_bf16_f32 v23, v23, v23
  v_mfma_f32_16x16x32_bf16 v[32:35], a[160:163], a[0:3], v[32:35]
  s_add_u32 s57, s57, 4096
  ds_read_b64_tr_b16 a[144:145], v2 offset:28800
  v_lshlrev_b32 v23, 16, v23
  v_mfma_f32_16x16x32_bf16 v[32:35], a[164:167], a[16:19], v[32:35]
  s_barrier
  v_sqrt_f32 v23, v23
  v_mfma_f32_16x16x32_bf16 v[36:39], a[164:167], a[20:23], v[36:39]
  s_nop 0
  ds_read_b64_tr_b16 a[146:147], v2 offset:32384
  v_cvt_pk_bf16_f32 v12, -v22, v23
  v_mfma_f32_16x16x32_bf16 v[36:39], a[160:163], a[4:7], v[36:39]
  v_and_b32 v23, 0xffff0000, v12
  v_mfma_f32_16x16x32_bf16 v[40:43], a[160:163], a[8:11], v[40:43]
  buffer_load_dwordx4 a[48:51], v0, s[36:39], s57 offen offset:0 sc1
  v_mfma_f32_16x16x32_bf16 v[40:43], a[164:167], a[24:27], v[40:43]
  ds_read_b64_tr_b16 a[148:149], v2 offset:35968
  v_mfma_f32_16x16x32_bf16 v[44:47], a[164:167], a[28:31], v[44:47]
  ds_read_b64_tr_b16 a[150:151], v2 offset:39552
  v_mfma_f32_16x16x32_bf16 v[44:47], a[160:163], a[12:15], v[44:47]
  v_rcp_f32 v10, v23
  v_mfma_f32_16x16x32_bf16 v[60:63], a[168:171], a[12:15], v[60:63]
  ds_read_b64_tr_b16 a[152:153], v2 offset:28832
  v_mul_f32 v11, v23, v23
  v_mfma_f32_16x16x32_bf16 v[60:63], a[172:175], a[28:31], v[60:63]
  v_mul_f32 v10, 0xbfb8aa3b, v10
  v_mul_f32 v24, 0x3a800000, v24
  v_mfma_f32_16x16x32_bf16 v[56:59], a[172:175], a[24:27], v[56:59]
  ds_read_b64_tr_b16 a[154:155], v2 offset:32416
  v_mul_f32 v25, 0x3a800000, v25
  v_mfma_f32_16x16x32_bf16 v[56:59], a[168:171], a[8:11], v[56:59]
  buffer_load_dwordx4 v4, s[16:19], s56 offen offset:1024 lds
  v_fma_f32 v25, -v24, v24, v25
  v_mfma_f32_16x16x32_bf16 v[52:55], a[168:171], a[4:7], v[52:55]
  ds_read_b64_tr_b16 a[156:157], v2 offset:36000
  v_max_f32 v25, 0, v25
  v_mfma_f32_16x16x32_bf16 v[52:55], a[172:175], a[20:23], v[52:55]
  v_cvt_pk_bf16_f32 v25, v25, v25
  v_lshlrev_b32 v25, 16, v25
  v_mfma_f32_16x16x32_bf16 v[48:51], a[172:175], a[16:19], v[48:51]
  ds_read_b64_tr_b16 a[158:159], v2 offset:39584
  v_add_f32 v25, 0x3727c5ac, v25
  v_mfma_f32_16x16x32_bf16 v[48:51], a[168:171], a[0:3], v[48:51]
  s_waitcnt lgkmcnt(8)
  v_cvt_pk_bf16_f32 v25, v25, v25
  v_lshlrev_b32 v25, 16, v25
  v_mfma_f32_16x16x32_bf16 v[64:67], a[128:131], a[0:3], v[64:67]
  ds_read_b64_tr_b16 a[160:161], v2 offset:28864
  v_mfma_f32_16x16x32_bf16 v[64:67], a[132:135], a[16:19], v[64:67]
  v_sqrt_f32 v25, v25
  v_mfma_f32_16x16x32_bf16 v[68:71], a[132:135], a[20:23], v[68:71]
  s_nop 0
  ds_read_b64_tr_b16 a[162:163], v2 offset:32448
  v_cvt_pk_bf16_f32 v15, -v24, v25
  v_mfma_f32_16x16x32_bf16 v[68:71], a[128:131], a[4:7], v[68:71]
  buffer_load_dwordx4 a[52:55], v0, s[36:39], s57 offen offset:1024 sc1
  v_and_b32 v25, 0xffff0000, v15
  v_mfma_f32_16x16x32_bf16 v[72:75], a[128:131], a[8:11], v[72:75]
  ds_read_b64_tr_b16 a[164:165], v2 offset:36032
  v_mfma_f32_16x16x32_bf16 v[72:75], a[132:135], a[24:27], v[72:75]
  v_rcp_f32 v13, v25
  v_mfma_f32_16x16x32_bf16 v[76:79], a[132:135], a[28:31], v[76:79]
  ds_read_b64_tr_b16 a[166:167], v2 offset:39616
  v_mul_f32 v14, v25, v25
  v_mfma_f32_16x16x32_bf16 v[76:79], a[128:131], a[12:15], v[76:79]
  v_mul_f32 v13, 0xbfb8aa3b, v13
  v_accvgpr_read_b32 v22, a192
  v_mfma_f32_16x16x32_bf16 v[92:95], a[136:139], a[12:15], v[92:95]
  ds_read_b64_tr_b16 a[168:169], v2 offset:43008
  v_accvgpr_read_b32 v23, a193
  v_mfma_f32_16x16x32_bf16 v[92:95], a[140:143], a[28:31], v[92:95]
  v_accvgpr_read_b32 v24, a194
  v_accvgpr_read_b32 v25, a195
  v_mfma_f32_16x16x32_bf16 v[88:91], a[140:143], a[24:27], v[88:91]
  buffer_load_dwordx4 v5, s[16:19], s56 offen offset:2048 lds
  v_accvgpr_read_b32 v26, a196
  v_mfma_f32_16x16x32_bf16 v[88:91], a[136:139], a[8:11], v[88:91]
  ds_read_b64_tr_b16 a[170:171], v2 offset:46592
  v_accvgpr_read_b32 v27, a197
  v_mfma_f32_16x16x32_bf16 v[84:87], a[136:139], a[4:7], v[84:87]
  ds_read_b64_tr_b16 a[172:173], v2 offset:50176
  v_accvgpr_read_b32 v28, a198
  v_mfma_f32_16x16x32_bf16 v[84:87], a[140:143], a[20:23], v[84:87]
  v_accvgpr_read_b32 v29, a199
  v_add_f32 v22, v22, v26
  v_mfma_f32_16x16x32_bf16 v[80:83], a[140:143], a[16:19], v[80:83]
  ds_read_b64_tr_b16 a[174:175], v2 offset:53760
  v_add_f32 v23, v23, v27
  v_mfma_f32_16x16x32_bf16 v[80:83], a[136:139], a[0:3], v[80:83]
  s_waitcnt lgkmcnt(8)
  v_add_f32 v24, v24, v28
  v_add_f32 v25, v25, v29
  v_mfma_f32_16x16x32_bf16 v[96:99], a[144:147], a[0:3], v[96:99]
  ds_read_b64_tr_b16 a[128:129], v2 offset:43040
  v_accvgpr_read_b32 v26, a200
  v_mfma_f32_16x16x32_bf16 v[96:99], a[148:151], a[16:19], v[96:99]
  v_accvgpr_read_b32 v27, a201
  v_accvgpr_read_b32 v28, a202
  v_mfma_f32_16x16x32_bf16 v[100:103], a[148:151], a[20:23], v[100:103]
  buffer_load_dwordx4 a[56:59], v0, s[36:39], s57 offen offset:2048 sc1
  v_accvgpr_read_b32 v29, a203
  v_mfma_f32_16x16x32_bf16 v[100:103], a[144:147], a[4:7], v[100:103]
  ds_read_b64_tr_b16 a[130:131], v2 offset:46624
  v_add_f32 v22, v22, v26
  v_mfma_f32_16x16x32_bf16 v[104:107], a[144:147], a[8:11], v[104:107]
  ds_read_b64_tr_b16 a[132:133], v2 offset:50208
  v_add_f32 v23, v23, v27
  v_mfma_f32_16x16x32_bf16 v[104:107], a[148:151], a[24:27], v[104:107]
  v_add_f32 v24, v24, v28
  v_add_f32 v25, v25, v29
  v_mfma_f32_16x16x32_bf16 v[108:111], a[148:151], a[28:31], v[108:111]
  ds_read_b64_tr_b16 a[134:135], v2 offset:53792
  v_accvgpr_read_b32 v26, a204
  v_mfma_f32_16x16x32_bf16 v[108:111], a[144:147], a[12:15], v[108:111]
  v_accvgpr_read_b32 v27, a205
  v_accvgpr_read_b32 v28, a206
  v_mfma_f32_16x16x32_bf16 v[124:127], a[152:155], a[12:15], v[124:127]
  ds_read_b64_tr_b16 a[136:137], v2 offset:43072
  v_accvgpr_read_b32 v29, a207
  v_mfma_f32_16x16x32_bf16 v[124:127], a[156:159], a[28:31], v[124:127]
  buffer_load_dwordx4 v6, s[16:19], s56 offen offset:3072 lds
  v_add_f32 v22, v22, v26
  v_mfma_f32_16x16x32_bf16 v[120:123], a[156:159], a[24:27], v[120:123]
  ds_read_b64_tr_b16 a[138:139], v2 offset:46656
  v_add_f32 v23, v23, v27
  v_mfma_f32_16x16x32_bf16 v[120:123], a[152:155], a[8:11], v[120:123]
  v_add_f32 v24, v24, v28
  v_add_f32 v25, v25, v29
  v_mfma_f32_16x16x32_bf16 v[116:119], a[152:155], a[4:7], v[116:119]
  ds_read_b64_tr_b16 a[140:141], v2 offset:50240
  v_mov_b32 v26, v22
  v_mfma_f32_16x16x32_bf16 v[116:119], a[156:159], a[20:23], v[116:119]
  v_mov_b32 v27, v23
  v_mov_b32 v28, v24
  v_mfma_f32_16x16x32_bf16 v[112:115], a[156:159], a[16:19], v[112:115]
  ds_read_b64_tr_b16 a[142:143], v2 offset:53824
  v_mov_b32 v29, v25
  v_mfma_f32_16x16x32_bf16 v[112:115], a[152:155], a[0:3], v[112:115]
  s_waitcnt lgkmcnt(8)
  v_permlane16_swap_b32 v22, v26
  v_permlane16_swap_b32 v23, v27
  v_mfma_f32_16x16x32_bf16 v[128:131], a[160:163], a[0:3], v[128:131]
  ds_read_b64_tr_b16 a[144:145], v2 offset:43104
  v_permlane16_swap_b32 v24, v28
  v_mfma_f32_16x16x32_bf16 v[128:131], a[164:167], a[16:19], v[128:131]
  buffer_load_dwordx4 a[60:63], v0, s[36:39], s57 offen offset:3072 sc1
  v_permlane16_swap_b32 v25, v29
  v_mfma_f32_16x16x32_bf16 v[132:135], a[164:167], a[20:23], v[132:135]
  s_add_u32 m0, s84, 32768
  ds_read_b64_tr_b16 a[146:147], v2 offset:46688
  v_add_f32 v22, v22, v26
  v_mfma_f32_16x16x32_bf16 v[132:135], a[160:163], a[4:7], v[132:135]
  v_add_f32 v23, v23, v27
  v_add_f32 v24, v24, v28
  v_mfma_f32_16x16x32_bf16 v[136:139], a[160:163], a[8:11], v[136:139]
  ds_read_b64_tr_b16 a[148:149], v2 offset:50272
  v_add_f32 v25, v25, v29
  v_mfma_f32_16x16x32_bf16 v[136:139], a[164:167], a[24:27], v[136:139]
Hc0_1:
  s_cbranch_execz Hc0_2
  v_mov_b32 v26, v22
  v_mov_b32 v27, v23
  v_mfma_f32_16x16x32_bf16 v[140:143], a[164:167], a[28:31], v[140:143]
  buffer_load_dwordx4 v7, s[16:19], s56 offen offset:0 lds
  s_bfe_u32 s57, s83, 0x40008
  v_mfma_f32_16x16x32_bf16 v[140:143], a[160:163], a[12:15], v[140:143]
  s_lshl_b32 s57, s57, 13
  s_add_u32 s57, s57, s85
  ds_read_b64_tr_b16 a[150:151], v2 offset:53856
  v_mfma_f32_16x16x32_bf16 v[156:159], a[168:171], a[12:15], v[156:159]
  ds_read_b64_tr_b16 a[152:153], v2 offset:43136
  v_mov_b32 v28, v24
  v_mfma_f32_16x16x32_bf16 v[156:159], a[172:175], a[28:31], v[156:159]
  v_mov_b32 v29, v25
  v_permlane32_swap_b32 v22, v26
  v_mfma_f32_16x16x32_bf16 v[152:155], a[172:175], a[24:27], v[152:155]
  ds_read_b64_tr_b16 a[154:155], v2 offset:46720
  v_permlane32_swap_b32 v23, v27
  v_mfma_f32_16x16x32_bf16 v[152:155], a[168:171], a[8:11], v[152:155]
  buffer_load_dwordx4 a[64:67], v0, s[36:39], s57 offen offset:0 sc1
  v_permlane32_swap_b32 v24, v28
  v_mfma_f32_16x16x32_bf16 v[148:151], a[168:171], a[4:7], v[148:151]
  ds_read_b64_tr_b16 a[156:157], v2 offset:50304
  v_permlane32_swap_b32 v25, v29
  v_mfma_f32_16x16x32_bf16 v[148:151], a[172:175], a[20:23], v[148:151]
  v_add_f32 v22, v22, v26
  v_add_f32 v23, v23, v27
  v_mfma_f32_16x16x32_bf16 v[144:147], a[172:175], a[16:19], v[144:147]
  ds_read_b64_tr_b16 a[158:159], v2 offset:53888
  v_add_f32 v24, v24, v28
  v_mfma_f32_16x16x32_bf16 v[144:147], a[168:171], a[0:3], v[144:147]
  s_waitcnt lgkmcnt(8)
  v_add_f32 v25, v25, v29
  v_mul_f32 v22, 0x3a800000, v22
  v_mfma_f32_16x16x32_bf16 v[160:163], a[128:131], a[0:3], v[160:163]
  ds_read_b64_tr_b16 a[160:161], v2 offset:43168
  v_mul_f32 v23, 0x3a800000, v23
  v_mfma_f32_16x16x32_bf16 v[160:163], a[132:135], a[16:19], v[160:163]
  v_fma_f32 v23, -v22, v22, v23
  v_max_f32 v23, 0, v23
  v_mfma_f32_16x16x32_bf16 v[164:167], a[132:135], a[20:23], v[164:167]
  buffer_load_dwordx4 v8, s[16:19], s56 offen offset:1024 lds
  v_cvt_pk_bf16_f32 v23, v23, v23
  v_mfma_f32_16x16x32_bf16 v[164:167], a[128:131], a[4:7], v[164:167]
  ds_read_b64_tr_b16 a[162:163], v2 offset:46752
  v_lshlrev_b32 v23, 16, v23
  v_mfma_f32_16x16x32_bf16 v[168:171], a[128:131], a[8:11], v[168:171]
  ds_read_b64_tr_b16 a[164:165], v2 offset:50336
  v_add_f32 v23, 0x3727c5ac, v23
  v_mfma_f32_16x16x32_bf16 v[168:171], a[132:135], a[24:27], v[168:171]
  v_cvt_pk_bf16_f32 v23, v23, v23
  v_lshlrev_b32 v23, 16, v23
  v_mfma_f32_16x16x32_bf16 v[172:175], a[132:135], a[28:31], v[172:175]
  ds_read_b64_tr_b16 a[166:167], v2 offset:53920
  v_mfma_f32_16x16x32_bf16 v[172:175], a[128:131], a[12:15], v[172:175]
  s_waitcnt vmcnt(15)
  s_barrier
  buffer_load_dwordx4 a[68:71], v0, s[36:39], s57 offen offset:1024 sc1
  v_mfma_f32_16x16x32_bf16 v[188:191], a[136:139], a[12:15], v[188:191]
  ds_read_b64_tr_b16 a[168:169], v2 offset:43200
  v_mfma_f32_16x16x32_bf16 v[188:191], a[140:143], a[28:31], v[188:191]
  v_sqrt_f32 v23, v23
  v_mfma_f32_16x16x32_bf16 v[184:187], a[140:143], a[24:27], v[184:187]
  s_nop 0
  ds_read_b64_tr_b16 a[170:171], v2 offset:46784
  v_cvt_pk_bf16_f32 v18, -v22, v23
  v_mfma_f32_16x16x32_bf16 v[184:187], a[136:139], a[8:11], v[184:187]
  v_and_b32 v23, 0xffff0000, v18
  v_mfma_f32_16x16x32_bf16 v[180:183], a[136:139], a[4:7], v[180:183]
  ds_read_b64_tr_b16 a[172:173], v2 offset:50368
  v_mfma_f32_16x16x32_bf16 v[180:183], a[140:143], a[20:23], v[180:183]
  v_rcp_f32 v16, v23
  v_mfma_f32_16x16x32_bf16 v[176:179], a[140:143], a[16:19], v[176:179]
  buffer_load_dwordx4 v9, s[16:19], s56 offen offset:2048 lds
  v_mul_f32 v17, v23, v23
  v_mfma_f32_16x16x32_bf16 v[176:179], a[136:139], a[0:3], v[176:179]
  s_waitcnt lgkmcnt(7)
  ds_read_b64_tr_b16 a[174:175], v2 offset:53952
  v_mul_f32 v16, 0xbfb8aa3b, v16
  v_mfma_f32_16x16x32_bf16 v[192:195], a[144:147], a[0:3], v[192:195]
  ds_read_b64_tr_b16 a[128:129], v1 offset:0
  v_mul_f32 v24, 0x3a800000, v24
  v_mfma_f32_16x16x32_bf16 v[192:195], a[148:151], a[16:19], v[192:195]
  v_mul_f32 v25, 0x3a800000, v25
  v_fma_f32 v25, -v24, v24, v25
  v_mfma_f32_16x16x32_bf16 v[196:199], a[148:151], a[20:23], v[196:199]
  ds_read_b64_tr_b16 a[130:131], v1 offset:3584
  v_max_f32 v25, 0, v25
  v_mfma_f32_16x16x32_bf16 v[196:199], a[144:147], a[4:7], v[196:199]
  v_cvt_pk_bf16_f32 v25, v25, v25
  v_lshlrev_b32 v25, 16, v25
  v_mfma_f32_16x16x32_bf16 v[200:203], a[144:147], a[8:11], v[200:203]
  ds_read_b64_tr_b16 a[132:133], v1 offset:7168
  v_add_f32 v25, 0x3727c5ac, v25
  v_mfma_f32_16x16x32_bf16 v[200:203], a[148:151], a[24:27], v[200:203]
  v_cvt_pk_bf16_f32 v25, v25, v25
  v_lshlrev_b32 v25, 16, v25
  v_mfma_f32_16x16x32_bf16 v[204:207], a[148:151], a[28:31], v[204:207]
  buffer_load_dwordx4 a[72:75], v0, s[36:39], s57 offen offset:2048 sc1
  v_mfma_f32_16x16x32_bf16 v[204:207], a[144:147], a[12:15], v[204:207]
  ds_read_b64_tr_b16 a[134:135], v1 offset:10752
  v_mfma_f32_16x16x32_bf16 v[220:223], a[152:155], a[12:15], v[220:223]
  ds_read_b64_tr_b16 a[136:137], v1 offset:32
  v_mfma_f32_16x16x32_bf16 v[220:223], a[156:159], a[28:31], v[220:223]
  v_sqrt_f32 v25, v25
  v_mfma_f32_16x16x32_bf16 v[216:219], a[156:159], a[24:27], v[216:219]
  s_nop 0
  ds_read_b64_tr_b16 a[138:139], v1 offset:3616
  v_cvt_pk_bf16_f32 v21, -v24, v25
  v_mfma_f32_16x16x32_bf16 v[216:219], a[152:155], a[8:11], v[216:219]
  v_and_b32 v25, 0xffff0000, v21
  v_mfma_f32_16x16x32_bf16 v[212:215], a[152:155], a[4:7], v[212:215]
  s_bfe_u32 s56, s83, 0x3000c
  s_lshl_b32 s56, s56, 2
  s_bitcmp1_b32 s83, 15
  v_mfma_f32_16x16x32_bf16 v[212:215], a[156:159], a[20:23], v[212:215]
  s_addc_u32 s56, s56, 0
  s_mul_i32 s56, s56, 229376
  s_add_u32 m0, s84, 57344
  v_mfma_f32_16x16x32_bf16 v[208:211], a[156:159], a[16:19], v[208:211]
  ds_read_b64_tr_b16 a[140:141], v1 offset:7200
  v_mfma_f32_16x16x32_bf16 v[208:211], a[152:155], a[0:3], v[208:211]
  s_waitcnt lgkmcnt(7)
  ds_read_b64_tr_b16 a[142:143], v1 offset:10784
  v_mfma_f32_16x16x32_bf16 v[224:227], a[160:163], a[0:3], v[224:227]
  buffer_load_dwordx4 v3, s[16:19], s56 offen offset:0 lds
  v_mfma_f32_16x16x32_bf16 v[224:227], a[164:167], a[16:19], v[224:227]
  v_rcp_f32 v19, v25
  v_mfma_f32_16x16x32_bf16 v[228:231], a[164:167], a[20:23], v[228:231]
  v_mul_f32 v20, v25, v25
  v_mul_f32 v19, 0xbfb8aa3b, v19
  v_mfma_f32_16x16x32_bf16 v[228:231], a[160:163], a[4:7], v[228:231]
  v_add_u32 v31, -28672, v31
  v_mfma_f32_16x16x32_bf16 v[232:235], a[160:163], a[8:11], v[232:235]
  ds_read_b64_tr_b16 a[176:177], v31 offset:0
  v_mfma_f32_16x16x32_bf16 v[232:235], a[164:167], a[24:27], v[232:235]
  buffer_load_dwordx4 a[76:79], v0, s[36:39], s57 offen offset:3072 sc1
  v_mfma_f32_16x16x32_bf16 v[236:239], a[164:167], a[28:31], v[236:239]
  ds_read_b64_tr_b16 a[178:179], v31 offset:3584
  v_mfma_f32_16x16x32_bf16 v[236:239], a[160:163], a[12:15], v[236:239]
  ds_read_b64_tr_b16 a[180:181], v31 offset:7168
  v_mfma_f32_16x16x32_bf16 v[252:255], a[168:171], a[12:15], v[252:255]
  ds_read_b64_tr_b16 a[144:145], v1 offset:64
  v_mfma_f32_16x16x32_bf16 v[252:255], a[172:175], a[28:31], v[252:255]
  ds_read_b64_tr_b16 a[182:183], v31 offset:10752
  v_mfma_f32_16x16x32_bf16 v[248:251], a[172:175], a[24:27], v[248:251]
  ds_read_b64_tr_b16 a[146:147], v1 offset:3648
  v_mfma_f32_16x16x32_bf16 v[248:251], a[168:171], a[8:11], v[248:251]
  ds_read_b64_tr_b16 a[184:185], v31 offset:32
  v_mfma_f32_16x16x32_bf16 v[244:247], a[168:171], a[4:7], v[244:247]
  buffer_load_dwordx4 v4, s[16:19], s56 offen offset:1024 lds
  v_mfma_f32_16x16x32_bf16 v[244:247], a[172:175], a[20:23], v[244:247]
  ds_read_b64_tr_b16 a[148:149], v1 offset:7232
  v_mfma_f32_16x16x32_bf16 v[240:243], a[172:175], a[16:19], v[240:243]
  s_add_u32 s57, s57, 4096
  ds_read_b64_tr_b16 a[150:151], v1 offset:10816
  v_mfma_f32_16x16x32_bf16 v[240:243], a[168:171], a[0:3], v[240:243]
  s_waitcnt vmcnt(9) lgkmcnt(9)
  ds_read_b64_tr_b16 a[186:187], v31 offset:3616
  v_mfma_f32_16x16x32_bf16 v[32:35], a[128:131], a[32:35], v[32:35]
  ds_read_b64_tr_b16 a[152:153], v1 offset:96
  v_mfma_f32_16x16x32_bf16 v[32:35], a[132:135], a[48:51], v[32:35]
  s_barrier
  ds_read_b64_tr_b16 a[188:189], v31 offset:7200
  v_mfma_f32_16x16x32_bf16 v[36:39], a[132:135], a[52:55], v[36:39]
  buffer_load_dwordx4 a[80:83], v0, s[36:39], s57 offen offset:0 sc1
  v_mfma_f32_16x16x32_bf16 v[36:39], a[128:131], a[36:39], v[36:39]
  ds_read_b64_tr_b16 a[154:155], v1 offset:3680
  v_mfma_f32_16x16x32_bf16 v[40:43], a[128:131], a[40:43], v[40:43]
  ds_read_b64_tr_b16 a[156:157], v1 offset:7264
  v_mfma_f32_16x16x32_bf16 v[40:43], a[132:135], a[56:59], v[40:43]
  ds_read_b64_tr_b16 a[190:191], v31 offset:10784
  v_mfma_f32_16x16x32_bf16 v[44:47], a[132:135], a[60:63], v[44:47]
  ds_read_b64_tr_b16 a[192:193], v31 offset:64
  ds_read_b64_tr_b16 a[194:195], v31 offset:3648
  ds_read_b64_tr_b16 a[196:197], v31 offset:7232
  ds_read_b64_tr_b16 a[198:199], v31 offset:10816
  ds_read_b64_tr_b16 a[200:201], v31 offset:96
  ds_read_b64_tr_b16 a[202:203], v31 offset:3680
  ds_read_b64_tr_b16 a[204:205], v31 offset:7264
  ds_read_b64_tr_b16 a[206:207], v31 offset:10848
  v_mfma_f32_16x16x32_bf16 v[44:47], a[128:131], a[44:47], v[44:47]
  ds_read_b64_tr_b16 a[158:159], v1 offset:10848
  v_lshrrev_b32 v22, 4, v0
  v_mfma_f32_16x16x32_bf16 v[60:63], a[136:139], a[44:47], v[60:63]
  buffer_load_dwordx4 v5, s[16:19], s56 offen offset:2048 lds
  v_and_b32 v23, 14, v22
  v_mfma_f32_16x16x32_bf16 v[60:63], a[140:143], a[60:63], v[60:63]
  ds_read_b64_tr_b16 a[160:161], v1 offset:128
  v_lshlrev_b32 v23, 27, v23
  v_mfma_f32_16x16x32_bf16 v[56:59], a[140:143], a[56:59], v[56:59]
  ds_read_b64_tr_b16 a[162:163], v1 offset:3712
  v_and_b32 v24, 1, v22
  v_mfma_f32_16x16x32_bf16 v[56:59], a[136:139], a[40:43], v[56:59]
  v_lshl_add_u32 v23, v24, 9, v23
  v_and_b32 v22, 0x30, v22
  v_mfma_f32_16x16x32_bf16 v[52:55], a[136:139], a[36:39], v[52:55]
  ds_read_b64_tr_b16 a[164:165], v1 offset:7296
  v_add_u32 v22, v22, v23
  v_mfma_f32_16x16x32_bf16 v[52:55], a[140:143], a[52:55], v[52:55]
  s_lshl3_add_u32 s76, s60, s58
  buffer_load_dwordx4 a[84:87], v0, s[36:39], s57 offen offset:1024 sc1
  s_lshr_b32 s77, s44, 1
  v_mfma_f32_16x16x32_bf16 v[48:51], a[140:143], a[48:51], v[48:51]
  s_lshl1_add_u32 s76, s76, s77
  ds_read_b64_tr_b16 a[166:167], v1 offset:10880
  s_and_b32 s77, s44, 1
  v_mfma_f32_16x16x32_bf16 v[48:51], a[136:139], a[32:35], v[48:51]
  s_waitcnt vmcnt(21) lgkmcnt(5)
  s_lshl2_add_u32 s76, s76, s77
  s_lshl_b32 s76, s76, 8
  v_mfma_f32_16x16x32_bf16 a[216:219], a[176:179], a[208:211], a[216:219]
  s_add_u32 s76, s76, 524288
  ds_read_b64_tr_b16 a[168:169], v1 offset:160
  v_mfma_f32_16x16x32_bf16 a[216:219], a[180:183], a[212:215], a[216:219]
  v_mfma_f32_16x16x32_bf16 a[220:223], a[184:187], a[208:211], a[220:223]
  ds_read_b64_tr_b16 a[170:171], v1 offset:3744
  v_mfma_f32_16x16x32_bf16 a[220:223], a[188:191], a[212:215], a[220:223]
  v_mfma_f32_16x16x32_bf16 a[224:227], a[192:195], a[208:211], a[224:227]
  buffer_load_dwordx4 v6, s[16:19], s56 offen offset:3072 lds
  v_mfma_f32_16x16x32_bf16 a[224:227], a[196:199], a[212:215], a[224:227]
  ds_read_b64_tr_b16 a[172:173], v1 offset:7328
  v_mfma_f32_16x16x32_bf16 a[228:231], a[200:203], a[208:211], a[228:231]
  ds_read_b64_tr_b16 a[174:175], v1 offset:10912
  v_mfma_f32_16x16x32_bf16 a[228:231], a[204:207], a[212:215], a[228:231]
  s_waitcnt lgkmcnt(8)
  v_mfma_f32_16x16x32_bf16 v[64:67], a[144:147], a[32:35], v[64:67]
  ds_read_b64_tr_b16 a[128:129], v1 offset:192
  v_mfma_f32_16x16x32_bf16 v[64:67], a[148:151], a[48:51], v[64:67]
  buffer_load_dwordx4 a[88:91], v0, s[36:39], s57 offen offset:2048 sc1
  v_mfma_f32_16x16x32_bf16 v[68:71], a[148:151], a[52:55], v[68:71]
  ds_read_b64_tr_b16 a[130:131], v1 offset:3776
  v_mfma_f32_16x16x32_bf16 v[68:71], a[144:147], a[36:39], v[68:71]
  s_add_u32 m0, s84, 61440
  v_mfma_f32_16x16x32_bf16 v[72:75], a[144:147], a[40:43], v[72:75]
  ds_read_b64_tr_b16 a[132:133], v1 offset:7360
  v_mfma_f32_16x16x32_bf16 v[72:75], a[148:151], a[56:59], v[72:75]
  v_mfma_f32_16x16x32_bf16 v[76:79], a[148:151], a[60:63], v[76:79]
  ds_read_b64_tr_b16 a[134:135], v1 offset:10944
  v_mfma_f32_16x16x32_bf16 v[76:79], a[144:147], a[44:47], v[76:79]
  buffer_load_dwordx4 v7, s[16:19], s56 offen offset:0 lds
  v_mfma_f32_16x16x32_bf16 v[92:95], a[152:155], a[44:47], v[92:95]
  ds_read_b64_tr_b16 a[136:137], v1 offset:14336
  v_mfma_f32_16x16x32_bf16 v[92:95], a[156:159], a[60:63], v[92:95]
  v_mfma_f32_16x16x32_bf16 v[88:91], a[156:159], a[56:59], v[88:91]
  ds_read_b64_tr_b16 a[138:139], v1 offset:17920
  v_mfma_f32_16x16x32_bf16 v[88:91], a[152:155], a[40:43], v[88:91]
  v_mfma_f32_16x16x32_bf16 v[84:87], a[152:155], a[36:39], v[84:87]
  buffer_load_dwordx4 a[92:95], v0, s[36:39], s57 offen offset:3072 sc1
  s_bfe_u32 s57, s83, 0x4000c
  v_mfma_f32_16x16x32_bf16 v[84:87], a[156:159], a[52:55], v[84:87]
  s_lshl_b32 s57, s57, 13
  s_add_u32 s57, s57, s85
  ds_read_b64_tr_b16 a[140:141], v1 offset:21504
  v_mfma_f32_16x16x32_bf16 v[80:83], a[156:159], a[48:51], v[80:83]
  ds_read_b64_tr_b16 a[142:143], v1 offset:25088
  v_mfma_f32_16x16x32_bf16 v[80:83], a[152:155], a[32:35], v[80:83]
  s_waitcnt lgkmcnt(8)
  v_mfma_f32_16x16x32_bf16 v[96:99], a[160:163], a[32:35], v[96:99]
  ds_read_b64_tr_b16 a[144:145], v1 offset:14368
  v_mfma_f32_16x16x32_bf16 v[96:99], a[164:167], a[48:51], v[96:99]
  buffer_load_dwordx4 a[96:99], v0, s[36:39], s57 offen offset:0 sc1
  v_mfma_f32_16x16x32_bf16 v[100:103], a[164:167], a[52:55], v[100:103]
  buffer_store_dwordx4 a[216:219], v22, s[36:39], s76 offen offset:0 sc1
  v_mfma_f32_16x16x32_bf16 v[100:103], a[160:163], a[36:39], v[100:103]
  ds_read_b64_tr_b16 a[146:147], v1 offset:17952
  v_mfma_f32_16x16x32_bf16 v[104:107], a[160:163], a[40:43], v[104:107]
  ds_read_b64_tr_b16 a[148:149], v1 offset:21536
  v_mfma_f32_16x16x32_bf16 v[104:107], a[164:167], a[56:59], v[104:107]
  v_mfma_f32_16x16x32_bf16 v[108:111], a[164:167], a[60:63], v[108:111]
  buffer_store_dwordx4 a[220:223], v22, s[36:39], s76 offen offset:64 sc1
  v_mfma_f32_16x16x32_bf16 v[108:111], a[160:163], a[44:47], v[108:111]
  ds_read_b64_tr_b16 a[150:151], v1 offset:25120
  v_mfma_f32_16x16x32_bf16 v[124:127], a[168:171], a[44:47], v[124:127]
  ds_read_b64_tr_b16 a[152:153], v1 offset:14400
  v_mfma_f32_16x16x32_bf16 v[124:127], a[172:175], a[60:63], v[124:127]
  v_mfma_f32_16x16x32_bf16 v[120:123], a[172:175], a[56:59], v[120:123]
  buffer_store_dwordx4 a[224:227], v22, s[36:39], s76 offen offset:128 sc1
  v_mfma_f32_16x16x32_bf16 v[120:123], a[168:171], a[40:43], v[120:123]
  ds_read_b64_tr_b16 a[154:155], v1 offset:17984
  v_mfma_f32_16x16x32_bf16 v[116:119], a[168:171], a[36:39], v[116:119]
  ds_read_b64_tr_b16 a[156:157], v1 offset:21568
  v_mfma_f32_16x16x32_bf16 v[116:119], a[172:175], a[52:55], v[116:119]
  v_mfma_f32_16x16x32_bf16 v[112:115], a[172:175], a[48:51], v[112:115]
  buffer_store_dwordx4 a[228:231], v22, s[36:39], s76 offen offset:192 sc1
  s_lshl_b32 s77, s60, 14
  v_mfma_f32_16x16x32_bf16 v[112:115], a[168:171], a[32:35], v[112:115]
  s_waitcnt lgkmcnt(7)
  ds_read_b64_tr_b16 a[158:159], v1 offset:25152
  s_lshl_b32 s78, s44, 9
  v_mfma_f32_16x16x32_bf16 v[128:131], a[128:131], a[32:35], v[128:131]
  s_add_u32 s77, s77, s78
  ds_read_b64_tr_b16 a[160:161], v1 offset:14432
  s_add_u32 s77, s77, 524288
  v_mfma_f32_16x16x32_bf16 v[128:131], a[132:135], a[48:51], v[128:131]
  s_lshr_b32 s78, s44, 1
  s_lshl_b32 s78, s78, 8
  s_and_b32 s65, s44, 1
  v_mfma_f32_16x16x32_bf16 v[132:135], a[132:135], a[52:55], v[132:135]
  s_add_u32 s78, s78, s65
  ds_read_b64_tr_b16 a[162:163], v1 offset:18016
  s_lshl3_add_u32 s78, s78, 159744
  v_mfma_f32_16x16x32_bf16 v[132:135], a[128:131], a[36:39], v[132:135]
  buffer_load_dwordx4 v8, s[16:19], s56 offen offset:1024 lds
  v_and_b32 v24, 0x1f0, v0
  v_mfma_f32_16x16x32_bf16 v[136:139], a[128:131], a[40:43], v[136:139]
  ds_read_b64_tr_b16 a[164:165], v1 offset:21600
  v_min_u32 v24, 432, v24
  v_mfma_f32_16x16x32_bf16 v[136:139], a[132:135], a[56:59], v[136:139]
  v_and_b32 v26, 0x200, v0
  v_lshl_add_u32 v25, v26, 4, v24
  v_mfma_f32_16x16x32_bf16 v[140:143], a[132:135], a[60:63], v[140:143]
  ds_read_b64_tr_b16 a[166:167], v1 offset:25184
  v_lshrrev_b32 v26, 4, v26
  v_mfma_f32_16x16x32_bf16 v[140:143], a[128:131], a[44:47], v[140:143]
  v_lshl_add_u32 v24, v24, 2, v26
  v_add_u32 v24, s78, v24
  v_mfma_f32_16x16x32_bf16 v[156:159], a[136:139], a[44:47], v[156:159]
  s_lshl2_add_u32 s65, s58, s44
  buffer_load_dwordx4 a[100:103], v0, s[36:39], s57 offen offset:1024 sc1
  s_lshl_b32 s65, s65, 19
  v_mfma_f32_16x16x32_bf16 v[156:159], a[140:143], a[60:63], v[156:159]
  s_mul_i32 s66, s60, 7
  ds_read_b64_tr_b16 a[168:169], v1 offset:14464
  s_and_b32 s78, s60, 1
  v_mfma_f32_16x16x32_bf16 v[152:155], a[140:143], a[56:59], v[152:155]
  s_add_u32 s66, s66, s78
  ds_read_b64_tr_b16 a[170:171], v1 offset:18048
  s_lshl_b32 s66, s66, 10
  v_mfma_f32_16x16x32_bf16 v[152:155], a[136:139], a[40:43], v[152:155]
  s_add_u32 s65, s65, s66
  s_add_u32 s67, s65, 19922944
  s_mul_i32 s78, s78, 7680
  v_mfma_f32_16x16x32_bf16 v[148:151], a[136:139], a[36:39], v[148:151]
  s_sub_u32 s65, s67, s78
  ds_read_b64_tr_b16 a[172:173], v1 offset:21632
  s_add_u32 s65, s65, 6144
  v_mfma_f32_16x16x32_bf16 v[148:151], a[140:143], a[52:55], v[148:151]
  s_add_u32 s66, s65, 262144
  buffer_load_dwordx4 v9, s[16:19], s56 offen offset:2048 lds
  s_lshl_b32 s45, s2, 7
  v_mfma_f32_16x16x32_bf16 v[144:147], a[140:143], a[48:51], v[144:147]
  s_add_u32 s45, s45, 5373952
  ds_read_b64_tr_b16 a[174:175], v1 offset:25216
  s_cmp_eq_u32 s44, 0
  v_mfma_f32_16x16x32_bf16 v[144:147], a[136:139], a[32:35], v[144:147]
  s_waitcnt lgkmcnt(8)
  s_cselect_b32 s45, s45, 1073741824
  s_add_u32 s76, s77, 4096
  v_mfma_f32_16x16x32_bf16 v[160:163], a[144:147], a[32:35], v[160:163]
  ds_read_b64_tr_b16 a[128:129], v1 offset:14496
  v_mfma_f32_16x16x32_bf16 v[160:163], a[148:151], a[48:51], v[160:163]
  v_mfma_f32_16x16x32_bf16 v[164:167], a[148:151], a[52:55], v[164:167]
  buffer_load_dwordx4 a[104:107], v0, s[36:39], s57 offen offset:2048 sc1
  v_mfma_f32_16x16x32_bf16 v[164:167], a[144:147], a[36:39], v[164:167]
  ds_read_b64_tr_b16 a[130:131], v1 offset:18080
  v_mfma_f32_16x16x32_bf16 v[168:171], a[144:147], a[40:43], v[168:171]
  ds_read_b64_tr_b16 a[132:133], v1 offset:21664
  v_mfma_f32_16x16x32_bf16 v[168:171], a[148:151], a[56:59], v[168:171]
  v_mfma_f32_16x16x32_bf16 v[172:175], a[148:151], a[60:63], v[172:175]
  ds_read_b64_tr_b16 a[134:135], v1 offset:25248
  v_mfma_f32_16x16x32_bf16 v[172:175], a[144:147], a[44:47], v[172:175]
  s_waitcnt vmcnt(20)
  s_barrier
  buffer_load_dwordx4 a[108:111], v0, s[36:39], s57 offen offset:3072 sc1
  s_bfe_u32 s56, s83, 0x30010
  v_mfma_f32_16x16x32_bf16 v[188:191], a[152:155], a[44:47], v[188:191]
  s_lshl_b32 s56, s56, 2
  s_bitcmp1_b32 s83, 19
  s_addc_u32 s56, s56, 0
  v_mfma_f32_16x16x32_bf16 v[188:191], a[156:159], a[60:63], v[188:191]
  s_mul_i32 s56, s56, 229376
  s_add_u32 m0, s84, 86016
  ds_read_b64_tr_b16 a[136:137], v1 offset:14528
  v_mfma_f32_16x16x32_bf16 v[184:187], a[156:159], a[56:59], v[184:187]
  ds_read_b64_tr_b16 a[138:139], v1 offset:18112
  v_mfma_f32_16x16x32_bf16 v[184:187], a[152:155], a[40:43], v[184:187]
  v_mfma_f32_16x16x32_bf16 v[180:183], a[152:155], a[36:39], v[180:183]
  buffer_load_dwordx4 v3, s[16:19], s56 offen offset:0 lds
  s_add_u32 s57, s57, 4096
  v_mfma_f32_16x16x32_bf16 v[180:183], a[156:159], a[52:55], v[180:183]
  ds_read_b64_tr_b16 a[140:141], v1 offset:21696
  v_mfma_f32_16x16x32_bf16 v[176:179], a[156:159], a[48:51], v[176:179]
  ds_read_b64_tr_b16 a[142:143], v1 offset:25280
  v_mfma_f32_16x16x32_bf16 v[176:179], a[152:155], a[32:35], v[176:179]
  s_waitcnt lgkmcnt(8)
  v_mfma_f32_16x16x32_bf16 v[192:195], a[160:163], a[32:35], v[192:195]
  ds_read_b64_tr_b16 a[144:145], v1 offset:28672
  v_mfma_f32_16x16x32_bf16 v[192:195], a[164:167], a[48:51], v[192:195]
  buffer_load_dwordx4 a[112:115], v0, s[36:39], s57 offen offset:0 sc1
  v_mfma_f32_16x16x32_bf16 v[196:199], a[164:167], a[52:55], v[196:199]
  ds_read_b64_tr_b16 a[146:147], v1 offset:32256
  v_mfma_f32_16x16x32_bf16 v[196:199], a[160:163], a[36:39], v[196:199]
  v_mfma_f32_16x16x32_bf16 v[200:203], a[160:163], a[40:43], v[200:203]
  ds_read_b64_tr_b16 a[148:149], v1 offset:35840
  v_mfma_f32_16x16x32_bf16 v[200:203], a[164:167], a[56:59], v[200:203]
  v_mfma_f32_16x16x32_bf16 v[204:207], a[164:167], a[60:63], v[204:207]
  buffer_load_dwordx4 v4, s[16:19], s56 offen offset:1024 lds
  v_mfma_f32_16x16x32_bf16 v[204:207], a[160:163], a[44:47], v[204:207]
  ds_read_b64_tr_b16 a[150:151], v1 offset:39424
  v_mfma_f32_16x16x32_bf16 v[220:223], a[168:171], a[44:47], v[220:223]
  ds_read_b64_tr_b16 a[152:153], v1 offset:28704
  v_mfma_f32_16x16x32_bf16 v[220:223], a[172:175], a[60:63], v[220:223]
  v_mfma_f32_16x16x32_bf16 v[216:219], a[172:175], a[56:59], v[216:219]
  ds_read_b64_tr_b16 a[154:155], v1 offset:32288
  v_mfma_f32_16x16x32_bf16 v[216:219], a[168:171], a[40:43], v[216:219]
  buffer_load_dwordx4 a[116:119], v0, s[36:39], s57 offen offset:1024 sc1
  v_mfma_f32_16x16x32_bf16 v[212:215], a[168:171], a[36:39], v[212:215]
  ds_read_b64_tr_b16 a[156:157], v1 offset:35872
  v_mfma_f32_16x16x32_bf16 v[212:215], a[172:175], a[52:55], v[212:215]
  v_mfma_f32_16x16x32_bf16 v[208:211], a[172:175], a[48:51], v[208:211]
  ds_read_b64_tr_b16 a[158:159], v1 offset:39456
  v_mfma_f32_16x16x32_bf16 v[208:211], a[168:171], a[32:35], v[208:211]
  s_waitcnt lgkmcnt(8)
  v_mfma_f32_16x16x32_bf16 v[224:227], a[128:131], a[32:35], v[224:227]
  buffer_load_dwordx4 a[120:123], v0, s[36:39], s57 offen offset:2048 sc1
  v_mfma_f32_16x16x32_bf16 v[224:227], a[132:135], a[48:51], v[224:227]
  ds_read_b64_tr_b16 a[160:161], v1 offset:28736
  v_mfma_f32_16x16x32_bf16 v[228:231], a[132:135], a[52:55], v[228:231]
  ds_read_b64_tr_b16 a[162:163], v1 offset:32320
  v_mfma_f32_16x16x32_bf16 v[228:231], a[128:131], a[36:39], v[228:231]
  v_mfma_f32_16x16x32_bf16 v[232:235], a[128:131], a[40:43], v[232:235]
  ds_read_b64_tr_b16 a[164:165], v1 offset:35904
  v_mfma_f32_16x16x32_bf16 v[232:235], a[132:135], a[56:59], v[232:235]
  buffer_load_dwordx4 v5, s[16:19], s56 offen offset:2048 lds
  v_mfma_f32_16x16x32_bf16 v[236:239], a[132:135], a[60:63], v[236:239]
  ds_read_b64_tr_b16 a[166:167], v1 offset:39488
  v_mfma_f32_16x16x32_bf16 v[236:239], a[128:131], a[44:47], v[236:239]
  v_mfma_f32_16x16x32_bf16 v[252:255], a[136:139], a[44:47], v[252:255]
  ds_read_b64_tr_b16 a[168:169], v1 offset:28768
  v_mfma_f32_16x16x32_bf16 v[252:255], a[140:143], a[60:63], v[252:255]
  v_mfma_f32_16x16x32_bf16 v[248:251], a[140:143], a[56:59], v[248:251]
  buffer_load_dwordx4 a[124:127], v0, s[36:39], s57 offen offset:3072 sc1
  v_mfma_f32_16x16x32_bf16 v[248:251], a[136:139], a[40:43], v[248:251]
  ds_read_b64_tr_b16 a[170:171], v1 offset:32352
  v_mfma_f32_16x16x32_bf16 v[244:247], a[136:139], a[36:39], v[244:247]
  ds_read_b64_tr_b16 a[172:173], v1 offset:35936
  v_mfma_f32_16x16x32_bf16 v[244:247], a[140:143], a[52:55], v[244:247]
  v_mfma_f32_16x16x32_bf16 v[240:243], a[140:143], a[48:51], v[240:243]
  ds_read_b64_tr_b16 a[174:175], v1 offset:39520
  v_mfma_f32_16x16x32_bf16 v[240:243], a[136:139], a[32:35], v[240:243]
  s_waitcnt vmcnt(17) lgkmcnt(8)
  buffer_load_dwordx4 v6, s[16:19], s56 offen offset:3072 lds
  s_bfe_u32 s57, s83, 0x40010
  v_mfma_f32_16x16x32_bf16 v[32:35], a[144:147], a[64:67], v[32:35]
  s_lshl_b32 s57, s57, 13
  s_add_u32 s57, s57, s85
  ds_read_b64_tr_b16 a[128:129], v1 offset:28800
  v_mfma_f32_16x16x32_bf16 v[32:35], a[148:151], a[80:83], v[32:35]
  s_barrier
  v_mfma_f32_16x16x32_bf16 v[36:39], a[148:151], a[84:87], v[36:39]
  ds_read_b64_tr_b16 a[130:131], v1 offset:32384
  v_mfma_f32_16x16x32_bf16 v[36:39], a[144:147], a[68:71], v[36:39]
  v_mfma_f32_16x16x32_bf16 v[40:43], a[144:147], a[72:75], v[40:43]
  buffer_load_dwordx4 a[0:3], v0, s[36:39], s57 offen offset:0 sc1
  v_mfma_f32_16x16x32_bf16 v[40:43], a[148:151], a[88:91], v[40:43]
  s_add_u32 m0, s84, 90112
  ds_read_b64_tr_b16 a[132:133], v1 offset:35968
  v_mfma_f32_16x16x32_bf16 v[44:47], a[148:151], a[92:95], v[44:47]
  ds_read_b64_tr_b16 a[134:135], v1 offset:39552
  v_mfma_f32_16x16x32_bf16 v[44:47], a[144:147], a[76:79], v[44:47]
  v_mfma_f32_16x16x32_bf16 v[60:63], a[152:155], a[76:79], v[60:63]
  ds_read_b64_tr_b16 a[136:137], v1 offset:28832
  v_mfma_f32_16x16x32_bf16 v[60:63], a[156:159], a[92:95], v[60:63]
  buffer_load_dwordx4 v7, s[16:19], s56 offen offset:0 lds
  v_mfma_f32_16x16x32_bf16 v[56:59], a[156:159], a[88:91], v[56:59]
  ds_read_b64_tr_b16 a[138:139], v1 offset:32416
  v_mfma_f32_16x16x32_bf16 v[56:59], a[152:155], a[72:75], v[56:59]
  v_mfma_f32_16x16x32_bf16 v[52:55], a[152:155], a[68:71], v[52:55]
  ds_read_b64_tr_b16 a[140:141], v1 offset:36000
  v_mfma_f32_16x16x32_bf16 v[52:55], a[156:159], a[84:87], v[52:55]
  v_mfma_f32_16x16x32_bf16 v[48:51], a[156:159], a[80:83], v[48:51]
  buffer_load_dwordx4 a[4:7], v0, s[36:39], s57 offen offset:1024 sc1
  v_mfma_f32_16x16x32_bf16 v[48:51], a[152:155], a[64:67], v[48:51]
  s_waitcnt lgkmcnt(7)
  ds_read_b64_tr_b16 a[142:143], v1 offset:39584
  v_mfma_f32_16x16x32_bf16 v[64:67], a[160:163], a[64:67], v[64:67]
  ds_read_b64_tr_b16 a[144:145], v1 offset:28864
  v_mfma_f32_16x16x32_bf16 v[64:67], a[164:167], a[80:83], v[64:67]
  v_mfma_f32_16x16x32_bf16 v[68:71], a[164:167], a[84:87], v[68:71]
  ds_read_b64_tr_b16 a[146:147], v1 offset:32448
  v_mfma_f32_16x16x32_bf16 v[68:71], a[160:163], a[68:71], v[68:71]
  v_mfma_f32_16x16x32_bf16 v[72:75], a[160:163], a[72:75], v[72:75]
  buffer_load_dwordx4 a[8:11], v0, s[36:39], s57 offen offset:2048 sc1
  v_mfma_f32_16x16x32_bf16 v[72:75], a[164:167], a[88:91], v[72:75]
  ds_read_b64_tr_b16 a[148:149], v1 offset:36032
  v_mfma_f32_16x16x32_bf16 v[76:79], a[164:167], a[92:95], v[76:79]
  ds_read_b64_tr_b16 a[150:151], v1 offset:39616
  v_mfma_f32_16x16x32_bf16 v[76:79], a[160:163], a[76:79], v[76:79]
  v_mfma_f32_16x16x32_bf16 v[92:95], a[168:171], a[76:79], v[92:95]
  ds_read_b64_tr_b16 a[152:153], v1 offset:43008
  v_mfma_f32_16x16x32_bf16 v[92:95], a[172:175], a[92:95], v[92:95]
  buffer_load_dwordx4 v8, s[16:19], s56 offen offset:1024 lds
  v_mfma_f32_16x16x32_bf16 v[88:91], a[172:175], a[88:91], v[88:91]
  ds_read_b64_tr_b16 a[154:155], v1 offset:46592
  v_mfma_f32_16x16x32_bf16 v[88:91], a[168:171], a[72:75], v[88:91]
  v_mfma_f32_16x16x32_bf16 v[84:87], a[168:171], a[68:71], v[84:87]
  ds_read_b64_tr_b16 a[156:157], v1 offset:50176
  v_mfma_f32_16x16x32_bf16 v[84:87], a[172:175], a[84:87], v[84:87]
  v_mfma_f32_16x16x32_bf16 v[80:83], a[172:175], a[80:83], v[80:83]
  buffer_load_dwordx4 a[12:15], v0, s[36:39], s57 offen offset:3072 sc1
  v_mfma_f32_16x16x32_bf16 v[80:83], a[168:171], a[64:67], v[80:83]
  s_waitcnt lgkmcnt(7)
  ds_read_b64_tr_b16 a[158:159], v1 offset:53760
  v_mfma_f32_16x16x32_bf16 v[96:99], a[128:131], a[64:67], v[96:99]
  ds_read_b64_tr_b16 a[160:161], v1 offset:43040
  v_mfma_f32_16x16x32_bf16 v[96:99], a[132:135], a[80:83], v[96:99]
  v_mfma_f32_16x16x32_bf16 v[100:103], a[132:135], a[84:87], v[100:103]
  ds_read_b64_tr_b16 a[162:163], v1 offset:46624
  v_mfma_f32_16x16x32_bf16 v[100:103], a[128:131], a[68:71], v[100:103]
  buffer_load_dwordx4 v9, s[16:19], s56 offen offset:2048 lds
  v_mfma_f32_16x16x32_bf16 v[104:107], a[128:131], a[72:75], v[104:107]
  s_add_u32 s57, s57, 4096
  ds_read_b64_tr_b16 a[164:165], v1 offset:50208
  v_mfma_f32_16x16x32_bf16 v[104:107], a[132:135], a[88:91], v[104:107]
  v_mfma_f32_16x16x32_bf16 v[108:111], a[132:135], a[92:95], v[108:111]
  ds_read_b64_tr_b16 a[166:167], v1 offset:53792
  v_mfma_f32_16x16x32_bf16 v[108:111], a[128:131], a[76:79], v[108:111]
  v_mfma_f32_16x16x32_bf16 v[124:127], a[136:139], a[76:79], v[124:127]
  buffer_load_dwordx4 a[16:19], v0, s[36:39], s57 offen offset:0 sc1
  v_mfma_f32_16x16x32_bf16 v[124:127], a[140:143], a[92:95], v[124:127]
  ds_read_b64_tr_b16 a[168:169], v1 offset:43072
  v_mfma_f32_16x16x32_bf16 v[120:123], a[140:143], a[88:91], v[120:123]
  ds_read_b64_tr_b16 a[170:171], v1 offset:46656
  v_mfma_f32_16x16x32_bf16 v[120:123], a[136:139], a[72:75], v[120:123]
  v_mfma_f32_16x16x32_bf16 v[116:119], a[136:139], a[68:71], v[116:119]
  ds_read_b64_tr_b16 a[172:173], v1 offset:50240
  v_mfma_f32_16x16x32_bf16 v[116:119], a[140:143], a[84:87], v[116:119]
  v_mfma_f32_16x16x32_bf16 v[112:115], a[140:143], a[80:83], v[112:115]
  ds_read_b64_tr_b16 a[174:175], v1 offset:53824
  v_mfma_f32_16x16x32_bf16 v[112:115], a[136:139], a[64:67], v[112:115]
  s_waitcnt lgkmcnt(8)
  v_mfma_f32_16x16x32_bf16 v[128:131], a[144:147], a[64:67], v[128:131]
  ds_read_b64_tr_b16 a[128:129], v1 offset:43104
  v_mfma_f32_16x16x32_bf16 v[128:131], a[148:151], a[80:83], v[128:131]
  v_mfma_f32_16x16x32_bf16 v[132:135], a[148:151], a[84:87], v[132:135]
  buffer_load_dwordx4 a[20:23], v0, s[36:39], s57 offen offset:1024 sc1
  s_bfe_u32 s56, s83, 0x30014
  v_mfma_f32_16x16x32_bf16 v[132:135], a[144:147], a[68:71], v[132:135]
  s_lshl_b32 s56, s56, 2
  s_bitcmp1_b32 s83, 23
  s_addc_u32 s56, s56, 0
  v_mfma_f32_16x16x32_bf16 v[136:139], a[144:147], a[72:75], v[136:139]
  s_mul_i32 s56, s56, 229376
  s_add_u32 m0, s84, 0
  ds_read_b64_tr_b16 a[130:131], v1 offset:46688
  v_mfma_f32_16x16x32_bf16 v[136:139], a[148:151], a[88:91], v[136:139]
  ds_read_b64_tr_b16 a[132:133], v1 offset:50272
  v_mfma_f32_16x16x32_bf16 v[140:143], a[148:151], a[92:95], v[140:143]
  ds_read_b64_tr_b16 a[134:135], v1 offset:53856
  v_mfma_f32_16x16x32_bf16 v[140:143], a[144:147], a[76:79], v[140:143]
  buffer_load_dwordx4 v3, s[16:19], s56 offen offset:0 lds
  v_mfma_f32_16x16x32_bf16 v[156:159], a[152:155], a[76:79], v[156:159]
  ds_read_b64_tr_b16 a[136:137], v1 offset:43136
  v_mfma_f32_16x16x32_bf16 v[156:159], a[156:159], a[92:95], v[156:159]
  v_mfma_f32_16x16x32_bf16 v[152:155], a[156:159], a[88:91], v[152:155]
  ds_read_b64_tr_b16 a[138:139], v1 offset:46720
  v_mfma_f32_16x16x32_bf16 v[152:155], a[152:155], a[72:75], v[152:155]
Hc1_1:
  s_cbranch_execz Hc1_2
  v_mfma_f32_16x16x32_bf16 v[148:151], a[152:155], a[68:71], v[148:151]
  buffer_load_dwordx4 a[24:27], v0, s[36:39], s57 offen offset:2048 sc1
  v_mfma_f32_16x16x32_bf16 v[148:151], a[156:159], a[84:87], v[148:151]
  ds_read_b64_tr_b16 a[140:141], v1 offset:50304
  v_mfma_f32_16x16x32_bf16 v[144:147], a[156:159], a[80:83], v[144:147]
  ds_read_b64_tr_b16 a[142:143], v1 offset:53888
  v_mfma_f32_16x16x32_bf16 v[144:147], a[152:155], a[64:67], v[144:147]
  s_waitcnt lgkmcnt(8)
  v_mfma_f32_16x16x32_bf16 v[160:163], a[160:163], a[64:67], v[160:163]
  ds_read_b64_tr_b16 a[144:145], v1 offset:43168
  v_mfma_f32_16x16x32_bf16 v[160:163], a[164:167], a[80:83], v[160:163]
  buffer_load_dwordx4 v4, s[16:19], s56 offen offset:1024 lds
  v_mfma_f32_16x16x32_bf16 v[164:167], a[164:167], a[84:87], v[164:167]
  ds_read_b64_tr_b16 a[146:147], v1 offset:46752
  v_mfma_f32_16x16x32_bf16 v[164:167], a[160:163], a[68:71], v[164:167]
  v_mfma_f32_16x16x32_bf16 v[168:171], a[160:163], a[72:75], v[168:171]
  ds_read_b64_tr_b16 a[148:149], v1 offset:50336
  v_mfma_f32_16x16x32_bf16 v[168:171], a[164:167], a[88:91], v[168:171]
  v_mfma_f32_16x16x32_bf16 v[172:175], a[164:167], a[92:95], v[172:175]
  buffer_load_dwordx4 a[28:31], v0, s[36:39], s57 offen offset:3072 sc1
  v_mfma_f32_16x16x32_bf16 v[172:175], a[160:163], a[76:79], v[172:175]
  s_waitcnt vmcnt(23)
  s_barrier
  ds_read_b64_tr_b16 a[150:151], v1 offset:53920
  v_mfma_f32_16x16x32_bf16 v[188:191], a[168:171], a[76:79], v[188:191]
  ds_read_b64_tr_b16 a[152:153], v1 offset:43200
  v_mfma_f32_16x16x32_bf16 v[188:191], a[172:175], a[92:95], v[188:191]
  v_mfma_f32_16x16x32_bf16 v[184:187], a[172:175], a[88:91], v[184:187]
  ds_read_b64_tr_b16 a[154:155], v1 offset:46784
  v_mfma_f32_16x16x32_bf16 v[184:187], a[168:171], a[72:75], v[184:187]
  buffer_load_dwordx4 v5, s[16:19], s56 offen offset:2048 lds
  s_bfe_u32 s57, s83, 0x40014
  v_mfma_f32_16x16x32_bf16 v[180:183], a[168:171], a[68:71], v[180:183]
  s_lshl_b32 s57, s57, 13
  s_add_u32 s57, s57, s85
  ds_read_b64_tr_b16 a[156:157], v1 offset:50368
  v_mfma_f32_16x16x32_bf16 v[180:183], a[172:175], a[84:87], v[180:183]
  v_mfma_f32_16x16x32_bf16 v[176:179], a[172:175], a[80:83], v[176:179]
  ds_read_b64_tr_b16 a[158:159], v1 offset:53952
  v_mfma_f32_16x16x32_bf16 v[176:179], a[168:171], a[64:67], v[176:179]
  s_waitcnt lgkmcnt(8)
  v_mfma_f32_16x16x32_bf16 v[192:195], a[128:131], a[64:67], v[192:195]
  buffer_load_dwordx4 a[32:35], v0, s[36:39], s57 offen offset:0 sc1
  v_mfma_f32_16x16x32_bf16 v[192:195], a[132:135], a[80:83], v[192:195]
  ds_read_b64_tr_b16 a[160:161], v2 offset:0
  v_mfma_f32_16x16x32_bf16 v[196:199], a[132:135], a[84:87], v[196:199]
  ds_read_b64_tr_b16 a[162:163], v2 offset:3584
  v_mfma_f32_16x16x32_bf16 v[196:199], a[128:131], a[68:71], v[196:199]
  v_mfma_f32_16x16x32_bf16 v[200:203], a[128:131], a[72:75], v[200:203]
  ds_read_b64_tr_b16 a[164:165], v2 offset:7168
  v_mfma_f32_16x16x32_bf16 v[200:203], a[132:135], a[88:91], v[200:203]
  buffer_load_dwordx4 a[36:39], v0, s[36:39], s57 offen offset:1024 sc1
  v_mfma_f32_16x16x32_bf16 v[204:207], a[132:135], a[92:95], v[204:207]
  ds_read_b64_tr_b16 a[166:167], v2 offset:10752
  v_mfma_f32_16x16x32_bf16 v[204:207], a[128:131], a[76:79], v[204:207]
  v_mfma_f32_16x16x32_bf16 v[220:223], a[136:139], a[76:79], v[220:223]
  ds_read_b64_tr_b16 a[168:169], v2 offset:32
  v_mfma_f32_16x16x32_bf16 v[220:223], a[140:143], a[92:95], v[220:223]
  v_mfma_f32_16x16x32_bf16 v[216:219], a[140:143], a[88:91], v[216:219]
  buffer_load_dwordx4 v6, s[16:19], s56 offen offset:3072 lds
  v_mfma_f32_16x16x32_bf16 v[216:219], a[136:139], a[72:75], v[216:219]
  ds_read_b64_tr_b16 a[170:171], v2 offset:3616
  v_mfma_f32_16x16x32_bf16 v[212:215], a[136:139], a[68:71], v[212:215]
  ds_read_b64_tr_b16 a[172:173], v2 offset:7200
  v_mfma_f32_16x16x32_bf16 v[212:215], a[140:143], a[84:87], v[212:215]
  v_mfma_f32_16x16x32_bf16 v[208:211], a[140:143], a[80:83], v[208:211]
  ds_read_b64_tr_b16 a[174:175], v2 offset:10784
  v_mfma_f32_16x16x32_bf16 v[208:211], a[136:139], a[64:67], v[208:211]
  s_waitcnt lgkmcnt(8)
  buffer_load_dwordx4 a[40:43], v0, s[36:39], s57 offen offset:2048 sc1
  s_add_u32 m0, s84, 4096
  v_mfma_f32_16x16x32_bf16 v[224:227], a[144:147], a[64:67], v[224:227]
  ds_read_b64_tr_b16 a[128:129], v2 offset:64
  v_mfma_f32_16x16x32_bf16 v[224:227], a[148:151], a[80:83], v[224:227]
  v_mfma_f32_16x16x32_bf16 v[228:231], a[148:151], a[84:87], v[228:231]
  ds_read_b64_tr_b16 a[130:131], v2 offset:3648
  v_mfma_f32_16x16x32_bf16 v[228:231], a[144:147], a[68:71], v[228:231]
  v_mfma_f32_16x16x32_bf16 v[232:235], a[144:147], a[72:75], v[232:235]
  buffer_load_dwordx4 v7, s[16:19], s56 offen offset:0 lds
  v_mfma_f32_16x16x32_bf16 v[232:235], a[148:151], a[88:91], v[232:235]
  ds_read_b64_tr_b16 a[132:133], v2 offset:7232
  v_mfma_f32_16x16x32_bf16 v[236:239], a[148:151], a[92:95], v[236:239]
  ds_read_b64_tr_b16 a[134:135], v2 offset:10816
  v_mfma_f32_16x16x32_bf16 v[236:239], a[144:147], a[76:79], v[236:239]
  v_mfma_f32_16x16x32_bf16 v[252:255], a[152:155], a[76:79], v[252:255]
  ds_read_b64_tr_b16 a[136:137], v2 offset:96
  v_mfma_f32_16x16x32_bf16 v[252:255], a[156:159], a[92:95], v[252:255]
  buffer_load_dwordx4 a[44:47], v0, s[36:39], s57 offen offset:3072 sc1
  v_mfma_f32_16x16x32_bf16 v[248:251], a[156:159], a[88:91], v[248:251]
  ds_read_b64_tr_b16 a[138:139], v2 offset:3680
  v_mfma_f32_16x16x32_bf16 v[248:251], a[152:155], a[72:75], v[248:251]
  v_mfma_f32_16x16x32_bf16 v[244:247], a[152:155], a[68:71], v[244:247]
  ds_read_b64_tr_b16 a[140:141], v2 offset:7264
  v_mfma_f32_16x16x32_bf16 v[244:247], a[156:159], a[84:87], v[244:247]
  v_mfma_f32_16x16x32_bf16 v[240:243], a[156:159], a[80:83], v[240:243]
  ds_read_b64_tr_b16 a[142:143], v2 offset:10848
  v_mfma_f32_16x16x32_bf16 v[240:243], a[152:155], a[64:67], v[240:243]
  s_waitcnt vmcnt(21) lgkmcnt(8)
  buffer_load_dwordx4 v8, s[16:19], s56 offen offset:1024 lds
  s_add_u32 s57, s57, 4096
  v_mfma_f32_16x16x32_bf16 v[32:35], a[160:163], a[96:99], v[32:35]
  ds_read_b64_tr_b16 a[144:145], v2 offset:128
  v_mfma_f32_16x16x32_bf16 v[32:35], a[164:167], a[112:115], v[32:35]
  s_barrier
  v_mfma_f32_16x16x32_bf16 v[36:39], a[164:167], a[116:119], v[36:39]
  ds_read_b64_tr_b16 a[146:147], v2 offset:3712
  v_mfma_f32_16x16x32_bf16 v[36:39], a[160:163], a[100:103], v[36:39]
  v_mfma_f32_16x16x32_bf16 v[40:43], a[160:163], a[104:107], v[40:43]
  buffer_load_dwordx4 a[48:51], v0, s[36:39], s57 offen offset:0 sc1
  v_mfma_f32_16x16x32_bf16 v[40:43], a[164:167], a[120:123], v[40:43]
  ds_read_b64_tr_b16 a[148:149], v2 offset:7296
  v_mfma_f32_16x16x32_bf16 v[44:47], a[164:167], a[124:127], v[44:47]
  ds_read_b64_tr_b16 a[150:151], v2 offset:10880
  v_mfma_f32_16x16x32_bf16 v[44:47], a[160:163], a[108:111], v[44:47]
  v_mfma_f32_16x16x32_bf16 v[60:63], a[168:171], a[108:111], v[60:63]
  ds_read_b64_tr_b16 a[152:153], v2 offset:160
  v_mfma_f32_16x16x32_bf16 v[60:63], a[172:175], a[124:127], v[60:63]
  v_mfma_f32_16x16x32_bf16 v[56:59], a[172:175], a[120:123], v[56:59]
  ds_read_b64_tr_b16 a[154:155], v2 offset:3744
  v_mfma_f32_16x16x32_bf16 v[56:59], a[168:171], a[104:107], v[56:59]
  buffer_load_dwordx4 v9, s[16:19], s56 offen offset:2048 lds
  v_mfma_f32_16x16x32_bf16 v[52:55], a[168:171], a[100:103], v[52:55]
  ds_read_b64_tr_b16 a[156:157], v2 offset:7328
  v_mfma_f32_16x16x32_bf16 v[52:55], a[172:175], a[116:119], v[52:55]
  v_mfma_f32_16x16x32_bf16 v[48:51], a[172:175], a[112:115], v[48:51]
  ds_read_b64_tr_b16 a[158:159], v2 offset:10912
  v_mfma_f32_16x16x32_bf16 v[48:51], a[168:171], a[96:99], v[48:51]
  s_waitcnt lgkmcnt(8)
  v_mfma_f32_16x16x32_bf16 v[64:67], a[128:131], a[96:99], v[64:67]
  buffer_load_dwordx4 a[52:55], v0, s[36:39], s57 offen offset:1024 sc1
  v_mfma_f32_16x16x32_bf16 v[64:67], a[132:135], a[112:115], v[64:67]
  ds_read_b64_tr_b16 a[160:161], v2 offset:192
  v_mfma_f32_16x16x32_bf16 v[68:71], a[132:135], a[116:119], v[68:71]
  ds_read_b64_tr_b16 a[162:163], v2 offset:3776
  v_mfma_f32_16x16x32_bf16 v[68:71], a[128:131], a[100:103], v[68:71]
  v_mfma_f32_16x16x32_bf16 v[72:75], a[128:131], a[104:107], v[72:75]
  ds_read_b64_tr_b16 a[164:165], v2 offset:7360
  v_mfma_f32_16x16x32_bf16 v[72:75], a[132:135], a[120:123], v[72:75]
  v_mfma_f32_16x16x32_bf16 v[76:79], a[132:135], a[124:127], v[76:79]
  buffer_load_dwordx4 a[56:59], v0, s[36:39], s57 offen offset:2048 sc1
  v_mfma_f32_16x16x32_bf16 v[76:79], a[128:131], a[108:111], v[76:79]
  ds_read_b64_tr_b16 a[166:167], v2 offset:10944
  v_mfma_f32_16x16x32_bf16 v[92:95], a[136:139], a[108:111], v[92:95]
  s_bfe_u32 s56, s83, 0x30018
  s_lshl_b32 s56, s56, 2
  s_bitcmp1_b32 s83, 27
  v_mfma_f32_16x16x32_bf16 v[92:95], a[140:143], a[124:127], v[92:95]
  s_addc_u32 s56, s56, 0
  s_mul_i32 s56, s56, 229376
  s_add_u32 m0, s84, 28672
  v_mfma_f32_16x16x32_bf16 v[88:91], a[140:143], a[120:123], v[88:91]
  ds_read_b64_tr_b16 a[168:169], v2 offset:14336
  v_mfma_f32_16x16x32_bf16 v[88:91], a[136:139], a[104:107], v[88:91]
  ds_read_b64_tr_b16 a[170:171], v2 offset:17920
  v_mfma_f32_16x16x32_bf16 v[84:87], a[136:139], a[100:103], v[84:87]
  buffer_load_dwordx4 v3, s[16:19], s56 offen offset:0 lds
  v_mfma_f32_16x16x32_bf16 v[84:87], a[140:143], a[116:119], v[84:87]
  ds_read_b64_tr_b16 a[172:173], v2 offset:21504
  v_mfma_f32_16x16x32_bf16 v[80:83], a[140:143], a[112:115], v[80:83]
  ds_read_b64_tr_b16 a[174:175], v2 offset:25088
  v_mfma_f32_16x16x32_bf16 v[80:83], a[136:139], a[96:99], v[80:83]
  s_waitcnt lgkmcnt(8)
  v_mfma_f32_16x16x32_bf16 v[96:99], a[144:147], a[96:99], v[96:99]
  ds_read_b64_tr_b16 a[128:129], v2 offset:14368
  v_mfma_f32_16x16x32_bf16 v[96:99], a[148:151], a[112:115], v[96:99]
  buffer_load_dwordx4 a[60:63], v0, s[36:39], s57 offen offset:3072 sc1
  s_bfe_u32 s57, s83, 0x40018
  v_mfma_f32_16x16x32_bf16 v[100:103], a[148:151], a[116:119], v[100:103]
  s_lshl_b32 s57, s57, 13
  s_add_u32 s57, s57, s85
  ds_read_b64_tr_b16 a[130:131], v2 offset:17952
  v_mfma_f32_16x16x32_bf16 v[100:103], a[144:147], a[100:103], v[100:103]
  v_mfma_f32_16x16x32_bf16 v[104:107], a[144:147], a[104:107], v[104:107]
  buffer_load_dwordx4 a[208:211], v25, s[36:39], s77 offen offset:0 sc1
  v_mfma_f32_16x16x32_bf16 v[104:107], a[148:151], a[120:123], v[104:107]
  ds_read_b64_tr_b16 a[132:133], v2 offset:21536
  v_mfma_f32_16x16x32_bf16 v[108:111], a[148:151], a[124:127], v[108:111]
  ds_read_b64_tr_b16 a[134:135], v2 offset:25120
  v_mfma_f32_16x16x32_bf16 v[108:111], a[144:147], a[108:111], v[108:111]
  v_mfma_f32_16x16x32_bf16 v[124:127], a[152:155], a[108:111], v[124:127]
  ds_read_b64_tr_b16 a[136:137], v2 offset:14400
  v_mfma_f32_16x16x32_bf16 v[124:127], a[156:159], a[124:127], v[124:127]
  buffer_load_dwordx4 a[212:215], v25, s[36:39], s77 offen offset:2048 sc1
  v_mfma_f32_16x16x32_bf16 v[120:123], a[156:159], a[120:123], v[120:123]
  ds_read_b64_tr_b16 a[138:139], v2 offset:17984
  v_mfma_f32_16x16x32_bf16 v[120:123], a[152:155], a[104:107], v[120:123]
  v_mfma_f32_16x16x32_bf16 v[116:119], a[152:155], a[100:103], v[116:119]
  ds_read_b64_tr_b16 a[140:141], v2 offset:21568
  v_mfma_f32_16x16x32_bf16 v[116:119], a[156:159], a[116:119], v[116:119]
  v_mfma_f32_16x16x32_bf16 v[112:115], a[156:159], a[112:115], v[112:115]
  buffer_load_dwordx4 a[216:219], v25, s[36:39], s76 offen offset:0 sc1
  v_mfma_f32_16x16x32_bf16 v[112:115], a[152:155], a[96:99], v[112:115]
  s_waitcnt lgkmcnt(7)
  ds_read_b64_tr_b16 a[142:143], v2 offset:25152
  v_mfma_f32_16x16x32_bf16 v[128:131], a[160:163], a[96:99], v[128:131]
  ds_read_b64_tr_b16 a[144:145], v2 offset:14432
  v_mfma_f32_16x16x32_bf16 v[128:131], a[164:167], a[112:115], v[128:131]
  v_mfma_f32_16x16x32_bf16 v[132:135], a[164:167], a[116:119], v[132:135]
  ds_read_b64_tr_b16 a[146:147], v2 offset:18016
  v_mfma_f32_16x16x32_bf16 v[132:135], a[160:163], a[100:103], v[132:135]
  buffer_load_dwordx4 a[220:223], v25, s[36:39], s76 offen offset:2048 sc1
  v_mfma_f32_16x16x32_bf16 v[136:139], a[160:163], a[104:107], v[136:139]
  ds_read_b64_tr_b16 a[148:149], v2 offset:21600
  v_mfma_f32_16x16x32_bf16 v[136:139], a[164:167], a[120:123], v[136:139]
  v_mfma_f32_16x16x32_bf16 v[140:143], a[164:167], a[124:127], v[140:143]
  ds_read_b64_tr_b16 a[150:151], v2 offset:25184
  v_mfma_f32_16x16x32_bf16 v[140:143], a[160:163], a[108:111], v[140:143]
  v_mfma_f32_16x16x32_bf16 v[156:159], a[168:171], a[108:111], v[156:159]
  buffer_load_dwordx4 a[64:67], v0, s[36:39], s57 offen offset:0 sc1
  v_mfma_f32_16x16x32_bf16 v[156:159], a[172:175], a[124:127], v[156:159]
  ds_read_b64_tr_b16 a[152:153], v2 offset:14464
  v_mfma_f32_16x16x32_bf16 v[152:155], a[172:175], a[120:123], v[152:155]
  ds_read_b64_tr_b16 a[154:155], v2 offset:18048
  v_mfma_f32_16x16x32_bf16 v[152:155], a[168:171], a[104:107], v[152:155]
  v_mfma_f32_16x16x32_bf16 v[148:151], a[168:171], a[100:103], v[148:151]
  ds_read_b64_tr_b16 a[156:157], v2 offset:21632
  v_mfma_f32_16x16x32_bf16 v[148:151], a[172:175], a[116:119], v[148:151]
  buffer_load_dwordx4 v4, s[16:19], s56 offen offset:1024 lds
  v_mfma_f32_16x16x32_bf16 v[144:147], a[172:175], a[112:115], v[144:147]
  ds_read_b64_tr_b16 a[158:159], v2 offset:25216
  v_mfma_f32_16x16x32_bf16 v[144:147], a[168:171], a[96:99], v[144:147]
  s_waitcnt lgkmcnt(8)
  v_mfma_f32_16x16x32_bf16 v[160:163], a[128:131], a[96:99], v[160:163]
  ds_read_b64_tr_b16 a[160:161], v2 offset:14496
  v_mfma_f32_16x16x32_bf16 v[160:163], a[132:135], a[112:115], v[160:163]
  v_mfma_f32_16x16x32_bf16 v[164:167], a[132:135], a[116:119], v[164:167]
  buffer_load_dwordx4 a[68:71], v0, s[36:39], s57 offen offset:1024 sc1
  v_mfma_f32_16x16x32_bf16 v[164:167], a[128:131], a[100:103], v[164:167]
  ds_read_b64_tr_b16 a[162:163], v2 offset:18080
  v_mfma_f32_16x16x32_bf16 v[168:171], a[128:131], a[104:107], v[168:171]
  ds_read_b64_tr_b16 a[164:165], v2 offset:21664
  v_mfma_f32_16x16x32_bf16 v[168:171], a[132:135], a[120:123], v[168:171]
  v_mfma_f32_16x16x32_bf16 v[172:175], a[132:135], a[124:127], v[172:175]
  ds_read_b64_tr_b16 a[166:167], v2 offset:25248
  v_mfma_f32_16x16x32_bf16 v[172:175], a[128:131], a[108:111], v[172:175]
  s_waitcnt vmcnt(27)
  s_barrier
  buffer_load_dwordx4 v5, s[16:19], s56 offen offset:2048 lds
  v_mfma_f32_16x16x32_bf16 v[188:191], a[136:139], a[108:111], v[188:191]
  ds_read_b64_tr_b16 a[168:169], v2 offset:14528
  v_mfma_f32_16x16x32_bf16 v[188:191], a[140:143], a[124:127], v[188:191]
  v_mfma_f32_16x16x32_bf16 v[184:187], a[140:143], a[120:123], v[184:187]
  ds_read_b64_tr_b16 a[170:171], v2 offset:18112
  v_mfma_f32_16x16x32_bf16 v[184:187], a[136:139], a[104:107], v[184:187]
  v_mfma_f32_16x16x32_bf16 v[180:183], a[136:139], a[100:103], v[180:183]
  buffer_load_dwordx4 a[72:75], v0, s[36:39], s57 offen offset:2048 sc1
  v_mfma_f32_16x16x32_bf16 v[180:183], a[140:143], a[116:119], v[180:183]
  ds_read_b64_tr_b16 a[172:173], v2 offset:21696
  v_mfma_f32_16x16x32_bf16 v[176:179], a[140:143], a[112:115], v[176:179]
  ds_read_b64_tr_b16 a[174:175], v2 offset:25280
  v_mfma_f32_16x16x32_bf16 v[176:179], a[136:139], a[96:99], v[176:179]
  s_waitcnt lgkmcnt(8)
  v_mfma_f32_16x16x32_bf16 v[192:195], a[144:147], a[96:99], v[192:195]
  ds_read_b64_tr_b16 a[128:129], v2 offset:28672
  v_mfma_f32_16x16x32_bf16 v[192:195], a[148:151], a[112:115], v[192:195]
  buffer_load_dwordx4 v6, s[16:19], s56 offen offset:3072 lds
  v_mfma_f32_16x16x32_bf16 v[196:199], a[148:151], a[116:119], v[196:199]
  ds_read_b64_tr_b16 a[130:131], v2 offset:32256
  v_mfma_f32_16x16x32_bf16 v[196:199], a[144:147], a[100:103], v[196:199]
  v_mfma_f32_16x16x32_bf16 v[200:203], a[144:147], a[104:107], v[200:203]
  ds_read_b64_tr_b16 a[132:133], v2 offset:35840
  v_mfma_f32_16x16x32_bf16 v[200:203], a[148:151], a[120:123], v[200:203]
  v_mfma_f32_16x16x32_bf16 v[204:207], a[148:151], a[124:127], v[204:207]
  buffer_load_dwordx4 a[76:79], v0, s[36:39], s57 offen offset:3072 sc1
  s_add_u32 m0, s84, 32768
  v_mfma_f32_16x16x32_bf16 v[204:207], a[144:147], a[108:111], v[204:207]
  ds_read_b64_tr_b16 a[134:135], v2 offset:39424
  v_mfma_f32_16x16x32_bf16 v[220:223], a[152:155], a[108:111], v[220:223]
  ds_read_b64_tr_b16 a[136:137], v2 offset:28704
  v_mfma_f32_16x16x32_bf16 v[220:223], a[156:159], a[124:127], v[220:223]
  v_mfma_f32_16x16x32_bf16 v[216:219], a[156:159], a[120:123], v[216:219]
  ds_read_b64_tr_b16 a[138:139], v2 offset:32288
  v_mfma_f32_16x16x32_bf16 v[216:219], a[152:155], a[104:107], v[216:219]
  buffer_load_dwordx4 v7, s[16:19], s56 offen offset:0 lds
  s_add_u32 s57, s57, 4096
  v_mfma_f32_16x16x32_bf16 v[212:215], a[152:155], a[100:103], v[212:215]
  ds_read_b64_tr_b16 a[140:141], v2 offset:35872
  v_mfma_f32_16x16x32_bf16 v[212:215], a[156:159], a[116:119], v[212:215]
  v_mfma_f32_16x16x32_bf16 v[208:211], a[156:159], a[112:115], v[208:211]
  ds_read_b64_tr_b16 a[142:143], v2 offset:39456
  v_mfma_f32_16x16x32_bf16 v[208:211], a[152:155], a[96:99], v[208:211]
  s_waitcnt lgkmcnt(8)
  v_mfma_f32_16x16x32_bf16 v[224:227], a[160:163], a[96:99], v[224:227]
  buffer_load_dwordx4 a[80:83], v0, s[36:39], s57 offen offset:0 sc1
  v_mfma_f32_16x16x32_bf16 v[224:227], a[164:167], a[112:115], v[224:227]
  ds_read_b64_tr_b16 a[144:145], v2 offset:28736
  v_mfma_f32_16x16x32_bf16 v[228:231], a[164:167], a[116:119], v[228:231]
  ds_read_b64_tr_b16 a[146:147], v2 offset:32320
  v_mfma_f32_16x16x32_bf16 v[228:231], a[160:163], a[100:103], v[228:231]
  v_mfma_f32_16x16x32_bf16 v[232:235], a[160:163], a[104:107], v[232:235]
  ds_read_b64_tr_b16 a[148:149], v2 offset:35904
  v_mfma_f32_16x16x32_bf16 v[232:235], a[164:167], a[120:123], v[232:235]
  buffer_load_dwordx4 a[84:87], v0, s[36:39], s57 offen offset:1024 sc1
  v_mfma_f32_16x16x32_bf16 v[236:239], a[164:167], a[124:127], v[236:239]
  ds_read_b64_tr_b16 a[150:151], v2 offset:39488
  v_mfma_f32_16x16x32_bf16 v[236:239], a[160:163], a[108:111], v[236:239]
  v_mfma_f32_16x16x32_bf16 v[252:255], a[168:171], a[108:111], v[252:255]
  ds_read_b64_tr_b16 a[152:153], v2 offset:28768
  v_mfma_f32_16x16x32_bf16 v[252:255], a[172:175], a[124:127], v[252:255]
  v_mfma_f32_16x16x32_bf16 v[248:251], a[172:175], a[120:123], v[248:251]
  buffer_load_dwordx4 v8, s[16:19], s56 offen offset:1024 lds
  v_mfma_f32_16x16x32_bf16 v[248:251], a[168:171], a[104:107], v[248:251]
  ds_read_b64_tr_b16 a[154:155], v2 offset:32352
  v_mfma_f32_16x16x32_bf16 v[244:247], a[168:171], a[100:103], v[244:247]
  ds_read_b64_tr_b16 a[156:157], v2 offset:35936
  v_mfma_f32_16x16x32_bf16 v[244:247], a[172:175], a[116:119], v[244:247]
  v_mfma_f32_16x16x32_bf16 v[240:243], a[172:175], a[112:115], v[240:243]
  ds_read_b64_tr_b16 a[158:159], v2 offset:39520
  v_mfma_f32_16x16x32_bf16 v[240:243], a[168:171], a[96:99], v[240:243]
  s_waitcnt vmcnt(29) lgkmcnt(8)
  buffer_load_dwordx4 a[88:91], v0, s[36:39], s57 offen offset:2048 sc1
  v_mfma_f32_16x16x32_bf16 v[32:35], a[128:131], a[0:3], v[32:35]
  ds_read_b64_tr_b16 a[160:161], v2 offset:28800
  v_mfma_f32_16x16x32_bf16 v[32:35], a[132:135], a[16:19], v[32:35]
  s_waitcnt vmcnt(20)
  s_barrier
  v_mfma_f32_16x16x32_bf16 v[36:39], a[132:135], a[20:23], v[36:39]
  ds_read_b64_tr_b16 a[162:163], v2 offset:32384
  v_mfma_f32_16x16x32_bf16 v[36:39], a[128:131], a[4:7], v[36:39]
  v_mfma_f32_16x16x32_bf16 v[40:43], a[128:131], a[8:11], v[40:43]
  buffer_load_dwordx4 v9, s[16:19], s56 offen offset:2048 lds
  v_mfma_f32_16x16x32_bf16 v[40:43], a[132:135], a[24:27], v[40:43]
  ds_read_b64_tr_b16 a[164:165], v2 offset:35968
  v_mfma_f32_16x16x32_bf16 v[44:47], a[132:135], a[28:31], v[44:47]
  ds_read_b64_tr_b16 a[166:167], v2 offset:39552
  v_mfma_f32_16x16x32_bf16 v[44:47], a[128:131], a[12:15], v[44:47]
  v_mfma_f32_16x16x32_bf16 v[60:63], a[136:139], a[12:15], v[60:63]
  ds_read_b64_tr_b16 a[168:169], v2 offset:28832
  v_mfma_f32_16x16x32_bf16 v[60:63], a[140:143], a[28:31], v[60:63]
  buffer_load_dwordx4 a[92:95], v0, s[36:39], s57 offen offset:3072 sc1
  s_bfe_u32 s56, s83, 0x3001c
  v_mfma_f32_16x16x32_bf16 v[56:59], a[140:143], a[24:27], v[56:59]
  s_lshl_b32 s56, s56, 2
  s_bitcmp1_b32 s83, 31
  s_addc_u32 s56, s56, 0
  v_mfma_f32_16x16x32_bf16 v[56:59], a[136:139], a[8:11], v[56:59]
  s_mul_i32 s56, s56, 229376
  s_add_u32 m0, s84, 57344
  ds_read_b64_tr_b16 a[170:171], v2 offset:32416
  v_mfma_f32_16x16x32_bf16 v[52:55], a[136:139], a[4:7], v[52:55]
  ds_read_b64_tr_b16 a[172:173], v2 offset:36000
  v_mfma_f32_16x16x32_bf16 v[52:55], a[140:143], a[20:23], v[52:55]
  s_waitcnt vmcnt(14)
  v_accvgpr_read_b32 v26, a208
  v_accvgpr_read_b32 v27, a209
  v_mfma_f32_16x16x32_bf16 v[48:51], a[140:143], a[16:19], v[48:51]
  buffer_load_dwordx4 v3, s[16:19], s56 offen offset:0 lds
  v_accvgpr_read_b32 v28, a210
  v_mfma_f32_16x16x32_bf16 v[48:51], a[136:139], a[0:3], v[48:51]
  s_waitcnt lgkmcnt(7)
  ds_read_b64_tr_b16 a[174:175], v2 offset:39584
  v_accvgpr_read_b32 v29, a211
  v_mfma_f32_16x16x32_bf16 v[64:67], a[144:147], a[0:3], v[64:67]
  ds_read_b64_tr_b16 a[128:129], v2 offset:28864
  v_max_u32 v31, v26, v27
  v_mfma_f32_16x16x32_bf16 v[64:67], a[148:151], a[16:19], v[64:67]
  v_max3_u32 v31, v31, v28, v29
  v_accvgpr_read_b32 v22, a212
  v_mfma_f32_16x16x32_bf16 v[68:71], a[148:151], a[20:23], v[68:71]
  ds_read_b64_tr_b16 a[130:131], v2 offset:32448
  v_accvgpr_read_b32 v23, a213
  v_mfma_f32_16x16x32_bf16 v[68:71], a[144:147], a[4:7], v[68:71]
  buffer_load_dwordx4 v4, s[16:19], s56 offen offset:1024 lds
  v_max3_u32 v31, v31, v22, v23
  v_mfma_f32_16x16x32_bf16 v[72:75], a[144:147], a[8:11], v[72:75]
  ds_read_b64_tr_b16 a[132:133], v2 offset:36032
  v_add_f32 v26, v26, v22
  v_mfma_f32_16x16x32_bf16 v[72:75], a[148:151], a[24:27], v[72:75]
  v_add_f32 v27, v27, v23
  v_accvgpr_read_b32 v22, a214
  v_mfma_f32_16x16x32_bf16 v[76:79], a[148:151], a[28:31], v[76:79]
  ds_read_b64_tr_b16 a[134:135], v2 offset:39616
  v_accvgpr_read_b32 v23, a215
  v_mfma_f32_16x16x32_bf16 v[76:79], a[144:147], a[12:15], v[76:79]
  v_max3_u32 v31, v31, v22, v23
  v_add_f32 v28, v28, v22
  v_mfma_f32_16x16x32_bf16 v[92:95], a[152:155], a[12:15], v[92:95]
  buffer_load_dwordx4 v5, s[16:19], s56 offen offset:2048 lds
  v_add_f32 v29, v29, v23
  v_mfma_f32_16x16x32_bf16 v[92:95], a[156:159], a[28:31], v[92:95]
  ds_read_b64_tr_b16 a[136:137], v2 offset:43008
  v_accvgpr_read_b32 v22, a216
  v_mfma_f32_16x16x32_bf16 v[88:91], a[156:159], a[24:27], v[88:91]
  ds_read_b64_tr_b16 a[138:139], v2 offset:46592
  v_accvgpr_read_b32 v23, a217
  v_mfma_f32_16x16x32_bf16 v[88:91], a[152:155], a[8:11], v[88:91]
  v_max3_u32 v31, v31, v22, v23
  v_add_f32 v26, v26, v22
  v_mfma_f32_16x16x32_bf16 v[84:87], a[152:155], a[4:7], v[84:87]
  ds_read_b64_tr_b16 a[140:141], v2 offset:50176
  v_add_f32 v27, v27, v23
  v_mfma_f32_16x16x32_bf16 v[84:87], a[156:159], a[20:23], v[84:87]
  buffer_load_dwordx4 v6, s[16:19], s56 offen offset:3072 lds
  s_add_u32 m0, s84, 61440
  v_mfma_f32_16x16x32_bf16 v[80:83], a[156:159], a[16:19], v[80:83]
  ds_read_b64_tr_b16 a[142:143], v2 offset:53760
  v_accvgpr_read_b32 v22, a218
  v_mfma_f32_16x16x32_bf16 v[80:83], a[152:155], a[0:3], v[80:83]
  s_waitcnt lgkmcnt(8)
  v_accvgpr_read_b32 v23, a219
  v_max3_u32 v31, v31, v22, v23
  v_mfma_f32_16x16x32_bf16 v[96:99], a[160:163], a[0:3], v[96:99]
  ds_read_b64_tr_b16 a[144:145], v2 offset:43040
  v_add_f32 v28, v28, v22
  v_mfma_f32_16x16x32_bf16 v[96:99], a[164:167], a[16:19], v[96:99]
  v_add_f32 v29, v29, v23
  v_accvgpr_read_b32 v22, a220
  v_mfma_f32_16x16x32_bf16 v[100:103], a[164:167], a[20:23], v[100:103]
  buffer_load_dwordx4 v7, s[16:19], s56 offen offset:0 lds
  v_accvgpr_read_b32 v23, a221
  v_mfma_f32_16x16x32_bf16 v[100:103], a[160:163], a[4:7], v[100:103]
  ds_read_b64_tr_b16 a[146:147], v2 offset:46624
  v_max3_u32 v31, v31, v22, v23
  v_mfma_f32_16x16x32_bf16 v[104:107], a[160:163], a[8:11], v[104:107]
  ds_read_b64_tr_b16 a[148:149], v2 offset:50208
  v_add_f32 v26, v26, v22
  v_mfma_f32_16x16x32_bf16 v[104:107], a[164:167], a[24:27], v[104:107]
  v_add_f32 v27, v27, v23
  v_accvgpr_read_b32 v22, a222
  v_mfma_f32_16x16x32_bf16 v[108:111], a[164:167], a[28:31], v[108:111]
  ds_read_b64_tr_b16 a[150:151], v2 offset:53792
  v_accvgpr_read_b32 v23, a223
  v_mfma_f32_16x16x32_bf16 v[108:111], a[160:163], a[12:15], v[108:111]
  buffer_load_dwordx4 v8, s[16:19], s56 offen offset:1024 lds
  v_max3_u32 v31, v31, v22, v23
  v_mfma_f32_16x16x32_bf16 v[124:127], a[168:171], a[12:15], v[124:127]
  ds_read_b64_tr_b16 a[152:153], v2 offset:43072
  v_add_f32 v28, v28, v22
  v_mfma_f32_16x16x32_bf16 v[124:127], a[172:175], a[28:31], v[124:127]
  v_add_f32 v29, v29, v23
  v_mfma_f32_16x16x32_bf16 v[120:123], a[172:175], a[24:27], v[120:123]
  ds_read_b64_tr_b16 a[154:155], v2 offset:46656
  v_mfma_f32_16x16x32_bf16 v[120:123], a[168:171], a[8:11], v[120:123]
  v_cmp_eq_u32 vcc, -1, v31
  s_nop 4
  s_cbranch_vccnz CK7s
CK7x:
  v_mfma_f32_16x16x32_bf16 v[116:119], a[168:171], a[4:7], v[116:119]
  s_nop 0
  buffer_load_dwordx4 v9, s[16:19], s56 offen offset:2048 lds
  s_bfe_u32 s57, s83, 0x4001c
  v_mfma_f32_16x16x32_bf16 v[116:119], a[172:175], a[20:23], v[116:119]
  s_lshl_b32 s57, s57, 13
  s_add_u32 s57, s57, s85
  ds_read_b64_tr_b16 a[156:157], v2 offset:50240
  v_mfma_f32_16x16x32_bf16 v[112:115], a[172:175], a[16:19], v[112:115]
  ds_read_b64_tr_b16 a[158:159], v2 offset:53824
  v_permlane32_swap_b32 v26, v28
  v_mfma_f32_16x16x32_bf16 v[112:115], a[168:171], a[0:3], v[112:115]
  s_waitcnt lgkmcnt(8)
  v_permlane32_swap_b32 v27, v29
  v_add_f32 v26, v26, v28
  v_mfma_f32_16x16x32_bf16 v[128:131], a[128:131], a[0:3], v[128:131]
  ds_read_b64_tr_b16 a[160:161], v2 offset:43104
  v_add_f32 v27, v27, v29
  v_mfma_f32_16x16x32_bf16 v[128:131], a[132:135], a[16:19], v[128:131]
  buffer_load_dwordx4 a[96:99], v0, s[36:39], s57 offen offset:0 sc1
  v_cvt_pk_bf16_f32 v25, v26, v26
  v_mfma_f32_16x16x32_bf16 v[132:135], a[132:135], a[20:23], v[132:135]
  ds_read_b64_tr_b16 a[162:163], v2 offset:46688
  v_lshlrev_b32 v25, 16, v25
  v_mfma_f32_16x16x32_bf16 v[132:135], a[128:131], a[4:7], v[132:135]
  v_sub_f32 v30, v26, v25
  v_cvt_pk_bf16_f32 v22, v26, v30
  v_mfma_f32_16x16x32_bf16 v[136:139], a[128:131], a[8:11], v[136:139]
  ds_read_b64_tr_b16 a[164:165], v2 offset:50272
  v_and_b32 v25, 0xffff0000, v22
  v_mfma_f32_16x16x32_bf16 v[136:139], a[132:135], a[24:27], v[136:139]
  v_sub_f32 v30, v30, v25
  v_cvt_pk_bf16_f32 v23, v30, 0
  v_mfma_f32_16x16x32_bf16 v[140:143], a[132:135], a[28:31], v[140:143]
  buffer_load_dwordx4 a[100:103], v0, s[36:39], s57 offen offset:1024 sc1
  v_mfma_f32_16x16x32_bf16 v[140:143], a[128:131], a[12:15], v[140:143]
  ds_read_b64_tr_b16 a[166:167], v2 offset:53856
  v_mfma_f32_16x16x32_bf16 v[156:159], a[136:139], a[12:15], v[156:159]
  ds_read_b64_tr_b16 a[168:169], v2 offset:43136
  v_mfma_f32_16x16x32_bf16 v[156:159], a[140:143], a[28:31], v[156:159]
  ds_write_b64 v24, v[22:23] offset:0
  v_cvt_pk_bf16_f32 v25, v27, v27
  v_mfma_f32_16x16x32_bf16 v[152:155], a[140:143], a[24:27], v[152:155]
  ds_read_b64_tr_b16 a[170:171], v2 offset:46720
  v_lshlrev_b32 v25, 16, v25
  v_mfma_f32_16x16x32_bf16 v[152:155], a[136:139], a[8:11], v[152:155]
  buffer_load_dwordx4 a[104:107], v0, s[36:39], s57 offen offset:2048 sc1
  v_sub_f32 v30, v27, v25
  v_mfma_f32_16x16x32_bf16 v[148:151], a[136:139], a[4:7], v[148:151]
  ds_read_b64_tr_b16 a[172:173], v2 offset:50304
  v_cvt_pk_bf16_f32 v28, v27, v30
  v_mfma_f32_16x16x32_bf16 v[148:151], a[140:143], a[20:23], v[148:151]
  v_and_b32 v25, 0xffff0000, v28
  v_sub_f32 v30, v30, v25
  v_mfma_f32_16x16x32_bf16 v[144:147], a[140:143], a[16:19], v[144:147]
  ds_read_b64_tr_b16 a[174:175], v2 offset:53888
  v_cvt_pk_bf16_f32 v29, v30, 0
  v_mfma_f32_16x16x32_bf16 v[144:147], a[136:139], a[0:3], v[144:147]
  s_waitcnt lgkmcnt(9)
  ds_write_b64 v24, v[28:29] offset:16
  v_mfma_f32_16x16x32_bf16 v[160:163], a[144:147], a[0:3], v[160:163]
  buffer_load_dwordx4 a[108:111], v0, s[36:39], s57 offen offset:3072 sc1
  s_add_u32 s57, s57, 4096
  v_mfma_f32_16x16x32_bf16 v[160:163], a[148:151], a[16:19], v[160:163]
  ds_read_b64_tr_b16 a[128:129], v2 offset:43168
  v_mfma_f32_16x16x32_bf16 v[164:167], a[148:151], a[20:23], v[164:167]
  ds_read_b64_tr_b16 a[130:131], v2 offset:46752
  v_mfma_f32_16x16x32_bf16 v[164:167], a[144:147], a[4:7], v[164:167]
  v_mfma_f32_16x16x32_bf16 v[168:171], a[144:147], a[8:11], v[168:171]
  ds_read_b64_tr_b16 a[132:133], v2 offset:50336
  v_mfma_f32_16x16x32_bf16 v[168:171], a[148:151], a[24:27], v[168:171]
  buffer_load_dwordx4 a[112:115], v0, s[36:39], s57 offen offset:0 sc1
  v_mfma_f32_16x16x32_bf16 v[172:175], a[148:151], a[28:31], v[172:175]
  ds_read_b64_tr_b16 a[134:135], v2 offset:53920
  v_mfma_f32_16x16x32_bf16 v[172:175], a[144:147], a[12:15], v[172:175]
  v_mfma_f32_16x16x32_bf16 v[188:191], a[152:155], a[12:15], v[188:191]
  ds_read_b64_tr_b16 a[136:137], v2 offset:43200
  v_mfma_f32_16x16x32_bf16 v[188:191], a[156:159], a[28:31], v[188:191]
  v_mfma_f32_16x16x32_bf16 v[184:187], a[156:159], a[24:27], v[184:187]
  buffer_load_dwordx4 a[116:119], v0, s[36:39], s57 offen offset:1024 sc1
  v_mfma_f32_16x16x32_bf16 v[184:187], a[152:155], a[8:11], v[184:187]
  ds_read_b64_tr_b16 a[138:139], v2 offset:46784
  v_mfma_f32_16x16x32_bf16 v[180:183], a[152:155], a[4:7], v[180:183]
  ds_read_b64_tr_b16 a[140:141], v2 offset:50368
  v_mfma_f32_16x16x32_bf16 v[180:183], a[156:159], a[20:23], v[180:183]
  v_mfma_f32_16x16x32_bf16 v[176:179], a[156:159], a[16:19], v[176:179]
  ds_read_b64_tr_b16 a[142:143], v2 offset:53952
  v_mfma_f32_16x16x32_bf16 v[176:179], a[152:155], a[0:3], v[176:179]
  s_waitcnt lgkmcnt(9)
  buffer_load_dwordx4 a[120:123], v0, s[36:39], s57 offen offset:2048 sc1
  v_mfma_f32_16x16x32_bf16 v[192:195], a[160:163], a[0:3], v[192:195]
  ds_read_b64_tr_b16 a[144:145], v1 offset:192
  v_mfma_f32_16x16x32_bf16 v[192:195], a[164:167], a[16:19], v[192:195]
  v_mfma_f32_16x16x32_bf16 v[196:199], a[164:167], a[20:23], v[196:199]
  s_lshl_b32 s68, s44, 8
  ds_read_b64_tr_b16 a[146:147], v1 offset:3776
  s_add_u32 s68, s68, s2
  v_mfma_f32_16x16x32_bf16 v[196:199], a[160:163], a[4:7], v[196:199]
  s_mul_i32 s68, s68, 7168
  v_mfma_f32_16x16x32_bf16 v[200:203], a[160:163], a[8:11], v[200:203]
  buffer_load_dwordx4 a[124:127], v0, s[36:39], s57 offen offset:3072 sc1
  v_mfma_f32_16x16x32_bf16 v[200:203], a[164:167], a[24:27], v[200:203]
  ds_read_b64_tr_b16 a[148:149], v1 offset:7360
  v_mfma_f32_16x16x32_bf16 v[204:207], a[164:167], a[28:31], v[204:207]
  ds_read_b64_tr_b16 a[150:151], v1 offset:10944
  v_mfma_f32_16x16x32_bf16 v[204:207], a[160:163], a[12:15], v[204:207]
  s_waitcnt vmcnt(16)
  s_barrier
  v_mfma_f32_16x16x32_bf16 v[220:223], a[168:171], a[12:15], v[220:223]
Hc2_1:
  s_cbranch_execz Rc
  ds_read_b64_tr_b16 a[152:153], v1 offset:14528
  v_mfma_f32_16x16x32_bf16 v[220:223], a[172:175], a[28:31], v[220:223]
  v_mfma_f32_16x16x32_bf16 v[216:219], a[172:175], a[24:27], v[216:219]
  ds_read_b64_tr_b16 a[154:155], v1 offset:18112
  v_mfma_f32_16x16x32_bf16 v[216:219], a[168:171], a[8:11], v[216:219]
  v_mfma_f32_16x16x32_bf16 v[212:215], a[168:171], a[4:7], v[212:215]
  ds_read_b64_tr_b16 a[156:157], v1 offset:21696
  v_mfma_f32_16x16x32_bf16 v[212:215], a[172:175], a[20:23], v[212:215]
  v_mfma_f32_16x16x32_bf16 v[208:211], a[172:175], a[16:19], v[208:211]
  ds_read_b64_tr_b16 a[158:159], v1 offset:25280
  v_mfma_f32_16x16x32_bf16 v[208:211], a[168:171], a[0:3], v[208:211]
  s_waitcnt lgkmcnt(8)
  v_mfma_f32_16x16x32_bf16 v[224:227], a[128:131], a[0:3], v[224:227]
  ds_read_b64_tr_b16 a[160:161], v1 offset:28864
  v_mfma_f32_16x16x32_bf16 v[224:227], a[132:135], a[16:19], v[224:227]
  v_mfma_f32_16x16x32_bf16 v[228:231], a[132:135], a[20:23], v[228:231]
  ds_read_b64_tr_b16 a[162:163], v1 offset:32448
  v_mfma_f32_16x16x32_bf16 v[228:231], a[128:131], a[4:7], v[228:231]
  v_mfma_f32_16x16x32_bf16 v[232:235], a[128:131], a[8:11], v[232:235]
  ds_read_b64_tr_b16 a[164:165], v1 offset:36032
  v_mfma_f32_16x16x32_bf16 v[232:235], a[132:135], a[24:27], v[232:235]
  v_mfma_f32_16x16x32_bf16 v[236:239], a[132:135], a[28:31], v[236:239]
  ds_read_b64_tr_b16 a[166:167], v1 offset:39616
  v_mfma_f32_16x16x32_bf16 v[236:239], a[128:131], a[12:15], v[236:239]
  v_mfma_f32_16x16x32_bf16 v[252:255], a[136:139], a[12:15], v[252:255]
  ds_read_b64_tr_b16 a[168:169], v1 offset:43200
  v_mfma_f32_16x16x32_bf16 v[252:255], a[140:143], a[28:31], v[252:255]
  v_mfma_f32_16x16x32_bf16 v[248:251], a[140:143], a[24:27], v[248:251]
  ds_read_b64_tr_b16 a[170:171], v1 offset:46784
  v_mfma_f32_16x16x32_bf16 v[248:251], a[136:139], a[8:11], v[248:251]
  v_mfma_f32_16x16x32_bf16 v[244:247], a[136:139], a[4:7], v[244:247]
  ds_read_b64_tr_b16 a[172:173], v1 offset:50368
  v_mfma_f32_16x16x32_bf16 v[244:247], a[140:143], a[20:23], v[244:247]
  v_mfma_f32_16x16x32_bf16 v[240:243], a[140:143], a[16:19], v[240:243]
  ds_read_b64_tr_b16 a[174:175], v1 offset:53952
  v_mfma_f32_16x16x32_bf16 v[240:243], a[136:139], a[0:3], v[240:243]
  s_waitcnt vmcnt(33) lgkmcnt(8)
  v_mfma_f32_16x16x32_bf16 v[128:131], a[144:147], a[32:35], v[128:131]
  v_lshrrev_b32 v8, 1, v0
  v_and_b32 v31, 0xf0, v0
  v_mfma_f32_16x16x32_bf16 v[128:131], a[148:151], a[48:51], v[128:131]
  s_waitcnt vmcnt(8)
  s_barrier
  v_add_u32 v31, 159744, v31
  v_mfma_f32_16x16x32_bf16 v[132:135], a[148:151], a[52:55], v[132:135]
  v_cmp_gt_u32 vcc, 0x100, v0
  s_mov_b32 s76, 0x01000100
  v_mfma_f32_16x16x32_bf16 v[132:135], a[144:147], a[36:39], v[132:135]
  s_mov_b32 s77, 0x03020302
  v_min_u32 v3, 880, v0
  v_lshlrev_b32 v3, 3, v3
  v_mfma_f32_16x16x32_bf16 v[136:139], a[144:147], a[40:43], v[136:139]
  buffer_load_dword a252, v3, s[24:27], s68 offen
  v_cndmask_b32 v12, 0, v12, vcc
  v_mfma_f32_16x16x32_bf16 v[136:139], a[148:151], a[56:59], v[136:139]
  v_perm_b32 v22, v12, v12, s76
  v_and_b32 v23, 0xffff, v12
  v_mfma_f32_16x16x32_bf16 v[140:143], a[148:151], a[60:63], v[140:143]
  v_perm_b32 v24, v12, v12, s77
  v_lshrrev_b32 v25, 16, v12
  v_mfma_f32_16x16x32_bf16 v[140:143], a[144:147], a[44:47], v[140:143]
  v_accvgpr_write_b32 a0, v22
  v_accvgpr_write_b32 a1, v23
  v_mfma_f32_16x16x32_bf16 v[252:255], a[152:155], a[44:47], v[252:255]
  ds_read_b64_tr_b16 a[128:129], v2 offset:192
  v_accvgpr_write_b32 a2, v24
  v_mfma_f32_16x16x32_bf16 v[252:255], a[156:159], a[60:63], v[252:255]
  v_accvgpr_write_b32 a3, v25
  v_cndmask_b32 v15, 0, v15, vcc
  v_mfma_f32_16x16x32_bf16 v[248:251], a[156:159], a[56:59], v[248:251]
  ds_read_b64_tr_b16 a[130:131], v2 offset:3776
  v_perm_b32 v26, v15, v15, s76
  v_mfma_f32_16x16x32_bf16 v[248:251], a[152:155], a[40:43], v[248:251]
  v_and_b32 v27, 0xffff, v15
  v_perm_b32 v28, v15, v15, s77
  v_mfma_f32_16x16x32_bf16 v[244:247], a[152:155], a[36:39], v[244:247]
  ds_read_b64_tr_b16 a[132:133], v2 offset:7360
  v_lshrrev_b32 v29, 16, v15
  v_mfma_f32_16x16x32_bf16 v[244:247], a[156:159], a[52:55], v[244:247]
  ds_read_b128 a[16:19], v31 offset:1536
  v_accvgpr_write_b32 a4, v26
  v_mfma_f32_16x16x32_bf16 v[240:243], a[156:159], a[48:51], v[240:243]
  ds_read_b128 a[20:23], v31 offset:3584
  v_accvgpr_write_b32 a5, v27
  v_mfma_f32_16x16x32_bf16 v[240:243], a[152:155], a[32:35], v[240:243]
  s_waitcnt vmcnt(16) lgkmcnt(5)
  ds_read_b64_tr_b16 a[134:135], v2 offset:10944
  v_accvgpr_write_b32 a6, v28
  v_mfma_f32_16x16x32_bf16 v[128:131], a[160:163], a[64:67], v[128:131]
  ds_read_b64_tr_b16 a[136:137], v2 offset:14528
  v_accvgpr_write_b32 a7, v29
  v_mfma_f32_16x16x32_bf16 v[128:131], a[164:167], a[80:83], v[128:131]
  v_cndmask_b32 v18, 0, v18, vcc
  v_perm_b32 v22, v18, v18, s76
  v_mfma_f32_16x16x32_bf16 v[132:135], a[164:167], a[84:87], v[132:135]
  ds_read_b64_tr_b16 a[138:139], v2 offset:18112
  v_and_b32 v23, 0xffff, v18
  v_mfma_f32_16x16x32_bf16 v[132:135], a[160:163], a[68:71], v[132:135]
  v_perm_b32 v24, v18, v18, s77
  v_lshrrev_b32 v25, 16, v18
  v_mfma_f32_16x16x32_bf16 v[136:139], a[160:163], a[72:75], v[136:139]
  ds_read_b64_tr_b16 a[140:141], v2 offset:21696
  v_accvgpr_write_b32 a8, v22
  v_mfma_f32_16x16x32_bf16 v[136:139], a[164:167], a[88:91], v[136:139]
  v_accvgpr_write_b32 a9, v23
  v_accvgpr_write_b32 a10, v24
  v_mfma_f32_16x16x32_bf16 v[140:143], a[164:167], a[92:95], v[140:143]
  ds_read_b64_tr_b16 a[142:143], v2 offset:25280
  v_accvgpr_write_b32 a11, v25
  v_mfma_f32_16x16x32_bf16 v[140:143], a[160:163], a[76:79], v[140:143]
  v_cndmask_b32 v21, 0, v21, vcc
  v_perm_b32 v26, v21, v21, s76
  v_mfma_f32_16x16x32_bf16 v[252:255], a[168:171], a[76:79], v[252:255]
  ds_read_b64_tr_b16 a[144:145], v1 offset:0
  v_and_b32 v27, 0xffff, v21
  v_mfma_f32_16x16x32_bf16 v[252:255], a[172:175], a[92:95], v[252:255]
  v_perm_b32 v28, v21, v21, s77
  v_lshrrev_b32 v29, 16, v21
  v_mfma_f32_16x16x32_bf16 v[248:251], a[172:175], a[88:91], v[248:251]
  ds_read_b64_tr_b16 a[146:147], v1 offset:3584
  v_accvgpr_write_b32 a12, v26
  v_mfma_f32_16x16x32_bf16 v[248:251], a[168:171], a[72:75], v[248:251]
  v_accvgpr_write_b32 a13, v27
  v_accvgpr_write_b32 a14, v28
  v_mfma_f32_16x16x32_bf16 v[244:247], a[168:171], a[68:71], v[244:247]
  v_accvgpr_write_b32 a15, v29
  v_mfma_f32_16x16x32_bf16 v[244:247], a[172:175], a[84:87], v[244:247]
  ds_read_b64_tr_b16 a[148:149], v1 offset:7168
  v_mfma_f32_16x16x32_bf16 v[240:243], a[172:175], a[80:83], v[240:243]
  ds_read_b64_tr_b16 a[150:151], v1 offset:10752
  v_mov_b32 v9, s3
  v_mfma_f32_16x16x32_bf16 v[240:243], a[168:171], a[64:67], v[240:243]
  s_waitcnt lgkmcnt(9)
  v_mfma_f32_16x16x32_bf16 v[128:131], a[16:19], a[0:3], v[128:131]
  v_mfma_f32_16x16x32_bf16 v[132:135], a[16:19], a[4:7], v[132:135]
  v_mfma_f32_16x16x32_bf16 v[136:139], a[16:19], a[8:11], v[136:139]
  v_mfma_f32_16x16x32_bf16 v[140:143], a[16:19], a[12:15], v[140:143]
  v_mfma_f32_16x16x32_bf16 v[240:243], a[20:23], a[0:3], v[240:243]
  v_mfma_f32_16x16x32_bf16 v[244:247], a[20:23], a[4:7], v[244:247]
  v_mfma_f32_16x16x32_bf16 v[248:251], a[20:23], a[8:11], v[248:251]
  v_mfma_f32_16x16x32_bf16 v[252:255], a[20:23], a[12:15], v[252:255]
  s_waitcnt vmcnt(1) lgkmcnt(4)
  v_mfma_f32_16x16x32_bf16 v[128:131], a[128:131], a[96:99], v[128:131]
  ds_read_b128 a[24:27], v31 offset:0
  v_mfma_f32_16x16x32_bf16 v[128:131], a[132:135], a[112:115], v[128:131]
  ds_read_b64_tr_b16 a[152:153], v1 offset:14336
  v_mfma_f32_16x16x32_bf16 v[132:135], a[132:135], a[116:119], v[132:135]
  ds_read_b128 a[28:31], v31 offset:2048
  v_mfma_f32_16x16x32_bf16 v[132:135], a[128:131], a[100:103], v[132:135]
  ds_read_b64_tr_b16 a[154:155], v1 offset:17920
  v_mfma_f32_16x16x32_bf16 v[136:139], a[128:131], a[104:107], v[136:139]
  ds_read_b64_tr_b16 a[156:157], v1 offset:21504
  v_mfma_f32_16x16x32_bf16 v[136:139], a[132:135], a[120:123], v[136:139]
  v_mfma_f32_16x16x32_bf16 v[140:143], a[132:135], a[124:127], v[140:143]
  ds_read_b64_tr_b16 a[158:159], v1 offset:25088
  v_mfma_f32_16x16x32_bf16 v[140:143], a[128:131], a[108:111], v[140:143]
  v_mfma_f32_16x16x32_bf16 v[252:255], a[136:139], a[108:111], v[252:255]
  ds_read_b64_tr_b16 a[160:161], v1 offset:28672
  v_mul_f32 v22, v10, v128
  v_mul_f32 v23, v10, v129
  v_mul_f32 v24, v10, v130
  v_mfma_f32_16x16x32_bf16 v[252:255], a[140:143], a[124:127], v[252:255]
  v_mul_f32 v25, v10, v131
  v_exp_f32 v22, v22
  v_mul_f32 v26, v13, v132
  v_mfma_f32_16x16x32_bf16 v[248:251], a[140:143], a[120:123], v[248:251]
  ds_read_b64_tr_b16 a[162:163], v1 offset:32256
  v_exp_f32 v23, v23
  v_mul_f32 v27, v13, v133
  v_mfma_f32_16x16x32_bf16 v[248:251], a[136:139], a[104:107], v[248:251]
  v_exp_f32 v24, v24
  v_mul_f32 v28, v13, v134
  v_mfma_f32_16x16x32_bf16 v[244:247], a[136:139], a[100:103], v[244:247]
  ds_read_b64_tr_b16 a[164:165], v1 offset:35840
  v_exp_f32 v25, v25
  v_mul_f32 v29, v13, v135
  v_mfma_f32_16x16x32_bf16 v[244:247], a[140:143], a[116:119], v[244:247]
  v_exp_f32 v26, v26
  v_fma_f32 v22, v22, v11, v11
  v_mfma_f32_16x16x32_bf16 v[240:243], a[140:143], a[112:115], v[240:243]
  ds_read_b64_tr_b16 a[166:167], v1 offset:39424
  v_exp_f32 v27, v27
  v_fma_f32 v23, v23, v11, v11
  v_mfma_f32_16x16x32_bf16 v[240:243], a[136:139], a[96:99], v[240:243]
  s_waitcnt lgkmcnt(4)
  v_exp_f32 v28, v28
  v_fma_f32 v24, v24, v11, v11
  v_mfma_f32_16x16x32_bf16 v[32:35], a[144:147], a[32:35], v[32:35]
  ds_read_b64_tr_b16 a[168:169], v1 offset:43008
  v_exp_f32 v29, v29
  v_fma_f32 v25, v25, v11, v11
  v_mfma_f32_16x16x32_bf16 v[32:35], a[148:151], a[48:51], v[32:35]
  v_rcp_f32 v22, v22
  v_fma_f32 v26, v26, v14, v14
  v_mfma_f32_16x16x32_bf16 v[36:39], a[148:151], a[52:55], v[36:39]
  ds_read_b64_tr_b16 a[170:171], v1 offset:46592
  v_rcp_f32 v23, v23
  v_fma_f32 v27, v27, v14, v14
  v_mfma_f32_16x16x32_bf16 v[36:39], a[144:147], a[36:39], v[36:39]
  v_rcp_f32 v24, v24
  v_fma_f32 v28, v28, v14, v14
  v_mfma_f32_16x16x32_bf16 v[40:43], a[144:147], a[40:43], v[40:43]
  ds_read_b64_tr_b16 a[172:173], v1 offset:50176
  v_rcp_f32 v25, v25
  v_fma_f32 v29, v29, v14, v14
  v_mfma_f32_16x16x32_bf16 v[40:43], a[148:151], a[56:59], v[40:43]
  v_rcp_f32 v26, v26
  v_mul_f32 v240, v128, v240
  v_mfma_f32_16x16x32_bf16 v[44:47], a[148:151], a[60:63], v[44:47]
  ds_read_b64_tr_b16 a[174:175], v1 offset:53760
  v_rcp_f32 v27, v27
  v_mul_f32 v241, v129, v241
  v_mfma_f32_16x16x32_bf16 v[44:47], a[144:147], a[44:47], v[44:47]
  s_waitcnt lgkmcnt(11)
  v_rcp_f32 v28, v28
  v_mul_f32 v242, v130, v242
  v_mfma_f32_16x16x32_bf16 v[32:35], a[24:27], a[0:3], v[32:35]
  ds_read_b64_tr_b16 a[128:129], v2 offset:0
  v_rcp_f32 v29, v29
  v_mul_f32 v243, v131, v243
  v_mfma_f32_16x16x32_bf16 v[36:39], a[24:27], a[4:7], v[36:39]
  v_mul_f32 v240, v240, v22
  v_mul_f32 v241, v241, v23
  v_mul_f32 v242, v242, v24
  v_mul_f32 v243, v243, v25
  v_mfma_f32_16x16x32_bf16 v[40:43], a[24:27], a[8:11], v[40:43]
  ds_read_b64_tr_b16 a[130:131], v2 offset:3584
  v_mul_f32 v22, v16, v136
  v_mul_f32 v23, v16, v137
  v_mul_f32 v24, v16, v138
  v_mfma_f32_16x16x32_bf16 v[44:47], a[24:27], a[12:15], v[44:47]
  v_mul_f32 v25, v16, v139
  v_exp_f32 v22, v22
  v_mul_f32 v244, v132, v244
  v_mfma_f32_16x16x32_bf16 v[144:147], a[28:31], a[0:3], v[144:147]
  ds_read_b64_tr_b16 a[132:133], v2 offset:7168
  v_exp_f32 v23, v23
  v_mul_f32 v245, v133, v245
  v_mfma_f32_16x16x32_bf16 v[148:151], a[28:31], a[4:7], v[148:151]
  v_exp_f32 v24, v24
  v_mul_f32 v246, v134, v246
  v_mfma_f32_16x16x32_bf16 v[152:155], a[28:31], a[8:11], v[152:155]
  ds_read_b64_tr_b16 a[134:135], v2 offset:10752
  v_exp_f32 v25, v25
  v_mul_f32 v247, v135, v247
  v_mfma_f32_16x16x32_bf16 v[156:159], a[28:31], a[12:15], v[156:159]
  v_mul_f32 v244, v244, v26
  v_mul_f32 v245, v245, v27
  v_mul_f32 v246, v246, v28
  v_mul_f32 v247, v247, v29
  v_mfma_f32_16x16x32_bf16 v[156:159], a[152:155], a[44:47], v[156:159]
  ds_read_b64_tr_b16 a[136:137], v2 offset:14336
  v_cvt_pk_bf16_f32 v128, v240, v241
  v_cvt_pk_bf16_f32 v129, v242, v243
  v_mfma_f32_16x16x32_bf16 v[156:159], a[156:159], a[60:63], v[156:159]
  buffer_store_dwordx2 v[128:129], v8, s[36:39], s65 offen offset:0 sc1
  v_mul_f32 v26, v19, v140
  v_mul_f32 v27, v19, v141
  v_mul_f32 v28, v19, v142
  v_mfma_f32_16x16x32_bf16 v[152:155], a[156:159], a[56:59], v[152:155]
  ds_read_b64_tr_b16 a[138:139], v2 offset:17920
  v_mul_f32 v29, v19, v143
  v_exp_f32 v26, v26
  v_mfma_f32_16x16x32_bf16 v[152:155], a[152:155], a[40:43], v[152:155]
  v_fma_f32 v22, v22, v17, v17
  v_exp_f32 v27, v27
  v_fma_f32 v23, v23, v17, v17
  v_mfma_f32_16x16x32_bf16 v[148:151], a[152:155], a[36:39], v[148:151]
  ds_read_b64_tr_b16 a[140:141], v2 offset:21504
  v_exp_f32 v28, v28
  v_fma_f32 v24, v24, v17, v17
  v_mfma_f32_16x16x32_bf16 v[148:151], a[156:159], a[52:55], v[148:151]
  v_exp_f32 v29, v29
  v_fma_f32 v25, v25, v17, v17
  v_cvt_pk_bf16_f32 v132, v244, v245
  v_mfma_f32_16x16x32_bf16 v[144:147], a[156:159], a[48:51], v[144:147]
  ds_read_b64_tr_b16 a[142:143], v2 offset:25088
  v_cvt_pk_bf16_f32 v133, v246, v247
  v_mfma_f32_16x16x32_bf16 v[144:147], a[152:155], a[32:35], v[144:147]
  s_waitcnt lgkmcnt(8)
  buffer_store_dwordx2 v[132:133], v8, s[36:39], s65 offen offset:1024 sc1
  v_rcp_f32 v22, v22
  v_fma_f32 v26, v26, v20, v20
  v_mfma_f32_16x16x32_bf16 v[32:35], a[160:163], a[64:67], v[32:35]
  ds_read_b64_tr_b16 a[144:145], v1 offset:32
  v_rcp_f32 v23, v23
  v_fma_f32 v27, v27, v20, v20
  v_mfma_f32_16x16x32_bf16 v[32:35], a[164:167], a[80:83], v[32:35]
  v_rcp_f32 v24, v24
  v_fma_f32 v28, v28, v20, v20
  v_mfma_f32_16x16x32_bf16 v[36:39], a[164:167], a[84:87], v[36:39]
  ds_read_b64_tr_b16 a[146:147], v1 offset:3616
  v_rcp_f32 v25, v25
  v_fma_f32 v29, v29, v20, v20
  v_mfma_f32_16x16x32_bf16 v[36:39], a[160:163], a[68:71], v[36:39]
  v_rcp_f32 v26, v26
  v_mul_f32 v248, v136, v248
  v_mfma_f32_16x16x32_bf16 v[40:43], a[160:163], a[72:75], v[40:43]
  ds_read_b64_tr_b16 a[148:149], v1 offset:7200
  v_rcp_f32 v27, v27
  v_mul_f32 v249, v137, v249
  v_mfma_f32_16x16x32_bf16 v[40:43], a[164:167], a[88:91], v[40:43]
  v_rcp_f32 v28, v28
  v_mul_f32 v250, v138, v250
  v_mfma_f32_16x16x32_bf16 v[44:47], a[164:167], a[92:95], v[44:47]
  ds_read_b64_tr_b16 a[150:151], v1 offset:10784
  v_rcp_f32 v29, v29
  v_mul_f32 v251, v139, v251
  v_mfma_f32_16x16x32_bf16 v[44:47], a[160:163], a[76:79], v[44:47]
  v_mul_f32 v248, v248, v22
  v_mul_f32 v249, v249, v23
  v_mul_f32 v250, v250, v24
  v_mul_f32 v251, v251, v25
  v_mfma_f32_16x16x32_bf16 v[156:159], a[168:171], a[76:79], v[156:159]
  v_mul_f32 v252, v140, v252
  v_mul_f32 v253, v141, v253
  v_mul_f32 v254, v142, v254
  v_mul_f32 v255, v143, v255
  v_mfma_f32_16x16x32_bf16 v[156:159], a[172:175], a[92:95], v[156:159]
  v_cvt_pk_bf16_f32 v136, v248, v249
  v_cvt_pk_bf16_f32 v137, v250, v251
  v_mfma_f32_16x16x32_bf16 v[152:155], a[172:175], a[88:91], v[152:155]
  buffer_store_dwordx2 v[136:137], v8, s[36:39], s66 offen offset:0 sc1
  v_mul_f32 v252, v252, v26
  v_mul_f32 v253, v253, v27
  v_mul_f32 v254, v254, v28
  v_mfma_f32_16x16x32_bf16 v[152:155], a[168:171], a[72:75], v[152:155]
  v_mul_f32 v255, v255, v29
  v_cvt_pk_bf16_f32 v140, v252, v253
  v_cvt_pk_bf16_f32 v141, v254, v255
  v_mfma_f32_16x16x32_bf16 v[148:151], a[168:171], a[68:71], v[148:151]
  buffer_store_dwordx2 v[140:141], v8, s[36:39], s66 offen offset:1024 sc1
  s_mov_b32 s65, s67
  s_add_u32 s66, s67, 262144
  v_mfma_f32_16x16x32_bf16 v[148:151], a[172:175], a[84:87], v[148:151]
  v_lshrrev_b32 v128, 4, v0
  s_add_u32 s87, s52, s54
  s_and_b32 s87, s87, 3
  s_and_b32 s90, s2, 1
  v_mfma_f32_16x16x32_bf16 v[144:147], a[172:175], a[80:83], v[144:147]
  s_lshl_b32 s89, s53, 7
  s_lshl3_add_u32 s89, s70, s89
  s_mul_i32 s88, s90, 3670016
  s_add_u32 s89, s89, s88
  s_lshr_b32 s88, s44, 1
  v_mfma_f32_16x16x32_bf16 v[144:147], a[168:171], a[64:67], v[144:147]
  s_waitcnt lgkmcnt(4)
  s_mul_i32 s88, s88, 196608
  v_bfe_u32 v129, v128, 4, 2
  v_bfe_u32 v130, v128, 1, 2
  v_xor_b32 v129, v129, v130
  v_mfma_f32_16x16x32_bf16 v[32:35], a[128:131], a[96:99], v[32:35]
  ds_read_b128 a[16:19], v31 offset:256
  v_lshlrev_b32 v129, 5, v129
  v_and_b32 v130, 1, v128
  v_lshl_add_u32 v129, v130, 4, v129
  v_mfma_f32_16x16x32_bf16 v[32:35], a[132:135], a[112:115], v[32:35]
  ds_read_b64_tr_b16 a[152:153], v1 offset:14368
  v_lshrrev_b32 v130, 3, v128
  v_lshlrev_b32 v130, 11, v130
  s_sub_u32 s24, s24, 2048
  v_mfma_f32_16x16x32_bf16 v[36:39], a[132:135], a[116:119], v[36:39]
  s_subb_u32 s25, s25, 0
  s_mov_b32 s26, 7342080
  ds_read_b128 a[20:23], v31 offset:2304
  v_add3_u32 v129, v129, v130, s89
  v_add_u32 v133, 2048, v129
  v_mfma_f32_16x16x32_bf16 v[36:39], a[128:131], a[100:103], v[36:39]
  ds_read_b64_tr_b16 a[154:155], v1 offset:17952
  v_add_u32 v134, 17408, v129
  v_xor_b32 v135, 128, v129
  v_add_u32 v136, 15360, v135
  v_mfma_f32_16x16x32_bf16 v[40:43], a[128:131], a[104:107], v[40:43]
  ds_read_b64_tr_b16 a[156:157], v1 offset:21536
  v_and_b32 v129, 7, v128
  v_lshrrev_b32 v131, 4, v128
  v_xor_b32 v129, v129, v131
  v_mfma_f32_16x16x32_bf16 v[40:43], a[132:135], a[120:123], v[40:43]
  v_lshl_add_u32 v252, v129, 4, v130
  v_xor_b32 v253, 64, v252
  v_add_u32 v253, 16384, v253
  s_lshl2_add_u32 s89, s52, s44
  v_mfma_f32_16x16x32_bf16 v[44:47], a[132:135], a[124:127], v[44:47]
  s_lshl_b32 s89, s89, 18
  s_mul_i32 s91, s90, 114688
  s_add_u32 s89, s89, s91
  s_add_u32 s89, s89, 19922944
  ds_read_b64_tr_b16 a[158:159], v1 offset:25120
  v_mfma_f32_16x16x32_bf16 v[44:47], a[128:131], a[108:111], v[44:47]
  v_add_u32 v137, s89, v0
  v_add_u32 v7, s89, v8
  v_bfe_u32 v129, v128, 3, 2
  v_lshlrev_b32 v129, 5, v129
  v_mfma_f32_16x16x32_bf16 v[156:159], a[136:139], a[108:111], v[156:159]
  ds_read_b64_tr_b16 a[160:161], v1 offset:28704
  v_and_b32 v130, 3, v128
  v_lshl_add_u32 v129, v130, 3, v129
  v_lshrrev_b32 v130, 2, v128
  v_mfma_f32_16x16x32_bf16 v[156:159], a[140:143], a[124:127], v[156:159]
  v_lshl_add_u32 v240, v130, 7, v129
  v_xor_b32 v241, 32, v240
  v_xor_b32 v242, 64, v240
  v_xor_b32 v243, 96, v240
  v_mfma_f32_16x16x32_bf16 v[152:155], a[140:143], a[120:123], v[152:155]
  ds_read_b64_tr_b16 a[162:163], v1 offset:32288
  v_xor_b32 v244, 65536, v240
  v_xor_b32 v245, 65568, v240
  v_xor_b32 v246, 65600, v240
  v_mfma_f32_16x16x32_bf16 v[152:155], a[136:139], a[104:107], v[152:155]
  v_xor_b32 v247, 65632, v240
  v_xor_b32 v248, 131072, v240
  v_xor_b32 v249, 131104, v240
  v_xor_b32 v250, 131136, v240
  v_mfma_f32_16x16x32_bf16 v[148:151], a[136:139], a[100:103], v[148:151]
  ds_read_b64_tr_b16 a[164:165], v1 offset:35872
  v_xor_b32 v251, 131168, v240
  s_lshr_b32 s89, s52, 1
  s_lshl_b32 s89, s89, 5
  v_mfma_f32_16x16x32_bf16 v[148:151], a[140:143], a[116:119], v[148:151]
  s_lshl2_add_u32 s89, s90, s89
  v_and_b32 v129, 3, v128
  v_bfe_u32 v130, v128, 2, 2
  v_lshl_add_u32 v129, v129, 3, v130
  v_add_lshl_u32 v138, v129, s89, 7
  v_mfma_f32_16x16x32_bf16 v[144:147], a[140:143], a[112:115], v[144:147]
  s_mov_b32 s91, 5373952
  ds_read_b64_tr_b16 a[166:167], v1 offset:39456
  v_mul_f32 v22, v10, v32
  v_mul_f32 v23, v10, v33
  v_mul_f32 v24, v10, v34
  v_mfma_f32_16x16x32_bf16 v[144:147], a[136:139], a[96:99], v[144:147]
  s_waitcnt lgkmcnt(4)
  v_mul_f32 v25, v10, v35
  v_exp_f32 v22, v22
  v_mul_f32 v26, v13, v36
  v_mfma_f32_16x16x32_bf16 v[48:51], a[144:147], a[32:35], v[48:51]
  ds_read_b64_tr_b16 a[168:169], v1 offset:43040
  v_exp_f32 v23, v23
  v_mul_f32 v27, v13, v37
  v_mfma_f32_16x16x32_bf16 v[48:51], a[148:151], a[48:51], v[48:51]
  v_exp_f32 v24, v24
  v_mul_f32 v28, v13, v38
  v_mfma_f32_16x16x32_bf16 v[52:55], a[148:151], a[52:55], v[52:55]
  ds_read_b64_tr_b16 a[170:171], v1 offset:46624
  v_exp_f32 v25, v25
  v_mul_f32 v29, v13, v39
  v_mfma_f32_16x16x32_bf16 v[52:55], a[144:147], a[36:39], v[52:55]
  v_exp_f32 v26, v26
  v_fma_f32 v22, v22, v11, v11
  v_mfma_f32_16x16x32_bf16 v[56:59], a[144:147], a[40:43], v[56:59]
  ds_read_b64_tr_b16 a[172:173], v1 offset:50208
  v_exp_f32 v27, v27
  v_fma_f32 v23, v23, v11, v11
  v_mfma_f32_16x16x32_bf16 v[56:59], a[148:151], a[56:59], v[56:59]
  v_exp_f32 v28, v28
  v_fma_f32 v24, v24, v11, v11
  v_mfma_f32_16x16x32_bf16 v[60:63], a[148:151], a[60:63], v[60:63]
  ds_read_b64_tr_b16 a[174:175], v1 offset:53792
  v_exp_f32 v29, v29
  v_fma_f32 v25, v25, v11, v11
  v_mfma_f32_16x16x32_bf16 v[60:63], a[144:147], a[44:47], v[60:63]
  s_waitcnt lgkmcnt(11)
  v_rcp_f32 v22, v22
  v_fma_f32 v26, v26, v14, v14
  v_mfma_f32_16x16x32_bf16 v[48:51], a[16:19], a[0:3], v[48:51]
  ds_read_b64_tr_b16 a[128:129], v2 offset:32
  v_rcp_f32 v23, v23
  v_fma_f32 v27, v27, v14, v14
  v_mfma_f32_16x16x32_bf16 v[52:55], a[16:19], a[4:7], v[52:55]
  v_rcp_f32 v24, v24
  v_fma_f32 v28, v28, v14, v14
  v_mfma_f32_16x16x32_bf16 v[56:59], a[16:19], a[8:11], v[56:59]
  ds_read_b64_tr_b16 a[130:131], v2 offset:3616
  v_rcp_f32 v25, v25
  v_fma_f32 v29, v29, v14, v14
  v_mfma_f32_16x16x32_bf16 v[60:63], a[16:19], a[12:15], v[60:63]
  v_rcp_f32 v26, v26
  v_mul_f32 v144, v32, v144
  v_mfma_f32_16x16x32_bf16 v[160:163], a[20:23], a[0:3], v[160:163]
  ds_read_b64_tr_b16 a[132:133], v2 offset:7200
  v_rcp_f32 v27, v27
  v_mul_f32 v145, v33, v145
  v_mfma_f32_16x16x32_bf16 v[164:167], a[20:23], a[4:7], v[164:167]
  v_rcp_f32 v28, v28
  v_mul_f32 v146, v34, v146
  v_mfma_f32_16x16x32_bf16 v[168:171], a[20:23], a[8:11], v[168:171]
  ds_read_b64_tr_b16 a[134:135], v2 offset:10784
  v_rcp_f32 v29, v29
  v_mul_f32 v147, v35, v147
  v_mfma_f32_16x16x32_bf16 v[172:175], a[20:23], a[12:15], v[172:175]
  v_mul_f32 v144, v144, v22
  v_mul_f32 v145, v145, v23
  v_mul_f32 v146, v146, v24
  v_mul_f32 v147, v147, v25
  v_mfma_f32_16x16x32_bf16 v[172:175], a[152:155], a[44:47], v[172:175]
  ds_read_b64_tr_b16 a[136:137], v2 offset:14368
  v_mul_f32 v22, v16, v40
  v_mul_f32 v23, v16, v41
  v_mul_f32 v24, v16, v42
  v_mul_f32 v25, v16, v43
  v_mfma_f32_16x16x32_bf16 v[172:175], a[156:159], a[60:63], v[172:175]
  v_exp_f32 v22, v22
  v_mul_f32 v148, v36, v148
  v_mfma_f32_16x16x32_bf16 v[168:171], a[156:159], a[56:59], v[168:171]
  ds_read_b64_tr_b16 a[138:139], v2 offset:17952
  v_exp_f32 v23, v23
  v_mul_f32 v149, v37, v149
  v_mfma_f32_16x16x32_bf16 v[168:171], a[152:155], a[40:43], v[168:171]
  v_exp_f32 v24, v24
  v_mul_f32 v150, v38, v150
  v_mfma_f32_16x16x32_bf16 v[164:167], a[152:155], a[36:39], v[164:167]
  ds_read_b64_tr_b16 a[140:141], v2 offset:21536
  v_exp_f32 v25, v25
  v_mul_f32 v151, v39, v151
  v_mfma_f32_16x16x32_bf16 v[164:167], a[156:159], a[52:55], v[164:167]
  v_mul_f32 v148, v148, v26
  v_mul_f32 v149, v149, v27
  v_mul_f32 v150, v150, v28
  v_mul_f32 v151, v151, v29
  v_mfma_f32_16x16x32_bf16 v[160:163], a[156:159], a[48:51], v[160:163]
  ds_read_b64_tr_b16 a[142:143], v2 offset:25120
  v_cvt_pk_bf16_f32 v32, v144, v145
  v_cvt_pk_bf16_f32 v33, v146, v147
  v_mul_f32 v26, v19, v44
  v_mfma_f32_16x16x32_bf16 v[160:163], a[152:155], a[32:35], v[160:163]
  s_waitcnt lgkmcnt(8)
  v_mul_f32 v27, v19, v45
  v_mul_f32 v28, v19, v46
  v_mul_f32 v29, v19, v47
  v_mfma_f32_16x16x32_bf16 v[48:51], a[160:163], a[64:67], v[48:51]
  ds_read_b64_tr_b16 a[144:145], v1 offset:64
  v_exp_f32 v26, v26
  v_fma_f32 v22, v22, v17, v17
  v_mfma_f32_16x16x32_bf16 v[48:51], a[164:167], a[80:83], v[48:51]
  v_exp_f32 v27, v27
  v_fma_f32 v23, v23, v17, v17
  v_mfma_f32_16x16x32_bf16 v[52:55], a[164:167], a[84:87], v[52:55]
  ds_read_b64_tr_b16 a[146:147], v1 offset:3648
  v_exp_f32 v28, v28
  v_fma_f32 v24, v24, v17, v17
  v_mfma_f32_16x16x32_bf16 v[52:55], a[160:163], a[68:71], v[52:55]
  v_exp_f32 v29, v29
  v_fma_f32 v25, v25, v17, v17
  v_cvt_pk_bf16_f32 v36, v148, v149
  v_mfma_f32_16x16x32_bf16 v[56:59], a[160:163], a[72:75], v[56:59]
  ds_read_b64_tr_b16 a[148:149], v1 offset:7232
  v_cvt_pk_bf16_f32 v37, v150, v151
  v_rcp_f32 v22, v22
  v_mfma_f32_16x16x32_bf16 v[56:59], a[164:167], a[88:91], v[56:59]
  v_fma_f32 v26, v26, v20, v20
  v_rcp_f32 v23, v23
  v_fma_f32 v27, v27, v20, v20
  v_mfma_f32_16x16x32_bf16 v[60:63], a[164:167], a[92:95], v[60:63]
  ds_read_b64_tr_b16 a[150:151], v1 offset:10816
  v_rcp_f32 v24, v24
  v_fma_f32 v28, v28, v20, v20
  v_mfma_f32_16x16x32_bf16 v[60:63], a[160:163], a[76:79], v[60:63]
  v_rcp_f32 v25, v25
  v_fma_f32 v29, v29, v20, v20
  v_mfma_f32_16x16x32_bf16 v[172:175], a[168:171], a[76:79], v[172:175]
  v_rcp_f32 v26, v26
  v_mul_f32 v152, v40, v152
  v_mfma_f32_16x16x32_bf16 v[172:175], a[172:175], a[92:95], v[172:175]
  v_rcp_f32 v27, v27
  v_mul_f32 v153, v41, v153
  v_mfma_f32_16x16x32_bf16 v[168:171], a[172:175], a[88:91], v[168:171]
  v_rcp_f32 v28, v28
  v_mul_f32 v154, v42, v154
  v_mfma_f32_16x16x32_bf16 v[168:171], a[168:171], a[72:75], v[168:171]
  v_rcp_f32 v29, v29
  v_mul_f32 v155, v43, v155
  v_mul_f32 v152, v152, v22
  v_mfma_f32_16x16x32_bf16 v[164:167], a[168:171], a[68:71], v[164:167]
  v_mul_f32 v153, v153, v23
  v_mul_f32 v154, v154, v24
  v_mul_f32 v155, v155, v25
  v_mul_f32 v156, v44, v156
  v_mfma_f32_16x16x32_bf16 v[164:167], a[172:175], a[84:87], v[164:167]
  v_mul_f32 v157, v45, v157
  v_mul_f32 v158, v46, v158
  v_mul_f32 v159, v47, v159
  v_cvt_pk_bf16_f32 v40, v152, v153
  v_mfma_f32_16x16x32_bf16 v[160:163], a[172:175], a[80:83], v[160:163]
  v_cvt_pk_bf16_f32 v41, v154, v155
  v_mul_f32 v156, v156, v26
  v_mul_f32 v157, v157, v27
  v_mul_f32 v158, v158, v28
  v_mfma_f32_16x16x32_bf16 v[160:163], a[168:171], a[64:67], v[160:163]
  s_waitcnt lgkmcnt(4)
  v_mul_f32 v159, v159, v29
  v_cvt_pk_bf16_f32 v44, v156, v157
  v_cvt_pk_bf16_f32 v45, v158, v159
  v_mfma_f32_16x16x32_bf16 v[48:51], a[128:131], a[96:99], v[48:51]
  ds_read_b128 a[24:27], v31 offset:512
  v_mfma_f32_16x16x32_bf16 v[48:51], a[132:135], a[112:115], v[48:51]
  ds_read_b64_tr_b16 a[152:153], v1 offset:14400
  v_mfma_f32_16x16x32_bf16 v[52:55], a[132:135], a[116:119], v[52:55]
  ds_read_b128 a[28:31], v31 offset:2560
  v_mfma_f32_16x16x32_bf16 v[52:55], a[128:131], a[100:103], v[52:55]
  s_waitcnt vmcnt(0)
  s_barrier
  ds_read_b64_tr_b16 a[154:155], v1 offset:17984
  v_mfma_f32_16x16x32_bf16 v[56:59], a[128:131], a[104:107], v[56:59]
  s_mov_b64 exec, 1
  buffer_store_dword v9, v0, s[36:39], s45 offen sc1
  s_mov_b64 exec, -1
  s_add_u32 s45, s45, 32768
  v_mfma_f32_16x16x32_bf16 v[56:59], a[132:135], a[120:123], v[56:59]
  ds_read_b64_tr_b16 a[156:157], v1 offset:21568
  v_mfma_f32_16x16x32_bf16 v[60:63], a[132:135], a[124:127], v[60:63]
  ds_read_b64_tr_b16 a[158:159], v1 offset:25152
  v_mfma_f32_16x16x32_bf16 v[60:63], a[128:131], a[108:111], v[60:63]
  v_mfma_f32_16x16x32_bf16 v[172:175], a[136:139], a[108:111], v[172:175]
  ds_read_b64_tr_b16 a[160:161], v1 offset:28736
  v_mul_f32 v22, v10, v48
  v_mul_f32 v23, v10, v49
  v_mul_f32 v24, v10, v50
  v_mfma_f32_16x16x32_bf16 v[172:175], a[140:143], a[124:127], v[172:175]
  v_mul_f32 v25, v10, v51
  v_exp_f32 v22, v22
  v_mul_f32 v26, v13, v52
  v_mfma_f32_16x16x32_bf16 v[168:171], a[140:143], a[120:123], v[168:171]
  ds_read_b64_tr_b16 a[162:163], v1 offset:32320
  v_exp_f32 v23, v23
  v_mul_f32 v27, v13, v53
  v_mfma_f32_16x16x32_bf16 v[168:171], a[136:139], a[104:107], v[168:171]
  v_exp_f32 v24, v24
  v_mul_f32 v28, v13, v54
  v_mfma_f32_16x16x32_bf16 v[164:167], a[136:139], a[100:103], v[164:167]
Hc0_2:
  s_cbranch_execz Rc
  ds_read_b64_tr_b16 a[164:165], v1 offset:35904
  v_exp_f32 v25, v25
  v_mul_f32 v29, v13, v55
  v_mfma_f32_16x16x32_bf16 v[164:167], a[140:143], a[116:119], v[164:167]
  v_exp_f32 v26, v26
  v_fma_f32 v22, v22, v11, v11
  v_mfma_f32_16x16x32_bf16 v[160:163], a[140:143], a[112:115], v[160:163]
  ds_read_b64_tr_b16 a[166:167], v1 offset:39488
  v_exp_f32 v27, v27
  v_fma_f32 v23, v23, v11, v11
  v_mfma_f32_16x16x32_bf16 v[160:163], a[136:139], a[96:99], v[160:163]
  s_waitcnt lgkmcnt(4)
  v_exp_f32 v28, v28
  v_fma_f32 v24, v24, v11, v11
  v_mfma_f32_16x16x32_bf16 v[64:67], a[144:147], a[32:35], v[64:67]
  ds_read_b64_tr_b16 a[168:169], v1 offset:43072
  v_exp_f32 v29, v29
  v_fma_f32 v25, v25, v11, v11
  v_mfma_f32_16x16x32_bf16 v[64:67], a[148:151], a[48:51], v[64:67]
  v_rcp_f32 v22, v22
  v_fma_f32 v26, v26, v14, v14
  v_mfma_f32_16x16x32_bf16 v[68:71], a[148:151], a[52:55], v[68:71]
  ds_read_b64_tr_b16 a[170:171], v1 offset:46656
  v_rcp_f32 v23, v23
  v_fma_f32 v27, v27, v14, v14
  v_mfma_f32_16x16x32_bf16 v[68:71], a[144:147], a[36:39], v[68:71]
  v_rcp_f32 v24, v24
  v_fma_f32 v28, v28, v14, v14
  v_mfma_f32_16x16x32_bf16 v[72:75], a[144:147], a[40:43], v[72:75]
  ds_read_b64_tr_b16 a[172:173], v1 offset:50240
  v_rcp_f32 v25, v25
  v_fma_f32 v29, v29, v14, v14
  v_mfma_f32_16x16x32_bf16 v[72:75], a[148:151], a[56:59], v[72:75]
  v_rcp_f32 v26, v26
  v_mul_f32 v160, v48, v160
  v_mfma_f32_16x16x32_bf16 v[76:79], a[148:151], a[60:63], v[76:79]
  ds_read_b64_tr_b16 a[174:175], v1 offset:53824
  v_rcp_f32 v27, v27
  v_mul_f32 v161, v49, v161
  v_mfma_f32_16x16x32_bf16 v[76:79], a[144:147], a[44:47], v[76:79]
  s_waitcnt lgkmcnt(11)
  v_rcp_f32 v28, v28
  v_mul_f32 v162, v50, v162
  v_mfma_f32_16x16x32_bf16 v[64:67], a[24:27], a[0:3], v[64:67]
  ds_read_b64_tr_b16 a[128:129], v2 offset:64
  v_rcp_f32 v29, v29
  v_mul_f32 v163, v51, v163
  v_mfma_f32_16x16x32_bf16 v[68:71], a[24:27], a[4:7], v[68:71]
  v_mul_f32 v160, v160, v22
  v_mul_f32 v161, v161, v23
  v_mul_f32 v162, v162, v24
  v_mul_f32 v163, v163, v25
  v_mfma_f32_16x16x32_bf16 v[72:75], a[24:27], a[8:11], v[72:75]
  ds_read_b64_tr_b16 a[130:131], v2 offset:3648
  v_mul_f32 v22, v16, v56
  v_mul_f32 v23, v16, v57
  v_mul_f32 v24, v16, v58
  v_mfma_f32_16x16x32_bf16 v[76:79], a[24:27], a[12:15], v[76:79]
  v_mul_f32 v25, v16, v59
  v_exp_f32 v22, v22
  v_mul_f32 v164, v52, v164
  v_mfma_f32_16x16x32_bf16 v[176:179], a[28:31], a[0:3], v[176:179]
  ds_read_b64_tr_b16 a[132:133], v2 offset:7232
  v_exp_f32 v23, v23
  v_mul_f32 v165, v53, v165
  v_mfma_f32_16x16x32_bf16 v[180:183], a[28:31], a[4:7], v[180:183]
  v_exp_f32 v24, v24
  v_mul_f32 v166, v54, v166
  v_mfma_f32_16x16x32_bf16 v[184:187], a[28:31], a[8:11], v[184:187]
  ds_read_b64_tr_b16 a[134:135], v2 offset:10816
  v_exp_f32 v25, v25
  v_mul_f32 v167, v55, v167
  v_mfma_f32_16x16x32_bf16 v[188:191], a[28:31], a[12:15], v[188:191]
  v_mul_f32 v164, v164, v26
  v_mul_f32 v165, v165, v27
  v_mul_f32 v166, v166, v28
  v_mul_f32 v167, v167, v29
  v_mfma_f32_16x16x32_bf16 v[188:191], a[152:155], a[44:47], v[188:191]
  ds_read_b64_tr_b16 a[136:137], v2 offset:14400
  v_cvt_pk_bf16_f32 v34, v160, v161
  v_cvt_pk_bf16_f32 v35, v162, v163
  v_mfma_f32_16x16x32_bf16 v[188:191], a[156:159], a[60:63], v[188:191]
  buffer_store_dwordx4 v[32:35], v0, s[36:39], s65 offen offset:0 sc1
  v_mul_f32 v26, v19, v60
  v_mul_f32 v27, v19, v61
  v_mul_f32 v28, v19, v62
  v_mfma_f32_16x16x32_bf16 v[184:187], a[156:159], a[56:59], v[184:187]
  s_mov_b32 s69, 3
  s_lshl_b32 s50, s69, 16
  s_lshl1_add_u32 s50, s88, s50
  s_add_u32 m0, s70, 94208
  ds_read_b64_tr_b16 a[138:139], v2 offset:17984
  v_mfma_f32_16x16x32_bf16 v[184:187], a[152:155], a[40:43], v[184:187]
  v_mul_f32 v29, v19, v63
  v_exp_f32 v26, v26
  v_fma_f32 v22, v22, v17, v17
  v_mfma_f32_16x16x32_bf16 v[180:183], a[152:155], a[36:39], v[180:183]
  ds_read_b64_tr_b16 a[140:141], v2 offset:21568
  v_exp_f32 v27, v27
  v_fma_f32 v23, v23, v17, v17
  v_mfma_f32_16x16x32_bf16 v[180:183], a[156:159], a[52:55], v[180:183]
  v_exp_f32 v28, v28
  v_fma_f32 v24, v24, v17, v17
  v_mfma_f32_16x16x32_bf16 v[176:179], a[156:159], a[48:51], v[176:179]
  buffer_load_dwordx4 v133, s[24:27], s50 offen offset:0 lds
  v_exp_f32 v29, v29
  v_fma_f32 v25, v25, v17, v17
  v_mfma_f32_16x16x32_bf16 v[176:179], a[152:155], a[32:35], v[176:179]
  s_waitcnt lgkmcnt(7)
  ds_read_b64_tr_b16 a[142:143], v2 offset:25152
  v_cvt_pk_bf16_f32 v38, v164, v165
  v_cvt_pk_bf16_f32 v39, v166, v167
  v_mfma_f32_16x16x32_bf16 v[64:67], a[160:163], a[64:67], v[64:67]
  ds_read_b64_tr_b16 a[144:145], v1 offset:96
  v_mfma_f32_16x16x32_bf16 v[64:67], a[164:167], a[80:83], v[64:67]
  buffer_store_dwordx4 v[36:39], v0, s[36:39], s65 offen offset:1024 sc1
  v_rcp_f32 v22, v22
  v_fma_f32 v26, v26, v20, v20
  v_mfma_f32_16x16x32_bf16 v[68:71], a[164:167], a[84:87], v[68:71]
  ds_read_b64_tr_b16 a[146:147], v1 offset:3680
  v_rcp_f32 v23, v23
  v_fma_f32 v27, v27, v20, v20
  v_mfma_f32_16x16x32_bf16 v[68:71], a[160:163], a[68:71], v[68:71]
  buffer_load_dwordx4 v134, s[24:27], s50 offen offset:1024 lds
  v_rcp_f32 v24, v24
  v_fma_f32 v28, v28, v20, v20
  v_mfma_f32_16x16x32_bf16 v[72:75], a[160:163], a[72:75], v[72:75]
  ds_read_b64_tr_b16 a[148:149], v1 offset:7264
  v_rcp_f32 v25, v25
  v_fma_f32 v29, v29, v20, v20
  v_mfma_f32_16x16x32_bf16 v[72:75], a[164:167], a[88:91], v[72:75]
  v_rcp_f32 v26, v26
  v_mul_f32 v168, v56, v168
  v_mfma_f32_16x16x32_bf16 v[76:79], a[164:167], a[92:95], v[76:79]
  buffer_load_dwordx4 v135, s[24:27], s50 offen offset:2048 lds
  v_rcp_f32 v27, v27
  v_mul_f32 v169, v57, v169
  v_mfma_f32_16x16x32_bf16 v[76:79], a[160:163], a[76:79], v[76:79]
  ds_read_b64_tr_b16 a[150:151], v1 offset:10848
  v_rcp_f32 v28, v28
  v_mul_f32 v170, v58, v170
  v_mfma_f32_16x16x32_bf16 v[188:191], a[168:171], a[76:79], v[188:191]
  v_rcp_f32 v29, v29
  v_mul_f32 v171, v59, v171
  v_mul_f32 v168, v168, v22
  v_mfma_f32_16x16x32_bf16 v[188:191], a[172:175], a[92:95], v[188:191]
  v_mul_f32 v169, v169, v23
  v_mul_f32 v170, v170, v24
  v_mul_f32 v171, v171, v25
  v_mul_f32 v172, v60, v172
  v_mfma_f32_16x16x32_bf16 v[184:187], a[172:175], a[88:91], v[184:187]
  buffer_load_dwordx4 v136, s[24:27], s50 offen offset:3072 lds
  s_mov_b32 s71, 17
  s_lshl_b32 s50, s71, 16
  s_lshl1_add_u32 s50, s88, s50
  v_mfma_f32_16x16x32_bf16 v[184:187], a[168:171], a[72:75], v[184:187]
  s_add_u32 m0, s70, 110592
  v_mul_f32 v173, v61, v173
  v_mul_f32 v174, v62, v174
  v_mul_f32 v175, v63, v175
  v_cvt_pk_bf16_f32 v42, v168, v169
  v_mfma_f32_16x16x32_bf16 v[180:183], a[168:171], a[68:71], v[180:183]
  v_cvt_pk_bf16_f32 v43, v170, v171
  v_mfma_f32_16x16x32_bf16 v[180:183], a[172:175], a[84:87], v[180:183]
  buffer_store_dwordx4 v[40:43], v0, s[36:39], s66 offen offset:0 sc1
  v_mul_f32 v172, v172, v26
  v_mul_f32 v173, v173, v27
  v_mul_f32 v174, v174, v28
  v_mfma_f32_16x16x32_bf16 v[176:179], a[172:175], a[80:83], v[176:179]
  v_mul_f32 v175, v175, v29
  v_cvt_pk_bf16_f32 v46, v172, v173
  v_cvt_pk_bf16_f32 v47, v174, v175
  v_mfma_f32_16x16x32_bf16 v[176:179], a[168:171], a[64:67], v[176:179]
  s_waitcnt lgkmcnt(4)
  buffer_load_dwordx4 v133, s[24:27], s50 offen offset:0 lds
  v_mfma_f32_16x16x32_bf16 v[64:67], a[128:131], a[96:99], v[64:67]
  ds_read_b128 a[16:19], v31 offset:768
  v_mfma_f32_16x16x32_bf16 v[64:67], a[132:135], a[112:115], v[64:67]
  ds_read_b64_tr_b16 a[152:153], v1 offset:14432
  v_mfma_f32_16x16x32_bf16 v[68:71], a[132:135], a[116:119], v[68:71]
  ds_read_b128 a[20:23], v31 offset:2816
  v_mfma_f32_16x16x32_bf16 v[68:71], a[128:131], a[100:103], v[68:71]
  buffer_load_dwordx4 v134, s[24:27], s50 offen offset:1024 lds
  v_mfma_f32_16x16x32_bf16 v[72:75], a[128:131], a[104:107], v[72:75]
  ds_read_b64_tr_b16 a[154:155], v1 offset:18016
  v_mfma_f32_16x16x32_bf16 v[72:75], a[132:135], a[120:123], v[72:75]
  ds_read_b64_tr_b16 a[156:157], v1 offset:21600
  v_mfma_f32_16x16x32_bf16 v[76:79], a[132:135], a[124:127], v[76:79]
  buffer_store_dwordx4 v[44:47], v0, s[36:39], s66 offen offset:1024 sc1
  s_add_u32 s65, s65, 2048
  s_add_u32 s66, s66, 2048
  v_mfma_f32_16x16x32_bf16 v[76:79], a[128:131], a[108:111], v[76:79]
  ds_read_b64_tr_b16 a[158:159], v1 offset:25184
  v_mfma_f32_16x16x32_bf16 v[188:191], a[136:139], a[108:111], v[188:191]
  buffer_load_dwordx4 v135, s[24:27], s50 offen offset:2048 lds
  v_mul_f32 v22, v10, v64
  v_mul_f32 v23, v10, v65
  v_mul_f32 v24, v10, v66
  v_mfma_f32_16x16x32_bf16 v[188:191], a[140:143], a[124:127], v[188:191]
  ds_read_b64_tr_b16 a[160:161], v1 offset:28768
  v_mul_f32 v25, v10, v67
  v_exp_f32 v22, v22
  v_mfma_f32_16x16x32_bf16 v[184:187], a[140:143], a[120:123], v[184:187]
  buffer_load_dwordx4 v136, s[24:27], s50 offen offset:3072 lds
  s_mov_b32 s72, 31
  s_lshl_b32 s50, s72, 16
  s_lshl1_add_u32 s50, s88, s50
  v_mfma_f32_16x16x32_bf16 v[184:187], a[136:139], a[104:107], v[184:187]
  s_add_u32 m0, s70, 126976
  ds_read_b64_tr_b16 a[162:163], v1 offset:32352
  v_mul_f32 v26, v13, v68
  v_exp_f32 v23, v23
  v_mfma_f32_16x16x32_bf16 v[180:183], a[136:139], a[100:103], v[180:183]
  ds_read_b64_tr_b16 a[164:165], v1 offset:35936
  v_mul_f32 v27, v13, v69
  v_exp_f32 v24, v24
  v_mfma_f32_16x16x32_bf16 v[180:183], a[140:143], a[116:119], v[180:183]
  v_mul_f32 v28, v13, v70
  v_exp_f32 v25, v25
  v_mul_f32 v29, v13, v71
  v_mfma_f32_16x16x32_bf16 v[176:179], a[140:143], a[112:115], v[176:179]
  buffer_load_dwordx4 v133, s[24:27], s50 offen offset:0 lds
  v_exp_f32 v26, v26
  v_fma_f32 v22, v22, v11, v11
  v_mfma_f32_16x16x32_bf16 v[176:179], a[136:139], a[96:99], v[176:179]
  s_waitcnt lgkmcnt(3)
  ds_read_b64_tr_b16 a[166:167], v1 offset:39520
  v_exp_f32 v27, v27
  v_fma_f32 v23, v23, v11, v11
  v_mfma_f32_16x16x32_bf16 v[80:83], a[144:147], a[32:35], v[80:83]
  ds_read_b64_tr_b16 a[168:169], v1 offset:43104
  v_exp_f32 v28, v28
  v_fma_f32 v24, v24, v11, v11
  v_mfma_f32_16x16x32_bf16 v[80:83], a[148:151], a[48:51], v[80:83]
  v_exp_f32 v29, v29
  v_fma_f32 v25, v25, v11, v11
  v_mfma_f32_16x16x32_bf16 v[84:87], a[148:151], a[52:55], v[84:87]
  buffer_load_dwordx4 v134, s[24:27], s50 offen offset:1024 lds
  v_rcp_f32 v22, v22
  v_fma_f32 v26, v26, v14, v14
  v_mfma_f32_16x16x32_bf16 v[84:87], a[144:147], a[36:39], v[84:87]
  ds_read_b64_tr_b16 a[170:171], v1 offset:46688
  v_rcp_f32 v23, v23
  v_fma_f32 v27, v27, v14, v14
  v_mfma_f32_16x16x32_bf16 v[88:91], a[144:147], a[40:43], v[88:91]
  ds_read_b64_tr_b16 a[172:173], v1 offset:50272
  v_rcp_f32 v24, v24
  v_fma_f32 v28, v28, v14, v14
  v_mfma_f32_16x16x32_bf16 v[88:91], a[148:151], a[56:59], v[88:91]
  v_rcp_f32 v25, v25
  v_fma_f32 v29, v29, v14, v14
  v_mfma_f32_16x16x32_bf16 v[92:95], a[148:151], a[60:63], v[92:95]
  buffer_load_dwordx4 v135, s[24:27], s50 offen offset:2048 lds
  v_rcp_f32 v26, v26
  v_mul_f32 v176, v64, v176
  v_mfma_f32_16x16x32_bf16 v[92:95], a[144:147], a[44:47], v[92:95]
  s_waitcnt lgkmcnt(10)
  ds_read_b64_tr_b16 a[174:175], v1 offset:53856
  v_rcp_f32 v27, v27
  v_mul_f32 v177, v65, v177
  v_mfma_f32_16x16x32_bf16 v[80:83], a[16:19], a[0:3], v[80:83]
  ds_read_b64_tr_b16 a[128:129], v2 offset:96
  v_rcp_f32 v28, v28
  v_mul_f32 v178, v66, v178
  v_mfma_f32_16x16x32_bf16 v[84:87], a[16:19], a[4:7], v[84:87]
  v_rcp_f32 v29, v29
  v_mul_f32 v179, v67, v179
  v_mul_f32 v176, v176, v22
  v_mfma_f32_16x16x32_bf16 v[88:91], a[16:19], a[8:11], v[88:91]
  buffer_load_dwordx4 v136, s[24:27], s50 offen offset:3072 lds
  s_mov_b32 s73, 45
  s_lshl_b32 s50, s73, 16
  s_lshl1_add_u32 s50, s88, s50
  v_mfma_f32_16x16x32_bf16 v[92:95], a[16:19], a[12:15], v[92:95]
  s_add_u32 m0, s70, 143360
  ds_read_b64_tr_b16 a[130:131], v2 offset:3680
  v_mul_f32 v177, v177, v23
  v_mul_f32 v178, v178, v24
  v_mul_f32 v179, v179, v25
  v_mfma_f32_16x16x32_bf16 v[192:195], a[20:23], a[0:3], v[192:195]
  ds_read_b64_tr_b16 a[132:133], v2 offset:7264
  v_mul_f32 v22, v16, v72
  v_mul_f32 v23, v16, v73
  v_mul_f32 v24, v16, v74
  v_mfma_f32_16x16x32_bf16 v[196:199], a[20:23], a[4:7], v[196:199]
  v_mul_f32 v25, v16, v75
  v_exp_f32 v22, v22
  v_mul_f32 v180, v68, v180
  v_mfma_f32_16x16x32_bf16 v[200:203], a[20:23], a[8:11], v[200:203]
  buffer_load_dwordx4 v133, s[24:27], s50 offen offset:0 lds
  v_exp_f32 v23, v23
  v_mul_f32 v181, v69, v181
  v_mfma_f32_16x16x32_bf16 v[204:207], a[20:23], a[12:15], v[204:207]
  ds_read_b64_tr_b16 a[134:135], v2 offset:10848
  v_exp_f32 v24, v24
  v_mul_f32 v182, v70, v182
  v_mfma_f32_16x16x32_bf16 v[204:207], a[152:155], a[44:47], v[204:207]
  ds_read_b64_tr_b16 a[136:137], v2 offset:14432
  v_exp_f32 v25, v25
  v_mul_f32 v183, v71, v183
  v_mfma_f32_16x16x32_bf16 v[204:207], a[156:159], a[60:63], v[204:207]
  v_mul_f32 v180, v180, v26
  v_mul_f32 v181, v181, v27
  v_mul_f32 v182, v182, v28
  v_mul_f32 v183, v183, v29
  v_mfma_f32_16x16x32_bf16 v[200:203], a[156:159], a[56:59], v[200:203]
  buffer_load_dwordx4 v134, s[24:27], s50 offen offset:1024 lds
  v_cvt_pk_bf16_f32 v64, v176, v177
  v_cvt_pk_bf16_f32 v65, v178, v179
  v_mul_f32 v26, v19, v76
  v_mfma_f32_16x16x32_bf16 v[200:203], a[152:155], a[40:43], v[200:203]
  ds_read_b64_tr_b16 a[138:139], v2 offset:18016
  v_mul_f32 v27, v19, v77
  v_mul_f32 v28, v19, v78
  v_mul_f32 v29, v19, v79
  v_mfma_f32_16x16x32_bf16 v[196:199], a[152:155], a[36:39], v[196:199]
  ds_read_b64_tr_b16 a[140:141], v2 offset:21600
  v_exp_f32 v26, v26
  v_fma_f32 v22, v22, v17, v17
  v_mfma_f32_16x16x32_bf16 v[196:199], a[156:159], a[52:55], v[196:199]
  v_exp_f32 v27, v27
  v_fma_f32 v23, v23, v17, v17
  v_mfma_f32_16x16x32_bf16 v[192:195], a[156:159], a[48:51], v[192:195]
  buffer_load_dwordx4 v135, s[24:27], s50 offen offset:2048 lds
  v_exp_f32 v28, v28
  v_fma_f32 v24, v24, v17, v17
  v_mfma_f32_16x16x32_bf16 v[192:195], a[152:155], a[32:35], v[192:195]
  s_waitcnt lgkmcnt(7)
  ds_read_b64_tr_b16 a[142:143], v2 offset:25184
  v_exp_f32 v29, v29
  v_fma_f32 v25, v25, v17, v17
  v_mfma_f32_16x16x32_bf16 v[80:83], a[160:163], a[64:67], v[80:83]
  ds_read_b64_tr_b16 a[144:145], v1 offset:128
  v_cvt_pk_bf16_f32 v68, v180, v181
  v_cvt_pk_bf16_f32 v69, v182, v183
  v_mfma_f32_16x16x32_bf16 v[80:83], a[164:167], a[80:83], v[80:83]
  v_rcp_f32 v22, v22
  v_fma_f32 v26, v26, v20, v20
  v_mfma_f32_16x16x32_bf16 v[84:87], a[164:167], a[84:87], v[84:87]
  buffer_load_dwordx4 v136, s[24:27], s50 offen offset:3072 lds
  v_rcp_f32 v23, v23
  v_fma_f32 v27, v27, v20, v20
  v_mfma_f32_16x16x32_bf16 v[84:87], a[160:163], a[68:71], v[84:87]
  ds_read_b64_tr_b16 a[146:147], v1 offset:3712
  v_rcp_f32 v24, v24
  v_fma_f32 v28, v28, v20, v20
  v_mfma_f32_16x16x32_bf16 v[88:91], a[160:163], a[72:75], v[88:91]
  ds_read_b64_tr_b16 a[148:149], v1 offset:7296
  v_rcp_f32 v25, v25
  v_fma_f32 v29, v29, v20, v20
  v_mfma_f32_16x16x32_bf16 v[88:91], a[164:167], a[88:91], v[88:91]
  v_rcp_f32 v26, v26
  v_mul_f32 v184, v72, v184
  v_mfma_f32_16x16x32_bf16 v[92:95], a[164:167], a[92:95], v[92:95]
  ds_read_b64_tr_b16 a[150:151], v1 offset:10880
  v_rcp_f32 v27, v27
  v_mul_f32 v185, v73, v185
  v_mfma_f32_16x16x32_bf16 v[92:95], a[160:163], a[76:79], v[92:95]
  v_rcp_f32 v28, v28
  v_mul_f32 v186, v74, v186
  v_mfma_f32_16x16x32_bf16 v[204:207], a[168:171], a[76:79], v[204:207]
  v_rcp_f32 v29, v29
  v_mul_f32 v187, v75, v187
  v_mul_f32 v184, v184, v22
  v_mfma_f32_16x16x32_bf16 v[204:207], a[172:175], a[92:95], v[204:207]
  v_mul_f32 v185, v185, v23
  v_mul_f32 v186, v186, v24
  v_mul_f32 v187, v187, v25
  v_mul_f32 v188, v76, v188
  v_mfma_f32_16x16x32_bf16 v[200:203], a[172:175], a[88:91], v[200:203]
  v_mul_f32 v189, v77, v189
  v_mul_f32 v190, v78, v190
  v_mul_f32 v191, v79, v191
  v_cvt_pk_bf16_f32 v72, v184, v185
  v_mfma_f32_16x16x32_bf16 v[200:203], a[168:171], a[72:75], v[200:203]
  v_cvt_pk_bf16_f32 v73, v186, v187
  v_mul_f32 v188, v188, v26
  v_mul_f32 v189, v189, v27
  v_mul_f32 v190, v190, v28
  v_mfma_f32_16x16x32_bf16 v[196:199], a[168:171], a[68:71], v[196:199]
  v_mul_f32 v191, v191, v29
  v_cvt_pk_bf16_f32 v76, v188, v189
  v_cvt_pk_bf16_f32 v77, v190, v191
  v_mfma_f32_16x16x32_bf16 v[196:199], a[172:175], a[84:87], v[196:199]
  v_mfma_f32_16x16x32_bf16 v[192:195], a[172:175], a[80:83], v[192:195]
  buffer_load_dword v139, v138, s[36:39], s91 offen sc1
  v_mfma_f32_16x16x32_bf16 v[192:195], a[168:171], a[64:67], v[192:195]
  s_waitcnt lgkmcnt(4)
  v_mfma_f32_16x16x32_bf16 v[80:83], a[128:131], a[96:99], v[80:83]
  ds_read_b128 a[24:27], v31 offset:1024
  v_mfma_f32_16x16x32_bf16 v[80:83], a[132:135], a[112:115], v[80:83]
  ds_read_b64_tr_b16 a[152:153], v1 offset:14464
  v_mfma_f32_16x16x32_bf16 v[84:87], a[132:135], a[116:119], v[84:87]
  ds_read_b128 a[28:31], v31 offset:3072
  v_mfma_f32_16x16x32_bf16 v[84:87], a[128:131], a[100:103], v[84:87]
  ds_read_b64_tr_b16 a[154:155], v1 offset:18048
  v_mfma_f32_16x16x32_bf16 v[88:91], a[128:131], a[104:107], v[88:91]
  ds_read_b64_tr_b16 a[156:157], v1 offset:21632
  v_mfma_f32_16x16x32_bf16 v[88:91], a[132:135], a[120:123], v[88:91]
  v_mfma_f32_16x16x32_bf16 v[92:95], a[132:135], a[124:127], v[92:95]
  ds_read_b64_tr_b16 a[158:159], v1 offset:25216
  v_mfma_f32_16x16x32_bf16 v[92:95], a[128:131], a[108:111], v[92:95]
  v_mfma_f32_16x16x32_bf16 v[204:207], a[136:139], a[108:111], v[204:207]
  ds_read_b64_tr_b16 a[160:161], v1 offset:28800
  v_mul_f32 v22, v10, v80
  v_mul_f32 v23, v10, v81
  v_mul_f32 v24, v10, v82
  v_mfma_f32_16x16x32_bf16 v[204:207], a[140:143], a[124:127], v[204:207]
  v_mul_f32 v25, v10, v83
  v_exp_f32 v22, v22
  v_mul_f32 v26, v13, v84
  v_mfma_f32_16x16x32_bf16 v[200:203], a[140:143], a[120:123], v[200:203]
  ds_read_b64_tr_b16 a[162:163], v1 offset:32384
  v_exp_f32 v23, v23
  v_mul_f32 v27, v13, v85
  v_mfma_f32_16x16x32_bf16 v[200:203], a[136:139], a[104:107], v[200:203]
  s_waitcnt vmcnt(11)
  s_barrier
  v_exp_f32 v24, v24
  v_mul_f32 v28, v13, v86
  v_mfma_f32_16x16x32_bf16 v[196:199], a[136:139], a[100:103], v[196:199]
  s_mov_b64 exec, 1
  buffer_store_dword v9, v0, s[36:39], s45 offen sc1
  s_mov_b64 exec, -1
  s_add_u32 s45, s45, 32768
  v_mfma_f32_16x16x32_bf16 v[196:199], a[140:143], a[116:119], v[196:199]
  ds_read_b64_tr_b16 a[164:165], v1 offset:35968
  v_exp_f32 v25, v25
  v_mul_f32 v29, v13, v87
  v_mfma_f32_16x16x32_bf16 v[192:195], a[140:143], a[112:115], v[192:195]
  ds_read_b64_tr_b16 a[166:167], v1 offset:39552
  v_exp_f32 v26, v26
  v_fma_f32 v22, v22, v11, v11
  v_mfma_f32_16x16x32_bf16 v[192:195], a[136:139], a[96:99], v[192:195]
  s_waitcnt lgkmcnt(4)
  v_exp_f32 v27, v27
  v_fma_f32 v23, v23, v11, v11
  v_mfma_f32_16x16x32_bf16 v[96:99], a[144:147], a[32:35], v[96:99]
  ds_read_b64_tr_b16 a[168:169], v1 offset:43136
  v_exp_f32 v28, v28
  v_fma_f32 v24, v24, v11, v11
  v_mfma_f32_16x16x32_bf16 v[96:99], a[148:151], a[48:51], v[96:99]
  v_exp_f32 v29, v29
  v_fma_f32 v25, v25, v11, v11
  v_mfma_f32_16x16x32_bf16 v[100:103], a[148:151], a[52:55], v[100:103]
  ds_read_b64_tr_b16 a[170:171], v1 offset:46720
  v_rcp_f32 v22, v22
  v_fma_f32 v26, v26, v14, v14
  v_mfma_f32_16x16x32_bf16 v[100:103], a[144:147], a[36:39], v[100:103]
  v_rcp_f32 v23, v23
  v_fma_f32 v27, v27, v14, v14
  v_mfma_f32_16x16x32_bf16 v[104:107], a[144:147], a[40:43], v[104:107]
  ds_read_b64_tr_b16 a[172:173], v1 offset:50304
  v_rcp_f32 v24, v24
  v_fma_f32 v28, v28, v14, v14
  v_mfma_f32_16x16x32_bf16 v[104:107], a[148:151], a[56:59], v[104:107]
  v_rcp_f32 v25, v25
  v_fma_f32 v29, v29, v14, v14
  v_mfma_f32_16x16x32_bf16 v[108:111], a[148:151], a[60:63], v[108:111]
  ds_read_b64_tr_b16 a[174:175], v1 offset:53888
  v_rcp_f32 v26, v26
  v_mul_f32 v192, v80, v192
  v_mfma_f32_16x16x32_bf16 v[108:111], a[144:147], a[44:47], v[108:111]
  s_waitcnt lgkmcnt(11)
  v_rcp_f32 v27, v27
  v_mul_f32 v193, v81, v193
  v_mfma_f32_16x16x32_bf16 v[96:99], a[24:27], a[0:3], v[96:99]
  ds_read_b64_tr_b16 a[128:129], v2 offset:128
  v_rcp_f32 v28, v28
  v_mul_f32 v194, v82, v194
  v_mfma_f32_16x16x32_bf16 v[100:103], a[24:27], a[4:7], v[100:103]
  v_rcp_f32 v29, v29
  v_mul_f32 v195, v83, v195
  v_mul_f32 v192, v192, v22
  v_mfma_f32_16x16x32_bf16 v[104:107], a[24:27], a[8:11], v[104:107]
  ds_read_b64_tr_b16 a[130:131], v2 offset:3712
  v_mul_f32 v193, v193, v23
  v_mul_f32 v194, v194, v24
  v_mul_f32 v195, v195, v25
  v_mfma_f32_16x16x32_bf16 v[108:111], a[24:27], a[12:15], v[108:111]
  v_mul_f32 v22, v16, v88
  v_mul_f32 v23, v16, v89
  v_mul_f32 v24, v16, v90
  v_mul_f32 v25, v16, v91
  v_mfma_f32_16x16x32_bf16 v[208:211], a[28:31], a[0:3], v[208:211]
  ds_read_b64_tr_b16 a[132:133], v2 offset:7296
  v_exp_f32 v22, v22
  v_mul_f32 v196, v84, v196
  v_mfma_f32_16x16x32_bf16 v[212:215], a[28:31], a[4:7], v[212:215]
  v_exp_f32 v23, v23
  v_mul_f32 v197, v85, v197
  v_mfma_f32_16x16x32_bf16 v[216:219], a[28:31], a[8:11], v[216:219]
  s_waitcnt vmcnt(1)
  v_cmp_ne_u32 vcc, s3, v139
  s_nop 4
  s_cbranch_vccnz CK8s
CK8x:
  v_mfma_f32_16x16x32_bf16 v[220:223], a[28:31], a[12:15], v[220:223]
  s_lshl_b32 s51, s69, 11
  s_add_u32 s91, s91, 32768
  ds_read_b64_tr_b16 a[134:135], v2 offset:10880
  v_exp_f32 v24, v24
  v_mfma_f32_16x16x32_bf16 v[220:223], a[152:155], a[44:47], v[220:223]
  buffer_load_dwordx2 a[216:217], v7, s[36:39], s51 offen offset:0 sc1
  v_mul_f32 v198, v86, v198
  v_exp_f32 v25, v25
  v_mfma_f32_16x16x32_bf16 v[220:223], a[156:159], a[60:63], v[220:223]
  ds_read_b64_tr_b16 a[136:137], v2 offset:14464
  v_mul_f32 v199, v87, v199
  v_mul_f32 v196, v196, v26
  v_mul_f32 v197, v197, v27
  v_mfma_f32_16x16x32_bf16 v[216:219], a[156:159], a[56:59], v[216:219]
  buffer_load_dwordx2 a[218:219], v7, s[36:39], s51 offen offset:512 sc1
  v_mul_f32 v198, v198, v28
  v_mul_f32 v199, v199, v29
  v_cvt_pk_bf16_f32 v66, v192, v193
  v_mfma_f32_16x16x32_bf16 v[216:219], a[152:155], a[40:43], v[216:219]
  ds_read_b64_tr_b16 a[138:139], v2 offset:18048
  v_cvt_pk_bf16_f32 v67, v194, v195
  v_mfma_f32_16x16x32_bf16 v[212:215], a[152:155], a[36:39], v[212:215]
  buffer_load_dwordx2 a[220:221], v7, s[36:39], s51 offen offset:1024 sc1
  v_mfma_f32_16x16x32_bf16 v[212:215], a[156:159], a[52:55], v[212:215]
  ds_read_b64_tr_b16 a[140:141], v2 offset:21632
  v_mfma_f32_16x16x32_bf16 v[208:211], a[156:159], a[48:51], v[208:211]
  buffer_load_dwordx2 a[222:223], v7, s[36:39], s51 offen offset:1536 sc1
  s_add_u32 s51, s51, 12288
  v_mfma_f32_16x16x32_bf16 v[208:211], a[152:155], a[32:35], v[208:211]
  s_waitcnt lgkmcnt(7)
  ds_read_b64_tr_b16 a[142:143], v2 offset:25216
  v_mfma_f32_16x16x32_bf16 v[96:99], a[160:163], a[64:67], v[96:99]
  buffer_load_dwordx2 a[224:225], v7, s[36:39], s51 offen offset:2048 sc1
  v_mfma_f32_16x16x32_bf16 v[96:99], a[164:167], a[80:83], v[96:99]
  ds_read_b64_tr_b16 a[144:145], v1 offset:160
  v_mfma_f32_16x16x32_bf16 v[100:103], a[164:167], a[84:87], v[100:103]
  buffer_load_dwordx2 a[226:227], v7, s[36:39], s51 offen offset:2560 sc1
  v_mfma_f32_16x16x32_bf16 v[100:103], a[160:163], a[68:71], v[100:103]
  ds_read_b64_tr_b16 a[146:147], v1 offset:3744
  v_mfma_f32_16x16x32_bf16 v[104:107], a[160:163], a[72:75], v[104:107]
  buffer_load_dwordx2 a[228:229], v7, s[36:39], s51 offen offset:3072 sc1
  v_mfma_f32_16x16x32_bf16 v[104:107], a[164:167], a[88:91], v[104:107]
  ds_read_b64_tr_b16 a[148:149], v1 offset:7328
  v_mfma_f32_16x16x32_bf16 v[108:111], a[164:167], a[92:95], v[108:111]
  buffer_load_dwordx2 a[230:231], v7, s[36:39], s51 offen offset:3584 sc1
  s_lshl_b32 s51, s71, 11
  v_mfma_f32_16x16x32_bf16 v[108:111], a[160:163], a[76:79], v[108:111]
  ds_read_b64_tr_b16 a[150:151], v1 offset:10912
  v_mfma_f32_16x16x32_bf16 v[220:223], a[168:171], a[76:79], v[220:223]
  buffer_load_dwordx2 v[176:177], v7, s[36:39], s51 offen offset:0 sc1
  v_mfma_f32_16x16x32_bf16 v[220:223], a[172:175], a[92:95], v[220:223]
  v_mfma_f32_16x16x32_bf16 v[216:219], a[172:175], a[88:91], v[216:219]
  buffer_load_dwordx2 v[178:179], v7, s[36:39], s51 offen offset:512 sc1
  v_mfma_f32_16x16x32_bf16 v[216:219], a[168:171], a[72:75], v[216:219]
  v_mfma_f32_16x16x32_bf16 v[212:215], a[168:171], a[68:71], v[212:215]
  buffer_load_dwordx2 v[180:181], v7, s[36:39], s51 offen offset:1024 sc1
  v_mfma_f32_16x16x32_bf16 v[212:215], a[172:175], a[84:87], v[212:215]
  v_mfma_f32_16x16x32_bf16 v[208:211], a[172:175], a[80:83], v[208:211]
  buffer_load_dwordx2 v[182:183], v7, s[36:39], s51 offen offset:1536 sc1
  s_add_u32 s51, s51, 12288
  v_mfma_f32_16x16x32_bf16 v[208:211], a[168:171], a[64:67], v[208:211]
  s_waitcnt lgkmcnt(4)
  v_mfma_f32_16x16x32_bf16 v[96:99], a[128:131], a[96:99], v[96:99]
  buffer_load_dwordx2 v[184:185], v7, s[36:39], s51 offen offset:2048 sc1
  v_mfma_f32_16x16x32_bf16 v[96:99], a[132:135], a[112:115], v[96:99]
  ds_read_b128 a[16:19], v31 offset:1280
  v_mfma_f32_16x16x32_bf16 v[100:103], a[132:135], a[116:119], v[100:103]
  buffer_load_dwordx2 v[186:187], v7, s[36:39], s51 offen offset:2560 sc1
  v_mfma_f32_16x16x32_bf16 v[100:103], a[128:131], a[100:103], v[100:103]
  ds_read_b64_tr_b16 a[152:153], v1 offset:14496
  v_mfma_f32_16x16x32_bf16 v[104:107], a[128:131], a[104:107], v[104:107]
  buffer_load_dwordx2 v[188:189], v7, s[36:39], s51 offen offset:3072 sc1
  v_mfma_f32_16x16x32_bf16 v[104:107], a[132:135], a[120:123], v[104:107]
  ds_read_b128 a[20:23], v31 offset:3328
  v_mfma_f32_16x16x32_bf16 v[108:111], a[132:135], a[124:127], v[108:111]
  buffer_load_dwordx2 v[190:191], v7, s[36:39], s51 offen offset:3584 sc1
  v_mfma_f32_16x16x32_bf16 v[108:111], a[128:131], a[108:111], v[108:111]
  ds_read_b64_tr_b16 a[154:155], v1 offset:18080
  v_mfma_f32_16x16x32_bf16 v[220:223], a[136:139], a[108:111], v[220:223]
  ds_read_b64_tr_b16 a[156:157], v1 offset:21664
  v_mfma_f32_16x16x32_bf16 v[220:223], a[140:143], a[124:127], v[220:223]
  ds_read_b64_tr_b16 a[158:159], v1 offset:25248
  v_mfma_f32_16x16x32_bf16 v[216:219], a[140:143], a[120:123], v[216:219]
  ds_read_b64_tr_b16 a[160:161], v1 offset:28832
  v_mfma_f32_16x16x32_bf16 v[216:219], a[136:139], a[104:107], v[216:219]
  ds_read_b64_tr_b16 a[162:163], v1 offset:32416
  v_mfma_f32_16x16x32_bf16 v[212:215], a[136:139], a[100:103], v[212:215]
  ds_read_b64_tr_b16 a[164:165], v1 offset:36000
  v_mfma_f32_16x16x32_bf16 v[212:215], a[140:143], a[116:119], v[212:215]
  buffer_store_dwordx4 v[64:67], v0, s[36:39], s65 offen offset:0 sc1
  v_mul_f32 v26, v19, v92
  v_mul_f32 v27, v19, v93
  v_mul_f32 v28, v19, v94
  v_mfma_f32_16x16x32_bf16 v[208:211], a[140:143], a[112:115], v[208:211]
  ds_read_b64_tr_b16 a[166:167], v1 offset:39584
  v_mul_f32 v29, v19, v95
  v_exp_f32 v26, v26
  v_mfma_f32_16x16x32_bf16 v[208:211], a[136:139], a[96:99], v[208:211]
  s_waitcnt lgkmcnt(4)
  v_fma_f32 v22, v22, v17, v17
  v_exp_f32 v27, v27
  v_fma_f32 v23, v23, v17, v17
  v_mfma_f32_16x16x32_bf16 v[112:115], a[144:147], a[32:35], v[112:115]
  ds_read_b64_tr_b16 a[168:169], v1 offset:43168
  v_exp_f32 v28, v28
  v_fma_f32 v24, v24, v17, v17
  v_mfma_f32_16x16x32_bf16 v[112:115], a[148:151], a[48:51], v[112:115]
  v_exp_f32 v29, v29
  v_fma_f32 v25, v25, v17, v17
  v_cvt_pk_bf16_f32 v70, v196, v197
  v_mfma_f32_16x16x32_bf16 v[116:119], a[148:151], a[52:55], v[116:119]
  ds_read_b64_tr_b16 a[170:171], v1 offset:46752
  v_cvt_pk_bf16_f32 v71, v198, v199
  v_mfma_f32_16x16x32_bf16 v[116:119], a[144:147], a[36:39], v[116:119]
  buffer_store_dwordx4 v[68:71], v0, s[36:39], s65 offen offset:1024 sc1
  v_rcp_f32 v22, v22
  v_fma_f32 v26, v26, v20, v20
  v_mfma_f32_16x16x32_bf16 v[120:123], a[144:147], a[40:43], v[120:123]
  ds_read_b64_tr_b16 a[172:173], v1 offset:50336
  v_rcp_f32 v23, v23
  v_fma_f32 v27, v27, v20, v20
  v_mfma_f32_16x16x32_bf16 v[120:123], a[148:151], a[56:59], v[120:123]
  v_rcp_f32 v24, v24
  v_fma_f32 v28, v28, v20, v20
  v_mfma_f32_16x16x32_bf16 v[124:127], a[148:151], a[60:63], v[124:127]
  ds_read_b64_tr_b16 a[174:175], v1 offset:53920
  v_rcp_f32 v25, v25
  v_fma_f32 v29, v29, v20, v20
  v_mfma_f32_16x16x32_bf16 v[124:127], a[144:147], a[44:47], v[124:127]
  s_waitcnt lgkmcnt(11)
  v_rcp_f32 v26, v26
  v_mul_f32 v200, v88, v200
  v_mfma_f32_16x16x32_bf16 v[112:115], a[16:19], a[0:3], v[112:115]
  v_rcp_f32 v27, v27
  v_mul_f32 v201, v89, v201
  v_rcp_f32 v28, v28
  v_mul_f32 v202, v90, v202
  v_rcp_f32 v29, v29
  v_mul_f32 v203, v91, v203
  v_mul_f32 v200, v200, v22
  v_mul_f32 v201, v201, v23
  v_mul_f32 v202, v202, v24
  v_mul_f32 v203, v203, v25
  v_mul_f32 v204, v92, v204
  v_mul_f32 v205, v93, v205
  v_mul_f32 v206, v94, v206
  v_mul_f32 v207, v95, v207
  v_cvt_pk_bf16_f32 v74, v200, v201
  v_cvt_pk_bf16_f32 v75, v202, v203
Hc1_2:
  s_cbranch_execz Rc
  buffer_store_dwordx4 v[72:75], v0, s[36:39], s66 offen offset:0 sc1
  v_mul_f32 v204, v204, v26
  v_mul_f32 v205, v205, v27
  v_mul_f32 v206, v206, v28
  v_mul_f32 v207, v207, v29
  v_cvt_pk_bf16_f32 v78, v204, v205
  v_cvt_pk_bf16_f32 v79, v206, v207
  buffer_store_dwordx4 v[76:79], v0, s[36:39], s66 offen offset:1024 sc1
  v_mfma_f32_16x16x32_bf16 v[116:119], a[16:19], a[4:7], v[116:119]
  s_lshl_b32 s51, s72, 11
  ds_read_b64_tr_b16 a[128:129], v2 offset:160
  s_add_u32 s65, s65, 2048
  s_add_u32 s66, s66, 2048
  v_mul_f32 v22, v10, v96
  v_mfma_f32_16x16x32_bf16 v[120:123], a[16:19], a[8:11], v[120:123]
  buffer_load_dwordx2 v[64:65], v7, s[36:39], s51 offen offset:0 sc1
  v_mul_f32 v23, v10, v97
  v_mul_f32 v24, v10, v98
  v_mul_f32 v25, v10, v99
  v_mfma_f32_16x16x32_bf16 v[124:127], a[16:19], a[12:15], v[124:127]
  ds_read_b64_tr_b16 a[130:131], v2 offset:3744
  v_exp_f32 v22, v22
  v_mul_f32 v26, v13, v100
  v_mfma_f32_16x16x32_bf16 v[224:227], a[20:23], a[0:3], v[224:227]
  buffer_load_dwordx2 v[66:67], v7, s[36:39], s51 offen offset:512 sc1
  v_exp_f32 v23, v23
  v_mul_f32 v27, v13, v101
  v_mfma_f32_16x16x32_bf16 v[228:231], a[20:23], a[4:7], v[228:231]
  ds_read_b64_tr_b16 a[132:133], v2 offset:7328
  v_exp_f32 v24, v24
  v_mul_f32 v28, v13, v102
  v_mfma_f32_16x16x32_bf16 v[232:235], a[20:23], a[8:11], v[232:235]
  buffer_load_dwordx2 v[68:69], v7, s[36:39], s51 offen offset:1024 sc1
  v_exp_f32 v25, v25
  v_mul_f32 v29, v13, v103
  v_mfma_f32_16x16x32_bf16 v[236:239], a[20:23], a[12:15], v[236:239]
  ds_read_b64_tr_b16 a[134:135], v2 offset:10912
  v_exp_f32 v26, v26
  v_fma_f32 v22, v22, v11, v11
  v_mfma_f32_16x16x32_bf16 v[236:239], a[152:155], a[44:47], v[236:239]
  buffer_load_dwordx2 v[70:71], v7, s[36:39], s51 offen offset:1536 sc1
  s_add_u32 s51, s51, 12288
  v_exp_f32 v27, v27
  v_mfma_f32_16x16x32_bf16 v[236:239], a[156:159], a[60:63], v[236:239]
  ds_read_b64_tr_b16 a[136:137], v2 offset:14496
  v_fma_f32 v23, v23, v11, v11
  v_exp_f32 v28, v28
  v_mfma_f32_16x16x32_bf16 v[232:235], a[156:159], a[56:59], v[232:235]
  buffer_load_dwordx2 v[72:73], v7, s[36:39], s51 offen offset:2048 sc1
  v_fma_f32 v24, v24, v11, v11
  v_exp_f32 v29, v29
  v_mfma_f32_16x16x32_bf16 v[232:235], a[152:155], a[40:43], v[232:235]
  ds_read_b64_tr_b16 a[138:139], v2 offset:18080
  v_fma_f32 v25, v25, v11, v11
  v_rcp_f32 v22, v22
  v_mfma_f32_16x16x32_bf16 v[228:231], a[152:155], a[36:39], v[228:231]
  buffer_load_dword v139, v138, s[36:39], s91 offen sc1
  v_fma_f32 v26, v26, v14, v14
  v_rcp_f32 v23, v23
  v_mfma_f32_16x16x32_bf16 v[228:231], a[156:159], a[52:55], v[228:231]
  ds_read_b64_tr_b16 a[140:141], v2 offset:21664
  v_fma_f32 v27, v27, v14, v14
  v_rcp_f32 v24, v24
  v_mfma_f32_16x16x32_bf16 v[224:227], a[156:159], a[48:51], v[224:227]
  buffer_load_dwordx2 v[74:75], v7, s[36:39], s51 offen offset:2560 sc1
  v_fma_f32 v28, v28, v14, v14
  v_rcp_f32 v25, v25
  v_mfma_f32_16x16x32_bf16 v[224:227], a[152:155], a[32:35], v[224:227]
  s_waitcnt lgkmcnt(7)
  ds_read_b64_tr_b16 a[142:143], v2 offset:25248
  v_fma_f32 v29, v29, v14, v14
  v_rcp_f32 v26, v26
  v_mfma_f32_16x16x32_bf16 v[112:115], a[160:163], a[64:67], v[112:115]
  buffer_load_dwordx2 v[76:77], v7, s[36:39], s51 offen offset:3072 sc1
  v_mul_f32 v208, v96, v208
  v_rcp_f32 v27, v27
  v_mfma_f32_16x16x32_bf16 v[112:115], a[164:167], a[80:83], v[112:115]
  v_mul_f32 v209, v97, v209
  v_rcp_f32 v28, v28
  v_mul_f32 v210, v98, v210
  v_mfma_f32_16x16x32_bf16 v[116:119], a[164:167], a[84:87], v[116:119]
  buffer_load_dwordx2 v[78:79], v7, s[36:39], s51 offen offset:3584 sc1
  s_lshl_b32 s51, s73, 11
  v_rcp_f32 v29, v29
  v_mfma_f32_16x16x32_bf16 v[116:119], a[160:163], a[68:71], v[116:119]
  v_mul_f32 v211, v99, v211
  v_mul_f32 v208, v208, v22
  v_mul_f32 v209, v209, v23
  v_mul_f32 v210, v210, v24
  v_mfma_f32_16x16x32_bf16 v[120:123], a[160:163], a[72:75], v[120:123]
  buffer_load_dwordx2 v[80:81], v7, s[36:39], s51 offen offset:0 sc1
  v_mul_f32 v211, v211, v25
  v_mul_f32 v22, v16, v104
  v_mul_f32 v23, v16, v105
  v_mfma_f32_16x16x32_bf16 v[120:123], a[164:167], a[88:91], v[120:123]
  v_mul_f32 v24, v16, v106
  v_mul_f32 v25, v16, v107
  v_exp_f32 v22, v22
  v_mfma_f32_16x16x32_bf16 v[124:127], a[164:167], a[92:95], v[124:127]
  buffer_load_dwordx2 v[82:83], v7, s[36:39], s51 offen offset:512 sc1
  v_mul_f32 v212, v100, v212
  v_exp_f32 v23, v23
  v_mfma_f32_16x16x32_bf16 v[124:127], a[160:163], a[76:79], v[124:127]
  s_waitcnt vmcnt(33)
  s_barrier
  v_mul_f32 v213, v101, v213
  v_exp_f32 v24, v24
  v_mfma_f32_16x16x32_bf16 v[236:239], a[168:171], a[76:79], v[236:239]
  buffer_load_dwordx2 v[84:85], v7, s[36:39], s51 offen offset:1024 sc1
  v_mul_f32 v214, v102, v214
  v_exp_f32 v25, v25
  v_mfma_f32_16x16x32_bf16 v[236:239], a[172:175], a[92:95], v[236:239]
  v_mul_f32 v215, v103, v215
  v_mul_f32 v212, v212, v26
  v_mul_f32 v213, v213, v27
  v_mul_f32 v214, v214, v28
  v_mfma_f32_16x16x32_bf16 v[232:235], a[172:175], a[88:91], v[232:235]
  buffer_load_dwordx2 v[86:87], v7, s[36:39], s51 offen offset:1536 sc1
  s_add_u32 s51, s51, 12288
  v_mul_f32 v215, v215, v29
  v_cvt_pk_bf16_f32 v96, v208, v209
  v_mfma_f32_16x16x32_bf16 v[232:235], a[168:171], a[72:75], v[232:235]
  v_cvt_pk_bf16_f32 v97, v210, v211
  v_mul_f32 v26, v19, v108
  v_mul_f32 v27, v19, v109
  v_mul_f32 v28, v19, v110
  v_mfma_f32_16x16x32_bf16 v[228:231], a[168:171], a[68:71], v[228:231]
  buffer_load_dwordx2 v[88:89], v7, s[36:39], s51 offen offset:2048 sc1
  v_mul_f32 v29, v19, v111
  v_exp_f32 v26, v26
  v_mfma_f32_16x16x32_bf16 v[228:231], a[172:175], a[84:87], v[228:231]
  v_fma_f32 v22, v22, v17, v17
  v_exp_f32 v27, v27
  v_fma_f32 v23, v23, v17, v17
  v_mfma_f32_16x16x32_bf16 v[224:227], a[172:175], a[80:83], v[224:227]
  buffer_load_dwordx2 v[90:91], v7, s[36:39], s51 offen offset:2560 sc1
  v_exp_f32 v28, v28
  v_fma_f32 v24, v24, v17, v17
  v_mfma_f32_16x16x32_bf16 v[224:227], a[168:171], a[64:67], v[224:227]
  s_waitcnt lgkmcnt(0)
  v_exp_f32 v29, v29
  v_fma_f32 v25, v25, v17, v17
  v_cvt_pk_bf16_f32 v100, v212, v213
  v_mfma_f32_16x16x32_bf16 v[112:115], a[128:131], a[96:99], v[112:115]
  s_barrier
  buffer_load_dwordx2 v[92:93], v7, s[36:39], s51 offen offset:3072 sc1
  ds_read_b64_tr_b16 a[176:177], v244 offset:28672
  v_cvt_pk_bf16_f32 v101, v214, v215
  v_mfma_f32_16x16x32_bf16 v[112:115], a[132:135], a[112:115], v[112:115]
  ds_read_b64_tr_b16 a[178:179], v244 offset:32768
  v_rcp_f32 v22, v22
  v_fma_f32 v26, v26, v20, v20
  v_mfma_f32_16x16x32_bf16 v[116:119], a[132:135], a[116:119], v[116:119]
  buffer_load_dwordx2 v[94:95], v7, s[36:39], s51 offen offset:3584 sc1
  ds_read_b64_tr_b16 a[180:181], v244 offset:36864
  v_rcp_f32 v23, v23
  v_mfma_f32_16x16x32_bf16 v[116:119], a[128:131], a[100:103], v[116:119]
G3M:
  ds_read_b64_tr_b16 a[182:183], v244 offset:40960
  v_fma_f32 v27, v27, v20, v20
  v_rcp_f32 v24, v24
  v_mfma_f32_16x16x32_bf16 v[120:123], a[128:131], a[104:107], v[120:123]
  ds_read_b64_tr_b16 a[184:185], v245 offset:28672
  v_fma_f32 v28, v28, v20, v20
  v_rcp_f32 v25, v25
  v_mfma_f32_16x16x32_bf16 v[120:123], a[132:135], a[120:123], v[120:123]
  ds_read_b64_tr_b16 a[186:187], v245 offset:32768
  v_fma_f32 v29, v29, v20, v20
  v_rcp_f32 v26, v26
  v_mfma_f32_16x16x32_bf16 v[124:127], a[132:135], a[124:127], v[124:127]
  ds_read_b64_tr_b16 a[188:189], v245 offset:36864
  v_mul_f32 v216, v104, v216
  v_rcp_f32 v27, v27
  v_mfma_f32_16x16x32_bf16 v[124:127], a[128:131], a[108:111], v[124:127]
  ds_read_b64_tr_b16 a[190:191], v245 offset:40960
  v_mul_f32 v217, v105, v217
  v_rcp_f32 v28, v28
  v_mfma_f32_16x16x32_bf16 v[236:239], a[136:139], a[108:111], v[236:239]
  ds_read_b64_tr_b16 a[192:193], v246 offset:28672
  v_mul_f32 v218, v106, v218
  v_rcp_f32 v29, v29
  v_mfma_f32_16x16x32_bf16 v[236:239], a[140:143], a[124:127], v[236:239]
  ds_read_b64_tr_b16 a[194:195], v246 offset:32768
  v_mul_f32 v219, v107, v219
  v_mul_f32 v216, v216, v22
  v_mul_f32 v217, v217, v23
  v_mfma_f32_16x16x32_bf16 v[232:235], a[140:143], a[120:123], v[232:235]
  ds_read_b64_tr_b16 a[196:197], v246 offset:36864
  v_mul_f32 v218, v218, v24
  v_mul_f32 v219, v219, v25
  v_mul_f32 v220, v108, v220
  v_mfma_f32_16x16x32_bf16 v[232:235], a[136:139], a[104:107], v[232:235]
  ds_read_b64_tr_b16 a[198:199], v246 offset:40960
  v_mul_f32 v221, v109, v221
  v_mul_f32 v222, v110, v222
  v_mul_f32 v223, v111, v223
  v_mfma_f32_16x16x32_bf16 v[228:231], a[136:139], a[100:103], v[228:231]
  ds_read_b64_tr_b16 a[200:201], v247 offset:28672
  v_cvt_pk_bf16_f32 v104, v216, v217
  v_cvt_pk_bf16_f32 v105, v218, v219
  v_mul_f32 v220, v220, v26
  v_mfma_f32_16x16x32_bf16 v[228:231], a[140:143], a[116:119], v[228:231]
  ds_read_b64_tr_b16 a[202:203], v247 offset:32768
  v_mul_f32 v221, v221, v27
  v_mul_f32 v222, v222, v28
  v_mul_f32 v223, v223, v29
  v_mfma_f32_16x16x32_bf16 v[224:227], a[140:143], a[112:115], v[224:227]
  ds_read_b64_tr_b16 a[204:205], v247 offset:36864
  v_cvt_pk_bf16_f32 v108, v220, v221
  v_cvt_pk_bf16_f32 v109, v222, v223
  v_mul_f32 v22, v10, v112
  v_mfma_f32_16x16x32_bf16 v[224:227], a[136:139], a[96:99], v[224:227]
  s_waitcnt vmcnt(29) lgkmcnt(11)
  ds_read_b64_tr_b16 a[206:207], v247 offset:40960
  v_mul_f32 v23, v10, v113
  v_mul_f32 v24, v10, v114
  v_mul_f32 v25, v10, v115
  v_mfma_f32_16x16x32_bf16 v[32:35], a[176:179], a[216:219], 0
  s_mov_b32 s74, 0
  s_lshl_b32 s50, s74, 16
  s_add_u32 s50, s50, s88
  s_add_u32 m0, s70, 12288
  ds_read_b64_tr_b16 a[208:209], v244 offset:30720
  v_mfma_f32_16x16x32_bf16 v[32:35], a[180:183], a[224:227], v[32:35]
  ds_read_b64_tr_b16 a[210:211], v244 offset:34816
  v_exp_f32 v22, v22
  v_mul_f32 v26, v13, v116
  v_mfma_f32_16x16x32_bf16 v[36:39], a[180:183], a[228:231], 0
  ds_read_b64_tr_b16 a[212:213], v244 offset:38912
  v_exp_f32 v23, v23
  v_mul_f32 v27, v13, v117
  v_mfma_f32_16x16x32_bf16 v[36:39], a[176:179], a[220:223], v[36:39]
  s_waitcnt lgkmcnt(11)
  ds_read_b64_tr_b16 a[214:215], v244 offset:43008
  v_exp_f32 v24, v24
  v_mul_f32 v28, v13, v118
  v_mfma_f32_16x16x32_bf16 v[44:47], a[184:187], a[220:223], 0
  s_waitcnt vmcnt(11)
  v_cmp_ne_u32 vcc, s3, v139
  s_nop 4
  s_cbranch_vccnz CK9s
CK9x:
  v_mfma_f32_16x16x32_bf16 v[44:47], a[188:191], a[228:231], v[44:47]
  s_add_u32 s91, s91, 32768
  buffer_load_dwordx4 v133, s[24:27], s50 offen offset:0 lds
  s_lshl_b32 s51, s74, 11
  ds_read_b64_tr_b16 a[176:177], v245 offset:30720
  v_mfma_f32_16x16x32_bf16 v[40:43], a[188:191], a[224:227], 0
  ds_read_b64_tr_b16 a[178:179], v245 offset:34816
  ds_read_b64_tr_b16 a[180:181], v245 offset:38912
  v_exp_f32 v25, v25
  v_mfma_f32_16x16x32_bf16 v[40:43], a[184:187], a[216:219], v[40:43]
  s_waitcnt lgkmcnt(11)
  buffer_load_dwordx4 a[48:51], v137, s[36:39], s51 offen offset:0 sc1
  ds_read_b64_tr_b16 a[182:183], v245 offset:43008
  v_mul_f32 v29, v13, v119
  v_mfma_f32_16x16x32_bf16 v[48:51], a[192:195], a[216:219], 0
  ds_read_b64_tr_b16 a[184:185], v246 offset:30720
  v_exp_f32 v26, v26
  v_fma_f32 v22, v22, v11, v11
  v_mfma_f32_16x16x32_bf16 v[48:51], a[196:199], a[224:227], v[48:51]
  ds_read_b64_tr_b16 a[186:187], v246 offset:34816
  v_exp_f32 v27, v27
  v_fma_f32 v23, v23, v11, v11
  v_mfma_f32_16x16x32_bf16 v[52:55], a[196:199], a[228:231], 0
  ds_read_b64_tr_b16 a[188:189], v246 offset:38912
  v_exp_f32 v28, v28
  v_fma_f32 v24, v24, v11, v11
  v_mfma_f32_16x16x32_bf16 v[52:55], a[192:195], a[220:223], v[52:55]
  s_waitcnt lgkmcnt(11)
  buffer_load_dwordx4 v134, s[24:27], s50 offen offset:1024 lds
  ds_read_b64_tr_b16 a[190:191], v246 offset:43008
  v_exp_f32 v29, v29
  v_mfma_f32_16x16x32_bf16 v[60:63], a[200:203], a[220:223], 0
  ds_read_b64_tr_b16 a[192:193], v247 offset:30720
  v_fma_f32 v25, v25, v11, v11
  v_rcp_f32 v22, v22
  v_mfma_f32_16x16x32_bf16 v[60:63], a[204:207], a[228:231], v[60:63]
  ds_read_b64_tr_b16 a[194:195], v247 offset:34816
  v_fma_f32 v26, v26, v14, v14
  v_rcp_f32 v23, v23
  v_mfma_f32_16x16x32_bf16 v[56:59], a[204:207], a[224:227], 0
  ds_read_b64_tr_b16 a[196:197], v247 offset:38912
  v_fma_f32 v27, v27, v14, v14
  v_rcp_f32 v24, v24
  v_mfma_f32_16x16x32_bf16 v[56:59], a[200:203], a[216:219], v[56:59]
  s_waitcnt lgkmcnt(11)
  buffer_load_dwordx4 a[52:55], v137, s[36:39], s51 offen offset:1024 sc1
  ds_read_b64_tr_b16 a[198:199], v247 offset:43008
  v_fma_f32 v28, v28, v14, v14
  v_mfma_f32_16x16x32_bf16 v[144:147], a[208:211], a[216:219], 0
  ds_read_b64_tr_b16 a[200:201], v244 offset:45056
  v_rcp_f32 v25, v25
  v_fma_f32 v29, v29, v14, v14
  v_mfma_f32_16x16x32_bf16 v[144:147], a[212:215], a[224:227], v[144:147]
  ds_read_b64_tr_b16 a[202:203], v244 offset:49152
  v_rcp_f32 v26, v26
  v_mul_f32 v224, v112, v224
  v_mfma_f32_16x16x32_bf16 v[148:151], a[212:215], a[228:231], 0
  ds_read_b64_tr_b16 a[204:205], v244 offset:53248
  v_rcp_f32 v27, v27
  v_mul_f32 v225, v113, v225
  v_mfma_f32_16x16x32_bf16 v[148:151], a[208:211], a[220:223], v[148:151]
  s_waitcnt lgkmcnt(11)
  buffer_load_dwordx4 v135, s[24:27], s50 offen offset:2048 lds
  s_add_u32 s51, s51, 6144
  ds_read_b64_tr_b16 a[206:207], v244 offset:57344
  v_mfma_f32_16x16x32_bf16 v[156:159], a[176:179], a[220:223], 0
  ds_read_b64_tr_b16 a[208:209], v245 offset:45056
  v_rcp_f32 v28, v28
  v_mul_f32 v226, v114, v226
  v_mfma_f32_16x16x32_bf16 v[156:159], a[180:183], a[228:231], v[156:159]
  ds_read_b64_tr_b16 a[210:211], v245 offset:49152
  v_rcp_f32 v29, v29
  v_mul_f32 v227, v115, v227
  v_mfma_f32_16x16x32_bf16 v[152:155], a[180:183], a[224:227], 0
  ds_read_b64_tr_b16 a[212:213], v245 offset:53248
  v_mul_f32 v224, v224, v22
  v_mul_f32 v225, v225, v23
  v_mul_f32 v226, v226, v24
  v_mfma_f32_16x16x32_bf16 v[152:155], a[176:179], a[216:219], v[152:155]
  s_waitcnt lgkmcnt(11)
  buffer_load_dwordx4 a[56:59], v137, s[36:39], s51 offen offset:2048 sc1
  ds_read_b64_tr_b16 a[214:215], v245 offset:57344
  v_mul_f32 v227, v227, v25
  v_mul_f32 v22, v16, v120
  v_mfma_f32_16x16x32_bf16 v[160:163], a[184:187], a[216:219], 0
  ds_read_b64_tr_b16 a[176:177], v246 offset:45056
  v_mul_f32 v23, v16, v121
  v_mul_f32 v24, v16, v122
  v_mul_f32 v25, v16, v123
  v_mfma_f32_16x16x32_bf16 v[160:163], a[188:191], a[224:227], v[160:163]
  ds_read_b64_tr_b16 a[178:179], v246 offset:49152
  v_exp_f32 v22, v22
  v_mul_f32 v228, v116, v228
  v_mfma_f32_16x16x32_bf16 v[164:167], a[188:191], a[228:231], 0
  ds_read_b64_tr_b16 a[180:181], v246 offset:53248
  v_exp_f32 v23, v23
  v_mul_f32 v229, v117, v229
  v_mfma_f32_16x16x32_bf16 v[164:167], a[184:187], a[220:223], v[164:167]
  s_waitcnt lgkmcnt(11)
  buffer_load_dwordx4 v136, s[24:27], s50 offen offset:3072 lds
  ds_read_b64_tr_b16 a[182:183], v246 offset:57344
  v_exp_f32 v24, v24
  v_mfma_f32_16x16x32_bf16 v[172:175], a[192:195], a[220:223], 0
  ds_read_b64_tr_b16 a[184:185], v247 offset:45056
  v_mul_f32 v230, v118, v230
  v_exp_f32 v25, v25
  v_mfma_f32_16x16x32_bf16 v[172:175], a[196:199], a[228:231], v[172:175]
  ds_read_b64_tr_b16 a[186:187], v247 offset:49152
  v_mul_f32 v231, v119, v231
  v_mul_f32 v228, v228, v26
  v_mul_f32 v229, v229, v27
  v_mfma_f32_16x16x32_bf16 v[168:171], a[196:199], a[224:227], 0
  ds_read_b64_tr_b16 a[188:189], v247 offset:53248
  v_mul_f32 v230, v230, v28
  v_mul_f32 v231, v231, v29
  v_cvt_pk_bf16_f32 v98, v224, v225
  v_mfma_f32_16x16x32_bf16 v[168:171], a[192:195], a[216:219], v[168:171]
  s_waitcnt vmcnt(28) lgkmcnt(11)
  buffer_load_dwordx4 a[60:63], v137, s[36:39], s51 offen offset:3072 sc1
  s_cmp_eq_u32 s87, 1
  s_cselect_b32 s75, 35, 7
  s_lshl_b32 s50, s75, 16
  v_mfma_f32_16x16x32_bf16 v[32:35], a[200:203], v[176:179], v[32:35]
  s_add_u32 s50, s50, s88
  s_add_u32 m0, s70, 28672
  ds_read_b64_tr_b16 a[190:191], v247 offset:57344
  ds_read_b64_tr_b16 a[192:193], v244 offset:47104
  v_cvt_pk_bf16_f32 v99, v226, v227
  v_mfma_f32_16x16x32_bf16 v[32:35], a[204:207], v[184:187], v[32:35]
  ds_read_b64_tr_b16 a[194:195], v244 offset:51200
  buffer_store_dwordx4 v[96:99], v0, s[36:39], s65 offen offset:0 sc1
  v_mul_f32 v26, v19, v124
  v_mul_f32 v27, v19, v125
  v_mfma_f32_16x16x32_bf16 v[36:39], a[204:207], v[188:191], v[36:39]
  ds_read_b64_tr_b16 a[196:197], v244 offset:55296
  v_mul_f32 v28, v19, v126
  v_mul_f32 v29, v19, v127
  v_mfma_f32_16x16x32_bf16 v[36:39], a[200:203], v[180:183], v[36:39]
  s_waitcnt lgkmcnt(11)
  buffer_load_dwordx4 v133, s[24:27], s50 offen offset:0 lds
  s_lshl_b32 s51, s75, 11
  ds_read_b64_tr_b16 a[198:199], v244 offset:59392
  v_mfma_f32_16x16x32_bf16 v[44:47], a[208:211], v[180:183], v[44:47]
  ds_read_b64_tr_b16 a[200:201], v245 offset:47104
  v_exp_f32 v26, v26
  v_fma_f32 v22, v22, v17, v17
  v_mfma_f32_16x16x32_bf16 v[44:47], a[212:215], v[188:191], v[44:47]
  ds_read_b64_tr_b16 a[202:203], v245 offset:51200
  v_exp_f32 v27, v27
  v_fma_f32 v23, v23, v17, v17
  v_mfma_f32_16x16x32_bf16 v[40:43], a[212:215], v[184:187], v[40:43]
  ds_read_b64_tr_b16 a[204:205], v245 offset:55296
  v_exp_f32 v28, v28
  v_fma_f32 v24, v24, v17, v17
  v_mfma_f32_16x16x32_bf16 v[40:43], a[208:211], v[176:179], v[40:43]
  s_waitcnt lgkmcnt(11)
  buffer_load_dwordx4 a[64:67], v137, s[36:39], s51 offen offset:0 sc1
  ds_read_b64_tr_b16 a[206:207], v245 offset:59392
  v_exp_f32 v29, v29
  v_mfma_f32_16x16x32_bf16 v[48:51], a[176:179], v[176:179], v[48:51]
  ds_read_b64_tr_b16 a[208:209], v246 offset:47104
  v_fma_f32 v25, v25, v17, v17
  v_cvt_pk_bf16_f32 v102, v228, v229
  v_cvt_pk_bf16_f32 v103, v230, v231
  v_mfma_f32_16x16x32_bf16 v[48:51], a[180:183], v[184:187], v[48:51]
  ds_read_b64_tr_b16 a[210:211], v246 offset:51200
  buffer_store_dwordx4 v[100:103], v0, s[36:39], s65 offen offset:1024 sc1
  v_rcp_f32 v22, v22
  v_mfma_f32_16x16x32_bf16 v[52:55], a[180:183], v[188:191], v[52:55]
  ds_read_b64_tr_b16 a[212:213], v246 offset:55296
  v_fma_f32 v26, v26, v20, v20
  v_rcp_f32 v23, v23
  v_mfma_f32_16x16x32_bf16 v[52:55], a[176:179], v[180:183], v[52:55]
  s_waitcnt lgkmcnt(11)
  buffer_load_dwordx4 v134, s[24:27], s50 offen offset:1024 lds
  ds_read_b64_tr_b16 a[214:215], v246 offset:59392
  v_fma_f32 v27, v27, v20, v20
  v_mfma_f32_16x16x32_bf16 v[60:63], a[184:187], v[180:183], v[60:63]
  ds_read_b64_tr_b16 a[176:177], v247 offset:47104
  v_rcp_f32 v24, v24
  v_fma_f32 v28, v28, v20, v20
  v_mfma_f32_16x16x32_bf16 v[60:63], a[188:191], v[188:191], v[60:63]
  ds_read_b64_tr_b16 a[178:179], v247 offset:51200
  v_rcp_f32 v25, v25
  v_fma_f32 v29, v29, v20, v20
  v_mfma_f32_16x16x32_bf16 v[56:59], a[188:191], v[184:187], v[56:59]
  ds_read_b64_tr_b16 a[180:181], v247 offset:55296
  v_rcp_f32 v26, v26
  v_mul_f32 v232, v120, v232
  v_mfma_f32_16x16x32_bf16 v[56:59], a[184:187], v[176:179], v[56:59]
  s_waitcnt lgkmcnt(11)
  buffer_load_dwordx4 a[68:71], v137, s[36:39], s51 offen offset:1024 sc1
  ds_read_b64_tr_b16 a[182:183], v247 offset:59392
  v_rcp_f32 v27, v27
  v_mfma_f32_16x16x32_bf16 v[144:147], a[192:195], v[176:179], v[144:147]
  ds_read_b64_tr_b16 a[184:185], v244 offset:61440
  v_mul_f32 v233, v121, v233
  v_rcp_f32 v28, v28
  v_mfma_f32_16x16x32_bf16 v[144:147], a[196:199], v[184:187], v[144:147]
  ds_read_b64_tr_b16 a[186:187], v248 offset:0
  v_mul_f32 v234, v122, v234
  v_rcp_f32 v29, v29
  v_mfma_f32_16x16x32_bf16 v[148:151], a[196:199], v[188:191], v[148:151]
  ds_read_b64_tr_b16 a[188:189], v248 offset:4096
  v_mul_f32 v235, v123, v235
  v_mul_f32 v232, v232, v22
  v_mul_f32 v233, v233, v23
  v_mfma_f32_16x16x32_bf16 v[148:151], a[192:195], v[180:183], v[148:151]
  s_waitcnt lgkmcnt(11)
  buffer_load_dwordx4 v135, s[24:27], s50 offen offset:2048 lds
  s_add_u32 s51, s51, 6144
  ds_read_b64_tr_b16 a[190:191], v248 offset:8192
  v_mul_f32 v234, v234, v24
  v_mfma_f32_16x16x32_bf16 v[156:159], a[200:203], v[180:183], v[156:159]
  ds_read_b64_tr_b16 a[192:193], v245 offset:61440
  v_mul_f32 v235, v235, v25
  v_mul_f32 v236, v124, v236
  v_mul_f32 v237, v125, v237
  v_mfma_f32_16x16x32_bf16 v[156:159], a[204:207], v[188:191], v[156:159]
  ds_read_b64_tr_b16 a[194:195], v249 offset:0
  v_mul_f32 v238, v126, v238
  v_mul_f32 v239, v127, v239
  v_cvt_pk_bf16_f32 v106, v232, v233
  v_mfma_f32_16x16x32_bf16 v[152:155], a[204:207], v[184:187], v[152:155]
  ds_read_b64_tr_b16 a[196:197], v249 offset:4096
  v_cvt_pk_bf16_f32 v107, v234, v235
  v_mfma_f32_16x16x32_bf16 v[152:155], a[200:203], v[176:179], v[152:155]
  s_waitcnt lgkmcnt(11)
  buffer_load_dwordx4 a[72:75], v137, s[36:39], s51 offen offset:2048 sc1
  ds_read_b64_tr_b16 a[198:199], v249 offset:8192
  v_mfma_f32_16x16x32_bf16 v[160:163], a[208:211], v[176:179], v[160:163]
  ds_read_b64_tr_b16 a[200:201], v246 offset:61440
  v_mfma_f32_16x16x32_bf16 v[160:163], a[212:215], v[184:187], v[160:163]
  ds_read_b64_tr_b16 a[202:203], v250 offset:0
  buffer_store_dwordx4 v[104:107], v0, s[36:39], s66 offen offset:0 sc1
  v_mul_f32 v236, v236, v26
  v_mul_f32 v237, v237, v27
  v_mfma_f32_16x16x32_bf16 v[164:167], a[212:215], v[188:191], v[164:167]
  v_mul_f32 v238, v238, v28
  v_mul_f32 v239, v239, v29
  v_cvt_pk_bf16_f32 v110, v236, v237
  v_cvt_pk_bf16_f32 v111, v238, v239
  buffer_store_dwordx4 v[108:111], v0, s[36:39], s66 offen offset:1024 sc1
  v_mfma_f32_16x16x32_bf16 v[164:167], a[208:211], v[180:183], v[164:167]
  s_waitcnt lgkmcnt(10)
  ds_read_b64_tr_b16 a[204:205], v250 offset:4096
  ds_read_b64_tr_b16 a[206:207], v250 offset:8192
  v_mfma_f32_16x16x32_bf16 v[172:175], a[176:179], v[180:183], v[172:175]
  ds_read_b64_tr_b16 a[208:209], v247 offset:61440
  v_mfma_f32_16x16x32_bf16 v[172:175], a[180:183], v[188:191], v[172:175]
  buffer_load_dwordx4 v136, s[24:27], s50 offen offset:3072 lds
  ds_read_b64_tr_b16 a[210:211], v251 offset:0
  v_mfma_f32_16x16x32_bf16 v[168:171], a[180:183], v[184:187], v[168:171]
  ds_read_b64_tr_b16 a[212:213], v251 offset:4096
  v_mfma_f32_16x16x32_bf16 v[168:171], a[176:179], v[176:179], v[168:171]
  s_waitcnt vmcnt(27) lgkmcnt(11)
  ds_read_b64_tr_b16 a[214:215], v251 offset:8192
  v_mfma_f32_16x16x32_bf16 v[32:35], a[184:187], v[64:67], v[32:35]
  buffer_load_dwordx4 a[76:79], v137, s[36:39], s51 offen offset:3072 sc1
  s_cmp_eq_u32 s87, 2
  v_mfma_f32_16x16x32_bf16 v[32:35], a[188:191], v[72:75], v[32:35]
  s_cselect_b32 s79, 42, 14
  s_lshl_b32 s50, s79, 16
  s_add_u32 s50, s50, s88
  v_mfma_f32_16x16x32_bf16 v[36:39], a[188:191], v[76:79], v[36:39]
  s_add_u32 m0, s70, 45056
  ds_read_b64_tr_b16 a[176:177], v244 offset:63488
  ds_read_b64_tr_b16 a[178:179], v248 offset:2048
  v_mfma_f32_16x16x32_bf16 v[36:39], a[184:187], v[68:71], v[36:39]
  s_waitcnt lgkmcnt(10)
  buffer_load_dwordx4 v133, s[24:27], s50 offen offset:0 lds
  s_lshl_b32 s51, s79, 11
  v_mfma_f32_16x16x32_bf16 v[44:47], a[192:195], v[68:71], v[44:47]
  ds_read_b64_tr_b16 a[180:181], v248 offset:6144
  ds_read_b64_tr_b16 a[182:183], v248 offset:10240
  v_mfma_f32_16x16x32_bf16 v[44:47], a[196:199], v[76:79], v[44:47]
  ds_read_b64_tr_b16 a[184:185], v245 offset:63488
  ds_read_b64_tr_b16 a[186:187], v249 offset:2048
  v_mfma_f32_16x16x32_bf16 v[40:43], a[196:199], v[72:75], v[40:43]
  buffer_load_dwordx4 a[80:83], v137, s[36:39], s51 offen offset:0 sc1
  ds_read_b64_tr_b16 a[188:189], v249 offset:6144
  v_mfma_f32_16x16x32_bf16 v[40:43], a[192:195], v[64:67], v[40:43]
  s_waitcnt lgkmcnt(11)
  ds_read_b64_tr_b16 a[190:191], v249 offset:10240
  v_mfma_f32_16x16x32_bf16 v[48:51], a[200:203], v[64:67], v[48:51]
  ds_read_b64_tr_b16 a[192:193], v246 offset:63488
  v_mfma_f32_16x16x32_bf16 v[48:51], a[204:207], v[72:75], v[48:51]
  ds_read_b64_tr_b16 a[194:195], v250 offset:2048
  v_mfma_f32_16x16x32_bf16 v[52:55], a[204:207], v[76:79], v[52:55]
  buffer_load_dwordx4 v134, s[24:27], s50 offen offset:1024 lds
  ds_read_b64_tr_b16 a[196:197], v250 offset:6144
  v_mfma_f32_16x16x32_bf16 v[52:55], a[200:203], v[68:71], v[52:55]
  s_waitcnt lgkmcnt(11)
  ds_read_b64_tr_b16 a[198:199], v250 offset:10240
  v_mfma_f32_16x16x32_bf16 v[60:63], a[208:211], v[68:71], v[60:63]
  ds_read_b64_tr_b16 a[200:201], v247 offset:63488
  v_mfma_f32_16x16x32_bf16 v[60:63], a[212:215], v[76:79], v[60:63]
  ds_read_b64_tr_b16 a[202:203], v251 offset:2048
  v_mfma_f32_16x16x32_bf16 v[56:59], a[212:215], v[72:75], v[56:59]
  buffer_load_dwordx4 a[84:87], v137, s[36:39], s51 offen offset:1024 sc1
  ds_read_b64_tr_b16 a[204:205], v251 offset:6144
  v_mfma_f32_16x16x32_bf16 v[56:59], a[208:211], v[64:67], v[56:59]
  s_waitcnt lgkmcnt(11)
  ds_read_b64_tr_b16 a[206:207], v251 offset:10240
  v_mfma_f32_16x16x32_bf16 v[144:147], a[176:179], v[64:67], v[144:147]
  ds_read_b64_tr_b16 a[208:209], v248 offset:12288
  v_mfma_f32_16x16x32_bf16 v[144:147], a[180:183], v[72:75], v[144:147]
  ds_read_b64_tr_b16 a[210:211], v248 offset:16384
  v_mfma_f32_16x16x32_bf16 v[148:151], a[180:183], v[76:79], v[148:151]
  buffer_load_dwordx4 v135, s[24:27], s50 offen offset:2048 lds
  s_add_u32 s51, s51, 6144
  v_mfma_f32_16x16x32_bf16 v[148:151], a[176:179], v[68:71], v[148:151]
  s_waitcnt lgkmcnt(10)
  ds_read_b64_tr_b16 a[212:213], v248 offset:20480
  ds_read_b64_tr_b16 a[214:215], v248 offset:24576
  v_mfma_f32_16x16x32_bf16 v[156:159], a[184:187], v[68:71], v[156:159]
  ds_read_b64_tr_b16 a[176:177], v249 offset:12288
  v_mfma_f32_16x16x32_bf16 v[156:159], a[188:191], v[76:79], v[156:159]
  ds_read_b64_tr_b16 a[178:179], v249 offset:16384
  v_mfma_f32_16x16x32_bf16 v[152:155], a[188:191], v[72:75], v[152:155]
  buffer_load_dwordx4 a[88:91], v137, s[36:39], s51 offen offset:2048 sc1
  ds_read_b64_tr_b16 a[180:181], v249 offset:20480
  v_mfma_f32_16x16x32_bf16 v[152:155], a[184:187], v[64:67], v[152:155]
  s_waitcnt lgkmcnt(11)
  ds_read_b64_tr_b16 a[182:183], v249 offset:24576
  v_mfma_f32_16x16x32_bf16 v[160:163], a[192:195], v[64:67], v[160:163]
  ds_read_b64_tr_b16 a[184:185], v250 offset:12288
  v_mfma_f32_16x16x32_bf16 v[160:163], a[196:199], v[72:75], v[160:163]
  ds_read_b64_tr_b16 a[186:187], v250 offset:16384
  v_mfma_f32_16x16x32_bf16 v[164:167], a[196:199], v[76:79], v[164:167]
  buffer_load_dwordx4 v136, s[24:27], s50 offen offset:3072 lds
  ds_read_b64_tr_b16 a[188:189], v250 offset:20480
  v_mfma_f32_16x16x32_bf16 v[164:167], a[192:195], v[68:71], v[164:167]
  s_waitcnt lgkmcnt(11)
  ds_read_b64_tr_b16 a[190:191], v250 offset:24576
  v_mfma_f32_16x16x32_bf16 v[172:175], a[200:203], v[68:71], v[172:175]
  ds_read_b64_tr_b16 a[192:193], v251 offset:12288
  v_mfma_f32_16x16x32_bf16 v[172:175], a[204:207], v[76:79], v[172:175]
  ds_read_b64_tr_b16 a[194:195], v251 offset:16384
  v_mfma_f32_16x16x32_bf16 v[168:171], a[204:207], v[72:75], v[168:171]
  buffer_load_dwordx4 a[92:95], v137, s[36:39], s51 offen offset:3072 sc1
  s_cmp_eq_u32 s87, 3
  v_mfma_f32_16x16x32_bf16 v[168:171], a[200:203], v[64:67], v[168:171]
  s_waitcnt vmcnt(28) lgkmcnt(10)
  s_cselect_b32 s80, 49, 21
  s_lshl_b32 s50, s80, 16
  v_mfma_f32_16x16x32_bf16 v[32:35], a[208:211], v[80:83], v[32:35]
  s_add_u32 s50, s50, s88
  s_add_u32 m0, s70, 61440
  ds_read_b64_tr_b16 a[196:197], v251 offset:20480
  v_mfma_f32_16x16x32_bf16 v[32:35], a[212:215], v[88:91], v[32:35]
  ds_read_b64_tr_b16 a[198:199], v251 offset:24576
  ds_read_b64_tr_b16 a[200:201], v248 offset:14336
  v_mfma_f32_16x16x32_bf16 v[36:39], a[212:215], v[92:95], v[36:39]
  ds_read_b64_tr_b16 a[202:203], v248 offset:18432
  buffer_load_dwordx4 v133, s[24:27], s50 offen offset:0 lds
  v_mfma_f32_16x16x32_bf16 v[36:39], a[208:211], v[84:87], v[36:39]
  s_waitcnt lgkmcnt(10)
  s_lshl_b32 s51, s80, 11
  ds_read_b64_tr_b16 a[204:205], v248 offset:22528
  v_mfma_f32_16x16x32_bf16 v[44:47], a[176:179], v[84:87], v[44:47]
  ds_read_b64_tr_b16 a[206:207], v248 offset:26624
  ds_read_b64_tr_b16 a[208:209], v249 offset:14336
  v_mfma_f32_16x16x32_bf16 v[44:47], a[180:183], v[92:95], v[44:47]
  ds_read_b64_tr_b16 a[210:211], v249 offset:18432
  v_mfma_f32_16x16x32_bf16 v[40:43], a[180:183], v[88:91], v[40:43]
  s_waitcnt vmcnt(11)
  buffer_load_dwordx4 a[96:99], v137, s[36:39], s51 offen offset:0 sc1
  ds_read_b64_tr_b16 a[212:213], v249 offset:22528
  v_mfma_f32_16x16x32_bf16 v[40:43], a[176:179], v[80:83], v[40:43]
  s_waitcnt vmcnt(23) lgkmcnt(11)
  s_barrier
  ds_read_b64_tr_b16 a[214:215], v249 offset:26624
  v_mfma_f32_16x16x32_bf16 v[48:51], a[184:187], v[80:83], v[48:51]
  s_mov_b64 exec, 1
  buffer_store_dword v9, v0, s[36:39], s45 offen sc1
  s_mov_b64 exec, -1
  v_mfma_f32_16x16x32_bf16 v[48:51], a[188:191], v[88:91], v[48:51]
  s_add_u32 s45, s45, 32768
  ds_read_b64_tr_b16 a[176:177], v250 offset:14336
  ds_read_b64_tr_b16 a[178:179], v250 offset:18432
  v_mfma_f32_16x16x32_bf16 v[52:55], a[188:191], v[92:95], v[52:55]
Hb0:
  s_cbranch_execz Hb0_1
  buffer_load_dwordx4 v134, s[24:27], s50 offen offset:1024 lds
  ds_read_b64_tr_b16 a[180:181], v250 offset:22528
  v_mfma_f32_16x16x32_bf16 v[52:55], a[184:187], v[84:87], v[52:55]
  s_waitcnt lgkmcnt(11)
  ds_read_b64_tr_b16 a[182:183], v250 offset:26624
  v_mfma_f32_16x16x32_bf16 v[60:63], a[192:195], v[84:87], v[60:63]
  ds_read_b64_tr_b16 a[184:185], v251 offset:14336
  v_mfma_f32_16x16x32_bf16 v[60:63], a[196:199], v[92:95], v[60:63]
  ds_read_b64_tr_b16 a[186:187], v251 offset:18432
  v_mfma_f32_16x16x32_bf16 v[56:59], a[196:199], v[88:91], v[56:59]
  buffer_load_dwordx4 a[100:103], v137, s[36:39], s51 offen offset:1024 sc1
  ds_read_b64_tr_b16 a[188:189], v251 offset:22528
  v_mfma_f32_16x16x32_bf16 v[56:59], a[192:195], v[80:83], v[56:59]
  s_waitcnt lgkmcnt(11)
  ds_read_b64_tr_b16 a[190:191], v251 offset:26624
  v_mfma_f32_16x16x32_bf16 v[144:147], a[200:203], v[80:83], v[144:147]
  ds_read_b64_tr_b16 a[192:193], v240 offset:12288
  v_mfma_f32_16x16x32_bf16 v[144:147], a[204:207], v[88:91], v[144:147]
  ds_read_b64_tr_b16 a[194:195], v240 offset:16384
  v_mfma_f32_16x16x32_bf16 v[148:151], a[204:207], v[92:95], v[148:151]
  buffer_load_dwordx4 v135, s[24:27], s50 offen offset:2048 lds
  s_add_u32 s51, s51, 6144
  v_mfma_f32_16x16x32_bf16 v[148:151], a[200:203], v[84:87], v[148:151]
  s_waitcnt lgkmcnt(10)
  ds_read_b64_tr_b16 a[196:197], v240 offset:20480
  ds_read_b64_tr_b16 a[198:199], v240 offset:24576
  v_mfma_f32_16x16x32_bf16 v[156:159], a[208:211], v[84:87], v[156:159]
  ds_read_b64_tr_b16 a[200:201], v241 offset:12288
  v_mfma_f32_16x16x32_bf16 v[156:159], a[212:215], v[92:95], v[156:159]
  ds_read_b64_tr_b16 a[202:203], v241 offset:16384
  v_mfma_f32_16x16x32_bf16 v[152:155], a[212:215], v[88:91], v[152:155]
  buffer_load_dwordx4 a[104:107], v137, s[36:39], s51 offen offset:2048 sc1
  ds_read_b64_tr_b16 a[204:205], v241 offset:20480
  v_mfma_f32_16x16x32_bf16 v[152:155], a[208:211], v[80:83], v[152:155]
  s_waitcnt lgkmcnt(11)
  ds_read_b64_tr_b16 a[206:207], v241 offset:24576
  v_mfma_f32_16x16x32_bf16 v[160:163], a[176:179], v[80:83], v[160:163]
  ds_read_b64_tr_b16 a[208:209], v242 offset:12288
  v_mfma_f32_16x16x32_bf16 v[160:163], a[180:183], v[88:91], v[160:163]
  buffer_load_dwordx4 v136, s[24:27], s50 offen offset:3072 lds
  ds_read_b64_tr_b16 a[210:211], v242 offset:16384
  v_mfma_f32_16x16x32_bf16 v[164:167], a[180:183], v[92:95], v[164:167]
  ds_read_b64_tr_b16 a[212:213], v242 offset:20480
  v_mfma_f32_16x16x32_bf16 v[164:167], a[176:179], v[84:87], v[164:167]
  s_waitcnt lgkmcnt(11)
  ds_read_b64_tr_b16 a[214:215], v242 offset:24576
  v_mfma_f32_16x16x32_bf16 v[172:175], a[184:187], v[84:87], v[172:175]
  ds_read_b64_tr_b16 a[176:177], v243 offset:12288
  v_mfma_f32_16x16x32_bf16 v[172:175], a[188:191], v[92:95], v[172:175]
  buffer_load_dwordx4 a[108:111], v137, s[36:39], s51 offen offset:3072 sc1
  s_mov_b32 s81, 28
  v_mfma_f32_16x16x32_bf16 v[168:171], a[188:191], v[88:91], v[168:171]
  s_lshl_b32 s50, s81, 16
  s_add_u32 s50, s50, s88
  s_add_u32 m0, s70, 77824
  v_mfma_f32_16x16x32_bf16 v[168:171], a[184:187], v[80:83], v[168:171]
  s_waitcnt vmcnt(29) lgkmcnt(9)
  ds_read_b64_tr_b16 a[178:179], v243 offset:16384
  ds_read_b64_tr_b16 a[180:181], v243 offset:20480
  v_mfma_f32_16x16x32_bf16 v[32:35], a[192:195], a[48:51], v[32:35]
  ds_read_b64_tr_b16 a[182:183], v243 offset:24576
  ds_read_b64_tr_b16 a[184:185], v240 offset:14336
  v_mfma_f32_16x16x32_bf16 v[32:35], a[196:199], a[56:59], v[32:35]
  buffer_load_dwordx4 v133, s[24:27], s50 offen offset:0 lds
  s_lshl_b32 s51, s81, 11
  v_mfma_f32_16x16x32_bf16 v[36:39], a[196:199], a[60:63], v[36:39]
  ds_read_b64_tr_b16 a[186:187], v240 offset:18432
  ds_read_b64_tr_b16 a[188:189], v240 offset:22528
  v_mfma_f32_16x16x32_bf16 v[36:39], a[192:195], a[52:55], v[36:39]
  s_waitcnt lgkmcnt(11)
  ds_read_b64_tr_b16 a[190:191], v240 offset:26624
  v_mfma_f32_16x16x32_bf16 v[44:47], a[200:203], a[52:55], v[44:47]
  ds_read_b64_tr_b16 a[192:193], v241 offset:14336
  v_mfma_f32_16x16x32_bf16 v[44:47], a[204:207], a[60:63], v[44:47]
  buffer_load_dwordx4 a[112:115], v137, s[36:39], s51 offen offset:0 sc1
  ds_read_b64_tr_b16 a[194:195], v241 offset:18432
  v_mfma_f32_16x16x32_bf16 v[40:43], a[204:207], a[56:59], v[40:43]
  ds_read_b64_tr_b16 a[196:197], v241 offset:22528
  v_mfma_f32_16x16x32_bf16 v[40:43], a[200:203], a[48:51], v[40:43]
  s_waitcnt vmcnt(20) lgkmcnt(11)
  s_barrier
  ds_read_b64_tr_b16 a[198:199], v241 offset:26624
  v_mfma_f32_16x16x32_bf16 v[48:51], a[208:211], a[48:51], v[48:51]
  ds_read_b64_tr_b16 a[200:201], v242 offset:14336
  v_mfma_f32_16x16x32_bf16 v[48:51], a[212:215], a[56:59], v[48:51]
  buffer_load_dwordx4 v134, s[24:27], s50 offen offset:1024 lds
  ds_read_b64_tr_b16 a[202:203], v242 offset:18432
  v_mfma_f32_16x16x32_bf16 v[52:55], a[212:215], a[60:63], v[52:55]
  ds_read_b64_tr_b16 a[204:205], v242 offset:22528
  v_mfma_f32_16x16x32_bf16 v[52:55], a[208:211], a[52:55], v[52:55]
  s_waitcnt lgkmcnt(11)
  ds_read_b64_tr_b16 a[206:207], v242 offset:26624
  v_mfma_f32_16x16x32_bf16 v[60:63], a[176:179], a[52:55], v[60:63]
  ds_read_b64_tr_b16 a[208:209], v243 offset:14336
  v_mfma_f32_16x16x32_bf16 v[60:63], a[180:183], a[60:63], v[60:63]
  buffer_load_dwordx4 a[116:119], v137, s[36:39], s51 offen offset:1024 sc1
  ds_read_b64_tr_b16 a[210:211], v243 offset:18432
  v_mfma_f32_16x16x32_bf16 v[56:59], a[180:183], a[56:59], v[56:59]
  ds_read_b64_tr_b16 a[212:213], v243 offset:22528
  v_mfma_f32_16x16x32_bf16 v[56:59], a[176:179], a[48:51], v[56:59]
  s_waitcnt lgkmcnt(11)
  ds_read_b64_tr_b16 a[214:215], v243 offset:26624
  v_mfma_f32_16x16x32_bf16 v[144:147], a[184:187], a[48:51], v[144:147]
  ds_read_b64_tr_b16 a[176:177], v240 offset:28672
  v_mfma_f32_16x16x32_bf16 v[144:147], a[188:191], a[56:59], v[144:147]
  buffer_load_dwordx4 v135, s[24:27], s50 offen offset:2048 lds
  s_add_u32 s51, s51, 6144
  v_mfma_f32_16x16x32_bf16 v[148:151], a[188:191], a[60:63], v[148:151]
  ds_read_b64_tr_b16 a[178:179], v240 offset:32768
  ds_read_b64_tr_b16 a[180:181], v240 offset:36864
  v_mfma_f32_16x16x32_bf16 v[148:151], a[184:187], a[52:55], v[148:151]
  s_waitcnt lgkmcnt(11)
  ds_read_b64_tr_b16 a[182:183], v240 offset:40960
  v_mfma_f32_16x16x32_bf16 v[156:159], a[192:195], a[52:55], v[156:159]
  ds_read_b64_tr_b16 a[184:185], v241 offset:28672
  v_mfma_f32_16x16x32_bf16 v[156:159], a[196:199], a[60:63], v[156:159]
  buffer_load_dwordx4 a[120:123], v137, s[36:39], s51 offen offset:2048 sc1
  ds_read_b64_tr_b16 a[186:187], v241 offset:32768
  v_mfma_f32_16x16x32_bf16 v[152:155], a[196:199], a[56:59], v[152:155]
  s_add_u32 s76, s70, 126976
  ds_read_b64_tr_b16 a[188:189], v241 offset:36864
  v_and_b32 v129, 15, v128
  v_mfma_f32_16x16x32_bf16 v[152:155], a[192:195], a[48:51], v[152:155]
  s_waitcnt lgkmcnt(11)
  ds_read_b64_tr_b16 a[190:191], v241 offset:40960
  v_lshrrev_b32 v131, 1, v129
  v_mfma_f32_16x16x32_bf16 v[160:163], a[200:203], a[48:51], v[160:163]
  ds_read_b64_tr_b16 a[192:193], v242 offset:28672
  v_lshrrev_b32 v130, 5, v128
  v_mfma_f32_16x16x32_bf16 v[160:163], a[204:207], a[56:59], v[160:163]
  buffer_load_dwordx4 v136, s[24:27], s50 offen offset:3072 lds
  ds_read_b64_tr_b16 a[194:195], v242 offset:32768
  v_mfma_f32_16x16x32_bf16 v[164:167], a[204:207], a[60:63], v[164:167]
  ds_read_b64_tr_b16 a[196:197], v242 offset:36864
  v_xor_b32 v131, v131, v130
  v_mfma_f32_16x16x32_bf16 v[164:167], a[200:203], a[52:55], v[164:167]
  s_waitcnt lgkmcnt(11)
  ds_read_b64_tr_b16 a[198:199], v242 offset:40960
  v_lshlrev_b32 v131, 4, v131
  v_mfma_f32_16x16x32_bf16 v[172:175], a[208:211], a[52:55], v[172:175]
  ds_read_b64_tr_b16 a[200:201], v243 offset:28672
  v_lshl_add_u32 v131, v129, 7, v131
  v_mfma_f32_16x16x32_bf16 v[172:175], a[212:215], a[60:63], v[172:175]
  buffer_load_dwordx4 a[124:127], v137, s[36:39], s51 offen offset:3072 sc1
  s_cmp_eq_u32 s87, 1
  v_mfma_f32_16x16x32_bf16 v[168:171], a[212:215], a[56:59], v[168:171]
  s_cselect_b32 s86, 7, 35
  s_lshl_b32 s50, s86, 16
  s_add_u32 s50, s50, s88
  v_mfma_f32_16x16x32_bf16 v[168:171], a[208:211], a[48:51], v[168:171]
  s_waitcnt vmcnt(25) lgkmcnt(9)
  s_add_u32 m0, s70, 94208
  ds_read_b64_tr_b16 a[202:203], v243 offset:32768
  v_mfma_f32_16x16x32_bf16 v[32:35], a[176:179], a[64:67], v[32:35]
  ds_read_b64_tr_b16 a[204:205], v243 offset:36864
  ds_read_b64_tr_b16 a[206:207], v243 offset:40960
  v_mfma_f32_16x16x32_bf16 v[32:35], a[180:183], a[72:75], v[32:35]
  ds_read_b64_tr_b16 a[208:209], v240 offset:30720
  buffer_load_dwordx4 v133, s[24:27], s50 offen offset:0 lds
  v_mfma_f32_16x16x32_bf16 v[36:39], a[180:183], a[76:79], v[36:39]
  s_lshl_b32 s51, s86, 11
  ds_read_b64_tr_b16 a[210:211], v240 offset:34816
  ds_read_b64_tr_b16 a[212:213], v240 offset:38912
  v_mfma_f32_16x16x32_bf16 v[36:39], a[176:179], a[68:71], v[36:39]
  s_waitcnt lgkmcnt(11)
  ds_read_b64_tr_b16 a[214:215], v240 offset:43008
  v_bfe_u32 v130, v128, 4, 1
  v_mfma_f32_16x16x32_bf16 v[44:47], a[184:187], a[68:71], v[44:47]
  ds_read_b64_tr_b16 a[176:177], v241 offset:30720
  v_lshl_add_u32 v131, v130, 3, v131
  v_mfma_f32_16x16x32_bf16 v[44:47], a[188:191], a[76:79], v[44:47]
  buffer_load_dwordx4 a[128:131], v137, s[36:39], s51 offen offset:0 sc1
  ds_read_b64_tr_b16 a[178:179], v241 offset:34816
  v_mfma_f32_16x16x32_bf16 v[40:43], a[188:191], a[72:75], v[40:43]
  ds_read_b64_tr_b16 a[180:181], v241 offset:38912
  v_add_u32 v140, s76, v131
  v_mfma_f32_16x16x32_bf16 v[40:43], a[184:187], a[64:67], v[40:43]
  s_waitcnt vmcnt(20) lgkmcnt(11)
  s_barrier
  ds_read_b64_tr_b16 a[182:183], v241 offset:43008
  v_mfma_f32_16x16x32_bf16 v[48:51], a[192:195], a[64:67], v[48:51]
  ds_read_b64_tr_b16 a[184:185], v242 offset:30720
  v_xor_b32 v141, 32, v140
  v_mfma_f32_16x16x32_bf16 v[48:51], a[196:199], a[72:75], v[48:51]
  buffer_load_dwordx4 v134, s[24:27], s50 offen offset:1024 lds
  ds_read_b64_tr_b16 a[186:187], v242 offset:34816
  v_mfma_f32_16x16x32_bf16 v[52:55], a[196:199], a[76:79], v[52:55]
  ds_read_b64_tr_b16 a[188:189], v242 offset:38912
  v_xor_b32 v142, 64, v140
  v_mfma_f32_16x16x32_bf16 v[52:55], a[192:195], a[68:71], v[52:55]
  s_waitcnt lgkmcnt(11)
  ds_read_b64_tr_b16 a[190:191], v242 offset:43008
  v_xor_b32 v143, 96, v140
  v_mfma_f32_16x16x32_bf16 v[60:63], a[200:203], a[68:71], v[60:63]
  ds_read_b64_tr_b16 a[192:193], v243 offset:30720
  v_add_u32 v254, s76, v0
  v_mfma_f32_16x16x32_bf16 v[60:63], a[204:207], a[76:79], v[60:63]
  s_lshl_b32 s76, s44, 10
  buffer_load_dwordx4 a[132:135], v137, s[36:39], s51 offen offset:1024 sc1
  ds_read_b64_tr_b16 a[194:195], v243 offset:34816
  v_mfma_f32_16x16x32_bf16 v[56:59], a[204:207], a[72:75], v[56:59]
  s_add_u32 s76, s76, 0
  ds_read_b64_tr_b16 a[196:197], v243 offset:38912
  v_add_u32 v129, s76, v0
  v_mfma_f32_16x16x32_bf16 v[56:59], a[200:203], a[64:67], v[56:59]
  s_waitcnt lgkmcnt(11)
  ds_read_b64_tr_b16 a[198:199], v243 offset:43008
  v_lshrrev_b32 v130, 4, v128
  v_mfma_f32_16x16x32_bf16 v[144:147], a[208:211], a[64:67], v[144:147]
  buffer_load_dwordx4 v135, s[24:27], s50 offen offset:2048 lds
  s_add_u32 s51, s51, 6144
  v_mfma_f32_16x16x32_bf16 v[144:147], a[212:215], a[72:75], v[144:147]
  ds_read_b64_tr_b16 a[200:201], v240 offset:45056
  ds_read_b64_tr_b16 a[202:203], v240 offset:49152
  v_mfma_f32_16x16x32_bf16 v[148:151], a[212:215], a[76:79], v[148:151]
  ds_read_b64_tr_b16 a[204:205], v240 offset:53248
  v_lshl_add_u32 v130, v130, 4, s76
  v_mfma_f32_16x16x32_bf16 v[148:151], a[208:211], a[68:71], v[148:151]
  s_waitcnt lgkmcnt(11)
  ds_read_b64_tr_b16 a[206:207], v240 offset:57344
  ds_write_b128 v129, a[248:251]
  v_mfma_f32_16x16x32_bf16 v[156:159], a[176:179], a[68:71], v[156:159]
  buffer_load_dwordx4 a[136:139], v137, s[36:39], s51 offen offset:2048 sc1
  ds_read_b64_tr_b16 a[208:209], v241 offset:45056
  v_mfma_f32_16x16x32_bf16 v[156:159], a[180:183], a[76:79], v[156:159]
  ds_read_b64_tr_b16 a[210:211], v241 offset:49152
  ds_read_b128 v[176:179], v130 offset:768
  v_mfma_f32_16x16x32_bf16 v[152:155], a[180:183], a[72:75], v[152:155]
  ds_read_b64_tr_b16 a[212:213], v241 offset:53248
  ds_read_b128 v[180:183], v130 offset:832
  v_mfma_f32_16x16x32_bf16 v[152:155], a[176:179], a[64:67], v[152:155]
  s_waitcnt lgkmcnt(14)
  ds_read_b64_tr_b16 a[214:215], v241 offset:57344
  ds_read_b128 v[184:187], v130 offset:896
  v_mfma_f32_16x16x32_bf16 v[160:163], a[184:187], a[64:67], v[160:163]
  buffer_load_dwordx4 v136, s[24:27], s50 offen offset:3072 lds
  ds_read_b64_tr_b16 a[176:177], v242 offset:45056
  v_mfma_f32_16x16x32_bf16 v[160:163], a[188:191], a[72:75], v[160:163]
  ds_read_b64_tr_b16 a[178:179], v242 offset:49152
  ds_read_b128 v[188:191], v130 offset:960
  v_mfma_f32_16x16x32_bf16 v[164:167], a[188:191], a[76:79], v[164:167]
  ds_read_b64_tr_b16 a[180:181], v242 offset:53248
  v_accvgpr_read_b32 v131, a232
  v_mfma_f32_16x16x32_bf16 v[164:167], a[184:187], a[68:71], v[164:167]
  s_waitcnt lgkmcnt(15)
  ds_read_b64_tr_b16 a[182:183], v242 offset:57344
  v_lshlrev_b32 v64, 16, v131
  v_mfma_f32_16x16x32_bf16 v[172:175], a[192:195], a[68:71], v[172:175]
  buffer_load_dwordx4 a[140:143], v137, s[36:39], s51 offen offset:3072 sc1
  s_cmp_eq_u32 s87, 2
  v_mfma_f32_16x16x32_bf16 v[172:175], a[196:199], a[76:79], v[172:175]
  s_cselect_b32 s69, 14, 42
  s_lshl_b32 s50, s69, 16
  s_add_u32 s50, s50, s88
  v_mfma_f32_16x16x32_bf16 v[168:171], a[196:199], a[72:75], v[168:171]
  s_add_u32 m0, s70, 110592
  ds_read_b64_tr_b16 a[184:185], v243 offset:45056
  ds_read_b64_tr_b16 a[186:187], v243 offset:49152
  v_mfma_f32_16x16x32_bf16 v[168:171], a[192:195], a[64:67], v[168:171]
  s_waitcnt vmcnt(25) lgkmcnt(15)
  ds_read_b64_tr_b16 a[188:189], v243 offset:53248
  ds_read_b64_tr_b16 a[190:191], v243 offset:57344
  v_mfma_f32_16x16x32_bf16 v[32:35], a[200:203], a[80:83], v[32:35]
  buffer_load_dwordx4 v133, s[24:27], s50 offen offset:0 lds
  s_lshl_b32 s51, s69, 11
  v_mfma_f32_16x16x32_bf16 v[32:35], a[204:207], a[88:91], v[32:35]
  ds_read_b64_tr_b16 a[192:193], v240 offset:47104
  ds_read_b64_tr_b16 a[194:195], v240 offset:51200
  v_mfma_f32_16x16x32_bf16 v[36:39], a[204:207], a[92:95], v[36:39]
  ds_read_b64_tr_b16 a[196:197], v240 offset:55296
  v_and_b32 v65, 0xffff0000, v131
  v_mfma_f32_16x16x32_bf16 v[36:39], a[200:203], a[84:87], v[36:39]
  s_waitcnt lgkmcnt(13)
  ds_read_b64_tr_b16 a[198:199], v240 offset:59392
  v_accvgpr_read_b32 v131, a233
  v_mfma_f32_16x16x32_bf16 v[44:47], a[208:211], a[84:87], v[44:47]
  buffer_load_dwordx4 a[216:219], v137, s[36:39], s51 offen offset:0 sc1
  ds_read_b64_tr_b16 a[200:201], v241 offset:47104
  v_mfma_f32_16x16x32_bf16 v[44:47], a[212:215], a[92:95], v[44:47]
  ds_read_b64_tr_b16 a[202:203], v241 offset:51200
  v_lshlrev_b32 v66, 16, v131
  v_mfma_f32_16x16x32_bf16 v[40:43], a[212:215], a[88:91], v[40:43]
  ds_read_b64_tr_b16 a[204:205], v241 offset:55296
  v_and_b32 v67, 0xffff0000, v131
  v_mfma_f32_16x16x32_bf16 v[40:43], a[208:211], a[80:83], v[40:43]
  s_waitcnt vmcnt(19) lgkmcnt(11)
  s_barrier
  ds_read_b64_tr_b16 a[206:207], v241 offset:59392
  v_mfma_f32_16x16x32_bf16 v[48:51], a[176:179], a[80:83], v[48:51]
  buffer_load_dwordx4 v134, s[24:27], s50 offen offset:1024 lds
  ds_read_b64_tr_b16 a[208:209], v242 offset:47104
  v_mfma_f32_16x16x32_bf16 v[48:51], a[180:183], a[88:91], v[48:51]
  ds_read_b64_tr_b16 a[210:211], v242 offset:51200
  v_accvgpr_read_b32 v131, a234
  v_mfma_f32_16x16x32_bf16 v[52:55], a[180:183], a[92:95], v[52:55]
  ds_read_b64_tr_b16 a[212:213], v242 offset:55296
  v_lshlrev_b32 v68, 16, v131
  v_mfma_f32_16x16x32_bf16 v[52:55], a[176:179], a[84:87], v[52:55]
  s_waitcnt lgkmcnt(11)
  ds_read_b64_tr_b16 a[214:215], v242 offset:59392
  v_and_b32 v69, 0xffff0000, v131
  v_mfma_f32_16x16x32_bf16 v[60:63], a[184:187], a[84:87], v[60:63]
  buffer_load_dwordx4 a[220:223], v137, s[36:39], s51 offen offset:1024 sc1
  ds_read_b64_tr_b16 a[176:177], v243 offset:47104
  v_mfma_f32_16x16x32_bf16 v[60:63], a[188:191], a[92:95], v[60:63]
  ds_read_b64_tr_b16 a[178:179], v243 offset:51200
  v_accvgpr_read_b32 v131, a235
  v_mfma_f32_16x16x32_bf16 v[56:59], a[188:191], a[88:91], v[56:59]
  ds_read_b64_tr_b16 a[180:181], v243 offset:55296
  v_lshlrev_b32 v70, 16, v131
  v_mfma_f32_16x16x32_bf16 v[56:59], a[184:187], a[80:83], v[56:59]
  s_waitcnt lgkmcnt(11)
  buffer_load_dword v139, v138, s[36:39], s91 offen sc1
  ds_read_b64_tr_b16 a[182:183], v243 offset:59392
  v_mfma_f32_16x16x32_bf16 v[144:147], a[192:195], a[80:83], v[144:147]
  ds_read_b64_tr_b16 a[184:185], v240 offset:61440
  v_and_b32 v71, 0xffff0000, v131
  v_mfma_f32_16x16x32_bf16 v[144:147], a[196:199], a[88:91], v[144:147]
  ds_read_b64_tr_b16 a[186:187], v244 offset:0
  v_accvgpr_read_b32 v131, a236
  v_mfma_f32_16x16x32_bf16 v[148:151], a[196:199], a[92:95], v[148:151]
  buffer_load_dwordx4 v135, s[24:27], s50 offen offset:2048 lds
  s_add_u32 s51, s51, 6144
  v_mfma_f32_16x16x32_bf16 v[148:151], a[192:195], a[84:87], v[148:151]
  s_waitcnt lgkmcnt(10)
  ds_read_b64_tr_b16 a[188:189], v244 offset:4096
  ds_read_b64_tr_b16 a[190:191], v244 offset:8192
  v_mfma_f32_16x16x32_bf16 v[156:159], a[200:203], a[84:87], v[156:159]
  ds_read_b64_tr_b16 a[192:193], v241 offset:61440
  v_lshlrev_b32 v72, 16, v131
  v_mfma_f32_16x16x32_bf16 v[156:159], a[204:207], a[92:95], v[156:159]
  buffer_load_dwordx4 a[224:227], v137, s[36:39], s51 offen offset:2048 sc1
  ds_read_b64_tr_b16 a[194:195], v245 offset:0
  v_mfma_f32_16x16x32_bf16 v[152:155], a[204:207], a[88:91], v[152:155]
  ds_read_b64_tr_b16 a[196:197], v245 offset:4096
  v_and_b32 v73, 0xffff0000, v131
  v_mfma_f32_16x16x32_bf16 v[152:155], a[200:203], a[80:83], v[152:155]
  s_waitcnt lgkmcnt(11)
  ds_read_b64_tr_b16 a[198:199], v245 offset:8192
  v_accvgpr_read_b32 v131, a237
  v_mfma_f32_16x16x32_bf16 v[160:163], a[208:211], a[80:83], v[160:163]
  buffer_load_dwordx4 v136, s[24:27], s50 offen offset:3072 lds
  ds_read_b64_tr_b16 a[200:201], v242 offset:61440
  v_mfma_f32_16x16x32_bf16 v[160:163], a[212:215], a[88:91], v[160:163]
  ds_read_b64_tr_b16 a[202:203], v246 offset:0
  v_lshlrev_b32 v74, 16, v131
  v_mfma_f32_16x16x32_bf16 v[164:167], a[212:215], a[92:95], v[164:167]
  ds_read_b64_tr_b16 a[204:205], v246 offset:4096
  v_and_b32 v75, 0xffff0000, v131
  v_mfma_f32_16x16x32_bf16 v[164:167], a[208:211], a[84:87], v[164:167]
  s_waitcnt lgkmcnt(11)
  ds_read_b64_tr_b16 a[206:207], v246 offset:8192
  v_accvgpr_read_b32 v131, a238
  v_mfma_f32_16x16x32_bf16 v[172:175], a[176:179], a[84:87], v[172:175]
  buffer_load_dwordx4 a[228:231], v137, s[36:39], s51 offen offset:3072 sc1
  s_cmp_eq_u32 s87, 3
  v_mfma_f32_16x16x32_bf16 v[172:175], a[180:183], a[92:95], v[172:175]
  s_cselect_b32 s71, 21, 49
  s_lshl_b32 s50, s71, 16
  s_add_u32 s50, s50, s88
  v_mfma_f32_16x16x32_bf16 v[168:171], a[180:183], a[88:91], v[168:171]
  s_add_u32 m0, s70, 126976
  ds_read_b64_tr_b16 a[208:209], v243 offset:61440
  ds_read_b64_tr_b16 a[210:211], v247 offset:0
  v_mfma_f32_16x16x32_bf16 v[168:171], a[176:179], a[80:83], v[168:171]
  s_waitcnt vmcnt(25) lgkmcnt(10)
  ds_read_b64_tr_b16 a[212:213], v247 offset:4096
  ds_read_b64_tr_b16 a[214:215], v247 offset:8192
  v_mfma_f32_16x16x32_bf16 v[32:35], a[184:187], a[96:99], v[32:35]
  buffer_load_dwordx4 v133, s[24:27], s50 offen offset:0 lds
  s_lshl_b32 s51, s71, 11
  v_mfma_f32_16x16x32_bf16 v[32:35], a[188:191], a[104:107], v[32:35]
  ds_read_b64_tr_b16 a[176:177], v240 offset:63488
  ds_read_b64_tr_b16 a[178:179], v244 offset:2048
  v_mfma_f32_16x16x32_bf16 v[36:39], a[188:191], a[108:111], v[36:39]
  ds_read_b64_tr_b16 a[180:181], v244 offset:6144
  v_lshlrev_b32 v76, 16, v131
  v_mfma_f32_16x16x32_bf16 v[36:39], a[184:187], a[100:103], v[36:39]
  s_waitcnt lgkmcnt(11)
  ds_read_b64_tr_b16 a[182:183], v244 offset:10240
  v_and_b32 v77, 0xffff0000, v131
  v_mfma_f32_16x16x32_bf16 v[44:47], a[192:195], a[100:103], v[44:47]
  buffer_load_dwordx4 a[0:3], v137, s[36:39], s51 offen offset:0 sc1
  ds_read_b64_tr_b16 a[184:185], v241 offset:63488
  v_mfma_f32_16x16x32_bf16 v[44:47], a[196:199], a[108:111], v[44:47]
  ds_read_b64_tr_b16 a[186:187], v245 offset:2048
  v_accvgpr_read_b32 v131, a239
  v_mfma_f32_16x16x32_bf16 v[40:43], a[196:199], a[104:107], v[40:43]
  ds_read_b64_tr_b16 a[188:189], v245 offset:6144
  v_lshlrev_b32 v78, 16, v131
  v_mfma_f32_16x16x32_bf16 v[40:43], a[192:195], a[96:99], v[40:43]
  s_waitcnt vmcnt(20) lgkmcnt(11)
  s_barrier
  ds_read_b64_tr_b16 a[190:191], v245 offset:10240
  v_mfma_f32_16x16x32_bf16 v[48:51], a[200:203], a[96:99], v[48:51]
  buffer_load_dwordx4 v134, s[24:27], s50 offen offset:1024 lds
  ds_read_b64_tr_b16 a[192:193], v242 offset:63488
  v_mfma_f32_16x16x32_bf16 v[48:51], a[204:207], a[104:107], v[48:51]
  ds_read_b64_tr_b16 a[194:195], v246 offset:2048
  v_and_b32 v79, 0xffff0000, v131
  v_mfma_f32_16x16x32_bf16 v[52:55], a[204:207], a[108:111], v[52:55]
  ds_read_b64_tr_b16 a[196:197], v246 offset:6144
  v_accvgpr_read_b32 v131, a240
  v_mfma_f32_16x16x32_bf16 v[52:55], a[200:203], a[100:103], v[52:55]
  s_waitcnt lgkmcnt(11)
  buffer_load_dwordx4 a[4:7], v137, s[36:39], s51 offen offset:1024 sc1
  ds_read_b64_tr_b16 a[198:199], v246 offset:10240
  v_mfma_f32_16x16x32_bf16 v[60:63], a[208:211], a[100:103], v[60:63]
  ds_read_b64_tr_b16 a[200:201], v243 offset:63488
  v_lshlrev_b32 v80, 16, v131
  v_mfma_f32_16x16x32_bf16 v[60:63], a[212:215], a[108:111], v[60:63]
  ds_read_b64_tr_b16 a[202:203], v247 offset:2048
  v_and_b32 v81, 0xffff0000, v131
  v_mfma_f32_16x16x32_bf16 v[56:59], a[212:215], a[104:107], v[56:59]
  ds_read_b64_tr_b16 a[204:205], v247 offset:6144
  v_accvgpr_read_b32 v131, a241
  v_mfma_f32_16x16x32_bf16 v[56:59], a[208:211], a[96:99], v[56:59]
  s_waitcnt lgkmcnt(11)
  buffer_load_dwordx4 v135, s[24:27], s50 offen offset:2048 lds
  s_add_u32 s51, s51, 6144
  v_mfma_f32_16x16x32_bf16 v[144:147], a[176:179], a[96:99], v[144:147]
  ds_read_b64_tr_b16 a[206:207], v247 offset:10240
  ds_read_b64_tr_b16 a[208:209], v244 offset:12288
  v_mfma_f32_16x16x32_bf16 v[144:147], a[180:183], a[104:107], v[144:147]
  ds_read_b64_tr_b16 a[210:211], v244 offset:16384
  v_lshlrev_b32 v82, 16, v131
  v_mfma_f32_16x16x32_bf16 v[148:151], a[180:183], a[108:111], v[148:151]
  ds_read_b64_tr_b16 a[212:213], v244 offset:20480
  v_and_b32 v83, 0xffff0000, v131
  v_mfma_f32_16x16x32_bf16 v[148:151], a[176:179], a[100:103], v[148:151]
  s_waitcnt lgkmcnt(11)
  buffer_load_dwordx4 a[8:11], v137, s[36:39], s51 offen offset:2048 sc1
  ds_read_b64_tr_b16 a[214:215], v244 offset:24576
  v_mfma_f32_16x16x32_bf16 v[156:159], a[184:187], a[100:103], v[156:159]
  ds_read_b64_tr_b16 a[176:177], v245 offset:12288
  v_accvgpr_read_b32 v131, a242
  v_mfma_f32_16x16x32_bf16 v[156:159], a[188:191], a[108:111], v[156:159]
  ds_read_b64_tr_b16 a[178:179], v245 offset:16384
  v_lshlrev_b32 v84, 16, v131
  v_mfma_f32_16x16x32_bf16 v[152:155], a[188:191], a[104:107], v[152:155]
  ds_read_b64_tr_b16 a[180:181], v245 offset:20480
  v_and_b32 v85, 0xffff0000, v131
  v_mfma_f32_16x16x32_bf16 v[152:155], a[184:187], a[96:99], v[152:155]
  s_waitcnt lgkmcnt(11)
  buffer_load_dwordx4 v136, s[24:27], s50 offen offset:3072 lds
  ds_read_b64_tr_b16 a[182:183], v245 offset:24576
  v_mfma_f32_16x16x32_bf16 v[160:163], a[192:195], a[96:99], v[160:163]
  ds_read_b64_tr_b16 a[184:185], v246 offset:12288
  v_accvgpr_read_b32 v131, a243
  v_mfma_f32_16x16x32_bf16 v[160:163], a[196:199], a[104:107], v[160:163]
  ds_read_b64_tr_b16 a[186:187], v246 offset:16384
  v_lshlrev_b32 v86, 16, v131
  v_mfma_f32_16x16x32_bf16 v[164:167], a[196:199], a[108:111], v[164:167]
  ds_read_b64_tr_b16 a[188:189], v246 offset:20480
  v_and_b32 v87, 0xffff0000, v131
  v_mfma_f32_16x16x32_bf16 v[164:167], a[192:195], a[100:103], v[164:167]
  s_waitcnt lgkmcnt(11)
  buffer_load_dwordx4 a[12:15], v137, s[36:39], s51 offen offset:3072 sc1
  s_mov_b32 s72, 1
  v_mfma_f32_16x16x32_bf16 v[172:175], a[200:203], a[100:103], v[172:175]
  s_lshl_b32 s50, s72, 16
  s_add_u32 m0, s70, 143360
  ds_read_b64_tr_b16 a[190:191], v246 offset:24576
  v_mfma_f32_16x16x32_bf16 v[172:175], a[204:207], a[108:111], v[172:175]
  ds_read_b64_tr_b16 a[192:193], v247 offset:12288
  ds_read_b64_tr_b16 a[194:195], v247 offset:16384
  v_mfma_f32_16x16x32_bf16 v[168:171], a[204:207], a[104:107], v[168:171]
  ds_read_b64_tr_b16 a[196:197], v247 offset:20480
  v_accvgpr_read_b32 v131, a244
  v_mfma_f32_16x16x32_bf16 v[168:171], a[200:203], a[96:99], v[168:171]
  s_waitcnt vmcnt(25) lgkmcnt(11)
  buffer_load_dwordx4 v133, s[24:27], s50 offen offset:0 lds
  ds_read_b64_tr_b16 a[198:199], v247 offset:24576
  v_mfma_f32_16x16x32_bf16 v[32:35], a[208:211], a[112:115], v[32:35]
  s_waitcnt vmcnt(13)
  v_cmp_ne_u32 vcc, s3, v139
  s_nop 4
  s_cbranch_vccnz CK10s
CK10x:
  v_mfma_f32_16x16x32_bf16 v[32:35], a[212:215], a[120:123], v[32:35]
  s_lshl_b32 s51, s72, 11
  s_add_u32 s91, s91, 32768
  ds_read_b64_tr_b16 a[200:201], v244 offset:14336
  v_mfma_f32_16x16x32_bf16 v[36:39], a[212:215], a[124:127], v[36:39]
  ds_read_b64_tr_b16 a[202:203], v244 offset:18432
  ds_read_b64_tr_b16 a[204:205], v244 offset:22528
  v_mfma_f32_16x16x32_bf16 v[36:39], a[208:211], a[116:119], v[36:39]
  s_waitcnt lgkmcnt(11)
  buffer_load_dwordx4 a[16:19], v137, s[36:39], s51 offen offset:0 sc1
  ds_read_b64_tr_b16 a[206:207], v244 offset:26624
  v_mfma_f32_16x16x32_bf16 v[44:47], a[176:179], a[116:119], v[44:47]
  ds_read_b64_tr_b16 a[208:209], v245 offset:14336
  v_lshlrev_b32 v88, 16, v131
  v_mfma_f32_16x16x32_bf16 v[44:47], a[180:183], a[124:127], v[44:47]
  ds_read_b64_tr_b16 a[210:211], v245 offset:18432
  v_and_b32 v89, 0xffff0000, v131
  v_mfma_f32_16x16x32_bf16 v[40:43], a[180:183], a[120:123], v[40:43]
  ds_read_b64_tr_b16 a[212:213], v245 offset:22528
  v_accvgpr_read_b32 v131, a245
  v_mfma_f32_16x16x32_bf16 v[40:43], a[176:179], a[112:115], v[40:43]
  s_waitcnt vmcnt(20) lgkmcnt(11)
  s_barrier
  buffer_load_dwordx4 v134, s[24:27], s50 offen offset:1024 lds
  v_mfma_f32_16x16x32_bf16 v[48:51], a[184:187], a[112:115], v[48:51]
  ds_read_b64_tr_b16 a[214:215], v245 offset:26624
  ds_read_b64_tr_b16 a[176:177], v246 offset:14336
  v_mfma_f32_16x16x32_bf16 v[48:51], a[188:191], a[120:123], v[48:51]
  ds_read_b64_tr_b16 a[178:179], v246 offset:18432
  v_lshlrev_b32 v90, 16, v131
  v_mfma_f32_16x16x32_bf16 v[52:55], a[188:191], a[124:127], v[52:55]
  ds_read_b64_tr_b16 a[180:181], v246 offset:22528
  v_and_b32 v91, 0xffff0000, v131
  v_mfma_f32_16x16x32_bf16 v[52:55], a[184:187], a[116:119], v[52:55]
  s_waitcnt lgkmcnt(11)
  buffer_load_dwordx4 a[20:23], v137, s[36:39], s51 offen offset:1024 sc1
  ds_read_b64_tr_b16 a[182:183], v246 offset:26624
  v_mfma_f32_16x16x32_bf16 v[60:63], a[192:195], a[116:119], v[60:63]
  ds_read_b64_tr_b16 a[184:185], v247 offset:14336
  v_accvgpr_read_b32 v131, a246
  v_mfma_f32_16x16x32_bf16 v[60:63], a[196:199], a[124:127], v[60:63]
  ds_read_b64_tr_b16 a[186:187], v247 offset:18432
  v_lshlrev_b32 v92, 16, v131
  v_mfma_f32_16x16x32_bf16 v[56:59], a[196:199], a[120:123], v[56:59]
  ds_read_b64_tr_b16 a[188:189], v247 offset:22528
  v_and_b32 v93, 0xffff0000, v131
  v_mfma_f32_16x16x32_bf16 v[56:59], a[192:195], a[112:115], v[56:59]
  s_waitcnt lgkmcnt(11)
  buffer_load_dwordx4 v135, s[24:27], s50 offen offset:2048 lds
  ds_read_b64_tr_b16 a[190:191], v247 offset:26624
  v_mfma_f32_16x16x32_bf16 v[144:147], a[200:203], a[112:115], v[144:147]
  ds_read_b64_tr_b16 a[192:193], v244 offset:28672
  v_accvgpr_read_b32 v131, a247
  v_mfma_f32_16x16x32_bf16 v[144:147], a[204:207], a[120:123], v[144:147]
  ds_read_b64_tr_b16 a[194:195], v244 offset:32768
  v_lshlrev_b32 v94, 16, v131
  v_mfma_f32_16x16x32_bf16 v[148:151], a[204:207], a[124:127], v[148:151]
  ds_read_b64_tr_b16 a[196:197], v244 offset:36864
  v_and_b32 v95, 0xffff0000, v131
  v_mfma_f32_16x16x32_bf16 v[148:151], a[200:203], a[116:119], v[148:151]
  s_waitcnt lgkmcnt(11)
  buffer_load_dwordx4 a[24:27], v137, s[36:39], s51 offen offset:2048 sc1
  ds_read_b64_tr_b16 a[198:199], v244 offset:40960
  v_mfma_f32_16x16x32_bf16 v[156:159], a[208:211], a[116:119], v[156:159]
  s_add_u32 s49, s55, 32768
  ds_read_b64_tr_b16 a[200:201], v245 offset:28672
  s_lshl_b32 s76, s2, 5
  v_mfma_f32_16x16x32_bf16 v[156:159], a[212:215], a[124:127], v[156:159]
  s_add_u32 s76, s76, s44
  ds_read_b64_tr_b16 a[202:203], v245 offset:32768
  s_lshl2_add_u32 s76, s76, 5472256
  v_mfma_f32_16x16x32_bf16 v[152:155], a[212:215], a[120:123], v[152:155]
  s_xor_b32 s77, s76, 128
  ds_read_b64_tr_b16 a[204:205], v245 offset:36864
  v_mov_b32 v132, 0
  v_mfma_f32_16x16x32_bf16 v[152:155], a[208:211], a[112:115], v[152:155]
  s_waitcnt lgkmcnt(11)
  buffer_load_dwordx4 v136, s[24:27], s50 offen offset:3072 lds
  ds_read_b64_tr_b16 a[206:207], v245 offset:40960
  v_mfma_f32_16x16x32_bf16 v[160:163], a[176:179], a[112:115], v[160:163]
  ds_read_b64_tr_b16 a[208:209], v246 offset:28672
  v_mfma_f32_16x16x32_bf16 v[160:163], a[180:183], a[120:123], v[160:163]
  ds_read_b64_tr_b16 a[210:211], v246 offset:32768
  v_mfma_f32_16x16x32_bf16 v[164:167], a[180:183], a[124:127], v[164:167]
Hb1:
  s_cbranch_execz Hb1_1
  ds_read_b64_tr_b16 a[212:213], v246 offset:36864
  v_mfma_f32_16x16x32_bf16 v[164:167], a[176:179], a[116:119], v[164:167]
  s_waitcnt lgkmcnt(11)
  buffer_load_dwordx4 a[28:31], v137, s[36:39], s51 offen offset:3072 sc1
  s_cmp_eq_u32 s87, 1
  v_mfma_f32_16x16x32_bf16 v[172:175], a[184:187], a[116:119], v[172:175]
  s_cselect_b32 s73, 19, 5
  s_lshl_b32 s50, s73, 16
  s_add_u32 m0, s70, 12288
  v_mfma_f32_16x16x32_bf16 v[172:175], a[188:191], a[124:127], v[172:175]
  ds_read_b64_tr_b16 a[214:215], v246 offset:40960
  ds_read_b64_tr_b16 a[176:177], v247 offset:28672
  v_mfma_f32_16x16x32_bf16 v[168:171], a[188:191], a[120:123], v[168:171]
  ds_read_b64_tr_b16 a[178:179], v247 offset:32768
  ds_read_b64_tr_b16 a[180:181], v247 offset:36864
  v_mfma_f32_16x16x32_bf16 v[168:171], a[184:187], a[112:115], v[168:171]
  s_waitcnt vmcnt(25) lgkmcnt(11)
  buffer_load_dwordx4 v133, s[24:27], s50 offen offset:0 lds
  s_lshl_b32 s51, s73, 11
  v_mfma_f32_16x16x32_bf16 v[32:35], a[192:195], a[128:131], v[32:35]
  ds_read_b64_tr_b16 a[182:183], v247 offset:40960
  ds_read_b64_tr_b16 a[184:185], v244 offset:30720
  v_mfma_f32_16x16x32_bf16 v[32:35], a[196:199], a[136:139], v[32:35]
  ds_read_b64_tr_b16 a[186:187], v244 offset:34816
  v_mfma_f32_16x16x32_bf16 v[36:39], a[196:199], a[140:143], v[36:39]
  buffer_load_dwordx4 a[32:35], v137, s[36:39], s51 offen offset:0 sc1
  ds_read_b64_tr_b16 a[188:189], v244 offset:38912
  v_mfma_f32_16x16x32_bf16 v[36:39], a[192:195], a[132:135], v[36:39]
  s_waitcnt lgkmcnt(11)
  ds_read_b64_tr_b16 a[190:191], v244 offset:43008
  v_mfma_f32_16x16x32_bf16 v[44:47], a[200:203], a[132:135], v[44:47]
  ds_read_b64_tr_b16 a[192:193], v245 offset:30720
  v_mfma_f32_16x16x32_bf16 v[44:47], a[204:207], a[140:143], v[44:47]
  ds_read_b64_tr_b16 a[194:195], v245 offset:34816
  v_mfma_f32_16x16x32_bf16 v[40:43], a[204:207], a[136:139], v[40:43]
  buffer_load_dwordx4 v134, s[24:27], s50 offen offset:1024 lds
  ds_read_b64_tr_b16 a[196:197], v245 offset:38912
  v_mfma_f32_16x16x32_bf16 v[40:43], a[200:203], a[128:131], v[40:43]
  s_waitcnt vmcnt(20) lgkmcnt(11)
  s_barrier
  ds_read_b64_tr_b16 a[198:199], v245 offset:43008
  v_mfma_f32_16x16x32_bf16 v[48:51], a[208:211], a[128:131], v[48:51]
  ds_read_b64_tr_b16 a[200:201], v246 offset:30720
  v_mfma_f32_16x16x32_bf16 v[48:51], a[212:215], a[136:139], v[48:51]
  ds_read_b64_tr_b16 a[202:203], v246 offset:34816
  v_mfma_f32_16x16x32_bf16 v[52:55], a[212:215], a[140:143], v[52:55]
  buffer_load_dwordx4 a[36:39], v137, s[36:39], s51 offen offset:1024 sc1
  ds_read_b64_tr_b16 a[204:205], v246 offset:38912
  v_mfma_f32_16x16x32_bf16 v[52:55], a[208:211], a[132:135], v[52:55]
  s_waitcnt lgkmcnt(11)
  ds_read_b64_tr_b16 a[206:207], v246 offset:43008
  v_mfma_f32_16x16x32_bf16 v[60:63], a[176:179], a[132:135], v[60:63]
  ds_read_b64_tr_b16 a[208:209], v247 offset:30720
  v_mfma_f32_16x16x32_bf16 v[60:63], a[180:183], a[140:143], v[60:63]
  ds_read_b64_tr_b16 a[210:211], v247 offset:34816
  v_mfma_f32_16x16x32_bf16 v[56:59], a[180:183], a[136:139], v[56:59]
  buffer_load_dwordx4 v135, s[24:27], s50 offen offset:2048 lds
  ds_read_b64_tr_b16 a[212:213], v247 offset:38912
  v_mfma_f32_16x16x32_bf16 v[56:59], a[176:179], a[128:131], v[56:59]
  s_waitcnt lgkmcnt(11)
  ds_read_b64_tr_b16 a[214:215], v247 offset:43008
  v_mfma_f32_16x16x32_bf16 v[144:147], a[184:187], a[128:131], v[144:147]
  ds_read_b64_tr_b16 a[176:177], v244 offset:45056
  v_mfma_f32_16x16x32_bf16 v[144:147], a[188:191], a[136:139], v[144:147]
  ds_read_b64_tr_b16 a[178:179], v244 offset:49152
  v_mfma_f32_16x16x32_bf16 v[148:151], a[188:191], a[140:143], v[148:151]
  buffer_load_dwordx4 a[40:43], v137, s[36:39], s51 offen offset:2048 sc1
  ds_read_b64_tr_b16 a[180:181], v244 offset:53248
  v_mfma_f32_16x16x32_bf16 v[148:151], a[184:187], a[132:135], v[148:151]
  s_waitcnt lgkmcnt(11)
  ds_read_b64_tr_b16 a[182:183], v244 offset:57344
  v_mfma_f32_16x16x32_bf16 v[156:159], a[192:195], a[132:135], v[156:159]
  ds_read_b64_tr_b16 a[184:185], v245 offset:45056
  v_mfma_f32_16x16x32_bf16 v[156:159], a[196:199], a[140:143], v[156:159]
  ds_read_b64_tr_b16 a[186:187], v245 offset:49152
  v_mfma_f32_16x16x32_bf16 v[152:155], a[196:199], a[136:139], v[152:155]
  buffer_load_dwordx4 v136, s[24:27], s50 offen offset:3072 lds
  ds_read_b64_tr_b16 a[188:189], v245 offset:53248
  v_mfma_f32_16x16x32_bf16 v[152:155], a[192:195], a[128:131], v[152:155]
  s_waitcnt lgkmcnt(11)
  ds_read_b64_tr_b16 a[190:191], v245 offset:57344
  v_mfma_f32_16x16x32_bf16 v[160:163], a[200:203], a[128:131], v[160:163]
  ds_read_b64_tr_b16 a[192:193], v246 offset:45056
  v_mfma_f32_16x16x32_bf16 v[160:163], a[204:207], a[136:139], v[160:163]
  ds_read_b64_tr_b16 a[194:195], v246 offset:49152
  v_mfma_f32_16x16x32_bf16 v[164:167], a[204:207], a[140:143], v[164:167]
  buffer_load_dwordx4 a[44:47], v137, s[36:39], s51 offen offset:3072 sc1
  s_cmp_eq_u32 s87, 2
  v_mfma_f32_16x16x32_bf16 v[164:167], a[200:203], a[132:135], v[164:167]
  s_waitcnt lgkmcnt(10)
  s_cselect_b32 s74, 22, 8
  s_lshl_b32 s50, s74, 16
  v_mfma_f32_16x16x32_bf16 v[172:175], a[208:211], a[132:135], v[172:175]
  s_add_u32 m0, s70, 28672
  ds_read_b64_tr_b16 a[196:197], v246 offset:53248
  ds_read_b64_tr_b16 a[198:199], v246 offset:57344
  v_mfma_f32_16x16x32_bf16 v[172:175], a[212:215], a[140:143], v[172:175]
  ds_read_b64_tr_b16 a[200:201], v247 offset:45056
  ds_read_b64_tr_b16 a[202:203], v247 offset:49152
  v_mfma_f32_16x16x32_bf16 v[168:171], a[212:215], a[136:139], v[168:171]
  buffer_load_dwordx4 v133, s[24:27], s50 offen offset:0 lds
  s_lshl_b32 s51, s74, 11
  v_mfma_f32_16x16x32_bf16 v[168:171], a[208:211], a[128:131], v[168:171]
  s_waitcnt vmcnt(25) lgkmcnt(10)
  ds_read_b64_tr_b16 a[204:205], v247 offset:53248
  ds_read_b64_tr_b16 a[206:207], v247 offset:57344
  v_mfma_f32_16x16x32_bf16 v[32:35], a[176:179], a[216:219], v[32:35]
  ds_read_b64_tr_b16 a[208:209], v244 offset:47104
  v_mfma_f32_16x16x32_bf16 v[32:35], a[180:183], a[224:227], v[32:35]
  ds_read_b64_tr_b16 a[210:211], v244 offset:51200
  v_mfma_f32_16x16x32_bf16 v[36:39], a[180:183], a[228:231], v[36:39]
  buffer_load_dwordx4 a[48:51], v137, s[36:39], s51 offen offset:0 sc1
  ds_read_b64_tr_b16 a[212:213], v244 offset:55296
  v_mfma_f32_16x16x32_bf16 v[36:39], a[176:179], a[220:223], v[36:39]
  s_waitcnt lgkmcnt(11)
  ds_read_b64_tr_b16 a[214:215], v244 offset:59392
  v_mfma_f32_16x16x32_bf16 v[44:47], a[184:187], a[220:223], v[44:47]
  ds_read_b64_tr_b16 a[176:177], v245 offset:47104
  v_mfma_f32_16x16x32_bf16 v[44:47], a[188:191], a[228:231], v[44:47]
  ds_read_b64_tr_b16 a[178:179], v245 offset:51200
  v_mfma_f32_16x16x32_bf16 v[40:43], a[188:191], a[224:227], v[40:43]
  buffer_load_dwordx4 v134, s[24:27], s50 offen offset:1024 lds
  ds_read_b64_tr_b16 a[180:181], v245 offset:55296
  v_mfma_f32_16x16x32_bf16 v[40:43], a[184:187], a[216:219], v[40:43]
  s_waitcnt vmcnt(20) lgkmcnt(11)
  s_barrier
  ds_read_b64_tr_b16 a[182:183], v245 offset:59392
  v_mfma_f32_16x16x32_bf16 v[48:51], a[192:195], a[216:219], v[48:51]
  ds_read_b64_tr_b16 a[184:185], v246 offset:47104
  v_mfma_f32_16x16x32_bf16 v[48:51], a[196:199], a[224:227], v[48:51]
  ds_read_b64_tr_b16 a[186:187], v246 offset:51200
  v_mfma_f32_16x16x32_bf16 v[52:55], a[196:199], a[228:231], v[52:55]
  buffer_load_dwordx4 a[52:55], v137, s[36:39], s51 offen offset:1024 sc1
  ds_read_b64_tr_b16 a[188:189], v246 offset:55296
  v_mfma_f32_16x16x32_bf16 v[52:55], a[192:195], a[220:223], v[52:55]
  s_waitcnt lgkmcnt(11)
  ds_read_b64_tr_b16 a[190:191], v246 offset:59392
  v_mfma_f32_16x16x32_bf16 v[60:63], a[200:203], a[220:223], v[60:63]
  ds_read_b64_tr_b16 a[192:193], v247 offset:47104
  v_mfma_f32_16x16x32_bf16 v[60:63], a[204:207], a[228:231], v[60:63]
  ds_read_b64_tr_b16 a[194:195], v247 offset:51200
  v_mfma_f32_16x16x32_bf16 v[56:59], a[204:207], a[224:227], v[56:59]
  buffer_load_dwordx4 v135, s[24:27], s50 offen offset:2048 lds
  ds_read_b64_tr_b16 a[196:197], v247 offset:55296
  v_mfma_f32_16x16x32_bf16 v[56:59], a[200:203], a[216:219], v[56:59]
  s_waitcnt lgkmcnt(11)
  ds_read_b64_tr_b16 a[198:199], v247 offset:59392
  v_mfma_f32_16x16x32_bf16 v[144:147], a[208:211], a[216:219], v[144:147]
  ds_read_b64_tr_b16 a[200:201], v244 offset:61440
  v_mfma_f32_16x16x32_bf16 v[144:147], a[212:215], a[224:227], v[144:147]
  ds_read_b64_tr_b16 a[202:203], v248 offset:0
  v_mfma_f32_16x16x32_bf16 v[148:151], a[212:215], a[228:231], v[148:151]
  buffer_load_dwordx4 a[56:59], v137, s[36:39], s51 offen offset:2048 sc1
  ds_read_b64_tr_b16 a[204:205], v248 offset:4096
  v_mfma_f32_16x16x32_bf16 v[148:151], a[208:211], a[220:223], v[148:151]
  s_waitcnt lgkmcnt(11)
  ds_read_b64_tr_b16 a[206:207], v248 offset:8192
  v_mfma_f32_16x16x32_bf16 v[156:159], a[176:179], a[220:223], v[156:159]
  ds_read_b64_tr_b16 a[208:209], v245 offset:61440
  v_mfma_f32_16x16x32_bf16 v[156:159], a[180:183], a[228:231], v[156:159]
  ds_read_b64_tr_b16 a[210:211], v249 offset:0
  v_mfma_f32_16x16x32_bf16 v[152:155], a[180:183], a[224:227], v[152:155]
  buffer_load_dwordx4 v136, s[24:27], s50 offen offset:3072 lds
  ds_read_b64_tr_b16 a[212:213], v249 offset:4096
  v_mfma_f32_16x16x32_bf16 v[152:155], a[176:179], a[216:219], v[152:155]
  s_waitcnt lgkmcnt(11)
  ds_read_b64_tr_b16 a[214:215], v249 offset:8192
  v_mfma_f32_16x16x32_bf16 v[160:163], a[184:187], a[216:219], v[160:163]
  ds_read_b64_tr_b16 a[176:177], v246 offset:61440
  v_mfma_f32_16x16x32_bf16 v[160:163], a[188:191], a[224:227], v[160:163]
  ds_read_b64_tr_b16 a[178:179], v250 offset:0
  v_mfma_f32_16x16x32_bf16 v[164:167], a[188:191], a[228:231], v[164:167]
  buffer_load_dwordx4 a[60:63], v137, s[36:39], s51 offen offset:3072 sc1
  s_cmp_eq_u32 s87, 3
  v_mfma_f32_16x16x32_bf16 v[164:167], a[184:187], a[220:223], v[164:167]
  s_waitcnt lgkmcnt(10)
  s_cselect_b32 s75, 26, 12
  s_lshl_b32 s50, s75, 16
  v_mfma_f32_16x16x32_bf16 v[172:175], a[192:195], a[220:223], v[172:175]
  s_add_u32 m0, s70, 45056
  ds_read_b64_tr_b16 a[180:181], v250 offset:4096
  ds_read_b64_tr_b16 a[182:183], v250 offset:8192
  v_mfma_f32_16x16x32_bf16 v[172:175], a[196:199], a[228:231], v[172:175]
  ds_read_b64_tr_b16 a[184:185], v247 offset:61440
  buffer_load_dwordx4 v133, s[24:27], s50 offen offset:0 lds
  v_mfma_f32_16x16x32_bf16 v[168:171], a[196:199], a[224:227], v[168:171]
  s_lshl_b32 s51, s75, 11
  ds_read_b64_tr_b16 a[186:187], v251 offset:0
  ds_read_b64_tr_b16 a[188:189], v251 offset:4096
  v_mfma_f32_16x16x32_bf16 v[168:171], a[192:195], a[216:219], v[168:171]
  s_waitcnt vmcnt(25) lgkmcnt(11)
  ds_read_b64_tr_b16 a[190:191], v251 offset:8192
  v_mfma_f32_16x16x32_bf16 v[32:35], a[200:203], a[0:3], v[32:35]
  ds_read_b64_tr_b16 a[192:193], v244 offset:63488
  v_mfma_f32_16x16x32_bf16 v[32:35], a[204:207], a[8:11], v[32:35]
  buffer_load_dwordx4 a[64:67], v137, s[36:39], s51 offen offset:0 sc1
  ds_read_b64_tr_b16 a[194:195], v248 offset:2048
  v_mfma_f32_16x16x32_bf16 v[36:39], a[204:207], a[12:15], v[36:39]
  ds_read_b64_tr_b16 a[196:197], v248 offset:6144
  v_mfma_f32_16x16x32_bf16 v[36:39], a[200:203], a[4:7], v[36:39]
  s_waitcnt lgkmcnt(11)
  ds_read_b64_tr_b16 a[198:199], v248 offset:10240
  v_mfma_f32_16x16x32_bf16 v[44:47], a[208:211], a[4:7], v[44:47]
  ds_read_b64_tr_b16 a[200:201], v245 offset:63488
  v_mfma_f32_16x16x32_bf16 v[44:47], a[212:215], a[12:15], v[44:47]
  buffer_load_dwordx4 v134, s[24:27], s50 offen offset:1024 lds
  ds_read_b64_tr_b16 a[202:203], v249 offset:2048
  v_mfma_f32_16x16x32_bf16 v[40:43], a[212:215], a[8:11], v[40:43]
  ds_read_b64_tr_b16 a[204:205], v249 offset:6144
  v_mfma_f32_16x16x32_bf16 v[40:43], a[208:211], a[0:3], v[40:43]
  s_waitcnt vmcnt(20) lgkmcnt(11)
  s_barrier
  ds_read_b64_tr_b16 a[206:207], v249 offset:10240
  v_mfma_f32_16x16x32_bf16 v[48:51], a[176:179], a[0:3], v[48:51]
  ds_read_b64_tr_b16 a[208:209], v246 offset:63488
  v_mfma_f32_16x16x32_bf16 v[48:51], a[180:183], a[8:11], v[48:51]
  buffer_load_dwordx4 a[68:71], v137, s[36:39], s51 offen offset:1024 sc1
  ds_read_b64_tr_b16 a[210:211], v250 offset:2048
  v_mfma_f32_16x16x32_bf16 v[52:55], a[180:183], a[12:15], v[52:55]
  ds_read_b64_tr_b16 a[212:213], v250 offset:6144
  v_mfma_f32_16x16x32_bf16 v[52:55], a[176:179], a[4:7], v[52:55]
  s_waitcnt lgkmcnt(11)
  ds_read_b64_tr_b16 a[214:215], v250 offset:10240
  v_mfma_f32_16x16x32_bf16 v[60:63], a[184:187], a[4:7], v[60:63]
  ds_read_b64_tr_b16 a[176:177], v247 offset:63488
  v_mfma_f32_16x16x32_bf16 v[60:63], a[188:191], a[12:15], v[60:63]
  buffer_load_dwordx4 v135, s[24:27], s50 offen offset:2048 lds
  ds_read_b64_tr_b16 a[178:179], v251 offset:2048
  v_mfma_f32_16x16x32_bf16 v[56:59], a[188:191], a[8:11], v[56:59]
  ds_read_b64_tr_b16 a[180:181], v251 offset:6144
  v_mfma_f32_16x16x32_bf16 v[56:59], a[184:187], a[0:3], v[56:59]
  s_waitcnt lgkmcnt(11)
  ds_read_b64_tr_b16 a[182:183], v251 offset:10240
  v_mfma_f32_16x16x32_bf16 v[144:147], a[192:195], a[0:3], v[144:147]
  ds_read_b64_tr_b16 a[184:185], v248 offset:12288
  v_mfma_f32_16x16x32_bf16 v[144:147], a[196:199], a[8:11], v[144:147]
  buffer_load_dwordx4 a[72:75], v137, s[36:39], s51 offen offset:2048 sc1
  ds_read_b64_tr_b16 a[186:187], v248 offset:16384
  v_mfma_f32_16x16x32_bf16 v[148:151], a[196:199], a[12:15], v[148:151]
  ds_read_b64_tr_b16 a[188:189], v248 offset:20480
  v_mfma_f32_16x16x32_bf16 v[148:151], a[192:195], a[4:7], v[148:151]
  s_waitcnt lgkmcnt(11)
  ds_read_b64_tr_b16 a[190:191], v248 offset:24576
  v_mfma_f32_16x16x32_bf16 v[156:159], a[200:203], a[4:7], v[156:159]
  ds_read_b64_tr_b16 a[192:193], v249 offset:12288
  v_mfma_f32_16x16x32_bf16 v[156:159], a[204:207], a[12:15], v[156:159]
  buffer_load_dwordx4 v136, s[24:27], s50 offen offset:3072 lds
  ds_read_b64_tr_b16 a[194:195], v249 offset:16384
  v_mfma_f32_16x16x32_bf16 v[152:155], a[204:207], a[8:11], v[152:155]
  ds_read_b64_tr_b16 a[196:197], v249 offset:20480
  v_mfma_f32_16x16x32_bf16 v[152:155], a[200:203], a[0:3], v[152:155]
  s_waitcnt lgkmcnt(11)
  ds_read_b64_tr_b16 a[198:199], v249 offset:24576
  v_mfma_f32_16x16x32_bf16 v[160:163], a[208:211], a[0:3], v[160:163]
  ds_read_b64_tr_b16 a[200:201], v250 offset:12288
  v_mfma_f32_16x16x32_bf16 v[160:163], a[212:215], a[8:11], v[160:163]
  buffer_load_dwordx4 a[76:79], v137, s[36:39], s51 offen offset:3072 sc1
  s_cmp_eq_u32 s87, 0
  v_mfma_f32_16x16x32_bf16 v[164:167], a[212:215], a[12:15], v[164:167]
  s_cselect_b32 s79, 29, 15
  s_lshl_b32 s50, s79, 16
  s_add_u32 m0, s70, 61440
  v_mfma_f32_16x16x32_bf16 v[164:167], a[208:211], a[4:7], v[164:167]
  s_waitcnt lgkmcnt(9)
  ds_read_b64_tr_b16 a[202:203], v250 offset:16384
  ds_read_b64_tr_b16 a[204:205], v250 offset:20480
  v_mfma_f32_16x16x32_bf16 v[172:175], a[176:179], a[4:7], v[172:175]
  ds_read_b64_tr_b16 a[206:207], v250 offset:24576
  ds_read_b64_tr_b16 a[208:209], v251 offset:12288
  v_mfma_f32_16x16x32_bf16 v[172:175], a[180:183], a[12:15], v[172:175]
  buffer_load_dwordx4 v133, s[24:27], s50 offen offset:0 lds
  s_lshl_b32 s51, s79, 11
  v_mfma_f32_16x16x32_bf16 v[168:171], a[180:183], a[8:11], v[168:171]
  ds_read_b64_tr_b16 a[210:211], v251 offset:16384
  ds_read_b64_tr_b16 a[212:213], v251 offset:20480
  v_mfma_f32_16x16x32_bf16 v[168:171], a[176:179], a[0:3], v[168:171]
  s_waitcnt vmcnt(25) lgkmcnt(11)
  ds_read_b64_tr_b16 a[214:215], v251 offset:24576
  v_mfma_f32_16x16x32_bf16 v[32:35], a[184:187], a[16:19], v[32:35]
  ds_read_b64_tr_b16 a[176:177], v248 offset:14336
  v_mfma_f32_16x16x32_bf16 v[32:35], a[188:191], a[24:27], v[32:35]
  buffer_load_dwordx4 a[80:83], v137, s[36:39], s51 offen offset:0 sc1
  ds_read_b64_tr_b16 a[178:179], v248 offset:18432
  v_mfma_f32_16x16x32_bf16 v[36:39], a[188:191], a[28:31], v[36:39]
  ds_read_b64_tr_b16 a[180:181], v248 offset:22528
  v_mfma_f32_16x16x32_bf16 v[36:39], a[184:187], a[20:23], v[36:39]
  s_waitcnt lgkmcnt(11)
  ds_read_b64_tr_b16 a[182:183], v248 offset:26624
  v_mfma_f32_16x16x32_bf16 v[44:47], a[192:195], a[20:23], v[44:47]
  ds_read_b64_tr_b16 a[184:185], v249 offset:14336
  v_mfma_f32_16x16x32_bf16 v[44:47], a[196:199], a[28:31], v[44:47]
  buffer_load_dwordx4 v134, s[24:27], s50 offen offset:1024 lds
  ds_read_b64_tr_b16 a[186:187], v249 offset:18432
  v_mfma_f32_16x16x32_bf16 v[40:43], a[196:199], a[24:27], v[40:43]
  ds_read_b64_tr_b16 a[188:189], v249 offset:22528
  v_mfma_f32_16x16x32_bf16 v[40:43], a[192:195], a[16:19], v[40:43]
  s_waitcnt vmcnt(20) lgkmcnt(11)
  s_barrier
  ds_read_b64_tr_b16 a[190:191], v249 offset:26624
  v_mfma_f32_16x16x32_bf16 v[48:51], a[200:203], a[16:19], v[48:51]
  ds_read_b64_tr_b16 a[192:193], v250 offset:14336
  v_mfma_f32_16x16x32_bf16 v[48:51], a[204:207], a[24:27], v[48:51]
  buffer_load_dwordx4 a[84:87], v137, s[36:39], s51 offen offset:1024 sc1
  ds_read_b64_tr_b16 a[194:195], v250 offset:18432
  v_mfma_f32_16x16x32_bf16 v[52:55], a[204:207], a[28:31], v[52:55]
  ds_read_b64_tr_b16 a[196:197], v250 offset:22528
  v_mfma_f32_16x16x32_bf16 v[52:55], a[200:203], a[20:23], v[52:55]
  s_waitcnt lgkmcnt(11)
  ds_read_b64_tr_b16 a[198:199], v250 offset:26624
  v_mfma_f32_16x16x32_bf16 v[60:63], a[208:211], a[20:23], v[60:63]
  ds_read_b64_tr_b16 a[200:201], v251 offset:14336
  v_mfma_f32_16x16x32_bf16 v[60:63], a[212:215], a[28:31], v[60:63]
  buffer_load_dwordx4 v135, s[24:27], s50 offen offset:2048 lds
  ds_read_b64_tr_b16 a[202:203], v251 offset:18432
  v_mfma_f32_16x16x32_bf16 v[56:59], a[212:215], a[24:27], v[56:59]
  ds_read_b64_tr_b16 a[204:205], v251 offset:22528
  v_mfma_f32_16x16x32_bf16 v[56:59], a[208:211], a[16:19], v[56:59]
  s_waitcnt lgkmcnt(11)
  ds_read_b64_tr_b16 a[206:207], v251 offset:26624
  v_mfma_f32_16x16x32_bf16 v[144:147], a[176:179], a[16:19], v[144:147]
  ds_read_b64_tr_b16 a[208:209], v240 offset:12288
  v_mfma_f32_16x16x32_bf16 v[144:147], a[180:183], a[24:27], v[144:147]
  buffer_load_dwordx4 a[88:91], v137, s[36:39], s51 offen offset:2048 sc1
  ds_read_b64_tr_b16 a[210:211], v240 offset:16384
  v_mfma_f32_16x16x32_bf16 v[148:151], a[180:183], a[28:31], v[148:151]
  ds_read_b64_tr_b16 a[212:213], v240 offset:20480
  v_mfma_f32_16x16x32_bf16 v[148:151], a[176:179], a[20:23], v[148:151]
  s_waitcnt lgkmcnt(11)
  ds_read_b64_tr_b16 a[214:215], v240 offset:24576
  v_mfma_f32_16x16x32_bf16 v[156:159], a[184:187], a[20:23], v[156:159]
  ds_read_b64_tr_b16 a[176:177], v241 offset:12288
  v_mfma_f32_16x16x32_bf16 v[156:159], a[188:191], a[28:31], v[156:159]
  buffer_load_dwordx4 v136, s[24:27], s50 offen offset:3072 lds
  ds_read_b64_tr_b16 a[178:179], v241 offset:16384
  v_mfma_f32_16x16x32_bf16 v[152:155], a[188:191], a[24:27], v[152:155]
  ds_read_b64_tr_b16 a[180:181], v241 offset:20480
  v_mfma_f32_16x16x32_bf16 v[152:155], a[184:187], a[16:19], v[152:155]
  s_waitcnt lgkmcnt(11)
  ds_read_b64_tr_b16 a[182:183], v241 offset:24576
  v_mfma_f32_16x16x32_bf16 v[160:163], a[192:195], a[16:19], v[160:163]
  buffer_load_dwordx4 a[92:95], v137, s[36:39], s51 offen offset:3072 sc1
  s_cmp_eq_u32 s87, 1
  v_mfma_f32_16x16x32_bf16 v[160:163], a[196:199], a[24:27], v[160:163]
  s_cselect_b32 s80, 33, 19
  s_lshl_b32 s50, s80, 16
  s_add_u32 m0, s70, 77824
  v_mfma_f32_16x16x32_bf16 v[164:167], a[196:199], a[28:31], v[164:167]
  ds_read_b64_tr_b16 a[184:185], v242 offset:12288
  ds_read_b64_tr_b16 a[186:187], v242 offset:16384
  v_mfma_f32_16x16x32_bf16 v[164:167], a[192:195], a[20:23], v[164:167]
  s_waitcnt lgkmcnt(10)
  ds_read_b64_tr_b16 a[188:189], v242 offset:20480
  ds_read_b64_tr_b16 a[190:191], v242 offset:24576
  v_mfma_f32_16x16x32_bf16 v[172:175], a[200:203], a[20:23], v[172:175]
  buffer_load_dwordx4 v133, s[24:27], s50 offen offset:0 lds
  s_lshl_b32 s51, s80, 11
  v_mfma_f32_16x16x32_bf16 v[172:175], a[204:207], a[28:31], v[172:175]
  ds_read_b64_tr_b16 a[192:193], v243 offset:12288
  ds_read_b64_tr_b16 a[194:195], v243 offset:16384
  v_mfma_f32_16x16x32_bf16 v[168:171], a[204:207], a[24:27], v[168:171]
  ds_read_b64_tr_b16 a[196:197], v243 offset:20480
  v_mfma_f32_16x16x32_bf16 v[168:171], a[200:203], a[16:19], v[168:171]
  s_waitcnt vmcnt(25) lgkmcnt(11)
  ds_read_b64_tr_b16 a[198:199], v243 offset:24576
  v_mfma_f32_16x16x32_bf16 v[32:35], a[208:211], a[32:35], v[32:35]
  buffer_load_dwordx4 a[96:99], v137, s[36:39], s51 offen offset:0 sc1
  ds_read_b64_tr_b16 a[200:201], v240 offset:14336
  v_mfma_f32_16x16x32_bf16 v[32:35], a[212:215], a[40:43], v[32:35]
  ds_read_b64_tr_b16 a[202:203], v240 offset:18432
  v_mfma_f32_16x16x32_bf16 v[36:39], a[212:215], a[44:47], v[36:39]
  ds_read_b64_tr_b16 a[204:205], v240 offset:22528
  v_mfma_f32_16x16x32_bf16 v[36:39], a[208:211], a[36:39], v[36:39]
  s_waitcnt lgkmcnt(11)
  ds_read_b64_tr_b16 a[206:207], v240 offset:26624
  v_mfma_f32_16x16x32_bf16 v[44:47], a[176:179], a[36:39], v[44:47]
  buffer_load_dwordx4 v134, s[24:27], s50 offen offset:1024 lds
  ds_read_b64_tr_b16 a[208:209], v241 offset:14336
  v_mfma_f32_16x16x32_bf16 v[44:47], a[180:183], a[44:47], v[44:47]
  ds_read_b64_tr_b16 a[210:211], v241 offset:18432
  v_mfma_f32_16x16x32_bf16 v[40:43], a[180:183], a[40:43], v[40:43]
  ds_read_b64_tr_b16 a[212:213], v241 offset:22528
  v_mfma_f32_16x16x32_bf16 v[40:43], a[176:179], a[32:35], v[40:43]
  s_waitcnt vmcnt(20) lgkmcnt(11)
  s_barrier
  ds_read_b64_tr_b16 a[214:215], v241 offset:26624
  v_mfma_f32_16x16x32_bf16 v[48:51], a[184:187], a[32:35], v[48:51]
  buffer_load_dwordx4 a[100:103], v137, s[36:39], s51 offen offset:1024 sc1
  ds_read_b64_tr_b16 a[176:177], v242 offset:14336
  v_mfma_f32_16x16x32_bf16 v[48:51], a[188:191], a[40:43], v[48:51]
  ds_read_b64_tr_b16 a[178:179], v242 offset:18432
  v_mfma_f32_16x16x32_bf16 v[52:55], a[188:191], a[44:47], v[52:55]
  ds_read_b64_tr_b16 a[180:181], v242 offset:22528
  v_mfma_f32_16x16x32_bf16 v[52:55], a[184:187], a[36:39], v[52:55]
  s_waitcnt lgkmcnt(11)
  ds_read_b64_tr_b16 a[182:183], v242 offset:26624
  v_mfma_f32_16x16x32_bf16 v[60:63], a[192:195], a[36:39], v[60:63]
  buffer_load_dwordx4 v135, s[24:27], s50 offen offset:2048 lds
  ds_read_b64_tr_b16 a[184:185], v243 offset:14336
  v_mfma_f32_16x16x32_bf16 v[60:63], a[196:199], a[44:47], v[60:63]
  ds_read_b64_tr_b16 a[186:187], v243 offset:18432
  v_mfma_f32_16x16x32_bf16 v[56:59], a[196:199], a[40:43], v[56:59]
  ds_read_b64_tr_b16 a[188:189], v243 offset:22528
  v_mfma_f32_16x16x32_bf16 v[56:59], a[192:195], a[32:35], v[56:59]
  s_waitcnt lgkmcnt(11)
  ds_read_b64_tr_b16 a[190:191], v243 offset:26624
  v_mfma_f32_16x16x32_bf16 v[144:147], a[200:203], a[32:35], v[144:147]
  buffer_load_dwordx4 a[104:107], v137, s[36:39], s51 offen offset:2048 sc1
  ds_read_b64_tr_b16 a[192:193], v240 offset:28672
  v_mfma_f32_16x16x32_bf16 v[144:147], a[204:207], a[40:43], v[144:147]
  ds_read_b64_tr_b16 a[194:195], v240 offset:32768
  v_mfma_f32_16x16x32_bf16 v[148:151], a[204:207], a[44:47], v[148:151]
  ds_read_b64_tr_b16 a[196:197], v240 offset:36864
  v_mfma_f32_16x16x32_bf16 v[148:151], a[200:203], a[36:39], v[148:151]
  s_waitcnt lgkmcnt(11)
  ds_read_b64_tr_b16 a[198:199], v240 offset:40960
  v_mfma_f32_16x16x32_bf16 v[156:159], a[208:211], a[36:39], v[156:159]
  buffer_load_dwordx4 v136, s[24:27], s50 offen offset:3072 lds
  ds_read_b64_tr_b16 a[200:201], v241 offset:28672
  v_mfma_f32_16x16x32_bf16 v[156:159], a[212:215], a[44:47], v[156:159]
  ds_read_b64_tr_b16 a[202:203], v241 offset:32768
  v_mfma_f32_16x16x32_bf16 v[152:155], a[212:215], a[40:43], v[152:155]
  ds_read_b64_tr_b16 a[204:205], v241 offset:36864
  v_mfma_f32_16x16x32_bf16 v[152:155], a[208:211], a[32:35], v[152:155]
  s_waitcnt lgkmcnt(11)
  ds_read_b64_tr_b16 a[206:207], v241 offset:40960
  v_mfma_f32_16x16x32_bf16 v[160:163], a[176:179], a[32:35], v[160:163]
  buffer_load_dwordx4 a[108:111], v137, s[36:39], s51 offen offset:3072 sc1
  s_cmp_eq_u32 s87, 2
  v_mfma_f32_16x16x32_bf16 v[160:163], a[180:183], a[40:43], v[160:163]
  s_cselect_b32 s81, 36, 22
  s_lshl_b32 s50, s81, 16
  s_add_u32 m0, s70, 94208
  v_mfma_f32_16x16x32_bf16 v[164:167], a[180:183], a[44:47], v[164:167]
  ds_read_b64_tr_b16 a[208:209], v242 offset:28672
  ds_read_b64_tr_b16 a[210:211], v242 offset:32768
  v_mfma_f32_16x16x32_bf16 v[164:167], a[176:179], a[36:39], v[164:167]
  s_waitcnt lgkmcnt(10)
  ds_read_b64_tr_b16 a[212:213], v242 offset:36864
  ds_read_b64_tr_b16 a[214:215], v242 offset:40960
  v_mfma_f32_16x16x32_bf16 v[172:175], a[184:187], a[36:39], v[172:175]
  buffer_load_dwordx4 v133, s[24:27], s50 offen offset:0 lds
  s_lshl_b32 s51, s81, 11
  v_mfma_f32_16x16x32_bf16 v[172:175], a[188:191], a[44:47], v[172:175]
  ds_read_b64_tr_b16 a[176:177], v243 offset:28672
  ds_read_b64_tr_b16 a[178:179], v243 offset:32768
  v_mfma_f32_16x16x32_bf16 v[168:171], a[188:191], a[40:43], v[168:171]
  ds_read_b64_tr_b16 a[180:181], v243 offset:36864
  v_mfma_f32_16x16x32_bf16 v[168:171], a[184:187], a[32:35], v[168:171]
  s_waitcnt vmcnt(25) lgkmcnt(11)
  ds_read_b64_tr_b16 a[182:183], v243 offset:40960
  v_mfma_f32_16x16x32_bf16 v[32:35], a[192:195], a[48:51], v[32:35]
  buffer_load_dwordx4 a[112:115], v137, s[36:39], s51 offen offset:0 sc1
  ds_read_b64_tr_b16 a[184:185], v240 offset:30720
  v_mfma_f32_16x16x32_bf16 v[32:35], a[196:199], a[56:59], v[32:35]
  ds_read_b64_tr_b16 a[186:187], v240 offset:34816
  v_mfma_f32_16x16x32_bf16 v[36:39], a[196:199], a[60:63], v[36:39]
  ds_read_b64_tr_b16 a[188:189], v240 offset:38912
  v_mfma_f32_16x16x32_bf16 v[36:39], a[192:195], a[52:55], v[36:39]
  s_waitcnt lgkmcnt(11)
  ds_read_b64_tr_b16 a[190:191], v240 offset:43008
  v_mfma_f32_16x16x32_bf16 v[44:47], a[200:203], a[52:55], v[44:47]
  buffer_load_dwordx4 v134, s[24:27], s50 offen offset:1024 lds
  ds_read_b64_tr_b16 a[192:193], v241 offset:30720
  v_mfma_f32_16x16x32_bf16 v[44:47], a[204:207], a[60:63], v[44:47]
  ds_read_b64_tr_b16 a[194:195], v241 offset:34816
  v_mfma_f32_16x16x32_bf16 v[40:43], a[204:207], a[56:59], v[40:43]
  ds_read_b64_tr_b16 a[196:197], v241 offset:38912
  v_mfma_f32_16x16x32_bf16 v[40:43], a[200:203], a[48:51], v[40:43]
  s_waitcnt vmcnt(20) lgkmcnt(11)
  s_barrier
  ds_read_b64_tr_b16 a[198:199], v241 offset:43008
  v_mfma_f32_16x16x32_bf16 v[48:51], a[208:211], a[48:51], v[48:51]
  buffer_load_dwordx4 a[116:119], v137, s[36:39], s51 offen offset:1024 sc1
  ds_read_b64_tr_b16 a[200:201], v242 offset:30720
  v_mfma_f32_16x16x32_bf16 v[48:51], a[212:215], a[56:59], v[48:51]
  ds_read_b64_tr_b16 a[202:203], v242 offset:34816
  v_mfma_f32_16x16x32_bf16 v[52:55], a[212:215], a[60:63], v[52:55]
  ds_read_b64_tr_b16 a[204:205], v242 offset:38912
  v_mfma_f32_16x16x32_bf16 v[52:55], a[208:211], a[52:55], v[52:55]
  s_waitcnt lgkmcnt(11)
  ds_read_b64_tr_b16 a[206:207], v242 offset:43008
  v_mfma_f32_16x16x32_bf16 v[60:63], a[176:179], a[52:55], v[60:63]
  buffer_load_dwordx4 v135, s[24:27], s50 offen offset:2048 lds
  ds_read_b64_tr_b16 a[208:209], v243 offset:30720
  v_mfma_f32_16x16x32_bf16 v[60:63], a[180:183], a[60:63], v[60:63]
  ds_read_b64_tr_b16 a[210:211], v243 offset:34816
  v_mfma_f32_16x16x32_bf16 v[56:59], a[180:183], a[56:59], v[56:59]
  ds_read_b64_tr_b16 a[212:213], v243 offset:38912
  v_mfma_f32_16x16x32_bf16 v[56:59], a[176:179], a[48:51], v[56:59]
  s_waitcnt lgkmcnt(11)
  buffer_load_dwordx4 a[120:123], v137, s[36:39], s51 offen offset:2048 sc1
  ds_read_b64_tr_b16 a[214:215], v243 offset:43008
  v_mfma_f32_16x16x32_bf16 v[144:147], a[184:187], a[48:51], v[144:147]
  ds_read_b64_tr_b16 a[176:177], v240 offset:45056
  v_mfma_f32_16x16x32_bf16 v[144:147], a[188:191], a[56:59], v[144:147]
  ds_read_b64_tr_b16 a[178:179], v240 offset:49152
  v_mfma_f32_16x16x32_bf16 v[148:151], a[188:191], a[60:63], v[148:151]
  ds_read_b64_tr_b16 a[180:181], v240 offset:53248
  v_mfma_f32_16x16x32_bf16 v[148:151], a[184:187], a[52:55], v[148:151]
  s_waitcnt lgkmcnt(11)
  buffer_load_dwordx4 v136, s[24:27], s50 offen offset:3072 lds
  ds_read_b64_tr_b16 a[182:183], v240 offset:57344
  v_mfma_f32_16x16x32_bf16 v[156:159], a[192:195], a[52:55], v[156:159]
  ds_read_b64_tr_b16 a[184:185], v241 offset:45056
  v_mfma_f32_16x16x32_bf16 v[156:159], a[196:199], a[60:63], v[156:159]
  ds_read_b64_tr_b16 a[186:187], v241 offset:49152
  v_mfma_f32_16x16x32_bf16 v[152:155], a[196:199], a[56:59], v[152:155]
  ds_read_b64_tr_b16 a[188:189], v241 offset:53248
  v_mfma_f32_16x16x32_bf16 v[152:155], a[192:195], a[48:51], v[152:155]
  s_waitcnt lgkmcnt(11)
  buffer_load_dwordx4 a[124:127], v137, s[36:39], s51 offen offset:3072 sc1
  s_cmp_eq_u32 s87, 3
  v_mfma_f32_16x16x32_bf16 v[160:163], a[200:203], a[48:51], v[160:163]
  s_cselect_b32 s86, 40, 26
  s_lshl_b32 s50, s86, 16
  s_add_u32 m0, s70, 110592
  v_mfma_f32_16x16x32_bf16 v[160:163], a[204:207], a[56:59], v[160:163]
  ds_read_b64_tr_b16 a[190:191], v241 offset:57344
  ds_read_b64_tr_b16 a[192:193], v242 offset:45056
  v_mfma_f32_16x16x32_bf16 v[164:167], a[204:207], a[60:63], v[164:167]
  ds_read_b64_tr_b16 a[194:195], v242 offset:49152
  ds_read_b64_tr_b16 a[196:197], v242 offset:53248
  v_mfma_f32_16x16x32_bf16 v[164:167], a[200:203], a[52:55], v[164:167]
  s_waitcnt lgkmcnt(11)
  buffer_load_dwordx4 v133, s[24:27], s50 offen offset:0 lds
  s_lshl_b32 s51, s86, 11
  v_mfma_f32_16x16x32_bf16 v[172:175], a[208:211], a[52:55], v[172:175]
  ds_read_b64_tr_b16 a[198:199], v242 offset:57344
  ds_read_b64_tr_b16 a[200:201], v243 offset:45056
  v_mfma_f32_16x16x32_bf16 v[172:175], a[212:215], a[60:63], v[172:175]
  ds_read_b64_tr_b16 a[202:203], v243 offset:49152
  v_mfma_f32_16x16x32_bf16 v[168:171], a[212:215], a[56:59], v[168:171]
  ds_read_b64_tr_b16 a[204:205], v243 offset:53248
  v_mfma_f32_16x16x32_bf16 v[168:171], a[208:211], a[48:51], v[168:171]
  s_waitcnt vmcnt(25) lgkmcnt(11)
  buffer_load_dwordx4 a[128:131], v137, s[36:39], s51 offen offset:0 sc1
  ds_read_b64_tr_b16 a[206:207], v243 offset:57344
  v_mfma_f32_16x16x32_bf16 v[32:35], a[176:179], a[64:67], v[32:35]
  ds_read_b64_tr_b16 a[208:209], v240 offset:47104
  v_mfma_f32_16x16x32_bf16 v[32:35], a[180:183], a[72:75], v[32:35]
  ds_read_b64_tr_b16 a[210:211], v240 offset:51200
  v_mfma_f32_16x16x32_bf16 v[36:39], a[180:183], a[76:79], v[36:39]
  ds_read_b64_tr_b16 a[212:213], v240 offset:55296
  v_mfma_f32_16x16x32_bf16 v[36:39], a[176:179], a[68:71], v[36:39]
  s_waitcnt lgkmcnt(11)
  buffer_load_dwordx4 v134, s[24:27], s50 offen offset:1024 lds
  ds_read_b64_tr_b16 a[214:215], v240 offset:59392
  v_mfma_f32_16x16x32_bf16 v[44:47], a[184:187], a[68:71], v[44:47]
  ds_read_b64_tr_b16 a[176:177], v241 offset:47104
  v_mfma_f32_16x16x32_bf16 v[44:47], a[188:191], a[76:79], v[44:47]
  ds_read_b64_tr_b16 a[178:179], v241 offset:51200
  v_mfma_f32_16x16x32_bf16 v[40:43], a[188:191], a[72:75], v[40:43]
  ds_read_b64_tr_b16 a[180:181], v241 offset:55296
  v_mfma_f32_16x16x32_bf16 v[40:43], a[184:187], a[64:67], v[40:43]
  s_waitcnt vmcnt(20) lgkmcnt(11)
  s_barrier
  buffer_load_dwordx4 a[132:135], v137, s[36:39], s51 offen offset:1024 sc1
  v_mfma_f32_16x16x32_bf16 v[48:51], a[192:195], a[64:67], v[48:51]
Hb2:
  s_cbranch_execz Rb
  ds_read_b64_tr_b16 a[182:183], v241 offset:59392
  ds_read_b64_tr_b16 a[184:185], v242 offset:47104
  v_mfma_f32_16x16x32_bf16 v[48:51], a[196:199], a[72:75], v[48:51]
  ds_read_b64_tr_b16 a[186:187], v242 offset:51200
  v_mfma_f32_16x16x32_bf16 v[52:55], a[196:199], a[76:79], v[52:55]
  ds_read_b64_tr_b16 a[188:189], v242 offset:55296
  v_mfma_f32_16x16x32_bf16 v[52:55], a[192:195], a[68:71], v[52:55]
  s_waitcnt lgkmcnt(11)
  buffer_load_dwordx4 v135, s[24:27], s50 offen offset:2048 lds
  ds_read_b64_tr_b16 a[190:191], v242 offset:59392
  v_mfma_f32_16x16x32_bf16 v[60:63], a[200:203], a[68:71], v[60:63]
  ds_read_b64_tr_b16 a[192:193], v243 offset:47104
  v_mfma_f32_16x16x32_bf16 v[60:63], a[204:207], a[76:79], v[60:63]
  ds_read_b64_tr_b16 a[194:195], v243 offset:51200
  v_mfma_f32_16x16x32_bf16 v[56:59], a[204:207], a[72:75], v[56:59]
  ds_read_b64_tr_b16 a[196:197], v243 offset:55296
  v_mfma_f32_16x16x32_bf16 v[56:59], a[200:203], a[64:67], v[56:59]
  s_waitcnt lgkmcnt(11)
  buffer_load_dwordx4 a[136:139], v137, s[36:39], s51 offen offset:2048 sc1
  ds_read_b64_tr_b16 a[198:199], v243 offset:59392
  v_mfma_f32_16x16x32_bf16 v[144:147], a[208:211], a[64:67], v[144:147]
  ds_read_b64_tr_b16 a[200:201], v240 offset:61440
  v_mfma_f32_16x16x32_bf16 v[144:147], a[212:215], a[72:75], v[144:147]
  ds_read_b64_tr_b16 a[202:203], v244 offset:0
  v_mfma_f32_16x16x32_bf16 v[148:151], a[212:215], a[76:79], v[148:151]
  ds_read_b64_tr_b16 a[204:205], v244 offset:4096
  v_mfma_f32_16x16x32_bf16 v[148:151], a[208:211], a[68:71], v[148:151]
  s_waitcnt lgkmcnt(11)
  buffer_load_dwordx4 v136, s[24:27], s50 offen offset:3072 lds
  ds_read_b64_tr_b16 a[206:207], v244 offset:8192
  v_mfma_f32_16x16x32_bf16 v[156:159], a[176:179], a[68:71], v[156:159]
  ds_read_b64_tr_b16 a[208:209], v241 offset:61440
  v_mfma_f32_16x16x32_bf16 v[156:159], a[180:183], a[76:79], v[156:159]
  ds_read_b64_tr_b16 a[210:211], v245 offset:0
  v_mfma_f32_16x16x32_bf16 v[152:155], a[180:183], a[72:75], v[152:155]
  ds_read_b64_tr_b16 a[212:213], v245 offset:4096
  v_mfma_f32_16x16x32_bf16 v[152:155], a[176:179], a[64:67], v[152:155]
  s_waitcnt lgkmcnt(11)
  buffer_load_dwordx4 a[140:143], v137, s[36:39], s51 offen offset:3072 sc1
  s_cmp_eq_u32 s87, 0
  v_mfma_f32_16x16x32_bf16 v[160:163], a[184:187], a[64:67], v[160:163]
  s_cselect_b32 s69, 43, 29
  s_lshl_b32 s51, s69, 11
  ds_read_b64_tr_b16 a[214:215], v245 offset:8192
  v_mfma_f32_16x16x32_bf16 v[160:163], a[188:191], a[72:75], v[160:163]
  ds_read_b64_tr_b16 a[176:177], v242 offset:61440
  ds_read_b64_tr_b16 a[178:179], v246 offset:0
  v_mfma_f32_16x16x32_bf16 v[164:167], a[188:191], a[76:79], v[164:167]
  ds_read_b64_tr_b16 a[180:181], v246 offset:4096
  v_mfma_f32_16x16x32_bf16 v[164:167], a[184:187], a[68:71], v[164:167]
  s_waitcnt lgkmcnt(11)
  buffer_load_dwordx4 a[216:219], v137, s[36:39], s51 offen offset:0 sc1
  ds_read_b64_tr_b16 a[182:183], v246 offset:8192
  v_mfma_f32_16x16x32_bf16 v[172:175], a[192:195], a[68:71], v[172:175]
  ds_read_b64_tr_b16 a[184:185], v243 offset:61440
  v_mfma_f32_16x16x32_bf16 v[172:175], a[196:199], a[76:79], v[172:175]
  ds_read_b64_tr_b16 a[186:187], v247 offset:0
  v_mfma_f32_16x16x32_bf16 v[168:171], a[196:199], a[72:75], v[168:171]
  ds_read_b64_tr_b16 a[188:189], v247 offset:4096
  v_mfma_f32_16x16x32_bf16 v[168:171], a[192:195], a[64:67], v[168:171]
  s_waitcnt vmcnt(25) lgkmcnt(11)
  buffer_load_dwordx4 a[220:223], v137, s[36:39], s51 offen offset:1024 sc1
  s_lshl_b32 s50, s69, 16
  v_mfma_f32_16x16x32_bf16 v[32:35], a[200:203], a[80:83], v[32:35]
  s_add_u32 m0, s70, 126976
  ds_read_b64_tr_b16 a[190:191], v247 offset:8192
  ds_read_b64_tr_b16 a[192:193], v240 offset:63488
  v_mfma_f32_16x16x32_bf16 v[32:35], a[204:207], a[88:91], v[32:35]
  ds_read_b64_tr_b16 a[194:195], v244 offset:2048
  v_mfma_f32_16x16x32_bf16 v[36:39], a[204:207], a[92:95], v[36:39]
  ds_read_b64_tr_b16 a[196:197], v244 offset:6144
  v_mfma_f32_16x16x32_bf16 v[36:39], a[200:203], a[84:87], v[36:39]
  s_waitcnt lgkmcnt(11)
  buffer_load_dwordx4 v135, s[24:27], s50 offen offset:2048 lds
  ds_read_b64_tr_b16 a[198:199], v244 offset:10240
  v_mfma_f32_16x16x32_bf16 v[44:47], a[208:211], a[84:87], v[44:47]
  ds_read_b64_tr_b16 a[200:201], v241 offset:63488
  v_mfma_f32_16x16x32_bf16 v[44:47], a[212:215], a[92:95], v[44:47]
  ds_read_b64_tr_b16 a[202:203], v245 offset:2048
  v_mfma_f32_16x16x32_bf16 v[40:43], a[212:215], a[88:91], v[40:43]
  ds_read_b64_tr_b16 a[204:205], v245 offset:6144
  v_mfma_f32_16x16x32_bf16 v[40:43], a[208:211], a[80:83], v[40:43]
  s_waitcnt vmcnt(20) lgkmcnt(11)
  s_barrier
  buffer_load_dwordx4 a[224:227], v137, s[36:39], s51 offen offset:2048 sc1
  v_mfma_f32_16x16x32_bf16 v[48:51], a[176:179], a[80:83], v[48:51]
  ds_read_b64_tr_b16 a[206:207], v245 offset:10240
  ds_read_b64_tr_b16 a[208:209], v242 offset:63488
  v_mfma_f32_16x16x32_bf16 v[48:51], a[180:183], a[88:91], v[48:51]
  ds_read_b64_tr_b16 a[210:211], v246 offset:2048
  v_mfma_f32_16x16x32_bf16 v[52:55], a[180:183], a[92:95], v[52:55]
  buffer_load_dwordx4 v136, s[24:27], s50 offen offset:3072 lds
  ds_read_b64_tr_b16 a[212:213], v246 offset:6144
  v_mfma_f32_16x16x32_bf16 v[52:55], a[176:179], a[84:87], v[52:55]
  s_waitcnt lgkmcnt(11)
  ds_read_b64_tr_b16 a[214:215], v246 offset:10240
  v_mfma_f32_16x16x32_bf16 v[60:63], a[184:187], a[84:87], v[60:63]
  ds_read_b64_tr_b16 a[176:177], v243 offset:63488
  v_mfma_f32_16x16x32_bf16 v[60:63], a[188:191], a[92:95], v[60:63]
  ds_read_b64_tr_b16 a[178:179], v247 offset:2048
  v_mfma_f32_16x16x32_bf16 v[56:59], a[188:191], a[88:91], v[56:59]
  buffer_load_dwordx4 a[228:231], v137, s[36:39], s51 offen offset:3072 sc1
  s_cmp_eq_u32 s87, 1
  v_mfma_f32_16x16x32_bf16 v[56:59], a[184:187], a[80:83], v[56:59]
  s_waitcnt lgkmcnt(10)
  s_cselect_b32 s71, 47, 33
  s_lshl_b32 s51, s71, 11
  v_mfma_f32_16x16x32_bf16 v[144:147], a[192:195], a[80:83], v[144:147]
  ds_read_b64_tr_b16 a[180:181], v247 offset:6144
  ds_read_b64_tr_b16 a[182:183], v247 offset:10240
  v_mfma_f32_16x16x32_bf16 v[144:147], a[196:199], a[88:91], v[144:147]
  ds_read_b64_tr_b16 a[184:185], v244 offset:12288
  ds_read_b64_tr_b16 a[186:187], v244 offset:16384
  v_mfma_f32_16x16x32_bf16 v[148:151], a[196:199], a[92:95], v[148:151]
  buffer_load_dwordx4 a[0:3], v137, s[36:39], s51 offen offset:0 sc1
  ds_read_b64_tr_b16 a[188:189], v244 offset:20480
  v_mfma_f32_16x16x32_bf16 v[148:151], a[192:195], a[84:87], v[148:151]
  s_waitcnt lgkmcnt(11)
  ds_read_b64_tr_b16 a[190:191], v244 offset:24576
  v_mfma_f32_16x16x32_bf16 v[156:159], a[200:203], a[84:87], v[156:159]
  ds_read_b64_tr_b16 a[192:193], v245 offset:12288
  v_mfma_f32_16x16x32_bf16 v[156:159], a[204:207], a[92:95], v[156:159]
  ds_read_b64_tr_b16 a[194:195], v245 offset:16384
  v_mfma_f32_16x16x32_bf16 v[152:155], a[204:207], a[88:91], v[152:155]
  buffer_load_dwordx4 a[4:7], v137, s[36:39], s51 offen offset:1024 sc1
  s_lshl_b32 s50, s71, 16
  v_mfma_f32_16x16x32_bf16 v[152:155], a[200:203], a[80:83], v[152:155]
  s_waitcnt lgkmcnt(10)
  s_add_u32 m0, s70, 143360
  ds_read_b64_tr_b16 a[196:197], v245 offset:20480
  v_mfma_f32_16x16x32_bf16 v[160:163], a[208:211], a[80:83], v[160:163]
  ds_read_b64_tr_b16 a[198:199], v245 offset:24576
  ds_read_b64_tr_b16 a[200:201], v246 offset:12288
  v_mfma_f32_16x16x32_bf16 v[160:163], a[212:215], a[88:91], v[160:163]
  ds_read_b64_tr_b16 a[202:203], v246 offset:16384
  v_mfma_f32_16x16x32_bf16 v[164:167], a[212:215], a[92:95], v[164:167]
  buffer_load_dwordx4 v135, s[24:27], s50 offen offset:2048 lds
  ds_read_b64_tr_b16 a[204:205], v246 offset:20480
  v_mfma_f32_16x16x32_bf16 v[164:167], a[208:211], a[84:87], v[164:167]
  s_waitcnt lgkmcnt(11)
  ds_read_b64_tr_b16 a[206:207], v246 offset:24576
  v_mfma_f32_16x16x32_bf16 v[172:175], a[176:179], a[84:87], v[172:175]
  ds_read_b64_tr_b16 a[208:209], v247 offset:12288
  v_mfma_f32_16x16x32_bf16 v[172:175], a[180:183], a[92:95], v[172:175]
  ds_read_b64_tr_b16 a[210:211], v247 offset:16384
  v_mfma_f32_16x16x32_bf16 v[168:171], a[180:183], a[88:91], v[168:171]
  buffer_load_dwordx4 a[8:11], v137, s[36:39], s51 offen offset:2048 sc1
  ds_read_b64_tr_b16 a[212:213], v247 offset:20480
  v_mfma_f32_16x16x32_bf16 v[168:171], a[176:179], a[80:83], v[168:171]
  s_waitcnt vmcnt(26) lgkmcnt(11)
  ds_read_b64_tr_b16 a[214:215], v247 offset:24576
  v_mfma_f32_16x16x32_bf16 v[32:35], a[184:187], a[96:99], v[32:35]
  ds_read_b64_tr_b16 a[176:177], v244 offset:14336
  v_mfma_f32_16x16x32_bf16 v[32:35], a[188:191], a[104:107], v[32:35]
  ds_read_b64_tr_b16 a[178:179], v244 offset:18432
  v_mfma_f32_16x16x32_bf16 v[36:39], a[188:191], a[108:111], v[36:39]
  buffer_load_dwordx4 v136, s[24:27], s50 offen offset:3072 lds
  ds_read_b64_tr_b16 a[180:181], v244 offset:22528
  v_mfma_f32_16x16x32_bf16 v[36:39], a[184:187], a[100:103], v[36:39]
  s_waitcnt lgkmcnt(11)
  ds_read_b64_tr_b16 a[182:183], v244 offset:26624
  v_mfma_f32_16x16x32_bf16 v[44:47], a[192:195], a[100:103], v[44:47]
  ds_read_b64_tr_b16 a[184:185], v245 offset:14336
  v_mfma_f32_16x16x32_bf16 v[44:47], a[196:199], a[108:111], v[44:47]
  ds_read_b64_tr_b16 a[186:187], v245 offset:18432
  v_mfma_f32_16x16x32_bf16 v[40:43], a[196:199], a[104:107], v[40:43]
  buffer_load_dwordx4 a[12:15], v137, s[36:39], s51 offen offset:3072 sc1
  s_cmp_eq_u32 s87, 2
  v_mfma_f32_16x16x32_bf16 v[40:43], a[192:195], a[96:99], v[40:43]
  s_waitcnt vmcnt(21) lgkmcnt(10)
  s_barrier
  s_cselect_b32 s72, 50, 36
  v_mfma_f32_16x16x32_bf16 v[48:51], a[200:203], a[96:99], v[48:51]
  s_lshl_b32 s51, s72, 11
  ds_read_b64_tr_b16 a[188:189], v245 offset:22528
  ds_read_b64_tr_b16 a[190:191], v245 offset:26624
  v_mfma_f32_16x16x32_bf16 v[48:51], a[204:207], a[104:107], v[48:51]
  ds_read_b64_tr_b16 a[192:193], v246 offset:14336
  ds_read_b64_tr_b16 a[194:195], v246 offset:18432
  v_mfma_f32_16x16x32_bf16 v[52:55], a[204:207], a[108:111], v[52:55]
  buffer_load_dwordx4 a[16:19], v137, s[36:39], s51 offen offset:0 sc1
  ds_read_b64_tr_b16 a[196:197], v246 offset:22528
  v_mfma_f32_16x16x32_bf16 v[52:55], a[200:203], a[100:103], v[52:55]
  s_waitcnt lgkmcnt(11)
  ds_read_b64_tr_b16 a[198:199], v246 offset:26624
  v_mfma_f32_16x16x32_bf16 v[60:63], a[208:211], a[100:103], v[60:63]
  ds_read_b64_tr_b16 a[200:201], v247 offset:14336
  v_mfma_f32_16x16x32_bf16 v[60:63], a[212:215], a[108:111], v[60:63]
  ds_read_b64_tr_b16 a[202:203], v247 offset:18432
  v_mfma_f32_16x16x32_bf16 v[56:59], a[212:215], a[104:107], v[56:59]
  buffer_load_dwordx4 a[20:23], v137, s[36:39], s51 offen offset:1024 sc1
  s_lshl_b32 s50, s72, 16
  v_mfma_f32_16x16x32_bf16 v[56:59], a[208:211], a[96:99], v[56:59]
  s_waitcnt lgkmcnt(10)
  s_add_u32 m0, s70, 12288
  ds_read_b64_tr_b16 a[204:205], v247 offset:22528
  v_mfma_f32_16x16x32_bf16 v[144:147], a[176:179], a[96:99], v[144:147]
  ds_read_b64_tr_b16 a[206:207], v247 offset:26624
  ds_read_b64_tr_b16 a[208:209], v244 offset:28672
  v_mfma_f32_16x16x32_bf16 v[144:147], a[180:183], a[104:107], v[144:147]
  ds_read_b64_tr_b16 a[210:211], v244 offset:32768
  v_mfma_f32_16x16x32_bf16 v[148:151], a[180:183], a[108:111], v[148:151]
  buffer_load_dwordx4 v135, s[24:27], s50 offen offset:2048 lds
  ds_read_b64_tr_b16 a[212:213], v244 offset:36864
  v_mfma_f32_16x16x32_bf16 v[148:151], a[176:179], a[100:103], v[148:151]
  s_waitcnt lgkmcnt(11)
  ds_read_b64_tr_b16 a[214:215], v244 offset:40960
  v_mfma_f32_16x16x32_bf16 v[156:159], a[184:187], a[100:103], v[156:159]
  ds_read_b64_tr_b16 a[176:177], v245 offset:28672
  v_mfma_f32_16x16x32_bf16 v[156:159], a[188:191], a[108:111], v[156:159]
  ds_read_b64_tr_b16 a[178:179], v245 offset:32768
  v_mfma_f32_16x16x32_bf16 v[152:155], a[188:191], a[104:107], v[152:155]
  buffer_load_dwordx4 a[24:27], v137, s[36:39], s51 offen offset:2048 sc1
  ds_read_b64_tr_b16 a[180:181], v245 offset:36864
  v_mfma_f32_16x16x32_bf16 v[152:155], a[184:187], a[96:99], v[152:155]
  s_waitcnt lgkmcnt(11)
  ds_read_b64_tr_b16 a[182:183], v245 offset:40960
  v_mfma_f32_16x16x32_bf16 v[160:163], a[192:195], a[96:99], v[160:163]
  ds_read_b64_tr_b16 a[184:185], v246 offset:28672
  v_mfma_f32_16x16x32_bf16 v[160:163], a[196:199], a[104:107], v[160:163]
  ds_read_b64_tr_b16 a[186:187], v246 offset:32768
  v_mfma_f32_16x16x32_bf16 v[164:167], a[196:199], a[108:111], v[164:167]
  buffer_load_dwordx4 v136, s[24:27], s50 offen offset:3072 lds
  ds_read_b64_tr_b16 a[188:189], v246 offset:36864
  v_mfma_f32_16x16x32_bf16 v[164:167], a[192:195], a[100:103], v[164:167]
  s_waitcnt lgkmcnt(11)
  ds_read_b64_tr_b16 a[190:191], v246 offset:40960
  v_mfma_f32_16x16x32_bf16 v[172:175], a[200:203], a[100:103], v[172:175]
  ds_read_b64_tr_b16 a[192:193], v247 offset:28672
  v_mfma_f32_16x16x32_bf16 v[172:175], a[204:207], a[108:111], v[172:175]
  ds_read_b64_tr_b16 a[194:195], v247 offset:32768
  v_mfma_f32_16x16x32_bf16 v[168:171], a[204:207], a[104:107], v[168:171]
  buffer_load_dwordx4 a[28:31], v137, s[36:39], s51 offen offset:3072 sc1
  s_cmp_eq_u32 s87, 3
  v_mfma_f32_16x16x32_bf16 v[168:171], a[200:203], a[96:99], v[168:171]
  s_waitcnt vmcnt(26) lgkmcnt(10)
  s_cselect_b32 s73, 54, 40
  s_lshl_b32 s51, s73, 11
  v_mfma_f32_16x16x32_bf16 v[32:35], a[208:211], a[112:115], v[32:35]
  ds_read_b64_tr_b16 a[196:197], v247 offset:36864
  ds_read_b64_tr_b16 a[198:199], v247 offset:40960
  v_mfma_f32_16x16x32_bf16 v[32:35], a[212:215], a[120:123], v[32:35]
  ds_read_b64_tr_b16 a[200:201], v244 offset:30720
  buffer_load_dwordx4 a[32:35], v137, s[36:39], s51 offen offset:0 sc1
  v_mfma_f32_16x16x32_bf16 v[36:39], a[212:215], a[124:127], v[36:39]
  ds_read_b64_tr_b16 a[202:203], v244 offset:34816
  ds_read_b64_tr_b16 a[204:205], v244 offset:38912
  v_mfma_f32_16x16x32_bf16 v[36:39], a[208:211], a[116:119], v[36:39]
  s_waitcnt lgkmcnt(11)
  ds_read_b64_tr_b16 a[206:207], v244 offset:43008
  v_mfma_f32_16x16x32_bf16 v[44:47], a[176:179], a[116:119], v[44:47]
  ds_read_b64_tr_b16 a[208:209], v245 offset:30720
  v_mfma_f32_16x16x32_bf16 v[44:47], a[180:183], a[124:127], v[44:47]
  buffer_load_dwordx4 a[36:39], v137, s[36:39], s51 offen offset:1024 sc1
  s_lshl_b32 s50, s73, 16
  v_mfma_f32_16x16x32_bf16 v[40:43], a[180:183], a[120:123], v[40:43]
  s_add_u32 m0, s70, 28672
  ds_read_b64_tr_b16 a[210:211], v245 offset:34816
  ds_read_b64_tr_b16 a[212:213], v245 offset:38912
  v_mfma_f32_16x16x32_bf16 v[40:43], a[176:179], a[112:115], v[40:43]
  s_waitcnt vmcnt(21) lgkmcnt(11)
  s_barrier
  ds_read_b64_tr_b16 a[214:215], v245 offset:43008
  v_mfma_f32_16x16x32_bf16 v[48:51], a[184:187], a[112:115], v[48:51]
  ds_read_b64_tr_b16 a[176:177], v246 offset:30720
  v_mfma_f32_16x16x32_bf16 v[48:51], a[188:191], a[120:123], v[48:51]
  buffer_load_dwordx4 v135, s[24:27], s50 offen offset:2048 lds
  ds_read_b64_tr_b16 a[178:179], v246 offset:34816
  v_mfma_f32_16x16x32_bf16 v[52:55], a[188:191], a[124:127], v[52:55]
  ds_read_b64_tr_b16 a[180:181], v246 offset:38912
  v_mfma_f32_16x16x32_bf16 v[52:55], a[184:187], a[116:119], v[52:55]
  s_waitcnt lgkmcnt(11)
  ds_read_b64_tr_b16 a[182:183], v246 offset:43008
  v_mfma_f32_16x16x32_bf16 v[60:63], a[192:195], a[116:119], v[60:63]
  ds_read_b64_tr_b16 a[184:185], v247 offset:30720
  v_mfma_f32_16x16x32_bf16 v[60:63], a[196:199], a[124:127], v[60:63]
  buffer_load_dwordx4 a[40:43], v137, s[36:39], s51 offen offset:2048 sc1
  ds_read_b64_tr_b16 a[186:187], v247 offset:34816
  v_mfma_f32_16x16x32_bf16 v[56:59], a[196:199], a[120:123], v[56:59]
  ds_read_b64_tr_b16 a[188:189], v247 offset:38912
  v_mfma_f32_16x16x32_bf16 v[56:59], a[192:195], a[112:115], v[56:59]
  s_waitcnt lgkmcnt(11)
  ds_read_b64_tr_b16 a[190:191], v247 offset:43008
  v_mfma_f32_16x16x32_bf16 v[144:147], a[200:203], a[112:115], v[144:147]
  ds_read_b64_tr_b16 a[192:193], v244 offset:45056
  v_mfma_f32_16x16x32_bf16 v[144:147], a[204:207], a[120:123], v[144:147]
  buffer_load_dwordx4 v136, s[24:27], s50 offen offset:3072 lds
  ds_read_b64_tr_b16 a[194:195], v244 offset:49152
  v_mfma_f32_16x16x32_bf16 v[148:151], a[204:207], a[124:127], v[148:151]
  ds_read_b64_tr_b16 a[196:197], v244 offset:53248
  v_mfma_f32_16x16x32_bf16 v[148:151], a[200:203], a[116:119], v[148:151]
  s_waitcnt lgkmcnt(11)
  ds_read_b64_tr_b16 a[198:199], v244 offset:57344
  v_mfma_f32_16x16x32_bf16 v[156:159], a[208:211], a[116:119], v[156:159]
  ds_read_b64_tr_b16 a[200:201], v245 offset:45056
  v_mfma_f32_16x16x32_bf16 v[156:159], a[212:215], a[124:127], v[156:159]
  buffer_load_dwordx4 a[44:47], v137, s[36:39], s51 offen offset:3072 sc1
  s_cmp_eq_u32 s87, 0
  v_mfma_f32_16x16x32_bf16 v[152:155], a[212:215], a[120:123], v[152:155]
  s_cselect_b32 s74, 15, 43
  s_lshl_b32 s51, s74, 11
  ds_read_b64_tr_b16 a[202:203], v245 offset:49152
  v_mfma_f32_16x16x32_bf16 v[152:155], a[208:211], a[112:115], v[152:155]
  s_waitcnt lgkmcnt(10)
  ds_read_b64_tr_b16 a[204:205], v245 offset:53248
  ds_read_b64_tr_b16 a[206:207], v245 offset:57344
  v_mfma_f32_16x16x32_bf16 v[160:163], a[176:179], a[112:115], v[160:163]
  ds_read_b64_tr_b16 a[208:209], v246 offset:45056
  v_mfma_f32_16x16x32_bf16 v[160:163], a[180:183], a[120:123], v[160:163]
  buffer_load_dwordx4 a[48:51], v137, s[36:39], s51 offen offset:0 sc1
  ds_read_b64_tr_b16 a[210:211], v246 offset:49152
  v_mfma_f32_16x16x32_bf16 v[164:167], a[180:183], a[124:127], v[164:167]
  ds_read_b64_tr_b16 a[212:213], v246 offset:53248
  v_mfma_f32_16x16x32_bf16 v[164:167], a[176:179], a[116:119], v[164:167]
  s_waitcnt lgkmcnt(11)
  ds_read_b64_tr_b16 a[214:215], v246 offset:57344
  v_mfma_f32_16x16x32_bf16 v[172:175], a[184:187], a[116:119], v[172:175]
  ds_read_b64_tr_b16 a[176:177], v247 offset:45056
  v_mfma_f32_16x16x32_bf16 v[172:175], a[188:191], a[124:127], v[172:175]
  buffer_load_dwordx4 a[52:55], v137, s[36:39], s51 offen offset:1024 sc1
  s_lshl_b32 s50, s74, 16
  v_mfma_f32_16x16x32_bf16 v[168:171], a[188:191], a[120:123], v[168:171]
  s_add_u32 m0, s70, 45056
  ds_read_b64_tr_b16 a[178:179], v247 offset:49152
  ds_read_b64_tr_b16 a[180:181], v247 offset:53248
  v_mfma_f32_16x16x32_bf16 v[168:171], a[184:187], a[112:115], v[168:171]
  s_waitcnt vmcnt(26) lgkmcnt(11)
  ds_read_b64_tr_b16 a[182:183], v247 offset:57344
  v_mfma_f32_16x16x32_bf16 v[32:35], a[192:195], a[128:131], v[32:35]
  ds_read_b64_tr_b16 a[184:185], v244 offset:47104
  v_mfma_f32_16x16x32_bf16 v[32:35], a[196:199], a[136:139], v[32:35]
  buffer_load_dwordx4 v135, s[24:27], s50 offen offset:2048 lds
  ds_read_b64_tr_b16 a[186:187], v244 offset:51200
  v_mfma_f32_16x16x32_bf16 v[36:39], a[196:199], a[140:143], v[36:39]
  ds_read_b64_tr_b16 a[188:189], v244 offset:55296
  v_mfma_f32_16x16x32_bf16 v[36:39], a[192:195], a[132:135], v[36:39]
  s_waitcnt lgkmcnt(11)
  ds_read_b64_tr_b16 a[190:191], v244 offset:59392
  v_mfma_f32_16x16x32_bf16 v[44:47], a[200:203], a[132:135], v[44:47]
  ds_read_b64_tr_b16 a[192:193], v245 offset:47104
  v_mfma_f32_16x16x32_bf16 v[44:47], a[204:207], a[140:143], v[44:47]
  buffer_load_dwordx4 a[56:59], v137, s[36:39], s51 offen offset:2048 sc1
  ds_read_b64_tr_b16 a[194:195], v245 offset:51200
  v_mfma_f32_16x16x32_bf16 v[40:43], a[204:207], a[136:139], v[40:43]
  ds_read_b64_tr_b16 a[196:197], v245 offset:55296
  v_mfma_f32_16x16x32_bf16 v[40:43], a[200:203], a[128:131], v[40:43]
  s_waitcnt vmcnt(23) lgkmcnt(11)
  s_barrier
  ds_read_b64_tr_b16 a[198:199], v245 offset:59392
  v_mfma_f32_16x16x32_bf16 v[48:51], a[208:211], a[128:131], v[48:51]
  ds_read_b64_tr_b16 a[200:201], v246 offset:47104
  v_mfma_f32_16x16x32_bf16 v[48:51], a[212:215], a[136:139], v[48:51]
  buffer_load_dwordx4 v136, s[24:27], s50 offen offset:3072 lds
  ds_read_b64_tr_b16 a[202:203], v246 offset:51200
  v_mfma_f32_16x16x32_bf16 v[52:55], a[212:215], a[140:143], v[52:55]
  ds_read_b64_tr_b16 a[204:205], v246 offset:55296
  v_mfma_f32_16x16x32_bf16 v[52:55], a[208:211], a[132:135], v[52:55]
  s_waitcnt lgkmcnt(11)
  ds_read_b64_tr_b16 a[206:207], v246 offset:59392
  v_mfma_f32_16x16x32_bf16 v[60:63], a[176:179], a[132:135], v[60:63]
  ds_read_b64_tr_b16 a[208:209], v247 offset:47104
  v_mfma_f32_16x16x32_bf16 v[60:63], a[180:183], a[140:143], v[60:63]
  buffer_load_dwordx4 a[60:63], v137, s[36:39], s51 offen offset:3072 sc1
  s_cmp_eq_u32 s87, 1
  v_mfma_f32_16x16x32_bf16 v[56:59], a[180:183], a[136:139], v[56:59]
  s_cselect_b32 s75, 5, 47
  s_lshl_b32 s51, s75, 11
  ds_read_b64_tr_b16 a[210:211], v247 offset:51200
  v_mfma_f32_16x16x32_bf16 v[56:59], a[176:179], a[128:131], v[56:59]
  s_waitcnt lgkmcnt(10)
  ds_read_b64_tr_b16 a[212:213], v247 offset:55296
  ds_read_b64_tr_b16 a[214:215], v247 offset:59392
  v_mfma_f32_16x16x32_bf16 v[144:147], a[184:187], a[128:131], v[144:147]
  ds_read_b64_tr_b16 a[176:177], v244 offset:63488
  v_mfma_f32_16x16x32_bf16 v[144:147], a[188:191], a[136:139], v[144:147]
  buffer_load_dwordx4 a[64:67], v137, s[36:39], s51 offen offset:0 sc1
  ds_read_b64_tr_b16 a[178:179], v248 offset:2048
  v_mfma_f32_16x16x32_bf16 v[148:151], a[188:191], a[140:143], v[148:151]
  ds_read_b64_tr_b16 a[180:181], v248 offset:6144
  v_mfma_f32_16x16x32_bf16 v[148:151], a[184:187], a[132:135], v[148:151]
  s_waitcnt lgkmcnt(11)
  ds_read_b64_tr_b16 a[182:183], v248 offset:10240
  v_mfma_f32_16x16x32_bf16 v[156:159], a[192:195], a[132:135], v[156:159]
  ds_read_b64_tr_b16 a[184:185], v245 offset:63488
  v_mfma_f32_16x16x32_bf16 v[156:159], a[196:199], a[140:143], v[156:159]
  buffer_load_dwordx4 a[68:71], v137, s[36:39], s51 offen offset:1024 sc1
  s_lshl_b32 s50, s75, 16
  v_mfma_f32_16x16x32_bf16 v[152:155], a[196:199], a[136:139], v[152:155]
  s_add_u32 m0, s70, 61440
  ds_read_b64_tr_b16 a[186:187], v249 offset:2048
  ds_read_b64_tr_b16 a[188:189], v249 offset:6144
  v_mfma_f32_16x16x32_bf16 v[152:155], a[192:195], a[128:131], v[152:155]
  s_waitcnt vmcnt(21) lgkmcnt(11)
  s_barrier
  ds_read_b64_tr_b16 a[190:191], v249 offset:10240
  v_mfma_f32_16x16x32_bf16 v[160:163], a[200:203], a[128:131], v[160:163]
  ds_read_b64_tr_b16 a[192:193], v246 offset:63488
  v_mfma_f32_16x16x32_bf16 v[160:163], a[204:207], a[136:139], v[160:163]
  buffer_load_dwordx4 v135, s[24:27], s50 offen offset:2048 lds
  ds_read_b64_tr_b16 a[194:195], v250 offset:2048
  v_mfma_f32_16x16x32_bf16 v[164:167], a[204:207], a[140:143], v[164:167]
  ds_read_b64_tr_b16 a[196:197], v250 offset:6144
  v_mfma_f32_16x16x32_bf16 v[164:167], a[200:203], a[132:135], v[164:167]
  s_waitcnt lgkmcnt(11)
  ds_read_b64_tr_b16 a[198:199], v250 offset:10240
  v_mfma_f32_16x16x32_bf16 v[172:175], a[208:211], a[132:135], v[172:175]
  buffer_load_dwordx4 a[72:75], v137, s[36:39], s51 offen offset:2048 sc1
  ds_read_b64_tr_b16 a[200:201], v247 offset:63488
  v_mfma_f32_16x16x32_bf16 v[172:175], a[212:215], a[140:143], v[172:175]
  ds_read_b64_tr_b16 a[202:203], v251 offset:2048
  v_mfma_f32_16x16x32_bf16 v[168:171], a[212:215], a[136:139], v[168:171]
  ds_read_b64_tr_b16 a[204:205], v251 offset:6144
  v_mfma_f32_16x16x32_bf16 v[168:171], a[208:211], a[128:131], v[168:171]
  s_waitcnt vmcnt(28) lgkmcnt(11)
  ds_read_b64_tr_b16 a[206:207], v251 offset:10240
  v_mfma_f32_16x16x32_bf16 v[144:147], a[176:179], a[216:219], v[144:147]
  buffer_load_dwordx4 v136, s[24:27], s50 offen offset:3072 lds
  ds_read_b64_tr_b16 a[208:209], v248 offset:14336
  v_mfma_f32_16x16x32_bf16 v[144:147], a[180:183], a[224:227], v[144:147]
  ds_read_b64_tr_b16 a[210:211], v248 offset:18432
  v_mfma_f32_16x16x32_bf16 v[148:151], a[180:183], a[228:231], v[148:151]
  ds_read_b64_tr_b16 a[212:213], v248 offset:22528
  v_mfma_f32_16x16x32_bf16 v[148:151], a[176:179], a[220:223], v[148:151]
  s_waitcnt lgkmcnt(11)
  ds_read_b64_tr_b16 a[214:215], v248 offset:26624
  v_mfma_f32_16x16x32_bf16 v[156:159], a[184:187], a[220:223], v[156:159]
  buffer_load_dwordx4 a[76:79], v137, s[36:39], s51 offen offset:3072 sc1
  s_cmp_eq_u32 s87, 2
  v_mfma_f32_16x16x32_bf16 v[156:159], a[188:191], a[228:231], v[156:159]
  s_cselect_b32 s79, 8, 50
  s_lshl_b32 s51, s79, 11
  ds_read_b64_tr_b16 a[176:177], v249 offset:14336
  v_mfma_f32_16x16x32_bf16 v[152:155], a[188:191], a[224:227], v[152:155]
  ds_read_b64_tr_b16 a[178:179], v249 offset:18432
  ds_read_b64_tr_b16 a[180:181], v249 offset:22528
  v_mfma_f32_16x16x32_bf16 v[152:155], a[184:187], a[216:219], v[152:155]
  s_waitcnt vmcnt(19) lgkmcnt(11)
  s_barrier
  ds_read_b64_tr_b16 a[182:183], v249 offset:26624
  v_mfma_f32_16x16x32_bf16 v[160:163], a[192:195], a[216:219], v[160:163]
  buffer_load_dwordx4 a[80:83], v137, s[36:39], s51 offen offset:0 sc1
  ds_read_b64_tr_b16 a[184:185], v250 offset:14336
  v_mfma_f32_16x16x32_bf16 v[160:163], a[196:199], a[224:227], v[160:163]
  ds_read_b64_tr_b16 a[186:187], v250 offset:18432
  v_mfma_f32_16x16x32_bf16 v[164:167], a[196:199], a[228:231], v[164:167]
  ds_read_b64_tr_b16 a[188:189], v250 offset:22528
  v_mfma_f32_16x16x32_bf16 v[164:167], a[192:195], a[220:223], v[164:167]
  s_waitcnt lgkmcnt(11)
  ds_read_b64_tr_b16 a[190:191], v250 offset:26624
  v_mfma_f32_16x16x32_bf16 v[172:175], a[200:203], a[220:223], v[172:175]
  buffer_load_dwordx4 a[84:87], v137, s[36:39], s51 offen offset:1024 sc1
  s_lshl_b32 s50, s79, 16
  v_mfma_f32_16x16x32_bf16 v[172:175], a[204:207], a[228:231], v[172:175]
  s_add_u32 m0, s70, 77824
  ds_read_b64_tr_b16 a[192:193], v251 offset:14336
  ds_read_b64_tr_b16 a[194:195], v251 offset:18432
  v_mfma_f32_16x16x32_bf16 v[168:171], a[204:207], a[224:227], v[168:171]
  ds_read_b64_tr_b16 a[196:197], v251 offset:22528
  v_mfma_f32_16x16x32_bf16 v[168:171], a[200:203], a[216:219], v[168:171]
  s_waitcnt vmcnt(26) lgkmcnt(11)
  ds_read_b64_tr_b16 a[198:199], v251 offset:26624
  v_mfma_f32_16x16x32_bf16 v[144:147], a[208:211], a[0:3], v[144:147]
  buffer_load_dwordx4 v135, s[24:27], s50 offen offset:2048 lds
  ds_read_b64_tr_b16 a[200:201], v240 offset:14336
  v_mfma_f32_16x16x32_bf16 v[144:147], a[212:215], a[8:11], v[144:147]
  ds_read_b64_tr_b16 a[202:203], v240 offset:18432
  v_mfma_f32_16x16x32_bf16 v[148:151], a[212:215], a[12:15], v[148:151]
  ds_read_b64_tr_b16 a[204:205], v240 offset:22528
  v_mfma_f32_16x16x32_bf16 v[148:151], a[208:211], a[4:7], v[148:151]
  s_waitcnt lgkmcnt(11)
  ds_read_b64_tr_b16 a[206:207], v240 offset:26624
  v_mfma_f32_16x16x32_bf16 v[156:159], a[176:179], a[4:7], v[156:159]
  buffer_load_dwordx4 a[88:91], v137, s[36:39], s51 offen offset:2048 sc1
  ds_read_b64_tr_b16 a[208:209], v241 offset:14336
  v_mfma_f32_16x16x32_bf16 v[156:159], a[180:183], a[12:15], v[156:159]
  ds_read_b64_tr_b16 a[210:211], v241 offset:18432
  v_mfma_f32_16x16x32_bf16 v[152:155], a[180:183], a[8:11], v[152:155]
  ds_read_b64_tr_b16 a[212:213], v241 offset:22528
  v_mfma_f32_16x16x32_bf16 v[152:155], a[176:179], a[0:3], v[152:155]
  s_waitcnt vmcnt(17) lgkmcnt(11)
  s_barrier
  ds_read_b64_tr_b16 a[214:215], v241 offset:26624
  v_mfma_f32_16x16x32_bf16 v[160:163], a[184:187], a[0:3], v[160:163]
  buffer_load_dwordx4 v136, s[24:27], s50 offen offset:3072 lds
  ds_read_b64_tr_b16 a[176:177], v242 offset:14336
  v_mfma_f32_16x16x32_bf16 v[160:163], a[188:191], a[8:11], v[160:163]
  ds_read_b64_tr_b16 a[178:179], v242 offset:18432
  v_mfma_f32_16x16x32_bf16 v[164:167], a[188:191], a[12:15], v[164:167]
  ds_read_b64_tr_b16 a[180:181], v242 offset:22528
  v_mfma_f32_16x16x32_bf16 v[164:167], a[184:187], a[4:7], v[164:167]
  s_waitcnt lgkmcnt(11)
  ds_read_b64_tr_b16 a[182:183], v242 offset:26624
  v_mfma_f32_16x16x32_bf16 v[172:175], a[192:195], a[4:7], v[172:175]
  buffer_load_dwordx4 a[92:95], v137, s[36:39], s51 offen offset:3072 sc1
  s_cmp_eq_u32 s87, 3
  v_mfma_f32_16x16x32_bf16 v[172:175], a[196:199], a[12:15], v[172:175]
  s_cselect_b32 s80, 12, 54
  s_lshl_b32 s51, s80, 11
  ds_read_b64_tr_b16 a[184:185], v243 offset:14336
  v_mfma_f32_16x16x32_bf16 v[168:171], a[196:199], a[8:11], v[168:171]
  ds_read_b64_tr_b16 a[186:187], v243 offset:18432
  ds_read_b64_tr_b16 a[188:189], v243 offset:22528
  v_mfma_f32_16x16x32_bf16 v[168:171], a[192:195], a[0:3], v[168:171]
  s_waitcnt vmcnt(24) lgkmcnt(11)
  ds_read_b64_tr_b16 a[190:191], v243 offset:26624
  v_mfma_f32_16x16x32_bf16 v[144:147], a[200:203], a[16:19], v[144:147]
  buffer_load_dwordx4 a[96:99], v137, s[36:39], s51 offen offset:0 sc1
  ds_read_b64_tr_b16 a[192:193], v240 offset:30720
  v_mfma_f32_16x16x32_bf16 v[144:147], a[204:207], a[24:27], v[144:147]
  ds_read_b64_tr_b16 a[194:195], v240 offset:34816
  v_mfma_f32_16x16x32_bf16 v[148:151], a[204:207], a[28:31], v[148:151]
  ds_read_b64_tr_b16 a[196:197], v240 offset:38912
  v_mfma_f32_16x16x32_bf16 v[148:151], a[200:203], a[20:23], v[148:151]
  s_waitcnt lgkmcnt(11)
  ds_read_b64_tr_b16 a[198:199], v240 offset:43008
  v_mfma_f32_16x16x32_bf16 v[156:159], a[208:211], a[20:23], v[156:159]
  buffer_load_dwordx4 a[100:103], v137, s[36:39], s51 offen offset:1024 sc1
  s_lshl_b32 s50, s80, 16
  v_mfma_f32_16x16x32_bf16 v[156:159], a[212:215], a[28:31], v[156:159]
  s_add_u32 m0, s70, 94208
  ds_read_b64_tr_b16 a[200:201], v241 offset:30720
  ds_read_b64_tr_b16 a[202:203], v241 offset:34816
  v_mfma_f32_16x16x32_bf16 v[152:155], a[212:215], a[24:27], v[152:155]
  ds_read_b64_tr_b16 a[204:205], v241 offset:38912
  v_mfma_f32_16x16x32_bf16 v[152:155], a[208:211], a[16:19], v[152:155]
  s_waitcnt vmcnt(15) lgkmcnt(11)
  s_barrier
  ds_read_b64_tr_b16 a[206:207], v241 offset:43008
  v_mfma_f32_16x16x32_bf16 v[160:163], a[176:179], a[16:19], v[160:163]
  buffer_load_dwordx4 v135, s[24:27], s50 offen offset:2048 lds
  ds_read_b64_tr_b16 a[208:209], v242 offset:30720
  v_mfma_f32_16x16x32_bf16 v[160:163], a[180:183], a[24:27], v[160:163]
  ds_read_b64_tr_b16 a[210:211], v242 offset:34816
  v_mfma_f32_16x16x32_bf16 v[164:167], a[180:183], a[28:31], v[164:167]
  ds_read_b64_tr_b16 a[212:213], v242 offset:38912
  v_mfma_f32_16x16x32_bf16 v[164:167], a[176:179], a[20:23], v[164:167]
  s_waitcnt lgkmcnt(11)
  ds_read_b64_tr_b16 a[214:215], v242 offset:43008
  v_mfma_f32_16x16x32_bf16 v[172:175], a[184:187], a[20:23], v[172:175]
  buffer_load_dwordx4 a[104:107], v137, s[36:39], s51 offen offset:2048 sc1
  ds_read_b64_tr_b16 a[176:177], v243 offset:30720
  v_mfma_f32_16x16x32_bf16 v[172:175], a[188:191], a[28:31], v[172:175]
  ds_read_b64_tr_b16 a[178:179], v243 offset:34816
  v_mfma_f32_16x16x32_bf16 v[168:171], a[188:191], a[24:27], v[168:171]
  ds_read_b64_tr_b16 a[180:181], v243 offset:38912
  v_mfma_f32_16x16x32_bf16 v[168:171], a[184:187], a[16:19], v[168:171]
  s_waitcnt vmcnt(22) lgkmcnt(11)
  ds_read_b64_tr_b16 a[182:183], v243 offset:43008
  v_mfma_f32_16x16x32_bf16 v[144:147], a[192:195], a[32:35], v[144:147]
  buffer_load_dwordx4 v136, s[24:27], s50 offen offset:3072 lds
  ds_read_b64_tr_b16 a[184:185], v240 offset:47104
  v_mfma_f32_16x16x32_bf16 v[144:147], a[196:199], a[40:43], v[144:147]
  ds_read_b64_tr_b16 a[186:187], v240 offset:51200
  v_mfma_f32_16x16x32_bf16 v[148:151], a[196:199], a[44:47], v[148:151]
Hb0_1:
  s_cbranch_execz Rb
  ds_read_b64_tr_b16 a[188:189], v240 offset:55296
  v_mfma_f32_16x16x32_bf16 v[148:151], a[192:195], a[36:39], v[148:151]
  s_waitcnt lgkmcnt(11)
  ds_read_b64_tr_b16 a[190:191], v240 offset:59392
  v_mfma_f32_16x16x32_bf16 v[156:159], a[200:203], a[36:39], v[156:159]
  buffer_load_dwordx4 a[108:111], v137, s[36:39], s51 offen offset:3072 sc1
  s_lshl_b32 s50, s69, 16
  v_mfma_f32_16x16x32_bf16 v[156:159], a[204:207], a[44:47], v[156:159]
  s_add_u32 m0, s70, 126976
  ds_read_b64_tr_b16 a[192:193], v241 offset:47104
  ds_read_b64_tr_b16 a[194:195], v241 offset:51200
  v_mfma_f32_16x16x32_bf16 v[152:155], a[204:207], a[40:43], v[152:155]
  ds_read_b64_tr_b16 a[196:197], v241 offset:55296
  v_mfma_f32_16x16x32_bf16 v[152:155], a[200:203], a[32:35], v[152:155]
  s_waitcnt vmcnt(13) lgkmcnt(11)
  s_barrier
  ds_read_b64_tr_b16 a[198:199], v241 offset:59392
  v_mfma_f32_16x16x32_bf16 v[160:163], a[208:211], a[32:35], v[160:163]
  buffer_load_dwordx4 v133, s[24:27], s50 offen offset:0 lds
  ds_read_b64_tr_b16 a[200:201], v242 offset:47104
  v_mfma_f32_16x16x32_bf16 v[160:163], a[212:215], a[40:43], v[160:163]
  ds_read_b64_tr_b16 a[202:203], v242 offset:51200
  v_mfma_f32_16x16x32_bf16 v[164:167], a[212:215], a[44:47], v[164:167]
  ds_read_b64_tr_b16 a[204:205], v242 offset:55296
  v_mfma_f32_16x16x32_bf16 v[164:167], a[208:211], a[36:39], v[164:167]
  s_waitcnt lgkmcnt(11)
  ds_read_b64_tr_b16 a[206:207], v242 offset:59392
  v_mfma_f32_16x16x32_bf16 v[172:175], a[176:179], a[36:39], v[172:175]
  buffer_load_dwordx4 v134, s[24:27], s50 offen offset:1024 lds
  s_lshl_b32 s50, s71, 16
  v_mfma_f32_16x16x32_bf16 v[172:175], a[180:183], a[44:47], v[172:175]
  s_add_u32 m0, s70, 143360
  ds_read_b64_tr_b16 a[208:209], v243 offset:47104
  ds_read_b64_tr_b16 a[210:211], v243 offset:51200
  v_mfma_f32_16x16x32_bf16 v[168:171], a[180:183], a[40:43], v[168:171]
  ds_read_b64_tr_b16 a[212:213], v243 offset:55296
  v_mfma_f32_16x16x32_bf16 v[168:171], a[176:179], a[32:35], v[168:171]
  s_waitcnt vmcnt(20) lgkmcnt(11)
  ds_read_b64_tr_b16 a[214:215], v243 offset:59392
  v_mfma_f32_16x16x32_bf16 v[144:147], a[184:187], a[48:51], v[144:147]
  buffer_load_dwordx4 v133, s[24:27], s50 offen offset:0 lds
  ds_read_b64_tr_b16 a[176:177], v240 offset:63488
  v_mfma_f32_16x16x32_bf16 v[144:147], a[188:191], a[56:59], v[144:147]
  ds_read_b64_tr_b16 a[178:179], v244 offset:2048
  v_mfma_f32_16x16x32_bf16 v[148:151], a[188:191], a[60:63], v[148:151]
  ds_read_b64_tr_b16 a[180:181], v244 offset:6144
  v_mfma_f32_16x16x32_bf16 v[148:151], a[184:187], a[52:55], v[148:151]
  s_waitcnt lgkmcnt(11)
  ds_read_b64_tr_b16 a[182:183], v244 offset:10240
  v_mfma_f32_16x16x32_bf16 v[156:159], a[192:195], a[52:55], v[156:159]
  buffer_load_dwordx4 v134, s[24:27], s50 offen offset:1024 lds
  s_lshl_b32 s50, s72, 16
  v_mfma_f32_16x16x32_bf16 v[156:159], a[196:199], a[60:63], v[156:159]
  s_add_u32 m0, s70, 12288
  ds_read_b64_tr_b16 a[184:185], v241 offset:63488
  ds_read_b64_tr_b16 a[186:187], v245 offset:2048
  v_mfma_f32_16x16x32_bf16 v[152:155], a[196:199], a[56:59], v[152:155]
  ds_read_b64_tr_b16 a[188:189], v245 offset:6144
  v_mfma_f32_16x16x32_bf16 v[152:155], a[192:195], a[48:51], v[152:155]
  s_waitcnt vmcnt(11) lgkmcnt(11)
  s_barrier
  ds_read_b64_tr_b16 a[190:191], v245 offset:10240
  v_mfma_f32_16x16x32_bf16 v[160:163], a[200:203], a[48:51], v[160:163]
  buffer_load_dwordx4 v133, s[24:27], s50 offen offset:0 lds
  ds_read_b64_tr_b16 a[192:193], v242 offset:63488
  v_mfma_f32_16x16x32_bf16 v[160:163], a[204:207], a[56:59], v[160:163]
  ds_read_b64_tr_b16 a[194:195], v246 offset:2048
  v_mfma_f32_16x16x32_bf16 v[164:167], a[204:207], a[60:63], v[164:167]
  ds_read_b64_tr_b16 a[196:197], v246 offset:6144
  v_mfma_f32_16x16x32_bf16 v[164:167], a[200:203], a[52:55], v[164:167]
  s_waitcnt lgkmcnt(11)
  ds_read_b64_tr_b16 a[198:199], v246 offset:10240
  v_mfma_f32_16x16x32_bf16 v[172:175], a[208:211], a[52:55], v[172:175]
  buffer_load_dwordx4 v134, s[24:27], s50 offen offset:1024 lds
  s_lshl_b32 s50, s73, 16
  v_mfma_f32_16x16x32_bf16 v[172:175], a[212:215], a[60:63], v[172:175]
  s_add_u32 m0, s70, 28672
  ds_read_b64_tr_b16 a[200:201], v243 offset:63488
  ds_read_b64_tr_b16 a[202:203], v247 offset:2048
  v_mfma_f32_16x16x32_bf16 v[168:171], a[212:215], a[56:59], v[168:171]
  ds_read_b64_tr_b16 a[204:205], v247 offset:6144
  v_mfma_f32_16x16x32_bf16 v[168:171], a[208:211], a[48:51], v[168:171]
  s_waitcnt vmcnt(18) lgkmcnt(11)
  ds_read_b64_tr_b16 a[206:207], v247 offset:10240
  v_mfma_f32_16x16x32_bf16 v[144:147], a[176:179], a[64:67], v[144:147]
  buffer_load_dwordx4 v133, s[24:27], s50 offen offset:0 lds
  ds_read_b64_tr_b16 a[208:209], v244 offset:14336
  v_mfma_f32_16x16x32_bf16 v[144:147], a[180:183], a[72:75], v[144:147]
  ds_read_b64_tr_b16 a[210:211], v244 offset:18432
  v_mfma_f32_16x16x32_bf16 v[148:151], a[180:183], a[76:79], v[148:151]
  ds_read_b64_tr_b16 a[212:213], v244 offset:22528
  v_mfma_f32_16x16x32_bf16 v[148:151], a[176:179], a[68:71], v[148:151]
  s_waitcnt lgkmcnt(11)
  ds_read_b64_tr_b16 a[214:215], v244 offset:26624
  v_mfma_f32_16x16x32_bf16 v[156:159], a[184:187], a[68:71], v[156:159]
  buffer_load_dwordx4 v134, s[24:27], s50 offen offset:1024 lds
  s_lshl_b32 s50, s74, 16
  v_mfma_f32_16x16x32_bf16 v[156:159], a[188:191], a[76:79], v[156:159]
  s_add_u32 m0, s70, 45056
  ds_read_b64_tr_b16 a[176:177], v245 offset:14336
  ds_read_b64_tr_b16 a[178:179], v245 offset:18432
  v_mfma_f32_16x16x32_bf16 v[152:155], a[188:191], a[72:75], v[152:155]
  ds_read_b64_tr_b16 a[180:181], v245 offset:22528
  v_mfma_f32_16x16x32_bf16 v[152:155], a[184:187], a[64:67], v[152:155]
  s_waitcnt vmcnt(9) lgkmcnt(11)
  s_barrier
  ds_read_b64_tr_b16 a[182:183], v245 offset:26624
  v_mfma_f32_16x16x32_bf16 v[160:163], a[192:195], a[64:67], v[160:163]
  buffer_load_dwordx4 v133, s[24:27], s50 offen offset:0 lds
  ds_read_b64_tr_b16 a[184:185], v246 offset:14336
  v_mfma_f32_16x16x32_bf16 v[160:163], a[196:199], a[72:75], v[160:163]
  ds_read_b64_tr_b16 a[186:187], v246 offset:18432
  v_mfma_f32_16x16x32_bf16 v[164:167], a[196:199], a[76:79], v[164:167]
  ds_read_b64_tr_b16 a[188:189], v246 offset:22528
  v_mfma_f32_16x16x32_bf16 v[164:167], a[192:195], a[68:71], v[164:167]
  s_waitcnt lgkmcnt(11)
  ds_read_b64_tr_b16 a[190:191], v246 offset:26624
  v_mfma_f32_16x16x32_bf16 v[172:175], a[200:203], a[68:71], v[172:175]
  buffer_load_dwordx4 v134, s[24:27], s50 offen offset:1024 lds
  s_lshl_b32 s50, s75, 16
  v_mfma_f32_16x16x32_bf16 v[172:175], a[204:207], a[76:79], v[172:175]
  s_add_u32 m0, s70, 61440
  ds_read_b64_tr_b16 a[192:193], v247 offset:14336
  ds_read_b64_tr_b16 a[194:195], v247 offset:18432
  v_mfma_f32_16x16x32_bf16 v[168:171], a[204:207], a[72:75], v[168:171]
  ds_read_b64_tr_b16 a[196:197], v247 offset:22528
  v_mfma_f32_16x16x32_bf16 v[168:171], a[200:203], a[64:67], v[168:171]
  s_waitcnt vmcnt(16) lgkmcnt(11)
  ds_read_b64_tr_b16 a[198:199], v247 offset:26624
  v_mfma_f32_16x16x32_bf16 v[144:147], a[208:211], a[80:83], v[144:147]
  buffer_load_dwordx4 v133, s[24:27], s50 offen offset:0 lds
  ds_read_b64_tr_b16 a[200:201], v244 offset:30720
  v_mfma_f32_16x16x32_bf16 v[144:147], a[212:215], a[88:91], v[144:147]
  ds_read_b64_tr_b16 a[202:203], v244 offset:34816
  v_mfma_f32_16x16x32_bf16 v[148:151], a[212:215], a[92:95], v[148:151]
  ds_read_b64_tr_b16 a[204:205], v244 offset:38912
  v_mfma_f32_16x16x32_bf16 v[148:151], a[208:211], a[84:87], v[148:151]
  s_waitcnt lgkmcnt(11)
  ds_read_b64_tr_b16 a[206:207], v244 offset:43008
  v_mfma_f32_16x16x32_bf16 v[156:159], a[176:179], a[84:87], v[156:159]
  buffer_load_dwordx4 v134, s[24:27], s50 offen offset:1024 lds
  s_lshl_b32 s50, s79, 16
  v_mfma_f32_16x16x32_bf16 v[156:159], a[180:183], a[92:95], v[156:159]
  s_add_u32 m0, s70, 77824
  ds_read_b64_tr_b16 a[208:209], v245 offset:30720
  ds_read_b64_tr_b16 a[210:211], v245 offset:34816
  v_mfma_f32_16x16x32_bf16 v[152:155], a[180:183], a[88:91], v[152:155]
  ds_read_b64_tr_b16 a[212:213], v245 offset:38912
  v_mfma_f32_16x16x32_bf16 v[152:155], a[176:179], a[80:83], v[152:155]
  s_waitcnt vmcnt(10) lgkmcnt(11)
  s_barrier
  ds_read_b64_tr_b16 a[214:215], v245 offset:43008
  v_mfma_f32_16x16x32_bf16 v[160:163], a[184:187], a[80:83], v[160:163]
  buffer_load_dwordx4 v133, s[24:27], s50 offen offset:0 lds
  ds_read_b64_tr_b16 a[176:177], v246 offset:30720
  v_mfma_f32_16x16x32_bf16 v[160:163], a[188:191], a[88:91], v[160:163]
  ds_read_b64_tr_b16 a[178:179], v246 offset:34816
  v_mfma_f32_16x16x32_bf16 v[164:167], a[188:191], a[92:95], v[164:167]
  ds_read_b64_tr_b16 a[180:181], v246 offset:38912
  v_mfma_f32_16x16x32_bf16 v[164:167], a[184:187], a[84:87], v[164:167]
  s_waitcnt lgkmcnt(11)
  ds_read_b64_tr_b16 a[182:183], v246 offset:43008
  v_mfma_f32_16x16x32_bf16 v[172:175], a[192:195], a[84:87], v[172:175]
  buffer_load_dwordx4 v134, s[24:27], s50 offen offset:1024 lds
  s_lshl_b32 s50, s80, 16
  v_mfma_f32_16x16x32_bf16 v[172:175], a[196:199], a[92:95], v[172:175]
  s_add_u32 m0, s70, 94208
  ds_read_b64_tr_b16 a[184:185], v247 offset:30720
  ds_read_b64_tr_b16 a[186:187], v247 offset:34816
  v_mfma_f32_16x16x32_bf16 v[168:171], a[196:199], a[88:91], v[168:171]
  ds_read_b64_tr_b16 a[188:189], v247 offset:38912
  v_mfma_f32_16x16x32_bf16 v[168:171], a[192:195], a[80:83], v[168:171]
  s_waitcnt vmcnt(14) lgkmcnt(11)
  ds_read_b64_tr_b16 a[190:191], v247 offset:43008
  v_mfma_f32_16x16x32_bf16 v[144:147], a[200:203], a[96:99], v[144:147]
  buffer_load_dwordx4 v133, s[24:27], s50 offen offset:0 lds
  ds_read_b64_tr_b16 a[192:193], v244 offset:61440
  v_mfma_f32_16x16x32_bf16 v[144:147], a[204:207], a[104:107], v[144:147]
  ds_read_b64_tr_b16 a[194:195], v248 offset:0
  v_mfma_f32_16x16x32_bf16 v[148:151], a[204:207], a[108:111], v[148:151]
  ds_read_b64_tr_b16 a[196:197], v248 offset:4096
  v_mfma_f32_16x16x32_bf16 v[148:151], a[200:203], a[100:103], v[148:151]
  s_waitcnt lgkmcnt(11)
  ds_read_b64_tr_b16 a[198:199], v248 offset:8192
  v_mfma_f32_16x16x32_bf16 v[156:159], a[208:211], a[100:103], v[156:159]
  buffer_load_dwordx4 v134, s[24:27], s50 offen offset:1024 lds
  ds_read_b64_tr_b16 a[200:201], v245 offset:61440
  v_mfma_f32_16x16x32_bf16 v[156:159], a[212:215], a[108:111], v[156:159]
  ds_read_b64_tr_b16 a[202:203], v249 offset:0
  v_mfma_f32_16x16x32_bf16 v[152:155], a[212:215], a[104:107], v[152:155]
  ds_read_b64_tr_b16 a[204:205], v249 offset:4096
  v_mfma_f32_16x16x32_bf16 v[152:155], a[208:211], a[96:99], v[152:155]
  s_waitcnt vmcnt(12) lgkmcnt(11)
  s_barrier
  ds_read_b64_tr_b16 a[206:207], v249 offset:8192
  v_mfma_f32_16x16x32_bf16 v[160:163], a[176:179], a[96:99], v[160:163]
  ds_read_b64_tr_b16 a[208:209], v246 offset:61440
  buffer_store_dwordx4 v[144:147], v0, s[36:39], s61 offen offset:0 sc1
  v_mfma_f32_16x16x32_bf16 v[160:163], a[180:183], a[104:107], v[160:163]
  buffer_store_dwordx4 v[148:151], v0, s[36:39], s61 offen offset:1024 sc1
  ds_read_b64_tr_b16 a[210:211], v250 offset:0
  v_mfma_f32_16x16x32_bf16 v[164:167], a[180:183], a[108:111], v[164:167]
  ds_read_b64_tr_b16 a[212:213], v250 offset:4096
  v_mfma_f32_16x16x32_bf16 v[164:167], a[176:179], a[100:103], v[164:167]
  s_waitcnt lgkmcnt(11)
  ds_read_b64_tr_b16 a[214:215], v250 offset:8192
  v_mfma_f32_16x16x32_bf16 v[172:175], a[184:187], a[100:103], v[172:175]
  ds_read_b64_tr_b16 a[176:177], v247 offset:61440
  buffer_store_dwordx4 v[152:155], v0, s[36:39], s61 offen offset:2048 sc1
  v_mfma_f32_16x16x32_bf16 v[172:175], a[188:191], a[108:111], v[172:175]
  buffer_store_dwordx4 v[156:159], v0, s[36:39], s61 offen offset:3072 sc1
  ds_read_b64_tr_b16 a[178:179], v251 offset:0
  v_mfma_f32_16x16x32_bf16 v[168:171], a[188:191], a[104:107], v[168:171]
  ds_read_b64_tr_b16 a[180:181], v251 offset:4096
  v_mfma_f32_16x16x32_bf16 v[168:171], a[184:187], a[96:99], v[168:171]
  s_waitcnt lgkmcnt(11)
  ds_read_b64_tr_b16 a[182:183], v251 offset:8192
  v_mfma_f32_16x16x32_bf16 v[32:35], a[192:195], a[216:219], v[32:35]
  ds_read_b64_tr_b16 a[184:185], v248 offset:12288
  buffer_store_dwordx4 v[160:163], v0, s[36:39], s62 offen offset:0 sc1
  v_mfma_f32_16x16x32_bf16 v[32:35], a[196:199], a[224:227], v[32:35]
  buffer_store_dwordx4 v[164:167], v0, s[36:39], s62 offen offset:1024 sc1
  ds_read_b64_tr_b16 a[186:187], v248 offset:16384
  v_mfma_f32_16x16x32_bf16 v[36:39], a[196:199], a[228:231], v[36:39]
  ds_read_b64_tr_b16 a[188:189], v248 offset:20480
  v_mfma_f32_16x16x32_bf16 v[36:39], a[192:195], a[220:223], v[36:39]
  s_waitcnt lgkmcnt(11)
  ds_read_b64_tr_b16 a[190:191], v248 offset:24576
  v_mfma_f32_16x16x32_bf16 v[44:47], a[200:203], a[220:223], v[44:47]
  ds_read_b64_tr_b16 a[192:193], v249 offset:12288
  buffer_store_dwordx4 v[168:171], v0, s[36:39], s62 offen offset:2048 sc1
  v_mfma_f32_16x16x32_bf16 v[44:47], a[204:207], a[228:231], v[44:47]
  buffer_store_dwordx4 v[172:175], v0, s[36:39], s62 offen offset:3072 sc1
  ds_read_b64_tr_b16 a[194:195], v249 offset:16384
  v_mfma_f32_16x16x32_bf16 v[40:43], a[204:207], a[224:227], v[40:43]
  ds_read_b64_tr_b16 a[196:197], v249 offset:20480
  v_mfma_f32_16x16x32_bf16 v[40:43], a[200:203], a[216:219], v[40:43]
  s_waitcnt vmcnt(18) lgkmcnt(11)
  s_barrier
  ds_read_b64_tr_b16 a[198:199], v249 offset:24576
  v_mfma_f32_16x16x32_bf16 v[48:51], a[208:211], a[216:219], v[48:51]
  ds_read_b64_tr_b16 a[200:201], v250 offset:12288
  v_mfma_f32_16x16x32_bf16 v[48:51], a[212:215], a[224:227], v[48:51]
  ds_read_b64_tr_b16 a[202:203], v250 offset:16384
  v_mfma_f32_16x16x32_bf16 v[52:55], a[212:215], a[228:231], v[52:55]
  ds_read_b64_tr_b16 a[204:205], v250 offset:20480
  v_mfma_f32_16x16x32_bf16 v[52:55], a[208:211], a[220:223], v[52:55]
  s_waitcnt lgkmcnt(11)
  ds_read_b64_tr_b16 a[206:207], v250 offset:24576
  v_mfma_f32_16x16x32_bf16 v[60:63], a[176:179], a[220:223], v[60:63]
  ds_read_b64_tr_b16 a[208:209], v251 offset:12288
  v_mfma_f32_16x16x32_bf16 v[60:63], a[180:183], a[228:231], v[60:63]
  ds_read_b64_tr_b16 a[210:211], v251 offset:16384
  v_mfma_f32_16x16x32_bf16 v[56:59], a[180:183], a[224:227], v[56:59]
  ds_read_b64_tr_b16 a[212:213], v251 offset:20480
  v_mfma_f32_16x16x32_bf16 v[56:59], a[176:179], a[216:219], v[56:59]
  s_waitcnt lgkmcnt(11)
  ds_read_b64_tr_b16 a[214:215], v251 offset:24576
  v_mfma_f32_16x16x32_bf16 v[32:35], a[184:187], a[0:3], v[32:35]
  ds_read_b64_tr_b16 a[176:177], v240 offset:12288
  v_mfma_f32_16x16x32_bf16 v[32:35], a[188:191], a[8:11], v[32:35]
  ds_read_b64_tr_b16 a[178:179], v240 offset:16384
  buffer_load_dword v139, v132, s[36:39], s77 offen sc1
  v_mfma_f32_16x16x32_bf16 v[36:39], a[188:191], a[12:15], v[36:39]
  ds_read_b64_tr_b16 a[180:181], v240 offset:20480
  v_mfma_f32_16x16x32_bf16 v[36:39], a[184:187], a[4:7], v[36:39]
  s_waitcnt lgkmcnt(11)
  ds_read_b64_tr_b16 a[182:183], v240 offset:24576
  v_mfma_f32_16x16x32_bf16 v[44:47], a[192:195], a[4:7], v[44:47]
  ds_read_b64_tr_b16 a[184:185], v241 offset:12288
  v_mfma_f32_16x16x32_bf16 v[44:47], a[196:199], a[12:15], v[44:47]
  ds_read_b64_tr_b16 a[186:187], v241 offset:16384
  v_mfma_f32_16x16x32_bf16 v[40:43], a[196:199], a[8:11], v[40:43]
  ds_read_b64_tr_b16 a[188:189], v241 offset:20480
  v_mfma_f32_16x16x32_bf16 v[40:43], a[192:195], a[0:3], v[40:43]
  s_waitcnt vmcnt(17) lgkmcnt(11)
  s_barrier
  ds_read_b64_tr_b16 a[190:191], v241 offset:24576
  v_mfma_f32_16x16x32_bf16 v[48:51], a[200:203], a[0:3], v[48:51]
  ds_read_b64_tr_b16 a[192:193], v242 offset:12288
  v_mfma_f32_16x16x32_bf16 v[48:51], a[204:207], a[8:11], v[48:51]
  ds_read_b64_tr_b16 a[194:195], v242 offset:16384
  v_mfma_f32_16x16x32_bf16 v[52:55], a[204:207], a[12:15], v[52:55]
  ds_read_b64_tr_b16 a[196:197], v242 offset:20480
  v_mfma_f32_16x16x32_bf16 v[52:55], a[200:203], a[4:7], v[52:55]
  s_waitcnt lgkmcnt(11)
  ds_read_b64_tr_b16 a[198:199], v242 offset:24576
  v_mfma_f32_16x16x32_bf16 v[60:63], a[208:211], a[4:7], v[60:63]
  ds_read_b64_tr_b16 a[200:201], v243 offset:12288
  v_mfma_f32_16x16x32_bf16 v[60:63], a[212:215], a[12:15], v[60:63]
  ds_read_b64_tr_b16 a[202:203], v243 offset:16384
  v_mfma_f32_16x16x32_bf16 v[56:59], a[212:215], a[8:11], v[56:59]
  ds_read_b64_tr_b16 a[204:205], v243 offset:20480
  v_mfma_f32_16x16x32_bf16 v[56:59], a[208:211], a[0:3], v[56:59]
  s_waitcnt lgkmcnt(11)
  ds_read_b64_tr_b16 a[206:207], v243 offset:24576
  v_mfma_f32_16x16x32_bf16 v[32:35], a[176:179], a[16:19], v[32:35]
  ds_read_b64_tr_b16 a[208:209], v240 offset:28672
  v_mfma_f32_16x16x32_bf16 v[32:35], a[180:183], a[24:27], v[32:35]
  ds_read_b64_tr_b16 a[210:211], v240 offset:32768
  v_mfma_f32_16x16x32_bf16 v[36:39], a[180:183], a[28:31], v[36:39]
  ds_read_b64_tr_b16 a[212:213], v240 offset:36864
  v_mfma_f32_16x16x32_bf16 v[36:39], a[176:179], a[20:23], v[36:39]
  s_waitcnt lgkmcnt(11)
  ds_read_b64_tr_b16 a[214:215], v240 offset:40960
  v_mfma_f32_16x16x32_bf16 v[44:47], a[184:187], a[20:23], v[44:47]
  ds_read_b64_tr_b16 a[176:177], v241 offset:28672
  v_mfma_f32_16x16x32_bf16 v[44:47], a[188:191], a[28:31], v[44:47]
  ds_read_b64_tr_b16 a[178:179], v241 offset:32768
  v_mfma_f32_16x16x32_bf16 v[40:43], a[188:191], a[24:27], v[40:43]
  ds_read_b64_tr_b16 a[180:181], v241 offset:36864
  v_mfma_f32_16x16x32_bf16 v[40:43], a[184:187], a[16:19], v[40:43]
  s_waitcnt vmcnt(15) lgkmcnt(11)
  s_barrier
  ds_read_b64_tr_b16 a[182:183], v241 offset:40960
  v_mfma_f32_16x16x32_bf16 v[48:51], a[192:195], a[16:19], v[48:51]
  ds_read_b64_tr_b16 a[184:185], v242 offset:28672
  v_mfma_f32_16x16x32_bf16 v[48:51], a[196:199], a[24:27], v[48:51]
  ds_read_b64_tr_b16 a[186:187], v242 offset:32768
  v_mfma_f32_16x16x32_bf16 v[52:55], a[196:199], a[28:31], v[52:55]
  ds_read_b64_tr_b16 a[188:189], v242 offset:36864
  v_mfma_f32_16x16x32_bf16 v[52:55], a[192:195], a[20:23], v[52:55]
  s_waitcnt lgkmcnt(11)
  ds_read_b64_tr_b16 a[190:191], v242 offset:40960
  v_mfma_f32_16x16x32_bf16 v[60:63], a[200:203], a[20:23], v[60:63]
  ds_read_b64_tr_b16 a[192:193], v243 offset:28672
  v_mfma_f32_16x16x32_bf16 v[60:63], a[204:207], a[28:31], v[60:63]
  ds_read_b64_tr_b16 a[194:195], v243 offset:32768
  v_mfma_f32_16x16x32_bf16 v[56:59], a[204:207], a[24:27], v[56:59]
  ds_read_b64_tr_b16 a[196:197], v243 offset:36864
  v_mfma_f32_16x16x32_bf16 v[56:59], a[200:203], a[16:19], v[56:59]
  s_waitcnt lgkmcnt(11)
  ds_read_b64_tr_b16 a[198:199], v243 offset:40960
  v_mfma_f32_16x16x32_bf16 v[32:35], a[208:211], a[32:35], v[32:35]
  ds_read_b64_tr_b16 a[200:201], v240 offset:45056
  v_mfma_f32_16x16x32_bf16 v[32:35], a[212:215], a[40:43], v[32:35]
  ds_read_b64_tr_b16 a[202:203], v240 offset:49152
  v_mfma_f32_16x16x32_bf16 v[36:39], a[212:215], a[44:47], v[36:39]
  ds_read_b64_tr_b16 a[204:205], v240 offset:53248
  v_mfma_f32_16x16x32_bf16 v[36:39], a[208:211], a[36:39], v[36:39]
  s_waitcnt lgkmcnt(11)
  ds_read_b64_tr_b16 a[206:207], v240 offset:57344
  v_mfma_f32_16x16x32_bf16 v[44:47], a[176:179], a[36:39], v[44:47]
  ds_read_b64_tr_b16 a[208:209], v241 offset:45056
  v_mfma_f32_16x16x32_bf16 v[44:47], a[180:183], a[44:47], v[44:47]
  ds_read_b64_tr_b16 a[210:211], v241 offset:49152
  v_mfma_f32_16x16x32_bf16 v[40:43], a[180:183], a[40:43], v[40:43]
  ds_read_b64_tr_b16 a[212:213], v241 offset:53248
  v_mfma_f32_16x16x32_bf16 v[40:43], a[176:179], a[32:35], v[40:43]
  s_waitcnt vmcnt(13) lgkmcnt(11)
  s_barrier
  ds_read_b64_tr_b16 a[214:215], v241 offset:57344
  v_mfma_f32_16x16x32_bf16 v[48:51], a[184:187], a[32:35], v[48:51]
  ds_read_b64_tr_b16 a[176:177], v242 offset:45056
  v_mfma_f32_16x16x32_bf16 v[48:51], a[188:191], a[40:43], v[48:51]
  ds_read_b64_tr_b16 a[178:179], v242 offset:49152
  v_mfma_f32_16x16x32_bf16 v[52:55], a[188:191], a[44:47], v[52:55]
  s_waitcnt vmcnt(0)
  ds_read_b64_tr_b16 a[180:181], v242 offset:53248
  s_mov_b64 exec, 1
  buffer_store_dword v9, v0, s[36:39], s76 offen sc1
  s_mov_b64 exec, -1
  v_mfma_f32_16x16x32_bf16 v[52:55], a[184:187], a[36:39], v[52:55]
  s_waitcnt lgkmcnt(11)
  ds_read_b64_tr_b16 a[182:183], v242 offset:57344
  v_readfirstlane_b32 s78, v139
  v_mfma_f32_16x16x32_bf16 v[60:63], a[192:195], a[36:39], v[60:63]
  s_nop 0
  ds_read_b64_tr_b16 a[184:185], v243 offset:45056
  s_cmp_eq_u32 s78, s3
  v_mfma_f32_16x16x32_bf16 v[60:63], a[196:199], a[44:47], v[60:63]
  s_cselect_b32 s89, s63, 1073741824
  ds_read_b64_tr_b16 a[186:187], v243 offset:49152
  s_cselect_b32 s90, s64, 1073741824
  v_mfma_f32_16x16x32_bf16 v[56:59], a[196:199], a[40:43], v[56:59]
  ds_read_b64_tr_b16 a[188:189], v243 offset:53248
  buffer_load_dwordx4 v[96:99], v0, s[36:39], s89 offen offset:0 sc1
  v_mfma_f32_16x16x32_bf16 v[56:59], a[192:195], a[32:35], v[56:59]
  s_waitcnt lgkmcnt(11)
  ds_read_b64_tr_b16 a[190:191], v243 offset:57344
  v_mfma_f32_16x16x32_bf16 v[32:35], a[200:203], a[48:51], v[32:35]
  ds_read_b64_tr_b16 a[192:193], v240 offset:61440
  v_mfma_f32_16x16x32_bf16 v[32:35], a[204:207], a[56:59], v[32:35]
  ds_read_b64_tr_b16 a[194:195], v244 offset:0
  buffer_load_dwordx4 v[100:103], v0, s[36:39], s89 offen offset:1024 sc1
  v_mfma_f32_16x16x32_bf16 v[36:39], a[204:207], a[60:63], v[36:39]
  ds_read_b64_tr_b16 a[196:197], v244 offset:4096
  v_mfma_f32_16x16x32_bf16 v[36:39], a[200:203], a[52:55], v[36:39]
  s_waitcnt lgkmcnt(11)
  ds_read_b64_tr_b16 a[198:199], v244 offset:8192
  v_mfma_f32_16x16x32_bf16 v[44:47], a[208:211], a[52:55], v[44:47]
  ds_read_b64_tr_b16 a[200:201], v241 offset:61440
  buffer_load_dwordx4 v[104:107], v0, s[36:39], s89 offen offset:2048 sc1
  v_mfma_f32_16x16x32_bf16 v[44:47], a[212:215], a[60:63], v[44:47]
  ds_read_b64_tr_b16 a[202:203], v245 offset:0
  v_mfma_f32_16x16x32_bf16 v[40:43], a[212:215], a[56:59], v[40:43]
  ds_read_b64_tr_b16 a[204:205], v245 offset:4096
  v_mfma_f32_16x16x32_bf16 v[40:43], a[208:211], a[48:51], v[40:43]
  s_waitcnt vmcnt(15) lgkmcnt(11)
  s_barrier
  ds_read_b64_tr_b16 a[206:207], v245 offset:8192
  v_mfma_f32_16x16x32_bf16 v[48:51], a[176:179], a[48:51], v[48:51]
  ds_read_b64_tr_b16 a[208:209], v242 offset:61440
  buffer_load_dwordx4 v[108:111], v0, s[36:39], s89 offen offset:3072 sc1
  v_mfma_f32_16x16x32_bf16 v[48:51], a[180:183], a[56:59], v[48:51]
  ds_read_b64_tr_b16 a[210:211], v246 offset:0
  v_mfma_f32_16x16x32_bf16 v[52:55], a[180:183], a[60:63], v[52:55]
  ds_read_b64_tr_b16 a[212:213], v246 offset:4096
  v_mfma_f32_16x16x32_bf16 v[52:55], a[176:179], a[52:55], v[52:55]
  s_waitcnt lgkmcnt(11)
  ds_read_b64_tr_b16 a[214:215], v246 offset:8192
  buffer_load_dwordx4 v[112:115], v0, s[36:39], s90 offen offset:0 sc1
  v_mfma_f32_16x16x32_bf16 v[60:63], a[184:187], a[52:55], v[60:63]
  ds_read_b64_tr_b16 a[176:177], v243 offset:61440
  v_mfma_f32_16x16x32_bf16 v[60:63], a[188:191], a[60:63], v[60:63]
  ds_read_b64_tr_b16 a[178:179], v247 offset:0
  v_mfma_f32_16x16x32_bf16 v[56:59], a[188:191], a[56:59], v[56:59]
  ds_read_b64_tr_b16 a[180:181], v247 offset:4096
  buffer_load_dwordx4 v[116:119], v0, s[36:39], s90 offen offset:1024 sc1
  v_mfma_f32_16x16x32_bf16 v[56:59], a[184:187], a[48:51], v[56:59]
  s_waitcnt lgkmcnt(11)
  ds_read_b64_tr_b16 a[182:183], v247 offset:8192
  v_mfma_f32_16x16x32_bf16 v[32:35], a[192:195], a[64:67], v[32:35]
  ds_read_b64_tr_b16 a[184:185], v244 offset:12288
  v_mfma_f32_16x16x32_bf16 v[32:35], a[196:199], a[72:75], v[32:35]
  ds_read_b64_tr_b16 a[186:187], v244 offset:16384
  buffer_load_dwordx4 v[120:123], v0, s[36:39], s90 offen offset:2048 sc1
  v_mfma_f32_16x16x32_bf16 v[36:39], a[196:199], a[76:79], v[36:39]
  ds_read_b64_tr_b16 a[188:189], v244 offset:20480
  v_mfma_f32_16x16x32_bf16 v[36:39], a[192:195], a[68:71], v[36:39]
  s_waitcnt lgkmcnt(11)
  ds_read_b64_tr_b16 a[190:191], v244 offset:24576
  v_mfma_f32_16x16x32_bf16 v[44:47], a[200:203], a[68:71], v[44:47]
  ds_read_b64_tr_b16 a[192:193], v245 offset:12288
  buffer_load_dwordx4 v[124:127], v0, s[36:39], s90 offen offset:3072 sc1
  v_mfma_f32_16x16x32_bf16 v[44:47], a[204:207], a[76:79], v[44:47]
  ds_read_b64_tr_b16 a[194:195], v245 offset:16384
  v_mfma_f32_16x16x32_bf16 v[40:43], a[204:207], a[72:75], v[40:43]
  ds_read_b64_tr_b16 a[196:197], v245 offset:20480
  v_mfma_f32_16x16x32_bf16 v[40:43], a[200:203], a[64:67], v[40:43]
  s_waitcnt vmcnt(18) lgkmcnt(11)
  s_barrier
  ds_read_b64_tr_b16 a[198:199], v245 offset:24576
  v_mfma_f32_16x16x32_bf16 v[48:51], a[208:211], a[64:67], v[48:51]
  ds_read_b64_tr_b16 a[200:201], v246 offset:12288
  v_mfma_f32_16x16x32_bf16 v[48:51], a[212:215], a[72:75], v[48:51]
  ds_read_b64_tr_b16 a[202:203], v246 offset:16384
  v_mfma_f32_16x16x32_bf16 v[52:55], a[212:215], a[76:79], v[52:55]
  ds_read_b64_tr_b16 a[204:205], v246 offset:20480
  v_mfma_f32_16x16x32_bf16 v[52:55], a[208:211], a[68:71], v[52:55]
  s_waitcnt lgkmcnt(11)
  ds_read_b64_tr_b16 a[206:207], v246 offset:24576
  v_mfma_f32_16x16x32_bf16 v[60:63], a[176:179], a[68:71], v[60:63]
  ds_read_b64_tr_b16 a[208:209], v247 offset:12288
  v_mfma_f32_16x16x32_bf16 v[60:63], a[180:183], a[76:79], v[60:63]
  ds_read_b64_tr_b16 a[210:211], v247 offset:16384
  v_mfma_f32_16x16x32_bf16 v[56:59], a[180:183], a[72:75], v[56:59]
  ds_read_b64_tr_b16 a[212:213], v247 offset:20480
  v_mfma_f32_16x16x32_bf16 v[56:59], a[176:179], a[64:67], v[56:59]
  s_waitcnt lgkmcnt(11)
  ds_read_b64_tr_b16 a[214:215], v247 offset:24576
  v_mfma_f32_16x16x32_bf16 v[32:35], a[184:187], a[80:83], v[32:35]
  ds_read_b64_tr_b16 a[176:177], v244 offset:28672
  v_mfma_f32_16x16x32_bf16 v[32:35], a[188:191], a[88:91], v[32:35]
  ds_read_b64_tr_b16 a[178:179], v244 offset:32768
  v_mfma_f32_16x16x32_bf16 v[36:39], a[188:191], a[92:95], v[36:39]
  ds_read_b64_tr_b16 a[180:181], v244 offset:36864
  v_mfma_f32_16x16x32_bf16 v[36:39], a[184:187], a[84:87], v[36:39]
  s_waitcnt lgkmcnt(11)
  ds_read_b64_tr_b16 a[182:183], v244 offset:40960
  v_mfma_f32_16x16x32_bf16 v[44:47], a[192:195], a[84:87], v[44:47]
  ds_read_b64_tr_b16 a[184:185], v245 offset:28672
  v_mfma_f32_16x16x32_bf16 v[44:47], a[196:199], a[92:95], v[44:47]
  ds_read_b64_tr_b16 a[186:187], v245 offset:32768
  v_mfma_f32_16x16x32_bf16 v[40:43], a[196:199], a[88:91], v[40:43]
  ds_read_b64_tr_b16 a[188:189], v245 offset:36864
  v_mfma_f32_16x16x32_bf16 v[40:43], a[192:195], a[80:83], v[40:43]
  s_waitcnt lgkmcnt(11)
  ds_read_b64_tr_b16 a[190:191], v245 offset:40960
  v_mfma_f32_16x16x32_bf16 v[48:51], a[200:203], a[80:83], v[48:51]
  ds_read_b64_tr_b16 a[192:193], v246 offset:28672
  v_mfma_f32_16x16x32_bf16 v[48:51], a[204:207], a[88:91], v[48:51]
  ds_read_b64_tr_b16 a[194:195], v246 offset:32768
  v_mfma_f32_16x16x32_bf16 v[52:55], a[204:207], a[92:95], v[52:55]
  ds_read_b64_tr_b16 a[196:197], v246 offset:36864
  v_mfma_f32_16x16x32_bf16 v[52:55], a[200:203], a[84:87], v[52:55]
  s_waitcnt lgkmcnt(11)
  ds_read_b64_tr_b16 a[198:199], v246 offset:40960
  v_mfma_f32_16x16x32_bf16 v[60:63], a[208:211], a[84:87], v[60:63]
  ds_read_b64_tr_b16 a[200:201], v247 offset:28672
  v_mfma_f32_16x16x32_bf16 v[60:63], a[212:215], a[92:95], v[60:63]
  ds_read_b64_tr_b16 a[202:203], v247 offset:32768
  v_mfma_f32_16x16x32_bf16 v[56:59], a[212:215], a[88:91], v[56:59]
  ds_read_b64_tr_b16 a[204:205], v247 offset:36864
  v_mfma_f32_16x16x32_bf16 v[56:59], a[208:211], a[80:83], v[56:59]
  s_waitcnt lgkmcnt(11)
  ds_read_b64_tr_b16 a[206:207], v247 offset:40960
  v_mfma_f32_16x16x32_bf16 v[32:35], a[176:179], a[96:99], v[32:35]
  buffer_load_dword v139, v132, s[36:39], s77 offen sc1
  v_mfma_f32_16x16x32_bf16 v[32:35], a[180:183], a[104:107], v[32:35]
  v_mfma_f32_16x16x32_bf16 v[36:39], a[180:183], a[108:111], v[36:39]
  v_mfma_f32_16x16x32_bf16 v[36:39], a[176:179], a[100:103], v[36:39]
  s_waitcnt lgkmcnt(8)
  v_mfma_f32_16x16x32_bf16 v[44:47], a[184:187], a[100:103], v[44:47]
  v_mfma_f32_16x16x32_bf16 v[44:47], a[188:191], a[108:111], v[44:47]
  v_mfma_f32_16x16x32_bf16 v[40:43], a[188:191], a[104:107], v[40:43]
  v_mfma_f32_16x16x32_bf16 v[40:43], a[184:187], a[96:99], v[40:43]
  s_waitcnt lgkmcnt(4)
  v_mfma_f32_16x16x32_bf16 v[48:51], a[192:195], a[96:99], v[48:51]
  v_mfma_f32_16x16x32_bf16 v[48:51], a[196:199], a[104:107], v[48:51]
  v_mfma_f32_16x16x32_bf16 v[52:55], a[196:199], a[108:111], v[52:55]
  v_mfma_f32_16x16x32_bf16 v[52:55], a[192:195], a[100:103], v[52:55]
  s_waitcnt lgkmcnt(0)
  v_mfma_f32_16x16x32_bf16 v[60:63], a[200:203], a[100:103], v[60:63]
  v_mfma_f32_16x16x32_bf16 v[60:63], a[204:207], a[108:111], v[60:63]
  v_mfma_f32_16x16x32_bf16 v[56:59], a[204:207], a[104:107], v[56:59]
  v_mfma_f32_16x16x32_bf16 v[56:59], a[200:203], a[96:99], v[56:59]
  s_cmp_eq_u32 s78, s3
  s_cbranch_scc0 CKXs
CKXx:
  v_pk_fma_f32 v[64:65], v[176:177], v[32:33], v[64:65]
  v_pk_fma_f32 v[66:67], v[178:179], v[34:35], v[66:67]
  v_pk_fma_f32 v[80:81], v[176:177], v[36:37], v[80:81]
  v_pk_fma_f32 v[82:83], v[178:179], v[38:39], v[82:83]
  v_pk_fma_f32 v[68:69], v[180:181], v[40:41], v[68:69]
  v_pk_fma_f32 v[70:71], v[182:183], v[42:43], v[70:71]
  v_pk_fma_f32 v[84:85], v[180:181], v[44:45], v[84:85]
  v_pk_fma_f32 v[86:87], v[182:183], v[46:47], v[86:87]
  v_pk_fma_f32 v[72:73], v[184:185], v[48:49], v[72:73]
  v_pk_fma_f32 v[74:75], v[186:187], v[50:51], v[74:75]
  v_pk_fma_f32 v[88:89], v[184:185], v[52:53], v[88:89]
  v_pk_fma_f32 v[90:91], v[186:187], v[54:55], v[90:91]
  v_pk_fma_f32 v[76:77], v[188:189], v[56:57], v[76:77]
  v_pk_fma_f32 v[78:79], v[190:191], v[58:59], v[78:79]
  v_pk_fma_f32 v[92:93], v[188:189], v[60:61], v[92:93]
  v_pk_fma_f32 v[94:95], v[190:191], v[62:63], v[94:95]
  s_waitcnt vmcnt(8)
  v_pk_fma_f32 v[64:65], v[176:177], v[96:97], v[64:65]
  v_pk_fma_f32 v[66:67], v[178:179], v[98:99], v[66:67]
  v_cvt_pk_bf16_f32 v192, v64, v65
  v_cvt_pk_bf16_f32 v193, v66, v67
  ds_write_b64 v140, v[192:193] offset:0
  s_waitcnt vmcnt(7)
  v_pk_fma_f32 v[80:81], v[176:177], v[100:101], v[80:81]
  v_pk_fma_f32 v[82:83], v[178:179], v[102:103], v[82:83]
  v_cvt_pk_bf16_f32 v200, v80, v81
  v_cvt_pk_bf16_f32 v201, v82, v83
  ds_write_b64 v140, v[200:201] offset:2048
  s_waitcnt vmcnt(6)
  v_pk_fma_f32 v[68:69], v[180:181], v[104:105], v[68:69]
  v_pk_fma_f32 v[70:71], v[182:183], v[106:107], v[70:71]
  v_cvt_pk_bf16_f32 v194, v68, v69
  v_cvt_pk_bf16_f32 v195, v70, v71
  ds_write_b64 v141, v[194:195] offset:0
  s_waitcnt vmcnt(5)
  v_pk_fma_f32 v[84:85], v[180:181], v[108:109], v[84:85]
  v_pk_fma_f32 v[86:87], v[182:183], v[110:111], v[86:87]
  v_cvt_pk_bf16_f32 v202, v84, v85
  v_cvt_pk_bf16_f32 v203, v86, v87
Hb1_1:
  s_cbranch_execz Rb
  ds_write_b64 v141, v[202:203] offset:2048
  s_waitcnt vmcnt(4)
  v_pk_fma_f32 v[72:73], v[184:185], v[112:113], v[72:73]
  v_pk_fma_f32 v[74:75], v[186:187], v[114:115], v[74:75]
  v_cvt_pk_bf16_f32 v196, v72, v73
  v_cvt_pk_bf16_f32 v197, v74, v75
  ds_write_b64 v142, v[196:197] offset:0
  s_waitcnt vmcnt(3)
  v_pk_fma_f32 v[88:89], v[184:185], v[116:117], v[88:89]
  v_pk_fma_f32 v[90:91], v[186:187], v[118:119], v[90:91]
  v_cvt_pk_bf16_f32 v204, v88, v89
  v_cvt_pk_bf16_f32 v205, v90, v91
  ds_write_b64 v142, v[204:205] offset:2048
  s_waitcnt vmcnt(2)
  v_pk_fma_f32 v[76:77], v[188:189], v[120:121], v[76:77]
  v_pk_fma_f32 v[78:79], v[190:191], v[122:123], v[78:79]
  v_cvt_pk_bf16_f32 v198, v76, v77
  v_cvt_pk_bf16_f32 v199, v78, v79
  ds_write_b64 v143, v[198:199] offset:0
  s_waitcnt vmcnt(1)
  v_pk_fma_f32 v[92:93], v[188:189], v[124:125], v[92:93]
  v_pk_fma_f32 v[94:95], v[190:191], v[126:127], v[94:95]
  v_cvt_pk_bf16_f32 v206, v92, v93
  v_cvt_pk_bf16_f32 v207, v94, v95
  ds_write_b64 v143, v[206:207] offset:2048
  ds_read_b128 v[64:67], v254 offset:0
  ds_read_b128 v[68:71], v254 offset:1024
  ds_read_b128 v[72:75], v254 offset:2048
  ds_read_b128 v[76:79], v254 offset:3072
  s_waitcnt lgkmcnt(3)
  buffer_store_dwordx4 v[64:67], v252, s[32:35], s55 offen
  s_waitcnt lgkmcnt(2)
  buffer_store_dwordx4 v[68:71], v253, s[32:35], s55 offen
  s_waitcnt lgkmcnt(1)
  buffer_store_dwordx4 v[72:75], v252, s[32:35], s49 offen
  s_waitcnt lgkmcnt(0)
  buffer_store_dwordx4 v[76:79], v253, s[32:35], s49 offen
XEND:
  s_endpgm
CK4s:
  s_mov_b32 s46, 30000
CK4:
  s_mov_b32 s49, 0
  buffer_load_dwordx4 v[156:159], v249, s[36:39], s49 offen sc1
  s_mov_b32 s49, 24576
  buffer_load_dwordx4 v[160:163], v249, s[36:39], s49 offen sc1
  s_mov_b32 s49, 49152
  buffer_load_dwordx4 v[164:167], v249, s[36:39], s49 offen sc1
  s_mov_b32 s49, 73728
  buffer_load_dwordx4 v[168:171], v249, s[36:39], s49 offen sc1
  s_sub_u32 s46, s46, 1
  s_waitcnt vmcnt(0)
  v_max_u32 v15, v156, v157
  v_max3_u32 v15, v15, v158, v159
  v_max3_u32 v15, v15, v160, v161
  v_max3_u32 v15, v15, v162, v163
  v_max3_u32 v15, v15, v164, v165
  v_max3_u32 v15, v15, v166, v167
  v_max3_u32 v15, v15, v168, v169
  v_max3_u32 v15, v15, v170, v171
  s_cmp_eq_u32 s46, 0
  s_cbranch_scc1 CK4x
  v_cmp_eq_u32 vcc, -1, v15
  s_nop 4
  s_cbranch_vccnz CK4
  s_branch CK4x
CKSs:
  s_mov_b32 s46, 30000
  v_lshlrev_b32 v14, 3, v0
CKS:
  s_mov_b32 s48, 5242880
  buffer_load_dword v16, v14, s[36:39], s48 offen sc1
  s_mov_b32 s48, 5251072
  buffer_load_dword v17, v14, s[36:39], s48 offen sc1
  s_mov_b32 s48, 5259264
  buffer_load_dword v18, v14, s[36:39], s48 offen sc1
  s_mov_b32 s48, 5267456
  buffer_load_dword v19, v14, s[36:39], s48 offen sc1
  s_sub_u32 s46, s46, 1
  s_cmp_eq_u32 s46, 0
  s_waitcnt vmcnt(0)
  s_cbranch_scc1 CKSy
  v_xor_b32 v15, s3, v16
  v_bitop3_b32 v15, v15, v17, s3 bitop3:0xf6
  v_bitop3_b32 v15, v15, v18, s3 bitop3:0xf6
  v_bitop3_b32 v15, v15, v19, s3 bitop3:0xf6
  v_cmp_ne_u32 vcc, 0, v15
  s_nop 4
  s_cbranch_vccnz CKS
CKSy:
  s_mov_b32 s48, 5505024
  s_mov_b64 exec, 1
  buffer_store_dword v12, v0, s[36:39], s48 offen sc1
  s_mov_b64 exec, -1
  s_branch CKSx
CK6s:
  s_mov_b32 s46, 60000
CK6:
  buffer_load_dword v29, v30, s[36:39], s68 offen sc1
  s_sub_u32 s46, s46, 1
  s_cmp_eq_u32 s46, 0
  s_waitcnt vmcnt(0)
  s_cbranch_scc1 CK6y
  v_cmp_ne_u32 vcc, s3, v29
  s_nop 4
  s_cbranch_vccnz CK6
CK6y:
  s_mov_b64 exec, -1
  s_branch CK6x
CK7s:
  s_mov_b32 s46, 30000
CK7:
  buffer_load_dwordx4 a[208:211], v25, s[36:39], s77 offen offset:0 sc1
  buffer_load_dwordx4 a[212:215], v25, s[36:39], s77 offen offset:2048 sc1
  buffer_load_dwordx4 a[216:219], v25, s[36:39], s76 offen offset:0 sc1
  buffer_load_dwordx4 a[220:223], v25, s[36:39], s76 offen offset:2048 sc1
  s_sub_u32 s46, s46, 1
  s_waitcnt vmcnt(0)
  v_accvgpr_read_b32 v26, a208
  v_accvgpr_read_b32 v27, a209
  v_accvgpr_read_b32 v28, a210
  v_accvgpr_read_b32 v29, a211
  v_max_u32 v31, v26, v27
  v_max3_u32 v31, v31, v28, v29
  v_accvgpr_read_b32 v22, a212
  v_accvgpr_read_b32 v23, a213
  v_max3_u32 v31, v31, v22, v23
  v_add_f32 v26, v26, v22
  v_add_f32 v27, v27, v23
  v_accvgpr_read_b32 v22, a214
  v_accvgpr_read_b32 v23, a215
  v_max3_u32 v31, v31, v22, v23
  v_add_f32 v28, v28, v22
  v_add_f32 v29, v29, v23
  v_accvgpr_read_b32 v22, a216
  v_accvgpr_read_b32 v23, a217
  v_max3_u32 v31, v31, v22, v23
  v_add_f32 v26, v26, v22
  v_add_f32 v27, v27, v23
  v_accvgpr_read_b32 v22, a218
  v_accvgpr_read_b32 v23, a219
  v_max3_u32 v31, v31, v22, v23
  v_add_f32 v28, v28, v22
  v_add_f32 v29, v29, v23
  v_accvgpr_read_b32 v22, a220
  v_accvgpr_read_b32 v23, a221
  v_max3_u32 v31, v31, v22, v23
  v_add_f32 v26, v26, v22
  v_add_f32 v27, v27, v23
  v_accvgpr_read_b32 v22, a222
  v_accvgpr_read_b32 v23, a223
  v_max3_u32 v31, v31, v22, v23
  v_add_f32 v28, v28, v22
  v_add_f32 v29, v29, v23
  s_cmp_eq_u32 s46, 0
  s_cbranch_scc1 CK7x
  v_cmp_eq_u32 vcc, -1, v31
  s_nop 4
  s_cbranch_vccnz CK7
  s_branch CK7x
CK8s:
  s_mov_b32 s46, 60000
CK8:
  buffer_load_dword v139, v138, s[36:39], s91 offen sc1
  s_sub_u32 s46, s46, 1
  s_cmp_eq_u32 s46, 0
  s_waitcnt vmcnt(0)
  s_cbranch_scc1 CK8y
  v_cmp_ne_u32 vcc, s3, v139
  s_nop 4
  s_cbranch_vccnz CK8
CK8y:
  s_mov_b64 exec, -1
  s_branch CK8x
CK9s:
  s_mov_b32 s46, 60000
CK9:
  buffer_load_dword v139, v138, s[36:39], s91 offen sc1
  s_sub_u32 s46, s46, 1
  s_cmp_eq_u32 s46, 0
  s_waitcnt vmcnt(0)
  s_cbranch_scc1 CK9y
  v_cmp_ne_u32 vcc, s3, v139
  s_nop 4
  s_cbranch_vccnz CK9
CK9y:
  s_mov_b64 exec, -1
  s_branch CK9x
CK10s:
  s_mov_b32 s46, 60000
CK10:
  buffer_load_dword v139, v138, s[36:39], s91 offen sc1
  s_sub_u32 s46, s46, 1
  s_cmp_eq_u32 s46, 0
  s_waitcnt vmcnt(0)
  s_cbranch_scc1 CK10y
  v_cmp_ne_u32 vcc, s3, v139
  s_nop 4
  s_cbranch_vccnz CK10
CK10y:
  s_mov_b64 exec, -1
  s_branch CK10x
CKXs:
  s_mov_b32 s46, 60000
  s_branch CKXw
CKX:
  buffer_load_dword v139, v132, s[36:39], s77 offen sc1
CKXw:
  s_sub_u32 s46, s46, 1
  s_cmp_eq_u32 s46, 0
  s_waitcnt vmcnt(0)
  s_cbranch_scc1 CKXy
  v_cmp_ne_u32 vcc, s3, v139
  s_nop 4
  s_cbranch_vccnz CKX
CKXy:
  buffer_load_dwordx4 v[96:99], v0, s[36:39], s63 offen offset:0 sc1
  buffer_load_dwordx4 v[100:103], v0, s[36:39], s63 offen offset:1024 sc1
  buffer_load_dwordx4 v[104:107], v0, s[36:39], s63 offen offset:2048 sc1
  buffer_load_dwordx4 v[108:111], v0, s[36:39], s63 offen offset:3072 sc1
  buffer_load_dwordx4 v[112:115], v0, s[36:39], s64 offen offset:0 sc1
  buffer_load_dwordx4 v[116:119], v0, s[36:39], s64 offen offset:1024 sc1
  buffer_load_dwordx4 v[120:123], v0, s[36:39], s64 offen offset:2048 sc1
  buffer_load_dwordx4 v[124:127], v0, s[36:39], s64 offen offset:3072 sc1
  buffer_load_dword v139, v132, s[36:39], s77 offen sc1
  s_branch CKXx
code_end:
.fill 2048, 4, 0xBF800000
.section .rodata,"a"
.p2align 6
.amdhsa_kernel adaLN_cond__sliding_local_dilated__swiglu_ffn__prompt_kernel
  .amdhsa_next_free_vgpr 512
  .amdhsa_next_free_sgpr 102
  .amdhsa_accum_offset 256
  .amdhsa_group_segment_fixed_size 0
  .amdhsa_kernarg_size 96
  .amdhsa_user_sgpr_count 2
  .amdhsa_user_sgpr_kernarg_segment_ptr 1
  .amdhsa_system_sgpr_workgroup_id_x 1
  .amdhsa_float_denorm_mode_32 3
.end_amdhsa_kernel
```

```asm
; @launch grid=(256,1,1) block=(256,1,1) lds=163840
.amdgcn_target "amdgcn-amd-amdhsa--gfx950"
.text
.globl adaLN_cond__sliding_local_dilated__swiglu_ffn__prompt_kernel
.type adaLN_cond__sliding_local_dilated__swiglu_ffn__prompt_kernel,@function
.p2align 12
.p2align 8
adaLN_cond__sliding_local_dilated__swiglu_ffn__prompt_kernel:
  s_cmp_ge_u32 s2, 256
  s_cbranch_scc1 XEND
  s_load_dwordx2 s[36:37], s[0:1], 88
  s_load_dwordx2 s[40:41], s[0:1], 56
  s_load_dwordx2 s[28:29], s[0:1], 64
  s_load_dwordx2 s[4:5], s[0:1], 0
  s_load_dwordx2 s[8:9], s[0:1], 8
  s_load_dwordx2 s[12:13], s[0:1], 16
  s_load_dwordx2 s[16:17], s[0:1], 32
  s_load_dwordx2 s[20:21], s[0:1], 40
  s_load_dwordx2 s[24:25], s[0:1], 48
  s_load_dwordx2 s[32:33], s[0:1], 72
  v_lshrrev_b32 v1, 6, v0
  v_and_b32 v10, 63, v0
  v_readfirstlane_b32 s44, v1
  v_lshlrev_b32 v0, 4, v10
  s_mov_b32 s38, 50331648
  s_mov_b32 s39, 0x20000
  s_mov_b32 s42, 2048
  s_mov_b32 s43, 0x20000
  s_mov_b32 s30, 12582912
  s_mov_b32 s31, 0x20000
  s_mov_b32 s6, 4194304
  s_mov_b32 s7, 0x20000
  s_mov_b32 s10, 6291456
  s_mov_b32 s11, 0x20000
  s_mov_b32 s14, 2097152
  s_mov_b32 s15, 0x20000
  s_mov_b32 s18, 7340032
  s_mov_b32 s19, 0x20000
  s_mov_b32 s22, 7340032
  s_mov_b32 s23, 0x20000
  s_mov_b32 s26, 7340032
  s_mov_b32 s27, 0x20000
  s_mov_b32 s34, 4194304
  s_mov_b32 s35, 0x20000
  s_and_b32 s48, s2, 3
  s_lshl2_add_u32 s48, s48, s44
  s_lshl_b32 s48, s48, 6
  v_and_b32 v176, 0x38, v10
  v_add_u32 v176, s48, v176
  v_lshlrev_b32 v177, 1, v176
  v_mul_u32_u24 v176, 12288, v176
  v_and_b32 v12, 7, v10
  v_lshl_add_u32 v176, v12, 4, v176
  v_mov_b32 v178, 0
  s_bfe_u32 s51, s2, 0x40003
  s_and_b32 s49, s2, 4
  s_lshl2_add_u32 s51, s49, s51
  s_and_b32 s49, s2, 128
  s_lshl2_add_u32 s51, s51, s49
  s_lshl_b32 s51, s51, 5
  s_mov_b32 s49, s51
  s_mov_b32 s50, 5505024
  v_lshrrev_b32 v13, 3, v10
  v_lshlrev_b32 v132, 11, v12
  v_lshl_add_u32 v132, v13, 4, v132
  s_and_b32 s48, s2, 127
  s_lshl_b32 s48, s48, 6
  s_add_u32 s48, s48, s44
  s_lshl_b32 s48, s48, 9
  s_cmp_lt_u32 s2, 128
  s_waitcnt lgkmcnt(0)
  buffer_load_dwordx4 v[188:191], v177, s[40:43], 0 offen
  s_cbranch_scc0 F_x
  buffer_load_dwordx4 v[136:139], v176, s[28:31], s49 offen nt
  s_add_u32 s49, s49, 12288
  buffer_load_dwordx4 v[140:143], v176, s[28:31], s49 offen nt
  s_add_u32 s49, s49, 12288
  buffer_load_dwordx4 v[144:147], v176, s[28:31], s49 offen nt
  s_add_u32 s49, s49, 12288
  buffer_load_dwordx4 v[148:151], v176, s[28:31], s49 offen nt
  s_add_u32 s49, s49, 12288
  buffer_load_dwordx4 v[152:155], v176, s[28:31], s49 offen nt
  s_add_u32 s49, s49, 12288
  buffer_load_dwordx4 v[156:159], v176, s[28:31], s49 offen nt
  s_add_u32 s49, s49, 12288
  buffer_load_dwordx4 v[160:163], v176, s[28:31], s49 offen nt
  s_add_u32 s49, s49, 12288
  buffer_load_dwordx4 v[164:167], v176, s[28:31], s49 offen nt
F_x:
  buffer_load_dword v195, v178, s[36:39], s50 offen sc1
  s_mov_b32 s50, s48
  s_getpc_b64 s[92:93]
PC0:
  s_sub_u32 s92, s92, PC0-adaLN_cond__sliding_local_dilated__swiglu_ffn__prompt_kernel
  s_subb_u32 s93, s93, 0
  s_cmp_lt_u32 s2, 128
  s_cbranch_scc1 F_ct
  s_bfe_u32 s48, s2, 0x30004
  s_and_b32 s49, s2, 3
  s_lshl3_add_u32 s48, s49, s48
  s_mul_i32 s48, s48, 393216
  s_and_b32 s49, s2, 4
  s_lshl_b32 s49, s49, 9
  s_add_u32 s48, s48, s49
  s_and_b32 s49, s2, 8
  s_lshl_b32 s49, s49, 7
  s_add_u32 s48, s48, s49
  s_cmp_lt_u32 s44, 1
  s_cselect_b32 s48, s48, 1073741824
  v_and_b32 v19, 31, v10
  v_mul_u32_u24 v19, 12288, v19
  buffer_load_dword a252, v19, s[28:31], s48 offen offset:384
  s_bfe_u32 s48, s2, 0x40003
  s_cmp_lt_u32 s48, (code_end-adaLN_cond__sliding_local_dilated__swiglu_ffn__prompt_kernel)/8192+1
  s_cselect_b32 s49, 3, 4
  s_lshl_b32 s48, s48, 13
  v_lshl_add_u32 v19, v0, 3, s48
  s_cmp_eq_u32 s44, s49
  s_cselect_b32 s49, -1, 0
  v_and_b32 v19, s49, v19
  global_load_dword a252, v19, s[92:93]
  s_bfe_u32 s48, s2, 0x20003
  s_mul_i32 s48, s48, 24576
  s_lshr_b32 s49, s2, 5
  s_lshl3_add_u32 s49, s44, s49
  s_cmp_eq_u32 s49, 15
  s_cselect_b32 s48, s48, 1073741824
  v_lshlrev_b32 v19, 3, v0
  buffer_load_dword a252, v19, s[36:39], s48 offen sc1
F_ct:
  s_and_b32 s48, s2, 7
  s_lshr_b32 s49, s2, 3
  s_and_b32 s58, s48, 3
  s_lshl_b32 s58, s58, 2
  s_and_b32 s57, s49, 3
  s_add_u32 s58, s58, s57
  s_lshr_b32 s57, s48, 2
  s_lshl_b32 s57, s57, 3
  s_lshr_b32 s49, s49, 2
  s_add_u32 s57, s57, s49
  s_lshr_b32 s59, s44, 1
  s_and_b32 s60, s44, 1
  s_mul_i32 s63, s44, 3072
  s_lshl_b32 s64, s44, 11
  s_lshl_b32 s65, s44, 8
  v_bfe_u32 v14, v10, 4, 2
  v_bfe_u32 v15, v10, 1, 2
  v_xor_b32 v14, v14, v15
  v_lshlrev_b32 v14, 5, v14
  v_and_b32 v15, 1, v10
  v_lshl_add_u32 v213, v15, 4, v14
  s_lshl_b32 s48, s58, 7
  s_mul_i32 s49, s44, 49152
  s_add_u32 s48, s48, s49
  v_mul_u32_u24 v14, 6144, v13
  v_add3_u32 v202, v14, v213, s48
  v_add_u32 v203, 195584, v202
  v_add_u32 v204, 391168, v202
  v_bfe_u32 v14, v10, 3, 2
  v_lshlrev_b32 v14, 5, v14
  v_and_b32 v15, 3, v10
  v_lshl_add_u32 v214, v15, 3, v14
  v_bfe_u32 v14, v10, 2, 3
  v_lshrrev_b32 v15, 5, v10
  v_mul_u32_u24 v15, 24, v15
  v_add_lshl_u32 v14, v14, v15, 7
  s_lshl_b32 s48, s60, 1
  s_add_u32 s48, s48, s59
  s_lshl_b32 s48, s48, 5
  v_xor_b32 v15, s48, v214
  v_add_u32 v196, v14, v15
  v_xor_b32 v197, 32, v196
  v_add_u32 v198, 64512, v196
  v_add_u32 v199, 64512, v197
  v_add_u32 v200, 129024, v196
  v_add_u32 v201, 129024, v197
  s_lshl_b32 s48, s57, 2
  s_add_u32 s49, s48, s44
  s_lshl_b32 s49, s49, 16
  s_add_u32 s49, s49, 1048576
  v_add_u32 v205, s49, v0
  s_max_u32 s48, s48, 1
  s_lshl_b32 s48, s48, 16
  s_add_u32 s48, s48, 984064
  s_add_u32 s48, s48, s65
  v_lshl_add_u32 v206, v10, 2, s48
  s_lshl_b32 s48, s59, 12
  v_add_u32 v210, 0, v0
  v_add_u32 v207, s48, v210
  v_add_u32 v211, 64512, v0
  v_add_u32 v208, s48, v211
  v_add_u32 v212, 129024, v0
  v_add_u32 v209, s48, v212
  s_lshl3_add_u32 s48, s57, 127
  v_min_u32 v215, 8, v10
  v_add_u32 v215, s48, v215
  v_max_u32 v215, 0x80, v215
  v_lshlrev_b32 v215, 7, v215
  v_lshlrev_b32 v18, 5, v12
  v_lshrrev_b32 v19, 4, v10
  v_lshl_add_u32 v18, v19, 3, v18
  s_add_u32 s48, s65, 162816
  v_add_u32 v177, s48, v18
  v_lshlrev_b32 v178, 2, v10
  s_and_b32 s49, s2, 3
  s_mul_i32 s56, s49, 24576
  s_lshl1_add_u32 s56, s51, s56
  s_add_u32 s51, s51, 4096
  s_cmp_lt_u32 s2, 128
  s_cbranch_scc1 F_cw
  s_waitcnt vmcnt(4)
F_cw:
  s_waitcnt vmcnt(9)
  v_lshlrev_b32 v168, 16, v188
  v_and_b32 v169, 0xffff0000, v188
  v_lshlrev_b32 v170, 16, v189
  v_and_b32 v171, 0xffff0000, v189
  v_lshlrev_b32 v172, 16, v190
  v_and_b32 v173, 0xffff0000, v190
  v_lshlrev_b32 v174, 16, v191
  v_and_b32 v175, 0xffff0000, v191
  v_mul_f32 v180, 0xbfb8aa3b, v168
  v_mul_f32 v181, 0xbfb8aa3b, v169
  v_mul_f32 v182, 0xbfb8aa3b, v170
  v_mul_f32 v183, 0xbfb8aa3b, v171
  v_mul_f32 v184, 0xbfb8aa3b, v172
  v_mul_f32 v185, 0xbfb8aa3b, v173
  v_mul_f32 v186, 0xbfb8aa3b, v174
  v_mul_f32 v187, 0xbfb8aa3b, v175
  v_exp_f32 v180, v180
  v_exp_f32 v181, v181
  v_exp_f32 v182, v182
  v_exp_f32 v183, v183
  v_exp_f32 v184, v184
  v_exp_f32 v185, v185
  v_exp_f32 v186, v186
  v_exp_f32 v187, v187
  v_add_f32 v180, 1.0, v180
  v_add_f32 v181, 1.0, v181
  v_add_f32 v182, 1.0, v182
  v_add_f32 v183, 1.0, v183
  v_add_f32 v184, 1.0, v184
  v_add_f32 v185, 1.0, v185
  v_add_f32 v186, 1.0, v186
  v_add_f32 v187, 1.0, v187
  v_rcp_f32 v180, v180
  v_rcp_f32 v181, v181
  v_rcp_f32 v182, v182
  v_rcp_f32 v183, v183
  v_rcp_f32 v184, v184
  v_rcp_f32 v185, v185
  v_rcp_f32 v186, v186
  v_rcp_f32 v187, v187
  v_mul_f32 v168, v168, v180
  v_mul_f32 v169, v169, v181
  v_mul_f32 v170, v170, v182
  v_mul_f32 v171, v171, v183
  v_mul_f32 v172, v172, v184
  v_mul_f32 v173, v173, v185
  v_mul_f32 v174, v174, v186
  v_mul_f32 v175, v175, v187
  v_cvt_pk_bf16_f32 v192, v168, v169
  v_lshlrev_b32 v168, 16, v192
  v_and_b32 v169, 0xffff0000, v192
  v_cvt_pk_bf16_f32 v192, v170, v171
  v_lshlrev_b32 v170, 16, v192
  v_and_b32 v171, 0xffff0000, v192
  v_cvt_pk_bf16_f32 v192, v172, v173
  v_lshlrev_b32 v172, 16, v192
  v_and_b32 v173, 0xffff0000, v192
  v_cvt_pk_bf16_f32 v192, v174, v175
  v_lshlrev_b32 v174, 16, v192
  v_and_b32 v175, 0xffff0000, v192
  s_cmp_lt_u32 s2, 128
  s_cbranch_scc1 F_xl1
  buffer_load_dwordx4 v[136:139], v132, s[4:7], s50 offen offset:0
  buffer_load_dwordx4 v[140:143], v132, s[4:7], s50 offen offset:128
  buffer_load_dwordx4 v[144:147], v132, s[4:7], s50 offen offset:256
  buffer_load_dwordx4 v[148:151], v132, s[4:7], s50 offen offset:384
  s_add_u32 s50, s50, 16384
  buffer_load_dwordx4 v[152:155], v132, s[4:7], s50 offen offset:0
  buffer_load_dwordx4 v[156:159], v132, s[4:7], s50 offen offset:128
  buffer_load_dwordx4 v[160:163], v132, s[4:7], s50 offen offset:256
  buffer_load_dwordx4 v[164:167], v132, s[4:7], s50 offen offset:384
F_xl1:
  s_cmp_lt_u32 s2, 128
  s_cbranch_scc0 AL
  s_waitcnt vmcnt(8)
  v_lshlrev_b32 v188, 16, v136
  v_and_b32 v189, 0xffff0000, v136
  v_lshlrev_b32 v190, 16, v137
  v_and_b32 v191, 0xffff0000, v137
  v_pk_mul_f32 v[180:181], v[188:189], v[168:169] op_sel_hi:[1,0]
  v_pk_mul_f32 v[182:183], v[190:191], v[168:169] op_sel_hi:[1,0]
  v_lshlrev_b32 v188, 16, v138
  v_and_b32 v189, 0xffff0000, v138
  v_lshlrev_b32 v190, 16, v139
  v_and_b32 v191, 0xffff0000, v139
  v_pk_mul_f32 v[184:185], v[188:189], v[168:169] op_sel_hi:[1,0]
  v_pk_mul_f32 v[186:187], v[190:191], v[168:169] op_sel_hi:[1,0]
  s_waitcnt vmcnt(7)
  v_lshlrev_b32 v188, 16, v140
  v_and_b32 v189, 0xffff0000, v140
  v_lshlrev_b32 v190, 16, v141
  v_and_b32 v191, 0xffff0000, v141
  v_pk_fma_f32 v[180:181], v[188:189], v[168:169], v[180:181] op_sel:[0,1,0] op_sel_hi:[1,1,1]
  v_pk_fma_f32 v[182:183], v[190:191], v[168:169], v[182:183] op_sel:[0,1,0] op_sel_hi:[1,1,1]
  v_lshlrev_b32 v188, 16, v142
  v_and_b32 v189, 0xffff0000, v142
  v_lshlrev_b32 v190, 16, v143
  v_and_b32 v191, 0xffff0000, v143
  v_pk_fma_f32 v[184:185], v[188:189], v[168:169], v[184:185] op_sel:[0,1,0] op_sel_hi:[1,1,1]
  v_pk_fma_f32 v[186:187], v[190:191], v[168:169], v[186:187] op_sel:[0,1,0] op_sel_hi:[1,1,1]
  s_waitcnt vmcnt(6)
  v_lshlrev_b32 v188, 16, v144
  v_and_b32 v189, 0xffff0000, v144
  v_lshlrev_b32 v190, 16, v145
  v_and_b32 v191, 0xffff0000, v145
  v_pk_fma_f32 v[180:181], v[188:189], v[170:171], v[180:181] op_sel:[0,0,0] op_sel_hi:[1,0,1]
  v_pk_fma_f32 v[182:183], v[190:191], v[170:171], v[182:183] op_sel:[0,0,0] op_sel_hi:[1,0,1]
  v_lshlrev_b32 v188, 16, v146
  v_and_b32 v189, 0xffff0000, v146
  v_lshlrev_b32 v190, 16, v147
  v_and_b32 v191, 0xffff0000, v147
  v_pk_fma_f32 v[184:185], v[188:189], v[170:171], v[184:185] op_sel:[0,0,0] op_sel_hi:[1,0,1]
  v_pk_fma_f32 v[186:187], v[190:191], v[170:171], v[186:187] op_sel:[0,0,0] op_sel_hi:[1,0,1]
  s_waitcnt vmcnt(5)
  v_lshlrev_b32 v188, 16, v148
  v_and_b32 v189, 0xffff0000, v148
  v_lshlrev_b32 v190, 16, v149
  v_and_b32 v191, 0xffff0000, v149
  v_pk_fma_f32 v[180:181], v[188:189], v[170:171], v[180:181] op_sel:[0,1,0] op_sel_hi:[1,1,1]
  v_pk_fma_f32 v[182:183], v[190:191], v[170:171], v[182:183] op_sel:[0,1,0] op_sel_hi:[1,1,1]
  v_lshlrev_b32 v188, 16, v150
  v_and_b32 v189, 0xffff0000, v150
  v_lshlrev_b32 v190, 16, v151
  v_and_b32 v191, 0xffff0000, v151
  v_pk_fma_f32 v[184:185], v[188:189], v[170:171], v[184:185] op_sel:[0,1,0] op_sel_hi:[1,1,1]
  v_pk_fma_f32 v[186:187], v[190:191], v[170:171], v[186:187] op_sel:[0,1,0] op_sel_hi:[1,1,1]
  s_waitcnt vmcnt(4)
  v_lshlrev_b32 v188, 16, v152
  v_and_b32 v189, 0xffff0000, v152
  v_lshlrev_b32 v190, 16, v153
  v_and_b32 v191, 0xffff0000, v153
  v_pk_fma_f32 v[180:181], v[188:189], v[172:173], v[180:181] op_sel:[0,0,0] op_sel_hi:[1,0,1]
  v_pk_fma_f32 v[182:183], v[190:191], v[172:173], v[182:183] op_sel:[0,0,0] op_sel_hi:[1,0,1]
  v_lshlrev_b32 v188, 16, v154
  v_and_b32 v189, 0xffff0000, v154
  v_lshlrev_b32 v190, 16, v155
  v_and_b32 v191, 0xffff0000, v155
  v_pk_fma_f32 v[184:185], v[188:189], v[172:173], v[184:185] op_sel:[0,0,0] op_sel_hi:[1,0,1]
  v_pk_fma_f32 v[186:187], v[190:191], v[172:173], v[186:187] op_sel:[0,0,0] op_sel_hi:[1,0,1]
  s_waitcnt vmcnt(3)
  v_lshlrev_b32 v188, 16, v156
  v_and_b32 v189, 0xffff0000, v156
  v_lshlrev_b32 v190, 16, v157
  v_and_b32 v191, 0xffff0000, v157
  v_pk_fma_f32 v[180:181], v[188:189], v[172:173], v[180:181] op_sel:[0,1,0] op_sel_hi:[1,1,1]
  v_pk_fma_f32 v[182:183], v[190:191], v[172:173], v[182:183] op_sel:[0,1,0] op_sel_hi:[1,1,1]
  v_lshlrev_b32 v188, 16, v158
  v_and_b32 v189, 0xffff0000, v158
  v_lshlrev_b32 v190, 16, v159
  v_and_b32 v191, 0xffff0000, v159
  v_pk_fma_f32 v[184:185], v[188:189], v[172:173], v[184:185] op_sel:[0,1,0] op_sel_hi:[1,1,1]
  v_pk_fma_f32 v[186:187], v[190:191], v[172:173], v[186:187] op_sel:[0,1,0] op_sel_hi:[1,1,1]
  s_waitcnt vmcnt(2)
  v_lshlrev_b32 v188, 16, v160
  v_and_b32 v189, 0xffff0000, v160
  v_lshlrev_b32 v190, 16, v161
  v_and_b32 v191, 0xffff0000, v161
  v_pk_fma_f32 v[180:181], v[188:189], v[174:175], v[180:181] op_sel:[0,0,0] op_sel_hi:[1,0,1]
  v_pk_fma_f32 v[182:183], v[190:191], v[174:175], v[182:183] op_sel:[0,0,0] op_sel_hi:[1,0,1]
  v_lshlrev_b32 v188, 16, v162
  v_and_b32 v189, 0xffff0000, v162
  v_lshlrev_b32 v190, 16, v163
  v_and_b32 v191, 0xffff0000, v163
  v_pk_fma_f32 v[184:185], v[188:189], v[174:175], v[184:185] op_sel:[0,0,0] op_sel_hi:[1,0,1]
  v_pk_fma_f32 v[186:187], v[190:191], v[174:175], v[186:187] op_sel:[0,0,0] op_sel_hi:[1,0,1]
  s_waitcnt vmcnt(1)
  v_lshlrev_b32 v188, 16, v164
  v_and_b32 v189, 0xffff0000, v164
  v_lshlrev_b32 v190, 16, v165
  v_and_b32 v191, 0xffff0000, v165
  v_pk_fma_f32 v[180:181], v[188:189], v[174:175], v[180:181] op_sel:[0,1,0] op_sel_hi:[1,1,1]
  v_pk_fma_f32 v[182:183], v[190:191], v[174:175], v[182:183] op_sel:[0,1,0] op_sel_hi:[1,1,1]
  v_lshlrev_b32 v188, 16, v166
  v_and_b32 v189, 0xffff0000, v166
  v_lshlrev_b32 v190, 16, v167
  v_and_b32 v191, 0xffff0000, v167
  v_pk_fma_f32 v[184:185], v[188:189], v[174:175], v[184:185] op_sel:[0,1,0] op_sel_hi:[1,1,1]
  v_pk_fma_f32 v[186:187], v[190:191], v[174:175], v[186:187] op_sel:[0,1,0] op_sel_hi:[1,1,1]
  s_nop 0
  v_permlane32_swap_b32 v180, v184
  v_permlane32_swap_b32 v181, v185
  v_permlane32_swap_b32 v182, v186
  v_permlane32_swap_b32 v183, v187
  v_add_f32 v180, v180, v184
  v_add_f32 v181, v181, v185
  v_add_f32 v182, v182, v186
  v_add_f32 v183, v183, v187
  s_nop 0
  v_permlane16_swap_b32 v180, v182
  v_permlane16_swap_b32 v181, v183
  v_add_f32 v180, v180, v182
  v_add_f32 v181, v181, v183
  v_add_u32 v188, 162816, v178
  v_add_f32_dpp v180, v180, v180 row_ror:8 row_mask:0xf bank_mask:0xf
  v_add_f32_dpp v181, v181, v181 row_ror:8 row_mask:0xf bank_mask:0xf
  ds_write_b64 v177, v[180:181]
  v_and_b32 v184, 3, v10
  v_lshlrev_b32 v184, 3, v184
  s_cmp_eq_u32 s44, 0
  s_cselect_b32 s48, s56, 1073741824
  s_waitcnt lgkmcnt(0)
  s_barrier
  ds_read_b32 v180, v188 offset:0
  ds_read_b32 v181, v188 offset:256
  ds_read_b32 v182, v188 offset:512
  ds_read_b32 v183, v188 offset:768
  s_waitcnt vmcnt(0)
  v_readfirstlane_b32 s3, v195
  s_lshl_b32 s45, s2, 7
  s_add_u32 s45, s45, 5242880
  s_cmp_eq_u32 s44, 0
  s_cselect_b32 s45, s45, 1073741824
  s_mul_i32 s3, s3, 0x9e3779b1
  s_add_u32 s3, s3, 0x7f4a7c15
  s_and_b32 s70, s2, 7
  s_bfe_u32 s49, s2, 0x20003
  s_lshl2_add_u32 s70, s70, s49
  s_lshr_b32 s49, s2, 5
  s_lshl3_add_u32 s70, s70, s49
  s_lshl1_add_u32 s70, s70, s44
  s_lshl_b32 s70, s70, 10
  s_add_u32 s70, s70, 524288
  s_add_u32 s56, s56, 8192
  s_cmp_lt_u32 s44, 2
  s_cselect_b32 s70, s70, 1073741824
  s_cmp_eq_u32 s44, 2
  s_cselect_b32 s71, s56, 1073741824
  v_bfe_u32 v184, s3, v184, 8
  v_mov_b32 v185, 0xffffff00
  s_waitcnt lgkmcnt(0)
  v_add_f32 v180, v180, v181
  v_add_f32 v182, v182, v183
  v_add_f32 v180, v180, v182
  v_add_u32 v180, 0x80, v180
  v_and_or_b32 v180, v180, v185, v184
  buffer_store_dword v180, v178, s[36:39], s48 offen sc1
  v_mov_b32 v184, -1
  v_mov_b32 v185, -1
  v_mov_b32 v186, -1
  v_mov_b32 v187, -1
  buffer_store_dwordx4 v[184:187], v0, s[36:39], s70 offen sc1
  buffer_store_dword v184, v178, s[36:39], s71 offen sc1
  s_lshl_b32 s48, s44, 7
  s_add_u32 s48, s48, s2
  s_lshl_b32 s48, s48, 13
  v_lshlrev_b32 v14, 3, v0
  s_mov_b32 s50, s48
  buffer_load_dword a252, v14, s[8:11], s50 offen
  s_mov_b32 s55, 0x20000
  s_sub_u32 s49, s48, 2097152
  s_add_u32 s48, s48, 4194304
  s_cmp_ge_u32 s44, 2
  s_cselect_b64 s[52:53], s[12:13], s[8:9]
  s_cselect_b32 s54, s14, s10
  s_cselect_b32 s48, s49, s48
  v_mov_b32 v12, s3
  s_waitcnt vmcnt(1)
  s_barrier
  s_mov_b64 exec, 1
  buffer_store_dword v12, v0, s[36:39], s45 offen sc1
  s_mov_b64 exec, -1
  s_waitcnt vmcnt(1)
  s_lshr_b32 s49, s2, 3
  s_mul_i32 s49, s49, 393216
  s_add_u32 s49, s49, s64
  s_and_b32 s50, s2, 2
  s_lshl_b32 s50, s50, 9
  s_add_u32 s49, s49, s50
  s_and_b32 s50, s2, 1
  s_lshl2_add_u32 s50, s50, s44
  s_cmp_lt_u32 s50, 3
  s_cselect_b32 s49, s49, 1073741824
  v_min_u32 v15, 63, v10
  v_mul_u32_u24 v15, 6144, v15
  buffer_load_dword a252, v15, s[8:11], s49 offen offset:384
  buffer_load_dword a252, v14, s[52:55], s48 offen
  s_branch J2
.p2align 12
AL:
  s_waitcnt vmcnt(8)
  v_readfirstlane_b32 s3, v195
  s_lshl_b32 s45, s2, 7
  s_add_u32 s45, s45, 5242880
  s_cmp_eq_u32 s44, 0
  s_cselect_b32 s45, s45, 1073741824
  s_mul_i32 s3, s3, 0x9e3779b1
  s_add_u32 s3, s3, 0x7f4a7c15
  s_and_b32 s70, s2, 7
  s_bfe_u32 s49, s2, 0x20003
  s_lshl2_add_u32 s70, s70, s49
  s_lshr_b32 s49, s2, 5
  s_lshl3_add_u32 s70, s70, s49
  s_lshl1_add_u32 s70, s70, s44
  s_lshl_b32 s70, s70, 10
  s_add_u32 s70, s70, 524288
  s_add_u32 s56, s56, 8192
  s_cmp_lt_u32 s44, 2
  s_cselect_b32 s70, s70, 1073741824
  s_cmp_eq_u32 s44, 2
  s_cselect_b32 s71, s56, 1073741824
  s_add_u32 s48, s64, 150528
  v_add_u32 v14, s48, v0
  v_lshl_add_u32 v15, v13, 5, s48
  v_lshlrev_b32 v17, 6, v12
  v_add_u32 v17, 158720, v17
  s_lshl_b32 s48, s44, 4
  v_add_u32 v16, s48, v17
  v_bfe_u32 v18, v10, 3, 1
  v_lshlrev_b32 v132, 9, v18
  v_bfe_u32 v18, v10, 4, 1
  v_lshl_add_u32 v132, v18, 8, v132
  v_lshrrev_b32 v18, 5, v10
  v_lshl_add_u32 v132, v18, 11, v132
  v_lshl_add_u32 v132, v12, 4, v132
  s_bfe_u32 s50, s2, 0x60001
  s_lshl2_add_u32 s50, s50, s44
  s_lshl_b32 s50, s50, 4
  s_and_b32 s48, s2, 1
  s_add_u32 s50, s50, s48
  s_lshl_b32 s50, s50, 10
  s_add_u32 s50, s50, 1048576
  s_bfe_u32 s66, s3, 0x80000
  s_bfe_u32 s67, s3, 0x80008
  s_bfe_u32 s68, s3, 0x80010
  s_bfe_u32 s69, s3, 0x80018
  s_waitcnt vmcnt(7)
  v_lshlrev_b32 v20, 16, v136
  v_and_b32 v21, 0xffff0000, v136
  v_lshlrev_b32 v22, 16, v137
  v_and_b32 v23, 0xffff0000, v137
  v_lshlrev_b32 v24, 16, v138
  v_and_b32 v25, 0xffff0000, v138
  v_lshlrev_b32 v26, 16, v139
  v_and_b32 v27, 0xffff0000, v139
  v_pk_mul_f32 v[126:127], v[20:21], v[20:21]
  v_pk_mul_f32 v[130:131], v[22:23], v[22:23]
  v_pk_fma_f32 v[126:127], v[24:25], v[24:25], v[126:127]
  v_pk_add_f32 v[124:125], v[24:25], v[20:21]
  v_pk_fma_f32 v[130:131], v[26:27], v[26:27], v[130:131]
  v_pk_add_f32 v[128:129], v[26:27], v[22:23]
  s_waitcnt vmcnt(6)
  v_lshlrev_b32 v28, 16, v140
  v_and_b32 v29, 0xffff0000, v140
  v_lshlrev_b32 v30, 16, v141
  v_and_b32 v31, 0xffff0000, v141
  v_lshlrev_b32 v32, 16, v142
  v_and_b32 v33, 0xffff0000, v142
  v_lshlrev_b32 v34, 16, v143
  v_and_b32 v35, 0xffff0000, v143
  v_pk_fma_f32 v[126:127], v[28:29], v[28:29], v[126:127]
  v_pk_add_f32 v[124:125], v[28:29], v[124:125]
  v_pk_fma_f32 v[130:131], v[30:31], v[30:31], v[130:131]
  v_pk_add_f32 v[128:129], v[30:31], v[128:129]
  v_pk_fma_f32 v[126:127], v[32:33], v[32:33], v[126:127]
  v_pk_add_f32 v[124:125], v[32:33], v[124:125]
  v_pk_fma_f32 v[130:131], v[34:35], v[34:35], v[130:131]
  v_pk_add_f32 v[128:129], v[34:35], v[128:129]
  s_waitcnt vmcnt(5)
  v_lshlrev_b32 v36, 16, v144
  v_and_b32 v37, 0xffff0000, v144
  v_lshlrev_b32 v38, 16, v145
  v_and_b32 v39, 0xffff0000, v145
  v_lshlrev_b32 v40, 16, v146
  v_and_b32 v41, 0xffff0000, v146
  v_lshlrev_b32 v42, 16, v147
  v_and_b32 v43, 0xffff0000, v147
  v_pk_fma_f32 v[126:127], v[36:37], v[36:37], v[126:127]
  v_pk_add_f32 v[124:125], v[36:37], v[124:125]
  v_pk_fma_f32 v[130:131], v[38:39], v[38:39], v[130:131]
  v_pk_add_f32 v[128:129], v[38:39], v[128:129]
  v_pk_fma_f32 v[126:127], v[40:41], v[40:41], v[126:127]
  v_pk_add_f32 v[124:125], v[40:41], v[124:125]
  v_pk_fma_f32 v[130:131], v[42:43], v[42:43], v[130:131]
  v_pk_add_f32 v[128:129], v[42:43], v[128:129]
  s_waitcnt vmcnt(4)
  v_lshlrev_b32 v44, 16, v148
  v_and_b32 v45, 0xffff0000, v148
  v_lshlrev_b32 v46, 16, v149
  v_and_b32 v47, 0xffff0000, v149
  v_lshlrev_b32 v48, 16, v150
  v_and_b32 v49, 0xffff0000, v150
  v_lshlrev_b32 v50, 16, v151
  v_and_b32 v51, 0xffff0000, v151
  v_pk_fma_f32 v[126:127], v[44:45], v[44:45], v[126:127]
  v_pk_add_f32 v[124:125], v[44:45], v[124:125]
  v_pk_fma_f32 v[130:131], v[46:47], v[46:47], v[130:131]
  v_pk_add_f32 v[128:129], v[46:47], v[128:129]
  v_pk_fma_f32 v[126:127], v[48:49], v[48:49], v[126:127]
  v_pk_add_f32 v[124:125], v[48:49], v[124:125]
  v_pk_fma_f32 v[130:131], v[50:51], v[50:51], v[130:131]
  v_pk_add_f32 v[128:129], v[50:51], v[128:129]
  v_pk_add_f32 v[124:125], v[124:125], v[128:129]
  v_pk_add_f32 v[126:127], v[126:127], v[130:131]
  v_add_f32 v180, v124, v125
  v_add_f32 v181, v126, v127
  s_waitcnt vmcnt(3)
  v_lshlrev_b32 v52, 16, v152
  v_and_b32 v53, 0xffff0000, v152
  v_lshlrev_b32 v54, 16, v153
  v_and_b32 v55, 0xffff0000, v153
  v_lshlrev_b32 v56, 16, v154
  v_and_b32 v57, 0xffff0000, v154
  v_lshlrev_b32 v58, 16, v155
  v_and_b32 v59, 0xffff0000, v155
  v_pk_mul_f32 v[126:127], v[52:53], v[52:53]
  v_pk_mul_f32 v[130:131], v[54:55], v[54:55]
  v_pk_fma_f32 v[126:127], v[56:57], v[56:57], v[126:127]
  v_pk_add_f32 v[124:125], v[56:57], v[52:53]
  v_pk_fma_f32 v[130:131], v[58:59], v[58:59], v[130:131]
  v_pk_add_f32 v[128:129], v[58:59], v[54:55]
  s_waitcnt vmcnt(2)
  v_lshlrev_b32 v60, 16, v156
  v_and_b32 v61, 0xffff0000, v156
  v_lshlrev_b32 v62, 16, v157
  v_and_b32 v63, 0xffff0000, v157
  v_lshlrev_b32 v64, 16, v158
  v_and_b32 v65, 0xffff0000, v158
  v_lshlrev_b32 v66, 16, v159
  v_and_b32 v67, 0xffff0000, v159
  v_pk_fma_f32 v[126:127], v[60:61], v[60:61], v[126:127]
  v_pk_add_f32 v[124:125], v[60:61], v[124:125]
  v_pk_fma_f32 v[130:131], v[62:63], v[62:63], v[130:131]
  v_pk_add_f32 v[128:129], v[62:63], v[128:129]
  v_pk_fma_f32 v[126:127], v[64:65], v[64:65], v[126:127]
  v_pk_add_f32 v[124:125], v[64:65], v[124:125]
  v_pk_fma_f32 v[130:131], v[66:67], v[66:67], v[130:131]
  v_pk_add_f32 v[128:129], v[66:67], v[128:129]
  s_waitcnt vmcnt(1)
  v_lshlrev_b32 v68, 16, v160
  v_and_b32 v69, 0xffff0000, v160
  v_lshlrev_b32 v70, 16, v161
  v_and_b32 v71, 0xffff0000, v161
  v_lshlrev_b32 v72, 16, v162
  v_and_b32 v73, 0xffff0000, v162
  v_lshlrev_b32 v74, 16, v163
  v_and_b32 v75, 0xffff0000, v163
  v_pk_fma_f32 v[126:127], v[68:69], v[68:69], v[126:127]
  v_pk_add_f32 v[124:125], v[68:69], v[124:125]
  v_pk_fma_f32 v[130:131], v[70:71], v[70:71], v[130:131]
  v_pk_add_f32 v[128:129], v[70:71], v[128:129]
  v_pk_fma_f32 v[126:127], v[72:73], v[72:73], v[126:127]
  v_pk_add_f32 v[124:125], v[72:73], v[124:125]
  v_pk_fma_f32 v[130:131], v[74:75], v[74:75], v[130:131]
  v_pk_add_f32 v[128:129], v[74:75], v[128:129]
  s_waitcnt vmcnt(0)
  v_lshlrev_b32 v76, 16, v164
  v_and_b32 v77, 0xffff0000, v164
  v_lshlrev_b32 v78, 16, v165
  v_and_b32 v79, 0xffff0000, v165
  v_lshlrev_b32 v80, 16, v166
  v_and_b32 v81, 0xffff0000, v166
  v_lshlrev_b32 v82, 16, v167
  v_and_b32 v83, 0xffff0000, v167
  v_pk_fma_f32 v[126:127], v[76:77], v[76:77], v[126:127]
  v_pk_add_f32 v[124:125], v[76:77], v[124:125]
  v_pk_fma_f32 v[130:131], v[78:79], v[78:79], v[130:131]
  v_pk_add_f32 v[128:129], v[78:79], v[128:129]
  v_pk_fma_f32 v[126:127], v[80:81], v[80:81], v[126:127]
  v_pk_add_f32 v[124:125], v[80:81], v[124:125]
  v_pk_fma_f32 v[130:131], v[82:83], v[82:83], v[130:131]
  v_pk_add_f32 v[128:129], v[82:83], v[128:129]
  v_pk_add_f32 v[124:125], v[124:125], v[128:129]
  v_pk_add_f32 v[126:127], v[126:127], v[130:131]
  v_add_f32 v182, v124, v125
  v_add_f32 v183, v126, v127
  s_nop 0
  v_add_f32_dpp v188, v180, v180 row_ror:8 row_mask:0xf bank_mask:0xf
  v_add_f32_dpp v189, v181, v181 row_ror:8 row_mask:0xf bank_mask:0xf
  v_add_f32_dpp v190, v182, v182 row_ror:8 row_mask:0xf bank_mask:0xf
  v_add_f32_dpp v191, v183, v183 row_ror:8 row_mask:0xf bank_mask:0xf
  v_mov_b32 v180, v188
  v_mov_b32 v181, v189
  v_mov_b32 v182, v190
  v_mov_b32 v183, v191
  v_permlane16_swap_b32 v188, v180
  v_permlane16_swap_b32 v189, v181
  v_permlane16_swap_b32 v190, v182
  v_permlane16_swap_b32 v191, v183
  v_pk_add_f32 v[188:189], v[188:189], v[180:181]
  v_pk_add_f32 v[190:191], v[190:191], v[182:183]
  v_mov_b32 v180, v188
  v_mov_b32 v181, v189
  v_mov_b32 v182, v190
  v_mov_b32 v183, v191
  v_permlane32_swap_b32 v188, v180
  v_permlane32_swap_b32 v189, v181
  v_permlane32_swap_b32 v190, v182
  v_permlane32_swap_b32 v191, v183
  v_pk_add_f32 v[188:189], v[188:189], v[180:181]
  v_pk_add_f32 v[190:191], v[190:191], v[182:183]
  ds_write_b128 v16, v[188:191]
  s_waitcnt lgkmcnt(0)
  s_barrier
  ds_read_b128 v[136:139], v17 offset:0
  ds_read_b128 v[140:143], v17 offset:16
  ds_read_b128 v[144:147], v17 offset:32
  ds_read_b128 v[148:151], v17 offset:48
  s_lshl_b32 s49, s44, 10
  buffer_load_dwordx4 v[220:223], v0, s[36:39], s49 offen sc1
  s_add_u32 s49, s49, 4096
  buffer_load_dwordx4 v[84:87], v0, s[36:39], s49 offen sc1
  s_add_u32 s49, s49, 20480
  buffer_load_dwordx4 v[224:227], v0, s[36:39], s49 offen sc1
  s_add_u32 s49, s49, 4096
  buffer_load_dwordx4 v[88:91], v0, s[36:39], s49 offen sc1
  s_add_u32 s49, s49, 20480
  buffer_load_dwordx4 v[228:231], v0, s[36:39], s49 offen sc1
  s_add_u32 s49, s49, 4096
  buffer_load_dwordx4 v[92:95], v0, s[36:39], s49 offen sc1
  s_add_u32 s49, s49, 20480
  buffer_load_dwordx4 v[232:235], v0, s[36:39], s49 offen sc1
  s_add_u32 s49, s49, 4096
  buffer_load_dwordx4 v[96:99], v0, s[36:39], s49 offen sc1
  s_waitcnt lgkmcnt(0)
  v_pk_add_f32 v[136:137], v[136:137], v[144:145]
  v_pk_add_f32 v[138:139], v[138:139], v[146:147]
  v_pk_add_f32 v[140:141], v[140:141], v[148:149]
  v_pk_add_f32 v[142:143], v[142:143], v[150:151]
  v_pk_add_f32 v[136:137], v[136:137], v[140:141]
  v_pk_add_f32 v[138:139], v[138:139], v[142:143]
  v_mul_f32 v188, 0x3a800000, v136
  v_mul_f32 v189, 0x3a800000, v137
  v_mul_f32 v190, 0x3a800000, v138
  v_mul_f32 v191, 0x3a800000, v139
  v_fma_f32 v189, -v188, v188, v189
  v_fma_f32 v191, -v190, v190, v191
  v_max_f32 v189, 0, v189
  v_max_f32 v191, 0, v191
  v_cvt_pk_bf16_f32 v189, v189, v189
  v_cvt_pk_bf16_f32 v191, v191, v191
  v_lshlrev_b32 v189, 16, v189
  v_lshlrev_b32 v191, 16, v191
  v_add_f32 v189, 0x3727c5ac, v189
  v_add_f32 v191, 0x3727c5ac, v191
  v_cvt_pk_bf16_f32 v189, v189, v189
  v_cvt_pk_bf16_f32 v191, v191, v191
  v_lshlrev_b32 v189, 16, v189
  v_lshlrev_b32 v191, 16, v191
  v_sqrt_f32 v189, v189
  v_sqrt_f32 v191, v191
  v_cvt_pk_bf16_f32 v188, v188, v188
  v_cvt_pk_bf16_f32 v190, v190, v190
  v_lshlrev_b32 v188, 16, v188
  v_lshlrev_b32 v190, 16, v190
  v_cvt_pk_bf16_f32 v189, v189, v189
  v_cvt_pk_bf16_f32 v191, v191, v191
  v_lshlrev_b32 v189, 16, v189
  v_lshlrev_b32 v191, 16, v191
  v_rcp_f32 v189, v189
  v_rcp_f32 v191, v191
  v_mul_f32 v188, -v188, v189
  v_mul_f32 v190, -v190, v191
  v_pk_fma_f32 v[20:21], v[20:21], v[188:189], v[188:189] op_sel:[0,1,0] op_sel_hi:[1,1,0]
  v_pk_fma_f32 v[22:23], v[22:23], v[188:189], v[188:189] op_sel:[0,1,0] op_sel_hi:[1,1,0]
  v_pk_fma_f32 v[24:25], v[24:25], v[188:189], v[188:189] op_sel:[0,1,0] op_sel_hi:[1,1,0]
  v_pk_fma_f32 v[26:27], v[26:27], v[188:189], v[188:189] op_sel:[0,1,0] op_sel_hi:[1,1,0]
  v_pk_fma_f32 v[28:29], v[28:29], v[188:189], v[188:189] op_sel:[0,1,0] op_sel_hi:[1,1,0]
  v_pk_fma_f32 v[30:31], v[30:31], v[188:189], v[188:189] op_sel:[0,1,0] op_sel_hi:[1,1,0]
  v_pk_fma_f32 v[32:33], v[32:33], v[188:189], v[188:189] op_sel:[0,1,0] op_sel_hi:[1,1,0]
  v_pk_fma_f32 v[34:35], v[34:35], v[188:189], v[188:189] op_sel:[0,1,0] op_sel_hi:[1,1,0]
  v_pk_fma_f32 v[36:37], v[36:37], v[188:189], v[188:189] op_sel:[0,1,0] op_sel_hi:[1,1,0]
  v_pk_fma_f32 v[38:39], v[38:39], v[188:189], v[188:189] op_sel:[0,1,0] op_sel_hi:[1,1,0]
  v_pk_fma_f32 v[40:41], v[40:41], v[188:189], v[188:189] op_sel:[0,1,0] op_sel_hi:[1,1,0]
  v_pk_fma_f32 v[42:43], v[42:43], v[188:189], v[188:189] op_sel:[0,1,0] op_sel_hi:[1,1,0]
  v_pk_fma_f32 v[44:45], v[44:45], v[188:189], v[188:189] op_sel:[0,1,0] op_sel_hi:[1,1,0]
  v_pk_fma_f32 v[46:47], v[46:47], v[188:189], v[188:189] op_sel:[0,1,0] op_sel_hi:[1,1,0]
  v_pk_fma_f32 v[48:49], v[48:49], v[188:189], v[188:189] op_sel:[0,1,0] op_sel_hi:[1,1,0]
  v_pk_fma_f32 v[50:51], v[50:51], v[188:189], v[188:189] op_sel:[0,1,0] op_sel_hi:[1,1,0]
  v_pk_fma_f32 v[52:53], v[52:53], v[190:191], v[190:191] op_sel:[0,1,0] op_sel_hi:[1,1,0]
  v_pk_fma_f32 v[54:55], v[54:55], v[190:191], v[190:191] op_sel:[0,1,0] op_sel_hi:[1,1,0]
  v_pk_fma_f32 v[56:57], v[56:57], v[190:191], v[190:191] op_sel:[0,1,0] op_sel_hi:[1,1,0]
  v_pk_fma_f32 v[58:59], v[58:59], v[190:191], v[190:191] op_sel:[0,1,0] op_sel_hi:[1,1,0]
  v_pk_fma_f32 v[60:61], v[60:61], v[190:191], v[190:191] op_sel:[0,1,0] op_sel_hi:[1,1,0]
  v_pk_fma_f32 v[62:63], v[62:63], v[190:191], v[190:191] op_sel:[0,1,0] op_sel_hi:[1,1,0]
  v_pk_fma_f32 v[64:65], v[64:65], v[190:191], v[190:191] op_sel:[0,1,0] op_sel_hi:[1,1,0]
  v_pk_fma_f32 v[66:67], v[66:67], v[190:191], v[190:191] op_sel:[0,1,0] op_sel_hi:[1,1,0]
  v_pk_fma_f32 v[68:69], v[68:69], v[190:191], v[190:191] op_sel:[0,1,0] op_sel_hi:[1,1,0]
  v_pk_fma_f32 v[70:71], v[70:71], v[190:191], v[190:191] op_sel:[0,1,0] op_sel_hi:[1,1,0]
  v_pk_fma_f32 v[72:73], v[72:73], v[190:191], v[190:191] op_sel:[0,1,0] op_sel_hi:[1,1,0]
  v_pk_fma_f32 v[74:75], v[74:75], v[190:191], v[190:191] op_sel:[0,1,0] op_sel_hi:[1,1,0]
  v_pk_fma_f32 v[76:77], v[76:77], v[190:191], v[190:191] op_sel:[0,1,0] op_sel_hi:[1,1,0]
  v_pk_fma_f32 v[78:79], v[78:79], v[190:191], v[190:191] op_sel:[0,1,0] op_sel_hi:[1,1,0]
  v_pk_fma_f32 v[80:81], v[80:81], v[190:191], v[190:191] op_sel:[0,1,0] op_sel_hi:[1,1,0]
  v_pk_fma_f32 v[82:83], v[82:83], v[190:191], v[190:191] op_sel:[0,1,0] op_sel_hi:[1,1,0]
  s_mov_b32 s46, 30000
  s_branch PLC
PLP:
  s_lshl_b32 s49, s44, 10
  buffer_load_dwordx4 v[220:223], v0, s[36:39], s49 offen sc1
  s_add_u32 s49, s49, 4096
  buffer_load_dwordx4 v[84:87], v0, s[36:39], s49 offen sc1
  s_add_u32 s49, s49, 20480
  buffer_load_dwordx4 v[224:227], v0, s[36:39], s49 offen sc1
  s_add_u32 s49, s49, 4096
  buffer_load_dwordx4 v[88:91], v0, s[36:39], s49 offen sc1
  s_add_u32 s49, s49, 20480
  buffer_load_dwordx4 v[228:231], v0, s[36:39], s49 offen sc1
  s_add_u32 s49, s49, 4096
  buffer_load_dwordx4 v[92:95], v0, s[36:39], s49 offen sc1
  s_add_u32 s49, s49, 20480
  buffer_load_dwordx4 v[232:235], v0, s[36:39], s49 offen sc1
  s_add_u32 s49, s49, 4096
  buffer_load_dwordx4 v[96:99], v0, s[36:39], s49 offen sc1
PLC:
  s_waitcnt vmcnt(7)
  v_xor_b32 v220, s66, v220
  v_xor_b32 v221, s67, v221
  v_xor_b32 v222, s68, v222
  v_xor_b32 v223, s69, v223
  v_or3_b32 v184, 0, v220, v221
  v_or3_b32 v184, v184, v222, v223
  s_waitcnt vmcnt(6)
  v_xor_b32 v84, s66, v84
  v_xor_b32 v85, s67, v85
  v_xor_b32 v86, s68, v86
  v_xor_b32 v87, s69, v87
  v_or3_b32 v184, v184, v84, v85
  v_or3_b32 v184, v184, v86, v87
  s_waitcnt vmcnt(5)
  v_xor_b32 v224, s66, v224
  v_xor_b32 v225, s67, v225
  v_xor_b32 v226, s68, v226
  v_xor_b32 v227, s69, v227
  v_or3_b32 v184, v184, v224, v225
  v_or3_b32 v184, v184, v226, v227
  s_waitcnt vmcnt(4)
  v_xor_b32 v88, s66, v88
  v_xor_b32 v89, s67, v89
  v_xor_b32 v90, s68, v90
  v_xor_b32 v91, s69, v91
  v_or3_b32 v184, v184, v88, v89
  v_or3_b32 v184, v184, v90, v91
  s_waitcnt vmcnt(3)
  v_xor_b32 v228, s66, v228
  v_xor_b32 v229, s67, v229
  v_xor_b32 v230, s68, v230
  v_xor_b32 v231, s69, v231
  v_or3_b32 v184, v184, v228, v229
  v_or3_b32 v184, v184, v230, v231
  s_waitcnt vmcnt(2)
  v_xor_b32 v92, s66, v92
  v_xor_b32 v93, s67, v93
  v_xor_b32 v94, s68, v94
  v_xor_b32 v95, s69, v95
  v_or3_b32 v184, v184, v92, v93
  v_or3_b32 v184, v184, v94, v95
  s_waitcnt vmcnt(1)
  v_xor_b32 v232, s66, v232
  v_xor_b32 v233, s67, v233
  v_xor_b32 v234, s68, v234
  v_xor_b32 v235, s69, v235
  v_or3_b32 v184, v184, v232, v233
  v_or3_b32 v184, v184, v234, v235
  s_waitcnt vmcnt(0)
  v_xor_b32 v96, s66, v96
  v_xor_b32 v97, s67, v97
  v_xor_b32 v98, s68, v98
  v_xor_b32 v99, s69, v99
  v_or3_b32 v184, v184, v96, v97
  v_or3_b32 v184, v184, v98, v99
  v_and_b32 v184, 0xff, v184
  v_cmp_ne_u32 vcc, 0, v184
  s_sub_u32 s46, s46, 1
  s_cmp_eq_u32 s46, 0
  s_cbranch_scc1 PLX
  s_nop 1
  s_cbranch_vccnz PLP
PLX:
  v_mov_b32 v180, -1
  v_mov_b32 v181, -1
  v_mov_b32 v182, -1
  v_mov_b32 v183, -1
  buffer_store_dwordx4 v[180:183], v0, s[36:39], s70 offen sc1
  buffer_store_dword v180, v178, s[36:39], s71 offen sc1
  v_pk_add_f32 v[84:85], v[84:85], v[92:93]
  v_pk_add_f32 v[220:221], v[220:221], v[228:229]
  v_pk_add_f32 v[86:87], v[86:87], v[94:95]
  v_pk_add_f32 v[222:223], v[222:223], v[230:231]
  v_pk_add_f32 v[88:89], v[88:89], v[96:97]
  v_pk_add_f32 v[224:225], v[224:225], v[232:233]
  v_pk_add_f32 v[90:91], v[90:91], v[98:99]
  v_pk_add_f32 v[226:227], v[226:227], v[234:235]
  v_pk_add_f32 v[84:85], v[84:85], v[88:89]
  v_pk_add_f32 v[220:221], v[220:221], v[224:225]
  v_pk_add_f32 v[86:87], v[86:87], v[90:91]
  v_pk_add_f32 v[222:223], v[222:223], v[226:227]
  v_cvt_pk_bf16_f32 v184, v220, v221
  v_lshlrev_b32 v220, 16, v184
  v_and_b32 v221, 0xffff0000, v184
  v_cvt_pk_bf16_f32 v184, v222, v223
  v_lshlrev_b32 v222, 16, v184
  v_and_b32 v223, 0xffff0000, v184
  ds_write_b128 v14, v[220:223] offset:1024
  v_cvt_pk_bf16_f32 v184, v84, v85
  v_lshlrev_b32 v84, 16, v184
  v_and_b32 v85, 0xffff0000, v184
  v_pk_add_f32 v[84:85], v[84:85], 1.0 op_sel_hi:[1,0]
  v_cvt_pk_bf16_f32 v184, v84, v85
  v_lshlrev_b32 v84, 16, v184
  v_and_b32 v85, 0xffff0000, v184
  v_cvt_pk_bf16_f32 v184, v86, v87
  v_lshlrev_b32 v86, 16, v184
  v_and_b32 v87, 0xffff0000, v184
  v_pk_add_f32 v[86:87], v[86:87], 1.0 op_sel_hi:[1,0]
  v_cvt_pk_bf16_f32 v184, v86, v87
  v_lshlrev_b32 v86, 16, v184
  v_and_b32 v87, 0xffff0000, v184
  ds_write_b128 v14, v[84:87]
  ds_read_b128 v[220:223], v15 offset:1024
  ds_read_b128 v[84:87], v15 offset:0
  ds_read_b128 v[224:227], v15 offset:1040
  ds_read_b128 v[88:91], v15 offset:16
  ds_read_b128 v[228:231], v15 offset:1280
  ds_read_b128 v[92:95], v15 offset:256
  ds_read_b128 v[232:235], v15 offset:1296
  ds_read_b128 v[96:99], v15 offset:272
  ds_read_b128 v[236:239], v15 offset:1536
  ds_read_b128 v[100:103], v15 offset:512
  ds_read_b128 v[240:243], v15 offset:1552
  ds_read_b128 v[104:107], v15 offset:528
  ds_read_b128 v[244:247], v15 offset:1792
  ds_read_b128 v[108:111], v15 offset:768
  ds_read_b128 v[248:251], v15 offset:1808
  ds_read_b128 v[112:115], v15 offset:784
  s_waitcnt lgkmcnt(12)
  v_pk_fma_f32 v[20:21], v[20:21], v[84:85], v[220:221]
  v_pk_fma_f32 v[22:23], v[22:23], v[86:87], v[222:223]
  v_pk_fma_f32 v[24:25], v[24:25], v[88:89], v[224:225]
  v_pk_fma_f32 v[26:27], v[26:27], v[90:91], v[226:227]
  v_pk_fma_f32 v[52:53], v[52:53], v[84:85], v[220:221]
  v_pk_fma_f32 v[54:55], v[54:55], v[86:87], v[222:223]
  v_pk_fma_f32 v[56:57], v[56:57], v[88:89], v[224:225]
  v_pk_fma_f32 v[58:59], v[58:59], v[90:91], v[226:227]
  v_cvt_pk_bf16_f32 v136, v20, v21
  v_cvt_pk_bf16_f32 v137, v22, v23
  v_cvt_pk_bf16_f32 v138, v24, v25
  v_cvt_pk_bf16_f32 v139, v26, v27
  v_cvt_pk_bf16_f32 v152, v52, v53
  v_cvt_pk_bf16_f32 v153, v54, v55
  v_cvt_pk_bf16_f32 v154, v56, v57
  v_cvt_pk_bf16_f32 v155, v58, v59
  v_permlane16_swap_b32 v136, v138
  v_permlane16_swap_b32 v137, v139
  v_permlane16_swap_b32 v152, v154
  v_permlane16_swap_b32 v153, v155
  buffer_store_dwordx4 v[136:139], v132, s[36:39], s50 offen offset:0 sc1
  buffer_store_dwordx4 v[152:155], v132, s[36:39], s50 offen offset:128 sc1
  s_add_u32 s50, s50, 4096
  s_waitcnt lgkmcnt(8)
  v_pk_fma_f32 v[28:29], v[28:29], v[92:93], v[228:229]
  v_pk_fma_f32 v[30:31], v[30:31], v[94:95], v[230:231]
  v_pk_fma_f32 v[32:33], v[32:33], v[96:97], v[232:233]
  v_pk_fma_f32 v[34:35], v[34:35], v[98:99], v[234:235]
  v_pk_fma_f32 v[60:61], v[60:61], v[92:93], v[228:229]
  v_pk_fma_f32 v[62:63], v[62:63], v[94:95], v[230:231]
  v_pk_fma_f32 v[64:65], v[64:65], v[96:97], v[232:233]
  v_pk_fma_f32 v[66:67], v[66:67], v[98:99], v[234:235]
  v_cvt_pk_bf16_f32 v140, v28, v29
  v_cvt_pk_bf16_f32 v141, v30, v31
  v_cvt_pk_bf16_f32 v142, v32, v33
  v_cvt_pk_bf16_f32 v143, v34, v35
  v_cvt_pk_bf16_f32 v156, v60, v61
  v_cvt_pk_bf16_f32 v157, v62, v63
  v_cvt_pk_bf16_f32 v158, v64, v65
  v_cvt_pk_bf16_f32 v159, v66, v67
  v_permlane16_swap_b32 v140, v142
  v_permlane16_swap_b32 v141, v143
  v_permlane16_swap_b32 v156, v158
  v_permlane16_swap_b32 v157, v159
  buffer_store_dwordx4 v[140:143], v132, s[36:39], s50 offen offset:0 sc1
  buffer_store_dwordx4 v[156:159], v132, s[36:39], s50 offen offset:128 sc1
  s_add_u32 s50, s50, 4096
  s_waitcnt lgkmcnt(4)
  v_pk_fma_f32 v[36:37], v[36:37], v[100:101], v[236:237]
  v_pk_fma_f32 v[38:39], v[38:39], v[102:103], v[238:239]
  v_pk_fma_f32 v[40:41], v[40:41], v[104:105], v[240:241]
  v_pk_fma_f32 v[42:43], v[42:43], v[106:107], v[242:243]
  v_pk_fma_f32 v[68:69], v[68:69], v[100:101], v[236:237]
  v_pk_fma_f32 v[70:71], v[70:71], v[102:103], v[238:239]
  v_pk_fma_f32 v[72:73], v[72:73], v[104:105], v[240:241]
  v_pk_fma_f32 v[74:75], v[74:75], v[106:107], v[242:243]
  v_cvt_pk_bf16_f32 v144, v36, v37
  v_cvt_pk_bf16_f32 v145, v38, v39
  v_cvt_pk_bf16_f32 v146, v40, v41
  v_cvt_pk_bf16_f32 v147, v42, v43
  v_cvt_pk_bf16_f32 v160, v68, v69
  v_cvt_pk_bf16_f32 v161, v70, v71
  v_cvt_pk_bf16_f32 v162, v72, v73
  v_cvt_pk_bf16_f32 v163, v74, v75
  v_permlane16_swap_b32 v144, v146
  v_permlane16_swap_b32 v145, v147
  v_permlane16_swap_b32 v160, v162
  v_permlane16_swap_b32 v161, v163
  buffer_store_dwordx4 v[144:147], v132, s[36:39], s50 offen offset:0 sc1
  buffer_store_dwordx4 v[160:163], v132, s[36:39], s50 offen offset:128 sc1
  s_add_u32 s50, s50, 4096
  s_waitcnt lgkmcnt(0)
  v_pk_fma_f32 v[44:45], v[44:45], v[108:109], v[244:245]
  v_pk_fma_f32 v[46:47], v[46:47], v[110:111], v[246:247]
  v_pk_fma_f32 v[48:49], v[48:49], v[112:113], v[248:249]
  v_pk_fma_f32 v[50:51], v[50:51], v[114:115], v[250:251]
  v_pk_fma_f32 v[76:77], v[76:77], v[108:109], v[244:245]
  v_pk_fma_f32 v[78:79], v[78:79], v[110:111], v[246:247]
  v_pk_fma_f32 v[80:81], v[80:81], v[112:113], v[248:249]
  v_pk_fma_f32 v[82:83], v[82:83], v[114:115], v[250:251]
  v_cvt_pk_bf16_f32 v148, v44, v45
  v_cvt_pk_bf16_f32 v149, v46, v47
  v_cvt_pk_bf16_f32 v150, v48, v49
  v_cvt_pk_bf16_f32 v151, v50, v51
  v_cvt_pk_bf16_f32 v164, v76, v77
  v_cvt_pk_bf16_f32 v165, v78, v79
  v_cvt_pk_bf16_f32 v166, v80, v81
  v_cvt_pk_bf16_f32 v167, v82, v83
  v_permlane16_swap_b32 v148, v150
  v_permlane16_swap_b32 v149, v151
  v_permlane16_swap_b32 v164, v166
  v_permlane16_swap_b32 v165, v167
  buffer_store_dwordx4 v[148:151], v132, s[36:39], s50 offen offset:0 sc1
  buffer_store_dwordx4 v[164:167], v132, s[36:39], s50 offen offset:128 sc1
  v_mov_b32 v12, s3
  s_waitcnt vmcnt(0) lgkmcnt(0)
  s_barrier
  s_mov_b64 exec, 1
  buffer_store_dword v12, v0, s[36:39], s45 offen sc1
  s_mov_b64 exec, -1
J2:
  s_mov_b32 s61, 0
  s_add_u32 m0, s63, 21504
  s_nop 0
  buffer_load_dwordx4 v202, s[8:11], s61 offen offset:0 lds
  s_mov_b32 s61, 2048
  s_add_u32 m0, s63, 43008
  s_nop 0
  buffer_load_dwordx4 v202, s[8:11], s61 offen offset:0 lds
  buffer_load_dwordx4 v203, s[8:11], s61 offen offset:1024 lds
  s_mov_b32 s61, 4096
  s_add_u32 m0, s63, 64512
  s_nop 0
  buffer_load_dwordx4 v202, s[8:11], s61 offen offset:0 lds
  buffer_load_dwordx4 v203, s[8:11], s61 offen offset:1024 lds
  buffer_load_dwordx4 v204, s[8:11], s61 offen offset:2048 lds
  s_mov_b32 s61, 196608
  s_add_u32 m0, s63, 86016
  s_nop 0
  buffer_load_dwordx4 v202, s[8:11], s61 offen offset:0 lds
  buffer_load_dwordx4 v203, s[8:11], s61 offen offset:1024 lds
  buffer_load_dwordx4 v204, s[8:11], s61 offen offset:2048 lds
  s_mov_b32 s61, 395264
  s_add_u32 m0, s63, 107520
  s_nop 0
  buffer_load_dwordx4 v202, s[8:11], s61 offen offset:0 lds
  buffer_load_dwordx4 v203, s[8:11], s61 offen offset:1024 lds
  buffer_load_dwordx4 v204, s[8:11], s61 offen offset:2048 lds
  s_mov_b32 s61, 593920
  s_add_u32 m0, s63, 129024
  s_nop 0
  buffer_load_dwordx4 v202, s[8:11], s61 offen offset:0 lds
  buffer_load_dwordx4 v203, s[8:11], s61 offen offset:1024 lds
  buffer_load_dwordx4 v204, s[8:11], s61 offen offset:2048 lds
  s_mov_b32 s61, 786432
  s_add_u32 m0, s63, 0
  s_nop 0
  buffer_load_dwordx4 v202, s[8:11], s61 offen offset:0 lds
  buffer_load_dwordx4 v203, s[8:11], s61 offen offset:1024 lds
  buffer_load_dwordx4 v204, s[8:11], s61 offen offset:2048 lds
  s_mov_b64 exec, 0
  s_cmp_eq_u32 s44, 1
  s_cbranch_scc1 Ha0
  s_cmp_eq_u32 s44, 2
  s_cbranch_scc1 Ha1
  s_cmp_eq_u32 s44, 3
  s_cbranch_scc1 Ha2
Ra:
  s_mov_b64 exec, -1
  s_cmp_lg_u32 s44, 0
  s_cbranch_scc1 SM2x
  s_mov_b32 s46, 60000
  s_mov_b32 s47, 5242880
SM2:
  buffer_load_dword v12, v215, s[36:39], s47 offen sc1
  s_sub_u32 s46, s46, 1
  s_cmp_eq_u32 s46, 0
  s_waitcnt vmcnt(0)
  s_cbranch_scc1 SM2x
  v_cmp_ne_u32 vcc, s3, v12
  s_nop 4
  s_cbranch_vccnz SM2
SM2x:
  s_barrier
  s_mov_b32 s62, 0
  s_add_u32 m0, s64, 33792
  s_nop 0
  buffer_load_dwordx4 v205, s[36:39], s62 offen offset:0 sc1 lds
  buffer_load_dwordx4 v205, s[36:39], s62 offen offset:1024 sc1 lds
  s_add_u32 m0, s65, 41984
  s_nop 0
  buffer_load_dword v206, s[36:39], s62 offen sc1 lds
  s_mov_b32 s62, 2048
  s_add_u32 m0, s64, 55296
  s_nop 0
  buffer_load_dwordx4 v205, s[36:39], s62 offen offset:0 sc1 lds
  buffer_load_dwordx4 v205, s[36:39], s62 offen offset:1024 sc1 lds
  s_add_u32 m0, s65, 63488
  s_nop 0
  buffer_load_dword v206, s[36:39], s62 offen sc1 lds
  s_mov_b32 s62, 4096
  s_add_u32 m0, s64, 76800
  s_nop 0
  buffer_load_dwordx4 v205, s[36:39], s62 offen offset:0 sc1 lds
  buffer_load_dwordx4 v205, s[36:39], s62 offen offset:1024 sc1 lds
  s_add_u32 m0, s65, 84992
  s_nop 0
  buffer_load_dword v206, s[36:39], s62 offen sc1 lds
  s_mov_b32 s62, 6144
Ha0:
  s_cbranch_execz Ha0_1
  s_add_u32 m0, s64, 98304
  s_nop 0
  buffer_load_dwordx4 v205, s[36:39], s62 offen offset:0 sc1 lds
  buffer_load_dwordx4 v205, s[36:39], s62 offen offset:1024 sc1 lds
  s_add_u32 m0, s65, 106496
  s_nop 0
  buffer_load_dword v206, s[36:39], s62 offen sc1 lds
  s_waitcnt vmcnt(6)
  s_barrier
  ds_read_b64_tr_b16 a[80:81], v196 offset:21504
  ds_read_b64_tr_b16 a[82:83], v196 offset:27648
  ds_read_b64_tr_b16 a[84:85], v197 offset:21504
  ds_read_b64_tr_b16 a[86:87], v197 offset:27648
  ds_read_b64_tr_b16 a[88:89], v196 offset:43008
  ds_read_b64_tr_b16 a[90:91], v196 offset:49152
  ds_read_b64_tr_b16 a[92:93], v196 offset:44032
  ds_read_b64_tr_b16 a[94:95], v196 offset:50176
  ds_read_b64_tr_b16 a[96:97], v197 offset:43008
  ds_read_b128 a[0:3], v207 offset:33792
  ds_read_b128 a[4:7], v207 offset:34816
  ds_read_b128 a[8:11], v207 offset:35840
  ds_read_b128 a[12:15], v207 offset:36864
  ds_read_b128 a[16:19], v210 offset:41984
  s_waitcnt lgkmcnt(0)
  v_mfma_f32_16x16x32_bf16 v[84:87], a[80:83], a[0:3], 0
  s_mov_b32 s62, 8192
  ds_read_b128 a[20:23], v207 offset:55296
  s_add_u32 m0, s64, 119808
  v_mfma_f32_16x16x32_bf16 v[88:91], a[80:83], a[4:7], 0
  s_waitcnt vmcnt(3)
  s_barrier
  ds_read_b128 a[24:27], v207 offset:56320
  v_mfma_f32_16x16x32_bf16 v[92:95], a[80:83], a[8:11], 0
  ds_read_b128 a[28:31], v207 offset:57344
  v_mfma_f32_16x16x32_bf16 v[96:99], a[80:83], a[12:15], 0
  s_waitcnt lgkmcnt(13)
  ds_read_b128 a[32:35], v207 offset:58368
  v_mfma_f32_16x16x32_bf16 v[112:115], a[84:87], a[12:15], 0
  ds_read_b128 a[36:39], v210 offset:63488
  v_mfma_f32_16x16x32_bf16 v[108:111], a[84:87], a[8:11], 0
  buffer_load_dwordx4 v205, s[36:39], s62 offen offset:0 sc1 lds
  v_mfma_f32_16x16x32_bf16 v[104:107], a[84:87], a[4:7], 0
  ds_read_b64_tr_b16 a[98:99], v197 offset:49152
  v_mfma_f32_16x16x32_bf16 v[100:103], a[84:87], a[0:3], 0
  s_waitcnt lgkmcnt(1)
  ds_read_b64_tr_b16 a[100:101], v197 offset:44032
  v_mfma_f32_16x16x32_bf16 v[20:23], a[88:91], a[0:3], 0
  ds_read_b64_tr_b16 a[102:103], v197 offset:50176
  v_mfma_f32_16x16x32_bf16 v[20:23], a[92:95], a[20:23], v[20:23]
  buffer_load_dwordx4 v205, s[36:39], s62 offen offset:1024 sc1 lds
  s_add_u32 m0, s65, 128000
  v_mfma_f32_16x16x32_bf16 v[24:27], a[92:95], a[24:27], 0
  ds_read_b128 a[40:43], v208 offset:12288
  v_mfma_f32_16x16x32_bf16 v[24:27], a[88:91], a[4:7], v[24:27]
  ds_read_b64_tr_b16 a[104:105], v198 offset:0
  v_mfma_f32_16x16x32_bf16 v[28:31], a[88:91], a[8:11], 0
  ds_read_b128 a[44:47], v208 offset:13312
  v_mfma_f32_16x16x32_bf16 v[28:31], a[92:95], a[28:31], v[28:31]
  buffer_load_dword v206, s[36:39], s62 offen sc1 lds
  s_mov_b32 s62, 10240
  v_mfma_f32_16x16x32_bf16 v[32:35], a[92:95], a[32:35], 0
  s_add_u32 m0, s64, 141312
  ds_read_b64_tr_b16 a[106:107], v198 offset:6144
  v_mfma_f32_16x16x32_bf16 v[32:35], a[88:91], a[12:15], v[32:35]
  ds_read_b128 a[48:51], v208 offset:14336
  v_mfma_f32_16x16x32_bf16 v[116:119], a[88:91], a[16:19], 0
  ds_read_b64_tr_b16 a[108:109], v198 offset:1024
  v_mfma_f32_16x16x32_bf16 v[116:119], a[92:95], a[36:39], v[116:119]
  s_waitcnt lgkmcnt(6)
  ds_read_b128 a[52:55], v208 offset:15360
  v_mfma_f32_16x16x32_bf16 v[48:51], a[96:99], a[12:15], 0
  buffer_load_dwordx4 v205, s[36:39], s62 offen offset:0 sc1 lds
  v_mfma_f32_16x16x32_bf16 v[48:51], a[100:103], a[32:35], v[48:51]
  ds_read_b128 a[56:59], v211 offset:20480
  v_mfma_f32_16x16x32_bf16 v[44:47], a[100:103], a[28:31], 0
  ds_read_b64_tr_b16 a[110:111], v198 offset:7168
  v_mfma_f32_16x16x32_bf16 v[44:47], a[96:99], a[8:11], v[44:47]
  ds_read_b64_tr_b16 a[112:113], v198 offset:2048
  v_mfma_f32_16x16x32_bf16 v[40:43], a[96:99], a[4:7], 0
  buffer_load_dwordx4 v205, s[36:39], s62 offen offset:1024 sc1 lds
  s_add_u32 m0, s65, 149504
  v_mfma_f32_16x16x32_bf16 v[40:43], a[100:103], a[24:27], v[40:43]
  ds_read_b64_tr_b16 a[114:115], v198 offset:8192
  v_mfma_f32_16x16x32_bf16 v[36:39], a[100:103], a[20:23], 0
  ds_read_b64_tr_b16 a[80:81], v199 offset:0
  v_mfma_f32_16x16x32_bf16 v[36:39], a[96:99], a[0:3], v[36:39]
  s_waitcnt lgkmcnt(1)
  ds_read_b64_tr_b16 a[82:83], v199 offset:6144
  v_mfma_f32_16x16x32_bf16 v[52:55], a[0:3], a[104:107], 0
  buffer_load_dword v206, s[36:39], s62 offen sc1 lds
  s_mov_b32 s62, 12288
  v_mfma_f32_16x16x32_bf16 v[52:55], a[20:23], a[108:111], v[52:55]
  s_add_u32 m0, s64, 12288
  ds_read_b64_tr_b16 a[84:85], v199 offset:1024
  v_mfma_f32_16x16x32_bf16 v[52:55], a[40:43], a[112:115], v[52:55]
  s_waitcnt vmcnt(6)
  s_barrier
  ds_read_b64_tr_b16 a[86:87], v199 offset:7168
  v_mfma_f32_16x16x32_bf16 v[56:59], a[44:47], a[112:115], 0
  ds_read_b64_tr_b16 a[88:89], v199 offset:2048
  v_mfma_f32_16x16x32_bf16 v[56:59], a[24:27], a[108:111], v[56:59]
  buffer_load_dwordx4 v205, s[36:39], s62 offen offset:0 sc1 lds
  v_mfma_f32_16x16x32_bf16 v[56:59], a[4:7], a[104:107], v[56:59]
  ds_read_b64_tr_b16 a[90:91], v199 offset:8192
  v_mfma_f32_16x16x32_bf16 v[60:63], a[8:11], a[104:107], 0
  ds_read_b128 a[60:63], v208 offset:33792
  v_mfma_f32_16x16x32_bf16 v[60:63], a[28:31], a[108:111], v[60:63]
  ds_read_b64_tr_b16 a[92:93], v198 offset:21504
  v_mfma_f32_16x16x32_bf16 v[60:63], a[48:51], a[112:115], v[60:63]
  buffer_load_dwordx4 v205, s[36:39], s62 offen offset:1024 sc1 lds
  s_add_u32 m0, s65, 20480
  v_mfma_f32_16x16x32_bf16 v[64:67], a[52:55], a[112:115], 0
  ds_read_b128 a[64:67], v208 offset:34816
  v_mfma_f32_16x16x32_bf16 v[64:67], a[32:35], a[108:111], v[64:67]
  ds_read_b64_tr_b16 a[94:95], v198 offset:27648
  v_mfma_f32_16x16x32_bf16 v[64:67], a[12:15], a[104:107], v[64:67]
  ds_read_b128 a[68:71], v208 offset:35840
  v_mfma_f32_16x16x32_bf16 v[120:123], a[16:19], a[104:107], 0
  buffer_load_dword v206, s[36:39], s62 offen sc1 lds
  s_mov_b32 s61, 985088
  v_mfma_f32_16x16x32_bf16 v[120:123], a[36:39], a[108:111], v[120:123]
  s_add_u32 m0, s63, 21504
  ds_read_b64_tr_b16 a[96:97], v198 offset:22528
  v_mfma_f32_16x16x32_bf16 v[120:123], a[56:59], a[112:115], v[120:123]
  s_waitcnt lgkmcnt(6)
  ds_read_b128 a[72:75], v208 offset:36864
  v_mfma_f32_16x16x32_bf16 v[80:83], a[12:15], a[80:83], 0
  ds_read_b64_tr_b16 a[98:99], v198 offset:28672
  v_mfma_f32_16x16x32_bf16 v[80:83], a[32:35], a[84:87], v[80:83]
  buffer_load_dwordx4 v202, s[8:11], s61 offen offset:0 lds
  v_mfma_f32_16x16x32_bf16 v[80:83], a[52:55], a[88:91], v[80:83]
  ds_read_b128 a[76:79], v211 offset:41984
  v_mfma_f32_16x16x32_bf16 v[76:79], a[48:51], a[88:91], 0
  ds_read_b64_tr_b16 a[100:101], v198 offset:23552
  v_mfma_f32_16x16x32_bf16 v[76:79], a[28:31], a[84:87], v[76:79]
  ds_read_b64_tr_b16 a[102:103], v198 offset:29696
  v_mfma_f32_16x16x32_bf16 v[76:79], a[8:11], a[80:83], v[76:79]
  buffer_load_dwordx4 v203, s[8:11], s61 offen offset:1024 lds
  v_mfma_f32_16x16x32_bf16 v[72:75], a[4:7], a[80:83], 0
  ds_read_b64_tr_b16 a[104:105], v199 offset:21504
  v_mfma_f32_16x16x32_bf16 v[72:75], a[24:27], a[84:87], v[72:75]
  ds_read_b64_tr_b16 a[106:107], v199 offset:27648
  v_mfma_f32_16x16x32_bf16 v[72:75], a[44:47], a[88:91], v[72:75]
  ds_read_b64_tr_b16 a[108:109], v199 offset:22528
  v_mfma_f32_16x16x32_bf16 v[68:71], a[40:43], a[88:91], 0
  buffer_load_dwordx4 v204, s[8:11], s61 offen offset:2048 lds
  s_mov_b32 s62, 14336
  v_mfma_f32_16x16x32_bf16 v[68:71], a[20:23], a[84:87], v[68:71]
  s_add_u32 m0, s64, 33792
  ds_read_b64_tr_b16 a[110:111], v199 offset:28672
  v_mfma_f32_16x16x32_bf16 v[68:71], a[0:3], a[80:83], v[68:71]
  s_waitcnt vmcnt(9) lgkmcnt(4)
  s_barrier
  v_mfma_f32_16x16x32_bf16 v[84:87], a[92:95], a[20:23], v[84:87]
  ds_read_b64_tr_b16 a[112:113], v199 offset:23552
  v_mfma_f32_16x16x32_bf16 v[84:87], a[96:99], a[40:43], v[84:87]
  buffer_load_dwordx4 v205, s[36:39], s62 offen offset:0 sc1 lds
  v_mfma_f32_16x16x32_bf16 v[84:87], a[100:103], a[60:63], v[84:87]
  ds_read_b64_tr_b16 a[114:115], v199 offset:29696
  v_mfma_f32_16x16x32_bf16 v[88:91], a[100:103], a[64:67], v[88:91]
  ds_read_b128 a[0:3], v208 offset:55296
  v_mfma_f32_16x16x32_bf16 v[88:91], a[96:99], a[44:47], v[88:91]
  ds_read_b64_tr_b16 a[80:81], v198 offset:43008
  v_mfma_f32_16x16x32_bf16 v[88:91], a[92:95], a[24:27], v[88:91]
  buffer_load_dwordx4 v205, s[36:39], s62 offen offset:1024 sc1 lds
  s_add_u32 m0, s65, 41984
  v_mfma_f32_16x16x32_bf16 v[92:95], a[92:95], a[28:31], v[92:95]
  ds_read_b128 a[4:7], v208 offset:56320
  v_mfma_f32_16x16x32_bf16 v[92:95], a[96:99], a[48:51], v[92:95]
  ds_read_b64_tr_b16 a[82:83], v198 offset:49152
  v_mfma_f32_16x16x32_bf16 v[92:95], a[100:103], a[68:71], v[92:95]
  ds_read_b128 a[8:11], v208 offset:57344
  v_mfma_f32_16x16x32_bf16 v[96:99], a[100:103], a[72:75], v[96:99]
  buffer_load_dword v206, s[36:39], s62 offen sc1 lds
  s_mov_b32 s61, 1183744
  v_mfma_f32_16x16x32_bf16 v[96:99], a[96:99], a[52:55], v[96:99]
  s_add_u32 m0, s63, 43008
  ds_read_b64_tr_b16 a[84:85], v198 offset:44032
  v_mfma_f32_16x16x32_bf16 v[96:99], a[92:95], a[32:35], v[96:99]
  s_waitcnt lgkmcnt(6)
  ds_read_b128 a[12:15], v208 offset:58368
  v_mfma_f32_16x16x32_bf16 v[112:115], a[104:107], a[32:35], v[112:115]
  ds_read_b128 a[16:19], v211 offset:63488
  v_mfma_f32_16x16x32_bf16 v[112:115], a[108:111], a[52:55], v[112:115]
  buffer_load_dwordx4 v202, s[8:11], s61 offen offset:0 lds
  v_mfma_f32_16x16x32_bf16 v[112:115], a[112:115], a[72:75], v[112:115]
  ds_read_b64_tr_b16 a[86:87], v198 offset:50176
  v_mfma_f32_16x16x32_bf16 v[108:111], a[112:115], a[68:71], v[108:111]
  ds_read_b64_tr_b16 a[88:89], v198 offset:45056
  v_mfma_f32_16x16x32_bf16 v[108:111], a[108:111], a[48:51], v[108:111]
  ds_read_b64_tr_b16 a[90:91], v198 offset:51200
  v_mfma_f32_16x16x32_bf16 v[108:111], a[104:107], a[28:31], v[108:111]
  buffer_load_dwordx4 v203, s[8:11], s61 offen offset:1024 lds
  v_mfma_f32_16x16x32_bf16 v[104:107], a[104:107], a[24:27], v[104:107]
  v_mfma_f32_16x16x32_bf16 v[104:107], a[108:111], a[44:47], v[104:107]
  ds_read_b64_tr_b16 a[92:93], v199 offset:43008
  v_mfma_f32_16x16x32_bf16 v[104:107], a[112:115], a[64:67], v[104:107]
  v_mfma_f32_16x16x32_bf16 v[100:103], a[112:115], a[60:63], v[100:103]
  buffer_load_dwordx4 v204, s[8:11], s61 offen offset:2048 lds
  s_mov_b32 s62, 16384
  v_mfma_f32_16x16x32_bf16 v[100:103], a[108:111], a[40:43], v[100:103]
  s_add_u32 m0, s64, 55296
  ds_read_b64_tr_b16 a[94:95], v199 offset:49152
  v_mfma_f32_16x16x32_bf16 v[100:103], a[104:107], a[20:23], v[100:103]
  s_waitcnt lgkmcnt(2)
  ds_read_b64_tr_b16 a[96:97], v199 offset:44032
  v_mfma_f32_16x16x32_bf16 v[20:23], a[80:83], a[40:43], v[20:23]
  v_mfma_f32_16x16x32_bf16 v[20:23], a[84:87], a[60:63], v[20:23]
  buffer_load_dwordx4 v205, s[36:39], s62 offen offset:0 sc1 lds
  v_mfma_f32_16x16x32_bf16 v[20:23], a[88:91], a[0:3], v[20:23]
  s_waitcnt vmcnt(13)
  s_barrier
  ds_read_b64_tr_b16 a[98:99], v199 offset:50176
  v_mfma_f32_16x16x32_bf16 v[24:27], a[88:91], a[4:7], v[24:27]
  ds_read_b64_tr_b16 a[100:101], v199 offset:45056
  v_mfma_f32_16x16x32_bf16 v[24:27], a[84:87], a[64:67], v[24:27]
  v_mfma_f32_16x16x32_bf16 v[24:27], a[80:83], a[44:47], v[24:27]
  buffer_load_dwordx4 v205, s[36:39], s62 offen offset:1024 sc1 lds
  s_add_u32 m0, s65, 63488
  v_mfma_f32_16x16x32_bf16 v[28:31], a[80:83], a[48:51], v[28:31]
  ds_read_b64_tr_b16 a[102:103], v199 offset:51200
  v_mfma_f32_16x16x32_bf16 v[28:31], a[84:87], a[68:71], v[28:31]
  ds_read_b128 a[20:23], v209 offset:12288
  v_mfma_f32_16x16x32_bf16 v[28:31], a[88:91], a[8:11], v[28:31]
  ds_read_b64_tr_b16 a[104:105], v200 offset:0
  v_mfma_f32_16x16x32_bf16 v[32:35], a[88:91], a[12:15], v[32:35]
  buffer_load_dword v206, s[36:39], s62 offen sc1 lds
  s_mov_b32 s61, 1376256
  v_mfma_f32_16x16x32_bf16 v[32:35], a[84:87], a[72:75], v[32:35]
  s_add_u32 m0, s63, 64512
  ds_read_b128 a[24:27], v209 offset:13312
  v_mfma_f32_16x16x32_bf16 v[32:35], a[80:83], a[52:55], v[32:35]
  ds_read_b64_tr_b16 a[106:107], v200 offset:6144
  v_mfma_f32_16x16x32_bf16 v[116:119], a[80:83], a[56:59], v[116:119]
  ds_read_b128 a[28:31], v209 offset:14336
  v_mfma_f32_16x16x32_bf16 v[116:119], a[84:87], a[76:79], v[116:119]
  buffer_load_dwordx4 v202, s[8:11], s61 offen offset:0 lds
  v_mfma_f32_16x16x32_bf16 v[116:119], a[88:91], a[16:19], v[116:119]
  s_waitcnt lgkmcnt(5)
  ds_read_b64_tr_b16 a[108:109], v200 offset:1024
  v_mfma_f32_16x16x32_bf16 v[48:51], a[92:95], a[52:55], v[48:51]
  ds_read_b128 a[32:35], v209 offset:15360
  v_mfma_f32_16x16x32_bf16 v[48:51], a[96:99], a[72:75], v[48:51]
  ds_read_b128 a[36:39], v212 offset:20480
  v_mfma_f32_16x16x32_bf16 v[48:51], a[100:103], a[12:15], v[48:51]
  buffer_load_dwordx4 v203, s[8:11], s61 offen offset:1024 lds
  v_mfma_f32_16x16x32_bf16 v[44:47], a[100:103], a[8:11], v[44:47]
  ds_read_b64_tr_b16 a[110:111], v200 offset:7168
  v_mfma_f32_16x16x32_bf16 v[44:47], a[96:99], a[68:71], v[44:47]
  ds_read_b64_tr_b16 a[112:113], v200 offset:2048
  v_mfma_f32_16x16x32_bf16 v[44:47], a[92:95], a[48:51], v[44:47]
  ds_read_b64_tr_b16 a[114:115], v200 offset:8192
  v_mfma_f32_16x16x32_bf16 v[40:43], a[92:95], a[44:47], v[40:43]
  buffer_load_dwordx4 v204, s[8:11], s61 offen offset:2048 lds
  s_mov_b32 s62, 18432
  v_mfma_f32_16x16x32_bf16 v[40:43], a[96:99], a[64:67], v[40:43]
  s_add_u32 m0, s64, 76800
  ds_read_b64_tr_b16 a[80:81], v201 offset:0
  v_mfma_f32_16x16x32_bf16 v[40:43], a[100:103], a[4:7], v[40:43]
  s_bfe_u32 s54, s2, 0x30003
  s_xor_b32 s54, s54, 1
  s_and_b32 s48, s2, 1
  v_mfma_f32_16x16x32_bf16 v[36:39], a[100:103], a[0:3], v[36:39]
  s_lshl1_add_u32 s53, s54, s48
  ds_read_b64_tr_b16 a[82:83], v201 offset:6144
  v_mfma_f32_16x16x32_bf16 v[36:39], a[96:99], a[60:63], v[36:39]
  buffer_load_dwordx4 v205, s[36:39], s62 offen offset:0 sc1 lds
  v_mfma_f32_16x16x32_bf16 v[36:39], a[92:95], a[40:43], v[36:39]
  s_waitcnt lgkmcnt(2)
  ds_read_b64_tr_b16 a[84:85], v201 offset:1024
  v_mfma_f32_16x16x32_bf16 v[52:55], a[60:63], a[104:107], v[52:55]
  v_mfma_f32_16x16x32_bf16 v[52:55], a[0:3], a[108:111], v[52:55]
  ds_read_b64_tr_b16 a[86:87], v201 offset:7168
  v_mfma_f32_16x16x32_bf16 v[52:55], a[20:23], a[112:115], v[52:55]
  s_waitcnt vmcnt(16)
  s_barrier
  buffer_load_dwordx4 v205, s[36:39], s62 offen offset:1024 sc1 lds
  v_mfma_f32_16x16x32_bf16 v[56:59], a[24:27], a[112:115], v[56:59]
  s_add_u32 m0, s65, 84992
  ds_read_b64_tr_b16 a[88:89], v201 offset:2048
  s_bfe_u32 s52, s2, 0x20001
  v_mfma_f32_16x16x32_bf16 v[56:59], a[4:7], a[108:111], v[56:59]
  s_lshr_b32 s49, s2, 6
  s_lshl2_add_u32 s52, s52, s49
  s_lshl_b32 s70, s44, 12
  v_mfma_f32_16x16x32_bf16 v[56:59], a[64:67], a[104:107], v[56:59]
  ds_read_b64_tr_b16 a[90:91], v201 offset:8192
  v_mfma_f32_16x16x32_bf16 v[60:63], a[68:71], a[104:107], v[60:63]
  buffer_load_dword v206, s[36:39], s62 offen sc1 lds
  s_mov_b32 s61, 1574912
  v_mfma_f32_16x16x32_bf16 v[60:63], a[8:11], a[108:111], v[60:63]
  s_add_u32 m0, s63, 86016
  ds_read_b128 a[40:43], v207 offset:12288
  v_mfma_f32_16x16x32_bf16 v[60:63], a[28:31], a[112:115], v[60:63]
  s_lshl_b32 s48, s53, 7
  ds_read_b64_tr_b16 a[92:93], v196 offset:0
  s_lshl_b32 s49, s44, 16
  v_mfma_f32_16x16x32_bf16 v[64:67], a[32:35], a[112:115], v[64:67]
  s_add_u32 s48, s48, s49
  ds_read_b128 a[44:47], v207 offset:13312
  v_lshrrev_b32 v12, 3, v10
  v_mfma_f32_16x16x32_bf16 v[64:67], a[12:15], a[108:111], v[64:67]
  buffer_load_dwordx4 v202, s[8:11], s61 offen offset:0 lds
  v_lshlrev_b32 v12, 11, v12
  v_mfma_f32_16x16x32_bf16 v[64:67], a[72:75], a[104:107], v[64:67]
  ds_read_b64_tr_b16 a[94:95], v196 offset:6144
  v_add3_u32 v216, v12, v213, s48
  v_mfma_f32_16x16x32_bf16 v[120:123], a[76:79], a[104:107], v[120:123]
  ds_read_b128 a[48:51], v207 offset:14336
  v_mfma_f32_16x16x32_bf16 v[120:123], a[16:19], a[108:111], v[120:123]
  ds_read_b64_tr_b16 a[96:97], v196 offset:1024
  v_mfma_f32_16x16x32_bf16 v[120:123], a[36:39], a[112:115], v[120:123]
  s_waitcnt lgkmcnt(6)
  buffer_load_dwordx4 v203, s[8:11], s61 offen offset:1024 lds
  v_mfma_f32_16x16x32_bf16 v[80:83], a[72:75], a[80:83], v[80:83]
  ds_read_b128 a[52:55], v207 offset:15360
  v_mfma_f32_16x16x32_bf16 v[80:83], a[12:15], a[84:87], v[80:83]
  ds_read_b64_tr_b16 a[98:99], v196 offset:7168
  v_mfma_f32_16x16x32_bf16 v[80:83], a[32:35], a[88:91], v[80:83]
  ds_read_b128 a[56:59], v210 offset:20480
  v_mfma_f32_16x16x32_bf16 v[76:79], a[28:31], a[88:91], v[76:79]
  buffer_load_dwordx4 v204, s[8:11], s61 offen offset:2048 lds
  s_mov_b32 s62, 20480
  v_mfma_f32_16x16x32_bf16 v[76:79], a[8:11], a[84:87], v[76:79]
  s_add_u32 m0, s64, 98304
  ds_read_b64_tr_b16 a[100:101], v196 offset:2048
  v_add_u32 v217, 15360, v216
  v_mfma_f32_16x16x32_bf16 v[76:79], a[68:71], a[80:83], v[76:79]
  ds_read_b64_tr_b16 a[102:103], v196 offset:8192
  v_add_u32 v218, 30720, v216
  v_mfma_f32_16x16x32_bf16 v[72:75], a[64:67], a[80:83], v[72:75]
  ds_read_b64_tr_b16 a[104:105], v197 offset:0
  v_add_u32 v219, 46080, v216
  v_mfma_f32_16x16x32_bf16 v[72:75], a[4:7], a[84:87], v[72:75]
  buffer_load_dwordx4 v205, s[36:39], s62 offen offset:0 sc1 lds
  v_mfma_f32_16x16x32_bf16 v[72:75], a[24:27], a[88:91], v[72:75]
  s_lshl_b32 s55, s52, 18
  ds_read_b64_tr_b16 a[106:107], v197 offset:6144
  s_add_u32 s55, s55, s48
  v_mfma_f32_16x16x32_bf16 v[68:71], a[20:23], a[88:91], v[68:71]
  ds_read_b64_tr_b16 a[108:109], v197 offset:1024
  v_mfma_f32_16x16x32_bf16 v[68:71], a[0:3], a[84:87], v[68:71]
  ds_read_b64_tr_b16 a[110:111], v197 offset:7168
  v_mfma_f32_16x16x32_bf16 v[68:71], a[60:63], a[80:83], v[68:71]
  s_waitcnt vmcnt(16) lgkmcnt(4)
  s_barrier
  buffer_load_dwordx4 v205, s[36:39], s62 offen offset:1024 sc1 lds
  v_mfma_f32_16x16x32_bf16 v[84:87], a[92:95], a[0:3], v[84:87]
  s_add_u32 m0, s65, 106496
  ds_read_b64_tr_b16 a[112:113], v197 offset:2048
  v_and_b32 v13, 7, v10
  v_mfma_f32_16x16x32_bf16 v[84:87], a[96:99], a[20:23], v[84:87]
  v_lshrrev_b32 v14, 4, v10
  v_xor_b32 v13, v13, v14
  v_mfma_f32_16x16x32_bf16 v[84:87], a[100:103], a[40:43], v[84:87]
  ds_read_b64_tr_b16 a[114:115], v197 offset:8192
  v_lshl_add_u32 v220, v13, 4, v12
  v_mfma_f32_16x16x32_bf16 v[88:91], a[100:103], a[44:47], v[88:91]
  buffer_load_dword v206, s[36:39], s62 offen sc1 lds
  s_mov_b32 s61, 1773568
  v_mfma_f32_16x16x32_bf16 v[88:91], a[96:99], a[24:27], v[88:91]
  s_add_u32 m0, s63, 107520
  ds_read_b128 a[60:63], v207 offset:33792
  v_xor_b32 v221, 64, v220
  v_mfma_f32_16x16x32_bf16 v[88:91], a[92:95], a[4:7], v[88:91]
  ds_read_b64_tr_b16 a[80:81], v196 offset:21504
  v_add_u32 v221, 15360, v221
  v_mfma_f32_16x16x32_bf16 v[92:95], a[92:95], a[8:11], v[92:95]
  ds_read_b128 a[64:67], v207 offset:34816
  v_mfma_f32_16x16x32_bf16 v[92:95], a[96:99], a[28:31], v[92:95]
  buffer_load_dwordx4 v202, s[8:11], s61 offen offset:0 lds
  v_mfma_f32_16x16x32_bf16 v[92:95], a[100:103], a[48:51], v[92:95]
  s_lshl_b32 s48, s44, 10
  ds_read_b64_tr_b16 a[82:83], v196 offset:27648
  s_add_u32 s48, s48, 147456
  v_mfma_f32_16x16x32_bf16 v[96:99], a[100:103], a[52:55], v[96:99]
  ds_read_b128 a[68:71], v207 offset:35840
  v_add_u32 v247, s48, v0
  v_mfma_f32_16x16x32_bf16 v[96:99], a[96:99], a[32:35], v[96:99]
  ds_read_b64_tr_b16 a[84:85], v196 offset:22528
  v_lshl_add_u32 v245, v14, 4, s48
  v_mfma_f32_16x16x32_bf16 v[96:99], a[92:95], a[12:15], v[96:99]
  s_waitcnt lgkmcnt(6)
  buffer_load_dwordx4 v203, s[8:11], s61 offen offset:1024 lds
  v_and_b32 v12, 1, v10
  v_mfma_f32_16x16x32_bf16 v[112:115], a[104:107], a[12:15], v[112:115]
  ds_read_b128 a[72:75], v207 offset:36864
  v_lshlrev_b32 v12, 8, v12
  v_mfma_f32_16x16x32_bf16 v[112:115], a[108:111], a[32:35], v[112:115]
  ds_read_b128 a[76:79], v210 offset:41984
  v_sub_u32 v246, v245, v12
  v_mfma_f32_16x16x32_bf16 v[112:115], a[112:115], a[52:55], v[112:115]
  ds_read_b64_tr_b16 a[86:87], v196 offset:28672
  v_mfma_f32_16x16x32_bf16 v[108:111], a[112:115], a[48:51], v[108:111]
  buffer_load_dwordx4 v204, s[8:11], s61 offen offset:2048 lds
  s_mov_b32 s62, 22528
  v_mfma_f32_16x16x32_bf16 v[108:111], a[108:111], a[28:31], v[108:111]
  s_add_u32 m0, s64, 119808
  ds_read_b64_tr_b16 a[88:89], v196 offset:23552
  v_mfma_f32_16x16x32_bf16 v[108:111], a[104:107], a[8:11], v[108:111]
  ds_read_b64_tr_b16 a[90:91], v196 offset:29696
  v_mfma_f32_16x16x32_bf16 v[104:107], a[104:107], a[4:7], v[104:107]
  v_mfma_f32_16x16x32_bf16 v[104:107], a[108:111], a[24:27], v[104:107]
  buffer_load_dwordx4 v205, s[36:39], s62 offen offset:0 sc1 lds
  v_mfma_f32_16x16x32_bf16 v[104:107], a[112:115], a[44:47], v[104:107]
  s_lshl_b32 s48, s53, 7
  ds_read_b64_tr_b16 a[92:93], v197 offset:21504
  v_and_b32 v13, 0xf0, v0
  v_mfma_f32_16x16x32_bf16 v[100:103], a[112:115], a[40:43], v[100:103]
  ds_read_b64_tr_b16 a[94:95], v197 offset:27648
  v_lshl_add_u32 v13, v14, 12, v13
  v_mfma_f32_16x16x32_bf16 v[100:103], a[108:111], a[20:23], v[100:103]
  s_lshl1_add_u32 s48, s48, 8192
  v_add_u32 v249, s48, v13
  v_mfma_f32_16x16x32_bf16 v[100:103], a[104:107], a[0:3], v[100:103]
  s_waitcnt lgkmcnt(2)
  buffer_load_dwordx4 v205, s[36:39], s62 offen offset:1024 sc1 lds
  s_add_u32 m0, s65, 128000
  v_mfma_f32_16x16x32_bf16 v[20:23], a[80:83], a[20:23], v[20:23]
  ds_read_b64_tr_b16 a[96:97], v197 offset:22528
  v_mfma_f32_16x16x32_bf16 v[20:23], a[84:87], a[40:43], v[20:23]
  ds_read_b64_tr_b16 a[98:99], v197 offset:28672
  v_mfma_f32_16x16x32_bf16 v[20:23], a[88:91], a[60:63], v[20:23]
  s_waitcnt vmcnt(17)
  s_barrier
  v_mfma_f32_16x16x32_bf16 v[24:27], a[88:91], a[64:67], v[24:27]
  buffer_load_dword v206, s[36:39], s62 offen sc1 lds
  s_mov_b32 s61, 1966080
  v_mfma_f32_16x16x32_bf16 v[24:27], a[84:87], a[44:47], v[24:27]
  s_add_u32 m0, s63, 129024
  ds_read_b64_tr_b16 a[100:101], v197 offset:23552
  v_lshrrev_b32 v12, 2, v10
  v_mfma_f32_16x16x32_bf16 v[24:27], a[80:83], a[24:27], v[24:27]
  ds_read_b64_tr_b16 a[102:103], v197 offset:29696
  v_lshl_add_u32 v232, v12, 7, v214
  v_mfma_f32_16x16x32_bf16 v[28:31], a[80:83], a[28:31], v[28:31]
  ds_read_b128 a[0:3], v207 offset:55296
  v_mfma_f32_16x16x32_bf16 v[28:31], a[84:87], a[48:51], v[28:31]
  buffer_load_dwordx4 v202, s[8:11], s61 offen offset:0 lds
  v_xor_b32 v233, 32, v232
  v_mfma_f32_16x16x32_bf16 v[28:31], a[88:91], a[68:71], v[28:31]
  ds_read_b64_tr_b16 a[104:105], v196 offset:43008
  v_xor_b32 v234, 64, v232
  v_mfma_f32_16x16x32_bf16 v[32:35], a[88:91], a[72:75], v[32:35]
  ds_read_b128 a[4:7], v207 offset:56320
  v_mfma_f32_16x16x32_bf16 v[32:35], a[84:87], a[52:55], v[32:35]
  ds_read_b64_tr_b16 a[106:107], v196 offset:49152
  v_xor_b32 v235, 96, v232
  v_mfma_f32_16x16x32_bf16 v[32:35], a[80:83], a[32:35], v[32:35]
  buffer_load_dwordx4 v203, s[8:11], s61 offen offset:1024 lds
  v_mfma_f32_16x16x32_bf16 v[116:119], a[80:83], a[36:39], v[116:119]
  ds_read_b128 a[8:11], v207 offset:57344
  v_xor_b32 v236, 65536, v232
  v_mfma_f32_16x16x32_bf16 v[116:119], a[84:87], a[56:59], v[116:119]
  ds_read_b64_tr_b16 a[108:109], v196 offset:44032
  v_xor_b32 v237, 65568, v232
  v_mfma_f32_16x16x32_bf16 v[116:119], a[88:91], a[76:79], v[116:119]
  s_waitcnt lgkmcnt(6)
  ds_read_b128 a[12:15], v207 offset:58368
  v_mfma_f32_16x16x32_bf16 v[48:51], a[92:95], a[32:35], v[48:51]
  buffer_load_dwordx4 v204, s[8:11], s61 offen offset:2048 lds
  s_mov_b32 s62, 24576
  v_mfma_f32_16x16x32_bf16 v[48:51], a[96:99], a[52:55], v[48:51]
  s_add_u32 m0, s64, 141312
  ds_read_b128 a[16:19], v210 offset:63488
  v_xor_b32 v238, 65600, v232
  v_mfma_f32_16x16x32_bf16 v[48:51], a[100:103], a[72:75], v[48:51]
  ds_read_b64_tr_b16 a[110:111], v196 offset:50176
  v_xor_b32 v239, 65632, v232
  v_mfma_f32_16x16x32_bf16 v[44:47], a[100:103], a[68:71], v[44:47]
  s_add_u32 s48, s70, 131072
  ds_read_b64_tr_b16 a[112:113], v196 offset:45056
  v_and_b32 v12, 15, v10
  v_mfma_f32_16x16x32_bf16 v[44:47], a[96:99], a[48:51], v[44:47]
  buffer_load_dwordx4 v205, s[36:39], s62 offen offset:0 sc1 lds
  v_lshrrev_b32 v14, 1, v12
  v_mfma_f32_16x16x32_bf16 v[44:47], a[92:95], a[28:31], v[44:47]
  ds_read_b64_tr_b16 a[114:115], v196 offset:51200
  v_lshrrev_b32 v13, 5, v10
  v_mfma_f32_16x16x32_bf16 v[40:43], a[92:95], a[24:27], v[40:43]
  v_xor_b32 v14, v14, v13
  v_lshlrev_b32 v14, 4, v14
  v_mfma_f32_16x16x32_bf16 v[40:43], a[96:99], a[44:47], v[40:43]
  ds_read_b64_tr_b16 a[80:81], v197 offset:43008
  v_lshl_add_u32 v14, v12, 7, v14
  v_mfma_f32_16x16x32_bf16 v[40:43], a[100:103], a[64:67], v[40:43]
  buffer_load_dwordx4 v205, s[36:39], s62 offen offset:1024 sc1 lds
  s_add_u32 m0, s65, 149504
  v_mfma_f32_16x16x32_bf16 v[36:39], a[100:103], a[60:63], v[36:39]
  ds_read_b64_tr_b16 a[82:83], v197 offset:49152
  v_bfe_u32 v13, v10, 4, 1
  v_mfma_f32_16x16x32_bf16 v[36:39], a[96:99], a[40:43], v[36:39]
  v_lshl_add_u32 v14, v13, 3, v14
  v_add_u32 v240, s48, v14
  v_mfma_f32_16x16x32_bf16 v[36:39], a[92:95], a[20:23], v[36:39]
  s_waitcnt lgkmcnt(2)
  ds_read_b64_tr_b16 a[84:85], v197 offset:44032
  v_xor_b32 v241, 32, v240
  v_mfma_f32_16x16x32_bf16 v[52:55], a[40:43], a[104:107], v[52:55]
  buffer_load_dword v206, s[36:39], s62 offen sc1 lds
  s_mov_b32 s61, 2164736
  v_mfma_f32_16x16x32_bf16 v[52:55], a[60:63], a[108:111], v[52:55]
  s_add_u32 m0, s63, 0
  ds_read_b64_tr_b16 a[86:87], v197 offset:50176
  v_xor_b32 v242, 64, v240
  v_mfma_f32_16x16x32_bf16 v[52:55], a[0:3], a[112:115], v[52:55]
  s_waitcnt vmcnt(18)
  s_barrier
  v_xor_b32 v243, 96, v240
  v_mfma_f32_16x16x32_bf16 v[56:59], a[4:7], a[112:115], v[56:59]
  ds_read_b64_tr_b16 a[88:89], v197 offset:45056
  v_mfma_f32_16x16x32_bf16 v[56:59], a[64:67], a[108:111], v[56:59]
  buffer_load_dwordx4 v202, s[8:11], s61 offen offset:0 lds
  v_mfma_f32_16x16x32_bf16 v[56:59], a[44:47], a[104:107], v[56:59]
  ds_read_b64_tr_b16 a[90:91], v197 offset:51200
  v_mfma_f32_16x16x32_bf16 v[60:63], a[48:51], a[104:107], v[60:63]
  ds_read_b128 a[20:23], v208 offset:12288
  v_mfma_f32_16x16x32_bf16 v[60:63], a[68:71], a[108:111], v[60:63]
  ds_read_b64_tr_b16 a[92:93], v198 offset:0
  v_mfma_f32_16x16x32_bf16 v[60:63], a[8:11], a[112:115], v[60:63]
  buffer_load_dwordx4 v203, s[8:11], s61 offen offset:1024 lds
  v_mfma_f32_16x16x32_bf16 v[64:67], a[12:15], a[112:115], v[64:67]
  ds_read_b128 a[24:27], v208 offset:13312
  v_mfma_f32_16x16x32_bf16 v[64:67], a[72:75], a[108:111], v[64:67]
  ds_read_b64_tr_b16 a[94:95], v198 offset:6144
  v_mfma_f32_16x16x32_bf16 v[64:67], a[52:55], a[104:107], v[64:67]
  ds_read_b128 a[28:31], v208 offset:14336
  v_mfma_f32_16x16x32_bf16 v[120:123], a[56:59], a[104:107], v[120:123]
  s_lshl2_add_u32 s48, s52, s44
  buffer_load_dwordx4 v204, s[8:11], s61 offen offset:2048 lds
  s_mov_b32 s62, 26624
  v_mfma_f32_16x16x32_bf16 v[120:123], a[76:79], a[108:111], v[120:123]
  s_add_u32 m0, s64, 12288
  ds_read_b64_tr_b16 a[96:97], v198 offset:1024
  s_lshl_b32 s49, s48, 16
  v_mfma_f32_16x16x32_bf16 v[120:123], a[16:19], a[112:115], v[120:123]
  s_waitcnt lgkmcnt(6)
  ds_read_b128 a[32:35], v208 offset:15360
  s_add_u32 s49, s49, 7340032
  v_mfma_f32_16x16x32_bf16 v[80:83], a[52:55], a[80:83], v[80:83]
  ds_read_b64_tr_b16 a[98:99], v198 offset:7168
  v_add_u32 v244, s49, v0
  v_mfma_f32_16x16x32_bf16 v[80:83], a[72:75], a[84:87], v[80:83]
  buffer_load_dwordx4 v205, s[36:39], s62 offen offset:0 sc1 lds
  v_mfma_f32_16x16x32_bf16 v[80:83], a[12:15], a[88:91], v[80:83]
Ha1:
  s_cbranch_execz Ha1_1
  ds_read_b128 a[36:39], v211 offset:20480
  v_mfma_f32_16x16x32_bf16 v[76:79], a[8:11], a[88:91], v[76:79]
  s_lshl4_add_u32 s74, s48, s53
  ds_read_b64_tr_b16 a[100:101], v198 offset:2048
  s_lshl_b32 s74, s74, 8
  v_mfma_f32_16x16x32_bf16 v[76:79], a[68:71], a[84:87], v[76:79]
  s_add_u32 s74, s74, 262144
  ds_read_b64_tr_b16 a[102:103], v198 offset:8192
  v_mfma_f32_16x16x32_bf16 v[76:79], a[48:51], a[80:83], v[76:79]
  buffer_load_dwordx4 v205, s[36:39], s62 offen offset:1024 sc1 lds
  s_add_u32 m0, s65, 20480
  v_mfma_f32_16x16x32_bf16 v[72:75], a[44:47], a[80:83], v[72:75]
  ds_read_b64_tr_b16 a[104:105], v199 offset:0
  v_mfma_f32_16x16x32_bf16 v[72:75], a[64:67], a[84:87], v[72:75]
  ds_read_b64_tr_b16 a[106:107], v199 offset:6144
  v_mfma_f32_16x16x32_bf16 v[72:75], a[4:7], a[88:91], v[72:75]
  s_lshr_b32 s73, s48, 1
  ds_read_b64_tr_b16 a[108:109], v199 offset:1024
  s_lshl_b32 s73, s73, 5
  v_mfma_f32_16x16x32_bf16 v[68:71], a[0:3], a[88:91], v[68:71]
  s_add_u32 s73, s73, s53
  buffer_load_dword v206, s[36:39], s62 offen sc1 lds
  s_mov_b32 s61, 2363392
  v_mfma_f32_16x16x32_bf16 v[68:71], a[60:63], a[84:87], v[68:71]
  s_add_u32 m0, s63, 21504
  ds_read_b64_tr_b16 a[110:111], v199 offset:7168
  s_and_b32 s49, s48, 1
  v_mfma_f32_16x16x32_bf16 v[68:71], a[40:43], a[80:83], v[68:71]
  s_waitcnt vmcnt(12) lgkmcnt(4)
  s_barrier
  s_lshl1_add_u32 s73, s73, s49
  v_mfma_f32_16x16x32_bf16 v[84:87], a[92:95], a[60:63], v[84:87]
  s_lshl_b32 s73, s73, 11
  ds_read_b64_tr_b16 a[112:113], v199 offset:2048
  s_add_u32 s73, s73, 36700160
  v_mfma_f32_16x16x32_bf16 v[84:87], a[96:99], a[0:3], v[84:87]
  buffer_load_dwordx4 v202, s[8:11], s61 offen offset:0 lds
  v_mfma_f32_16x16x32_bf16 v[84:87], a[100:103], a[20:23], v[84:87]
  ds_read_b64_tr_b16 a[114:115], v199 offset:8192
  v_mfma_f32_16x16x32_bf16 v[88:91], a[100:103], a[24:27], v[88:91]
  ds_read_b128 a[40:43], v208 offset:33792
  v_mfma_f32_16x16x32_bf16 v[88:91], a[96:99], a[4:7], v[88:91]
  ds_read_b64_tr_b16 a[80:81], v198 offset:21504
  v_mfma_f32_16x16x32_bf16 v[88:91], a[92:95], a[64:67], v[88:91]
  buffer_load_dwordx4 v203, s[8:11], s61 offen offset:1024 lds
  v_mfma_f32_16x16x32_bf16 v[92:95], a[92:95], a[68:71], v[92:95]
  ds_read_b128 a[44:47], v208 offset:34816
  v_mfma_f32_16x16x32_bf16 v[92:95], a[96:99], a[8:11], v[92:95]
  s_lshl2_add_u32 s75, s48, s53
  ds_read_b64_tr_b16 a[82:83], v198 offset:27648
  s_lshl_b32 s75, s75, 10
  v_mfma_f32_16x16x32_bf16 v[92:95], a[100:103], a[28:31], v[92:95]
  s_add_u32 s75, s75, 5767168
  ds_read_b128 a[48:51], v208 offset:35840
  s_and_b32 s48, s48, 7
  v_mfma_f32_16x16x32_bf16 v[96:99], a[100:103], a[32:35], v[96:99]
  s_cselect_b32 s75, 1073741824, s75
  buffer_load_dwordx4 v204, s[8:11], s61 offen offset:2048 lds
  s_mov_b32 s62, 28672
  v_mfma_f32_16x16x32_bf16 v[96:99], a[96:99], a[12:15], v[96:99]
  s_add_u32 m0, s64, 33792
  ds_read_b64_tr_b16 a[84:85], v198 offset:22528
  v_mfma_f32_16x16x32_bf16 v[96:99], a[92:95], a[72:75], v[96:99]
  s_waitcnt lgkmcnt(6)
  ds_read_b128 a[52:55], v208 offset:36864
  v_mfma_f32_16x16x32_bf16 v[112:115], a[104:107], a[72:75], v[112:115]
  ds_read_b128 a[56:59], v211 offset:41984
  v_mfma_f32_16x16x32_bf16 v[112:115], a[108:111], a[12:15], v[112:115]
  buffer_load_dwordx4 v205, s[36:39], s62 offen offset:0 sc1 lds
  v_mfma_f32_16x16x32_bf16 v[112:115], a[112:115], a[32:35], v[112:115]
  ds_read_b64_tr_b16 a[86:87], v198 offset:28672
  v_mfma_f32_16x16x32_bf16 v[108:111], a[112:115], a[28:31], v[108:111]
  s_and_b32 s48, s52, 7
  ds_read_b64_tr_b16 a[88:89], v198 offset:23552
  s_lshl_b32 s48, s48, 5
  v_mfma_f32_16x16x32_bf16 v[108:111], a[108:111], a[8:11], v[108:111]
  s_lshr_b32 s49, s52, 3
  ds_read_b64_tr_b16 a[90:91], v198 offset:29696
  s_lshl2_add_u32 s48, s49, s48
  v_mfma_f32_16x16x32_bf16 v[108:111], a[104:107], a[68:71], v[108:111]
  buffer_load_dwordx4 v205, s[36:39], s62 offen offset:1024 sc1 lds
  s_add_u32 m0, s65, 41984
  v_mfma_f32_16x16x32_bf16 v[104:107], a[104:107], a[64:67], v[104:107]
  v_mfma_f32_16x16x32_bf16 v[104:107], a[108:111], a[4:7], v[104:107]
  ds_read_b64_tr_b16 a[92:93], v199 offset:21504
  v_mfma_f32_16x16x32_bf16 v[104:107], a[112:115], a[24:27], v[104:107]
  v_mfma_f32_16x16x32_bf16 v[100:103], a[112:115], a[20:23], v[100:103]
  buffer_load_dword v206, s[36:39], s62 offen sc1 lds
  s_mov_b32 s61, 2555904
  v_mfma_f32_16x16x32_bf16 v[100:103], a[108:111], a[0:3], v[100:103]
  s_add_u32 m0, s63, 43008
  ds_read_b64_tr_b16 a[94:95], v199 offset:27648
  v_and_b32 v12, 3, v10
  v_mfma_f32_16x16x32_bf16 v[100:103], a[104:107], a[60:63], v[100:103]
  s_waitcnt lgkmcnt(2)
  ds_read_b64_tr_b16 a[96:97], v199 offset:22528
  v_bfe_u32 v13, v10, 2, 2
  v_mfma_f32_16x16x32_bf16 v[20:23], a[80:83], a[0:3], v[20:23]
  v_lshl_add_u32 v12, v12, 3, v13
  v_add_lshl_u32 v250, v12, s48, 7
  v_mfma_f32_16x16x32_bf16 v[20:23], a[84:87], a[20:23], v[20:23]
  buffer_load_dwordx4 v202, s[8:11], s61 offen offset:0 lds
  v_mfma_f32_16x16x32_bf16 v[20:23], a[88:91], a[40:43], v[20:23]
  ds_read_b64_tr_b16 a[98:99], v199 offset:28672
  v_mfma_f32_16x16x32_bf16 v[24:27], a[88:91], a[44:47], v[24:27]
  ds_read_b64_tr_b16 a[100:101], v199 offset:23552
  v_mfma_f32_16x16x32_bf16 v[24:27], a[84:87], a[24:27], v[24:27]
  v_add_u32 v250, 32768, v250
  v_and_b32 v12, 7, v10
  v_mfma_f32_16x16x32_bf16 v[24:27], a[80:83], a[4:7], v[24:27]
  buffer_load_dwordx4 v203, s[8:11], s61 offen offset:1024 lds
  v_and_b32 v13, 8, v10
  v_mfma_f32_16x16x32_bf16 v[28:31], a[80:83], a[8:11], v[28:31]
  ds_read_b64_tr_b16 a[102:103], v199 offset:29696
  v_lshl_add_u32 v12, v13, 4, v12
  v_mfma_f32_16x16x32_bf16 v[28:31], a[84:87], a[28:31], v[28:31]
  s_lshl_b32 s48, s53, 3
  ds_read_b128 a[60:63], v208 offset:55296
  v_add_lshl_u32 v12, v12, s48, 7
  v_mfma_f32_16x16x32_bf16 v[28:31], a[88:91], a[48:51], v[28:31]
  ds_read_b64_tr_b16 a[104:105], v198 offset:43008
  v_cmp_gt_u32 vcc, 16, v10
  v_mfma_f32_16x16x32_bf16 v[32:35], a[88:91], a[52:55], v[32:35]
  s_nop 1
  buffer_load_dwordx4 v204, s[8:11], s61 offen offset:2048 lds
  s_mov_b32 s62, 30720
  v_mfma_f32_16x16x32_bf16 v[32:35], a[84:87], a[32:35], v[32:35]
  s_add_u32 m0, s64, 55296
  ds_read_b128 a[64:67], v208 offset:56320
  v_cndmask_b32 v250, v12, v250, vcc
  v_mfma_f32_16x16x32_bf16 v[32:35], a[80:83], a[12:15], v[32:35]
  ds_read_b64_tr_b16 a[106:107], v198 offset:49152
  v_mfma_f32_16x16x32_bf16 v[116:119], a[80:83], a[16:19], v[116:119]
  ds_read_b128 a[68:71], v208 offset:57344
  v_mfma_f32_16x16x32_bf16 v[116:119], a[84:87], a[36:39], v[116:119]
  buffer_load_dwordx4 v205, s[36:39], s62 offen offset:0 sc1 lds
  v_mfma_f32_16x16x32_bf16 v[116:119], a[88:91], a[56:59], v[116:119]
  s_waitcnt lgkmcnt(5)
  ds_read_b64_tr_b16 a[108:109], v198 offset:44032
  v_mfma_f32_16x16x32_bf16 v[48:51], a[92:95], a[12:15], v[48:51]
  ds_read_b128 a[72:75], v208 offset:58368
  v_mfma_f32_16x16x32_bf16 v[48:51], a[96:99], a[32:35], v[48:51]
  ds_read_b128 a[76:79], v211 offset:63488
  v_mfma_f32_16x16x32_bf16 v[48:51], a[100:103], a[52:55], v[48:51]
  buffer_load_dwordx4 v205, s[36:39], s62 offen offset:1024 sc1 lds
  s_add_u32 m0, s65, 63488
  v_mfma_f32_16x16x32_bf16 v[44:47], a[100:103], a[48:51], v[44:47]
  s_lshl_b32 s48, s59, 3
  ds_read_b64_tr_b16 a[110:111], v198 offset:50176
  s_add_u32 s48, s48, 150528
  v_mfma_f32_16x16x32_bf16 v[44:47], a[96:99], a[28:31], v[44:47]
  ds_read_b64_tr_b16 a[112:113], v198 offset:45056
  v_add_u32 v12, s48, v0
  v_mfma_f32_16x16x32_bf16 v[44:47], a[92:95], a[8:11], v[44:47]
  ds_read_b64_tr_b16 a[114:115], v198 offset:51200
  v_add_u32 v222, s64, v12
  v_mfma_f32_16x16x32_bf16 v[40:43], a[92:95], a[4:7], v[40:43]
  buffer_load_dword v206, s[36:39], s62 offen sc1 lds
  v_xor_b32 v223, 8, v222
  v_mfma_f32_16x16x32_bf16 v[40:43], a[96:99], a[24:27], v[40:43]
  ds_read_b64_tr_b16 a[80:81], v199 offset:43008
  v_mfma_f32_16x16x32_bf16 v[40:43], a[100:103], a[44:47], v[40:43]
  v_mfma_f32_16x16x32_bf16 v[36:39], a[100:103], a[40:43], v[36:39]
  ds_read_b64_tr_b16 a[82:83], v199 offset:49152
  v_mfma_f32_16x16x32_bf16 v[36:39], a[96:99], a[20:23], v[36:39]
  v_mfma_f32_16x16x32_bf16 v[36:39], a[92:95], a[0:3], v[36:39]
  s_waitcnt lgkmcnt(2)
  ds_read_b64_tr_b16 a[84:85], v199 offset:44032
  s_lshl_b32 s48, s60, 11
  v_mfma_f32_16x16x32_bf16 v[52:55], a[20:23], a[104:107], v[52:55]
  s_add_u32 s48, s48, 8192
  v_add_u32 v224, s48, v12
  s_lshl_b32 s48, s59, 13
  v_mfma_f32_16x16x32_bf16 v[52:55], a[40:43], a[108:111], v[52:55]
  s_mov_b32 s61, 2754560
  s_add_u32 m0, s63, 64512
  ds_read_b64_tr_b16 a[86:87], v199 offset:50176
  v_mfma_f32_16x16x32_bf16 v[52:55], a[60:63], a[112:115], v[52:55]
  s_waitcnt vmcnt(12)
  s_barrier
  v_subrev_u32 v225, s48, v224
  v_mfma_f32_16x16x32_bf16 v[56:59], a[64:67], a[112:115], v[56:59]
  ds_read_b64_tr_b16 a[88:89], v199 offset:45056
  v_xor_b32 v226, 8, v225
  v_mfma_f32_16x16x32_bf16 v[56:59], a[44:47], a[108:111], v[56:59]
  buffer_load_dwordx4 v202, s[8:11], s61 offen offset:0 lds
  v_and_b32 v227, -9, v225
  v_mfma_f32_16x16x32_bf16 v[56:59], a[24:27], a[104:107], v[56:59]
  ds_read_b64_tr_b16 a[90:91], v199 offset:51200
  v_mfma_f32_16x16x32_bf16 v[60:63], a[28:31], a[104:107], v[60:63]
  ds_read_b128 a[0:3], v209 offset:12288
  v_mfma_f32_16x16x32_bf16 v[60:63], a[48:51], a[108:111], v[60:63]
  ds_read_b64_tr_b16 a[92:93], v200 offset:0
  v_mfma_f32_16x16x32_bf16 v[60:63], a[68:71], a[112:115], v[60:63]
  ds_read_b128 a[4:7], v209 offset:13312
  v_mfma_f32_16x16x32_bf16 v[64:67], a[72:75], a[112:115], v[64:67]
  buffer_load_dwordx4 v203, s[8:11], s61 offen offset:1024 lds
  v_mfma_f32_16x16x32_bf16 v[64:67], a[52:55], a[108:111], v[64:67]
  ds_read_b64_tr_b16 a[94:95], v200 offset:6144
  v_mfma_f32_16x16x32_bf16 v[64:67], a[32:35], a[104:107], v[64:67]
  s_mov_b32 s76, 0xaaaaaaaa
  ds_read_b128 a[8:11], v209 offset:14336
  s_mov_b32 s77, 0xaaaaaaaa
  v_mfma_f32_16x16x32_bf16 v[120:123], a[36:39], a[104:107], v[120:123]
  s_mov_b32 s78, 0x000f0000
  ds_read_b64_tr_b16 a[96:97], v200 offset:1024
  s_mov_b32 s79, 0x0fff00ff
  v_mfma_f32_16x16x32_bf16 v[120:123], a[56:59], a[108:111], v[120:123]
  s_mov_b32 s80, 0x003f0003
  ds_read_b128 a[12:15], v209 offset:15360
  s_mov_b32 s81, 0x3fff03ff
  v_mfma_f32_16x16x32_bf16 v[120:123], a[76:79], a[112:115], v[120:123]
  s_waitcnt lgkmcnt(7)
  buffer_load_dwordx4 v204, s[8:11], s61 offen offset:2048 lds
  s_mov_b32 s62, 32768
  v_mfma_f32_16x16x32_bf16 v[80:83], a[32:35], a[80:83], v[80:83]
  s_add_u32 m0, s64, 76800
  ds_read_b64_tr_b16 a[98:99], v200 offset:7168
  v_mfma_f32_16x16x32_bf16 v[80:83], a[52:55], a[84:87], v[80:83]
  ds_read_b128 a[16:19], v212 offset:20480
  v_mfma_f32_16x16x32_bf16 v[80:83], a[72:75], a[88:91], v[80:83]
  ds_read_b64_tr_b16 a[100:101], v200 offset:2048
  v_mfma_f32_16x16x32_bf16 v[76:79], a[68:71], a[88:91], v[76:79]
  buffer_load_dwordx4 v205, s[36:39], s62 offen offset:0 sc1 lds
  v_mfma_f32_16x16x32_bf16 v[76:79], a[48:51], a[84:87], v[76:79]
  ds_read_b64_tr_b16 a[102:103], v200 offset:8192
  v_mfma_f32_16x16x32_bf16 v[76:79], a[28:31], a[80:83], v[76:79]
  ds_read_b64_tr_b16 a[104:105], v201 offset:0
  v_mov_b32 v12, 0x0c0c0100
  v_mfma_f32_16x16x32_bf16 v[72:75], a[24:27], a[80:83], v[72:75]
  ds_read_b64_tr_b16 a[106:107], v201 offset:6144
  v_mov_b32 v13, 0x01000c0c
  v_mfma_f32_16x16x32_bf16 v[72:75], a[44:47], a[84:87], v[72:75]
  buffer_load_dwordx4 v205, s[36:39], s62 offen offset:1024 sc1 lds
  s_add_u32 m0, s65, 84992
  v_mfma_f32_16x16x32_bf16 v[72:75], a[64:67], a[88:91], v[72:75]
  ds_read_b64_tr_b16 a[108:109], v201 offset:1024
  v_cndmask_b32 v12, v12, v13, s[76:77]
  v_mfma_f32_16x16x32_bf16 v[68:71], a[60:63], a[88:91], v[68:71]
  v_mov_b32 v14, 0x0c0c0c0c
  v_cndmask_b32 v228, v14, v12, s[78:79]
  v_mfma_f32_16x16x32_bf16 v[68:71], a[40:43], a[84:87], v[68:71]
  ds_read_b64_tr_b16 a[110:111], v201 offset:7168
  v_cndmask_b32 v230, v12, v14, s[78:79]
  v_mfma_f32_16x16x32_bf16 v[68:71], a[20:23], a[80:83], v[68:71]
  s_waitcnt lgkmcnt(4)
  buffer_load_dword v206, s[36:39], s62 offen sc1 lds
  s_mov_b32 s61, 2953216
  v_mfma_f32_16x16x32_bf16 v[84:87], a[92:95], a[40:43], v[84:87]
  s_add_u32 m0, s63, 86016
  ds_read_b64_tr_b16 a[112:113], v201 offset:2048
  v_mfma_f32_16x16x32_bf16 v[84:87], a[96:99], a[60:63], v[84:87]
  v_mfma_f32_16x16x32_bf16 v[84:87], a[100:103], a[0:3], v[84:87]
  ds_read_b64_tr_b16 a[114:115], v201 offset:8192
  v_mfma_f32_16x16x32_bf16 v[88:91], a[100:103], a[4:7], v[88:91]
  buffer_load_dwordx4 v202, s[8:11], s61 offen offset:0 lds
  v_mov_b32 v12, 0x0c0c0302
  v_mfma_f32_16x16x32_bf16 v[88:91], a[96:99], a[64:67], v[88:91]
  ds_read_b128 a[20:23], v207 offset:12288
  v_mov_b32 v13, 0x03020c0c
  v_mfma_f32_16x16x32_bf16 v[88:91], a[92:95], a[44:47], v[88:91]
  ds_read_b64_tr_b16 a[80:81], v196 offset:0
  v_cndmask_b32 v12, v12, v13, s[76:77]
  v_mfma_f32_16x16x32_bf16 v[92:95], a[92:95], a[48:51], v[92:95]
  ds_read_b128 a[24:27], v207 offset:13312
  v_cndmask_b32 v229, v14, v12, s[80:81]
  v_mfma_f32_16x16x32_bf16 v[92:95], a[96:99], a[68:71], v[92:95]
  buffer_load_dwordx4 v203, s[8:11], s61 offen offset:1024 lds
  v_cndmask_b32 v231, v12, v14, s[80:81]
  v_mfma_f32_16x16x32_bf16 v[92:95], a[100:103], a[8:11], v[92:95]
  ds_read_b64_tr_b16 a[82:83], v196 offset:6144
  v_mfma_f32_16x16x32_bf16 v[96:99], a[100:103], a[12:15], v[96:99]
  ds_read_b128 a[28:31], v207 offset:14336
  v_mfma_f32_16x16x32_bf16 v[96:99], a[96:99], a[72:75], v[96:99]
  ds_read_b64_tr_b16 a[84:85], v196 offset:1024
  v_mfma_f32_16x16x32_bf16 v[96:99], a[92:95], a[52:55], v[96:99]
  s_waitcnt lgkmcnt(6)
  ds_read_b128 a[32:35], v207 offset:15360
  s_lshl1_add_u32 s48, s57, s59
  v_mfma_f32_16x16x32_bf16 v[112:115], a[104:107], a[52:55], v[112:115]
  s_lshl_b32 s71, s48, 17
  buffer_load_dwordx4 v204, s[8:11], s61 offen offset:2048 lds
  s_mov_b32 s62, 34816
  v_mfma_f32_16x16x32_bf16 v[112:115], a[108:111], a[72:75], v[112:115]
  s_add_u32 m0, s64, 98304
  ds_read_b128 a[36:39], v210 offset:20480
  s_lshl1_add_u32 s48, s58, s60
  v_mfma_f32_16x16x32_bf16 v[112:115], a[112:115], a[12:15], v[112:115]
  s_lshl_b32 s48, s48, 11
  ds_read_b64_tr_b16 a[86:87], v196 offset:7168
  v_mfma_f32_16x16x32_bf16 v[108:111], a[112:115], a[8:11], v[108:111]
  ds_read_b64_tr_b16 a[88:89], v196 offset:2048
  v_mfma_f32_16x16x32_bf16 v[108:111], a[108:111], a[68:71], v[108:111]
  buffer_load_dwordx4 v205, s[36:39], s62 offen offset:0 sc1 lds
  v_mfma_f32_16x16x32_bf16 v[108:111], a[104:107], a[48:51], v[108:111]
  s_add_u32 s71, s71, s48
  ds_read_b64_tr_b16 a[90:91], v196 offset:8192
  s_add_u32 s71, s71, 7340032
  v_mfma_f32_16x16x32_bf16 v[104:107], a[104:107], a[44:47], v[104:107]
  s_add_u32 s72, s71, 65536
  s_or_b32 s57, s57, s59
  v_mfma_f32_16x16x32_bf16 v[104:107], a[108:111], a[64:67], v[104:107]
  ds_read_b64_tr_b16 a[92:93], v197 offset:0
  v_mfma_f32_16x16x32_bf16 v[104:107], a[112:115], a[4:7], v[104:107]
  buffer_load_dwordx4 v205, s[36:39], s62 offen offset:1024 sc1 lds
  s_add_u32 m0, s65, 106496
  v_mfma_f32_16x16x32_bf16 v[100:103], a[112:115], a[0:3], v[100:103]
  ds_read_b64_tr_b16 a[94:95], v197 offset:6144
  v_mfma_f32_16x16x32_bf16 v[100:103], a[108:111], a[60:63], v[100:103]
  v_mfma_f32_16x16x32_bf16 v[100:103], a[104:107], a[40:43], v[100:103]
  s_waitcnt lgkmcnt(2)
  ds_read_b64_tr_b16 a[96:97], v197 offset:1024
  v_mfma_f32_16x16x32_bf16 v[20:23], a[80:83], a[60:63], v[20:23]
  s_lshl_b32 s45, s2, 7
  buffer_load_dword v206, s[36:39], s62 offen sc1 lds
  s_add_u32 s45, s45, 5275648
  v_mfma_f32_16x16x32_bf16 v[20:23], a[84:87], a[0:3], v[20:23]
  s_mov_b32 s61, 3145728
  s_add_u32 m0, s63, 107520
  ds_read_b64_tr_b16 a[98:99], v197 offset:7168
  v_mfma_f32_16x16x32_bf16 v[20:23], a[88:91], a[20:23], v[20:23]
  s_waitcnt vmcnt(12)
  s_barrier
  s_cmp_eq_u32 s44, 0
  v_mfma_f32_16x16x32_bf16 v[24:27], a[88:91], a[24:27], v[24:27]
  s_cselect_b32 s45, s45, 1073741824
  ds_read_b64_tr_b16 a[100:101], v197 offset:2048
  v_mfma_f32_16x16x32_bf16 v[24:27], a[84:87], a[4:7], v[24:27]
  buffer_load_dwordx4 v202, s[8:11], s61 offen offset:0 lds
  v_mfma_f32_16x16x32_bf16 v[24:27], a[80:83], a[64:67], v[24:27]
  ds_read_b64_tr_b16 a[102:103], v197 offset:8192
  v_mfma_f32_16x16x32_bf16 v[28:31], a[80:83], a[68:71], v[28:31]
  s_lshr_b32 s49, s2, 3
  ds_read_b128 a[40:43], v207 offset:33792
  s_and_b32 s60, s49, 3
  v_mfma_f32_16x16x32_bf16 v[28:31], a[84:87], a[8:11], v[28:31]
  s_lshr_b32 s58, s49, 2
  ds_read_b64_tr_b16 a[104:105], v196 offset:21504
  s_lshl1_add_u32 s49, s60, s58
  v_mfma_f32_16x16x32_bf16 v[28:31], a[88:91], a[28:31], v[28:31]
  s_and_b32 s49, s49, 7
  ds_read_b128 a[44:47], v207 offset:34816
  s_and_b32 s48, s2, 7
  v_mfma_f32_16x16x32_bf16 v[32:35], a[88:91], a[32:35], v[32:35]
  s_lshl2_add_u32 s60, s48, s60
  buffer_load_dwordx4 v203, s[8:11], s61 offen offset:1024 lds
  v_mfma_f32_16x16x32_bf16 v[32:35], a[84:87], a[12:15], v[32:35]
  ds_read_b64_tr_b16 a[106:107], v196 offset:27648
  v_mfma_f32_16x16x32_bf16 v[32:35], a[80:83], a[72:75], v[32:35]
  ds_read_b128 a[48:51], v207 offset:35840
  v_mfma_f32_16x16x32_bf16 v[116:119], a[80:83], a[76:79], v[116:119]
  ds_read_b64_tr_b16 a[108:109], v196 offset:22528
  v_mfma_f32_16x16x32_bf16 v[116:119], a[84:87], a[16:19], v[116:119]
  ds_read_b128 a[52:55], v207 offset:36864
  v_mfma_f32_16x16x32_bf16 v[116:119], a[88:91], a[36:39], v[116:119]
  s_waitcnt lgkmcnt(7)
  buffer_load_dwordx4 v204, s[8:11], s61 offen offset:2048 lds
  s_mov_b32 s62, 36864
  v_mfma_f32_16x16x32_bf16 v[48:51], a[92:95], a[72:75], v[48:51]
  s_add_u32 m0, s64, 119808
  ds_read_b128 a[56:59], v210 offset:41984
  v_mfma_f32_16x16x32_bf16 v[48:51], a[96:99], a[12:15], v[48:51]
  ds_read_b64_tr_b16 a[110:111], v196 offset:28672
  v_mfma_f32_16x16x32_bf16 v[48:51], a[100:103], a[32:35], v[48:51]
  s_mov_b32 s82, 0xd0643521
  ds_read_b64_tr_b16 a[112:113], v196 offset:23552
  s_mov_b32 s83, 0xfecba987
  v_mfma_f32_16x16x32_bf16 v[44:47], a[100:103], a[28:31], v[44:47]
  buffer_load_dwordx4 v205, s[36:39], s62 offen offset:0 sc1 lds
  v_mfma_f32_16x16x32_bf16 v[44:47], a[96:99], a[8:11], v[44:47]
  ds_read_b64_tr_b16 a[114:115], v196 offset:29696
  v_mfma_f32_16x16x32_bf16 v[44:47], a[92:95], a[68:71], v[44:47]
  s_cmp_eq_u32 s49, 1
  s_cselect_b32 s82, 0x71546320, s82
  s_cselect_b32 s83, 0xfdcba89e, s83
  v_mfma_f32_16x16x32_bf16 v[40:43], a[92:95], a[64:67], v[40:43]
  v_mfma_f32_16x16x32_bf16 v[40:43], a[96:99], a[4:7], v[40:43]
  buffer_load_dwordx4 v205, s[36:39], s62 offen offset:1024 sc1 lds
  s_add_u32 m0, s65, 128000
  v_mfma_f32_16x16x32_bf16 v[40:43], a[100:103], a[24:27], v[40:43]
  ds_read_b64_tr_b16 a[80:81], v197 offset:21504
  v_mfma_f32_16x16x32_bf16 v[36:39], a[100:103], a[20:23], v[36:39]
  ds_read_b64_tr_b16 a[82:83], v197 offset:27648
  v_mfma_f32_16x16x32_bf16 v[36:39], a[96:99], a[0:3], v[36:39]
  s_cmp_eq_u32 s49, 2
  s_cselect_b32 s82, 0x62574310, s82
  s_cselect_b32 s83, 0xfedcb9a8, s83
  v_mfma_f32_16x16x32_bf16 v[36:39], a[92:95], a[60:63], v[36:39]
  s_waitcnt lgkmcnt(2)
  buffer_load_dword v206, s[36:39], s62 offen sc1 lds
  s_mov_b32 s61, 3344384
  v_mfma_f32_16x16x32_bf16 v[52:55], a[0:3], a[104:107], v[52:55]
  s_add_u32 m0, s63, 129024
  ds_read_b64_tr_b16 a[84:85], v197 offset:22528
  v_mfma_f32_16x16x32_bf16 v[52:55], a[20:23], a[108:111], v[52:55]
  ds_read_b64_tr_b16 a[86:87], v197 offset:28672
  v_mfma_f32_16x16x32_bf16 v[52:55], a[40:43], a[112:115], v[52:55]
  v_mfma_f32_16x16x32_bf16 v[56:59], a[44:47], a[112:115], v[56:59]
  s_cmp_eq_u32 s49, 3
  buffer_load_dwordx4 v202, s[8:11], s61 offen offset:0 lds
  s_cselect_b32 s82, 0x63854210, s82
  v_mfma_f32_16x16x32_bf16 v[56:59], a[24:27], a[108:111], v[56:59]
  s_cselect_b32 s83, 0xfedca9b7, s83
  ds_read_b64_tr_b16 a[88:89], v197 offset:23552
  v_mfma_f32_16x16x32_bf16 v[56:59], a[4:7], a[104:107], v[56:59]
  ds_read_b64_tr_b16 a[90:91], v197 offset:29696
  v_mfma_f32_16x16x32_bf16 v[60:63], a[8:11], a[104:107], v[60:63]
  ds_read_b128 a[60:63], v207 offset:55296
  v_mfma_f32_16x16x32_bf16 v[60:63], a[28:31], a[108:111], v[60:63]
  buffer_load_dwordx4 v203, s[8:11], s61 offen offset:1024 lds
  v_mfma_f32_16x16x32_bf16 v[60:63], a[48:51], a[112:115], v[60:63]
  s_cmp_eq_u32 s49, 4
  ds_read_b64_tr_b16 a[92:93], v196 offset:43008
  s_cselect_b32 s82, 0x64953210, s82
  v_mfma_f32_16x16x32_bf16 v[64:67], a[52:55], a[112:115], v[64:67]
  s_cselect_b32 s83, 0xfedba8c7, s83
  ds_read_b128 a[64:67], v207 offset:56320
  v_mfma_f32_16x16x32_bf16 v[64:67], a[32:35], a[108:111], v[64:67]
  ds_read_b64_tr_b16 a[94:95], v196 offset:49152
  v_mfma_f32_16x16x32_bf16 v[64:67], a[12:15], a[104:107], v[64:67]
  buffer_load_dwordx4 v204, s[8:11], s61 offen offset:2048 lds
  s_mov_b32 s62, 38912
  v_mfma_f32_16x16x32_bf16 v[120:123], a[16:19], a[104:107], v[120:123]
  s_add_u32 m0, s64, 141312
  ds_read_b128 a[68:71], v207 offset:57344
  v_mfma_f32_16x16x32_bf16 v[120:123], a[36:39], a[108:111], v[120:123]
  s_cmp_eq_u32 s49, 5
  ds_read_b64_tr_b16 a[96:97], v196 offset:44032
  s_cselect_b32 s82, 0x65a43210, s82
  v_mfma_f32_16x16x32_bf16 v[120:123], a[56:59], a[112:115], v[120:123]
  s_waitcnt lgkmcnt(6)
  ds_read_b128 a[72:75], v207 offset:58368
  s_cselect_b32 s83, 0xfecb98d7, s83
  v_mfma_f32_16x16x32_bf16 v[80:83], a[12:15], a[80:83], v[80:83]
  buffer_load_dwordx4 v205, s[36:39], s62 offen offset:0 sc1 lds
  v_mfma_f32_16x16x32_bf16 v[80:83], a[32:35], a[84:87], v[80:83]
  ds_read_b64_tr_b16 a[98:99], v196 offset:50176
  v_mfma_f32_16x16x32_bf16 v[80:83], a[52:55], a[88:91], v[80:83]
  s_cmp_eq_u32 s49, 6
  ds_read_b128 a[76:79], v210 offset:63488
  s_cselect_b32 s82, 0xb6543210, s82
  v_mfma_f32_16x16x32_bf16 v[76:79], a[48:51], a[88:91], v[76:79]
  s_cselect_b32 s83, 0xfdca98e7, s83
  ds_read_b64_tr_b16 a[100:101], v196 offset:45056
  v_mfma_f32_16x16x32_bf16 v[76:79], a[28:31], a[84:87], v[76:79]
  buffer_load_dwordx4 v205, s[36:39], s62 offen offset:1024 sc1 lds
  s_add_u32 m0, s65, 149504
  v_mfma_f32_16x16x32_bf16 v[76:79], a[8:11], a[80:83], v[76:79]
  ds_read_b64_tr_b16 a[102:103], v196 offset:51200
  v_mfma_f32_16x16x32_bf16 v[72:75], a[4:7], a[80:83], v[72:75]
  ds_read_b64_tr_b16 a[104:105], v197 offset:43008
  v_mfma_f32_16x16x32_bf16 v[72:75], a[24:27], a[84:87], v[72:75]
  s_cmp_eq_u32 s49, 7
  ds_read_b64_tr_b16 a[106:107], v197 offset:49152
  s_cselect_b32 s82, 0xc7543210, s82
  v_mfma_f32_16x16x32_bf16 v[72:75], a[44:47], a[88:91], v[72:75]
  s_cselect_b32 s83, 0xedba98f6, s83
  buffer_load_dword v206, s[36:39], s62 offen sc1 lds
  v_mfma_f32_16x16x32_bf16 v[68:71], a[40:43], a[88:91], v[68:71]
  ds_read_b64_tr_b16 a[108:109], v197 offset:44032
  v_mfma_f32_16x16x32_bf16 v[68:71], a[20:23], a[84:87], v[68:71]
  s_mov_b32 s61, 3543040
  s_add_u32 m0, s63, 0
  ds_read_b64_tr_b16 a[110:111], v197 offset:50176
  v_mfma_f32_16x16x32_bf16 v[68:71], a[0:3], a[80:83], v[68:71]
  s_waitcnt vmcnt(12) lgkmcnt(4)
  s_barrier
  v_mfma_f32_16x16x32_bf16 v[84:87], a[92:95], a[20:23], v[84:87]
  s_mul_i32 s84, s44, 7168
  ds_read_b64_tr_b16 a[112:113], v197 offset:45056
  s_lshl2_add_u32 s85, s58, s44
  v_mfma_f32_16x16x32_bf16 v[84:87], a[96:99], a[40:43], v[84:87]
  s_lshl_b32 s85, s85, 17
  buffer_load_dwordx4 v202, s[8:11], s61 offen offset:0 lds
  s_add_u32 s85, s85, 36700160
  v_mfma_f32_16x16x32_bf16 v[84:87], a[100:103], a[60:63], v[84:87]
  ds_read_b64_tr_b16 a[114:115], v197 offset:51200
  v_mfma_f32_16x16x32_bf16 v[88:91], a[100:103], a[64:67], v[88:91]
  ds_read_b128 a[0:3], v208 offset:12288
  v_mfma_f32_16x16x32_bf16 v[88:91], a[96:99], a[44:47], v[88:91]
  ds_read_b64_tr_b16 a[80:81], v198 offset:0
  v_mfma_f32_16x16x32_bf16 v[88:91], a[92:95], a[24:27], v[88:91]
  ds_read_b128 a[4:7], v208 offset:13312
  v_mfma_f32_16x16x32_bf16 v[92:95], a[92:95], a[28:31], v[92:95]
  s_cmp_ge_u32 s44, 2
  buffer_load_dwordx4 v203, s[8:11], s61 offen offset:1024 lds
  s_cselect_b64 s[16:17], s[20:21], s[16:17]
  v_mfma_f32_16x16x32_bf16 v[92:95], a[96:99], a[48:51], v[92:95]
  ds_read_b64_tr_b16 a[82:83], v198 offset:6144
  v_mfma_f32_16x16x32_bf16 v[92:95], a[100:103], a[68:71], v[92:95]
  ds_read_b128 a[8:11], v208 offset:14336
  v_mfma_f32_16x16x32_bf16 v[96:99], a[100:103], a[72:75], v[96:99]
  ds_read_b64_tr_b16 a[84:85], v198 offset:1024
  v_mfma_f32_16x16x32_bf16 v[96:99], a[96:99], a[52:55], v[96:99]
  ds_read_b128 a[12:15], v208 offset:15360
  v_lshrrev_b32 v12, 2, v10
  v_mfma_f32_16x16x32_bf16 v[96:99], a[92:95], a[32:35], v[96:99]
  s_waitcnt lgkmcnt(7)
  buffer_load_dwordx4 v204, s[8:11], s61 offen offset:2048 lds
  s_mov_b32 s62, 40960
  v_mfma_f32_16x16x32_bf16 v[112:115], a[104:107], a[32:35], v[112:115]
  s_add_u32 m0, s64, 12288
  ds_read_b128 a[16:19], v211 offset:20480
  v_mul_u32_u24 v12, 224, v12
  v_mfma_f32_16x16x32_bf16 v[112:115], a[108:111], a[52:55], v[112:115]
  ds_read_b64_tr_b16 a[86:87], v198 offset:7168
  v_and_b32 v13, 3, v10
  v_mfma_f32_16x16x32_bf16 v[112:115], a[112:115], a[72:75], v[112:115]
  ds_read_b64_tr_b16 a[88:89], v198 offset:2048
  v_lshl_add_u32 v1, v13, 3, v12
  v_mfma_f32_16x16x32_bf16 v[108:111], a[112:115], a[68:71], v[108:111]
  buffer_load_dwordx4 v205, s[36:39], s62 offen offset:0 sc1 lds
  v_add_u32 v2, 57344, v1
  v_mfma_f32_16x16x32_bf16 v[108:111], a[108:111], a[48:51], v[108:111]
  ds_read_b64_tr_b16 a[90:91], v198 offset:8192
  v_mfma_f32_16x16x32_bf16 v[108:111], a[104:107], a[28:31], v[108:111]
  v_mfma_f32_16x16x32_bf16 v[104:107], a[104:107], a[24:27], v[104:107]
  s_mul_i32 s48, s60, 224
  s_and_b32 s49, s44, 1
  s_mul_i32 s49, s49, 458752
  v_mfma_f32_16x16x32_bf16 v[104:107], a[108:111], a[44:47], v[104:107]
  s_add_u32 s48, s48, s49
  buffer_load_dwordx4 v205, s[36:39], s62 offen offset:1024 sc1 lds
  s_add_u32 m0, s65, 20480
  v_mfma_f32_16x16x32_bf16 v[104:107], a[112:115], a[64:67], v[104:107]
  s_and_b32 s49, s60, 1
  ds_read_b64_tr_b16 a[92:93], v199 offset:0
  s_lshl_b32 s49, s49, 1
  v_mfma_f32_16x16x32_bf16 v[100:103], a[112:115], a[60:63], v[100:103]
  ds_read_b64_tr_b16 a[94:95], v199 offset:6144
  v_mfma_f32_16x16x32_bf16 v[100:103], a[108:111], a[40:43], v[100:103]
  v_mfma_f32_16x16x32_bf16 v[100:103], a[104:107], a[20:23], v[100:103]
  s_waitcnt lgkmcnt(2)
  buffer_load_dword v206, s[36:39], s62 offen sc1 lds
  s_mov_b32 s61, 3735552
  v_mfma_f32_16x16x32_bf16 v[20:23], a[80:83], a[40:43], v[20:23]
  s_add_u32 m0, s63, 21504
  ds_read_b64_tr_b16 a[96:97], v199 offset:1024
  v_mfma_f32_16x16x32_bf16 v[20:23], a[84:87], a[60:63], v[20:23]
  ds_read_b64_tr_b16 a[98:99], v199 offset:7168
  v_mfma_f32_16x16x32_bf16 v[20:23], a[88:91], a[0:3], v[20:23]
  v_mfma_f32_16x16x32_bf16 v[24:27], a[88:91], a[4:7], v[24:27]
  buffer_load_dwordx4 v202, s[8:11], s61 offen offset:0 lds
  v_add_u32 v12, 0, v10
  v_mfma_f32_16x16x32_bf16 v[24:27], a[84:87], a[64:67], v[24:27]
  ds_read_b64_tr_b16 a[100:101], v199 offset:2048
  v_mul_u32_u24 v13, 4682, v12
  v_mfma_f32_16x16x32_bf16 v[24:27], a[80:83], a[44:47], v[24:27]
  ds_read_b64_tr_b16 a[102:103], v199 offset:8192
  v_lshrrev_b32 v13, 16, v13
  v_mfma_f32_16x16x32_bf16 v[28:31], a[80:83], a[48:51], v[28:31]
  ds_read_b128 a[20:23], v208 offset:33792
  v_mul_i32_i24 v14, -14, v13
  v_mfma_f32_16x16x32_bf16 v[28:31], a[84:87], a[68:71], v[28:31]
  buffer_load_dwordx4 v203, s[8:11], s61 offen offset:1024 lds
  v_add3_u32 v12, v12, v14, s49
  v_mfma_f32_16x16x32_bf16 v[28:31], a[88:91], a[8:11], v[28:31]
Ha2:
  s_cbranch_execz Ha2_1
  ds_read_b64_tr_b16 a[104:105], v198 offset:21504
  v_mfma_f32_16x16x32_bf16 v[32:35], a[88:91], a[12:15], v[32:35]
  ds_read_b128 a[24:27], v208 offset:34816
  v_mfma_f32_16x16x32_bf16 v[32:35], a[84:87], a[72:75], v[32:35]
  ds_read_b64_tr_b16 a[106:107], v198 offset:27648
  v_mfma_f32_16x16x32_bf16 v[32:35], a[80:83], a[52:55], v[32:35]
  buffer_load_dwordx4 v204, s[8:11], s61 offen offset:2048 lds
  s_mov_b32 s62, 43008
  v_mfma_f32_16x16x32_bf16 v[116:119], a[80:83], a[56:59], v[116:119]
  s_add_u32 m0, s64, 33792
  ds_read_b128 a[28:31], v208 offset:35840
  v_add_u32 v14, -14, v12
  v_mfma_f32_16x16x32_bf16 v[116:119], a[84:87], a[76:79], v[116:119]
  ds_read_b64_tr_b16 a[108:109], v198 offset:22528
  v_min_u32 v12, v12, v14
  v_mfma_f32_16x16x32_bf16 v[116:119], a[88:91], a[16:19], v[116:119]
  s_waitcnt lgkmcnt(6)
  ds_read_b128 a[32:35], v208 offset:36864
  v_mul_u32_u24 v13, 7168, v13
  v_mfma_f32_16x16x32_bf16 v[48:51], a[92:95], a[52:55], v[48:51]
  buffer_load_dwordx4 v205, s[36:39], s62 offen offset:0 sc1 lds
  v_lshl_add_u32 v12, v12, 4, v13
  v_mfma_f32_16x16x32_bf16 v[48:51], a[96:99], a[72:75], v[48:51]
  ds_read_b128 a[36:39], v211 offset:41984
  v_add_u32 v3, s48, v12
  v_mfma_f32_16x16x32_bf16 v[48:51], a[100:103], a[12:15], v[48:51]
  ds_read_b64_tr_b16 a[110:111], v198 offset:28672
  v_mfma_f32_16x16x32_bf16 v[44:47], a[100:103], a[8:11], v[44:47]
  ds_read_b64_tr_b16 a[112:113], v198 offset:23552
  v_mfma_f32_16x16x32_bf16 v[44:47], a[96:99], a[68:71], v[44:47]
  s_sub_u32 s48, s48, 1024
  buffer_load_dwordx4 v205, s[36:39], s62 offen offset:1024 sc1 lds
  s_add_u32 m0, s65, 41984
  v_mfma_f32_16x16x32_bf16 v[44:47], a[92:95], a[48:51], v[44:47]
  ds_read_b64_tr_b16 a[114:115], v198 offset:29696
  v_mfma_f32_16x16x32_bf16 v[40:43], a[92:95], a[44:47], v[40:43]
  v_add_u32 v12, 64, v10
  v_mul_u32_u24 v13, 4682, v12
  v_mfma_f32_16x16x32_bf16 v[40:43], a[96:99], a[64:67], v[40:43]
  ds_read_b64_tr_b16 a[80:81], v199 offset:21504
  v_lshrrev_b32 v13, 16, v13
  v_mfma_f32_16x16x32_bf16 v[40:43], a[100:103], a[4:7], v[40:43]
  buffer_load_dword v206, s[36:39], s62 offen sc1 lds
  v_mul_i32_i24 v14, -14, v13
  v_mfma_f32_16x16x32_bf16 v[36:39], a[100:103], a[0:3], v[36:39]
  ds_read_b64_tr_b16 a[82:83], v199 offset:27648
  v_add3_u32 v12, v12, v14, s49
  v_mfma_f32_16x16x32_bf16 v[36:39], a[96:99], a[60:63], v[36:39]
  v_mfma_f32_16x16x32_bf16 v[36:39], a[92:95], a[40:43], v[36:39]
  s_waitcnt lgkmcnt(2)
  ds_read_b64_tr_b16 a[84:85], v199 offset:22528
  v_mfma_f32_16x16x32_bf16 v[52:55], a[60:63], a[104:107], v[52:55]
  v_mfma_f32_16x16x32_bf16 v[52:55], a[0:3], a[108:111], v[52:55]
  s_mov_b32 s61, 3934208
  s_add_u32 m0, s63, 43008
  ds_read_b64_tr_b16 a[86:87], v199 offset:28672
  v_mfma_f32_16x16x32_bf16 v[52:55], a[20:23], a[112:115], v[52:55]
  s_waitcnt vmcnt(12)
  s_barrier
  v_add_u32 v14, -14, v12
  v_mfma_f32_16x16x32_bf16 v[56:59], a[24:27], a[112:115], v[56:59]
  ds_read_b64_tr_b16 a[88:89], v199 offset:23552
  v_min_u32 v12, v12, v14
  v_mfma_f32_16x16x32_bf16 v[56:59], a[4:7], a[108:111], v[56:59]
  buffer_load_dwordx4 v202, s[8:11], s61 offen offset:0 lds
  v_mul_u32_u24 v13, 7168, v13
  v_mfma_f32_16x16x32_bf16 v[56:59], a[64:67], a[104:107], v[56:59]
  ds_read_b64_tr_b16 a[90:91], v199 offset:29696
  v_lshl_add_u32 v12, v12, 4, v13
  v_mfma_f32_16x16x32_bf16 v[60:63], a[68:71], a[104:107], v[60:63]
  ds_read_b128 a[40:43], v208 offset:55296
  v_add_u32 v4, s48, v12
  v_mfma_f32_16x16x32_bf16 v[60:63], a[8:11], a[108:111], v[60:63]
  ds_read_b64_tr_b16 a[92:93], v198 offset:43008
  v_mfma_f32_16x16x32_bf16 v[60:63], a[28:31], a[112:115], v[60:63]
  ds_read_b128 a[44:47], v208 offset:56320
  v_mfma_f32_16x16x32_bf16 v[64:67], a[32:35], a[112:115], v[64:67]
  buffer_load_dwordx4 v203, s[8:11], s61 offen offset:1024 lds
  v_mfma_f32_16x16x32_bf16 v[64:67], a[12:15], a[108:111], v[64:67]
  s_sub_u32 s48, s48, 1024
  ds_read_b64_tr_b16 a[94:95], v198 offset:49152
  v_mfma_f32_16x16x32_bf16 v[64:67], a[72:75], a[104:107], v[64:67]
  ds_read_b128 a[48:51], v208 offset:57344
  v_mfma_f32_16x16x32_bf16 v[120:123], a[76:79], a[104:107], v[120:123]
  ds_read_b64_tr_b16 a[96:97], v198 offset:44032
  v_add_u32 v12, 128, v10
  v_mfma_f32_16x16x32_bf16 v[120:123], a[16:19], a[108:111], v[120:123]
  ds_read_b128 a[52:55], v208 offset:58368
  v_mul_u32_u24 v13, 4682, v12
  v_mfma_f32_16x16x32_bf16 v[120:123], a[36:39], a[112:115], v[120:123]
  s_waitcnt lgkmcnt(7)
  buffer_load_dwordx4 v204, s[8:11], s61 offen offset:2048 lds
  s_mov_b32 s62, 45056
  v_mfma_f32_16x16x32_bf16 v[80:83], a[72:75], a[80:83], v[80:83]
  s_add_u32 m0, s64, 55296
  ds_read_b64_tr_b16 a[98:99], v198 offset:50176
  v_lshrrev_b32 v13, 16, v13
  v_mfma_f32_16x16x32_bf16 v[80:83], a[12:15], a[84:87], v[80:83]
  ds_read_b128 a[56:59], v211 offset:63488
  v_mul_i32_i24 v14, -14, v13
  v_mfma_f32_16x16x32_bf16 v[80:83], a[32:35], a[88:91], v[80:83]
  ds_read_b64_tr_b16 a[100:101], v198 offset:45056
  v_add3_u32 v12, v12, v14, s49
  v_mfma_f32_16x16x32_bf16 v[76:79], a[28:31], a[88:91], v[76:79]
  buffer_load_dwordx4 v205, s[36:39], s62 offen offset:0 sc1 lds
  v_mfma_f32_16x16x32_bf16 v[76:79], a[8:11], a[84:87], v[76:79]
  ds_read_b64_tr_b16 a[102:103], v198 offset:51200
  v_mfma_f32_16x16x32_bf16 v[76:79], a[68:71], a[80:83], v[76:79]
  ds_read_b64_tr_b16 a[104:105], v199 offset:43008
  v_add_u32 v14, -14, v12
  v_mfma_f32_16x16x32_bf16 v[72:75], a[64:67], a[80:83], v[72:75]
  ds_read_b64_tr_b16 a[106:107], v199 offset:49152
  v_min_u32 v12, v12, v14
  v_mfma_f32_16x16x32_bf16 v[72:75], a[4:7], a[84:87], v[72:75]
  buffer_load_dwordx4 v205, s[36:39], s62 offen offset:1024 sc1 lds
  s_add_u32 m0, s65, 63488
  v_mfma_f32_16x16x32_bf16 v[72:75], a[24:27], a[88:91], v[72:75]
  ds_read_b64_tr_b16 a[108:109], v199 offset:44032
  v_mul_u32_u24 v13, 7168, v13
  v_mfma_f32_16x16x32_bf16 v[68:71], a[20:23], a[88:91], v[68:71]
  v_lshl_add_u32 v12, v12, 4, v13
  v_add_u32 v5, s48, v12
  v_mfma_f32_16x16x32_bf16 v[68:71], a[0:3], a[84:87], v[68:71]
  ds_read_b64_tr_b16 a[110:111], v199 offset:50176
  v_mfma_f32_16x16x32_bf16 v[68:71], a[60:63], a[80:83], v[68:71]
  s_waitcnt lgkmcnt(4)
  buffer_load_dword v206, s[36:39], s62 offen sc1 lds
  s_mov_b32 s61, 4132864
  v_mfma_f32_16x16x32_bf16 v[84:87], a[92:95], a[0:3], v[84:87]
  s_add_u32 m0, s63, 64512
  ds_read_b64_tr_b16 a[112:113], v199 offset:45056
  v_mfma_f32_16x16x32_bf16 v[84:87], a[96:99], a[20:23], v[84:87]
  s_sub_u32 s48, s48, 1024
  v_mfma_f32_16x16x32_bf16 v[84:87], a[100:103], a[40:43], v[84:87]
  ds_read_b64_tr_b16 a[114:115], v199 offset:51200
  v_add_u32 v12, 192, v10
  v_mfma_f32_16x16x32_bf16 v[88:91], a[100:103], a[44:47], v[88:91]
  buffer_load_dwordx4 v202, s[8:11], s61 offen offset:0 lds
  v_mul_u32_u24 v13, 4682, v12
  v_mfma_f32_16x16x32_bf16 v[88:91], a[96:99], a[24:27], v[88:91]
  ds_read_b128 a[60:63], v209 offset:12288
  v_lshrrev_b32 v13, 16, v13
  v_mfma_f32_16x16x32_bf16 v[88:91], a[92:95], a[4:7], v[88:91]
  ds_read_b64_tr_b16 a[80:81], v200 offset:0
  v_mul_i32_i24 v14, -14, v13
  v_mfma_f32_16x16x32_bf16 v[92:95], a[92:95], a[8:11], v[92:95]
  ds_read_b128 a[64:67], v209 offset:13312
  v_add3_u32 v12, v12, v14, s49
  v_mfma_f32_16x16x32_bf16 v[92:95], a[96:99], a[28:31], v[92:95]
  buffer_load_dwordx4 v203, s[8:11], s61 offen offset:1024 lds
  v_mfma_f32_16x16x32_bf16 v[92:95], a[100:103], a[48:51], v[92:95]
  ds_read_b64_tr_b16 a[82:83], v200 offset:6144
  v_mfma_f32_16x16x32_bf16 v[96:99], a[100:103], a[52:55], v[96:99]
  ds_read_b128 a[68:71], v209 offset:14336
  v_mfma_f32_16x16x32_bf16 v[96:99], a[96:99], a[32:35], v[96:99]
  ds_read_b64_tr_b16 a[84:85], v200 offset:1024
  v_add_u32 v14, -14, v12
  v_mfma_f32_16x16x32_bf16 v[96:99], a[92:95], a[12:15], v[96:99]
  s_waitcnt lgkmcnt(6)
  ds_read_b128 a[72:75], v209 offset:15360
  v_min_u32 v12, v12, v14
  v_mfma_f32_16x16x32_bf16 v[112:115], a[104:107], a[12:15], v[112:115]
  buffer_load_dwordx4 v204, s[8:11], s61 offen offset:2048 lds
  s_mov_b32 s62, 47104
  v_mfma_f32_16x16x32_bf16 v[112:115], a[108:111], a[32:35], v[112:115]
  s_add_u32 m0, s64, 76800
  ds_read_b128 a[76:79], v212 offset:20480
  v_mul_u32_u24 v13, 7168, v13
  v_mfma_f32_16x16x32_bf16 v[112:115], a[112:115], a[52:55], v[112:115]
  ds_read_b64_tr_b16 a[86:87], v200 offset:7168
  v_lshl_add_u32 v12, v12, 4, v13
  v_mfma_f32_16x16x32_bf16 v[108:111], a[112:115], a[48:51], v[108:111]
  ds_read_b64_tr_b16 a[88:89], v200 offset:2048
  v_add_u32 v6, s48, v12
  v_mfma_f32_16x16x32_bf16 v[108:111], a[108:111], a[28:31], v[108:111]
  buffer_load_dwordx4 v205, s[36:39], s62 offen offset:0 sc1 lds
  v_mfma_f32_16x16x32_bf16 v[108:111], a[104:107], a[8:11], v[108:111]
  ds_read_b64_tr_b16 a[90:91], v200 offset:8192
  v_mfma_f32_16x16x32_bf16 v[104:107], a[104:107], a[4:7], v[104:107]
  s_sub_u32 s48, s48, -3072
  v_mfma_f32_16x16x32_bf16 v[104:107], a[108:111], a[24:27], v[104:107]
  ds_read_b64_tr_b16 a[92:93], v201 offset:0
  v_mfma_f32_16x16x32_bf16 v[104:107], a[112:115], a[44:47], v[104:107]
  buffer_load_dwordx4 v205, s[36:39], s62 offen offset:1024 sc1 lds
  s_add_u32 m0, s65, 84992
  v_mfma_f32_16x16x32_bf16 v[100:103], a[112:115], a[40:43], v[100:103]
  ds_read_b64_tr_b16 a[94:95], v201 offset:6144
  v_add_u32 v12, 256, v10
  v_mfma_f32_16x16x32_bf16 v[100:103], a[108:111], a[20:23], v[100:103]
  v_mul_u32_u24 v13, 4682, v12
  v_lshrrev_b32 v13, 16, v13
  v_mfma_f32_16x16x32_bf16 v[100:103], a[104:107], a[0:3], v[100:103]
  s_waitcnt lgkmcnt(2)
  ds_read_b64_tr_b16 a[96:97], v201 offset:1024
  v_mul_i32_i24 v14, -14, v13
  v_mfma_f32_16x16x32_bf16 v[20:23], a[80:83], a[20:23], v[20:23]
  buffer_load_dword v206, s[36:39], s62 offen sc1 lds
  v_add3_u32 v12, v12, v14, s49
  v_mfma_f32_16x16x32_bf16 v[20:23], a[84:87], a[40:43], v[20:23]
  s_mov_b32 s61, 4325376
  s_add_u32 m0, s63, 86016
  ds_read_b64_tr_b16 a[98:99], v201 offset:7168
  v_mfma_f32_16x16x32_bf16 v[20:23], a[88:91], a[60:63], v[20:23]
  s_waitcnt vmcnt(12)
  s_barrier
  v_mfma_f32_16x16x32_bf16 v[24:27], a[88:91], a[64:67], v[24:27]
  ds_read_b64_tr_b16 a[100:101], v201 offset:2048
  v_mfma_f32_16x16x32_bf16 v[24:27], a[84:87], a[44:47], v[24:27]
  buffer_load_dwordx4 v202, s[8:11], s61 offen offset:0 lds
  v_add_u32 v14, -14, v12
  v_mfma_f32_16x16x32_bf16 v[24:27], a[80:83], a[24:27], v[24:27]
  ds_read_b64_tr_b16 a[102:103], v201 offset:8192
  v_min_u32 v12, v12, v14
  v_mfma_f32_16x16x32_bf16 v[28:31], a[80:83], a[28:31], v[28:31]
  ds_read_b128 a[0:3], v207 offset:12288
  v_mul_u32_u24 v13, 7168, v13
  v_mfma_f32_16x16x32_bf16 v[28:31], a[84:87], a[48:51], v[28:31]
  ds_read_b64_tr_b16 a[104:105], v196 offset:0
  v_lshl_add_u32 v12, v12, 4, v13
  v_mfma_f32_16x16x32_bf16 v[28:31], a[88:91], a[68:71], v[28:31]
  ds_read_b128 a[4:7], v207 offset:13312
  v_add_u32 v7, s48, v12
  v_mfma_f32_16x16x32_bf16 v[32:35], a[88:91], a[72:75], v[32:35]
  buffer_load_dwordx4 v203, s[8:11], s61 offen offset:1024 lds
  v_mfma_f32_16x16x32_bf16 v[32:35], a[84:87], a[52:55], v[32:35]
  ds_read_b64_tr_b16 a[106:107], v196 offset:6144
  v_mfma_f32_16x16x32_bf16 v[32:35], a[80:83], a[32:35], v[32:35]
  ds_read_b128 a[8:11], v207 offset:14336
  v_mfma_f32_16x16x32_bf16 v[116:119], a[80:83], a[36:39], v[116:119]
  s_sub_u32 s48, s48, 1024
  ds_read_b64_tr_b16 a[108:109], v196 offset:1024
  v_mfma_f32_16x16x32_bf16 v[116:119], a[84:87], a[56:59], v[116:119]
  ds_read_b128 a[12:15], v207 offset:15360
  v_add_u32 v12, 320, v10
  v_mfma_f32_16x16x32_bf16 v[116:119], a[88:91], a[76:79], v[116:119]
  s_waitcnt lgkmcnt(7)
  buffer_load_dwordx4 v204, s[8:11], s61 offen offset:2048 lds
  s_mov_b32 s62, 49152
  v_mfma_f32_16x16x32_bf16 v[48:51], a[92:95], a[32:35], v[48:51]
  s_add_u32 m0, s64, 98304
  ds_read_b128 a[16:19], v210 offset:20480
  v_mul_u32_u24 v13, 4682, v12
  v_mfma_f32_16x16x32_bf16 v[48:51], a[96:99], a[52:55], v[48:51]
  ds_read_b64_tr_b16 a[110:111], v196 offset:7168
  v_lshrrev_b32 v13, 16, v13
  v_mfma_f32_16x16x32_bf16 v[48:51], a[100:103], a[72:75], v[48:51]
  ds_read_b64_tr_b16 a[112:113], v196 offset:2048
  v_mul_i32_i24 v14, -14, v13
  v_mfma_f32_16x16x32_bf16 v[44:47], a[100:103], a[68:71], v[44:47]
  buffer_load_dwordx4 v205, s[36:39], s62 offen offset:0 sc1 lds
  v_add3_u32 v12, v12, v14, s49
  v_mfma_f32_16x16x32_bf16 v[44:47], a[96:99], a[48:51], v[44:47]
  ds_read_b64_tr_b16 a[114:115], v196 offset:8192
  v_mfma_f32_16x16x32_bf16 v[44:47], a[92:95], a[28:31], v[44:47]
  v_mfma_f32_16x16x32_bf16 v[40:43], a[92:95], a[24:27], v[40:43]
  v_add_u32 v14, -14, v12
  v_min_u32 v12, v12, v14
  v_mfma_f32_16x16x32_bf16 v[40:43], a[96:99], a[44:47], v[40:43]
  buffer_load_dwordx4 v205, s[36:39], s62 offen offset:1024 sc1 lds
  s_add_u32 m0, s65, 106496
  v_mfma_f32_16x16x32_bf16 v[40:43], a[100:103], a[64:67], v[40:43]
  ds_read_b64_tr_b16 a[80:81], v197 offset:0
  v_mul_u32_u24 v13, 7168, v13
  v_mfma_f32_16x16x32_bf16 v[36:39], a[100:103], a[60:63], v[36:39]
  ds_read_b64_tr_b16 a[82:83], v197 offset:6144
  v_lshl_add_u32 v12, v12, 4, v13
  v_mfma_f32_16x16x32_bf16 v[36:39], a[96:99], a[40:43], v[36:39]
  v_add_u32 v8, s48, v12
  v_mfma_f32_16x16x32_bf16 v[36:39], a[92:95], a[20:23], v[36:39]
  s_waitcnt lgkmcnt(2)
  buffer_load_dword v206, s[36:39], s62 offen sc1 lds
  s_mov_b32 s61, 4524032
  v_mfma_f32_16x16x32_bf16 v[52:55], a[40:43], a[104:107], v[52:55]
  s_add_u32 m0, s63, 107520
  ds_read_b64_tr_b16 a[84:85], v197 offset:1024
  v_mfma_f32_16x16x32_bf16 v[52:55], a[60:63], a[108:111], v[52:55]
  ds_read_b64_tr_b16 a[86:87], v197 offset:7168
  v_mfma_f32_16x16x32_bf16 v[52:55], a[0:3], a[112:115], v[52:55]
  s_sub_u32 s48, s48, 1024
  v_mfma_f32_16x16x32_bf16 v[56:59], a[4:7], a[112:115], v[56:59]
  buffer_load_dwordx4 v202, s[8:11], s61 offen offset:0 lds
  v_mfma_f32_16x16x32_bf16 v[56:59], a[64:67], a[108:111], v[56:59]
  ds_read_b64_tr_b16 a[88:89], v197 offset:2048
  v_add_u32 v12, 384, v10
  v_mfma_f32_16x16x32_bf16 v[56:59], a[44:47], a[104:107], v[56:59]
  ds_read_b64_tr_b16 a[90:91], v197 offset:8192
  v_mul_u32_u24 v13, 4682, v12
  v_mfma_f32_16x16x32_bf16 v[60:63], a[48:51], a[104:107], v[60:63]
  ds_read_b128 a[20:23], v207 offset:33792
  v_lshrrev_b32 v13, 16, v13
  v_mfma_f32_16x16x32_bf16 v[60:63], a[68:71], a[108:111], v[60:63]
  buffer_load_dwordx4 v203, s[8:11], s61 offen offset:1024 lds
  v_mul_i32_i24 v14, -14, v13
  v_mfma_f32_16x16x32_bf16 v[60:63], a[8:11], a[112:115], v[60:63]
  ds_read_b64_tr_b16 a[92:93], v196 offset:21504
  v_add3_u32 v12, v12, v14, s49
  v_mfma_f32_16x16x32_bf16 v[64:67], a[12:15], a[112:115], v[64:67]
  ds_read_b128 a[24:27], v207 offset:34816
  v_mfma_f32_16x16x32_bf16 v[64:67], a[72:75], a[108:111], v[64:67]
  ds_read_b64_tr_b16 a[94:95], v196 offset:27648
  v_mfma_f32_16x16x32_bf16 v[64:67], a[52:55], a[104:107], v[64:67]
  buffer_load_dwordx4 v204, s[8:11], s61 offen offset:2048 lds
  s_mov_b32 s62, 51200
  v_mfma_f32_16x16x32_bf16 v[120:123], a[56:59], a[104:107], v[120:123]
  s_add_u32 m0, s64, 119808
  ds_read_b128 a[28:31], v207 offset:35840
  v_add_u32 v14, -14, v12
  v_mfma_f32_16x16x32_bf16 v[120:123], a[76:79], a[108:111], v[120:123]
  ds_read_b64_tr_b16 a[96:97], v196 offset:22528
  v_min_u32 v12, v12, v14
  v_mfma_f32_16x16x32_bf16 v[120:123], a[16:19], a[112:115], v[120:123]
  s_waitcnt lgkmcnt(6)
  ds_read_b128 a[32:35], v207 offset:36864
  v_mul_u32_u24 v13, 7168, v13
  v_mfma_f32_16x16x32_bf16 v[80:83], a[52:55], a[80:83], v[80:83]
  buffer_load_dwordx4 v205, s[36:39], s62 offen offset:0 sc1 lds
  v_lshl_add_u32 v12, v12, 4, v13
  v_mfma_f32_16x16x32_bf16 v[80:83], a[72:75], a[84:87], v[80:83]
  ds_read_b64_tr_b16 a[98:99], v196 offset:28672
  v_add_u32 v9, s48, v12
  v_mfma_f32_16x16x32_bf16 v[80:83], a[12:15], a[88:91], v[80:83]
  ds_read_b128 a[36:39], v210 offset:41984
  v_mfma_f32_16x16x32_bf16 v[76:79], a[8:11], a[88:91], v[76:79]
  ds_read_b64_tr_b16 a[100:101], v196 offset:23552
  v_mfma_f32_16x16x32_bf16 v[76:79], a[68:71], a[84:87], v[76:79]
  buffer_load_dwordx4 v205, s[36:39], s62 offen offset:1024 sc1 lds
  s_add_u32 m0, s65, 128000
  v_mfma_f32_16x16x32_bf16 v[76:79], a[48:51], a[80:83], v[76:79]
  s_sub_u32 s48, s48, 1024
  ds_read_b64_tr_b16 a[102:103], v196 offset:29696
  v_mfma_f32_16x16x32_bf16 v[72:75], a[44:47], a[80:83], v[72:75]
  ds_read_b64_tr_b16 a[104:105], v197 offset:21504
  v_mfma_f32_16x16x32_bf16 v[72:75], a[64:67], a[84:87], v[72:75]
  s_and_b32 s48, s58, 1
  ds_read_b64_tr_b16 a[106:107], v197 offset:27648
  s_lshl_b32 s48, s48, 7
  v_mfma_f32_16x16x32_bf16 v[72:75], a[4:7], a[88:91], v[72:75]
  s_and_b32 s49, s58, 6
  buffer_load_dword v206, s[36:39], s62 offen sc1 lds
  s_add_u32 s48, s48, s49
  v_mfma_f32_16x16x32_bf16 v[68:71], a[0:3], a[88:91], v[68:71]
  ds_read_b64_tr_b16 a[108:109], v197 offset:22528
  v_mfma_f32_16x16x32_bf16 v[68:71], a[60:63], a[84:87], v[68:71]
  s_mov_b32 s61, 4722688
  s_add_u32 m0, s63, 129024
  ds_read_b64_tr_b16 a[110:111], v197 offset:28672
  v_mfma_f32_16x16x32_bf16 v[68:71], a[40:43], a[80:83], v[68:71]
  s_waitcnt vmcnt(12) lgkmcnt(4)
  s_barrier
  v_mfma_f32_16x16x32_bf16 v[84:87], a[92:95], a[60:63], v[84:87]
  ds_read_b64_tr_b16 a[112:113], v197 offset:23552
  v_mfma_f32_16x16x32_bf16 v[84:87], a[96:99], a[0:3], v[84:87]
  buffer_load_dwordx4 v202, s[8:11], s61 offen offset:0 lds
  v_bfe_u32 v12, v10, 1, 4
  v_mfma_f32_16x16x32_bf16 v[84:87], a[100:103], a[20:23], v[84:87]
  ds_read_b64_tr_b16 a[114:115], v197 offset:29696
  v_and_b32 v13, 1, v10
  v_mfma_f32_16x16x32_bf16 v[88:91], a[100:103], a[24:27], v[88:91]
  ds_read_b128 a[40:43], v207 offset:55296
  v_lshl_add_u32 v12, v12, 3, v13
  v_mfma_f32_16x16x32_bf16 v[88:91], a[96:99], a[4:7], v[88:91]
  ds_read_b64_tr_b16 a[80:81], v196 offset:43008
  v_add_lshl_u32 v251, v12, s48, 7
  v_mfma_f32_16x16x32_bf16 v[88:91], a[92:95], a[64:67], v[88:91]
  ds_read_b128 a[44:47], v207 offset:56320
  v_mfma_f32_16x16x32_bf16 v[92:95], a[92:95], a[68:71], v[92:95]
  buffer_load_dwordx4 v203, s[8:11], s61 offen offset:1024 lds
  v_mfma_f32_16x16x32_bf16 v[92:95], a[96:99], a[8:11], v[92:95]
  ds_read_b64_tr_b16 a[82:83], v196 offset:49152
  v_add_u32 v251, 98304, v251
  v_mfma_f32_16x16x32_bf16 v[92:95], a[100:103], a[28:31], v[92:95]
  ds_read_b128 a[48:51], v207 offset:57344
  v_and_b32 v12, 7, v10
  v_mfma_f32_16x16x32_bf16 v[96:99], a[100:103], a[32:35], v[96:99]
  ds_read_b64_tr_b16 a[84:85], v196 offset:44032
  v_lshlrev_b32 v12, 5, v12
  v_mfma_f32_16x16x32_bf16 v[96:99], a[96:99], a[12:15], v[96:99]
  s_and_b32 s48, s2, 31
  ds_read_b128 a[52:55], v207 offset:58368
  v_add_lshl_u32 v12, v12, s48, 7
  v_mfma_f32_16x16x32_bf16 v[96:99], a[92:95], a[72:75], v[96:99]
  s_waitcnt lgkmcnt(7)
  buffer_load_dwordx4 v204, s[8:11], s61 offen offset:2048 lds
  s_mov_b32 s62, 53248
  v_mfma_f32_16x16x32_bf16 v[112:115], a[104:107], a[72:75], v[112:115]
  s_add_u32 m0, s64, 141312
  ds_read_b128 a[56:59], v210 offset:63488
  v_cmp_gt_u32 vcc, 32, v10
  v_mfma_f32_16x16x32_bf16 v[112:115], a[108:111], a[12:15], v[112:115]
  s_nop 1
  ds_read_b64_tr_b16 a[86:87], v196 offset:50176
  v_cndmask_b32 v251, v12, v251, vcc
  v_mfma_f32_16x16x32_bf16 v[112:115], a[112:115], a[32:35], v[112:115]
  ds_read_b64_tr_b16 a[88:89], v196 offset:45056
  v_mfma_f32_16x16x32_bf16 v[108:111], a[112:115], a[28:31], v[108:111]
  buffer_load_dwordx4 v205, s[36:39], s62 offen offset:0 sc1 lds
  v_mfma_f32_16x16x32_bf16 v[108:111], a[108:111], a[8:11], v[108:111]
  ds_read_b64_tr_b16 a[90:91], v196 offset:51200
  v_mfma_f32_16x16x32_bf16 v[108:111], a[104:107], a[68:71], v[108:111]
  v_mfma_f32_16x16x32_bf16 v[104:107], a[104:107], a[64:67], v[104:107]
  v_mfma_f32_16x16x32_bf16 v[104:107], a[108:111], a[4:7], v[104:107]
  buffer_load_dwordx4 v205, s[36:39], s62 offen offset:1024 sc1 lds
  s_add_u32 m0, s65, 149504
  v_mfma_f32_16x16x32_bf16 v[104:107], a[112:115], a[24:27], v[104:107]
  ds_read_b64_tr_b16 a[92:93], v197 offset:43008
  v_mfma_f32_16x16x32_bf16 v[100:103], a[112:115], a[20:23], v[100:103]
  ds_read_b64_tr_b16 a[94:95], v197 offset:49152
  v_mfma_f32_16x16x32_bf16 v[100:103], a[108:111], a[0:3], v[100:103]
  v_mfma_f32_16x16x32_bf16 v[100:103], a[104:107], a[60:63], v[100:103]
  s_waitcnt lgkmcnt(2)
  buffer_load_dword v206, s[36:39], s62 offen sc1 lds
  s_mov_b32 s61, 4915200
  v_mfma_f32_16x16x32_bf16 v[20:23], a[80:83], a[0:3], v[20:23]
  s_add_u32 m0, s63, 0
  ds_read_b64_tr_b16 a[96:97], v197 offset:44032
  v_mfma_f32_16x16x32_bf16 v[20:23], a[84:87], a[20:23], v[20:23]
  ds_read_b64_tr_b16 a[98:99], v197 offset:50176
  v_mfma_f32_16x16x32_bf16 v[20:23], a[88:91], a[40:43], v[20:23]
  v_mfma_f32_16x16x32_bf16 v[24:27], a[88:91], a[44:47], v[24:27]
  buffer_load_dwordx4 v202, s[8:11], s61 offen offset:0 lds
  v_mfma_f32_16x16x32_bf16 v[24:27], a[84:87], a[24:27], v[24:27]
  ds_read_b64_tr_b16 a[100:101], v197 offset:45056
  v_mfma_f32_16x16x32_bf16 v[24:27], a[80:83], a[4:7], v[24:27]
  ds_read_b64_tr_b16 a[102:103], v197 offset:51200
  v_mfma_f32_16x16x32_bf16 v[28:31], a[80:83], a[8:11], v[28:31]
  ds_read_b128 a[60:63], v208 offset:12288
  v_mfma_f32_16x16x32_bf16 v[28:31], a[84:87], a[28:31], v[28:31]
  buffer_load_dwordx4 v203, s[8:11], s61 offen offset:1024 lds
  v_mfma_f32_16x16x32_bf16 v[28:31], a[88:91], a[48:51], v[28:31]
  ds_read_b64_tr_b16 a[104:105], v198 offset:0
  v_mfma_f32_16x16x32_bf16 v[32:35], a[88:91], a[52:55], v[32:35]
  ds_read_b128 a[64:67], v208 offset:13312
  v_mfma_f32_16x16x32_bf16 v[32:35], a[84:87], a[32:35], v[32:35]
  ds_read_b64_tr_b16 a[106:107], v198 offset:6144
  v_mfma_f32_16x16x32_bf16 v[32:35], a[80:83], a[12:15], v[32:35]
  buffer_load_dwordx4 v204, s[8:11], s61 offen offset:2048 lds
  s_mov_b32 s62, 55296
  v_mfma_f32_16x16x32_bf16 v[116:119], a[80:83], a[16:19], v[116:119]
  s_add_u32 m0, s64, 12288
  ds_read_b128 a[68:71], v208 offset:14336
  v_mfma_f32_16x16x32_bf16 v[116:119], a[84:87], a[36:39], v[116:119]
  ds_read_b64_tr_b16 a[108:109], v198 offset:1024
  v_mfma_f32_16x16x32_bf16 v[116:119], a[88:91], a[56:59], v[116:119]
  s_waitcnt lgkmcnt(6)
  ds_read_b128 a[72:75], v208 offset:15360
  v_mfma_f32_16x16x32_bf16 v[48:51], a[92:95], a[12:15], v[48:51]
  buffer_load_dwordx4 v205, s[36:39], s62 offen offset:0 sc1 lds
  v_mfma_f32_16x16x32_bf16 v[48:51], a[96:99], a[32:35], v[48:51]
  ds_read_b128 a[76:79], v211 offset:20480
  v_mfma_f32_16x16x32_bf16 v[48:51], a[100:103], a[52:55], v[48:51]
  ds_read_b64_tr_b16 a[110:111], v198 offset:7168
  v_mfma_f32_16x16x32_bf16 v[44:47], a[100:103], a[48:51], v[44:47]
  ds_read_b64_tr_b16 a[112:113], v198 offset:2048
  v_mfma_f32_16x16x32_bf16 v[44:47], a[96:99], a[28:31], v[44:47]
  buffer_load_dwordx4 v205, s[36:39], s62 offen offset:1024 sc1 lds
  s_add_u32 m0, s65, 20480
  v_mfma_f32_16x16x32_bf16 v[44:47], a[92:95], a[8:11], v[44:47]
  ds_read_b64_tr_b16 a[114:115], v198 offset:8192
  v_mfma_f32_16x16x32_bf16 v[40:43], a[92:95], a[4:7], v[40:43]
  v_mfma_f32_16x16x32_bf16 v[40:43], a[96:99], a[24:27], v[40:43]
  ds_read_b64_tr_b16 a[80:81], v199 offset:0
  v_mfma_f32_16x16x32_bf16 v[40:43], a[100:103], a[44:47], v[40:43]
  buffer_load_dword v206, s[36:39], s62 offen sc1 lds
  v_mfma_f32_16x16x32_bf16 v[36:39], a[100:103], a[40:43], v[36:39]
  ds_read_b64_tr_b16 a[82:83], v199 offset:6144
  v_mfma_f32_16x16x32_bf16 v[36:39], a[96:99], a[20:23], v[36:39]
  v_mfma_f32_16x16x32_bf16 v[36:39], a[92:95], a[0:3], v[36:39]
  s_waitcnt lgkmcnt(2)
  ds_read_b64_tr_b16 a[84:85], v199 offset:1024
  v_mfma_f32_16x16x32_bf16 v[52:55], a[20:23], a[104:107], v[52:55]
  v_mfma_f32_16x16x32_bf16 v[52:55], a[40:43], a[108:111], v[52:55]
  s_mov_b32 s61, 5113856
  s_add_u32 m0, s63, 21504
  ds_read_b64_tr_b16 a[86:87], v199 offset:7168
  v_mfma_f32_16x16x32_bf16 v[52:55], a[60:63], a[112:115], v[52:55]
  s_waitcnt vmcnt(12)
  s_barrier
  v_mfma_f32_16x16x32_bf16 v[56:59], a[64:67], a[112:115], v[56:59]
  ds_read_b64_tr_b16 a[88:89], v199 offset:2048
  v_mfma_f32_16x16x32_bf16 v[56:59], a[44:47], a[108:111], v[56:59]
  buffer_load_dwordx4 v202, s[8:11], s61 offen offset:0 lds
  v_mfma_f32_16x16x32_bf16 v[56:59], a[24:27], a[104:107], v[56:59]
  ds_read_b64_tr_b16 a[90:91], v199 offset:8192
  v_mfma_f32_16x16x32_bf16 v[60:63], a[28:31], a[104:107], v[60:63]
  ds_read_b128 a[0:3], v208 offset:33792
  v_mfma_f32_16x16x32_bf16 v[60:63], a[48:51], a[108:111], v[60:63]
  ds_read_b64_tr_b16 a[92:93], v198 offset:21504
  v_mfma_f32_16x16x32_bf16 v[60:63], a[68:71], a[112:115], v[60:63]
  ds_read_b128 a[4:7], v208 offset:34816
  v_mfma_f32_16x16x32_bf16 v[64:67], a[72:75], a[112:115], v[64:67]
  buffer_load_dwordx4 v203, s[8:11], s61 offen offset:1024 lds
  v_mfma_f32_16x16x32_bf16 v[64:67], a[52:55], a[108:111], v[64:67]
  ds_read_b64_tr_b16 a[94:95], v198 offset:27648
  v_mfma_f32_16x16x32_bf16 v[64:67], a[32:35], a[104:107], v[64:67]
  ds_read_b128 a[8:11], v208 offset:35840
  v_mfma_f32_16x16x32_bf16 v[120:123], a[36:39], a[104:107], v[120:123]
  ds_read_b64_tr_b16 a[96:97], v198 offset:22528
  v_mfma_f32_16x16x32_bf16 v[120:123], a[56:59], a[108:111], v[120:123]
  ds_read_b128 a[12:15], v208 offset:36864
  v_mfma_f32_16x16x32_bf16 v[120:123], a[76:79], a[112:115], v[120:123]
  s_waitcnt lgkmcnt(7)
  buffer_load_dwordx4 v204, s[8:11], s61 offen offset:2048 lds
  s_mov_b32 s62, 57344
  v_mfma_f32_16x16x32_bf16 v[80:83], a[32:35], a[80:83], v[80:83]
  s_add_u32 m0, s64, 33792
  ds_read_b64_tr_b16 a[98:99], v198 offset:28672
  v_mfma_f32_16x16x32_bf16 v[80:83], a[52:55], a[84:87], v[80:83]
  ds_read_b128 a[16:19], v211 offset:41984
  v_mfma_f32_16x16x32_bf16 v[80:83], a[72:75], a[88:91], v[80:83]
  ds_read_b64_tr_b16 a[100:101], v198 offset:23552
  v_mfma_f32_16x16x32_bf16 v[76:79], a[68:71], a[88:91], v[76:79]
  buffer_load_dwordx4 v205, s[36:39], s62 offen offset:0 sc1 lds
  v_mfma_f32_16x16x32_bf16 v[76:79], a[48:51], a[84:87], v[76:79]
  ds_read_b64_tr_b16 a[102:103], v198 offset:29696
  v_mfma_f32_16x16x32_bf16 v[76:79], a[28:31], a[80:83], v[76:79]
  ds_read_b64_tr_b16 a[104:105], v199 offset:21504
  v_mfma_f32_16x16x32_bf16 v[72:75], a[24:27], a[80:83], v[72:75]
  ds_read_b64_tr_b16 a[106:107], v199 offset:27648
  v_mfma_f32_16x16x32_bf16 v[72:75], a[44:47], a[84:87], v[72:75]
  buffer_load_dwordx4 v205, s[36:39], s62 offen offset:1024 sc1 lds
  s_add_u32 m0, s65, 41984
  v_mfma_f32_16x16x32_bf16 v[72:75], a[64:67], a[88:91], v[72:75]
  ds_read_b64_tr_b16 a[108:109], v199 offset:22528
  v_mfma_f32_16x16x32_bf16 v[68:71], a[60:63], a[88:91], v[68:71]
  s_lshr_b32 s68, s2, 3
  s_lshl2_add_u32 s68, s68, s44
  s_bfe_u32 s69, s2, 0x20001
  v_mfma_f32_16x16x32_bf16 v[68:71], a[40:43], a[84:87], v[68:71]
  s_lshl_b32 s69, s69, 7
  s_add_u32 s69, s69, s68
  s_lshl_b32 s69, s69, 13
  v_mfma_f32_16x16x32_bf16 v[68:71], a[20:23], a[80:83], v[68:71]
  s_waitcnt lgkmcnt(3)
  s_lshl_b32 s68, s68, 14
  s_bitcmp1_b32 s2, 0
  v_mfma_f32_16x16x32_bf16 v[84:87], a[92:95], a[40:43], v[84:87]
  s_cselect_b32 s68, s68, 1073741824
  s_cselect_b32 s69, s69, 1073741824
  buffer_load_dword v206, s[36:39], s62 offen sc1 lds
  v_mfma_f32_16x16x32_bf16 v[84:87], a[96:99], a[60:63], v[84:87]
  s_mov_b32 s61, 5312512
  s_add_u32 m0, s63, 43008
  ds_read_b64_tr_b16 a[110:111], v199 offset:28672
  v_mfma_f32_16x16x32_bf16 v[84:87], a[100:103], a[0:3], v[84:87]
  ds_read_b64_tr_b16 a[112:113], v199 offset:23552
  v_and_b32 v214, 15, v10
  v_mfma_f32_16x16x32_bf16 v[88:91], a[100:103], a[4:7], v[88:91]
  ds_read_b64_tr_b16 a[114:115], v199 offset:29696
  v_lshlrev_b32 v214, 10, v214
  v_mfma_f32_16x16x32_bf16 v[88:91], a[96:99], a[64:67], v[88:91]
  buffer_load_dwordx4 v202, s[8:11], s61 offen offset:0 lds
  v_mfma_f32_16x16x32_bf16 v[88:91], a[92:95], a[44:47], v[88:91]
Ha0_1:
  s_cbranch_execz Ha0_2
  ds_read_b128 a[20:23], v208 offset:55296
  v_mfma_f32_16x16x32_bf16 v[92:95], a[92:95], a[48:51], v[92:95]
  ds_read_b64_tr_b16 a[80:81], v198 offset:43008
  v_mfma_f32_16x16x32_bf16 v[92:95], a[96:99], a[68:71], v[92:95]
  ds_read_b128 a[24:27], v208 offset:56320
  v_mfma_f32_16x16x32_bf16 v[92:95], a[100:103], a[8:11], v[92:95]
  buffer_load_dwordx4 v203, s[8:11], s61 offen offset:1024 lds
  v_mfma_f32_16x16x32_bf16 v[96:99], a[100:103], a[12:15], v[96:99]
  ds_read_b64_tr_b16 a[82:83], v198 offset:49152
  v_mfma_f32_16x16x32_bf16 v[96:99], a[96:99], a[72:75], v[96:99]
  ds_read_b128 a[28:31], v208 offset:57344
  v_mfma_f32_16x16x32_bf16 v[96:99], a[92:95], a[52:55], v[96:99]
  s_waitcnt lgkmcnt(5)
  ds_read_b64_tr_b16 a[84:85], v198 offset:44032
  v_mfma_f32_16x16x32_bf16 v[112:115], a[104:107], a[52:55], v[112:115]
  ds_read_b128 a[32:35], v208 offset:58368
  v_mfma_f32_16x16x32_bf16 v[112:115], a[108:111], a[72:75], v[112:115]
  buffer_load_dwordx4 v204, s[8:11], s61 offen offset:2048 lds
  s_mov_b32 s62, 59392
  v_mfma_f32_16x16x32_bf16 v[112:115], a[112:115], a[12:15], v[112:115]
  s_add_u32 m0, s64, 55296
  ds_read_b128 a[36:39], v211 offset:63488
  v_mfma_f32_16x16x32_bf16 v[108:111], a[112:115], a[8:11], v[108:111]
  ds_read_b64_tr_b16 a[86:87], v198 offset:50176
  v_mfma_f32_16x16x32_bf16 v[108:111], a[108:111], a[68:71], v[108:111]
  ds_read_b64_tr_b16 a[88:89], v198 offset:45056
  v_mfma_f32_16x16x32_bf16 v[108:111], a[104:107], a[48:51], v[108:111]
  buffer_load_dwordx4 v205, s[36:39], s62 offen offset:0 sc1 lds
  v_mfma_f32_16x16x32_bf16 v[104:107], a[104:107], a[44:47], v[104:107]
  ds_read_b64_tr_b16 a[90:91], v198 offset:51200
  v_mfma_f32_16x16x32_bf16 v[104:107], a[108:111], a[64:67], v[104:107]
  ds_read_b64_tr_b16 a[92:93], v199 offset:43008
  v_mfma_f32_16x16x32_bf16 v[104:107], a[112:115], a[4:7], v[104:107]
  v_mfma_f32_16x16x32_bf16 v[100:103], a[112:115], a[0:3], v[100:103]
  buffer_load_dwordx4 v205, s[36:39], s62 offen offset:1024 sc1 lds
  s_add_u32 m0, s65, 63488
  v_mfma_f32_16x16x32_bf16 v[100:103], a[108:111], a[60:63], v[100:103]
  ds_read_b64_tr_b16 a[94:95], v199 offset:49152
  v_mfma_f32_16x16x32_bf16 v[100:103], a[104:107], a[40:43], v[100:103]
  s_waitcnt lgkmcnt(2)
  ds_read_b64_tr_b16 a[96:97], v199 offset:44032
  v_mfma_f32_16x16x32_bf16 v[20:23], a[80:83], a[60:63], v[20:23]
  v_mfma_f32_16x16x32_bf16 v[20:23], a[84:87], a[0:3], v[20:23]
  buffer_load_dword v206, s[36:39], s62 offen sc1 lds
  s_mov_b32 s61, 5505024
  v_mfma_f32_16x16x32_bf16 v[20:23], a[88:91], a[20:23], v[20:23]
  s_waitcnt vmcnt(12)
  s_barrier
  s_add_u32 m0, s63, 64512
  v_mfma_f32_16x16x32_bf16 v[24:27], a[88:91], a[24:27], v[24:27]
  ds_read_b64_tr_b16 a[98:99], v199 offset:50176
  v_mfma_f32_16x16x32_bf16 v[24:27], a[84:87], a[4:7], v[24:27]
  ds_read_b64_tr_b16 a[100:101], v199 offset:45056
  v_mfma_f32_16x16x32_bf16 v[24:27], a[80:83], a[64:67], v[24:27]
  buffer_load_dword a252, v214, s[12:15], s68 offen offset:384
  v_and_b32 v214, 0x1fff, v214
  v_mfma_f32_16x16x32_bf16 v[28:31], a[80:83], a[68:71], v[28:31]
  ds_read_b64_tr_b16 a[102:103], v199 offset:51200
  v_mfma_f32_16x16x32_bf16 v[28:31], a[84:87], a[8:11], v[28:31]
  ds_read_b128 a[40:43], v209 offset:12288
  v_mfma_f32_16x16x32_bf16 v[28:31], a[88:91], a[28:31], v[28:31]
  ds_read_b64_tr_b16 a[104:105], v200 offset:0
  v_mfma_f32_16x16x32_bf16 v[32:35], a[88:91], a[32:35], v[32:35]
  buffer_load_dwordx4 v202, s[8:11], s61 offen offset:0 lds
  v_mfma_f32_16x16x32_bf16 v[32:35], a[84:87], a[12:15], v[32:35]
  ds_read_b128 a[44:47], v209 offset:13312
  v_mfma_f32_16x16x32_bf16 v[32:35], a[80:83], a[72:75], v[32:35]
  ds_read_b64_tr_b16 a[106:107], v200 offset:6144
  v_mfma_f32_16x16x32_bf16 v[116:119], a[80:83], a[76:79], v[116:119]
  ds_read_b128 a[48:51], v209 offset:14336
  v_mfma_f32_16x16x32_bf16 v[116:119], a[84:87], a[16:19], v[116:119]
  buffer_load_dword a252, v214, s[4:7], s69 offen offset:384
  v_mfma_f32_16x16x32_bf16 v[116:119], a[88:91], a[36:39], v[116:119]
  s_waitcnt lgkmcnt(5)
  ds_read_b64_tr_b16 a[108:109], v200 offset:1024
  v_mfma_f32_16x16x32_bf16 v[48:51], a[92:95], a[72:75], v[48:51]
  ds_read_b128 a[52:55], v209 offset:15360
  v_mfma_f32_16x16x32_bf16 v[48:51], a[96:99], a[12:15], v[48:51]
  ds_read_b128 a[56:59], v212 offset:20480
  v_mfma_f32_16x16x32_bf16 v[48:51], a[100:103], a[32:35], v[48:51]
  buffer_load_dwordx4 v203, s[8:11], s61 offen offset:1024 lds
  v_mfma_f32_16x16x32_bf16 v[44:47], a[100:103], a[28:31], v[44:47]
  ds_read_b64_tr_b16 a[110:111], v200 offset:7168
  v_mfma_f32_16x16x32_bf16 v[44:47], a[96:99], a[8:11], v[44:47]
  ds_read_b64_tr_b16 a[112:113], v200 offset:2048
  v_mfma_f32_16x16x32_bf16 v[44:47], a[92:95], a[68:71], v[44:47]
  ds_read_b64_tr_b16 a[114:115], v200 offset:8192
  v_mfma_f32_16x16x32_bf16 v[40:43], a[92:95], a[64:67], v[40:43]
  buffer_load_dwordx4 v204, s[8:11], s61 offen offset:2048 lds
  s_mov_b32 s62, 61440
  v_mfma_f32_16x16x32_bf16 v[40:43], a[96:99], a[4:7], v[40:43]
  s_add_u32 m0, s64, 76800
  ds_read_b64_tr_b16 a[80:81], v201 offset:0
  v_mfma_f32_16x16x32_bf16 v[40:43], a[100:103], a[24:27], v[40:43]
  v_mfma_f32_16x16x32_bf16 v[36:39], a[100:103], a[20:23], v[36:39]
  ds_read_b64_tr_b16 a[82:83], v201 offset:6144
  v_mfma_f32_16x16x32_bf16 v[36:39], a[96:99], a[0:3], v[36:39]
  buffer_load_dwordx4 v205, s[36:39], s62 offen offset:0 sc1 lds
  v_mfma_f32_16x16x32_bf16 v[36:39], a[92:95], a[60:63], v[36:39]
  s_waitcnt lgkmcnt(2)
  ds_read_b64_tr_b16 a[84:85], v201 offset:1024
  v_mfma_f32_16x16x32_bf16 v[52:55], a[0:3], a[104:107], v[52:55]
  v_mfma_f32_16x16x32_bf16 v[52:55], a[20:23], a[108:111], v[52:55]
  ds_read_b64_tr_b16 a[86:87], v201 offset:7168
  v_mfma_f32_16x16x32_bf16 v[52:55], a[40:43], a[112:115], v[52:55]
  buffer_load_dwordx4 v205, s[36:39], s62 offen offset:1024 sc1 lds
  s_add_u32 m0, s65, 84992
  v_mfma_f32_16x16x32_bf16 v[56:59], a[44:47], a[112:115], v[56:59]
  ds_read_b64_tr_b16 a[88:89], v201 offset:2048
  v_mfma_f32_16x16x32_bf16 v[56:59], a[24:27], a[108:111], v[56:59]
  v_mfma_f32_16x16x32_bf16 v[56:59], a[4:7], a[104:107], v[56:59]
  ds_read_b64_tr_b16 a[90:91], v201 offset:8192
  v_mfma_f32_16x16x32_bf16 v[60:63], a[8:11], a[104:107], v[60:63]
  buffer_load_dword v206, s[36:39], s62 offen sc1 lds
  s_mov_b32 s61, 5703680
  v_mfma_f32_16x16x32_bf16 v[60:63], a[28:31], a[108:111], v[60:63]
  s_add_u32 m0, s63, 86016
  ds_read_b128 a[60:63], v207 offset:12288
  v_mfma_f32_16x16x32_bf16 v[60:63], a[48:51], a[112:115], v[60:63]
  ds_read_b64_tr_b16 a[92:93], v196 offset:0
  v_mfma_f32_16x16x32_bf16 v[64:67], a[52:55], a[112:115], v[64:67]
  ds_read_b128 a[64:67], v207 offset:13312
  v_mfma_f32_16x16x32_bf16 v[64:67], a[32:35], a[108:111], v[64:67]
  buffer_load_dwordx4 v202, s[8:11], s61 offen offset:0 lds
  v_mfma_f32_16x16x32_bf16 v[64:67], a[12:15], a[104:107], v[64:67]
  ds_read_b64_tr_b16 a[94:95], v196 offset:6144
  v_mfma_f32_16x16x32_bf16 v[120:123], a[16:19], a[104:107], v[120:123]
  ds_read_b128 a[68:71], v207 offset:14336
  v_mfma_f32_16x16x32_bf16 v[120:123], a[36:39], a[108:111], v[120:123]
  ds_read_b64_tr_b16 a[96:97], v196 offset:1024
  v_mfma_f32_16x16x32_bf16 v[120:123], a[56:59], a[112:115], v[120:123]
  s_waitcnt lgkmcnt(6)
  buffer_load_dwordx4 v203, s[8:11], s61 offen offset:1024 lds
  v_mfma_f32_16x16x32_bf16 v[80:83], a[12:15], a[80:83], v[80:83]
  ds_read_b128 a[72:75], v207 offset:15360
  v_mfma_f32_16x16x32_bf16 v[80:83], a[32:35], a[84:87], v[80:83]
  ds_read_b64_tr_b16 a[98:99], v196 offset:7168
  v_mfma_f32_16x16x32_bf16 v[80:83], a[52:55], a[88:91], v[80:83]
  ds_read_b128 a[76:79], v210 offset:20480
  v_mfma_f32_16x16x32_bf16 v[76:79], a[48:51], a[88:91], v[76:79]
  buffer_load_dwordx4 v204, s[8:11], s61 offen offset:2048 lds
  s_mov_b32 s62, 63488
  v_mfma_f32_16x16x32_bf16 v[76:79], a[28:31], a[84:87], v[76:79]
  s_add_u32 m0, s64, 98304
  ds_read_b64_tr_b16 a[100:101], v196 offset:2048
  v_mfma_f32_16x16x32_bf16 v[76:79], a[8:11], a[80:83], v[76:79]
  ds_read_b64_tr_b16 a[102:103], v196 offset:8192
  v_mfma_f32_16x16x32_bf16 v[72:75], a[4:7], a[80:83], v[72:75]
  ds_read_b64_tr_b16 a[104:105], v197 offset:0
  v_mfma_f32_16x16x32_bf16 v[72:75], a[24:27], a[84:87], v[72:75]
  buffer_load_dwordx4 v205, s[36:39], s62 offen offset:0 sc1 lds
  v_mfma_f32_16x16x32_bf16 v[72:75], a[44:47], a[88:91], v[72:75]
  ds_read_b64_tr_b16 a[106:107], v197 offset:6144
  v_mfma_f32_16x16x32_bf16 v[68:71], a[40:43], a[88:91], v[68:71]
  ds_read_b64_tr_b16 a[108:109], v197 offset:1024
  v_mfma_f32_16x16x32_bf16 v[68:71], a[20:23], a[84:87], v[68:71]
  ds_read_b64_tr_b16 a[110:111], v197 offset:7168
  v_mfma_f32_16x16x32_bf16 v[68:71], a[0:3], a[80:83], v[68:71]
  s_waitcnt vmcnt(12) lgkmcnt(4)
  s_barrier
  buffer_load_dwordx4 v205, s[36:39], s62 offen offset:1024 sc1 lds
  v_mfma_f32_16x16x32_bf16 v[84:87], a[92:95], a[20:23], v[84:87]
  s_add_u32 m0, s65, 106496
  ds_read_b64_tr_b16 a[112:113], v197 offset:2048
  v_mfma_f32_16x16x32_bf16 v[84:87], a[96:99], a[40:43], v[84:87]
  v_mfma_f32_16x16x32_bf16 v[84:87], a[100:103], a[60:63], v[84:87]
  ds_read_b64_tr_b16 a[114:115], v197 offset:8192
  v_mfma_f32_16x16x32_bf16 v[88:91], a[100:103], a[64:67], v[88:91]
  buffer_load_dword v206, s[36:39], s62 offen sc1 lds
  s_mov_b32 s61, 5902336
  v_mfma_f32_16x16x32_bf16 v[88:91], a[96:99], a[44:47], v[88:91]
  s_add_u32 m0, s63, 107520
  ds_read_b128 a[0:3], v207 offset:33792
  v_mfma_f32_16x16x32_bf16 v[88:91], a[92:95], a[24:27], v[88:91]
  ds_read_b64_tr_b16 a[80:81], v196 offset:21504
  v_mfma_f32_16x16x32_bf16 v[92:95], a[92:95], a[28:31], v[92:95]
  ds_read_b128 a[4:7], v207 offset:34816
  v_mfma_f32_16x16x32_bf16 v[92:95], a[96:99], a[48:51], v[92:95]
  buffer_load_dwordx4 v202, s[8:11], s61 offen offset:0 lds
  v_mfma_f32_16x16x32_bf16 v[92:95], a[100:103], a[68:71], v[92:95]
  ds_read_b64_tr_b16 a[82:83], v196 offset:27648
  v_mfma_f32_16x16x32_bf16 v[96:99], a[100:103], a[72:75], v[96:99]
  ds_read_b128 a[8:11], v207 offset:35840
  v_mfma_f32_16x16x32_bf16 v[96:99], a[96:99], a[52:55], v[96:99]
  ds_read_b64_tr_b16 a[84:85], v196 offset:22528
  v_mfma_f32_16x16x32_bf16 v[96:99], a[92:95], a[32:35], v[96:99]
  s_waitcnt lgkmcnt(6)
  buffer_load_dwordx4 v203, s[8:11], s61 offen offset:1024 lds
  s_mov_b32 s61, 6094848
  v_mfma_f32_16x16x32_bf16 v[112:115], a[104:107], a[32:35], v[112:115]
  s_add_u32 m0, s63, 129024
  ds_read_b128 a[12:15], v207 offset:36864
  v_mfma_f32_16x16x32_bf16 v[112:115], a[108:111], a[52:55], v[112:115]
  ds_read_b128 a[16:19], v210 offset:41984
  v_mfma_f32_16x16x32_bf16 v[112:115], a[112:115], a[72:75], v[112:115]
  ds_read_b64_tr_b16 a[86:87], v196 offset:28672
  v_mfma_f32_16x16x32_bf16 v[108:111], a[112:115], a[68:71], v[108:111]
  buffer_load_dwordx4 v202, s[8:11], s61 offen offset:0 lds
  s_nop 0
  v_mfma_f32_16x16x32_bf16 v[108:111], a[108:111], a[48:51], v[108:111]
  s_bfe_u32 s66, s2, 0x30004
  s_and_b32 s67, s2, 3
  s_lshl3_add_u32 s66, s67, s66
  v_mfma_f32_16x16x32_bf16 v[108:111], a[104:107], a[28:31], v[108:111]
  s_lshl2_add_u32 s66, s66, s44
  s_mul_i32 s66, s66, 98304
  s_and_b32 s67, s51, 0x3800
  v_mfma_f32_16x16x32_bf16 v[104:107], a[104:107], a[24:27], v[104:107]
  s_add_u32 s66, s66, s67
  s_and_b32 s67, s2, 8
  s_lshl_b32 s67, s67, 7
  v_mfma_f32_16x16x32_bf16 v[104:107], a[108:111], a[44:47], v[104:107]
  s_add_u32 s66, s66, s67
  ds_read_b64_tr_b16 a[88:89], v196 offset:23552
  v_and_b32 v215, 7, v10
  v_mfma_f32_16x16x32_bf16 v[104:107], a[112:115], a[64:67], v[104:107]
  ds_read_b64_tr_b16 a[90:91], v196 offset:29696
  v_mul_u32_u24 v215, 12288, v215
  v_mfma_f32_16x16x32_bf16 v[100:103], a[112:115], a[60:63], v[100:103]
  buffer_load_dword a252, v215, s[28:31], s66 offen offset:384
  v_mfma_f32_16x16x32_bf16 v[100:103], a[108:111], a[40:43], v[100:103]
  ds_read_b64_tr_b16 a[92:93], v197 offset:21504
  v_mfma_f32_16x16x32_bf16 v[100:103], a[104:107], a[20:23], v[100:103]
  s_waitcnt lgkmcnt(1)
  ds_read_b64_tr_b16 a[94:95], v197 offset:27648
  v_mfma_f32_16x16x32_bf16 v[20:23], a[80:83], a[40:43], v[20:23]
  ds_read_b64_tr_b16 a[96:97], v197 offset:22528
  v_mfma_f32_16x16x32_bf16 v[20:23], a[84:87], a[60:63], v[20:23]
  buffer_load_dwordx4 v[136:139], v176, s[28:31], s51 offen nt
  s_add_u32 s51, s51, 12288
  v_mfma_f32_16x16x32_bf16 v[20:23], a[88:91], a[0:3], v[20:23]
  ds_read_b64_tr_b16 a[98:99], v197 offset:28672
  v_mfma_f32_16x16x32_bf16 v[24:27], a[88:91], a[4:7], v[24:27]
  ds_read_b64_tr_b16 a[100:101], v197 offset:23552
  v_mfma_f32_16x16x32_bf16 v[24:27], a[84:87], a[64:67], v[24:27]
  v_mfma_f32_16x16x32_bf16 v[24:27], a[80:83], a[44:47], v[24:27]
  buffer_load_dwordx4 v[140:143], v176, s[28:31], s51 offen nt
  s_add_u32 s51, s51, 12288
  v_mfma_f32_16x16x32_bf16 v[28:31], a[80:83], a[48:51], v[28:31]
  ds_read_b64_tr_b16 a[102:103], v197 offset:29696
  v_mfma_f32_16x16x32_bf16 v[28:31], a[84:87], a[68:71], v[28:31]
  ds_read_b128 a[20:23], v207 offset:55296
  v_mfma_f32_16x16x32_bf16 v[28:31], a[88:91], a[8:11], v[28:31]
  ds_read_b64_tr_b16 a[104:105], v196 offset:43008
  v_mfma_f32_16x16x32_bf16 v[32:35], a[88:91], a[12:15], v[32:35]
  buffer_load_dwordx4 v[144:147], v176, s[28:31], s51 offen nt
  s_add_u32 s51, s51, 12288
  v_mfma_f32_16x16x32_bf16 v[32:35], a[84:87], a[72:75], v[32:35]
  ds_read_b128 a[24:27], v207 offset:56320
  v_mfma_f32_16x16x32_bf16 v[32:35], a[80:83], a[52:55], v[32:35]
  ds_read_b64_tr_b16 a[106:107], v196 offset:49152
  v_mfma_f32_16x16x32_bf16 v[116:119], a[80:83], a[56:59], v[116:119]
  ds_read_b128 a[28:31], v207 offset:57344
  v_mfma_f32_16x16x32_bf16 v[116:119], a[84:87], a[76:79], v[116:119]
  buffer_load_dwordx4 v[148:151], v176, s[28:31], s51 offen nt
  s_add_u32 s51, s51, 12288
  v_mfma_f32_16x16x32_bf16 v[116:119], a[88:91], a[16:19], v[116:119]
  s_waitcnt lgkmcnt(5)
  ds_read_b64_tr_b16 a[108:109], v196 offset:44032
  v_mfma_f32_16x16x32_bf16 v[48:51], a[92:95], a[52:55], v[48:51]
  ds_read_b128 a[32:35], v207 offset:58368
  v_mfma_f32_16x16x32_bf16 v[48:51], a[96:99], a[72:75], v[48:51]
  ds_read_b128 a[36:39], v210 offset:63488
  v_mfma_f32_16x16x32_bf16 v[48:51], a[100:103], a[12:15], v[48:51]
  buffer_load_dwordx4 v[152:155], v176, s[28:31], s51 offen nt
  s_add_u32 s51, s51, 12288
  v_mfma_f32_16x16x32_bf16 v[44:47], a[100:103], a[8:11], v[44:47]
  ds_read_b64_tr_b16 a[110:111], v196 offset:50176
  v_mfma_f32_16x16x32_bf16 v[44:47], a[96:99], a[68:71], v[44:47]
  ds_read_b64_tr_b16 a[112:113], v196 offset:45056
  v_mfma_f32_16x16x32_bf16 v[44:47], a[92:95], a[48:51], v[44:47]
  ds_read_b64_tr_b16 a[114:115], v196 offset:51200
  v_mfma_f32_16x16x32_bf16 v[40:43], a[92:95], a[44:47], v[40:43]
  buffer_load_dwordx4 v[156:159], v176, s[28:31], s51 offen nt
  s_add_u32 s51, s51, 12288
  v_mfma_f32_16x16x32_bf16 v[40:43], a[96:99], a[64:67], v[40:43]
  ds_read_b64_tr_b16 a[80:81], v197 offset:43008
  v_mfma_f32_16x16x32_bf16 v[40:43], a[100:103], a[4:7], v[40:43]
  v_mfma_f32_16x16x32_bf16 v[36:39], a[100:103], a[0:3], v[36:39]
  ds_read_b64_tr_b16 a[82:83], v197 offset:49152
  v_mfma_f32_16x16x32_bf16 v[36:39], a[96:99], a[60:63], v[36:39]
  buffer_load_dwordx4 v[160:163], v176, s[28:31], s51 offen nt
  s_add_u32 s51, s51, 12288
  v_mfma_f32_16x16x32_bf16 v[36:39], a[92:95], a[40:43], v[36:39]
  s_waitcnt lgkmcnt(2)
  ds_read_b64_tr_b16 a[84:85], v197 offset:44032
  v_mfma_f32_16x16x32_bf16 v[52:55], a[60:63], a[104:107], v[52:55]
  v_mfma_f32_16x16x32_bf16 v[52:55], a[0:3], a[108:111], v[52:55]
  ds_read_b64_tr_b16 a[86:87], v197 offset:50176
  v_mfma_f32_16x16x32_bf16 v[52:55], a[20:23], a[112:115], v[52:55]
  s_waitcnt vmcnt(11)
  s_barrier
  buffer_load_dwordx4 v[164:167], v176, s[28:31], s51 offen nt
  v_mfma_f32_16x16x32_bf16 v[56:59], a[24:27], a[112:115], v[56:59]
  ds_read_b64_tr_b16 a[88:89], v197 offset:45056
  v_lshrrev_b32 v215, 2, v10
  v_mfma_f32_16x16x32_bf16 v[56:59], a[4:7], a[108:111], v[56:59]
  v_min_u32 v215, (XEND-G3S)/4096, v215
  v_and_b32 v213, 3, v10
  v_mfma_f32_16x16x32_bf16 v[56:59], a[64:67], a[104:107], v[56:59]
  ds_read_b64_tr_b16 a[90:91], v197 offset:51200
  v_lshlrev_b32 v213, 7, v213
  v_mfma_f32_16x16x32_bf16 v[60:63], a[68:71], a[104:107], v[60:63]
  ds_read_b128 a[40:43], v208 offset:12288
  v_lshl_add_u32 v215, v215, 12, v213
  v_mfma_f32_16x16x32_bf16 v[60:63], a[8:11], a[108:111], v[60:63]
  s_add_u32 s94, s92, AL-adaLN_cond__sliding_local_dilated__swiglu_ffn__prompt_kernel+((G3S-AL+4095)/4096)*4096
  s_addc_u32 s95, s93, 0
  global_load_dword a252, v215, s[94:95]
  v_mfma_f32_16x16x32_bf16 v[60:63], a[28:31], a[112:115], v[60:63]
  s_lshl_b32 s66, s2, 7
  s_add_u32 s66, s66, 5242880
  s_cmp_eq_u32 s44, 2
  v_mfma_f32_16x16x32_bf16 v[64:67], a[32:35], a[112:115], v[64:67]
  s_cselect_b32 s66, s66, 1073741824
  ds_read_b64_tr_b16 a[92:93], v198 offset:0
  v_and_b32 v215, 7, v10
  v_mfma_f32_16x16x32_bf16 v[64:67], a[12:15], a[108:111], v[64:67]
  ds_read_b128 a[44:47], v208 offset:13312
  v_lshlrev_b32 v215, 15, v215
  v_mfma_f32_16x16x32_bf16 v[64:67], a[72:75], a[104:107], v[64:67]
  buffer_load_dword a252, v215, s[36:39], s66 offen sc1
  s_and_b32 s66, s44, 1
  v_mfma_f32_16x16x32_bf16 v[120:123], a[76:79], a[104:107], v[120:123]
  s_lshl1_add_u32 s66, s2, s66
  s_mul_i32 s66, s66, 35
  ds_read_b64_tr_b16 a[94:95], v198 offset:6144
  v_mfma_f32_16x16x32_bf16 v[120:123], a[16:19], a[108:111], v[120:123]
  ds_read_b128 a[48:51], v208 offset:14336
  v_min_u32 v215, 34, v10
  v_mfma_f32_16x16x32_bf16 v[120:123], a[36:39], a[112:115], v[120:123]
  s_waitcnt lgkmcnt(5)
  ds_read_b64_tr_b16 a[96:97], v198 offset:1024
  v_add_u32 v215, s66, v215
  v_mfma_f32_16x16x32_bf16 v[80:83], a[72:75], a[80:83], v[80:83]
  ds_read_b128 a[52:55], v208 offset:15360
  v_lshrrev_b32 v213, 8, v215
  v_mfma_f32_16x16x32_bf16 v[80:83], a[12:15], a[84:87], v[80:83]
  ds_read_b64_tr_b16 a[98:99], v198 offset:7168
  v_mul_u32_u24 v213, 9363, v213
  v_mfma_f32_16x16x32_bf16 v[80:83], a[32:35], a[88:91], v[80:83]
  ds_read_b128 a[56:59], v211 offset:20480
  v_lshrrev_b32 v213, 16, v213
  v_mfma_f32_16x16x32_bf16 v[76:79], a[28:31], a[88:91], v[76:79]
  ds_read_b64_tr_b16 a[100:101], v198 offset:2048
  v_mul_u32_u24 v213, 1792, v213
  v_mfma_f32_16x16x32_bf16 v[76:79], a[8:11], a[84:87], v[76:79]
  ds_read_b64_tr_b16 a[102:103], v198 offset:8192
  v_add_lshl_u32 v215, v215, v213, 7
  v_mfma_f32_16x16x32_bf16 v[76:79], a[68:71], a[80:83], v[76:79]
  buffer_load_dword a252, v215, s[16:19], 0 offen
  v_mfma_f32_16x16x32_bf16 v[72:75], a[64:67], a[80:83], v[72:75]
  ds_read_b64_tr_b16 a[104:105], v199 offset:0
  v_mfma_f32_16x16x32_bf16 v[72:75], a[4:7], a[84:87], v[72:75]
  ds_read_b64_tr_b16 a[106:107], v199 offset:6144
  v_mfma_f32_16x16x32_bf16 v[72:75], a[24:27], a[88:91], v[72:75]
  ds_read_b64_tr_b16 a[108:109], v199 offset:1024
  v_mfma_f32_16x16x32_bf16 v[68:71], a[20:23], a[88:91], v[68:71]
  v_mfma_f32_16x16x32_bf16 v[68:71], a[0:3], a[84:87], v[68:71]
  ds_read_b64_tr_b16 a[110:111], v199 offset:7168
  v_mfma_f32_16x16x32_bf16 v[68:71], a[60:63], a[80:83], v[68:71]
  s_waitcnt lgkmcnt(4)
  v_mfma_f32_16x16x32_bf16 v[84:87], a[92:95], a[0:3], v[84:87]
  ds_read_b64_tr_b16 a[112:113], v199 offset:2048
  v_mfma_f32_16x16x32_bf16 v[84:87], a[96:99], a[20:23], v[84:87]
  v_mfma_f32_16x16x32_bf16 v[84:87], a[100:103], a[40:43], v[84:87]
  ds_read_b64_tr_b16 a[114:115], v199 offset:8192
  v_mfma_f32_16x16x32_bf16 v[88:91], a[100:103], a[44:47], v[88:91]
  ds_read_b128 a[60:63], v208 offset:33792
  v_mfma_f32_16x16x32_bf16 v[88:91], a[96:99], a[24:27], v[88:91]
  ds_read_b64_tr_b16 a[80:81], v198 offset:21504
  v_mfma_f32_16x16x32_bf16 v[88:91], a[92:95], a[4:7], v[88:91]
  ds_read_b128 a[64:67], v208 offset:34816
  v_mfma_f32_16x16x32_bf16 v[92:95], a[92:95], a[8:11], v[92:95]
  ds_read_b64_tr_b16 a[82:83], v198 offset:27648
  v_mfma_f32_16x16x32_bf16 v[92:95], a[96:99], a[28:31], v[92:95]
  ds_read_b128 a[68:71], v208 offset:35840
  v_mfma_f32_16x16x32_bf16 v[92:95], a[100:103], a[48:51], v[92:95]
  ds_read_b64_tr_b16 a[84:85], v198 offset:22528
  v_mfma_f32_16x16x32_bf16 v[96:99], a[100:103], a[52:55], v[96:99]
  ds_read_b128 a[72:75], v208 offset:36864
  v_mfma_f32_16x16x32_bf16 v[96:99], a[96:99], a[32:35], v[96:99]
  ds_read_b128 a[76:79], v211 offset:41984
  v_mfma_f32_16x16x32_bf16 v[96:99], a[92:95], a[12:15], v[96:99]
  s_waitcnt lgkmcnt(8)
  ds_read_b64_tr_b16 a[86:87], v198 offset:28672
  v_mfma_f32_16x16x32_bf16 v[112:115], a[104:107], a[12:15], v[112:115]
  v_mfma_f32_16x16x32_bf16 v[112:115], a[108:111], a[32:35], v[112:115]
  ds_read_b64_tr_b16 a[88:89], v198 offset:23552
  v_mfma_f32_16x16x32_bf16 v[112:115], a[112:115], a[52:55], v[112:115]
  v_mfma_f32_16x16x32_bf16 v[108:111], a[112:115], a[48:51], v[108:111]
  ds_read_b64_tr_b16 a[90:91], v198 offset:29696
  v_mfma_f32_16x16x32_bf16 v[108:111], a[108:111], a[28:31], v[108:111]
  v_mfma_f32_16x16x32_bf16 v[108:111], a[104:107], a[8:11], v[108:111]
  v_mfma_f32_16x16x32_bf16 v[104:107], a[104:107], a[4:7], v[104:107]
  v_mfma_f32_16x16x32_bf16 v[104:107], a[108:111], a[24:27], v[104:107]
  ds_read_b64_tr_b16 a[92:93], v199 offset:21504
  v_mfma_f32_16x16x32_bf16 v[104:107], a[112:115], a[44:47], v[104:107]
  v_mfma_f32_16x16x32_bf16 v[100:103], a[112:115], a[40:43], v[100:103]
  ds_read_b64_tr_b16 a[94:95], v199 offset:27648
  v_mfma_f32_16x16x32_bf16 v[100:103], a[108:111], a[20:23], v[100:103]
  v_mfma_f32_16x16x32_bf16 v[100:103], a[104:107], a[0:3], v[100:103]
  s_waitcnt lgkmcnt(2)
  ds_read_b64_tr_b16 a[96:97], v199 offset:22528
  v_mfma_f32_16x16x32_bf16 v[20:23], a[80:83], a[20:23], v[20:23]
  v_mfma_f32_16x16x32_bf16 v[20:23], a[84:87], a[40:43], v[20:23]
  ds_read_b64_tr_b16 a[98:99], v199 offset:28672
  v_mfma_f32_16x16x32_bf16 v[20:23], a[88:91], a[60:63], v[20:23]
  s_waitcnt vmcnt(12)
  s_barrier
  v_mfma_f32_16x16x32_bf16 v[24:27], a[88:91], a[64:67], v[24:27]
  ds_read_b64_tr_b16 a[100:101], v199 offset:23552
  v_mfma_f32_16x16x32_bf16 v[24:27], a[84:87], a[44:47], v[24:27]
  v_mfma_f32_16x16x32_bf16 v[24:27], a[80:83], a[24:27], v[24:27]
  ds_read_b64_tr_b16 a[102:103], v199 offset:29696
  v_mfma_f32_16x16x32_bf16 v[28:31], a[80:83], a[28:31], v[28:31]
  v_mfma_f32_16x16x32_bf16 v[28:31], a[84:87], a[48:51], v[28:31]
  ds_read_b64_tr_b16 a[104:105], v198 offset:43008
  v_mfma_f32_16x16x32_bf16 v[28:31], a[88:91], a[68:71], v[28:31]
  v_mfma_f32_16x16x32_bf16 v[32:35], a[88:91], a[72:75], v[32:35]
  ds_read_b64_tr_b16 a[106:107], v198 offset:49152
  v_mfma_f32_16x16x32_bf16 v[32:35], a[84:87], a[52:55], v[32:35]
  v_mfma_f32_16x16x32_bf16 v[32:35], a[80:83], a[32:35], v[32:35]
  v_mfma_f32_16x16x32_bf16 v[116:119], a[80:83], a[36:39], v[116:119]
  ds_read_b64_tr_b16 a[108:109], v198 offset:44032
  v_mfma_f32_16x16x32_bf16 v[116:119], a[84:87], a[56:59], v[116:119]
  v_mfma_f32_16x16x32_bf16 v[116:119], a[88:91], a[76:79], v[116:119]
  s_waitcnt lgkmcnt(3)
  ds_read_b64_tr_b16 a[110:111], v198 offset:50176
  v_mfma_f32_16x16x32_bf16 v[48:51], a[92:95], a[32:35], v[48:51]
  v_mfma_f32_16x16x32_bf16 v[48:51], a[96:99], a[52:55], v[48:51]
  v_mfma_f32_16x16x32_bf16 v[48:51], a[100:103], a[72:75], v[48:51]
  ds_read_b64_tr_b16 a[112:113], v199 offset:43008
  v_mfma_f32_16x16x32_bf16 v[44:47], a[100:103], a[68:71], v[44:47]
  v_mfma_f32_16x16x32_bf16 v[44:47], a[96:99], a[48:51], v[44:47]
  ds_read_b64_tr_b16 a[114:115], v199 offset:49152
  v_mfma_f32_16x16x32_bf16 v[44:47], a[92:95], a[28:31], v[44:47]
  v_mfma_f32_16x16x32_bf16 v[40:43], a[92:95], a[24:27], v[40:43]
  ds_read_b64_tr_b16 a[80:81], v199 offset:44032
  v_mfma_f32_16x16x32_bf16 v[40:43], a[96:99], a[44:47], v[40:43]
  v_cvt_pk_bf16_f32 v116, v116, v117
  v_cvt_pk_bf16_f32 v117, v118, v119
  v_mfma_f32_16x16x32_bf16 v[40:43], a[100:103], a[64:67], v[40:43]
  ds_read_b64_tr_b16 a[82:83], v199 offset:50176
  v_mfma_f32_16x16x32_bf16 v[36:39], a[100:103], a[60:63], v[36:39]
  ds_write_b64 v224, v[116:117]
  v_cvt_pk_bf16_f32 v32, v32, v33
  v_mfma_f32_16x16x32_bf16 v[36:39], a[96:99], a[40:43], v[36:39]
  ds_read_b64_tr_b16 a[84:85], v200 offset:0
  v_cvt_pk_bf16_f32 v33, v34, v35
  v_mfma_f32_16x16x32_bf16 v[36:39], a[92:95], a[20:23], v[36:39]
  s_waitcnt lgkmcnt(6)
  v_cvt_pk_bf16_f32 v34, v48, v49
  v_cvt_pk_bf16_f32 v35, v50, v51
  v_mfma_f32_16x16x32_bf16 v[52:55], a[40:43], a[104:107], v[52:55]
  ds_read_b64_tr_b16 a[86:87], v200 offset:6144
  v_mfma_f32_16x16x32_bf16 v[52:55], a[60:63], a[108:111], v[52:55]
  ds_write_b64 v222, v[32:33]
  v_mfma_f32_16x16x32_bf16 v[56:59], a[64:67], a[108:111], v[56:59]
  ds_read_b64_tr_b16 a[88:89], v201 offset:0
  v_mfma_f32_16x16x32_bf16 v[56:59], a[44:47], a[104:107], v[56:59]
  ds_write_b64 v223, v[34:35]
  v_cvt_pk_bf16_f32 v28, v28, v29
  v_mfma_f32_16x16x32_bf16 v[60:63], a[48:51], a[104:107], v[60:63]
  ds_read_b64_tr_b16 a[90:91], v201 offset:6144
  v_cvt_pk_bf16_f32 v29, v30, v31
  v_mfma_f32_16x16x32_bf16 v[60:63], a[68:71], a[108:111], v[60:63]
  v_cvt_pk_bf16_f32 v30, v44, v45
  v_cvt_pk_bf16_f32 v31, v46, v47
  v_mfma_f32_16x16x32_bf16 v[64:67], a[72:75], a[108:111], v[64:67]
  v_cvt_pk_bf16_f32 v24, v24, v25
  v_cvt_pk_bf16_f32 v25, v26, v27
  v_mfma_f32_16x16x32_bf16 v[64:67], a[52:55], a[104:107], v[64:67]
  v_cvt_pk_bf16_f32 v26, v40, v41
  v_cvt_pk_bf16_f32 v27, v42, v43
  v_mfma_f32_16x16x32_bf16 v[120:123], a[56:59], a[104:107], v[120:123]
  v_cvt_pk_bf16_f32 v20, v20, v21
  v_cvt_pk_bf16_f32 v21, v22, v23
  v_mfma_f32_16x16x32_bf16 v[120:123], a[76:79], a[108:111], v[120:123]
  s_waitcnt lgkmcnt(7)
  v_cvt_pk_bf16_f32 v22, v36, v37
  v_cvt_pk_bf16_f32 v23, v38, v39
  v_mfma_f32_16x16x32_bf16 v[80:83], a[52:55], a[112:115], v[80:83]
  v_cvt_pk_bf16_f32 v55, v54, v55
  v_cvt_pk_bf16_f32 v54, v52, v53
  v_mfma_f32_16x16x32_bf16 v[80:83], a[72:75], a[80:83], v[80:83]
  v_cvt_pk_bf16_f32 v56, v56, v57
  v_cvt_pk_bf16_f32 v57, v58, v59
  v_mfma_f32_16x16x32_bf16 v[76:79], a[68:71], a[80:83], v[76:79]
  v_cvt_pk_bf16_f32 v58, v60, v61
  v_cvt_pk_bf16_f32 v59, v62, v63
  v_mfma_f32_16x16x32_bf16 v[76:79], a[48:51], a[112:115], v[76:79]
  v_mfma_f32_16x16x32_bf16 v[72:75], a[44:47], a[112:115], v[72:75]
  v_cvt_pk_bf16_f32 v60, v64, v65
  v_cvt_pk_bf16_f32 v61, v66, v67
  v_mfma_f32_16x16x32_bf16 v[72:75], a[64:67], a[80:83], v[72:75]
  v_mfma_f32_16x16x32_bf16 v[68:71], a[60:63], a[80:83], v[68:71]
  v_cvt_pk_bf16_f32 v120, v120, v121
  v_cvt_pk_bf16_f32 v121, v122, v123
  v_mfma_f32_16x16x32_bf16 v[68:71], a[40:43], a[112:115], v[68:71]
  s_waitcnt lgkmcnt(4)
  ds_write_b64 v222, v[60:61] offset:1024
  v_mfma_f32_16x16x32_bf16 v[84:87], a[84:87], a[60:63], v[84:87]
  ds_write_b64 v224, v[120:121] offset:1024
  v_mfma_f32_16x16x32_bf16 v[88:91], a[84:87], a[64:67], v[88:91]
  v_mfma_f32_16x16x32_bf16 v[92:95], a[84:87], a[68:71], v[92:95]
  v_mfma_f32_16x16x32_bf16 v[96:99], a[84:87], a[72:75], v[96:99]
  s_waitcnt lgkmcnt(2)
  v_mfma_f32_16x16x32_bf16 v[112:115], a[88:91], a[72:75], v[112:115]
  v_mfma_f32_16x16x32_bf16 v[108:111], a[88:91], a[68:71], v[108:111]
  v_mfma_f32_16x16x32_bf16 v[104:107], a[88:91], a[64:67], v[104:107]
  v_cvt_pk_bf16_f32 v71, v70, v71
  v_cvt_pk_bf16_f32 v70, v68, v69
  v_mfma_f32_16x16x32_bf16 v[100:103], a[88:91], a[60:63], v[100:103]
  v_cvt_pk_bf16_f32 v72, v72, v73
  v_cvt_pk_bf16_f32 v73, v74, v75
  v_cvt_pk_bf16_f32 v74, v76, v77
  v_cvt_pk_bf16_f32 v75, v78, v79
  v_cvt_pk_bf16_f32 v76, v80, v81
  v_cvt_pk_bf16_f32 v77, v82, v83
  ds_write_b64 v223, v[76:77] offset:1024
  s_waitcnt lgkmcnt(0)
  s_barrier
  ds_read_b64 v[124:125], v225
  ds_read_b64 v[126:127], v226
  ds_read_b64 v[52:53], v227 offset:1024
  ds_read_b64 v[68:69], v227 offset:1032
  v_cvt_pk_bf16_f32 v96, v96, v97
  v_cvt_pk_bf16_f32 v97, v98, v99
  v_cvt_pk_bf16_f32 v98, v112, v113
  v_cvt_pk_bf16_f32 v99, v114, v115
  v_cvt_pk_bf16_f32 v92, v92, v93
  v_cvt_pk_bf16_f32 v93, v94, v95
  v_cvt_pk_bf16_f32 v94, v108, v109
  v_cvt_pk_bf16_f32 v95, v110, v111
  v_mfma_f32_16x16x32_bf16 v[112:115], v[32:35], v[96:99], 0
  v_mfma_f32_16x16x32_bf16 v[48:51], v[28:31], v[96:99], 0
Ha1_1:
  s_cbranch_execz Ra
  v_cvt_pk_bf16_f32 v88, v88, v89
  s_mov_b32 s50, 0
  s_add_u32 m0, s70, 81920
  s_nop 0
  buffer_load_dwordx4 v216, s[12:15], s50 offen offset:0 lds
  v_cvt_pk_bf16_f32 v89, v90, v91
  v_cvt_pk_bf16_f32 v90, v104, v105
  v_cvt_pk_bf16_f32 v91, v106, v107
  v_mfma_f32_16x16x32_bf16 v[108:111], v[28:31], v[92:95], 0
  v_mfma_f32_16x16x32_bf16 v[44:47], v[24:27], v[92:95], 0
  v_cvt_pk_bf16_f32 v84, v84, v85
  v_cvt_pk_bf16_f32 v85, v86, v87
  v_cvt_pk_bf16_f32 v86, v100, v101
  v_cvt_pk_bf16_f32 v87, v102, v103
  buffer_load_dwordx4 v217, s[12:15], s50 offen offset:1024 lds
  v_mfma_f32_16x16x32_bf16 v[104:107], v[24:27], v[88:91], 0
  v_mfma_f32_16x16x32_bf16 v[40:43], v[20:23], v[88:91], 0
  s_cmp_eq_u32 s57, 0
  s_cselect_b64 s[66:67], s[78:79], 0
  s_cselect_b64 s[68:69], s[80:81], 0
  s_waitcnt lgkmcnt(2)
  v_mfma_f32_16x16x32_bf16 v[100:103], v[20:23], v[84:87], 0
  v_mfma_f32_16x16x32_bf16 v[36:39], v[124:127], v[84:87], 0
  s_cmp_eq_u32 s59, 0
  s_cbranch_scc1 F_sw
  v_swap_b32 v54, v70
  v_swap_b32 v55, v71
  v_swap_b32 v56, v72
  v_swap_b32 v57, v73
  v_swap_b32 v58, v74
  v_swap_b32 v59, v75
  v_swap_b32 v60, v76
  v_swap_b32 v61, v77
F_sw:
  v_mov_b32 v12, 0xcfa8965f
  buffer_load_dwordx4 v218, s[12:15], s50 offen offset:2048 lds
  v_mov_b32 v14, 0x3e8293ee
  v_cndmask_b32 v194, v112, v113, s[76:77]
  v_cndmask_b32 v195, v114, v115, s[76:77]
  v_cndmask_b32 v192, v48, v49, s[76:77]
  v_cndmask_b32 v193, v50, v51, s[76:77]
  v_cndmask_b32 v190, v108, v109, s[76:77]
  v_cndmask_b32 v191, v110, v111, s[76:77]
  v_cndmask_b32 v188, v44, v45, s[76:77]
  v_cndmask_b32 v189, v46, v47, s[76:77]
  buffer_load_dwordx4 v219, s[12:15], s50 offen offset:3072 lds
  v_cndmask_b32 v186, v104, v105, s[76:77]
  v_cndmask_b32 v187, v106, v107, s[76:77]
  v_cndmask_b32 v184, v40, v41, s[76:77]
  v_cndmask_b32 v185, v42, v43, s[76:77]
  v_cndmask_b32 v182, v100, v101, s[76:77]
  v_cndmask_b32 v183, v102, v103, s[76:77]
  v_cndmask_b32 v180, v36, v37, s[76:77]
  v_cndmask_b32 v181, v38, v39, s[76:77]
  v_cndmask_b32 v192, v194, v192, s[78:79]
  s_mov_b32 s50, 262144
  s_add_u32 m0, s70, 98304
  s_nop 0
  buffer_load_dwordx4 v216, s[12:15], s50 offen offset:0 lds
  v_cndmask_b32 v193, v195, v193, s[80:81]
  v_cndmask_b32 v188, v190, v188, s[78:79]
  v_cndmask_b32 v189, v191, v189, s[80:81]
  v_cndmask_b32 v184, v186, v184, s[78:79]
  v_cndmask_b32 v185, v187, v185, s[80:81]
  v_cndmask_b32 v180, v182, v180, s[78:79]
  v_cndmask_b32 v181, v183, v181, s[80:81]
  v_cndmask_b32 v180, v180, v12, s[66:67]
  v_cndmask_b32 v181, v181, v12, s[68:69]
  buffer_load_dwordx4 v217, s[12:15], s50 offen offset:1024 lds
  v_max_f32 v194, v192, v193
  v_max_f32 v195, v192, v193
  v_max_f32 v190, v188, v189
  v_max_f32 v191, v188, v189
  v_max_f32 v186, v184, v185
  v_max_f32 v187, v184, v185
  v_max_f32 v182, v180, v181
  v_max_f32 v183, v180, v181
  v_permlane16_swap_b32 v194, v195
  buffer_load_dwordx4 v218, s[12:15], s50 offen offset:2048 lds
  v_permlane16_swap_b32 v190, v191
  v_permlane16_swap_b32 v186, v187
  v_permlane16_swap_b32 v182, v183
  v_max_f32 v194, v194, v195
  v_max_f32 v190, v190, v191
  v_max_f32 v186, v186, v187
  v_max_f32 v182, v182, v183
  v_mov_b32 v195, v194
  v_mov_b32 v191, v190
  buffer_load_dwordx4 v219, s[12:15], s50 offen offset:3072 lds
  v_mov_b32 v187, v186
  v_mov_b32 v183, v182
  v_permlane32_swap_b32 v194, v195
  v_permlane32_swap_b32 v190, v191
  v_permlane32_swap_b32 v186, v187
  v_permlane32_swap_b32 v182, v183
  v_max_f32 v194, v194, v195
  v_max_f32 v190, v190, v191
  v_max_f32 v186, v186, v187
  s_mov_b32 s50, 524288
  s_add_u32 m0, s70, 0
  s_nop 0
  buffer_load_dwordx4 v216, s[12:15], s50 offen offset:0 lds
  v_max_f32 v182, v182, v183
  v_mul_f32 v194, 0xbe8293ee, v194
  v_mul_f32 v190, 0xbe8293ee, v190
  v_mul_f32 v186, 0xbe8293ee, v186
  v_mul_f32 v182, 0xbe8293ee, v182
  v_pk_fma_f32 v[192:193], v[192:193], v[14:15], v[194:195] op_sel_hi:[1,0,0]
  v_pk_fma_f32 v[188:189], v[188:189], v[14:15], v[190:191] op_sel_hi:[1,0,0]
  v_pk_fma_f32 v[184:185], v[184:185], v[14:15], v[186:187] op_sel_hi:[1,0,0]
  v_pk_fma_f32 v[180:181], v[180:181], v[14:15], v[182:183] op_sel_hi:[1,0,0]
  buffer_load_dwordx4 v217, s[12:15], s50 offen offset:1024 lds
  v_exp_f32 v192, v192
  v_exp_f32 v193, v193
  v_exp_f32 v188, v188
  v_exp_f32 v189, v189
  v_exp_f32 v184, v184
  v_exp_f32 v185, v185
  v_exp_f32 v180, v180
  v_exp_f32 v181, v181
  v_add_f32 v194, v192, v193
  buffer_load_dwordx4 v218, s[12:15], s50 offen offset:2048 lds
  v_add_f32 v195, v192, v193
  v_add_f32 v190, v188, v189
  v_add_f32 v191, v188, v189
  v_add_f32 v186, v184, v185
  v_add_f32 v187, v184, v185
  v_add_f32 v182, v180, v181
  v_add_f32 v183, v180, v181
  v_permlane16_swap_b32 v194, v195
  v_permlane16_swap_b32 v190, v191
  buffer_load_dwordx4 v219, s[12:15], s50 offen offset:3072 lds
  v_permlane16_swap_b32 v186, v187
  v_permlane16_swap_b32 v182, v183
  v_add_f32 v194, v194, v195
  v_add_f32 v190, v190, v191
  v_add_f32 v186, v186, v187
  v_add_f32 v182, v182, v183
  v_mov_b32 v195, v194
  v_mov_b32 v191, v190
  v_mov_b32 v187, v186
  s_mov_b32 s50, 786432
  s_add_u32 m0, s70, 16384
  s_nop 0
  buffer_load_dwordx4 v216, s[12:15], s50 offen offset:0 lds
  v_mov_b32 v183, v182
  v_permlane32_swap_b32 v194, v195
  v_permlane32_swap_b32 v190, v191
  v_permlane32_swap_b32 v186, v187
  v_permlane32_swap_b32 v182, v183
  v_add_f32 v194, v194, v195
  v_add_f32 v190, v190, v191
  v_add_f32 v186, v186, v187
  v_add_f32 v182, v182, v183
  buffer_load_dwordx4 v217, s[12:15], s50 offen offset:1024 lds
  v_rcp_f32 v194, v194
  v_rcp_f32 v190, v190
  v_rcp_f32 v186, v186
  v_rcp_f32 v182, v182
  v_pk_mul_f32 v[192:193], v[192:193], v[194:195] op_sel_hi:[1,0]
  v_pk_mul_f32 v[188:189], v[188:189], v[190:191] op_sel_hi:[1,0]
  v_pk_mul_f32 v[184:185], v[184:185], v[186:187] op_sel_hi:[1,0]
  v_pk_mul_f32 v[180:181], v[180:181], v[182:183] op_sel_hi:[1,0]
  v_cvt_pk_bf16_f32 v192, v192, v193
  v_cvt_pk_bf16_f32 v188, v188, v189
  v_cvt_pk_bf16_f32 v184, v184, v185
  v_cvt_pk_bf16_f32 v180, v180, v181
  s_waitcnt lgkmcnt(0)
  v_perm_b32 v48, v192, v192, v228
  v_perm_b32 v49, v192, v192, v229
  v_perm_b32 v50, v192, v192, v230
  v_perm_b32 v51, v192, v192, v231
  v_perm_b32 v44, v188, v188, v228
  v_perm_b32 v45, v188, v188, v229
  v_perm_b32 v46, v188, v188, v230
  v_perm_b32 v47, v188, v188, v231
  v_mfma_f32_16x16x32_bf16 v[32:35], v[58:61], v[48:51], 0
  v_mfma_f32_16x16x32_bf16 v[96:99], v[74:77], v[48:51], 0
  v_perm_b32 v40, v184, v184, v228
  v_perm_b32 v41, v184, v184, v229
  v_perm_b32 v42, v184, v184, v230
  v_perm_b32 v43, v184, v184, v231
  v_mfma_f32_16x16x32_bf16 v[28:31], v[56:59], v[44:47], 0
  v_mfma_f32_16x16x32_bf16 v[92:95], v[72:75], v[44:47], 0
  v_perm_b32 v36, v180, v180, v228
  v_perm_b32 v37, v180, v180, v229
  v_perm_b32 v38, v180, v180, v230
  v_perm_b32 v39, v180, v180, v231
  v_mfma_f32_16x16x32_bf16 v[24:27], v[54:57], v[40:43], 0
  v_mfma_f32_16x16x32_bf16 v[88:91], v[70:73], v[40:43], 0
  s_nop 0
  v_mfma_f32_16x16x32_bf16 v[20:23], v[52:55], v[36:39], 0
  v_mfma_f32_16x16x32_bf16 v[84:87], v[68:71], v[36:39], 0
  v_cvt_pk_bf16_f32 v192, v32, v33
  v_cvt_pk_bf16_f32 v193, v34, v35
  v_cvt_pk_bf16_f32 v194, v96, v97
  v_cvt_pk_bf16_f32 v195, v98, v99
  buffer_store_dwordx4 v[192:195], v0, s[36:39], s72 offen offset:1024 sc1
  v_cvt_pk_bf16_f32 v188, v28, v29
  v_cvt_pk_bf16_f32 v189, v30, v31
  v_cvt_pk_bf16_f32 v190, v92, v93
  v_cvt_pk_bf16_f32 v191, v94, v95
  buffer_store_dwordx4 v[188:191], v0, s[36:39], s72 offen offset:0 sc1
  v_cvt_pk_bf16_f32 v184, v24, v25
  v_cvt_pk_bf16_f32 v185, v26, v27
  v_cvt_pk_bf16_f32 v186, v88, v89
  v_cvt_pk_bf16_f32 v187, v90, v91
  buffer_store_dwordx4 v[184:187], v0, s[36:39], s71 offen offset:1024 sc1
  v_cvt_pk_bf16_f32 v180, v20, v21
  v_cvt_pk_bf16_f32 v181, v22, v23
  v_cvt_pk_bf16_f32 v182, v84, v85
  v_cvt_pk_bf16_f32 v183, v86, v87
  buffer_store_dwordx4 v[180:183], v0, s[36:39], s71 offen offset:0 sc1
  s_waitcnt vmcnt(21)
  v_lshlrev_b32 v60, 16, v136
  v_and_b32 v61, 0xffff0000, v136
  v_lshlrev_b32 v62, 16, v137
  v_and_b32 v63, 0xffff0000, v137
  v_pk_mul_f32 v[52:53], v[60:61], v[168:169] op_sel_hi:[1,0]
  v_pk_mul_f32 v[54:55], v[62:63], v[168:169] op_sel_hi:[1,0]
  v_lshlrev_b32 v60, 16, v138
  v_and_b32 v61, 0xffff0000, v138
  v_lshlrev_b32 v62, 16, v139
  v_and_b32 v63, 0xffff0000, v139
  v_pk_mul_f32 v[56:57], v[60:61], v[168:169] op_sel_hi:[1,0]
  v_pk_mul_f32 v[58:59], v[62:63], v[168:169] op_sel_hi:[1,0]
  buffer_load_dwordx4 v218, s[12:15], s50 offen offset:2048 lds
  v_lshlrev_b32 v60, 16, v140
  v_and_b32 v61, 0xffff0000, v140
  v_lshlrev_b32 v62, 16, v141
  v_and_b32 v63, 0xffff0000, v141
  v_pk_fma_f32 v[52:53], v[60:61], v[168:169], v[52:53] op_sel:[0,1,0] op_sel_hi:[1,1,1]
  v_pk_fma_f32 v[54:55], v[62:63], v[168:169], v[54:55] op_sel:[0,1,0] op_sel_hi:[1,1,1]
  v_lshlrev_b32 v60, 16, v142
  v_and_b32 v61, 0xffff0000, v142
  v_lshlrev_b32 v62, 16, v143
  v_and_b32 v63, 0xffff0000, v143
  v_pk_fma_f32 v[56:57], v[60:61], v[168:169], v[56:57] op_sel:[0,1,0] op_sel_hi:[1,1,1]
  v_pk_fma_f32 v[58:59], v[62:63], v[168:169], v[58:59] op_sel:[0,1,0] op_sel_hi:[1,1,1]
  buffer_load_dwordx4 v219, s[12:15], s50 offen offset:3072 lds
  v_lshlrev_b32 v60, 16, v144
  v_and_b32 v61, 0xffff0000, v144
  v_lshlrev_b32 v62, 16, v145
  v_and_b32 v63, 0xffff0000, v145
  v_pk_fma_f32 v[52:53], v[60:61], v[170:171], v[52:53] op_sel:[0,0,0] op_sel_hi:[1,0,1]
  v_pk_fma_f32 v[54:55], v[62:63], v[170:171], v[54:55] op_sel:[0,0,0] op_sel_hi:[1,0,1]
  v_lshlrev_b32 v60, 16, v146
  v_and_b32 v61, 0xffff0000, v146
  v_lshlrev_b32 v62, 16, v147
  v_and_b32 v63, 0xffff0000, v147
  v_pk_fma_f32 v[56:57], v[60:61], v[170:171], v[56:57] op_sel:[0,0,0] op_sel_hi:[1,0,1]
  v_pk_fma_f32 v[58:59], v[62:63], v[170:171], v[58:59] op_sel:[0,0,0] op_sel_hi:[1,0,1]
  s_mov_b32 s50, 1048576
  s_add_u32 m0, s70, 32768
  s_nop 0
  buffer_load_dwordx4 v216, s[12:15], s50 offen offset:0 lds
  v_lshlrev_b32 v60, 16, v148
  v_and_b32 v61, 0xffff0000, v148
  v_lshlrev_b32 v62, 16, v149
  v_and_b32 v63, 0xffff0000, v149
  v_pk_fma_f32 v[52:53], v[60:61], v[170:171], v[52:53] op_sel:[0,1,0] op_sel_hi:[1,1,1]
  v_pk_fma_f32 v[54:55], v[62:63], v[170:171], v[54:55] op_sel:[0,1,0] op_sel_hi:[1,1,1]
  v_lshlrev_b32 v60, 16, v150
  v_and_b32 v61, 0xffff0000, v150
  v_lshlrev_b32 v62, 16, v151
  v_and_b32 v63, 0xffff0000, v151
  v_pk_fma_f32 v[56:57], v[60:61], v[170:171], v[56:57] op_sel:[0,1,0] op_sel_hi:[1,1,1]
  v_pk_fma_f32 v[58:59], v[62:63], v[170:171], v[58:59] op_sel:[0,1,0] op_sel_hi:[1,1,1]
  buffer_load_dwordx4 v217, s[12:15], s50 offen offset:1024 lds
  v_lshlrev_b32 v60, 16, v152
  v_and_b32 v61, 0xffff0000, v152
  v_lshlrev_b32 v62, 16, v153
  v_and_b32 v63, 0xffff0000, v153
  v_pk_fma_f32 v[52:53], v[60:61], v[172:173], v[52:53] op_sel:[0,0,0] op_sel_hi:[1,0,1]
  v_pk_fma_f32 v[54:55], v[62:63], v[172:173], v[54:55] op_sel:[0,0,0] op_sel_hi:[1,0,1]
  v_lshlrev_b32 v60, 16, v154
  v_and_b32 v61, 0xffff0000, v154
  v_lshlrev_b32 v62, 16, v155
  v_and_b32 v63, 0xffff0000, v155
  v_pk_fma_f32 v[56:57], v[60:61], v[172:173], v[56:57] op_sel:[0,0,0] op_sel_hi:[1,0,1]
  v_pk_fma_f32 v[58:59], v[62:63], v[172:173], v[58:59] op_sel:[0,0,0] op_sel_hi:[1,0,1]
  buffer_load_dwordx4 v218, s[12:15], s50 offen offset:2048 lds
  v_lshlrev_b32 v60, 16, v156
  v_and_b32 v61, 0xffff0000, v156
  v_lshlrev_b32 v62, 16, v157
  v_and_b32 v63, 0xffff0000, v157
  v_pk_fma_f32 v[52:53], v[60:61], v[172:173], v[52:53] op_sel:[0,1,0] op_sel_hi:[1,1,1]
  v_pk_fma_f32 v[54:55], v[62:63], v[172:173], v[54:55] op_sel:[0,1,0] op_sel_hi:[1,1,1]
  v_lshlrev_b32 v60, 16, v158
  v_and_b32 v61, 0xffff0000, v158
  v_lshlrev_b32 v62, 16, v159
  v_and_b32 v63, 0xffff0000, v159
  v_pk_fma_f32 v[56:57], v[60:61], v[172:173], v[56:57] op_sel:[0,1,0] op_sel_hi:[1,1,1]
  v_pk_fma_f32 v[58:59], v[62:63], v[172:173], v[58:59] op_sel:[0,1,0] op_sel_hi:[1,1,1]
  buffer_load_dwordx4 v219, s[12:15], s50 offen offset:3072 lds
  v_lshlrev_b32 v60, 16, v160
  v_and_b32 v61, 0xffff0000, v160
  v_lshlrev_b32 v62, 16, v161
  v_and_b32 v63, 0xffff0000, v161
  v_pk_fma_f32 v[52:53], v[60:61], v[174:175], v[52:53] op_sel:[0,0,0] op_sel_hi:[1,0,1]
  v_pk_fma_f32 v[54:55], v[62:63], v[174:175], v[54:55] op_sel:[0,0,0] op_sel_hi:[1,0,1]
  v_lshlrev_b32 v60, 16, v162
  v_and_b32 v61, 0xffff0000, v162
  v_lshlrev_b32 v62, 16, v163
  v_and_b32 v63, 0xffff0000, v163
  v_pk_fma_f32 v[56:57], v[60:61], v[174:175], v[56:57] op_sel:[0,0,0] op_sel_hi:[1,0,1]
  v_pk_fma_f32 v[58:59], v[62:63], v[174:175], v[58:59] op_sel:[0,0,0] op_sel_hi:[1,0,1]
  v_lshlrev_b32 v60, 16, v164
  v_and_b32 v61, 0xffff0000, v164
  v_lshlrev_b32 v62, 16, v165
  v_and_b32 v63, 0xffff0000, v165
  v_pk_fma_f32 v[52:53], v[60:61], v[174:175], v[52:53] op_sel:[0,1,0] op_sel_hi:[1,1,1]
  v_pk_fma_f32 v[54:55], v[62:63], v[174:175], v[54:55] op_sel:[0,1,0] op_sel_hi:[1,1,1]
  v_lshlrev_b32 v60, 16, v166
  v_and_b32 v61, 0xffff0000, v166
  v_lshlrev_b32 v62, 16, v167
  v_and_b32 v63, 0xffff0000, v167
  v_pk_fma_f32 v[56:57], v[60:61], v[174:175], v[56:57] op_sel:[0,1,0] op_sel_hi:[1,1,1]
  v_pk_fma_f32 v[58:59], v[62:63], v[174:175], v[58:59] op_sel:[0,1,0] op_sel_hi:[1,1,1]
  s_nop 0
  v_permlane32_swap_b32 v52, v56
  v_permlane32_swap_b32 v53, v57
  v_permlane32_swap_b32 v54, v58
  v_permlane32_swap_b32 v55, v59
  v_add_f32 v52, v52, v56
  v_add_f32 v53, v53, v57
  v_add_f32 v54, v54, v58
  v_add_f32 v55, v55, v59
  s_nop 0
  v_permlane16_swap_b32 v52, v54
  v_permlane16_swap_b32 v53, v55
  v_add_f32 v52, v52, v54
  v_add_f32 v53, v53, v55
  v_add_u32 v60, 162816, v178
  v_add_f32_dpp v52, v52, v52 row_ror:8 row_mask:0xf bank_mask:0xf
  v_add_f32_dpp v53, v53, v53 row_ror:8 row_mask:0xf bank_mask:0xf
  ds_write_b64 v177, v[52:53]
  v_mov_b32 v12, s3
  s_waitcnt vmcnt(6) lgkmcnt(0)
  s_barrier
  s_mov_b64 exec, 1
  buffer_store_dword v12, v0, s[36:39], s45 offen sc1
  s_mov_b64 exec, -1
  ds_read_b32 v52, v60 offset:0
  ds_read_b32 v53, v60 offset:256
  ds_read_b32 v54, v60 offset:512
  ds_read_b32 v55, v60 offset:768
  s_cmp_eq_u32 s44, 1
  s_cselect_b32 s49, s56, 1073741824
  s_lshl_b32 s45, s2, 7
  s_add_u32 s45, s45, 5341184
  s_cmp_eq_u32 s44, 0
  s_cselect_b32 s45, s45, 1073741824
  s_waitcnt lgkmcnt(0)
  v_add_f32 v52, v52, v53
  v_add_f32 v54, v54, v55
  v_add_f32 v52, v52, v54
  buffer_store_dword v52, v178, s[36:39], s49 offen sc1
  s_mov_b32 s50, 1310720
  s_add_u32 m0, s70, 49152
  s_nop 0
  buffer_load_dwordx4 v216, s[12:15], s50 offen offset:0 lds
  buffer_load_dwordx4 v217, s[12:15], s50 offen offset:1024 lds
  buffer_load_dwordx4 v218, s[12:15], s50 offen offset:2048 lds
  buffer_load_dwordx4 v219, s[12:15], s50 offen offset:3072 lds
  s_mov_b32 s50, 1572864
  s_add_u32 m0, s70, 65536
  s_nop 0
  buffer_load_dwordx4 v216, s[12:15], s50 offen offset:0 lds
  buffer_load_dwordx4 v217, s[12:15], s50 offen offset:1024 lds
  buffer_load_dwordx4 v218, s[12:15], s50 offen offset:2048 lds
  buffer_load_dwordx4 v219, s[12:15], s50 offen offset:3072 lds
  s_mov_b32 s50, 1835008
  s_add_u32 m0, s70, 114688
  s_nop 0
  buffer_load_dwordx4 v216, s[12:15], s50 offen offset:0 lds
  buffer_load_dwordx4 v217, s[12:15], s50 offen offset:1024 lds
  buffer_load_dwordx4 v218, s[12:15], s50 offen offset:2048 lds
  buffer_load_dwordx4 v219, s[12:15], s50 offen offset:3072 lds
  s_add_u32 m0, s70, 131072
  s_nop 0
  buffer_load_dwordx4 v220, s[4:7], s55 offen offset:0 lds
  buffer_load_dwordx4 v221, s[4:7], s55 offen offset:1024 lds
  s_add_u32 m0, s70, 133120
  s_add_u32 s48, s55, 32768
  buffer_load_dwordx4 v220, s[4:7], s48 offen offset:0 lds
  buffer_load_dwordx4 v221, s[4:7], s48 offen offset:1024 lds
  ds_read_b64_tr_b16 a[176:177], v236 offset:16384
  ds_read_b64_tr_b16 a[178:179], v236 offset:18432
  ds_read_b64_tr_b16 a[180:181], v236 offset:20480
  ds_read_b64_tr_b16 a[182:183], v236 offset:22528
  ds_read_b64_tr_b16 a[184:185], v237 offset:16384
  ds_read_b64_tr_b16 a[186:187], v237 offset:18432
  ds_read_b64_tr_b16 a[188:189], v237 offset:20480
  ds_read_b64_tr_b16 a[190:191], v237 offset:22528
  ds_read_b64_tr_b16 a[192:193], v238 offset:16384
  ds_read_b64_tr_b16 a[194:195], v238 offset:18432
  ds_read_b64_tr_b16 a[196:197], v238 offset:20480
  ds_read_b64_tr_b16 a[198:199], v238 offset:22528
  ds_read_b64_tr_b16 a[200:201], v239 offset:16384
  ds_read_b64_tr_b16 a[202:203], v239 offset:18432
  ds_read_b64_tr_b16 a[204:205], v239 offset:20480
  ds_read_b64_tr_b16 a[206:207], v239 offset:22528
  ds_read_b64_tr_b16 a[208:209], v236 offset:24576
  ds_read_b64_tr_b16 a[210:211], v236 offset:26624
  ds_read_b64_tr_b16 a[212:213], v236 offset:28672
  ds_read_b64_tr_b16 a[214:215], v236 offset:30720
  ds_read_b64_tr_b16 a[216:217], v237 offset:24576
  ds_read_b64_tr_b16 a[218:219], v237 offset:26624
  ds_read_b64_tr_b16 a[220:221], v237 offset:28672
  ds_read_b64_tr_b16 a[222:223], v237 offset:30720
  ds_read_b64_tr_b16 a[224:225], v238 offset:24576
  ds_read_b64_tr_b16 a[226:227], v238 offset:26624
  ds_read_b64_tr_b16 a[228:229], v238 offset:28672
  ds_read_b64_tr_b16 a[230:231], v238 offset:30720
  s_mov_b64 exec, 0
  s_cmp_eq_u32 s44, 1
  s_cbranch_scc1 Hc0
  s_cmp_eq_u32 s44, 2
  s_cbranch_scc1 Hc1
  s_cmp_eq_u32 s44, 3
  s_cbranch_scc1 Hc2
Rc:
  s_mov_b64 exec, -1
  s_cmp_lg_u32 s44, 0
  s_cbranch_scc1 SM3x
  s_mov_b32 s46, 60000
  s_mov_b32 s47, 5242880
SM3:
  buffer_load_dword v13, v250, s[36:39], s47 offen sc1
  s_sub_u32 s46, s46, 1
  s_cmp_eq_u32 s46, 0
  s_waitcnt vmcnt(0)
  s_cbranch_scc1 SM3x
  v_cmp_ne_u32 vcc, s3, v13
  s_nop 4
  s_cbranch_vccnz SM3
SM3x:
  s_waitcnt vmcnt(0)
  s_barrier
  buffer_load_dwordx4 a[0:3], v244, s[36:39], 0 offen offset:0 sc1
  buffer_load_dwordx4 a[8:11], v244, s[36:39], 0 offen offset:2048 sc1
  buffer_load_dwordx4 a[4:7], v244, s[36:39], 0 offen offset:1024 sc1
  buffer_load_dwordx4 a[12:15], v244, s[36:39], 0 offen offset:3072 sc1
  s_mov_b32 s50, 4096
  buffer_load_dwordx4 a[16:19], v244, s[36:39], s50 offen offset:0 sc1
  buffer_load_dwordx4 a[20:23], v244, s[36:39], s50 offen offset:1024 sc1
  buffer_load_dwordx4 a[24:27], v244, s[36:39], s50 offen offset:2048 sc1
  buffer_load_dwordx4 a[28:31], v244, s[36:39], s50 offen offset:3072 sc1
  ds_read_b64 v[116:117], v240 offset:0
  ds_read_b64 v[118:119], v241 offset:0
  ds_read_b64 v[120:121], v242 offset:0
  ds_read_b64 v[122:123], v243 offset:0
  ds_read_b64 v[124:125], v240 offset:2048
  ds_read_b64 v[126:127], v241 offset:2048
  ds_read_b64 v[128:129], v242 offset:2048
  ds_read_b64 v[130:131], v243 offset:2048
  v_lshrrev_b32 v13, 4, v10
  v_cmp_eq_u32 vcc, 2, v13
  s_add_u32 s51, s73, 65536
  v_mov_b32 v12, s3
  v_cndmask_b32 v13, 0, 1.0, vcc
  s_waitcnt lgkmcnt(0)
  v_lshlrev_b32 v52, 16, v116
  v_and_b32 v53, 0xffff0000, v116
  v_lshlrev_b32 v54, 16, v117
  v_and_b32 v55, 0xffff0000, v117
  v_lshlrev_b32 v56, 16, v118
  v_and_b32 v57, 0xffff0000, v118
  v_lshlrev_b32 v58, 16, v119
  v_and_b32 v59, 0xffff0000, v119
  v_lshlrev_b32 v60, 16, v120
  v_and_b32 v61, 0xffff0000, v120
  v_lshlrev_b32 v62, 16, v121
  v_and_b32 v63, 0xffff0000, v121
  v_lshlrev_b32 v64, 16, v122
  v_and_b32 v65, 0xffff0000, v122
  v_lshlrev_b32 v66, 16, v123
  v_and_b32 v67, 0xffff0000, v123
  v_lshlrev_b32 v68, 16, v124
  v_and_b32 v69, 0xffff0000, v124
  v_lshlrev_b32 v70, 16, v125
  v_and_b32 v71, 0xffff0000, v125
  v_lshlrev_b32 v72, 16, v126
  v_and_b32 v73, 0xffff0000, v126
  v_lshlrev_b32 v74, 16, v127
  v_and_b32 v75, 0xffff0000, v127
  v_lshlrev_b32 v76, 16, v128
  v_and_b32 v77, 0xffff0000, v128
  v_lshlrev_b32 v78, 16, v129
  v_and_b32 v79, 0xffff0000, v129
  v_lshlrev_b32 v80, 16, v130
  v_and_b32 v81, 0xffff0000, v130
  v_lshlrev_b32 v82, 16, v131
  v_and_b32 v83, 0xffff0000, v131
  s_waitcnt vmcnt(7) lgkmcnt(15)
  v_mfma_f32_16x16x32_bf16 v[20:23], a[176:179], a[0:3], 0
  s_waitcnt vmcnt(6)
  s_mov_b32 s50, 8192
  buffer_load_dwordx4 a[32:35], v244, s[36:39], s50 offen offset:0 sc1
  v_mfma_f32_16x16x32_bf16 v[20:23], a[180:183], a[8:11], v[20:23]
  s_waitcnt vmcnt(5)
  v_mfma_f32_16x16x32_bf16 v[24:27], a[180:183], a[12:15], 0
  s_waitcnt vmcnt(6)
  buffer_load_dwordx4 a[36:39], v244, s[36:39], s50 offen offset:1024 sc1
  v_mfma_f32_16x16x32_bf16 v[24:27], a[176:179], a[4:7], v[24:27]
  s_waitcnt lgkmcnt(15)
  ds_read_b64_tr_b16 a[176:177], v239 offset:24576
  ds_read_b64_tr_b16 a[178:179], v239 offset:26624
  v_mfma_f32_16x16x32_bf16 v[32:35], a[184:187], a[4:7], 0
  ds_read_b64_tr_b16 a[180:181], v239 offset:28672
  ds_read_b64_tr_b16 a[182:183], v239 offset:30720
  v_mfma_f32_16x16x32_bf16 v[32:35], a[188:191], a[12:15], v[32:35]
  buffer_load_dwordx4 a[40:43], v244, s[36:39], s50 offen offset:2048 sc1
  v_mfma_f32_16x16x32_bf16 v[28:31], a[188:191], a[8:11], 0
  buffer_load_dwordx4 a[44:47], v244, s[36:39], s50 offen offset:3072 sc1
  v_mfma_f32_16x16x32_bf16 v[28:31], a[184:187], a[0:3], v[28:31]
  s_waitcnt lgkmcnt(15)
  s_mov_b32 s50, 12288
  ds_read_b64_tr_b16 a[184:185], v236 offset:32768
  v_mfma_f32_16x16x32_bf16 v[36:39], a[192:195], a[0:3], 0
  ds_read_b64_tr_b16 a[186:187], v236 offset:34816
  ds_read_b64_tr_b16 a[188:189], v236 offset:36864
  v_mfma_f32_16x16x32_bf16 v[36:39], a[196:199], a[8:11], v[36:39]
  ds_read_b64_tr_b16 a[190:191], v236 offset:38912
  buffer_load_dwordx4 a[48:51], v244, s[36:39], s50 offen offset:0 sc1
  v_mfma_f32_16x16x32_bf16 v[40:43], a[196:199], a[12:15], 0
  buffer_load_dwordx4 a[52:55], v244, s[36:39], s50 offen offset:1024 sc1
  v_mfma_f32_16x16x32_bf16 v[40:43], a[192:195], a[4:7], v[40:43]
  s_waitcnt lgkmcnt(15)
  ds_read_b64_tr_b16 a[192:193], v237 offset:32768
  ds_read_b64_tr_b16 a[194:195], v237 offset:34816
  v_mfma_f32_16x16x32_bf16 v[48:51], a[200:203], a[4:7], 0
  s_mov_b32 s49, 0
  ds_read_b64_tr_b16 a[196:197], v237 offset:36864
  ds_read_b64_tr_b16 a[198:199], v237 offset:38912
  v_mfma_f32_16x16x32_bf16 v[48:51], a[204:207], a[12:15], v[48:51]
  buffer_load_dwordx4 a[56:59], v244, s[36:39], s50 offen offset:2048 sc1
  buffer_load_dwordx4 v[156:159], v249, s[36:39], s49 offen sc1
  v_mfma_f32_16x16x32_bf16 v[44:47], a[204:207], a[8:11], 0
  s_mov_b32 s49, 24576
  buffer_load_dwordx4 v[160:163], v249, s[36:39], s49 offen sc1
  s_mov_b32 s49, 49152
  v_mfma_f32_16x16x32_bf16 v[44:47], a[200:203], a[0:3], v[44:47]
  s_waitcnt vmcnt(9) lgkmcnt(15)
  buffer_load_dwordx4 v[164:167], v249, s[36:39], s49 offen sc1
  s_mov_b32 s49, 73728
  v_mfma_f32_16x16x32_bf16 v[20:23], a[208:211], a[16:19], v[20:23]
  buffer_load_dwordx4 v[168:171], v249, s[36:39], s49 offen sc1
  buffer_load_dwordx4 a[60:63], v244, s[36:39], s50 offen offset:3072 sc1
  v_mfma_f32_16x16x32_bf16 v[20:23], a[212:215], a[24:27], v[20:23]
  s_mov_b32 s50, 16384
  ds_read_b64_tr_b16 a[200:201], v238 offset:32768
  ds_read_b64_tr_b16 a[202:203], v238 offset:34816
  v_mfma_f32_16x16x32_bf16 v[24:27], a[212:215], a[28:31], v[24:27]
  ds_read_b64_tr_b16 a[204:205], v238 offset:36864
  ds_read_b64_tr_b16 a[206:207], v238 offset:38912
  v_mfma_f32_16x16x32_bf16 v[24:27], a[208:211], a[20:23], v[24:27]
  s_waitcnt lgkmcnt(15)
  buffer_load_dwordx4 a[64:67], v244, s[36:39], s50 offen offset:0 sc1
  buffer_load_dwordx4 a[68:71], v244, s[36:39], s50 offen offset:1024 sc1
  v_mfma_f32_16x16x32_bf16 v[32:35], a[216:219], a[20:23], v[32:35]
  ds_read_b64_tr_b16 a[208:209], v239 offset:32768
  ds_read_b64_tr_b16 a[210:211], v239 offset:34816
  v_mfma_f32_16x16x32_bf16 v[32:35], a[220:223], a[28:31], v[32:35]
  ds_read_b64_tr_b16 a[212:213], v239 offset:36864
  ds_read_b64_tr_b16 a[214:215], v239 offset:38912
  v_mfma_f32_16x16x32_bf16 v[28:31], a[220:223], a[24:27], v[28:31]
  buffer_load_dwordx4 a[72:75], v244, s[36:39], s50 offen offset:2048 sc1
  buffer_load_dwordx4 a[76:79], v244, s[36:39], s50 offen offset:3072 sc1
  v_mfma_f32_16x16x32_bf16 v[28:31], a[216:219], a[16:19], v[28:31]
  s_waitcnt lgkmcnt(15)
  s_mov_b32 s50, 20480
  ds_read_b64_tr_b16 a[216:217], v236 offset:40960
  v_mfma_f32_16x16x32_bf16 v[36:39], a[224:227], a[16:19], v[36:39]
  ds_read_b64_tr_b16 a[218:219], v236 offset:43008
  ds_read_b64_tr_b16 a[220:221], v236 offset:45056
  v_mfma_f32_16x16x32_bf16 v[36:39], a[228:231], a[24:27], v[36:39]
  ds_read_b64_tr_b16 a[222:223], v236 offset:47104
  buffer_load_dwordx4 a[80:83], v244, s[36:39], s50 offen offset:0 sc1
  v_mfma_f32_16x16x32_bf16 v[40:43], a[228:231], a[28:31], v[40:43]
  buffer_load_dwordx4 a[84:87], v244, s[36:39], s50 offen offset:1024 sc1
  v_mfma_f32_16x16x32_bf16 v[40:43], a[224:227], a[20:23], v[40:43]
  s_waitcnt lgkmcnt(15)
  ds_read_b64_tr_b16 a[224:225], v237 offset:40960
  ds_read_b64_tr_b16 a[226:227], v237 offset:43008
  v_mfma_f32_16x16x32_bf16 v[48:51], a[176:179], a[20:23], v[48:51]
  ds_read_b64_tr_b16 a[228:229], v237 offset:45056
  ds_read_b64_tr_b16 a[230:231], v237 offset:47104
  v_mfma_f32_16x16x32_bf16 v[48:51], a[180:183], a[28:31], v[48:51]
  buffer_load_dwordx4 a[88:91], v244, s[36:39], s50 offen offset:2048 sc1
  v_mfma_f32_16x16x32_bf16 v[44:47], a[180:183], a[24:27], v[44:47]
  buffer_load_dwordx4 a[92:95], v244, s[36:39], s50 offen offset:3072 sc1
  v_mfma_f32_16x16x32_bf16 v[44:47], a[176:179], a[16:19], v[44:47]
  s_waitcnt vmcnt(16) lgkmcnt(15)
  s_mov_b32 s50, 24576
  ds_read_b64_tr_b16 a[176:177], v238 offset:40960
  v_mfma_f32_16x16x32_bf16 v[20:23], a[184:187], a[32:35], v[20:23]
  ds_read_b64_tr_b16 a[178:179], v238 offset:43008
  ds_read_b64_tr_b16 a[180:181], v238 offset:45056
  v_mfma_f32_16x16x32_bf16 v[20:23], a[188:191], a[40:43], v[20:23]
  buffer_load_dwordx4 a[96:99], v244, s[36:39], s50 offen offset:0 sc1
  ds_read_b64_tr_b16 a[182:183], v238 offset:47104
  v_mfma_f32_16x16x32_bf16 v[24:27], a[188:191], a[44:47], v[24:27]
  buffer_load_dwordx4 a[100:103], v244, s[36:39], s50 offen offset:1024 sc1
  v_mfma_f32_16x16x32_bf16 v[24:27], a[184:187], a[36:39], v[24:27]
  s_waitcnt lgkmcnt(15)
  ds_read_b64_tr_b16 a[184:185], v239 offset:40960
  ds_read_b64_tr_b16 a[186:187], v239 offset:43008
  v_mfma_f32_16x16x32_bf16 v[32:35], a[192:195], a[36:39], v[32:35]
  ds_read_b64_tr_b16 a[188:189], v239 offset:45056
  buffer_load_dwordx4 a[104:107], v244, s[36:39], s50 offen offset:2048 sc1
  v_mfma_f32_16x16x32_bf16 v[32:35], a[196:199], a[44:47], v[32:35]
  ds_read_b64_tr_b16 a[190:191], v239 offset:47104
  v_mfma_f32_16x16x32_bf16 v[28:31], a[196:199], a[40:43], v[28:31]
  buffer_load_dwordx4 a[108:111], v244, s[36:39], s50 offen offset:3072 sc1
  v_mfma_f32_16x16x32_bf16 v[28:31], a[192:195], a[32:35], v[28:31]
  s_waitcnt lgkmcnt(15)
  s_mov_b32 s50, 28672
  ds_read_b64_tr_b16 a[192:193], v232 offset:0
  v_mfma_f32_16x16x32_bf16 v[36:39], a[200:203], a[32:35], v[36:39]
Ha2_1:
  s_cbranch_execz Ra
  ds_read_b64_tr_b16 a[194:195], v232 offset:2048
  ds_read_b64_tr_b16 a[196:197], v232 offset:4096
  v_mfma_f32_16x16x32_bf16 v[36:39], a[204:207], a[40:43], v[36:39]
  buffer_load_dwordx4 a[112:115], v244, s[36:39], s50 offen offset:0 sc1
  ds_read_b64_tr_b16 a[198:199], v232 offset:6144
  v_mfma_f32_16x16x32_bf16 v[40:43], a[204:207], a[44:47], v[40:43]
  buffer_load_dwordx4 a[116:119], v244, s[36:39], s50 offen offset:1024 sc1
  v_mfma_f32_16x16x32_bf16 v[40:43], a[200:203], a[36:39], v[40:43]
  s_waitcnt lgkmcnt(15)
  ds_read_b64_tr_b16 a[200:201], v233 offset:0
  ds_read_b64_tr_b16 a[202:203], v233 offset:2048
  v_mfma_f32_16x16x32_bf16 v[48:51], a[208:211], a[36:39], v[48:51]
  ds_read_b64_tr_b16 a[204:205], v233 offset:4096
  buffer_load_dwordx4 a[120:123], v244, s[36:39], s50 offen offset:2048 sc1
  v_mfma_f32_16x16x32_bf16 v[48:51], a[212:215], a[44:47], v[48:51]
  ds_read_b64_tr_b16 a[206:207], v233 offset:6144
  v_mfma_f32_16x16x32_bf16 v[44:47], a[212:215], a[40:43], v[44:47]
  buffer_load_dwordx4 a[124:127], v244, s[36:39], s50 offen offset:3072 sc1
  v_mfma_f32_16x16x32_bf16 v[44:47], a[208:211], a[32:35], v[44:47]
  s_waitcnt vmcnt(16) lgkmcnt(15)
  ds_read_b64_tr_b16 a[208:209], v234 offset:0
  ds_read_b64_tr_b16 a[210:211], v234 offset:2048
  v_mfma_f32_16x16x32_bf16 v[20:23], a[216:219], a[48:51], v[20:23]
  s_mov_b32 s50, 32768
  ds_read_b64_tr_b16 a[212:213], v234 offset:4096
  ds_read_b64_tr_b16 a[214:215], v234 offset:6144
  v_mfma_f32_16x16x32_bf16 v[20:23], a[220:223], a[56:59], v[20:23]
  buffer_load_dwordx4 a[128:131], v244, s[36:39], s50 offen offset:0 sc1
  v_mfma_f32_16x16x32_bf16 v[24:27], a[220:223], a[60:63], v[24:27]
  v_mfma_f32_16x16x32_bf16 v[24:27], a[216:219], a[52:55], v[24:27]
  s_waitcnt lgkmcnt(15)
  ds_read_b64_tr_b16 a[216:217], v235 offset:0
  ds_read_b64_tr_b16 a[218:219], v235 offset:2048
  v_mfma_f32_16x16x32_bf16 v[32:35], a[224:227], a[52:55], v[32:35]
  ds_read_b64_tr_b16 a[220:221], v235 offset:4096
  ds_read_b64_tr_b16 a[222:223], v235 offset:6144
  v_mfma_f32_16x16x32_bf16 v[32:35], a[228:231], a[60:63], v[32:35]
  buffer_load_dwordx4 a[132:135], v244, s[36:39], s50 offen offset:1024 sc1
  v_mfma_f32_16x16x32_bf16 v[28:31], a[228:231], a[56:59], v[28:31]
  v_mfma_f32_16x16x32_bf16 v[28:31], a[224:227], a[48:51], v[28:31]
  s_waitcnt lgkmcnt(15)
  ds_read_b64_tr_b16 a[224:225], v232 offset:8192
  ds_read_b64_tr_b16 a[226:227], v232 offset:10240
  v_mfma_f32_16x16x32_bf16 v[36:39], a[176:179], a[48:51], v[36:39]
  ds_read_b64_tr_b16 a[228:229], v232 offset:12288
  ds_read_b64_tr_b16 a[230:231], v232 offset:14336
  v_mfma_f32_16x16x32_bf16 v[36:39], a[180:183], a[56:59], v[36:39]
  buffer_load_dwordx4 a[136:139], v244, s[36:39], s50 offen offset:2048 sc1
  v_mfma_f32_16x16x32_bf16 v[40:43], a[180:183], a[60:63], v[40:43]
  v_mfma_f32_16x16x32_bf16 v[40:43], a[176:179], a[52:55], v[40:43]
  s_waitcnt lgkmcnt(15)
  ds_read_b64_tr_b16 a[176:177], v233 offset:8192
  ds_read_b64_tr_b16 a[178:179], v233 offset:10240
  v_mfma_f32_16x16x32_bf16 v[48:51], a[184:187], a[52:55], v[48:51]
  ds_read_b64_tr_b16 a[180:181], v233 offset:12288
  v_mfma_f32_16x16x32_bf16 v[48:51], a[188:191], a[60:63], v[48:51]
  buffer_load_dwordx4 a[140:143], v244, s[36:39], s50 offen offset:3072 sc1
  ds_read_b64_tr_b16 a[182:183], v233 offset:14336
  v_mfma_f32_16x16x32_bf16 v[44:47], a[188:191], a[56:59], v[44:47]
  v_mfma_f32_16x16x32_bf16 v[44:47], a[184:187], a[48:51], v[44:47]
  s_waitcnt vmcnt(16) lgkmcnt(15)
  ds_read_b64_tr_b16 a[184:185], v234 offset:8192
  ds_read_b64_tr_b16 a[186:187], v234 offset:10240
  v_mfma_f32_16x16x32_bf16 v[20:23], a[192:195], a[64:67], v[20:23]
  s_mov_b32 s50, 36864
  ds_read_b64_tr_b16 a[188:189], v234 offset:12288
  v_mfma_f32_16x16x32_bf16 v[20:23], a[196:199], a[72:75], v[20:23]
  buffer_load_dwordx4 a[144:147], v244, s[36:39], s50 offen offset:0 sc1
  ds_read_b64_tr_b16 a[190:191], v234 offset:14336
  v_mfma_f32_16x16x32_bf16 v[24:27], a[196:199], a[76:79], v[24:27]
  v_mfma_f32_16x16x32_bf16 v[24:27], a[192:195], a[68:71], v[24:27]
  s_waitcnt lgkmcnt(15)
  ds_read_b64_tr_b16 a[192:193], v235 offset:8192
  ds_read_b64_tr_b16 a[194:195], v235 offset:10240
  v_mfma_f32_16x16x32_bf16 v[32:35], a[200:203], a[68:71], v[32:35]
  ds_read_b64_tr_b16 a[196:197], v235 offset:12288
  v_mfma_f32_16x16x32_bf16 v[32:35], a[204:207], a[76:79], v[32:35]
  buffer_load_dwordx4 a[148:151], v244, s[36:39], s50 offen offset:1024 sc1
  ds_read_b64_tr_b16 a[198:199], v235 offset:14336
  v_mfma_f32_16x16x32_bf16 v[28:31], a[204:207], a[72:75], v[28:31]
  v_mfma_f32_16x16x32_bf16 v[28:31], a[200:203], a[64:67], v[28:31]
  s_waitcnt lgkmcnt(15)
  ds_read_b64_tr_b16 a[200:201], v232 offset:16384
  ds_read_b64_tr_b16 a[202:203], v232 offset:18432
  v_mfma_f32_16x16x32_bf16 v[36:39], a[208:211], a[64:67], v[36:39]
  ds_read_b64_tr_b16 a[204:205], v232 offset:20480
  v_mfma_f32_16x16x32_bf16 v[36:39], a[212:215], a[72:75], v[36:39]
  buffer_load_dwordx4 a[152:155], v244, s[36:39], s50 offen offset:2048 sc1
  ds_read_b64_tr_b16 a[206:207], v232 offset:22528
  v_mfma_f32_16x16x32_bf16 v[40:43], a[212:215], a[76:79], v[40:43]
  v_mfma_f32_16x16x32_bf16 v[40:43], a[208:211], a[68:71], v[40:43]
  s_waitcnt lgkmcnt(15)
  ds_read_b64_tr_b16 a[208:209], v233 offset:16384
  ds_read_b64_tr_b16 a[210:211], v233 offset:18432
  v_mfma_f32_16x16x32_bf16 v[48:51], a[216:219], a[68:71], v[48:51]
  ds_read_b64_tr_b16 a[212:213], v233 offset:20480
  v_mfma_f32_16x16x32_bf16 v[48:51], a[220:223], a[76:79], v[48:51]
  buffer_load_dwordx4 a[156:159], v244, s[36:39], s50 offen offset:3072 sc1
  ds_read_b64_tr_b16 a[214:215], v233 offset:22528
  v_mfma_f32_16x16x32_bf16 v[44:47], a[220:223], a[72:75], v[44:47]
  v_mfma_f32_16x16x32_bf16 v[44:47], a[216:219], a[64:67], v[44:47]
  s_waitcnt vmcnt(16) lgkmcnt(15)
  ds_read_b64_tr_b16 a[216:217], v234 offset:16384
  ds_read_b64_tr_b16 a[218:219], v234 offset:18432
  v_mfma_f32_16x16x32_bf16 v[20:23], a[224:227], a[80:83], v[20:23]
  s_mov_b32 s50, 40960
  ds_read_b64_tr_b16 a[220:221], v234 offset:20480
  v_mfma_f32_16x16x32_bf16 v[20:23], a[228:231], a[88:91], v[20:23]
  buffer_load_dwordx4 a[160:163], v244, s[36:39], s50 offen offset:0 sc1
  ds_read_b64_tr_b16 a[222:223], v234 offset:22528
  v_mfma_f32_16x16x32_bf16 v[24:27], a[228:231], a[92:95], v[24:27]
  v_mfma_f32_16x16x32_bf16 v[24:27], a[224:227], a[84:87], v[24:27]
  s_waitcnt lgkmcnt(15)
  ds_read_b64_tr_b16 a[224:225], v235 offset:16384
  ds_read_b64_tr_b16 a[226:227], v235 offset:18432
  v_mfma_f32_16x16x32_bf16 v[32:35], a[176:179], a[84:87], v[32:35]
  ds_read_b64_tr_b16 a[228:229], v235 offset:20480
  v_mfma_f32_16x16x32_bf16 v[32:35], a[180:183], a[92:95], v[32:35]
  buffer_load_dwordx4 a[164:167], v244, s[36:39], s50 offen offset:1024 sc1
  ds_read_b64_tr_b16 a[230:231], v235 offset:22528
  v_mfma_f32_16x16x32_bf16 v[28:31], a[180:183], a[88:91], v[28:31]
  v_mfma_f32_16x16x32_bf16 v[28:31], a[176:179], a[80:83], v[28:31]
  s_waitcnt lgkmcnt(15)
  ds_read_b64_tr_b16 a[176:177], v232 offset:24576
  ds_read_b64_tr_b16 a[178:179], v232 offset:26624
  v_mfma_f32_16x16x32_bf16 v[36:39], a[184:187], a[80:83], v[36:39]
  s_waitcnt vmcnt(27)
  v_max_u32 v15, v156, v157
  v_max3_u32 v15, v15, v158, v159
  v_mfma_f32_16x16x32_bf16 v[36:39], a[188:191], a[88:91], v[36:39]
  buffer_load_dwordx4 a[168:171], v244, s[36:39], s50 offen offset:2048 sc1
  ds_read_b64_tr_b16 a[180:181], v232 offset:28672
  v_mfma_f32_16x16x32_bf16 v[40:43], a[188:191], a[92:95], v[40:43]
  ds_read_b64_tr_b16 a[182:183], v232 offset:30720
  v_max3_u32 v15, v15, v160, v161
  v_mfma_f32_16x16x32_bf16 v[40:43], a[184:187], a[84:87], v[40:43]
  s_waitcnt lgkmcnt(15)
  ds_read_b64_tr_b16 a[184:185], v233 offset:24576
  v_max3_u32 v15, v15, v162, v163
  v_mfma_f32_16x16x32_bf16 v[48:51], a[192:195], a[84:87], v[48:51]
  ds_read_b64_tr_b16 a[186:187], v233 offset:26624
  v_max3_u32 v15, v15, v164, v165
  v_mfma_f32_16x16x32_bf16 v[48:51], a[196:199], a[92:95], v[48:51]
  buffer_load_dwordx4 a[172:175], v244, s[36:39], s50 offen offset:3072 sc1
  ds_read_b64_tr_b16 a[188:189], v233 offset:28672
  v_mfma_f32_16x16x32_bf16 v[44:47], a[196:199], a[88:91], v[44:47]
  ds_read_b64_tr_b16 a[190:191], v233 offset:30720
  v_max3_u32 v15, v15, v166, v167
  v_mfma_f32_16x16x32_bf16 v[44:47], a[192:195], a[80:83], v[44:47]
  s_waitcnt vmcnt(16) lgkmcnt(15)
  ds_read_b64_tr_b16 a[192:193], v234 offset:24576
  v_max3_u32 v15, v15, v168, v169
  v_mfma_f32_16x16x32_bf16 v[20:23], a[200:203], a[96:99], v[20:23]
  s_mov_b32 s50, 45056
  ds_read_b64_tr_b16 a[194:195], v234 offset:26624
  v_max3_u32 v15, v15, v170, v171
  v_mfma_f32_16x16x32_bf16 v[20:23], a[204:207], a[104:107], v[20:23]
  buffer_load_dwordx4 a[0:3], v244, s[36:39], s50 offen offset:0 sc1
  ds_read_b64_tr_b16 a[196:197], v234 offset:28672
  v_mfma_f32_16x16x32_bf16 v[24:27], a[204:207], a[108:111], v[24:27]
  ds_read_b64_tr_b16 a[198:199], v234 offset:30720
  v_mfma_f32_16x16x32_bf16 v[24:27], a[200:203], a[100:103], v[24:27]
  s_waitcnt lgkmcnt(15)
  ds_read_b64_tr_b16 a[200:201], v235 offset:24576
  v_mfma_f32_16x16x32_bf16 v[32:35], a[208:211], a[100:103], v[32:35]
  ds_read_b64_tr_b16 a[202:203], v235 offset:26624
  v_mfma_f32_16x16x32_bf16 v[32:35], a[212:215], a[108:111], v[32:35]
  buffer_load_dwordx4 a[4:7], v244, s[36:39], s50 offen offset:1024 sc1
  ds_read_b64_tr_b16 a[204:205], v235 offset:28672
  v_mfma_f32_16x16x32_bf16 v[28:31], a[212:215], a[104:107], v[28:31]
  ds_read_b64_tr_b16 a[206:207], v235 offset:30720
  v_mfma_f32_16x16x32_bf16 v[28:31], a[208:211], a[96:99], v[28:31]
  s_waitcnt lgkmcnt(15)
  ds_read_b64_tr_b16 a[208:209], v232 offset:32768
  v_mfma_f32_16x16x32_bf16 v[36:39], a[216:219], a[96:99], v[36:39]
  ds_read_b64_tr_b16 a[210:211], v232 offset:34816
  v_mfma_f32_16x16x32_bf16 v[36:39], a[220:223], a[104:107], v[36:39]
  buffer_load_dwordx4 a[8:11], v244, s[36:39], s50 offen offset:2048 sc1
  ds_read_b64_tr_b16 a[212:213], v232 offset:36864
  v_mfma_f32_16x16x32_bf16 v[40:43], a[220:223], a[108:111], v[40:43]
  v_cmp_eq_u32 vcc, -1, v15
  s_nop 4
  s_cbranch_vccnz CK4s
CK4x:
  v_mfma_f32_16x16x32_bf16 v[40:43], a[216:219], a[100:103], v[40:43]
  s_waitcnt lgkmcnt(15)
  ds_read_b64_tr_b16 a[214:215], v232 offset:38912
  ds_read_b64_tr_b16 a[216:217], v233 offset:32768
  v_mfma_f32_16x16x32_bf16 v[48:51], a[224:227], a[100:103], v[48:51]
  ds_read_b64_tr_b16 a[218:219], v233 offset:34816
  v_add_f32 v156, v156, v164
  v_mfma_f32_16x16x32_bf16 v[48:51], a[228:231], a[108:111], v[48:51]
  buffer_load_dwordx4 a[12:15], v244, s[36:39], s50 offen offset:3072 sc1
  ds_read_b64_tr_b16 a[220:221], v233 offset:36864
  v_mfma_f32_16x16x32_bf16 v[44:47], a[228:231], a[104:107], v[44:47]
  ds_read_b64_tr_b16 a[222:223], v233 offset:38912
  v_add_f32 v157, v157, v165
  v_add_f32 v158, v158, v166
  v_add_f32 v159, v159, v167
  v_mfma_f32_16x16x32_bf16 v[44:47], a[224:227], a[96:99], v[44:47]
  s_waitcnt vmcnt(16) lgkmcnt(15)
  ds_read_b64_tr_b16 a[224:225], v232 offset:40960
  v_add_f32 v160, v160, v168
  v_add_f32 v161, v161, v169
  v_add_f32 v162, v162, v170
  v_mfma_f32_16x16x32_bf16 v[20:23], a[176:179], a[112:115], v[20:23]
  s_mov_b32 s50, 49152
  ds_read_b64_tr_b16 a[226:227], v232 offset:43008
  v_add_f32 v163, v163, v171
  v_add_f32 v156, v156, v160
  v_add_f32 v157, v157, v161
  v_mfma_f32_16x16x32_bf16 v[20:23], a[180:183], a[120:123], v[20:23]
  buffer_load_dwordx4 a[16:19], v244, s[36:39], s50 offen offset:0 sc1
  ds_read_b64_tr_b16 a[228:229], v232 offset:45056
  v_add_f32 v158, v158, v162
  v_add_f32 v159, v159, v163
  v_mfma_f32_16x16x32_bf16 v[24:27], a[180:183], a[124:127], v[24:27]
  ds_read_b64_tr_b16 a[230:231], v232 offset:47104
  v_cvt_pk_bf16_f32 v160, v156, v157
  v_lshlrev_b32 v156, 16, v160
  v_and_b32 v157, 0xffff0000, v160
  v_mfma_f32_16x16x32_bf16 v[24:27], a[176:179], a[116:119], v[24:27]
  s_waitcnt lgkmcnt(15)
  ds_read_b64_tr_b16 a[176:177], v233 offset:40960
  v_cvt_pk_bf16_f32 v161, v158, v159
  v_lshlrev_b32 v158, 16, v161
  v_and_b32 v159, 0xffff0000, v161
  v_mfma_f32_16x16x32_bf16 v[32:35], a[184:187], a[116:119], v[32:35]
  ds_read_b64_tr_b16 a[178:179], v233 offset:43008
  v_add_f32 v156, v13, v156
  v_add_f32 v157, v13, v157
  v_add_f32 v158, v13, v158
  v_mfma_f32_16x16x32_bf16 v[32:35], a[188:191], a[124:127], v[32:35]
  buffer_load_dwordx4 a[20:23], v244, s[36:39], s50 offen offset:1024 sc1
  v_add_f32 v159, v13, v159
  v_cvt_pk_bf16_f32 v160, v156, v157
  v_lshlrev_b32 v156, 16, v160
  v_mfma_f32_16x16x32_bf16 v[28:31], a[188:191], a[120:123], v[28:31]
  ds_read_b64_tr_b16 a[180:181], v233 offset:45056
  v_and_b32 v157, 0xffff0000, v160
  v_cvt_pk_bf16_f32 v161, v158, v159
  v_lshlrev_b32 v158, 16, v161
  v_mfma_f32_16x16x32_bf16 v[28:31], a[184:187], a[112:115], v[28:31]
  s_waitcnt lgkmcnt(15)
  ds_read_b64_tr_b16 a[182:183], v233 offset:47104
  v_and_b32 v159, 0xffff0000, v161
  v_mfma_f32_16x16x32_bf16 v[36:39], a[192:195], a[112:115], v[36:39]
  ds_write_b128 v247, v[156:159]
  ds_read_b128 v[84:87], v245 offset:0
  v_mfma_f32_16x16x32_bf16 v[36:39], a[196:199], a[120:123], v[36:39]
  ds_read_b128 v[100:103], v245 offset:512
  ds_read_b128 v[88:91], v245 offset:64
  v_mfma_f32_16x16x32_bf16 v[40:43], a[196:199], a[124:127], v[40:43]
  ds_read_b128 v[104:107], v245 offset:576
  ds_read_b128 v[92:95], v245 offset:128
  v_mfma_f32_16x16x32_bf16 v[40:43], a[192:195], a[116:119], v[40:43]
  s_waitcnt lgkmcnt(15)
  ds_read_b128 v[108:111], v245 offset:640
  ds_read_b128 v[96:99], v245 offset:192
  v_mfma_f32_16x16x32_bf16 v[48:51], a[200:203], a[116:119], v[48:51]
  ds_read_b128 v[112:115], v245 offset:704
  ds_read_b128 v[116:119], v246 offset:512
  v_mfma_f32_16x16x32_bf16 v[48:51], a[204:207], a[124:127], v[48:51]
  ds_read_b128 v[120:123], v246 offset:576
  ds_read_b128 v[124:127], v246 offset:640
  v_mfma_f32_16x16x32_bf16 v[44:47], a[204:207], a[120:123], v[44:47]
  ds_read_b128 v[128:131], v246 offset:704
  ds_read_b64_tr_b16 a[184:185], v232 offset:49152
  v_accvgpr_write_b32 a248, v156
  v_accvgpr_write_b32 a249, v157
  v_mfma_f32_16x16x32_bf16 v[44:47], a[200:203], a[112:115], v[44:47]
  s_waitcnt vmcnt(14) lgkmcnt(15)
  buffer_load_dwordx4 a[24:27], v244, s[36:39], s50 offen offset:2048 sc1
  ds_read_b64_tr_b16 a[186:187], v232 offset:51200
  v_accvgpr_write_b32 a250, v158
  v_accvgpr_write_b32 a251, v159
  v_mfma_f32_16x16x32_bf16 v[20:23], a[208:211], a[128:131], v[20:23]
  ds_read_b64_tr_b16 a[188:189], v232 offset:53248
  ds_read_b64_tr_b16 a[190:191], v232 offset:55296
  v_mfma_f32_16x16x32_bf16 v[20:23], a[212:215], a[136:139], v[20:23]
  ds_read_b64_tr_b16 a[192:193], v233 offset:49152
  buffer_load_dwordx4 a[28:31], v244, s[36:39], s50 offen offset:3072 sc1
  s_mov_b32 s50, 53248
  v_mfma_f32_16x16x32_bf16 v[24:27], a[212:215], a[140:143], v[24:27]
  ds_read_b64_tr_b16 a[194:195], v233 offset:51200
  ds_read_b64_tr_b16 a[196:197], v233 offset:53248
  v_mfma_f32_16x16x32_bf16 v[24:27], a[208:211], a[132:135], v[24:27]
  s_waitcnt lgkmcnt(15)
  ds_read_b64_tr_b16 a[198:199], v233 offset:55296
  ds_read_b64_tr_b16 a[200:201], v232 offset:57344
  v_mfma_f32_16x16x32_bf16 v[32:35], a[216:219], a[132:135], v[32:35]
  buffer_load_dwordx4 a[32:35], v244, s[36:39], s50 offen offset:0 sc1
  ds_read_b64_tr_b16 a[202:203], v232 offset:59392
  v_mfma_f32_16x16x32_bf16 v[32:35], a[220:223], a[140:143], v[32:35]
  ds_read_b64_tr_b16 a[204:205], v232 offset:61440
  buffer_load_dwordx4 a[36:39], v244, s[36:39], s50 offen offset:1024 sc1
  v_mfma_f32_16x16x32_bf16 v[28:31], a[220:223], a[136:139], v[28:31]
  ds_read_b64_tr_b16 a[206:207], v232 offset:63488
  ds_read_b64_tr_b16 a[208:209], v233 offset:57344
  v_mfma_f32_16x16x32_bf16 v[28:31], a[216:219], a[128:131], v[28:31]
  s_waitcnt vmcnt(14) lgkmcnt(15)
  buffer_load_dwordx4 a[40:43], v244, s[36:39], s50 offen offset:2048 sc1
  ds_read_b64_tr_b16 a[210:211], v233 offset:59392
  v_mfma_f32_16x16x32_bf16 v[20:23], a[224:227], a[144:147], v[20:23]
  ds_read_b64_tr_b16 a[212:213], v233 offset:61440
  buffer_load_dwordx4 a[44:47], v244, s[36:39], s50 offen offset:3072 sc1
  s_mov_b32 s50, 57344
  v_mfma_f32_16x16x32_bf16 v[20:23], a[228:231], a[152:155], v[20:23]
  s_waitcnt lgkmcnt(15)
  ds_read_b64_tr_b16 a[214:215], v233 offset:63488
  ds_read_b64_tr_b16 a[216:217], v236 offset:0
  v_cvt_pk_bf16_f32 v148, v116, v117
  v_cvt_pk_bf16_f32 v149, v118, v119
  v_mfma_f32_16x16x32_bf16 v[24:27], a[228:231], a[156:159], v[24:27]
  buffer_load_dwordx4 a[48:51], v244, s[36:39], s50 offen offset:0 sc1
  ds_read_b64_tr_b16 a[218:219], v236 offset:2048
  v_cvt_pk_bf16_f32 v150, v120, v121
  v_cvt_pk_bf16_f32 v151, v122, v123
  v_mfma_f32_16x16x32_bf16 v[24:27], a[224:227], a[148:151], v[24:27]
  s_waitcnt lgkmcnt(15)
  ds_read_b64_tr_b16 a[220:221], v236 offset:4096
  buffer_load_dwordx4 a[52:55], v244, s[36:39], s50 offen offset:1024 sc1
  v_cvt_pk_bf16_f32 v152, v124, v125
  v_cvt_pk_bf16_f32 v153, v126, v127
  v_mfma_f32_16x16x32_bf16 v[32:35], a[176:179], a[148:151], v[32:35]
  ds_read_b64_tr_b16 a[222:223], v236 offset:6144
  ds_read_b64_tr_b16 a[224:225], v237 offset:0
  v_cvt_pk_bf16_f32 v154, v128, v129
  v_cvt_pk_bf16_f32 v155, v130, v131
  v_mfma_f32_16x16x32_bf16 v[32:35], a[180:183], a[156:159], v[32:35]
  buffer_load_dwordx4 a[56:59], v244, s[36:39], s50 offen offset:2048 sc1
  ds_read_b64_tr_b16 a[226:227], v237 offset:2048
  v_mfma_f32_16x16x32_bf16 v[28:31], a[180:183], a[152:155], v[28:31]
  ds_read_b64_tr_b16 a[228:229], v237 offset:4096
  v_mfma_f32_16x16x32_bf16 v[28:31], a[176:179], a[144:147], v[28:31]
  s_waitcnt vmcnt(15) lgkmcnt(15)
  buffer_load_dwordx4 a[60:63], v244, s[36:39], s50 offen offset:3072 sc1
  ds_read_b64_tr_b16 a[230:231], v237 offset:6144
  v_mfma_f32_16x16x32_bf16 v[20:23], a[184:187], a[160:163], v[20:23]
  s_mov_b32 s50, 61440
  ds_read_b64_tr_b16 a[176:177], v236 offset:8192
  v_mfma_f32_16x16x32_bf16 v[20:23], a[188:191], a[168:171], v[20:23]
  buffer_load_dwordx4 a[64:67], v244, s[36:39], s50 offen offset:0 sc1
  ds_read_b64_tr_b16 a[178:179], v236 offset:10240
  v_mfma_f32_16x16x32_bf16 v[24:27], a[188:191], a[172:175], v[24:27]
  ds_read_b64_tr_b16 a[180:181], v236 offset:12288
  v_mfma_f32_16x16x32_bf16 v[24:27], a[184:187], a[164:167], v[24:27]
  s_waitcnt lgkmcnt(15)
  buffer_load_dwordx4 a[68:71], v244, s[36:39], s50 offen offset:1024 sc1
  v_mfma_f32_16x16x32_bf16 v[32:35], a[192:195], a[164:167], v[32:35]
  ds_read_b64_tr_b16 a[182:183], v236 offset:14336
  v_mfma_f32_16x16x32_bf16 v[32:35], a[196:199], a[172:175], v[32:35]
  buffer_load_dwordx4 a[72:75], v244, s[36:39], s50 offen offset:2048 sc1
  ds_read_b64_tr_b16 a[184:185], v237 offset:8192
  v_mfma_f32_16x16x32_bf16 v[28:31], a[196:199], a[168:171], v[28:31]
  ds_read_b64_tr_b16 a[186:187], v237 offset:10240
  v_mfma_f32_16x16x32_bf16 v[28:31], a[192:195], a[160:163], v[28:31]
  s_waitcnt vmcnt(15) lgkmcnt(15)
  buffer_load_dwordx4 a[76:79], v244, s[36:39], s50 offen offset:3072 sc1
  ds_read_b64_tr_b16 a[188:189], v237 offset:12288
  v_mfma_f32_16x16x32_bf16 v[20:23], a[200:203], a[0:3], v[20:23]
  ds_read_b64_tr_b16 a[190:191], v237 offset:14336
  v_mfma_f32_16x16x32_bf16 v[20:23], a[204:207], a[8:11], v[20:23]
  ds_read_b64_tr_b16 a[192:193], v236 offset:49152
  v_mfma_f32_16x16x32_bf16 v[24:27], a[204:207], a[12:15], v[24:27]
  ds_read_b64_tr_b16 a[194:195], v236 offset:51200
  v_mfma_f32_16x16x32_bf16 v[24:27], a[200:203], a[4:7], v[24:27]
  s_waitcnt lgkmcnt(15)
  ds_read_b64_tr_b16 a[196:197], v236 offset:53248
  v_mfma_f32_16x16x32_bf16 v[32:35], a[208:211], a[4:7], v[32:35]
  ds_read_b64_tr_b16 a[198:199], v236 offset:55296
  v_mfma_f32_16x16x32_bf16 v[32:35], a[212:215], a[12:15], v[32:35]
  ds_read_b64_tr_b16 a[200:201], v237 offset:49152
  v_mfma_f32_16x16x32_bf16 v[28:31], a[212:215], a[8:11], v[28:31]
  ds_read_b64_tr_b16 a[202:203], v237 offset:51200
  v_mfma_f32_16x16x32_bf16 v[28:31], a[208:211], a[0:3], v[28:31]
  s_waitcnt vmcnt(12) lgkmcnt(15)
  ds_read_b64_tr_b16 a[204:205], v237 offset:53248
  v_mfma_f32_16x16x32_bf16 v[20:23], a[216:219], a[16:19], v[20:23]
  ds_read_b64_tr_b16 a[206:207], v237 offset:55296
  v_mfma_f32_16x16x32_bf16 v[20:23], a[220:223], a[24:27], v[20:23]
  ds_read_b64_tr_b16 a[208:209], v236 offset:57344
  v_mfma_f32_16x16x32_bf16 v[24:27], a[220:223], a[28:31], v[24:27]
  ds_read_b64_tr_b16 a[210:211], v236 offset:59392
  v_mfma_f32_16x16x32_bf16 v[24:27], a[216:219], a[20:23], v[24:27]
  s_waitcnt lgkmcnt(15)
  ds_read_b64_tr_b16 a[212:213], v236 offset:61440
  v_mfma_f32_16x16x32_bf16 v[32:35], a[224:227], a[20:23], v[32:35]
  ds_read_b64_tr_b16 a[214:215], v236 offset:63488
  v_mfma_f32_16x16x32_bf16 v[32:35], a[228:231], a[28:31], v[32:35]
  ds_read_b64_tr_b16 a[216:217], v237 offset:57344
  v_mfma_f32_16x16x32_bf16 v[28:31], a[228:231], a[24:27], v[28:31]
  ds_read_b64_tr_b16 a[218:219], v237 offset:59392
  v_mfma_f32_16x16x32_bf16 v[28:31], a[224:227], a[16:19], v[28:31]
  s_waitcnt vmcnt(8) lgkmcnt(15)
  ds_read_b64_tr_b16 a[220:221], v237 offset:61440
  v_mfma_f32_16x16x32_bf16 v[20:23], a[176:179], a[32:35], v[20:23]
  ds_read_b64_tr_b16 a[222:223], v237 offset:63488
  v_mfma_f32_16x16x32_bf16 v[20:23], a[180:183], a[40:43], v[20:23]
  ds_read_b64_tr_b16 a[224:225], v234 offset:32768
  v_mfma_f32_16x16x32_bf16 v[24:27], a[180:183], a[44:47], v[24:27]
  ds_read_b64_tr_b16 a[226:227], v234 offset:34816
  v_mfma_f32_16x16x32_bf16 v[24:27], a[176:179], a[36:39], v[24:27]
  s_waitcnt lgkmcnt(15)
  ds_read_b64_tr_b16 a[228:229], v234 offset:36864
  v_mfma_f32_16x16x32_bf16 v[32:35], a[184:187], a[36:39], v[32:35]
  ds_read_b64_tr_b16 a[230:231], v234 offset:38912
  v_mfma_f32_16x16x32_bf16 v[32:35], a[188:191], a[44:47], v[32:35]
  ds_read_b64_tr_b16 a[176:177], v235 offset:32768
  v_mfma_f32_16x16x32_bf16 v[28:31], a[188:191], a[40:43], v[28:31]
  ds_read_b64_tr_b16 a[178:179], v235 offset:34816
  v_mfma_f32_16x16x32_bf16 v[28:31], a[184:187], a[32:35], v[28:31]
  s_waitcnt vmcnt(4) lgkmcnt(15)
  ds_read_b64_tr_b16 a[180:181], v235 offset:36864
  v_mfma_f32_16x16x32_bf16 v[20:23], a[192:195], a[48:51], v[20:23]
  v_mfma_f32_16x16x32_bf16 v[20:23], a[196:199], a[56:59], v[20:23]
  ds_read_b64_tr_b16 a[182:183], v235 offset:38912
  v_mfma_f32_16x16x32_bf16 v[24:27], a[196:199], a[60:63], v[24:27]
  ds_read_b64_tr_b16 a[184:185], v234 offset:40960
  v_mfma_f32_16x16x32_bf16 v[24:27], a[192:195], a[52:55], v[24:27]
  s_waitcnt lgkmcnt(15)
  ds_read_b64_tr_b16 a[186:187], v234 offset:43008
  v_mfma_f32_16x16x32_bf16 v[32:35], a[200:203], a[52:55], v[32:35]
  ds_read_b64_tr_b16 a[188:189], v234 offset:45056
  v_mfma_f32_16x16x32_bf16 v[32:35], a[204:207], a[60:63], v[32:35]
  ds_read_b64_tr_b16 a[190:191], v234 offset:47104
  v_mfma_f32_16x16x32_bf16 v[28:31], a[204:207], a[56:59], v[28:31]
  ds_read_b64_tr_b16 a[192:193], v235 offset:40960
  v_mfma_f32_16x16x32_bf16 v[28:31], a[200:203], a[48:51], v[28:31]
  s_waitcnt vmcnt(0) lgkmcnt(15)
  ds_read_b64_tr_b16 a[194:195], v235 offset:43008
  v_mfma_f32_16x16x32_bf16 v[20:23], a[208:211], a[64:67], v[20:23]
  ds_read_b64_tr_b16 a[196:197], v235 offset:45056
  v_mfma_f32_16x16x32_bf16 v[20:23], a[212:215], a[72:75], v[20:23]
  ds_read_b64_tr_b16 a[198:199], v235 offset:47104
  v_mfma_f32_16x16x32_bf16 v[24:27], a[212:215], a[76:79], v[24:27]
  ds_read_b64_tr_b16 a[200:201], v234 offset:49152
  v_mfma_f32_16x16x32_bf16 v[24:27], a[208:211], a[68:71], v[24:27]
  s_waitcnt lgkmcnt(15)
  ds_read_b64_tr_b16 a[202:203], v234 offset:51200
  v_mfma_f32_16x16x32_bf16 v[32:35], a[216:219], a[68:71], v[32:35]
  ds_read_b64_tr_b16 a[204:205], v234 offset:53248
  v_mfma_f32_16x16x32_bf16 v[32:35], a[220:223], a[76:79], v[32:35]
  ds_read_b64_tr_b16 a[206:207], v234 offset:55296
  v_mfma_f32_16x16x32_bf16 v[28:31], a[220:223], a[72:75], v[28:31]
  ds_read_b64_tr_b16 a[208:209], v235 offset:49152
  v_mfma_f32_16x16x32_bf16 v[28:31], a[216:219], a[64:67], v[28:31]
  s_waitcnt lgkmcnt(15)
  ds_read_b64_tr_b16 a[210:211], v235 offset:51200
  v_mfma_f32_16x16x32_bf16 v[36:39], a[224:227], a[128:131], v[36:39]
  s_waitcnt lgkmcnt(15)
  s_nop 3
  v_pk_fma_f32 v[68:69], v[84:85], v[24:25], v[68:69]
  v_pk_fma_f32 v[70:71], v[86:87], v[26:27], v[70:71]
  v_pk_fma_f32 v[72:73], v[88:89], v[32:33], v[72:73]
  v_pk_fma_f32 v[74:75], v[90:91], v[34:35], v[74:75]
  v_pk_mul_f32 v[24:25], v[68:69], v[100:101]
  v_pk_mul_f32 v[26:27], v[70:71], v[102:103]
  v_pk_mul_f32 v[32:33], v[72:73], v[104:105]
  v_pk_mul_f32 v[34:35], v[74:75], v[106:107]
  v_cvt_pk_bf16_f32 v140, v24, v25
  v_cvt_pk_bf16_f32 v141, v26, v27
  v_cvt_pk_bf16_f32 v142, v32, v33
  v_cvt_pk_bf16_f32 v143, v34, v35
  buffer_store_dwordx4 v[140:143], v0, s[36:39], s73 offen offset:1024 sc1
  v_pk_fma_f32 v[52:53], v[84:85], v[20:21], v[52:53]
  v_pk_fma_f32 v[54:55], v[86:87], v[22:23], v[54:55]
  v_pk_fma_f32 v[56:57], v[88:89], v[28:29], v[56:57]
  v_pk_fma_f32 v[58:59], v[90:91], v[30:31], v[58:59]
  v_pk_mul_f32 v[20:21], v[52:53], v[100:101]
  v_pk_mul_f32 v[22:23], v[54:55], v[102:103]
  v_pk_mul_f32 v[28:29], v[56:57], v[104:105]
  v_pk_mul_f32 v[30:31], v[58:59], v[106:107]
  v_cvt_pk_bf16_f32 v132, v20, v21
  v_cvt_pk_bf16_f32 v133, v22, v23
  v_cvt_pk_bf16_f32 v134, v28, v29
  v_cvt_pk_bf16_f32 v135, v30, v31
  buffer_store_dwordx4 v[132:135], v0, s[36:39], s73 offen offset:0 sc1
  ds_read_b64_tr_b16 a[212:213], v235 offset:53248
  v_mfma_f32_16x16x32_bf16 v[36:39], a[228:231], a[136:139], v[36:39]
  ds_read_b64_tr_b16 a[214:215], v235 offset:55296
  v_mfma_f32_16x16x32_bf16 v[40:43], a[228:231], a[140:143], v[40:43]
  ds_read_b64_tr_b16 a[216:217], v234 offset:57344
  v_mfma_f32_16x16x32_bf16 v[40:43], a[224:227], a[132:135], v[40:43]
  s_waitcnt lgkmcnt(15)
  ds_read_b64_tr_b16 a[218:219], v234 offset:59392
  v_mfma_f32_16x16x32_bf16 v[48:51], a[176:179], a[132:135], v[48:51]
  ds_read_b64_tr_b16 a[220:221], v234 offset:61440
  v_mfma_f32_16x16x32_bf16 v[48:51], a[180:183], a[140:143], v[48:51]
  ds_read_b64_tr_b16 a[222:223], v234 offset:63488
  v_mfma_f32_16x16x32_bf16 v[44:47], a[180:183], a[136:139], v[44:47]
  ds_read_b64_tr_b16 a[224:225], v235 offset:57344
  v_mfma_f32_16x16x32_bf16 v[44:47], a[176:179], a[128:131], v[44:47]
  s_waitcnt lgkmcnt(15)
  ds_read_b64_tr_b16 a[226:227], v235 offset:59392
  v_mfma_f32_16x16x32_bf16 v[36:39], a[184:187], a[144:147], v[36:39]
  ds_read_b64_tr_b16 a[228:229], v235 offset:61440
  buffer_store_dwordx4 v[148:151], v0, s[36:39], s75 offen sc1
  v_mfma_f32_16x16x32_bf16 v[36:39], a[188:191], a[152:155], v[36:39]
  s_add_u32 s75, s75, 16384
  buffer_store_dwordx4 v[152:155], v0, s[36:39], s75 offen sc1
  ds_read_b64_tr_b16 a[230:231], v235 offset:63488
  v_mfma_f32_16x16x32_bf16 v[40:43], a[188:191], a[156:159], v[40:43]
  ds_read_b64_tr_b16 a[176:177], v238 offset:0
  v_mfma_f32_16x16x32_bf16 v[40:43], a[184:187], a[148:151], v[40:43]
  s_waitcnt lgkmcnt(15)
  ds_read_b64_tr_b16 a[178:179], v238 offset:2048
  v_mfma_f32_16x16x32_bf16 v[48:51], a[192:195], a[148:151], v[48:51]
  ds_read_b64_tr_b16 a[180:181], v238 offset:4096
  v_mfma_f32_16x16x32_bf16 v[48:51], a[196:199], a[156:159], v[48:51]
  ds_read_b64_tr_b16 a[182:183], v238 offset:6144
  v_mfma_f32_16x16x32_bf16 v[44:47], a[196:199], a[152:155], v[44:47]
  v_mfma_f32_16x16x32_bf16 v[44:47], a[192:195], a[144:147], v[44:47]
  s_waitcnt lgkmcnt(15)
  ds_read_b64_tr_b16 a[184:185], v239 offset:0
  v_mfma_f32_16x16x32_bf16 v[36:39], a[200:203], a[160:163], v[36:39]
  ds_read_b64_tr_b16 a[186:187], v239 offset:2048
  v_mfma_f32_16x16x32_bf16 v[36:39], a[204:207], a[168:171], v[36:39]
  ds_read_b64_tr_b16 a[188:189], v239 offset:4096
  v_mfma_f32_16x16x32_bf16 v[40:43], a[204:207], a[172:175], v[40:43]
  ds_read_b64_tr_b16 a[190:191], v239 offset:6144
  v_mfma_f32_16x16x32_bf16 v[40:43], a[200:203], a[164:167], v[40:43]
  s_waitcnt lgkmcnt(15)
  ds_read_b64_tr_b16 a[192:193], v238 offset:8192
  v_mfma_f32_16x16x32_bf16 v[48:51], a[208:211], a[164:167], v[48:51]
  ds_read_b64_tr_b16 a[194:195], v238 offset:10240
  v_mfma_f32_16x16x32_bf16 v[48:51], a[212:215], a[172:175], v[48:51]
  ds_read_b64_tr_b16 a[196:197], v238 offset:12288
  v_mfma_f32_16x16x32_bf16 v[44:47], a[212:215], a[168:171], v[44:47]
  ds_read_b64_tr_b16 a[198:199], v238 offset:14336
  v_mfma_f32_16x16x32_bf16 v[44:47], a[208:211], a[160:163], v[44:47]
  s_waitcnt lgkmcnt(15)
  ds_read_b64_tr_b16 a[200:201], v239 offset:8192
  v_mfma_f32_16x16x32_bf16 v[36:39], a[216:219], a[0:3], v[36:39]
  ds_read_b64_tr_b16 a[202:203], v239 offset:10240
  v_mfma_f32_16x16x32_bf16 v[36:39], a[220:223], a[8:11], v[36:39]
  ds_read_b64_tr_b16 a[204:205], v239 offset:12288
  v_mfma_f32_16x16x32_bf16 v[40:43], a[220:223], a[12:15], v[40:43]
  ds_read_b64_tr_b16 a[206:207], v239 offset:14336
  v_mfma_f32_16x16x32_bf16 v[40:43], a[216:219], a[4:7], v[40:43]
  s_waitcnt lgkmcnt(15)
  s_bfe_u32 s56, s82, 0x30000
  s_lshl_b32 s56, s56, 2
  v_mfma_f32_16x16x32_bf16 v[48:51], a[224:227], a[4:7], v[48:51]
  s_bitcmp1_b32 s82, 3
  s_addc_u32 s56, s56, 0
  s_mul_i32 s56, s56, 229376
  v_mfma_f32_16x16x32_bf16 v[48:51], a[228:231], a[12:15], v[48:51]
  s_waitcnt vmcnt(2)
  s_barrier
  s_add_u32 m0, s84, 86016
  v_mfma_f32_16x16x32_bf16 v[44:47], a[228:231], a[8:11], v[44:47]
  s_mov_b64 exec, 1
  buffer_store_dword v12, v0, s[36:39], s45 offen sc1
  s_mov_b64 exec, -1
  v_mfma_f32_16x16x32_bf16 v[44:47], a[224:227], a[0:3], v[44:47]
  s_waitcnt lgkmcnt(12)
Ha0_2:
  s_cbranch_execz Ra
  ds_read_b64_tr_b16 a[208:209], v238 offset:49152
  ds_read_b64_tr_b16 a[210:211], v238 offset:51200
  v_mfma_f32_16x16x32_bf16 v[36:39], a[176:179], a[16:19], v[36:39]
  s_add_u32 s45, s45, -32768
  ds_read_b64_tr_b16 a[212:213], v238 offset:53248
  ds_read_b64_tr_b16 a[214:215], v238 offset:55296
  v_mfma_f32_16x16x32_bf16 v[36:39], a[180:183], a[24:27], v[36:39]
  ds_read_b64_tr_b16 a[216:217], v239 offset:49152
  buffer_load_dwordx4 v3, s[16:19], s56 offen offset:0 lds
  v_mfma_f32_16x16x32_bf16 v[40:43], a[180:183], a[28:31], v[40:43]
  ds_read_b64_tr_b16 a[218:219], v239 offset:51200
  ds_read_b64_tr_b16 a[220:221], v239 offset:53248
  v_mfma_f32_16x16x32_bf16 v[40:43], a[176:179], a[20:23], v[40:43]
  s_waitcnt lgkmcnt(15)
  ds_read_b64_tr_b16 a[222:223], v239 offset:55296
  buffer_load_dwordx4 v4, s[16:19], s56 offen offset:1024 lds
  v_mfma_f32_16x16x32_bf16 v[48:51], a[184:187], a[20:23], v[48:51]
  ds_read_b64_tr_b16 a[224:225], v238 offset:57344
  ds_read_b64_tr_b16 a[226:227], v238 offset:59392
  v_mfma_f32_16x16x32_bf16 v[48:51], a[188:191], a[28:31], v[48:51]
  ds_read_b64_tr_b16 a[228:229], v238 offset:61440
  v_mfma_f32_16x16x32_bf16 v[44:47], a[188:191], a[24:27], v[44:47]
  buffer_load_dwordx4 v5, s[16:19], s56 offen offset:2048 lds
  ds_read_b64_tr_b16 a[230:231], v238 offset:63488
  v_mfma_f32_16x16x32_bf16 v[44:47], a[184:187], a[16:19], v[44:47]
  s_waitcnt lgkmcnt(15)
  ds_read_b64_tr_b16 a[176:177], v239 offset:57344
  v_mfma_f32_16x16x32_bf16 v[36:39], a[192:195], a[32:35], v[36:39]
  ds_read_b64_tr_b16 a[178:179], v239 offset:59392
  v_mfma_f32_16x16x32_bf16 v[36:39], a[196:199], a[40:43], v[36:39]
  buffer_load_dwordx4 v6, s[16:19], s56 offen offset:3072 lds
  s_add_u32 m0, s84, 90112
  v_mfma_f32_16x16x32_bf16 v[40:43], a[196:199], a[44:47], v[40:43]
  ds_read_b64_tr_b16 a[180:181], v239 offset:61440
  ds_read_b64_tr_b16 a[182:183], v239 offset:63488
  v_mfma_f32_16x16x32_bf16 v[40:43], a[192:195], a[36:39], v[40:43]
  s_waitcnt lgkmcnt(15)
  v_mfma_f32_16x16x32_bf16 v[48:51], a[200:203], a[36:39], v[48:51]
  buffer_load_dwordx4 v7, s[16:19], s56 offen offset:0 lds
  v_mfma_f32_16x16x32_bf16 v[48:51], a[204:207], a[44:47], v[48:51]
  v_mfma_f32_16x16x32_bf16 v[44:47], a[204:207], a[40:43], v[44:47]
  v_mfma_f32_16x16x32_bf16 v[44:47], a[200:203], a[32:35], v[44:47]
  s_waitcnt lgkmcnt(12)
  buffer_load_dwordx4 v8, s[16:19], s56 offen offset:1024 lds
  v_mfma_f32_16x16x32_bf16 v[36:39], a[208:211], a[48:51], v[36:39]
  v_mfma_f32_16x16x32_bf16 v[36:39], a[212:215], a[56:59], v[36:39]
  v_mfma_f32_16x16x32_bf16 v[40:43], a[212:215], a[60:63], v[40:43]
  buffer_load_dwordx4 v9, s[16:19], s56 offen offset:2048 lds
  s_bfe_u32 s56, s82, 0x30004
  v_mfma_f32_16x16x32_bf16 v[40:43], a[208:211], a[52:55], v[40:43]
  s_waitcnt lgkmcnt(8)
  s_lshl_b32 s56, s56, 2
  s_bitcmp1_b32 s82, 7
  v_mfma_f32_16x16x32_bf16 v[48:51], a[216:219], a[52:55], v[48:51]
  s_addc_u32 s56, s56, 0
  s_mul_i32 s56, s56, 229376
  s_add_u32 m0, s84, 0
  v_mfma_f32_16x16x32_bf16 v[48:51], a[220:223], a[60:63], v[48:51]
  buffer_load_dwordx4 v3, s[16:19], s56 offen offset:0 lds
  v_mfma_f32_16x16x32_bf16 v[44:47], a[220:223], a[56:59], v[44:47]
  v_mfma_f32_16x16x32_bf16 v[44:47], a[216:219], a[48:51], v[44:47]
  s_waitcnt lgkmcnt(4)
  v_mfma_f32_16x16x32_bf16 v[36:39], a[224:227], a[64:67], v[36:39]
  buffer_load_dwordx4 v4, s[16:19], s56 offen offset:1024 lds
  v_mfma_f32_16x16x32_bf16 v[36:39], a[228:231], a[72:75], v[36:39]
  v_mfma_f32_16x16x32_bf16 v[40:43], a[228:231], a[76:79], v[40:43]
  v_mfma_f32_16x16x32_bf16 v[40:43], a[224:227], a[68:71], v[40:43]
  s_waitcnt lgkmcnt(0)
  buffer_load_dwordx4 v5, s[16:19], s56 offen offset:2048 lds
  v_mfma_f32_16x16x32_bf16 v[48:51], a[176:179], a[68:71], v[48:51]
  v_mfma_f32_16x16x32_bf16 v[48:51], a[180:183], a[76:79], v[48:51]
  v_mfma_f32_16x16x32_bf16 v[44:47], a[180:183], a[72:75], v[44:47]
  v_mfma_f32_16x16x32_bf16 v[44:47], a[176:179], a[64:67], v[44:47]
  s_bfe_u32 s57, s82, 0x40000
  s_lshl_b32 s57, s57, 13
  s_add_u32 s57, s57, s85
  s_nop 0
  v_pk_fma_f32 v[76:77], v[92:93], v[40:41], v[76:77]
  v_pk_fma_f32 v[78:79], v[94:95], v[42:43], v[78:79]
  v_pk_fma_f32 v[80:81], v[96:97], v[48:49], v[80:81]
  v_pk_fma_f32 v[82:83], v[98:99], v[50:51], v[82:83]
  buffer_load_dwordx4 v6, s[16:19], s56 offen offset:3072 lds
  v_pk_mul_f32 v[40:41], v[76:77], v[108:109]
  v_pk_mul_f32 v[42:43], v[78:79], v[110:111]
  v_pk_mul_f32 v[48:49], v[80:81], v[112:113]
  v_pk_mul_f32 v[50:51], v[82:83], v[114:115]
  s_add_u32 m0, s84, 4096
  s_nop 0
  buffer_load_dwordx4 v7, s[16:19], s56 offen offset:0 lds
  v_cvt_pk_bf16_f32 v144, v40, v41
  v_cvt_pk_bf16_f32 v145, v42, v43
  v_cvt_pk_bf16_f32 v146, v48, v49
  v_cvt_pk_bf16_f32 v147, v50, v51
  buffer_load_dwordx4 v8, s[16:19], s56 offen offset:1024 lds
  v_pk_fma_f32 v[60:61], v[92:93], v[36:37], v[60:61]
  v_pk_fma_f32 v[62:63], v[94:95], v[38:39], v[62:63]
  v_pk_fma_f32 v[64:65], v[96:97], v[44:45], v[64:65]
  v_pk_fma_f32 v[66:67], v[98:99], v[46:47], v[66:67]
  buffer_load_dwordx4 v9, s[16:19], s56 offen offset:2048 lds
  v_pk_mul_f32 v[36:37], v[60:61], v[108:109]
  v_pk_mul_f32 v[38:39], v[62:63], v[110:111]
  v_pk_mul_f32 v[44:45], v[64:65], v[112:113]
  v_pk_mul_f32 v[46:47], v[66:67], v[114:115]
  v_cvt_pk_bf16_f32 v136, v36, v37
  v_cvt_pk_bf16_f32 v137, v38, v39
  v_cvt_pk_bf16_f32 v138, v44, v45
  v_cvt_pk_bf16_f32 v139, v46, v47
  s_lshl2_add_u32 s48, s2, s44
  s_cmp_eq_u32 s48, 1
  s_cbranch_scc1 CKSs
CKSx:
  s_mov_b64 exec, 0
  s_cmp_eq_u32 s44, 1
  s_cbranch_scc1 Hb0
  s_cmp_eq_u32 s44, 2
  s_cbranch_scc1 Hb1
  s_cmp_eq_u32 s44, 3
  s_cbranch_scc1 Hb2
Rb:
  s_mov_b64 exec, -1
G3S:
  s_cmp_lg_u32 s44, 0
  s_cbranch_scc1 SM5x
  s_mov_b32 s46, 60000
  s_mov_b32 s47, 5242880
SM5:
  buffer_load_dword v13, v251, s[36:39], s47 offen sc1
  s_sub_u32 s46, s46, 1
  s_cmp_eq_u32 s46, 0
  s_waitcnt vmcnt(0)
  s_cbranch_scc1 SM5x
  v_cmp_ne_u32 vcc, s3, v13
  s_nop 4
  s_cbranch_vccnz SM5
SM5x:
  s_waitcnt vmcnt(7)
  s_barrier
  buffer_load_dwordx4 a[0:3], v0, s[36:39], s57 offen offset:0 sc1
  buffer_load_dwordx4 a[4:7], v0, s[36:39], s57 offen offset:1024 sc1
  buffer_load_dwordx4 a[8:11], v0, s[36:39], s57 offen offset:2048 sc1
  buffer_load_dwordx4 a[12:15], v0, s[36:39], s57 offen offset:3072 sc1
  s_add_u32 s57, s57, 4096
  buffer_load_dwordx4 a[16:19], v0, s[36:39], s57 offen offset:0 sc1
  buffer_load_dwordx4 a[20:23], v0, s[36:39], s57 offen offset:1024 sc1
  buffer_load_dwordx4 a[24:27], v0, s[36:39], s57 offen offset:2048 sc1
  buffer_load_dwordx4 a[28:31], v0, s[36:39], s57 offen offset:3072 sc1
  buffer_store_dwordx4 v[144:147], v0, s[36:39], s51 offen offset:1024 sc1
  buffer_store_dwordx4 v[136:139], v0, s[36:39], s51 offen offset:0 sc1
  v_pk_mul_f32 v[30:31], v[52:53], v[52:53]
  v_pk_mul_f32 v[34:35], v[68:69], v[68:69]
  v_pk_fma_f32 v[30:31], v[54:55], v[54:55], v[30:31]
  v_pk_add_f32 v[28:29], v[54:55], v[52:53]
  v_pk_fma_f32 v[34:35], v[70:71], v[70:71], v[34:35]
  v_pk_add_f32 v[32:33], v[70:71], v[68:69]
  v_pk_fma_f32 v[30:31], v[56:57], v[56:57], v[30:31]
  v_pk_add_f32 v[28:29], v[56:57], v[28:29]
  v_pk_fma_f32 v[34:35], v[72:73], v[72:73], v[34:35]
  v_pk_add_f32 v[32:33], v[72:73], v[32:33]
  v_pk_fma_f32 v[30:31], v[58:59], v[58:59], v[30:31]
  v_pk_add_f32 v[28:29], v[58:59], v[28:29]
  v_pk_fma_f32 v[34:35], v[74:75], v[74:75], v[34:35]
  v_pk_add_f32 v[32:33], v[74:75], v[32:33]
  v_pk_fma_f32 v[30:31], v[60:61], v[60:61], v[30:31]
  v_pk_add_f32 v[28:29], v[60:61], v[28:29]
  v_pk_fma_f32 v[34:35], v[76:77], v[76:77], v[34:35]
  v_pk_add_f32 v[32:33], v[76:77], v[32:33]
  v_pk_fma_f32 v[30:31], v[62:63], v[62:63], v[30:31]
  v_pk_add_f32 v[28:29], v[62:63], v[28:29]
  v_pk_fma_f32 v[34:35], v[78:79], v[78:79], v[34:35]
  v_pk_add_f32 v[32:33], v[78:79], v[32:33]
  v_pk_fma_f32 v[30:31], v[64:65], v[64:65], v[30:31]
  v_pk_add_f32 v[28:29], v[64:65], v[28:29]
  v_pk_fma_f32 v[34:35], v[80:81], v[80:81], v[34:35]
  v_pk_add_f32 v[32:33], v[80:81], v[32:33]
  v_pk_fma_f32 v[30:31], v[66:67], v[66:67], v[30:31]
  v_pk_add_f32 v[28:29], v[66:67], v[28:29]
  v_pk_fma_f32 v[34:35], v[82:83], v[82:83], v[34:35]
  v_pk_add_f32 v[32:33], v[82:83], v[32:33]
  v_add_f32 v20, v28, v29
  v_add_f32 v21, v30, v31
  v_add_f32 v22, v32, v33
  v_add_f32 v23, v34, v35
  v_mov_b32 v24, v20
  v_mov_b32 v25, v21
  v_mov_b32 v26, v22
  v_mov_b32 v27, v23
  v_permlane16_swap_b32 v20, v24
  v_permlane16_swap_b32 v21, v25
  v_permlane16_swap_b32 v22, v26
  v_permlane16_swap_b32 v23, v27
  v_pk_add_f32 v[20:21], v[20:21], v[24:25]
  v_pk_add_f32 v[22:23], v[22:23], v[26:27]
  v_mov_b32 v24, v20
  v_mov_b32 v25, v21
  v_mov_b32 v26, v22
  v_mov_b32 v27, v23
  v_permlane32_swap_b32 v20, v24
  v_permlane32_swap_b32 v21, v25
  v_permlane32_swap_b32 v22, v26
  v_permlane32_swap_b32 v23, v27
  v_pk_add_f32 v[20:21], v[20:21], v[24:25]
  v_pk_add_f32 v[22:23], v[22:23], v[26:27]
  s_mov_b64 exec, 0xffff
  buffer_store_dwordx4 v[20:23], v0, s[36:39], s74 offen sc1
  s_mov_b64 exec, -1
  v_cvt_pk_bf16_f32 v116, v52, v53
  v_cvt_pk_bf16_f32 v117, v54, v55
  v_cvt_pk_bf16_f32 v118, v56, v57
  v_cvt_pk_bf16_f32 v119, v58, v59
  v_cvt_pk_bf16_f32 v120, v60, v61
  v_cvt_pk_bf16_f32 v121, v62, v63
  v_cvt_pk_bf16_f32 v122, v64, v65
  v_cvt_pk_bf16_f32 v123, v66, v67
  v_cvt_pk_bf16_f32 v124, v68, v69
  v_cvt_pk_bf16_f32 v125, v70, v71
  v_cvt_pk_bf16_f32 v126, v72, v73
  v_cvt_pk_bf16_f32 v127, v74, v75
  v_cvt_pk_bf16_f32 v128, v76, v77
  v_cvt_pk_bf16_f32 v129, v78, v79
  v_cvt_pk_bf16_f32 v130, v80, v81
  v_cvt_pk_bf16_f32 v131, v82, v83
  v_accvgpr_write_b32 a232, v116
  v_accvgpr_write_b32 a233, v117
  v_accvgpr_write_b32 a234, v118
  v_accvgpr_write_b32 a235, v119
  v_accvgpr_write_b32 a236, v120
  v_accvgpr_write_b32 a237, v121
  v_accvgpr_write_b32 a238, v122
  v_accvgpr_write_b32 a239, v123
  v_accvgpr_write_b32 a240, v124
  v_accvgpr_write_b32 a241, v125
  v_accvgpr_write_b32 a242, v126
  v_accvgpr_write_b32 a243, v127
  v_accvgpr_write_b32 a244, v128
  v_accvgpr_write_b32 a245, v129
  v_accvgpr_write_b32 a246, v130
  v_accvgpr_write_b32 a247, v131
  v_and_b32 v30, 0x7fff, v251
  ds_read_b64_tr_b16 a[128:129], v2 offset:28672
  ds_read_b64_tr_b16 a[130:131], v2 offset:32256
  ds_read_b64_tr_b16 a[132:133], v2 offset:28704
  ds_read_b64_tr_b16 a[134:135], v2 offset:32288
  ds_read_b64_tr_b16 a[136:137], v2 offset:28736
  ds_read_b64_tr_b16 a[138:139], v2 offset:32320
  ds_read_b64_tr_b16 a[140:141], v2 offset:28768
  ds_read_b64_tr_b16 a[142:143], v2 offset:32352
  ds_read_b64_tr_b16 a[144:145], v2 offset:28800
  ds_read_b64_tr_b16 a[146:147], v2 offset:32384
  ds_read_b64_tr_b16 a[148:149], v2 offset:28832
  ds_read_b64_tr_b16 a[150:151], v2 offset:32416
  ds_read_b64_tr_b16 a[152:153], v2 offset:35840
  ds_read_b64_tr_b16 a[154:155], v2 offset:39424
  ds_read_b64_tr_b16 a[156:157], v2 offset:35872
  ds_read_b64_tr_b16 a[158:159], v2 offset:39456
  s_waitcnt vmcnt(10) lgkmcnt(12)
  v_mfma_f32_16x16x32_bf16 v[32:35], a[128:131], a[0:3], 0
  s_waitcnt vmcnt(9)
  s_bfe_u32 s57, s82, 0x40004
  s_lshl_b32 s57, s57, 13
  v_mfma_f32_16x16x32_bf16 v[36:39], a[128:131], a[4:7], 0
  s_waitcnt vmcnt(8)
  s_add_u32 s57, s57, s85
  buffer_load_dwordx4 a[32:35], v0, s[36:39], s57 offen offset:0 sc1
  v_mfma_f32_16x16x32_bf16 v[40:43], a[128:131], a[8:11], 0
  s_waitcnt vmcnt(8)
  ds_read_b64_tr_b16 a[160:161], v2 offset:35904
  v_mfma_f32_16x16x32_bf16 v[44:47], a[128:131], a[12:15], 0
  ds_read_b64_tr_b16 a[162:163], v2 offset:39488
  v_mfma_f32_16x16x32_bf16 v[60:63], a[132:135], a[12:15], 0
  ds_read_b64_tr_b16 a[164:165], v2 offset:35936
  v_mfma_f32_16x16x32_bf16 v[56:59], a[132:135], a[8:11], 0
  v_mfma_f32_16x16x32_bf16 v[52:55], a[132:135], a[4:7], 0
  buffer_load_dwordx4 a[36:39], v0, s[36:39], s57 offen offset:1024 sc1
  v_mfma_f32_16x16x32_bf16 v[48:51], a[132:135], a[0:3], 0
  s_waitcnt lgkmcnt(11)
  ds_read_b64_tr_b16 a[166:167], v2 offset:39520
  v_mfma_f32_16x16x32_bf16 v[64:67], a[136:139], a[0:3], 0
  ds_read_b64_tr_b16 a[168:169], v2 offset:35968
  v_mfma_f32_16x16x32_bf16 v[68:71], a[136:139], a[4:7], 0
  v_mfma_f32_16x16x32_bf16 v[72:75], a[136:139], a[8:11], 0
  s_mov_b32 s68, 5308416
  ds_read_b64_tr_b16 a[170:171], v2 offset:39552
  v_mfma_f32_16x16x32_bf16 v[76:79], a[136:139], a[12:15], 0
  buffer_load_dwordx4 a[40:43], v0, s[36:39], s57 offen offset:2048 sc1
  v_mfma_f32_16x16x32_bf16 v[92:95], a[140:143], a[12:15], 0
  ds_read_b64_tr_b16 a[172:173], v2 offset:36000
  v_mfma_f32_16x16x32_bf16 v[88:91], a[140:143], a[8:11], 0
  v_mfma_f32_16x16x32_bf16 v[84:87], a[140:143], a[4:7], 0
  ds_read_b64_tr_b16 a[174:175], v2 offset:39584
  v_mfma_f32_16x16x32_bf16 v[80:83], a[140:143], a[0:3], 0
  s_waitcnt lgkmcnt(12)
  v_mfma_f32_16x16x32_bf16 v[96:99], a[144:147], a[0:3], 0
  buffer_load_dwordx4 a[44:47], v0, s[36:39], s57 offen offset:3072 sc1
  s_bfe_u32 s56, s82, 0x30008
  v_mfma_f32_16x16x32_bf16 v[100:103], a[144:147], a[4:7], 0
  s_lshl_b32 s56, s56, 2
  s_bitcmp1_b32 s82, 11
  s_addc_u32 s56, s56, 0
  v_mfma_f32_16x16x32_bf16 v[104:107], a[144:147], a[8:11], 0
  s_mul_i32 s56, s56, 229376
  s_add_u32 m0, s84, 28672
  ds_read_b64_tr_b16 a[128:129], v2 offset:28864
  v_mfma_f32_16x16x32_bf16 v[108:111], a[144:147], a[12:15], 0
  ds_read_b64_tr_b16 a[130:131], v2 offset:32448
  v_mfma_f32_16x16x32_bf16 v[124:127], a[148:151], a[12:15], 0
  ds_read_b64_tr_b16 a[132:133], v2 offset:36032
  v_mfma_f32_16x16x32_bf16 v[120:123], a[148:151], a[8:11], 0
  buffer_load_dwordx4 v3, s[16:19], s56 offen offset:0 lds
  s_add_u32 s57, s57, 4096
  v_mfma_f32_16x16x32_bf16 v[116:119], a[148:151], a[4:7], 0
  ds_read_b64_tr_b16 a[134:135], v2 offset:39616
  v_mfma_f32_16x16x32_bf16 v[112:115], a[148:151], a[0:3], 0
  s_waitcnt vmcnt(8) lgkmcnt(12)
  v_mfma_f32_16x16x32_bf16 v[32:35], a[152:155], a[16:19], v[32:35]
  ds_read_b64_tr_b16 a[136:137], v2 offset:43008
  v_mfma_f32_16x16x32_bf16 v[36:39], a[152:155], a[20:23], v[36:39]
  v_mfma_f32_16x16x32_bf16 v[40:43], a[152:155], a[24:27], v[40:43]
  buffer_load_dwordx4 a[48:51], v0, s[36:39], s57 offen offset:0 sc1
  v_mfma_f32_16x16x32_bf16 v[44:47], a[152:155], a[28:31], v[44:47]
  ds_read_b64_tr_b16 a[138:139], v2 offset:46592
  v_mfma_f32_16x16x32_bf16 v[60:63], a[156:159], a[28:31], v[60:63]
  ds_read_b64_tr_b16 a[140:141], v2 offset:50176
  v_mfma_f32_16x16x32_bf16 v[56:59], a[156:159], a[24:27], v[56:59]
  v_mfma_f32_16x16x32_bf16 v[52:55], a[156:159], a[20:23], v[52:55]
  ds_read_b64_tr_b16 a[142:143], v2 offset:53760
  v_mfma_f32_16x16x32_bf16 v[48:51], a[156:159], a[16:19], v[48:51]
  s_waitcnt lgkmcnt(12)
  buffer_load_dwordx4 v4, s[16:19], s56 offen offset:1024 lds
  v_mfma_f32_16x16x32_bf16 v[64:67], a[160:163], a[16:19], v[64:67]
  ds_read_b64_tr_b16 a[144:145], v2 offset:43040
  v_mfma_f32_16x16x32_bf16 v[68:71], a[160:163], a[20:23], v[68:71]
  v_mfma_f32_16x16x32_bf16 v[72:75], a[160:163], a[24:27], v[72:75]
  ds_read_b64_tr_b16 a[146:147], v2 offset:46624
  v_mfma_f32_16x16x32_bf16 v[76:79], a[160:163], a[28:31], v[76:79]
  v_mfma_f32_16x16x32_bf16 v[92:95], a[164:167], a[28:31], v[92:95]
  buffer_load_dwordx4 a[52:55], v0, s[36:39], s57 offen offset:1024 sc1
  v_mfma_f32_16x16x32_bf16 v[88:91], a[164:167], a[24:27], v[88:91]
  ds_read_b64_tr_b16 a[148:149], v2 offset:50208
  v_mfma_f32_16x16x32_bf16 v[84:87], a[164:167], a[20:23], v[84:87]
  ds_read_b64_tr_b16 a[150:151], v2 offset:53792
  v_mfma_f32_16x16x32_bf16 v[80:83], a[164:167], a[16:19], v[80:83]
  s_waitcnt lgkmcnt(12)
  v_mfma_f32_16x16x32_bf16 v[96:99], a[168:171], a[16:19], v[96:99]
  s_bfe_u32 s59, s82, 0x40018
  s_lshl4_add_u32 s59, s58, s59
  s_lshl_b32 s59, s59, 11
  v_mfma_f32_16x16x32_bf16 v[100:103], a[168:171], a[20:23], v[100:103]
  s_add_u32 s59, s59, 5767168
  buffer_load_dwordx4 v5, s[16:19], s56 offen offset:2048 lds
  s_lshr_b32 s76, s44, 1
  v_mfma_f32_16x16x32_bf16 v[104:107], a[168:171], a[24:27], v[104:107]
  s_mul_i32 s76, s76, 14336
  ds_read_b64_tr_b16 a[152:153], v2 offset:43072
  s_and_b32 s77, s44, 1
  v_mfma_f32_16x16x32_bf16 v[108:111], a[168:171], a[28:31], v[108:111]
  s_lshl_b32 s77, s77, 7
  ds_read_b64_tr_b16 a[154:155], v2 offset:46656
  s_add_u32 s76, s76, s77
  v_mfma_f32_16x16x32_bf16 v[124:127], a[172:175], a[28:31], v[124:127]
  ds_read_b64_tr_b16 a[156:157], v2 offset:50240
  v_add_u32 v31, s76, v1
  v_mfma_f32_16x16x32_bf16 v[120:123], a[172:175], a[24:27], v[120:123]
  s_lshl_b32 s61, s2, 15
  s_lshl1_add_u32 s61, s70, s61
  s_xor_b32 s63, s61, 32768
  v_mfma_f32_16x16x32_bf16 v[116:119], a[172:175], a[20:23], v[116:119]
  s_add_u32 s61, s61, 41943040
  buffer_load_dwordx4 a[56:59], v0, s[36:39], s57 offen offset:2048 sc1
  s_add_u32 s62, s61, 4096
  v_mfma_f32_16x16x32_bf16 v[112:115], a[172:175], a[16:19], v[112:115]
  s_waitcnt lgkmcnt(7)
  ds_read_b64_tr_b16 a[158:159], v2 offset:53824
  s_add_u32 s63, s63, 41943040
  v_mfma_f32_16x16x32_bf16 v[128:131], a[128:131], a[0:3], 0
  s_add_u32 s64, s63, 4096
  ds_read_b64_tr_b16 a[160:161], v2 offset:43104
  v_mfma_f32_16x16x32_bf16 v[128:131], a[132:135], a[16:19], v[128:131]
  v_mfma_f32_16x16x32_bf16 v[132:135], a[132:135], a[20:23], 0
  ds_read_b64_tr_b16 a[162:163], v2 offset:46688
  v_mfma_f32_16x16x32_bf16 v[132:135], a[128:131], a[4:7], v[132:135]
  buffer_load_dwordx4 v6, s[16:19], s56 offen offset:3072 lds
  v_mfma_f32_16x16x32_bf16 v[136:139], a[128:131], a[8:11], 0
  ds_read_b64_tr_b16 a[164:165], v2 offset:50272
  v_mfma_f32_16x16x32_bf16 v[136:139], a[132:135], a[24:27], v[136:139]
  v_mfma_f32_16x16x32_bf16 v[140:143], a[132:135], a[28:31], 0
  ds_read_b64_tr_b16 a[166:167], v2 offset:53856
  v_mfma_f32_16x16x32_bf16 v[140:143], a[128:131], a[12:15], v[140:143]
  v_mfma_f32_16x16x32_bf16 v[156:159], a[136:139], a[12:15], 0
  buffer_load_dwordx4 a[60:63], v0, s[36:39], s57 offen offset:3072 sc1
  s_add_u32 m0, s84, 32768
  v_mfma_f32_16x16x32_bf16 v[156:159], a[140:143], a[28:31], v[156:159]
  ds_read_b64_tr_b16 a[168:169], v2 offset:43136
  v_mfma_f32_16x16x32_bf16 v[152:155], a[140:143], a[24:27], 0
  ds_read_b64_tr_b16 a[170:171], v2 offset:46720
  v_mfma_f32_16x16x32_bf16 v[152:155], a[136:139], a[8:11], v[152:155]
  v_mfma_f32_16x16x32_bf16 v[148:151], a[136:139], a[4:7], 0
  ds_read_b64_tr_b16 a[172:173], v2 offset:50304
  v_mfma_f32_16x16x32_bf16 v[148:151], a[140:143], a[20:23], v[148:151]
  buffer_load_dwordx4 v7, s[16:19], s56 offen offset:0 lds
  s_bfe_u32 s57, s82, 0x40008
  v_mfma_f32_16x16x32_bf16 v[144:147], a[140:143], a[16:19], 0
  s_lshl_b32 s57, s57, 13
  s_add_u32 s57, s57, s85
  ds_read_b64_tr_b16 a[174:175], v2 offset:53888
  v_mfma_f32_16x16x32_bf16 v[144:147], a[136:139], a[0:3], v[144:147]
  s_waitcnt lgkmcnt(8)
  v_mfma_f32_16x16x32_bf16 v[160:163], a[144:147], a[0:3], 0
  ds_read_b64_tr_b16 a[128:129], v2 offset:43168
  v_mfma_f32_16x16x32_bf16 v[160:163], a[148:151], a[16:19], v[160:163]
  s_waitcnt vmcnt(13)
  s_barrier
  v_mfma_f32_16x16x32_bf16 v[164:167], a[148:151], a[20:23], 0
  buffer_load_dwordx4 a[64:67], v0, s[36:39], s57 offen offset:0 sc1
  v_mfma_f32_16x16x32_bf16 v[164:167], a[144:147], a[4:7], v[164:167]
  s_mov_b64 exec, 1
  buffer_store_dword v12, v0, s[36:39], s45 offen sc1
  s_mov_b64 exec, -1
  v_mfma_f32_16x16x32_bf16 v[168:171], a[144:147], a[8:11], 0
  ds_read_b64_tr_b16 a[130:131], v2 offset:46752
  v_mfma_f32_16x16x32_bf16 v[168:171], a[148:151], a[24:27], v[168:171]
  ds_read_b64_tr_b16 a[132:133], v2 offset:50336
  v_mfma_f32_16x16x32_bf16 v[172:175], a[148:151], a[28:31], 0
  ds_read_b64_tr_b16 a[134:135], v2 offset:53920
  v_mfma_f32_16x16x32_bf16 v[172:175], a[144:147], a[12:15], v[172:175]
  s_waitcnt vmcnt(26)
  s_barrier
  buffer_load_dwordx4 v8, s[16:19], s56 offen offset:1024 lds
  v_mfma_f32_16x16x32_bf16 v[188:191], a[152:155], a[12:15], 0
  ds_read_b64_tr_b16 a[136:137], v2 offset:43200
  v_mfma_f32_16x16x32_bf16 v[188:191], a[156:159], a[28:31], v[188:191]
  v_mfma_f32_16x16x32_bf16 v[184:187], a[156:159], a[24:27], 0
  ds_read_b64_tr_b16 a[138:139], v2 offset:46784
  v_mfma_f32_16x16x32_bf16 v[184:187], a[152:155], a[8:11], v[184:187]
  v_mfma_f32_16x16x32_bf16 v[180:183], a[152:155], a[4:7], 0
  buffer_load_dwordx4 a[68:71], v0, s[36:39], s57 offen offset:1024 sc1
  v_mfma_f32_16x16x32_bf16 v[180:183], a[156:159], a[20:23], v[180:183]
  ds_read_b64_tr_b16 a[140:141], v2 offset:50368
  v_mfma_f32_16x16x32_bf16 v[176:179], a[156:159], a[16:19], 0
  ds_read_b64_tr_b16 a[142:143], v2 offset:53952
  v_mfma_f32_16x16x32_bf16 v[176:179], a[152:155], a[0:3], v[176:179]
  s_waitcnt lgkmcnt(8)
  v_mfma_f32_16x16x32_bf16 v[192:195], a[160:163], a[0:3], 0
  ds_read_b64_tr_b16 a[144:145], v1 offset:0
  v_mfma_f32_16x16x32_bf16 v[192:195], a[164:167], a[16:19], v[192:195]
  v_mfma_f32_16x16x32_bf16 v[196:199], a[164:167], a[20:23], 0
  ds_read_b64_tr_b16 a[146:147], v1 offset:3584
  v_mfma_f32_16x16x32_bf16 v[196:199], a[160:163], a[4:7], v[196:199]
  v_mfma_f32_16x16x32_bf16 v[200:203], a[160:163], a[8:11], 0
  ds_read_b64_tr_b16 a[148:149], v1 offset:7168
  v_mfma_f32_16x16x32_bf16 v[200:203], a[164:167], a[24:27], v[200:203]
  v_mfma_f32_16x16x32_bf16 v[204:207], a[164:167], a[28:31], 0
  buffer_load_dwordx4 v9, s[16:19], s56 offen offset:2048 lds
  v_mfma_f32_16x16x32_bf16 v[204:207], a[160:163], a[12:15], v[204:207]
  ds_read_b64_tr_b16 a[150:151], v1 offset:10752
  v_mfma_f32_16x16x32_bf16 v[220:223], a[168:171], a[12:15], 0
  ds_read_b64_tr_b16 a[152:153], v1 offset:32
  v_mfma_f32_16x16x32_bf16 v[220:223], a[172:175], a[28:31], v[220:223]
  v_mfma_f32_16x16x32_bf16 v[216:219], a[172:175], a[24:27], 0
  ds_read_b64_tr_b16 a[154:155], v1 offset:3616
  v_mfma_f32_16x16x32_bf16 v[216:219], a[168:171], a[8:11], v[216:219]
  buffer_load_dwordx4 a[72:75], v0, s[36:39], s57 offen offset:2048 sc1
  v_mfma_f32_16x16x32_bf16 v[212:215], a[168:171], a[4:7], 0
  ds_read_b64_tr_b16 a[156:157], v1 offset:7200
  v_mfma_f32_16x16x32_bf16 v[212:215], a[172:175], a[20:23], v[212:215]
  v_mfma_f32_16x16x32_bf16 v[208:211], a[172:175], a[16:19], 0
  ds_read_b64_tr_b16 a[158:159], v1 offset:10784
  v_mfma_f32_16x16x32_bf16 v[208:211], a[168:171], a[0:3], v[208:211]
  s_waitcnt lgkmcnt(8)
  v_mfma_f32_16x16x32_bf16 v[224:227], a[128:131], a[0:3], 0
  ds_read_b64_tr_b16 a[160:161], v1 offset:64
  v_mfma_f32_16x16x32_bf16 v[224:227], a[132:135], a[16:19], v[224:227]
  v_mfma_f32_16x16x32_bf16 v[228:231], a[132:135], a[20:23], 0
  ds_read_b64_tr_b16 a[162:163], v1 offset:3648
  v_mfma_f32_16x16x32_bf16 v[228:231], a[128:131], a[4:7], v[228:231]
  v_mfma_f32_16x16x32_bf16 v[232:235], a[128:131], a[8:11], 0
  ds_read_b64_tr_b16 a[164:165], v1 offset:7232
  v_mfma_f32_16x16x32_bf16 v[232:235], a[132:135], a[24:27], v[232:235]
  buffer_load_dwordx4 a[76:79], v0, s[36:39], s57 offen offset:3072 sc1
  v_mfma_f32_16x16x32_bf16 v[236:239], a[132:135], a[28:31], 0
  ds_read_b64_tr_b16 a[166:167], v1 offset:10816
  v_mfma_f32_16x16x32_bf16 v[236:239], a[128:131], a[12:15], v[236:239]
  v_mfma_f32_16x16x32_bf16 v[252:255], a[136:139], a[12:15], 0
  ds_read_b64_tr_b16 a[168:169], v1 offset:96
  v_mfma_f32_16x16x32_bf16 v[252:255], a[140:143], a[28:31], v[252:255]
  s_bfe_u32 s56, s82, 0x3000c
  s_lshl_b32 s56, s56, 2
  s_bitcmp1_b32 s82, 15
  v_mfma_f32_16x16x32_bf16 v[248:251], a[140:143], a[24:27], 0
  s_addc_u32 s56, s56, 0
  s_mul_i32 s56, s56, 229376
  s_add_u32 m0, s84, 57344
  v_mfma_f32_16x16x32_bf16 v[248:251], a[136:139], a[8:11], v[248:251]
  ds_read_b64_tr_b16 a[170:171], v1 offset:3680
  v_mfma_f32_16x16x32_bf16 v[244:247], a[136:139], a[4:7], 0
  ds_read_b64_tr_b16 a[172:173], v1 offset:7264
  v_mfma_f32_16x16x32_bf16 v[244:247], a[140:143], a[20:23], v[244:247]
  buffer_load_dwordx4 v3, s[16:19], s56 offen offset:0 lds
  v_mfma_f32_16x16x32_bf16 v[240:243], a[140:143], a[16:19], 0
  ds_read_b64_tr_b16 a[174:175], v1 offset:10848
  v_mfma_f32_16x16x32_bf16 v[240:243], a[136:139], a[0:3], v[240:243]
  s_waitcnt vmcnt(9) lgkmcnt(8)
  v_mfma_f32_16x16x32_bf16 v[32:35], a[144:147], a[32:35], v[32:35]
  s_add_u32 s57, s57, 4096
  ds_read_b64_tr_b16 a[128:129], v1 offset:128
  v_mfma_f32_16x16x32_bf16 v[32:35], a[148:151], a[48:51], v[32:35]
  v_mfma_f32_16x16x32_bf16 v[36:39], a[148:151], a[52:55], v[36:39]
  ds_read_b64_tr_b16 a[130:131], v1 offset:3712
  v_mfma_f32_16x16x32_bf16 v[36:39], a[144:147], a[36:39], v[36:39]
  v_mfma_f32_16x16x32_bf16 v[40:43], a[144:147], a[40:43], v[40:43]
  buffer_load_dwordx4 a[80:83], v0, s[36:39], s57 offen offset:0 sc1
  v_mfma_f32_16x16x32_bf16 v[40:43], a[148:151], a[56:59], v[40:43]
  ds_read_b64_tr_b16 a[132:133], v1 offset:7296
  v_mfma_f32_16x16x32_bf16 v[44:47], a[148:151], a[60:63], v[44:47]
  ds_read_b64_tr_b16 a[134:135], v1 offset:10880
  v_mfma_f32_16x16x32_bf16 v[44:47], a[144:147], a[44:47], v[44:47]
  v_mfma_f32_16x16x32_bf16 v[60:63], a[152:155], a[44:47], v[60:63]
  ds_read_b64_tr_b16 a[136:137], v1 offset:160
  v_mfma_f32_16x16x32_bf16 v[60:63], a[156:159], a[60:63], v[60:63]
  v_mfma_f32_16x16x32_bf16 v[56:59], a[156:159], a[56:59], v[56:59]
  ds_read_b64_tr_b16 a[138:139], v1 offset:3744
  v_mfma_f32_16x16x32_bf16 v[56:59], a[152:155], a[40:43], v[56:59]
  buffer_load_dwordx4 v4, s[16:19], s56 offen offset:1024 lds
  v_mfma_f32_16x16x32_bf16 v[52:55], a[152:155], a[36:39], v[52:55]
  ds_read_b64_tr_b16 a[140:141], v1 offset:7328
  v_mfma_f32_16x16x32_bf16 v[52:55], a[156:159], a[52:55], v[52:55]
  v_mfma_f32_16x16x32_bf16 v[48:51], a[156:159], a[48:51], v[48:51]
  ds_read_b64_tr_b16 a[142:143], v1 offset:10912
  v_mfma_f32_16x16x32_bf16 v[48:51], a[152:155], a[32:35], v[48:51]
  s_waitcnt lgkmcnt(8)
  v_mfma_f32_16x16x32_bf16 v[64:67], a[160:163], a[32:35], v[64:67]
  ds_read_b64_tr_b16 a[144:145], v1 offset:192
  v_mfma_f32_16x16x32_bf16 v[64:67], a[164:167], a[48:51], v[64:67]
  v_mfma_f32_16x16x32_bf16 v[68:71], a[164:167], a[52:55], v[68:71]
  ds_read_b64_tr_b16 a[146:147], v1 offset:3776
  v_mfma_f32_16x16x32_bf16 v[68:71], a[160:163], a[36:39], v[68:71]
  buffer_load_dwordx4 a[84:87], v0, s[36:39], s57 offen offset:1024 sc1
  v_mfma_f32_16x16x32_bf16 v[72:75], a[160:163], a[40:43], v[72:75]
  ds_read_b64_tr_b16 a[148:149], v1 offset:7360
  v_mfma_f32_16x16x32_bf16 v[72:75], a[164:167], a[56:59], v[72:75]
  v_mfma_f32_16x16x32_bf16 v[76:79], a[164:167], a[60:63], v[76:79]
  ds_read_b64_tr_b16 a[150:151], v1 offset:10944
  v_mfma_f32_16x16x32_bf16 v[76:79], a[160:163], a[44:47], v[76:79]
  v_mfma_f32_16x16x32_bf16 v[92:95], a[168:171], a[44:47], v[92:95]
  ds_read_b64_tr_b16 a[152:153], v1 offset:14336
  v_mfma_f32_16x16x32_bf16 v[92:95], a[172:175], a[60:63], v[92:95]
  v_mfma_f32_16x16x32_bf16 v[88:91], a[172:175], a[56:59], v[88:91]
  buffer_load_dwordx4 v5, s[16:19], s56 offen offset:2048 lds
  v_mfma_f32_16x16x32_bf16 v[88:91], a[168:171], a[40:43], v[88:91]
  ds_read_b64_tr_b16 a[154:155], v1 offset:17920
  v_mfma_f32_16x16x32_bf16 v[84:87], a[168:171], a[36:39], v[84:87]
  ds_read_b64_tr_b16 a[156:157], v1 offset:21504
  v_mfma_f32_16x16x32_bf16 v[84:87], a[172:175], a[52:55], v[84:87]
  v_mfma_f32_16x16x32_bf16 v[80:83], a[172:175], a[48:51], v[80:83]
  ds_read_b64_tr_b16 a[158:159], v1 offset:25088
  v_mfma_f32_16x16x32_bf16 v[80:83], a[168:171], a[32:35], v[80:83]
  s_waitcnt lgkmcnt(8)
  v_mfma_f32_16x16x32_bf16 v[96:99], a[128:131], a[32:35], v[96:99]
  ds_read_b64_tr_b16 a[160:161], v1 offset:14368
  v_mfma_f32_16x16x32_bf16 v[96:99], a[132:135], a[48:51], v[96:99]
  v_mfma_f32_16x16x32_bf16 v[100:103], a[132:135], a[52:55], v[100:103]
  buffer_load_dwordx4 a[88:91], v0, s[36:39], s57 offen offset:2048 sc1
  v_mfma_f32_16x16x32_bf16 v[100:103], a[128:131], a[36:39], v[100:103]
Hc0:
  s_cbranch_execz Hc0_1
  ds_read_b64_tr_b16 a[162:163], v1 offset:17952
  v_mfma_f32_16x16x32_bf16 v[104:107], a[128:131], a[40:43], v[104:107]
  ds_read_b64_tr_b16 a[164:165], v1 offset:21536
  v_mfma_f32_16x16x32_bf16 v[104:107], a[132:135], a[56:59], v[104:107]
  v_mfma_f32_16x16x32_bf16 v[108:111], a[132:135], a[60:63], v[108:111]
  ds_read_b64_tr_b16 a[166:167], v1 offset:25120
  v_mfma_f32_16x16x32_bf16 v[108:111], a[128:131], a[44:47], v[108:111]
  v_mfma_f32_16x16x32_bf16 v[124:127], a[136:139], a[44:47], v[124:127]
  ds_read_b64_tr_b16 a[168:169], v1 offset:14400
  v_mfma_f32_16x16x32_bf16 v[124:127], a[140:143], a[60:63], v[124:127]
  buffer_load_dwordx4 v6, s[16:19], s56 offen offset:3072 lds
  v_mfma_f32_16x16x32_bf16 v[120:123], a[140:143], a[56:59], v[120:123]
  ds_read_b64_tr_b16 a[170:171], v1 offset:17984
  v_mfma_f32_16x16x32_bf16 v[120:123], a[136:139], a[40:43], v[120:123]
  v_mfma_f32_16x16x32_bf16 v[116:119], a[136:139], a[36:39], v[116:119]
  ds_read_b64_tr_b16 a[172:173], v1 offset:21568
  v_mfma_f32_16x16x32_bf16 v[116:119], a[140:143], a[52:55], v[116:119]
  v_mfma_f32_16x16x32_bf16 v[112:115], a[140:143], a[48:51], v[112:115]
  ds_read_b64_tr_b16 a[174:175], v1 offset:25152
  v_mfma_f32_16x16x32_bf16 v[112:115], a[136:139], a[32:35], v[112:115]
  s_waitcnt lgkmcnt(8)
  v_mfma_f32_16x16x32_bf16 v[128:131], a[144:147], a[32:35], v[128:131]
  ds_read_b64_tr_b16 a[128:129], v1 offset:14432
  v_mfma_f32_16x16x32_bf16 v[128:131], a[148:151], a[48:51], v[128:131]
  buffer_load_dwordx4 a[92:95], v0, s[36:39], s57 offen offset:3072 sc1
  v_mfma_f32_16x16x32_bf16 v[132:135], a[148:151], a[52:55], v[132:135]
  ds_read_b64_tr_b16 a[130:131], v1 offset:18016
  v_mfma_f32_16x16x32_bf16 v[132:135], a[144:147], a[36:39], v[132:135]
  v_mfma_f32_16x16x32_bf16 v[136:139], a[144:147], a[40:43], v[136:139]
  s_add_u32 m0, s84, 61440
  ds_read_b64_tr_b16 a[132:133], v1 offset:21600
  v_mfma_f32_16x16x32_bf16 v[136:139], a[148:151], a[56:59], v[136:139]
  v_mfma_f32_16x16x32_bf16 v[140:143], a[148:151], a[60:63], v[140:143]
  ds_read_b64_tr_b16 a[134:135], v1 offset:25184
  v_mfma_f32_16x16x32_bf16 v[140:143], a[144:147], a[44:47], v[140:143]
  v_mfma_f32_16x16x32_bf16 v[156:159], a[152:155], a[44:47], v[156:159]
  buffer_load_dwordx4 v7, s[16:19], s56 offen offset:0 lds
  s_bfe_u32 s57, s82, 0x4000c
  v_mfma_f32_16x16x32_bf16 v[156:159], a[156:159], a[60:63], v[156:159]
  s_lshl_b32 s57, s57, 13
  s_add_u32 s57, s57, s85
  ds_read_b64_tr_b16 a[136:137], v1 offset:14464
  v_mfma_f32_16x16x32_bf16 v[152:155], a[156:159], a[56:59], v[152:155]
  ds_read_b64_tr_b16 a[138:139], v1 offset:18048
  v_mfma_f32_16x16x32_bf16 v[152:155], a[152:155], a[40:43], v[152:155]
  v_mfma_f32_16x16x32_bf16 v[148:151], a[152:155], a[36:39], v[148:151]
  ds_read_b64_tr_b16 a[140:141], v1 offset:21632
  v_mfma_f32_16x16x32_bf16 v[148:151], a[156:159], a[52:55], v[148:151]
  buffer_load_dwordx4 a[96:99], v0, s[36:39], s57 offen offset:0 sc1
  v_mfma_f32_16x16x32_bf16 v[144:147], a[156:159], a[48:51], v[144:147]
  ds_read_b64_tr_b16 a[142:143], v1 offset:25216
  v_mfma_f32_16x16x32_bf16 v[144:147], a[152:155], a[32:35], v[144:147]
  s_waitcnt lgkmcnt(8)
  v_mfma_f32_16x16x32_bf16 v[160:163], a[160:163], a[32:35], v[160:163]
  ds_read_b64_tr_b16 a[144:145], v1 offset:14496
  v_mfma_f32_16x16x32_bf16 v[160:163], a[164:167], a[48:51], v[160:163]
  v_mfma_f32_16x16x32_bf16 v[164:167], a[164:167], a[52:55], v[164:167]
  ds_read_b64_tr_b16 a[146:147], v1 offset:18080
  v_mfma_f32_16x16x32_bf16 v[164:167], a[160:163], a[36:39], v[164:167]
  v_mfma_f32_16x16x32_bf16 v[168:171], a[160:163], a[40:43], v[168:171]
  ds_read_b64_tr_b16 a[148:149], v1 offset:21664
  v_mfma_f32_16x16x32_bf16 v[168:171], a[164:167], a[56:59], v[168:171]
  v_mfma_f32_16x16x32_bf16 v[172:175], a[164:167], a[60:63], v[172:175]
  ds_read_b64_tr_b16 a[150:151], v1 offset:25248
  v_mfma_f32_16x16x32_bf16 v[172:175], a[160:163], a[44:47], v[172:175]
  s_waitcnt vmcnt(12)
  s_barrier
  buffer_load_dwordx4 v8, s[16:19], s56 offen offset:1024 lds
  v_mfma_f32_16x16x32_bf16 v[188:191], a[168:171], a[44:47], v[188:191]
  ds_read_b64_tr_b16 a[152:153], v1 offset:14528
  v_mfma_f32_16x16x32_bf16 v[188:191], a[172:175], a[60:63], v[188:191]
  v_mfma_f32_16x16x32_bf16 v[184:187], a[172:175], a[56:59], v[184:187]
  ds_read_b64_tr_b16 a[154:155], v1 offset:18112
  v_mfma_f32_16x16x32_bf16 v[184:187], a[168:171], a[40:43], v[184:187]
  v_mfma_f32_16x16x32_bf16 v[180:183], a[168:171], a[36:39], v[180:183]
  buffer_load_dwordx4 a[100:103], v0, s[36:39], s57 offen offset:1024 sc1
  v_mfma_f32_16x16x32_bf16 v[180:183], a[172:175], a[52:55], v[180:183]
  ds_read_b64_tr_b16 a[156:157], v1 offset:21696
  v_mfma_f32_16x16x32_bf16 v[176:179], a[172:175], a[48:51], v[176:179]
  ds_read_b64_tr_b16 a[158:159], v1 offset:25280
  v_mfma_f32_16x16x32_bf16 v[176:179], a[168:171], a[32:35], v[176:179]
  s_waitcnt lgkmcnt(8)
  v_mfma_f32_16x16x32_bf16 v[192:195], a[128:131], a[32:35], v[192:195]
  ds_read_b64_tr_b16 a[160:161], v1 offset:28672
  v_mfma_f32_16x16x32_bf16 v[192:195], a[132:135], a[48:51], v[192:195]
  v_mfma_f32_16x16x32_bf16 v[196:199], a[132:135], a[52:55], v[196:199]
  ds_read_b64_tr_b16 a[162:163], v1 offset:32256
  v_mfma_f32_16x16x32_bf16 v[196:199], a[128:131], a[36:39], v[196:199]
  v_mfma_f32_16x16x32_bf16 v[200:203], a[128:131], a[40:43], v[200:203]
  ds_read_b64_tr_b16 a[164:165], v1 offset:35840
  v_mfma_f32_16x16x32_bf16 v[200:203], a[132:135], a[56:59], v[200:203]
  v_mfma_f32_16x16x32_bf16 v[204:207], a[132:135], a[60:63], v[204:207]
  buffer_load_dwordx4 v9, s[16:19], s56 offen offset:2048 lds
  v_mfma_f32_16x16x32_bf16 v[204:207], a[128:131], a[44:47], v[204:207]
  ds_read_b64_tr_b16 a[166:167], v1 offset:39424
  v_mfma_f32_16x16x32_bf16 v[220:223], a[136:139], a[44:47], v[220:223]
  ds_read_b64_tr_b16 a[168:169], v1 offset:28704
  v_mfma_f32_16x16x32_bf16 v[220:223], a[140:143], a[60:63], v[220:223]
  v_mfma_f32_16x16x32_bf16 v[216:219], a[140:143], a[56:59], v[216:219]
  ds_read_b64_tr_b16 a[170:171], v1 offset:32288
  v_mfma_f32_16x16x32_bf16 v[216:219], a[136:139], a[40:43], v[216:219]
  buffer_load_dwordx4 a[104:107], v0, s[36:39], s57 offen offset:2048 sc1
  v_mfma_f32_16x16x32_bf16 v[212:215], a[136:139], a[36:39], v[212:215]
  ds_read_b64_tr_b16 a[172:173], v1 offset:35872
  v_mfma_f32_16x16x32_bf16 v[212:215], a[140:143], a[52:55], v[212:215]
  v_mfma_f32_16x16x32_bf16 v[208:211], a[140:143], a[48:51], v[208:211]
  ds_read_b64_tr_b16 a[174:175], v1 offset:39456
  v_mfma_f32_16x16x32_bf16 v[208:211], a[136:139], a[32:35], v[208:211]
  s_waitcnt lgkmcnt(8)
  v_mfma_f32_16x16x32_bf16 v[224:227], a[144:147], a[32:35], v[224:227]
  ds_read_b64_tr_b16 a[128:129], v1 offset:28736
  v_mfma_f32_16x16x32_bf16 v[224:227], a[148:151], a[48:51], v[224:227]
  v_mfma_f32_16x16x32_bf16 v[228:231], a[148:151], a[52:55], v[228:231]
  ds_read_b64_tr_b16 a[130:131], v1 offset:32320
  v_mfma_f32_16x16x32_bf16 v[228:231], a[144:147], a[36:39], v[228:231]
  v_mfma_f32_16x16x32_bf16 v[232:235], a[144:147], a[40:43], v[232:235]
  ds_read_b64_tr_b16 a[132:133], v1 offset:35904
  v_mfma_f32_16x16x32_bf16 v[232:235], a[148:151], a[56:59], v[232:235]
  buffer_load_dwordx4 a[108:111], v0, s[36:39], s57 offen offset:3072 sc1
  v_mfma_f32_16x16x32_bf16 v[236:239], a[148:151], a[60:63], v[236:239]
  ds_read_b64_tr_b16 a[134:135], v1 offset:39488
  v_mfma_f32_16x16x32_bf16 v[236:239], a[144:147], a[44:47], v[236:239]
  v_mfma_f32_16x16x32_bf16 v[252:255], a[152:155], a[44:47], v[252:255]
  ds_read_b64_tr_b16 a[136:137], v1 offset:28768
  v_mfma_f32_16x16x32_bf16 v[252:255], a[156:159], a[60:63], v[252:255]
  s_bfe_u32 s56, s82, 0x30010
  s_lshl_b32 s56, s56, 2
  s_bitcmp1_b32 s82, 19
  v_mfma_f32_16x16x32_bf16 v[248:251], a[156:159], a[56:59], v[248:251]
  s_addc_u32 s56, s56, 0
  s_mul_i32 s56, s56, 229376
  s_add_u32 m0, s84, 86016
  v_mfma_f32_16x16x32_bf16 v[248:251], a[152:155], a[40:43], v[248:251]
  ds_read_b64_tr_b16 a[138:139], v1 offset:32352
  v_mfma_f32_16x16x32_bf16 v[244:247], a[152:155], a[36:39], v[244:247]
  ds_read_b64_tr_b16 a[140:141], v1 offset:35936
  v_mfma_f32_16x16x32_bf16 v[244:247], a[156:159], a[52:55], v[244:247]
  buffer_load_dwordx4 v3, s[16:19], s56 offen offset:0 lds
  v_mfma_f32_16x16x32_bf16 v[240:243], a[156:159], a[48:51], v[240:243]
  ds_read_b64_tr_b16 a[142:143], v1 offset:39520
  v_mfma_f32_16x16x32_bf16 v[240:243], a[152:155], a[32:35], v[240:243]
  s_waitcnt vmcnt(8) lgkmcnt(8)
  v_mfma_f32_16x16x32_bf16 v[32:35], a[160:163], a[64:67], v[32:35]
  s_add_u32 s57, s57, 4096
  ds_read_b64_tr_b16 a[144:145], v1 offset:28800
  v_mfma_f32_16x16x32_bf16 v[32:35], a[164:167], a[80:83], v[32:35]
  v_mfma_f32_16x16x32_bf16 v[36:39], a[164:167], a[84:87], v[36:39]
  ds_read_b64_tr_b16 a[146:147], v1 offset:32384
  v_mfma_f32_16x16x32_bf16 v[36:39], a[160:163], a[68:71], v[36:39]
  v_mfma_f32_16x16x32_bf16 v[40:43], a[160:163], a[72:75], v[40:43]
  buffer_load_dwordx4 a[112:115], v0, s[36:39], s57 offen offset:0 sc1
  v_mfma_f32_16x16x32_bf16 v[40:43], a[164:167], a[88:91], v[40:43]
  ds_read_b64_tr_b16 a[148:149], v1 offset:35968
  v_mfma_f32_16x16x32_bf16 v[44:47], a[164:167], a[92:95], v[44:47]
  ds_read_b64_tr_b16 a[150:151], v1 offset:39552
  v_mfma_f32_16x16x32_bf16 v[44:47], a[160:163], a[76:79], v[44:47]
  v_mfma_f32_16x16x32_bf16 v[60:63], a[168:171], a[76:79], v[60:63]
  ds_read_b64_tr_b16 a[152:153], v1 offset:28832
  v_mfma_f32_16x16x32_bf16 v[60:63], a[172:175], a[92:95], v[60:63]
  v_mfma_f32_16x16x32_bf16 v[56:59], a[172:175], a[88:91], v[56:59]
  ds_read_b64_tr_b16 a[154:155], v1 offset:32416
  v_mfma_f32_16x16x32_bf16 v[56:59], a[168:171], a[72:75], v[56:59]
  buffer_load_dwordx4 v4, s[16:19], s56 offen offset:1024 lds
  v_mfma_f32_16x16x32_bf16 v[52:55], a[168:171], a[68:71], v[52:55]
  ds_read_b64_tr_b16 a[156:157], v1 offset:36000
  v_mfma_f32_16x16x32_bf16 v[52:55], a[172:175], a[84:87], v[52:55]
  v_mfma_f32_16x16x32_bf16 v[48:51], a[172:175], a[80:83], v[48:51]
  ds_read_b64_tr_b16 a[158:159], v1 offset:39584
  v_mfma_f32_16x16x32_bf16 v[48:51], a[168:171], a[64:67], v[48:51]
  s_waitcnt lgkmcnt(8)
  v_mfma_f32_16x16x32_bf16 v[64:67], a[128:131], a[64:67], v[64:67]
  ds_read_b64_tr_b16 a[160:161], v1 offset:28864
  v_mfma_f32_16x16x32_bf16 v[64:67], a[132:135], a[80:83], v[64:67]
  v_mfma_f32_16x16x32_bf16 v[68:71], a[132:135], a[84:87], v[68:71]
  ds_read_b64_tr_b16 a[162:163], v1 offset:32448
  v_mfma_f32_16x16x32_bf16 v[68:71], a[128:131], a[68:71], v[68:71]
  buffer_load_dwordx4 a[116:119], v0, s[36:39], s57 offen offset:1024 sc1
  v_mfma_f32_16x16x32_bf16 v[72:75], a[128:131], a[72:75], v[72:75]
  ds_read_b64_tr_b16 a[164:165], v1 offset:36032
  v_mfma_f32_16x16x32_bf16 v[72:75], a[132:135], a[88:91], v[72:75]
  v_mfma_f32_16x16x32_bf16 v[76:79], a[132:135], a[92:95], v[76:79]
  ds_read_b64_tr_b16 a[166:167], v1 offset:39616
  v_mfma_f32_16x16x32_bf16 v[76:79], a[128:131], a[76:79], v[76:79]
  v_mfma_f32_16x16x32_bf16 v[92:95], a[136:139], a[76:79], v[92:95]
  ds_read_b64_tr_b16 a[168:169], v1 offset:43008
  v_mfma_f32_16x16x32_bf16 v[92:95], a[140:143], a[92:95], v[92:95]
  v_mfma_f32_16x16x32_bf16 v[88:91], a[140:143], a[88:91], v[88:91]
  buffer_load_dwordx4 v5, s[16:19], s56 offen offset:2048 lds
  v_mfma_f32_16x16x32_bf16 v[88:91], a[136:139], a[72:75], v[88:91]
  ds_read_b64_tr_b16 a[170:171], v1 offset:46592
  v_mfma_f32_16x16x32_bf16 v[84:87], a[136:139], a[68:71], v[84:87]
  ds_read_b64_tr_b16 a[172:173], v1 offset:50176
  v_mfma_f32_16x16x32_bf16 v[84:87], a[140:143], a[84:87], v[84:87]
  v_mfma_f32_16x16x32_bf16 v[80:83], a[140:143], a[80:83], v[80:83]
  ds_read_b64_tr_b16 a[174:175], v1 offset:53760
  v_mfma_f32_16x16x32_bf16 v[80:83], a[136:139], a[64:67], v[80:83]
  s_waitcnt lgkmcnt(8)
  v_mfma_f32_16x16x32_bf16 v[96:99], a[144:147], a[64:67], v[96:99]
  ds_read_b64_tr_b16 a[128:129], v1 offset:43040
  v_mfma_f32_16x16x32_bf16 v[96:99], a[148:151], a[80:83], v[96:99]
  v_mfma_f32_16x16x32_bf16 v[100:103], a[148:151], a[84:87], v[100:103]
  buffer_load_dwordx4 a[120:123], v0, s[36:39], s57 offen offset:2048 sc1
  v_mfma_f32_16x16x32_bf16 v[100:103], a[144:147], a[68:71], v[100:103]
  ds_read_b64_tr_b16 a[130:131], v1 offset:46624
  v_mfma_f32_16x16x32_bf16 v[104:107], a[144:147], a[72:75], v[104:107]
  ds_read_b64_tr_b16 a[132:133], v1 offset:50208
  v_mfma_f32_16x16x32_bf16 v[104:107], a[148:151], a[88:91], v[104:107]
  v_mfma_f32_16x16x32_bf16 v[108:111], a[148:151], a[92:95], v[108:111]
  ds_read_b64_tr_b16 a[134:135], v1 offset:53792
  v_mfma_f32_16x16x32_bf16 v[108:111], a[144:147], a[76:79], v[108:111]
  v_mfma_f32_16x16x32_bf16 v[124:127], a[152:155], a[76:79], v[124:127]
  ds_read_b64_tr_b16 a[136:137], v1 offset:43072
  v_mfma_f32_16x16x32_bf16 v[124:127], a[156:159], a[92:95], v[124:127]
  buffer_load_dwordx4 v6, s[16:19], s56 offen offset:3072 lds
  v_mfma_f32_16x16x32_bf16 v[120:123], a[156:159], a[88:91], v[120:123]
  ds_read_b64_tr_b16 a[138:139], v1 offset:46656
  v_mfma_f32_16x16x32_bf16 v[120:123], a[152:155], a[72:75], v[120:123]
  v_mfma_f32_16x16x32_bf16 v[116:119], a[152:155], a[68:71], v[116:119]
  ds_read_b64_tr_b16 a[140:141], v1 offset:50240
  v_mfma_f32_16x16x32_bf16 v[116:119], a[156:159], a[84:87], v[116:119]
  v_mfma_f32_16x16x32_bf16 v[112:115], a[156:159], a[80:83], v[112:115]
  ds_read_b64_tr_b16 a[142:143], v1 offset:53824
  v_mfma_f32_16x16x32_bf16 v[112:115], a[152:155], a[64:67], v[112:115]
  s_waitcnt lgkmcnt(8)
  v_mfma_f32_16x16x32_bf16 v[128:131], a[160:163], a[64:67], v[128:131]
  ds_read_b64_tr_b16 a[144:145], v1 offset:43104
  v_mfma_f32_16x16x32_bf16 v[128:131], a[164:167], a[80:83], v[128:131]
  buffer_load_dwordx4 a[124:127], v0, s[36:39], s57 offen offset:3072 sc1
  v_mfma_f32_16x16x32_bf16 v[132:135], a[164:167], a[84:87], v[132:135]
  ds_read_b64_tr_b16 a[146:147], v1 offset:46688
  v_mfma_f32_16x16x32_bf16 v[132:135], a[160:163], a[68:71], v[132:135]
  v_mfma_f32_16x16x32_bf16 v[136:139], a[160:163], a[72:75], v[136:139]
  s_add_u32 m0, s84, 90112
  ds_read_b64_tr_b16 a[148:149], v1 offset:50272
  v_mfma_f32_16x16x32_bf16 v[136:139], a[164:167], a[88:91], v[136:139]
  v_mfma_f32_16x16x32_bf16 v[140:143], a[164:167], a[92:95], v[140:143]
  ds_read_b64_tr_b16 a[150:151], v1 offset:53856
  v_mfma_f32_16x16x32_bf16 v[140:143], a[160:163], a[76:79], v[140:143]
  v_mfma_f32_16x16x32_bf16 v[156:159], a[168:171], a[76:79], v[156:159]
  buffer_load_dwordx4 v7, s[16:19], s56 offen offset:0 lds
  s_bfe_u32 s57, s82, 0x40010
  v_mfma_f32_16x16x32_bf16 v[156:159], a[172:175], a[92:95], v[156:159]
  s_lshl_b32 s57, s57, 13
  s_add_u32 s57, s57, s85
  ds_read_b64_tr_b16 a[152:153], v1 offset:43136
  v_mfma_f32_16x16x32_bf16 v[152:155], a[172:175], a[88:91], v[152:155]
  ds_read_b64_tr_b16 a[154:155], v1 offset:46720
  v_mfma_f32_16x16x32_bf16 v[152:155], a[168:171], a[72:75], v[152:155]
  v_mfma_f32_16x16x32_bf16 v[148:151], a[168:171], a[68:71], v[148:151]
  ds_read_b64_tr_b16 a[156:157], v1 offset:50304
  v_mfma_f32_16x16x32_bf16 v[148:151], a[172:175], a[84:87], v[148:151]
  buffer_load_dwordx4 a[0:3], v0, s[36:39], s57 offen offset:0 sc1
  v_mfma_f32_16x16x32_bf16 v[144:147], a[172:175], a[80:83], v[144:147]
  ds_read_b64_tr_b16 a[158:159], v1 offset:53888
  v_mfma_f32_16x16x32_bf16 v[144:147], a[168:171], a[64:67], v[144:147]
  s_waitcnt lgkmcnt(8)
  v_mfma_f32_16x16x32_bf16 v[160:163], a[128:131], a[64:67], v[160:163]
  ds_read_b64_tr_b16 a[160:161], v1 offset:43168
  v_mfma_f32_16x16x32_bf16 v[160:163], a[132:135], a[80:83], v[160:163]
  v_mfma_f32_16x16x32_bf16 v[164:167], a[132:135], a[84:87], v[164:167]
  ds_read_b64_tr_b16 a[162:163], v1 offset:46752
  v_mfma_f32_16x16x32_bf16 v[164:167], a[128:131], a[68:71], v[164:167]
  v_mfma_f32_16x16x32_bf16 v[168:171], a[128:131], a[72:75], v[168:171]
  ds_read_b64_tr_b16 a[164:165], v1 offset:50336
  v_mfma_f32_16x16x32_bf16 v[168:171], a[132:135], a[88:91], v[168:171]
  v_mfma_f32_16x16x32_bf16 v[172:175], a[132:135], a[92:95], v[172:175]
  ds_read_b64_tr_b16 a[166:167], v1 offset:53920
  v_mfma_f32_16x16x32_bf16 v[172:175], a[128:131], a[76:79], v[172:175]
  s_waitcnt vmcnt(12)
  s_barrier
  buffer_load_dwordx4 v8, s[16:19], s56 offen offset:1024 lds
  v_mfma_f32_16x16x32_bf16 v[188:191], a[136:139], a[76:79], v[188:191]
  ds_read_b64_tr_b16 a[168:169], v1 offset:43200
  v_mfma_f32_16x16x32_bf16 v[188:191], a[140:143], a[92:95], v[188:191]
  v_mfma_f32_16x16x32_bf16 v[184:187], a[140:143], a[88:91], v[184:187]
  ds_read_b64_tr_b16 a[170:171], v1 offset:46784
  v_mfma_f32_16x16x32_bf16 v[184:187], a[136:139], a[72:75], v[184:187]
  v_mfma_f32_16x16x32_bf16 v[180:183], a[136:139], a[68:71], v[180:183]
  buffer_load_dwordx4 a[4:7], v0, s[36:39], s57 offen offset:1024 sc1
  v_mfma_f32_16x16x32_bf16 v[180:183], a[140:143], a[84:87], v[180:183]
  ds_read_b64_tr_b16 a[172:173], v1 offset:50368
  v_mfma_f32_16x16x32_bf16 v[176:179], a[140:143], a[80:83], v[176:179]
  ds_read_b64_tr_b16 a[174:175], v1 offset:53952
  v_mfma_f32_16x16x32_bf16 v[176:179], a[136:139], a[64:67], v[176:179]
  s_waitcnt lgkmcnt(8)
  v_mfma_f32_16x16x32_bf16 v[192:195], a[144:147], a[64:67], v[192:195]
  ds_read_b64_tr_b16 a[128:129], v2 offset:0
  v_mfma_f32_16x16x32_bf16 v[192:195], a[148:151], a[80:83], v[192:195]
  v_mfma_f32_16x16x32_bf16 v[196:199], a[148:151], a[84:87], v[196:199]
  ds_read_b64_tr_b16 a[130:131], v2 offset:3584
  v_mfma_f32_16x16x32_bf16 v[196:199], a[144:147], a[68:71], v[196:199]
  v_mfma_f32_16x16x32_bf16 v[200:203], a[144:147], a[72:75], v[200:203]
  ds_read_b64_tr_b16 a[132:133], v2 offset:7168
  v_mfma_f32_16x16x32_bf16 v[200:203], a[148:151], a[88:91], v[200:203]
  v_mfma_f32_16x16x32_bf16 v[204:207], a[148:151], a[92:95], v[204:207]
  buffer_load_dwordx4 v9, s[16:19], s56 offen offset:2048 lds
  v_mfma_f32_16x16x32_bf16 v[204:207], a[144:147], a[76:79], v[204:207]
  ds_read_b64_tr_b16 a[134:135], v2 offset:10752
  v_mfma_f32_16x16x32_bf16 v[220:223], a[152:155], a[76:79], v[220:223]
  ds_read_b64_tr_b16 a[136:137], v2 offset:32
  v_mfma_f32_16x16x32_bf16 v[220:223], a[156:159], a[92:95], v[220:223]
  v_mfma_f32_16x16x32_bf16 v[216:219], a[156:159], a[88:91], v[216:219]
  ds_read_b64_tr_b16 a[138:139], v2 offset:3616
  v_mfma_f32_16x16x32_bf16 v[216:219], a[152:155], a[72:75], v[216:219]
  buffer_load_dwordx4 a[8:11], v0, s[36:39], s57 offen offset:2048 sc1
  v_mfma_f32_16x16x32_bf16 v[212:215], a[152:155], a[68:71], v[212:215]
  ds_read_b64_tr_b16 a[140:141], v2 offset:7200
  v_mfma_f32_16x16x32_bf16 v[212:215], a[156:159], a[84:87], v[212:215]
  v_mfma_f32_16x16x32_bf16 v[208:211], a[156:159], a[80:83], v[208:211]
  ds_read_b64_tr_b16 a[142:143], v2 offset:10784
  v_mfma_f32_16x16x32_bf16 v[208:211], a[152:155], a[64:67], v[208:211]
  s_waitcnt lgkmcnt(8)
  v_mfma_f32_16x16x32_bf16 v[224:227], a[160:163], a[64:67], v[224:227]
  buffer_load_dword v29, v30, s[36:39], s68 offen sc1
  v_mfma_f32_16x16x32_bf16 v[224:227], a[164:167], a[80:83], v[224:227]
  ds_read_b64_tr_b16 a[144:145], v2 offset:64
  v_mfma_f32_16x16x32_bf16 v[228:231], a[164:167], a[84:87], v[228:231]
  ds_read_b64_tr_b16 a[146:147], v2 offset:3648
  v_mfma_f32_16x16x32_bf16 v[228:231], a[160:163], a[68:71], v[228:231]
  v_mfma_f32_16x16x32_bf16 v[232:235], a[160:163], a[72:75], v[232:235]
  ds_read_b64_tr_b16 a[148:149], v2 offset:7232
  v_mfma_f32_16x16x32_bf16 v[232:235], a[164:167], a[88:91], v[232:235]
  buffer_load_dwordx4 a[12:15], v0, s[36:39], s57 offen offset:3072 sc1
  v_mfma_f32_16x16x32_bf16 v[236:239], a[164:167], a[92:95], v[236:239]
  ds_read_b64_tr_b16 a[150:151], v2 offset:10816
  v_mfma_f32_16x16x32_bf16 v[236:239], a[160:163], a[76:79], v[236:239]
  v_mfma_f32_16x16x32_bf16 v[252:255], a[168:171], a[76:79], v[252:255]
  ds_read_b64_tr_b16 a[152:153], v2 offset:96
  v_mfma_f32_16x16x32_bf16 v[252:255], a[172:175], a[92:95], v[252:255]
  s_bfe_u32 s56, s82, 0x30014
  s_lshl_b32 s56, s56, 2
  s_bitcmp1_b32 s82, 23
  v_mfma_f32_16x16x32_bf16 v[248:251], a[172:175], a[88:91], v[248:251]
  s_addc_u32 s56, s56, 0
  s_mul_i32 s56, s56, 229376
  s_add_u32 m0, s84, 0
  v_mfma_f32_16x16x32_bf16 v[248:251], a[168:171], a[72:75], v[248:251]
  ds_read_b64_tr_b16 a[154:155], v2 offset:3680
  v_mfma_f32_16x16x32_bf16 v[244:247], a[168:171], a[68:71], v[244:247]
  ds_read_b64_tr_b16 a[156:157], v2 offset:7264
  v_mfma_f32_16x16x32_bf16 v[244:247], a[172:175], a[84:87], v[244:247]
  buffer_load_dwordx4 v3, s[16:19], s56 offen offset:0 lds
  v_mfma_f32_16x16x32_bf16 v[240:243], a[172:175], a[80:83], v[240:243]
  ds_read_b64_tr_b16 a[158:159], v2 offset:10848
  v_mfma_f32_16x16x32_bf16 v[240:243], a[168:171], a[64:67], v[240:243]
  s_waitcnt vmcnt(9) lgkmcnt(8)
  v_mfma_f32_16x16x32_bf16 v[32:35], a[128:131], a[96:99], v[32:35]
  s_add_u32 s57, s57, 4096
  ds_read_b64_tr_b16 a[160:161], v2 offset:128
  v_mfma_f32_16x16x32_bf16 v[32:35], a[132:135], a[112:115], v[32:35]
  v_mfma_f32_16x16x32_bf16 v[36:39], a[132:135], a[116:119], v[36:39]
  ds_read_b64_tr_b16 a[162:163], v2 offset:3712
  v_mfma_f32_16x16x32_bf16 v[36:39], a[128:131], a[100:103], v[36:39]
  v_mfma_f32_16x16x32_bf16 v[40:43], a[128:131], a[104:107], v[40:43]
  buffer_load_dwordx4 a[16:19], v0, s[36:39], s57 offen offset:0 sc1
  v_mfma_f32_16x16x32_bf16 v[40:43], a[132:135], a[120:123], v[40:43]
  ds_read_b64_tr_b16 a[164:165], v2 offset:7296
  v_mfma_f32_16x16x32_bf16 v[44:47], a[132:135], a[124:127], v[44:47]
  ds_read_b64_tr_b16 a[166:167], v2 offset:10880
  v_mfma_f32_16x16x32_bf16 v[44:47], a[128:131], a[108:111], v[44:47]
  v_mfma_f32_16x16x32_bf16 v[60:63], a[136:139], a[108:111], v[60:63]
  ds_read_b64_tr_b16 a[168:169], v2 offset:160
  v_mfma_f32_16x16x32_bf16 v[60:63], a[140:143], a[124:127], v[60:63]
  v_mfma_f32_16x16x32_bf16 v[56:59], a[140:143], a[120:123], v[56:59]
  ds_read_b64_tr_b16 a[170:171], v2 offset:3744
  v_mfma_f32_16x16x32_bf16 v[56:59], a[136:139], a[104:107], v[56:59]
  buffer_load_dwordx4 v4, s[16:19], s56 offen offset:1024 lds
  v_mfma_f32_16x16x32_bf16 v[52:55], a[136:139], a[100:103], v[52:55]
  ds_read_b64_tr_b16 a[172:173], v2 offset:7328
  v_mfma_f32_16x16x32_bf16 v[52:55], a[140:143], a[116:119], v[52:55]
  v_mfma_f32_16x16x32_bf16 v[48:51], a[140:143], a[112:115], v[48:51]
  ds_read_b64_tr_b16 a[174:175], v2 offset:10912
  v_mfma_f32_16x16x32_bf16 v[48:51], a[136:139], a[96:99], v[48:51]
  s_waitcnt lgkmcnt(8)
  v_mfma_f32_16x16x32_bf16 v[64:67], a[144:147], a[96:99], v[64:67]
  ds_read_b64_tr_b16 a[128:129], v2 offset:192
  v_mfma_f32_16x16x32_bf16 v[64:67], a[148:151], a[112:115], v[64:67]
  v_mfma_f32_16x16x32_bf16 v[68:71], a[148:151], a[116:119], v[68:71]
  ds_read_b64_tr_b16 a[130:131], v2 offset:3776
  v_mfma_f32_16x16x32_bf16 v[68:71], a[144:147], a[100:103], v[68:71]
  buffer_load_dwordx4 a[20:23], v0, s[36:39], s57 offen offset:1024 sc1
  v_mfma_f32_16x16x32_bf16 v[72:75], a[144:147], a[104:107], v[72:75]
  ds_read_b64_tr_b16 a[132:133], v2 offset:7360
  v_mfma_f32_16x16x32_bf16 v[72:75], a[148:151], a[120:123], v[72:75]
  v_mfma_f32_16x16x32_bf16 v[76:79], a[148:151], a[124:127], v[76:79]
  ds_read_b64_tr_b16 a[134:135], v2 offset:10944
  v_mfma_f32_16x16x32_bf16 v[76:79], a[144:147], a[108:111], v[76:79]
  v_mfma_f32_16x16x32_bf16 v[92:95], a[152:155], a[108:111], v[92:95]
  ds_read_b64_tr_b16 a[136:137], v2 offset:14336
  v_mfma_f32_16x16x32_bf16 v[92:95], a[156:159], a[124:127], v[92:95]
  v_mfma_f32_16x16x32_bf16 v[88:91], a[156:159], a[120:123], v[88:91]
  buffer_load_dwordx4 v5, s[16:19], s56 offen offset:2048 lds
  v_mfma_f32_16x16x32_bf16 v[88:91], a[152:155], a[104:107], v[88:91]
  ds_read_b64_tr_b16 a[138:139], v2 offset:17920
  v_mfma_f32_16x16x32_bf16 v[84:87], a[152:155], a[100:103], v[84:87]
  ds_read_b64_tr_b16 a[140:141], v2 offset:21504
  v_mfma_f32_16x16x32_bf16 v[84:87], a[156:159], a[116:119], v[84:87]
  v_mfma_f32_16x16x32_bf16 v[80:83], a[156:159], a[112:115], v[80:83]
  ds_read_b64_tr_b16 a[142:143], v2 offset:25088
  v_mfma_f32_16x16x32_bf16 v[80:83], a[152:155], a[96:99], v[80:83]
  s_waitcnt lgkmcnt(8)
  v_mfma_f32_16x16x32_bf16 v[96:99], a[160:163], a[96:99], v[96:99]
  ds_read_b64_tr_b16 a[144:145], v2 offset:14368
  v_mfma_f32_16x16x32_bf16 v[96:99], a[164:167], a[112:115], v[96:99]
  v_mfma_f32_16x16x32_bf16 v[100:103], a[164:167], a[116:119], v[100:103]
  buffer_load_dwordx4 a[24:27], v0, s[36:39], s57 offen offset:2048 sc1
  v_mfma_f32_16x16x32_bf16 v[100:103], a[160:163], a[100:103], v[100:103]
  ds_read_b64_tr_b16 a[146:147], v2 offset:17952
  v_mfma_f32_16x16x32_bf16 v[104:107], a[160:163], a[104:107], v[104:107]
  ds_read_b64_tr_b16 a[148:149], v2 offset:21536
  v_mfma_f32_16x16x32_bf16 v[104:107], a[164:167], a[120:123], v[104:107]
  v_mfma_f32_16x16x32_bf16 v[108:111], a[164:167], a[124:127], v[108:111]
  ds_read_b64_tr_b16 a[150:151], v2 offset:25120
  v_mfma_f32_16x16x32_bf16 v[108:111], a[160:163], a[108:111], v[108:111]
  v_mfma_f32_16x16x32_bf16 v[124:127], a[168:171], a[108:111], v[124:127]
  ds_read_b64_tr_b16 a[152:153], v2 offset:14400
  v_mfma_f32_16x16x32_bf16 v[124:127], a[172:175], a[124:127], v[124:127]
  buffer_load_dwordx4 v6, s[16:19], s56 offen offset:3072 lds
  v_mfma_f32_16x16x32_bf16 v[120:123], a[172:175], a[120:123], v[120:123]
  ds_read_b64_tr_b16 a[154:155], v2 offset:17984
  v_mfma_f32_16x16x32_bf16 v[120:123], a[168:171], a[104:107], v[120:123]
  v_mfma_f32_16x16x32_bf16 v[116:119], a[168:171], a[100:103], v[116:119]
  ds_read_b64_tr_b16 a[156:157], v2 offset:21568
  v_mfma_f32_16x16x32_bf16 v[116:119], a[172:175], a[116:119], v[116:119]
  v_mfma_f32_16x16x32_bf16 v[112:115], a[172:175], a[112:115], v[112:115]
  ds_read_b64_tr_b16 a[158:159], v2 offset:25152
  v_mfma_f32_16x16x32_bf16 v[112:115], a[168:171], a[96:99], v[112:115]
  s_waitcnt lgkmcnt(8)
  v_mfma_f32_16x16x32_bf16 v[128:131], a[128:131], a[96:99], v[128:131]
  ds_read_b64_tr_b16 a[160:161], v2 offset:14432
  v_mfma_f32_16x16x32_bf16 v[128:131], a[132:135], a[112:115], v[128:131]
  buffer_load_dwordx4 a[28:31], v0, s[36:39], s57 offen offset:3072 sc1
  v_mfma_f32_16x16x32_bf16 v[132:135], a[132:135], a[116:119], v[132:135]
  s_waitcnt vmcnt(9)
  v_cmp_ne_u32 vcc, s3, v29
  s_nop 4
  s_cbranch_vccnz CK6s
CK6x:
  v_mfma_f32_16x16x32_bf16 v[132:135], a[128:131], a[100:103], v[132:135]
  ds_read_b64_tr_b16 a[162:163], v2 offset:18016
  v_mfma_f32_16x16x32_bf16 v[136:139], a[128:131], a[104:107], v[136:139]
  s_add_u32 m0, s84, 4096
  ds_read_b64_tr_b16 a[164:165], v2 offset:21600
  v_mfma_f32_16x16x32_bf16 v[136:139], a[132:135], a[120:123], v[136:139]
  v_mfma_f32_16x16x32_bf16 v[140:143], a[132:135], a[124:127], v[140:143]
  ds_read_b64_tr_b16 a[166:167], v2 offset:25184
  v_mfma_f32_16x16x32_bf16 v[140:143], a[128:131], a[108:111], v[140:143]
  v_mfma_f32_16x16x32_bf16 v[156:159], a[136:139], a[108:111], v[156:159]
  buffer_load_dwordx4 v7, s[16:19], s56 offen offset:0 lds
  s_bfe_u32 s57, s82, 0x40014
  v_mfma_f32_16x16x32_bf16 v[156:159], a[140:143], a[124:127], v[156:159]
  s_lshl_b32 s57, s57, 13
  s_add_u32 s57, s57, s85
  ds_read_b64_tr_b16 a[168:169], v2 offset:14464
  v_mfma_f32_16x16x32_bf16 v[152:155], a[140:143], a[120:123], v[152:155]
  ds_read_b64_tr_b16 a[170:171], v2 offset:18048
  v_mfma_f32_16x16x32_bf16 v[152:155], a[136:139], a[104:107], v[152:155]
  v_mfma_f32_16x16x32_bf16 v[148:151], a[136:139], a[100:103], v[148:151]
  ds_read_b64_tr_b16 a[172:173], v2 offset:21632
  v_mfma_f32_16x16x32_bf16 v[148:151], a[140:143], a[116:119], v[148:151]
  buffer_load_dwordx4 a[32:35], v0, s[36:39], s57 offen offset:0 sc1
  v_mfma_f32_16x16x32_bf16 v[144:147], a[140:143], a[112:115], v[144:147]
  ds_read_b64_tr_b16 a[174:175], v2 offset:25216
  v_mfma_f32_16x16x32_bf16 v[144:147], a[136:139], a[96:99], v[144:147]
  s_waitcnt lgkmcnt(8)
  v_mfma_f32_16x16x32_bf16 v[160:163], a[144:147], a[96:99], v[160:163]
  ds_read_b64_tr_b16 a[128:129], v2 offset:14496
  v_mfma_f32_16x16x32_bf16 v[160:163], a[148:151], a[112:115], v[160:163]
  v_mfma_f32_16x16x32_bf16 v[164:167], a[148:151], a[116:119], v[164:167]
  ds_read_b64_tr_b16 a[130:131], v2 offset:18080
  v_mfma_f32_16x16x32_bf16 v[164:167], a[144:147], a[100:103], v[164:167]
  v_mfma_f32_16x16x32_bf16 v[168:171], a[144:147], a[104:107], v[168:171]
  ds_read_b64_tr_b16 a[132:133], v2 offset:21664
  v_mfma_f32_16x16x32_bf16 v[168:171], a[148:151], a[120:123], v[168:171]
  v_mfma_f32_16x16x32_bf16 v[172:175], a[148:151], a[124:127], v[172:175]
  ds_read_b64_tr_b16 a[134:135], v2 offset:25248
  v_mfma_f32_16x16x32_bf16 v[172:175], a[144:147], a[108:111], v[172:175]
  s_waitcnt vmcnt(13)
  s_barrier
  buffer_load_dwordx4 v8, s[16:19], s56 offen offset:1024 lds
  v_mfma_f32_16x16x32_bf16 v[188:191], a[152:155], a[108:111], v[188:191]
  ds_read_b64_tr_b16 a[136:137], v2 offset:14528
  v_mfma_f32_16x16x32_bf16 v[188:191], a[156:159], a[124:127], v[188:191]
  v_mfma_f32_16x16x32_bf16 v[184:187], a[156:159], a[120:123], v[184:187]
  ds_read_b64_tr_b16 a[138:139], v2 offset:18112
  v_mfma_f32_16x16x32_bf16 v[184:187], a[152:155], a[104:107], v[184:187]
  v_mfma_f32_16x16x32_bf16 v[180:183], a[152:155], a[100:103], v[180:183]
  buffer_load_dwordx4 a[36:39], v0, s[36:39], s57 offen offset:1024 sc1
  v_mfma_f32_16x16x32_bf16 v[180:183], a[156:159], a[116:119], v[180:183]
  ds_read_b64_tr_b16 a[140:141], v2 offset:21696
  v_mfma_f32_16x16x32_bf16 v[176:179], a[156:159], a[112:115], v[176:179]
  ds_read_b64_tr_b16 a[142:143], v2 offset:25280
  v_mfma_f32_16x16x32_bf16 v[176:179], a[152:155], a[96:99], v[176:179]
  s_waitcnt lgkmcnt(8)
  v_mfma_f32_16x16x32_bf16 v[192:195], a[160:163], a[96:99], v[192:195]
  ds_read_b64_tr_b16 a[144:145], v2 offset:28672
  v_mfma_f32_16x16x32_bf16 v[192:195], a[164:167], a[112:115], v[192:195]
  v_mfma_f32_16x16x32_bf16 v[196:199], a[164:167], a[116:119], v[196:199]
  ds_read_b64_tr_b16 a[146:147], v2 offset:32256
  v_mfma_f32_16x16x32_bf16 v[196:199], a[160:163], a[100:103], v[196:199]
  v_mfma_f32_16x16x32_bf16 v[200:203], a[160:163], a[104:107], v[200:203]
  ds_read_b64_tr_b16 a[148:149], v2 offset:35840
  v_mfma_f32_16x16x32_bf16 v[200:203], a[164:167], a[120:123], v[200:203]
  v_mfma_f32_16x16x32_bf16 v[204:207], a[164:167], a[124:127], v[204:207]
  buffer_load_dwordx4 v9, s[16:19], s56 offen offset:2048 lds
  v_mfma_f32_16x16x32_bf16 v[204:207], a[160:163], a[108:111], v[204:207]
  ds_read_b64_tr_b16 a[150:151], v2 offset:39424
  v_mfma_f32_16x16x32_bf16 v[220:223], a[168:171], a[108:111], v[220:223]
  ds_read_b64_tr_b16 a[152:153], v2 offset:28704
  v_mfma_f32_16x16x32_bf16 v[220:223], a[172:175], a[124:127], v[220:223]
  v_mfma_f32_16x16x32_bf16 v[216:219], a[172:175], a[120:123], v[216:219]
  ds_read_b64_tr_b16 a[154:155], v2 offset:32288
  v_mfma_f32_16x16x32_bf16 v[216:219], a[168:171], a[104:107], v[216:219]
  buffer_load_dwordx4 a[40:43], v0, s[36:39], s57 offen offset:2048 sc1
  v_mfma_f32_16x16x32_bf16 v[212:215], a[168:171], a[100:103], v[212:215]
  ds_read_b64_tr_b16 a[156:157], v2 offset:35872
  v_mfma_f32_16x16x32_bf16 v[212:215], a[172:175], a[116:119], v[212:215]
  v_mfma_f32_16x16x32_bf16 v[208:211], a[172:175], a[112:115], v[208:211]
  ds_read_b64_tr_b16 a[158:159], v2 offset:39456
  v_mfma_f32_16x16x32_bf16 v[208:211], a[168:171], a[96:99], v[208:211]
  s_waitcnt lgkmcnt(8)
  v_mfma_f32_16x16x32_bf16 v[224:227], a[128:131], a[96:99], v[224:227]
  ds_read_b64_tr_b16 a[160:161], v2 offset:28736
  v_mfma_f32_16x16x32_bf16 v[224:227], a[132:135], a[112:115], v[224:227]
  v_mfma_f32_16x16x32_bf16 v[228:231], a[132:135], a[116:119], v[228:231]
  ds_read_b64_tr_b16 a[162:163], v2 offset:32320
  v_mfma_f32_16x16x32_bf16 v[228:231], a[128:131], a[100:103], v[228:231]
  v_mfma_f32_16x16x32_bf16 v[232:235], a[128:131], a[104:107], v[232:235]
  ds_read_b64_tr_b16 a[164:165], v2 offset:35904
  v_mfma_f32_16x16x32_bf16 v[232:235], a[132:135], a[120:123], v[232:235]
  buffer_load_dwordx4 a[44:47], v0, s[36:39], s57 offen offset:3072 sc1
  v_mfma_f32_16x16x32_bf16 v[236:239], a[132:135], a[124:127], v[236:239]
Hc1:
  s_cbranch_execz Hc1_1
  ds_read_b64_tr_b16 a[166:167], v2 offset:39488
  v_mfma_f32_16x16x32_bf16 v[236:239], a[128:131], a[108:111], v[236:239]
  v_mfma_f32_16x16x32_bf16 v[252:255], a[136:139], a[108:111], v[252:255]
  ds_read_b64_tr_b16 a[168:169], v2 offset:28768
  v_mfma_f32_16x16x32_bf16 v[252:255], a[140:143], a[124:127], v[252:255]
  s_bfe_u32 s56, s82, 0x30018
  s_lshl_b32 s56, s56, 2
  s_bitcmp1_b32 s82, 27
  v_mfma_f32_16x16x32_bf16 v[248:251], a[140:143], a[120:123], v[248:251]
  s_addc_u32 s56, s56, 0
  s_mul_i32 s56, s56, 229376
  s_add_u32 m0, s84, 28672
  v_mfma_f32_16x16x32_bf16 v[248:251], a[136:139], a[104:107], v[248:251]
  ds_read_b64_tr_b16 a[170:171], v2 offset:32352
  v_mfma_f32_16x16x32_bf16 v[244:247], a[136:139], a[100:103], v[244:247]
  ds_read_b64_tr_b16 a[172:173], v2 offset:35936
  v_mfma_f32_16x16x32_bf16 v[244:247], a[140:143], a[116:119], v[244:247]
  buffer_load_dwordx4 v3, s[16:19], s56 offen offset:0 lds
  v_mfma_f32_16x16x32_bf16 v[240:243], a[140:143], a[112:115], v[240:243]
  ds_read_b64_tr_b16 a[174:175], v2 offset:39520
  v_mfma_f32_16x16x32_bf16 v[240:243], a[136:139], a[96:99], v[240:243]
  s_waitcnt vmcnt(8) lgkmcnt(8)
  v_mfma_f32_16x16x32_bf16 v[32:35], a[144:147], a[0:3], v[32:35]
  s_add_u32 s57, s57, 4096
  ds_read_b64_tr_b16 a[128:129], v2 offset:28800
  v_mfma_f32_16x16x32_bf16 v[32:35], a[148:151], a[16:19], v[32:35]
  v_mfma_f32_16x16x32_bf16 v[36:39], a[148:151], a[20:23], v[36:39]
  ds_read_b64_tr_b16 a[130:131], v2 offset:32384
  v_mfma_f32_16x16x32_bf16 v[36:39], a[144:147], a[4:7], v[36:39]
  v_mfma_f32_16x16x32_bf16 v[40:43], a[144:147], a[8:11], v[40:43]
  buffer_load_dwordx4 a[48:51], v0, s[36:39], s57 offen offset:0 sc1
  v_mfma_f32_16x16x32_bf16 v[40:43], a[148:151], a[24:27], v[40:43]
  ds_read_b64_tr_b16 a[132:133], v2 offset:35968
  v_mfma_f32_16x16x32_bf16 v[44:47], a[148:151], a[28:31], v[44:47]
  ds_read_b64_tr_b16 a[134:135], v2 offset:39552
  v_mfma_f32_16x16x32_bf16 v[44:47], a[144:147], a[12:15], v[44:47]
  v_mfma_f32_16x16x32_bf16 v[60:63], a[152:155], a[12:15], v[60:63]
  ds_read_b64_tr_b16 a[136:137], v2 offset:28832
  v_mfma_f32_16x16x32_bf16 v[60:63], a[156:159], a[28:31], v[60:63]
  v_mfma_f32_16x16x32_bf16 v[56:59], a[156:159], a[24:27], v[56:59]
  ds_read_b64_tr_b16 a[138:139], v2 offset:32416
  v_mfma_f32_16x16x32_bf16 v[56:59], a[152:155], a[8:11], v[56:59]
  buffer_load_dwordx4 v4, s[16:19], s56 offen offset:1024 lds
  v_mfma_f32_16x16x32_bf16 v[52:55], a[152:155], a[4:7], v[52:55]
  ds_read_b64_tr_b16 a[140:141], v2 offset:36000
  v_mfma_f32_16x16x32_bf16 v[52:55], a[156:159], a[20:23], v[52:55]
  v_mfma_f32_16x16x32_bf16 v[48:51], a[156:159], a[16:19], v[48:51]
  ds_read_b64_tr_b16 a[142:143], v2 offset:39584
  v_mfma_f32_16x16x32_bf16 v[48:51], a[152:155], a[0:3], v[48:51]
  s_waitcnt lgkmcnt(8)
  v_mfma_f32_16x16x32_bf16 v[64:67], a[160:163], a[0:3], v[64:67]
  ds_read_b64_tr_b16 a[144:145], v2 offset:28864
  v_mfma_f32_16x16x32_bf16 v[64:67], a[164:167], a[16:19], v[64:67]
  v_mfma_f32_16x16x32_bf16 v[68:71], a[164:167], a[20:23], v[68:71]
  ds_read_b64_tr_b16 a[146:147], v2 offset:32448
  v_mfma_f32_16x16x32_bf16 v[68:71], a[160:163], a[4:7], v[68:71]
  buffer_load_dwordx4 a[52:55], v0, s[36:39], s57 offen offset:1024 sc1
  v_mfma_f32_16x16x32_bf16 v[72:75], a[160:163], a[8:11], v[72:75]
  ds_read_b64_tr_b16 a[148:149], v2 offset:36032
  v_mfma_f32_16x16x32_bf16 v[72:75], a[164:167], a[24:27], v[72:75]
  v_mfma_f32_16x16x32_bf16 v[76:79], a[164:167], a[28:31], v[76:79]
  ds_read_b64_tr_b16 a[150:151], v2 offset:39616
  v_mfma_f32_16x16x32_bf16 v[76:79], a[160:163], a[12:15], v[76:79]
  v_mfma_f32_16x16x32_bf16 v[92:95], a[168:171], a[12:15], v[92:95]
  ds_read_b64_tr_b16 a[152:153], v2 offset:43008
  v_mfma_f32_16x16x32_bf16 v[92:95], a[172:175], a[28:31], v[92:95]
  v_mfma_f32_16x16x32_bf16 v[88:91], a[172:175], a[24:27], v[88:91]
  buffer_load_dwordx4 v5, s[16:19], s56 offen offset:2048 lds
  v_mfma_f32_16x16x32_bf16 v[88:91], a[168:171], a[8:11], v[88:91]
  ds_read_b64_tr_b16 a[154:155], v2 offset:46592
  v_mfma_f32_16x16x32_bf16 v[84:87], a[168:171], a[4:7], v[84:87]
  ds_read_b64_tr_b16 a[156:157], v2 offset:50176
  v_mfma_f32_16x16x32_bf16 v[84:87], a[172:175], a[20:23], v[84:87]
  v_mfma_f32_16x16x32_bf16 v[80:83], a[172:175], a[16:19], v[80:83]
  ds_read_b64_tr_b16 a[158:159], v2 offset:53760
  v_mfma_f32_16x16x32_bf16 v[80:83], a[168:171], a[0:3], v[80:83]
  s_waitcnt lgkmcnt(8)
  v_mfma_f32_16x16x32_bf16 v[96:99], a[128:131], a[0:3], v[96:99]
  ds_read_b64_tr_b16 a[160:161], v2 offset:43040
  v_mfma_f32_16x16x32_bf16 v[96:99], a[132:135], a[16:19], v[96:99]
  v_mfma_f32_16x16x32_bf16 v[100:103], a[132:135], a[20:23], v[100:103]
  buffer_load_dwordx4 a[56:59], v0, s[36:39], s57 offen offset:2048 sc1
  v_mfma_f32_16x16x32_bf16 v[100:103], a[128:131], a[4:7], v[100:103]
  ds_read_b64_tr_b16 a[162:163], v2 offset:46624
  v_mfma_f32_16x16x32_bf16 v[104:107], a[128:131], a[8:11], v[104:107]
  ds_read_b64_tr_b16 a[164:165], v2 offset:50208
  v_mfma_f32_16x16x32_bf16 v[104:107], a[132:135], a[24:27], v[104:107]
  v_mfma_f32_16x16x32_bf16 v[108:111], a[132:135], a[28:31], v[108:111]
  ds_read_b64_tr_b16 a[166:167], v2 offset:53792
  v_mfma_f32_16x16x32_bf16 v[108:111], a[128:131], a[12:15], v[108:111]
  v_mfma_f32_16x16x32_bf16 v[124:127], a[136:139], a[12:15], v[124:127]
  ds_read_b64_tr_b16 a[168:169], v2 offset:43072
  v_mfma_f32_16x16x32_bf16 v[124:127], a[140:143], a[28:31], v[124:127]
  buffer_load_dwordx4 v6, s[16:19], s56 offen offset:3072 lds
  v_mfma_f32_16x16x32_bf16 v[120:123], a[140:143], a[24:27], v[120:123]
  ds_read_b64_tr_b16 a[170:171], v2 offset:46656
  v_mfma_f32_16x16x32_bf16 v[120:123], a[136:139], a[8:11], v[120:123]
  v_mfma_f32_16x16x32_bf16 v[116:119], a[136:139], a[4:7], v[116:119]
  ds_read_b64_tr_b16 a[172:173], v2 offset:50240
  v_mfma_f32_16x16x32_bf16 v[116:119], a[140:143], a[20:23], v[116:119]
  v_mfma_f32_16x16x32_bf16 v[112:115], a[140:143], a[16:19], v[112:115]
  ds_read_b64_tr_b16 a[174:175], v2 offset:53824
  v_mfma_f32_16x16x32_bf16 v[112:115], a[136:139], a[0:3], v[112:115]
  s_waitcnt lgkmcnt(8)
  v_mfma_f32_16x16x32_bf16 v[128:131], a[144:147], a[0:3], v[128:131]
  ds_read_b64_tr_b16 a[128:129], v2 offset:43104
  v_mfma_f32_16x16x32_bf16 v[128:131], a[148:151], a[16:19], v[128:131]
  buffer_load_dwordx4 a[60:63], v0, s[36:39], s57 offen offset:3072 sc1
  v_mfma_f32_16x16x32_bf16 v[132:135], a[148:151], a[20:23], v[132:135]
  ds_read_b64_tr_b16 a[130:131], v2 offset:46688
  v_mfma_f32_16x16x32_bf16 v[132:135], a[144:147], a[4:7], v[132:135]
  v_mfma_f32_16x16x32_bf16 v[136:139], a[144:147], a[8:11], v[136:139]
  s_add_u32 m0, s84, 32768
  ds_read_b64_tr_b16 a[132:133], v2 offset:50272
  v_mfma_f32_16x16x32_bf16 v[136:139], a[148:151], a[24:27], v[136:139]
  v_mfma_f32_16x16x32_bf16 v[140:143], a[148:151], a[28:31], v[140:143]
  ds_read_b64_tr_b16 a[134:135], v2 offset:53856
  v_mfma_f32_16x16x32_bf16 v[140:143], a[144:147], a[12:15], v[140:143]
  v_mfma_f32_16x16x32_bf16 v[156:159], a[152:155], a[12:15], v[156:159]
  buffer_load_dwordx4 v7, s[16:19], s56 offen offset:0 lds
  s_bfe_u32 s57, s82, 0x40018
  v_mfma_f32_16x16x32_bf16 v[156:159], a[156:159], a[28:31], v[156:159]
  s_lshl_b32 s57, s57, 13
  s_add_u32 s57, s57, s85
  ds_read_b64_tr_b16 a[136:137], v2 offset:43136
  v_mfma_f32_16x16x32_bf16 v[152:155], a[156:159], a[24:27], v[152:155]
  ds_read_b64_tr_b16 a[138:139], v2 offset:46720
  v_mfma_f32_16x16x32_bf16 v[152:155], a[152:155], a[8:11], v[152:155]
  v_mfma_f32_16x16x32_bf16 v[148:151], a[152:155], a[4:7], v[148:151]
  ds_read_b64_tr_b16 a[140:141], v2 offset:50304
  v_mfma_f32_16x16x32_bf16 v[148:151], a[156:159], a[20:23], v[148:151]
  buffer_load_dwordx4 a[64:67], v0, s[36:39], s57 offen offset:0 sc1
  v_mfma_f32_16x16x32_bf16 v[144:147], a[156:159], a[16:19], v[144:147]
  ds_read_b64_tr_b16 a[142:143], v2 offset:53888
  v_mfma_f32_16x16x32_bf16 v[144:147], a[152:155], a[0:3], v[144:147]
  s_waitcnt lgkmcnt(8)
  v_mfma_f32_16x16x32_bf16 v[160:163], a[160:163], a[0:3], v[160:163]
  ds_read_b64_tr_b16 a[144:145], v2 offset:43168
  v_mfma_f32_16x16x32_bf16 v[160:163], a[164:167], a[16:19], v[160:163]
  v_mfma_f32_16x16x32_bf16 v[164:167], a[164:167], a[20:23], v[164:167]
  ds_read_b64_tr_b16 a[146:147], v2 offset:46752
  v_mfma_f32_16x16x32_bf16 v[164:167], a[160:163], a[4:7], v[164:167]
  v_mfma_f32_16x16x32_bf16 v[168:171], a[160:163], a[8:11], v[168:171]
  ds_read_b64_tr_b16 a[148:149], v2 offset:50336
  v_mfma_f32_16x16x32_bf16 v[168:171], a[164:167], a[24:27], v[168:171]
  v_mfma_f32_16x16x32_bf16 v[172:175], a[164:167], a[28:31], v[172:175]
  ds_read_b64_tr_b16 a[150:151], v2 offset:53920
  v_mfma_f32_16x16x32_bf16 v[172:175], a[160:163], a[12:15], v[172:175]
  s_waitcnt vmcnt(12)
  s_barrier
  buffer_load_dwordx4 v8, s[16:19], s56 offen offset:1024 lds
  v_mfma_f32_16x16x32_bf16 v[188:191], a[168:171], a[12:15], v[188:191]
  ds_read_b64_tr_b16 a[152:153], v2 offset:43200
  v_mfma_f32_16x16x32_bf16 v[188:191], a[172:175], a[28:31], v[188:191]
  v_mfma_f32_16x16x32_bf16 v[184:187], a[172:175], a[24:27], v[184:187]
  ds_read_b64_tr_b16 a[154:155], v2 offset:46784
  v_mfma_f32_16x16x32_bf16 v[184:187], a[168:171], a[8:11], v[184:187]
  v_mfma_f32_16x16x32_bf16 v[180:183], a[168:171], a[4:7], v[180:183]
  buffer_load_dwordx4 a[68:71], v0, s[36:39], s57 offen offset:1024 sc1
  v_mfma_f32_16x16x32_bf16 v[180:183], a[172:175], a[20:23], v[180:183]
  ds_read_b64_tr_b16 a[156:157], v2 offset:50368
  v_mfma_f32_16x16x32_bf16 v[176:179], a[172:175], a[16:19], v[176:179]
  ds_read_b64_tr_b16 a[158:159], v2 offset:53952
  v_mfma_f32_16x16x32_bf16 v[176:179], a[168:171], a[0:3], v[176:179]
  s_waitcnt lgkmcnt(8)
  v_mfma_f32_16x16x32_bf16 v[192:195], a[128:131], a[0:3], v[192:195]
  ds_read_b64_tr_b16 a[160:161], v1 offset:0
  v_mfma_f32_16x16x32_bf16 v[192:195], a[132:135], a[16:19], v[192:195]
  v_mfma_f32_16x16x32_bf16 v[196:199], a[132:135], a[20:23], v[196:199]
  ds_read_b64_tr_b16 a[162:163], v1 offset:3584
  v_mfma_f32_16x16x32_bf16 v[196:199], a[128:131], a[4:7], v[196:199]
  v_mfma_f32_16x16x32_bf16 v[200:203], a[128:131], a[8:11], v[200:203]
  ds_read_b64_tr_b16 a[164:165], v1 offset:7168
  v_mfma_f32_16x16x32_bf16 v[200:203], a[132:135], a[24:27], v[200:203]
  v_mfma_f32_16x16x32_bf16 v[204:207], a[132:135], a[28:31], v[204:207]
  buffer_load_dwordx4 v9, s[16:19], s56 offen offset:2048 lds
  v_mfma_f32_16x16x32_bf16 v[204:207], a[128:131], a[12:15], v[204:207]
  ds_read_b64_tr_b16 a[166:167], v1 offset:10752
  v_mfma_f32_16x16x32_bf16 v[220:223], a[136:139], a[12:15], v[220:223]
  ds_read_b64_tr_b16 a[168:169], v1 offset:32
  v_mfma_f32_16x16x32_bf16 v[220:223], a[140:143], a[28:31], v[220:223]
  v_mfma_f32_16x16x32_bf16 v[216:219], a[140:143], a[24:27], v[216:219]
  ds_read_b64_tr_b16 a[170:171], v1 offset:3616
  v_mfma_f32_16x16x32_bf16 v[216:219], a[136:139], a[8:11], v[216:219]
  buffer_load_dwordx4 a[72:75], v0, s[36:39], s57 offen offset:2048 sc1
  v_mfma_f32_16x16x32_bf16 v[212:215], a[136:139], a[4:7], v[212:215]
  ds_read_b64_tr_b16 a[172:173], v1 offset:7200
  v_mfma_f32_16x16x32_bf16 v[212:215], a[140:143], a[20:23], v[212:215]
  v_mfma_f32_16x16x32_bf16 v[208:211], a[140:143], a[16:19], v[208:211]
  ds_read_b64_tr_b16 a[174:175], v1 offset:10784
  v_mfma_f32_16x16x32_bf16 v[208:211], a[136:139], a[0:3], v[208:211]
  s_waitcnt lgkmcnt(8)
  v_mfma_f32_16x16x32_bf16 v[224:227], a[144:147], a[0:3], v[224:227]
  ds_read_b64_tr_b16 a[128:129], v1 offset:64
  v_mfma_f32_16x16x32_bf16 v[224:227], a[148:151], a[16:19], v[224:227]
  v_mfma_f32_16x16x32_bf16 v[228:231], a[148:151], a[20:23], v[228:231]
  ds_read_b64_tr_b16 a[130:131], v1 offset:3648
  v_mfma_f32_16x16x32_bf16 v[228:231], a[144:147], a[4:7], v[228:231]
  v_mfma_f32_16x16x32_bf16 v[232:235], a[144:147], a[8:11], v[232:235]
  ds_read_b64_tr_b16 a[132:133], v1 offset:7232
  v_mfma_f32_16x16x32_bf16 v[232:235], a[148:151], a[24:27], v[232:235]
  buffer_load_dwordx4 a[76:79], v0, s[36:39], s57 offen offset:3072 sc1
  v_mfma_f32_16x16x32_bf16 v[236:239], a[148:151], a[28:31], v[236:239]
  ds_read_b64_tr_b16 a[134:135], v1 offset:10816
  v_mfma_f32_16x16x32_bf16 v[236:239], a[144:147], a[12:15], v[236:239]
  v_mfma_f32_16x16x32_bf16 v[252:255], a[152:155], a[12:15], v[252:255]
  ds_read_b64_tr_b16 a[136:137], v1 offset:96
  v_mfma_f32_16x16x32_bf16 v[252:255], a[156:159], a[28:31], v[252:255]
  s_bfe_u32 s56, s82, 0x3001c
  s_lshl_b32 s56, s56, 2
  s_bitcmp1_b32 s82, 31
  v_mfma_f32_16x16x32_bf16 v[248:251], a[156:159], a[24:27], v[248:251]
  s_addc_u32 s56, s56, 0
  s_mul_i32 s56, s56, 229376
  s_add_u32 m0, s84, 57344
  v_mfma_f32_16x16x32_bf16 v[248:251], a[152:155], a[8:11], v[248:251]
  buffer_load_dwordx4 a[208:211], v0, s[36:39], s59 offen offset:0 sc1
  v_add_u32 v31, 28672, v31
  v_mfma_f32_16x16x32_bf16 v[244:247], a[152:155], a[4:7], v[244:247]
  ds_read_b64_tr_b16 a[138:139], v1 offset:3680
  v_mfma_f32_16x16x32_bf16 v[244:247], a[156:159], a[20:23], v[244:247]
  ds_read_b64_tr_b16 a[140:141], v1 offset:7264
  v_mfma_f32_16x16x32_bf16 v[240:243], a[156:159], a[16:19], v[240:243]
  ds_read_b64_tr_b16 a[142:143], v1 offset:10848
  v_mfma_f32_16x16x32_bf16 v[240:243], a[152:155], a[0:3], v[240:243]
  s_waitcnt vmcnt(8) lgkmcnt(8)
  v_mfma_f32_16x16x32_bf16 v[32:35], a[160:163], a[32:35], v[32:35]
  buffer_load_dwordx4 a[212:215], v0, s[36:39], s59 offen offset:1024 sc1
  v_mfma_f32_16x16x32_bf16 v[32:35], a[164:167], a[48:51], v[32:35]
  ds_read_b64_tr_b16 a[144:145], v1 offset:128
  v_mfma_f32_16x16x32_bf16 v[36:39], a[164:167], a[52:55], v[36:39]
  ds_read_b64_tr_b16 a[146:147], v1 offset:3712
  v_mfma_f32_16x16x32_bf16 v[36:39], a[160:163], a[36:39], v[36:39]
  v_mfma_f32_16x16x32_bf16 v[40:43], a[160:163], a[40:43], v[40:43]
  ds_read_b64_tr_b16 a[148:149], v1 offset:7296
  v_mfma_f32_16x16x32_bf16 v[40:43], a[164:167], a[56:59], v[40:43]
  buffer_load_dwordx4 v3, s[16:19], s56 offen offset:0 lds
  s_add_u32 s57, s57, 4096
  v_mfma_f32_16x16x32_bf16 v[44:47], a[164:167], a[60:63], v[44:47]
  ds_read_b64_tr_b16 a[150:151], v1 offset:10880
  v_mfma_f32_16x16x32_bf16 v[44:47], a[160:163], a[44:47], v[44:47]
  v_mfma_f32_16x16x32_bf16 v[60:63], a[168:171], a[44:47], v[60:63]
  ds_read_b64_tr_b16 a[152:153], v1 offset:160
  v_mfma_f32_16x16x32_bf16 v[60:63], a[172:175], a[60:63], v[60:63]
  v_mfma_f32_16x16x32_bf16 v[56:59], a[172:175], a[56:59], v[56:59]
  buffer_load_dwordx4 a[80:83], v0, s[36:39], s57 offen offset:0 sc1
  v_mfma_f32_16x16x32_bf16 v[56:59], a[168:171], a[40:43], v[56:59]
  ds_read_b64_tr_b16 a[154:155], v1 offset:3744
  v_mfma_f32_16x16x32_bf16 v[52:55], a[168:171], a[36:39], v[52:55]
  ds_read_b64_tr_b16 a[156:157], v1 offset:7328
  v_mfma_f32_16x16x32_bf16 v[52:55], a[172:175], a[52:55], v[52:55]
  v_mfma_f32_16x16x32_bf16 v[48:51], a[172:175], a[48:51], v[48:51]
  ds_read_b64_tr_b16 a[158:159], v1 offset:10912
  v_mfma_f32_16x16x32_bf16 v[48:51], a[168:171], a[32:35], v[48:51]
  s_waitcnt lgkmcnt(8)
  buffer_load_dwordx4 v4, s[16:19], s56 offen offset:1024 lds
  v_mfma_f32_16x16x32_bf16 v[64:67], a[128:131], a[32:35], v[64:67]
  ds_read_b64_tr_b16 a[160:161], v1 offset:192
  v_mfma_f32_16x16x32_bf16 v[64:67], a[132:135], a[48:51], v[64:67]
  v_mfma_f32_16x16x32_bf16 v[68:71], a[132:135], a[52:55], v[68:71]
  ds_read_b64_tr_b16 a[162:163], v1 offset:3776
  v_mfma_f32_16x16x32_bf16 v[68:71], a[128:131], a[36:39], v[68:71]
  v_mfma_f32_16x16x32_bf16 v[72:75], a[128:131], a[40:43], v[72:75]
  buffer_load_dwordx4 a[84:87], v0, s[36:39], s57 offen offset:1024 sc1
  v_mfma_f32_16x16x32_bf16 v[72:75], a[132:135], a[56:59], v[72:75]
  ds_read_b64_tr_b16 a[164:165], v1 offset:7360
  v_mfma_f32_16x16x32_bf16 v[76:79], a[132:135], a[60:63], v[76:79]
  ds_read_b64_tr_b16 a[166:167], v1 offset:10944
  v_mfma_f32_16x16x32_bf16 v[76:79], a[128:131], a[44:47], v[76:79]
  v_mfma_f32_16x16x32_bf16 v[92:95], a[136:139], a[44:47], v[92:95]
  ds_read_b64_tr_b16 a[168:169], v1 offset:14336
  v_mfma_f32_16x16x32_bf16 v[92:95], a[140:143], a[60:63], v[92:95]
  v_mfma_f32_16x16x32_bf16 v[88:91], a[140:143], a[56:59], v[88:91]
  buffer_load_dwordx4 v5, s[16:19], s56 offen offset:2048 lds
  v_mfma_f32_16x16x32_bf16 v[88:91], a[136:139], a[40:43], v[88:91]
  ds_read_b64_tr_b16 a[170:171], v1 offset:17920
  v_mfma_f32_16x16x32_bf16 v[84:87], a[136:139], a[36:39], v[84:87]
  ds_read_b64_tr_b16 a[172:173], v1 offset:21504
  v_mfma_f32_16x16x32_bf16 v[84:87], a[140:143], a[52:55], v[84:87]
  v_mfma_f32_16x16x32_bf16 v[80:83], a[140:143], a[48:51], v[80:83]
  ds_read_b64_tr_b16 a[174:175], v1 offset:25088
  v_mfma_f32_16x16x32_bf16 v[80:83], a[136:139], a[32:35], v[80:83]
  s_waitcnt lgkmcnt(8)
  v_mfma_f32_16x16x32_bf16 v[96:99], a[144:147], a[32:35], v[96:99]
  ds_read_b64_tr_b16 a[128:129], v1 offset:14368
  v_mfma_f32_16x16x32_bf16 v[96:99], a[148:151], a[48:51], v[96:99]
  v_mfma_f32_16x16x32_bf16 v[100:103], a[148:151], a[52:55], v[100:103]
  buffer_load_dwordx4 a[88:91], v0, s[36:39], s57 offen offset:2048 sc1
  v_mfma_f32_16x16x32_bf16 v[100:103], a[144:147], a[36:39], v[100:103]
  ds_read_b64_tr_b16 a[130:131], v1 offset:17952
  v_mfma_f32_16x16x32_bf16 v[104:107], a[144:147], a[40:43], v[104:107]
  ds_read_b64_tr_b16 a[132:133], v1 offset:21536
  v_mfma_f32_16x16x32_bf16 v[104:107], a[148:151], a[56:59], v[104:107]
  v_mfma_f32_16x16x32_bf16 v[108:111], a[148:151], a[60:63], v[108:111]
  ds_read_b64_tr_b16 a[134:135], v1 offset:25120
  v_mfma_f32_16x16x32_bf16 v[108:111], a[144:147], a[44:47], v[108:111]
  v_mfma_f32_16x16x32_bf16 v[124:127], a[152:155], a[44:47], v[124:127]
  ds_read_b64_tr_b16 a[136:137], v1 offset:14400
  v_mfma_f32_16x16x32_bf16 v[124:127], a[156:159], a[60:63], v[124:127]
  buffer_load_dwordx4 v6, s[16:19], s56 offen offset:3072 lds
  v_mfma_f32_16x16x32_bf16 v[120:123], a[156:159], a[56:59], v[120:123]
  ds_read_b64_tr_b16 a[138:139], v1 offset:17984
  v_mfma_f32_16x16x32_bf16 v[120:123], a[152:155], a[40:43], v[120:123]
  v_mfma_f32_16x16x32_bf16 v[116:119], a[152:155], a[36:39], v[116:119]
  ds_read_b64_tr_b16 a[140:141], v1 offset:21568
  v_mfma_f32_16x16x32_bf16 v[116:119], a[156:159], a[52:55], v[116:119]
  v_mfma_f32_16x16x32_bf16 v[112:115], a[156:159], a[48:51], v[112:115]
  ds_read_b64_tr_b16 a[142:143], v1 offset:25152
  v_mfma_f32_16x16x32_bf16 v[112:115], a[152:155], a[32:35], v[112:115]
  s_waitcnt lgkmcnt(8)
  v_mfma_f32_16x16x32_bf16 v[128:131], a[160:163], a[32:35], v[128:131]
  ds_read_b64_tr_b16 a[144:145], v1 offset:14432
  v_mfma_f32_16x16x32_bf16 v[128:131], a[164:167], a[48:51], v[128:131]
  buffer_load_dwordx4 a[92:95], v0, s[36:39], s57 offen offset:3072 sc1
  v_mfma_f32_16x16x32_bf16 v[132:135], a[164:167], a[52:55], v[132:135]
  ds_read_b64_tr_b16 a[146:147], v1 offset:18016
  v_mfma_f32_16x16x32_bf16 v[132:135], a[160:163], a[36:39], v[132:135]
  v_mfma_f32_16x16x32_bf16 v[136:139], a[160:163], a[40:43], v[136:139]
  s_add_u32 m0, s84, 61440
  ds_read_b64_tr_b16 a[148:149], v1 offset:21600
  v_mfma_f32_16x16x32_bf16 v[136:139], a[164:167], a[56:59], v[136:139]
  v_mfma_f32_16x16x32_bf16 v[140:143], a[164:167], a[60:63], v[140:143]
  ds_read_b64_tr_b16 a[150:151], v1 offset:25184
  v_mfma_f32_16x16x32_bf16 v[140:143], a[160:163], a[44:47], v[140:143]
  v_mfma_f32_16x16x32_bf16 v[156:159], a[168:171], a[44:47], v[156:159]
  buffer_load_dwordx4 v7, s[16:19], s56 offen offset:0 lds
  s_bfe_u32 s57, s82, 0x4001c
  v_mfma_f32_16x16x32_bf16 v[156:159], a[172:175], a[60:63], v[156:159]
  s_lshl_b32 s57, s57, 13
  s_add_u32 s57, s57, s85
  ds_read_b64_tr_b16 a[152:153], v1 offset:14464
  v_mfma_f32_16x16x32_bf16 v[152:155], a[172:175], a[56:59], v[152:155]
  ds_read_b64_tr_b16 a[154:155], v1 offset:18048
  v_mfma_f32_16x16x32_bf16 v[152:155], a[168:171], a[40:43], v[152:155]
  v_mfma_f32_16x16x32_bf16 v[148:151], a[168:171], a[36:39], v[148:151]
  ds_read_b64_tr_b16 a[156:157], v1 offset:21632
  v_mfma_f32_16x16x32_bf16 v[148:151], a[172:175], a[52:55], v[148:151]
  buffer_load_dwordx4 a[96:99], v0, s[36:39], s57 offen offset:0 sc1
  v_mfma_f32_16x16x32_bf16 v[144:147], a[172:175], a[48:51], v[144:147]
  ds_read_b64_tr_b16 a[158:159], v1 offset:25216
  v_mfma_f32_16x16x32_bf16 v[144:147], a[168:171], a[32:35], v[144:147]
  s_waitcnt lgkmcnt(8)
  v_mfma_f32_16x16x32_bf16 v[160:163], a[128:131], a[32:35], v[160:163]
  ds_read_b64_tr_b16 a[160:161], v1 offset:14496
  v_mfma_f32_16x16x32_bf16 v[160:163], a[132:135], a[48:51], v[160:163]
  v_mfma_f32_16x16x32_bf16 v[164:167], a[132:135], a[52:55], v[164:167]
  ds_read_b64_tr_b16 a[162:163], v1 offset:18080
  v_mfma_f32_16x16x32_bf16 v[164:167], a[128:131], a[36:39], v[164:167]
  v_mfma_f32_16x16x32_bf16 v[168:171], a[128:131], a[40:43], v[168:171]
  ds_read_b64_tr_b16 a[164:165], v1 offset:21664
  v_mfma_f32_16x16x32_bf16 v[168:171], a[132:135], a[56:59], v[168:171]
  v_mfma_f32_16x16x32_bf16 v[172:175], a[132:135], a[60:63], v[172:175]
  ds_read_b64_tr_b16 a[166:167], v1 offset:25248
  v_mfma_f32_16x16x32_bf16 v[172:175], a[128:131], a[44:47], v[172:175]
  s_waitcnt vmcnt(14)
  s_barrier
  buffer_load_dwordx4 v8, s[16:19], s56 offen offset:1024 lds
  v_mfma_f32_16x16x32_bf16 v[188:191], a[136:139], a[44:47], v[188:191]
  ds_read_b64_tr_b16 a[168:169], v1 offset:14528
  v_mfma_f32_16x16x32_bf16 v[188:191], a[140:143], a[60:63], v[188:191]
  v_mfma_f32_16x16x32_bf16 v[184:187], a[140:143], a[56:59], v[184:187]
  ds_read_b64_tr_b16 a[170:171], v1 offset:18112
  v_mfma_f32_16x16x32_bf16 v[184:187], a[136:139], a[40:43], v[184:187]
  v_mfma_f32_16x16x32_bf16 v[180:183], a[136:139], a[36:39], v[180:183]
  buffer_load_dwordx4 a[100:103], v0, s[36:39], s57 offen offset:1024 sc1
  v_mfma_f32_16x16x32_bf16 v[180:183], a[140:143], a[52:55], v[180:183]
  ds_read_b64_tr_b16 a[172:173], v1 offset:21696
  v_mfma_f32_16x16x32_bf16 v[176:179], a[140:143], a[48:51], v[176:179]
  ds_read_b64_tr_b16 a[174:175], v1 offset:25280
  v_mfma_f32_16x16x32_bf16 v[176:179], a[136:139], a[32:35], v[176:179]
  s_waitcnt lgkmcnt(8)
  v_mfma_f32_16x16x32_bf16 v[192:195], a[144:147], a[32:35], v[192:195]
  ds_read_b64_tr_b16 a[128:129], v1 offset:28672
  v_mfma_f32_16x16x32_bf16 v[192:195], a[148:151], a[48:51], v[192:195]
  v_mfma_f32_16x16x32_bf16 v[196:199], a[148:151], a[52:55], v[196:199]
  ds_read_b64_tr_b16 a[130:131], v1 offset:32256
  v_mfma_f32_16x16x32_bf16 v[196:199], a[144:147], a[36:39], v[196:199]
  v_mfma_f32_16x16x32_bf16 v[200:203], a[144:147], a[40:43], v[200:203]
  ds_read_b64_tr_b16 a[132:133], v1 offset:35840
  v_mfma_f32_16x16x32_bf16 v[200:203], a[148:151], a[56:59], v[200:203]
  ds_read_b64_tr_b16 a[176:177], v31 offset:0
  v_mfma_f32_16x16x32_bf16 v[204:207], a[148:151], a[60:63], v[204:207]
  buffer_load_dwordx4 v9, s[16:19], s56 offen offset:2048 lds
  v_mfma_f32_16x16x32_bf16 v[204:207], a[144:147], a[44:47], v[204:207]
  ds_read_b64_tr_b16 a[134:135], v1 offset:39424
  v_mfma_f32_16x16x32_bf16 v[220:223], a[152:155], a[44:47], v[220:223]
  ds_read_b64_tr_b16 a[136:137], v1 offset:28704
  v_mfma_f32_16x16x32_bf16 v[220:223], a[156:159], a[60:63], v[220:223]
  ds_read_b64_tr_b16 a[178:179], v31 offset:3584
  v_mfma_f32_16x16x32_bf16 v[216:219], a[156:159], a[56:59], v[216:219]
  ds_read_b64_tr_b16 a[138:139], v1 offset:32288
  v_mfma_f32_16x16x32_bf16 v[216:219], a[152:155], a[40:43], v[216:219]
  buffer_load_dwordx4 a[104:107], v0, s[36:39], s57 offen offset:2048 sc1
  v_mfma_f32_16x16x32_bf16 v[212:215], a[152:155], a[36:39], v[212:215]
  ds_read_b64_tr_b16 a[140:141], v1 offset:35872
  v_mfma_f32_16x16x32_bf16 v[212:215], a[156:159], a[52:55], v[212:215]
  ds_read_b64_tr_b16 a[180:181], v31 offset:7168
  v_mfma_f32_16x16x32_bf16 v[208:211], a[156:159], a[48:51], v[208:211]
  ds_read_b64_tr_b16 a[142:143], v1 offset:39456
  v_mfma_f32_16x16x32_bf16 v[208:211], a[152:155], a[32:35], v[208:211]
  s_waitcnt lgkmcnt(11)
  ds_read_b64_tr_b16 a[182:183], v31 offset:10752
  v_mfma_f32_16x16x32_bf16 v[224:227], a[160:163], a[32:35], v[224:227]
  ds_read_b64_tr_b16 a[144:145], v1 offset:28736
  v_mfma_f32_16x16x32_bf16 v[224:227], a[164:167], a[48:51], v[224:227]
  ds_read_b64_tr_b16 a[184:185], v31 offset:32
  v_mfma_f32_16x16x32_bf16 v[228:231], a[164:167], a[52:55], v[228:231]
  ds_read_b64_tr_b16 a[146:147], v1 offset:32320
  v_mfma_f32_16x16x32_bf16 v[228:231], a[160:163], a[36:39], v[228:231]
  ds_read_b64_tr_b16 a[186:187], v31 offset:3616
  v_mfma_f32_16x16x32_bf16 v[232:235], a[160:163], a[40:43], v[232:235]
  ds_read_b64_tr_b16 a[148:149], v1 offset:35904
  v_mfma_f32_16x16x32_bf16 v[232:235], a[164:167], a[56:59], v[232:235]
  buffer_load_dwordx4 a[108:111], v0, s[36:39], s57 offen offset:3072 sc1
  v_mfma_f32_16x16x32_bf16 v[236:239], a[164:167], a[60:63], v[236:239]
  ds_read_b64_tr_b16 a[150:151], v1 offset:39488
  v_mfma_f32_16x16x32_bf16 v[236:239], a[160:163], a[44:47], v[236:239]
  ds_read_b64_tr_b16 a[188:189], v31 offset:7200
  v_mfma_f32_16x16x32_bf16 v[252:255], a[168:171], a[44:47], v[252:255]
  ds_read_b64_tr_b16 a[152:153], v1 offset:28768
  v_mfma_f32_16x16x32_bf16 v[252:255], a[172:175], a[60:63], v[252:255]
  s_bfe_u32 s56, s83, 0x30000
  s_lshl_b32 s56, s56, 2
  s_bitcmp1_b32 s83, 3
  v_mfma_f32_16x16x32_bf16 v[248:251], a[172:175], a[56:59], v[248:251]
  s_addc_u32 s56, s56, 0
  s_mul_i32 s56, s56, 229376
  s_add_u32 m0, s84, 86016
  v_mfma_f32_16x16x32_bf16 v[248:251], a[168:171], a[40:43], v[248:251]
  ds_read_b64_tr_b16 a[154:155], v1 offset:32352
  v_mfma_f32_16x16x32_bf16 v[244:247], a[168:171], a[36:39], v[244:247]
  ds_read_b64_tr_b16 a[156:157], v1 offset:35936
  v_mfma_f32_16x16x32_bf16 v[244:247], a[172:175], a[52:55], v[244:247]
  buffer_load_dwordx4 v3, s[16:19], s56 offen offset:0 lds
  v_mfma_f32_16x16x32_bf16 v[240:243], a[172:175], a[48:51], v[240:243]
  ds_read_b64_tr_b16 a[158:159], v1 offset:39520
  v_mfma_f32_16x16x32_bf16 v[240:243], a[168:171], a[32:35], v[240:243]
  s_waitcnt vmcnt(8) lgkmcnt(12)
  ds_read_b64_tr_b16 a[190:191], v31 offset:10784
  v_mfma_f32_16x16x32_bf16 v[32:35], a[128:131], a[64:67], v[32:35]
  s_add_u32 s57, s57, 4096
  ds_read_b64_tr_b16 a[192:193], v31 offset:64
  v_mfma_f32_16x16x32_bf16 v[32:35], a[132:135], a[80:83], v[32:35]
  ds_read_b64_tr_b16 a[194:195], v31 offset:3648
  v_mfma_f32_16x16x32_bf16 v[36:39], a[132:135], a[84:87], v[36:39]
  ds_read_b64_tr_b16 a[196:197], v31 offset:7232
  v_mfma_f32_16x16x32_bf16 v[36:39], a[128:131], a[68:71], v[36:39]
  ds_read_b64_tr_b16 a[198:199], v31 offset:10816
  v_mfma_f32_16x16x32_bf16 v[40:43], a[128:131], a[72:75], v[40:43]
  buffer_load_dwordx4 a[112:115], v0, s[36:39], s57 offen offset:0 sc1
  v_mfma_f32_16x16x32_bf16 v[40:43], a[132:135], a[88:91], v[40:43]
  ds_read_b64_tr_b16 a[200:201], v31 offset:96
  v_mfma_f32_16x16x32_bf16 v[44:47], a[132:135], a[92:95], v[44:47]
  ds_read_b64_tr_b16 a[202:203], v31 offset:3680
  v_mfma_f32_16x16x32_bf16 v[44:47], a[128:131], a[76:79], v[44:47]
  ds_read_b64_tr_b16 a[204:205], v31 offset:7264
  v_mfma_f32_16x16x32_bf16 v[60:63], a[136:139], a[76:79], v[60:63]
  ds_read_b64_tr_b16 a[160:161], v1 offset:28800
  v_mfma_f32_16x16x32_bf16 v[60:63], a[140:143], a[92:95], v[60:63]
  ds_read_b64_tr_b16 a[206:207], v31 offset:10848
  v_mfma_f32_16x16x32_bf16 v[56:59], a[140:143], a[88:91], v[56:59]
  ds_read_b64_tr_b16 a[162:163], v1 offset:32384
  v_mfma_f32_16x16x32_bf16 v[56:59], a[136:139], a[72:75], v[56:59]
  buffer_load_dwordx4 v4, s[16:19], s56 offen offset:1024 lds
  v_mfma_f32_16x16x32_bf16 v[52:55], a[136:139], a[68:71], v[52:55]
  ds_read_b64_tr_b16 a[164:165], v1 offset:35968
  v_mfma_f32_16x16x32_bf16 v[52:55], a[140:143], a[84:87], v[52:55]
  v_mfma_f32_16x16x32_bf16 v[48:51], a[140:143], a[80:83], v[48:51]
  ds_read_b64_tr_b16 a[166:167], v1 offset:39552
  v_mfma_f32_16x16x32_bf16 v[48:51], a[136:139], a[64:67], v[48:51]
  s_waitcnt lgkmcnt(13)
  v_mfma_f32_16x16x32_bf16 v[64:67], a[144:147], a[64:67], v[64:67]
  ds_read_b64_tr_b16 a[168:169], v1 offset:28832
  v_mfma_f32_16x16x32_bf16 v[64:67], a[148:151], a[80:83], v[64:67]
  v_mfma_f32_16x16x32_bf16 v[68:71], a[148:151], a[84:87], v[68:71]
  ds_read_b64_tr_b16 a[170:171], v1 offset:32416
  v_mfma_f32_16x16x32_bf16 v[68:71], a[144:147], a[68:71], v[68:71]
  buffer_load_dwordx4 a[116:119], v0, s[36:39], s57 offen offset:1024 sc1
  v_mfma_f32_16x16x32_bf16 v[72:75], a[144:147], a[72:75], v[72:75]
  ds_read_b64_tr_b16 a[172:173], v1 offset:36000
  v_mfma_f32_16x16x32_bf16 v[72:75], a[148:151], a[88:91], v[72:75]
  v_mfma_f32_16x16x32_bf16 v[76:79], a[148:151], a[92:95], v[76:79]
  ds_read_b64_tr_b16 a[174:175], v1 offset:39584
  v_mfma_f32_16x16x32_bf16 v[76:79], a[144:147], a[76:79], v[76:79]
  v_mfma_f32_16x16x32_bf16 v[92:95], a[152:155], a[76:79], v[92:95]
  ds_read_b64_tr_b16 a[128:129], v1 offset:28864
  v_mfma_f32_16x16x32_bf16 v[92:95], a[156:159], a[92:95], v[92:95]
  v_mfma_f32_16x16x32_bf16 v[88:91], a[156:159], a[88:91], v[88:91]
  buffer_load_dwordx4 v5, s[16:19], s56 offen offset:2048 lds
  v_mfma_f32_16x16x32_bf16 v[88:91], a[152:155], a[72:75], v[88:91]
  ds_read_b64_tr_b16 a[130:131], v1 offset:32448
  v_mfma_f32_16x16x32_bf16 v[84:87], a[152:155], a[68:71], v[84:87]
  ds_read_b64_tr_b16 a[132:133], v1 offset:36032
  v_mfma_f32_16x16x32_bf16 v[84:87], a[156:159], a[84:87], v[84:87]
  v_mfma_f32_16x16x32_bf16 v[80:83], a[156:159], a[80:83], v[80:83]
  ds_read_b64_tr_b16 a[134:135], v1 offset:39616
  v_mfma_f32_16x16x32_bf16 v[80:83], a[152:155], a[64:67], v[80:83]
  s_waitcnt vmcnt(20) lgkmcnt(11)
  v_mfma_f32_16x16x32_bf16 a[216:219], a[176:179], a[208:211], 0
  ds_read_b64_tr_b16 a[136:137], v1 offset:43008
  v_mfma_f32_16x16x32_bf16 a[216:219], a[180:183], a[212:215], a[216:219]
  v_mfma_f32_16x16x32_bf16 a[220:223], a[184:187], a[208:211], 0
  buffer_load_dwordx4 a[120:123], v0, s[36:39], s57 offen offset:2048 sc1
  v_mfma_f32_16x16x32_bf16 a[220:223], a[188:191], a[212:215], a[220:223]
  ds_read_b64_tr_b16 a[138:139], v1 offset:46592
  v_mfma_f32_16x16x32_bf16 a[224:227], a[192:195], a[208:211], 0
  ds_read_b64_tr_b16 a[140:141], v1 offset:50176
  v_mfma_f32_16x16x32_bf16 a[224:227], a[196:199], a[212:215], a[224:227]
  v_mfma_f32_16x16x32_bf16 a[228:231], a[200:203], a[208:211], 0
  ds_read_b64_tr_b16 a[142:143], v1 offset:53760
  v_mfma_f32_16x16x32_bf16 a[228:231], a[204:207], a[212:215], a[228:231]
  s_waitcnt lgkmcnt(8)
  v_mfma_f32_16x16x32_bf16 v[96:99], a[160:163], a[64:67], v[96:99]
  ds_read_b64_tr_b16 a[144:145], v1 offset:43040
  v_mfma_f32_16x16x32_bf16 v[96:99], a[164:167], a[80:83], v[96:99]
  buffer_load_dwordx4 v6, s[16:19], s56 offen offset:3072 lds
  v_mfma_f32_16x16x32_bf16 v[100:103], a[164:167], a[84:87], v[100:103]
  s_lshl2_add_u32 s76, s58, s44
  ds_read_b64_tr_b16 a[146:147], v1 offset:46624
  s_lshl_b32 s76, s76, 13
  v_mfma_f32_16x16x32_bf16 v[100:103], a[160:163], a[68:71], v[100:103]
  s_add_u32 s76, s76, 262144
  s_add_u32 s77, s76, 4096
  v_mfma_f32_16x16x32_bf16 v[104:107], a[160:163], a[72:75], v[104:107]
  ds_read_b64_tr_b16 a[148:149], v1 offset:50208
  v_mfma_f32_16x16x32_bf16 v[104:107], a[164:167], a[88:91], v[104:107]
  v_mfma_f32_16x16x32_bf16 v[108:111], a[164:167], a[92:95], v[108:111]
  ds_read_b64_tr_b16 a[150:151], v1 offset:53792
  v_mfma_f32_16x16x32_bf16 v[108:111], a[160:163], a[76:79], v[108:111]
  buffer_load_dwordx4 a[176:179], v0, s[36:39], s76 offen offset:0 sc1
  v_mfma_f32_16x16x32_bf16 v[124:127], a[168:171], a[76:79], v[124:127]
Hc2:
  s_cbranch_execz Hc2_1
  ds_read_b64_tr_b16 a[152:153], v1 offset:43072
  v_mfma_f32_16x16x32_bf16 v[124:127], a[172:175], a[92:95], v[124:127]
  v_mfma_f32_16x16x32_bf16 v[120:123], a[172:175], a[88:91], v[120:123]
  ds_read_b64_tr_b16 a[154:155], v1 offset:46656
  v_mfma_f32_16x16x32_bf16 v[120:123], a[168:171], a[72:75], v[120:123]
  v_mfma_f32_16x16x32_bf16 v[116:119], a[168:171], a[68:71], v[116:119]
  buffer_load_dwordx4 a[124:127], v0, s[36:39], s57 offen offset:3072 sc1
  s_add_u32 m0, s84, 90112
  v_mfma_f32_16x16x32_bf16 v[116:119], a[172:175], a[84:87], v[116:119]
  ds_read_b64_tr_b16 a[156:157], v1 offset:50240
  v_mfma_f32_16x16x32_bf16 v[112:115], a[172:175], a[80:83], v[112:115]
  ds_read_b64_tr_b16 a[158:159], v1 offset:53824
  v_mfma_f32_16x16x32_bf16 v[112:115], a[168:171], a[64:67], v[112:115]
  s_waitcnt lgkmcnt(8)
  v_mfma_f32_16x16x32_bf16 v[128:131], a[128:131], a[64:67], v[128:131]
  ds_read_b64_tr_b16 a[160:161], v1 offset:43104
  v_mfma_f32_16x16x32_bf16 v[128:131], a[132:135], a[80:83], v[128:131]
  buffer_load_dwordx4 v7, s[16:19], s56 offen offset:0 lds
  s_bfe_u32 s57, s83, 0x40000
  v_mfma_f32_16x16x32_bf16 v[132:135], a[132:135], a[84:87], v[132:135]
  s_lshl_b32 s57, s57, 13
  s_add_u32 s57, s57, s85
  ds_read_b64_tr_b16 a[162:163], v1 offset:46688
  v_mfma_f32_16x16x32_bf16 v[132:135], a[128:131], a[68:71], v[132:135]
  v_mfma_f32_16x16x32_bf16 v[136:139], a[128:131], a[72:75], v[136:139]
  ds_read_b64_tr_b16 a[164:165], v1 offset:50272
  v_mfma_f32_16x16x32_bf16 v[136:139], a[132:135], a[88:91], v[136:139]
  v_mfma_f32_16x16x32_bf16 v[140:143], a[132:135], a[92:95], v[140:143]
  buffer_load_dwordx4 a[0:3], v0, s[36:39], s57 offen offset:0 sc1
  v_mfma_f32_16x16x32_bf16 v[140:143], a[128:131], a[76:79], v[140:143]
  ds_read_b64_tr_b16 a[166:167], v1 offset:53856
  v_mfma_f32_16x16x32_bf16 v[156:159], a[136:139], a[76:79], v[156:159]
  ds_read_b64_tr_b16 a[168:169], v1 offset:43136
  v_mfma_f32_16x16x32_bf16 v[156:159], a[140:143], a[92:95], v[156:159]
  v_mfma_f32_16x16x32_bf16 v[152:155], a[140:143], a[88:91], v[152:155]
  ds_read_b64_tr_b16 a[170:171], v1 offset:46720
  v_mfma_f32_16x16x32_bf16 v[152:155], a[136:139], a[72:75], v[152:155]
  buffer_load_dwordx4 a[180:183], v0, s[36:39], s76 offen offset:1024 sc1
  v_mfma_f32_16x16x32_bf16 v[148:151], a[136:139], a[68:71], v[148:151]
  ds_read_b64_tr_b16 a[172:173], v1 offset:50304
  v_mfma_f32_16x16x32_bf16 v[148:151], a[140:143], a[84:87], v[148:151]
  v_mfma_f32_16x16x32_bf16 v[144:147], a[140:143], a[80:83], v[144:147]
  ds_read_b64_tr_b16 a[174:175], v1 offset:53888
  v_mfma_f32_16x16x32_bf16 v[144:147], a[136:139], a[64:67], v[144:147]
  s_waitcnt lgkmcnt(8)
  v_mfma_f32_16x16x32_bf16 v[160:163], a[144:147], a[64:67], v[160:163]
  buffer_load_dwordx4 v8, s[16:19], s56 offen offset:1024 lds
  v_mfma_f32_16x16x32_bf16 v[160:163], a[148:151], a[80:83], v[160:163]
  ds_read_b64_tr_b16 a[128:129], v1 offset:43168
  v_mfma_f32_16x16x32_bf16 v[164:167], a[148:151], a[84:87], v[164:167]
  ds_read_b64_tr_b16 a[130:131], v1 offset:46752
  v_mfma_f32_16x16x32_bf16 v[164:167], a[144:147], a[68:71], v[164:167]
  v_mfma_f32_16x16x32_bf16 v[168:171], a[144:147], a[72:75], v[168:171]
  ds_read_b64_tr_b16 a[132:133], v1 offset:50336
  v_mfma_f32_16x16x32_bf16 v[168:171], a[148:151], a[88:91], v[168:171]
  buffer_load_dwordx4 a[4:7], v0, s[36:39], s57 offen offset:1024 sc1
  v_mfma_f32_16x16x32_bf16 v[172:175], a[148:151], a[92:95], v[172:175]
  ds_read_b64_tr_b16 a[134:135], v1 offset:53920
  v_mfma_f32_16x16x32_bf16 v[172:175], a[144:147], a[76:79], v[172:175]
  s_waitcnt vmcnt(16)
  s_barrier
  v_mfma_f32_16x16x32_bf16 v[188:191], a[152:155], a[76:79], v[188:191]
  ds_read_b64_tr_b16 a[136:137], v1 offset:43200
  v_mfma_f32_16x16x32_bf16 v[188:191], a[156:159], a[92:95], v[188:191]
  v_mfma_f32_16x16x32_bf16 v[184:187], a[156:159], a[88:91], v[184:187]
  ds_read_b64_tr_b16 a[138:139], v1 offset:46784
  v_mfma_f32_16x16x32_bf16 v[184:187], a[152:155], a[72:75], v[184:187]
  buffer_load_dwordx4 a[184:187], v0, s[36:39], s76 offen offset:2048 sc1
  v_mfma_f32_16x16x32_bf16 v[180:183], a[152:155], a[68:71], v[180:183]
  ds_read_b64_tr_b16 a[140:141], v1 offset:50368
  v_mfma_f32_16x16x32_bf16 v[180:183], a[156:159], a[84:87], v[180:183]
  v_mfma_f32_16x16x32_bf16 v[176:179], a[156:159], a[80:83], v[176:179]
  ds_read_b64_tr_b16 a[142:143], v1 offset:53952
  v_mfma_f32_16x16x32_bf16 v[176:179], a[152:155], a[64:67], v[176:179]
  s_waitcnt lgkmcnt(8)
  v_mfma_f32_16x16x32_bf16 v[192:195], a[160:163], a[64:67], v[192:195]
  buffer_load_dwordx4 v9, s[16:19], s56 offen offset:2048 lds
  v_mfma_f32_16x16x32_bf16 v[192:195], a[164:167], a[80:83], v[192:195]
  ds_read_b64_tr_b16 a[144:145], v2 offset:0
  v_mfma_f32_16x16x32_bf16 v[196:199], a[164:167], a[84:87], v[196:199]
  ds_read_b64_tr_b16 a[146:147], v2 offset:3584
  v_mfma_f32_16x16x32_bf16 v[196:199], a[160:163], a[68:71], v[196:199]
  v_mfma_f32_16x16x32_bf16 v[200:203], a[160:163], a[72:75], v[200:203]
  ds_read_b64_tr_b16 a[148:149], v2 offset:7168
  v_mfma_f32_16x16x32_bf16 v[200:203], a[164:167], a[88:91], v[200:203]
  buffer_load_dwordx4 a[8:11], v0, s[36:39], s57 offen offset:2048 sc1
  v_mfma_f32_16x16x32_bf16 v[204:207], a[164:167], a[92:95], v[204:207]
  ds_read_b64_tr_b16 a[150:151], v2 offset:10752
  v_mfma_f32_16x16x32_bf16 v[204:207], a[160:163], a[76:79], v[204:207]
  v_mfma_f32_16x16x32_bf16 v[220:223], a[168:171], a[76:79], v[220:223]
  ds_read_b64_tr_b16 a[152:153], v2 offset:32
  v_mfma_f32_16x16x32_bf16 v[220:223], a[172:175], a[92:95], v[220:223]
  buffer_load_dwordx4 a[188:191], v0, s[36:39], s76 offen offset:3072 sc1
  v_mfma_f32_16x16x32_bf16 v[216:219], a[172:175], a[88:91], v[216:219]
  ds_read_b64_tr_b16 a[154:155], v2 offset:3616
  v_mfma_f32_16x16x32_bf16 v[216:219], a[168:171], a[72:75], v[216:219]
  v_mfma_f32_16x16x32_bf16 v[212:215], a[168:171], a[68:71], v[212:215]
  ds_read_b64_tr_b16 a[156:157], v2 offset:7200
  v_mfma_f32_16x16x32_bf16 v[212:215], a[172:175], a[84:87], v[212:215]
  v_mfma_f32_16x16x32_bf16 v[208:211], a[172:175], a[80:83], v[208:211]
  buffer_load_dwordx4 a[12:15], v0, s[36:39], s57 offen offset:3072 sc1
  v_mfma_f32_16x16x32_bf16 v[208:211], a[168:171], a[64:67], v[208:211]
  s_waitcnt lgkmcnt(7)
  ds_read_b64_tr_b16 a[158:159], v2 offset:10784
  v_mfma_f32_16x16x32_bf16 v[224:227], a[128:131], a[64:67], v[224:227]
  ds_read_b64_tr_b16 a[160:161], v2 offset:64
  v_mfma_f32_16x16x32_bf16 v[224:227], a[132:135], a[80:83], v[224:227]
  s_bfe_u32 s56, s83, 0x30004
  s_lshl_b32 s56, s56, 2
  s_bitcmp1_b32 s83, 7
  v_mfma_f32_16x16x32_bf16 v[228:231], a[132:135], a[84:87], v[228:231]
  buffer_load_dwordx4 a[192:195], v0, s[36:39], s77 offen offset:0 sc1
  s_addc_u32 s56, s56, 0
  v_mfma_f32_16x16x32_bf16 v[228:231], a[128:131], a[68:71], v[228:231]
  s_mul_i32 s56, s56, 229376
  s_add_u32 m0, s84, 0
  ds_read_b64_tr_b16 a[162:163], v2 offset:3648
  v_mfma_f32_16x16x32_bf16 v[232:235], a[128:131], a[72:75], v[232:235]
  ds_read_b64_tr_b16 a[164:165], v2 offset:7232
  v_mfma_f32_16x16x32_bf16 v[232:235], a[132:135], a[88:91], v[232:235]
  v_mfma_f32_16x16x32_bf16 v[236:239], a[132:135], a[92:95], v[236:239]
  ds_read_b64_tr_b16 a[166:167], v2 offset:10816
  v_mfma_f32_16x16x32_bf16 v[236:239], a[128:131], a[76:79], v[236:239]
  buffer_load_dwordx4 v3, s[16:19], s56 offen offset:0 lds
  v_mfma_f32_16x16x32_bf16 v[252:255], a[136:139], a[76:79], v[252:255]
  ds_read_b64_tr_b16 a[168:169], v2 offset:96
  v_mfma_f32_16x16x32_bf16 v[252:255], a[140:143], a[92:95], v[252:255]
  v_mfma_f32_16x16x32_bf16 v[248:251], a[140:143], a[88:91], v[248:251]
  ds_read_b64_tr_b16 a[170:171], v2 offset:3680
  v_mfma_f32_16x16x32_bf16 v[248:251], a[136:139], a[72:75], v[248:251]
  buffer_load_dwordx4 a[196:199], v0, s[36:39], s77 offen offset:1024 sc1
  v_mfma_f32_16x16x32_bf16 v[244:247], a[136:139], a[68:71], v[244:247]
  ds_read_b64_tr_b16 a[172:173], v2 offset:7264
  v_mfma_f32_16x16x32_bf16 v[244:247], a[140:143], a[84:87], v[244:247]
  v_mfma_f32_16x16x32_bf16 v[240:243], a[140:143], a[80:83], v[240:243]
  ds_read_b64_tr_b16 a[174:175], v2 offset:10848
  v_mfma_f32_16x16x32_bf16 v[240:243], a[136:139], a[64:67], v[240:243]
  s_waitcnt vmcnt(13) lgkmcnt(8)
  v_mfma_f32_16x16x32_bf16 v[32:35], a[144:147], a[96:99], v[32:35]
  s_add_u32 s57, s57, 4096
  ds_read_b64_tr_b16 a[128:129], v2 offset:128
  v_mfma_f32_16x16x32_bf16 v[32:35], a[148:151], a[112:115], v[32:35]
  buffer_load_dwordx4 a[200:203], v0, s[36:39], s77 offen offset:2048 sc1
  v_mfma_f32_16x16x32_bf16 v[36:39], a[148:151], a[116:119], v[36:39]
  ds_read_b64_tr_b16 a[130:131], v2 offset:3712
  v_mfma_f32_16x16x32_bf16 v[36:39], a[144:147], a[100:103], v[36:39]
  v_mfma_f32_16x16x32_bf16 v[40:43], a[144:147], a[104:107], v[40:43]
  ds_read_b64_tr_b16 a[132:133], v2 offset:7296
  v_mfma_f32_16x16x32_bf16 v[40:43], a[148:151], a[120:123], v[40:43]
  v_mfma_f32_16x16x32_bf16 v[44:47], a[148:151], a[124:127], v[44:47]
  buffer_load_dwordx4 a[16:19], v0, s[36:39], s57 offen offset:0 sc1
  v_mfma_f32_16x16x32_bf16 v[44:47], a[144:147], a[108:111], v[44:47]
  ds_read_b64_tr_b16 a[134:135], v2 offset:10880
  v_mfma_f32_16x16x32_bf16 v[60:63], a[152:155], a[108:111], v[60:63]
  ds_read_b64_tr_b16 a[136:137], v2 offset:160
  v_mfma_f32_16x16x32_bf16 v[60:63], a[156:159], a[124:127], v[60:63]
  v_mfma_f32_16x16x32_bf16 v[56:59], a[156:159], a[120:123], v[56:59]
  ds_read_b64_tr_b16 a[138:139], v2 offset:3744
  v_mfma_f32_16x16x32_bf16 v[56:59], a[152:155], a[104:107], v[56:59]
  buffer_load_dwordx4 v4, s[16:19], s56 offen offset:1024 lds
  v_mfma_f32_16x16x32_bf16 v[52:55], a[152:155], a[100:103], v[52:55]
  ds_read_b64_tr_b16 a[140:141], v2 offset:7328
  v_mfma_f32_16x16x32_bf16 v[52:55], a[156:159], a[116:119], v[52:55]
  buffer_load_dwordx4 a[204:207], v0, s[36:39], s77 offen offset:3072 sc1
  v_mfma_f32_16x16x32_bf16 v[48:51], a[156:159], a[112:115], v[48:51]
  ds_read_b64_tr_b16 a[142:143], v2 offset:10912
  v_mfma_f32_16x16x32_bf16 v[48:51], a[152:155], a[96:99], v[48:51]
  s_waitcnt lgkmcnt(8)
  v_mfma_f32_16x16x32_bf16 v[64:67], a[160:163], a[96:99], v[64:67]
  ds_read_b64_tr_b16 a[144:145], v2 offset:192
  v_mfma_f32_16x16x32_bf16 v[64:67], a[164:167], a[112:115], v[64:67]
  v_mfma_f32_16x16x32_bf16 v[68:71], a[164:167], a[116:119], v[68:71]
  ds_read_b64_tr_b16 a[146:147], v2 offset:3776
  v_mfma_f32_16x16x32_bf16 v[68:71], a[160:163], a[100:103], v[68:71]
  buffer_load_dwordx4 a[20:23], v0, s[36:39], s57 offen offset:1024 sc1
  v_mfma_f32_16x16x32_bf16 v[72:75], a[160:163], a[104:107], v[72:75]
  ds_read_b64_tr_b16 a[148:149], v2 offset:7360
  v_mfma_f32_16x16x32_bf16 v[72:75], a[164:167], a[120:123], v[72:75]
  v_mfma_f32_16x16x32_bf16 v[76:79], a[164:167], a[124:127], v[76:79]
  ds_read_b64_tr_b16 a[150:151], v2 offset:10944
  v_mfma_f32_16x16x32_bf16 v[76:79], a[160:163], a[108:111], v[76:79]
  v_mfma_f32_16x16x32_bf16 v[92:95], a[168:171], a[108:111], v[92:95]
  ds_read_b64_tr_b16 a[152:153], v2 offset:14336
  v_mfma_f32_16x16x32_bf16 v[92:95], a[172:175], a[124:127], v[92:95]
  v_mfma_f32_16x16x32_bf16 v[88:91], a[172:175], a[120:123], v[88:91]
  buffer_load_dwordx4 v5, s[16:19], s56 offen offset:2048 lds
  v_mfma_f32_16x16x32_bf16 v[88:91], a[168:171], a[104:107], v[88:91]
  ds_read_b64_tr_b16 a[154:155], v2 offset:17920
  v_mfma_f32_16x16x32_bf16 v[84:87], a[168:171], a[100:103], v[84:87]
  ds_read_b64_tr_b16 a[156:157], v2 offset:21504
  v_mfma_f32_16x16x32_bf16 v[84:87], a[172:175], a[116:119], v[84:87]
  v_mfma_f32_16x16x32_bf16 v[80:83], a[172:175], a[112:115], v[80:83]
  ds_read_b64_tr_b16 a[158:159], v2 offset:25088
  v_mfma_f32_16x16x32_bf16 v[80:83], a[168:171], a[96:99], v[80:83]
  s_waitcnt lgkmcnt(8)
  v_mfma_f32_16x16x32_bf16 v[96:99], a[128:131], a[96:99], v[96:99]
  ds_read_b64_tr_b16 a[160:161], v2 offset:14368
  v_mfma_f32_16x16x32_bf16 v[96:99], a[132:135], a[112:115], v[96:99]
  v_mfma_f32_16x16x32_bf16 v[100:103], a[132:135], a[116:119], v[100:103]
  buffer_load_dwordx4 a[24:27], v0, s[36:39], s57 offen offset:2048 sc1
  v_mfma_f32_16x16x32_bf16 v[100:103], a[128:131], a[100:103], v[100:103]
  ds_read_b64_tr_b16 a[162:163], v2 offset:17952
  v_mfma_f32_16x16x32_bf16 v[104:107], a[128:131], a[104:107], v[104:107]
  ds_read_b64_tr_b16 a[164:165], v2 offset:21536
  v_mfma_f32_16x16x32_bf16 v[104:107], a[132:135], a[120:123], v[104:107]
  v_mfma_f32_16x16x32_bf16 v[108:111], a[132:135], a[124:127], v[108:111]
  ds_read_b64_tr_b16 a[166:167], v2 offset:25120
  v_mfma_f32_16x16x32_bf16 v[108:111], a[128:131], a[108:111], v[108:111]
  v_mfma_f32_16x16x32_bf16 v[124:127], a[136:139], a[108:111], v[124:127]
  ds_read_b64_tr_b16 a[168:169], v2 offset:14400
  v_mfma_f32_16x16x32_bf16 v[124:127], a[140:143], a[124:127], v[124:127]
  buffer_load_dwordx4 v6, s[16:19], s56 offen offset:3072 lds
  v_mfma_f32_16x16x32_bf16 v[120:123], a[140:143], a[120:123], v[120:123]
  ds_read_b64_tr_b16 a[170:171], v2 offset:17984
  v_mfma_f32_16x16x32_bf16 v[120:123], a[136:139], a[104:107], v[120:123]
  v_mfma_f32_16x16x32_bf16 v[116:119], a[136:139], a[100:103], v[116:119]
  ds_read_b64_tr_b16 a[172:173], v2 offset:21568
  v_mfma_f32_16x16x32_bf16 v[116:119], a[140:143], a[116:119], v[116:119]
  v_mfma_f32_16x16x32_bf16 v[112:115], a[140:143], a[112:115], v[112:115]
  ds_read_b64_tr_b16 a[174:175], v2 offset:25152
  v_mfma_f32_16x16x32_bf16 v[112:115], a[136:139], a[96:99], v[112:115]
  s_waitcnt lgkmcnt(8)
  v_mfma_f32_16x16x32_bf16 v[128:131], a[144:147], a[96:99], v[128:131]
  ds_read_b64_tr_b16 a[128:129], v2 offset:14432
  v_mfma_f32_16x16x32_bf16 v[128:131], a[148:151], a[112:115], v[128:131]
  buffer_load_dwordx4 a[28:31], v0, s[36:39], s57 offen offset:3072 sc1
  v_mfma_f32_16x16x32_bf16 v[132:135], a[148:151], a[116:119], v[132:135]
  ds_read_b64_tr_b16 a[130:131], v2 offset:18016
  v_mfma_f32_16x16x32_bf16 v[132:135], a[144:147], a[100:103], v[132:135]
  v_mfma_f32_16x16x32_bf16 v[136:139], a[144:147], a[104:107], v[136:139]
  s_add_u32 m0, s84, 4096
  ds_read_b64_tr_b16 a[132:133], v2 offset:21600
  v_mfma_f32_16x16x32_bf16 v[136:139], a[148:151], a[120:123], v[136:139]
  v_mfma_f32_16x16x32_bf16 v[140:143], a[148:151], a[124:127], v[140:143]
  ds_read_b64_tr_b16 a[134:135], v2 offset:25184
  v_mfma_f32_16x16x32_bf16 v[140:143], a[144:147], a[108:111], v[140:143]
  v_mfma_f32_16x16x32_bf16 v[156:159], a[152:155], a[108:111], v[156:159]
  buffer_load_dwordx4 v7, s[16:19], s56 offen offset:0 lds
  s_bfe_u32 s57, s83, 0x40004
  v_mfma_f32_16x16x32_bf16 v[156:159], a[156:159], a[124:127], v[156:159]
  s_lshl_b32 s57, s57, 13
  s_add_u32 s57, s57, s85
  ds_read_b64_tr_b16 a[136:137], v2 offset:14464
  v_mfma_f32_16x16x32_bf16 v[152:155], a[156:159], a[120:123], v[152:155]
  ds_read_b64_tr_b16 a[138:139], v2 offset:18048
  v_mfma_f32_16x16x32_bf16 v[152:155], a[152:155], a[104:107], v[152:155]
  v_mfma_f32_16x16x32_bf16 v[148:151], a[152:155], a[100:103], v[148:151]
  ds_read_b64_tr_b16 a[140:141], v2 offset:21632
  v_mfma_f32_16x16x32_bf16 v[148:151], a[156:159], a[116:119], v[148:151]
  buffer_load_dwordx4 a[32:35], v0, s[36:39], s57 offen offset:0 sc1
  v_mfma_f32_16x16x32_bf16 v[144:147], a[156:159], a[112:115], v[144:147]
  ds_read_b64_tr_b16 a[142:143], v2 offset:25216
  v_mfma_f32_16x16x32_bf16 v[144:147], a[152:155], a[96:99], v[144:147]
  s_waitcnt lgkmcnt(8)
  v_mfma_f32_16x16x32_bf16 v[160:163], a[160:163], a[96:99], v[160:163]
  s_waitcnt vmcnt(7)
  ds_read_b64_tr_b16 a[144:145], v2 offset:14496
  v_accvgpr_read_b32 v22, a176
  v_mfma_f32_16x16x32_bf16 v[160:163], a[164:167], a[112:115], v[160:163]
  v_accvgpr_read_b32 v23, a177
  v_accvgpr_read_b32 v24, a178
  v_mfma_f32_16x16x32_bf16 v[164:167], a[164:167], a[116:119], v[164:167]
  ds_read_b64_tr_b16 a[146:147], v2 offset:18080
  v_accvgpr_read_b32 v25, a179
  v_mfma_f32_16x16x32_bf16 v[164:167], a[160:163], a[100:103], v[164:167]
  v_accvgpr_read_b32 v26, a180
  v_accvgpr_read_b32 v27, a181
  v_mfma_f32_16x16x32_bf16 v[168:171], a[160:163], a[104:107], v[168:171]
  ds_read_b64_tr_b16 a[148:149], v2 offset:21664
  v_accvgpr_read_b32 v28, a182
  v_mfma_f32_16x16x32_bf16 v[168:171], a[164:167], a[120:123], v[168:171]
  v_accvgpr_read_b32 v29, a183
  v_add_f32 v22, v22, v26
  v_mfma_f32_16x16x32_bf16 v[172:175], a[164:167], a[124:127], v[172:175]
  ds_read_b64_tr_b16 a[150:151], v2 offset:25248
  v_add_f32 v23, v23, v27
  v_mfma_f32_16x16x32_bf16 v[172:175], a[160:163], a[108:111], v[172:175]
  s_waitcnt vmcnt(17)
  s_barrier
  buffer_load_dwordx4 v8, s[16:19], s56 offen offset:1024 lds
  v_add_f32 v24, v24, v28
  v_mfma_f32_16x16x32_bf16 v[188:191], a[168:171], a[108:111], v[188:191]
  ds_read_b64_tr_b16 a[152:153], v2 offset:14528
  v_add_f32 v25, v25, v29
  v_mfma_f32_16x16x32_bf16 v[188:191], a[172:175], a[124:127], v[188:191]
  v_accvgpr_read_b32 v26, a184
  v_accvgpr_read_b32 v27, a185
  v_mfma_f32_16x16x32_bf16 v[184:187], a[172:175], a[120:123], v[184:187]
  ds_read_b64_tr_b16 a[154:155], v2 offset:18112
  v_accvgpr_read_b32 v28, a186
  v_mfma_f32_16x16x32_bf16 v[184:187], a[168:171], a[104:107], v[184:187]
  v_accvgpr_read_b32 v29, a187
  v_add_f32 v22, v22, v26
  v_mfma_f32_16x16x32_bf16 v[180:183], a[168:171], a[100:103], v[180:183]
  buffer_load_dwordx4 a[36:39], v0, s[36:39], s57 offen offset:1024 sc1
  v_add_f32 v23, v23, v27
  v_mfma_f32_16x16x32_bf16 v[180:183], a[172:175], a[116:119], v[180:183]
  ds_read_b64_tr_b16 a[156:157], v2 offset:21696
  v_add_f32 v24, v24, v28
  v_mfma_f32_16x16x32_bf16 v[176:179], a[172:175], a[112:115], v[176:179]
  ds_read_b64_tr_b16 a[158:159], v2 offset:25280
  v_add_f32 v25, v25, v29
  v_mfma_f32_16x16x32_bf16 v[176:179], a[168:171], a[96:99], v[176:179]
  s_waitcnt lgkmcnt(8)
  v_accvgpr_read_b32 v26, a188
  v_accvgpr_read_b32 v27, a189
  v_mfma_f32_16x16x32_bf16 v[192:195], a[128:131], a[96:99], v[192:195]
  ds_read_b64_tr_b16 a[160:161], v2 offset:28672
  v_accvgpr_read_b32 v28, a190
  v_mfma_f32_16x16x32_bf16 v[192:195], a[132:135], a[112:115], v[192:195]
  v_accvgpr_read_b32 v29, a191
  v_add_f32 v22, v22, v26
  v_mfma_f32_16x16x32_bf16 v[196:199], a[132:135], a[116:119], v[196:199]
  ds_read_b64_tr_b16 a[162:163], v2 offset:32256
  v_add_f32 v23, v23, v27
  v_mfma_f32_16x16x32_bf16 v[196:199], a[128:131], a[100:103], v[196:199]
  v_add_f32 v24, v24, v28
  v_add_f32 v25, v25, v29
  v_mfma_f32_16x16x32_bf16 v[200:203], a[128:131], a[104:107], v[200:203]
  ds_read_b64_tr_b16 a[164:165], v2 offset:35840
  v_mov_b32 v26, v22
  v_mfma_f32_16x16x32_bf16 v[200:203], a[132:135], a[120:123], v[200:203]
  v_mov_b32 v27, v23
  v_mov_b32 v28, v24
  v_mfma_f32_16x16x32_bf16 v[204:207], a[132:135], a[124:127], v[204:207]
  buffer_load_dwordx4 v9, s[16:19], s56 offen offset:2048 lds
  v_mov_b32 v29, v25
  v_mfma_f32_16x16x32_bf16 v[204:207], a[128:131], a[108:111], v[204:207]
  ds_read_b64_tr_b16 a[166:167], v2 offset:39424
  v_permlane16_swap_b32 v22, v26
  v_mfma_f32_16x16x32_bf16 v[220:223], a[136:139], a[108:111], v[220:223]
  ds_read_b64_tr_b16 a[168:169], v2 offset:28704
  v_permlane16_swap_b32 v23, v27
  v_mfma_f32_16x16x32_bf16 v[220:223], a[140:143], a[124:127], v[220:223]
  v_permlane16_swap_b32 v24, v28
  v_permlane16_swap_b32 v25, v29
  v_mfma_f32_16x16x32_bf16 v[216:219], a[140:143], a[120:123], v[216:219]
  s_add_u32 s59, s59, 16384
  ds_read_b64_tr_b16 a[170:171], v2 offset:32288
  v_add_f32 v22, v22, v26
  v_mfma_f32_16x16x32_bf16 v[216:219], a[136:139], a[104:107], v[216:219]
  buffer_load_dwordx4 a[40:43], v0, s[36:39], s57 offen offset:2048 sc1
  v_add_f32 v23, v23, v27
  v_mfma_f32_16x16x32_bf16 v[212:215], a[136:139], a[100:103], v[212:215]
  ds_read_b64_tr_b16 a[172:173], v2 offset:35872
  v_add_f32 v24, v24, v28
  v_mfma_f32_16x16x32_bf16 v[212:215], a[140:143], a[116:119], v[212:215]
  v_add_f32 v25, v25, v29
  v_mov_b32 v26, v22
  v_mfma_f32_16x16x32_bf16 v[208:211], a[140:143], a[112:115], v[208:211]
  ds_read_b64_tr_b16 a[174:175], v2 offset:39456
  v_mov_b32 v27, v23
  v_mfma_f32_16x16x32_bf16 v[208:211], a[136:139], a[96:99], v[208:211]
  s_waitcnt lgkmcnt(8)
  v_mov_b32 v28, v24
  v_mov_b32 v29, v25
  v_mfma_f32_16x16x32_bf16 v[224:227], a[144:147], a[96:99], v[224:227]
  buffer_load_dwordx4 a[208:211], v0, s[36:39], s59 offen offset:0 sc1
  v_permlane32_swap_b32 v22, v26
  v_mfma_f32_16x16x32_bf16 v[224:227], a[148:151], a[112:115], v[224:227]
  ds_read_b64_tr_b16 a[128:129], v2 offset:28736
  v_permlane32_swap_b32 v23, v27
  v_mfma_f32_16x16x32_bf16 v[228:231], a[148:151], a[116:119], v[228:231]
  ds_read_b64_tr_b16 a[130:131], v2 offset:32320
  v_permlane32_swap_b32 v24, v28
  v_mfma_f32_16x16x32_bf16 v[228:231], a[144:147], a[100:103], v[228:231]
  v_permlane32_swap_b32 v25, v29
  v_add_f32 v22, v22, v26
  v_mfma_f32_16x16x32_bf16 v[232:235], a[144:147], a[104:107], v[232:235]
  ds_read_b64_tr_b16 a[132:133], v2 offset:35904
  v_add_f32 v23, v23, v27
  v_mfma_f32_16x16x32_bf16 v[232:235], a[148:151], a[120:123], v[232:235]
  buffer_load_dwordx4 a[212:215], v0, s[36:39], s59 offen offset:1024 sc1
  v_add_f32 v24, v24, v28
  v_mfma_f32_16x16x32_bf16 v[236:239], a[148:151], a[124:127], v[236:239]
  ds_read_b64_tr_b16 a[134:135], v2 offset:39488
  v_add_f32 v25, v25, v29
  v_mfma_f32_16x16x32_bf16 v[236:239], a[144:147], a[108:111], v[236:239]
  v_mul_f32 v22, 0x3a800000, v22
  v_mul_f32 v23, 0x3a800000, v23
  v_mfma_f32_16x16x32_bf16 v[252:255], a[152:155], a[108:111], v[252:255]
  ds_read_b64_tr_b16 a[136:137], v2 offset:28768
  v_fma_f32 v23, -v22, v22, v23
  v_mfma_f32_16x16x32_bf16 v[252:255], a[156:159], a[124:127], v[252:255]
  v_max_f32 v23, 0, v23
  v_cvt_pk_bf16_f32 v23, v23, v23
  v_mfma_f32_16x16x32_bf16 v[248:251], a[156:159], a[120:123], v[248:251]
  buffer_load_dwordx4 a[44:47], v0, s[36:39], s57 offen offset:3072 sc1
  s_bfe_u32 s56, s83, 0x30008
  v_mfma_f32_16x16x32_bf16 v[248:251], a[152:155], a[104:107], v[248:251]
  s_lshl_b32 s56, s56, 2
  s_bitcmp1_b32 s83, 11
  s_addc_u32 s56, s56, 0
  v_mfma_f32_16x16x32_bf16 v[244:247], a[152:155], a[100:103], v[244:247]
  s_mul_i32 s56, s56, 229376
  s_add_u32 m0, s84, 28672
  ds_read_b64_tr_b16 a[138:139], v2 offset:32352
  v_mfma_f32_16x16x32_bf16 v[244:247], a[156:159], a[116:119], v[244:247]
  ds_read_b64_tr_b16 a[140:141], v2 offset:35936
  v_lshlrev_b32 v23, 16, v23
  v_mfma_f32_16x16x32_bf16 v[240:243], a[156:159], a[112:115], v[240:243]
  ds_read_b64_tr_b16 a[142:143], v2 offset:39520
  v_add_f32 v23, 0x3727c5ac, v23
  v_mfma_f32_16x16x32_bf16 v[240:243], a[152:155], a[96:99], v[240:243]
  s_waitcnt vmcnt(9) lgkmcnt(8)
  buffer_load_dwordx4 v3, s[16:19], s56 offen offset:0 lds
  v_cvt_pk_bf16_f32 v23, v23, v23
  v_mfma_f32_16x16x32_bf16 v[32:35], a[160:163], a[0:3], v[32:35]
  s_add_u32 s57, s57, 4096
  ds_read_b64_tr_b16 a[144:145], v2 offset:28800
  v_lshlrev_b32 v23, 16, v23
  v_mfma_f32_16x16x32_bf16 v[32:35], a[164:167], a[16:19], v[32:35]
  s_barrier
  v_sqrt_f32 v23, v23
  v_mfma_f32_16x16x32_bf16 v[36:39], a[164:167], a[20:23], v[36:39]
  s_nop 0
  ds_read_b64_tr_b16 a[146:147], v2 offset:32384
  v_cvt_pk_bf16_f32 v12, -v22, v23
  v_mfma_f32_16x16x32_bf16 v[36:39], a[160:163], a[4:7], v[36:39]
  v_and_b32 v23, 0xffff0000, v12
  v_mfma_f32_16x16x32_bf16 v[40:43], a[160:163], a[8:11], v[40:43]
  buffer_load_dwordx4 a[48:51], v0, s[36:39], s57 offen offset:0 sc1
  v_mfma_f32_16x16x32_bf16 v[40:43], a[164:167], a[24:27], v[40:43]
  ds_read_b64_tr_b16 a[148:149], v2 offset:35968
  v_mfma_f32_16x16x32_bf16 v[44:47], a[164:167], a[28:31], v[44:47]
  ds_read_b64_tr_b16 a[150:151], v2 offset:39552
  v_mfma_f32_16x16x32_bf16 v[44:47], a[160:163], a[12:15], v[44:47]
  v_rcp_f32 v10, v23
  v_mfma_f32_16x16x32_bf16 v[60:63], a[168:171], a[12:15], v[60:63]
  ds_read_b64_tr_b16 a[152:153], v2 offset:28832
  v_mul_f32 v11, v23, v23
  v_mfma_f32_16x16x32_bf16 v[60:63], a[172:175], a[28:31], v[60:63]
  v_mul_f32 v10, 0xbfb8aa3b, v10
  v_mul_f32 v24, 0x3a800000, v24
  v_mfma_f32_16x16x32_bf16 v[56:59], a[172:175], a[24:27], v[56:59]
  ds_read_b64_tr_b16 a[154:155], v2 offset:32416
  v_mul_f32 v25, 0x3a800000, v25
  v_mfma_f32_16x16x32_bf16 v[56:59], a[168:171], a[8:11], v[56:59]
  buffer_load_dwordx4 v4, s[16:19], s56 offen offset:1024 lds
  v_fma_f32 v25, -v24, v24, v25
  v_mfma_f32_16x16x32_bf16 v[52:55], a[168:171], a[4:7], v[52:55]
  ds_read_b64_tr_b16 a[156:157], v2 offset:36000
  v_max_f32 v25, 0, v25
  v_mfma_f32_16x16x32_bf16 v[52:55], a[172:175], a[20:23], v[52:55]
  v_cvt_pk_bf16_f32 v25, v25, v25
  v_lshlrev_b32 v25, 16, v25
  v_mfma_f32_16x16x32_bf16 v[48:51], a[172:175], a[16:19], v[48:51]
  ds_read_b64_tr_b16 a[158:159], v2 offset:39584
  v_add_f32 v25, 0x3727c5ac, v25
  v_mfma_f32_16x16x32_bf16 v[48:51], a[168:171], a[0:3], v[48:51]
  s_waitcnt lgkmcnt(8)
  v_cvt_pk_bf16_f32 v25, v25, v25
  v_lshlrev_b32 v25, 16, v25
  v_mfma_f32_16x16x32_bf16 v[64:67], a[128:131], a[0:3], v[64:67]
  ds_read_b64_tr_b16 a[160:161], v2 offset:28864
  v_mfma_f32_16x16x32_bf16 v[64:67], a[132:135], a[16:19], v[64:67]
  v_sqrt_f32 v25, v25
  v_mfma_f32_16x16x32_bf16 v[68:71], a[132:135], a[20:23], v[68:71]
  s_nop 0
  ds_read_b64_tr_b16 a[162:163], v2 offset:32448
  v_cvt_pk_bf16_f32 v15, -v24, v25
  v_mfma_f32_16x16x32_bf16 v[68:71], a[128:131], a[4:7], v[68:71]
  buffer_load_dwordx4 a[52:55], v0, s[36:39], s57 offen offset:1024 sc1
  v_and_b32 v25, 0xffff0000, v15
  v_mfma_f32_16x16x32_bf16 v[72:75], a[128:131], a[8:11], v[72:75]
  ds_read_b64_tr_b16 a[164:165], v2 offset:36032
  v_mfma_f32_16x16x32_bf16 v[72:75], a[132:135], a[24:27], v[72:75]
  v_rcp_f32 v13, v25
  v_mfma_f32_16x16x32_bf16 v[76:79], a[132:135], a[28:31], v[76:79]
  ds_read_b64_tr_b16 a[166:167], v2 offset:39616
  v_mul_f32 v14, v25, v25
  v_mfma_f32_16x16x32_bf16 v[76:79], a[128:131], a[12:15], v[76:79]
  v_mul_f32 v13, 0xbfb8aa3b, v13
  v_accvgpr_read_b32 v22, a192
  v_mfma_f32_16x16x32_bf16 v[92:95], a[136:139], a[12:15], v[92:95]
  ds_read_b64_tr_b16 a[168:169], v2 offset:43008
  v_accvgpr_read_b32 v23, a193
  v_mfma_f32_16x16x32_bf16 v[92:95], a[140:143], a[28:31], v[92:95]
  v_accvgpr_read_b32 v24, a194
  v_accvgpr_read_b32 v25, a195
  v_mfma_f32_16x16x32_bf16 v[88:91], a[140:143], a[24:27], v[88:91]
  buffer_load_dwordx4 v5, s[16:19], s56 offen offset:2048 lds
  v_accvgpr_read_b32 v26, a196
  v_mfma_f32_16x16x32_bf16 v[88:91], a[136:139], a[8:11], v[88:91]
  ds_read_b64_tr_b16 a[170:171], v2 offset:46592
  v_accvgpr_read_b32 v27, a197
  v_mfma_f32_16x16x32_bf16 v[84:87], a[136:139], a[4:7], v[84:87]
  ds_read_b64_tr_b16 a[172:173], v2 offset:50176
  v_accvgpr_read_b32 v28, a198
  v_mfma_f32_16x16x32_bf16 v[84:87], a[140:143], a[20:23], v[84:87]
  v_accvgpr_read_b32 v29, a199
  v_add_f32 v22, v22, v26
  v_mfma_f32_16x16x32_bf16 v[80:83], a[140:143], a[16:19], v[80:83]
  ds_read_b64_tr_b16 a[174:175], v2 offset:53760
  v_add_f32 v23, v23, v27
  v_mfma_f32_16x16x32_bf16 v[80:83], a[136:139], a[0:3], v[80:83]
  s_waitcnt lgkmcnt(8)
  v_add_f32 v24, v24, v28
  v_add_f32 v25, v25, v29
  v_mfma_f32_16x16x32_bf16 v[96:99], a[144:147], a[0:3], v[96:99]
  ds_read_b64_tr_b16 a[128:129], v2 offset:43040
  v_accvgpr_read_b32 v26, a200
  v_mfma_f32_16x16x32_bf16 v[96:99], a[148:151], a[16:19], v[96:99]
  v_accvgpr_read_b32 v27, a201
  v_accvgpr_read_b32 v28, a202
  v_mfma_f32_16x16x32_bf16 v[100:103], a[148:151], a[20:23], v[100:103]
  buffer_load_dwordx4 a[56:59], v0, s[36:39], s57 offen offset:2048 sc1
  v_accvgpr_read_b32 v29, a203
  v_mfma_f32_16x16x32_bf16 v[100:103], a[144:147], a[4:7], v[100:103]
  ds_read_b64_tr_b16 a[130:131], v2 offset:46624
  v_add_f32 v22, v22, v26
  v_mfma_f32_16x16x32_bf16 v[104:107], a[144:147], a[8:11], v[104:107]
  ds_read_b64_tr_b16 a[132:133], v2 offset:50208
  v_add_f32 v23, v23, v27
  v_mfma_f32_16x16x32_bf16 v[104:107], a[148:151], a[24:27], v[104:107]
  v_add_f32 v24, v24, v28
  v_add_f32 v25, v25, v29
  v_mfma_f32_16x16x32_bf16 v[108:111], a[148:151], a[28:31], v[108:111]
  ds_read_b64_tr_b16 a[134:135], v2 offset:53792
  v_accvgpr_read_b32 v26, a204
  v_mfma_f32_16x16x32_bf16 v[108:111], a[144:147], a[12:15], v[108:111]
  v_accvgpr_read_b32 v27, a205
  v_accvgpr_read_b32 v28, a206
  v_mfma_f32_16x16x32_bf16 v[124:127], a[152:155], a[12:15], v[124:127]
  ds_read_b64_tr_b16 a[136:137], v2 offset:43072
  v_accvgpr_read_b32 v29, a207
  v_mfma_f32_16x16x32_bf16 v[124:127], a[156:159], a[28:31], v[124:127]
  buffer_load_dwordx4 v6, s[16:19], s56 offen offset:3072 lds
  v_add_f32 v22, v22, v26
  v_mfma_f32_16x16x32_bf16 v[120:123], a[156:159], a[24:27], v[120:123]
  ds_read_b64_tr_b16 a[138:139], v2 offset:46656
  v_add_f32 v23, v23, v27
  v_mfma_f32_16x16x32_bf16 v[120:123], a[152:155], a[8:11], v[120:123]
  v_add_f32 v24, v24, v28
  v_add_f32 v25, v25, v29
  v_mfma_f32_16x16x32_bf16 v[116:119], a[152:155], a[4:7], v[116:119]
  ds_read_b64_tr_b16 a[140:141], v2 offset:50240
  v_mov_b32 v26, v22
  v_mfma_f32_16x16x32_bf16 v[116:119], a[156:159], a[20:23], v[116:119]
  v_mov_b32 v27, v23
  v_mov_b32 v28, v24
  v_mfma_f32_16x16x32_bf16 v[112:115], a[156:159], a[16:19], v[112:115]
  ds_read_b64_tr_b16 a[142:143], v2 offset:53824
  v_mov_b32 v29, v25
  v_mfma_f32_16x16x32_bf16 v[112:115], a[152:155], a[0:3], v[112:115]
  s_waitcnt lgkmcnt(8)
  v_permlane16_swap_b32 v22, v26
  v_permlane16_swap_b32 v23, v27
  v_mfma_f32_16x16x32_bf16 v[128:131], a[160:163], a[0:3], v[128:131]
  ds_read_b64_tr_b16 a[144:145], v2 offset:43104
  v_permlane16_swap_b32 v24, v28
  v_mfma_f32_16x16x32_bf16 v[128:131], a[164:167], a[16:19], v[128:131]
  buffer_load_dwordx4 a[60:63], v0, s[36:39], s57 offen offset:3072 sc1
  v_permlane16_swap_b32 v25, v29
  v_mfma_f32_16x16x32_bf16 v[132:135], a[164:167], a[20:23], v[132:135]
  s_add_u32 m0, s84, 32768
  ds_read_b64_tr_b16 a[146:147], v2 offset:46688
  v_add_f32 v22, v22, v26
  v_mfma_f32_16x16x32_bf16 v[132:135], a[160:163], a[4:7], v[132:135]
  v_add_f32 v23, v23, v27
  v_add_f32 v24, v24, v28
  v_mfma_f32_16x16x32_bf16 v[136:139], a[160:163], a[8:11], v[136:139]
  ds_read_b64_tr_b16 a[148:149], v2 offset:50272
  v_add_f32 v25, v25, v29
  v_mfma_f32_16x16x32_bf16 v[136:139], a[164:167], a[24:27], v[136:139]
Hc0_1:
  s_cbranch_execz Hc0_2
  v_mov_b32 v26, v22
  v_mov_b32 v27, v23
  v_mfma_f32_16x16x32_bf16 v[140:143], a[164:167], a[28:31], v[140:143]
  buffer_load_dwordx4 v7, s[16:19], s56 offen offset:0 lds
  s_bfe_u32 s57, s83, 0x40008
  v_mfma_f32_16x16x32_bf16 v[140:143], a[160:163], a[12:15], v[140:143]
  s_lshl_b32 s57, s57, 13
  s_add_u32 s57, s57, s85
  ds_read_b64_tr_b16 a[150:151], v2 offset:53856
  v_mfma_f32_16x16x32_bf16 v[156:159], a[168:171], a[12:15], v[156:159]
  ds_read_b64_tr_b16 a[152:153], v2 offset:43136
  v_mov_b32 v28, v24
  v_mfma_f32_16x16x32_bf16 v[156:159], a[172:175], a[28:31], v[156:159]
  v_mov_b32 v29, v25
  v_permlane32_swap_b32 v22, v26
  v_mfma_f32_16x16x32_bf16 v[152:155], a[172:175], a[24:27], v[152:155]
  ds_read_b64_tr_b16 a[154:155], v2 offset:46720
  v_permlane32_swap_b32 v23, v27
  v_mfma_f32_16x16x32_bf16 v[152:155], a[168:171], a[8:11], v[152:155]
  buffer_load_dwordx4 a[64:67], v0, s[36:39], s57 offen offset:0 sc1
  v_permlane32_swap_b32 v24, v28
  v_mfma_f32_16x16x32_bf16 v[148:151], a[168:171], a[4:7], v[148:151]
  ds_read_b64_tr_b16 a[156:157], v2 offset:50304
  v_permlane32_swap_b32 v25, v29
  v_mfma_f32_16x16x32_bf16 v[148:151], a[172:175], a[20:23], v[148:151]
  v_add_f32 v22, v22, v26
  v_add_f32 v23, v23, v27
  v_mfma_f32_16x16x32_bf16 v[144:147], a[172:175], a[16:19], v[144:147]
  ds_read_b64_tr_b16 a[158:159], v2 offset:53888
  v_add_f32 v24, v24, v28
  v_mfma_f32_16x16x32_bf16 v[144:147], a[168:171], a[0:3], v[144:147]
  s_waitcnt lgkmcnt(8)
  v_add_f32 v25, v25, v29
  v_mul_f32 v22, 0x3a800000, v22
  v_mfma_f32_16x16x32_bf16 v[160:163], a[128:131], a[0:3], v[160:163]
  ds_read_b64_tr_b16 a[160:161], v2 offset:43168
  v_mul_f32 v23, 0x3a800000, v23
  v_mfma_f32_16x16x32_bf16 v[160:163], a[132:135], a[16:19], v[160:163]
  v_fma_f32 v23, -v22, v22, v23
  v_max_f32 v23, 0, v23
  v_mfma_f32_16x16x32_bf16 v[164:167], a[132:135], a[20:23], v[164:167]
  buffer_load_dwordx4 v8, s[16:19], s56 offen offset:1024 lds
  v_cvt_pk_bf16_f32 v23, v23, v23
  v_mfma_f32_16x16x32_bf16 v[164:167], a[128:131], a[4:7], v[164:167]
  ds_read_b64_tr_b16 a[162:163], v2 offset:46752
  v_lshlrev_b32 v23, 16, v23
  v_mfma_f32_16x16x32_bf16 v[168:171], a[128:131], a[8:11], v[168:171]
  ds_read_b64_tr_b16 a[164:165], v2 offset:50336
  v_add_f32 v23, 0x3727c5ac, v23
  v_mfma_f32_16x16x32_bf16 v[168:171], a[132:135], a[24:27], v[168:171]
  v_cvt_pk_bf16_f32 v23, v23, v23
  v_lshlrev_b32 v23, 16, v23
  v_mfma_f32_16x16x32_bf16 v[172:175], a[132:135], a[28:31], v[172:175]
  ds_read_b64_tr_b16 a[166:167], v2 offset:53920
  v_mfma_f32_16x16x32_bf16 v[172:175], a[128:131], a[12:15], v[172:175]
  s_waitcnt vmcnt(15)
  s_barrier
  buffer_load_dwordx4 a[68:71], v0, s[36:39], s57 offen offset:1024 sc1
  v_mfma_f32_16x16x32_bf16 v[188:191], a[136:139], a[12:15], v[188:191]
  ds_read_b64_tr_b16 a[168:169], v2 offset:43200
  v_mfma_f32_16x16x32_bf16 v[188:191], a[140:143], a[28:31], v[188:191]
  v_sqrt_f32 v23, v23
  v_mfma_f32_16x16x32_bf16 v[184:187], a[140:143], a[24:27], v[184:187]
  s_nop 0
  ds_read_b64_tr_b16 a[170:171], v2 offset:46784
  v_cvt_pk_bf16_f32 v18, -v22, v23
  v_mfma_f32_16x16x32_bf16 v[184:187], a[136:139], a[8:11], v[184:187]
  v_and_b32 v23, 0xffff0000, v18
  v_mfma_f32_16x16x32_bf16 v[180:183], a[136:139], a[4:7], v[180:183]
  ds_read_b64_tr_b16 a[172:173], v2 offset:50368
  v_mfma_f32_16x16x32_bf16 v[180:183], a[140:143], a[20:23], v[180:183]
  v_rcp_f32 v16, v23
  v_mfma_f32_16x16x32_bf16 v[176:179], a[140:143], a[16:19], v[176:179]
  buffer_load_dwordx4 v9, s[16:19], s56 offen offset:2048 lds
  v_mul_f32 v17, v23, v23
  v_mfma_f32_16x16x32_bf16 v[176:179], a[136:139], a[0:3], v[176:179]
  s_waitcnt lgkmcnt(7)
  ds_read_b64_tr_b16 a[174:175], v2 offset:53952
  v_mul_f32 v16, 0xbfb8aa3b, v16
  v_mfma_f32_16x16x32_bf16 v[192:195], a[144:147], a[0:3], v[192:195]
  ds_read_b64_tr_b16 a[128:129], v1 offset:0
  v_mul_f32 v24, 0x3a800000, v24
  v_mfma_f32_16x16x32_bf16 v[192:195], a[148:151], a[16:19], v[192:195]
  v_mul_f32 v25, 0x3a800000, v25
  v_fma_f32 v25, -v24, v24, v25
  v_mfma_f32_16x16x32_bf16 v[196:199], a[148:151], a[20:23], v[196:199]
  ds_read_b64_tr_b16 a[130:131], v1 offset:3584
  v_max_f32 v25, 0, v25
  v_mfma_f32_16x16x32_bf16 v[196:199], a[144:147], a[4:7], v[196:199]
  v_cvt_pk_bf16_f32 v25, v25, v25
  v_lshlrev_b32 v25, 16, v25
  v_mfma_f32_16x16x32_bf16 v[200:203], a[144:147], a[8:11], v[200:203]
  ds_read_b64_tr_b16 a[132:133], v1 offset:7168
  v_add_f32 v25, 0x3727c5ac, v25
  v_mfma_f32_16x16x32_bf16 v[200:203], a[148:151], a[24:27], v[200:203]
  v_cvt_pk_bf16_f32 v25, v25, v25
  v_lshlrev_b32 v25, 16, v25
  v_mfma_f32_16x16x32_bf16 v[204:207], a[148:151], a[28:31], v[204:207]
  buffer_load_dwordx4 a[72:75], v0, s[36:39], s57 offen offset:2048 sc1
  v_mfma_f32_16x16x32_bf16 v[204:207], a[144:147], a[12:15], v[204:207]
  ds_read_b64_tr_b16 a[134:135], v1 offset:10752
  v_mfma_f32_16x16x32_bf16 v[220:223], a[152:155], a[12:15], v[220:223]
  ds_read_b64_tr_b16 a[136:137], v1 offset:32
  v_mfma_f32_16x16x32_bf16 v[220:223], a[156:159], a[28:31], v[220:223]
  v_sqrt_f32 v25, v25
  v_mfma_f32_16x16x32_bf16 v[216:219], a[156:159], a[24:27], v[216:219]
  s_nop 0
  ds_read_b64_tr_b16 a[138:139], v1 offset:3616
  v_cvt_pk_bf16_f32 v21, -v24, v25
  v_mfma_f32_16x16x32_bf16 v[216:219], a[152:155], a[8:11], v[216:219]
  v_and_b32 v25, 0xffff0000, v21
  v_mfma_f32_16x16x32_bf16 v[212:215], a[152:155], a[4:7], v[212:215]
  s_bfe_u32 s56, s83, 0x3000c
  s_lshl_b32 s56, s56, 2
  s_bitcmp1_b32 s83, 15
  v_mfma_f32_16x16x32_bf16 v[212:215], a[156:159], a[20:23], v[212:215]
  s_addc_u32 s56, s56, 0
  s_mul_i32 s56, s56, 229376
  s_add_u32 m0, s84, 57344
  v_mfma_f32_16x16x32_bf16 v[208:211], a[156:159], a[16:19], v[208:211]
  ds_read_b64_tr_b16 a[140:141], v1 offset:7200
  v_mfma_f32_16x16x32_bf16 v[208:211], a[152:155], a[0:3], v[208:211]
  s_waitcnt lgkmcnt(7)
  ds_read_b64_tr_b16 a[142:143], v1 offset:10784
  v_mfma_f32_16x16x32_bf16 v[224:227], a[160:163], a[0:3], v[224:227]
  buffer_load_dwordx4 v3, s[16:19], s56 offen offset:0 lds
  v_mfma_f32_16x16x32_bf16 v[224:227], a[164:167], a[16:19], v[224:227]
  v_rcp_f32 v19, v25
  v_mfma_f32_16x16x32_bf16 v[228:231], a[164:167], a[20:23], v[228:231]
  v_mul_f32 v20, v25, v25
  v_mul_f32 v19, 0xbfb8aa3b, v19
  v_mfma_f32_16x16x32_bf16 v[228:231], a[160:163], a[4:7], v[228:231]
  v_add_u32 v31, -28672, v31
  v_mfma_f32_16x16x32_bf16 v[232:235], a[160:163], a[8:11], v[232:235]
  ds_read_b64_tr_b16 a[176:177], v31 offset:0
  v_mfma_f32_16x16x32_bf16 v[232:235], a[164:167], a[24:27], v[232:235]
  buffer_load_dwordx4 a[76:79], v0, s[36:39], s57 offen offset:3072 sc1
  v_mfma_f32_16x16x32_bf16 v[236:239], a[164:167], a[28:31], v[236:239]
  ds_read_b64_tr_b16 a[178:179], v31 offset:3584
  v_mfma_f32_16x16x32_bf16 v[236:239], a[160:163], a[12:15], v[236:239]
  ds_read_b64_tr_b16 a[180:181], v31 offset:7168
  v_mfma_f32_16x16x32_bf16 v[252:255], a[168:171], a[12:15], v[252:255]
  ds_read_b64_tr_b16 a[144:145], v1 offset:64
  v_mfma_f32_16x16x32_bf16 v[252:255], a[172:175], a[28:31], v[252:255]
  ds_read_b64_tr_b16 a[182:183], v31 offset:10752
  v_mfma_f32_16x16x32_bf16 v[248:251], a[172:175], a[24:27], v[248:251]
  ds_read_b64_tr_b16 a[146:147], v1 offset:3648
  v_mfma_f32_16x16x32_bf16 v[248:251], a[168:171], a[8:11], v[248:251]
  ds_read_b64_tr_b16 a[184:185], v31 offset:32
  v_mfma_f32_16x16x32_bf16 v[244:247], a[168:171], a[4:7], v[244:247]
  buffer_load_dwordx4 v4, s[16:19], s56 offen offset:1024 lds
  v_mfma_f32_16x16x32_bf16 v[244:247], a[172:175], a[20:23], v[244:247]
  ds_read_b64_tr_b16 a[148:149], v1 offset:7232
  v_mfma_f32_16x16x32_bf16 v[240:243], a[172:175], a[16:19], v[240:243]
  s_add_u32 s57, s57, 4096
  ds_read_b64_tr_b16 a[150:151], v1 offset:10816
  v_mfma_f32_16x16x32_bf16 v[240:243], a[168:171], a[0:3], v[240:243]
  s_waitcnt vmcnt(9) lgkmcnt(9)
  ds_read_b64_tr_b16 a[186:187], v31 offset:3616
  v_mfma_f32_16x16x32_bf16 v[32:35], a[128:131], a[32:35], v[32:35]
  ds_read_b64_tr_b16 a[152:153], v1 offset:96
  v_mfma_f32_16x16x32_bf16 v[32:35], a[132:135], a[48:51], v[32:35]
  s_barrier
  ds_read_b64_tr_b16 a[188:189], v31 offset:7200
  v_mfma_f32_16x16x32_bf16 v[36:39], a[132:135], a[52:55], v[36:39]
  buffer_load_dwordx4 a[80:83], v0, s[36:39], s57 offen offset:0 sc1
  v_mfma_f32_16x16x32_bf16 v[36:39], a[128:131], a[36:39], v[36:39]
  ds_read_b64_tr_b16 a[154:155], v1 offset:3680
  v_mfma_f32_16x16x32_bf16 v[40:43], a[128:131], a[40:43], v[40:43]
  ds_read_b64_tr_b16 a[156:157], v1 offset:7264
  v_mfma_f32_16x16x32_bf16 v[40:43], a[132:135], a[56:59], v[40:43]
  ds_read_b64_tr_b16 a[190:191], v31 offset:10784
  v_mfma_f32_16x16x32_bf16 v[44:47], a[132:135], a[60:63], v[44:47]
  ds_read_b64_tr_b16 a[192:193], v31 offset:64
  ds_read_b64_tr_b16 a[194:195], v31 offset:3648
  ds_read_b64_tr_b16 a[196:197], v31 offset:7232
  ds_read_b64_tr_b16 a[198:199], v31 offset:10816
  ds_read_b64_tr_b16 a[200:201], v31 offset:96
  ds_read_b64_tr_b16 a[202:203], v31 offset:3680
  ds_read_b64_tr_b16 a[204:205], v31 offset:7264
  ds_read_b64_tr_b16 a[206:207], v31 offset:10848
  v_mfma_f32_16x16x32_bf16 v[44:47], a[128:131], a[44:47], v[44:47]
  ds_read_b64_tr_b16 a[158:159], v1 offset:10848
  v_lshrrev_b32 v22, 4, v0
  v_mfma_f32_16x16x32_bf16 v[60:63], a[136:139], a[44:47], v[60:63]
  buffer_load_dwordx4 v5, s[16:19], s56 offen offset:2048 lds
  v_and_b32 v23, 14, v22
  v_mfma_f32_16x16x32_bf16 v[60:63], a[140:143], a[60:63], v[60:63]
  ds_read_b64_tr_b16 a[160:161], v1 offset:128
  v_lshlrev_b32 v23, 27, v23
  v_mfma_f32_16x16x32_bf16 v[56:59], a[140:143], a[56:59], v[56:59]
  ds_read_b64_tr_b16 a[162:163], v1 offset:3712
  v_and_b32 v24, 1, v22
  v_mfma_f32_16x16x32_bf16 v[56:59], a[136:139], a[40:43], v[56:59]
  v_lshl_add_u32 v23, v24, 9, v23
  v_and_b32 v22, 0x30, v22
  v_mfma_f32_16x16x32_bf16 v[52:55], a[136:139], a[36:39], v[52:55]
  ds_read_b64_tr_b16 a[164:165], v1 offset:7296
  v_add_u32 v22, v22, v23
  v_mfma_f32_16x16x32_bf16 v[52:55], a[140:143], a[52:55], v[52:55]
  s_lshl3_add_u32 s76, s60, s58
  buffer_load_dwordx4 a[84:87], v0, s[36:39], s57 offen offset:1024 sc1
  s_lshr_b32 s77, s44, 1
  v_mfma_f32_16x16x32_bf16 v[48:51], a[140:143], a[48:51], v[48:51]
  s_lshl1_add_u32 s76, s76, s77
  ds_read_b64_tr_b16 a[166:167], v1 offset:10880
  s_and_b32 s77, s44, 1
  v_mfma_f32_16x16x32_bf16 v[48:51], a[136:139], a[32:35], v[48:51]
  s_waitcnt vmcnt(21) lgkmcnt(5)
  s_lshl2_add_u32 s76, s76, s77
  s_lshl_b32 s76, s76, 8
  v_mfma_f32_16x16x32_bf16 a[216:219], a[176:179], a[208:211], a[216:219]
  s_add_u32 s76, s76, 524288
  ds_read_b64_tr_b16 a[168:169], v1 offset:160
  v_mfma_f32_16x16x32_bf16 a[216:219], a[180:183], a[212:215], a[216:219]
  v_mfma_f32_16x16x32_bf16 a[220:223], a[184:187], a[208:211], a[220:223]
  ds_read_b64_tr_b16 a[170:171], v1 offset:3744
  v_mfma_f32_16x16x32_bf16 a[220:223], a[188:191], a[212:215], a[220:223]
  v_mfma_f32_16x16x32_bf16 a[224:227], a[192:195], a[208:211], a[224:227]
  buffer_load_dwordx4 v6, s[16:19], s56 offen offset:3072 lds
  v_mfma_f32_16x16x32_bf16 a[224:227], a[196:199], a[212:215], a[224:227]
  ds_read_b64_tr_b16 a[172:173], v1 offset:7328
  v_mfma_f32_16x16x32_bf16 a[228:231], a[200:203], a[208:211], a[228:231]
  ds_read_b64_tr_b16 a[174:175], v1 offset:10912
  v_mfma_f32_16x16x32_bf16 a[228:231], a[204:207], a[212:215], a[228:231]
  s_waitcnt lgkmcnt(8)
  v_mfma_f32_16x16x32_bf16 v[64:67], a[144:147], a[32:35], v[64:67]
  ds_read_b64_tr_b16 a[128:129], v1 offset:192
  v_mfma_f32_16x16x32_bf16 v[64:67], a[148:151], a[48:51], v[64:67]
  buffer_load_dwordx4 a[88:91], v0, s[36:39], s57 offen offset:2048 sc1
  v_mfma_f32_16x16x32_bf16 v[68:71], a[148:151], a[52:55], v[68:71]
  ds_read_b64_tr_b16 a[130:131], v1 offset:3776
  v_mfma_f32_16x16x32_bf16 v[68:71], a[144:147], a[36:39], v[68:71]
  s_add_u32 m0, s84, 61440
  v_mfma_f32_16x16x32_bf16 v[72:75], a[144:147], a[40:43], v[72:75]
  ds_read_b64_tr_b16 a[132:133], v1 offset:7360
  v_mfma_f32_16x16x32_bf16 v[72:75], a[148:151], a[56:59], v[72:75]
  v_mfma_f32_16x16x32_bf16 v[76:79], a[148:151], a[60:63], v[76:79]
  ds_read_b64_tr_b16 a[134:135], v1 offset:10944
  v_mfma_f32_16x16x32_bf16 v[76:79], a[144:147], a[44:47], v[76:79]
  buffer_load_dwordx4 v7, s[16:19], s56 offen offset:0 lds
  v_mfma_f32_16x16x32_bf16 v[92:95], a[152:155], a[44:47], v[92:95]
  ds_read_b64_tr_b16 a[136:137], v1 offset:14336
  v_mfma_f32_16x16x32_bf16 v[92:95], a[156:159], a[60:63], v[92:95]
  v_mfma_f32_16x16x32_bf16 v[88:91], a[156:159], a[56:59], v[88:91]
  ds_read_b64_tr_b16 a[138:139], v1 offset:17920
  v_mfma_f32_16x16x32_bf16 v[88:91], a[152:155], a[40:43], v[88:91]
  v_mfma_f32_16x16x32_bf16 v[84:87], a[152:155], a[36:39], v[84:87]
  buffer_load_dwordx4 a[92:95], v0, s[36:39], s57 offen offset:3072 sc1
  s_bfe_u32 s57, s83, 0x4000c
  v_mfma_f32_16x16x32_bf16 v[84:87], a[156:159], a[52:55], v[84:87]
  s_lshl_b32 s57, s57, 13
  s_add_u32 s57, s57, s85
  ds_read_b64_tr_b16 a[140:141], v1 offset:21504
  v_mfma_f32_16x16x32_bf16 v[80:83], a[156:159], a[48:51], v[80:83]
  ds_read_b64_tr_b16 a[142:143], v1 offset:25088
  v_mfma_f32_16x16x32_bf16 v[80:83], a[152:155], a[32:35], v[80:83]
  s_waitcnt lgkmcnt(8)
  v_mfma_f32_16x16x32_bf16 v[96:99], a[160:163], a[32:35], v[96:99]
  ds_read_b64_tr_b16 a[144:145], v1 offset:14368
  v_mfma_f32_16x16x32_bf16 v[96:99], a[164:167], a[48:51], v[96:99]
  buffer_load_dwordx4 a[96:99], v0, s[36:39], s57 offen offset:0 sc1
  v_mfma_f32_16x16x32_bf16 v[100:103], a[164:167], a[52:55], v[100:103]
  buffer_store_dwordx4 a[216:219], v22, s[36:39], s76 offen offset:0 sc1
  v_mfma_f32_16x16x32_bf16 v[100:103], a[160:163], a[36:39], v[100:103]
  ds_read_b64_tr_b16 a[146:147], v1 offset:17952
  v_mfma_f32_16x16x32_bf16 v[104:107], a[160:163], a[40:43], v[104:107]
  ds_read_b64_tr_b16 a[148:149], v1 offset:21536
  v_mfma_f32_16x16x32_bf16 v[104:107], a[164:167], a[56:59], v[104:107]
  v_mfma_f32_16x16x32_bf16 v[108:111], a[164:167], a[60:63], v[108:111]
  buffer_store_dwordx4 a[220:223], v22, s[36:39], s76 offen offset:64 sc1
  v_mfma_f32_16x16x32_bf16 v[108:111], a[160:163], a[44:47], v[108:111]
  ds_read_b64_tr_b16 a[150:151], v1 offset:25120
  v_mfma_f32_16x16x32_bf16 v[124:127], a[168:171], a[44:47], v[124:127]
  ds_read_b64_tr_b16 a[152:153], v1 offset:14400
  v_mfma_f32_16x16x32_bf16 v[124:127], a[172:175], a[60:63], v[124:127]
  v_mfma_f32_16x16x32_bf16 v[120:123], a[172:175], a[56:59], v[120:123]
  buffer_store_dwordx4 a[224:227], v22, s[36:39], s76 offen offset:128 sc1
  v_mfma_f32_16x16x32_bf16 v[120:123], a[168:171], a[40:43], v[120:123]
  ds_read_b64_tr_b16 a[154:155], v1 offset:17984
  v_mfma_f32_16x16x32_bf16 v[116:119], a[168:171], a[36:39], v[116:119]
  ds_read_b64_tr_b16 a[156:157], v1 offset:21568
  v_mfma_f32_16x16x32_bf16 v[116:119], a[172:175], a[52:55], v[116:119]
  v_mfma_f32_16x16x32_bf16 v[112:115], a[172:175], a[48:51], v[112:115]
  buffer_store_dwordx4 a[228:231], v22, s[36:39], s76 offen offset:192 sc1
  s_lshl_b32 s77, s60, 14
  v_mfma_f32_16x16x32_bf16 v[112:115], a[168:171], a[32:35], v[112:115]
  s_waitcnt lgkmcnt(7)
  ds_read_b64_tr_b16 a[158:159], v1 offset:25152
  s_lshl_b32 s78, s44, 9
  v_mfma_f32_16x16x32_bf16 v[128:131], a[128:131], a[32:35], v[128:131]
  s_add_u32 s77, s77, s78
  ds_read_b64_tr_b16 a[160:161], v1 offset:14432
  s_add_u32 s77, s77, 524288
  v_mfma_f32_16x16x32_bf16 v[128:131], a[132:135], a[48:51], v[128:131]
  s_lshr_b32 s78, s44, 1
  s_lshl_b32 s78, s78, 8
  s_and_b32 s65, s44, 1
  v_mfma_f32_16x16x32_bf16 v[132:135], a[132:135], a[52:55], v[132:135]
  s_add_u32 s78, s78, s65
  ds_read_b64_tr_b16 a[162:163], v1 offset:18016
  s_lshl3_add_u32 s78, s78, 159744
  v_mfma_f32_16x16x32_bf16 v[132:135], a[128:131], a[36:39], v[132:135]
  buffer_load_dwordx4 v8, s[16:19], s56 offen offset:1024 lds
  v_and_b32 v24, 0x1f0, v0
  v_mfma_f32_16x16x32_bf16 v[136:139], a[128:131], a[40:43], v[136:139]
  ds_read_b64_tr_b16 a[164:165], v1 offset:21600
  v_min_u32 v24, 432, v24
  v_mfma_f32_16x16x32_bf16 v[136:139], a[132:135], a[56:59], v[136:139]
  v_and_b32 v26, 0x200, v0
  v_lshl_add_u32 v25, v26, 4, v24
  v_mfma_f32_16x16x32_bf16 v[140:143], a[132:135], a[60:63], v[140:143]
  ds_read_b64_tr_b16 a[166:167], v1 offset:25184
  v_lshrrev_b32 v26, 4, v26
  v_mfma_f32_16x16x32_bf16 v[140:143], a[128:131], a[44:47], v[140:143]
  v_lshl_add_u32 v24, v24, 2, v26
  v_add_u32 v24, s78, v24
  v_mfma_f32_16x16x32_bf16 v[156:159], a[136:139], a[44:47], v[156:159]
  s_lshl2_add_u32 s65, s58, s44
  buffer_load_dwordx4 a[100:103], v0, s[36:39], s57 offen offset:1024 sc1
  s_lshl_b32 s65, s65, 19
  v_mfma_f32_16x16x32_bf16 v[156:159], a[140:143], a[60:63], v[156:159]
  s_mul_i32 s66, s60, 7
  ds_read_b64_tr_b16 a[168:169], v1 offset:14464
  s_and_b32 s78, s60, 1
  v_mfma_f32_16x16x32_bf16 v[152:155], a[140:143], a[56:59], v[152:155]
  s_add_u32 s66, s66, s78
  ds_read_b64_tr_b16 a[170:171], v1 offset:18048
  s_lshl_b32 s66, s66, 10
  v_mfma_f32_16x16x32_bf16 v[152:155], a[136:139], a[40:43], v[152:155]
  s_add_u32 s65, s65, s66
  s_add_u32 s67, s65, 19922944
  s_mul_i32 s78, s78, 7680
  v_mfma_f32_16x16x32_bf16 v[148:151], a[136:139], a[36:39], v[148:151]
  s_sub_u32 s65, s67, s78
  ds_read_b64_tr_b16 a[172:173], v1 offset:21632
  s_add_u32 s65, s65, 6144
  v_mfma_f32_16x16x32_bf16 v[148:151], a[140:143], a[52:55], v[148:151]
  s_add_u32 s66, s65, 262144
  buffer_load_dwordx4 v9, s[16:19], s56 offen offset:2048 lds
  s_lshl_b32 s45, s2, 7
  v_mfma_f32_16x16x32_bf16 v[144:147], a[140:143], a[48:51], v[144:147]
  s_add_u32 s45, s45, 5373952
  ds_read_b64_tr_b16 a[174:175], v1 offset:25216
  s_cmp_eq_u32 s44, 0
  v_mfma_f32_16x16x32_bf16 v[144:147], a[136:139], a[32:35], v[144:147]
  s_waitcnt lgkmcnt(8)
  s_cselect_b32 s45, s45, 1073741824
  s_add_u32 s76, s77, 4096
  v_mfma_f32_16x16x32_bf16 v[160:163], a[144:147], a[32:35], v[160:163]
  ds_read_b64_tr_b16 a[128:129], v1 offset:14496
  v_mfma_f32_16x16x32_bf16 v[160:163], a[148:151], a[48:51], v[160:163]
  v_mfma_f32_16x16x32_bf16 v[164:167], a[148:151], a[52:55], v[164:167]
  buffer_load_dwordx4 a[104:107], v0, s[36:39], s57 offen offset:2048 sc1
  v_mfma_f32_16x16x32_bf16 v[164:167], a[144:147], a[36:39], v[164:167]
  ds_read_b64_tr_b16 a[130:131], v1 offset:18080
  v_mfma_f32_16x16x32_bf16 v[168:171], a[144:147], a[40:43], v[168:171]
  ds_read_b64_tr_b16 a[132:133], v1 offset:21664
  v_mfma_f32_16x16x32_bf16 v[168:171], a[148:151], a[56:59], v[168:171]
  v_mfma_f32_16x16x32_bf16 v[172:175], a[148:151], a[60:63], v[172:175]
  ds_read_b64_tr_b16 a[134:135], v1 offset:25248
  v_mfma_f32_16x16x32_bf16 v[172:175], a[144:147], a[44:47], v[172:175]
  s_waitcnt vmcnt(20)
  s_barrier
  buffer_load_dwordx4 a[108:111], v0, s[36:39], s57 offen offset:3072 sc1
  s_bfe_u32 s56, s83, 0x30010
  v_mfma_f32_16x16x32_bf16 v[188:191], a[152:155], a[44:47], v[188:191]
  s_lshl_b32 s56, s56, 2
  s_bitcmp1_b32 s83, 19
  s_addc_u32 s56, s56, 0
  v_mfma_f32_16x16x32_bf16 v[188:191], a[156:159], a[60:63], v[188:191]
  s_mul_i32 s56, s56, 229376
  s_add_u32 m0, s84, 86016
  ds_read_b64_tr_b16 a[136:137], v1 offset:14528
  v_mfma_f32_16x16x32_bf16 v[184:187], a[156:159], a[56:59], v[184:187]
  ds_read_b64_tr_b16 a[138:139], v1 offset:18112
  v_mfma_f32_16x16x32_bf16 v[184:187], a[152:155], a[40:43], v[184:187]
  v_mfma_f32_16x16x32_bf16 v[180:183], a[152:155], a[36:39], v[180:183]
  buffer_load_dwordx4 v3, s[16:19], s56 offen offset:0 lds
  s_add_u32 s57, s57, 4096
  v_mfma_f32_16x16x32_bf16 v[180:183], a[156:159], a[52:55], v[180:183]
  ds_read_b64_tr_b16 a[140:141], v1 offset:21696
  v_mfma_f32_16x16x32_bf16 v[176:179], a[156:159], a[48:51], v[176:179]
  ds_read_b64_tr_b16 a[142:143], v1 offset:25280
  v_mfma_f32_16x16x32_bf16 v[176:179], a[152:155], a[32:35], v[176:179]
  s_waitcnt lgkmcnt(8)
  v_mfma_f32_16x16x32_bf16 v[192:195], a[160:163], a[32:35], v[192:195]
  ds_read_b64_tr_b16 a[144:145], v1 offset:28672
  v_mfma_f32_16x16x32_bf16 v[192:195], a[164:167], a[48:51], v[192:195]
  buffer_load_dwordx4 a[112:115], v0, s[36:39], s57 offen offset:0 sc1
  v_mfma_f32_16x16x32_bf16 v[196:199], a[164:167], a[52:55], v[196:199]
  ds_read_b64_tr_b16 a[146:147], v1 offset:32256
  v_mfma_f32_16x16x32_bf16 v[196:199], a[160:163], a[36:39], v[196:199]
  v_mfma_f32_16x16x32_bf16 v[200:203], a[160:163], a[40:43], v[200:203]
  ds_read_b64_tr_b16 a[148:149], v1 offset:35840
  v_mfma_f32_16x16x32_bf16 v[200:203], a[164:167], a[56:59], v[200:203]
  v_mfma_f32_16x16x32_bf16 v[204:207], a[164:167], a[60:63], v[204:207]
  buffer_load_dwordx4 v4, s[16:19], s56 offen offset:1024 lds
  v_mfma_f32_16x16x32_bf16 v[204:207], a[160:163], a[44:47], v[204:207]
  ds_read_b64_tr_b16 a[150:151], v1 offset:39424
  v_mfma_f32_16x16x32_bf16 v[220:223], a[168:171], a[44:47], v[220:223]
  ds_read_b64_tr_b16 a[152:153], v1 offset:28704
  v_mfma_f32_16x16x32_bf16 v[220:223], a[172:175], a[60:63], v[220:223]
  v_mfma_f32_16x16x32_bf16 v[216:219], a[172:175], a[56:59], v[216:219]
  ds_read_b64_tr_b16 a[154:155], v1 offset:32288
  v_mfma_f32_16x16x32_bf16 v[216:219], a[168:171], a[40:43], v[216:219]
  buffer_load_dwordx4 a[116:119], v0, s[36:39], s57 offen offset:1024 sc1
  v_mfma_f32_16x16x32_bf16 v[212:215], a[168:171], a[36:39], v[212:215]
  ds_read_b64_tr_b16 a[156:157], v1 offset:35872
  v_mfma_f32_16x16x32_bf16 v[212:215], a[172:175], a[52:55], v[212:215]
  v_mfma_f32_16x16x32_bf16 v[208:211], a[172:175], a[48:51], v[208:211]
  ds_read_b64_tr_b16 a[158:159], v1 offset:39456
  v_mfma_f32_16x16x32_bf16 v[208:211], a[168:171], a[32:35], v[208:211]
  s_waitcnt lgkmcnt(8)
  v_mfma_f32_16x16x32_bf16 v[224:227], a[128:131], a[32:35], v[224:227]
  buffer_load_dwordx4 a[120:123], v0, s[36:39], s57 offen offset:2048 sc1
  v_mfma_f32_16x16x32_bf16 v[224:227], a[132:135], a[48:51], v[224:227]
  ds_read_b64_tr_b16 a[160:161], v1 offset:28736
  v_mfma_f32_16x16x32_bf16 v[228:231], a[132:135], a[52:55], v[228:231]
  ds_read_b64_tr_b16 a[162:163], v1 offset:32320
  v_mfma_f32_16x16x32_bf16 v[228:231], a[128:131], a[36:39], v[228:231]
  v_mfma_f32_16x16x32_bf16 v[232:235], a[128:131], a[40:43], v[232:235]
  ds_read_b64_tr_b16 a[164:165], v1 offset:35904
  v_mfma_f32_16x16x32_bf16 v[232:235], a[132:135], a[56:59], v[232:235]
  buffer_load_dwordx4 v5, s[16:19], s56 offen offset:2048 lds
  v_mfma_f32_16x16x32_bf16 v[236:239], a[132:135], a[60:63], v[236:239]
  ds_read_b64_tr_b16 a[166:167], v1 offset:39488
  v_mfma_f32_16x16x32_bf16 v[236:239], a[128:131], a[44:47], v[236:239]
  v_mfma_f32_16x16x32_bf16 v[252:255], a[136:139], a[44:47], v[252:255]
  ds_read_b64_tr_b16 a[168:169], v1 offset:28768
  v_mfma_f32_16x16x32_bf16 v[252:255], a[140:143], a[60:63], v[252:255]
  v_mfma_f32_16x16x32_bf16 v[248:251], a[140:143], a[56:59], v[248:251]
  buffer_load_dwordx4 a[124:127], v0, s[36:39], s57 offen offset:3072 sc1
  v_mfma_f32_16x16x32_bf16 v[248:251], a[136:139], a[40:43], v[248:251]
  ds_read_b64_tr_b16 a[170:171], v1 offset:32352
  v_mfma_f32_16x16x32_bf16 v[244:247], a[136:139], a[36:39], v[244:247]
  ds_read_b64_tr_b16 a[172:173], v1 offset:35936
  v_mfma_f32_16x16x32_bf16 v[244:247], a[140:143], a[52:55], v[244:247]
  v_mfma_f32_16x16x32_bf16 v[240:243], a[140:143], a[48:51], v[240:243]
  ds_read_b64_tr_b16 a[174:175], v1 offset:39520
  v_mfma_f32_16x16x32_bf16 v[240:243], a[136:139], a[32:35], v[240:243]
  s_waitcnt vmcnt(17) lgkmcnt(8)
  buffer_load_dwordx4 v6, s[16:19], s56 offen offset:3072 lds
  s_bfe_u32 s57, s83, 0x40010
  v_mfma_f32_16x16x32_bf16 v[32:35], a[144:147], a[64:67], v[32:35]
  s_lshl_b32 s57, s57, 13
  s_add_u32 s57, s57, s85
  ds_read_b64_tr_b16 a[128:129], v1 offset:28800
  v_mfma_f32_16x16x32_bf16 v[32:35], a[148:151], a[80:83], v[32:35]
  s_barrier
  v_mfma_f32_16x16x32_bf16 v[36:39], a[148:151], a[84:87], v[36:39]
  ds_read_b64_tr_b16 a[130:131], v1 offset:32384
  v_mfma_f32_16x16x32_bf16 v[36:39], a[144:147], a[68:71], v[36:39]
  v_mfma_f32_16x16x32_bf16 v[40:43], a[144:147], a[72:75], v[40:43]
  buffer_load_dwordx4 a[0:3], v0, s[36:39], s57 offen offset:0 sc1
  v_mfma_f32_16x16x32_bf16 v[40:43], a[148:151], a[88:91], v[40:43]
  s_add_u32 m0, s84, 90112
  ds_read_b64_tr_b16 a[132:133], v1 offset:35968
  v_mfma_f32_16x16x32_bf16 v[44:47], a[148:151], a[92:95], v[44:47]
  ds_read_b64_tr_b16 a[134:135], v1 offset:39552
  v_mfma_f32_16x16x32_bf16 v[44:47], a[144:147], a[76:79], v[44:47]
  v_mfma_f32_16x16x32_bf16 v[60:63], a[152:155], a[76:79], v[60:63]
  ds_read_b64_tr_b16 a[136:137], v1 offset:28832
  v_mfma_f32_16x16x32_bf16 v[60:63], a[156:159], a[92:95], v[60:63]
  buffer_load_dwordx4 v7, s[16:19], s56 offen offset:0 lds
  v_mfma_f32_16x16x32_bf16 v[56:59], a[156:159], a[88:91], v[56:59]
  ds_read_b64_tr_b16 a[138:139], v1 offset:32416
  v_mfma_f32_16x16x32_bf16 v[56:59], a[152:155], a[72:75], v[56:59]
  v_mfma_f32_16x16x32_bf16 v[52:55], a[152:155], a[68:71], v[52:55]
  ds_read_b64_tr_b16 a[140:141], v1 offset:36000
  v_mfma_f32_16x16x32_bf16 v[52:55], a[156:159], a[84:87], v[52:55]
  v_mfma_f32_16x16x32_bf16 v[48:51], a[156:159], a[80:83], v[48:51]
  buffer_load_dwordx4 a[4:7], v0, s[36:39], s57 offen offset:1024 sc1
  v_mfma_f32_16x16x32_bf16 v[48:51], a[152:155], a[64:67], v[48:51]
  s_waitcnt lgkmcnt(7)
  ds_read_b64_tr_b16 a[142:143], v1 offset:39584
  v_mfma_f32_16x16x32_bf16 v[64:67], a[160:163], a[64:67], v[64:67]
  ds_read_b64_tr_b16 a[144:145], v1 offset:28864
  v_mfma_f32_16x16x32_bf16 v[64:67], a[164:167], a[80:83], v[64:67]
  v_mfma_f32_16x16x32_bf16 v[68:71], a[164:167], a[84:87], v[68:71]
  ds_read_b64_tr_b16 a[146:147], v1 offset:32448
  v_mfma_f32_16x16x32_bf16 v[68:71], a[160:163], a[68:71], v[68:71]
  v_mfma_f32_16x16x32_bf16 v[72:75], a[160:163], a[72:75], v[72:75]
  buffer_load_dwordx4 a[8:11], v0, s[36:39], s57 offen offset:2048 sc1
  v_mfma_f32_16x16x32_bf16 v[72:75], a[164:167], a[88:91], v[72:75]
  ds_read_b64_tr_b16 a[148:149], v1 offset:36032
  v_mfma_f32_16x16x32_bf16 v[76:79], a[164:167], a[92:95], v[76:79]
  ds_read_b64_tr_b16 a[150:151], v1 offset:39616
  v_mfma_f32_16x16x32_bf16 v[76:79], a[160:163], a[76:79], v[76:79]
  v_mfma_f32_16x16x32_bf16 v[92:95], a[168:171], a[76:79], v[92:95]
  ds_read_b64_tr_b16 a[152:153], v1 offset:43008
  v_mfma_f32_16x16x32_bf16 v[92:95], a[172:175], a[92:95], v[92:95]
  buffer_load_dwordx4 v8, s[16:19], s56 offen offset:1024 lds
  v_mfma_f32_16x16x32_bf16 v[88:91], a[172:175], a[88:91], v[88:91]
  ds_read_b64_tr_b16 a[154:155], v1 offset:46592
  v_mfma_f32_16x16x32_bf16 v[88:91], a[168:171], a[72:75], v[88:91]
  v_mfma_f32_16x16x32_bf16 v[84:87], a[168:171], a[68:71], v[84:87]
  ds_read_b64_tr_b16 a[156:157], v1 offset:50176
  v_mfma_f32_16x16x32_bf16 v[84:87], a[172:175], a[84:87], v[84:87]
  v_mfma_f32_16x16x32_bf16 v[80:83], a[172:175], a[80:83], v[80:83]
  buffer_load_dwordx4 a[12:15], v0, s[36:39], s57 offen offset:3072 sc1
  v_mfma_f32_16x16x32_bf16 v[80:83], a[168:171], a[64:67], v[80:83]
  s_waitcnt lgkmcnt(7)
  ds_read_b64_tr_b16 a[158:159], v1 offset:53760
  v_mfma_f32_16x16x32_bf16 v[96:99], a[128:131], a[64:67], v[96:99]
  ds_read_b64_tr_b16 a[160:161], v1 offset:43040
  v_mfma_f32_16x16x32_bf16 v[96:99], a[132:135], a[80:83], v[96:99]
  v_mfma_f32_16x16x32_bf16 v[100:103], a[132:135], a[84:87], v[100:103]
  ds_read_b64_tr_b16 a[162:163], v1 offset:46624
  v_mfma_f32_16x16x32_bf16 v[100:103], a[128:131], a[68:71], v[100:103]
  buffer_load_dwordx4 v9, s[16:19], s56 offen offset:2048 lds
  v_mfma_f32_16x16x32_bf16 v[104:107], a[128:131], a[72:75], v[104:107]
  s_add_u32 s57, s57, 4096
  ds_read_b64_tr_b16 a[164:165], v1 offset:50208
  v_mfma_f32_16x16x32_bf16 v[104:107], a[132:135], a[88:91], v[104:107]
  v_mfma_f32_16x16x32_bf16 v[108:111], a[132:135], a[92:95], v[108:111]
  ds_read_b64_tr_b16 a[166:167], v1 offset:53792
  v_mfma_f32_16x16x32_bf16 v[108:111], a[128:131], a[76:79], v[108:111]
  v_mfma_f32_16x16x32_bf16 v[124:127], a[136:139], a[76:79], v[124:127]
  buffer_load_dwordx4 a[16:19], v0, s[36:39], s57 offen offset:0 sc1
  v_mfma_f32_16x16x32_bf16 v[124:127], a[140:143], a[92:95], v[124:127]
  ds_read_b64_tr_b16 a[168:169], v1 offset:43072
  v_mfma_f32_16x16x32_bf16 v[120:123], a[140:143], a[88:91], v[120:123]
  ds_read_b64_tr_b16 a[170:171], v1 offset:46656
  v_mfma_f32_16x16x32_bf16 v[120:123], a[136:139], a[72:75], v[120:123]
  v_mfma_f32_16x16x32_bf16 v[116:119], a[136:139], a[68:71], v[116:119]
  ds_read_b64_tr_b16 a[172:173], v1 offset:50240
  v_mfma_f32_16x16x32_bf16 v[116:119], a[140:143], a[84:87], v[116:119]
  v_mfma_f32_16x16x32_bf16 v[112:115], a[140:143], a[80:83], v[112:115]
  ds_read_b64_tr_b16 a[174:175], v1 offset:53824
  v_mfma_f32_16x16x32_bf16 v[112:115], a[136:139], a[64:67], v[112:115]
  s_waitcnt lgkmcnt(8)
  v_mfma_f32_16x16x32_bf16 v[128:131], a[144:147], a[64:67], v[128:131]
  ds_read_b64_tr_b16 a[128:129], v1 offset:43104
  v_mfma_f32_16x16x32_bf16 v[128:131], a[148:151], a[80:83], v[128:131]
  v_mfma_f32_16x16x32_bf16 v[132:135], a[148:151], a[84:87], v[132:135]
  buffer_load_dwordx4 a[20:23], v0, s[36:39], s57 offen offset:1024 sc1
  s_bfe_u32 s56, s83, 0x30014
  v_mfma_f32_16x16x32_bf16 v[132:135], a[144:147], a[68:71], v[132:135]
  s_lshl_b32 s56, s56, 2
  s_bitcmp1_b32 s83, 23
  s_addc_u32 s56, s56, 0
  v_mfma_f32_16x16x32_bf16 v[136:139], a[144:147], a[72:75], v[136:139]
  s_mul_i32 s56, s56, 229376
  s_add_u32 m0, s84, 0
  ds_read_b64_tr_b16 a[130:131], v1 offset:46688
  v_mfma_f32_16x16x32_bf16 v[136:139], a[148:151], a[88:91], v[136:139]
  ds_read_b64_tr_b16 a[132:133], v1 offset:50272
  v_mfma_f32_16x16x32_bf16 v[140:143], a[148:151], a[92:95], v[140:143]
  ds_read_b64_tr_b16 a[134:135], v1 offset:53856
  v_mfma_f32_16x16x32_bf16 v[140:143], a[144:147], a[76:79], v[140:143]
  buffer_load_dwordx4 v3, s[16:19], s56 offen offset:0 lds
  v_mfma_f32_16x16x32_bf16 v[156:159], a[152:155], a[76:79], v[156:159]
  ds_read_b64_tr_b16 a[136:137], v1 offset:43136
  v_mfma_f32_16x16x32_bf16 v[156:159], a[156:159], a[92:95], v[156:159]
  v_mfma_f32_16x16x32_bf16 v[152:155], a[156:159], a[88:91], v[152:155]
  ds_read_b64_tr_b16 a[138:139], v1 offset:46720
  v_mfma_f32_16x16x32_bf16 v[152:155], a[152:155], a[72:75], v[152:155]
Hc1_1:
  s_cbranch_execz Hc1_2
  v_mfma_f32_16x16x32_bf16 v[148:151], a[152:155], a[68:71], v[148:151]
  buffer_load_dwordx4 a[24:27], v0, s[36:39], s57 offen offset:2048 sc1
  v_mfma_f32_16x16x32_bf16 v[148:151], a[156:159], a[84:87], v[148:151]
  ds_read_b64_tr_b16 a[140:141], v1 offset:50304
  v_mfma_f32_16x16x32_bf16 v[144:147], a[156:159], a[80:83], v[144:147]
  ds_read_b64_tr_b16 a[142:143], v1 offset:53888
  v_mfma_f32_16x16x32_bf16 v[144:147], a[152:155], a[64:67], v[144:147]
  s_waitcnt lgkmcnt(8)
  v_mfma_f32_16x16x32_bf16 v[160:163], a[160:163], a[64:67], v[160:163]
  ds_read_b64_tr_b16 a[144:145], v1 offset:43168
  v_mfma_f32_16x16x32_bf16 v[160:163], a[164:167], a[80:83], v[160:163]
  buffer_load_dwordx4 v4, s[16:19], s56 offen offset:1024 lds
  v_mfma_f32_16x16x32_bf16 v[164:167], a[164:167], a[84:87], v[164:167]
  ds_read_b64_tr_b16 a[146:147], v1 offset:46752
  v_mfma_f32_16x16x32_bf16 v[164:167], a[160:163], a[68:71], v[164:167]
  v_mfma_f32_16x16x32_bf16 v[168:171], a[160:163], a[72:75], v[168:171]
  ds_read_b64_tr_b16 a[148:149], v1 offset:50336
  v_mfma_f32_16x16x32_bf16 v[168:171], a[164:167], a[88:91], v[168:171]
  v_mfma_f32_16x16x32_bf16 v[172:175], a[164:167], a[92:95], v[172:175]
  buffer_load_dwordx4 a[28:31], v0, s[36:39], s57 offen offset:3072 sc1
  v_mfma_f32_16x16x32_bf16 v[172:175], a[160:163], a[76:79], v[172:175]
  s_waitcnt vmcnt(23)
  s_barrier
  ds_read_b64_tr_b16 a[150:151], v1 offset:53920
  v_mfma_f32_16x16x32_bf16 v[188:191], a[168:171], a[76:79], v[188:191]
  ds_read_b64_tr_b16 a[152:153], v1 offset:43200
  v_mfma_f32_16x16x32_bf16 v[188:191], a[172:175], a[92:95], v[188:191]
  v_mfma_f32_16x16x32_bf16 v[184:187], a[172:175], a[88:91], v[184:187]
  ds_read_b64_tr_b16 a[154:155], v1 offset:46784
  v_mfma_f32_16x16x32_bf16 v[184:187], a[168:171], a[72:75], v[184:187]
  buffer_load_dwordx4 v5, s[16:19], s56 offen offset:2048 lds
  s_bfe_u32 s57, s83, 0x40014
  v_mfma_f32_16x16x32_bf16 v[180:183], a[168:171], a[68:71], v[180:183]
  s_lshl_b32 s57, s57, 13
  s_add_u32 s57, s57, s85
  ds_read_b64_tr_b16 a[156:157], v1 offset:50368
  v_mfma_f32_16x16x32_bf16 v[180:183], a[172:175], a[84:87], v[180:183]
  v_mfma_f32_16x16x32_bf16 v[176:179], a[172:175], a[80:83], v[176:179]
  ds_read_b64_tr_b16 a[158:159], v1 offset:53952
  v_mfma_f32_16x16x32_bf16 v[176:179], a[168:171], a[64:67], v[176:179]
  s_waitcnt lgkmcnt(8)
  v_mfma_f32_16x16x32_bf16 v[192:195], a[128:131], a[64:67], v[192:195]
  buffer_load_dwordx4 a[32:35], v0, s[36:39], s57 offen offset:0 sc1
  v_mfma_f32_16x16x32_bf16 v[192:195], a[132:135], a[80:83], v[192:195]
  ds_read_b64_tr_b16 a[160:161], v2 offset:0
  v_mfma_f32_16x16x32_bf16 v[196:199], a[132:135], a[84:87], v[196:199]
  ds_read_b64_tr_b16 a[162:163], v2 offset:3584
  v_mfma_f32_16x16x32_bf16 v[196:199], a[128:131], a[68:71], v[196:199]
  v_mfma_f32_16x16x32_bf16 v[200:203], a[128:131], a[72:75], v[200:203]
  ds_read_b64_tr_b16 a[164:165], v2 offset:7168
  v_mfma_f32_16x16x32_bf16 v[200:203], a[132:135], a[88:91], v[200:203]
  buffer_load_dwordx4 a[36:39], v0, s[36:39], s57 offen offset:1024 sc1
  v_mfma_f32_16x16x32_bf16 v[204:207], a[132:135], a[92:95], v[204:207]
  ds_read_b64_tr_b16 a[166:167], v2 offset:10752
  v_mfma_f32_16x16x32_bf16 v[204:207], a[128:131], a[76:79], v[204:207]
  v_mfma_f32_16x16x32_bf16 v[220:223], a[136:139], a[76:79], v[220:223]
  ds_read_b64_tr_b16 a[168:169], v2 offset:32
  v_mfma_f32_16x16x32_bf16 v[220:223], a[140:143], a[92:95], v[220:223]
  v_mfma_f32_16x16x32_bf16 v[216:219], a[140:143], a[88:91], v[216:219]
  buffer_load_dwordx4 v6, s[16:19], s56 offen offset:3072 lds
  v_mfma_f32_16x16x32_bf16 v[216:219], a[136:139], a[72:75], v[216:219]
  ds_read_b64_tr_b16 a[170:171], v2 offset:3616
  v_mfma_f32_16x16x32_bf16 v[212:215], a[136:139], a[68:71], v[212:215]
  ds_read_b64_tr_b16 a[172:173], v2 offset:7200
  v_mfma_f32_16x16x32_bf16 v[212:215], a[140:143], a[84:87], v[212:215]
  v_mfma_f32_16x16x32_bf16 v[208:211], a[140:143], a[80:83], v[208:211]
  ds_read_b64_tr_b16 a[174:175], v2 offset:10784
  v_mfma_f32_16x16x32_bf16 v[208:211], a[136:139], a[64:67], v[208:211]
  s_waitcnt lgkmcnt(8)
  buffer_load_dwordx4 a[40:43], v0, s[36:39], s57 offen offset:2048 sc1
  s_add_u32 m0, s84, 4096
  v_mfma_f32_16x16x32_bf16 v[224:227], a[144:147], a[64:67], v[224:227]
  ds_read_b64_tr_b16 a[128:129], v2 offset:64
  v_mfma_f32_16x16x32_bf16 v[224:227], a[148:151], a[80:83], v[224:227]
  v_mfma_f32_16x16x32_bf16 v[228:231], a[148:151], a[84:87], v[228:231]
  ds_read_b64_tr_b16 a[130:131], v2 offset:3648
  v_mfma_f32_16x16x32_bf16 v[228:231], a[144:147], a[68:71], v[228:231]
  v_mfma_f32_16x16x32_bf16 v[232:235], a[144:147], a[72:75], v[232:235]
  buffer_load_dwordx4 v7, s[16:19], s56 offen offset:0 lds
  v_mfma_f32_16x16x32_bf16 v[232:235], a[148:151], a[88:91], v[232:235]
  ds_read_b64_tr_b16 a[132:133], v2 offset:7232
  v_mfma_f32_16x16x32_bf16 v[236:239], a[148:151], a[92:95], v[236:239]
  ds_read_b64_tr_b16 a[134:135], v2 offset:10816
  v_mfma_f32_16x16x32_bf16 v[236:239], a[144:147], a[76:79], v[236:239]
  v_mfma_f32_16x16x32_bf16 v[252:255], a[152:155], a[76:79], v[252:255]
  ds_read_b64_tr_b16 a[136:137], v2 offset:96
  v_mfma_f32_16x16x32_bf16 v[252:255], a[156:159], a[92:95], v[252:255]
  buffer_load_dwordx4 a[44:47], v0, s[36:39], s57 offen offset:3072 sc1
  v_mfma_f32_16x16x32_bf16 v[248:251], a[156:159], a[88:91], v[248:251]
  ds_read_b64_tr_b16 a[138:139], v2 offset:3680
  v_mfma_f32_16x16x32_bf16 v[248:251], a[152:155], a[72:75], v[248:251]
  v_mfma_f32_16x16x32_bf16 v[244:247], a[152:155], a[68:71], v[244:247]
  ds_read_b64_tr_b16 a[140:141], v2 offset:7264
  v_mfma_f32_16x16x32_bf16 v[244:247], a[156:159], a[84:87], v[244:247]
  v_mfma_f32_16x16x32_bf16 v[240:243], a[156:159], a[80:83], v[240:243]
  ds_read_b64_tr_b16 a[142:143], v2 offset:10848
  v_mfma_f32_16x16x32_bf16 v[240:243], a[152:155], a[64:67], v[240:243]
  s_waitcnt vmcnt(21) lgkmcnt(8)
  buffer_load_dwordx4 v8, s[16:19], s56 offen offset:1024 lds
  s_add_u32 s57, s57, 4096
  v_mfma_f32_16x16x32_bf16 v[32:35], a[160:163], a[96:99], v[32:35]
  ds_read_b64_tr_b16 a[144:145], v2 offset:128
  v_mfma_f32_16x16x32_bf16 v[32:35], a[164:167], a[112:115], v[32:35]
  s_barrier
  v_mfma_f32_16x16x32_bf16 v[36:39], a[164:167], a[116:119], v[36:39]
  ds_read_b64_tr_b16 a[146:147], v2 offset:3712
  v_mfma_f32_16x16x32_bf16 v[36:39], a[160:163], a[100:103], v[36:39]
  v_mfma_f32_16x16x32_bf16 v[40:43], a[160:163], a[104:107], v[40:43]
  buffer_load_dwordx4 a[48:51], v0, s[36:39], s57 offen offset:0 sc1
  v_mfma_f32_16x16x32_bf16 v[40:43], a[164:167], a[120:123], v[40:43]
  ds_read_b64_tr_b16 a[148:149], v2 offset:7296
  v_mfma_f32_16x16x32_bf16 v[44:47], a[164:167], a[124:127], v[44:47]
  ds_read_b64_tr_b16 a[150:151], v2 offset:10880
  v_mfma_f32_16x16x32_bf16 v[44:47], a[160:163], a[108:111], v[44:47]
  v_mfma_f32_16x16x32_bf16 v[60:63], a[168:171], a[108:111], v[60:63]
  ds_read_b64_tr_b16 a[152:153], v2 offset:160
  v_mfma_f32_16x16x32_bf16 v[60:63], a[172:175], a[124:127], v[60:63]
  v_mfma_f32_16x16x32_bf16 v[56:59], a[172:175], a[120:123], v[56:59]
  ds_read_b64_tr_b16 a[154:155], v2 offset:3744
  v_mfma_f32_16x16x32_bf16 v[56:59], a[168:171], a[104:107], v[56:59]
  buffer_load_dwordx4 v9, s[16:19], s56 offen offset:2048 lds
  v_mfma_f32_16x16x32_bf16 v[52:55], a[168:171], a[100:103], v[52:55]
  ds_read_b64_tr_b16 a[156:157], v2 offset:7328
  v_mfma_f32_16x16x32_bf16 v[52:55], a[172:175], a[116:119], v[52:55]
  v_mfma_f32_16x16x32_bf16 v[48:51], a[172:175], a[112:115], v[48:51]
  ds_read_b64_tr_b16 a[158:159], v2 offset:10912
  v_mfma_f32_16x16x32_bf16 v[48:51], a[168:171], a[96:99], v[48:51]
  s_waitcnt lgkmcnt(8)
  v_mfma_f32_16x16x32_bf16 v[64:67], a[128:131], a[96:99], v[64:67]
  buffer_load_dwordx4 a[52:55], v0, s[36:39], s57 offen offset:1024 sc1
  v_mfma_f32_16x16x32_bf16 v[64:67], a[132:135], a[112:115], v[64:67]
  ds_read_b64_tr_b16 a[160:161], v2 offset:192
  v_mfma_f32_16x16x32_bf16 v[68:71], a[132:135], a[116:119], v[68:71]
  ds_read_b64_tr_b16 a[162:163], v2 offset:3776
  v_mfma_f32_16x16x32_bf16 v[68:71], a[128:131], a[100:103], v[68:71]
  v_mfma_f32_16x16x32_bf16 v[72:75], a[128:131], a[104:107], v[72:75]
  ds_read_b64_tr_b16 a[164:165], v2 offset:7360
  v_mfma_f32_16x16x32_bf16 v[72:75], a[132:135], a[120:123], v[72:75]
  v_mfma_f32_16x16x32_bf16 v[76:79], a[132:135], a[124:127], v[76:79]
  buffer_load_dwordx4 a[56:59], v0, s[36:39], s57 offen offset:2048 sc1
  v_mfma_f32_16x16x32_bf16 v[76:79], a[128:131], a[108:111], v[76:79]
  ds_read_b64_tr_b16 a[166:167], v2 offset:10944
  v_mfma_f32_16x16x32_bf16 v[92:95], a[136:139], a[108:111], v[92:95]
  s_bfe_u32 s56, s83, 0x30018
  s_lshl_b32 s56, s56, 2
  s_bitcmp1_b32 s83, 27
  v_mfma_f32_16x16x32_bf16 v[92:95], a[140:143], a[124:127], v[92:95]
  s_addc_u32 s56, s56, 0
  s_mul_i32 s56, s56, 229376
  s_add_u32 m0, s84, 28672
  v_mfma_f32_16x16x32_bf16 v[88:91], a[140:143], a[120:123], v[88:91]
  ds_read_b64_tr_b16 a[168:169], v2 offset:14336
  v_mfma_f32_16x16x32_bf16 v[88:91], a[136:139], a[104:107], v[88:91]
  ds_read_b64_tr_b16 a[170:171], v2 offset:17920
  v_mfma_f32_16x16x32_bf16 v[84:87], a[136:139], a[100:103], v[84:87]
  buffer_load_dwordx4 v3, s[16:19], s56 offen offset:0 lds
  v_mfma_f32_16x16x32_bf16 v[84:87], a[140:143], a[116:119], v[84:87]
  ds_read_b64_tr_b16 a[172:173], v2 offset:21504
  v_mfma_f32_16x16x32_bf16 v[80:83], a[140:143], a[112:115], v[80:83]
  ds_read_b64_tr_b16 a[174:175], v2 offset:25088
  v_mfma_f32_16x16x32_bf16 v[80:83], a[136:139], a[96:99], v[80:83]
  s_waitcnt lgkmcnt(8)
  v_mfma_f32_16x16x32_bf16 v[96:99], a[144:147], a[96:99], v[96:99]
  ds_read_b64_tr_b16 a[128:129], v2 offset:14368
  v_mfma_f32_16x16x32_bf16 v[96:99], a[148:151], a[112:115], v[96:99]
  buffer_load_dwordx4 a[60:63], v0, s[36:39], s57 offen offset:3072 sc1
  s_bfe_u32 s57, s83, 0x40018
  v_mfma_f32_16x16x32_bf16 v[100:103], a[148:151], a[116:119], v[100:103]
  s_lshl_b32 s57, s57, 13
  s_add_u32 s57, s57, s85
  ds_read_b64_tr_b16 a[130:131], v2 offset:17952
  v_mfma_f32_16x16x32_bf16 v[100:103], a[144:147], a[100:103], v[100:103]
  v_mfma_f32_16x16x32_bf16 v[104:107], a[144:147], a[104:107], v[104:107]
  buffer_load_dwordx4 a[208:211], v25, s[36:39], s77 offen offset:0 sc1
  v_mfma_f32_16x16x32_bf16 v[104:107], a[148:151], a[120:123], v[104:107]
  ds_read_b64_tr_b16 a[132:133], v2 offset:21536
  v_mfma_f32_16x16x32_bf16 v[108:111], a[148:151], a[124:127], v[108:111]
  ds_read_b64_tr_b16 a[134:135], v2 offset:25120
  v_mfma_f32_16x16x32_bf16 v[108:111], a[144:147], a[108:111], v[108:111]
  v_mfma_f32_16x16x32_bf16 v[124:127], a[152:155], a[108:111], v[124:127]
  ds_read_b64_tr_b16 a[136:137], v2 offset:14400
  v_mfma_f32_16x16x32_bf16 v[124:127], a[156:159], a[124:127], v[124:127]
  buffer_load_dwordx4 a[212:215], v25, s[36:39], s77 offen offset:2048 sc1
  v_mfma_f32_16x16x32_bf16 v[120:123], a[156:159], a[120:123], v[120:123]
  ds_read_b64_tr_b16 a[138:139], v2 offset:17984
  v_mfma_f32_16x16x32_bf16 v[120:123], a[152:155], a[104:107], v[120:123]
  v_mfma_f32_16x16x32_bf16 v[116:119], a[152:155], a[100:103], v[116:119]
  ds_read_b64_tr_b16 a[140:141], v2 offset:21568
  v_mfma_f32_16x16x32_bf16 v[116:119], a[156:159], a[116:119], v[116:119]
  v_mfma_f32_16x16x32_bf16 v[112:115], a[156:159], a[112:115], v[112:115]
  buffer_load_dwordx4 a[216:219], v25, s[36:39], s76 offen offset:0 sc1
  v_mfma_f32_16x16x32_bf16 v[112:115], a[152:155], a[96:99], v[112:115]
  s_waitcnt lgkmcnt(7)
  ds_read_b64_tr_b16 a[142:143], v2 offset:25152
  v_mfma_f32_16x16x32_bf16 v[128:131], a[160:163], a[96:99], v[128:131]
  ds_read_b64_tr_b16 a[144:145], v2 offset:14432
  v_mfma_f32_16x16x32_bf16 v[128:131], a[164:167], a[112:115], v[128:131]
  v_mfma_f32_16x16x32_bf16 v[132:135], a[164:167], a[116:119], v[132:135]
  ds_read_b64_tr_b16 a[146:147], v2 offset:18016
  v_mfma_f32_16x16x32_bf16 v[132:135], a[160:163], a[100:103], v[132:135]
  buffer_load_dwordx4 a[220:223], v25, s[36:39], s76 offen offset:2048 sc1
  v_mfma_f32_16x16x32_bf16 v[136:139], a[160:163], a[104:107], v[136:139]
  ds_read_b64_tr_b16 a[148:149], v2 offset:21600
  v_mfma_f32_16x16x32_bf16 v[136:139], a[164:167], a[120:123], v[136:139]
  v_mfma_f32_16x16x32_bf16 v[140:143], a[164:167], a[124:127], v[140:143]
  ds_read_b64_tr_b16 a[150:151], v2 offset:25184
  v_mfma_f32_16x16x32_bf16 v[140:143], a[160:163], a[108:111], v[140:143]
  v_mfma_f32_16x16x32_bf16 v[156:159], a[168:171], a[108:111], v[156:159]
  buffer_load_dwordx4 a[64:67], v0, s[36:39], s57 offen offset:0 sc1
  v_mfma_f32_16x16x32_bf16 v[156:159], a[172:175], a[124:127], v[156:159]
  ds_read_b64_tr_b16 a[152:153], v2 offset:14464
  v_mfma_f32_16x16x32_bf16 v[152:155], a[172:175], a[120:123], v[152:155]
  ds_read_b64_tr_b16 a[154:155], v2 offset:18048
  v_mfma_f32_16x16x32_bf16 v[152:155], a[168:171], a[104:107], v[152:155]
  v_mfma_f32_16x16x32_bf16 v[148:151], a[168:171], a[100:103], v[148:151]
  ds_read_b64_tr_b16 a[156:157], v2 offset:21632
  v_mfma_f32_16x16x32_bf16 v[148:151], a[172:175], a[116:119], v[148:151]
  buffer_load_dwordx4 v4, s[16:19], s56 offen offset:1024 lds
  v_mfma_f32_16x16x32_bf16 v[144:147], a[172:175], a[112:115], v[144:147]
  ds_read_b64_tr_b16 a[158:159], v2 offset:25216
  v_mfma_f32_16x16x32_bf16 v[144:147], a[168:171], a[96:99], v[144:147]
  s_waitcnt lgkmcnt(8)
  v_mfma_f32_16x16x32_bf16 v[160:163], a[128:131], a[96:99], v[160:163]
  ds_read_b64_tr_b16 a[160:161], v2 offset:14496
  v_mfma_f32_16x16x32_bf16 v[160:163], a[132:135], a[112:115], v[160:163]
  v_mfma_f32_16x16x32_bf16 v[164:167], a[132:135], a[116:119], v[164:167]
  buffer_load_dwordx4 a[68:71], v0, s[36:39], s57 offen offset:1024 sc1
  v_mfma_f32_16x16x32_bf16 v[164:167], a[128:131], a[100:103], v[164:167]
  ds_read_b64_tr_b16 a[162:163], v2 offset:18080
  v_mfma_f32_16x16x32_bf16 v[168:171], a[128:131], a[104:107], v[168:171]
  ds_read_b64_tr_b16 a[164:165], v2 offset:21664
  v_mfma_f32_16x16x32_bf16 v[168:171], a[132:135], a[120:123], v[168:171]
  v_mfma_f32_16x16x32_bf16 v[172:175], a[132:135], a[124:127], v[172:175]
  ds_read_b64_tr_b16 a[166:167], v2 offset:25248
  v_mfma_f32_16x16x32_bf16 v[172:175], a[128:131], a[108:111], v[172:175]
  s_waitcnt vmcnt(27)
  s_barrier
  buffer_load_dwordx4 v5, s[16:19], s56 offen offset:2048 lds
  v_mfma_f32_16x16x32_bf16 v[188:191], a[136:139], a[108:111], v[188:191]
  ds_read_b64_tr_b16 a[168:169], v2 offset:14528
  v_mfma_f32_16x16x32_bf16 v[188:191], a[140:143], a[124:127], v[188:191]
  v_mfma_f32_16x16x32_bf16 v[184:187], a[140:143], a[120:123], v[184:187]
  ds_read_b64_tr_b16 a[170:171], v2 offset:18112
  v_mfma_f32_16x16x32_bf16 v[184:187], a[136:139], a[104:107], v[184:187]
  v_mfma_f32_16x16x32_bf16 v[180:183], a[136:139], a[100:103], v[180:183]
  buffer_load_dwordx4 a[72:75], v0, s[36:39], s57 offen offset:2048 sc1
  v_mfma_f32_16x16x32_bf16 v[180:183], a[140:143], a[116:119], v[180:183]
  ds_read_b64_tr_b16 a[172:173], v2 offset:21696
  v_mfma_f32_16x16x32_bf16 v[176:179], a[140:143], a[112:115], v[176:179]
  ds_read_b64_tr_b16 a[174:175], v2 offset:25280
  v_mfma_f32_16x16x32_bf16 v[176:179], a[136:139], a[96:99], v[176:179]
  s_waitcnt lgkmcnt(8)
  v_mfma_f32_16x16x32_bf16 v[192:195], a[144:147], a[96:99], v[192:195]
  ds_read_b64_tr_b16 a[128:129], v2 offset:28672
  v_mfma_f32_16x16x32_bf16 v[192:195], a[148:151], a[112:115], v[192:195]
  buffer_load_dwordx4 v6, s[16:19], s56 offen offset:3072 lds
  v_mfma_f32_16x16x32_bf16 v[196:199], a[148:151], a[116:119], v[196:199]
  ds_read_b64_tr_b16 a[130:131], v2 offset:32256
  v_mfma_f32_16x16x32_bf16 v[196:199], a[144:147], a[100:103], v[196:199]
  v_mfma_f32_16x16x32_bf16 v[200:203], a[144:147], a[104:107], v[200:203]
  ds_read_b64_tr_b16 a[132:133], v2 offset:35840
  v_mfma_f32_16x16x32_bf16 v[200:203], a[148:151], a[120:123], v[200:203]
  v_mfma_f32_16x16x32_bf16 v[204:207], a[148:151], a[124:127], v[204:207]
  buffer_load_dwordx4 a[76:79], v0, s[36:39], s57 offen offset:3072 sc1
  s_add_u32 m0, s84, 32768
  v_mfma_f32_16x16x32_bf16 v[204:207], a[144:147], a[108:111], v[204:207]
  ds_read_b64_tr_b16 a[134:135], v2 offset:39424
  v_mfma_f32_16x16x32_bf16 v[220:223], a[152:155], a[108:111], v[220:223]
  ds_read_b64_tr_b16 a[136:137], v2 offset:28704
  v_mfma_f32_16x16x32_bf16 v[220:223], a[156:159], a[124:127], v[220:223]
  v_mfma_f32_16x16x32_bf16 v[216:219], a[156:159], a[120:123], v[216:219]
  ds_read_b64_tr_b16 a[138:139], v2 offset:32288
  v_mfma_f32_16x16x32_bf16 v[216:219], a[152:155], a[104:107], v[216:219]
  buffer_load_dwordx4 v7, s[16:19], s56 offen offset:0 lds
  s_add_u32 s57, s57, 4096
  v_mfma_f32_16x16x32_bf16 v[212:215], a[152:155], a[100:103], v[212:215]
  ds_read_b64_tr_b16 a[140:141], v2 offset:35872
  v_mfma_f32_16x16x32_bf16 v[212:215], a[156:159], a[116:119], v[212:215]
  v_mfma_f32_16x16x32_bf16 v[208:211], a[156:159], a[112:115], v[208:211]
  ds_read_b64_tr_b16 a[142:143], v2 offset:39456
  v_mfma_f32_16x16x32_bf16 v[208:211], a[152:155], a[96:99], v[208:211]
  s_waitcnt lgkmcnt(8)
  v_mfma_f32_16x16x32_bf16 v[224:227], a[160:163], a[96:99], v[224:227]
  buffer_load_dwordx4 a[80:83], v0, s[36:39], s57 offen offset:0 sc1
  v_mfma_f32_16x16x32_bf16 v[224:227], a[164:167], a[112:115], v[224:227]
  ds_read_b64_tr_b16 a[144:145], v2 offset:28736
  v_mfma_f32_16x16x32_bf16 v[228:231], a[164:167], a[116:119], v[228:231]
  ds_read_b64_tr_b16 a[146:147], v2 offset:32320
  v_mfma_f32_16x16x32_bf16 v[228:231], a[160:163], a[100:103], v[228:231]
  v_mfma_f32_16x16x32_bf16 v[232:235], a[160:163], a[104:107], v[232:235]
  ds_read_b64_tr_b16 a[148:149], v2 offset:35904
  v_mfma_f32_16x16x32_bf16 v[232:235], a[164:167], a[120:123], v[232:235]
  buffer_load_dwordx4 a[84:87], v0, s[36:39], s57 offen offset:1024 sc1
  v_mfma_f32_16x16x32_bf16 v[236:239], a[164:167], a[124:127], v[236:239]
  ds_read_b64_tr_b16 a[150:151], v2 offset:39488
  v_mfma_f32_16x16x32_bf16 v[236:239], a[160:163], a[108:111], v[236:239]
  v_mfma_f32_16x16x32_bf16 v[252:255], a[168:171], a[108:111], v[252:255]
  ds_read_b64_tr_b16 a[152:153], v2 offset:28768
  v_mfma_f32_16x16x32_bf16 v[252:255], a[172:175], a[124:127], v[252:255]
  v_mfma_f32_16x16x32_bf16 v[248:251], a[172:175], a[120:123], v[248:251]
  buffer_load_dwordx4 v8, s[16:19], s56 offen offset:1024 lds
  v_mfma_f32_16x16x32_bf16 v[248:251], a[168:171], a[104:107], v[248:251]
  ds_read_b64_tr_b16 a[154:155], v2 offset:32352
  v_mfma_f32_16x16x32_bf16 v[244:247], a[168:171], a[100:103], v[244:247]
  ds_read_b64_tr_b16 a[156:157], v2 offset:35936
  v_mfma_f32_16x16x32_bf16 v[244:247], a[172:175], a[116:119], v[244:247]
  v_mfma_f32_16x16x32_bf16 v[240:243], a[172:175], a[112:115], v[240:243]
  ds_read_b64_tr_b16 a[158:159], v2 offset:39520
  v_mfma_f32_16x16x32_bf16 v[240:243], a[168:171], a[96:99], v[240:243]
  s_waitcnt vmcnt(29) lgkmcnt(8)
  buffer_load_dwordx4 a[88:91], v0, s[36:39], s57 offen offset:2048 sc1
  v_mfma_f32_16x16x32_bf16 v[32:35], a[128:131], a[0:3], v[32:35]
  ds_read_b64_tr_b16 a[160:161], v2 offset:28800
  v_mfma_f32_16x16x32_bf16 v[32:35], a[132:135], a[16:19], v[32:35]
  s_waitcnt vmcnt(20)
  s_barrier
  v_mfma_f32_16x16x32_bf16 v[36:39], a[132:135], a[20:23], v[36:39]
  ds_read_b64_tr_b16 a[162:163], v2 offset:32384
  v_mfma_f32_16x16x32_bf16 v[36:39], a[128:131], a[4:7], v[36:39]
  v_mfma_f32_16x16x32_bf16 v[40:43], a[128:131], a[8:11], v[40:43]
  buffer_load_dwordx4 v9, s[16:19], s56 offen offset:2048 lds
  v_mfma_f32_16x16x32_bf16 v[40:43], a[132:135], a[24:27], v[40:43]
  ds_read_b64_tr_b16 a[164:165], v2 offset:35968
  v_mfma_f32_16x16x32_bf16 v[44:47], a[132:135], a[28:31], v[44:47]
  ds_read_b64_tr_b16 a[166:167], v2 offset:39552
  v_mfma_f32_16x16x32_bf16 v[44:47], a[128:131], a[12:15], v[44:47]
  v_mfma_f32_16x16x32_bf16 v[60:63], a[136:139], a[12:15], v[60:63]
  ds_read_b64_tr_b16 a[168:169], v2 offset:28832
  v_mfma_f32_16x16x32_bf16 v[60:63], a[140:143], a[28:31], v[60:63]
  buffer_load_dwordx4 a[92:95], v0, s[36:39], s57 offen offset:3072 sc1
  s_bfe_u32 s56, s83, 0x3001c
  v_mfma_f32_16x16x32_bf16 v[56:59], a[140:143], a[24:27], v[56:59]
  s_lshl_b32 s56, s56, 2
  s_bitcmp1_b32 s83, 31
  s_addc_u32 s56, s56, 0
  v_mfma_f32_16x16x32_bf16 v[56:59], a[136:139], a[8:11], v[56:59]
  s_mul_i32 s56, s56, 229376
  s_add_u32 m0, s84, 57344
  ds_read_b64_tr_b16 a[170:171], v2 offset:32416
  v_mfma_f32_16x16x32_bf16 v[52:55], a[136:139], a[4:7], v[52:55]
  ds_read_b64_tr_b16 a[172:173], v2 offset:36000
  v_mfma_f32_16x16x32_bf16 v[52:55], a[140:143], a[20:23], v[52:55]
  s_waitcnt vmcnt(14)
  v_accvgpr_read_b32 v26, a208
  v_accvgpr_read_b32 v27, a209
  v_mfma_f32_16x16x32_bf16 v[48:51], a[140:143], a[16:19], v[48:51]
  buffer_load_dwordx4 v3, s[16:19], s56 offen offset:0 lds
  v_accvgpr_read_b32 v28, a210
  v_mfma_f32_16x16x32_bf16 v[48:51], a[136:139], a[0:3], v[48:51]
  s_waitcnt lgkmcnt(7)
  ds_read_b64_tr_b16 a[174:175], v2 offset:39584
  v_accvgpr_read_b32 v29, a211
  v_mfma_f32_16x16x32_bf16 v[64:67], a[144:147], a[0:3], v[64:67]
  ds_read_b64_tr_b16 a[128:129], v2 offset:28864
  v_max_u32 v31, v26, v27
  v_mfma_f32_16x16x32_bf16 v[64:67], a[148:151], a[16:19], v[64:67]
  v_max3_u32 v31, v31, v28, v29
  v_accvgpr_read_b32 v22, a212
  v_mfma_f32_16x16x32_bf16 v[68:71], a[148:151], a[20:23], v[68:71]
  ds_read_b64_tr_b16 a[130:131], v2 offset:32448
  v_accvgpr_read_b32 v23, a213
  v_mfma_f32_16x16x32_bf16 v[68:71], a[144:147], a[4:7], v[68:71]
  buffer_load_dwordx4 v4, s[16:19], s56 offen offset:1024 lds
  v_max3_u32 v31, v31, v22, v23
  v_mfma_f32_16x16x32_bf16 v[72:75], a[144:147], a[8:11], v[72:75]
  ds_read_b64_tr_b16 a[132:133], v2 offset:36032
  v_add_f32 v26, v26, v22
  v_mfma_f32_16x16x32_bf16 v[72:75], a[148:151], a[24:27], v[72:75]
  v_add_f32 v27, v27, v23
  v_accvgpr_read_b32 v22, a214
  v_mfma_f32_16x16x32_bf16 v[76:79], a[148:151], a[28:31], v[76:79]
  ds_read_b64_tr_b16 a[134:135], v2 offset:39616
  v_accvgpr_read_b32 v23, a215
  v_mfma_f32_16x16x32_bf16 v[76:79], a[144:147], a[12:15], v[76:79]
  v_max3_u32 v31, v31, v22, v23
  v_add_f32 v28, v28, v22
  v_mfma_f32_16x16x32_bf16 v[92:95], a[152:155], a[12:15], v[92:95]
  buffer_load_dwordx4 v5, s[16:19], s56 offen offset:2048 lds
  v_add_f32 v29, v29, v23
  v_mfma_f32_16x16x32_bf16 v[92:95], a[156:159], a[28:31], v[92:95]
  ds_read_b64_tr_b16 a[136:137], v2 offset:43008
  v_accvgpr_read_b32 v22, a216
  v_mfma_f32_16x16x32_bf16 v[88:91], a[156:159], a[24:27], v[88:91]
  ds_read_b64_tr_b16 a[138:139], v2 offset:46592
  v_accvgpr_read_b32 v23, a217
  v_mfma_f32_16x16x32_bf16 v[88:91], a[152:155], a[8:11], v[88:91]
  v_max3_u32 v31, v31, v22, v23
  v_add_f32 v26, v26, v22
  v_mfma_f32_16x16x32_bf16 v[84:87], a[152:155], a[4:7], v[84:87]
  ds_read_b64_tr_b16 a[140:141], v2 offset:50176
  v_add_f32 v27, v27, v23
  v_mfma_f32_16x16x32_bf16 v[84:87], a[156:159], a[20:23], v[84:87]
  buffer_load_dwordx4 v6, s[16:19], s56 offen offset:3072 lds
  s_add_u32 m0, s84, 61440
  v_mfma_f32_16x16x32_bf16 v[80:83], a[156:159], a[16:19], v[80:83]
  ds_read_b64_tr_b16 a[142:143], v2 offset:53760
  v_accvgpr_read_b32 v22, a218
  v_mfma_f32_16x16x32_bf16 v[80:83], a[152:155], a[0:3], v[80:83]
  s_waitcnt lgkmcnt(8)
  v_accvgpr_read_b32 v23, a219
  v_max3_u32 v31, v31, v22, v23
  v_mfma_f32_16x16x32_bf16 v[96:99], a[160:163], a[0:3], v[96:99]
  ds_read_b64_tr_b16 a[144:145], v2 offset:43040
  v_add_f32 v28, v28, v22
  v_mfma_f32_16x16x32_bf16 v[96:99], a[164:167], a[16:19], v[96:99]
  v_add_f32 v29, v29, v23
  v_accvgpr_read_b32 v22, a220
  v_mfma_f32_16x16x32_bf16 v[100:103], a[164:167], a[20:23], v[100:103]
  buffer_load_dwordx4 v7, s[16:19], s56 offen offset:0 lds
  v_accvgpr_read_b32 v23, a221
  v_mfma_f32_16x16x32_bf16 v[100:103], a[160:163], a[4:7], v[100:103]
  ds_read_b64_tr_b16 a[146:147], v2 offset:46624
  v_max3_u32 v31, v31, v22, v23
  v_mfma_f32_16x16x32_bf16 v[104:107], a[160:163], a[8:11], v[104:107]
  ds_read_b64_tr_b16 a[148:149], v2 offset:50208
  v_add_f32 v26, v26, v22
  v_mfma_f32_16x16x32_bf16 v[104:107], a[164:167], a[24:27], v[104:107]
  v_add_f32 v27, v27, v23
  v_accvgpr_read_b32 v22, a222
  v_mfma_f32_16x16x32_bf16 v[108:111], a[164:167], a[28:31], v[108:111]
  ds_read_b64_tr_b16 a[150:151], v2 offset:53792
  v_accvgpr_read_b32 v23, a223
  v_mfma_f32_16x16x32_bf16 v[108:111], a[160:163], a[12:15], v[108:111]
  buffer_load_dwordx4 v8, s[16:19], s56 offen offset:1024 lds
  v_max3_u32 v31, v31, v22, v23
  v_mfma_f32_16x16x32_bf16 v[124:127], a[168:171], a[12:15], v[124:127]
  ds_read_b64_tr_b16 a[152:153], v2 offset:43072
  v_add_f32 v28, v28, v22
  v_mfma_f32_16x16x32_bf16 v[124:127], a[172:175], a[28:31], v[124:127]
  v_add_f32 v29, v29, v23
  v_mfma_f32_16x16x32_bf16 v[120:123], a[172:175], a[24:27], v[120:123]
  ds_read_b64_tr_b16 a[154:155], v2 offset:46656
  v_mfma_f32_16x16x32_bf16 v[120:123], a[168:171], a[8:11], v[120:123]
  v_cmp_eq_u32 vcc, -1, v31
  s_nop 4
  s_cbranch_vccnz CK7s
CK7x:
  v_mfma_f32_16x16x32_bf16 v[116:119], a[168:171], a[4:7], v[116:119]
  s_nop 0
  buffer_load_dwordx4 v9, s[16:19], s56 offen offset:2048 lds
  s_bfe_u32 s57, s83, 0x4001c
  v_mfma_f32_16x16x32_bf16 v[116:119], a[172:175], a[20:23], v[116:119]
  s_lshl_b32 s57, s57, 13
  s_add_u32 s57, s57, s85
  ds_read_b64_tr_b16 a[156:157], v2 offset:50240
  v_mfma_f32_16x16x32_bf16 v[112:115], a[172:175], a[16:19], v[112:115]
  ds_read_b64_tr_b16 a[158:159], v2 offset:53824
  v_permlane32_swap_b32 v26, v28
  v_mfma_f32_16x16x32_bf16 v[112:115], a[168:171], a[0:3], v[112:115]
  s_waitcnt lgkmcnt(8)
  v_permlane32_swap_b32 v27, v29
  v_add_f32 v26, v26, v28
  v_mfma_f32_16x16x32_bf16 v[128:131], a[128:131], a[0:3], v[128:131]
  ds_read_b64_tr_b16 a[160:161], v2 offset:43104
  v_add_f32 v27, v27, v29
  v_mfma_f32_16x16x32_bf16 v[128:131], a[132:135], a[16:19], v[128:131]
  buffer_load_dwordx4 a[96:99], v0, s[36:39], s57 offen offset:0 sc1
  v_cvt_pk_bf16_f32 v25, v26, v26
  v_mfma_f32_16x16x32_bf16 v[132:135], a[132:135], a[20:23], v[132:135]
  ds_read_b64_tr_b16 a[162:163], v2 offset:46688
  v_lshlrev_b32 v25, 16, v25
  v_mfma_f32_16x16x32_bf16 v[132:135], a[128:131], a[4:7], v[132:135]
  v_sub_f32 v30, v26, v25
  v_cvt_pk_bf16_f32 v22, v26, v30
  v_mfma_f32_16x16x32_bf16 v[136:139], a[128:131], a[8:11], v[136:139]
  ds_read_b64_tr_b16 a[164:165], v2 offset:50272
  v_and_b32 v25, 0xffff0000, v22
  v_mfma_f32_16x16x32_bf16 v[136:139], a[132:135], a[24:27], v[136:139]
  v_sub_f32 v30, v30, v25
  v_cvt_pk_bf16_f32 v23, v30, 0
  v_mfma_f32_16x16x32_bf16 v[140:143], a[132:135], a[28:31], v[140:143]
  buffer_load_dwordx4 a[100:103], v0, s[36:39], s57 offen offset:1024 sc1
  v_mfma_f32_16x16x32_bf16 v[140:143], a[128:131], a[12:15], v[140:143]
  ds_read_b64_tr_b16 a[166:167], v2 offset:53856
  v_mfma_f32_16x16x32_bf16 v[156:159], a[136:139], a[12:15], v[156:159]
  ds_read_b64_tr_b16 a[168:169], v2 offset:43136
  v_mfma_f32_16x16x32_bf16 v[156:159], a[140:143], a[28:31], v[156:159]
  ds_write_b64 v24, v[22:23] offset:0
  v_cvt_pk_bf16_f32 v25, v27, v27
  v_mfma_f32_16x16x32_bf16 v[152:155], a[140:143], a[24:27], v[152:155]
  ds_read_b64_tr_b16 a[170:171], v2 offset:46720
  v_lshlrev_b32 v25, 16, v25
  v_mfma_f32_16x16x32_bf16 v[152:155], a[136:139], a[8:11], v[152:155]
  buffer_load_dwordx4 a[104:107], v0, s[36:39], s57 offen offset:2048 sc1
  v_sub_f32 v30, v27, v25
  v_mfma_f32_16x16x32_bf16 v[148:151], a[136:139], a[4:7], v[148:151]
  ds_read_b64_tr_b16 a[172:173], v2 offset:50304
  v_cvt_pk_bf16_f32 v28, v27, v30
  v_mfma_f32_16x16x32_bf16 v[148:151], a[140:143], a[20:23], v[148:151]
  v_and_b32 v25, 0xffff0000, v28
  v_sub_f32 v30, v30, v25
  v_mfma_f32_16x16x32_bf16 v[144:147], a[140:143], a[16:19], v[144:147]
  ds_read_b64_tr_b16 a[174:175], v2 offset:53888
  v_cvt_pk_bf16_f32 v29, v30, 0
  v_mfma_f32_16x16x32_bf16 v[144:147], a[136:139], a[0:3], v[144:147]
  s_waitcnt lgkmcnt(9)
  ds_write_b64 v24, v[28:29] offset:16
  v_mfma_f32_16x16x32_bf16 v[160:163], a[144:147], a[0:3], v[160:163]
  buffer_load_dwordx4 a[108:111], v0, s[36:39], s57 offen offset:3072 sc1
  s_add_u32 s57, s57, 4096
  v_mfma_f32_16x16x32_bf16 v[160:163], a[148:151], a[16:19], v[160:163]
  ds_read_b64_tr_b16 a[128:129], v2 offset:43168
  v_mfma_f32_16x16x32_bf16 v[164:167], a[148:151], a[20:23], v[164:167]
  ds_read_b64_tr_b16 a[130:131], v2 offset:46752
  v_mfma_f32_16x16x32_bf16 v[164:167], a[144:147], a[4:7], v[164:167]
  v_mfma_f32_16x16x32_bf16 v[168:171], a[144:147], a[8:11], v[168:171]
  ds_read_b64_tr_b16 a[132:133], v2 offset:50336
  v_mfma_f32_16x16x32_bf16 v[168:171], a[148:151], a[24:27], v[168:171]
  buffer_load_dwordx4 a[112:115], v0, s[36:39], s57 offen offset:0 sc1
  v_mfma_f32_16x16x32_bf16 v[172:175], a[148:151], a[28:31], v[172:175]
  ds_read_b64_tr_b16 a[134:135], v2 offset:53920
  v_mfma_f32_16x16x32_bf16 v[172:175], a[144:147], a[12:15], v[172:175]
  v_mfma_f32_16x16x32_bf16 v[188:191], a[152:155], a[12:15], v[188:191]
  ds_read_b64_tr_b16 a[136:137], v2 offset:43200
  v_mfma_f32_16x16x32_bf16 v[188:191], a[156:159], a[28:31], v[188:191]
  v_mfma_f32_16x16x32_bf16 v[184:187], a[156:159], a[24:27], v[184:187]
  buffer_load_dwordx4 a[116:119], v0, s[36:39], s57 offen offset:1024 sc1
  v_mfma_f32_16x16x32_bf16 v[184:187], a[152:155], a[8:11], v[184:187]
  ds_read_b64_tr_b16 a[138:139], v2 offset:46784
  v_mfma_f32_16x16x32_bf16 v[180:183], a[152:155], a[4:7], v[180:183]
  ds_read_b64_tr_b16 a[140:141], v2 offset:50368
  v_mfma_f32_16x16x32_bf16 v[180:183], a[156:159], a[20:23], v[180:183]
  v_mfma_f32_16x16x32_bf16 v[176:179], a[156:159], a[16:19], v[176:179]
  ds_read_b64_tr_b16 a[142:143], v2 offset:53952
  v_mfma_f32_16x16x32_bf16 v[176:179], a[152:155], a[0:3], v[176:179]
  s_waitcnt lgkmcnt(9)
  buffer_load_dwordx4 a[120:123], v0, s[36:39], s57 offen offset:2048 sc1
  v_mfma_f32_16x16x32_bf16 v[192:195], a[160:163], a[0:3], v[192:195]
  ds_read_b64_tr_b16 a[144:145], v1 offset:192
  v_mfma_f32_16x16x32_bf16 v[192:195], a[164:167], a[16:19], v[192:195]
  v_mfma_f32_16x16x32_bf16 v[196:199], a[164:167], a[20:23], v[196:199]
  s_lshl_b32 s68, s44, 8
  ds_read_b64_tr_b16 a[146:147], v1 offset:3776
  s_add_u32 s68, s68, s2
  v_mfma_f32_16x16x32_bf16 v[196:199], a[160:163], a[4:7], v[196:199]
  s_mul_i32 s68, s68, 7168
  v_mfma_f32_16x16x32_bf16 v[200:203], a[160:163], a[8:11], v[200:203]
  buffer_load_dwordx4 a[124:127], v0, s[36:39], s57 offen offset:3072 sc1
  v_mfma_f32_16x16x32_bf16 v[200:203], a[164:167], a[24:27], v[200:203]
  ds_read_b64_tr_b16 a[148:149], v1 offset:7360
  v_mfma_f32_16x16x32_bf16 v[204:207], a[164:167], a[28:31], v[204:207]
  ds_read_b64_tr_b16 a[150:151], v1 offset:10944
  v_mfma_f32_16x16x32_bf16 v[204:207], a[160:163], a[12:15], v[204:207]
  s_waitcnt vmcnt(16)
  s_barrier
  v_mfma_f32_16x16x32_bf16 v[220:223], a[168:171], a[12:15], v[220:223]
Hc2_1:
  s_cbranch_execz Rc
  ds_read_b64_tr_b16 a[152:153], v1 offset:14528
  v_mfma_f32_16x16x32_bf16 v[220:223], a[172:175], a[28:31], v[220:223]
  v_mfma_f32_16x16x32_bf16 v[216:219], a[172:175], a[24:27], v[216:219]
  ds_read_b64_tr_b16 a[154:155], v1 offset:18112
  v_mfma_f32_16x16x32_bf16 v[216:219], a[168:171], a[8:11], v[216:219]
  v_mfma_f32_16x16x32_bf16 v[212:215], a[168:171], a[4:7], v[212:215]
  ds_read_b64_tr_b16 a[156:157], v1 offset:21696
  v_mfma_f32_16x16x32_bf16 v[212:215], a[172:175], a[20:23], v[212:215]
  v_mfma_f32_16x16x32_bf16 v[208:211], a[172:175], a[16:19], v[208:211]
  ds_read_b64_tr_b16 a[158:159], v1 offset:25280
  v_mfma_f32_16x16x32_bf16 v[208:211], a[168:171], a[0:3], v[208:211]
  s_waitcnt lgkmcnt(8)
  v_mfma_f32_16x16x32_bf16 v[224:227], a[128:131], a[0:3], v[224:227]
  ds_read_b64_tr_b16 a[160:161], v1 offset:28864
  v_mfma_f32_16x16x32_bf16 v[224:227], a[132:135], a[16:19], v[224:227]
  v_mfma_f32_16x16x32_bf16 v[228:231], a[132:135], a[20:23], v[228:231]
  ds_read_b64_tr_b16 a[162:163], v1 offset:32448
  v_mfma_f32_16x16x32_bf16 v[228:231], a[128:131], a[4:7], v[228:231]
  v_mfma_f32_16x16x32_bf16 v[232:235], a[128:131], a[8:11], v[232:235]
  ds_read_b64_tr_b16 a[164:165], v1 offset:36032
  v_mfma_f32_16x16x32_bf16 v[232:235], a[132:135], a[24:27], v[232:235]
  v_mfma_f32_16x16x32_bf16 v[236:239], a[132:135], a[28:31], v[236:239]
  ds_read_b64_tr_b16 a[166:167], v1 offset:39616
  v_mfma_f32_16x16x32_bf16 v[236:239], a[128:131], a[12:15], v[236:239]
  v_mfma_f32_16x16x32_bf16 v[252:255], a[136:139], a[12:15], v[252:255]
  ds_read_b64_tr_b16 a[168:169], v1 offset:43200
  v_mfma_f32_16x16x32_bf16 v[252:255], a[140:143], a[28:31], v[252:255]
  v_mfma_f32_16x16x32_bf16 v[248:251], a[140:143], a[24:27], v[248:251]
  ds_read_b64_tr_b16 a[170:171], v1 offset:46784
  v_mfma_f32_16x16x32_bf16 v[248:251], a[136:139], a[8:11], v[248:251]
  v_mfma_f32_16x16x32_bf16 v[244:247], a[136:139], a[4:7], v[244:247]
  ds_read_b64_tr_b16 a[172:173], v1 offset:50368
  v_mfma_f32_16x16x32_bf16 v[244:247], a[140:143], a[20:23], v[244:247]
  v_mfma_f32_16x16x32_bf16 v[240:243], a[140:143], a[16:19], v[240:243]
  ds_read_b64_tr_b16 a[174:175], v1 offset:53952
  v_mfma_f32_16x16x32_bf16 v[240:243], a[136:139], a[0:3], v[240:243]
  s_waitcnt vmcnt(33) lgkmcnt(8)
  v_mfma_f32_16x16x32_bf16 v[128:131], a[144:147], a[32:35], v[128:131]
  v_lshrrev_b32 v8, 1, v0
  v_and_b32 v31, 0xf0, v0
  v_mfma_f32_16x16x32_bf16 v[128:131], a[148:151], a[48:51], v[128:131]
  s_waitcnt vmcnt(8)
  s_barrier
  v_add_u32 v31, 159744, v31
  v_mfma_f32_16x16x32_bf16 v[132:135], a[148:151], a[52:55], v[132:135]
  v_cmp_gt_u32 vcc, 0x100, v0
  s_mov_b32 s76, 0x01000100
  v_mfma_f32_16x16x32_bf16 v[132:135], a[144:147], a[36:39], v[132:135]
  s_mov_b32 s77, 0x03020302
  v_min_u32 v3, 880, v0
  v_lshlrev_b32 v3, 3, v3
  v_mfma_f32_16x16x32_bf16 v[136:139], a[144:147], a[40:43], v[136:139]
  buffer_load_dword a252, v3, s[24:27], s68 offen
  v_cndmask_b32 v12, 0, v12, vcc
  v_mfma_f32_16x16x32_bf16 v[136:139], a[148:151], a[56:59], v[136:139]
  v_perm_b32 v22, v12, v12, s76
  v_and_b32 v23, 0xffff, v12
  v_mfma_f32_16x16x32_bf16 v[140:143], a[148:151], a[60:63], v[140:143]
  v_perm_b32 v24, v12, v12, s77
  v_lshrrev_b32 v25, 16, v12
  v_mfma_f32_16x16x32_bf16 v[140:143], a[144:147], a[44:47], v[140:143]
  v_accvgpr_write_b32 a0, v22
  v_accvgpr_write_b32 a1, v23
  v_mfma_f32_16x16x32_bf16 v[252:255], a[152:155], a[44:47], v[252:255]
  ds_read_b64_tr_b16 a[128:129], v2 offset:192
  v_accvgpr_write_b32 a2, v24
  v_mfma_f32_16x16x32_bf16 v[252:255], a[156:159], a[60:63], v[252:255]
  v_accvgpr_write_b32 a3, v25
  v_cndmask_b32 v15, 0, v15, vcc
  v_mfma_f32_16x16x32_bf16 v[248:251], a[156:159], a[56:59], v[248:251]
  ds_read_b64_tr_b16 a[130:131], v2 offset:3776
  v_perm_b32 v26, v15, v15, s76
  v_mfma_f32_16x16x32_bf16 v[248:251], a[152:155], a[40:43], v[248:251]
  v_and_b32 v27, 0xffff, v15
  v_perm_b32 v28, v15, v15, s77
  v_mfma_f32_16x16x32_bf16 v[244:247], a[152:155], a[36:39], v[244:247]
  ds_read_b64_tr_b16 a[132:133], v2 offset:7360
  v_lshrrev_b32 v29, 16, v15
  v_mfma_f32_16x16x32_bf16 v[244:247], a[156:159], a[52:55], v[244:247]
  ds_read_b128 a[16:19], v31 offset:1536
  v_accvgpr_write_b32 a4, v26
  v_mfma_f32_16x16x32_bf16 v[240:243], a[156:159], a[48:51], v[240:243]
  ds_read_b128 a[20:23], v31 offset:3584
  v_accvgpr_write_b32 a5, v27
  v_mfma_f32_16x16x32_bf16 v[240:243], a[152:155], a[32:35], v[240:243]
  s_waitcnt vmcnt(16) lgkmcnt(5)
  ds_read_b64_tr_b16 a[134:135], v2 offset:10944
  v_accvgpr_write_b32 a6, v28
  v_mfma_f32_16x16x32_bf16 v[128:131], a[160:163], a[64:67], v[128:131]
  ds_read_b64_tr_b16 a[136:137], v2 offset:14528
  v_accvgpr_write_b32 a7, v29
  v_mfma_f32_16x16x32_bf16 v[128:131], a[164:167], a[80:83], v[128:131]
  v_cndmask_b32 v18, 0, v18, vcc
  v_perm_b32 v22, v18, v18, s76
  v_mfma_f32_16x16x32_bf16 v[132:135], a[164:167], a[84:87], v[132:135]
  ds_read_b64_tr_b16 a[138:139], v2 offset:18112
  v_and_b32 v23, 0xffff, v18
  v_mfma_f32_16x16x32_bf16 v[132:135], a[160:163], a[68:71], v[132:135]
  v_perm_b32 v24, v18, v18, s77
  v_lshrrev_b32 v25, 16, v18
  v_mfma_f32_16x16x32_bf16 v[136:139], a[160:163], a[72:75], v[136:139]
  ds_read_b64_tr_b16 a[140:141], v2 offset:21696
  v_accvgpr_write_b32 a8, v22
  v_mfma_f32_16x16x32_bf16 v[136:139], a[164:167], a[88:91], v[136:139]
  v_accvgpr_write_b32 a9, v23
  v_accvgpr_write_b32 a10, v24
  v_mfma_f32_16x16x32_bf16 v[140:143], a[164:167], a[92:95], v[140:143]
  ds_read_b64_tr_b16 a[142:143], v2 offset:25280
  v_accvgpr_write_b32 a11, v25
  v_mfma_f32_16x16x32_bf16 v[140:143], a[160:163], a[76:79], v[140:143]
  v_cndmask_b32 v21, 0, v21, vcc
  v_perm_b32 v26, v21, v21, s76
  v_mfma_f32_16x16x32_bf16 v[252:255], a[168:171], a[76:79], v[252:255]
  ds_read_b64_tr_b16 a[144:145], v1 offset:0
  v_and_b32 v27, 0xffff, v21
  v_mfma_f32_16x16x32_bf16 v[252:255], a[172:175], a[92:95], v[252:255]
  v_perm_b32 v28, v21, v21, s77
  v_lshrrev_b32 v29, 16, v21
  v_mfma_f32_16x16x32_bf16 v[248:251], a[172:175], a[88:91], v[248:251]
  ds_read_b64_tr_b16 a[146:147], v1 offset:3584
  v_accvgpr_write_b32 a12, v26
  v_mfma_f32_16x16x32_bf16 v[248:251], a[168:171], a[72:75], v[248:251]
  v_accvgpr_write_b32 a13, v27
  v_accvgpr_write_b32 a14, v28
  v_mfma_f32_16x16x32_bf16 v[244:247], a[168:171], a[68:71], v[244:247]
  v_accvgpr_write_b32 a15, v29
  v_mfma_f32_16x16x32_bf16 v[244:247], a[172:175], a[84:87], v[244:247]
  ds_read_b64_tr_b16 a[148:149], v1 offset:7168
  v_mfma_f32_16x16x32_bf16 v[240:243], a[172:175], a[80:83], v[240:243]
  ds_read_b64_tr_b16 a[150:151], v1 offset:10752
  v_mov_b32 v9, s3
  v_mfma_f32_16x16x32_bf16 v[240:243], a[168:171], a[64:67], v[240:243]
  s_waitcnt lgkmcnt(9)
  v_mfma_f32_16x16x32_bf16 v[128:131], a[16:19], a[0:3], v[128:131]
  v_mfma_f32_16x16x32_bf16 v[132:135], a[16:19], a[4:7], v[132:135]
  v_mfma_f32_16x16x32_bf16 v[136:139], a[16:19], a[8:11], v[136:139]
  v_mfma_f32_16x16x32_bf16 v[140:143], a[16:19], a[12:15], v[140:143]
  v_mfma_f32_16x16x32_bf16 v[240:243], a[20:23], a[0:3], v[240:243]
  v_mfma_f32_16x16x32_bf16 v[244:247], a[20:23], a[4:7], v[244:247]
  v_mfma_f32_16x16x32_bf16 v[248:251], a[20:23], a[8:11], v[248:251]
  v_mfma_f32_16x16x32_bf16 v[252:255], a[20:23], a[12:15], v[252:255]
  s_waitcnt vmcnt(1) lgkmcnt(4)
  v_mfma_f32_16x16x32_bf16 v[128:131], a[128:131], a[96:99], v[128:131]
  ds_read_b128 a[24:27], v31 offset:0
  v_mfma_f32_16x16x32_bf16 v[128:131], a[132:135], a[112:115], v[128:131]
  ds_read_b64_tr_b16 a[152:153], v1 offset:14336
  v_mfma_f32_16x16x32_bf16 v[132:135], a[132:135], a[116:119], v[132:135]
  ds_read_b128 a[28:31], v31 offset:2048
  v_mfma_f32_16x16x32_bf16 v[132:135], a[128:131], a[100:103], v[132:135]
  ds_read_b64_tr_b16 a[154:155], v1 offset:17920
  v_mfma_f32_16x16x32_bf16 v[136:139], a[128:131], a[104:107], v[136:139]
  ds_read_b64_tr_b16 a[156:157], v1 offset:21504
  v_mfma_f32_16x16x32_bf16 v[136:139], a[132:135], a[120:123], v[136:139]
  v_mfma_f32_16x16x32_bf16 v[140:143], a[132:135], a[124:127], v[140:143]
  ds_read_b64_tr_b16 a[158:159], v1 offset:25088
  v_mfma_f32_16x16x32_bf16 v[140:143], a[128:131], a[108:111], v[140:143]
  v_mfma_f32_16x16x32_bf16 v[252:255], a[136:139], a[108:111], v[252:255]
  ds_read_b64_tr_b16 a[160:161], v1 offset:28672
  v_mul_f32 v22, v10, v128
  v_mul_f32 v23, v10, v129
  v_mul_f32 v24, v10, v130
  v_mfma_f32_16x16x32_bf16 v[252:255], a[140:143], a[124:127], v[252:255]
  v_mul_f32 v25, v10, v131
  v_exp_f32 v22, v22
  v_mul_f32 v26, v13, v132
  v_mfma_f32_16x16x32_bf16 v[248:251], a[140:143], a[120:123], v[248:251]
  ds_read_b64_tr_b16 a[162:163], v1 offset:32256
  v_exp_f32 v23, v23
  v_mul_f32 v27, v13, v133
  v_mfma_f32_16x16x32_bf16 v[248:251], a[136:139], a[104:107], v[248:251]
  v_exp_f32 v24, v24
  v_mul_f32 v28, v13, v134
  v_mfma_f32_16x16x32_bf16 v[244:247], a[136:139], a[100:103], v[244:247]
  ds_read_b64_tr_b16 a[164:165], v1 offset:35840
  v_exp_f32 v25, v25
  v_mul_f32 v29, v13, v135
  v_mfma_f32_16x16x32_bf16 v[244:247], a[140:143], a[116:119], v[244:247]
  v_exp_f32 v26, v26
  v_fma_f32 v22, v22, v11, v11
  v_mfma_f32_16x16x32_bf16 v[240:243], a[140:143], a[112:115], v[240:243]
  ds_read_b64_tr_b16 a[166:167], v1 offset:39424
  v_exp_f32 v27, v27
  v_fma_f32 v23, v23, v11, v11
  v_mfma_f32_16x16x32_bf16 v[240:243], a[136:139], a[96:99], v[240:243]
  s_waitcnt lgkmcnt(4)
  v_exp_f32 v28, v28
  v_fma_f32 v24, v24, v11, v11
  v_mfma_f32_16x16x32_bf16 v[32:35], a[144:147], a[32:35], v[32:35]
  ds_read_b64_tr_b16 a[168:169], v1 offset:43008
  v_exp_f32 v29, v29
  v_fma_f32 v25, v25, v11, v11
  v_mfma_f32_16x16x32_bf16 v[32:35], a[148:151], a[48:51], v[32:35]
  v_rcp_f32 v22, v22
  v_fma_f32 v26, v26, v14, v14
  v_mfma_f32_16x16x32_bf16 v[36:39], a[148:151], a[52:55], v[36:39]
  ds_read_b64_tr_b16 a[170:171], v1 offset:46592
  v_rcp_f32 v23, v23
  v_fma_f32 v27, v27, v14, v14
  v_mfma_f32_16x16x32_bf16 v[36:39], a[144:147], a[36:39], v[36:39]
  v_rcp_f32 v24, v24
  v_fma_f32 v28, v28, v14, v14
  v_mfma_f32_16x16x32_bf16 v[40:43], a[144:147], a[40:43], v[40:43]
  ds_read_b64_tr_b16 a[172:173], v1 offset:50176
  v_rcp_f32 v25, v25
  v_fma_f32 v29, v29, v14, v14
  v_mfma_f32_16x16x32_bf16 v[40:43], a[148:151], a[56:59], v[40:43]
  v_rcp_f32 v26, v26
  v_mul_f32 v240, v128, v240
  v_mfma_f32_16x16x32_bf16 v[44:47], a[148:151], a[60:63], v[44:47]
  ds_read_b64_tr_b16 a[174:175], v1 offset:53760
  v_rcp_f32 v27, v27
  v_mul_f32 v241, v129, v241
  v_mfma_f32_16x16x32_bf16 v[44:47], a[144:147], a[44:47], v[44:47]
  s_waitcnt lgkmcnt(11)
  v_rcp_f32 v28, v28
  v_mul_f32 v242, v130, v242
  v_mfma_f32_16x16x32_bf16 v[32:35], a[24:27], a[0:3], v[32:35]
  ds_read_b64_tr_b16 a[128:129], v2 offset:0
  v_rcp_f32 v29, v29
  v_mul_f32 v243, v131, v243
  v_mfma_f32_16x16x32_bf16 v[36:39], a[24:27], a[4:7], v[36:39]
  v_mul_f32 v240, v240, v22
  v_mul_f32 v241, v241, v23
  v_mul_f32 v242, v242, v24
  v_mul_f32 v243, v243, v25
  v_mfma_f32_16x16x32_bf16 v[40:43], a[24:27], a[8:11], v[40:43]
  ds_read_b64_tr_b16 a[130:131], v2 offset:3584
  v_mul_f32 v22, v16, v136
  v_mul_f32 v23, v16, v137
  v_mul_f32 v24, v16, v138
  v_mfma_f32_16x16x32_bf16 v[44:47], a[24:27], a[12:15], v[44:47]
  v_mul_f32 v25, v16, v139
  v_exp_f32 v22, v22
  v_mul_f32 v244, v132, v244
  v_mfma_f32_16x16x32_bf16 v[144:147], a[28:31], a[0:3], v[144:147]
  ds_read_b64_tr_b16 a[132:133], v2 offset:7168
  v_exp_f32 v23, v23
  v_mul_f32 v245, v133, v245
  v_mfma_f32_16x16x32_bf16 v[148:151], a[28:31], a[4:7], v[148:151]
  v_exp_f32 v24, v24
  v_mul_f32 v246, v134, v246
  v_mfma_f32_16x16x32_bf16 v[152:155], a[28:31], a[8:11], v[152:155]
  ds_read_b64_tr_b16 a[134:135], v2 offset:10752
  v_exp_f32 v25, v25
  v_mul_f32 v247, v135, v247
  v_mfma_f32_16x16x32_bf16 v[156:159], a[28:31], a[12:15], v[156:159]
  v_mul_f32 v244, v244, v26
  v_mul_f32 v245, v245, v27
  v_mul_f32 v246, v246, v28
  v_mul_f32 v247, v247, v29
  v_mfma_f32_16x16x32_bf16 v[156:159], a[152:155], a[44:47], v[156:159]
  ds_read_b64_tr_b16 a[136:137], v2 offset:14336
  v_cvt_pk_bf16_f32 v128, v240, v241
  v_cvt_pk_bf16_f32 v129, v242, v243
  v_mfma_f32_16x16x32_bf16 v[156:159], a[156:159], a[60:63], v[156:159]
  buffer_store_dwordx2 v[128:129], v8, s[36:39], s65 offen offset:0 sc1
  v_mul_f32 v26, v19, v140
  v_mul_f32 v27, v19, v141
  v_mul_f32 v28, v19, v142
  v_mfma_f32_16x16x32_bf16 v[152:155], a[156:159], a[56:59], v[152:155]
  ds_read_b64_tr_b16 a[138:139], v2 offset:17920
  v_mul_f32 v29, v19, v143
  v_exp_f32 v26, v26
  v_mfma_f32_16x16x32_bf16 v[152:155], a[152:155], a[40:43], v[152:155]
  v_fma_f32 v22, v22, v17, v17
  v_exp_f32 v27, v27
  v_fma_f32 v23, v23, v17, v17
  v_mfma_f32_16x16x32_bf16 v[148:151], a[152:155], a[36:39], v[148:151]
  ds_read_b64_tr_b16 a[140:141], v2 offset:21504
  v_exp_f32 v28, v28
  v_fma_f32 v24, v24, v17, v17
  v_mfma_f32_16x16x32_bf16 v[148:151], a[156:159], a[52:55], v[148:151]
  v_exp_f32 v29, v29
  v_fma_f32 v25, v25, v17, v17
  v_cvt_pk_bf16_f32 v132, v244, v245
  v_mfma_f32_16x16x32_bf16 v[144:147], a[156:159], a[48:51], v[144:147]
  ds_read_b64_tr_b16 a[142:143], v2 offset:25088
  v_cvt_pk_bf16_f32 v133, v246, v247
  v_mfma_f32_16x16x32_bf16 v[144:147], a[152:155], a[32:35], v[144:147]
  s_waitcnt lgkmcnt(8)
  buffer_store_dwordx2 v[132:133], v8, s[36:39], s65 offen offset:1024 sc1
  v_rcp_f32 v22, v22
  v_fma_f32 v26, v26, v20, v20
  v_mfma_f32_16x16x32_bf16 v[32:35], a[160:163], a[64:67], v[32:35]
  ds_read_b64_tr_b16 a[144:145], v1 offset:32
  v_rcp_f32 v23, v23
  v_fma_f32 v27, v27, v20, v20
  v_mfma_f32_16x16x32_bf16 v[32:35], a[164:167], a[80:83], v[32:35]
  v_rcp_f32 v24, v24
  v_fma_f32 v28, v28, v20, v20
  v_mfma_f32_16x16x32_bf16 v[36:39], a[164:167], a[84:87], v[36:39]
  ds_read_b64_tr_b16 a[146:147], v1 offset:3616
  v_rcp_f32 v25, v25
  v_fma_f32 v29, v29, v20, v20
  v_mfma_f32_16x16x32_bf16 v[36:39], a[160:163], a[68:71], v[36:39]
  v_rcp_f32 v26, v26
  v_mul_f32 v248, v136, v248
  v_mfma_f32_16x16x32_bf16 v[40:43], a[160:163], a[72:75], v[40:43]
  ds_read_b64_tr_b16 a[148:149], v1 offset:7200
  v_rcp_f32 v27, v27
  v_mul_f32 v249, v137, v249
  v_mfma_f32_16x16x32_bf16 v[40:43], a[164:167], a[88:91], v[40:43]
  v_rcp_f32 v28, v28
  v_mul_f32 v250, v138, v250
  v_mfma_f32_16x16x32_bf16 v[44:47], a[164:167], a[92:95], v[44:47]
  ds_read_b64_tr_b16 a[150:151], v1 offset:10784
  v_rcp_f32 v29, v29
  v_mul_f32 v251, v139, v251
  v_mfma_f32_16x16x32_bf16 v[44:47], a[160:163], a[76:79], v[44:47]
  v_mul_f32 v248, v248, v22
  v_mul_f32 v249, v249, v23
  v_mul_f32 v250, v250, v24
  v_mul_f32 v251, v251, v25
  v_mfma_f32_16x16x32_bf16 v[156:159], a[168:171], a[76:79], v[156:159]
  v_mul_f32 v252, v140, v252
  v_mul_f32 v253, v141, v253
  v_mul_f32 v254, v142, v254
  v_mul_f32 v255, v143, v255
  v_mfma_f32_16x16x32_bf16 v[156:159], a[172:175], a[92:95], v[156:159]
  v_cvt_pk_bf16_f32 v136, v248, v249
  v_cvt_pk_bf16_f32 v137, v250, v251
  v_mfma_f32_16x16x32_bf16 v[152:155], a[172:175], a[88:91], v[152:155]
  buffer_store_dwordx2 v[136:137], v8, s[36:39], s66 offen offset:0 sc1
  v_mul_f32 v252, v252, v26
  v_mul_f32 v253, v253, v27
  v_mul_f32 v254, v254, v28
  v_mfma_f32_16x16x32_bf16 v[152:155], a[168:171], a[72:75], v[152:155]
  v_mul_f32 v255, v255, v29
  v_cvt_pk_bf16_f32 v140, v252, v253
  v_cvt_pk_bf16_f32 v141, v254, v255
  v_mfma_f32_16x16x32_bf16 v[148:151], a[168:171], a[68:71], v[148:151]
  buffer_store_dwordx2 v[140:141], v8, s[36:39], s66 offen offset:1024 sc1
  s_mov_b32 s65, s67
  s_add_u32 s66, s67, 262144
  v_mfma_f32_16x16x32_bf16 v[148:151], a[172:175], a[84:87], v[148:151]
  v_lshrrev_b32 v128, 4, v0
  s_lshr_b32 s90, s54, 2
  s_mul_i32 s90, s90, 2
  s_add_u32 s87, s52, s54
  v_mfma_f32_16x16x32_bf16 v[144:147], a[172:175], a[80:83], v[144:147]
  s_add_u32 s87, s87, s90
  s_and_b32 s87, s87, 3
  s_and_b32 s90, s2, 1
  s_lshl_b32 s89, s53, 7
  s_lshl3_add_u32 s89, s70, s89
  v_mfma_f32_16x16x32_bf16 v[144:147], a[168:171], a[64:67], v[144:147]
  s_waitcnt lgkmcnt(4)
  s_mul_i32 s88, s90, 3670016
  s_add_u32 s89, s89, s88
  s_lshr_b32 s88, s44, 1
  s_mul_i32 s88, s88, 196608
  v_mfma_f32_16x16x32_bf16 v[32:35], a[128:131], a[96:99], v[32:35]
  ds_read_b128 a[16:19], v31 offset:256
  v_bfe_u32 v129, v128, 4, 2
  v_bfe_u32 v130, v128, 1, 2
  v_xor_b32 v129, v129, v130
  v_mfma_f32_16x16x32_bf16 v[32:35], a[132:135], a[112:115], v[32:35]
  ds_read_b64_tr_b16 a[152:153], v1 offset:14368
  v_lshlrev_b32 v129, 5, v129
  v_and_b32 v130, 1, v128
  v_lshl_add_u32 v129, v130, 4, v129
  v_mfma_f32_16x16x32_bf16 v[36:39], a[132:135], a[116:119], v[36:39]
  ds_read_b128 a[20:23], v31 offset:2304
  v_lshrrev_b32 v130, 3, v128
  v_lshlrev_b32 v130, 11, v130
  s_sub_u32 s24, s24, 2048
  v_mfma_f32_16x16x32_bf16 v[36:39], a[128:131], a[100:103], v[36:39]
  s_subb_u32 s25, s25, 0
  s_mov_b32 s26, 7342080
  ds_read_b64_tr_b16 a[154:155], v1 offset:17952
  v_add3_u32 v129, v129, v130, s89
  v_add_u32 v133, 2048, v129
  v_mfma_f32_16x16x32_bf16 v[40:43], a[128:131], a[104:107], v[40:43]
  ds_read_b64_tr_b16 a[156:157], v1 offset:21536
  v_add_u32 v134, 17408, v129
  v_xor_b32 v135, 128, v129
  v_add_u32 v136, 15360, v135
  v_mfma_f32_16x16x32_bf16 v[40:43], a[132:135], a[120:123], v[40:43]
  v_and_b32 v129, 7, v128
  v_lshrrev_b32 v131, 4, v128
  v_xor_b32 v129, v129, v131
  v_lshl_add_u32 v252, v129, 4, v130
  v_mfma_f32_16x16x32_bf16 v[44:47], a[132:135], a[124:127], v[44:47]
  ds_read_b64_tr_b16 a[158:159], v1 offset:25120
  v_xor_b32 v253, 64, v252
  v_add_u32 v253, 16384, v253
  s_lshl2_add_u32 s89, s52, s44
  v_mfma_f32_16x16x32_bf16 v[44:47], a[128:131], a[108:111], v[44:47]
  s_lshl_b32 s89, s89, 18
  s_mul_i32 s91, s90, 114688
  s_add_u32 s89, s89, s91
  s_add_u32 s89, s89, 19922944
  v_add_u32 v137, s89, v0
  v_mfma_f32_16x16x32_bf16 v[156:159], a[136:139], a[108:111], v[156:159]
  ds_read_b64_tr_b16 a[160:161], v1 offset:28704
  v_add_u32 v7, s89, v8
  v_bfe_u32 v129, v128, 3, 2
  v_lshlrev_b32 v129, 5, v129
  v_mfma_f32_16x16x32_bf16 v[156:159], a[140:143], a[124:127], v[156:159]
  v_and_b32 v130, 3, v128
  v_lshl_add_u32 v129, v130, 3, v129
  v_lshrrev_b32 v130, 2, v128
  v_lshl_add_u32 v240, v130, 7, v129
  v_mfma_f32_16x16x32_bf16 v[152:155], a[140:143], a[120:123], v[152:155]
  ds_read_b64_tr_b16 a[162:163], v1 offset:32288
  v_xor_b32 v241, 32, v240
  v_xor_b32 v242, 64, v240
  v_xor_b32 v243, 96, v240
  v_mfma_f32_16x16x32_bf16 v[152:155], a[136:139], a[104:107], v[152:155]
  v_xor_b32 v244, 65536, v240
  v_xor_b32 v245, 65568, v240
  v_xor_b32 v246, 65600, v240
  v_xor_b32 v247, 65632, v240
  v_mfma_f32_16x16x32_bf16 v[148:151], a[136:139], a[100:103], v[148:151]
  ds_read_b64_tr_b16 a[164:165], v1 offset:35872
  v_xor_b32 v248, 131072, v240
  v_xor_b32 v249, 131104, v240
  v_xor_b32 v250, 131136, v240
  v_mfma_f32_16x16x32_bf16 v[148:151], a[140:143], a[116:119], v[148:151]
  v_xor_b32 v251, 131168, v240
  s_lshr_b32 s89, s52, 1
  s_lshl_b32 s89, s89, 5
  s_lshl2_add_u32 s89, s90, s89
  v_mfma_f32_16x16x32_bf16 v[144:147], a[140:143], a[112:115], v[144:147]
  ds_read_b64_tr_b16 a[166:167], v1 offset:39456
  v_and_b32 v129, 3, v128
  v_bfe_u32 v130, v128, 2, 2
  v_lshl_add_u32 v129, v129, 3, v130
  v_mfma_f32_16x16x32_bf16 v[144:147], a[136:139], a[96:99], v[144:147]
  s_waitcnt lgkmcnt(4)
  v_add_lshl_u32 v138, v129, s89, 7
  s_mov_b32 s91, 5373952
  v_mul_f32 v22, v10, v32
  v_mul_f32 v23, v10, v33
  v_mfma_f32_16x16x32_bf16 v[48:51], a[144:147], a[32:35], v[48:51]
  ds_read_b64_tr_b16 a[168:169], v1 offset:43040
  v_mul_f32 v24, v10, v34
  v_mul_f32 v25, v10, v35
  v_mfma_f32_16x16x32_bf16 v[48:51], a[148:151], a[48:51], v[48:51]
  v_exp_f32 v22, v22
  v_mul_f32 v26, v13, v36
  v_mfma_f32_16x16x32_bf16 v[52:55], a[148:151], a[52:55], v[52:55]
  ds_read_b64_tr_b16 a[170:171], v1 offset:46624
  v_exp_f32 v23, v23
  v_mul_f32 v27, v13, v37
  v_mfma_f32_16x16x32_bf16 v[52:55], a[144:147], a[36:39], v[52:55]
  v_exp_f32 v24, v24
  v_mul_f32 v28, v13, v38
  v_mfma_f32_16x16x32_bf16 v[56:59], a[144:147], a[40:43], v[56:59]
  ds_read_b64_tr_b16 a[172:173], v1 offset:50208
  v_exp_f32 v25, v25
  v_mul_f32 v29, v13, v39
  v_mfma_f32_16x16x32_bf16 v[56:59], a[148:151], a[56:59], v[56:59]
  v_exp_f32 v26, v26
  v_fma_f32 v22, v22, v11, v11
  v_mfma_f32_16x16x32_bf16 v[60:63], a[148:151], a[60:63], v[60:63]
  ds_read_b64_tr_b16 a[174:175], v1 offset:53792
  v_exp_f32 v27, v27
  v_fma_f32 v23, v23, v11, v11
  v_mfma_f32_16x16x32_bf16 v[60:63], a[144:147], a[44:47], v[60:63]
  s_waitcnt lgkmcnt(11)
  v_exp_f32 v28, v28
  v_fma_f32 v24, v24, v11, v11
  v_mfma_f32_16x16x32_bf16 v[48:51], a[16:19], a[0:3], v[48:51]
  ds_read_b64_tr_b16 a[128:129], v2 offset:32
  v_exp_f32 v29, v29
  v_fma_f32 v25, v25, v11, v11
  v_mfma_f32_16x16x32_bf16 v[52:55], a[16:19], a[4:7], v[52:55]
  v_rcp_f32 v22, v22
  v_fma_f32 v26, v26, v14, v14
  v_mfma_f32_16x16x32_bf16 v[56:59], a[16:19], a[8:11], v[56:59]
  ds_read_b64_tr_b16 a[130:131], v2 offset:3616
  v_rcp_f32 v23, v23
  v_fma_f32 v27, v27, v14, v14
  v_mfma_f32_16x16x32_bf16 v[60:63], a[16:19], a[12:15], v[60:63]
  v_rcp_f32 v24, v24
  v_fma_f32 v28, v28, v14, v14
  v_mfma_f32_16x16x32_bf16 v[160:163], a[20:23], a[0:3], v[160:163]
  ds_read_b64_tr_b16 a[132:133], v2 offset:7200
  v_rcp_f32 v25, v25
  v_fma_f32 v29, v29, v14, v14
  v_mfma_f32_16x16x32_bf16 v[164:167], a[20:23], a[4:7], v[164:167]
  v_rcp_f32 v26, v26
  v_mul_f32 v144, v32, v144
  v_mfma_f32_16x16x32_bf16 v[168:171], a[20:23], a[8:11], v[168:171]
  ds_read_b64_tr_b16 a[134:135], v2 offset:10784
  v_rcp_f32 v27, v27
  v_mul_f32 v145, v33, v145
  v_mfma_f32_16x16x32_bf16 v[172:175], a[20:23], a[12:15], v[172:175]
  v_rcp_f32 v28, v28
  v_mul_f32 v146, v34, v146
  v_mfma_f32_16x16x32_bf16 v[172:175], a[152:155], a[44:47], v[172:175]
  ds_read_b64_tr_b16 a[136:137], v2 offset:14368
  v_rcp_f32 v29, v29
  v_mul_f32 v147, v35, v147
  v_mul_f32 v144, v144, v22
  v_mfma_f32_16x16x32_bf16 v[172:175], a[156:159], a[60:63], v[172:175]
  v_mul_f32 v145, v145, v23
  v_mul_f32 v146, v146, v24
  v_mul_f32 v147, v147, v25
  v_mul_f32 v22, v16, v40
  v_mfma_f32_16x16x32_bf16 v[168:171], a[156:159], a[56:59], v[168:171]
  ds_read_b64_tr_b16 a[138:139], v2 offset:17952
  v_mul_f32 v23, v16, v41
  v_mul_f32 v24, v16, v42
  v_mul_f32 v25, v16, v43
  v_mfma_f32_16x16x32_bf16 v[168:171], a[152:155], a[40:43], v[168:171]
  v_exp_f32 v22, v22
  v_mul_f32 v148, v36, v148
  v_mfma_f32_16x16x32_bf16 v[164:167], a[152:155], a[36:39], v[164:167]
  ds_read_b64_tr_b16 a[140:141], v2 offset:21536
  v_exp_f32 v23, v23
  v_mul_f32 v149, v37, v149
  v_mfma_f32_16x16x32_bf16 v[164:167], a[156:159], a[52:55], v[164:167]
  v_exp_f32 v24, v24
  v_mul_f32 v150, v38, v150
  v_mfma_f32_16x16x32_bf16 v[160:163], a[156:159], a[48:51], v[160:163]
  ds_read_b64_tr_b16 a[142:143], v2 offset:25120
  v_exp_f32 v25, v25
  v_mul_f32 v151, v39, v151
  v_mfma_f32_16x16x32_bf16 v[160:163], a[152:155], a[32:35], v[160:163]
  s_waitcnt lgkmcnt(8)
  v_mul_f32 v148, v148, v26
  v_mul_f32 v149, v149, v27
  v_mul_f32 v150, v150, v28
  v_mul_f32 v151, v151, v29
  v_mfma_f32_16x16x32_bf16 v[48:51], a[160:163], a[64:67], v[48:51]
  ds_read_b64_tr_b16 a[144:145], v1 offset:64
  v_cvt_pk_bf16_f32 v32, v144, v145
  v_cvt_pk_bf16_f32 v33, v146, v147
  v_mul_f32 v26, v19, v44
  v_mfma_f32_16x16x32_bf16 v[48:51], a[164:167], a[80:83], v[48:51]
  v_mul_f32 v27, v19, v45
  v_mul_f32 v28, v19, v46
  v_mul_f32 v29, v19, v47
  v_mfma_f32_16x16x32_bf16 v[52:55], a[164:167], a[84:87], v[52:55]
  ds_read_b64_tr_b16 a[146:147], v1 offset:3648
  v_exp_f32 v26, v26
  v_fma_f32 v22, v22, v17, v17
  v_mfma_f32_16x16x32_bf16 v[52:55], a[160:163], a[68:71], v[52:55]
  v_exp_f32 v27, v27
  v_fma_f32 v23, v23, v17, v17
  v_mfma_f32_16x16x32_bf16 v[56:59], a[160:163], a[72:75], v[56:59]
  ds_read_b64_tr_b16 a[148:149], v1 offset:7232
  v_exp_f32 v28, v28
  v_fma_f32 v24, v24, v17, v17
  v_mfma_f32_16x16x32_bf16 v[56:59], a[164:167], a[88:91], v[56:59]
  v_exp_f32 v29, v29
  v_fma_f32 v25, v25, v17, v17
  v_cvt_pk_bf16_f32 v36, v148, v149
  v_mfma_f32_16x16x32_bf16 v[60:63], a[164:167], a[92:95], v[60:63]
  ds_read_b64_tr_b16 a[150:151], v1 offset:10816
  v_cvt_pk_bf16_f32 v37, v150, v151
  v_rcp_f32 v22, v22
  v_mfma_f32_16x16x32_bf16 v[60:63], a[160:163], a[76:79], v[60:63]
  v_fma_f32 v26, v26, v20, v20
  v_rcp_f32 v23, v23
  v_fma_f32 v27, v27, v20, v20
  v_mfma_f32_16x16x32_bf16 v[172:175], a[168:171], a[76:79], v[172:175]
  v_rcp_f32 v24, v24
  v_fma_f32 v28, v28, v20, v20
  v_mfma_f32_16x16x32_bf16 v[172:175], a[172:175], a[92:95], v[172:175]
  v_rcp_f32 v25, v25
  v_fma_f32 v29, v29, v20, v20
  v_mfma_f32_16x16x32_bf16 v[168:171], a[172:175], a[88:91], v[168:171]
  v_rcp_f32 v26, v26
  v_mul_f32 v152, v40, v152
  v_mfma_f32_16x16x32_bf16 v[168:171], a[168:171], a[72:75], v[168:171]
  v_rcp_f32 v27, v27
  v_mul_f32 v153, v41, v153
  v_mfma_f32_16x16x32_bf16 v[164:167], a[168:171], a[68:71], v[164:167]
  v_rcp_f32 v28, v28
  v_mul_f32 v154, v42, v154
  v_mfma_f32_16x16x32_bf16 v[164:167], a[172:175], a[84:87], v[164:167]
  v_rcp_f32 v29, v29
  v_mul_f32 v155, v43, v155
  v_mul_f32 v152, v152, v22
  v_mfma_f32_16x16x32_bf16 v[160:163], a[172:175], a[80:83], v[160:163]
  v_mul_f32 v153, v153, v23
  v_mul_f32 v154, v154, v24
  v_mul_f32 v155, v155, v25
  v_mul_f32 v156, v44, v156
  v_mfma_f32_16x16x32_bf16 v[160:163], a[168:171], a[64:67], v[160:163]
  s_waitcnt lgkmcnt(4)
  v_mul_f32 v157, v45, v157
  v_mul_f32 v158, v46, v158
  v_mul_f32 v159, v47, v159
  v_cvt_pk_bf16_f32 v40, v152, v153
  v_mfma_f32_16x16x32_bf16 v[48:51], a[128:131], a[96:99], v[48:51]
  ds_read_b128 a[24:27], v31 offset:512
  v_cvt_pk_bf16_f32 v41, v154, v155
  v_mul_f32 v156, v156, v26
  v_mul_f32 v157, v157, v27
  v_mfma_f32_16x16x32_bf16 v[48:51], a[132:135], a[112:115], v[48:51]
  ds_read_b64_tr_b16 a[152:153], v1 offset:14400
  v_mul_f32 v158, v158, v28
  v_mul_f32 v159, v159, v29
  v_cvt_pk_bf16_f32 v44, v156, v157
  v_mfma_f32_16x16x32_bf16 v[52:55], a[132:135], a[116:119], v[52:55]
  ds_read_b128 a[28:31], v31 offset:2560
  v_cvt_pk_bf16_f32 v45, v158, v159
  v_mfma_f32_16x16x32_bf16 v[52:55], a[128:131], a[100:103], v[52:55]
  s_waitcnt vmcnt(0)
  s_barrier
  ds_read_b64_tr_b16 a[154:155], v1 offset:17984
  v_mfma_f32_16x16x32_bf16 v[56:59], a[128:131], a[104:107], v[56:59]
  s_mov_b64 exec, 1
  buffer_store_dword v9, v0, s[36:39], s45 offen sc1
  s_mov_b64 exec, -1
  s_add_u32 s45, s45, 32768
  v_mfma_f32_16x16x32_bf16 v[56:59], a[132:135], a[120:123], v[56:59]
  ds_read_b64_tr_b16 a[156:157], v1 offset:21568
  v_mfma_f32_16x16x32_bf16 v[60:63], a[132:135], a[124:127], v[60:63]
  ds_read_b64_tr_b16 a[158:159], v1 offset:25152
  v_mfma_f32_16x16x32_bf16 v[60:63], a[128:131], a[108:111], v[60:63]
  v_mfma_f32_16x16x32_bf16 v[172:175], a[136:139], a[108:111], v[172:175]
  ds_read_b64_tr_b16 a[160:161], v1 offset:28736
  v_mul_f32 v22, v10, v48
  v_mul_f32 v23, v10, v49
  v_mul_f32 v24, v10, v50
  v_mfma_f32_16x16x32_bf16 v[172:175], a[140:143], a[124:127], v[172:175]
  v_mul_f32 v25, v10, v51
  v_exp_f32 v22, v22
  v_mul_f32 v26, v13, v52
  v_mfma_f32_16x16x32_bf16 v[168:171], a[140:143], a[120:123], v[168:171]
  ds_read_b64_tr_b16 a[162:163], v1 offset:32320
  v_exp_f32 v23, v23
  v_mul_f32 v27, v13, v53
  v_mfma_f32_16x16x32_bf16 v[168:171], a[136:139], a[104:107], v[168:171]
Hc0_2:
  s_cbranch_execz Rc
  v_exp_f32 v24, v24
  v_mul_f32 v28, v13, v54
  v_mfma_f32_16x16x32_bf16 v[164:167], a[136:139], a[100:103], v[164:167]
  ds_read_b64_tr_b16 a[164:165], v1 offset:35904
  v_exp_f32 v25, v25
  v_mul_f32 v29, v13, v55
  v_mfma_f32_16x16x32_bf16 v[164:167], a[140:143], a[116:119], v[164:167]
  v_exp_f32 v26, v26
  v_fma_f32 v22, v22, v11, v11
  v_mfma_f32_16x16x32_bf16 v[160:163], a[140:143], a[112:115], v[160:163]
  ds_read_b64_tr_b16 a[166:167], v1 offset:39488
  v_exp_f32 v27, v27
  v_fma_f32 v23, v23, v11, v11
  v_mfma_f32_16x16x32_bf16 v[160:163], a[136:139], a[96:99], v[160:163]
  s_waitcnt lgkmcnt(4)
  v_exp_f32 v28, v28
  v_fma_f32 v24, v24, v11, v11
  v_mfma_f32_16x16x32_bf16 v[64:67], a[144:147], a[32:35], v[64:67]
  ds_read_b64_tr_b16 a[168:169], v1 offset:43072
  v_exp_f32 v29, v29
  v_fma_f32 v25, v25, v11, v11
  v_mfma_f32_16x16x32_bf16 v[64:67], a[148:151], a[48:51], v[64:67]
  v_rcp_f32 v22, v22
  v_fma_f32 v26, v26, v14, v14
  v_mfma_f32_16x16x32_bf16 v[68:71], a[148:151], a[52:55], v[68:71]
  ds_read_b64_tr_b16 a[170:171], v1 offset:46656
  v_rcp_f32 v23, v23
  v_fma_f32 v27, v27, v14, v14
  v_mfma_f32_16x16x32_bf16 v[68:71], a[144:147], a[36:39], v[68:71]
  v_rcp_f32 v24, v24
  v_fma_f32 v28, v28, v14, v14
  v_mfma_f32_16x16x32_bf16 v[72:75], a[144:147], a[40:43], v[72:75]
  ds_read_b64_tr_b16 a[172:173], v1 offset:50240
  v_rcp_f32 v25, v25
  v_fma_f32 v29, v29, v14, v14
  v_mfma_f32_16x16x32_bf16 v[72:75], a[148:151], a[56:59], v[72:75]
  v_rcp_f32 v26, v26
  v_mul_f32 v160, v48, v160
  v_mfma_f32_16x16x32_bf16 v[76:79], a[148:151], a[60:63], v[76:79]
  ds_read_b64_tr_b16 a[174:175], v1 offset:53824
  v_rcp_f32 v27, v27
  v_mul_f32 v161, v49, v161
  v_mfma_f32_16x16x32_bf16 v[76:79], a[144:147], a[44:47], v[76:79]
  s_waitcnt lgkmcnt(11)
  v_rcp_f32 v28, v28
  v_mul_f32 v162, v50, v162
  v_mfma_f32_16x16x32_bf16 v[64:67], a[24:27], a[0:3], v[64:67]
  ds_read_b64_tr_b16 a[128:129], v2 offset:64
  v_rcp_f32 v29, v29
  v_mul_f32 v163, v51, v163
  v_mfma_f32_16x16x32_bf16 v[68:71], a[24:27], a[4:7], v[68:71]
  v_mul_f32 v160, v160, v22
  v_mul_f32 v161, v161, v23
  v_mul_f32 v162, v162, v24
  v_mul_f32 v163, v163, v25
  v_mfma_f32_16x16x32_bf16 v[72:75], a[24:27], a[8:11], v[72:75]
  ds_read_b64_tr_b16 a[130:131], v2 offset:3648
  v_mul_f32 v22, v16, v56
  v_mul_f32 v23, v16, v57
  v_mul_f32 v24, v16, v58
  v_mfma_f32_16x16x32_bf16 v[76:79], a[24:27], a[12:15], v[76:79]
  v_mul_f32 v25, v16, v59
  v_exp_f32 v22, v22
  v_mul_f32 v164, v52, v164
  v_mfma_f32_16x16x32_bf16 v[176:179], a[28:31], a[0:3], v[176:179]
  ds_read_b64_tr_b16 a[132:133], v2 offset:7232
  v_exp_f32 v23, v23
  v_mul_f32 v165, v53, v165
  v_mfma_f32_16x16x32_bf16 v[180:183], a[28:31], a[4:7], v[180:183]
  v_exp_f32 v24, v24
  v_mul_f32 v166, v54, v166
  v_mfma_f32_16x16x32_bf16 v[184:187], a[28:31], a[8:11], v[184:187]
  ds_read_b64_tr_b16 a[134:135], v2 offset:10816
  v_exp_f32 v25, v25
  v_mul_f32 v167, v55, v167
  v_mfma_f32_16x16x32_bf16 v[188:191], a[28:31], a[12:15], v[188:191]
  v_mul_f32 v164, v164, v26
  v_mul_f32 v165, v165, v27
  v_mul_f32 v166, v166, v28
  v_mul_f32 v167, v167, v29
  v_mfma_f32_16x16x32_bf16 v[188:191], a[152:155], a[44:47], v[188:191]
  ds_read_b64_tr_b16 a[136:137], v2 offset:14400
  v_cvt_pk_bf16_f32 v34, v160, v161
  v_cvt_pk_bf16_f32 v35, v162, v163
  v_mfma_f32_16x16x32_bf16 v[188:191], a[156:159], a[60:63], v[188:191]
  buffer_store_dwordx4 v[32:35], v0, s[36:39], s65 offen offset:0 sc1
  v_mul_f32 v26, v19, v60
  v_mul_f32 v27, v19, v61
  v_mul_f32 v28, v19, v62
  v_mfma_f32_16x16x32_bf16 v[184:187], a[156:159], a[56:59], v[184:187]
  s_mov_b32 s69, 3
  s_lshl_b32 s50, s69, 16
  s_lshl1_add_u32 s50, s88, s50
  s_add_u32 m0, s70, 94208
  ds_read_b64_tr_b16 a[138:139], v2 offset:17984
  v_mfma_f32_16x16x32_bf16 v[184:187], a[152:155], a[40:43], v[184:187]
  v_mul_f32 v29, v19, v63
  v_exp_f32 v26, v26
  v_fma_f32 v22, v22, v17, v17
  v_mfma_f32_16x16x32_bf16 v[180:183], a[152:155], a[36:39], v[180:183]
  ds_read_b64_tr_b16 a[140:141], v2 offset:21568
  v_exp_f32 v27, v27
  v_fma_f32 v23, v23, v17, v17
  v_mfma_f32_16x16x32_bf16 v[180:183], a[156:159], a[52:55], v[180:183]
  v_exp_f32 v28, v28
  v_fma_f32 v24, v24, v17, v17
  v_mfma_f32_16x16x32_bf16 v[176:179], a[156:159], a[48:51], v[176:179]
  buffer_load_dwordx4 v133, s[24:27], s50 offen offset:0 lds
  v_exp_f32 v29, v29
  v_fma_f32 v25, v25, v17, v17
  v_mfma_f32_16x16x32_bf16 v[176:179], a[152:155], a[32:35], v[176:179]
  s_waitcnt lgkmcnt(7)
  ds_read_b64_tr_b16 a[142:143], v2 offset:25152
  v_cvt_pk_bf16_f32 v38, v164, v165
  v_cvt_pk_bf16_f32 v39, v166, v167
  v_mfma_f32_16x16x32_bf16 v[64:67], a[160:163], a[64:67], v[64:67]
  ds_read_b64_tr_b16 a[144:145], v1 offset:96
  v_mfma_f32_16x16x32_bf16 v[64:67], a[164:167], a[80:83], v[64:67]
  buffer_store_dwordx4 v[36:39], v0, s[36:39], s65 offen offset:1024 sc1
  v_rcp_f32 v22, v22
  v_fma_f32 v26, v26, v20, v20
  v_mfma_f32_16x16x32_bf16 v[68:71], a[164:167], a[84:87], v[68:71]
  ds_read_b64_tr_b16 a[146:147], v1 offset:3680
  v_rcp_f32 v23, v23
  v_fma_f32 v27, v27, v20, v20
  v_mfma_f32_16x16x32_bf16 v[68:71], a[160:163], a[68:71], v[68:71]
  buffer_load_dwordx4 v134, s[24:27], s50 offen offset:1024 lds
  v_rcp_f32 v24, v24
  v_fma_f32 v28, v28, v20, v20
  v_mfma_f32_16x16x32_bf16 v[72:75], a[160:163], a[72:75], v[72:75]
  ds_read_b64_tr_b16 a[148:149], v1 offset:7264
  v_rcp_f32 v25, v25
  v_fma_f32 v29, v29, v20, v20
  v_mfma_f32_16x16x32_bf16 v[72:75], a[164:167], a[88:91], v[72:75]
  v_rcp_f32 v26, v26
  v_mul_f32 v168, v56, v168
  v_mfma_f32_16x16x32_bf16 v[76:79], a[164:167], a[92:95], v[76:79]
  buffer_load_dwordx4 v135, s[24:27], s50 offen offset:2048 lds
  v_rcp_f32 v27, v27
  v_mul_f32 v169, v57, v169
  v_mfma_f32_16x16x32_bf16 v[76:79], a[160:163], a[76:79], v[76:79]
  ds_read_b64_tr_b16 a[150:151], v1 offset:10848
  v_rcp_f32 v28, v28
  v_mul_f32 v170, v58, v170
  v_mfma_f32_16x16x32_bf16 v[188:191], a[168:171], a[76:79], v[188:191]
  v_rcp_f32 v29, v29
  v_mul_f32 v171, v59, v171
  v_mul_f32 v168, v168, v22
  v_mfma_f32_16x16x32_bf16 v[188:191], a[172:175], a[92:95], v[188:191]
  v_mul_f32 v169, v169, v23
  v_mul_f32 v170, v170, v24
  v_mul_f32 v171, v171, v25
  v_mul_f32 v172, v60, v172
  v_mfma_f32_16x16x32_bf16 v[184:187], a[172:175], a[88:91], v[184:187]
  buffer_load_dwordx4 v136, s[24:27], s50 offen offset:3072 lds
  s_mov_b32 s71, 17
  s_lshl_b32 s50, s71, 16
  s_lshl1_add_u32 s50, s88, s50
  v_mfma_f32_16x16x32_bf16 v[184:187], a[168:171], a[72:75], v[184:187]
  s_add_u32 m0, s70, 110592
  v_mul_f32 v173, v61, v173
  v_mul_f32 v174, v62, v174
  v_mul_f32 v175, v63, v175
  v_cvt_pk_bf16_f32 v42, v168, v169
  v_mfma_f32_16x16x32_bf16 v[180:183], a[168:171], a[68:71], v[180:183]
  v_cvt_pk_bf16_f32 v43, v170, v171
  v_mfma_f32_16x16x32_bf16 v[180:183], a[172:175], a[84:87], v[180:183]
  buffer_store_dwordx4 v[40:43], v0, s[36:39], s66 offen offset:0 sc1
  v_mul_f32 v172, v172, v26
  v_mul_f32 v173, v173, v27
  v_mul_f32 v174, v174, v28
  v_mfma_f32_16x16x32_bf16 v[176:179], a[172:175], a[80:83], v[176:179]
  v_mul_f32 v175, v175, v29
  v_cvt_pk_bf16_f32 v46, v172, v173
  v_cvt_pk_bf16_f32 v47, v174, v175
  v_mfma_f32_16x16x32_bf16 v[176:179], a[168:171], a[64:67], v[176:179]
  s_waitcnt lgkmcnt(4)
  buffer_load_dwordx4 v133, s[24:27], s50 offen offset:0 lds
  v_mfma_f32_16x16x32_bf16 v[64:67], a[128:131], a[96:99], v[64:67]
  ds_read_b128 a[16:19], v31 offset:768
  v_mfma_f32_16x16x32_bf16 v[64:67], a[132:135], a[112:115], v[64:67]
  ds_read_b64_tr_b16 a[152:153], v1 offset:14432
  v_mfma_f32_16x16x32_bf16 v[68:71], a[132:135], a[116:119], v[68:71]
  ds_read_b128 a[20:23], v31 offset:2816
  v_mfma_f32_16x16x32_bf16 v[68:71], a[128:131], a[100:103], v[68:71]
  buffer_load_dwordx4 v134, s[24:27], s50 offen offset:1024 lds
  v_mfma_f32_16x16x32_bf16 v[72:75], a[128:131], a[104:107], v[72:75]
  ds_read_b64_tr_b16 a[154:155], v1 offset:18016
  v_mfma_f32_16x16x32_bf16 v[72:75], a[132:135], a[120:123], v[72:75]
  ds_read_b64_tr_b16 a[156:157], v1 offset:21600
  v_mfma_f32_16x16x32_bf16 v[76:79], a[132:135], a[124:127], v[76:79]
  buffer_store_dwordx4 v[44:47], v0, s[36:39], s66 offen offset:1024 sc1
  s_add_u32 s65, s65, 2048
  s_add_u32 s66, s66, 2048
  v_mfma_f32_16x16x32_bf16 v[76:79], a[128:131], a[108:111], v[76:79]
  ds_read_b64_tr_b16 a[158:159], v1 offset:25184
  v_mfma_f32_16x16x32_bf16 v[188:191], a[136:139], a[108:111], v[188:191]
  buffer_load_dwordx4 v135, s[24:27], s50 offen offset:2048 lds
  v_mul_f32 v22, v10, v64
  v_mul_f32 v23, v10, v65
  v_mul_f32 v24, v10, v66
  v_mfma_f32_16x16x32_bf16 v[188:191], a[140:143], a[124:127], v[188:191]
  ds_read_b64_tr_b16 a[160:161], v1 offset:28768
  v_mul_f32 v25, v10, v67
  v_exp_f32 v22, v22
  v_mfma_f32_16x16x32_bf16 v[184:187], a[140:143], a[120:123], v[184:187]
  buffer_load_dwordx4 v136, s[24:27], s50 offen offset:3072 lds
  s_mov_b32 s72, 31
  s_lshl_b32 s50, s72, 16
  s_lshl1_add_u32 s50, s88, s50
  v_mfma_f32_16x16x32_bf16 v[184:187], a[136:139], a[104:107], v[184:187]
  s_add_u32 m0, s70, 126976
  ds_read_b64_tr_b16 a[162:163], v1 offset:32352
  v_mul_f32 v26, v13, v68
  v_exp_f32 v23, v23
  v_mfma_f32_16x16x32_bf16 v[180:183], a[136:139], a[100:103], v[180:183]
  ds_read_b64_tr_b16 a[164:165], v1 offset:35936
  v_mul_f32 v27, v13, v69
  v_exp_f32 v24, v24
  v_mfma_f32_16x16x32_bf16 v[180:183], a[140:143], a[116:119], v[180:183]
  v_mul_f32 v28, v13, v70
  v_exp_f32 v25, v25
  v_mul_f32 v29, v13, v71
  v_mfma_f32_16x16x32_bf16 v[176:179], a[140:143], a[112:115], v[176:179]
  buffer_load_dwordx4 v133, s[24:27], s50 offen offset:0 lds
  v_exp_f32 v26, v26
  v_fma_f32 v22, v22, v11, v11
  v_mfma_f32_16x16x32_bf16 v[176:179], a[136:139], a[96:99], v[176:179]
  s_waitcnt lgkmcnt(3)
  ds_read_b64_tr_b16 a[166:167], v1 offset:39520
  v_exp_f32 v27, v27
  v_fma_f32 v23, v23, v11, v11
  v_mfma_f32_16x16x32_bf16 v[80:83], a[144:147], a[32:35], v[80:83]
  ds_read_b64_tr_b16 a[168:169], v1 offset:43104
  v_exp_f32 v28, v28
  v_fma_f32 v24, v24, v11, v11
  v_mfma_f32_16x16x32_bf16 v[80:83], a[148:151], a[48:51], v[80:83]
  v_exp_f32 v29, v29
  v_fma_f32 v25, v25, v11, v11
  v_mfma_f32_16x16x32_bf16 v[84:87], a[148:151], a[52:55], v[84:87]
  buffer_load_dwordx4 v134, s[24:27], s50 offen offset:1024 lds
  v_rcp_f32 v22, v22
  v_fma_f32 v26, v26, v14, v14
  v_mfma_f32_16x16x32_bf16 v[84:87], a[144:147], a[36:39], v[84:87]
  ds_read_b64_tr_b16 a[170:171], v1 offset:46688
  v_rcp_f32 v23, v23
  v_fma_f32 v27, v27, v14, v14
  v_mfma_f32_16x16x32_bf16 v[88:91], a[144:147], a[40:43], v[88:91]
  ds_read_b64_tr_b16 a[172:173], v1 offset:50272
  v_rcp_f32 v24, v24
  v_fma_f32 v28, v28, v14, v14
  v_mfma_f32_16x16x32_bf16 v[88:91], a[148:151], a[56:59], v[88:91]
  v_rcp_f32 v25, v25
  v_fma_f32 v29, v29, v14, v14
  v_mfma_f32_16x16x32_bf16 v[92:95], a[148:151], a[60:63], v[92:95]
  buffer_load_dwordx4 v135, s[24:27], s50 offen offset:2048 lds
  v_rcp_f32 v26, v26
  v_mul_f32 v176, v64, v176
  v_mfma_f32_16x16x32_bf16 v[92:95], a[144:147], a[44:47], v[92:95]
  s_waitcnt lgkmcnt(10)
  ds_read_b64_tr_b16 a[174:175], v1 offset:53856
  v_rcp_f32 v27, v27
  v_mul_f32 v177, v65, v177
  v_mfma_f32_16x16x32_bf16 v[80:83], a[16:19], a[0:3], v[80:83]
  ds_read_b64_tr_b16 a[128:129], v2 offset:96
  v_rcp_f32 v28, v28
  v_mul_f32 v178, v66, v178
  v_mfma_f32_16x16x32_bf16 v[84:87], a[16:19], a[4:7], v[84:87]
  v_rcp_f32 v29, v29
  v_mul_f32 v179, v67, v179
  v_mul_f32 v176, v176, v22
  v_mfma_f32_16x16x32_bf16 v[88:91], a[16:19], a[8:11], v[88:91]
  buffer_load_dwordx4 v136, s[24:27], s50 offen offset:3072 lds
  s_mov_b32 s73, 45
  s_lshl_b32 s50, s73, 16
  s_lshl1_add_u32 s50, s88, s50
  v_mfma_f32_16x16x32_bf16 v[92:95], a[16:19], a[12:15], v[92:95]
  s_add_u32 m0, s70, 143360
  ds_read_b64_tr_b16 a[130:131], v2 offset:3680
  v_mul_f32 v177, v177, v23
  v_mul_f32 v178, v178, v24
  v_mul_f32 v179, v179, v25
  v_mfma_f32_16x16x32_bf16 v[192:195], a[20:23], a[0:3], v[192:195]
  ds_read_b64_tr_b16 a[132:133], v2 offset:7264
  v_mul_f32 v22, v16, v72
  v_mul_f32 v23, v16, v73
  v_mul_f32 v24, v16, v74
  v_mfma_f32_16x16x32_bf16 v[196:199], a[20:23], a[4:7], v[196:199]
  v_mul_f32 v25, v16, v75
  v_exp_f32 v22, v22
  v_mul_f32 v180, v68, v180
  v_mfma_f32_16x16x32_bf16 v[200:203], a[20:23], a[8:11], v[200:203]
  buffer_load_dwordx4 v133, s[24:27], s50 offen offset:0 lds
  v_exp_f32 v23, v23
  v_mul_f32 v181, v69, v181
  v_mfma_f32_16x16x32_bf16 v[204:207], a[20:23], a[12:15], v[204:207]
  ds_read_b64_tr_b16 a[134:135], v2 offset:10848
  v_exp_f32 v24, v24
  v_mul_f32 v182, v70, v182
  v_mfma_f32_16x16x32_bf16 v[204:207], a[152:155], a[44:47], v[204:207]
  ds_read_b64_tr_b16 a[136:137], v2 offset:14432
  v_exp_f32 v25, v25
  v_mul_f32 v183, v71, v183
  v_mfma_f32_16x16x32_bf16 v[204:207], a[156:159], a[60:63], v[204:207]
  v_mul_f32 v180, v180, v26
  v_mul_f32 v181, v181, v27
  v_mul_f32 v182, v182, v28
  v_mul_f32 v183, v183, v29
  v_mfma_f32_16x16x32_bf16 v[200:203], a[156:159], a[56:59], v[200:203]
  buffer_load_dwordx4 v134, s[24:27], s50 offen offset:1024 lds
  v_cvt_pk_bf16_f32 v64, v176, v177
  v_cvt_pk_bf16_f32 v65, v178, v179
  v_mul_f32 v26, v19, v76
  v_mfma_f32_16x16x32_bf16 v[200:203], a[152:155], a[40:43], v[200:203]
  ds_read_b64_tr_b16 a[138:139], v2 offset:18016
  v_mul_f32 v27, v19, v77
  v_mul_f32 v28, v19, v78
  v_mul_f32 v29, v19, v79
  v_mfma_f32_16x16x32_bf16 v[196:199], a[152:155], a[36:39], v[196:199]
  ds_read_b64_tr_b16 a[140:141], v2 offset:21600
  v_exp_f32 v26, v26
  v_fma_f32 v22, v22, v17, v17
  v_mfma_f32_16x16x32_bf16 v[196:199], a[156:159], a[52:55], v[196:199]
  v_exp_f32 v27, v27
  v_fma_f32 v23, v23, v17, v17
  v_mfma_f32_16x16x32_bf16 v[192:195], a[156:159], a[48:51], v[192:195]
  buffer_load_dwordx4 v135, s[24:27], s50 offen offset:2048 lds
  v_exp_f32 v28, v28
  v_fma_f32 v24, v24, v17, v17
  v_mfma_f32_16x16x32_bf16 v[192:195], a[152:155], a[32:35], v[192:195]
  s_waitcnt lgkmcnt(7)
  ds_read_b64_tr_b16 a[142:143], v2 offset:25184
  v_exp_f32 v29, v29
  v_fma_f32 v25, v25, v17, v17
  v_mfma_f32_16x16x32_bf16 v[80:83], a[160:163], a[64:67], v[80:83]
  ds_read_b64_tr_b16 a[144:145], v1 offset:128
  v_cvt_pk_bf16_f32 v68, v180, v181
  v_cvt_pk_bf16_f32 v69, v182, v183
  v_mfma_f32_16x16x32_bf16 v[80:83], a[164:167], a[80:83], v[80:83]
  v_rcp_f32 v22, v22
  v_fma_f32 v26, v26, v20, v20
  v_mfma_f32_16x16x32_bf16 v[84:87], a[164:167], a[84:87], v[84:87]
  buffer_load_dwordx4 v136, s[24:27], s50 offen offset:3072 lds
  v_rcp_f32 v23, v23
  v_fma_f32 v27, v27, v20, v20
  v_mfma_f32_16x16x32_bf16 v[84:87], a[160:163], a[68:71], v[84:87]
  ds_read_b64_tr_b16 a[146:147], v1 offset:3712
  v_rcp_f32 v24, v24
  v_fma_f32 v28, v28, v20, v20
  v_mfma_f32_16x16x32_bf16 v[88:91], a[160:163], a[72:75], v[88:91]
  ds_read_b64_tr_b16 a[148:149], v1 offset:7296
  v_rcp_f32 v25, v25
  v_fma_f32 v29, v29, v20, v20
  v_mfma_f32_16x16x32_bf16 v[88:91], a[164:167], a[88:91], v[88:91]
  v_rcp_f32 v26, v26
  v_mul_f32 v184, v72, v184
  v_mfma_f32_16x16x32_bf16 v[92:95], a[164:167], a[92:95], v[92:95]
  ds_read_b64_tr_b16 a[150:151], v1 offset:10880
  v_rcp_f32 v27, v27
  v_mul_f32 v185, v73, v185
  v_mfma_f32_16x16x32_bf16 v[92:95], a[160:163], a[76:79], v[92:95]
  v_rcp_f32 v28, v28
  v_mul_f32 v186, v74, v186
  v_mfma_f32_16x16x32_bf16 v[204:207], a[168:171], a[76:79], v[204:207]
  v_rcp_f32 v29, v29
  v_mul_f32 v187, v75, v187
  v_mul_f32 v184, v184, v22
  v_mfma_f32_16x16x32_bf16 v[204:207], a[172:175], a[92:95], v[204:207]
  v_mul_f32 v185, v185, v23
  v_mul_f32 v186, v186, v24
  v_mul_f32 v187, v187, v25
  v_mul_f32 v188, v76, v188
  v_mfma_f32_16x16x32_bf16 v[200:203], a[172:175], a[88:91], v[200:203]
  v_mul_f32 v189, v77, v189
  v_mul_f32 v190, v78, v190
  v_mul_f32 v191, v79, v191
  v_cvt_pk_bf16_f32 v72, v184, v185
  v_mfma_f32_16x16x32_bf16 v[200:203], a[168:171], a[72:75], v[200:203]
  v_cvt_pk_bf16_f32 v73, v186, v187
  v_mul_f32 v188, v188, v26
  v_mul_f32 v189, v189, v27
  v_mul_f32 v190, v190, v28
  v_mfma_f32_16x16x32_bf16 v[196:199], a[168:171], a[68:71], v[196:199]
  v_mul_f32 v191, v191, v29
  v_cvt_pk_bf16_f32 v76, v188, v189
  v_cvt_pk_bf16_f32 v77, v190, v191
  v_mfma_f32_16x16x32_bf16 v[196:199], a[172:175], a[84:87], v[196:199]
  v_mfma_f32_16x16x32_bf16 v[192:195], a[172:175], a[80:83], v[192:195]
  buffer_load_dword v139, v138, s[36:39], s91 offen sc1
  v_mfma_f32_16x16x32_bf16 v[192:195], a[168:171], a[64:67], v[192:195]
  s_waitcnt lgkmcnt(4)
  v_mfma_f32_16x16x32_bf16 v[80:83], a[128:131], a[96:99], v[80:83]
  ds_read_b128 a[24:27], v31 offset:1024
  v_mfma_f32_16x16x32_bf16 v[80:83], a[132:135], a[112:115], v[80:83]
  ds_read_b64_tr_b16 a[152:153], v1 offset:14464
  v_mfma_f32_16x16x32_bf16 v[84:87], a[132:135], a[116:119], v[84:87]
  ds_read_b128 a[28:31], v31 offset:3072
  v_mfma_f32_16x16x32_bf16 v[84:87], a[128:131], a[100:103], v[84:87]
  ds_read_b64_tr_b16 a[154:155], v1 offset:18048
  v_mfma_f32_16x16x32_bf16 v[88:91], a[128:131], a[104:107], v[88:91]
  ds_read_b64_tr_b16 a[156:157], v1 offset:21632
  v_mfma_f32_16x16x32_bf16 v[88:91], a[132:135], a[120:123], v[88:91]
  v_mfma_f32_16x16x32_bf16 v[92:95], a[132:135], a[124:127], v[92:95]
  ds_read_b64_tr_b16 a[158:159], v1 offset:25216
  v_mfma_f32_16x16x32_bf16 v[92:95], a[128:131], a[108:111], v[92:95]
  v_mfma_f32_16x16x32_bf16 v[204:207], a[136:139], a[108:111], v[204:207]
  ds_read_b64_tr_b16 a[160:161], v1 offset:28800
  v_mul_f32 v22, v10, v80
  v_mul_f32 v23, v10, v81
  v_mul_f32 v24, v10, v82
  v_mfma_f32_16x16x32_bf16 v[204:207], a[140:143], a[124:127], v[204:207]
  v_mul_f32 v25, v10, v83
  v_exp_f32 v22, v22
  v_mul_f32 v26, v13, v84
  v_mfma_f32_16x16x32_bf16 v[200:203], a[140:143], a[120:123], v[200:203]
  ds_read_b64_tr_b16 a[162:163], v1 offset:32384
  v_exp_f32 v23, v23
  v_mul_f32 v27, v13, v85
  v_mfma_f32_16x16x32_bf16 v[200:203], a[136:139], a[104:107], v[200:203]
  s_waitcnt vmcnt(11)
  s_barrier
  v_exp_f32 v24, v24
  v_mul_f32 v28, v13, v86
  v_mfma_f32_16x16x32_bf16 v[196:199], a[136:139], a[100:103], v[196:199]
  s_mov_b64 exec, 1
  buffer_store_dword v9, v0, s[36:39], s45 offen sc1
  s_mov_b64 exec, -1
  s_add_u32 s45, s45, 32768
  v_mfma_f32_16x16x32_bf16 v[196:199], a[140:143], a[116:119], v[196:199]
  ds_read_b64_tr_b16 a[164:165], v1 offset:35968
  v_exp_f32 v25, v25
  v_mul_f32 v29, v13, v87
  v_mfma_f32_16x16x32_bf16 v[192:195], a[140:143], a[112:115], v[192:195]
  ds_read_b64_tr_b16 a[166:167], v1 offset:39552
  v_exp_f32 v26, v26
  v_fma_f32 v22, v22, v11, v11
  v_mfma_f32_16x16x32_bf16 v[192:195], a[136:139], a[96:99], v[192:195]
  s_waitcnt lgkmcnt(4)
  v_exp_f32 v27, v27
  v_fma_f32 v23, v23, v11, v11
  v_mfma_f32_16x16x32_bf16 v[96:99], a[144:147], a[32:35], v[96:99]
  ds_read_b64_tr_b16 a[168:169], v1 offset:43136
  v_exp_f32 v28, v28
  v_fma_f32 v24, v24, v11, v11
  v_mfma_f32_16x16x32_bf16 v[96:99], a[148:151], a[48:51], v[96:99]
  v_exp_f32 v29, v29
  v_fma_f32 v25, v25, v11, v11
  v_mfma_f32_16x16x32_bf16 v[100:103], a[148:151], a[52:55], v[100:103]
  ds_read_b64_tr_b16 a[170:171], v1 offset:46720
  v_rcp_f32 v22, v22
  v_fma_f32 v26, v26, v14, v14
  v_mfma_f32_16x16x32_bf16 v[100:103], a[144:147], a[36:39], v[100:103]
  v_rcp_f32 v23, v23
  v_fma_f32 v27, v27, v14, v14
  v_mfma_f32_16x16x32_bf16 v[104:107], a[144:147], a[40:43], v[104:107]
  ds_read_b64_tr_b16 a[172:173], v1 offset:50304
  v_rcp_f32 v24, v24
  v_fma_f32 v28, v28, v14, v14
  v_mfma_f32_16x16x32_bf16 v[104:107], a[148:151], a[56:59], v[104:107]
  v_rcp_f32 v25, v25
  v_fma_f32 v29, v29, v14, v14
  v_mfma_f32_16x16x32_bf16 v[108:111], a[148:151], a[60:63], v[108:111]
  ds_read_b64_tr_b16 a[174:175], v1 offset:53888
  v_rcp_f32 v26, v26
  v_mul_f32 v192, v80, v192
  v_mfma_f32_16x16x32_bf16 v[108:111], a[144:147], a[44:47], v[108:111]
  s_waitcnt lgkmcnt(11)
  v_rcp_f32 v27, v27
  v_mul_f32 v193, v81, v193
  v_mfma_f32_16x16x32_bf16 v[96:99], a[24:27], a[0:3], v[96:99]
  ds_read_b64_tr_b16 a[128:129], v2 offset:128
  v_rcp_f32 v28, v28
  v_mul_f32 v194, v82, v194
  v_mfma_f32_16x16x32_bf16 v[100:103], a[24:27], a[4:7], v[100:103]
  v_rcp_f32 v29, v29
  v_mul_f32 v195, v83, v195
  v_mul_f32 v192, v192, v22
  v_mfma_f32_16x16x32_bf16 v[104:107], a[24:27], a[8:11], v[104:107]
  ds_read_b64_tr_b16 a[130:131], v2 offset:3712
  v_mul_f32 v193, v193, v23
  v_mul_f32 v194, v194, v24
  v_mul_f32 v195, v195, v25
  v_mfma_f32_16x16x32_bf16 v[108:111], a[24:27], a[12:15], v[108:111]
  v_mul_f32 v22, v16, v88
  v_mul_f32 v23, v16, v89
  v_mul_f32 v24, v16, v90
  v_mul_f32 v25, v16, v91
  v_mfma_f32_16x16x32_bf16 v[208:211], a[28:31], a[0:3], v[208:211]
  ds_read_b64_tr_b16 a[132:133], v2 offset:7296
  v_exp_f32 v22, v22
  v_mul_f32 v196, v84, v196
  v_mfma_f32_16x16x32_bf16 v[212:215], a[28:31], a[4:7], v[212:215]
  v_exp_f32 v23, v23
  v_mul_f32 v197, v85, v197
  v_mfma_f32_16x16x32_bf16 v[216:219], a[28:31], a[8:11], v[216:219]
  s_waitcnt vmcnt(1)
  v_cmp_ne_u32 vcc, s3, v139
  s_nop 4
  s_cbranch_vccnz CK8s
CK8x:
  v_mfma_f32_16x16x32_bf16 v[220:223], a[28:31], a[12:15], v[220:223]
  s_lshl_b32 s51, s69, 11
  s_add_u32 s91, s91, 32768
  ds_read_b64_tr_b16 a[134:135], v2 offset:10880
  v_exp_f32 v24, v24
  v_mfma_f32_16x16x32_bf16 v[220:223], a[152:155], a[44:47], v[220:223]
  buffer_load_dwordx2 a[216:217], v7, s[36:39], s51 offen offset:0 sc1
  v_mul_f32 v198, v86, v198
  v_exp_f32 v25, v25
  v_mfma_f32_16x16x32_bf16 v[220:223], a[156:159], a[60:63], v[220:223]
  ds_read_b64_tr_b16 a[136:137], v2 offset:14464
  v_mul_f32 v199, v87, v199
  v_mul_f32 v196, v196, v26
  v_mul_f32 v197, v197, v27
  v_mfma_f32_16x16x32_bf16 v[216:219], a[156:159], a[56:59], v[216:219]
  buffer_load_dwordx2 a[218:219], v7, s[36:39], s51 offen offset:512 sc1
  v_mul_f32 v198, v198, v28
  v_mul_f32 v199, v199, v29
  v_cvt_pk_bf16_f32 v66, v192, v193
  v_mfma_f32_16x16x32_bf16 v[216:219], a[152:155], a[40:43], v[216:219]
  ds_read_b64_tr_b16 a[138:139], v2 offset:18048
  v_cvt_pk_bf16_f32 v67, v194, v195
  v_mfma_f32_16x16x32_bf16 v[212:215], a[152:155], a[36:39], v[212:215]
  buffer_load_dwordx2 a[220:221], v7, s[36:39], s51 offen offset:1024 sc1
  v_mfma_f32_16x16x32_bf16 v[212:215], a[156:159], a[52:55], v[212:215]
  ds_read_b64_tr_b16 a[140:141], v2 offset:21632
  v_mfma_f32_16x16x32_bf16 v[208:211], a[156:159], a[48:51], v[208:211]
  buffer_load_dwordx2 a[222:223], v7, s[36:39], s51 offen offset:1536 sc1
  s_add_u32 s51, s51, 12288
  v_mfma_f32_16x16x32_bf16 v[208:211], a[152:155], a[32:35], v[208:211]
  s_waitcnt lgkmcnt(7)
  ds_read_b64_tr_b16 a[142:143], v2 offset:25216
  v_mfma_f32_16x16x32_bf16 v[96:99], a[160:163], a[64:67], v[96:99]
  buffer_load_dwordx2 a[224:225], v7, s[36:39], s51 offen offset:2048 sc1
  v_mfma_f32_16x16x32_bf16 v[96:99], a[164:167], a[80:83], v[96:99]
  ds_read_b64_tr_b16 a[144:145], v1 offset:160
  v_mfma_f32_16x16x32_bf16 v[100:103], a[164:167], a[84:87], v[100:103]
  buffer_load_dwordx2 a[226:227], v7, s[36:39], s51 offen offset:2560 sc1
  v_mfma_f32_16x16x32_bf16 v[100:103], a[160:163], a[68:71], v[100:103]
  ds_read_b64_tr_b16 a[146:147], v1 offset:3744
  v_mfma_f32_16x16x32_bf16 v[104:107], a[160:163], a[72:75], v[104:107]
  buffer_load_dwordx2 a[228:229], v7, s[36:39], s51 offen offset:3072 sc1
  v_mfma_f32_16x16x32_bf16 v[104:107], a[164:167], a[88:91], v[104:107]
  ds_read_b64_tr_b16 a[148:149], v1 offset:7328
  v_mfma_f32_16x16x32_bf16 v[108:111], a[164:167], a[92:95], v[108:111]
  buffer_load_dwordx2 a[230:231], v7, s[36:39], s51 offen offset:3584 sc1
  s_lshl_b32 s51, s71, 11
  v_mfma_f32_16x16x32_bf16 v[108:111], a[160:163], a[76:79], v[108:111]
  ds_read_b64_tr_b16 a[150:151], v1 offset:10912
  v_mfma_f32_16x16x32_bf16 v[220:223], a[168:171], a[76:79], v[220:223]
  buffer_load_dwordx2 v[176:177], v7, s[36:39], s51 offen offset:0 sc1
  v_mfma_f32_16x16x32_bf16 v[220:223], a[172:175], a[92:95], v[220:223]
  v_mfma_f32_16x16x32_bf16 v[216:219], a[172:175], a[88:91], v[216:219]
  buffer_load_dwordx2 v[178:179], v7, s[36:39], s51 offen offset:512 sc1
  v_mfma_f32_16x16x32_bf16 v[216:219], a[168:171], a[72:75], v[216:219]
  v_mfma_f32_16x16x32_bf16 v[212:215], a[168:171], a[68:71], v[212:215]
  buffer_load_dwordx2 v[180:181], v7, s[36:39], s51 offen offset:1024 sc1
  v_mfma_f32_16x16x32_bf16 v[212:215], a[172:175], a[84:87], v[212:215]
  v_mfma_f32_16x16x32_bf16 v[208:211], a[172:175], a[80:83], v[208:211]
  buffer_load_dwordx2 v[182:183], v7, s[36:39], s51 offen offset:1536 sc1
  s_add_u32 s51, s51, 12288
  v_mfma_f32_16x16x32_bf16 v[208:211], a[168:171], a[64:67], v[208:211]
  s_waitcnt lgkmcnt(4)
  v_mfma_f32_16x16x32_bf16 v[96:99], a[128:131], a[96:99], v[96:99]
  buffer_load_dwordx2 v[184:185], v7, s[36:39], s51 offen offset:2048 sc1
  v_mfma_f32_16x16x32_bf16 v[96:99], a[132:135], a[112:115], v[96:99]
  ds_read_b128 a[16:19], v31 offset:1280
  v_mfma_f32_16x16x32_bf16 v[100:103], a[132:135], a[116:119], v[100:103]
  buffer_load_dwordx2 v[186:187], v7, s[36:39], s51 offen offset:2560 sc1
  v_mfma_f32_16x16x32_bf16 v[100:103], a[128:131], a[100:103], v[100:103]
  ds_read_b64_tr_b16 a[152:153], v1 offset:14496
  v_mfma_f32_16x16x32_bf16 v[104:107], a[128:131], a[104:107], v[104:107]
  buffer_load_dwordx2 v[188:189], v7, s[36:39], s51 offen offset:3072 sc1
  v_mfma_f32_16x16x32_bf16 v[104:107], a[132:135], a[120:123], v[104:107]
  ds_read_b128 a[20:23], v31 offset:3328
  v_mfma_f32_16x16x32_bf16 v[108:111], a[132:135], a[124:127], v[108:111]
  buffer_load_dwordx2 v[190:191], v7, s[36:39], s51 offen offset:3584 sc1
  v_mfma_f32_16x16x32_bf16 v[108:111], a[128:131], a[108:111], v[108:111]
  ds_read_b64_tr_b16 a[154:155], v1 offset:18080
  v_mfma_f32_16x16x32_bf16 v[220:223], a[136:139], a[108:111], v[220:223]
  ds_read_b64_tr_b16 a[156:157], v1 offset:21664
  v_mfma_f32_16x16x32_bf16 v[220:223], a[140:143], a[124:127], v[220:223]
  ds_read_b64_tr_b16 a[158:159], v1 offset:25248
  v_mfma_f32_16x16x32_bf16 v[216:219], a[140:143], a[120:123], v[216:219]
  ds_read_b64_tr_b16 a[160:161], v1 offset:28832
  v_mfma_f32_16x16x32_bf16 v[216:219], a[136:139], a[104:107], v[216:219]
  ds_read_b64_tr_b16 a[162:163], v1 offset:32416
  v_mfma_f32_16x16x32_bf16 v[212:215], a[136:139], a[100:103], v[212:215]
  ds_read_b64_tr_b16 a[164:165], v1 offset:36000
  v_mfma_f32_16x16x32_bf16 v[212:215], a[140:143], a[116:119], v[212:215]
  buffer_store_dwordx4 v[64:67], v0, s[36:39], s65 offen offset:0 sc1
  v_mul_f32 v26, v19, v92
  v_mul_f32 v27, v19, v93
  v_mul_f32 v28, v19, v94
  v_mfma_f32_16x16x32_bf16 v[208:211], a[140:143], a[112:115], v[208:211]
  ds_read_b64_tr_b16 a[166:167], v1 offset:39584
  v_mul_f32 v29, v19, v95
  v_exp_f32 v26, v26
  v_mfma_f32_16x16x32_bf16 v[208:211], a[136:139], a[96:99], v[208:211]
  s_waitcnt lgkmcnt(4)
  v_fma_f32 v22, v22, v17, v17
  v_exp_f32 v27, v27
  v_fma_f32 v23, v23, v17, v17
  v_mfma_f32_16x16x32_bf16 v[112:115], a[144:147], a[32:35], v[112:115]
  ds_read_b64_tr_b16 a[168:169], v1 offset:43168
  v_exp_f32 v28, v28
  v_fma_f32 v24, v24, v17, v17
  v_mfma_f32_16x16x32_bf16 v[112:115], a[148:151], a[48:51], v[112:115]
  v_exp_f32 v29, v29
  v_fma_f32 v25, v25, v17, v17
  v_cvt_pk_bf16_f32 v70, v196, v197
  v_mfma_f32_16x16x32_bf16 v[116:119], a[148:151], a[52:55], v[116:119]
  ds_read_b64_tr_b16 a[170:171], v1 offset:46752
  v_cvt_pk_bf16_f32 v71, v198, v199
  v_mfma_f32_16x16x32_bf16 v[116:119], a[144:147], a[36:39], v[116:119]
  buffer_store_dwordx4 v[68:71], v0, s[36:39], s65 offen offset:1024 sc1
  v_rcp_f32 v22, v22
  v_fma_f32 v26, v26, v20, v20
  v_mfma_f32_16x16x32_bf16 v[120:123], a[144:147], a[40:43], v[120:123]
  ds_read_b64_tr_b16 a[172:173], v1 offset:50336
  v_rcp_f32 v23, v23
  v_fma_f32 v27, v27, v20, v20
  v_mfma_f32_16x16x32_bf16 v[120:123], a[148:151], a[56:59], v[120:123]
  v_rcp_f32 v24, v24
  v_fma_f32 v28, v28, v20, v20
  v_mfma_f32_16x16x32_bf16 v[124:127], a[148:151], a[60:63], v[124:127]
  ds_read_b64_tr_b16 a[174:175], v1 offset:53920
  v_rcp_f32 v25, v25
  v_fma_f32 v29, v29, v20, v20
  v_mfma_f32_16x16x32_bf16 v[124:127], a[144:147], a[44:47], v[124:127]
  s_waitcnt lgkmcnt(11)
  v_rcp_f32 v26, v26
  v_mul_f32 v200, v88, v200
  v_mfma_f32_16x16x32_bf16 v[112:115], a[16:19], a[0:3], v[112:115]
  v_rcp_f32 v27, v27
  v_mul_f32 v201, v89, v201
  v_rcp_f32 v28, v28
  v_mul_f32 v202, v90, v202
  v_rcp_f32 v29, v29
  v_mul_f32 v203, v91, v203
  v_mul_f32 v200, v200, v22
  v_mul_f32 v201, v201, v23
  v_mul_f32 v202, v202, v24
  v_mul_f32 v203, v203, v25
  v_mul_f32 v204, v92, v204
  v_mul_f32 v205, v93, v205
  v_mul_f32 v206, v94, v206
  v_mul_f32 v207, v95, v207
  v_cvt_pk_bf16_f32 v74, v200, v201
Hc1_2:
  s_cbranch_execz Rc
  v_cvt_pk_bf16_f32 v75, v202, v203
  buffer_store_dwordx4 v[72:75], v0, s[36:39], s66 offen offset:0 sc1
  v_mul_f32 v204, v204, v26
  v_mul_f32 v205, v205, v27
  v_mul_f32 v206, v206, v28
  v_mul_f32 v207, v207, v29
  v_cvt_pk_bf16_f32 v78, v204, v205
  v_cvt_pk_bf16_f32 v79, v206, v207
  buffer_store_dwordx4 v[76:79], v0, s[36:39], s66 offen offset:1024 sc1
  v_mfma_f32_16x16x32_bf16 v[116:119], a[16:19], a[4:7], v[116:119]
  s_lshl_b32 s51, s72, 11
  ds_read_b64_tr_b16 a[128:129], v2 offset:160
  s_add_u32 s65, s65, 2048
  s_add_u32 s66, s66, 2048
  v_mul_f32 v22, v10, v96
  v_mfma_f32_16x16x32_bf16 v[120:123], a[16:19], a[8:11], v[120:123]
  buffer_load_dwordx2 v[64:65], v7, s[36:39], s51 offen offset:0 sc1
  v_mul_f32 v23, v10, v97
  v_mul_f32 v24, v10, v98
  v_mul_f32 v25, v10, v99
  v_mfma_f32_16x16x32_bf16 v[124:127], a[16:19], a[12:15], v[124:127]
  ds_read_b64_tr_b16 a[130:131], v2 offset:3744
  v_exp_f32 v22, v22
  v_mul_f32 v26, v13, v100
  v_mfma_f32_16x16x32_bf16 v[224:227], a[20:23], a[0:3], v[224:227]
  buffer_load_dwordx2 v[66:67], v7, s[36:39], s51 offen offset:512 sc1
  v_exp_f32 v23, v23
  v_mul_f32 v27, v13, v101
  v_mfma_f32_16x16x32_bf16 v[228:231], a[20:23], a[4:7], v[228:231]
  ds_read_b64_tr_b16 a[132:133], v2 offset:7328
  v_exp_f32 v24, v24
  v_mul_f32 v28, v13, v102
  v_mfma_f32_16x16x32_bf16 v[232:235], a[20:23], a[8:11], v[232:235]
  buffer_load_dwordx2 v[68:69], v7, s[36:39], s51 offen offset:1024 sc1
  v_exp_f32 v25, v25
  v_mul_f32 v29, v13, v103
  v_mfma_f32_16x16x32_bf16 v[236:239], a[20:23], a[12:15], v[236:239]
  ds_read_b64_tr_b16 a[134:135], v2 offset:10912
  v_exp_f32 v26, v26
  v_fma_f32 v22, v22, v11, v11
  v_mfma_f32_16x16x32_bf16 v[236:239], a[152:155], a[44:47], v[236:239]
  buffer_load_dwordx2 v[70:71], v7, s[36:39], s51 offen offset:1536 sc1
  s_add_u32 s51, s51, 12288
  v_exp_f32 v27, v27
  v_mfma_f32_16x16x32_bf16 v[236:239], a[156:159], a[60:63], v[236:239]
  ds_read_b64_tr_b16 a[136:137], v2 offset:14496
  v_fma_f32 v23, v23, v11, v11
  v_exp_f32 v28, v28
  v_mfma_f32_16x16x32_bf16 v[232:235], a[156:159], a[56:59], v[232:235]
  buffer_load_dwordx2 v[72:73], v7, s[36:39], s51 offen offset:2048 sc1
  v_fma_f32 v24, v24, v11, v11
  v_exp_f32 v29, v29
  v_mfma_f32_16x16x32_bf16 v[232:235], a[152:155], a[40:43], v[232:235]
  ds_read_b64_tr_b16 a[138:139], v2 offset:18080
  v_fma_f32 v25, v25, v11, v11
  v_rcp_f32 v22, v22
  v_mfma_f32_16x16x32_bf16 v[228:231], a[152:155], a[36:39], v[228:231]
  buffer_load_dword v139, v138, s[36:39], s91 offen sc1
  v_fma_f32 v26, v26, v14, v14
  v_rcp_f32 v23, v23
  v_mfma_f32_16x16x32_bf16 v[228:231], a[156:159], a[52:55], v[228:231]
  ds_read_b64_tr_b16 a[140:141], v2 offset:21664
  v_fma_f32 v27, v27, v14, v14
  v_rcp_f32 v24, v24
  v_mfma_f32_16x16x32_bf16 v[224:227], a[156:159], a[48:51], v[224:227]
  buffer_load_dwordx2 v[74:75], v7, s[36:39], s51 offen offset:2560 sc1
  v_fma_f32 v28, v28, v14, v14
  v_rcp_f32 v25, v25
  v_mfma_f32_16x16x32_bf16 v[224:227], a[152:155], a[32:35], v[224:227]
  s_waitcnt lgkmcnt(7)
  ds_read_b64_tr_b16 a[142:143], v2 offset:25248
  v_fma_f32 v29, v29, v14, v14
  v_rcp_f32 v26, v26
  v_mfma_f32_16x16x32_bf16 v[112:115], a[160:163], a[64:67], v[112:115]
  buffer_load_dwordx2 v[76:77], v7, s[36:39], s51 offen offset:3072 sc1
  v_mul_f32 v208, v96, v208
  v_rcp_f32 v27, v27
  v_mfma_f32_16x16x32_bf16 v[112:115], a[164:167], a[80:83], v[112:115]
  v_mul_f32 v209, v97, v209
  v_rcp_f32 v28, v28
  v_mul_f32 v210, v98, v210
  v_mfma_f32_16x16x32_bf16 v[116:119], a[164:167], a[84:87], v[116:119]
  buffer_load_dwordx2 v[78:79], v7, s[36:39], s51 offen offset:3584 sc1
  s_lshl_b32 s51, s73, 11
  v_rcp_f32 v29, v29
  v_mfma_f32_16x16x32_bf16 v[116:119], a[160:163], a[68:71], v[116:119]
  v_mul_f32 v211, v99, v211
  v_mul_f32 v208, v208, v22
  v_mul_f32 v209, v209, v23
  v_mul_f32 v210, v210, v24
  v_mfma_f32_16x16x32_bf16 v[120:123], a[160:163], a[72:75], v[120:123]
  buffer_load_dwordx2 v[80:81], v7, s[36:39], s51 offen offset:0 sc1
  v_mul_f32 v211, v211, v25
  v_mul_f32 v22, v16, v104
  v_mul_f32 v23, v16, v105
  v_mfma_f32_16x16x32_bf16 v[120:123], a[164:167], a[88:91], v[120:123]
  v_mul_f32 v24, v16, v106
  v_mul_f32 v25, v16, v107
  v_exp_f32 v22, v22
  v_mfma_f32_16x16x32_bf16 v[124:127], a[164:167], a[92:95], v[124:127]
  buffer_load_dwordx2 v[82:83], v7, s[36:39], s51 offen offset:512 sc1
  v_mul_f32 v212, v100, v212
  v_exp_f32 v23, v23
  v_mfma_f32_16x16x32_bf16 v[124:127], a[160:163], a[76:79], v[124:127]
  s_waitcnt vmcnt(33)
  s_barrier
  v_mul_f32 v213, v101, v213
  v_exp_f32 v24, v24
  v_mfma_f32_16x16x32_bf16 v[236:239], a[168:171], a[76:79], v[236:239]
  buffer_load_dwordx2 v[84:85], v7, s[36:39], s51 offen offset:1024 sc1
  v_mul_f32 v214, v102, v214
  v_exp_f32 v25, v25
  v_mfma_f32_16x16x32_bf16 v[236:239], a[172:175], a[92:95], v[236:239]
  v_mul_f32 v215, v103, v215
  v_mul_f32 v212, v212, v26
  v_mul_f32 v213, v213, v27
  v_mul_f32 v214, v214, v28
  v_mfma_f32_16x16x32_bf16 v[232:235], a[172:175], a[88:91], v[232:235]
  buffer_load_dwordx2 v[86:87], v7, s[36:39], s51 offen offset:1536 sc1
  s_add_u32 s51, s51, 12288
  v_mul_f32 v215, v215, v29
  v_cvt_pk_bf16_f32 v96, v208, v209
  v_mfma_f32_16x16x32_bf16 v[232:235], a[168:171], a[72:75], v[232:235]
  v_cvt_pk_bf16_f32 v97, v210, v211
  v_mul_f32 v26, v19, v108
  v_mul_f32 v27, v19, v109
  v_mul_f32 v28, v19, v110
  v_mfma_f32_16x16x32_bf16 v[228:231], a[168:171], a[68:71], v[228:231]
  buffer_load_dwordx2 v[88:89], v7, s[36:39], s51 offen offset:2048 sc1
  v_mul_f32 v29, v19, v111
  v_exp_f32 v26, v26
  v_mfma_f32_16x16x32_bf16 v[228:231], a[172:175], a[84:87], v[228:231]
  v_fma_f32 v22, v22, v17, v17
  v_exp_f32 v27, v27
  v_fma_f32 v23, v23, v17, v17
  v_mfma_f32_16x16x32_bf16 v[224:227], a[172:175], a[80:83], v[224:227]
  buffer_load_dwordx2 v[90:91], v7, s[36:39], s51 offen offset:2560 sc1
  v_exp_f32 v28, v28
  v_fma_f32 v24, v24, v17, v17
  v_mfma_f32_16x16x32_bf16 v[224:227], a[168:171], a[64:67], v[224:227]
  s_waitcnt lgkmcnt(0)
  v_exp_f32 v29, v29
  v_fma_f32 v25, v25, v17, v17
  v_cvt_pk_bf16_f32 v100, v212, v213
  v_mfma_f32_16x16x32_bf16 v[112:115], a[128:131], a[96:99], v[112:115]
  s_barrier
  buffer_load_dwordx2 v[92:93], v7, s[36:39], s51 offen offset:3072 sc1
  ds_read_b64_tr_b16 a[176:177], v244 offset:28672
  v_cvt_pk_bf16_f32 v101, v214, v215
  v_mfma_f32_16x16x32_bf16 v[112:115], a[132:135], a[112:115], v[112:115]
  ds_read_b64_tr_b16 a[178:179], v244 offset:32768
  v_rcp_f32 v22, v22
  v_fma_f32 v26, v26, v20, v20
  v_mfma_f32_16x16x32_bf16 v[116:119], a[132:135], a[116:119], v[116:119]
  buffer_load_dwordx2 v[94:95], v7, s[36:39], s51 offen offset:3584 sc1
  ds_read_b64_tr_b16 a[180:181], v244 offset:36864
  v_rcp_f32 v23, v23
  v_mfma_f32_16x16x32_bf16 v[116:119], a[128:131], a[100:103], v[116:119]
G3M:
  ds_read_b64_tr_b16 a[182:183], v244 offset:40960
  v_fma_f32 v27, v27, v20, v20
  v_rcp_f32 v24, v24
  v_mfma_f32_16x16x32_bf16 v[120:123], a[128:131], a[104:107], v[120:123]
  ds_read_b64_tr_b16 a[184:185], v245 offset:28672
  v_fma_f32 v28, v28, v20, v20
  v_rcp_f32 v25, v25
  v_mfma_f32_16x16x32_bf16 v[120:123], a[132:135], a[120:123], v[120:123]
  ds_read_b64_tr_b16 a[186:187], v245 offset:32768
  v_fma_f32 v29, v29, v20, v20
  v_rcp_f32 v26, v26
  v_mfma_f32_16x16x32_bf16 v[124:127], a[132:135], a[124:127], v[124:127]
  ds_read_b64_tr_b16 a[188:189], v245 offset:36864
  v_mul_f32 v216, v104, v216
  v_rcp_f32 v27, v27
  v_mfma_f32_16x16x32_bf16 v[124:127], a[128:131], a[108:111], v[124:127]
  ds_read_b64_tr_b16 a[190:191], v245 offset:40960
  v_mul_f32 v217, v105, v217
  v_rcp_f32 v28, v28
  v_mfma_f32_16x16x32_bf16 v[236:239], a[136:139], a[108:111], v[236:239]
  ds_read_b64_tr_b16 a[192:193], v246 offset:28672
  v_mul_f32 v218, v106, v218
  v_rcp_f32 v29, v29
  v_mfma_f32_16x16x32_bf16 v[236:239], a[140:143], a[124:127], v[236:239]
  ds_read_b64_tr_b16 a[194:195], v246 offset:32768
  v_mul_f32 v219, v107, v219
  v_mul_f32 v216, v216, v22
  v_mul_f32 v217, v217, v23
  v_mfma_f32_16x16x32_bf16 v[232:235], a[140:143], a[120:123], v[232:235]
  ds_read_b64_tr_b16 a[196:197], v246 offset:36864
  v_mul_f32 v218, v218, v24
  v_mul_f32 v219, v219, v25
  v_mul_f32 v220, v108, v220
  v_mfma_f32_16x16x32_bf16 v[232:235], a[136:139], a[104:107], v[232:235]
  ds_read_b64_tr_b16 a[198:199], v246 offset:40960
  v_mul_f32 v221, v109, v221
  v_mul_f32 v222, v110, v222
  v_mul_f32 v223, v111, v223
  v_mfma_f32_16x16x32_bf16 v[228:231], a[136:139], a[100:103], v[228:231]
  ds_read_b64_tr_b16 a[200:201], v247 offset:28672
  v_cvt_pk_bf16_f32 v104, v216, v217
  v_cvt_pk_bf16_f32 v105, v218, v219
  v_mul_f32 v220, v220, v26
  v_mfma_f32_16x16x32_bf16 v[228:231], a[140:143], a[116:119], v[228:231]
  ds_read_b64_tr_b16 a[202:203], v247 offset:32768
  v_mul_f32 v221, v221, v27
  v_mul_f32 v222, v222, v28
  v_mul_f32 v223, v223, v29
  v_mfma_f32_16x16x32_bf16 v[224:227], a[140:143], a[112:115], v[224:227]
  ds_read_b64_tr_b16 a[204:205], v247 offset:36864
  v_cvt_pk_bf16_f32 v108, v220, v221
  v_cvt_pk_bf16_f32 v109, v222, v223
  v_mul_f32 v22, v10, v112
  v_mfma_f32_16x16x32_bf16 v[224:227], a[136:139], a[96:99], v[224:227]
  s_waitcnt vmcnt(29) lgkmcnt(11)
  ds_read_b64_tr_b16 a[206:207], v247 offset:40960
  v_mul_f32 v23, v10, v113
  v_mul_f32 v24, v10, v114
  v_mul_f32 v25, v10, v115
  v_mfma_f32_16x16x32_bf16 v[32:35], a[176:179], a[216:219], 0
  s_cmp_eq_u32 s87, 0
  s_cselect_b32 s74, 14, 0
  s_lshl_b32 s50, s74, 16
  s_add_u32 s50, s50, s88
  s_add_u32 m0, s70, 12288
  v_mfma_f32_16x16x32_bf16 v[32:35], a[180:183], a[224:227], v[32:35]
  ds_read_b64_tr_b16 a[208:209], v244 offset:30720
  ds_read_b64_tr_b16 a[210:211], v244 offset:34816
  v_exp_f32 v22, v22
  v_mfma_f32_16x16x32_bf16 v[36:39], a[180:183], a[228:231], 0
  ds_read_b64_tr_b16 a[212:213], v244 offset:38912
  v_mul_f32 v26, v13, v116
  v_exp_f32 v23, v23
  v_mfma_f32_16x16x32_bf16 v[36:39], a[176:179], a[220:223], v[36:39]
  s_waitcnt lgkmcnt(11)
  ds_read_b64_tr_b16 a[214:215], v244 offset:43008
  v_mul_f32 v27, v13, v117
  v_exp_f32 v24, v24
  v_mfma_f32_16x16x32_bf16 v[44:47], a[184:187], a[220:223], 0
  s_waitcnt vmcnt(11)
  v_cmp_ne_u32 vcc, s3, v139
  s_nop 4
  s_cbranch_vccnz CK9s
CK9x:
  v_mfma_f32_16x16x32_bf16 v[44:47], a[188:191], a[228:231], v[44:47]
  s_add_u32 s91, s91, 32768
  buffer_load_dwordx4 v133, s[24:27], s50 offen offset:0 lds
  s_lshl_b32 s51, s74, 11
  ds_read_b64_tr_b16 a[176:177], v245 offset:30720
  v_mul_f32 v28, v13, v118
  v_mfma_f32_16x16x32_bf16 v[40:43], a[188:191], a[224:227], 0
  ds_read_b64_tr_b16 a[178:179], v245 offset:34816
  ds_read_b64_tr_b16 a[180:181], v245 offset:38912
  v_exp_f32 v25, v25
  v_mfma_f32_16x16x32_bf16 v[40:43], a[184:187], a[216:219], v[40:43]
  s_waitcnt lgkmcnt(11)
  buffer_load_dwordx4 a[48:51], v137, s[36:39], s51 offen offset:0 sc1
  ds_read_b64_tr_b16 a[182:183], v245 offset:43008
  v_mul_f32 v29, v13, v119
  v_mfma_f32_16x16x32_bf16 v[48:51], a[192:195], a[216:219], 0
  ds_read_b64_tr_b16 a[184:185], v246 offset:30720
  v_exp_f32 v26, v26
  v_fma_f32 v22, v22, v11, v11
  v_mfma_f32_16x16x32_bf16 v[48:51], a[196:199], a[224:227], v[48:51]
  ds_read_b64_tr_b16 a[186:187], v246 offset:34816
  v_exp_f32 v27, v27
  v_fma_f32 v23, v23, v11, v11
  v_mfma_f32_16x16x32_bf16 v[52:55], a[196:199], a[228:231], 0
  ds_read_b64_tr_b16 a[188:189], v246 offset:38912
  v_exp_f32 v28, v28
  v_fma_f32 v24, v24, v11, v11
  v_mfma_f32_16x16x32_bf16 v[52:55], a[192:195], a[220:223], v[52:55]
  s_waitcnt lgkmcnt(11)
  buffer_load_dwordx4 v134, s[24:27], s50 offen offset:1024 lds
  ds_read_b64_tr_b16 a[190:191], v246 offset:43008
  v_exp_f32 v29, v29
  v_mfma_f32_16x16x32_bf16 v[60:63], a[200:203], a[220:223], 0
  ds_read_b64_tr_b16 a[192:193], v247 offset:30720
  v_fma_f32 v25, v25, v11, v11
  v_rcp_f32 v22, v22
  v_mfma_f32_16x16x32_bf16 v[60:63], a[204:207], a[228:231], v[60:63]
  ds_read_b64_tr_b16 a[194:195], v247 offset:34816
  v_fma_f32 v26, v26, v14, v14
  v_rcp_f32 v23, v23
  v_mfma_f32_16x16x32_bf16 v[56:59], a[204:207], a[224:227], 0
  ds_read_b64_tr_b16 a[196:197], v247 offset:38912
  v_fma_f32 v27, v27, v14, v14
  v_rcp_f32 v24, v24
  v_mfma_f32_16x16x32_bf16 v[56:59], a[200:203], a[216:219], v[56:59]
  s_waitcnt lgkmcnt(11)
  buffer_load_dwordx4 a[52:55], v137, s[36:39], s51 offen offset:1024 sc1
  ds_read_b64_tr_b16 a[198:199], v247 offset:43008
  v_fma_f32 v28, v28, v14, v14
  v_mfma_f32_16x16x32_bf16 v[144:147], a[208:211], a[216:219], 0
  ds_read_b64_tr_b16 a[200:201], v244 offset:45056
  v_rcp_f32 v25, v25
  v_fma_f32 v29, v29, v14, v14
  v_mfma_f32_16x16x32_bf16 v[144:147], a[212:215], a[224:227], v[144:147]
  ds_read_b64_tr_b16 a[202:203], v244 offset:49152
  v_rcp_f32 v26, v26
  v_mul_f32 v224, v112, v224
  v_mfma_f32_16x16x32_bf16 v[148:151], a[212:215], a[228:231], 0
  ds_read_b64_tr_b16 a[204:205], v244 offset:53248
  v_rcp_f32 v27, v27
  v_mul_f32 v225, v113, v225
  v_mfma_f32_16x16x32_bf16 v[148:151], a[208:211], a[220:223], v[148:151]
  s_waitcnt lgkmcnt(11)
  buffer_load_dwordx4 v135, s[24:27], s50 offen offset:2048 lds
  s_add_u32 s51, s51, 6144
  ds_read_b64_tr_b16 a[206:207], v244 offset:57344
  v_mfma_f32_16x16x32_bf16 v[156:159], a[176:179], a[220:223], 0
  ds_read_b64_tr_b16 a[208:209], v245 offset:45056
  v_rcp_f32 v28, v28
  v_mul_f32 v226, v114, v226
  v_mfma_f32_16x16x32_bf16 v[156:159], a[180:183], a[228:231], v[156:159]
  ds_read_b64_tr_b16 a[210:211], v245 offset:49152
  v_rcp_f32 v29, v29
  v_mul_f32 v227, v115, v227
  v_mfma_f32_16x16x32_bf16 v[152:155], a[180:183], a[224:227], 0
  ds_read_b64_tr_b16 a[212:213], v245 offset:53248
  v_mul_f32 v224, v224, v22
  v_mul_f32 v225, v225, v23
  v_mul_f32 v226, v226, v24
  v_mfma_f32_16x16x32_bf16 v[152:155], a[176:179], a[216:219], v[152:155]
  s_waitcnt lgkmcnt(11)
  buffer_load_dwordx4 a[56:59], v137, s[36:39], s51 offen offset:2048 sc1
  ds_read_b64_tr_b16 a[214:215], v245 offset:57344
  v_mul_f32 v227, v227, v25
  v_mul_f32 v22, v16, v120
  v_mfma_f32_16x16x32_bf16 v[160:163], a[184:187], a[216:219], 0
  ds_read_b64_tr_b16 a[176:177], v246 offset:45056
  v_mul_f32 v23, v16, v121
  v_mul_f32 v24, v16, v122
  v_mul_f32 v25, v16, v123
  v_mfma_f32_16x16x32_bf16 v[160:163], a[188:191], a[224:227], v[160:163]
  ds_read_b64_tr_b16 a[178:179], v246 offset:49152
  v_exp_f32 v22, v22
  v_mul_f32 v228, v116, v228
  v_mfma_f32_16x16x32_bf16 v[164:167], a[188:191], a[228:231], 0
  ds_read_b64_tr_b16 a[180:181], v246 offset:53248
  v_exp_f32 v23, v23
  v_mul_f32 v229, v117, v229
  v_mfma_f32_16x16x32_bf16 v[164:167], a[184:187], a[220:223], v[164:167]
  s_waitcnt lgkmcnt(11)
  buffer_load_dwordx4 v136, s[24:27], s50 offen offset:3072 lds
  ds_read_b64_tr_b16 a[182:183], v246 offset:57344
  v_exp_f32 v24, v24
  v_mfma_f32_16x16x32_bf16 v[172:175], a[192:195], a[220:223], 0
  ds_read_b64_tr_b16 a[184:185], v247 offset:45056
  v_mul_f32 v230, v118, v230
  v_exp_f32 v25, v25
  v_mfma_f32_16x16x32_bf16 v[172:175], a[196:199], a[228:231], v[172:175]
  ds_read_b64_tr_b16 a[186:187], v247 offset:49152
  v_mul_f32 v231, v119, v231
  v_mul_f32 v228, v228, v26
  v_mul_f32 v229, v229, v27
  v_mfma_f32_16x16x32_bf16 v[168:171], a[196:199], a[224:227], 0
  ds_read_b64_tr_b16 a[188:189], v247 offset:53248
  v_mul_f32 v230, v230, v28
  v_mul_f32 v231, v231, v29
  v_cvt_pk_bf16_f32 v98, v224, v225
  v_mfma_f32_16x16x32_bf16 v[168:171], a[192:195], a[216:219], v[168:171]
  s_waitcnt vmcnt(28) lgkmcnt(11)
  buffer_load_dwordx4 a[60:63], v137, s[36:39], s51 offen offset:3072 sc1
  s_cmp_eq_u32 s87, 1
  s_cselect_b32 s75, 21, 7
  s_lshl_b32 s50, s75, 16
  v_mfma_f32_16x16x32_bf16 v[32:35], a[200:203], v[176:179], v[32:35]
  s_add_u32 s50, s50, s88
  s_add_u32 m0, s70, 28672
  ds_read_b64_tr_b16 a[190:191], v247 offset:57344
  ds_read_b64_tr_b16 a[192:193], v244 offset:47104
  v_cvt_pk_bf16_f32 v99, v226, v227
  v_mfma_f32_16x16x32_bf16 v[32:35], a[204:207], v[184:187], v[32:35]
  ds_read_b64_tr_b16 a[194:195], v244 offset:51200
  buffer_store_dwordx4 v[96:99], v0, s[36:39], s65 offen offset:0 sc1
  v_mul_f32 v26, v19, v124
  v_mul_f32 v27, v19, v125
  v_mfma_f32_16x16x32_bf16 v[36:39], a[204:207], v[188:191], v[36:39]
  ds_read_b64_tr_b16 a[196:197], v244 offset:55296
  v_mul_f32 v28, v19, v126
  v_mul_f32 v29, v19, v127
  v_mfma_f32_16x16x32_bf16 v[36:39], a[200:203], v[180:183], v[36:39]
  s_waitcnt lgkmcnt(11)
  buffer_load_dwordx4 v133, s[24:27], s50 offen offset:0 lds
  s_lshl_b32 s51, s75, 11
  ds_read_b64_tr_b16 a[198:199], v244 offset:59392
  v_mfma_f32_16x16x32_bf16 v[44:47], a[208:211], v[180:183], v[44:47]
  ds_read_b64_tr_b16 a[200:201], v245 offset:47104
  v_exp_f32 v26, v26
  v_fma_f32 v22, v22, v17, v17
  v_mfma_f32_16x16x32_bf16 v[44:47], a[212:215], v[188:191], v[44:47]
  ds_read_b64_tr_b16 a[202:203], v245 offset:51200
  v_exp_f32 v27, v27
  v_fma_f32 v23, v23, v17, v17
  v_mfma_f32_16x16x32_bf16 v[40:43], a[212:215], v[184:187], v[40:43]
  ds_read_b64_tr_b16 a[204:205], v245 offset:55296
  v_exp_f32 v28, v28
  v_fma_f32 v24, v24, v17, v17
  v_mfma_f32_16x16x32_bf16 v[40:43], a[208:211], v[176:179], v[40:43]
  s_waitcnt lgkmcnt(11)
  buffer_load_dwordx4 a[64:67], v137, s[36:39], s51 offen offset:0 sc1
  ds_read_b64_tr_b16 a[206:207], v245 offset:59392
  v_exp_f32 v29, v29
  v_mfma_f32_16x16x32_bf16 v[48:51], a[176:179], v[176:179], v[48:51]
  ds_read_b64_tr_b16 a[208:209], v246 offset:47104
  v_fma_f32 v25, v25, v17, v17
  v_cvt_pk_bf16_f32 v102, v228, v229
  v_cvt_pk_bf16_f32 v103, v230, v231
  v_mfma_f32_16x16x32_bf16 v[48:51], a[180:183], v[184:187], v[48:51]
  ds_read_b64_tr_b16 a[210:211], v246 offset:51200
  buffer_store_dwordx4 v[100:103], v0, s[36:39], s65 offen offset:1024 sc1
  v_rcp_f32 v22, v22
  v_mfma_f32_16x16x32_bf16 v[52:55], a[180:183], v[188:191], v[52:55]
  ds_read_b64_tr_b16 a[212:213], v246 offset:55296
  v_fma_f32 v26, v26, v20, v20
  v_rcp_f32 v23, v23
  v_mfma_f32_16x16x32_bf16 v[52:55], a[176:179], v[180:183], v[52:55]
  s_waitcnt lgkmcnt(11)
  buffer_load_dwordx4 v134, s[24:27], s50 offen offset:1024 lds
  ds_read_b64_tr_b16 a[214:215], v246 offset:59392
  v_fma_f32 v27, v27, v20, v20
  v_mfma_f32_16x16x32_bf16 v[60:63], a[184:187], v[180:183], v[60:63]
  ds_read_b64_tr_b16 a[176:177], v247 offset:47104
  v_rcp_f32 v24, v24
  v_fma_f32 v28, v28, v20, v20
  v_mfma_f32_16x16x32_bf16 v[60:63], a[188:191], v[188:191], v[60:63]
  ds_read_b64_tr_b16 a[178:179], v247 offset:51200
  v_rcp_f32 v25, v25
  v_fma_f32 v29, v29, v20, v20
  v_mfma_f32_16x16x32_bf16 v[56:59], a[188:191], v[184:187], v[56:59]
  ds_read_b64_tr_b16 a[180:181], v247 offset:55296
  v_rcp_f32 v26, v26
  v_mul_f32 v232, v120, v232
  v_mfma_f32_16x16x32_bf16 v[56:59], a[184:187], v[176:179], v[56:59]
  s_waitcnt lgkmcnt(11)
  buffer_load_dwordx4 a[68:71], v137, s[36:39], s51 offen offset:1024 sc1
  ds_read_b64_tr_b16 a[182:183], v247 offset:59392
  v_rcp_f32 v27, v27
  v_mfma_f32_16x16x32_bf16 v[144:147], a[192:195], v[176:179], v[144:147]
  ds_read_b64_tr_b16 a[184:185], v244 offset:61440
  v_mul_f32 v233, v121, v233
  v_rcp_f32 v28, v28
  v_mfma_f32_16x16x32_bf16 v[144:147], a[196:199], v[184:187], v[144:147]
  ds_read_b64_tr_b16 a[186:187], v248 offset:0
  v_mul_f32 v234, v122, v234
  v_rcp_f32 v29, v29
  v_mfma_f32_16x16x32_bf16 v[148:151], a[196:199], v[188:191], v[148:151]
  ds_read_b64_tr_b16 a[188:189], v248 offset:4096
  v_mul_f32 v235, v123, v235
  v_mul_f32 v232, v232, v22
  v_mul_f32 v233, v233, v23
  v_mfma_f32_16x16x32_bf16 v[148:151], a[192:195], v[180:183], v[148:151]
  s_waitcnt lgkmcnt(11)
  buffer_load_dwordx4 v135, s[24:27], s50 offen offset:2048 lds
  s_add_u32 s51, s51, 6144
  ds_read_b64_tr_b16 a[190:191], v248 offset:8192
  v_mul_f32 v234, v234, v24
  v_mfma_f32_16x16x32_bf16 v[156:159], a[200:203], v[180:183], v[156:159]
  ds_read_b64_tr_b16 a[192:193], v245 offset:61440
  v_mul_f32 v235, v235, v25
  v_mul_f32 v236, v124, v236
  v_mul_f32 v237, v125, v237
  v_mfma_f32_16x16x32_bf16 v[156:159], a[204:207], v[188:191], v[156:159]
  ds_read_b64_tr_b16 a[194:195], v249 offset:0
  v_mul_f32 v238, v126, v238
  v_mul_f32 v239, v127, v239
  v_cvt_pk_bf16_f32 v106, v232, v233
  v_mfma_f32_16x16x32_bf16 v[152:155], a[204:207], v[184:187], v[152:155]
  ds_read_b64_tr_b16 a[196:197], v249 offset:4096
  v_cvt_pk_bf16_f32 v107, v234, v235
  v_mfma_f32_16x16x32_bf16 v[152:155], a[200:203], v[176:179], v[152:155]
  s_waitcnt lgkmcnt(11)
  buffer_load_dwordx4 a[72:75], v137, s[36:39], s51 offen offset:2048 sc1
  ds_read_b64_tr_b16 a[198:199], v249 offset:8192
  v_mfma_f32_16x16x32_bf16 v[160:163], a[208:211], v[176:179], v[160:163]
  ds_read_b64_tr_b16 a[200:201], v246 offset:61440
  v_mfma_f32_16x16x32_bf16 v[160:163], a[212:215], v[184:187], v[160:163]
  ds_read_b64_tr_b16 a[202:203], v250 offset:0
  buffer_store_dwordx4 v[104:107], v0, s[36:39], s66 offen offset:0 sc1
  v_mul_f32 v236, v236, v26
  v_mul_f32 v237, v237, v27
  v_mfma_f32_16x16x32_bf16 v[164:167], a[212:215], v[188:191], v[164:167]
  v_mul_f32 v238, v238, v28
  v_mul_f32 v239, v239, v29
  v_cvt_pk_bf16_f32 v110, v236, v237
  v_cvt_pk_bf16_f32 v111, v238, v239
  buffer_store_dwordx4 v[108:111], v0, s[36:39], s66 offen offset:1024 sc1
  v_mfma_f32_16x16x32_bf16 v[164:167], a[208:211], v[180:183], v[164:167]
  s_waitcnt lgkmcnt(10)
  ds_read_b64_tr_b16 a[204:205], v250 offset:4096
  ds_read_b64_tr_b16 a[206:207], v250 offset:8192
  v_mfma_f32_16x16x32_bf16 v[172:175], a[176:179], v[180:183], v[172:175]
  ds_read_b64_tr_b16 a[208:209], v247 offset:61440
  v_mfma_f32_16x16x32_bf16 v[172:175], a[180:183], v[188:191], v[172:175]
  buffer_load_dwordx4 v136, s[24:27], s50 offen offset:3072 lds
  ds_read_b64_tr_b16 a[210:211], v251 offset:0
  v_mfma_f32_16x16x32_bf16 v[168:171], a[180:183], v[184:187], v[168:171]
  ds_read_b64_tr_b16 a[212:213], v251 offset:4096
  v_mfma_f32_16x16x32_bf16 v[168:171], a[176:179], v[176:179], v[168:171]
  s_waitcnt vmcnt(27) lgkmcnt(11)
  ds_read_b64_tr_b16 a[214:215], v251 offset:8192
  v_mfma_f32_16x16x32_bf16 v[32:35], a[184:187], v[64:67], v[32:35]
  buffer_load_dwordx4 a[76:79], v137, s[36:39], s51 offen offset:3072 sc1
  s_cmp_eq_u32 s87, 0
  v_mfma_f32_16x16x32_bf16 v[32:35], a[188:191], v[72:75], v[32:35]
  s_cselect_b32 s79, 0, 14
  s_cmp_eq_u32 s87, 2
  s_cselect_b32 s79, 28, s79
  v_mfma_f32_16x16x32_bf16 v[36:39], a[188:191], v[76:79], v[36:39]
  s_lshl_b32 s50, s79, 16
  s_add_u32 s50, s50, s88
  s_add_u32 m0, s70, 45056
  v_mfma_f32_16x16x32_bf16 v[36:39], a[184:187], v[68:71], v[36:39]
  s_waitcnt lgkmcnt(8)
  ds_read_b64_tr_b16 a[176:177], v244 offset:63488
  ds_read_b64_tr_b16 a[178:179], v248 offset:2048
  v_mfma_f32_16x16x32_bf16 v[44:47], a[192:195], v[68:71], v[44:47]
  buffer_load_dwordx4 v133, s[24:27], s50 offen offset:0 lds
  s_lshl_b32 s51, s79, 11
  v_mfma_f32_16x16x32_bf16 v[44:47], a[196:199], v[76:79], v[44:47]
  ds_read_b64_tr_b16 a[180:181], v248 offset:6144
  ds_read_b64_tr_b16 a[182:183], v248 offset:10240
  v_mfma_f32_16x16x32_bf16 v[40:43], a[196:199], v[72:75], v[40:43]
  ds_read_b64_tr_b16 a[184:185], v245 offset:63488
  ds_read_b64_tr_b16 a[186:187], v249 offset:2048
  v_mfma_f32_16x16x32_bf16 v[40:43], a[192:195], v[64:67], v[40:43]
  s_waitcnt lgkmcnt(10)
  buffer_load_dwordx4 a[80:83], v137, s[36:39], s51 offen offset:0 sc1
  ds_read_b64_tr_b16 a[188:189], v249 offset:6144
  v_mfma_f32_16x16x32_bf16 v[48:51], a[200:203], v[64:67], v[48:51]
  ds_read_b64_tr_b16 a[190:191], v249 offset:10240
  ds_read_b64_tr_b16 a[192:193], v246 offset:63488
  v_mfma_f32_16x16x32_bf16 v[48:51], a[204:207], v[72:75], v[48:51]
  ds_read_b64_tr_b16 a[194:195], v250 offset:2048
  v_mfma_f32_16x16x32_bf16 v[52:55], a[204:207], v[76:79], v[52:55]
  buffer_load_dwordx4 v134, s[24:27], s50 offen offset:1024 lds
  ds_read_b64_tr_b16 a[196:197], v250 offset:6144
  v_mfma_f32_16x16x32_bf16 v[52:55], a[200:203], v[68:71], v[52:55]
  s_waitcnt lgkmcnt(11)
  ds_read_b64_tr_b16 a[198:199], v250 offset:10240
  v_mfma_f32_16x16x32_bf16 v[60:63], a[208:211], v[68:71], v[60:63]
  ds_read_b64_tr_b16 a[200:201], v247 offset:63488
  v_mfma_f32_16x16x32_bf16 v[60:63], a[212:215], v[76:79], v[60:63]
  ds_read_b64_tr_b16 a[202:203], v251 offset:2048
  v_mfma_f32_16x16x32_bf16 v[56:59], a[212:215], v[72:75], v[56:59]
  buffer_load_dwordx4 a[84:87], v137, s[36:39], s51 offen offset:1024 sc1
  ds_read_b64_tr_b16 a[204:205], v251 offset:6144
  v_mfma_f32_16x16x32_bf16 v[56:59], a[208:211], v[64:67], v[56:59]
  s_waitcnt lgkmcnt(11)
  ds_read_b64_tr_b16 a[206:207], v251 offset:10240
  v_mfma_f32_16x16x32_bf16 v[144:147], a[176:179], v[64:67], v[144:147]
  ds_read_b64_tr_b16 a[208:209], v248 offset:12288
  v_mfma_f32_16x16x32_bf16 v[144:147], a[180:183], v[72:75], v[144:147]
  ds_read_b64_tr_b16 a[210:211], v248 offset:16384
  v_mfma_f32_16x16x32_bf16 v[148:151], a[180:183], v[76:79], v[148:151]
  buffer_load_dwordx4 v135, s[24:27], s50 offen offset:2048 lds
  s_add_u32 s51, s51, 6144
  v_mfma_f32_16x16x32_bf16 v[148:151], a[176:179], v[68:71], v[148:151]
  s_waitcnt lgkmcnt(10)
  ds_read_b64_tr_b16 a[212:213], v248 offset:20480
  ds_read_b64_tr_b16 a[214:215], v248 offset:24576
  v_mfma_f32_16x16x32_bf16 v[156:159], a[184:187], v[68:71], v[156:159]
  ds_read_b64_tr_b16 a[176:177], v249 offset:12288
  v_mfma_f32_16x16x32_bf16 v[156:159], a[188:191], v[76:79], v[156:159]
  ds_read_b64_tr_b16 a[178:179], v249 offset:16384
  v_mfma_f32_16x16x32_bf16 v[152:155], a[188:191], v[72:75], v[152:155]
  buffer_load_dwordx4 a[88:91], v137, s[36:39], s51 offen offset:2048 sc1
  ds_read_b64_tr_b16 a[180:181], v249 offset:20480
  v_mfma_f32_16x16x32_bf16 v[152:155], a[184:187], v[64:67], v[152:155]
  s_waitcnt lgkmcnt(11)
  ds_read_b64_tr_b16 a[182:183], v249 offset:24576
  v_mfma_f32_16x16x32_bf16 v[160:163], a[192:195], v[64:67], v[160:163]
  ds_read_b64_tr_b16 a[184:185], v250 offset:12288
  v_mfma_f32_16x16x32_bf16 v[160:163], a[196:199], v[72:75], v[160:163]
  ds_read_b64_tr_b16 a[186:187], v250 offset:16384
  v_mfma_f32_16x16x32_bf16 v[164:167], a[196:199], v[76:79], v[164:167]
  buffer_load_dwordx4 v136, s[24:27], s50 offen offset:3072 lds
  ds_read_b64_tr_b16 a[188:189], v250 offset:20480
  v_mfma_f32_16x16x32_bf16 v[164:167], a[192:195], v[68:71], v[164:167]
  s_waitcnt lgkmcnt(11)
  ds_read_b64_tr_b16 a[190:191], v250 offset:24576
  v_mfma_f32_16x16x32_bf16 v[172:175], a[200:203], v[68:71], v[172:175]
  ds_read_b64_tr_b16 a[192:193], v251 offset:12288
  v_mfma_f32_16x16x32_bf16 v[172:175], a[204:207], v[76:79], v[172:175]
  ds_read_b64_tr_b16 a[194:195], v251 offset:16384
  v_mfma_f32_16x16x32_bf16 v[168:171], a[204:207], v[72:75], v[168:171]
  buffer_load_dwordx4 a[92:95], v137, s[36:39], s51 offen offset:3072 sc1
  s_cmp_eq_u32 s87, 1
  v_mfma_f32_16x16x32_bf16 v[168:171], a[200:203], v[64:67], v[168:171]
  s_waitcnt vmcnt(28) lgkmcnt(10)
  s_cselect_b32 s80, 7, 21
  s_cmp_eq_u32 s87, 3
  v_mfma_f32_16x16x32_bf16 v[32:35], a[208:211], v[80:83], v[32:35]
  s_cselect_b32 s80, 35, s80
  s_lshl_b32 s50, s80, 16
  s_add_u32 s50, s50, s88
  v_mfma_f32_16x16x32_bf16 v[32:35], a[212:215], v[88:91], v[32:35]
  s_add_u32 m0, s70, 61440
  ds_read_b64_tr_b16 a[196:197], v251 offset:20480
  ds_read_b64_tr_b16 a[198:199], v251 offset:24576
  v_mfma_f32_16x16x32_bf16 v[36:39], a[212:215], v[92:95], v[36:39]
  ds_read_b64_tr_b16 a[200:201], v248 offset:14336
  ds_read_b64_tr_b16 a[202:203], v248 offset:18432
  v_mfma_f32_16x16x32_bf16 v[36:39], a[208:211], v[84:87], v[36:39]
  s_waitcnt lgkmcnt(10)
  buffer_load_dwordx4 v133, s[24:27], s50 offen offset:0 lds
  s_lshl_b32 s51, s80, 11
  v_mfma_f32_16x16x32_bf16 v[44:47], a[176:179], v[84:87], v[44:47]
  ds_read_b64_tr_b16 a[204:205], v248 offset:22528
  ds_read_b64_tr_b16 a[206:207], v248 offset:26624
  v_mfma_f32_16x16x32_bf16 v[44:47], a[180:183], v[92:95], v[44:47]
  ds_read_b64_tr_b16 a[208:209], v249 offset:14336
  ds_read_b64_tr_b16 a[210:211], v249 offset:18432
  v_mfma_f32_16x16x32_bf16 v[40:43], a[180:183], v[88:91], v[40:43]
  s_waitcnt vmcnt(11)
  buffer_load_dwordx4 a[96:99], v137, s[36:39], s51 offen offset:0 sc1
  ds_read_b64_tr_b16 a[212:213], v249 offset:22528
  v_mfma_f32_16x16x32_bf16 v[40:43], a[176:179], v[80:83], v[40:43]
  s_waitcnt vmcnt(23) lgkmcnt(11)
  s_barrier
  ds_read_b64_tr_b16 a[214:215], v249 offset:26624
  v_mfma_f32_16x16x32_bf16 v[48:51], a[184:187], v[80:83], v[48:51]
  s_mov_b64 exec, 1
  buffer_store_dword v9, v0, s[36:39], s45 offen sc1
  s_mov_b64 exec, -1
  v_mfma_f32_16x16x32_bf16 v[48:51], a[188:191], v[88:91], v[48:51]
  s_add_u32 s45, s45, 32768
  ds_read_b64_tr_b16 a[176:177], v250 offset:14336
Hb0:
  s_cbranch_execz Hb0_1
  ds_read_b64_tr_b16 a[178:179], v250 offset:18432
  v_mfma_f32_16x16x32_bf16 v[52:55], a[188:191], v[92:95], v[52:55]
  buffer_load_dwordx4 v134, s[24:27], s50 offen offset:1024 lds
  ds_read_b64_tr_b16 a[180:181], v250 offset:22528
  v_mfma_f32_16x16x32_bf16 v[52:55], a[184:187], v[84:87], v[52:55]
  s_waitcnt lgkmcnt(11)
  ds_read_b64_tr_b16 a[182:183], v250 offset:26624
  v_mfma_f32_16x16x32_bf16 v[60:63], a[192:195], v[84:87], v[60:63]
  ds_read_b64_tr_b16 a[184:185], v251 offset:14336
  v_mfma_f32_16x16x32_bf16 v[60:63], a[196:199], v[92:95], v[60:63]
  ds_read_b64_tr_b16 a[186:187], v251 offset:18432
  v_mfma_f32_16x16x32_bf16 v[56:59], a[196:199], v[88:91], v[56:59]
  buffer_load_dwordx4 a[100:103], v137, s[36:39], s51 offen offset:1024 sc1
  ds_read_b64_tr_b16 a[188:189], v251 offset:22528
  v_mfma_f32_16x16x32_bf16 v[56:59], a[192:195], v[80:83], v[56:59]
  s_waitcnt lgkmcnt(11)
  ds_read_b64_tr_b16 a[190:191], v251 offset:26624
  v_mfma_f32_16x16x32_bf16 v[144:147], a[200:203], v[80:83], v[144:147]
  ds_read_b64_tr_b16 a[192:193], v240 offset:12288
  v_mfma_f32_16x16x32_bf16 v[144:147], a[204:207], v[88:91], v[144:147]
  ds_read_b64_tr_b16 a[194:195], v240 offset:16384
  v_mfma_f32_16x16x32_bf16 v[148:151], a[204:207], v[92:95], v[148:151]
  buffer_load_dwordx4 v135, s[24:27], s50 offen offset:2048 lds
  s_add_u32 s51, s51, 6144
  v_mfma_f32_16x16x32_bf16 v[148:151], a[200:203], v[84:87], v[148:151]
  s_waitcnt lgkmcnt(10)
  ds_read_b64_tr_b16 a[196:197], v240 offset:20480
  ds_read_b64_tr_b16 a[198:199], v240 offset:24576
  v_mfma_f32_16x16x32_bf16 v[156:159], a[208:211], v[84:87], v[156:159]
  ds_read_b64_tr_b16 a[200:201], v241 offset:12288
  v_mfma_f32_16x16x32_bf16 v[156:159], a[212:215], v[92:95], v[156:159]
  ds_read_b64_tr_b16 a[202:203], v241 offset:16384
  v_mfma_f32_16x16x32_bf16 v[152:155], a[212:215], v[88:91], v[152:155]
  buffer_load_dwordx4 a[104:107], v137, s[36:39], s51 offen offset:2048 sc1
  ds_read_b64_tr_b16 a[204:205], v241 offset:20480
  v_mfma_f32_16x16x32_bf16 v[152:155], a[208:211], v[80:83], v[152:155]
  s_waitcnt lgkmcnt(11)
  ds_read_b64_tr_b16 a[206:207], v241 offset:24576
  v_mfma_f32_16x16x32_bf16 v[160:163], a[176:179], v[80:83], v[160:163]
  ds_read_b64_tr_b16 a[208:209], v242 offset:12288
  v_mfma_f32_16x16x32_bf16 v[160:163], a[180:183], v[88:91], v[160:163]
  buffer_load_dwordx4 v136, s[24:27], s50 offen offset:3072 lds
  ds_read_b64_tr_b16 a[210:211], v242 offset:16384
  v_mfma_f32_16x16x32_bf16 v[164:167], a[180:183], v[92:95], v[164:167]
  ds_read_b64_tr_b16 a[212:213], v242 offset:20480
  v_mfma_f32_16x16x32_bf16 v[164:167], a[176:179], v[84:87], v[164:167]
  s_waitcnt lgkmcnt(11)
  ds_read_b64_tr_b16 a[214:215], v242 offset:24576
  v_mfma_f32_16x16x32_bf16 v[172:175], a[184:187], v[84:87], v[172:175]
  ds_read_b64_tr_b16 a[176:177], v243 offset:12288
  v_mfma_f32_16x16x32_bf16 v[172:175], a[188:191], v[92:95], v[172:175]
  buffer_load_dwordx4 a[108:111], v137, s[36:39], s51 offen offset:3072 sc1
  s_cmp_eq_u32 s87, 0
  v_mfma_f32_16x16x32_bf16 v[168:171], a[188:191], v[88:91], v[168:171]
  s_cselect_b32 s81, 42, 28
  s_cmp_eq_u32 s87, 2
  s_cselect_b32 s81, 14, s81
  v_mfma_f32_16x16x32_bf16 v[168:171], a[184:187], v[80:83], v[168:171]
  s_waitcnt vmcnt(29) lgkmcnt(9)
  s_lshl_b32 s50, s81, 16
  s_add_u32 s50, s50, s88
  v_mfma_f32_16x16x32_bf16 v[32:35], a[192:195], a[48:51], v[32:35]
  s_add_u32 m0, s70, 77824
  ds_read_b64_tr_b16 a[178:179], v243 offset:16384
  ds_read_b64_tr_b16 a[180:181], v243 offset:20480
  v_mfma_f32_16x16x32_bf16 v[32:35], a[196:199], a[56:59], v[32:35]
  ds_read_b64_tr_b16 a[182:183], v243 offset:24576
  ds_read_b64_tr_b16 a[184:185], v240 offset:14336
  v_mfma_f32_16x16x32_bf16 v[36:39], a[196:199], a[60:63], v[36:39]
  buffer_load_dwordx4 v133, s[24:27], s50 offen offset:0 lds
  s_lshl_b32 s51, s81, 11
  v_mfma_f32_16x16x32_bf16 v[36:39], a[192:195], a[52:55], v[36:39]
  s_waitcnt lgkmcnt(9)
  ds_read_b64_tr_b16 a[186:187], v240 offset:18432
  ds_read_b64_tr_b16 a[188:189], v240 offset:22528
  v_mfma_f32_16x16x32_bf16 v[44:47], a[200:203], a[52:55], v[44:47]
  ds_read_b64_tr_b16 a[190:191], v240 offset:26624
  ds_read_b64_tr_b16 a[192:193], v241 offset:14336
  v_mfma_f32_16x16x32_bf16 v[44:47], a[204:207], a[60:63], v[44:47]
  buffer_load_dwordx4 a[112:115], v137, s[36:39], s51 offen offset:0 sc1
  ds_read_b64_tr_b16 a[194:195], v241 offset:18432
  v_mfma_f32_16x16x32_bf16 v[40:43], a[204:207], a[56:59], v[40:43]
  ds_read_b64_tr_b16 a[196:197], v241 offset:22528
  v_mfma_f32_16x16x32_bf16 v[40:43], a[200:203], a[48:51], v[40:43]
  s_waitcnt vmcnt(20) lgkmcnt(11)
  s_barrier
  ds_read_b64_tr_b16 a[198:199], v241 offset:26624
  v_mfma_f32_16x16x32_bf16 v[48:51], a[208:211], a[48:51], v[48:51]
  ds_read_b64_tr_b16 a[200:201], v242 offset:14336
  v_mfma_f32_16x16x32_bf16 v[48:51], a[212:215], a[56:59], v[48:51]
  buffer_load_dwordx4 v134, s[24:27], s50 offen offset:1024 lds
  ds_read_b64_tr_b16 a[202:203], v242 offset:18432
  v_mfma_f32_16x16x32_bf16 v[52:55], a[212:215], a[60:63], v[52:55]
  ds_read_b64_tr_b16 a[204:205], v242 offset:22528
  v_mfma_f32_16x16x32_bf16 v[52:55], a[208:211], a[52:55], v[52:55]
  s_waitcnt lgkmcnt(11)
  ds_read_b64_tr_b16 a[206:207], v242 offset:26624
  v_mfma_f32_16x16x32_bf16 v[60:63], a[176:179], a[52:55], v[60:63]
  ds_read_b64_tr_b16 a[208:209], v243 offset:14336
  v_mfma_f32_16x16x32_bf16 v[60:63], a[180:183], a[60:63], v[60:63]
  buffer_load_dwordx4 a[116:119], v137, s[36:39], s51 offen offset:1024 sc1
  ds_read_b64_tr_b16 a[210:211], v243 offset:18432
  v_mfma_f32_16x16x32_bf16 v[56:59], a[180:183], a[56:59], v[56:59]
  ds_read_b64_tr_b16 a[212:213], v243 offset:22528
  v_mfma_f32_16x16x32_bf16 v[56:59], a[176:179], a[48:51], v[56:59]
  s_waitcnt lgkmcnt(11)
  ds_read_b64_tr_b16 a[214:215], v243 offset:26624
  v_mfma_f32_16x16x32_bf16 v[144:147], a[184:187], a[48:51], v[144:147]
  ds_read_b64_tr_b16 a[176:177], v240 offset:28672
  v_mfma_f32_16x16x32_bf16 v[144:147], a[188:191], a[56:59], v[144:147]
  buffer_load_dwordx4 v135, s[24:27], s50 offen offset:2048 lds
  s_add_u32 s51, s51, 6144
  v_mfma_f32_16x16x32_bf16 v[148:151], a[188:191], a[60:63], v[148:151]
  ds_read_b64_tr_b16 a[178:179], v240 offset:32768
  ds_read_b64_tr_b16 a[180:181], v240 offset:36864
  v_mfma_f32_16x16x32_bf16 v[148:151], a[184:187], a[52:55], v[148:151]
  s_waitcnt lgkmcnt(11)
  ds_read_b64_tr_b16 a[182:183], v240 offset:40960
  v_mfma_f32_16x16x32_bf16 v[156:159], a[192:195], a[52:55], v[156:159]
  ds_read_b64_tr_b16 a[184:185], v241 offset:28672
  v_mfma_f32_16x16x32_bf16 v[156:159], a[196:199], a[60:63], v[156:159]
  buffer_load_dwordx4 a[120:123], v137, s[36:39], s51 offen offset:2048 sc1
  ds_read_b64_tr_b16 a[186:187], v241 offset:32768
  v_mfma_f32_16x16x32_bf16 v[152:155], a[196:199], a[56:59], v[152:155]
  s_add_u32 s76, s70, 126976
  ds_read_b64_tr_b16 a[188:189], v241 offset:36864
  v_and_b32 v129, 15, v128
  v_mfma_f32_16x16x32_bf16 v[152:155], a[192:195], a[48:51], v[152:155]
  s_waitcnt lgkmcnt(11)
  ds_read_b64_tr_b16 a[190:191], v241 offset:40960
  v_lshrrev_b32 v131, 1, v129
  v_mfma_f32_16x16x32_bf16 v[160:163], a[200:203], a[48:51], v[160:163]
  ds_read_b64_tr_b16 a[192:193], v242 offset:28672
  v_lshrrev_b32 v130, 5, v128
  v_mfma_f32_16x16x32_bf16 v[160:163], a[204:207], a[56:59], v[160:163]
  buffer_load_dwordx4 v136, s[24:27], s50 offen offset:3072 lds
  ds_read_b64_tr_b16 a[194:195], v242 offset:32768
  v_mfma_f32_16x16x32_bf16 v[164:167], a[204:207], a[60:63], v[164:167]
  ds_read_b64_tr_b16 a[196:197], v242 offset:36864
  v_xor_b32 v131, v131, v130
  v_mfma_f32_16x16x32_bf16 v[164:167], a[200:203], a[52:55], v[164:167]
  s_waitcnt lgkmcnt(11)
  ds_read_b64_tr_b16 a[198:199], v242 offset:40960
  v_lshlrev_b32 v131, 4, v131
  v_mfma_f32_16x16x32_bf16 v[172:175], a[208:211], a[52:55], v[172:175]
  ds_read_b64_tr_b16 a[200:201], v243 offset:28672
  v_lshl_add_u32 v131, v129, 7, v131
  v_mfma_f32_16x16x32_bf16 v[172:175], a[212:215], a[60:63], v[172:175]
  buffer_load_dwordx4 a[124:127], v137, s[36:39], s51 offen offset:3072 sc1
  s_cmp_eq_u32 s87, 1
  v_mfma_f32_16x16x32_bf16 v[168:171], a[212:215], a[56:59], v[168:171]
  s_cselect_b32 s86, 49, 35
  s_cmp_eq_u32 s87, 3
  s_cselect_b32 s86, 21, s86
  v_mfma_f32_16x16x32_bf16 v[168:171], a[208:211], a[48:51], v[168:171]
  s_waitcnt vmcnt(25) lgkmcnt(9)
  s_lshl_b32 s50, s86, 16
  s_add_u32 s50, s50, s88
  v_mfma_f32_16x16x32_bf16 v[32:35], a[176:179], a[64:67], v[32:35]
  s_add_u32 m0, s70, 94208
  ds_read_b64_tr_b16 a[202:203], v243 offset:32768
  ds_read_b64_tr_b16 a[204:205], v243 offset:36864
  v_mfma_f32_16x16x32_bf16 v[32:35], a[180:183], a[72:75], v[32:35]
  ds_read_b64_tr_b16 a[206:207], v243 offset:40960
  ds_read_b64_tr_b16 a[208:209], v240 offset:30720
  v_mfma_f32_16x16x32_bf16 v[36:39], a[180:183], a[76:79], v[36:39]
  buffer_load_dwordx4 v133, s[24:27], s50 offen offset:0 lds
  s_lshl_b32 s51, s86, 11
  v_mfma_f32_16x16x32_bf16 v[36:39], a[176:179], a[68:71], v[36:39]
  s_waitcnt lgkmcnt(9)
  ds_read_b64_tr_b16 a[210:211], v240 offset:34816
  ds_read_b64_tr_b16 a[212:213], v240 offset:38912
  v_mfma_f32_16x16x32_bf16 v[44:47], a[184:187], a[68:71], v[44:47]
  ds_read_b64_tr_b16 a[214:215], v240 offset:43008
  ds_read_b64_tr_b16 a[176:177], v241 offset:30720
  v_mfma_f32_16x16x32_bf16 v[44:47], a[188:191], a[76:79], v[44:47]
  buffer_load_dwordx4 a[128:131], v137, s[36:39], s51 offen offset:0 sc1
  ds_read_b64_tr_b16 a[178:179], v241 offset:34816
  v_mfma_f32_16x16x32_bf16 v[40:43], a[188:191], a[72:75], v[40:43]
  ds_read_b64_tr_b16 a[180:181], v241 offset:38912
  v_bfe_u32 v130, v128, 4, 1
  v_mfma_f32_16x16x32_bf16 v[40:43], a[184:187], a[64:67], v[40:43]
  s_waitcnt vmcnt(20) lgkmcnt(11)
  s_barrier
  ds_read_b64_tr_b16 a[182:183], v241 offset:43008
  v_mfma_f32_16x16x32_bf16 v[48:51], a[192:195], a[64:67], v[48:51]
  ds_read_b64_tr_b16 a[184:185], v242 offset:30720
  v_lshl_add_u32 v131, v130, 3, v131
  v_mfma_f32_16x16x32_bf16 v[48:51], a[196:199], a[72:75], v[48:51]
  buffer_load_dwordx4 v134, s[24:27], s50 offen offset:1024 lds
  ds_read_b64_tr_b16 a[186:187], v242 offset:34816
  v_mfma_f32_16x16x32_bf16 v[52:55], a[196:199], a[76:79], v[52:55]
  ds_read_b64_tr_b16 a[188:189], v242 offset:38912
  v_add_u32 v140, s76, v131
  v_mfma_f32_16x16x32_bf16 v[52:55], a[192:195], a[68:71], v[52:55]
  s_waitcnt lgkmcnt(11)
  ds_read_b64_tr_b16 a[190:191], v242 offset:43008
  v_xor_b32 v141, 32, v140
  v_mfma_f32_16x16x32_bf16 v[60:63], a[200:203], a[68:71], v[60:63]
  ds_read_b64_tr_b16 a[192:193], v243 offset:30720
  v_xor_b32 v142, 64, v140
  v_mfma_f32_16x16x32_bf16 v[60:63], a[204:207], a[76:79], v[60:63]
  buffer_load_dwordx4 a[132:135], v137, s[36:39], s51 offen offset:1024 sc1
  ds_read_b64_tr_b16 a[194:195], v243 offset:34816
  v_mfma_f32_16x16x32_bf16 v[56:59], a[204:207], a[72:75], v[56:59]
  ds_read_b64_tr_b16 a[196:197], v243 offset:38912
  v_xor_b32 v143, 96, v140
  v_mfma_f32_16x16x32_bf16 v[56:59], a[200:203], a[64:67], v[56:59]
  s_waitcnt lgkmcnt(11)
  ds_read_b64_tr_b16 a[198:199], v243 offset:43008
  v_add_u32 v254, s76, v0
  v_mfma_f32_16x16x32_bf16 v[144:147], a[208:211], a[64:67], v[144:147]
  s_lshl_b32 s76, s44, 10
  buffer_load_dwordx4 v135, s[24:27], s50 offen offset:2048 lds
  s_add_u32 s51, s51, 6144
  v_mfma_f32_16x16x32_bf16 v[144:147], a[212:215], a[72:75], v[144:147]
  s_add_u32 s76, s76, 0
  ds_read_b64_tr_b16 a[200:201], v240 offset:45056
  ds_read_b64_tr_b16 a[202:203], v240 offset:49152
  v_mfma_f32_16x16x32_bf16 v[148:151], a[212:215], a[76:79], v[148:151]
  ds_read_b64_tr_b16 a[204:205], v240 offset:53248
  v_add_u32 v129, s76, v0
  v_mfma_f32_16x16x32_bf16 v[148:151], a[208:211], a[68:71], v[148:151]
  s_waitcnt lgkmcnt(11)
  ds_read_b64_tr_b16 a[206:207], v240 offset:57344
  v_lshrrev_b32 v130, 4, v128
  v_mfma_f32_16x16x32_bf16 v[156:159], a[176:179], a[68:71], v[156:159]
  buffer_load_dwordx4 a[136:139], v137, s[36:39], s51 offen offset:2048 sc1
  ds_read_b64_tr_b16 a[208:209], v241 offset:45056
  v_mfma_f32_16x16x32_bf16 v[156:159], a[180:183], a[76:79], v[156:159]
  ds_read_b64_tr_b16 a[210:211], v241 offset:49152
  v_lshl_add_u32 v130, v130, 4, s76
  v_mfma_f32_16x16x32_bf16 v[152:155], a[180:183], a[72:75], v[152:155]
  ds_read_b64_tr_b16 a[212:213], v241 offset:53248
  ds_write_b128 v129, a[248:251]
  v_mfma_f32_16x16x32_bf16 v[152:155], a[176:179], a[64:67], v[152:155]
  s_waitcnt lgkmcnt(12)
  ds_read_b64_tr_b16 a[214:215], v241 offset:57344
  ds_read_b128 v[176:179], v130 offset:768
  v_mfma_f32_16x16x32_bf16 v[160:163], a[184:187], a[64:67], v[160:163]
  buffer_load_dwordx4 v136, s[24:27], s50 offen offset:3072 lds
  ds_read_b64_tr_b16 a[176:177], v242 offset:45056
  v_mfma_f32_16x16x32_bf16 v[160:163], a[188:191], a[72:75], v[160:163]
  ds_read_b64_tr_b16 a[178:179], v242 offset:49152
  ds_read_b128 v[180:183], v130 offset:832
  v_mfma_f32_16x16x32_bf16 v[164:167], a[188:191], a[76:79], v[164:167]
  ds_read_b64_tr_b16 a[180:181], v242 offset:53248
  ds_read_b128 v[184:187], v130 offset:896
  v_mfma_f32_16x16x32_bf16 v[164:167], a[184:187], a[68:71], v[164:167]
  s_waitcnt lgkmcnt(15)
  ds_read_b64_tr_b16 a[182:183], v242 offset:57344
  ds_read_b128 v[188:191], v130 offset:960
  v_mfma_f32_16x16x32_bf16 v[172:175], a[192:195], a[68:71], v[172:175]
  buffer_load_dwordx4 a[140:143], v137, s[36:39], s51 offen offset:3072 sc1
  s_cmp_eq_u32 s87, 0
  v_mfma_f32_16x16x32_bf16 v[172:175], a[196:199], a[76:79], v[172:175]
  s_cselect_b32 s69, 28, 42
  s_lshl_b32 s50, s69, 16
  s_add_u32 s50, s50, s88
  v_mfma_f32_16x16x32_bf16 v[168:171], a[196:199], a[72:75], v[168:171]
  s_add_u32 m0, s70, 110592
  ds_read_b64_tr_b16 a[184:185], v243 offset:45056
  ds_read_b64_tr_b16 a[186:187], v243 offset:49152
  v_mfma_f32_16x16x32_bf16 v[168:171], a[192:195], a[64:67], v[168:171]
  s_waitcnt vmcnt(25) lgkmcnt(15)
  ds_read_b64_tr_b16 a[188:189], v243 offset:53248
  ds_read_b64_tr_b16 a[190:191], v243 offset:57344
  v_mfma_f32_16x16x32_bf16 v[32:35], a[200:203], a[80:83], v[32:35]
  buffer_load_dwordx4 v133, s[24:27], s50 offen offset:0 lds
  s_lshl_b32 s51, s69, 11
  v_mfma_f32_16x16x32_bf16 v[32:35], a[204:207], a[88:91], v[32:35]
  ds_read_b64_tr_b16 a[192:193], v240 offset:47104
  ds_read_b64_tr_b16 a[194:195], v240 offset:51200
  v_mfma_f32_16x16x32_bf16 v[36:39], a[204:207], a[92:95], v[36:39]
  ds_read_b64_tr_b16 a[196:197], v240 offset:55296
  v_accvgpr_read_b32 v131, a232
  v_mfma_f32_16x16x32_bf16 v[36:39], a[200:203], a[84:87], v[36:39]
  s_waitcnt lgkmcnt(15)
  ds_read_b64_tr_b16 a[198:199], v240 offset:59392
  v_lshlrev_b32 v64, 16, v131
  v_mfma_f32_16x16x32_bf16 v[44:47], a[208:211], a[84:87], v[44:47]
  buffer_load_dwordx4 a[216:219], v137, s[36:39], s51 offen offset:0 sc1
  ds_read_b64_tr_b16 a[200:201], v241 offset:47104
  v_mfma_f32_16x16x32_bf16 v[44:47], a[212:215], a[92:95], v[44:47]
  ds_read_b64_tr_b16 a[202:203], v241 offset:51200
  v_and_b32 v65, 0xffff0000, v131
  v_mfma_f32_16x16x32_bf16 v[40:43], a[212:215], a[88:91], v[40:43]
  ds_read_b64_tr_b16 a[204:205], v241 offset:55296
  v_accvgpr_read_b32 v131, a233
  v_mfma_f32_16x16x32_bf16 v[40:43], a[208:211], a[80:83], v[40:43]
  s_waitcnt vmcnt(19) lgkmcnt(12)
  s_barrier
  ds_read_b64_tr_b16 a[206:207], v241 offset:59392
  v_mfma_f32_16x16x32_bf16 v[48:51], a[176:179], a[80:83], v[48:51]
  buffer_load_dwordx4 v134, s[24:27], s50 offen offset:1024 lds
  ds_read_b64_tr_b16 a[208:209], v242 offset:47104
  v_mfma_f32_16x16x32_bf16 v[48:51], a[180:183], a[88:91], v[48:51]
  ds_read_b64_tr_b16 a[210:211], v242 offset:51200
  v_lshlrev_b32 v66, 16, v131
  v_mfma_f32_16x16x32_bf16 v[52:55], a[180:183], a[92:95], v[52:55]
  ds_read_b64_tr_b16 a[212:213], v242 offset:55296
  v_and_b32 v67, 0xffff0000, v131
  v_mfma_f32_16x16x32_bf16 v[52:55], a[176:179], a[84:87], v[52:55]
  s_waitcnt lgkmcnt(11)
  ds_read_b64_tr_b16 a[214:215], v242 offset:59392
  v_accvgpr_read_b32 v131, a234
  v_mfma_f32_16x16x32_bf16 v[60:63], a[184:187], a[84:87], v[60:63]
  buffer_load_dwordx4 a[220:223], v137, s[36:39], s51 offen offset:1024 sc1
  ds_read_b64_tr_b16 a[176:177], v243 offset:47104
  v_mfma_f32_16x16x32_bf16 v[60:63], a[188:191], a[92:95], v[60:63]
  ds_read_b64_tr_b16 a[178:179], v243 offset:51200
  v_lshlrev_b32 v68, 16, v131
  v_mfma_f32_16x16x32_bf16 v[56:59], a[188:191], a[88:91], v[56:59]
  ds_read_b64_tr_b16 a[180:181], v243 offset:55296
  v_and_b32 v69, 0xffff0000, v131
  v_mfma_f32_16x16x32_bf16 v[56:59], a[184:187], a[80:83], v[56:59]
  s_waitcnt lgkmcnt(11)
  buffer_load_dword v139, v138, s[36:39], s91 offen sc1
  ds_read_b64_tr_b16 a[182:183], v243 offset:59392
  v_mfma_f32_16x16x32_bf16 v[144:147], a[192:195], a[80:83], v[144:147]
  ds_read_b64_tr_b16 a[184:185], v240 offset:61440
  v_accvgpr_read_b32 v131, a235
  v_mfma_f32_16x16x32_bf16 v[144:147], a[196:199], a[88:91], v[144:147]
  ds_read_b64_tr_b16 a[186:187], v244 offset:0
  v_lshlrev_b32 v70, 16, v131
  v_mfma_f32_16x16x32_bf16 v[148:151], a[196:199], a[92:95], v[148:151]
  buffer_load_dwordx4 v135, s[24:27], s50 offen offset:2048 lds
  s_add_u32 s51, s51, 6144
  v_mfma_f32_16x16x32_bf16 v[148:151], a[192:195], a[84:87], v[148:151]
  s_waitcnt lgkmcnt(10)
  ds_read_b64_tr_b16 a[188:189], v244 offset:4096
  ds_read_b64_tr_b16 a[190:191], v244 offset:8192
  v_mfma_f32_16x16x32_bf16 v[156:159], a[200:203], a[84:87], v[156:159]
  ds_read_b64_tr_b16 a[192:193], v241 offset:61440
  v_and_b32 v71, 0xffff0000, v131
  v_mfma_f32_16x16x32_bf16 v[156:159], a[204:207], a[92:95], v[156:159]
  buffer_load_dwordx4 a[224:227], v137, s[36:39], s51 offen offset:2048 sc1
  ds_read_b64_tr_b16 a[194:195], v245 offset:0
  v_mfma_f32_16x16x32_bf16 v[152:155], a[204:207], a[88:91], v[152:155]
  ds_read_b64_tr_b16 a[196:197], v245 offset:4096
  v_accvgpr_read_b32 v131, a236
  v_mfma_f32_16x16x32_bf16 v[152:155], a[200:203], a[80:83], v[152:155]
  s_waitcnt lgkmcnt(11)
  ds_read_b64_tr_b16 a[198:199], v245 offset:8192
  v_lshlrev_b32 v72, 16, v131
  v_mfma_f32_16x16x32_bf16 v[160:163], a[208:211], a[80:83], v[160:163]
  buffer_load_dwordx4 v136, s[24:27], s50 offen offset:3072 lds
  ds_read_b64_tr_b16 a[200:201], v242 offset:61440
  v_mfma_f32_16x16x32_bf16 v[160:163], a[212:215], a[88:91], v[160:163]
  ds_read_b64_tr_b16 a[202:203], v246 offset:0
  v_and_b32 v73, 0xffff0000, v131
  v_mfma_f32_16x16x32_bf16 v[164:167], a[212:215], a[92:95], v[164:167]
  ds_read_b64_tr_b16 a[204:205], v246 offset:4096
  v_accvgpr_read_b32 v131, a237
  v_mfma_f32_16x16x32_bf16 v[164:167], a[208:211], a[84:87], v[164:167]
  s_waitcnt lgkmcnt(11)
  ds_read_b64_tr_b16 a[206:207], v246 offset:8192
  v_lshlrev_b32 v74, 16, v131
  v_mfma_f32_16x16x32_bf16 v[172:175], a[176:179], a[84:87], v[172:175]
  buffer_load_dwordx4 a[228:231], v137, s[36:39], s51 offen offset:3072 sc1
  s_cmp_eq_u32 s87, 1
  v_mfma_f32_16x16x32_bf16 v[172:175], a[180:183], a[92:95], v[172:175]
  s_cselect_b32 s71, 35, 49
  s_lshl_b32 s50, s71, 16
  s_add_u32 s50, s50, s88
  v_mfma_f32_16x16x32_bf16 v[168:171], a[180:183], a[88:91], v[168:171]
  s_add_u32 m0, s70, 126976
  ds_read_b64_tr_b16 a[208:209], v243 offset:61440
  ds_read_b64_tr_b16 a[210:211], v247 offset:0
  v_mfma_f32_16x16x32_bf16 v[168:171], a[176:179], a[80:83], v[168:171]
  s_waitcnt vmcnt(25) lgkmcnt(10)
  ds_read_b64_tr_b16 a[212:213], v247 offset:4096
  ds_read_b64_tr_b16 a[214:215], v247 offset:8192
  v_mfma_f32_16x16x32_bf16 v[32:35], a[184:187], a[96:99], v[32:35]
  buffer_load_dwordx4 v133, s[24:27], s50 offen offset:0 lds
  s_lshl_b32 s51, s71, 11
  v_mfma_f32_16x16x32_bf16 v[32:35], a[188:191], a[104:107], v[32:35]
  ds_read_b64_tr_b16 a[176:177], v240 offset:63488
  ds_read_b64_tr_b16 a[178:179], v244 offset:2048
  v_mfma_f32_16x16x32_bf16 v[36:39], a[188:191], a[108:111], v[36:39]
  ds_read_b64_tr_b16 a[180:181], v244 offset:6144
  v_and_b32 v75, 0xffff0000, v131
  v_mfma_f32_16x16x32_bf16 v[36:39], a[184:187], a[100:103], v[36:39]
  s_waitcnt lgkmcnt(11)
  ds_read_b64_tr_b16 a[182:183], v244 offset:10240
  v_accvgpr_read_b32 v131, a238
  v_mfma_f32_16x16x32_bf16 v[44:47], a[192:195], a[100:103], v[44:47]
  buffer_load_dwordx4 a[0:3], v137, s[36:39], s51 offen offset:0 sc1
  ds_read_b64_tr_b16 a[184:185], v241 offset:63488
  v_mfma_f32_16x16x32_bf16 v[44:47], a[196:199], a[108:111], v[44:47]
  ds_read_b64_tr_b16 a[186:187], v245 offset:2048
  v_lshlrev_b32 v76, 16, v131
  v_mfma_f32_16x16x32_bf16 v[40:43], a[196:199], a[104:107], v[40:43]
  ds_read_b64_tr_b16 a[188:189], v245 offset:6144
  v_and_b32 v77, 0xffff0000, v131
  v_mfma_f32_16x16x32_bf16 v[40:43], a[192:195], a[96:99], v[40:43]
  s_waitcnt vmcnt(20) lgkmcnt(11)
  s_barrier
  ds_read_b64_tr_b16 a[190:191], v245 offset:10240
  v_mfma_f32_16x16x32_bf16 v[48:51], a[200:203], a[96:99], v[48:51]
  buffer_load_dwordx4 v134, s[24:27], s50 offen offset:1024 lds
  ds_read_b64_tr_b16 a[192:193], v242 offset:63488
  v_mfma_f32_16x16x32_bf16 v[48:51], a[204:207], a[104:107], v[48:51]
  ds_read_b64_tr_b16 a[194:195], v246 offset:2048
  v_accvgpr_read_b32 v131, a239
  v_mfma_f32_16x16x32_bf16 v[52:55], a[204:207], a[108:111], v[52:55]
  ds_read_b64_tr_b16 a[196:197], v246 offset:6144
  v_lshlrev_b32 v78, 16, v131
  v_mfma_f32_16x16x32_bf16 v[52:55], a[200:203], a[100:103], v[52:55]
  s_waitcnt lgkmcnt(11)
  buffer_load_dwordx4 a[4:7], v137, s[36:39], s51 offen offset:1024 sc1
  ds_read_b64_tr_b16 a[198:199], v246 offset:10240
  v_mfma_f32_16x16x32_bf16 v[60:63], a[208:211], a[100:103], v[60:63]
  ds_read_b64_tr_b16 a[200:201], v243 offset:63488
  v_and_b32 v79, 0xffff0000, v131
  v_mfma_f32_16x16x32_bf16 v[60:63], a[212:215], a[108:111], v[60:63]
  ds_read_b64_tr_b16 a[202:203], v247 offset:2048
  v_accvgpr_read_b32 v131, a240
  v_mfma_f32_16x16x32_bf16 v[56:59], a[212:215], a[104:107], v[56:59]
  ds_read_b64_tr_b16 a[204:205], v247 offset:6144
  v_lshlrev_b32 v80, 16, v131
  v_mfma_f32_16x16x32_bf16 v[56:59], a[208:211], a[96:99], v[56:59]
  s_waitcnt lgkmcnt(11)
  buffer_load_dwordx4 v135, s[24:27], s50 offen offset:2048 lds
  s_add_u32 s51, s51, 6144
  v_mfma_f32_16x16x32_bf16 v[144:147], a[176:179], a[96:99], v[144:147]
  ds_read_b64_tr_b16 a[206:207], v247 offset:10240
  ds_read_b64_tr_b16 a[208:209], v244 offset:12288
  v_mfma_f32_16x16x32_bf16 v[144:147], a[180:183], a[104:107], v[144:147]
  ds_read_b64_tr_b16 a[210:211], v244 offset:16384
  v_and_b32 v81, 0xffff0000, v131
  v_mfma_f32_16x16x32_bf16 v[148:151], a[180:183], a[108:111], v[148:151]
  ds_read_b64_tr_b16 a[212:213], v244 offset:20480
  v_accvgpr_read_b32 v131, a241
  v_mfma_f32_16x16x32_bf16 v[148:151], a[176:179], a[100:103], v[148:151]
  s_waitcnt lgkmcnt(11)
  buffer_load_dwordx4 a[8:11], v137, s[36:39], s51 offen offset:2048 sc1
  ds_read_b64_tr_b16 a[214:215], v244 offset:24576
  v_mfma_f32_16x16x32_bf16 v[156:159], a[184:187], a[100:103], v[156:159]
  ds_read_b64_tr_b16 a[176:177], v245 offset:12288
  v_lshlrev_b32 v82, 16, v131
  v_mfma_f32_16x16x32_bf16 v[156:159], a[188:191], a[108:111], v[156:159]
  ds_read_b64_tr_b16 a[178:179], v245 offset:16384
  v_and_b32 v83, 0xffff0000, v131
  v_mfma_f32_16x16x32_bf16 v[152:155], a[188:191], a[104:107], v[152:155]
  ds_read_b64_tr_b16 a[180:181], v245 offset:20480
  v_accvgpr_read_b32 v131, a242
  v_mfma_f32_16x16x32_bf16 v[152:155], a[184:187], a[96:99], v[152:155]
  s_waitcnt lgkmcnt(11)
  buffer_load_dwordx4 v136, s[24:27], s50 offen offset:3072 lds
  ds_read_b64_tr_b16 a[182:183], v245 offset:24576
  v_mfma_f32_16x16x32_bf16 v[160:163], a[192:195], a[96:99], v[160:163]
  ds_read_b64_tr_b16 a[184:185], v246 offset:12288
  v_lshlrev_b32 v84, 16, v131
  v_mfma_f32_16x16x32_bf16 v[160:163], a[196:199], a[104:107], v[160:163]
  ds_read_b64_tr_b16 a[186:187], v246 offset:16384
  v_and_b32 v85, 0xffff0000, v131
  v_mfma_f32_16x16x32_bf16 v[164:167], a[196:199], a[108:111], v[164:167]
  ds_read_b64_tr_b16 a[188:189], v246 offset:20480
  v_accvgpr_read_b32 v131, a243
  v_mfma_f32_16x16x32_bf16 v[164:167], a[192:195], a[100:103], v[164:167]
  s_waitcnt lgkmcnt(11)
  buffer_load_dwordx4 a[12:15], v137, s[36:39], s51 offen offset:3072 sc1
  s_cmp_eq_u32 s87, 0
  v_mfma_f32_16x16x32_bf16 v[172:175], a[200:203], a[100:103], v[172:175]
  s_cselect_b32 s72, 8, 1
  s_lshl_b32 s50, s72, 16
  s_add_u32 m0, s70, 143360
  v_mfma_f32_16x16x32_bf16 v[172:175], a[204:207], a[108:111], v[172:175]
  ds_read_b64_tr_b16 a[190:191], v246 offset:24576
  ds_read_b64_tr_b16 a[192:193], v247 offset:12288
  v_mfma_f32_16x16x32_bf16 v[168:171], a[204:207], a[104:107], v[168:171]
  ds_read_b64_tr_b16 a[194:195], v247 offset:16384
  ds_read_b64_tr_b16 a[196:197], v247 offset:20480
  v_mfma_f32_16x16x32_bf16 v[168:171], a[200:203], a[96:99], v[168:171]
  s_waitcnt vmcnt(25) lgkmcnt(11)
  buffer_load_dwordx4 v133, s[24:27], s50 offen offset:0 lds
  ds_read_b64_tr_b16 a[198:199], v247 offset:24576
  v_mfma_f32_16x16x32_bf16 v[32:35], a[208:211], a[112:115], v[32:35]
  s_waitcnt vmcnt(13)
  v_cmp_ne_u32 vcc, s3, v139
  s_nop 4
  s_cbranch_vccnz CK10s
CK10x:
  v_mfma_f32_16x16x32_bf16 v[32:35], a[212:215], a[120:123], v[32:35]
  s_lshl_b32 s51, s72, 11
  s_add_u32 s91, s91, 32768
  ds_read_b64_tr_b16 a[200:201], v244 offset:14336
  v_mfma_f32_16x16x32_bf16 v[36:39], a[212:215], a[124:127], v[36:39]
  ds_read_b64_tr_b16 a[202:203], v244 offset:18432
  ds_read_b64_tr_b16 a[204:205], v244 offset:22528
  v_mfma_f32_16x16x32_bf16 v[36:39], a[208:211], a[116:119], v[36:39]
  s_waitcnt lgkmcnt(11)
  buffer_load_dwordx4 a[16:19], v137, s[36:39], s51 offen offset:0 sc1
  ds_read_b64_tr_b16 a[206:207], v244 offset:26624
  v_mfma_f32_16x16x32_bf16 v[44:47], a[176:179], a[116:119], v[44:47]
  ds_read_b64_tr_b16 a[208:209], v245 offset:14336
  v_lshlrev_b32 v86, 16, v131
  v_mfma_f32_16x16x32_bf16 v[44:47], a[180:183], a[124:127], v[44:47]
  ds_read_b64_tr_b16 a[210:211], v245 offset:18432
  v_and_b32 v87, 0xffff0000, v131
  v_mfma_f32_16x16x32_bf16 v[40:43], a[180:183], a[120:123], v[40:43]
  ds_read_b64_tr_b16 a[212:213], v245 offset:22528
  v_accvgpr_read_b32 v131, a244
  v_mfma_f32_16x16x32_bf16 v[40:43], a[176:179], a[112:115], v[40:43]
  s_waitcnt vmcnt(20) lgkmcnt(11)
  s_barrier
  buffer_load_dwordx4 v134, s[24:27], s50 offen offset:1024 lds
  v_mfma_f32_16x16x32_bf16 v[48:51], a[184:187], a[112:115], v[48:51]
  ds_read_b64_tr_b16 a[214:215], v245 offset:26624
  ds_read_b64_tr_b16 a[176:177], v246 offset:14336
  v_mfma_f32_16x16x32_bf16 v[48:51], a[188:191], a[120:123], v[48:51]
  ds_read_b64_tr_b16 a[178:179], v246 offset:18432
  v_lshlrev_b32 v88, 16, v131
  v_mfma_f32_16x16x32_bf16 v[52:55], a[188:191], a[124:127], v[52:55]
  ds_read_b64_tr_b16 a[180:181], v246 offset:22528
  v_and_b32 v89, 0xffff0000, v131
  v_mfma_f32_16x16x32_bf16 v[52:55], a[184:187], a[116:119], v[52:55]
  s_waitcnt lgkmcnt(11)
  buffer_load_dwordx4 a[20:23], v137, s[36:39], s51 offen offset:1024 sc1
  ds_read_b64_tr_b16 a[182:183], v246 offset:26624
  v_mfma_f32_16x16x32_bf16 v[60:63], a[192:195], a[116:119], v[60:63]
  ds_read_b64_tr_b16 a[184:185], v247 offset:14336
  v_accvgpr_read_b32 v131, a245
  v_mfma_f32_16x16x32_bf16 v[60:63], a[196:199], a[124:127], v[60:63]
  ds_read_b64_tr_b16 a[186:187], v247 offset:18432
  v_lshlrev_b32 v90, 16, v131
  v_mfma_f32_16x16x32_bf16 v[56:59], a[196:199], a[120:123], v[56:59]
  ds_read_b64_tr_b16 a[188:189], v247 offset:22528
  v_and_b32 v91, 0xffff0000, v131
  v_mfma_f32_16x16x32_bf16 v[56:59], a[192:195], a[112:115], v[56:59]
  s_waitcnt lgkmcnt(11)
  buffer_load_dwordx4 v135, s[24:27], s50 offen offset:2048 lds
  ds_read_b64_tr_b16 a[190:191], v247 offset:26624
  v_mfma_f32_16x16x32_bf16 v[144:147], a[200:203], a[112:115], v[144:147]
  ds_read_b64_tr_b16 a[192:193], v244 offset:28672
  v_accvgpr_read_b32 v131, a246
  v_mfma_f32_16x16x32_bf16 v[144:147], a[204:207], a[120:123], v[144:147]
  ds_read_b64_tr_b16 a[194:195], v244 offset:32768
  v_lshlrev_b32 v92, 16, v131
  v_mfma_f32_16x16x32_bf16 v[148:151], a[204:207], a[124:127], v[148:151]
  ds_read_b64_tr_b16 a[196:197], v244 offset:36864
  v_and_b32 v93, 0xffff0000, v131
  v_mfma_f32_16x16x32_bf16 v[148:151], a[200:203], a[116:119], v[148:151]
  s_waitcnt lgkmcnt(11)
  buffer_load_dwordx4 a[24:27], v137, s[36:39], s51 offen offset:2048 sc1
  ds_read_b64_tr_b16 a[198:199], v244 offset:40960
  v_mfma_f32_16x16x32_bf16 v[156:159], a[208:211], a[116:119], v[156:159]
  ds_read_b64_tr_b16 a[200:201], v245 offset:28672
  v_accvgpr_read_b32 v131, a247
  v_mfma_f32_16x16x32_bf16 v[156:159], a[212:215], a[124:127], v[156:159]
  ds_read_b64_tr_b16 a[202:203], v245 offset:32768
  v_lshlrev_b32 v94, 16, v131
  v_mfma_f32_16x16x32_bf16 v[152:155], a[212:215], a[120:123], v[152:155]
  ds_read_b64_tr_b16 a[204:205], v245 offset:36864
  v_and_b32 v95, 0xffff0000, v131
  v_mfma_f32_16x16x32_bf16 v[152:155], a[208:211], a[112:115], v[152:155]
  s_waitcnt lgkmcnt(11)
  buffer_load_dwordx4 v136, s[24:27], s50 offen offset:3072 lds
  ds_read_b64_tr_b16 a[206:207], v245 offset:40960
  v_mfma_f32_16x16x32_bf16 v[160:163], a[176:179], a[112:115], v[160:163]
  s_add_u32 s49, s55, 32768
  ds_read_b64_tr_b16 a[208:209], v246 offset:28672
  s_lshl_b32 s76, s2, 5
  v_mfma_f32_16x16x32_bf16 v[160:163], a[180:183], a[120:123], v[160:163]
  s_add_u32 s76, s76, s44
  ds_read_b64_tr_b16 a[210:211], v246 offset:32768
  s_lshl2_add_u32 s76, s76, 5472256
  v_mfma_f32_16x16x32_bf16 v[164:167], a[180:183], a[124:127], v[164:167]
Hb1:
  s_cbranch_execz Hb1_1
  s_xor_b32 s77, s76, 128
  ds_read_b64_tr_b16 a[212:213], v246 offset:36864
  v_mov_b32 v132, 0
  v_mfma_f32_16x16x32_bf16 v[164:167], a[176:179], a[116:119], v[164:167]
  s_waitcnt lgkmcnt(11)
  buffer_load_dwordx4 a[28:31], v137, s[36:39], s51 offen offset:3072 sc1
  s_cmp_eq_u32 s87, 1
  v_mfma_f32_16x16x32_bf16 v[172:175], a[184:187], a[116:119], v[172:175]
  s_cselect_b32 s73, 12, 5
  s_lshl_b32 s50, s73, 16
  s_add_u32 m0, s70, 12288
  v_mfma_f32_16x16x32_bf16 v[172:175], a[188:191], a[124:127], v[172:175]
  ds_read_b64_tr_b16 a[214:215], v246 offset:40960
  ds_read_b64_tr_b16 a[176:177], v247 offset:28672
  v_mfma_f32_16x16x32_bf16 v[168:171], a[188:191], a[120:123], v[168:171]
  ds_read_b64_tr_b16 a[178:179], v247 offset:32768
  ds_read_b64_tr_b16 a[180:181], v247 offset:36864
  v_mfma_f32_16x16x32_bf16 v[168:171], a[184:187], a[112:115], v[168:171]
  s_waitcnt vmcnt(25) lgkmcnt(11)
  buffer_load_dwordx4 v133, s[24:27], s50 offen offset:0 lds
  s_lshl_b32 s51, s73, 11
  v_mfma_f32_16x16x32_bf16 v[32:35], a[192:195], a[128:131], v[32:35]
  ds_read_b64_tr_b16 a[182:183], v247 offset:40960
  ds_read_b64_tr_b16 a[184:185], v244 offset:30720
  v_mfma_f32_16x16x32_bf16 v[32:35], a[196:199], a[136:139], v[32:35]
  ds_read_b64_tr_b16 a[186:187], v244 offset:34816
  v_mfma_f32_16x16x32_bf16 v[36:39], a[196:199], a[140:143], v[36:39]
  buffer_load_dwordx4 a[32:35], v137, s[36:39], s51 offen offset:0 sc1
  ds_read_b64_tr_b16 a[188:189], v244 offset:38912
  v_mfma_f32_16x16x32_bf16 v[36:39], a[192:195], a[132:135], v[36:39]
  s_waitcnt lgkmcnt(11)
  ds_read_b64_tr_b16 a[190:191], v244 offset:43008
  v_mfma_f32_16x16x32_bf16 v[44:47], a[200:203], a[132:135], v[44:47]
  ds_read_b64_tr_b16 a[192:193], v245 offset:30720
  v_mfma_f32_16x16x32_bf16 v[44:47], a[204:207], a[140:143], v[44:47]
  ds_read_b64_tr_b16 a[194:195], v245 offset:34816
  v_mfma_f32_16x16x32_bf16 v[40:43], a[204:207], a[136:139], v[40:43]
  buffer_load_dwordx4 v134, s[24:27], s50 offen offset:1024 lds
  ds_read_b64_tr_b16 a[196:197], v245 offset:38912
  v_mfma_f32_16x16x32_bf16 v[40:43], a[200:203], a[128:131], v[40:43]
  s_waitcnt vmcnt(20) lgkmcnt(11)
  s_barrier
  ds_read_b64_tr_b16 a[198:199], v245 offset:43008
  v_mfma_f32_16x16x32_bf16 v[48:51], a[208:211], a[128:131], v[48:51]
  ds_read_b64_tr_b16 a[200:201], v246 offset:30720
  v_mfma_f32_16x16x32_bf16 v[48:51], a[212:215], a[136:139], v[48:51]
  ds_read_b64_tr_b16 a[202:203], v246 offset:34816
  v_mfma_f32_16x16x32_bf16 v[52:55], a[212:215], a[140:143], v[52:55]
  buffer_load_dwordx4 a[36:39], v137, s[36:39], s51 offen offset:1024 sc1
  ds_read_b64_tr_b16 a[204:205], v246 offset:38912
  v_mfma_f32_16x16x32_bf16 v[52:55], a[208:211], a[132:135], v[52:55]
  s_waitcnt lgkmcnt(11)
  ds_read_b64_tr_b16 a[206:207], v246 offset:43008
  v_mfma_f32_16x16x32_bf16 v[60:63], a[176:179], a[132:135], v[60:63]
  ds_read_b64_tr_b16 a[208:209], v247 offset:30720
  v_mfma_f32_16x16x32_bf16 v[60:63], a[180:183], a[140:143], v[60:63]
  ds_read_b64_tr_b16 a[210:211], v247 offset:34816
  v_mfma_f32_16x16x32_bf16 v[56:59], a[180:183], a[136:139], v[56:59]
  buffer_load_dwordx4 v135, s[24:27], s50 offen offset:2048 lds
  ds_read_b64_tr_b16 a[212:213], v247 offset:38912
  v_mfma_f32_16x16x32_bf16 v[56:59], a[176:179], a[128:131], v[56:59]
  s_waitcnt lgkmcnt(11)
  ds_read_b64_tr_b16 a[214:215], v247 offset:43008
  v_mfma_f32_16x16x32_bf16 v[144:147], a[184:187], a[128:131], v[144:147]
  ds_read_b64_tr_b16 a[176:177], v244 offset:45056
  v_mfma_f32_16x16x32_bf16 v[144:147], a[188:191], a[136:139], v[144:147]
  ds_read_b64_tr_b16 a[178:179], v244 offset:49152
  v_mfma_f32_16x16x32_bf16 v[148:151], a[188:191], a[140:143], v[148:151]
  buffer_load_dwordx4 a[40:43], v137, s[36:39], s51 offen offset:2048 sc1
  ds_read_b64_tr_b16 a[180:181], v244 offset:53248
  v_mfma_f32_16x16x32_bf16 v[148:151], a[184:187], a[132:135], v[148:151]
  s_waitcnt lgkmcnt(11)
  ds_read_b64_tr_b16 a[182:183], v244 offset:57344
  v_mfma_f32_16x16x32_bf16 v[156:159], a[192:195], a[132:135], v[156:159]
  ds_read_b64_tr_b16 a[184:185], v245 offset:45056
  v_mfma_f32_16x16x32_bf16 v[156:159], a[196:199], a[140:143], v[156:159]
  ds_read_b64_tr_b16 a[186:187], v245 offset:49152
  v_mfma_f32_16x16x32_bf16 v[152:155], a[196:199], a[136:139], v[152:155]
  buffer_load_dwordx4 v136, s[24:27], s50 offen offset:3072 lds
  ds_read_b64_tr_b16 a[188:189], v245 offset:53248
  v_mfma_f32_16x16x32_bf16 v[152:155], a[192:195], a[128:131], v[152:155]
  s_waitcnt lgkmcnt(11)
  ds_read_b64_tr_b16 a[190:191], v245 offset:57344
  v_mfma_f32_16x16x32_bf16 v[160:163], a[200:203], a[128:131], v[160:163]
  ds_read_b64_tr_b16 a[192:193], v246 offset:45056
  v_mfma_f32_16x16x32_bf16 v[160:163], a[204:207], a[136:139], v[160:163]
  ds_read_b64_tr_b16 a[194:195], v246 offset:49152
  v_mfma_f32_16x16x32_bf16 v[164:167], a[204:207], a[140:143], v[164:167]
  buffer_load_dwordx4 a[44:47], v137, s[36:39], s51 offen offset:3072 sc1
  s_cmp_eq_u32 s87, 0
  v_mfma_f32_16x16x32_bf16 v[164:167], a[200:203], a[132:135], v[164:167]
  s_waitcnt lgkmcnt(10)
  s_cselect_b32 s74, 1, 8
  s_cmp_eq_u32 s87, 2
  v_mfma_f32_16x16x32_bf16 v[172:175], a[208:211], a[132:135], v[172:175]
  s_cselect_b32 s74, 15, s74
  s_lshl_b32 s50, s74, 16
  s_add_u32 m0, s70, 28672
  v_mfma_f32_16x16x32_bf16 v[172:175], a[212:215], a[140:143], v[172:175]
  ds_read_b64_tr_b16 a[196:197], v246 offset:53248
  ds_read_b64_tr_b16 a[198:199], v246 offset:57344
  v_mfma_f32_16x16x32_bf16 v[168:171], a[212:215], a[136:139], v[168:171]
  ds_read_b64_tr_b16 a[200:201], v247 offset:45056
  ds_read_b64_tr_b16 a[202:203], v247 offset:49152
  v_mfma_f32_16x16x32_bf16 v[168:171], a[208:211], a[128:131], v[168:171]
  s_waitcnt vmcnt(24) lgkmcnt(10)
  buffer_load_dwordx4 v133, s[24:27], s50 offen offset:0 lds
  s_lshl_b32 s51, s74, 11
  v_mfma_f32_16x16x32_bf16 v[32:35], a[176:179], a[216:219], v[32:35]
  ds_read_b64_tr_b16 a[204:205], v247 offset:53248
  ds_read_b64_tr_b16 a[206:207], v247 offset:57344
  v_mfma_f32_16x16x32_bf16 v[32:35], a[180:183], a[224:227], v[32:35]
  ds_read_b64_tr_b16 a[208:209], v244 offset:47104
  ds_read_b64_tr_b16 a[210:211], v244 offset:51200
  v_mfma_f32_16x16x32_bf16 v[36:39], a[180:183], a[228:231], v[36:39]
  buffer_load_dwordx4 a[48:51], v137, s[36:39], s51 offen offset:0 sc1
  ds_read_b64_tr_b16 a[212:213], v244 offset:55296
  v_mfma_f32_16x16x32_bf16 v[36:39], a[176:179], a[220:223], v[36:39]
  s_waitcnt lgkmcnt(11)
  ds_read_b64_tr_b16 a[214:215], v244 offset:59392
  v_mfma_f32_16x16x32_bf16 v[44:47], a[184:187], a[220:223], v[44:47]
  ds_read_b64_tr_b16 a[176:177], v245 offset:47104
  v_mfma_f32_16x16x32_bf16 v[44:47], a[188:191], a[228:231], v[44:47]
  ds_read_b64_tr_b16 a[178:179], v245 offset:51200
  v_mfma_f32_16x16x32_bf16 v[40:43], a[188:191], a[224:227], v[40:43]
  buffer_load_dwordx4 v134, s[24:27], s50 offen offset:1024 lds
  ds_read_b64_tr_b16 a[180:181], v245 offset:55296
  v_mfma_f32_16x16x32_bf16 v[40:43], a[184:187], a[216:219], v[40:43]
  s_waitcnt vmcnt(20) lgkmcnt(11)
  s_barrier
  ds_read_b64_tr_b16 a[182:183], v245 offset:59392
  v_mfma_f32_16x16x32_bf16 v[48:51], a[192:195], a[216:219], v[48:51]
  ds_read_b64_tr_b16 a[184:185], v246 offset:47104
  v_mfma_f32_16x16x32_bf16 v[48:51], a[196:199], a[224:227], v[48:51]
  ds_read_b64_tr_b16 a[186:187], v246 offset:51200
  v_mfma_f32_16x16x32_bf16 v[52:55], a[196:199], a[228:231], v[52:55]
  buffer_load_dwordx4 a[52:55], v137, s[36:39], s51 offen offset:1024 sc1
  ds_read_b64_tr_b16 a[188:189], v246 offset:55296
  v_mfma_f32_16x16x32_bf16 v[52:55], a[192:195], a[220:223], v[52:55]
  s_waitcnt lgkmcnt(11)
  ds_read_b64_tr_b16 a[190:191], v246 offset:59392
  v_mfma_f32_16x16x32_bf16 v[60:63], a[200:203], a[220:223], v[60:63]
  ds_read_b64_tr_b16 a[192:193], v247 offset:47104
  v_mfma_f32_16x16x32_bf16 v[60:63], a[204:207], a[228:231], v[60:63]
  ds_read_b64_tr_b16 a[194:195], v247 offset:51200
  v_mfma_f32_16x16x32_bf16 v[56:59], a[204:207], a[224:227], v[56:59]
  buffer_load_dwordx4 v135, s[24:27], s50 offen offset:2048 lds
  ds_read_b64_tr_b16 a[196:197], v247 offset:55296
  v_mfma_f32_16x16x32_bf16 v[56:59], a[200:203], a[216:219], v[56:59]
  s_waitcnt lgkmcnt(11)
  ds_read_b64_tr_b16 a[198:199], v247 offset:59392
  v_mfma_f32_16x16x32_bf16 v[144:147], a[208:211], a[216:219], v[144:147]
  ds_read_b64_tr_b16 a[200:201], v244 offset:61440
  v_mfma_f32_16x16x32_bf16 v[144:147], a[212:215], a[224:227], v[144:147]
  ds_read_b64_tr_b16 a[202:203], v248 offset:0
  v_mfma_f32_16x16x32_bf16 v[148:151], a[212:215], a[228:231], v[148:151]
  buffer_load_dwordx4 a[56:59], v137, s[36:39], s51 offen offset:2048 sc1
  ds_read_b64_tr_b16 a[204:205], v248 offset:4096
  v_mfma_f32_16x16x32_bf16 v[148:151], a[208:211], a[220:223], v[148:151]
  s_waitcnt lgkmcnt(11)
  ds_read_b64_tr_b16 a[206:207], v248 offset:8192
  v_mfma_f32_16x16x32_bf16 v[156:159], a[176:179], a[220:223], v[156:159]
  ds_read_b64_tr_b16 a[208:209], v245 offset:61440
  v_mfma_f32_16x16x32_bf16 v[156:159], a[180:183], a[228:231], v[156:159]
  ds_read_b64_tr_b16 a[210:211], v249 offset:0
  v_mfma_f32_16x16x32_bf16 v[152:155], a[180:183], a[224:227], v[152:155]
  buffer_load_dwordx4 v136, s[24:27], s50 offen offset:3072 lds
  ds_read_b64_tr_b16 a[212:213], v249 offset:4096
  v_mfma_f32_16x16x32_bf16 v[152:155], a[176:179], a[216:219], v[152:155]
  s_waitcnt lgkmcnt(11)
  ds_read_b64_tr_b16 a[214:215], v249 offset:8192
  v_mfma_f32_16x16x32_bf16 v[160:163], a[184:187], a[216:219], v[160:163]
  ds_read_b64_tr_b16 a[176:177], v246 offset:61440
  v_mfma_f32_16x16x32_bf16 v[160:163], a[188:191], a[224:227], v[160:163]
  ds_read_b64_tr_b16 a[178:179], v250 offset:0
  v_mfma_f32_16x16x32_bf16 v[164:167], a[188:191], a[228:231], v[164:167]
  buffer_load_dwordx4 a[60:63], v137, s[36:39], s51 offen offset:3072 sc1
  s_cmp_eq_u32 s87, 1
  v_mfma_f32_16x16x32_bf16 v[164:167], a[184:187], a[220:223], v[164:167]
  s_waitcnt lgkmcnt(10)
  s_cselect_b32 s75, 5, 12
  s_cmp_eq_u32 s87, 3
  v_mfma_f32_16x16x32_bf16 v[172:175], a[192:195], a[220:223], v[172:175]
  s_cselect_b32 s75, 19, s75
  s_lshl_b32 s50, s75, 16
  s_add_u32 m0, s70, 45056
  v_mfma_f32_16x16x32_bf16 v[172:175], a[196:199], a[228:231], v[172:175]
  ds_read_b64_tr_b16 a[180:181], v250 offset:4096
  ds_read_b64_tr_b16 a[182:183], v250 offset:8192
  v_mfma_f32_16x16x32_bf16 v[168:171], a[196:199], a[224:227], v[168:171]
  ds_read_b64_tr_b16 a[184:185], v247 offset:61440
  buffer_load_dwordx4 v133, s[24:27], s50 offen offset:0 lds
  v_mfma_f32_16x16x32_bf16 v[168:171], a[192:195], a[216:219], v[168:171]
  s_waitcnt vmcnt(25) lgkmcnt(9)
  s_lshl_b32 s51, s75, 11
  ds_read_b64_tr_b16 a[186:187], v251 offset:0
  v_mfma_f32_16x16x32_bf16 v[32:35], a[200:203], a[0:3], v[32:35]
  ds_read_b64_tr_b16 a[188:189], v251 offset:4096
  ds_read_b64_tr_b16 a[190:191], v251 offset:8192
  v_mfma_f32_16x16x32_bf16 v[32:35], a[204:207], a[8:11], v[32:35]
  ds_read_b64_tr_b16 a[192:193], v244 offset:63488
  buffer_load_dwordx4 a[64:67], v137, s[36:39], s51 offen offset:0 sc1
  v_mfma_f32_16x16x32_bf16 v[36:39], a[204:207], a[12:15], v[36:39]
  ds_read_b64_tr_b16 a[194:195], v248 offset:2048
  ds_read_b64_tr_b16 a[196:197], v248 offset:6144
  v_mfma_f32_16x16x32_bf16 v[36:39], a[200:203], a[4:7], v[36:39]
  s_waitcnt lgkmcnt(11)
  ds_read_b64_tr_b16 a[198:199], v248 offset:10240
  v_mfma_f32_16x16x32_bf16 v[44:47], a[208:211], a[4:7], v[44:47]
  ds_read_b64_tr_b16 a[200:201], v245 offset:63488
  v_mfma_f32_16x16x32_bf16 v[44:47], a[212:215], a[12:15], v[44:47]
  buffer_load_dwordx4 v134, s[24:27], s50 offen offset:1024 lds
  ds_read_b64_tr_b16 a[202:203], v249 offset:2048
  v_mfma_f32_16x16x32_bf16 v[40:43], a[212:215], a[8:11], v[40:43]
  ds_read_b64_tr_b16 a[204:205], v249 offset:6144
  v_mfma_f32_16x16x32_bf16 v[40:43], a[208:211], a[0:3], v[40:43]
  s_waitcnt vmcnt(20) lgkmcnt(11)
  s_barrier
  ds_read_b64_tr_b16 a[206:207], v249 offset:10240
  v_mfma_f32_16x16x32_bf16 v[48:51], a[176:179], a[0:3], v[48:51]
  ds_read_b64_tr_b16 a[208:209], v246 offset:63488
  v_mfma_f32_16x16x32_bf16 v[48:51], a[180:183], a[8:11], v[48:51]
  buffer_load_dwordx4 a[68:71], v137, s[36:39], s51 offen offset:1024 sc1
  ds_read_b64_tr_b16 a[210:211], v250 offset:2048
  v_mfma_f32_16x16x32_bf16 v[52:55], a[180:183], a[12:15], v[52:55]
  ds_read_b64_tr_b16 a[212:213], v250 offset:6144
  v_mfma_f32_16x16x32_bf16 v[52:55], a[176:179], a[4:7], v[52:55]
  s_waitcnt lgkmcnt(11)
  ds_read_b64_tr_b16 a[214:215], v250 offset:10240
  v_mfma_f32_16x16x32_bf16 v[60:63], a[184:187], a[4:7], v[60:63]
  ds_read_b64_tr_b16 a[176:177], v247 offset:63488
  v_mfma_f32_16x16x32_bf16 v[60:63], a[188:191], a[12:15], v[60:63]
  buffer_load_dwordx4 v135, s[24:27], s50 offen offset:2048 lds
  ds_read_b64_tr_b16 a[178:179], v251 offset:2048
  v_mfma_f32_16x16x32_bf16 v[56:59], a[188:191], a[8:11], v[56:59]
  ds_read_b64_tr_b16 a[180:181], v251 offset:6144
  v_mfma_f32_16x16x32_bf16 v[56:59], a[184:187], a[0:3], v[56:59]
  s_waitcnt lgkmcnt(11)
  ds_read_b64_tr_b16 a[182:183], v251 offset:10240
  v_mfma_f32_16x16x32_bf16 v[144:147], a[192:195], a[0:3], v[144:147]
  ds_read_b64_tr_b16 a[184:185], v248 offset:12288
  v_mfma_f32_16x16x32_bf16 v[144:147], a[196:199], a[8:11], v[144:147]
  buffer_load_dwordx4 a[72:75], v137, s[36:39], s51 offen offset:2048 sc1
  ds_read_b64_tr_b16 a[186:187], v248 offset:16384
  v_mfma_f32_16x16x32_bf16 v[148:151], a[196:199], a[12:15], v[148:151]
  ds_read_b64_tr_b16 a[188:189], v248 offset:20480
  v_mfma_f32_16x16x32_bf16 v[148:151], a[192:195], a[4:7], v[148:151]
  s_waitcnt lgkmcnt(11)
  ds_read_b64_tr_b16 a[190:191], v248 offset:24576
  v_mfma_f32_16x16x32_bf16 v[156:159], a[200:203], a[4:7], v[156:159]
  ds_read_b64_tr_b16 a[192:193], v249 offset:12288
  v_mfma_f32_16x16x32_bf16 v[156:159], a[204:207], a[12:15], v[156:159]
  buffer_load_dwordx4 v136, s[24:27], s50 offen offset:3072 lds
  ds_read_b64_tr_b16 a[194:195], v249 offset:16384
  v_mfma_f32_16x16x32_bf16 v[152:155], a[204:207], a[8:11], v[152:155]
  ds_read_b64_tr_b16 a[196:197], v249 offset:20480
  v_mfma_f32_16x16x32_bf16 v[152:155], a[200:203], a[0:3], v[152:155]
  s_waitcnt lgkmcnt(11)
  ds_read_b64_tr_b16 a[198:199], v249 offset:24576
  v_mfma_f32_16x16x32_bf16 v[160:163], a[208:211], a[0:3], v[160:163]
  ds_read_b64_tr_b16 a[200:201], v250 offset:12288
  v_mfma_f32_16x16x32_bf16 v[160:163], a[212:215], a[8:11], v[160:163]
  buffer_load_dwordx4 a[76:79], v137, s[36:39], s51 offen offset:3072 sc1
  s_cmp_eq_u32 s87, 0
  v_mfma_f32_16x16x32_bf16 v[164:167], a[212:215], a[12:15], v[164:167]
  s_cselect_b32 s79, 22, 15
  s_cmp_eq_u32 s87, 2
  s_cselect_b32 s79, 8, s79
  v_mfma_f32_16x16x32_bf16 v[164:167], a[208:211], a[4:7], v[164:167]
  s_waitcnt lgkmcnt(9)
  s_lshl_b32 s50, s79, 16
  s_add_u32 m0, s70, 61440
  v_mfma_f32_16x16x32_bf16 v[172:175], a[176:179], a[4:7], v[172:175]
  ds_read_b64_tr_b16 a[202:203], v250 offset:16384
  ds_read_b64_tr_b16 a[204:205], v250 offset:20480
  v_mfma_f32_16x16x32_bf16 v[172:175], a[180:183], a[12:15], v[172:175]
  ds_read_b64_tr_b16 a[206:207], v250 offset:24576
  ds_read_b64_tr_b16 a[208:209], v251 offset:12288
  v_mfma_f32_16x16x32_bf16 v[168:171], a[180:183], a[8:11], v[168:171]
  buffer_load_dwordx4 v133, s[24:27], s50 offen offset:0 lds
  s_lshl_b32 s51, s79, 11
  v_mfma_f32_16x16x32_bf16 v[168:171], a[176:179], a[0:3], v[168:171]
  s_waitcnt vmcnt(25) lgkmcnt(9)
  ds_read_b64_tr_b16 a[210:211], v251 offset:16384
  ds_read_b64_tr_b16 a[212:213], v251 offset:20480
  v_mfma_f32_16x16x32_bf16 v[32:35], a[184:187], a[16:19], v[32:35]
  ds_read_b64_tr_b16 a[214:215], v251 offset:24576
  ds_read_b64_tr_b16 a[176:177], v248 offset:14336
  v_mfma_f32_16x16x32_bf16 v[32:35], a[188:191], a[24:27], v[32:35]
  buffer_load_dwordx4 a[80:83], v137, s[36:39], s51 offen offset:0 sc1
  ds_read_b64_tr_b16 a[178:179], v248 offset:18432
  v_mfma_f32_16x16x32_bf16 v[36:39], a[188:191], a[28:31], v[36:39]
  ds_read_b64_tr_b16 a[180:181], v248 offset:22528
  v_mfma_f32_16x16x32_bf16 v[36:39], a[184:187], a[20:23], v[36:39]
  s_waitcnt lgkmcnt(11)
  ds_read_b64_tr_b16 a[182:183], v248 offset:26624
  v_mfma_f32_16x16x32_bf16 v[44:47], a[192:195], a[20:23], v[44:47]
  ds_read_b64_tr_b16 a[184:185], v249 offset:14336
  v_mfma_f32_16x16x32_bf16 v[44:47], a[196:199], a[28:31], v[44:47]
  buffer_load_dwordx4 v134, s[24:27], s50 offen offset:1024 lds
  ds_read_b64_tr_b16 a[186:187], v249 offset:18432
  v_mfma_f32_16x16x32_bf16 v[40:43], a[196:199], a[24:27], v[40:43]
  ds_read_b64_tr_b16 a[188:189], v249 offset:22528
  v_mfma_f32_16x16x32_bf16 v[40:43], a[192:195], a[16:19], v[40:43]
  s_waitcnt vmcnt(20) lgkmcnt(11)
  s_barrier
  ds_read_b64_tr_b16 a[190:191], v249 offset:26624
  v_mfma_f32_16x16x32_bf16 v[48:51], a[200:203], a[16:19], v[48:51]
  ds_read_b64_tr_b16 a[192:193], v250 offset:14336
  v_mfma_f32_16x16x32_bf16 v[48:51], a[204:207], a[24:27], v[48:51]
  buffer_load_dwordx4 a[84:87], v137, s[36:39], s51 offen offset:1024 sc1
  ds_read_b64_tr_b16 a[194:195], v250 offset:18432
  v_mfma_f32_16x16x32_bf16 v[52:55], a[204:207], a[28:31], v[52:55]
  ds_read_b64_tr_b16 a[196:197], v250 offset:22528
  v_mfma_f32_16x16x32_bf16 v[52:55], a[200:203], a[20:23], v[52:55]
  s_waitcnt lgkmcnt(11)
  ds_read_b64_tr_b16 a[198:199], v250 offset:26624
  v_mfma_f32_16x16x32_bf16 v[60:63], a[208:211], a[20:23], v[60:63]
  ds_read_b64_tr_b16 a[200:201], v251 offset:14336
  v_mfma_f32_16x16x32_bf16 v[60:63], a[212:215], a[28:31], v[60:63]
  buffer_load_dwordx4 v135, s[24:27], s50 offen offset:2048 lds
  ds_read_b64_tr_b16 a[202:203], v251 offset:18432
  v_mfma_f32_16x16x32_bf16 v[56:59], a[212:215], a[24:27], v[56:59]
  ds_read_b64_tr_b16 a[204:205], v251 offset:22528
  v_mfma_f32_16x16x32_bf16 v[56:59], a[208:211], a[16:19], v[56:59]
  s_waitcnt lgkmcnt(11)
  ds_read_b64_tr_b16 a[206:207], v251 offset:26624
  v_mfma_f32_16x16x32_bf16 v[144:147], a[176:179], a[16:19], v[144:147]
  ds_read_b64_tr_b16 a[208:209], v240 offset:12288
  v_mfma_f32_16x16x32_bf16 v[144:147], a[180:183], a[24:27], v[144:147]
  buffer_load_dwordx4 a[88:91], v137, s[36:39], s51 offen offset:2048 sc1
  ds_read_b64_tr_b16 a[210:211], v240 offset:16384
  v_mfma_f32_16x16x32_bf16 v[148:151], a[180:183], a[28:31], v[148:151]
  ds_read_b64_tr_b16 a[212:213], v240 offset:20480
  v_mfma_f32_16x16x32_bf16 v[148:151], a[176:179], a[20:23], v[148:151]
  s_waitcnt lgkmcnt(11)
  ds_read_b64_tr_b16 a[214:215], v240 offset:24576
  v_mfma_f32_16x16x32_bf16 v[156:159], a[184:187], a[20:23], v[156:159]
  ds_read_b64_tr_b16 a[176:177], v241 offset:12288
  v_mfma_f32_16x16x32_bf16 v[156:159], a[188:191], a[28:31], v[156:159]
  buffer_load_dwordx4 v136, s[24:27], s50 offen offset:3072 lds
  ds_read_b64_tr_b16 a[178:179], v241 offset:16384
  v_mfma_f32_16x16x32_bf16 v[152:155], a[188:191], a[24:27], v[152:155]
  ds_read_b64_tr_b16 a[180:181], v241 offset:20480
  v_mfma_f32_16x16x32_bf16 v[152:155], a[184:187], a[16:19], v[152:155]
  s_waitcnt lgkmcnt(11)
  ds_read_b64_tr_b16 a[182:183], v241 offset:24576
  v_mfma_f32_16x16x32_bf16 v[160:163], a[192:195], a[16:19], v[160:163]
  buffer_load_dwordx4 a[92:95], v137, s[36:39], s51 offen offset:3072 sc1
  s_cmp_eq_u32 s87, 1
  v_mfma_f32_16x16x32_bf16 v[160:163], a[196:199], a[24:27], v[160:163]
  s_cselect_b32 s80, 26, 19
  s_cmp_eq_u32 s87, 3
  s_cselect_b32 s80, 12, s80
  v_mfma_f32_16x16x32_bf16 v[164:167], a[196:199], a[28:31], v[164:167]
  s_lshl_b32 s50, s80, 16
  s_add_u32 m0, s70, 77824
  ds_read_b64_tr_b16 a[184:185], v242 offset:12288
  v_mfma_f32_16x16x32_bf16 v[164:167], a[192:195], a[20:23], v[164:167]
  s_waitcnt lgkmcnt(9)
  ds_read_b64_tr_b16 a[186:187], v242 offset:16384
  ds_read_b64_tr_b16 a[188:189], v242 offset:20480
  v_mfma_f32_16x16x32_bf16 v[172:175], a[200:203], a[20:23], v[172:175]
  ds_read_b64_tr_b16 a[190:191], v242 offset:24576
  buffer_load_dwordx4 v133, s[24:27], s50 offen offset:0 lds
  v_mfma_f32_16x16x32_bf16 v[172:175], a[204:207], a[28:31], v[172:175]
  s_lshl_b32 s51, s80, 11
  ds_read_b64_tr_b16 a[192:193], v243 offset:12288
  ds_read_b64_tr_b16 a[194:195], v243 offset:16384
  v_mfma_f32_16x16x32_bf16 v[168:171], a[204:207], a[24:27], v[168:171]
  ds_read_b64_tr_b16 a[196:197], v243 offset:20480
  v_mfma_f32_16x16x32_bf16 v[168:171], a[200:203], a[16:19], v[168:171]
  s_waitcnt vmcnt(25) lgkmcnt(11)
  ds_read_b64_tr_b16 a[198:199], v243 offset:24576
  v_mfma_f32_16x16x32_bf16 v[32:35], a[208:211], a[32:35], v[32:35]
  buffer_load_dwordx4 a[96:99], v137, s[36:39], s51 offen offset:0 sc1
  ds_read_b64_tr_b16 a[200:201], v240 offset:14336
  v_mfma_f32_16x16x32_bf16 v[32:35], a[212:215], a[40:43], v[32:35]
  ds_read_b64_tr_b16 a[202:203], v240 offset:18432
  v_mfma_f32_16x16x32_bf16 v[36:39], a[212:215], a[44:47], v[36:39]
  ds_read_b64_tr_b16 a[204:205], v240 offset:22528
  v_mfma_f32_16x16x32_bf16 v[36:39], a[208:211], a[36:39], v[36:39]
  s_waitcnt lgkmcnt(11)
  ds_read_b64_tr_b16 a[206:207], v240 offset:26624
  v_mfma_f32_16x16x32_bf16 v[44:47], a[176:179], a[36:39], v[44:47]
  buffer_load_dwordx4 v134, s[24:27], s50 offen offset:1024 lds
  ds_read_b64_tr_b16 a[208:209], v241 offset:14336
  v_mfma_f32_16x16x32_bf16 v[44:47], a[180:183], a[44:47], v[44:47]
  ds_read_b64_tr_b16 a[210:211], v241 offset:18432
  v_mfma_f32_16x16x32_bf16 v[40:43], a[180:183], a[40:43], v[40:43]
  ds_read_b64_tr_b16 a[212:213], v241 offset:22528
  v_mfma_f32_16x16x32_bf16 v[40:43], a[176:179], a[32:35], v[40:43]
  s_waitcnt vmcnt(20) lgkmcnt(11)
  s_barrier
  ds_read_b64_tr_b16 a[214:215], v241 offset:26624
  v_mfma_f32_16x16x32_bf16 v[48:51], a[184:187], a[32:35], v[48:51]
  buffer_load_dwordx4 a[100:103], v137, s[36:39], s51 offen offset:1024 sc1
  ds_read_b64_tr_b16 a[176:177], v242 offset:14336
  v_mfma_f32_16x16x32_bf16 v[48:51], a[188:191], a[40:43], v[48:51]
  ds_read_b64_tr_b16 a[178:179], v242 offset:18432
  v_mfma_f32_16x16x32_bf16 v[52:55], a[188:191], a[44:47], v[52:55]
  ds_read_b64_tr_b16 a[180:181], v242 offset:22528
  v_mfma_f32_16x16x32_bf16 v[52:55], a[184:187], a[36:39], v[52:55]
  s_waitcnt lgkmcnt(11)
  ds_read_b64_tr_b16 a[182:183], v242 offset:26624
  v_mfma_f32_16x16x32_bf16 v[60:63], a[192:195], a[36:39], v[60:63]
  buffer_load_dwordx4 v135, s[24:27], s50 offen offset:2048 lds
  ds_read_b64_tr_b16 a[184:185], v243 offset:14336
  v_mfma_f32_16x16x32_bf16 v[60:63], a[196:199], a[44:47], v[60:63]
  ds_read_b64_tr_b16 a[186:187], v243 offset:18432
  v_mfma_f32_16x16x32_bf16 v[56:59], a[196:199], a[40:43], v[56:59]
  ds_read_b64_tr_b16 a[188:189], v243 offset:22528
  v_mfma_f32_16x16x32_bf16 v[56:59], a[192:195], a[32:35], v[56:59]
  s_waitcnt lgkmcnt(11)
  ds_read_b64_tr_b16 a[190:191], v243 offset:26624
  v_mfma_f32_16x16x32_bf16 v[144:147], a[200:203], a[32:35], v[144:147]
  buffer_load_dwordx4 a[104:107], v137, s[36:39], s51 offen offset:2048 sc1
  ds_read_b64_tr_b16 a[192:193], v240 offset:28672
  v_mfma_f32_16x16x32_bf16 v[144:147], a[204:207], a[40:43], v[144:147]
  ds_read_b64_tr_b16 a[194:195], v240 offset:32768
  v_mfma_f32_16x16x32_bf16 v[148:151], a[204:207], a[44:47], v[148:151]
  ds_read_b64_tr_b16 a[196:197], v240 offset:36864
  v_mfma_f32_16x16x32_bf16 v[148:151], a[200:203], a[36:39], v[148:151]
  s_waitcnt lgkmcnt(11)
  ds_read_b64_tr_b16 a[198:199], v240 offset:40960
  v_mfma_f32_16x16x32_bf16 v[156:159], a[208:211], a[36:39], v[156:159]
  buffer_load_dwordx4 v136, s[24:27], s50 offen offset:3072 lds
  ds_read_b64_tr_b16 a[200:201], v241 offset:28672
  v_mfma_f32_16x16x32_bf16 v[156:159], a[212:215], a[44:47], v[156:159]
  ds_read_b64_tr_b16 a[202:203], v241 offset:32768
  v_mfma_f32_16x16x32_bf16 v[152:155], a[212:215], a[40:43], v[152:155]
  ds_read_b64_tr_b16 a[204:205], v241 offset:36864
  v_mfma_f32_16x16x32_bf16 v[152:155], a[208:211], a[32:35], v[152:155]
  s_waitcnt lgkmcnt(11)
  ds_read_b64_tr_b16 a[206:207], v241 offset:40960
  v_mfma_f32_16x16x32_bf16 v[160:163], a[176:179], a[32:35], v[160:163]
  buffer_load_dwordx4 a[108:111], v137, s[36:39], s51 offen offset:3072 sc1
  s_cmp_eq_u32 s87, 0
  v_mfma_f32_16x16x32_bf16 v[160:163], a[180:183], a[40:43], v[160:163]
  s_cselect_b32 s81, 15, 22
  s_cmp_eq_u32 s87, 2
  s_cselect_b32 s81, 29, s81
  v_mfma_f32_16x16x32_bf16 v[164:167], a[180:183], a[44:47], v[164:167]
  s_lshl_b32 s50, s81, 16
  s_add_u32 m0, s70, 94208
  ds_read_b64_tr_b16 a[208:209], v242 offset:28672
  v_mfma_f32_16x16x32_bf16 v[164:167], a[176:179], a[36:39], v[164:167]
  s_waitcnt lgkmcnt(9)
  ds_read_b64_tr_b16 a[210:211], v242 offset:32768
  ds_read_b64_tr_b16 a[212:213], v242 offset:36864
  v_mfma_f32_16x16x32_bf16 v[172:175], a[184:187], a[36:39], v[172:175]
  ds_read_b64_tr_b16 a[214:215], v242 offset:40960
  buffer_load_dwordx4 v133, s[24:27], s50 offen offset:0 lds
  v_mfma_f32_16x16x32_bf16 v[172:175], a[188:191], a[44:47], v[172:175]
  s_lshl_b32 s51, s81, 11
  ds_read_b64_tr_b16 a[176:177], v243 offset:28672
  ds_read_b64_tr_b16 a[178:179], v243 offset:32768
  v_mfma_f32_16x16x32_bf16 v[168:171], a[188:191], a[40:43], v[168:171]
  ds_read_b64_tr_b16 a[180:181], v243 offset:36864
  v_mfma_f32_16x16x32_bf16 v[168:171], a[184:187], a[32:35], v[168:171]
  s_waitcnt vmcnt(25) lgkmcnt(11)
  ds_read_b64_tr_b16 a[182:183], v243 offset:40960
  v_mfma_f32_16x16x32_bf16 v[32:35], a[192:195], a[48:51], v[32:35]
  buffer_load_dwordx4 a[112:115], v137, s[36:39], s51 offen offset:0 sc1
  ds_read_b64_tr_b16 a[184:185], v240 offset:30720
  v_mfma_f32_16x16x32_bf16 v[32:35], a[196:199], a[56:59], v[32:35]
  ds_read_b64_tr_b16 a[186:187], v240 offset:34816
  v_mfma_f32_16x16x32_bf16 v[36:39], a[196:199], a[60:63], v[36:39]
  ds_read_b64_tr_b16 a[188:189], v240 offset:38912
  v_mfma_f32_16x16x32_bf16 v[36:39], a[192:195], a[52:55], v[36:39]
  s_waitcnt lgkmcnt(11)
  ds_read_b64_tr_b16 a[190:191], v240 offset:43008
  v_mfma_f32_16x16x32_bf16 v[44:47], a[200:203], a[52:55], v[44:47]
  buffer_load_dwordx4 v134, s[24:27], s50 offen offset:1024 lds
  ds_read_b64_tr_b16 a[192:193], v241 offset:30720
  v_mfma_f32_16x16x32_bf16 v[44:47], a[204:207], a[60:63], v[44:47]
  ds_read_b64_tr_b16 a[194:195], v241 offset:34816
  v_mfma_f32_16x16x32_bf16 v[40:43], a[204:207], a[56:59], v[40:43]
  ds_read_b64_tr_b16 a[196:197], v241 offset:38912
  v_mfma_f32_16x16x32_bf16 v[40:43], a[200:203], a[48:51], v[40:43]
  s_waitcnt vmcnt(20) lgkmcnt(11)
  s_barrier
  ds_read_b64_tr_b16 a[198:199], v241 offset:43008
  v_mfma_f32_16x16x32_bf16 v[48:51], a[208:211], a[48:51], v[48:51]
  buffer_load_dwordx4 a[116:119], v137, s[36:39], s51 offen offset:1024 sc1
  ds_read_b64_tr_b16 a[200:201], v242 offset:30720
  v_mfma_f32_16x16x32_bf16 v[48:51], a[212:215], a[56:59], v[48:51]
  ds_read_b64_tr_b16 a[202:203], v242 offset:34816
  v_mfma_f32_16x16x32_bf16 v[52:55], a[212:215], a[60:63], v[52:55]
  ds_read_b64_tr_b16 a[204:205], v242 offset:38912
  v_mfma_f32_16x16x32_bf16 v[52:55], a[208:211], a[52:55], v[52:55]
  s_waitcnt lgkmcnt(11)
  ds_read_b64_tr_b16 a[206:207], v242 offset:43008
  v_mfma_f32_16x16x32_bf16 v[60:63], a[176:179], a[52:55], v[60:63]
  buffer_load_dwordx4 v135, s[24:27], s50 offen offset:2048 lds
  ds_read_b64_tr_b16 a[208:209], v243 offset:30720
  v_mfma_f32_16x16x32_bf16 v[60:63], a[180:183], a[60:63], v[60:63]
  ds_read_b64_tr_b16 a[210:211], v243 offset:34816
  v_mfma_f32_16x16x32_bf16 v[56:59], a[180:183], a[56:59], v[56:59]
  ds_read_b64_tr_b16 a[212:213], v243 offset:38912
  v_mfma_f32_16x16x32_bf16 v[56:59], a[176:179], a[48:51], v[56:59]
  s_waitcnt lgkmcnt(11)
  buffer_load_dwordx4 a[120:123], v137, s[36:39], s51 offen offset:2048 sc1
  ds_read_b64_tr_b16 a[214:215], v243 offset:43008
  v_mfma_f32_16x16x32_bf16 v[144:147], a[184:187], a[48:51], v[144:147]
  ds_read_b64_tr_b16 a[176:177], v240 offset:45056
  v_mfma_f32_16x16x32_bf16 v[144:147], a[188:191], a[56:59], v[144:147]
  ds_read_b64_tr_b16 a[178:179], v240 offset:49152
  v_mfma_f32_16x16x32_bf16 v[148:151], a[188:191], a[60:63], v[148:151]
  ds_read_b64_tr_b16 a[180:181], v240 offset:53248
  v_mfma_f32_16x16x32_bf16 v[148:151], a[184:187], a[52:55], v[148:151]
  s_waitcnt lgkmcnt(11)
  buffer_load_dwordx4 v136, s[24:27], s50 offen offset:3072 lds
  ds_read_b64_tr_b16 a[182:183], v240 offset:57344
  v_mfma_f32_16x16x32_bf16 v[156:159], a[192:195], a[52:55], v[156:159]
  ds_read_b64_tr_b16 a[184:185], v241 offset:45056
  v_mfma_f32_16x16x32_bf16 v[156:159], a[196:199], a[60:63], v[156:159]
  ds_read_b64_tr_b16 a[186:187], v241 offset:49152
  v_mfma_f32_16x16x32_bf16 v[152:155], a[196:199], a[56:59], v[152:155]
  ds_read_b64_tr_b16 a[188:189], v241 offset:53248
  v_mfma_f32_16x16x32_bf16 v[152:155], a[192:195], a[48:51], v[152:155]
  s_waitcnt lgkmcnt(11)
  buffer_load_dwordx4 a[124:127], v137, s[36:39], s51 offen offset:3072 sc1
  s_cmp_eq_u32 s87, 1
  v_mfma_f32_16x16x32_bf16 v[160:163], a[200:203], a[48:51], v[160:163]
  s_cselect_b32 s86, 19, 26
  s_cmp_eq_u32 s87, 3
  s_cselect_b32 s86, 33, s86
  v_mfma_f32_16x16x32_bf16 v[160:163], a[204:207], a[56:59], v[160:163]
  s_lshl_b32 s50, s86, 16
  s_add_u32 m0, s70, 110592
  ds_read_b64_tr_b16 a[190:191], v241 offset:57344
  v_mfma_f32_16x16x32_bf16 v[164:167], a[204:207], a[60:63], v[164:167]
  ds_read_b64_tr_b16 a[192:193], v242 offset:45056
  ds_read_b64_tr_b16 a[194:195], v242 offset:49152
  v_mfma_f32_16x16x32_bf16 v[164:167], a[200:203], a[52:55], v[164:167]
  s_waitcnt lgkmcnt(10)
  ds_read_b64_tr_b16 a[196:197], v242 offset:53248
  buffer_load_dwordx4 v133, s[24:27], s50 offen offset:0 lds
  v_mfma_f32_16x16x32_bf16 v[172:175], a[208:211], a[52:55], v[172:175]
  s_lshl_b32 s51, s86, 11
  ds_read_b64_tr_b16 a[198:199], v242 offset:57344
  ds_read_b64_tr_b16 a[200:201], v243 offset:45056
  v_mfma_f32_16x16x32_bf16 v[172:175], a[212:215], a[60:63], v[172:175]
  ds_read_b64_tr_b16 a[202:203], v243 offset:49152
  v_mfma_f32_16x16x32_bf16 v[168:171], a[212:215], a[56:59], v[168:171]
  ds_read_b64_tr_b16 a[204:205], v243 offset:53248
  v_mfma_f32_16x16x32_bf16 v[168:171], a[208:211], a[48:51], v[168:171]
  s_waitcnt vmcnt(25) lgkmcnt(11)
  buffer_load_dwordx4 a[128:131], v137, s[36:39], s51 offen offset:0 sc1
  ds_read_b64_tr_b16 a[206:207], v243 offset:57344
  v_mfma_f32_16x16x32_bf16 v[32:35], a[176:179], a[64:67], v[32:35]
  ds_read_b64_tr_b16 a[208:209], v240 offset:47104
  v_mfma_f32_16x16x32_bf16 v[32:35], a[180:183], a[72:75], v[32:35]
  ds_read_b64_tr_b16 a[210:211], v240 offset:51200
  v_mfma_f32_16x16x32_bf16 v[36:39], a[180:183], a[76:79], v[36:39]
Hb2:
  s_cbranch_execz Rb
  ds_read_b64_tr_b16 a[212:213], v240 offset:55296
  v_mfma_f32_16x16x32_bf16 v[36:39], a[176:179], a[68:71], v[36:39]
  s_waitcnt lgkmcnt(11)
  buffer_load_dwordx4 v134, s[24:27], s50 offen offset:1024 lds
  ds_read_b64_tr_b16 a[214:215], v240 offset:59392
  v_mfma_f32_16x16x32_bf16 v[44:47], a[184:187], a[68:71], v[44:47]
  ds_read_b64_tr_b16 a[176:177], v241 offset:47104
  v_mfma_f32_16x16x32_bf16 v[44:47], a[188:191], a[76:79], v[44:47]
  ds_read_b64_tr_b16 a[178:179], v241 offset:51200
  v_mfma_f32_16x16x32_bf16 v[40:43], a[188:191], a[72:75], v[40:43]
  ds_read_b64_tr_b16 a[180:181], v241 offset:55296
  v_mfma_f32_16x16x32_bf16 v[40:43], a[184:187], a[64:67], v[40:43]
  s_waitcnt vmcnt(20) lgkmcnt(11)
  s_barrier
  buffer_load_dwordx4 a[132:135], v137, s[36:39], s51 offen offset:1024 sc1
  v_mfma_f32_16x16x32_bf16 v[48:51], a[192:195], a[64:67], v[48:51]
  ds_read_b64_tr_b16 a[182:183], v241 offset:59392
  ds_read_b64_tr_b16 a[184:185], v242 offset:47104
  v_mfma_f32_16x16x32_bf16 v[48:51], a[196:199], a[72:75], v[48:51]
  ds_read_b64_tr_b16 a[186:187], v242 offset:51200
  v_mfma_f32_16x16x32_bf16 v[52:55], a[196:199], a[76:79], v[52:55]
  ds_read_b64_tr_b16 a[188:189], v242 offset:55296
  v_mfma_f32_16x16x32_bf16 v[52:55], a[192:195], a[68:71], v[52:55]
  s_waitcnt lgkmcnt(11)
  buffer_load_dwordx4 v135, s[24:27], s50 offen offset:2048 lds
  ds_read_b64_tr_b16 a[190:191], v242 offset:59392
  v_mfma_f32_16x16x32_bf16 v[60:63], a[200:203], a[68:71], v[60:63]
  ds_read_b64_tr_b16 a[192:193], v243 offset:47104
  v_mfma_f32_16x16x32_bf16 v[60:63], a[204:207], a[76:79], v[60:63]
  ds_read_b64_tr_b16 a[194:195], v243 offset:51200
  v_mfma_f32_16x16x32_bf16 v[56:59], a[204:207], a[72:75], v[56:59]
  ds_read_b64_tr_b16 a[196:197], v243 offset:55296
  v_mfma_f32_16x16x32_bf16 v[56:59], a[200:203], a[64:67], v[56:59]
  s_waitcnt lgkmcnt(11)
  buffer_load_dwordx4 a[136:139], v137, s[36:39], s51 offen offset:2048 sc1
  ds_read_b64_tr_b16 a[198:199], v243 offset:59392
  v_mfma_f32_16x16x32_bf16 v[144:147], a[208:211], a[64:67], v[144:147]
  ds_read_b64_tr_b16 a[200:201], v240 offset:61440
  v_mfma_f32_16x16x32_bf16 v[144:147], a[212:215], a[72:75], v[144:147]
  ds_read_b64_tr_b16 a[202:203], v244 offset:0
  v_mfma_f32_16x16x32_bf16 v[148:151], a[212:215], a[76:79], v[148:151]
  ds_read_b64_tr_b16 a[204:205], v244 offset:4096
  v_mfma_f32_16x16x32_bf16 v[148:151], a[208:211], a[68:71], v[148:151]
  s_waitcnt lgkmcnt(11)
  buffer_load_dwordx4 v136, s[24:27], s50 offen offset:3072 lds
  ds_read_b64_tr_b16 a[206:207], v244 offset:8192
  v_mfma_f32_16x16x32_bf16 v[156:159], a[176:179], a[68:71], v[156:159]
  ds_read_b64_tr_b16 a[208:209], v241 offset:61440
  v_mfma_f32_16x16x32_bf16 v[156:159], a[180:183], a[76:79], v[156:159]
  ds_read_b64_tr_b16 a[210:211], v245 offset:0
  v_mfma_f32_16x16x32_bf16 v[152:155], a[180:183], a[72:75], v[152:155]
  ds_read_b64_tr_b16 a[212:213], v245 offset:4096
  v_mfma_f32_16x16x32_bf16 v[152:155], a[176:179], a[64:67], v[152:155]
  s_waitcnt lgkmcnt(11)
  buffer_load_dwordx4 a[140:143], v137, s[36:39], s51 offen offset:3072 sc1
  s_cmp_eq_u32 s87, 0
  v_mfma_f32_16x16x32_bf16 v[160:163], a[184:187], a[64:67], v[160:163]
  s_cselect_b32 s69, 36, 29
  s_cmp_eq_u32 s87, 2
  s_cselect_b32 s69, 22, s69
  v_mfma_f32_16x16x32_bf16 v[160:163], a[188:191], a[72:75], v[160:163]
  s_lshl_b32 s51, s69, 11
  ds_read_b64_tr_b16 a[214:215], v245 offset:8192
  ds_read_b64_tr_b16 a[176:177], v242 offset:61440
  v_mfma_f32_16x16x32_bf16 v[164:167], a[188:191], a[76:79], v[164:167]
  ds_read_b64_tr_b16 a[178:179], v246 offset:0
  ds_read_b64_tr_b16 a[180:181], v246 offset:4096
  v_mfma_f32_16x16x32_bf16 v[164:167], a[184:187], a[68:71], v[164:167]
  s_waitcnt lgkmcnt(11)
  buffer_load_dwordx4 a[216:219], v137, s[36:39], s51 offen offset:0 sc1
  ds_read_b64_tr_b16 a[182:183], v246 offset:8192
  v_mfma_f32_16x16x32_bf16 v[172:175], a[192:195], a[68:71], v[172:175]
  ds_read_b64_tr_b16 a[184:185], v243 offset:61440
  v_mfma_f32_16x16x32_bf16 v[172:175], a[196:199], a[76:79], v[172:175]
  ds_read_b64_tr_b16 a[186:187], v247 offset:0
  v_mfma_f32_16x16x32_bf16 v[168:171], a[196:199], a[72:75], v[168:171]
  ds_read_b64_tr_b16 a[188:189], v247 offset:4096
  v_mfma_f32_16x16x32_bf16 v[168:171], a[192:195], a[64:67], v[168:171]
  s_waitcnt vmcnt(25) lgkmcnt(11)
  buffer_load_dwordx4 a[220:223], v137, s[36:39], s51 offen offset:1024 sc1
  s_lshl_b32 s50, s69, 16
  v_mfma_f32_16x16x32_bf16 v[32:35], a[200:203], a[80:83], v[32:35]
  s_add_u32 m0, s70, 126976
  ds_read_b64_tr_b16 a[190:191], v247 offset:8192
  ds_read_b64_tr_b16 a[192:193], v240 offset:63488
  v_mfma_f32_16x16x32_bf16 v[32:35], a[204:207], a[88:91], v[32:35]
  ds_read_b64_tr_b16 a[194:195], v244 offset:2048
  v_mfma_f32_16x16x32_bf16 v[36:39], a[204:207], a[92:95], v[36:39]
  ds_read_b64_tr_b16 a[196:197], v244 offset:6144
  v_mfma_f32_16x16x32_bf16 v[36:39], a[200:203], a[84:87], v[36:39]
  s_waitcnt lgkmcnt(11)
  buffer_load_dwordx4 v135, s[24:27], s50 offen offset:2048 lds
  ds_read_b64_tr_b16 a[198:199], v244 offset:10240
  v_mfma_f32_16x16x32_bf16 v[44:47], a[208:211], a[84:87], v[44:47]
  ds_read_b64_tr_b16 a[200:201], v241 offset:63488
  v_mfma_f32_16x16x32_bf16 v[44:47], a[212:215], a[92:95], v[44:47]
  ds_read_b64_tr_b16 a[202:203], v245 offset:2048
  v_mfma_f32_16x16x32_bf16 v[40:43], a[212:215], a[88:91], v[40:43]
  ds_read_b64_tr_b16 a[204:205], v245 offset:6144
  v_mfma_f32_16x16x32_bf16 v[40:43], a[208:211], a[80:83], v[40:43]
  s_waitcnt vmcnt(20) lgkmcnt(11)
  s_barrier
  buffer_load_dwordx4 a[224:227], v137, s[36:39], s51 offen offset:2048 sc1
  v_mfma_f32_16x16x32_bf16 v[48:51], a[176:179], a[80:83], v[48:51]
  ds_read_b64_tr_b16 a[206:207], v245 offset:10240
  ds_read_b64_tr_b16 a[208:209], v242 offset:63488
  v_mfma_f32_16x16x32_bf16 v[48:51], a[180:183], a[88:91], v[48:51]
  ds_read_b64_tr_b16 a[210:211], v246 offset:2048
  v_mfma_f32_16x16x32_bf16 v[52:55], a[180:183], a[92:95], v[52:55]
  buffer_load_dwordx4 v136, s[24:27], s50 offen offset:3072 lds
  ds_read_b64_tr_b16 a[212:213], v246 offset:6144
  v_mfma_f32_16x16x32_bf16 v[52:55], a[176:179], a[84:87], v[52:55]
  s_waitcnt lgkmcnt(11)
  ds_read_b64_tr_b16 a[214:215], v246 offset:10240
  v_mfma_f32_16x16x32_bf16 v[60:63], a[184:187], a[84:87], v[60:63]
  ds_read_b64_tr_b16 a[176:177], v243 offset:63488
  v_mfma_f32_16x16x32_bf16 v[60:63], a[188:191], a[92:95], v[60:63]
  ds_read_b64_tr_b16 a[178:179], v247 offset:2048
  v_mfma_f32_16x16x32_bf16 v[56:59], a[188:191], a[88:91], v[56:59]
  buffer_load_dwordx4 a[228:231], v137, s[36:39], s51 offen offset:3072 sc1
  s_cmp_eq_u32 s87, 1
  v_mfma_f32_16x16x32_bf16 v[56:59], a[184:187], a[80:83], v[56:59]
  s_waitcnt lgkmcnt(10)
  s_cselect_b32 s71, 40, 33
  s_cmp_eq_u32 s87, 3
  v_mfma_f32_16x16x32_bf16 v[144:147], a[192:195], a[80:83], v[144:147]
  s_cselect_b32 s71, 26, s71
  s_lshl_b32 s51, s71, 11
  ds_read_b64_tr_b16 a[180:181], v247 offset:6144
  v_mfma_f32_16x16x32_bf16 v[144:147], a[196:199], a[88:91], v[144:147]
  ds_read_b64_tr_b16 a[182:183], v247 offset:10240
  ds_read_b64_tr_b16 a[184:185], v244 offset:12288
  v_mfma_f32_16x16x32_bf16 v[148:151], a[196:199], a[92:95], v[148:151]
  ds_read_b64_tr_b16 a[186:187], v244 offset:16384
  buffer_load_dwordx4 a[0:3], v137, s[36:39], s51 offen offset:0 sc1
  v_mfma_f32_16x16x32_bf16 v[148:151], a[192:195], a[84:87], v[148:151]
  s_waitcnt lgkmcnt(10)
  ds_read_b64_tr_b16 a[188:189], v244 offset:20480
  ds_read_b64_tr_b16 a[190:191], v244 offset:24576
  v_mfma_f32_16x16x32_bf16 v[156:159], a[200:203], a[84:87], v[156:159]
  ds_read_b64_tr_b16 a[192:193], v245 offset:12288
  v_mfma_f32_16x16x32_bf16 v[156:159], a[204:207], a[92:95], v[156:159]
  ds_read_b64_tr_b16 a[194:195], v245 offset:16384
  v_mfma_f32_16x16x32_bf16 v[152:155], a[204:207], a[88:91], v[152:155]
  buffer_load_dwordx4 a[4:7], v137, s[36:39], s51 offen offset:1024 sc1
  s_lshl_b32 s50, s71, 16
  v_mfma_f32_16x16x32_bf16 v[152:155], a[200:203], a[80:83], v[152:155]
  s_waitcnt lgkmcnt(10)
  s_add_u32 m0, s70, 143360
  ds_read_b64_tr_b16 a[196:197], v245 offset:20480
  v_mfma_f32_16x16x32_bf16 v[160:163], a[208:211], a[80:83], v[160:163]
  ds_read_b64_tr_b16 a[198:199], v245 offset:24576
  ds_read_b64_tr_b16 a[200:201], v246 offset:12288
  v_mfma_f32_16x16x32_bf16 v[160:163], a[212:215], a[88:91], v[160:163]
  ds_read_b64_tr_b16 a[202:203], v246 offset:16384
  v_mfma_f32_16x16x32_bf16 v[164:167], a[212:215], a[92:95], v[164:167]
  buffer_load_dwordx4 v135, s[24:27], s50 offen offset:2048 lds
  ds_read_b64_tr_b16 a[204:205], v246 offset:20480
  v_mfma_f32_16x16x32_bf16 v[164:167], a[208:211], a[84:87], v[164:167]
  s_waitcnt lgkmcnt(11)
  ds_read_b64_tr_b16 a[206:207], v246 offset:24576
  v_mfma_f32_16x16x32_bf16 v[172:175], a[176:179], a[84:87], v[172:175]
  ds_read_b64_tr_b16 a[208:209], v247 offset:12288
  v_mfma_f32_16x16x32_bf16 v[172:175], a[180:183], a[92:95], v[172:175]
  ds_read_b64_tr_b16 a[210:211], v247 offset:16384
  v_mfma_f32_16x16x32_bf16 v[168:171], a[180:183], a[88:91], v[168:171]
  buffer_load_dwordx4 a[8:11], v137, s[36:39], s51 offen offset:2048 sc1
  ds_read_b64_tr_b16 a[212:213], v247 offset:20480
  v_mfma_f32_16x16x32_bf16 v[168:171], a[176:179], a[80:83], v[168:171]
  s_waitcnt vmcnt(26) lgkmcnt(11)
  ds_read_b64_tr_b16 a[214:215], v247 offset:24576
  v_mfma_f32_16x16x32_bf16 v[32:35], a[184:187], a[96:99], v[32:35]
  ds_read_b64_tr_b16 a[176:177], v244 offset:14336
  v_mfma_f32_16x16x32_bf16 v[32:35], a[188:191], a[104:107], v[32:35]
  ds_read_b64_tr_b16 a[178:179], v244 offset:18432
  v_mfma_f32_16x16x32_bf16 v[36:39], a[188:191], a[108:111], v[36:39]
  buffer_load_dwordx4 v136, s[24:27], s50 offen offset:3072 lds
  ds_read_b64_tr_b16 a[180:181], v244 offset:22528
  v_mfma_f32_16x16x32_bf16 v[36:39], a[184:187], a[100:103], v[36:39]
  s_waitcnt lgkmcnt(11)
  ds_read_b64_tr_b16 a[182:183], v244 offset:26624
  v_mfma_f32_16x16x32_bf16 v[44:47], a[192:195], a[100:103], v[44:47]
  ds_read_b64_tr_b16 a[184:185], v245 offset:14336
  v_mfma_f32_16x16x32_bf16 v[44:47], a[196:199], a[108:111], v[44:47]
  ds_read_b64_tr_b16 a[186:187], v245 offset:18432
  v_mfma_f32_16x16x32_bf16 v[40:43], a[196:199], a[104:107], v[40:43]
  buffer_load_dwordx4 a[12:15], v137, s[36:39], s51 offen offset:3072 sc1
  s_cmp_eq_u32 s87, 0
  v_mfma_f32_16x16x32_bf16 v[40:43], a[192:195], a[96:99], v[40:43]
  s_waitcnt vmcnt(21) lgkmcnt(10)
  s_barrier
  s_cselect_b32 s72, 29, 36
  v_mfma_f32_16x16x32_bf16 v[48:51], a[200:203], a[96:99], v[48:51]
  s_cmp_eq_u32 s87, 2
  s_cselect_b32 s72, 43, s72
  s_lshl_b32 s51, s72, 11
  v_mfma_f32_16x16x32_bf16 v[48:51], a[204:207], a[104:107], v[48:51]
  ds_read_b64_tr_b16 a[188:189], v245 offset:22528
  ds_read_b64_tr_b16 a[190:191], v245 offset:26624
  v_mfma_f32_16x16x32_bf16 v[52:55], a[204:207], a[108:111], v[52:55]
  ds_read_b64_tr_b16 a[192:193], v246 offset:14336
  ds_read_b64_tr_b16 a[194:195], v246 offset:18432
  v_mfma_f32_16x16x32_bf16 v[52:55], a[200:203], a[100:103], v[52:55]
  s_waitcnt lgkmcnt(10)
  buffer_load_dwordx4 a[16:19], v137, s[36:39], s51 offen offset:0 sc1
  ds_read_b64_tr_b16 a[196:197], v246 offset:22528
  v_mfma_f32_16x16x32_bf16 v[60:63], a[208:211], a[100:103], v[60:63]
  ds_read_b64_tr_b16 a[198:199], v246 offset:26624
  ds_read_b64_tr_b16 a[200:201], v247 offset:14336
  v_mfma_f32_16x16x32_bf16 v[60:63], a[212:215], a[108:111], v[60:63]
  ds_read_b64_tr_b16 a[202:203], v247 offset:18432
  v_mfma_f32_16x16x32_bf16 v[56:59], a[212:215], a[104:107], v[56:59]
  buffer_load_dwordx4 a[20:23], v137, s[36:39], s51 offen offset:1024 sc1
  s_lshl_b32 s50, s72, 16
  v_mfma_f32_16x16x32_bf16 v[56:59], a[208:211], a[96:99], v[56:59]
  s_waitcnt lgkmcnt(10)
  s_add_u32 m0, s70, 12288
  ds_read_b64_tr_b16 a[204:205], v247 offset:22528
  v_mfma_f32_16x16x32_bf16 v[144:147], a[176:179], a[96:99], v[144:147]
  ds_read_b64_tr_b16 a[206:207], v247 offset:26624
  ds_read_b64_tr_b16 a[208:209], v244 offset:28672
  v_mfma_f32_16x16x32_bf16 v[144:147], a[180:183], a[104:107], v[144:147]
  ds_read_b64_tr_b16 a[210:211], v244 offset:32768
  v_mfma_f32_16x16x32_bf16 v[148:151], a[180:183], a[108:111], v[148:151]
  buffer_load_dwordx4 v135, s[24:27], s50 offen offset:2048 lds
  ds_read_b64_tr_b16 a[212:213], v244 offset:36864
  v_mfma_f32_16x16x32_bf16 v[148:151], a[176:179], a[100:103], v[148:151]
  s_waitcnt lgkmcnt(11)
  ds_read_b64_tr_b16 a[214:215], v244 offset:40960
  v_mfma_f32_16x16x32_bf16 v[156:159], a[184:187], a[100:103], v[156:159]
  ds_read_b64_tr_b16 a[176:177], v245 offset:28672
  v_mfma_f32_16x16x32_bf16 v[156:159], a[188:191], a[108:111], v[156:159]
  ds_read_b64_tr_b16 a[178:179], v245 offset:32768
  v_mfma_f32_16x16x32_bf16 v[152:155], a[188:191], a[104:107], v[152:155]
  buffer_load_dwordx4 a[24:27], v137, s[36:39], s51 offen offset:2048 sc1
  ds_read_b64_tr_b16 a[180:181], v245 offset:36864
  v_mfma_f32_16x16x32_bf16 v[152:155], a[184:187], a[96:99], v[152:155]
  s_waitcnt lgkmcnt(11)
  ds_read_b64_tr_b16 a[182:183], v245 offset:40960
  v_mfma_f32_16x16x32_bf16 v[160:163], a[192:195], a[96:99], v[160:163]
  ds_read_b64_tr_b16 a[184:185], v246 offset:28672
  v_mfma_f32_16x16x32_bf16 v[160:163], a[196:199], a[104:107], v[160:163]
  ds_read_b64_tr_b16 a[186:187], v246 offset:32768
  v_mfma_f32_16x16x32_bf16 v[164:167], a[196:199], a[108:111], v[164:167]
  buffer_load_dwordx4 v136, s[24:27], s50 offen offset:3072 lds
  ds_read_b64_tr_b16 a[188:189], v246 offset:36864
  v_mfma_f32_16x16x32_bf16 v[164:167], a[192:195], a[100:103], v[164:167]
  s_waitcnt lgkmcnt(11)
  ds_read_b64_tr_b16 a[190:191], v246 offset:40960
  v_mfma_f32_16x16x32_bf16 v[172:175], a[200:203], a[100:103], v[172:175]
  ds_read_b64_tr_b16 a[192:193], v247 offset:28672
  v_mfma_f32_16x16x32_bf16 v[172:175], a[204:207], a[108:111], v[172:175]
  ds_read_b64_tr_b16 a[194:195], v247 offset:32768
  v_mfma_f32_16x16x32_bf16 v[168:171], a[204:207], a[104:107], v[168:171]
  buffer_load_dwordx4 a[28:31], v137, s[36:39], s51 offen offset:3072 sc1
  s_cmp_eq_u32 s87, 1
  v_mfma_f32_16x16x32_bf16 v[168:171], a[200:203], a[96:99], v[168:171]
  s_waitcnt vmcnt(26) lgkmcnt(10)
  s_cselect_b32 s73, 33, 40
  s_cmp_eq_u32 s87, 3
  v_mfma_f32_16x16x32_bf16 v[32:35], a[208:211], a[112:115], v[32:35]
  s_cselect_b32 s73, 47, s73
  s_lshl_b32 s51, s73, 11
  ds_read_b64_tr_b16 a[196:197], v247 offset:36864
  v_mfma_f32_16x16x32_bf16 v[32:35], a[212:215], a[120:123], v[32:35]
  ds_read_b64_tr_b16 a[198:199], v247 offset:40960
  ds_read_b64_tr_b16 a[200:201], v244 offset:30720
  v_mfma_f32_16x16x32_bf16 v[36:39], a[212:215], a[124:127], v[36:39]
  buffer_load_dwordx4 a[32:35], v137, s[36:39], s51 offen offset:0 sc1
  ds_read_b64_tr_b16 a[202:203], v244 offset:34816
  v_mfma_f32_16x16x32_bf16 v[36:39], a[208:211], a[116:119], v[36:39]
  s_waitcnt lgkmcnt(10)
  ds_read_b64_tr_b16 a[204:205], v244 offset:38912
  ds_read_b64_tr_b16 a[206:207], v244 offset:43008
  v_mfma_f32_16x16x32_bf16 v[44:47], a[176:179], a[116:119], v[44:47]
  ds_read_b64_tr_b16 a[208:209], v245 offset:30720
  v_mfma_f32_16x16x32_bf16 v[44:47], a[180:183], a[124:127], v[44:47]
  buffer_load_dwordx4 a[36:39], v137, s[36:39], s51 offen offset:1024 sc1
  s_lshl_b32 s50, s73, 16
  v_mfma_f32_16x16x32_bf16 v[40:43], a[180:183], a[120:123], v[40:43]
  s_add_u32 m0, s70, 28672
  ds_read_b64_tr_b16 a[210:211], v245 offset:34816
  ds_read_b64_tr_b16 a[212:213], v245 offset:38912
  v_mfma_f32_16x16x32_bf16 v[40:43], a[176:179], a[112:115], v[40:43]
  s_waitcnt vmcnt(21) lgkmcnt(11)
  s_barrier
  ds_read_b64_tr_b16 a[214:215], v245 offset:43008
  v_mfma_f32_16x16x32_bf16 v[48:51], a[184:187], a[112:115], v[48:51]
  ds_read_b64_tr_b16 a[176:177], v246 offset:30720
  v_mfma_f32_16x16x32_bf16 v[48:51], a[188:191], a[120:123], v[48:51]
  buffer_load_dwordx4 v135, s[24:27], s50 offen offset:2048 lds
  ds_read_b64_tr_b16 a[178:179], v246 offset:34816
  v_mfma_f32_16x16x32_bf16 v[52:55], a[188:191], a[124:127], v[52:55]
  ds_read_b64_tr_b16 a[180:181], v246 offset:38912
  v_mfma_f32_16x16x32_bf16 v[52:55], a[184:187], a[116:119], v[52:55]
  s_waitcnt lgkmcnt(11)
  ds_read_b64_tr_b16 a[182:183], v246 offset:43008
  v_mfma_f32_16x16x32_bf16 v[60:63], a[192:195], a[116:119], v[60:63]
  ds_read_b64_tr_b16 a[184:185], v247 offset:30720
  v_mfma_f32_16x16x32_bf16 v[60:63], a[196:199], a[124:127], v[60:63]
  buffer_load_dwordx4 a[40:43], v137, s[36:39], s51 offen offset:2048 sc1
  ds_read_b64_tr_b16 a[186:187], v247 offset:34816
  v_mfma_f32_16x16x32_bf16 v[56:59], a[196:199], a[120:123], v[56:59]
  ds_read_b64_tr_b16 a[188:189], v247 offset:38912
  v_mfma_f32_16x16x32_bf16 v[56:59], a[192:195], a[112:115], v[56:59]
  s_waitcnt lgkmcnt(11)
  ds_read_b64_tr_b16 a[190:191], v247 offset:43008
  v_mfma_f32_16x16x32_bf16 v[144:147], a[200:203], a[112:115], v[144:147]
  ds_read_b64_tr_b16 a[192:193], v244 offset:45056
  v_mfma_f32_16x16x32_bf16 v[144:147], a[204:207], a[120:123], v[144:147]
  buffer_load_dwordx4 v136, s[24:27], s50 offen offset:3072 lds
  ds_read_b64_tr_b16 a[194:195], v244 offset:49152
  v_mfma_f32_16x16x32_bf16 v[148:151], a[204:207], a[124:127], v[148:151]
  ds_read_b64_tr_b16 a[196:197], v244 offset:53248
  v_mfma_f32_16x16x32_bf16 v[148:151], a[200:203], a[116:119], v[148:151]
  s_waitcnt lgkmcnt(11)
  ds_read_b64_tr_b16 a[198:199], v244 offset:57344
  v_mfma_f32_16x16x32_bf16 v[156:159], a[208:211], a[116:119], v[156:159]
  ds_read_b64_tr_b16 a[200:201], v245 offset:45056
  v_mfma_f32_16x16x32_bf16 v[156:159], a[212:215], a[124:127], v[156:159]
  buffer_load_dwordx4 a[44:47], v137, s[36:39], s51 offen offset:3072 sc1
  s_cmp_eq_u32 s87, 0
  v_mfma_f32_16x16x32_bf16 v[152:155], a[212:215], a[120:123], v[152:155]
  s_cselect_b32 s74, 50, 43
  s_cmp_eq_u32 s87, 2
  s_cselect_b32 s74, 36, s74
  v_mfma_f32_16x16x32_bf16 v[152:155], a[208:211], a[112:115], v[152:155]
  s_waitcnt lgkmcnt(9)
  s_lshl_b32 s51, s74, 11
  ds_read_b64_tr_b16 a[202:203], v245 offset:49152
  v_mfma_f32_16x16x32_bf16 v[160:163], a[176:179], a[112:115], v[160:163]
  ds_read_b64_tr_b16 a[204:205], v245 offset:53248
  ds_read_b64_tr_b16 a[206:207], v245 offset:57344
  v_mfma_f32_16x16x32_bf16 v[160:163], a[180:183], a[120:123], v[160:163]
  ds_read_b64_tr_b16 a[208:209], v246 offset:45056
  buffer_load_dwordx4 a[48:51], v137, s[36:39], s51 offen offset:0 sc1
  v_mfma_f32_16x16x32_bf16 v[164:167], a[180:183], a[124:127], v[164:167]
  ds_read_b64_tr_b16 a[210:211], v246 offset:49152
  ds_read_b64_tr_b16 a[212:213], v246 offset:53248
  v_mfma_f32_16x16x32_bf16 v[164:167], a[176:179], a[116:119], v[164:167]
  s_waitcnt lgkmcnt(11)
  ds_read_b64_tr_b16 a[214:215], v246 offset:57344
  v_mfma_f32_16x16x32_bf16 v[172:175], a[184:187], a[116:119], v[172:175]
  ds_read_b64_tr_b16 a[176:177], v247 offset:45056
  v_mfma_f32_16x16x32_bf16 v[172:175], a[188:191], a[124:127], v[172:175]
  buffer_load_dwordx4 a[52:55], v137, s[36:39], s51 offen offset:1024 sc1
  s_lshl_b32 s50, s74, 16
  v_mfma_f32_16x16x32_bf16 v[168:171], a[188:191], a[120:123], v[168:171]
  s_add_u32 m0, s70, 45056
  ds_read_b64_tr_b16 a[178:179], v247 offset:49152
  ds_read_b64_tr_b16 a[180:181], v247 offset:53248
  v_mfma_f32_16x16x32_bf16 v[168:171], a[184:187], a[112:115], v[168:171]
  s_waitcnt vmcnt(26) lgkmcnt(11)
  ds_read_b64_tr_b16 a[182:183], v247 offset:57344
  v_mfma_f32_16x16x32_bf16 v[32:35], a[192:195], a[128:131], v[32:35]
  ds_read_b64_tr_b16 a[184:185], v244 offset:47104
  v_mfma_f32_16x16x32_bf16 v[32:35], a[196:199], a[136:139], v[32:35]
  buffer_load_dwordx4 v135, s[24:27], s50 offen offset:2048 lds
  ds_read_b64_tr_b16 a[186:187], v244 offset:51200
  v_mfma_f32_16x16x32_bf16 v[36:39], a[196:199], a[140:143], v[36:39]
  ds_read_b64_tr_b16 a[188:189], v244 offset:55296
  v_mfma_f32_16x16x32_bf16 v[36:39], a[192:195], a[132:135], v[36:39]
  s_waitcnt lgkmcnt(11)
  ds_read_b64_tr_b16 a[190:191], v244 offset:59392
  v_mfma_f32_16x16x32_bf16 v[44:47], a[200:203], a[132:135], v[44:47]
  ds_read_b64_tr_b16 a[192:193], v245 offset:47104
  v_mfma_f32_16x16x32_bf16 v[44:47], a[204:207], a[140:143], v[44:47]
  buffer_load_dwordx4 a[56:59], v137, s[36:39], s51 offen offset:2048 sc1
  ds_read_b64_tr_b16 a[194:195], v245 offset:51200
  v_mfma_f32_16x16x32_bf16 v[40:43], a[204:207], a[136:139], v[40:43]
  ds_read_b64_tr_b16 a[196:197], v245 offset:55296
  v_mfma_f32_16x16x32_bf16 v[40:43], a[200:203], a[128:131], v[40:43]
  s_waitcnt vmcnt(23) lgkmcnt(11)
  s_barrier
  ds_read_b64_tr_b16 a[198:199], v245 offset:59392
  v_mfma_f32_16x16x32_bf16 v[48:51], a[208:211], a[128:131], v[48:51]
  ds_read_b64_tr_b16 a[200:201], v246 offset:47104
  v_mfma_f32_16x16x32_bf16 v[48:51], a[212:215], a[136:139], v[48:51]
  buffer_load_dwordx4 v136, s[24:27], s50 offen offset:3072 lds
  ds_read_b64_tr_b16 a[202:203], v246 offset:51200
  v_mfma_f32_16x16x32_bf16 v[52:55], a[212:215], a[140:143], v[52:55]
  ds_read_b64_tr_b16 a[204:205], v246 offset:55296
  v_mfma_f32_16x16x32_bf16 v[52:55], a[208:211], a[132:135], v[52:55]
  s_waitcnt lgkmcnt(11)
  ds_read_b64_tr_b16 a[206:207], v246 offset:59392
  v_mfma_f32_16x16x32_bf16 v[60:63], a[176:179], a[132:135], v[60:63]
  ds_read_b64_tr_b16 a[208:209], v247 offset:47104
  v_mfma_f32_16x16x32_bf16 v[60:63], a[180:183], a[140:143], v[60:63]
  buffer_load_dwordx4 a[60:63], v137, s[36:39], s51 offen offset:3072 sc1
  s_cmp_eq_u32 s87, 1
  v_mfma_f32_16x16x32_bf16 v[56:59], a[180:183], a[136:139], v[56:59]
  s_cselect_b32 s75, 54, 47
  s_cmp_eq_u32 s87, 3
  s_cselect_b32 s75, 40, s75
  v_mfma_f32_16x16x32_bf16 v[56:59], a[176:179], a[128:131], v[56:59]
  s_waitcnt lgkmcnt(9)
  s_lshl_b32 s51, s75, 11
  ds_read_b64_tr_b16 a[210:211], v247 offset:51200
  v_mfma_f32_16x16x32_bf16 v[144:147], a[184:187], a[128:131], v[144:147]
  ds_read_b64_tr_b16 a[212:213], v247 offset:55296
  ds_read_b64_tr_b16 a[214:215], v247 offset:59392
  v_mfma_f32_16x16x32_bf16 v[144:147], a[188:191], a[136:139], v[144:147]
  ds_read_b64_tr_b16 a[176:177], v244 offset:63488
  buffer_load_dwordx4 a[64:67], v137, s[36:39], s51 offen offset:0 sc1
  v_mfma_f32_16x16x32_bf16 v[148:151], a[188:191], a[140:143], v[148:151]
  ds_read_b64_tr_b16 a[178:179], v248 offset:2048
  ds_read_b64_tr_b16 a[180:181], v248 offset:6144
  v_mfma_f32_16x16x32_bf16 v[148:151], a[184:187], a[132:135], v[148:151]
  s_waitcnt lgkmcnt(11)
  ds_read_b64_tr_b16 a[182:183], v248 offset:10240
  v_mfma_f32_16x16x32_bf16 v[156:159], a[192:195], a[132:135], v[156:159]
  ds_read_b64_tr_b16 a[184:185], v245 offset:63488
  v_mfma_f32_16x16x32_bf16 v[156:159], a[196:199], a[140:143], v[156:159]
  buffer_load_dwordx4 a[68:71], v137, s[36:39], s51 offen offset:1024 sc1
  s_lshl_b32 s50, s75, 16
  v_mfma_f32_16x16x32_bf16 v[152:155], a[196:199], a[136:139], v[152:155]
  s_add_u32 m0, s70, 61440
  ds_read_b64_tr_b16 a[186:187], v249 offset:2048
  ds_read_b64_tr_b16 a[188:189], v249 offset:6144
  v_mfma_f32_16x16x32_bf16 v[152:155], a[192:195], a[128:131], v[152:155]
  s_waitcnt vmcnt(21) lgkmcnt(11)
  s_barrier
  ds_read_b64_tr_b16 a[190:191], v249 offset:10240
  v_mfma_f32_16x16x32_bf16 v[160:163], a[200:203], a[128:131], v[160:163]
  ds_read_b64_tr_b16 a[192:193], v246 offset:63488
  v_mfma_f32_16x16x32_bf16 v[160:163], a[204:207], a[136:139], v[160:163]
  buffer_load_dwordx4 v135, s[24:27], s50 offen offset:2048 lds
  ds_read_b64_tr_b16 a[194:195], v250 offset:2048
  v_mfma_f32_16x16x32_bf16 v[164:167], a[204:207], a[140:143], v[164:167]
  ds_read_b64_tr_b16 a[196:197], v250 offset:6144
  v_mfma_f32_16x16x32_bf16 v[164:167], a[200:203], a[132:135], v[164:167]
  s_waitcnt lgkmcnt(11)
  ds_read_b64_tr_b16 a[198:199], v250 offset:10240
  v_mfma_f32_16x16x32_bf16 v[172:175], a[208:211], a[132:135], v[172:175]
  buffer_load_dwordx4 a[72:75], v137, s[36:39], s51 offen offset:2048 sc1
  ds_read_b64_tr_b16 a[200:201], v247 offset:63488
  v_mfma_f32_16x16x32_bf16 v[172:175], a[212:215], a[140:143], v[172:175]
  ds_read_b64_tr_b16 a[202:203], v251 offset:2048
  v_mfma_f32_16x16x32_bf16 v[168:171], a[212:215], a[136:139], v[168:171]
  ds_read_b64_tr_b16 a[204:205], v251 offset:6144
  v_mfma_f32_16x16x32_bf16 v[168:171], a[208:211], a[128:131], v[168:171]
  s_waitcnt vmcnt(28) lgkmcnt(11)
  ds_read_b64_tr_b16 a[206:207], v251 offset:10240
  v_mfma_f32_16x16x32_bf16 v[144:147], a[176:179], a[216:219], v[144:147]
  buffer_load_dwordx4 v136, s[24:27], s50 offen offset:3072 lds
  ds_read_b64_tr_b16 a[208:209], v248 offset:14336
  v_mfma_f32_16x16x32_bf16 v[144:147], a[180:183], a[224:227], v[144:147]
  ds_read_b64_tr_b16 a[210:211], v248 offset:18432
  v_mfma_f32_16x16x32_bf16 v[148:151], a[180:183], a[228:231], v[148:151]
  ds_read_b64_tr_b16 a[212:213], v248 offset:22528
  v_mfma_f32_16x16x32_bf16 v[148:151], a[176:179], a[220:223], v[148:151]
  s_waitcnt lgkmcnt(11)
  ds_read_b64_tr_b16 a[214:215], v248 offset:26624
  v_mfma_f32_16x16x32_bf16 v[156:159], a[184:187], a[220:223], v[156:159]
  buffer_load_dwordx4 a[76:79], v137, s[36:39], s51 offen offset:3072 sc1
  s_cmp_eq_u32 s87, 0
  v_mfma_f32_16x16x32_bf16 v[156:159], a[188:191], a[228:231], v[156:159]
  s_cselect_b32 s79, 43, 50
  s_lshl_b32 s51, s79, 11
  ds_read_b64_tr_b16 a[176:177], v249 offset:14336
  v_mfma_f32_16x16x32_bf16 v[152:155], a[188:191], a[224:227], v[152:155]
  ds_read_b64_tr_b16 a[178:179], v249 offset:18432
  ds_read_b64_tr_b16 a[180:181], v249 offset:22528
  v_mfma_f32_16x16x32_bf16 v[152:155], a[184:187], a[216:219], v[152:155]
  s_waitcnt vmcnt(19) lgkmcnt(11)
  s_barrier
  ds_read_b64_tr_b16 a[182:183], v249 offset:26624
  v_mfma_f32_16x16x32_bf16 v[160:163], a[192:195], a[216:219], v[160:163]
  buffer_load_dwordx4 a[80:83], v137, s[36:39], s51 offen offset:0 sc1
  ds_read_b64_tr_b16 a[184:185], v250 offset:14336
  v_mfma_f32_16x16x32_bf16 v[160:163], a[196:199], a[224:227], v[160:163]
  ds_read_b64_tr_b16 a[186:187], v250 offset:18432
  v_mfma_f32_16x16x32_bf16 v[164:167], a[196:199], a[228:231], v[164:167]
  ds_read_b64_tr_b16 a[188:189], v250 offset:22528
  v_mfma_f32_16x16x32_bf16 v[164:167], a[192:195], a[220:223], v[164:167]
  s_waitcnt lgkmcnt(11)
  ds_read_b64_tr_b16 a[190:191], v250 offset:26624
  v_mfma_f32_16x16x32_bf16 v[172:175], a[200:203], a[220:223], v[172:175]
  buffer_load_dwordx4 a[84:87], v137, s[36:39], s51 offen offset:1024 sc1
  s_lshl_b32 s50, s79, 16
  v_mfma_f32_16x16x32_bf16 v[172:175], a[204:207], a[228:231], v[172:175]
  s_add_u32 m0, s70, 77824
  ds_read_b64_tr_b16 a[192:193], v251 offset:14336
  ds_read_b64_tr_b16 a[194:195], v251 offset:18432
  v_mfma_f32_16x16x32_bf16 v[168:171], a[204:207], a[224:227], v[168:171]
  ds_read_b64_tr_b16 a[196:197], v251 offset:22528
  v_mfma_f32_16x16x32_bf16 v[168:171], a[200:203], a[216:219], v[168:171]
  s_waitcnt vmcnt(26) lgkmcnt(11)
  ds_read_b64_tr_b16 a[198:199], v251 offset:26624
  v_mfma_f32_16x16x32_bf16 v[144:147], a[208:211], a[0:3], v[144:147]
  buffer_load_dwordx4 v135, s[24:27], s50 offen offset:2048 lds
  ds_read_b64_tr_b16 a[200:201], v240 offset:14336
  v_mfma_f32_16x16x32_bf16 v[144:147], a[212:215], a[8:11], v[144:147]
  ds_read_b64_tr_b16 a[202:203], v240 offset:18432
  v_mfma_f32_16x16x32_bf16 v[148:151], a[212:215], a[12:15], v[148:151]
  ds_read_b64_tr_b16 a[204:205], v240 offset:22528
  v_mfma_f32_16x16x32_bf16 v[148:151], a[208:211], a[4:7], v[148:151]
  s_waitcnt lgkmcnt(11)
  ds_read_b64_tr_b16 a[206:207], v240 offset:26624
  v_mfma_f32_16x16x32_bf16 v[156:159], a[176:179], a[4:7], v[156:159]
  buffer_load_dwordx4 a[88:91], v137, s[36:39], s51 offen offset:2048 sc1
  ds_read_b64_tr_b16 a[208:209], v241 offset:14336
  v_mfma_f32_16x16x32_bf16 v[156:159], a[180:183], a[12:15], v[156:159]
  ds_read_b64_tr_b16 a[210:211], v241 offset:18432
  v_mfma_f32_16x16x32_bf16 v[152:155], a[180:183], a[8:11], v[152:155]
  ds_read_b64_tr_b16 a[212:213], v241 offset:22528
  v_mfma_f32_16x16x32_bf16 v[152:155], a[176:179], a[0:3], v[152:155]
  s_waitcnt vmcnt(17) lgkmcnt(11)
  s_barrier
  ds_read_b64_tr_b16 a[214:215], v241 offset:26624
  v_mfma_f32_16x16x32_bf16 v[160:163], a[184:187], a[0:3], v[160:163]
  buffer_load_dwordx4 v136, s[24:27], s50 offen offset:3072 lds
  ds_read_b64_tr_b16 a[176:177], v242 offset:14336
  v_mfma_f32_16x16x32_bf16 v[160:163], a[188:191], a[8:11], v[160:163]
  ds_read_b64_tr_b16 a[178:179], v242 offset:18432
  v_mfma_f32_16x16x32_bf16 v[164:167], a[188:191], a[12:15], v[164:167]
  ds_read_b64_tr_b16 a[180:181], v242 offset:22528
  v_mfma_f32_16x16x32_bf16 v[164:167], a[184:187], a[4:7], v[164:167]
  s_waitcnt lgkmcnt(11)
  ds_read_b64_tr_b16 a[182:183], v242 offset:26624
  v_mfma_f32_16x16x32_bf16 v[172:175], a[192:195], a[4:7], v[172:175]
  buffer_load_dwordx4 a[92:95], v137, s[36:39], s51 offen offset:3072 sc1
  s_cmp_eq_u32 s87, 1
  v_mfma_f32_16x16x32_bf16 v[172:175], a[196:199], a[12:15], v[172:175]
  s_cselect_b32 s80, 47, 54
  s_lshl_b32 s51, s80, 11
  ds_read_b64_tr_b16 a[184:185], v243 offset:14336
  v_mfma_f32_16x16x32_bf16 v[168:171], a[196:199], a[8:11], v[168:171]
  ds_read_b64_tr_b16 a[186:187], v243 offset:18432
  ds_read_b64_tr_b16 a[188:189], v243 offset:22528
  v_mfma_f32_16x16x32_bf16 v[168:171], a[192:195], a[0:3], v[168:171]
  s_waitcnt vmcnt(24) lgkmcnt(11)
  ds_read_b64_tr_b16 a[190:191], v243 offset:26624
  v_mfma_f32_16x16x32_bf16 v[144:147], a[200:203], a[16:19], v[144:147]
  buffer_load_dwordx4 a[96:99], v137, s[36:39], s51 offen offset:0 sc1
  ds_read_b64_tr_b16 a[192:193], v240 offset:30720
  v_mfma_f32_16x16x32_bf16 v[144:147], a[204:207], a[24:27], v[144:147]
  ds_read_b64_tr_b16 a[194:195], v240 offset:34816
  v_mfma_f32_16x16x32_bf16 v[148:151], a[204:207], a[28:31], v[148:151]
  ds_read_b64_tr_b16 a[196:197], v240 offset:38912
  v_mfma_f32_16x16x32_bf16 v[148:151], a[200:203], a[20:23], v[148:151]
  s_waitcnt lgkmcnt(11)
  ds_read_b64_tr_b16 a[198:199], v240 offset:43008
  v_mfma_f32_16x16x32_bf16 v[156:159], a[208:211], a[20:23], v[156:159]
  buffer_load_dwordx4 a[100:103], v137, s[36:39], s51 offen offset:1024 sc1
  s_lshl_b32 s50, s80, 16
  v_mfma_f32_16x16x32_bf16 v[156:159], a[212:215], a[28:31], v[156:159]
  s_add_u32 m0, s70, 94208
  ds_read_b64_tr_b16 a[200:201], v241 offset:30720
  ds_read_b64_tr_b16 a[202:203], v241 offset:34816
  v_mfma_f32_16x16x32_bf16 v[152:155], a[212:215], a[24:27], v[152:155]
  ds_read_b64_tr_b16 a[204:205], v241 offset:38912
  v_mfma_f32_16x16x32_bf16 v[152:155], a[208:211], a[16:19], v[152:155]
  s_waitcnt vmcnt(15) lgkmcnt(11)
  s_barrier
  ds_read_b64_tr_b16 a[206:207], v241 offset:43008
  v_mfma_f32_16x16x32_bf16 v[160:163], a[176:179], a[16:19], v[160:163]
  buffer_load_dwordx4 v135, s[24:27], s50 offen offset:2048 lds
  ds_read_b64_tr_b16 a[208:209], v242 offset:30720
  v_mfma_f32_16x16x32_bf16 v[160:163], a[180:183], a[24:27], v[160:163]
  ds_read_b64_tr_b16 a[210:211], v242 offset:34816
  v_mfma_f32_16x16x32_bf16 v[164:167], a[180:183], a[28:31], v[164:167]
Hb0_1:
  s_cbranch_execz Rb
  ds_read_b64_tr_b16 a[212:213], v242 offset:38912
  v_mfma_f32_16x16x32_bf16 v[164:167], a[176:179], a[20:23], v[164:167]
  s_waitcnt lgkmcnt(11)
  ds_read_b64_tr_b16 a[214:215], v242 offset:43008
  v_mfma_f32_16x16x32_bf16 v[172:175], a[184:187], a[20:23], v[172:175]
  buffer_load_dwordx4 a[104:107], v137, s[36:39], s51 offen offset:2048 sc1
  ds_read_b64_tr_b16 a[176:177], v243 offset:30720
  v_mfma_f32_16x16x32_bf16 v[172:175], a[188:191], a[28:31], v[172:175]
  ds_read_b64_tr_b16 a[178:179], v243 offset:34816
  v_mfma_f32_16x16x32_bf16 v[168:171], a[188:191], a[24:27], v[168:171]
  ds_read_b64_tr_b16 a[180:181], v243 offset:38912
  v_mfma_f32_16x16x32_bf16 v[168:171], a[184:187], a[16:19], v[168:171]
  s_waitcnt vmcnt(22) lgkmcnt(11)
  ds_read_b64_tr_b16 a[182:183], v243 offset:43008
  v_mfma_f32_16x16x32_bf16 v[144:147], a[192:195], a[32:35], v[144:147]
  buffer_load_dwordx4 v136, s[24:27], s50 offen offset:3072 lds
  ds_read_b64_tr_b16 a[184:185], v240 offset:47104
  v_mfma_f32_16x16x32_bf16 v[144:147], a[196:199], a[40:43], v[144:147]
  ds_read_b64_tr_b16 a[186:187], v240 offset:51200
  v_mfma_f32_16x16x32_bf16 v[148:151], a[196:199], a[44:47], v[148:151]
  ds_read_b64_tr_b16 a[188:189], v240 offset:55296
  v_mfma_f32_16x16x32_bf16 v[148:151], a[192:195], a[36:39], v[148:151]
  s_waitcnt lgkmcnt(11)
  ds_read_b64_tr_b16 a[190:191], v240 offset:59392
  v_mfma_f32_16x16x32_bf16 v[156:159], a[200:203], a[36:39], v[156:159]
  buffer_load_dwordx4 a[108:111], v137, s[36:39], s51 offen offset:3072 sc1
  s_lshl_b32 s50, s69, 16
  v_mfma_f32_16x16x32_bf16 v[156:159], a[204:207], a[44:47], v[156:159]
  s_add_u32 m0, s70, 126976
  ds_read_b64_tr_b16 a[192:193], v241 offset:47104
  ds_read_b64_tr_b16 a[194:195], v241 offset:51200
  v_mfma_f32_16x16x32_bf16 v[152:155], a[204:207], a[40:43], v[152:155]
  ds_read_b64_tr_b16 a[196:197], v241 offset:55296
  v_mfma_f32_16x16x32_bf16 v[152:155], a[200:203], a[32:35], v[152:155]
  s_waitcnt vmcnt(13) lgkmcnt(11)
  s_barrier
  ds_read_b64_tr_b16 a[198:199], v241 offset:59392
  v_mfma_f32_16x16x32_bf16 v[160:163], a[208:211], a[32:35], v[160:163]
  buffer_load_dwordx4 v133, s[24:27], s50 offen offset:0 lds
  ds_read_b64_tr_b16 a[200:201], v242 offset:47104
  v_mfma_f32_16x16x32_bf16 v[160:163], a[212:215], a[40:43], v[160:163]
  ds_read_b64_tr_b16 a[202:203], v242 offset:51200
  v_mfma_f32_16x16x32_bf16 v[164:167], a[212:215], a[44:47], v[164:167]
  ds_read_b64_tr_b16 a[204:205], v242 offset:55296
  v_mfma_f32_16x16x32_bf16 v[164:167], a[208:211], a[36:39], v[164:167]
  s_waitcnt lgkmcnt(11)
  ds_read_b64_tr_b16 a[206:207], v242 offset:59392
  v_mfma_f32_16x16x32_bf16 v[172:175], a[176:179], a[36:39], v[172:175]
  buffer_load_dwordx4 v134, s[24:27], s50 offen offset:1024 lds
  s_lshl_b32 s50, s71, 16
  v_mfma_f32_16x16x32_bf16 v[172:175], a[180:183], a[44:47], v[172:175]
  s_add_u32 m0, s70, 143360
  ds_read_b64_tr_b16 a[208:209], v243 offset:47104
  ds_read_b64_tr_b16 a[210:211], v243 offset:51200
  v_mfma_f32_16x16x32_bf16 v[168:171], a[180:183], a[40:43], v[168:171]
  ds_read_b64_tr_b16 a[212:213], v243 offset:55296
  v_mfma_f32_16x16x32_bf16 v[168:171], a[176:179], a[32:35], v[168:171]
  s_waitcnt vmcnt(20) lgkmcnt(11)
  ds_read_b64_tr_b16 a[214:215], v243 offset:59392
  v_mfma_f32_16x16x32_bf16 v[144:147], a[184:187], a[48:51], v[144:147]
  buffer_load_dwordx4 v133, s[24:27], s50 offen offset:0 lds
  ds_read_b64_tr_b16 a[176:177], v240 offset:63488
  v_mfma_f32_16x16x32_bf16 v[144:147], a[188:191], a[56:59], v[144:147]
  ds_read_b64_tr_b16 a[178:179], v244 offset:2048
  v_mfma_f32_16x16x32_bf16 v[148:151], a[188:191], a[60:63], v[148:151]
  ds_read_b64_tr_b16 a[180:181], v244 offset:6144
  v_mfma_f32_16x16x32_bf16 v[148:151], a[184:187], a[52:55], v[148:151]
  s_waitcnt lgkmcnt(11)
  ds_read_b64_tr_b16 a[182:183], v244 offset:10240
  v_mfma_f32_16x16x32_bf16 v[156:159], a[192:195], a[52:55], v[156:159]
  buffer_load_dwordx4 v134, s[24:27], s50 offen offset:1024 lds
  s_lshl_b32 s50, s72, 16
  v_mfma_f32_16x16x32_bf16 v[156:159], a[196:199], a[60:63], v[156:159]
  s_add_u32 m0, s70, 12288
  ds_read_b64_tr_b16 a[184:185], v241 offset:63488
  ds_read_b64_tr_b16 a[186:187], v245 offset:2048
  v_mfma_f32_16x16x32_bf16 v[152:155], a[196:199], a[56:59], v[152:155]
  ds_read_b64_tr_b16 a[188:189], v245 offset:6144
  v_mfma_f32_16x16x32_bf16 v[152:155], a[192:195], a[48:51], v[152:155]
  s_waitcnt vmcnt(11) lgkmcnt(11)
  s_barrier
  ds_read_b64_tr_b16 a[190:191], v245 offset:10240
  v_mfma_f32_16x16x32_bf16 v[160:163], a[200:203], a[48:51], v[160:163]
  buffer_load_dwordx4 v133, s[24:27], s50 offen offset:0 lds
  ds_read_b64_tr_b16 a[192:193], v242 offset:63488
  v_mfma_f32_16x16x32_bf16 v[160:163], a[204:207], a[56:59], v[160:163]
  ds_read_b64_tr_b16 a[194:195], v246 offset:2048
  v_mfma_f32_16x16x32_bf16 v[164:167], a[204:207], a[60:63], v[164:167]
  ds_read_b64_tr_b16 a[196:197], v246 offset:6144
  v_mfma_f32_16x16x32_bf16 v[164:167], a[200:203], a[52:55], v[164:167]
  s_waitcnt lgkmcnt(11)
  ds_read_b64_tr_b16 a[198:199], v246 offset:10240
  v_mfma_f32_16x16x32_bf16 v[172:175], a[208:211], a[52:55], v[172:175]
  buffer_load_dwordx4 v134, s[24:27], s50 offen offset:1024 lds
  s_lshl_b32 s50, s73, 16
  v_mfma_f32_16x16x32_bf16 v[172:175], a[212:215], a[60:63], v[172:175]
  s_add_u32 m0, s70, 28672
  ds_read_b64_tr_b16 a[200:201], v243 offset:63488
  ds_read_b64_tr_b16 a[202:203], v247 offset:2048
  v_mfma_f32_16x16x32_bf16 v[168:171], a[212:215], a[56:59], v[168:171]
  ds_read_b64_tr_b16 a[204:205], v247 offset:6144
  v_mfma_f32_16x16x32_bf16 v[168:171], a[208:211], a[48:51], v[168:171]
  s_waitcnt vmcnt(18) lgkmcnt(11)
  ds_read_b64_tr_b16 a[206:207], v247 offset:10240
  v_mfma_f32_16x16x32_bf16 v[144:147], a[176:179], a[64:67], v[144:147]
  buffer_load_dwordx4 v133, s[24:27], s50 offen offset:0 lds
  ds_read_b64_tr_b16 a[208:209], v244 offset:14336
  v_mfma_f32_16x16x32_bf16 v[144:147], a[180:183], a[72:75], v[144:147]
  ds_read_b64_tr_b16 a[210:211], v244 offset:18432
  v_mfma_f32_16x16x32_bf16 v[148:151], a[180:183], a[76:79], v[148:151]
  ds_read_b64_tr_b16 a[212:213], v244 offset:22528
  v_mfma_f32_16x16x32_bf16 v[148:151], a[176:179], a[68:71], v[148:151]
  s_waitcnt lgkmcnt(11)
  ds_read_b64_tr_b16 a[214:215], v244 offset:26624
  v_mfma_f32_16x16x32_bf16 v[156:159], a[184:187], a[68:71], v[156:159]
  buffer_load_dwordx4 v134, s[24:27], s50 offen offset:1024 lds
  s_lshl_b32 s50, s74, 16
  v_mfma_f32_16x16x32_bf16 v[156:159], a[188:191], a[76:79], v[156:159]
  s_add_u32 m0, s70, 45056
  ds_read_b64_tr_b16 a[176:177], v245 offset:14336
  ds_read_b64_tr_b16 a[178:179], v245 offset:18432
  v_mfma_f32_16x16x32_bf16 v[152:155], a[188:191], a[72:75], v[152:155]
  ds_read_b64_tr_b16 a[180:181], v245 offset:22528
  v_mfma_f32_16x16x32_bf16 v[152:155], a[184:187], a[64:67], v[152:155]
  s_waitcnt vmcnt(9) lgkmcnt(11)
  s_barrier
  ds_read_b64_tr_b16 a[182:183], v245 offset:26624
  v_mfma_f32_16x16x32_bf16 v[160:163], a[192:195], a[64:67], v[160:163]
  buffer_load_dwordx4 v133, s[24:27], s50 offen offset:0 lds
  ds_read_b64_tr_b16 a[184:185], v246 offset:14336
  v_mfma_f32_16x16x32_bf16 v[160:163], a[196:199], a[72:75], v[160:163]
  ds_read_b64_tr_b16 a[186:187], v246 offset:18432
  v_mfma_f32_16x16x32_bf16 v[164:167], a[196:199], a[76:79], v[164:167]
  ds_read_b64_tr_b16 a[188:189], v246 offset:22528
  v_mfma_f32_16x16x32_bf16 v[164:167], a[192:195], a[68:71], v[164:167]
  s_waitcnt lgkmcnt(11)
  ds_read_b64_tr_b16 a[190:191], v246 offset:26624
  v_mfma_f32_16x16x32_bf16 v[172:175], a[200:203], a[68:71], v[172:175]
  buffer_load_dwordx4 v134, s[24:27], s50 offen offset:1024 lds
  s_lshl_b32 s50, s75, 16
  v_mfma_f32_16x16x32_bf16 v[172:175], a[204:207], a[76:79], v[172:175]
  s_add_u32 m0, s70, 61440
  ds_read_b64_tr_b16 a[192:193], v247 offset:14336
  ds_read_b64_tr_b16 a[194:195], v247 offset:18432
  v_mfma_f32_16x16x32_bf16 v[168:171], a[204:207], a[72:75], v[168:171]
  ds_read_b64_tr_b16 a[196:197], v247 offset:22528
  v_mfma_f32_16x16x32_bf16 v[168:171], a[200:203], a[64:67], v[168:171]
  s_waitcnt vmcnt(16) lgkmcnt(11)
  ds_read_b64_tr_b16 a[198:199], v247 offset:26624
  v_mfma_f32_16x16x32_bf16 v[144:147], a[208:211], a[80:83], v[144:147]
  buffer_load_dwordx4 v133, s[24:27], s50 offen offset:0 lds
  ds_read_b64_tr_b16 a[200:201], v244 offset:30720
  v_mfma_f32_16x16x32_bf16 v[144:147], a[212:215], a[88:91], v[144:147]
  ds_read_b64_tr_b16 a[202:203], v244 offset:34816
  v_mfma_f32_16x16x32_bf16 v[148:151], a[212:215], a[92:95], v[148:151]
  ds_read_b64_tr_b16 a[204:205], v244 offset:38912
  v_mfma_f32_16x16x32_bf16 v[148:151], a[208:211], a[84:87], v[148:151]
  s_waitcnt lgkmcnt(11)
  ds_read_b64_tr_b16 a[206:207], v244 offset:43008
  v_mfma_f32_16x16x32_bf16 v[156:159], a[176:179], a[84:87], v[156:159]
  buffer_load_dwordx4 v134, s[24:27], s50 offen offset:1024 lds
  s_lshl_b32 s50, s79, 16
  v_mfma_f32_16x16x32_bf16 v[156:159], a[180:183], a[92:95], v[156:159]
  s_add_u32 m0, s70, 77824
  ds_read_b64_tr_b16 a[208:209], v245 offset:30720
  ds_read_b64_tr_b16 a[210:211], v245 offset:34816
  v_mfma_f32_16x16x32_bf16 v[152:155], a[180:183], a[88:91], v[152:155]
  ds_read_b64_tr_b16 a[212:213], v245 offset:38912
  v_mfma_f32_16x16x32_bf16 v[152:155], a[176:179], a[80:83], v[152:155]
  s_waitcnt vmcnt(10) lgkmcnt(11)
  s_barrier
  ds_read_b64_tr_b16 a[214:215], v245 offset:43008
  v_mfma_f32_16x16x32_bf16 v[160:163], a[184:187], a[80:83], v[160:163]
  buffer_load_dwordx4 v133, s[24:27], s50 offen offset:0 lds
  ds_read_b64_tr_b16 a[176:177], v246 offset:30720
  v_mfma_f32_16x16x32_bf16 v[160:163], a[188:191], a[88:91], v[160:163]
  ds_read_b64_tr_b16 a[178:179], v246 offset:34816
  v_mfma_f32_16x16x32_bf16 v[164:167], a[188:191], a[92:95], v[164:167]
  ds_read_b64_tr_b16 a[180:181], v246 offset:38912
  v_mfma_f32_16x16x32_bf16 v[164:167], a[184:187], a[84:87], v[164:167]
  s_waitcnt lgkmcnt(11)
  ds_read_b64_tr_b16 a[182:183], v246 offset:43008
  v_mfma_f32_16x16x32_bf16 v[172:175], a[192:195], a[84:87], v[172:175]
  buffer_load_dwordx4 v134, s[24:27], s50 offen offset:1024 lds
  s_lshl_b32 s50, s80, 16
  v_mfma_f32_16x16x32_bf16 v[172:175], a[196:199], a[92:95], v[172:175]
  s_add_u32 m0, s70, 94208
  ds_read_b64_tr_b16 a[184:185], v247 offset:30720
  ds_read_b64_tr_b16 a[186:187], v247 offset:34816
  v_mfma_f32_16x16x32_bf16 v[168:171], a[196:199], a[88:91], v[168:171]
  ds_read_b64_tr_b16 a[188:189], v247 offset:38912
  v_mfma_f32_16x16x32_bf16 v[168:171], a[192:195], a[80:83], v[168:171]
  s_waitcnt vmcnt(14) lgkmcnt(11)
  ds_read_b64_tr_b16 a[190:191], v247 offset:43008
  v_mfma_f32_16x16x32_bf16 v[144:147], a[200:203], a[96:99], v[144:147]
  buffer_load_dwordx4 v133, s[24:27], s50 offen offset:0 lds
  ds_read_b64_tr_b16 a[192:193], v244 offset:61440
  v_mfma_f32_16x16x32_bf16 v[144:147], a[204:207], a[104:107], v[144:147]
  ds_read_b64_tr_b16 a[194:195], v248 offset:0
  v_mfma_f32_16x16x32_bf16 v[148:151], a[204:207], a[108:111], v[148:151]
  ds_read_b64_tr_b16 a[196:197], v248 offset:4096
  v_mfma_f32_16x16x32_bf16 v[148:151], a[200:203], a[100:103], v[148:151]
  s_waitcnt lgkmcnt(11)
  ds_read_b64_tr_b16 a[198:199], v248 offset:8192
  v_mfma_f32_16x16x32_bf16 v[156:159], a[208:211], a[100:103], v[156:159]
  buffer_load_dwordx4 v134, s[24:27], s50 offen offset:1024 lds
  ds_read_b64_tr_b16 a[200:201], v245 offset:61440
  v_mfma_f32_16x16x32_bf16 v[156:159], a[212:215], a[108:111], v[156:159]
  ds_read_b64_tr_b16 a[202:203], v249 offset:0
  v_mfma_f32_16x16x32_bf16 v[152:155], a[212:215], a[104:107], v[152:155]
  ds_read_b64_tr_b16 a[204:205], v249 offset:4096
  v_mfma_f32_16x16x32_bf16 v[152:155], a[208:211], a[96:99], v[152:155]
  s_waitcnt vmcnt(12) lgkmcnt(11)
  s_barrier
  ds_read_b64_tr_b16 a[206:207], v249 offset:8192
  v_mfma_f32_16x16x32_bf16 v[160:163], a[176:179], a[96:99], v[160:163]
  ds_read_b64_tr_b16 a[208:209], v246 offset:61440
  buffer_store_dwordx4 v[144:147], v0, s[36:39], s61 offen offset:0 sc1
  v_mfma_f32_16x16x32_bf16 v[160:163], a[180:183], a[104:107], v[160:163]
  buffer_store_dwordx4 v[148:151], v0, s[36:39], s61 offen offset:1024 sc1
  ds_read_b64_tr_b16 a[210:211], v250 offset:0
  v_mfma_f32_16x16x32_bf16 v[164:167], a[180:183], a[108:111], v[164:167]
  ds_read_b64_tr_b16 a[212:213], v250 offset:4096
  v_mfma_f32_16x16x32_bf16 v[164:167], a[176:179], a[100:103], v[164:167]
  s_waitcnt lgkmcnt(11)
  ds_read_b64_tr_b16 a[214:215], v250 offset:8192
  v_mfma_f32_16x16x32_bf16 v[172:175], a[184:187], a[100:103], v[172:175]
  ds_read_b64_tr_b16 a[176:177], v247 offset:61440
  buffer_store_dwordx4 v[152:155], v0, s[36:39], s61 offen offset:2048 sc1
  v_mfma_f32_16x16x32_bf16 v[172:175], a[188:191], a[108:111], v[172:175]
  buffer_store_dwordx4 v[156:159], v0, s[36:39], s61 offen offset:3072 sc1
  ds_read_b64_tr_b16 a[178:179], v251 offset:0
  v_mfma_f32_16x16x32_bf16 v[168:171], a[188:191], a[104:107], v[168:171]
  ds_read_b64_tr_b16 a[180:181], v251 offset:4096
  v_mfma_f32_16x16x32_bf16 v[168:171], a[184:187], a[96:99], v[168:171]
  s_waitcnt lgkmcnt(11)
  ds_read_b64_tr_b16 a[182:183], v251 offset:8192
  v_mfma_f32_16x16x32_bf16 v[32:35], a[192:195], a[216:219], v[32:35]
  ds_read_b64_tr_b16 a[184:185], v248 offset:12288
  buffer_store_dwordx4 v[160:163], v0, s[36:39], s62 offen offset:0 sc1
  v_mfma_f32_16x16x32_bf16 v[32:35], a[196:199], a[224:227], v[32:35]
  buffer_store_dwordx4 v[164:167], v0, s[36:39], s62 offen offset:1024 sc1
  ds_read_b64_tr_b16 a[186:187], v248 offset:16384
  v_mfma_f32_16x16x32_bf16 v[36:39], a[196:199], a[228:231], v[36:39]
  ds_read_b64_tr_b16 a[188:189], v248 offset:20480
  v_mfma_f32_16x16x32_bf16 v[36:39], a[192:195], a[220:223], v[36:39]
  s_waitcnt lgkmcnt(11)
  ds_read_b64_tr_b16 a[190:191], v248 offset:24576
  v_mfma_f32_16x16x32_bf16 v[44:47], a[200:203], a[220:223], v[44:47]
  ds_read_b64_tr_b16 a[192:193], v249 offset:12288
  buffer_store_dwordx4 v[168:171], v0, s[36:39], s62 offen offset:2048 sc1
  v_mfma_f32_16x16x32_bf16 v[44:47], a[204:207], a[228:231], v[44:47]
  buffer_store_dwordx4 v[172:175], v0, s[36:39], s62 offen offset:3072 sc1
  ds_read_b64_tr_b16 a[194:195], v249 offset:16384
  v_mfma_f32_16x16x32_bf16 v[40:43], a[204:207], a[224:227], v[40:43]
  ds_read_b64_tr_b16 a[196:197], v249 offset:20480
  v_mfma_f32_16x16x32_bf16 v[40:43], a[200:203], a[216:219], v[40:43]
  s_waitcnt vmcnt(18) lgkmcnt(11)
  s_barrier
  ds_read_b64_tr_b16 a[198:199], v249 offset:24576
  v_mfma_f32_16x16x32_bf16 v[48:51], a[208:211], a[216:219], v[48:51]
  ds_read_b64_tr_b16 a[200:201], v250 offset:12288
  v_mfma_f32_16x16x32_bf16 v[48:51], a[212:215], a[224:227], v[48:51]
  ds_read_b64_tr_b16 a[202:203], v250 offset:16384
  v_mfma_f32_16x16x32_bf16 v[52:55], a[212:215], a[228:231], v[52:55]
  ds_read_b64_tr_b16 a[204:205], v250 offset:20480
  v_mfma_f32_16x16x32_bf16 v[52:55], a[208:211], a[220:223], v[52:55]
  s_waitcnt lgkmcnt(11)
  ds_read_b64_tr_b16 a[206:207], v250 offset:24576
  v_mfma_f32_16x16x32_bf16 v[60:63], a[176:179], a[220:223], v[60:63]
  ds_read_b64_tr_b16 a[208:209], v251 offset:12288
  v_mfma_f32_16x16x32_bf16 v[60:63], a[180:183], a[228:231], v[60:63]
  ds_read_b64_tr_b16 a[210:211], v251 offset:16384
  v_mfma_f32_16x16x32_bf16 v[56:59], a[180:183], a[224:227], v[56:59]
  ds_read_b64_tr_b16 a[212:213], v251 offset:20480
  v_mfma_f32_16x16x32_bf16 v[56:59], a[176:179], a[216:219], v[56:59]
  s_waitcnt lgkmcnt(11)
  ds_read_b64_tr_b16 a[214:215], v251 offset:24576
  v_mfma_f32_16x16x32_bf16 v[32:35], a[184:187], a[0:3], v[32:35]
  ds_read_b64_tr_b16 a[176:177], v240 offset:12288
  v_mfma_f32_16x16x32_bf16 v[32:35], a[188:191], a[8:11], v[32:35]
  ds_read_b64_tr_b16 a[178:179], v240 offset:16384
  buffer_load_dword v139, v132, s[36:39], s77 offen sc1
  v_mfma_f32_16x16x32_bf16 v[36:39], a[188:191], a[12:15], v[36:39]
  ds_read_b64_tr_b16 a[180:181], v240 offset:20480
  v_mfma_f32_16x16x32_bf16 v[36:39], a[184:187], a[4:7], v[36:39]
  s_waitcnt lgkmcnt(11)
  ds_read_b64_tr_b16 a[182:183], v240 offset:24576
  v_mfma_f32_16x16x32_bf16 v[44:47], a[192:195], a[4:7], v[44:47]
  ds_read_b64_tr_b16 a[184:185], v241 offset:12288
  v_mfma_f32_16x16x32_bf16 v[44:47], a[196:199], a[12:15], v[44:47]
  ds_read_b64_tr_b16 a[186:187], v241 offset:16384
  v_mfma_f32_16x16x32_bf16 v[40:43], a[196:199], a[8:11], v[40:43]
  ds_read_b64_tr_b16 a[188:189], v241 offset:20480
  v_mfma_f32_16x16x32_bf16 v[40:43], a[192:195], a[0:3], v[40:43]
  s_waitcnt vmcnt(17) lgkmcnt(11)
  s_barrier
  ds_read_b64_tr_b16 a[190:191], v241 offset:24576
  v_mfma_f32_16x16x32_bf16 v[48:51], a[200:203], a[0:3], v[48:51]
  ds_read_b64_tr_b16 a[192:193], v242 offset:12288
  v_mfma_f32_16x16x32_bf16 v[48:51], a[204:207], a[8:11], v[48:51]
  ds_read_b64_tr_b16 a[194:195], v242 offset:16384
  v_mfma_f32_16x16x32_bf16 v[52:55], a[204:207], a[12:15], v[52:55]
  ds_read_b64_tr_b16 a[196:197], v242 offset:20480
  v_mfma_f32_16x16x32_bf16 v[52:55], a[200:203], a[4:7], v[52:55]
  s_waitcnt lgkmcnt(11)
  ds_read_b64_tr_b16 a[198:199], v242 offset:24576
  v_mfma_f32_16x16x32_bf16 v[60:63], a[208:211], a[4:7], v[60:63]
  ds_read_b64_tr_b16 a[200:201], v243 offset:12288
  v_mfma_f32_16x16x32_bf16 v[60:63], a[212:215], a[12:15], v[60:63]
  ds_read_b64_tr_b16 a[202:203], v243 offset:16384
  v_mfma_f32_16x16x32_bf16 v[56:59], a[212:215], a[8:11], v[56:59]
  ds_read_b64_tr_b16 a[204:205], v243 offset:20480
  v_mfma_f32_16x16x32_bf16 v[56:59], a[208:211], a[0:3], v[56:59]
  s_waitcnt lgkmcnt(11)
  ds_read_b64_tr_b16 a[206:207], v243 offset:24576
  v_mfma_f32_16x16x32_bf16 v[32:35], a[176:179], a[16:19], v[32:35]
  ds_read_b64_tr_b16 a[208:209], v240 offset:28672
  v_mfma_f32_16x16x32_bf16 v[32:35], a[180:183], a[24:27], v[32:35]
  ds_read_b64_tr_b16 a[210:211], v240 offset:32768
  v_mfma_f32_16x16x32_bf16 v[36:39], a[180:183], a[28:31], v[36:39]
  ds_read_b64_tr_b16 a[212:213], v240 offset:36864
  v_mfma_f32_16x16x32_bf16 v[36:39], a[176:179], a[20:23], v[36:39]
  s_waitcnt lgkmcnt(11)
  ds_read_b64_tr_b16 a[214:215], v240 offset:40960
  v_mfma_f32_16x16x32_bf16 v[44:47], a[184:187], a[20:23], v[44:47]
  ds_read_b64_tr_b16 a[176:177], v241 offset:28672
  v_mfma_f32_16x16x32_bf16 v[44:47], a[188:191], a[28:31], v[44:47]
  ds_read_b64_tr_b16 a[178:179], v241 offset:32768
  v_mfma_f32_16x16x32_bf16 v[40:43], a[188:191], a[24:27], v[40:43]
  ds_read_b64_tr_b16 a[180:181], v241 offset:36864
  v_mfma_f32_16x16x32_bf16 v[40:43], a[184:187], a[16:19], v[40:43]
  s_waitcnt vmcnt(15) lgkmcnt(11)
  s_barrier
  ds_read_b64_tr_b16 a[182:183], v241 offset:40960
  v_mfma_f32_16x16x32_bf16 v[48:51], a[192:195], a[16:19], v[48:51]
  ds_read_b64_tr_b16 a[184:185], v242 offset:28672
  v_mfma_f32_16x16x32_bf16 v[48:51], a[196:199], a[24:27], v[48:51]
  ds_read_b64_tr_b16 a[186:187], v242 offset:32768
  v_mfma_f32_16x16x32_bf16 v[52:55], a[196:199], a[28:31], v[52:55]
  ds_read_b64_tr_b16 a[188:189], v242 offset:36864
  v_mfma_f32_16x16x32_bf16 v[52:55], a[192:195], a[20:23], v[52:55]
  s_waitcnt lgkmcnt(11)
  ds_read_b64_tr_b16 a[190:191], v242 offset:40960
  v_mfma_f32_16x16x32_bf16 v[60:63], a[200:203], a[20:23], v[60:63]
  ds_read_b64_tr_b16 a[192:193], v243 offset:28672
  v_mfma_f32_16x16x32_bf16 v[60:63], a[204:207], a[28:31], v[60:63]
  ds_read_b64_tr_b16 a[194:195], v243 offset:32768
  v_mfma_f32_16x16x32_bf16 v[56:59], a[204:207], a[24:27], v[56:59]
  ds_read_b64_tr_b16 a[196:197], v243 offset:36864
  v_mfma_f32_16x16x32_bf16 v[56:59], a[200:203], a[16:19], v[56:59]
  s_waitcnt lgkmcnt(11)
  ds_read_b64_tr_b16 a[198:199], v243 offset:40960
  v_mfma_f32_16x16x32_bf16 v[32:35], a[208:211], a[32:35], v[32:35]
  ds_read_b64_tr_b16 a[200:201], v240 offset:45056
  v_mfma_f32_16x16x32_bf16 v[32:35], a[212:215], a[40:43], v[32:35]
  ds_read_b64_tr_b16 a[202:203], v240 offset:49152
  v_mfma_f32_16x16x32_bf16 v[36:39], a[212:215], a[44:47], v[36:39]
  ds_read_b64_tr_b16 a[204:205], v240 offset:53248
  v_mfma_f32_16x16x32_bf16 v[36:39], a[208:211], a[36:39], v[36:39]
  s_waitcnt lgkmcnt(11)
  ds_read_b64_tr_b16 a[206:207], v240 offset:57344
  v_mfma_f32_16x16x32_bf16 v[44:47], a[176:179], a[36:39], v[44:47]
  ds_read_b64_tr_b16 a[208:209], v241 offset:45056
  v_mfma_f32_16x16x32_bf16 v[44:47], a[180:183], a[44:47], v[44:47]
  ds_read_b64_tr_b16 a[210:211], v241 offset:49152
  v_mfma_f32_16x16x32_bf16 v[40:43], a[180:183], a[40:43], v[40:43]
  ds_read_b64_tr_b16 a[212:213], v241 offset:53248
  v_mfma_f32_16x16x32_bf16 v[40:43], a[176:179], a[32:35], v[40:43]
  s_waitcnt vmcnt(13) lgkmcnt(11)
  s_barrier
  ds_read_b64_tr_b16 a[214:215], v241 offset:57344
  v_mfma_f32_16x16x32_bf16 v[48:51], a[184:187], a[32:35], v[48:51]
  ds_read_b64_tr_b16 a[176:177], v242 offset:45056
  v_mfma_f32_16x16x32_bf16 v[48:51], a[188:191], a[40:43], v[48:51]
  ds_read_b64_tr_b16 a[178:179], v242 offset:49152
  v_mfma_f32_16x16x32_bf16 v[52:55], a[188:191], a[44:47], v[52:55]
  s_waitcnt vmcnt(0)
  ds_read_b64_tr_b16 a[180:181], v242 offset:53248
  s_mov_b64 exec, 1
  buffer_store_dword v9, v0, s[36:39], s76 offen sc1
  s_mov_b64 exec, -1
  v_mfma_f32_16x16x32_bf16 v[52:55], a[184:187], a[36:39], v[52:55]
  s_waitcnt lgkmcnt(11)
  ds_read_b64_tr_b16 a[182:183], v242 offset:57344
  v_readfirstlane_b32 s78, v139
  v_mfma_f32_16x16x32_bf16 v[60:63], a[192:195], a[36:39], v[60:63]
  s_nop 0
  ds_read_b64_tr_b16 a[184:185], v243 offset:45056
  s_cmp_eq_u32 s78, s3
  v_mfma_f32_16x16x32_bf16 v[60:63], a[196:199], a[44:47], v[60:63]
  s_cselect_b32 s89, s63, 1073741824
  ds_read_b64_tr_b16 a[186:187], v243 offset:49152
  s_cselect_b32 s90, s64, 1073741824
  v_mfma_f32_16x16x32_bf16 v[56:59], a[196:199], a[40:43], v[56:59]
  ds_read_b64_tr_b16 a[188:189], v243 offset:53248
  buffer_load_dwordx4 v[96:99], v0, s[36:39], s89 offen offset:0 sc1
  v_mfma_f32_16x16x32_bf16 v[56:59], a[192:195], a[32:35], v[56:59]
  s_waitcnt lgkmcnt(11)
  ds_read_b64_tr_b16 a[190:191], v243 offset:57344
  v_mfma_f32_16x16x32_bf16 v[32:35], a[200:203], a[48:51], v[32:35]
  ds_read_b64_tr_b16 a[192:193], v240 offset:61440
  v_mfma_f32_16x16x32_bf16 v[32:35], a[204:207], a[56:59], v[32:35]
  ds_read_b64_tr_b16 a[194:195], v244 offset:0
  buffer_load_dwordx4 v[100:103], v0, s[36:39], s89 offen offset:1024 sc1
  v_mfma_f32_16x16x32_bf16 v[36:39], a[204:207], a[60:63], v[36:39]
  ds_read_b64_tr_b16 a[196:197], v244 offset:4096
  v_mfma_f32_16x16x32_bf16 v[36:39], a[200:203], a[52:55], v[36:39]
  s_waitcnt lgkmcnt(11)
  ds_read_b64_tr_b16 a[198:199], v244 offset:8192
  v_mfma_f32_16x16x32_bf16 v[44:47], a[208:211], a[52:55], v[44:47]
  ds_read_b64_tr_b16 a[200:201], v241 offset:61440
  buffer_load_dwordx4 v[104:107], v0, s[36:39], s89 offen offset:2048 sc1
  v_mfma_f32_16x16x32_bf16 v[44:47], a[212:215], a[60:63], v[44:47]
  ds_read_b64_tr_b16 a[202:203], v245 offset:0
  v_mfma_f32_16x16x32_bf16 v[40:43], a[212:215], a[56:59], v[40:43]
  ds_read_b64_tr_b16 a[204:205], v245 offset:4096
  v_mfma_f32_16x16x32_bf16 v[40:43], a[208:211], a[48:51], v[40:43]
  s_waitcnt vmcnt(15) lgkmcnt(11)
  s_barrier
  ds_read_b64_tr_b16 a[206:207], v245 offset:8192
  v_mfma_f32_16x16x32_bf16 v[48:51], a[176:179], a[48:51], v[48:51]
  ds_read_b64_tr_b16 a[208:209], v242 offset:61440
  buffer_load_dwordx4 v[108:111], v0, s[36:39], s89 offen offset:3072 sc1
  v_mfma_f32_16x16x32_bf16 v[48:51], a[180:183], a[56:59], v[48:51]
  ds_read_b64_tr_b16 a[210:211], v246 offset:0
  v_mfma_f32_16x16x32_bf16 v[52:55], a[180:183], a[60:63], v[52:55]
  ds_read_b64_tr_b16 a[212:213], v246 offset:4096
  v_mfma_f32_16x16x32_bf16 v[52:55], a[176:179], a[52:55], v[52:55]
  s_waitcnt lgkmcnt(11)
  ds_read_b64_tr_b16 a[214:215], v246 offset:8192
  buffer_load_dwordx4 v[112:115], v0, s[36:39], s90 offen offset:0 sc1
  v_mfma_f32_16x16x32_bf16 v[60:63], a[184:187], a[52:55], v[60:63]
  ds_read_b64_tr_b16 a[176:177], v243 offset:61440
  v_mfma_f32_16x16x32_bf16 v[60:63], a[188:191], a[60:63], v[60:63]
  ds_read_b64_tr_b16 a[178:179], v247 offset:0
  v_mfma_f32_16x16x32_bf16 v[56:59], a[188:191], a[56:59], v[56:59]
  ds_read_b64_tr_b16 a[180:181], v247 offset:4096
  buffer_load_dwordx4 v[116:119], v0, s[36:39], s90 offen offset:1024 sc1
  v_mfma_f32_16x16x32_bf16 v[56:59], a[184:187], a[48:51], v[56:59]
  s_waitcnt lgkmcnt(11)
  ds_read_b64_tr_b16 a[182:183], v247 offset:8192
  v_mfma_f32_16x16x32_bf16 v[32:35], a[192:195], a[64:67], v[32:35]
  ds_read_b64_tr_b16 a[184:185], v244 offset:12288
  v_mfma_f32_16x16x32_bf16 v[32:35], a[196:199], a[72:75], v[32:35]
  ds_read_b64_tr_b16 a[186:187], v244 offset:16384
  buffer_load_dwordx4 v[120:123], v0, s[36:39], s90 offen offset:2048 sc1
  v_mfma_f32_16x16x32_bf16 v[36:39], a[196:199], a[76:79], v[36:39]
  ds_read_b64_tr_b16 a[188:189], v244 offset:20480
  v_mfma_f32_16x16x32_bf16 v[36:39], a[192:195], a[68:71], v[36:39]
  s_waitcnt lgkmcnt(11)
  ds_read_b64_tr_b16 a[190:191], v244 offset:24576
  v_mfma_f32_16x16x32_bf16 v[44:47], a[200:203], a[68:71], v[44:47]
  ds_read_b64_tr_b16 a[192:193], v245 offset:12288
  buffer_load_dwordx4 v[124:127], v0, s[36:39], s90 offen offset:3072 sc1
  v_mfma_f32_16x16x32_bf16 v[44:47], a[204:207], a[76:79], v[44:47]
  ds_read_b64_tr_b16 a[194:195], v245 offset:16384
  v_mfma_f32_16x16x32_bf16 v[40:43], a[204:207], a[72:75], v[40:43]
  ds_read_b64_tr_b16 a[196:197], v245 offset:20480
  v_mfma_f32_16x16x32_bf16 v[40:43], a[200:203], a[64:67], v[40:43]
  s_waitcnt vmcnt(18) lgkmcnt(11)
  s_barrier
  ds_read_b64_tr_b16 a[198:199], v245 offset:24576
  v_mfma_f32_16x16x32_bf16 v[48:51], a[208:211], a[64:67], v[48:51]
  ds_read_b64_tr_b16 a[200:201], v246 offset:12288
  v_mfma_f32_16x16x32_bf16 v[48:51], a[212:215], a[72:75], v[48:51]
  ds_read_b64_tr_b16 a[202:203], v246 offset:16384
  v_mfma_f32_16x16x32_bf16 v[52:55], a[212:215], a[76:79], v[52:55]
  ds_read_b64_tr_b16 a[204:205], v246 offset:20480
  v_mfma_f32_16x16x32_bf16 v[52:55], a[208:211], a[68:71], v[52:55]
  s_waitcnt lgkmcnt(11)
  ds_read_b64_tr_b16 a[206:207], v246 offset:24576
  v_mfma_f32_16x16x32_bf16 v[60:63], a[176:179], a[68:71], v[60:63]
  ds_read_b64_tr_b16 a[208:209], v247 offset:12288
  v_mfma_f32_16x16x32_bf16 v[60:63], a[180:183], a[76:79], v[60:63]
  ds_read_b64_tr_b16 a[210:211], v247 offset:16384
  v_mfma_f32_16x16x32_bf16 v[56:59], a[180:183], a[72:75], v[56:59]
  ds_read_b64_tr_b16 a[212:213], v247 offset:20480
  v_mfma_f32_16x16x32_bf16 v[56:59], a[176:179], a[64:67], v[56:59]
  s_waitcnt lgkmcnt(11)
  ds_read_b64_tr_b16 a[214:215], v247 offset:24576
  v_mfma_f32_16x16x32_bf16 v[32:35], a[184:187], a[80:83], v[32:35]
  ds_read_b64_tr_b16 a[176:177], v244 offset:28672
  v_mfma_f32_16x16x32_bf16 v[32:35], a[188:191], a[88:91], v[32:35]
  ds_read_b64_tr_b16 a[178:179], v244 offset:32768
  v_mfma_f32_16x16x32_bf16 v[36:39], a[188:191], a[92:95], v[36:39]
  ds_read_b64_tr_b16 a[180:181], v244 offset:36864
  v_mfma_f32_16x16x32_bf16 v[36:39], a[184:187], a[84:87], v[36:39]
  s_waitcnt lgkmcnt(11)
  ds_read_b64_tr_b16 a[182:183], v244 offset:40960
  v_mfma_f32_16x16x32_bf16 v[44:47], a[192:195], a[84:87], v[44:47]
  ds_read_b64_tr_b16 a[184:185], v245 offset:28672
  v_mfma_f32_16x16x32_bf16 v[44:47], a[196:199], a[92:95], v[44:47]
  ds_read_b64_tr_b16 a[186:187], v245 offset:32768
  v_mfma_f32_16x16x32_bf16 v[40:43], a[196:199], a[88:91], v[40:43]
  ds_read_b64_tr_b16 a[188:189], v245 offset:36864
  v_mfma_f32_16x16x32_bf16 v[40:43], a[192:195], a[80:83], v[40:43]
  s_waitcnt lgkmcnt(11)
  ds_read_b64_tr_b16 a[190:191], v245 offset:40960
  v_mfma_f32_16x16x32_bf16 v[48:51], a[200:203], a[80:83], v[48:51]
  ds_read_b64_tr_b16 a[192:193], v246 offset:28672
  v_mfma_f32_16x16x32_bf16 v[48:51], a[204:207], a[88:91], v[48:51]
  ds_read_b64_tr_b16 a[194:195], v246 offset:32768
  v_mfma_f32_16x16x32_bf16 v[52:55], a[204:207], a[92:95], v[52:55]
  ds_read_b64_tr_b16 a[196:197], v246 offset:36864
  v_mfma_f32_16x16x32_bf16 v[52:55], a[200:203], a[84:87], v[52:55]
  s_waitcnt lgkmcnt(11)
  ds_read_b64_tr_b16 a[198:199], v246 offset:40960
  v_mfma_f32_16x16x32_bf16 v[60:63], a[208:211], a[84:87], v[60:63]
  ds_read_b64_tr_b16 a[200:201], v247 offset:28672
  v_mfma_f32_16x16x32_bf16 v[60:63], a[212:215], a[92:95], v[60:63]
  ds_read_b64_tr_b16 a[202:203], v247 offset:32768
  v_mfma_f32_16x16x32_bf16 v[56:59], a[212:215], a[88:91], v[56:59]
  ds_read_b64_tr_b16 a[204:205], v247 offset:36864
  v_mfma_f32_16x16x32_bf16 v[56:59], a[208:211], a[80:83], v[56:59]
  s_waitcnt lgkmcnt(11)
  ds_read_b64_tr_b16 a[206:207], v247 offset:40960
  v_mfma_f32_16x16x32_bf16 v[32:35], a[176:179], a[96:99], v[32:35]
  buffer_load_dword v139, v132, s[36:39], s77 offen sc1
  v_mfma_f32_16x16x32_bf16 v[32:35], a[180:183], a[104:107], v[32:35]
  v_mfma_f32_16x16x32_bf16 v[36:39], a[180:183], a[108:111], v[36:39]
  v_mfma_f32_16x16x32_bf16 v[36:39], a[176:179], a[100:103], v[36:39]
  s_waitcnt lgkmcnt(8)
  v_mfma_f32_16x16x32_bf16 v[44:47], a[184:187], a[100:103], v[44:47]
  v_mfma_f32_16x16x32_bf16 v[44:47], a[188:191], a[108:111], v[44:47]
  v_mfma_f32_16x16x32_bf16 v[40:43], a[188:191], a[104:107], v[40:43]
  v_mfma_f32_16x16x32_bf16 v[40:43], a[184:187], a[96:99], v[40:43]
  s_waitcnt lgkmcnt(4)
  v_mfma_f32_16x16x32_bf16 v[48:51], a[192:195], a[96:99], v[48:51]
  v_mfma_f32_16x16x32_bf16 v[48:51], a[196:199], a[104:107], v[48:51]
  v_mfma_f32_16x16x32_bf16 v[52:55], a[196:199], a[108:111], v[52:55]
  v_mfma_f32_16x16x32_bf16 v[52:55], a[192:195], a[100:103], v[52:55]
  s_waitcnt lgkmcnt(0)
  v_mfma_f32_16x16x32_bf16 v[60:63], a[200:203], a[100:103], v[60:63]
  v_mfma_f32_16x16x32_bf16 v[60:63], a[204:207], a[108:111], v[60:63]
  v_mfma_f32_16x16x32_bf16 v[56:59], a[204:207], a[104:107], v[56:59]
  v_mfma_f32_16x16x32_bf16 v[56:59], a[200:203], a[96:99], v[56:59]
  s_cmp_eq_u32 s78, s3
  s_cbranch_scc0 CKXs
CKXx:
  v_pk_fma_f32 v[64:65], v[176:177], v[32:33], v[64:65]
  v_pk_fma_f32 v[66:67], v[178:179], v[34:35], v[66:67]
  v_pk_fma_f32 v[80:81], v[176:177], v[36:37], v[80:81]
  v_pk_fma_f32 v[82:83], v[178:179], v[38:39], v[82:83]
  v_pk_fma_f32 v[68:69], v[180:181], v[40:41], v[68:69]
  v_pk_fma_f32 v[70:71], v[182:183], v[42:43], v[70:71]
  v_pk_fma_f32 v[84:85], v[180:181], v[44:45], v[84:85]
  v_pk_fma_f32 v[86:87], v[182:183], v[46:47], v[86:87]
  v_pk_fma_f32 v[72:73], v[184:185], v[48:49], v[72:73]
  v_pk_fma_f32 v[74:75], v[186:187], v[50:51], v[74:75]
  v_pk_fma_f32 v[88:89], v[184:185], v[52:53], v[88:89]
  v_pk_fma_f32 v[90:91], v[186:187], v[54:55], v[90:91]
  v_pk_fma_f32 v[76:77], v[188:189], v[56:57], v[76:77]
  v_pk_fma_f32 v[78:79], v[190:191], v[58:59], v[78:79]
  v_pk_fma_f32 v[92:93], v[188:189], v[60:61], v[92:93]
  v_pk_fma_f32 v[94:95], v[190:191], v[62:63], v[94:95]
  s_waitcnt vmcnt(8)
  v_pk_fma_f32 v[64:65], v[176:177], v[96:97], v[64:65]
  v_pk_fma_f32 v[66:67], v[178:179], v[98:99], v[66:67]
Hb1_1:
  s_cbranch_execz Rb
  v_cvt_pk_bf16_f32 v192, v64, v65
  v_cvt_pk_bf16_f32 v193, v66, v67
  ds_write_b64 v140, v[192:193] offset:0
  s_waitcnt vmcnt(7)
  v_pk_fma_f32 v[80:81], v[176:177], v[100:101], v[80:81]
  v_pk_fma_f32 v[82:83], v[178:179], v[102:103], v[82:83]
  v_cvt_pk_bf16_f32 v200, v80, v81
  v_cvt_pk_bf16_f32 v201, v82, v83
  ds_write_b64 v140, v[200:201] offset:2048
  s_waitcnt vmcnt(6)
  v_pk_fma_f32 v[68:69], v[180:181], v[104:105], v[68:69]
  v_pk_fma_f32 v[70:71], v[182:183], v[106:107], v[70:71]
  v_cvt_pk_bf16_f32 v194, v68, v69
  v_cvt_pk_bf16_f32 v195, v70, v71
  ds_write_b64 v141, v[194:195] offset:0
  s_waitcnt vmcnt(5)
  v_pk_fma_f32 v[84:85], v[180:181], v[108:109], v[84:85]
  v_pk_fma_f32 v[86:87], v[182:183], v[110:111], v[86:87]
  v_cvt_pk_bf16_f32 v202, v84, v85
  v_cvt_pk_bf16_f32 v203, v86, v87
  ds_write_b64 v141, v[202:203] offset:2048
  s_waitcnt vmcnt(4)
  v_pk_fma_f32 v[72:73], v[184:185], v[112:113], v[72:73]
  v_pk_fma_f32 v[74:75], v[186:187], v[114:115], v[74:75]
  v_cvt_pk_bf16_f32 v196, v72, v73
  v_cvt_pk_bf16_f32 v197, v74, v75
  ds_write_b64 v142, v[196:197] offset:0
  s_waitcnt vmcnt(3)
  v_pk_fma_f32 v[88:89], v[184:185], v[116:117], v[88:89]
  v_pk_fma_f32 v[90:91], v[186:187], v[118:119], v[90:91]
  v_cvt_pk_bf16_f32 v204, v88, v89
  v_cvt_pk_bf16_f32 v205, v90, v91
  ds_write_b64 v142, v[204:205] offset:2048
  s_waitcnt vmcnt(2)
  v_pk_fma_f32 v[76:77], v[188:189], v[120:121], v[76:77]
  v_pk_fma_f32 v[78:79], v[190:191], v[122:123], v[78:79]
  v_cvt_pk_bf16_f32 v198, v76, v77
  v_cvt_pk_bf16_f32 v199, v78, v79
  ds_write_b64 v143, v[198:199] offset:0
  s_waitcnt vmcnt(1)
  v_pk_fma_f32 v[92:93], v[188:189], v[124:125], v[92:93]
  v_pk_fma_f32 v[94:95], v[190:191], v[126:127], v[94:95]
  v_cvt_pk_bf16_f32 v206, v92, v93
  v_cvt_pk_bf16_f32 v207, v94, v95
  ds_write_b64 v143, v[206:207] offset:2048
  ds_read_b128 v[64:67], v254 offset:0
  ds_read_b128 v[68:71], v254 offset:1024
  ds_read_b128 v[72:75], v254 offset:2048
  ds_read_b128 v[76:79], v254 offset:3072
  s_waitcnt lgkmcnt(3)
  buffer_store_dwordx4 v[64:67], v252, s[32:35], s55 offen
  s_waitcnt lgkmcnt(2)
  buffer_store_dwordx4 v[68:71], v253, s[32:35], s55 offen
  s_waitcnt lgkmcnt(1)
  buffer_store_dwordx4 v[72:75], v252, s[32:35], s49 offen
  s_waitcnt lgkmcnt(0)
  buffer_store_dwordx4 v[76:79], v253, s[32:35], s49 offen
XEND:
  s_endpgm
CK4s:
  s_mov_b32 s46, 30000
CK4:
  s_mov_b32 s49, 0
  buffer_load_dwordx4 v[156:159], v249, s[36:39], s49 offen sc1
  s_mov_b32 s49, 24576
  buffer_load_dwordx4 v[160:163], v249, s[36:39], s49 offen sc1
  s_mov_b32 s49, 49152
  buffer_load_dwordx4 v[164:167], v249, s[36:39], s49 offen sc1
  s_mov_b32 s49, 73728
  buffer_load_dwordx4 v[168:171], v249, s[36:39], s49 offen sc1
  s_sub_u32 s46, s46, 1
  s_waitcnt vmcnt(0)
  v_max_u32 v15, v156, v157
  v_max3_u32 v15, v15, v158, v159
  v_max3_u32 v15, v15, v160, v161
  v_max3_u32 v15, v15, v162, v163
  v_max3_u32 v15, v15, v164, v165
  v_max3_u32 v15, v15, v166, v167
  v_max3_u32 v15, v15, v168, v169
  v_max3_u32 v15, v15, v170, v171
  s_cmp_eq_u32 s46, 0
  s_cbranch_scc1 CK4x
  v_cmp_eq_u32 vcc, -1, v15
  s_nop 4
  s_cbranch_vccnz CK4
  s_branch CK4x
CKSs:
  s_mov_b32 s46, 30000
  v_lshlrev_b32 v14, 3, v0
CKS:
  s_mov_b32 s48, 5242880
  buffer_load_dword v16, v14, s[36:39], s48 offen sc1
  s_mov_b32 s48, 5251072
  buffer_load_dword v17, v14, s[36:39], s48 offen sc1
  s_mov_b32 s48, 5259264
  buffer_load_dword v18, v14, s[36:39], s48 offen sc1
  s_mov_b32 s48, 5267456
  buffer_load_dword v19, v14, s[36:39], s48 offen sc1
  s_sub_u32 s46, s46, 1
  s_cmp_eq_u32 s46, 0
  s_waitcnt vmcnt(0)
  s_cbranch_scc1 CKSy
  v_xor_b32 v15, s3, v16
  v_bitop3_b32 v15, v15, v17, s3 bitop3:0xf6
  v_bitop3_b32 v15, v15, v18, s3 bitop3:0xf6
  v_bitop3_b32 v15, v15, v19, s3 bitop3:0xf6
  v_cmp_ne_u32 vcc, 0, v15
  s_nop 4
  s_cbranch_vccnz CKS
CKSy:
  s_mov_b32 s48, 5505024
  s_mov_b64 exec, 1
  buffer_store_dword v12, v0, s[36:39], s48 offen sc1
  s_mov_b64 exec, -1
  s_branch CKSx
CK6s:
  s_mov_b32 s46, 60000
CK6:
  buffer_load_dword v29, v30, s[36:39], s68 offen sc1
  s_sub_u32 s46, s46, 1
  s_cmp_eq_u32 s46, 0
  s_waitcnt vmcnt(0)
  s_cbranch_scc1 CK6y
  v_cmp_ne_u32 vcc, s3, v29
  s_nop 4
  s_cbranch_vccnz CK6
CK6y:
  s_mov_b64 exec, -1
  s_branch CK6x
CK7s:
  s_mov_b32 s46, 30000
CK7:
  buffer_load_dwordx4 a[208:211], v25, s[36:39], s77 offen offset:0 sc1
  buffer_load_dwordx4 a[212:215], v25, s[36:39], s77 offen offset:2048 sc1
  buffer_load_dwordx4 a[216:219], v25, s[36:39], s76 offen offset:0 sc1
  buffer_load_dwordx4 a[220:223], v25, s[36:39], s76 offen offset:2048 sc1
  s_sub_u32 s46, s46, 1
  s_waitcnt vmcnt(0)
  v_accvgpr_read_b32 v26, a208
  v_accvgpr_read_b32 v27, a209
  v_accvgpr_read_b32 v28, a210
  v_accvgpr_read_b32 v29, a211
  v_max_u32 v31, v26, v27
  v_max3_u32 v31, v31, v28, v29
  v_accvgpr_read_b32 v22, a212
  v_accvgpr_read_b32 v23, a213
  v_max3_u32 v31, v31, v22, v23
  v_add_f32 v26, v26, v22
  v_add_f32 v27, v27, v23
  v_accvgpr_read_b32 v22, a214
  v_accvgpr_read_b32 v23, a215
  v_max3_u32 v31, v31, v22, v23
  v_add_f32 v28, v28, v22
  v_add_f32 v29, v29, v23
  v_accvgpr_read_b32 v22, a216
  v_accvgpr_read_b32 v23, a217
  v_max3_u32 v31, v31, v22, v23
  v_add_f32 v26, v26, v22
  v_add_f32 v27, v27, v23
  v_accvgpr_read_b32 v22, a218
  v_accvgpr_read_b32 v23, a219
  v_max3_u32 v31, v31, v22, v23
  v_add_f32 v28, v28, v22
  v_add_f32 v29, v29, v23
  v_accvgpr_read_b32 v22, a220
  v_accvgpr_read_b32 v23, a221
  v_max3_u32 v31, v31, v22, v23
  v_add_f32 v26, v26, v22
  v_add_f32 v27, v27, v23
  v_accvgpr_read_b32 v22, a222
  v_accvgpr_read_b32 v23, a223
  v_max3_u32 v31, v31, v22, v23
  v_add_f32 v28, v28, v22
  v_add_f32 v29, v29, v23
  s_cmp_eq_u32 s46, 0
  s_cbranch_scc1 CK7x
  v_cmp_eq_u32 vcc, -1, v31
  s_nop 4
  s_cbranch_vccnz CK7
  s_branch CK7x
CK8s:
  s_mov_b32 s46, 60000
CK8:
  buffer_load_dword v139, v138, s[36:39], s91 offen sc1
  s_sub_u32 s46, s46, 1
  s_cmp_eq_u32 s46, 0
  s_waitcnt vmcnt(0)
  s_cbranch_scc1 CK8y
  v_cmp_ne_u32 vcc, s3, v139
  s_nop 4
  s_cbranch_vccnz CK8
CK8y:
  s_mov_b64 exec, -1
  s_branch CK8x
CK9s:
  s_mov_b32 s46, 60000
CK9:
  buffer_load_dword v139, v138, s[36:39], s91 offen sc1
  s_sub_u32 s46, s46, 1
  s_cmp_eq_u32 s46, 0
  s_waitcnt vmcnt(0)
  s_cbranch_scc1 CK9y
  v_cmp_ne_u32 vcc, s3, v139
  s_nop 4
  s_cbranch_vccnz CK9
CK9y:
  s_mov_b64 exec, -1
  s_branch CK9x
CK10s:
  s_mov_b32 s46, 60000
CK10:
  buffer_load_dword v139, v138, s[36:39], s91 offen sc1
  s_sub_u32 s46, s46, 1
  s_cmp_eq_u32 s46, 0
  s_waitcnt vmcnt(0)
  s_cbranch_scc1 CK10y
  v_cmp_ne_u32 vcc, s3, v139
  s_nop 4
  s_cbranch_vccnz CK10
CK10y:
  s_mov_b64 exec, -1
  s_branch CK10x
CKXs:
  s_mov_b32 s46, 60000
  s_branch CKXw
CKX:
  buffer_load_dword v139, v132, s[36:39], s77 offen sc1
CKXw:
  s_sub_u32 s46, s46, 1
  s_cmp_eq_u32 s46, 0
  s_waitcnt vmcnt(0)
  s_cbranch_scc1 CKXy
  v_cmp_ne_u32 vcc, s3, v139
  s_nop 4
  s_cbranch_vccnz CKX
CKXy:
  buffer_load_dwordx4 v[96:99], v0, s[36:39], s63 offen offset:0 sc1
  buffer_load_dwordx4 v[100:103], v0, s[36:39], s63 offen offset:1024 sc1
  buffer_load_dwordx4 v[104:107], v0, s[36:39], s63 offen offset:2048 sc1
  buffer_load_dwordx4 v[108:111], v0, s[36:39], s63 offen offset:3072 sc1
  buffer_load_dwordx4 v[112:115], v0, s[36:39], s64 offen offset:0 sc1
  buffer_load_dwordx4 v[116:119], v0, s[36:39], s64 offen offset:1024 sc1
  buffer_load_dwordx4 v[120:123], v0, s[36:39], s64 offen offset:2048 sc1
  buffer_load_dwordx4 v[124:127], v0, s[36:39], s64 offen offset:3072 sc1
  buffer_load_dword v139, v132, s[36:39], s77 offen sc1
  s_branch CKXx
code_end:
.fill 2048, 4, 0xBF800000
.section .rodata,"a"
.p2align 6
.amdhsa_kernel adaLN_cond__sliding_local_dilated__swiglu_ffn__prompt_kernel
  .amdhsa_next_free_vgpr 512
  .amdhsa_next_free_sgpr 102
  .amdhsa_accum_offset 256
  .amdhsa_group_segment_fixed_size 0
  .amdhsa_kernarg_size 96
  .amdhsa_user_sgpr_count 2
  .amdhsa_user_sgpr_kernarg_segment_ptr 1
  .amdhsa_system_sgpr_workgroup_id_x 1
  .amdhsa_float_denorm_mode_32 3
.end_amdhsa_kernel
```

```asm
; @launch grid=(256,1,1) block=(256,1,1) lds=163840
.amdgcn_target "amdgcn-amd-amdhsa--gfx950"
.text
.globl adaLN_cond__sliding_local_dilated__swiglu_ffn__prompt_kernel
.type adaLN_cond__sliding_local_dilated__swiglu_ffn__prompt_kernel,@function
.p2align 12
.p2align 8
adaLN_cond__sliding_local_dilated__swiglu_ffn__prompt_kernel:
  s_cmp_ge_u32 s2, 256
  s_cbranch_scc1 XEND
  s_load_dwordx2 s[36:37], s[0:1], 88
  s_load_dwordx2 s[40:41], s[0:1], 56
  s_load_dwordx2 s[28:29], s[0:1], 64
  s_load_dwordx2 s[4:5], s[0:1], 0
  s_load_dwordx2 s[8:9], s[0:1], 8
  s_load_dwordx2 s[12:13], s[0:1], 16
  s_load_dwordx2 s[16:17], s[0:1], 32
  s_load_dwordx2 s[20:21], s[0:1], 40
  s_load_dwordx2 s[24:25], s[0:1], 48
  s_load_dwordx2 s[32:33], s[0:1], 72
  v_lshrrev_b32 v1, 6, v0
  v_and_b32 v10, 63, v0
  v_readfirstlane_b32 s44, v1
  v_lshlrev_b32 v0, 4, v10
  s_mov_b32 s38, 50331648
  s_mov_b32 s39, 0x20000
  s_mov_b32 s42, 2048
  s_mov_b32 s43, 0x20000
  s_mov_b32 s30, 12582912
  s_mov_b32 s31, 0x20000
  s_mov_b32 s6, 4194304
  s_mov_b32 s7, 0x20000
  s_mov_b32 s10, 6291456
  s_mov_b32 s11, 0x20000
  s_mov_b32 s14, 2097152
  s_mov_b32 s15, 0x20000
  s_mov_b32 s18, 7340032
  s_mov_b32 s19, 0x20000
  s_mov_b32 s22, 7340032
  s_mov_b32 s23, 0x20000
  s_mov_b32 s26, 7340032
  s_mov_b32 s27, 0x20000
  s_mov_b32 s34, 4194304
  s_mov_b32 s35, 0x20000
  s_and_b32 s48, s2, 3
  s_lshl2_add_u32 s48, s48, s44
  s_lshl_b32 s48, s48, 6
  v_and_b32 v176, 0x38, v10
  v_add_u32 v176, s48, v176
  v_lshlrev_b32 v177, 1, v176
  v_mul_u32_u24 v176, 12288, v176
  v_and_b32 v12, 7, v10
  v_lshl_add_u32 v176, v12, 4, v176
  v_mov_b32 v178, 0
  s_bfe_u32 s51, s2, 0x40003
  s_and_b32 s49, s2, 4
  s_lshl2_add_u32 s51, s49, s51
  s_and_b32 s49, s2, 128
  s_lshl2_add_u32 s51, s51, s49
  s_lshl_b32 s51, s51, 5
  s_mov_b32 s49, s51
  s_mov_b32 s50, 5505024
  v_lshrrev_b32 v13, 3, v10
  v_lshlrev_b32 v132, 11, v12
  v_lshl_add_u32 v132, v13, 4, v132
  s_and_b32 s48, s2, 127
  s_lshl_b32 s48, s48, 7
  s_add_u32 s48, s48, s44
  s_lshl_b32 s48, s48, 8
  s_cmp_lt_u32 s2, 128
  s_waitcnt lgkmcnt(0)
  buffer_load_dwordx4 v[188:191], v177, s[40:43], 0 offen
  s_cbranch_scc0 F_x
  buffer_load_dwordx4 v[136:139], v176, s[28:31], s49 offen nt
  s_add_u32 s49, s49, 12288
  buffer_load_dwordx4 v[140:143], v176, s[28:31], s49 offen nt
  s_add_u32 s49, s49, 12288
  buffer_load_dwordx4 v[144:147], v176, s[28:31], s49 offen nt
  s_add_u32 s49, s49, 12288
  buffer_load_dwordx4 v[148:151], v176, s[28:31], s49 offen nt
  s_add_u32 s49, s49, 12288
  buffer_load_dwordx4 v[152:155], v176, s[28:31], s49 offen nt
  s_add_u32 s49, s49, 12288
  buffer_load_dwordx4 v[156:159], v176, s[28:31], s49 offen nt
  s_add_u32 s49, s49, 12288
  buffer_load_dwordx4 v[160:163], v176, s[28:31], s49 offen nt
  s_add_u32 s49, s49, 12288
  buffer_load_dwordx4 v[164:167], v176, s[28:31], s49 offen nt
F_x:
  buffer_load_dword v195, v178, s[36:39], s50 offen sc1
  s_mov_b32 s50, s48
  s_getpc_b64 s[92:93]
PC0:
  s_sub_u32 s92, s92, PC0-adaLN_cond__sliding_local_dilated__swiglu_ffn__prompt_kernel
  s_subb_u32 s93, s93, 0
  s_cmp_lt_u32 s2, 128
  s_cbranch_scc1 F_ct
  s_bfe_u32 s48, s2, 0x30004
  s_and_b32 s49, s2, 3
  s_lshl3_add_u32 s48, s49, s48
  s_mul_i32 s48, s48, 393216
  s_and_b32 s49, s2, 4
  s_lshl_b32 s49, s49, 9
  s_add_u32 s48, s48, s49
  s_and_b32 s49, s2, 8
  s_lshl_b32 s49, s49, 7
  s_add_u32 s48, s48, s49
  s_cmp_lt_u32 s44, 1
  s_cselect_b32 s48, s48, 1073741824
  v_and_b32 v19, 31, v10
  v_mul_u32_u24 v19, 12288, v19
  buffer_load_dword a252, v19, s[28:31], s48 offen offset:384
  s_bfe_u32 s48, s2, 0x40003
  s_cmp_lt_u32 s48, (code_end-adaLN_cond__sliding_local_dilated__swiglu_ffn__prompt_kernel)/8192+1
  s_cselect_b32 s49, 3, 4
  s_lshl_b32 s48, s48, 13
  v_lshl_add_u32 v19, v0, 3, s48
  s_cmp_eq_u32 s44, s49
  s_cselect_b32 s49, -1, 0
  v_and_b32 v19, s49, v19
  global_load_dword a252, v19, s[92:93]
  s_bfe_u32 s48, s2, 0x20003
  s_mul_i32 s48, s48, 24576
  s_lshr_b32 s49, s2, 5
  s_lshl3_add_u32 s49, s44, s49
  s_cmp_eq_u32 s49, 15
  s_cselect_b32 s48, s48, 1073741824
  v_lshlrev_b32 v19, 3, v0
  buffer_load_dword a252, v19, s[36:39], s48 offen sc1
F_ct:
  s_and_b32 s48, s2, 7
  s_lshr_b32 s49, s2, 3
  s_and_b32 s58, s48, 3
  s_lshl_b32 s58, s58, 2
  s_and_b32 s57, s49, 3
  s_add_u32 s58, s58, s57
  s_lshr_b32 s57, s48, 2
  s_lshl_b32 s57, s57, 3
  s_lshr_b32 s49, s49, 2
  s_add_u32 s57, s57, s49
  s_lshr_b32 s59, s44, 1
  s_and_b32 s60, s44, 1
  s_mul_i32 s63, s44, 3072
  s_lshl_b32 s64, s44, 11
  s_lshl_b32 s65, s44, 8
  v_bfe_u32 v14, v10, 4, 2
  v_bfe_u32 v15, v10, 1, 2
  v_xor_b32 v14, v14, v15
  v_lshlrev_b32 v14, 5, v14
  v_and_b32 v15, 1, v10
  v_lshl_add_u32 v213, v15, 4, v14
  s_lshl_b32 s48, s58, 7
  s_mul_i32 s49, s44, 49152
  s_add_u32 s48, s48, s49
  v_mul_u32_u24 v14, 6144, v13
  v_add3_u32 v202, v14, v213, s48
  v_add_u32 v203, 195584, v202
  v_add_u32 v204, 391168, v202
  v_bfe_u32 v14, v10, 3, 2
  v_lshlrev_b32 v14, 5, v14
  v_and_b32 v15, 3, v10
  v_lshl_add_u32 v214, v15, 3, v14
  v_bfe_u32 v14, v10, 2, 3
  v_lshrrev_b32 v15, 5, v10
  v_mul_u32_u24 v15, 24, v15
  v_add_lshl_u32 v14, v14, v15, 7
  s_lshl_b32 s48, s60, 1
  s_add_u32 s48, s48, s59
  s_lshl_b32 s48, s48, 5
  v_xor_b32 v15, s48, v214
  v_add_u32 v196, v14, v15
  v_xor_b32 v197, 32, v196
  v_add_u32 v198, 64512, v196
  v_add_u32 v199, 64512, v197
  v_add_u32 v200, 129024, v196
  v_add_u32 v201, 129024, v197
  s_lshl_b32 s48, s57, 2
  s_add_u32 s49, s48, s44
  s_lshl_b32 s49, s49, 16
  s_add_u32 s49, s49, 1048576
  v_add_u32 v205, s49, v0
  s_max_u32 s48, s48, 1
  s_lshl_b32 s48, s48, 16
  s_add_u32 s48, s48, 984064
  s_add_u32 s48, s48, s65
  v_lshl_add_u32 v206, v10, 2, s48
  s_lshl_b32 s48, s59, 12
  v_add_u32 v210, 0, v0
  v_add_u32 v207, s48, v210
  v_add_u32 v211, 64512, v0
  v_add_u32 v208, s48, v211
  v_add_u32 v212, 129024, v0
  v_add_u32 v209, s48, v212
  s_lshl3_add_u32 s48, s57, 127
  v_min_u32 v215, 8, v10
  v_add_u32 v215, s48, v215
  v_max_u32 v215, 0x80, v215
  v_lshlrev_b32 v215, 7, v215
  v_lshlrev_b32 v18, 5, v12
  v_lshrrev_b32 v19, 4, v10
  v_lshl_add_u32 v18, v19, 3, v18
  s_add_u32 s48, s65, 162816
  v_add_u32 v177, s48, v18
  v_lshlrev_b32 v178, 2, v10
  s_and_b32 s49, s2, 3
  s_mul_i32 s56, s49, 24576
  s_lshl1_add_u32 s56, s51, s56
  s_add_u32 s51, s51, 4096
  s_cmp_lt_u32 s2, 128
  s_cbranch_scc1 F_cw
  s_waitcnt vmcnt(4)
F_cw:
  s_waitcnt vmcnt(9)
  v_lshlrev_b32 v168, 16, v188
  v_and_b32 v169, 0xffff0000, v188
  v_lshlrev_b32 v170, 16, v189
  v_and_b32 v171, 0xffff0000, v189
  v_lshlrev_b32 v172, 16, v190
  v_and_b32 v173, 0xffff0000, v190
  v_lshlrev_b32 v174, 16, v191
  v_and_b32 v175, 0xffff0000, v191
  v_mul_f32 v180, 0xbfb8aa3b, v168
  v_mul_f32 v181, 0xbfb8aa3b, v169
  v_mul_f32 v182, 0xbfb8aa3b, v170
  v_mul_f32 v183, 0xbfb8aa3b, v171
  v_mul_f32 v184, 0xbfb8aa3b, v172
  v_mul_f32 v185, 0xbfb8aa3b, v173
  v_mul_f32 v186, 0xbfb8aa3b, v174
  v_mul_f32 v187, 0xbfb8aa3b, v175
  v_exp_f32 v180, v180
  v_exp_f32 v181, v181
  v_exp_f32 v182, v182
  v_exp_f32 v183, v183
  v_exp_f32 v184, v184
  v_exp_f32 v185, v185
  v_exp_f32 v186, v186
  v_exp_f32 v187, v187
  v_add_f32 v180, 1.0, v180
  v_add_f32 v181, 1.0, v181
  v_add_f32 v182, 1.0, v182
  v_add_f32 v183, 1.0, v183
  v_add_f32 v184, 1.0, v184
  v_add_f32 v185, 1.0, v185
  v_add_f32 v186, 1.0, v186
  v_add_f32 v187, 1.0, v187
  v_rcp_f32 v180, v180
  v_rcp_f32 v181, v181
  v_rcp_f32 v182, v182
  v_rcp_f32 v183, v183
  v_rcp_f32 v184, v184
  v_rcp_f32 v185, v185
  v_rcp_f32 v186, v186
  v_rcp_f32 v187, v187
  v_mul_f32 v168, v168, v180
  v_mul_f32 v169, v169, v181
  v_mul_f32 v170, v170, v182
  v_mul_f32 v171, v171, v183
  v_mul_f32 v172, v172, v184
  v_mul_f32 v173, v173, v185
  v_mul_f32 v174, v174, v186
  v_mul_f32 v175, v175, v187
  v_cvt_pk_bf16_f32 v192, v168, v169
  v_lshlrev_b32 v168, 16, v192
  v_and_b32 v169, 0xffff0000, v192
  v_cvt_pk_bf16_f32 v192, v170, v171
  v_lshlrev_b32 v170, 16, v192
  v_and_b32 v171, 0xffff0000, v192
  v_cvt_pk_bf16_f32 v192, v172, v173
  v_lshlrev_b32 v172, 16, v192
  v_and_b32 v173, 0xffff0000, v192
  v_cvt_pk_bf16_f32 v192, v174, v175
  v_lshlrev_b32 v174, 16, v192
  v_and_b32 v175, 0xffff0000, v192
  s_cmp_lt_u32 s2, 128
  s_cbranch_scc1 F_xl1
  buffer_load_dwordx4 v[136:139], v132, s[4:7], s50 offen offset:0
  buffer_load_dwordx4 v[140:143], v132, s[4:7], s50 offen offset:128
  buffer_load_dwordx4 v[144:147], v132, s[4:7], s50 offen offset:1024
  buffer_load_dwordx4 v[148:151], v132, s[4:7], s50 offen offset:1152
  s_add_u32 s50, s50, 16384
  buffer_load_dwordx4 v[152:155], v132, s[4:7], s50 offen offset:0
  buffer_load_dwordx4 v[156:159], v132, s[4:7], s50 offen offset:128
  buffer_load_dwordx4 v[160:163], v132, s[4:7], s50 offen offset:1024
  buffer_load_dwordx4 v[164:167], v132, s[4:7], s50 offen offset:1152
F_xl1:
  s_cmp_lt_u32 s2, 128
  s_cbranch_scc0 AL
  s_waitcnt vmcnt(8)
  v_lshlrev_b32 v188, 16, v136
  v_and_b32 v189, 0xffff0000, v136
  v_lshlrev_b32 v190, 16, v137
  v_and_b32 v191, 0xffff0000, v137
  v_pk_mul_f32 v[180:181], v[188:189], v[168:169] op_sel_hi:[1,0]
  v_pk_mul_f32 v[182:183], v[190:191], v[168:169] op_sel_hi:[1,0]
  v_lshlrev_b32 v188, 16, v138
  v_and_b32 v189, 0xffff0000, v138
  v_lshlrev_b32 v190, 16, v139
  v_and_b32 v191, 0xffff0000, v139
  v_pk_mul_f32 v[184:185], v[188:189], v[168:169] op_sel_hi:[1,0]
  v_pk_mul_f32 v[186:187], v[190:191], v[168:169] op_sel_hi:[1,0]
  s_waitcnt vmcnt(7)
  v_lshlrev_b32 v188, 16, v140
  v_and_b32 v189, 0xffff0000, v140
  v_lshlrev_b32 v190, 16, v141
  v_and_b32 v191, 0xffff0000, v141
  v_pk_fma_f32 v[180:181], v[188:189], v[168:169], v[180:181] op_sel:[0,1,0] op_sel_hi:[1,1,1]
  v_pk_fma_f32 v[182:183], v[190:191], v[168:169], v[182:183] op_sel:[0,1,0] op_sel_hi:[1,1,1]
  v_lshlrev_b32 v188, 16, v142
  v_and_b32 v189, 0xffff0000, v142
  v_lshlrev_b32 v190, 16, v143
  v_and_b32 v191, 0xffff0000, v143
  v_pk_fma_f32 v[184:185], v[188:189], v[168:169], v[184:185] op_sel:[0,1,0] op_sel_hi:[1,1,1]
  v_pk_fma_f32 v[186:187], v[190:191], v[168:169], v[186:187] op_sel:[0,1,0] op_sel_hi:[1,1,1]
  s_waitcnt vmcnt(6)
  v_lshlrev_b32 v188, 16, v144
  v_and_b32 v189, 0xffff0000, v144
  v_lshlrev_b32 v190, 16, v145
  v_and_b32 v191, 0xffff0000, v145
  v_pk_fma_f32 v[180:181], v[188:189], v[170:171], v[180:181] op_sel:[0,0,0] op_sel_hi:[1,0,1]
  v_pk_fma_f32 v[182:183], v[190:191], v[170:171], v[182:183] op_sel:[0,0,0] op_sel_hi:[1,0,1]
  v_lshlrev_b32 v188, 16, v146
  v_and_b32 v189, 0xffff0000, v146
  v_lshlrev_b32 v190, 16, v147
  v_and_b32 v191, 0xffff0000, v147
  v_pk_fma_f32 v[184:185], v[188:189], v[170:171], v[184:185] op_sel:[0,0,0] op_sel_hi:[1,0,1]
  v_pk_fma_f32 v[186:187], v[190:191], v[170:171], v[186:187] op_sel:[0,0,0] op_sel_hi:[1,0,1]
  s_waitcnt vmcnt(5)
  v_lshlrev_b32 v188, 16, v148
  v_and_b32 v189, 0xffff0000, v148
  v_lshlrev_b32 v190, 16, v149
  v_and_b32 v191, 0xffff0000, v149
  v_pk_fma_f32 v[180:181], v[188:189], v[170:171], v[180:181] op_sel:[0,1,0] op_sel_hi:[1,1,1]
  v_pk_fma_f32 v[182:183], v[190:191], v[170:171], v[182:183] op_sel:[0,1,0] op_sel_hi:[1,1,1]
  v_lshlrev_b32 v188, 16, v150
  v_and_b32 v189, 0xffff0000, v150
  v_lshlrev_b32 v190, 16, v151
  v_and_b32 v191, 0xffff0000, v151
  v_pk_fma_f32 v[184:185], v[188:189], v[170:171], v[184:185] op_sel:[0,1,0] op_sel_hi:[1,1,1]
  v_pk_fma_f32 v[186:187], v[190:191], v[170:171], v[186:187] op_sel:[0,1,0] op_sel_hi:[1,1,1]
  s_waitcnt vmcnt(4)
  v_lshlrev_b32 v188, 16, v152
  v_and_b32 v189, 0xffff0000, v152
  v_lshlrev_b32 v190, 16, v153
  v_and_b32 v191, 0xffff0000, v153
  v_pk_fma_f32 v[180:181], v[188:189], v[172:173], v[180:181] op_sel:[0,0,0] op_sel_hi:[1,0,1]
  v_pk_fma_f32 v[182:183], v[190:191], v[172:173], v[182:183] op_sel:[0,0,0] op_sel_hi:[1,0,1]
  v_lshlrev_b32 v188, 16, v154
  v_and_b32 v189, 0xffff0000, v154
  v_lshlrev_b32 v190, 16, v155
  v_and_b32 v191, 0xffff0000, v155
  v_pk_fma_f32 v[184:185], v[188:189], v[172:173], v[184:185] op_sel:[0,0,0] op_sel_hi:[1,0,1]
  v_pk_fma_f32 v[186:187], v[190:191], v[172:173], v[186:187] op_sel:[0,0,0] op_sel_hi:[1,0,1]
  s_waitcnt vmcnt(3)
  v_lshlrev_b32 v188, 16, v156
  v_and_b32 v189, 0xffff0000, v156
  v_lshlrev_b32 v190, 16, v157
  v_and_b32 v191, 0xffff0000, v157
  v_pk_fma_f32 v[180:181], v[188:189], v[172:173], v[180:181] op_sel:[0,1,0] op_sel_hi:[1,1,1]
  v_pk_fma_f32 v[182:183], v[190:191], v[172:173], v[182:183] op_sel:[0,1,0] op_sel_hi:[1,1,1]
  v_lshlrev_b32 v188, 16, v158
  v_and_b32 v189, 0xffff0000, v158
  v_lshlrev_b32 v190, 16, v159
  v_and_b32 v191, 0xffff0000, v159
  v_pk_fma_f32 v[184:185], v[188:189], v[172:173], v[184:185] op_sel:[0,1,0] op_sel_hi:[1,1,1]
  v_pk_fma_f32 v[186:187], v[190:191], v[172:173], v[186:187] op_sel:[0,1,0] op_sel_hi:[1,1,1]
  s_waitcnt vmcnt(2)
  v_lshlrev_b32 v188, 16, v160
  v_and_b32 v189, 0xffff0000, v160
  v_lshlrev_b32 v190, 16, v161
  v_and_b32 v191, 0xffff0000, v161
  v_pk_fma_f32 v[180:181], v[188:189], v[174:175], v[180:181] op_sel:[0,0,0] op_sel_hi:[1,0,1]
  v_pk_fma_f32 v[182:183], v[190:191], v[174:175], v[182:183] op_sel:[0,0,0] op_sel_hi:[1,0,1]
  v_lshlrev_b32 v188, 16, v162
  v_and_b32 v189, 0xffff0000, v162
  v_lshlrev_b32 v190, 16, v163
  v_and_b32 v191, 0xffff0000, v163
  v_pk_fma_f32 v[184:185], v[188:189], v[174:175], v[184:185] op_sel:[0,0,0] op_sel_hi:[1,0,1]
  v_pk_fma_f32 v[186:187], v[190:191], v[174:175], v[186:187] op_sel:[0,0,0] op_sel_hi:[1,0,1]
  s_waitcnt vmcnt(1)
  v_lshlrev_b32 v188, 16, v164
  v_and_b32 v189, 0xffff0000, v164
  v_lshlrev_b32 v190, 16, v165
  v_and_b32 v191, 0xffff0000, v165
  v_pk_fma_f32 v[180:181], v[188:189], v[174:175], v[180:181] op_sel:[0,1,0] op_sel_hi:[1,1,1]
  v_pk_fma_f32 v[182:183], v[190:191], v[174:175], v[182:183] op_sel:[0,1,0] op_sel_hi:[1,1,1]
  v_lshlrev_b32 v188, 16, v166
  v_and_b32 v189, 0xffff0000, v166
  v_lshlrev_b32 v190, 16, v167
  v_and_b32 v191, 0xffff0000, v167
  v_pk_fma_f32 v[184:185], v[188:189], v[174:175], v[184:185] op_sel:[0,1,0] op_sel_hi:[1,1,1]
  v_pk_fma_f32 v[186:187], v[190:191], v[174:175], v[186:187] op_sel:[0,1,0] op_sel_hi:[1,1,1]
  s_nop 0
  v_permlane32_swap_b32 v180, v184
  v_permlane32_swap_b32 v181, v185
  v_permlane32_swap_b32 v182, v186
  v_permlane32_swap_b32 v183, v187
  v_add_f32 v180, v180, v184
  v_add_f32 v181, v181, v185
  v_add_f32 v182, v182, v186
  v_add_f32 v183, v183, v187
  s_nop 0
  v_permlane16_swap_b32 v180, v182
  v_permlane16_swap_b32 v181, v183
  v_add_f32 v180, v180, v182
  v_add_f32 v181, v181, v183
  v_add_u32 v188, 162816, v178
  v_add_f32_dpp v180, v180, v180 row_ror:8 row_mask:0xf bank_mask:0xf
  v_add_f32_dpp v181, v181, v181 row_ror:8 row_mask:0xf bank_mask:0xf
  ds_write_b64 v177, v[180:181]
  v_and_b32 v184, 3, v10
  v_lshlrev_b32 v184, 3, v184
  s_cmp_eq_u32 s44, 0
  s_cselect_b32 s48, s56, 1073741824
  s_waitcnt lgkmcnt(0)
  s_barrier
  ds_read_b32 v180, v188 offset:0
  ds_read_b32 v181, v188 offset:256
  ds_read_b32 v182, v188 offset:512
  ds_read_b32 v183, v188 offset:768
  s_waitcnt vmcnt(0)
  v_readfirstlane_b32 s3, v195
  s_lshl_b32 s45, s2, 7
  s_add_u32 s45, s45, 5242880
  s_cmp_eq_u32 s44, 0
  s_cselect_b32 s45, s45, 1073741824
  s_mul_i32 s3, s3, 0x9e3779b1
  s_add_u32 s3, s3, 0x7f4a7c15
  s_and_b32 s70, s2, 7
  s_bfe_u32 s49, s2, 0x20003
  s_lshl2_add_u32 s70, s70, s49
  s_lshr_b32 s49, s2, 5
  s_lshl3_add_u32 s70, s70, s49
  s_lshl1_add_u32 s70, s70, s44
  s_lshl_b32 s70, s70, 10
  s_add_u32 s70, s70, 524288
  s_add_u32 s56, s56, 8192
  s_cmp_lt_u32 s44, 2
  s_cselect_b32 s70, s70, 1073741824
  s_cmp_eq_u32 s44, 2
  s_cselect_b32 s71, s56, 1073741824
  v_bfe_u32 v184, s3, v184, 8
  v_mov_b32 v185, 0xffffff00
  s_waitcnt lgkmcnt(0)
  v_add_f32 v180, v180, v181
  v_add_f32 v182, v182, v183
  v_add_f32 v180, v180, v182
  v_add_u32 v180, 0x80, v180
  v_and_or_b32 v180, v180, v185, v184
  buffer_store_dword v180, v178, s[36:39], s48 offen sc1
  v_mov_b32 v184, -1
  v_mov_b32 v185, -1
  v_mov_b32 v186, -1
  v_mov_b32 v187, -1
  buffer_store_dwordx4 v[184:187], v0, s[36:39], s70 offen sc1
  buffer_store_dword v184, v178, s[36:39], s71 offen sc1
  s_lshl_b32 s48, s44, 7
  s_add_u32 s48, s48, s2
  s_lshl_b32 s48, s48, 13
  v_lshlrev_b32 v14, 3, v0
  s_mov_b32 s50, s48
  buffer_load_dword a252, v14, s[8:11], s50 offen
  s_mov_b32 s55, 0x20000
  s_sub_u32 s49, s48, 2097152
  s_add_u32 s48, s48, 4194304
  s_cmp_ge_u32 s44, 2
  s_cselect_b64 s[52:53], s[12:13], s[8:9]
  s_cselect_b32 s54, s14, s10
  s_cselect_b32 s48, s49, s48
  v_mov_b32 v12, s3
  s_waitcnt vmcnt(1)
  s_barrier
  s_mov_b64 exec, 1
  buffer_store_dword v12, v0, s[36:39], s45 offen sc1
  s_mov_b64 exec, -1
  s_waitcnt vmcnt(1)
  s_lshr_b32 s49, s2, 3
  s_mul_i32 s49, s49, 393216
  s_add_u32 s49, s49, s64
  s_and_b32 s50, s2, 2
  s_lshl_b32 s50, s50, 9
  s_add_u32 s49, s49, s50
  s_and_b32 s50, s2, 1
  s_lshl2_add_u32 s50, s50, s44
  s_cmp_lt_u32 s50, 3
  s_cselect_b32 s49, s49, 1073741824
  v_min_u32 v15, 63, v10
  v_mul_u32_u24 v15, 6144, v15
  buffer_load_dword a252, v15, s[8:11], s49 offen offset:384
  buffer_load_dword a252, v14, s[52:55], s48 offen
  s_branch J2
.p2align 12
AL:
  s_waitcnt vmcnt(8)
  v_readfirstlane_b32 s3, v195
  s_lshl_b32 s45, s2, 7
  s_add_u32 s45, s45, 5242880
  s_cmp_eq_u32 s44, 0
  s_cselect_b32 s45, s45, 1073741824
  s_mul_i32 s3, s3, 0x9e3779b1
  s_add_u32 s3, s3, 0x7f4a7c15
  s_and_b32 s70, s2, 7
  s_bfe_u32 s49, s2, 0x20003
  s_lshl2_add_u32 s70, s70, s49
  s_lshr_b32 s49, s2, 5
  s_lshl3_add_u32 s70, s70, s49
  s_lshl1_add_u32 s70, s70, s44
  s_lshl_b32 s70, s70, 10
  s_add_u32 s70, s70, 524288
  s_add_u32 s56, s56, 8192
  s_cmp_lt_u32 s44, 2
  s_cselect_b32 s70, s70, 1073741824
  s_cmp_eq_u32 s44, 2
  s_cselect_b32 s71, s56, 1073741824
  s_add_u32 s48, s64, 150528
  v_add_u32 v14, s48, v0
  v_lshl_add_u32 v15, v13, 5, s48
  v_lshlrev_b32 v17, 6, v12
  v_add_u32 v17, 158720, v17
  s_lshl_b32 s48, s44, 4
  v_add_u32 v16, s48, v17
  v_bfe_u32 v18, v10, 3, 1
  v_lshlrev_b32 v132, 9, v18
  v_bfe_u32 v18, v10, 4, 1
  v_lshl_add_u32 v132, v18, 8, v132
  v_lshrrev_b32 v18, 5, v10
  v_lshl_add_u32 v132, v18, 11, v132
  v_lshl_add_u32 v132, v12, 4, v132
  s_bfe_u32 s50, s2, 0x60001
  s_lshl3_add_u32 s50, s50, s44
  s_lshl_b32 s50, s50, 3
  s_and_b32 s48, s2, 1
  s_add_u32 s50, s50, s48
  s_lshl_b32 s50, s50, 10
  s_add_u32 s50, s50, 1048576
  s_bfe_u32 s66, s3, 0x80000
  s_bfe_u32 s67, s3, 0x80008
  s_bfe_u32 s68, s3, 0x80010
  s_bfe_u32 s69, s3, 0x80018
  v_and_b32 v185, 0x200, v0
  v_mul_u32_u24 v185, 3, v185
  v_add_u32 v185, v185, v0
  s_waitcnt vmcnt(7)
  v_lshlrev_b32 v20, 16, v136
  v_and_b32 v21, 0xffff0000, v136
  v_lshlrev_b32 v22, 16, v137
  v_and_b32 v23, 0xffff0000, v137
  v_lshlrev_b32 v24, 16, v138
  v_and_b32 v25, 0xffff0000, v138
  v_lshlrev_b32 v26, 16, v139
  v_and_b32 v27, 0xffff0000, v139
  v_pk_mul_f32 v[126:127], v[20:21], v[20:21]
  v_pk_mul_f32 v[130:131], v[22:23], v[22:23]
  v_pk_fma_f32 v[126:127], v[24:25], v[24:25], v[126:127]
  v_pk_add_f32 v[124:125], v[24:25], v[20:21]
  v_pk_fma_f32 v[130:131], v[26:27], v[26:27], v[130:131]
  v_pk_add_f32 v[128:129], v[26:27], v[22:23]
  s_waitcnt vmcnt(6)
  v_lshlrev_b32 v28, 16, v140
  v_and_b32 v29, 0xffff0000, v140
  v_lshlrev_b32 v30, 16, v141
  v_and_b32 v31, 0xffff0000, v141
  v_lshlrev_b32 v32, 16, v142
  v_and_b32 v33, 0xffff0000, v142
  v_lshlrev_b32 v34, 16, v143
  v_and_b32 v35, 0xffff0000, v143
  v_pk_fma_f32 v[126:127], v[28:29], v[28:29], v[126:127]
  v_pk_add_f32 v[124:125], v[28:29], v[124:125]
  v_pk_fma_f32 v[130:131], v[30:31], v[30:31], v[130:131]
  v_pk_add_f32 v[128:129], v[30:31], v[128:129]
  v_pk_fma_f32 v[126:127], v[32:33], v[32:33], v[126:127]
  v_pk_add_f32 v[124:125], v[32:33], v[124:125]
  v_pk_fma_f32 v[130:131], v[34:35], v[34:35], v[130:131]
  v_pk_add_f32 v[128:129], v[34:35], v[128:129]
  s_waitcnt vmcnt(5)
  v_lshlrev_b32 v36, 16, v144
  v_and_b32 v37, 0xffff0000, v144
  v_lshlrev_b32 v38, 16, v145
  v_and_b32 v39, 0xffff0000, v145
  v_lshlrev_b32 v40, 16, v146
  v_and_b32 v41, 0xffff0000, v146
  v_lshlrev_b32 v42, 16, v147
  v_and_b32 v43, 0xffff0000, v147
  v_pk_fma_f32 v[126:127], v[36:37], v[36:37], v[126:127]
  v_pk_add_f32 v[124:125], v[36:37], v[124:125]
  v_pk_fma_f32 v[130:131], v[38:39], v[38:39], v[130:131]
  v_pk_add_f32 v[128:129], v[38:39], v[128:129]
  v_pk_fma_f32 v[126:127], v[40:41], v[40:41], v[126:127]
  v_pk_add_f32 v[124:125], v[40:41], v[124:125]
  v_pk_fma_f32 v[130:131], v[42:43], v[42:43], v[130:131]
  v_pk_add_f32 v[128:129], v[42:43], v[128:129]
  s_waitcnt vmcnt(4)
  v_lshlrev_b32 v44, 16, v148
  v_and_b32 v45, 0xffff0000, v148
  v_lshlrev_b32 v46, 16, v149
  v_and_b32 v47, 0xffff0000, v149
  v_lshlrev_b32 v48, 16, v150
  v_and_b32 v49, 0xffff0000, v150
  v_lshlrev_b32 v50, 16, v151
  v_and_b32 v51, 0xffff0000, v151
  v_pk_fma_f32 v[126:127], v[44:45], v[44:45], v[126:127]
  v_pk_add_f32 v[124:125], v[44:45], v[124:125]
  v_pk_fma_f32 v[130:131], v[46:47], v[46:47], v[130:131]
  v_pk_add_f32 v[128:129], v[46:47], v[128:129]
  v_pk_fma_f32 v[126:127], v[48:49], v[48:49], v[126:127]
  v_pk_add_f32 v[124:125], v[48:49], v[124:125]
  v_pk_fma_f32 v[130:131], v[50:51], v[50:51], v[130:131]
  v_pk_add_f32 v[128:129], v[50:51], v[128:129]
  v_pk_add_f32 v[124:125], v[124:125], v[128:129]
  v_pk_add_f32 v[126:127], v[126:127], v[130:131]
  v_add_f32 v180, v124, v125
  v_add_f32 v181, v126, v127
  s_waitcnt vmcnt(3)
  v_lshlrev_b32 v52, 16, v152
  v_and_b32 v53, 0xffff0000, v152
  v_lshlrev_b32 v54, 16, v153
  v_and_b32 v55, 0xffff0000, v153
  v_lshlrev_b32 v56, 16, v154
  v_and_b32 v57, 0xffff0000, v154
  v_lshlrev_b32 v58, 16, v155
  v_and_b32 v59, 0xffff0000, v155
  v_pk_mul_f32 v[126:127], v[52:53], v[52:53]
  v_pk_mul_f32 v[130:131], v[54:55], v[54:55]
  v_pk_fma_f32 v[126:127], v[56:57], v[56:57], v[126:127]
  v_pk_add_f32 v[124:125], v[56:57], v[52:53]
  v_pk_fma_f32 v[130:131], v[58:59], v[58:59], v[130:131]
  v_pk_add_f32 v[128:129], v[58:59], v[54:55]
  s_waitcnt vmcnt(2)
  v_lshlrev_b32 v60, 16, v156
  v_and_b32 v61, 0xffff0000, v156
  v_lshlrev_b32 v62, 16, v157
  v_and_b32 v63, 0xffff0000, v157
  v_lshlrev_b32 v64, 16, v158
  v_and_b32 v65, 0xffff0000, v158
  v_lshlrev_b32 v66, 16, v159
  v_and_b32 v67, 0xffff0000, v159
  v_pk_fma_f32 v[126:127], v[60:61], v[60:61], v[126:127]
  v_pk_add_f32 v[124:125], v[60:61], v[124:125]
  v_pk_fma_f32 v[130:131], v[62:63], v[62:63], v[130:131]
  v_pk_add_f32 v[128:129], v[62:63], v[128:129]
  v_pk_fma_f32 v[126:127], v[64:65], v[64:65], v[126:127]
  v_pk_add_f32 v[124:125], v[64:65], v[124:125]
  v_pk_fma_f32 v[130:131], v[66:67], v[66:67], v[130:131]
  v_pk_add_f32 v[128:129], v[66:67], v[128:129]
  s_waitcnt vmcnt(1)
  v_lshlrev_b32 v68, 16, v160
  v_and_b32 v69, 0xffff0000, v160
  v_lshlrev_b32 v70, 16, v161
  v_and_b32 v71, 0xffff0000, v161
  v_lshlrev_b32 v72, 16, v162
  v_and_b32 v73, 0xffff0000, v162
  v_lshlrev_b32 v74, 16, v163
  v_and_b32 v75, 0xffff0000, v163
  v_pk_fma_f32 v[126:127], v[68:69], v[68:69], v[126:127]
  v_pk_add_f32 v[124:125], v[68:69], v[124:125]
  v_pk_fma_f32 v[130:131], v[70:71], v[70:71], v[130:131]
  v_pk_add_f32 v[128:129], v[70:71], v[128:129]
  v_pk_fma_f32 v[126:127], v[72:73], v[72:73], v[126:127]
  v_pk_add_f32 v[124:125], v[72:73], v[124:125]
  v_pk_fma_f32 v[130:131], v[74:75], v[74:75], v[130:131]
  v_pk_add_f32 v[128:129], v[74:75], v[128:129]
  s_waitcnt vmcnt(0)
  v_lshlrev_b32 v76, 16, v164
  v_and_b32 v77, 0xffff0000, v164
  v_lshlrev_b32 v78, 16, v165
  v_and_b32 v79, 0xffff0000, v165
  v_lshlrev_b32 v80, 16, v166
  v_and_b32 v81, 0xffff0000, v166
  v_lshlrev_b32 v82, 16, v167
  v_and_b32 v83, 0xffff0000, v167
  v_pk_fma_f32 v[126:127], v[76:77], v[76:77], v[126:127]
  v_pk_add_f32 v[124:125], v[76:77], v[124:125]
  v_pk_fma_f32 v[130:131], v[78:79], v[78:79], v[130:131]
  v_pk_add_f32 v[128:129], v[78:79], v[128:129]
  v_pk_fma_f32 v[126:127], v[80:81], v[80:81], v[126:127]
  v_pk_add_f32 v[124:125], v[80:81], v[124:125]
  v_pk_fma_f32 v[130:131], v[82:83], v[82:83], v[130:131]
  v_pk_add_f32 v[128:129], v[82:83], v[128:129]
  v_pk_add_f32 v[124:125], v[124:125], v[128:129]
  v_pk_add_f32 v[126:127], v[126:127], v[130:131]
  v_add_f32 v182, v124, v125
  v_add_f32 v183, v126, v127
  s_nop 0
  v_add_f32_dpp v188, v180, v180 row_ror:8 row_mask:0xf bank_mask:0xf
  v_add_f32_dpp v189, v181, v181 row_ror:8 row_mask:0xf bank_mask:0xf
  v_add_f32_dpp v190, v182, v182 row_ror:8 row_mask:0xf bank_mask:0xf
  v_add_f32_dpp v191, v183, v183 row_ror:8 row_mask:0xf bank_mask:0xf
  v_mov_b32 v180, v188
  v_mov_b32 v181, v189
  v_mov_b32 v182, v190
  v_mov_b32 v183, v191
  v_permlane16_swap_b32 v188, v180
  v_permlane16_swap_b32 v189, v181
  v_permlane16_swap_b32 v190, v182
  v_permlane16_swap_b32 v191, v183
  v_pk_add_f32 v[188:189], v[188:189], v[180:181]
  v_pk_add_f32 v[190:191], v[190:191], v[182:183]
  v_mov_b32 v180, v188
  v_mov_b32 v181, v189
  v_mov_b32 v182, v190
  v_mov_b32 v183, v191
  v_permlane32_swap_b32 v188, v180
  v_permlane32_swap_b32 v189, v181
  v_permlane32_swap_b32 v190, v182
  v_permlane32_swap_b32 v191, v183
  v_pk_add_f32 v[188:189], v[188:189], v[180:181]
  v_pk_add_f32 v[190:191], v[190:191], v[182:183]
  ds_write_b128 v16, v[188:191]
  s_waitcnt lgkmcnt(0)
  s_barrier
  ds_read_b128 v[136:139], v17 offset:0
  ds_read_b128 v[140:143], v17 offset:16
  ds_read_b128 v[144:147], v17 offset:32
  ds_read_b128 v[148:151], v17 offset:48
  s_lshl_b32 s49, s44, 9
  buffer_load_dwordx4 v[220:223], v185, s[36:39], s49 offen sc1
  s_add_u32 s49, s49, 4096
  buffer_load_dwordx4 v[84:87], v185, s[36:39], s49 offen sc1
  s_add_u32 s49, s49, 20480
  buffer_load_dwordx4 v[224:227], v185, s[36:39], s49 offen sc1
  s_add_u32 s49, s49, 4096
  buffer_load_dwordx4 v[88:91], v185, s[36:39], s49 offen sc1
  s_add_u32 s49, s49, 20480
  buffer_load_dwordx4 v[228:231], v185, s[36:39], s49 offen sc1
  s_add_u32 s49, s49, 4096
  buffer_load_dwordx4 v[92:95], v185, s[36:39], s49 offen sc1
  s_add_u32 s49, s49, 20480
  buffer_load_dwordx4 v[232:235], v185, s[36:39], s49 offen sc1
  s_add_u32 s49, s49, 4096
  buffer_load_dwordx4 v[96:99], v185, s[36:39], s49 offen sc1
  s_waitcnt lgkmcnt(0)
  v_pk_add_f32 v[136:137], v[136:137], v[144:145]
  v_pk_add_f32 v[138:139], v[138:139], v[146:147]
  v_pk_add_f32 v[140:141], v[140:141], v[148:149]
  v_pk_add_f32 v[142:143], v[142:143], v[150:151]
  v_pk_add_f32 v[136:137], v[136:137], v[140:141]
  v_pk_add_f32 v[138:139], v[138:139], v[142:143]
  v_mul_f32 v188, 0x3a800000, v136
  v_mul_f32 v189, 0x3a800000, v137
  v_mul_f32 v190, 0x3a800000, v138
  v_mul_f32 v191, 0x3a800000, v139
  v_fma_f32 v189, -v188, v188, v189
  v_fma_f32 v191, -v190, v190, v191
  v_max_f32 v189, 0, v189
  v_max_f32 v191, 0, v191
  v_cvt_pk_bf16_f32 v189, v189, v189
  v_cvt_pk_bf16_f32 v191, v191, v191
  v_lshlrev_b32 v189, 16, v189
  v_lshlrev_b32 v191, 16, v191
  v_add_f32 v189, 0x3727c5ac, v189
  v_add_f32 v191, 0x3727c5ac, v191
  v_cvt_pk_bf16_f32 v189, v189, v189
  v_cvt_pk_bf16_f32 v191, v191, v191
  v_lshlrev_b32 v189, 16, v189
  v_lshlrev_b32 v191, 16, v191
  v_sqrt_f32 v189, v189
  v_sqrt_f32 v191, v191
  v_cvt_pk_bf16_f32 v188, v188, v188
  v_cvt_pk_bf16_f32 v190, v190, v190
  v_lshlrev_b32 v188, 16, v188
  v_lshlrev_b32 v190, 16, v190
  v_cvt_pk_bf16_f32 v189, v189, v189
  v_cvt_pk_bf16_f32 v191, v191, v191
  v_lshlrev_b32 v189, 16, v189
  v_lshlrev_b32 v191, 16, v191
  v_rcp_f32 v189, v189
  v_rcp_f32 v191, v191
  v_mul_f32 v188, -v188, v189
  v_mul_f32 v190, -v190, v191
  v_pk_fma_f32 v[20:21], v[20:21], v[188:189], v[188:189] op_sel:[0,1,0] op_sel_hi:[1,1,0]
  v_pk_fma_f32 v[22:23], v[22:23], v[188:189], v[188:189] op_sel:[0,1,0] op_sel_hi:[1,1,0]
  v_pk_fma_f32 v[24:25], v[24:25], v[188:189], v[188:189] op_sel:[0,1,0] op_sel_hi:[1,1,0]
  v_pk_fma_f32 v[26:27], v[26:27], v[188:189], v[188:189] op_sel:[0,1,0] op_sel_hi:[1,1,0]
  v_pk_fma_f32 v[28:29], v[28:29], v[188:189], v[188:189] op_sel:[0,1,0] op_sel_hi:[1,1,0]
  v_pk_fma_f32 v[30:31], v[30:31], v[188:189], v[188:189] op_sel:[0,1,0] op_sel_hi:[1,1,0]
  v_pk_fma_f32 v[32:33], v[32:33], v[188:189], v[188:189] op_sel:[0,1,0] op_sel_hi:[1,1,0]
  v_pk_fma_f32 v[34:35], v[34:35], v[188:189], v[188:189] op_sel:[0,1,0] op_sel_hi:[1,1,0]
  v_pk_fma_f32 v[36:37], v[36:37], v[188:189], v[188:189] op_sel:[0,1,0] op_sel_hi:[1,1,0]
  v_pk_fma_f32 v[38:39], v[38:39], v[188:189], v[188:189] op_sel:[0,1,0] op_sel_hi:[1,1,0]
  v_pk_fma_f32 v[40:41], v[40:41], v[188:189], v[188:189] op_sel:[0,1,0] op_sel_hi:[1,1,0]
  v_pk_fma_f32 v[42:43], v[42:43], v[188:189], v[188:189] op_sel:[0,1,0] op_sel_hi:[1,1,0]
  v_pk_fma_f32 v[44:45], v[44:45], v[188:189], v[188:189] op_sel:[0,1,0] op_sel_hi:[1,1,0]
  v_pk_fma_f32 v[46:47], v[46:47], v[188:189], v[188:189] op_sel:[0,1,0] op_sel_hi:[1,1,0]
  v_pk_fma_f32 v[48:49], v[48:49], v[188:189], v[188:189] op_sel:[0,1,0] op_sel_hi:[1,1,0]
  v_pk_fma_f32 v[50:51], v[50:51], v[188:189], v[188:189] op_sel:[0,1,0] op_sel_hi:[1,1,0]
  v_pk_fma_f32 v[52:53], v[52:53], v[190:191], v[190:191] op_sel:[0,1,0] op_sel_hi:[1,1,0]
  v_pk_fma_f32 v[54:55], v[54:55], v[190:191], v[190:191] op_sel:[0,1,0] op_sel_hi:[1,1,0]
  v_pk_fma_f32 v[56:57], v[56:57], v[190:191], v[190:191] op_sel:[0,1,0] op_sel_hi:[1,1,0]
  v_pk_fma_f32 v[58:59], v[58:59], v[190:191], v[190:191] op_sel:[0,1,0] op_sel_hi:[1,1,0]
  v_pk_fma_f32 v[60:61], v[60:61], v[190:191], v[190:191] op_sel:[0,1,0] op_sel_hi:[1,1,0]
  v_pk_fma_f32 v[62:63], v[62:63], v[190:191], v[190:191] op_sel:[0,1,0] op_sel_hi:[1,1,0]
  v_pk_fma_f32 v[64:65], v[64:65], v[190:191], v[190:191] op_sel:[0,1,0] op_sel_hi:[1,1,0]
  v_pk_fma_f32 v[66:67], v[66:67], v[190:191], v[190:191] op_sel:[0,1,0] op_sel_hi:[1,1,0]
  v_pk_fma_f32 v[68:69], v[68:69], v[190:191], v[190:191] op_sel:[0,1,0] op_sel_hi:[1,1,0]
  v_pk_fma_f32 v[70:71], v[70:71], v[190:191], v[190:191] op_sel:[0,1,0] op_sel_hi:[1,1,0]
  v_pk_fma_f32 v[72:73], v[72:73], v[190:191], v[190:191] op_sel:[0,1,0] op_sel_hi:[1,1,0]
  v_pk_fma_f32 v[74:75], v[74:75], v[190:191], v[190:191] op_sel:[0,1,0] op_sel_hi:[1,1,0]
  v_pk_fma_f32 v[76:77], v[76:77], v[190:191], v[190:191] op_sel:[0,1,0] op_sel_hi:[1,1,0]
  v_pk_fma_f32 v[78:79], v[78:79], v[190:191], v[190:191] op_sel:[0,1,0] op_sel_hi:[1,1,0]
  v_pk_fma_f32 v[80:81], v[80:81], v[190:191], v[190:191] op_sel:[0,1,0] op_sel_hi:[1,1,0]
  v_pk_fma_f32 v[82:83], v[82:83], v[190:191], v[190:191] op_sel:[0,1,0] op_sel_hi:[1,1,0]
  s_mov_b32 s46, 30000
  s_branch PLC
PLP:
  s_lshl_b32 s49, s44, 9
  buffer_load_dwordx4 v[220:223], v185, s[36:39], s49 offen sc1
  s_add_u32 s49, s49, 4096
  buffer_load_dwordx4 v[84:87], v185, s[36:39], s49 offen sc1
  s_add_u32 s49, s49, 20480
  buffer_load_dwordx4 v[224:227], v185, s[36:39], s49 offen sc1
  s_add_u32 s49, s49, 4096
  buffer_load_dwordx4 v[88:91], v185, s[36:39], s49 offen sc1
  s_add_u32 s49, s49, 20480
  buffer_load_dwordx4 v[228:231], v185, s[36:39], s49 offen sc1
  s_add_u32 s49, s49, 4096
  buffer_load_dwordx4 v[92:95], v185, s[36:39], s49 offen sc1
  s_add_u32 s49, s49, 20480
  buffer_load_dwordx4 v[232:235], v185, s[36:39], s49 offen sc1
  s_add_u32 s49, s49, 4096
  buffer_load_dwordx4 v[96:99], v185, s[36:39], s49 offen sc1
PLC:
  s_waitcnt vmcnt(7)
  v_xor_b32 v220, s66, v220
  v_xor_b32 v221, s67, v221
  v_xor_b32 v222, s68, v222
  v_xor_b32 v223, s69, v223
  v_or3_b32 v184, 0, v220, v221
  v_or3_b32 v184, v184, v222, v223
  s_waitcnt vmcnt(6)
  v_xor_b32 v84, s66, v84
  v_xor_b32 v85, s67, v85
  v_xor_b32 v86, s68, v86
  v_xor_b32 v87, s69, v87
  v_or3_b32 v184, v184, v84, v85
  v_or3_b32 v184, v184, v86, v87
  s_waitcnt vmcnt(5)
  v_xor_b32 v224, s66, v224
  v_xor_b32 v225, s67, v225
  v_xor_b32 v226, s68, v226
  v_xor_b32 v227, s69, v227
  v_or3_b32 v184, v184, v224, v225
  v_or3_b32 v184, v184, v226, v227
  s_waitcnt vmcnt(4)
  v_xor_b32 v88, s66, v88
  v_xor_b32 v89, s67, v89
  v_xor_b32 v90, s68, v90
  v_xor_b32 v91, s69, v91
  v_or3_b32 v184, v184, v88, v89
  v_or3_b32 v184, v184, v90, v91
  s_waitcnt vmcnt(3)
  v_xor_b32 v228, s66, v228
  v_xor_b32 v229, s67, v229
  v_xor_b32 v230, s68, v230
  v_xor_b32 v231, s69, v231
  v_or3_b32 v184, v184, v228, v229
  v_or3_b32 v184, v184, v230, v231
  s_waitcnt vmcnt(2)
  v_xor_b32 v92, s66, v92
  v_xor_b32 v93, s67, v93
  v_xor_b32 v94, s68, v94
  v_xor_b32 v95, s69, v95
  v_or3_b32 v184, v184, v92, v93
  v_or3_b32 v184, v184, v94, v95
  s_waitcnt vmcnt(1)
  v_xor_b32 v232, s66, v232
  v_xor_b32 v233, s67, v233
  v_xor_b32 v234, s68, v234
  v_xor_b32 v235, s69, v235
  v_or3_b32 v184, v184, v232, v233
  v_or3_b32 v184, v184, v234, v235
  s_waitcnt vmcnt(0)
  v_xor_b32 v96, s66, v96
  v_xor_b32 v97, s67, v97
  v_xor_b32 v98, s68, v98
  v_xor_b32 v99, s69, v99
  v_or3_b32 v184, v184, v96, v97
  v_or3_b32 v184, v184, v98, v99
  v_and_b32 v184, 0xff, v184
  v_cmp_ne_u32 vcc, 0, v184
  s_sub_u32 s46, s46, 1
  s_cmp_eq_u32 s46, 0
  s_cbranch_scc1 PLX
  s_nop 1
  s_cbranch_vccnz PLP
PLX:
  v_mov_b32 v180, -1
  v_mov_b32 v181, -1
  v_mov_b32 v182, -1
  v_mov_b32 v183, -1
  buffer_store_dwordx4 v[180:183], v0, s[36:39], s70 offen sc1
  buffer_store_dword v180, v178, s[36:39], s71 offen sc1
  v_pk_add_f32 v[84:85], v[84:85], v[92:93]
  v_pk_add_f32 v[220:221], v[220:221], v[228:229]
  v_pk_add_f32 v[86:87], v[86:87], v[94:95]
  v_pk_add_f32 v[222:223], v[222:223], v[230:231]
  v_pk_add_f32 v[88:89], v[88:89], v[96:97]
  v_pk_add_f32 v[224:225], v[224:225], v[232:233]
  v_pk_add_f32 v[90:91], v[90:91], v[98:99]
  v_pk_add_f32 v[226:227], v[226:227], v[234:235]
  v_pk_add_f32 v[84:85], v[84:85], v[88:89]
  v_pk_add_f32 v[220:221], v[220:221], v[224:225]
  v_pk_add_f32 v[86:87], v[86:87], v[90:91]
  v_pk_add_f32 v[222:223], v[222:223], v[226:227]
  v_cvt_pk_bf16_f32 v184, v220, v221
  v_lshlrev_b32 v220, 16, v184
  v_and_b32 v221, 0xffff0000, v184
  v_cvt_pk_bf16_f32 v184, v222, v223
  v_lshlrev_b32 v222, 16, v184
  v_and_b32 v223, 0xffff0000, v184
  ds_write_b128 v14, v[220:223] offset:1024
  v_cvt_pk_bf16_f32 v184, v84, v85
  v_lshlrev_b32 v84, 16, v184
  v_and_b32 v85, 0xffff0000, v184
  v_pk_add_f32 v[84:85], v[84:85], 1.0 op_sel_hi:[1,0]
  v_cvt_pk_bf16_f32 v184, v84, v85
  v_lshlrev_b32 v84, 16, v184
  v_and_b32 v85, 0xffff0000, v184
  v_cvt_pk_bf16_f32 v184, v86, v87
  v_lshlrev_b32 v86, 16, v184
  v_and_b32 v87, 0xffff0000, v184
  v_pk_add_f32 v[86:87], v[86:87], 1.0 op_sel_hi:[1,0]
  v_cvt_pk_bf16_f32 v184, v86, v87
  v_lshlrev_b32 v86, 16, v184
  v_and_b32 v87, 0xffff0000, v184
  ds_write_b128 v14, v[84:87]
  ds_read_b128 v[220:223], v15 offset:1024
  ds_read_b128 v[84:87], v15 offset:0
  ds_read_b128 v[224:227], v15 offset:1040
  ds_read_b128 v[88:91], v15 offset:16
  ds_read_b128 v[228:231], v15 offset:1280
  ds_read_b128 v[92:95], v15 offset:256
  ds_read_b128 v[232:235], v15 offset:1296
  ds_read_b128 v[96:99], v15 offset:272
  ds_read_b128 v[236:239], v15 offset:1536
  ds_read_b128 v[100:103], v15 offset:512
  ds_read_b128 v[240:243], v15 offset:1552
  ds_read_b128 v[104:107], v15 offset:528
  ds_read_b128 v[244:247], v15 offset:1792
  ds_read_b128 v[108:111], v15 offset:768
  ds_read_b128 v[248:251], v15 offset:1808
  ds_read_b128 v[112:115], v15 offset:784
  s_waitcnt lgkmcnt(12)
  v_pk_fma_f32 v[20:21], v[20:21], v[84:85], v[220:221]
  v_pk_fma_f32 v[22:23], v[22:23], v[86:87], v[222:223]
  v_pk_fma_f32 v[24:25], v[24:25], v[88:89], v[224:225]
  v_pk_fma_f32 v[26:27], v[26:27], v[90:91], v[226:227]
  v_pk_fma_f32 v[52:53], v[52:53], v[84:85], v[220:221]
  v_pk_fma_f32 v[54:55], v[54:55], v[86:87], v[222:223]
  v_pk_fma_f32 v[56:57], v[56:57], v[88:89], v[224:225]
  v_pk_fma_f32 v[58:59], v[58:59], v[90:91], v[226:227]
  v_cvt_pk_bf16_f32 v136, v20, v21
  v_cvt_pk_bf16_f32 v137, v22, v23
  v_cvt_pk_bf16_f32 v138, v24, v25
  v_cvt_pk_bf16_f32 v139, v26, v27
  v_cvt_pk_bf16_f32 v152, v52, v53
  v_cvt_pk_bf16_f32 v153, v54, v55
  v_cvt_pk_bf16_f32 v154, v56, v57
  v_cvt_pk_bf16_f32 v155, v58, v59
  v_permlane16_swap_b32 v136, v138
  v_permlane16_swap_b32 v137, v139
  v_permlane16_swap_b32 v152, v154
  v_permlane16_swap_b32 v153, v155
  buffer_store_dwordx4 v[136:139], v132, s[36:39], s50 offen offset:0 sc1
  buffer_store_dwordx4 v[152:155], v132, s[36:39], s50 offen offset:128 sc1
  s_add_u32 s50, s50, 4096
  s_waitcnt lgkmcnt(8)
  v_pk_fma_f32 v[28:29], v[28:29], v[92:93], v[228:229]
  v_pk_fma_f32 v[30:31], v[30:31], v[94:95], v[230:231]
  v_pk_fma_f32 v[32:33], v[32:33], v[96:97], v[232:233]
  v_pk_fma_f32 v[34:35], v[34:35], v[98:99], v[234:235]
  v_pk_fma_f32 v[60:61], v[60:61], v[92:93], v[228:229]
  v_pk_fma_f32 v[62:63], v[62:63], v[94:95], v[230:231]
  v_pk_fma_f32 v[64:65], v[64:65], v[96:97], v[232:233]
  v_pk_fma_f32 v[66:67], v[66:67], v[98:99], v[234:235]
  v_cvt_pk_bf16_f32 v140, v28, v29
  v_cvt_pk_bf16_f32 v141, v30, v31
  v_cvt_pk_bf16_f32 v142, v32, v33
  v_cvt_pk_bf16_f32 v143, v34, v35
  v_cvt_pk_bf16_f32 v156, v60, v61
  v_cvt_pk_bf16_f32 v157, v62, v63
  v_cvt_pk_bf16_f32 v158, v64, v65
  v_cvt_pk_bf16_f32 v159, v66, v67
  v_permlane16_swap_b32 v140, v142
  v_permlane16_swap_b32 v141, v143
  v_permlane16_swap_b32 v156, v158
  v_permlane16_swap_b32 v157, v159
  buffer_store_dwordx4 v[140:143], v132, s[36:39], s50 offen offset:0 sc1
  buffer_store_dwordx4 v[156:159], v132, s[36:39], s50 offen offset:128 sc1
  s_add_u32 s50, s50, 28672
  s_waitcnt lgkmcnt(4)
  v_pk_fma_f32 v[36:37], v[36:37], v[100:101], v[236:237]
  v_pk_fma_f32 v[38:39], v[38:39], v[102:103], v[238:239]
  v_pk_fma_f32 v[40:41], v[40:41], v[104:105], v[240:241]
  v_pk_fma_f32 v[42:43], v[42:43], v[106:107], v[242:243]
  v_pk_fma_f32 v[68:69], v[68:69], v[100:101], v[236:237]
  v_pk_fma_f32 v[70:71], v[70:71], v[102:103], v[238:239]
  v_pk_fma_f32 v[72:73], v[72:73], v[104:105], v[240:241]
  v_pk_fma_f32 v[74:75], v[74:75], v[106:107], v[242:243]
  v_cvt_pk_bf16_f32 v144, v36, v37
  v_cvt_pk_bf16_f32 v145, v38, v39
  v_cvt_pk_bf16_f32 v146, v40, v41
  v_cvt_pk_bf16_f32 v147, v42, v43
  v_cvt_pk_bf16_f32 v160, v68, v69
  v_cvt_pk_bf16_f32 v161, v70, v71
  v_cvt_pk_bf16_f32 v162, v72, v73
  v_cvt_pk_bf16_f32 v163, v74, v75
  v_permlane16_swap_b32 v144, v146
  v_permlane16_swap_b32 v145, v147
  v_permlane16_swap_b32 v160, v162
  v_permlane16_swap_b32 v161, v163
  buffer_store_dwordx4 v[144:147], v132, s[36:39], s50 offen offset:0 sc1
  buffer_store_dwordx4 v[160:163], v132, s[36:39], s50 offen offset:128 sc1
  s_add_u32 s50, s50, 4096
  s_waitcnt lgkmcnt(0)
  v_pk_fma_f32 v[44:45], v[44:45], v[108:109], v[244:245]
  v_pk_fma_f32 v[46:47], v[46:47], v[110:111], v[246:247]
  v_pk_fma_f32 v[48:49], v[48:49], v[112:113], v[248:249]
  v_pk_fma_f32 v[50:51], v[50:51], v[114:115], v[250:251]
  v_pk_fma_f32 v[76:77], v[76:77], v[108:109], v[244:245]
  v_pk_fma_f32 v[78:79], v[78:79], v[110:111], v[246:247]
  v_pk_fma_f32 v[80:81], v[80:81], v[112:113], v[248:249]
  v_pk_fma_f32 v[82:83], v[82:83], v[114:115], v[250:251]
  v_cvt_pk_bf16_f32 v148, v44, v45
  v_cvt_pk_bf16_f32 v149, v46, v47
  v_cvt_pk_bf16_f32 v150, v48, v49
  v_cvt_pk_bf16_f32 v151, v50, v51
  v_cvt_pk_bf16_f32 v164, v76, v77
  v_cvt_pk_bf16_f32 v165, v78, v79
  v_cvt_pk_bf16_f32 v166, v80, v81
  v_cvt_pk_bf16_f32 v167, v82, v83
  v_permlane16_swap_b32 v148, v150
  v_permlane16_swap_b32 v149, v151
  v_permlane16_swap_b32 v164, v166
  v_permlane16_swap_b32 v165, v167
  buffer_store_dwordx4 v[148:151], v132, s[36:39], s50 offen offset:0 sc1
  buffer_store_dwordx4 v[164:167], v132, s[36:39], s50 offen offset:128 sc1
  v_mov_b32 v12, s3
  s_waitcnt vmcnt(4) lgkmcnt(0)
  s_barrier
  s_mov_b64 exec, 1
  buffer_store_dword v12, v0, s[36:39], s45 offen sc1
  s_mov_b64 exec, -1
J2:
  s_mov_b32 s61, 0
  s_add_u32 m0, s63, 21504
  s_nop 0
  buffer_load_dwordx4 v202, s[8:11], s61 offen offset:0 lds
  s_mov_b32 s61, 2048
  s_add_u32 m0, s63, 43008
  s_nop 0
  buffer_load_dwordx4 v202, s[8:11], s61 offen offset:0 lds
  buffer_load_dwordx4 v203, s[8:11], s61 offen offset:1024 lds
  s_mov_b32 s61, 4096
  s_add_u32 m0, s63, 64512
  s_nop 0
  buffer_load_dwordx4 v202, s[8:11], s61 offen offset:0 lds
  buffer_load_dwordx4 v203, s[8:11], s61 offen offset:1024 lds
  buffer_load_dwordx4 v204, s[8:11], s61 offen offset:2048 lds
  s_mov_b32 s61, 196608
  s_add_u32 m0, s63, 86016
  s_nop 0
  buffer_load_dwordx4 v202, s[8:11], s61 offen offset:0 lds
  buffer_load_dwordx4 v203, s[8:11], s61 offen offset:1024 lds
  buffer_load_dwordx4 v204, s[8:11], s61 offen offset:2048 lds
  s_mov_b32 s61, 395264
  s_add_u32 m0, s63, 107520
  s_nop 0
  buffer_load_dwordx4 v202, s[8:11], s61 offen offset:0 lds
  buffer_load_dwordx4 v203, s[8:11], s61 offen offset:1024 lds
  buffer_load_dwordx4 v204, s[8:11], s61 offen offset:2048 lds
  s_mov_b32 s61, 593920
  s_add_u32 m0, s63, 129024
  s_nop 0
  buffer_load_dwordx4 v202, s[8:11], s61 offen offset:0 lds
  buffer_load_dwordx4 v203, s[8:11], s61 offen offset:1024 lds
  buffer_load_dwordx4 v204, s[8:11], s61 offen offset:2048 lds
  s_mov_b32 s61, 786432
  s_add_u32 m0, s63, 0
  s_nop 0
  buffer_load_dwordx4 v202, s[8:11], s61 offen offset:0 lds
  buffer_load_dwordx4 v203, s[8:11], s61 offen offset:1024 lds
  buffer_load_dwordx4 v204, s[8:11], s61 offen offset:2048 lds
  s_mov_b64 exec, 0
  s_cmp_eq_u32 s44, 1
  s_cbranch_scc1 Ha0
  s_cmp_eq_u32 s44, 2
  s_cbranch_scc1 Ha1
  s_cmp_eq_u32 s44, 3
  s_cbranch_scc1 Ha2
Ra:
  s_mov_b64 exec, -1
  s_cmp_lg_u32 s44, 0
  s_cbranch_scc1 SM2x
  s_mov_b32 s46, 60000
  s_mov_b32 s47, 5242880
SM2:
  buffer_load_dword v13, v215, s[36:39], s47 offen sc1
  s_sub_u32 s46, s46, 1
  s_cmp_eq_u32 s46, 0
  s_waitcnt vmcnt(0)
  s_cbranch_scc1 SM2x
  v_cmp_ne_u32 vcc, s3, v13
  s_nop 4
  s_cbranch_vccnz SM2
SM2x:
  s_waitcnt vmcnt(19)
  s_barrier
  s_mov_b32 s62, 0
  s_add_u32 m0, s64, 33792
  s_nop 0
  buffer_load_dwordx4 v205, s[36:39], s62 offen offset:0 sc1 lds
  buffer_load_dwordx4 v205, s[36:39], s62 offen offset:1024 sc1 lds
  s_add_u32 m0, s65, 41984
  s_nop 0
  buffer_load_dword v206, s[36:39], s62 offen sc1 lds
  s_mov_b32 s62, 2048
  s_add_u32 m0, s64, 55296
  s_nop 0
  buffer_load_dwordx4 v205, s[36:39], s62 offen offset:0 sc1 lds
  buffer_load_dwordx4 v205, s[36:39], s62 offen offset:1024 sc1 lds
  s_add_u32 m0, s65, 63488
  s_nop 0
  buffer_load_dword v206, s[36:39], s62 offen sc1 lds
  s_mov_b32 s62, 4096
  s_add_u32 m0, s64, 76800
  s_nop 0
  buffer_load_dwordx4 v205, s[36:39], s62 offen offset:0 sc1 lds
  buffer_load_dwordx4 v205, s[36:39], s62 offen offset:1024 sc1 lds
  s_add_u32 m0, s65, 84992
  s_nop 0
Ha0:
  s_cbranch_execz Ha0_1
  buffer_load_dword v206, s[36:39], s62 offen sc1 lds
  s_mov_b32 s62, 6144
  s_add_u32 m0, s64, 98304
  s_nop 0
  buffer_load_dwordx4 v205, s[36:39], s62 offen offset:0 sc1 lds
  buffer_load_dwordx4 v205, s[36:39], s62 offen offset:1024 sc1 lds
  s_add_u32 m0, s65, 106496
  s_nop 0
  buffer_load_dword v206, s[36:39], s62 offen sc1 lds
  s_add_u32 s45, s45, 4
  s_mov_b32 s66, 5242884
  s_mov_b64 exec, 1
  buffer_store_dword v12, v0, s[36:39], s45 offen sc1
  s_mov_b64 exec, -1
  s_waitcnt vmcnt(7)
  s_barrier
  ds_read_b64_tr_b16 a[80:81], v196 offset:21504
  ds_read_b64_tr_b16 a[82:83], v196 offset:27648
  ds_read_b64_tr_b16 a[84:85], v197 offset:21504
  ds_read_b64_tr_b16 a[86:87], v197 offset:27648
  ds_read_b64_tr_b16 a[88:89], v196 offset:43008
  ds_read_b64_tr_b16 a[90:91], v196 offset:49152
  ds_read_b64_tr_b16 a[92:93], v196 offset:44032
  ds_read_b64_tr_b16 a[94:95], v196 offset:50176
  ds_read_b64_tr_b16 a[96:97], v197 offset:43008
  ds_read_b128 a[0:3], v207 offset:33792
  ds_read_b128 a[4:7], v207 offset:34816
  ds_read_b128 a[8:11], v207 offset:35840
  ds_read_b128 a[12:15], v207 offset:36864
  ds_read_b128 a[16:19], v210 offset:41984
  s_waitcnt lgkmcnt(0)
  v_mfma_f32_16x16x32_bf16 v[84:87], a[80:83], a[0:3], 0
  s_mov_b32 s62, 8192
  ds_read_b128 a[20:23], v207 offset:55296
  s_add_u32 m0, s64, 119808
  v_mfma_f32_16x16x32_bf16 v[88:91], a[80:83], a[4:7], 0
  s_waitcnt vmcnt(4)
  s_barrier
  ds_read_b128 a[24:27], v207 offset:56320
  v_mfma_f32_16x16x32_bf16 v[92:95], a[80:83], a[8:11], 0
  ds_read_b128 a[28:31], v207 offset:57344
  v_mfma_f32_16x16x32_bf16 v[96:99], a[80:83], a[12:15], 0
  s_waitcnt lgkmcnt(13)
  ds_read_b128 a[32:35], v207 offset:58368
  v_mfma_f32_16x16x32_bf16 v[112:115], a[84:87], a[12:15], 0
  ds_read_b128 a[36:39], v210 offset:63488
  v_mfma_f32_16x16x32_bf16 v[108:111], a[84:87], a[8:11], 0
  buffer_load_dwordx4 v205, s[36:39], s62 offen offset:0 sc1 lds
  v_mfma_f32_16x16x32_bf16 v[104:107], a[84:87], a[4:7], 0
  ds_read_b64_tr_b16 a[98:99], v197 offset:49152
  v_mfma_f32_16x16x32_bf16 v[100:103], a[84:87], a[0:3], 0
  s_waitcnt lgkmcnt(1)
  ds_read_b64_tr_b16 a[100:101], v197 offset:44032
  v_mfma_f32_16x16x32_bf16 v[20:23], a[88:91], a[0:3], 0
  ds_read_b64_tr_b16 a[102:103], v197 offset:50176
  v_mfma_f32_16x16x32_bf16 v[20:23], a[92:95], a[20:23], v[20:23]
  buffer_load_dwordx4 v205, s[36:39], s62 offen offset:1024 sc1 lds
  s_add_u32 m0, s65, 128000
  v_mfma_f32_16x16x32_bf16 v[24:27], a[92:95], a[24:27], 0
  ds_read_b128 a[40:43], v208 offset:12288
  v_mfma_f32_16x16x32_bf16 v[24:27], a[88:91], a[4:7], v[24:27]
  ds_read_b64_tr_b16 a[104:105], v198 offset:0
  v_mfma_f32_16x16x32_bf16 v[28:31], a[88:91], a[8:11], 0
  ds_read_b128 a[44:47], v208 offset:13312
  v_mfma_f32_16x16x32_bf16 v[28:31], a[92:95], a[28:31], v[28:31]
  buffer_load_dword v206, s[36:39], s62 offen sc1 lds
  s_mov_b32 s62, 10240
  v_mfma_f32_16x16x32_bf16 v[32:35], a[92:95], a[32:35], 0
  s_add_u32 m0, s64, 141312
  ds_read_b64_tr_b16 a[106:107], v198 offset:6144
  v_mfma_f32_16x16x32_bf16 v[32:35], a[88:91], a[12:15], v[32:35]
  ds_read_b128 a[48:51], v208 offset:14336
  v_mfma_f32_16x16x32_bf16 v[116:119], a[88:91], a[16:19], 0
  ds_read_b64_tr_b16 a[108:109], v198 offset:1024
  v_mfma_f32_16x16x32_bf16 v[116:119], a[92:95], a[36:39], v[116:119]
  s_waitcnt lgkmcnt(6)
  ds_read_b128 a[52:55], v208 offset:15360
  v_mfma_f32_16x16x32_bf16 v[48:51], a[96:99], a[12:15], 0
  buffer_load_dwordx4 v205, s[36:39], s62 offen offset:0 sc1 lds
  v_mfma_f32_16x16x32_bf16 v[48:51], a[100:103], a[32:35], v[48:51]
  ds_read_b128 a[56:59], v211 offset:20480
  v_mfma_f32_16x16x32_bf16 v[44:47], a[100:103], a[28:31], 0
  ds_read_b64_tr_b16 a[110:111], v198 offset:7168
  v_mfma_f32_16x16x32_bf16 v[44:47], a[96:99], a[8:11], v[44:47]
  ds_read_b64_tr_b16 a[112:113], v198 offset:2048
  v_mfma_f32_16x16x32_bf16 v[40:43], a[96:99], a[4:7], 0
  buffer_load_dwordx4 v205, s[36:39], s62 offen offset:1024 sc1 lds
  s_add_u32 m0, s65, 149504
  v_mfma_f32_16x16x32_bf16 v[40:43], a[100:103], a[24:27], v[40:43]
  ds_read_b64_tr_b16 a[114:115], v198 offset:8192
  v_mfma_f32_16x16x32_bf16 v[36:39], a[100:103], a[20:23], 0
  ds_read_b64_tr_b16 a[80:81], v199 offset:0
  v_mfma_f32_16x16x32_bf16 v[36:39], a[96:99], a[0:3], v[36:39]
  s_waitcnt lgkmcnt(1)
  ds_read_b64_tr_b16 a[82:83], v199 offset:6144
  v_mfma_f32_16x16x32_bf16 v[52:55], a[0:3], a[104:107], 0
  buffer_load_dword v206, s[36:39], s62 offen sc1 lds
  s_mov_b32 s62, 12288
  v_mfma_f32_16x16x32_bf16 v[52:55], a[20:23], a[108:111], v[52:55]
  s_add_u32 m0, s64, 12288
  ds_read_b64_tr_b16 a[84:85], v199 offset:1024
  v_mfma_f32_16x16x32_bf16 v[52:55], a[40:43], a[112:115], v[52:55]
  s_waitcnt vmcnt(7)
  s_barrier
  ds_read_b64_tr_b16 a[86:87], v199 offset:7168
  v_mfma_f32_16x16x32_bf16 v[56:59], a[44:47], a[112:115], 0
  ds_read_b64_tr_b16 a[88:89], v199 offset:2048
  v_mfma_f32_16x16x32_bf16 v[56:59], a[24:27], a[108:111], v[56:59]
  buffer_load_dwordx4 v205, s[36:39], s62 offen offset:0 sc1 lds
  v_mfma_f32_16x16x32_bf16 v[56:59], a[4:7], a[104:107], v[56:59]
  ds_read_b64_tr_b16 a[90:91], v199 offset:8192
  v_mfma_f32_16x16x32_bf16 v[60:63], a[8:11], a[104:107], 0
  ds_read_b128 a[60:63], v208 offset:33792
  v_mfma_f32_16x16x32_bf16 v[60:63], a[28:31], a[108:111], v[60:63]
  ds_read_b64_tr_b16 a[92:93], v198 offset:21504
  v_mfma_f32_16x16x32_bf16 v[60:63], a[48:51], a[112:115], v[60:63]
  buffer_load_dwordx4 v205, s[36:39], s62 offen offset:1024 sc1 lds
  s_add_u32 m0, s65, 20480
  v_mfma_f32_16x16x32_bf16 v[64:67], a[52:55], a[112:115], 0
  ds_read_b128 a[64:67], v208 offset:34816
  v_mfma_f32_16x16x32_bf16 v[64:67], a[32:35], a[108:111], v[64:67]
  ds_read_b64_tr_b16 a[94:95], v198 offset:27648
  v_mfma_f32_16x16x32_bf16 v[64:67], a[12:15], a[104:107], v[64:67]
  ds_read_b128 a[68:71], v208 offset:35840
  v_mfma_f32_16x16x32_bf16 v[120:123], a[16:19], a[104:107], 0
  buffer_load_dword v206, s[36:39], s62 offen sc1 lds
  s_mov_b32 s61, 985088
  v_mfma_f32_16x16x32_bf16 v[120:123], a[36:39], a[108:111], v[120:123]
  s_add_u32 m0, s63, 21504
  ds_read_b64_tr_b16 a[96:97], v198 offset:22528
  v_mfma_f32_16x16x32_bf16 v[120:123], a[56:59], a[112:115], v[120:123]
  s_waitcnt lgkmcnt(6)
  ds_read_b128 a[72:75], v208 offset:36864
  v_mfma_f32_16x16x32_bf16 v[80:83], a[12:15], a[80:83], 0
  ds_read_b64_tr_b16 a[98:99], v198 offset:28672
  v_mfma_f32_16x16x32_bf16 v[80:83], a[32:35], a[84:87], v[80:83]
  buffer_load_dwordx4 v202, s[8:11], s61 offen offset:0 lds
  v_mfma_f32_16x16x32_bf16 v[80:83], a[52:55], a[88:91], v[80:83]
  ds_read_b128 a[76:79], v211 offset:41984
  v_mfma_f32_16x16x32_bf16 v[76:79], a[48:51], a[88:91], 0
  ds_read_b64_tr_b16 a[100:101], v198 offset:23552
  v_mfma_f32_16x16x32_bf16 v[76:79], a[28:31], a[84:87], v[76:79]
  ds_read_b64_tr_b16 a[102:103], v198 offset:29696
  v_mfma_f32_16x16x32_bf16 v[76:79], a[8:11], a[80:83], v[76:79]
  buffer_load_dwordx4 v203, s[8:11], s61 offen offset:1024 lds
  v_mfma_f32_16x16x32_bf16 v[72:75], a[4:7], a[80:83], 0
  ds_read_b64_tr_b16 a[104:105], v199 offset:21504
  v_mfma_f32_16x16x32_bf16 v[72:75], a[24:27], a[84:87], v[72:75]
  ds_read_b64_tr_b16 a[106:107], v199 offset:27648
  v_mfma_f32_16x16x32_bf16 v[72:75], a[44:47], a[88:91], v[72:75]
  ds_read_b64_tr_b16 a[108:109], v199 offset:22528
  v_mfma_f32_16x16x32_bf16 v[68:71], a[40:43], a[88:91], 0
  buffer_load_dwordx4 v204, s[8:11], s61 offen offset:2048 lds
  s_mov_b32 s62, 14336
  v_mfma_f32_16x16x32_bf16 v[68:71], a[20:23], a[84:87], v[68:71]
  s_add_u32 m0, s64, 33792
  ds_read_b64_tr_b16 a[110:111], v199 offset:28672
  v_mfma_f32_16x16x32_bf16 v[68:71], a[0:3], a[80:83], v[68:71]
  s_waitcnt vmcnt(9) lgkmcnt(4)
  s_barrier
  v_mfma_f32_16x16x32_bf16 v[84:87], a[92:95], a[20:23], v[84:87]
  ds_read_b64_tr_b16 a[112:113], v199 offset:23552
  v_mfma_f32_16x16x32_bf16 v[84:87], a[96:99], a[40:43], v[84:87]
  buffer_load_dwordx4 v205, s[36:39], s62 offen offset:0 sc1 lds
  v_mfma_f32_16x16x32_bf16 v[84:87], a[100:103], a[60:63], v[84:87]
  ds_read_b64_tr_b16 a[114:115], v199 offset:29696
  v_mfma_f32_16x16x32_bf16 v[88:91], a[100:103], a[64:67], v[88:91]
  ds_read_b128 a[0:3], v208 offset:55296
  v_mfma_f32_16x16x32_bf16 v[88:91], a[96:99], a[44:47], v[88:91]
  ds_read_b64_tr_b16 a[80:81], v198 offset:43008
  v_mfma_f32_16x16x32_bf16 v[88:91], a[92:95], a[24:27], v[88:91]
  buffer_load_dwordx4 v205, s[36:39], s62 offen offset:1024 sc1 lds
  s_add_u32 m0, s65, 41984
  v_mfma_f32_16x16x32_bf16 v[92:95], a[92:95], a[28:31], v[92:95]
  ds_read_b128 a[4:7], v208 offset:56320
  v_mfma_f32_16x16x32_bf16 v[92:95], a[96:99], a[48:51], v[92:95]
  ds_read_b64_tr_b16 a[82:83], v198 offset:49152
  v_mfma_f32_16x16x32_bf16 v[92:95], a[100:103], a[68:71], v[92:95]
  ds_read_b128 a[8:11], v208 offset:57344
  v_mfma_f32_16x16x32_bf16 v[96:99], a[100:103], a[72:75], v[96:99]
  buffer_load_dword v206, s[36:39], s62 offen sc1 lds
  s_mov_b32 s61, 1183744
  v_mfma_f32_16x16x32_bf16 v[96:99], a[96:99], a[52:55], v[96:99]
  s_add_u32 m0, s63, 43008
  ds_read_b64_tr_b16 a[84:85], v198 offset:44032
  v_mfma_f32_16x16x32_bf16 v[96:99], a[92:95], a[32:35], v[96:99]
  s_waitcnt lgkmcnt(6)
  ds_read_b128 a[12:15], v208 offset:58368
  v_mfma_f32_16x16x32_bf16 v[112:115], a[104:107], a[32:35], v[112:115]
  ds_read_b128 a[16:19], v211 offset:63488
  v_mfma_f32_16x16x32_bf16 v[112:115], a[108:111], a[52:55], v[112:115]
  buffer_load_dwordx4 v202, s[8:11], s61 offen offset:0 lds
  v_mfma_f32_16x16x32_bf16 v[112:115], a[112:115], a[72:75], v[112:115]
  ds_read_b64_tr_b16 a[86:87], v198 offset:50176
  v_mfma_f32_16x16x32_bf16 v[108:111], a[112:115], a[68:71], v[108:111]
  ds_read_b64_tr_b16 a[88:89], v198 offset:45056
  v_mfma_f32_16x16x32_bf16 v[108:111], a[108:111], a[48:51], v[108:111]
  ds_read_b64_tr_b16 a[90:91], v198 offset:51200
  v_mfma_f32_16x16x32_bf16 v[108:111], a[104:107], a[28:31], v[108:111]
  buffer_load_dwordx4 v203, s[8:11], s61 offen offset:1024 lds
  v_mfma_f32_16x16x32_bf16 v[104:107], a[104:107], a[24:27], v[104:107]
  v_mfma_f32_16x16x32_bf16 v[104:107], a[108:111], a[44:47], v[104:107]
  ds_read_b64_tr_b16 a[92:93], v199 offset:43008
  v_mfma_f32_16x16x32_bf16 v[104:107], a[112:115], a[64:67], v[104:107]
  v_mfma_f32_16x16x32_bf16 v[100:103], a[112:115], a[60:63], v[100:103]
  buffer_load_dwordx4 v204, s[8:11], s61 offen offset:2048 lds
  s_mov_b32 s62, 16384
  v_mfma_f32_16x16x32_bf16 v[100:103], a[108:111], a[40:43], v[100:103]
  s_add_u32 m0, s64, 55296
  ds_read_b64_tr_b16 a[94:95], v199 offset:49152
  v_mfma_f32_16x16x32_bf16 v[100:103], a[104:107], a[20:23], v[100:103]
  s_waitcnt lgkmcnt(2)
  ds_read_b64_tr_b16 a[96:97], v199 offset:44032
  v_mfma_f32_16x16x32_bf16 v[20:23], a[80:83], a[40:43], v[20:23]
  v_mfma_f32_16x16x32_bf16 v[20:23], a[84:87], a[60:63], v[20:23]
  buffer_load_dwordx4 v205, s[36:39], s62 offen offset:0 sc1 lds
  v_mfma_f32_16x16x32_bf16 v[20:23], a[88:91], a[0:3], v[20:23]
  s_waitcnt vmcnt(13)
  s_barrier
  ds_read_b64_tr_b16 a[98:99], v199 offset:50176
  v_mfma_f32_16x16x32_bf16 v[24:27], a[88:91], a[4:7], v[24:27]
  ds_read_b64_tr_b16 a[100:101], v199 offset:45056
  v_mfma_f32_16x16x32_bf16 v[24:27], a[84:87], a[64:67], v[24:27]
  v_mfma_f32_16x16x32_bf16 v[24:27], a[80:83], a[44:47], v[24:27]
  buffer_load_dwordx4 v205, s[36:39], s62 offen offset:1024 sc1 lds
  s_add_u32 m0, s65, 63488
  v_mfma_f32_16x16x32_bf16 v[28:31], a[80:83], a[48:51], v[28:31]
  ds_read_b64_tr_b16 a[102:103], v199 offset:51200
  v_mfma_f32_16x16x32_bf16 v[28:31], a[84:87], a[68:71], v[28:31]
  ds_read_b128 a[20:23], v209 offset:12288
  v_mfma_f32_16x16x32_bf16 v[28:31], a[88:91], a[8:11], v[28:31]
  ds_read_b64_tr_b16 a[104:105], v200 offset:0
  v_mfma_f32_16x16x32_bf16 v[32:35], a[88:91], a[12:15], v[32:35]
  buffer_load_dword v206, s[36:39], s62 offen sc1 lds
  s_mov_b32 s61, 1376256
  v_mfma_f32_16x16x32_bf16 v[32:35], a[84:87], a[72:75], v[32:35]
  s_add_u32 m0, s63, 64512
  ds_read_b128 a[24:27], v209 offset:13312
  v_mfma_f32_16x16x32_bf16 v[32:35], a[80:83], a[52:55], v[32:35]
  ds_read_b64_tr_b16 a[106:107], v200 offset:6144
  v_mfma_f32_16x16x32_bf16 v[116:119], a[80:83], a[56:59], v[116:119]
  ds_read_b128 a[28:31], v209 offset:14336
  v_mfma_f32_16x16x32_bf16 v[116:119], a[84:87], a[76:79], v[116:119]
  buffer_load_dwordx4 v202, s[8:11], s61 offen offset:0 lds
  v_mfma_f32_16x16x32_bf16 v[116:119], a[88:91], a[16:19], v[116:119]
  s_waitcnt lgkmcnt(5)
  ds_read_b64_tr_b16 a[108:109], v200 offset:1024
  v_mfma_f32_16x16x32_bf16 v[48:51], a[92:95], a[52:55], v[48:51]
  ds_read_b128 a[32:35], v209 offset:15360
  v_mfma_f32_16x16x32_bf16 v[48:51], a[96:99], a[72:75], v[48:51]
  ds_read_b128 a[36:39], v212 offset:20480
  v_mfma_f32_16x16x32_bf16 v[48:51], a[100:103], a[12:15], v[48:51]
  buffer_load_dwordx4 v203, s[8:11], s61 offen offset:1024 lds
  v_mfma_f32_16x16x32_bf16 v[44:47], a[100:103], a[8:11], v[44:47]
  ds_read_b64_tr_b16 a[110:111], v200 offset:7168
  v_mfma_f32_16x16x32_bf16 v[44:47], a[96:99], a[68:71], v[44:47]
  ds_read_b64_tr_b16 a[112:113], v200 offset:2048
  v_mfma_f32_16x16x32_bf16 v[44:47], a[92:95], a[48:51], v[44:47]
  ds_read_b64_tr_b16 a[114:115], v200 offset:8192
  v_mfma_f32_16x16x32_bf16 v[40:43], a[92:95], a[44:47], v[40:43]
  buffer_load_dwordx4 v204, s[8:11], s61 offen offset:2048 lds
  s_mov_b32 s62, 18432
  v_mfma_f32_16x16x32_bf16 v[40:43], a[96:99], a[64:67], v[40:43]
  s_add_u32 m0, s64, 76800
  ds_read_b64_tr_b16 a[80:81], v201 offset:0
  v_mfma_f32_16x16x32_bf16 v[40:43], a[100:103], a[4:7], v[40:43]
  s_bfe_u32 s54, s2, 0x30003
  s_xor_b32 s54, s54, 1
  s_and_b32 s48, s2, 1
  v_mfma_f32_16x16x32_bf16 v[36:39], a[100:103], a[0:3], v[36:39]
  s_lshl1_add_u32 s53, s54, s48
  ds_read_b64_tr_b16 a[82:83], v201 offset:6144
  v_mfma_f32_16x16x32_bf16 v[36:39], a[96:99], a[60:63], v[36:39]
  buffer_load_dwordx4 v205, s[36:39], s62 offen offset:0 sc1 lds
  v_mfma_f32_16x16x32_bf16 v[36:39], a[92:95], a[40:43], v[36:39]
  s_waitcnt lgkmcnt(2)
  ds_read_b64_tr_b16 a[84:85], v201 offset:1024
  v_mfma_f32_16x16x32_bf16 v[52:55], a[60:63], a[104:107], v[52:55]
  v_mfma_f32_16x16x32_bf16 v[52:55], a[0:3], a[108:111], v[52:55]
  ds_read_b64_tr_b16 a[86:87], v201 offset:7168
  v_mfma_f32_16x16x32_bf16 v[52:55], a[20:23], a[112:115], v[52:55]
  s_waitcnt vmcnt(16)
  s_barrier
  buffer_load_dwordx4 v205, s[36:39], s62 offen offset:1024 sc1 lds
  v_mfma_f32_16x16x32_bf16 v[56:59], a[24:27], a[112:115], v[56:59]
  s_add_u32 m0, s65, 84992
  ds_read_b64_tr_b16 a[88:89], v201 offset:2048
  s_and_b32 s76, s54, 0
  v_mfma_f32_16x16x32_bf16 v[56:59], a[4:7], a[108:111], v[56:59]
  s_lshl_b32 s76, s76, 21
  v_mfma_f32_16x16x32_bf16 v[56:59], a[64:67], a[104:107], v[56:59]
  s_bfe_u32 s52, s2, 0x20001
  ds_read_b64_tr_b16 a[90:91], v201 offset:8192
  s_lshr_b32 s49, s2, 6
  v_mfma_f32_16x16x32_bf16 v[60:63], a[68:71], a[104:107], v[60:63]
  s_lshl2_add_u32 s52, s52, s49
  buffer_load_dword v206, s[36:39], s62 offen sc1 lds
  s_mov_b32 s61, 1574912
  v_mfma_f32_16x16x32_bf16 v[60:63], a[8:11], a[108:111], v[60:63]
  s_add_u32 m0, s63, 86016
  ds_read_b128 a[40:43], v207 offset:12288
  s_lshl_b32 s70, s44, 12
  v_mfma_f32_16x16x32_bf16 v[60:63], a[28:31], a[112:115], v[60:63]
  ds_read_b64_tr_b16 a[92:93], v196 offset:0
  v_mfma_f32_16x16x32_bf16 v[64:67], a[32:35], a[112:115], v[64:67]
  ds_read_b128 a[44:47], v207 offset:13312
  v_mfma_f32_16x16x32_bf16 v[64:67], a[12:15], a[108:111], v[64:67]
  buffer_load_dwordx4 v202, s[8:11], s61 offen offset:0 lds
  v_mfma_f32_16x16x32_bf16 v[64:67], a[72:75], a[104:107], v[64:67]
  ds_read_b64_tr_b16 a[94:95], v196 offset:6144
  v_mfma_f32_16x16x32_bf16 v[120:123], a[76:79], a[104:107], v[120:123]
  s_lshl_b32 s48, s53, 7
  ds_read_b128 a[48:51], v207 offset:14336
  s_lshl_b32 s49, s44, 16
  v_mfma_f32_16x16x32_bf16 v[120:123], a[16:19], a[108:111], v[120:123]
  s_add_u32 s48, s48, s49
  ds_read_b64_tr_b16 a[96:97], v196 offset:1024
  v_lshrrev_b32 v12, 3, v10
  v_mfma_f32_16x16x32_bf16 v[120:123], a[36:39], a[112:115], v[120:123]
  s_waitcnt lgkmcnt(6)
  buffer_load_dwordx4 v203, s[8:11], s61 offen offset:1024 lds
  v_lshlrev_b32 v12, 11, v12
  v_mfma_f32_16x16x32_bf16 v[80:83], a[72:75], a[80:83], v[80:83]
  ds_read_b128 a[52:55], v207 offset:15360
  v_add3_u32 v216, v12, v213, s48
  v_mfma_f32_16x16x32_bf16 v[80:83], a[12:15], a[84:87], v[80:83]
  ds_read_b64_tr_b16 a[98:99], v196 offset:7168
  v_mfma_f32_16x16x32_bf16 v[80:83], a[32:35], a[88:91], v[80:83]
  ds_read_b128 a[56:59], v210 offset:20480
  v_mfma_f32_16x16x32_bf16 v[76:79], a[28:31], a[88:91], v[76:79]
  buffer_load_dwordx4 v204, s[8:11], s61 offen offset:2048 lds
  s_mov_b32 s62, 20480
  v_mfma_f32_16x16x32_bf16 v[76:79], a[8:11], a[84:87], v[76:79]
  s_add_u32 m0, s64, 98304
  ds_read_b64_tr_b16 a[100:101], v196 offset:2048
  v_mfma_f32_16x16x32_bf16 v[76:79], a[68:71], a[80:83], v[76:79]
  ds_read_b64_tr_b16 a[102:103], v196 offset:8192
  v_mfma_f32_16x16x32_bf16 v[72:75], a[64:67], a[80:83], v[72:75]
  ds_read_b64_tr_b16 a[104:105], v197 offset:0
  v_add_u32 v217, 15360, v216
  v_mfma_f32_16x16x32_bf16 v[72:75], a[4:7], a[84:87], v[72:75]
  buffer_load_dwordx4 v205, s[36:39], s62 offen offset:0 sc1 lds
  v_mfma_f32_16x16x32_bf16 v[72:75], a[24:27], a[88:91], v[72:75]
  ds_read_b64_tr_b16 a[106:107], v197 offset:6144
  v_add_u32 v218, 30720, v216
  v_mfma_f32_16x16x32_bf16 v[68:71], a[20:23], a[88:91], v[68:71]
  ds_read_b64_tr_b16 a[108:109], v197 offset:1024
  v_add_u32 v219, 46080, v216
  v_mfma_f32_16x16x32_bf16 v[68:71], a[0:3], a[84:87], v[68:71]
  ds_read_b64_tr_b16 a[110:111], v197 offset:7168
  v_mfma_f32_16x16x32_bf16 v[68:71], a[60:63], a[80:83], v[68:71]
  s_waitcnt vmcnt(16) lgkmcnt(4)
  s_barrier
  buffer_load_dwordx4 v205, s[36:39], s62 offen offset:1024 sc1 lds
  v_mfma_f32_16x16x32_bf16 v[84:87], a[92:95], a[0:3], v[84:87]
  s_add_u32 m0, s65, 106496
  ds_read_b64_tr_b16 a[112:113], v197 offset:2048
  s_lshl_b32 s55, s52, 18
  v_mfma_f32_16x16x32_bf16 v[84:87], a[96:99], a[20:23], v[84:87]
  s_add_u32 s55, s55, s48
  v_mfma_f32_16x16x32_bf16 v[84:87], a[100:103], a[40:43], v[84:87]
  ds_read_b64_tr_b16 a[114:115], v197 offset:8192
  v_and_b32 v13, 7, v10
  v_mfma_f32_16x16x32_bf16 v[88:91], a[100:103], a[44:47], v[88:91]
  buffer_load_dword v206, s[36:39], s62 offen sc1 lds
  s_mov_b32 s61, 1773568
  v_mfma_f32_16x16x32_bf16 v[88:91], a[96:99], a[24:27], v[88:91]
  s_add_u32 m0, s63, 107520
  ds_read_b128 a[60:63], v207 offset:33792
  v_lshrrev_b32 v14, 4, v10
  v_mfma_f32_16x16x32_bf16 v[88:91], a[92:95], a[4:7], v[88:91]
  ds_read_b64_tr_b16 a[80:81], v196 offset:21504
  v_xor_b32 v13, v13, v14
  v_mfma_f32_16x16x32_bf16 v[92:95], a[92:95], a[8:11], v[92:95]
  ds_read_b128 a[64:67], v207 offset:34816
  v_lshl_add_u32 v220, v13, 4, v12
  v_mfma_f32_16x16x32_bf16 v[92:95], a[96:99], a[28:31], v[92:95]
  buffer_load_dwordx4 v202, s[8:11], s61 offen offset:0 lds
  v_xor_b32 v221, 64, v220
  v_mfma_f32_16x16x32_bf16 v[92:95], a[100:103], a[48:51], v[92:95]
  ds_read_b64_tr_b16 a[82:83], v196 offset:27648
  v_add_u32 v221, 15360, v221
  v_mfma_f32_16x16x32_bf16 v[96:99], a[100:103], a[52:55], v[96:99]
  ds_read_b128 a[68:71], v207 offset:35840
  v_mfma_f32_16x16x32_bf16 v[96:99], a[96:99], a[32:35], v[96:99]
  ds_read_b64_tr_b16 a[84:85], v196 offset:22528
  v_mfma_f32_16x16x32_bf16 v[96:99], a[92:95], a[12:15], v[96:99]
  s_waitcnt lgkmcnt(6)
  buffer_load_dwordx4 v203, s[8:11], s61 offen offset:1024 lds
  v_mfma_f32_16x16x32_bf16 v[112:115], a[104:107], a[12:15], v[112:115]
  s_lshl_b32 s48, s44, 10
  ds_read_b128 a[72:75], v207 offset:36864
  s_add_u32 s48, s48, 147456
  v_mfma_f32_16x16x32_bf16 v[112:115], a[108:111], a[32:35], v[112:115]
  ds_read_b128 a[76:79], v210 offset:41984
  v_add_u32 v247, s48, v0
  v_mfma_f32_16x16x32_bf16 v[112:115], a[112:115], a[52:55], v[112:115]
  ds_read_b64_tr_b16 a[86:87], v196 offset:28672
  v_lshl_add_u32 v245, v14, 4, s48
  v_mfma_f32_16x16x32_bf16 v[108:111], a[112:115], a[48:51], v[108:111]
  buffer_load_dwordx4 v204, s[8:11], s61 offen offset:2048 lds
  s_mov_b32 s62, 22528
  v_mfma_f32_16x16x32_bf16 v[108:111], a[108:111], a[28:31], v[108:111]
  s_add_u32 m0, s64, 119808
  ds_read_b64_tr_b16 a[88:89], v196 offset:23552
  v_and_b32 v12, 1, v10
  v_mfma_f32_16x16x32_bf16 v[108:111], a[104:107], a[8:11], v[108:111]
  ds_read_b64_tr_b16 a[90:91], v196 offset:29696
  v_lshlrev_b32 v12, 8, v12
  v_mfma_f32_16x16x32_bf16 v[104:107], a[104:107], a[4:7], v[104:107]
  v_sub_u32 v246, v245, v12
  v_mfma_f32_16x16x32_bf16 v[104:107], a[108:111], a[24:27], v[104:107]
  buffer_load_dwordx4 v205, s[36:39], s62 offen offset:0 sc1 lds
  v_mfma_f32_16x16x32_bf16 v[104:107], a[112:115], a[44:47], v[104:107]
  ds_read_b64_tr_b16 a[92:93], v197 offset:21504
  v_mfma_f32_16x16x32_bf16 v[100:103], a[112:115], a[40:43], v[100:103]
  ds_read_b64_tr_b16 a[94:95], v197 offset:27648
  v_mfma_f32_16x16x32_bf16 v[100:103], a[108:111], a[20:23], v[100:103]
  v_mfma_f32_16x16x32_bf16 v[100:103], a[104:107], a[0:3], v[100:103]
  s_waitcnt lgkmcnt(2)
  buffer_load_dwordx4 v205, s[36:39], s62 offen offset:1024 sc1 lds
  s_add_u32 m0, s65, 128000
  v_mfma_f32_16x16x32_bf16 v[20:23], a[80:83], a[20:23], v[20:23]
  s_lshl_b32 s48, s53, 7
  ds_read_b64_tr_b16 a[96:97], v197 offset:22528
  v_and_b32 v13, 0xf0, v0
  v_mfma_f32_16x16x32_bf16 v[20:23], a[84:87], a[40:43], v[20:23]
  ds_read_b64_tr_b16 a[98:99], v197 offset:28672
  v_lshl_add_u32 v13, v14, 12, v13
  v_mfma_f32_16x16x32_bf16 v[20:23], a[88:91], a[60:63], v[20:23]
  s_waitcnt vmcnt(17)
  s_barrier
  s_lshl1_add_u32 s48, s48, 8192
  v_mfma_f32_16x16x32_bf16 v[24:27], a[88:91], a[64:67], v[24:27]
  buffer_load_dword v206, s[36:39], s62 offen sc1 lds
  s_mov_b32 s61, 1966080
  v_mfma_f32_16x16x32_bf16 v[24:27], a[84:87], a[44:47], v[24:27]
  s_add_u32 m0, s63, 129024
  ds_read_b64_tr_b16 a[100:101], v197 offset:23552
  v_add_u32 v249, s48, v13
  v_mfma_f32_16x16x32_bf16 v[24:27], a[80:83], a[24:27], v[24:27]
  ds_read_b64_tr_b16 a[102:103], v197 offset:29696
  v_mfma_f32_16x16x32_bf16 v[28:31], a[80:83], a[28:31], v[28:31]
  ds_read_b128 a[0:3], v207 offset:55296
  v_mfma_f32_16x16x32_bf16 v[28:31], a[84:87], a[48:51], v[28:31]
  buffer_load_dwordx4 v202, s[8:11], s61 offen offset:0 lds
  v_lshrrev_b32 v12, 2, v10
  v_mfma_f32_16x16x32_bf16 v[28:31], a[88:91], a[68:71], v[28:31]
  ds_read_b64_tr_b16 a[104:105], v196 offset:43008
  v_lshl_add_u32 v232, v12, 7, v214
  v_mfma_f32_16x16x32_bf16 v[32:35], a[88:91], a[72:75], v[32:35]
  ds_read_b128 a[4:7], v207 offset:56320
  v_mfma_f32_16x16x32_bf16 v[32:35], a[84:87], a[52:55], v[32:35]
  ds_read_b64_tr_b16 a[106:107], v196 offset:49152
  v_xor_b32 v233, 32, v232
  v_mfma_f32_16x16x32_bf16 v[32:35], a[80:83], a[32:35], v[32:35]
  buffer_load_dwordx4 v203, s[8:11], s61 offen offset:1024 lds
  v_mfma_f32_16x16x32_bf16 v[116:119], a[80:83], a[36:39], v[116:119]
  ds_read_b128 a[8:11], v207 offset:57344
  v_xor_b32 v234, 64, v232
  v_mfma_f32_16x16x32_bf16 v[116:119], a[84:87], a[56:59], v[116:119]
  ds_read_b64_tr_b16 a[108:109], v196 offset:44032
  v_xor_b32 v235, 96, v232
  v_mfma_f32_16x16x32_bf16 v[116:119], a[88:91], a[76:79], v[116:119]
  s_waitcnt lgkmcnt(6)
  ds_read_b128 a[12:15], v207 offset:58368
  v_mfma_f32_16x16x32_bf16 v[48:51], a[92:95], a[32:35], v[48:51]
  buffer_load_dwordx4 v204, s[8:11], s61 offen offset:2048 lds
  s_mov_b32 s62, 24576
  v_mfma_f32_16x16x32_bf16 v[48:51], a[96:99], a[52:55], v[48:51]
  s_add_u32 m0, s64, 141312
  ds_read_b128 a[16:19], v210 offset:63488
  v_xor_b32 v236, 65536, v232
  v_mfma_f32_16x16x32_bf16 v[48:51], a[100:103], a[72:75], v[48:51]
  ds_read_b64_tr_b16 a[110:111], v196 offset:50176
  v_xor_b32 v237, 65568, v232
  v_mfma_f32_16x16x32_bf16 v[44:47], a[100:103], a[68:71], v[44:47]
  ds_read_b64_tr_b16 a[112:113], v196 offset:45056
  v_xor_b32 v238, 65600, v232
  v_mfma_f32_16x16x32_bf16 v[44:47], a[96:99], a[48:51], v[44:47]
  buffer_load_dwordx4 v205, s[36:39], s62 offen offset:0 sc1 lds
  v_mfma_f32_16x16x32_bf16 v[44:47], a[92:95], a[28:31], v[44:47]
  ds_read_b64_tr_b16 a[114:115], v196 offset:51200
  v_xor_b32 v239, 65632, v232
  v_mfma_f32_16x16x32_bf16 v[40:43], a[92:95], a[24:27], v[40:43]
  s_add_u32 s48, s70, 131072
  v_and_b32 v12, 15, v10
  v_lshrrev_b32 v14, 1, v12
  v_mfma_f32_16x16x32_bf16 v[40:43], a[96:99], a[44:47], v[40:43]
  ds_read_b64_tr_b16 a[80:81], v197 offset:43008
  v_lshrrev_b32 v13, 5, v10
  v_mfma_f32_16x16x32_bf16 v[40:43], a[100:103], a[64:67], v[40:43]
  buffer_load_dwordx4 v205, s[36:39], s62 offen offset:1024 sc1 lds
  s_add_u32 m0, s65, 149504
  v_mfma_f32_16x16x32_bf16 v[36:39], a[100:103], a[60:63], v[36:39]
  ds_read_b64_tr_b16 a[82:83], v197 offset:49152
  v_xor_b32 v14, v14, v13
  v_mfma_f32_16x16x32_bf16 v[36:39], a[96:99], a[40:43], v[36:39]
  buffer_load_dword v19, v215, s[36:39], s66 offen sc1
  v_lshlrev_b32 v14, 4, v14
  v_mfma_f32_16x16x32_bf16 v[36:39], a[92:95], a[20:23], v[36:39]
  s_waitcnt lgkmcnt(2)
  ds_read_b64_tr_b16 a[84:85], v197 offset:44032
  v_lshl_add_u32 v14, v12, 7, v14
  v_mfma_f32_16x16x32_bf16 v[52:55], a[40:43], a[104:107], v[52:55]
  v_bfe_u32 v13, v10, 4, 1
  v_lshl_add_u32 v14, v13, 3, v14
  v_mfma_f32_16x16x32_bf16 v[52:55], a[60:63], a[108:111], v[52:55]
  buffer_load_dword v206, s[36:39], s62 offen sc1 lds
  s_mov_b32 s61, 2164736
  v_mfma_f32_16x16x32_bf16 v[52:55], a[0:3], a[112:115], v[52:55]
  s_waitcnt vmcnt(19)
  s_barrier
  s_add_u32 m0, s63, 0
  v_mfma_f32_16x16x32_bf16 v[56:59], a[4:7], a[112:115], v[56:59]
  ds_read_b64_tr_b16 a[86:87], v197 offset:50176
  v_add_u32 v240, s48, v14
  v_mfma_f32_16x16x32_bf16 v[56:59], a[64:67], a[108:111], v[56:59]
  buffer_load_dwordx4 v[136:139], v176, s[28:31], s51 offen nt
  s_add_u32 s51, s51, 12288
  v_mfma_f32_16x16x32_bf16 v[56:59], a[44:47], a[104:107], v[56:59]
  ds_read_b64_tr_b16 a[88:89], v197 offset:45056
  v_xor_b32 v241, 32, v240
  v_mfma_f32_16x16x32_bf16 v[60:63], a[48:51], a[104:107], v[60:63]
  ds_read_b64_tr_b16 a[90:91], v197 offset:51200
  v_xor_b32 v242, 64, v240
  v_mfma_f32_16x16x32_bf16 v[60:63], a[68:71], a[108:111], v[60:63]
  buffer_load_dwordx4 v[140:143], v176, s[28:31], s51 offen nt
  s_add_u32 s51, s51, 12288
  v_mfma_f32_16x16x32_bf16 v[60:63], a[8:11], a[112:115], v[60:63]
  ds_read_b128 a[20:23], v208 offset:12288
  v_xor_b32 v243, 96, v240
  v_mfma_f32_16x16x32_bf16 v[64:67], a[12:15], a[112:115], v[64:67]
  ds_read_b64_tr_b16 a[92:93], v198 offset:0
  v_mfma_f32_16x16x32_bf16 v[64:67], a[72:75], a[108:111], v[64:67]
  buffer_load_dwordx4 v[144:147], v176, s[28:31], s51 offen nt
  s_add_u32 s51, s51, 12288
  v_mfma_f32_16x16x32_bf16 v[64:67], a[52:55], a[104:107], v[64:67]
  ds_read_b128 a[24:27], v208 offset:13312
  v_mfma_f32_16x16x32_bf16 v[120:123], a[56:59], a[104:107], v[120:123]
  ds_read_b64_tr_b16 a[94:95], v198 offset:6144
  v_mfma_f32_16x16x32_bf16 v[120:123], a[76:79], a[108:111], v[120:123]
  buffer_load_dwordx4 v[148:151], v176, s[28:31], s51 offen nt
  s_add_u32 s51, s51, 12288
  v_mfma_f32_16x16x32_bf16 v[120:123], a[16:19], a[112:115], v[120:123]
  s_waitcnt lgkmcnt(4)
  ds_read_b128 a[28:31], v208 offset:14336
  v_mfma_f32_16x16x32_bf16 v[80:83], a[52:55], a[80:83], v[80:83]
  s_lshl2_add_u32 s48, s52, s44
  ds_read_b64_tr_b16 a[96:97], v198 offset:1024
  s_lshl_b32 s49, s48, 16
Ha1:
  s_cbranch_execz Ha1_1
  v_mfma_f32_16x16x32_bf16 v[80:83], a[72:75], a[84:87], v[80:83]
  s_add_u32 s49, s49, 7340032
  buffer_load_dwordx4 v202, s[8:11], s61 offen offset:0 lds
  v_add_u32 v244, s49, v0
  v_mfma_f32_16x16x32_bf16 v[80:83], a[12:15], a[88:91], v[80:83]
  ds_read_b128 a[32:35], v208 offset:15360
  v_mfma_f32_16x16x32_bf16 v[76:79], a[8:11], a[88:91], v[76:79]
  ds_read_b64_tr_b16 a[98:99], v198 offset:7168
  v_mfma_f32_16x16x32_bf16 v[76:79], a[68:71], a[84:87], v[76:79]
  ds_read_b128 a[36:39], v211 offset:20480
  v_mfma_f32_16x16x32_bf16 v[76:79], a[48:51], a[80:83], v[76:79]
  ds_read_b64_tr_b16 a[100:101], v198 offset:2048
  v_mfma_f32_16x16x32_bf16 v[72:75], a[44:47], a[80:83], v[72:75]
  s_lshl4_add_u32 s74, s48, s53
  ds_read_b64_tr_b16 a[102:103], v198 offset:8192
  s_lshl_b32 s74, s74, 8
  v_mfma_f32_16x16x32_bf16 v[72:75], a[64:67], a[84:87], v[72:75]
  s_add_u32 s74, s74, 262144
  ds_read_b64_tr_b16 a[104:105], v199 offset:0
  v_mfma_f32_16x16x32_bf16 v[72:75], a[4:7], a[88:91], v[72:75]
  ds_read_b64_tr_b16 a[106:107], v199 offset:6144
  v_mfma_f32_16x16x32_bf16 v[68:71], a[0:3], a[88:91], v[68:71]
  ds_read_b64_tr_b16 a[108:109], v199 offset:1024
  v_mfma_f32_16x16x32_bf16 v[68:71], a[60:63], a[84:87], v[68:71]
  ds_read_b64_tr_b16 a[110:111], v199 offset:7168
  v_mfma_f32_16x16x32_bf16 v[68:71], a[40:43], a[80:83], v[68:71]
  s_waitcnt vmcnt(18) lgkmcnt(4)
  s_barrier
  s_lshr_b32 s73, s48, 1
  v_mfma_f32_16x16x32_bf16 v[84:87], a[92:95], a[60:63], v[84:87]
  s_lshl_b32 s73, s73, 5
  ds_read_b64_tr_b16 a[112:113], v199 offset:2048
  s_add_u32 s73, s73, s53
  v_mfma_f32_16x16x32_bf16 v[84:87], a[96:99], a[0:3], v[84:87]
  s_and_b32 s49, s48, 1
  s_lshl1_add_u32 s73, s73, s49
  s_lshl_b32 s73, s73, 11
  v_mfma_f32_16x16x32_bf16 v[84:87], a[100:103], a[20:23], v[84:87]
  s_add_u32 s73, s73, 36700160
  ds_read_b64_tr_b16 a[114:115], v199 offset:8192
  v_mfma_f32_16x16x32_bf16 v[88:91], a[100:103], a[24:27], v[88:91]
  ds_read_b128 a[40:43], v208 offset:33792
  v_mfma_f32_16x16x32_bf16 v[88:91], a[96:99], a[4:7], v[88:91]
  ds_read_b64_tr_b16 a[80:81], v198 offset:21504
  v_mfma_f32_16x16x32_bf16 v[88:91], a[92:95], a[64:67], v[88:91]
  ds_read_b128 a[44:47], v208 offset:34816
  v_mfma_f32_16x16x32_bf16 v[92:95], a[92:95], a[68:71], v[92:95]
  ds_read_b64_tr_b16 a[82:83], v198 offset:27648
  v_mfma_f32_16x16x32_bf16 v[92:95], a[96:99], a[8:11], v[92:95]
  ds_read_b128 a[48:51], v208 offset:35840
  v_mfma_f32_16x16x32_bf16 v[92:95], a[100:103], a[28:31], v[92:95]
  ds_read_b64_tr_b16 a[84:85], v198 offset:22528
  v_mfma_f32_16x16x32_bf16 v[96:99], a[100:103], a[32:35], v[96:99]
  ds_read_b128 a[52:55], v208 offset:36864
  v_mfma_f32_16x16x32_bf16 v[96:99], a[96:99], a[12:15], v[96:99]
  s_lshl2_add_u32 s75, s48, s53
  ds_read_b128 a[56:59], v211 offset:41984
  s_lshl_b32 s75, s75, 10
  v_mfma_f32_16x16x32_bf16 v[96:99], a[92:95], a[72:75], v[96:99]
  s_waitcnt lgkmcnt(8)
  ds_read_b64_tr_b16 a[86:87], v198 offset:28672
  s_add_u32 s75, s75, 5767168
  v_mfma_f32_16x16x32_bf16 v[112:115], a[104:107], a[72:75], v[112:115]
  s_and_b32 s48, s48, 7
  s_cselect_b32 s75, 1073741824, s75
  v_mfma_f32_16x16x32_bf16 v[112:115], a[108:111], a[12:15], v[112:115]
  ds_read_b64_tr_b16 a[88:89], v198 offset:23552
  v_mfma_f32_16x16x32_bf16 v[112:115], a[112:115], a[32:35], v[112:115]
  v_mfma_f32_16x16x32_bf16 v[108:111], a[112:115], a[28:31], v[108:111]
  ds_read_b64_tr_b16 a[90:91], v198 offset:29696
  v_mfma_f32_16x16x32_bf16 v[108:111], a[108:111], a[8:11], v[108:111]
  v_mfma_f32_16x16x32_bf16 v[108:111], a[104:107], a[68:71], v[108:111]
  v_mfma_f32_16x16x32_bf16 v[104:107], a[104:107], a[64:67], v[104:107]
  s_and_b32 s48, s52, 7
  s_lshl_b32 s48, s48, 5
  s_lshr_b32 s49, s52, 3
  v_mfma_f32_16x16x32_bf16 v[104:107], a[108:111], a[4:7], v[104:107]
  s_lshl2_add_u32 s48, s49, s48
  ds_read_b64_tr_b16 a[92:93], v199 offset:21504
  v_mfma_f32_16x16x32_bf16 v[104:107], a[112:115], a[24:27], v[104:107]
  v_mfma_f32_16x16x32_bf16 v[100:103], a[112:115], a[20:23], v[100:103]
  ds_read_b64_tr_b16 a[94:95], v199 offset:27648
  v_mfma_f32_16x16x32_bf16 v[100:103], a[108:111], a[0:3], v[100:103]
  v_mfma_f32_16x16x32_bf16 v[100:103], a[104:107], a[60:63], v[100:103]
  s_waitcnt lgkmcnt(2)
  ds_read_b64_tr_b16 a[96:97], v199 offset:22528
  v_mfma_f32_16x16x32_bf16 v[20:23], a[80:83], a[0:3], v[20:23]
  v_mfma_f32_16x16x32_bf16 v[20:23], a[84:87], a[20:23], v[20:23]
  ds_read_b64_tr_b16 a[98:99], v199 offset:28672
  v_and_b32 v12, 3, v10
  v_mfma_f32_16x16x32_bf16 v[20:23], a[88:91], a[40:43], v[20:23]
  s_waitcnt vmcnt(12)
  s_barrier
  v_bfe_u32 v13, v10, 2, 2
  v_mfma_f32_16x16x32_bf16 v[24:27], a[88:91], a[44:47], v[24:27]
  ds_read_b64_tr_b16 a[100:101], v199 offset:23552
  v_lshl_add_u32 v12, v12, 3, v13
  v_mfma_f32_16x16x32_bf16 v[24:27], a[84:87], a[24:27], v[24:27]
  v_add_lshl_u32 v250, v12, s48, 7
  v_mfma_f32_16x16x32_bf16 v[24:27], a[80:83], a[4:7], v[24:27]
  ds_read_b64_tr_b16 a[102:103], v199 offset:29696
  v_mfma_f32_16x16x32_bf16 v[28:31], a[80:83], a[8:11], v[28:31]
  ds_read_b128 a[60:63], v208 offset:55296
  v_mfma_f32_16x16x32_bf16 v[28:31], a[84:87], a[28:31], v[28:31]
  ds_read_b64_tr_b16 a[104:105], v198 offset:43008
  v_add_u32 v250, 32768, v250
  v_mfma_f32_16x16x32_bf16 v[28:31], a[88:91], a[48:51], v[28:31]
  ds_read_b128 a[64:67], v208 offset:56320
  v_and_b32 v12, 7, v10
  v_mfma_f32_16x16x32_bf16 v[32:35], a[88:91], a[52:55], v[32:35]
  buffer_load_dwordx4 v203, s[8:11], s61 offen offset:1024 lds
  v_and_b32 v13, 8, v10
  v_mfma_f32_16x16x32_bf16 v[32:35], a[84:87], a[32:35], v[32:35]
  ds_read_b64_tr_b16 a[106:107], v198 offset:49152
  v_lshl_add_u32 v12, v13, 4, v12
  v_mfma_f32_16x16x32_bf16 v[32:35], a[80:83], a[12:15], v[32:35]
  s_lshl_b32 s48, s53, 3
  ds_read_b128 a[68:71], v208 offset:57344
  v_add_lshl_u32 v12, v12, s48, 7
  v_mfma_f32_16x16x32_bf16 v[116:119], a[80:83], a[16:19], v[116:119]
  ds_read_b64_tr_b16 a[108:109], v198 offset:44032
  v_cmp_gt_u32 vcc, 16, v10
  v_mfma_f32_16x16x32_bf16 v[116:119], a[84:87], a[36:39], v[116:119]
  s_nop 1
  ds_read_b128 a[72:75], v208 offset:58368
  v_cndmask_b32 v250, v12, v250, vcc
  v_mfma_f32_16x16x32_bf16 v[116:119], a[88:91], a[56:59], v[116:119]
  s_waitcnt lgkmcnt(7)
  buffer_load_dwordx4 v204, s[8:11], s61 offen offset:2048 lds
  s_mov_b32 s62, 26624
  v_mfma_f32_16x16x32_bf16 v[48:51], a[92:95], a[12:15], v[48:51]
  s_add_u32 m0, s64, 12288
  ds_read_b128 a[76:79], v211 offset:63488
  v_mfma_f32_16x16x32_bf16 v[48:51], a[96:99], a[32:35], v[48:51]
  ds_read_b64_tr_b16 a[110:111], v198 offset:50176
  v_mfma_f32_16x16x32_bf16 v[48:51], a[100:103], a[52:55], v[48:51]
  buffer_load_dwordx4 v205, s[36:39], s62 offen offset:0 sc1 lds
  v_mfma_f32_16x16x32_bf16 v[44:47], a[100:103], a[48:51], v[44:47]
  ds_read_b64_tr_b16 a[112:113], v198 offset:45056
  v_mfma_f32_16x16x32_bf16 v[44:47], a[96:99], a[28:31], v[44:47]
  ds_read_b64_tr_b16 a[114:115], v198 offset:51200
  v_mfma_f32_16x16x32_bf16 v[44:47], a[92:95], a[8:11], v[44:47]
  buffer_load_dwordx4 v205, s[36:39], s62 offen offset:1024 sc1 lds
  v_mfma_f32_16x16x32_bf16 v[40:43], a[92:95], a[4:7], v[40:43]
  s_add_u32 m0, s65, 20480
  v_mfma_f32_16x16x32_bf16 v[40:43], a[96:99], a[24:27], v[40:43]
  s_lshl_b32 s48, s59, 3
  ds_read_b64_tr_b16 a[80:81], v199 offset:43008
  s_add_u32 s48, s48, 150528
  v_mfma_f32_16x16x32_bf16 v[40:43], a[100:103], a[44:47], v[40:43]
  v_add_u32 v12, s48, v0
  v_add_u32 v222, s64, v12
  v_mfma_f32_16x16x32_bf16 v[36:39], a[100:103], a[40:43], v[36:39]
  buffer_load_dword v206, s[36:39], s62 offen sc1 lds
  v_xor_b32 v223, 8, v222
  v_mfma_f32_16x16x32_bf16 v[36:39], a[96:99], a[20:23], v[36:39]
  s_mov_b32 s61, 2363392
  ds_read_b64_tr_b16 a[82:83], v199 offset:49152
  s_add_u32 m0, s63, 21504
  v_mfma_f32_16x16x32_bf16 v[36:39], a[92:95], a[0:3], v[36:39]
  s_waitcnt lgkmcnt(2)
  ds_read_b64_tr_b16 a[84:85], v199 offset:44032
  v_mfma_f32_16x16x32_bf16 v[52:55], a[20:23], a[104:107], v[52:55]
  v_mfma_f32_16x16x32_bf16 v[52:55], a[40:43], a[108:111], v[52:55]
  buffer_load_dwordx4 v202, s[8:11], s61 offen offset:0 lds
  v_mfma_f32_16x16x32_bf16 v[52:55], a[60:63], a[112:115], v[52:55]
  s_waitcnt vmcnt(11)
  s_barrier
  ds_read_b64_tr_b16 a[86:87], v199 offset:50176
  v_mfma_f32_16x16x32_bf16 v[56:59], a[64:67], a[112:115], v[56:59]
  s_lshl_b32 s48, s60, 11
  ds_read_b64_tr_b16 a[88:89], v199 offset:45056
  s_add_u32 s48, s48, 8192
  v_mfma_f32_16x16x32_bf16 v[56:59], a[44:47], a[108:111], v[56:59]
  v_add_u32 v224, s48, v12
  s_lshl_b32 s48, s59, 13
  v_mfma_f32_16x16x32_bf16 v[56:59], a[24:27], a[104:107], v[56:59]
  buffer_load_dwordx4 v203, s[8:11], s61 offen offset:1024 lds
  v_subrev_u32 v225, s48, v224
  v_mfma_f32_16x16x32_bf16 v[60:63], a[28:31], a[104:107], v[60:63]
  ds_read_b64_tr_b16 a[90:91], v199 offset:51200
  v_xor_b32 v226, 8, v225
  v_mfma_f32_16x16x32_bf16 v[60:63], a[48:51], a[108:111], v[60:63]
  ds_read_b128 a[0:3], v209 offset:12288
  v_and_b32 v227, -9, v225
  v_mfma_f32_16x16x32_bf16 v[60:63], a[68:71], a[112:115], v[60:63]
  ds_read_b64_tr_b16 a[92:93], v200 offset:0
  v_mfma_f32_16x16x32_bf16 v[64:67], a[72:75], a[112:115], v[64:67]
  ds_read_b128 a[4:7], v209 offset:13312
  v_mfma_f32_16x16x32_bf16 v[64:67], a[52:55], a[108:111], v[64:67]
  buffer_load_dwordx4 v204, s[8:11], s61 offen offset:2048 lds
  s_mov_b32 s62, 28672
  v_mfma_f32_16x16x32_bf16 v[64:67], a[32:35], a[104:107], v[64:67]
  s_add_u32 m0, s64, 33792
  ds_read_b64_tr_b16 a[94:95], v200 offset:6144
  v_mfma_f32_16x16x32_bf16 v[120:123], a[36:39], a[104:107], v[120:123]
  ds_read_b128 a[8:11], v209 offset:14336
  v_mfma_f32_16x16x32_bf16 v[120:123], a[56:59], a[108:111], v[120:123]
  ds_read_b64_tr_b16 a[96:97], v200 offset:1024
  v_mfma_f32_16x16x32_bf16 v[120:123], a[76:79], a[112:115], v[120:123]
  s_waitcnt lgkmcnt(6)
  ds_read_b128 a[12:15], v209 offset:15360
  s_mov_b32 s78, 0xaaaaaaaa
  v_mfma_f32_16x16x32_bf16 v[80:83], a[32:35], a[80:83], v[80:83]
  s_mov_b32 s79, 0xaaaaaaaa
  buffer_load_dwordx4 v205, s[36:39], s62 offen offset:0 sc1 lds
  s_mov_b32 s80, 0x000f0000
  v_mfma_f32_16x16x32_bf16 v[80:83], a[52:55], a[84:87], v[80:83]
  s_mov_b32 s81, 0x0fff00ff
  ds_read_b64_tr_b16 a[98:99], v200 offset:7168
  s_mov_b32 s82, 0x003f0003
  v_mfma_f32_16x16x32_bf16 v[80:83], a[72:75], a[88:91], v[80:83]
  s_mov_b32 s83, 0x3fff03ff
  ds_read_b128 a[16:19], v212 offset:20480
  v_mfma_f32_16x16x32_bf16 v[76:79], a[68:71], a[88:91], v[76:79]
  ds_read_b64_tr_b16 a[100:101], v200 offset:2048
  v_mfma_f32_16x16x32_bf16 v[76:79], a[48:51], a[84:87], v[76:79]
  buffer_load_dwordx4 v205, s[36:39], s62 offen offset:1024 sc1 lds
  s_add_u32 m0, s65, 41984
  v_mfma_f32_16x16x32_bf16 v[76:79], a[28:31], a[80:83], v[76:79]
  ds_read_b64_tr_b16 a[102:103], v200 offset:8192
  v_mfma_f32_16x16x32_bf16 v[72:75], a[24:27], a[80:83], v[72:75]
  ds_read_b64_tr_b16 a[104:105], v201 offset:0
  v_mfma_f32_16x16x32_bf16 v[72:75], a[44:47], a[84:87], v[72:75]
  buffer_load_dword v206, s[36:39], s62 offen sc1 lds
  s_mov_b32 s61, 2555904
  v_mfma_f32_16x16x32_bf16 v[72:75], a[64:67], a[88:91], v[72:75]
  s_add_u32 m0, s63, 43008
  ds_read_b64_tr_b16 a[106:107], v201 offset:6144
  v_mov_b32 v12, 0x0c0c0100
  v_mfma_f32_16x16x32_bf16 v[68:71], a[60:63], a[88:91], v[68:71]
  ds_read_b64_tr_b16 a[108:109], v201 offset:1024
  v_mov_b32 v13, 0x01000c0c
  v_mfma_f32_16x16x32_bf16 v[68:71], a[40:43], a[84:87], v[68:71]
  buffer_load_dwordx4 v202, s[8:11], s61 offen offset:0 lds
  v_cndmask_b32 v12, v12, v13, s[78:79]
  v_mfma_f32_16x16x32_bf16 v[68:71], a[20:23], a[80:83], v[68:71]
  s_waitcnt vmcnt(7) lgkmcnt(3)
  s_barrier
  ds_read_b64_tr_b16 a[110:111], v201 offset:7168
  v_mfma_f32_16x16x32_bf16 v[84:87], a[92:95], a[40:43], v[84:87]
  ds_read_b64_tr_b16 a[112:113], v201 offset:2048
  v_mov_b32 v14, 0x0c0c0c0c
  v_mfma_f32_16x16x32_bf16 v[84:87], a[96:99], a[60:63], v[84:87]
  buffer_load_dwordx4 v203, s[8:11], s61 offen offset:1024 lds
  v_cndmask_b32 v228, v14, v12, s[80:81]
  v_mfma_f32_16x16x32_bf16 v[84:87], a[100:103], a[0:3], v[84:87]
  ds_read_b64_tr_b16 a[114:115], v201 offset:8192
  v_cndmask_b32 v230, v12, v14, s[80:81]
  v_mfma_f32_16x16x32_bf16 v[88:91], a[100:103], a[4:7], v[88:91]
  ds_read_b128 a[20:23], v207 offset:12288
  v_mfma_f32_16x16x32_bf16 v[88:91], a[96:99], a[64:67], v[88:91]
  ds_read_b64_tr_b16 a[80:81], v196 offset:0
  v_mfma_f32_16x16x32_bf16 v[88:91], a[92:95], a[44:47], v[88:91]
  ds_read_b128 a[24:27], v207 offset:13312
  v_mfma_f32_16x16x32_bf16 v[92:95], a[92:95], a[48:51], v[92:95]
  buffer_load_dwordx4 v204, s[8:11], s61 offen offset:2048 lds
  s_mov_b32 s62, 30720
  v_mfma_f32_16x16x32_bf16 v[92:95], a[96:99], a[68:71], v[92:95]
  s_add_u32 m0, s64, 55296
  ds_read_b64_tr_b16 a[82:83], v196 offset:6144
  v_mov_b32 v12, 0x0c0c0302
  v_mfma_f32_16x16x32_bf16 v[92:95], a[100:103], a[8:11], v[92:95]
  ds_read_b128 a[28:31], v207 offset:14336
  v_mov_b32 v13, 0x03020c0c
  v_mfma_f32_16x16x32_bf16 v[96:99], a[100:103], a[12:15], v[96:99]
  buffer_load_dwordx4 v205, s[36:39], s62 offen offset:0 sc1 lds
  v_cndmask_b32 v12, v12, v13, s[78:79]
  v_mfma_f32_16x16x32_bf16 v[96:99], a[96:99], a[72:75], v[96:99]
  ds_read_b64_tr_b16 a[84:85], v196 offset:1024
  v_cndmask_b32 v229, v14, v12, s[82:83]
  v_mfma_f32_16x16x32_bf16 v[96:99], a[92:95], a[52:55], v[96:99]
  s_waitcnt lgkmcnt(6)
  ds_read_b128 a[32:35], v207 offset:15360
  v_cndmask_b32 v231, v12, v14, s[82:83]
  v_mfma_f32_16x16x32_bf16 v[112:115], a[104:107], a[52:55], v[112:115]
  ds_read_b128 a[36:39], v210 offset:20480
  v_mfma_f32_16x16x32_bf16 v[112:115], a[108:111], a[72:75], v[112:115]
  ds_read_b64_tr_b16 a[86:87], v196 offset:7168
  v_mfma_f32_16x16x32_bf16 v[112:115], a[112:115], a[12:15], v[112:115]
  s_lshl1_add_u32 s48, s57, s59
  buffer_load_dwordx4 v205, s[36:39], s62 offen offset:1024 sc1 lds
  s_add_u32 m0, s65, 63488
  v_mfma_f32_16x16x32_bf16 v[108:111], a[112:115], a[8:11], v[108:111]
  s_lshl_b32 s71, s48, 17
  ds_read_b64_tr_b16 a[88:89], v196 offset:2048
  s_lshl1_add_u32 s48, s58, s60
  v_mfma_f32_16x16x32_bf16 v[108:111], a[108:111], a[68:71], v[108:111]
  s_lshl_b32 s48, s48, 11
  ds_read_b64_tr_b16 a[90:91], v196 offset:8192
  v_mfma_f32_16x16x32_bf16 v[108:111], a[104:107], a[48:51], v[108:111]
  buffer_load_dword v206, s[36:39], s62 offen sc1 lds
  s_mov_b32 s61, 2754560
  v_mfma_f32_16x16x32_bf16 v[104:107], a[104:107], a[44:47], v[104:107]
  s_add_u32 m0, s63, 64512
  v_mfma_f32_16x16x32_bf16 v[104:107], a[108:111], a[64:67], v[104:107]
  ds_read_b64_tr_b16 a[92:93], v197 offset:0
  v_mfma_f32_16x16x32_bf16 v[104:107], a[112:115], a[4:7], v[104:107]
  s_add_u32 s71, s71, s48
  buffer_load_dwordx4 v202, s[8:11], s61 offen offset:0 lds
  s_add_u32 s71, s71, 7340032
  v_mfma_f32_16x16x32_bf16 v[100:103], a[112:115], a[0:3], v[100:103]
  s_add_u32 s72, s71, 65536
  ds_read_b64_tr_b16 a[94:95], v197 offset:6144
  s_or_b32 s57, s57, s59
  v_mfma_f32_16x16x32_bf16 v[100:103], a[108:111], a[60:63], v[100:103]
  v_mfma_f32_16x16x32_bf16 v[100:103], a[104:107], a[40:43], v[100:103]
  s_waitcnt lgkmcnt(2)
  ds_read_b64_tr_b16 a[96:97], v197 offset:1024
  v_mfma_f32_16x16x32_bf16 v[20:23], a[80:83], a[60:63], v[20:23]
  buffer_load_dwordx4 v203, s[8:11], s61 offen offset:1024 lds
  v_mfma_f32_16x16x32_bf16 v[20:23], a[84:87], a[0:3], v[20:23]
  ds_read_b64_tr_b16 a[98:99], v197 offset:7168
  v_mfma_f32_16x16x32_bf16 v[20:23], a[88:91], a[20:23], v[20:23]
  s_waitcnt vmcnt(8)
  s_barrier
  v_mfma_f32_16x16x32_bf16 v[24:27], a[88:91], a[24:27], v[24:27]
  s_lshl_b32 s45, s2, 7
  s_waitcnt vmcnt(25)
  v_cmp_ne_u32 vcc, s3, v19
  s_nop 4
  s_cbranch_vccnz CK3s
CK3x:
  v_mfma_f32_16x16x32_bf16 v[24:27], a[84:87], a[4:7], v[24:27]
  s_add_u32 s45, s45, 5275648
  ds_read_b64_tr_b16 a[100:101], v197 offset:2048
  s_cmp_eq_u32 s44, 0
  v_mfma_f32_16x16x32_bf16 v[24:27], a[80:83], a[64:67], v[24:27]
  s_cselect_b32 s45, s45, 1073741824
  buffer_load_dwordx4 v204, s[8:11], s61 offen offset:2048 lds
  s_mov_b32 s62, 32768
  v_mfma_f32_16x16x32_bf16 v[28:31], a[80:83], a[68:71], v[28:31]
  s_add_u32 m0, s64, 76800
  ds_read_b64_tr_b16 a[102:103], v197 offset:8192
  v_mfma_f32_16x16x32_bf16 v[28:31], a[84:87], a[8:11], v[28:31]
  ds_read_b128 a[40:43], v207 offset:33792
  v_mfma_f32_16x16x32_bf16 v[28:31], a[88:91], a[28:31], v[28:31]
  ds_read_b64_tr_b16 a[104:105], v196 offset:21504
  v_mfma_f32_16x16x32_bf16 v[32:35], a[88:91], a[32:35], v[32:35]
  s_lshr_b32 s49, s2, 3
  ds_read_b128 a[44:47], v207 offset:34816
  s_and_b32 s60, s49, 3
  v_mfma_f32_16x16x32_bf16 v[32:35], a[84:87], a[12:15], v[32:35]
  s_lshr_b32 s58, s49, 2
  buffer_load_dwordx4 v205, s[36:39], s62 offen offset:0 sc1 lds
  s_lshl1_add_u32 s49, s60, s58
  v_mfma_f32_16x16x32_bf16 v[32:35], a[80:83], a[72:75], v[32:35]
  s_and_b32 s49, s49, 7
  ds_read_b64_tr_b16 a[106:107], v196 offset:27648
  s_and_b32 s48, s2, 7
  v_mfma_f32_16x16x32_bf16 v[116:119], a[80:83], a[76:79], v[116:119]
  s_lshl2_add_u32 s60, s48, s60
  ds_read_b128 a[48:51], v207 offset:35840
  v_mfma_f32_16x16x32_bf16 v[116:119], a[84:87], a[16:19], v[116:119]
  buffer_load_dwordx4 v205, s[36:39], s62 offen offset:1024 sc1 lds
  s_add_u32 m0, s65, 84992
  v_mfma_f32_16x16x32_bf16 v[116:119], a[88:91], a[36:39], v[116:119]
  s_waitcnt lgkmcnt(5)
  ds_read_b64_tr_b16 a[108:109], v196 offset:22528
  v_mfma_f32_16x16x32_bf16 v[48:51], a[92:95], a[72:75], v[48:51]
  ds_read_b128 a[52:55], v207 offset:36864
  v_mfma_f32_16x16x32_bf16 v[48:51], a[96:99], a[12:15], v[48:51]
  ds_read_b128 a[56:59], v210 offset:41984
  v_mfma_f32_16x16x32_bf16 v[48:51], a[100:103], a[32:35], v[48:51]
  ds_read_b64_tr_b16 a[110:111], v196 offset:28672
  v_mfma_f32_16x16x32_bf16 v[44:47], a[100:103], a[28:31], v[44:47]
  buffer_load_dword v206, s[36:39], s62 offen sc1 lds
  s_mov_b32 s61, 2953216
  v_mfma_f32_16x16x32_bf16 v[44:47], a[96:99], a[8:11], v[44:47]
  s_add_u32 m0, s63, 86016
  ds_read_b64_tr_b16 a[112:113], v196 offset:23552
  v_mfma_f32_16x16x32_bf16 v[44:47], a[92:95], a[68:71], v[44:47]
  s_mov_b32 s84, 0xd0643521
  ds_read_b64_tr_b16 a[114:115], v196 offset:29696
  s_mov_b32 s85, 0xfecba987
  v_mfma_f32_16x16x32_bf16 v[40:43], a[92:95], a[64:67], v[40:43]
  buffer_load_dwordx4 v202, s[8:11], s61 offen offset:0 lds
  v_mfma_f32_16x16x32_bf16 v[40:43], a[96:99], a[4:7], v[40:43]
  ds_read_b64_tr_b16 a[80:81], v197 offset:21504
  v_mfma_f32_16x16x32_bf16 v[40:43], a[100:103], a[24:27], v[40:43]
  v_mfma_f32_16x16x32_bf16 v[36:39], a[100:103], a[20:23], v[36:39]
  s_cmp_eq_u32 s49, 1
  buffer_load_dwordx4 v203, s[8:11], s61 offen offset:1024 lds
  s_cselect_b32 s84, 0x71546320, s84
  v_mfma_f32_16x16x32_bf16 v[36:39], a[96:99], a[0:3], v[36:39]
  s_cselect_b32 s85, 0xfdcba89e, s85
  ds_read_b64_tr_b16 a[82:83], v197 offset:27648
  v_mfma_f32_16x16x32_bf16 v[36:39], a[92:95], a[60:63], v[36:39]
  s_waitcnt lgkmcnt(2)
  ds_read_b64_tr_b16 a[84:85], v197 offset:22528
  v_mfma_f32_16x16x32_bf16 v[52:55], a[0:3], a[104:107], v[52:55]
  buffer_load_dwordx4 v204, s[8:11], s61 offen offset:2048 lds
  v_mfma_f32_16x16x32_bf16 v[52:55], a[20:23], a[108:111], v[52:55]
  s_mov_b32 s62, 34816
  s_add_u32 m0, s64, 98304
  ds_read_b64_tr_b16 a[86:87], v197 offset:28672
  v_mfma_f32_16x16x32_bf16 v[52:55], a[40:43], a[112:115], v[52:55]
  s_waitcnt vmcnt(9)
  s_barrier
  s_cmp_eq_u32 s49, 2
  v_mfma_f32_16x16x32_bf16 v[56:59], a[44:47], a[112:115], v[56:59]
  s_cselect_b32 s84, 0x62574310, s84
  ds_read_b64_tr_b16 a[88:89], v197 offset:23552
  s_cselect_b32 s85, 0xfedcb9a8, s85
  v_mfma_f32_16x16x32_bf16 v[56:59], a[24:27], a[108:111], v[56:59]
  buffer_load_dwordx4 v205, s[36:39], s62 offen offset:0 sc1 lds
  v_mfma_f32_16x16x32_bf16 v[56:59], a[4:7], a[104:107], v[56:59]
  ds_read_b64_tr_b16 a[90:91], v197 offset:29696
  v_mfma_f32_16x16x32_bf16 v[60:63], a[8:11], a[104:107], v[60:63]
  s_cmp_eq_u32 s49, 3
  ds_read_b128 a[60:63], v207 offset:55296
  s_cselect_b32 s84, 0x63854210, s84
  v_mfma_f32_16x16x32_bf16 v[60:63], a[28:31], a[108:111], v[60:63]
  s_cselect_b32 s85, 0xfedca9b7, s85
  buffer_load_dwordx4 v205, s[36:39], s62 offen offset:1024 sc1 lds
  v_mfma_f32_16x16x32_bf16 v[60:63], a[48:51], a[112:115], v[60:63]
  s_add_u32 m0, s65, 106496
  ds_read_b64_tr_b16 a[92:93], v196 offset:43008
  v_mfma_f32_16x16x32_bf16 v[64:67], a[52:55], a[112:115], v[64:67]
  ds_read_b128 a[64:67], v207 offset:56320
  v_mfma_f32_16x16x32_bf16 v[64:67], a[32:35], a[108:111], v[64:67]
  ds_read_b64_tr_b16 a[94:95], v196 offset:49152
  v_mfma_f32_16x16x32_bf16 v[64:67], a[12:15], a[104:107], v[64:67]
  s_cmp_eq_u32 s49, 4
  ds_read_b128 a[68:71], v207 offset:57344
  s_cselect_b32 s84, 0x64953210, s84
  v_mfma_f32_16x16x32_bf16 v[120:123], a[16:19], a[104:107], v[120:123]
  s_cselect_b32 s85, 0xfedba8c7, s85
  buffer_load_dword v206, s[36:39], s62 offen sc1 lds
  s_mov_b32 s61, 3145728
  v_mfma_f32_16x16x32_bf16 v[120:123], a[36:39], a[108:111], v[120:123]
  s_add_u32 m0, s63, 107520
  ds_read_b64_tr_b16 a[96:97], v196 offset:44032
  v_mfma_f32_16x16x32_bf16 v[120:123], a[56:59], a[112:115], v[120:123]
  s_waitcnt lgkmcnt(6)
  ds_read_b128 a[72:75], v207 offset:58368
  v_mfma_f32_16x16x32_bf16 v[80:83], a[12:15], a[80:83], v[80:83]
  ds_read_b64_tr_b16 a[98:99], v196 offset:50176
  v_mfma_f32_16x16x32_bf16 v[80:83], a[32:35], a[84:87], v[80:83]
  s_cmp_eq_u32 s49, 5
  ds_read_b128 a[76:79], v210 offset:63488
  s_cselect_b32 s84, 0x65a43210, s84
  v_mfma_f32_16x16x32_bf16 v[80:83], a[52:55], a[88:91], v[80:83]
  s_cselect_b32 s85, 0xfecb98d7, s85
  buffer_load_dwordx4 v202, s[8:11], s61 offen offset:0 lds
  v_mfma_f32_16x16x32_bf16 v[76:79], a[48:51], a[88:91], v[76:79]
  ds_read_b64_tr_b16 a[100:101], v196 offset:45056
  v_mfma_f32_16x16x32_bf16 v[76:79], a[28:31], a[84:87], v[76:79]
  ds_read_b64_tr_b16 a[102:103], v196 offset:51200
  v_mfma_f32_16x16x32_bf16 v[76:79], a[8:11], a[80:83], v[76:79]
  buffer_load_dwordx4 v203, s[8:11], s61 offen offset:1024 lds
  v_mfma_f32_16x16x32_bf16 v[72:75], a[4:7], a[80:83], v[72:75]
  s_cmp_eq_u32 s49, 6
  ds_read_b64_tr_b16 a[104:105], v197 offset:43008
  s_cselect_b32 s84, 0xb6543210, s84
  v_mfma_f32_16x16x32_bf16 v[72:75], a[24:27], a[84:87], v[72:75]
  s_cselect_b32 s85, 0xfdca98e7, s85
  ds_read_b64_tr_b16 a[106:107], v197 offset:49152
  v_mfma_f32_16x16x32_bf16 v[72:75], a[44:47], a[88:91], v[72:75]
  buffer_load_dwordx4 v204, s[8:11], s61 offen offset:2048 lds
  v_mfma_f32_16x16x32_bf16 v[68:71], a[40:43], a[88:91], v[68:71]
  s_mov_b32 s62, 36864
  ds_read_b64_tr_b16 a[108:109], v197 offset:44032
  s_add_u32 m0, s64, 119808
  v_mfma_f32_16x16x32_bf16 v[68:71], a[20:23], a[84:87], v[68:71]
  s_cmp_eq_u32 s49, 7
  ds_read_b64_tr_b16 a[110:111], v197 offset:50176
  s_cselect_b32 s84, 0xc7543210, s84
  v_mfma_f32_16x16x32_bf16 v[68:71], a[0:3], a[80:83], v[68:71]
  s_waitcnt vmcnt(9) lgkmcnt(4)
  s_barrier
  s_cselect_b32 s85, 0xedba98f6, s85
  v_mfma_f32_16x16x32_bf16 v[84:87], a[92:95], a[20:23], v[84:87]
  buffer_load_dwordx4 v205, s[36:39], s62 offen offset:0 sc1 lds
  v_mfma_f32_16x16x32_bf16 v[84:87], a[96:99], a[40:43], v[84:87]
  ds_read_b64_tr_b16 a[112:113], v197 offset:45056
  v_mfma_f32_16x16x32_bf16 v[84:87], a[100:103], a[60:63], v[84:87]
  ds_read_b64_tr_b16 a[114:115], v197 offset:51200
  v_mfma_f32_16x16x32_bf16 v[88:91], a[100:103], a[64:67], v[88:91]
  s_mul_i32 s77, s44, 7168
  ds_read_b128 a[0:3], v208 offset:12288
  s_lshl2_add_u32 s86, s58, s44
  v_mfma_f32_16x16x32_bf16 v[88:91], a[96:99], a[44:47], v[88:91]
  s_lshl_b32 s86, s86, 17
  buffer_load_dwordx4 v205, s[36:39], s62 offen offset:1024 sc1 lds
  s_add_u32 m0, s65, 128000
  v_mfma_f32_16x16x32_bf16 v[88:91], a[92:95], a[24:27], v[88:91]
  s_add_u32 s86, s86, 36700160
  ds_read_b64_tr_b16 a[80:81], v198 offset:0
  v_mfma_f32_16x16x32_bf16 v[92:95], a[92:95], a[28:31], v[92:95]
  ds_read_b128 a[4:7], v208 offset:13312
  v_mfma_f32_16x16x32_bf16 v[92:95], a[96:99], a[48:51], v[92:95]
  ds_read_b64_tr_b16 a[82:83], v198 offset:6144
  v_mfma_f32_16x16x32_bf16 v[92:95], a[100:103], a[68:71], v[92:95]
  ds_read_b128 a[8:11], v208 offset:14336
  v_mfma_f32_16x16x32_bf16 v[96:99], a[100:103], a[72:75], v[96:99]
  buffer_load_dword v206, s[36:39], s62 offen sc1 lds
  s_mov_b32 s61, 3344384
  v_mfma_f32_16x16x32_bf16 v[96:99], a[96:99], a[52:55], v[96:99]
  s_add_u32 m0, s63, 129024
  ds_read_b64_tr_b16 a[84:85], v198 offset:1024
  s_cmp_ge_u32 s44, 2
  v_mfma_f32_16x16x32_bf16 v[96:99], a[92:95], a[32:35], v[96:99]
  s_waitcnt lgkmcnt(6)
  ds_read_b128 a[12:15], v208 offset:15360
  s_cselect_b64 s[16:17], s[20:21], s[16:17]
  v_mfma_f32_16x16x32_bf16 v[112:115], a[104:107], a[32:35], v[112:115]
  ds_read_b128 a[16:19], v211 offset:20480
  v_mfma_f32_16x16x32_bf16 v[112:115], a[108:111], a[52:55], v[112:115]
  buffer_load_dwordx4 v202, s[8:11], s61 offen offset:0 lds
  v_lshrrev_b32 v12, 2, v10
  v_mfma_f32_16x16x32_bf16 v[112:115], a[112:115], a[72:75], v[112:115]
  ds_read_b64_tr_b16 a[86:87], v198 offset:7168
  v_mul_u32_u24 v12, 224, v12
  v_mfma_f32_16x16x32_bf16 v[108:111], a[112:115], a[68:71], v[108:111]
  ds_read_b64_tr_b16 a[88:89], v198 offset:2048
  v_and_b32 v13, 3, v10
  v_mfma_f32_16x16x32_bf16 v[108:111], a[108:111], a[48:51], v[108:111]
  buffer_load_dwordx4 v203, s[8:11], s61 offen offset:1024 lds
  v_lshl_add_u32 v1, v13, 3, v12
  v_mfma_f32_16x16x32_bf16 v[108:111], a[104:107], a[28:31], v[108:111]
  ds_read_b64_tr_b16 a[90:91], v198 offset:8192
  v_add_u32 v2, 57344, v1
  v_mfma_f32_16x16x32_bf16 v[104:107], a[104:107], a[24:27], v[104:107]
  v_mfma_f32_16x16x32_bf16 v[104:107], a[108:111], a[44:47], v[104:107]
  buffer_load_dwordx4 v204, s[8:11], s61 offen offset:2048 lds
  v_mfma_f32_16x16x32_bf16 v[104:107], a[112:115], a[64:67], v[104:107]
  s_mov_b32 s62, 38912
  ds_read_b64_tr_b16 a[92:93], v199 offset:0
  s_add_u32 m0, s64, 141312
  v_mfma_f32_16x16x32_bf16 v[100:103], a[112:115], a[60:63], v[100:103]
  s_mul_i32 s48, s60, 224
  ds_read_b64_tr_b16 a[94:95], v199 offset:6144
  s_and_b32 s49, s44, 1
  v_mfma_f32_16x16x32_bf16 v[100:103], a[108:111], a[40:43], v[100:103]
  s_mul_i32 s49, s49, 458752
  s_add_u32 s48, s48, s49
  s_and_b32 s49, s60, 1
  v_mfma_f32_16x16x32_bf16 v[100:103], a[104:107], a[20:23], v[100:103]
  s_waitcnt lgkmcnt(2)
  buffer_load_dwordx4 v205, s[36:39], s62 offen offset:0 sc1 lds
  s_lshl_b32 s49, s49, 1
  v_mfma_f32_16x16x32_bf16 v[20:23], a[80:83], a[40:43], v[20:23]
  ds_read_b64_tr_b16 a[96:97], v199 offset:1024
  v_mfma_f32_16x16x32_bf16 v[20:23], a[84:87], a[60:63], v[20:23]
  ds_read_b64_tr_b16 a[98:99], v199 offset:7168
  v_mfma_f32_16x16x32_bf16 v[20:23], a[88:91], a[0:3], v[20:23]
  s_waitcnt vmcnt(10)
  s_barrier
  v_mfma_f32_16x16x32_bf16 v[24:27], a[88:91], a[4:7], v[24:27]
  buffer_load_dwordx4 v205, s[36:39], s62 offen offset:1024 sc1 lds
  v_mfma_f32_16x16x32_bf16 v[24:27], a[84:87], a[64:67], v[24:27]
  s_add_u32 m0, s65, 149504
  ds_read_b64_tr_b16 a[100:101], v199 offset:2048
  v_mfma_f32_16x16x32_bf16 v[24:27], a[80:83], a[44:47], v[24:27]
  ds_read_b64_tr_b16 a[102:103], v199 offset:8192
  v_mfma_f32_16x16x32_bf16 v[28:31], a[80:83], a[48:51], v[28:31]
Ha2:
  s_cbranch_execz Ha2_1
  ds_read_b128 a[20:23], v208 offset:33792
  v_add_u32 v12, 0, v10
  v_mfma_f32_16x16x32_bf16 v[28:31], a[84:87], a[68:71], v[28:31]
  buffer_load_dword v206, s[36:39], s62 offen sc1 lds
  s_mov_b32 s61, 3543040
  v_mfma_f32_16x16x32_bf16 v[28:31], a[88:91], a[8:11], v[28:31]
  s_add_u32 m0, s63, 0
  ds_read_b64_tr_b16 a[104:105], v198 offset:21504
  v_mul_u32_u24 v13, 4682, v12
  v_mfma_f32_16x16x32_bf16 v[32:35], a[88:91], a[12:15], v[32:35]
  ds_read_b128 a[24:27], v208 offset:34816
  v_lshrrev_b32 v13, 16, v13
  v_mfma_f32_16x16x32_bf16 v[32:35], a[84:87], a[72:75], v[32:35]
  ds_read_b64_tr_b16 a[106:107], v198 offset:27648
  v_mul_i32_i24 v14, -14, v13
  v_mfma_f32_16x16x32_bf16 v[32:35], a[80:83], a[52:55], v[32:35]
  ds_read_b128 a[28:31], v208 offset:35840
  v_add3_u32 v12, v12, v14, s49
  v_mfma_f32_16x16x32_bf16 v[116:119], a[80:83], a[56:59], v[116:119]
  buffer_load_dwordx4 v202, s[8:11], s61 offen offset:0 lds
  v_mfma_f32_16x16x32_bf16 v[116:119], a[84:87], a[76:79], v[116:119]
  ds_read_b64_tr_b16 a[108:109], v198 offset:22528
  v_mfma_f32_16x16x32_bf16 v[116:119], a[88:91], a[16:19], v[116:119]
  s_waitcnt lgkmcnt(6)
  ds_read_b128 a[32:35], v208 offset:36864
  v_add_u32 v14, -14, v12
  v_mfma_f32_16x16x32_bf16 v[48:51], a[92:95], a[52:55], v[48:51]
  ds_read_b128 a[36:39], v211 offset:41984
  v_min_u32 v12, v12, v14
  v_mfma_f32_16x16x32_bf16 v[48:51], a[96:99], a[72:75], v[48:51]
  buffer_load_dwordx4 v203, s[8:11], s61 offen offset:1024 lds
  v_mul_u32_u24 v13, 7168, v13
  v_mfma_f32_16x16x32_bf16 v[48:51], a[100:103], a[12:15], v[48:51]
  ds_read_b64_tr_b16 a[110:111], v198 offset:28672
  v_lshl_add_u32 v12, v12, 4, v13
  v_mfma_f32_16x16x32_bf16 v[44:47], a[100:103], a[8:11], v[44:47]
  ds_read_b64_tr_b16 a[112:113], v198 offset:23552
  v_add_u32 v3, s48, v12
  v_mfma_f32_16x16x32_bf16 v[44:47], a[96:99], a[68:71], v[44:47]
  buffer_load_dwordx4 v204, s[8:11], s61 offen offset:2048 lds
  s_mov_b32 s62, 40960
  v_mfma_f32_16x16x32_bf16 v[44:47], a[92:95], a[48:51], v[44:47]
  s_add_u32 m0, s64, 12288
  ds_read_b64_tr_b16 a[114:115], v198 offset:29696
  v_mfma_f32_16x16x32_bf16 v[40:43], a[92:95], a[44:47], v[40:43]
  v_mfma_f32_16x16x32_bf16 v[40:43], a[96:99], a[64:67], v[40:43]
  s_sub_u32 s48, s48, 1024
  buffer_load_dwordx4 v205, s[36:39], s62 offen offset:0 sc1 lds
  v_mfma_f32_16x16x32_bf16 v[40:43], a[100:103], a[4:7], v[40:43]
  ds_read_b64_tr_b16 a[80:81], v199 offset:21504
  v_mfma_f32_16x16x32_bf16 v[36:39], a[100:103], a[0:3], v[36:39]
  ds_read_b64_tr_b16 a[82:83], v199 offset:27648
  v_add_u32 v12, 64, v10
  v_mfma_f32_16x16x32_bf16 v[36:39], a[96:99], a[60:63], v[36:39]
  v_mul_u32_u24 v13, 4682, v12
  v_lshrrev_b32 v13, 16, v13
  v_mfma_f32_16x16x32_bf16 v[36:39], a[92:95], a[40:43], v[36:39]
  s_waitcnt lgkmcnt(2)
  buffer_load_dwordx4 v205, s[36:39], s62 offen offset:1024 sc1 lds
  v_mul_i32_i24 v14, -14, v13
  v_mfma_f32_16x16x32_bf16 v[52:55], a[60:63], a[104:107], v[52:55]
  s_add_u32 m0, s65, 20480
  ds_read_b64_tr_b16 a[84:85], v199 offset:22528
  v_add3_u32 v12, v12, v14, s49
  v_mfma_f32_16x16x32_bf16 v[52:55], a[0:3], a[108:111], v[52:55]
  ds_read_b64_tr_b16 a[86:87], v199 offset:28672
  v_mfma_f32_16x16x32_bf16 v[52:55], a[20:23], a[112:115], v[52:55]
  s_waitcnt vmcnt(11)
  s_barrier
  v_mfma_f32_16x16x32_bf16 v[56:59], a[24:27], a[112:115], v[56:59]
  buffer_load_dword v206, s[36:39], s62 offen sc1 lds
  s_mov_b32 s61, 3735552
  v_mfma_f32_16x16x32_bf16 v[56:59], a[4:7], a[108:111], v[56:59]
  s_add_u32 m0, s63, 21504
  ds_read_b64_tr_b16 a[88:89], v199 offset:23552
  v_mfma_f32_16x16x32_bf16 v[56:59], a[64:67], a[104:107], v[56:59]
  ds_read_b64_tr_b16 a[90:91], v199 offset:29696
  v_add_u32 v14, -14, v12
  v_mfma_f32_16x16x32_bf16 v[60:63], a[68:71], a[104:107], v[60:63]
  ds_read_b128 a[40:43], v208 offset:55296
  v_min_u32 v12, v12, v14
  v_mfma_f32_16x16x32_bf16 v[60:63], a[8:11], a[108:111], v[60:63]
  buffer_load_dwordx4 v202, s[8:11], s61 offen offset:0 lds
  v_mul_u32_u24 v13, 7168, v13
  v_mfma_f32_16x16x32_bf16 v[60:63], a[28:31], a[112:115], v[60:63]
  ds_read_b64_tr_b16 a[92:93], v198 offset:43008
  v_lshl_add_u32 v12, v12, 4, v13
  v_mfma_f32_16x16x32_bf16 v[64:67], a[32:35], a[112:115], v[64:67]
  ds_read_b128 a[44:47], v208 offset:56320
  v_add_u32 v4, s48, v12
  v_mfma_f32_16x16x32_bf16 v[64:67], a[12:15], a[108:111], v[64:67]
  ds_read_b64_tr_b16 a[94:95], v198 offset:49152
  v_mfma_f32_16x16x32_bf16 v[64:67], a[72:75], a[104:107], v[64:67]
  ds_read_b128 a[48:51], v208 offset:57344
  v_mfma_f32_16x16x32_bf16 v[120:123], a[76:79], a[104:107], v[120:123]
  buffer_load_dwordx4 v203, s[8:11], s61 offen offset:1024 lds
  v_mfma_f32_16x16x32_bf16 v[120:123], a[16:19], a[108:111], v[120:123]
  s_sub_u32 s48, s48, 1024
  ds_read_b64_tr_b16 a[96:97], v198 offset:44032
  v_mfma_f32_16x16x32_bf16 v[120:123], a[36:39], a[112:115], v[120:123]
  s_waitcnt lgkmcnt(6)
  ds_read_b128 a[52:55], v208 offset:58368
  v_mfma_f32_16x16x32_bf16 v[80:83], a[72:75], a[80:83], v[80:83]
  ds_read_b64_tr_b16 a[98:99], v198 offset:50176
  v_add_u32 v12, 128, v10
  v_mfma_f32_16x16x32_bf16 v[80:83], a[12:15], a[84:87], v[80:83]
  ds_read_b128 a[56:59], v211 offset:63488
  v_mul_u32_u24 v13, 4682, v12
  v_mfma_f32_16x16x32_bf16 v[80:83], a[32:35], a[88:91], v[80:83]
  buffer_load_dwordx4 v204, s[8:11], s61 offen offset:2048 lds
  s_mov_b32 s62, 43008
  v_mfma_f32_16x16x32_bf16 v[76:79], a[28:31], a[88:91], v[76:79]
  s_add_u32 m0, s64, 33792
  ds_read_b64_tr_b16 a[100:101], v198 offset:45056
  v_lshrrev_b32 v13, 16, v13
  v_mfma_f32_16x16x32_bf16 v[76:79], a[8:11], a[84:87], v[76:79]
  ds_read_b64_tr_b16 a[102:103], v198 offset:51200
  v_mul_i32_i24 v14, -14, v13
  v_mfma_f32_16x16x32_bf16 v[76:79], a[68:71], a[80:83], v[76:79]
  buffer_load_dwordx4 v205, s[36:39], s62 offen offset:0 sc1 lds
  v_add3_u32 v12, v12, v14, s49
  v_mfma_f32_16x16x32_bf16 v[72:75], a[64:67], a[80:83], v[72:75]
  ds_read_b64_tr_b16 a[104:105], v199 offset:43008
  v_mfma_f32_16x16x32_bf16 v[72:75], a[4:7], a[84:87], v[72:75]
  ds_read_b64_tr_b16 a[106:107], v199 offset:49152
  v_mfma_f32_16x16x32_bf16 v[72:75], a[24:27], a[88:91], v[72:75]
  buffer_load_dwordx4 v205, s[36:39], s62 offen offset:1024 sc1 lds
  s_add_u32 m0, s65, 41984
  v_mfma_f32_16x16x32_bf16 v[68:71], a[20:23], a[88:91], v[68:71]
  ds_read_b64_tr_b16 a[108:109], v199 offset:44032
  v_add_u32 v14, -14, v12
  v_mfma_f32_16x16x32_bf16 v[68:71], a[0:3], a[84:87], v[68:71]
  ds_read_b64_tr_b16 a[110:111], v199 offset:50176
  v_min_u32 v12, v12, v14
  v_mfma_f32_16x16x32_bf16 v[68:71], a[60:63], a[80:83], v[68:71]
  s_waitcnt vmcnt(11) lgkmcnt(4)
  s_barrier
  buffer_load_dword v206, s[36:39], s62 offen sc1 lds
  v_mfma_f32_16x16x32_bf16 v[84:87], a[92:95], a[0:3], v[84:87]
  s_mov_b32 s61, 3934208
  s_add_u32 m0, s63, 43008
  ds_read_b64_tr_b16 a[112:113], v199 offset:45056
  v_mfma_f32_16x16x32_bf16 v[84:87], a[96:99], a[20:23], v[84:87]
  v_mul_u32_u24 v13, 7168, v13
  v_lshl_add_u32 v12, v12, 4, v13
  v_mfma_f32_16x16x32_bf16 v[84:87], a[100:103], a[40:43], v[84:87]
  ds_read_b64_tr_b16 a[114:115], v199 offset:51200
  v_add_u32 v5, s48, v12
  v_mfma_f32_16x16x32_bf16 v[88:91], a[100:103], a[44:47], v[88:91]
  ds_read_b128 a[60:63], v209 offset:12288
  v_mfma_f32_16x16x32_bf16 v[88:91], a[96:99], a[24:27], v[88:91]
  s_sub_u32 s48, s48, 1024
  buffer_load_dwordx4 v202, s[8:11], s61 offen offset:0 lds
  v_mfma_f32_16x16x32_bf16 v[88:91], a[92:95], a[4:7], v[88:91]
  ds_read_b64_tr_b16 a[80:81], v200 offset:0
  v_add_u32 v12, 192, v10
  v_mfma_f32_16x16x32_bf16 v[92:95], a[92:95], a[8:11], v[92:95]
  ds_read_b128 a[64:67], v209 offset:13312
  v_mul_u32_u24 v13, 4682, v12
  v_mfma_f32_16x16x32_bf16 v[92:95], a[96:99], a[28:31], v[92:95]
  buffer_load_dwordx4 v203, s[8:11], s61 offen offset:1024 lds
  v_lshrrev_b32 v13, 16, v13
  v_mfma_f32_16x16x32_bf16 v[92:95], a[100:103], a[48:51], v[92:95]
  ds_read_b64_tr_b16 a[82:83], v200 offset:6144
  v_mul_i32_i24 v14, -14, v13
  v_mfma_f32_16x16x32_bf16 v[96:99], a[100:103], a[52:55], v[96:99]
  ds_read_b128 a[68:71], v209 offset:14336
  v_add3_u32 v12, v12, v14, s49
  v_mfma_f32_16x16x32_bf16 v[96:99], a[96:99], a[32:35], v[96:99]
  ds_read_b64_tr_b16 a[84:85], v200 offset:1024
  v_mfma_f32_16x16x32_bf16 v[96:99], a[92:95], a[12:15], v[96:99]
  s_waitcnt lgkmcnt(6)
  ds_read_b128 a[72:75], v209 offset:15360
  v_mfma_f32_16x16x32_bf16 v[112:115], a[104:107], a[12:15], v[112:115]
  buffer_load_dwordx4 v204, s[8:11], s61 offen offset:2048 lds
  s_mov_b32 s62, 45056
  v_mfma_f32_16x16x32_bf16 v[112:115], a[108:111], a[32:35], v[112:115]
  s_add_u32 m0, s64, 55296
  ds_read_b128 a[76:79], v212 offset:20480
  v_add_u32 v14, -14, v12
  v_mfma_f32_16x16x32_bf16 v[112:115], a[112:115], a[52:55], v[112:115]
  ds_read_b64_tr_b16 a[86:87], v200 offset:7168
  v_min_u32 v12, v12, v14
  v_mfma_f32_16x16x32_bf16 v[108:111], a[112:115], a[48:51], v[108:111]
  ds_read_b64_tr_b16 a[88:89], v200 offset:2048
  v_mul_u32_u24 v13, 7168, v13
  v_mfma_f32_16x16x32_bf16 v[108:111], a[108:111], a[28:31], v[108:111]
  buffer_load_dwordx4 v205, s[36:39], s62 offen offset:0 sc1 lds
  v_lshl_add_u32 v12, v12, 4, v13
  v_mfma_f32_16x16x32_bf16 v[108:111], a[104:107], a[8:11], v[108:111]
  ds_read_b64_tr_b16 a[90:91], v200 offset:8192
  v_add_u32 v6, s48, v12
  v_mfma_f32_16x16x32_bf16 v[104:107], a[104:107], a[4:7], v[104:107]
  v_mfma_f32_16x16x32_bf16 v[104:107], a[108:111], a[24:27], v[104:107]
  buffer_load_dwordx4 v205, s[36:39], s62 offen offset:1024 sc1 lds
  s_add_u32 m0, s65, 63488
  v_mfma_f32_16x16x32_bf16 v[104:107], a[112:115], a[44:47], v[104:107]
  ds_read_b64_tr_b16 a[92:93], v201 offset:0
  v_mfma_f32_16x16x32_bf16 v[100:103], a[112:115], a[40:43], v[100:103]
  s_sub_u32 s48, s48, -3072
  ds_read_b64_tr_b16 a[94:95], v201 offset:6144
  v_mfma_f32_16x16x32_bf16 v[100:103], a[108:111], a[20:23], v[100:103]
  buffer_load_dword v206, s[36:39], s62 offen sc1 lds
  v_mfma_f32_16x16x32_bf16 v[100:103], a[104:107], a[0:3], v[100:103]
  s_waitcnt lgkmcnt(2)
  s_mov_b32 s61, 4132864
  s_add_u32 m0, s63, 64512
  v_mfma_f32_16x16x32_bf16 v[20:23], a[80:83], a[20:23], v[20:23]
  ds_read_b64_tr_b16 a[96:97], v201 offset:1024
  v_add_u32 v12, 256, v10
  v_mfma_f32_16x16x32_bf16 v[20:23], a[84:87], a[40:43], v[20:23]
  ds_read_b64_tr_b16 a[98:99], v201 offset:7168
  v_mul_u32_u24 v13, 4682, v12
  v_mfma_f32_16x16x32_bf16 v[20:23], a[88:91], a[60:63], v[20:23]
  s_waitcnt vmcnt(12)
  s_barrier
  buffer_load_dwordx4 v202, s[8:11], s61 offen offset:0 lds
  v_mfma_f32_16x16x32_bf16 v[24:27], a[88:91], a[64:67], v[24:27]
  ds_read_b64_tr_b16 a[100:101], v201 offset:2048
  v_lshrrev_b32 v13, 16, v13
  v_mfma_f32_16x16x32_bf16 v[24:27], a[84:87], a[44:47], v[24:27]
  v_mul_i32_i24 v14, -14, v13
  v_add3_u32 v12, v12, v14, s49
  v_mfma_f32_16x16x32_bf16 v[24:27], a[80:83], a[24:27], v[24:27]
  ds_read_b64_tr_b16 a[102:103], v201 offset:8192
  v_mfma_f32_16x16x32_bf16 v[28:31], a[80:83], a[28:31], v[28:31]
  ds_read_b128 a[0:3], v207 offset:12288
  v_mfma_f32_16x16x32_bf16 v[28:31], a[84:87], a[48:51], v[28:31]
  buffer_load_dwordx4 v203, s[8:11], s61 offen offset:1024 lds
  v_add_u32 v14, -14, v12
  v_mfma_f32_16x16x32_bf16 v[28:31], a[88:91], a[68:71], v[28:31]
  ds_read_b64_tr_b16 a[104:105], v196 offset:0
  v_min_u32 v12, v12, v14
  v_mfma_f32_16x16x32_bf16 v[32:35], a[88:91], a[72:75], v[32:35]
  ds_read_b128 a[4:7], v207 offset:13312
  v_mul_u32_u24 v13, 7168, v13
  v_mfma_f32_16x16x32_bf16 v[32:35], a[84:87], a[52:55], v[32:35]
  buffer_load_dwordx4 v204, s[8:11], s61 offen offset:2048 lds
  s_mov_b32 s62, 47104
  v_mfma_f32_16x16x32_bf16 v[32:35], a[80:83], a[32:35], v[32:35]
  s_add_u32 m0, s64, 76800
  ds_read_b64_tr_b16 a[106:107], v196 offset:6144
  v_lshl_add_u32 v12, v12, 4, v13
  v_mfma_f32_16x16x32_bf16 v[116:119], a[80:83], a[36:39], v[116:119]
  ds_read_b128 a[8:11], v207 offset:14336
  v_add_u32 v7, s48, v12
  v_mfma_f32_16x16x32_bf16 v[116:119], a[84:87], a[56:59], v[116:119]
  ds_read_b64_tr_b16 a[108:109], v196 offset:1024
  v_mfma_f32_16x16x32_bf16 v[116:119], a[88:91], a[76:79], v[116:119]
  s_waitcnt lgkmcnt(6)
  ds_read_b128 a[12:15], v207 offset:15360
  v_mfma_f32_16x16x32_bf16 v[48:51], a[92:95], a[32:35], v[48:51]
  s_sub_u32 s48, s48, 1024
  buffer_load_dwordx4 v205, s[36:39], s62 offen offset:0 sc1 lds
  v_mfma_f32_16x16x32_bf16 v[48:51], a[96:99], a[52:55], v[48:51]
  ds_read_b128 a[16:19], v210 offset:20480
  v_mfma_f32_16x16x32_bf16 v[48:51], a[100:103], a[72:75], v[48:51]
  ds_read_b64_tr_b16 a[110:111], v196 offset:7168
  v_add_u32 v12, 320, v10
  v_mfma_f32_16x16x32_bf16 v[44:47], a[100:103], a[68:71], v[44:47]
  ds_read_b64_tr_b16 a[112:113], v196 offset:2048
  v_mul_u32_u24 v13, 4682, v12
  v_mfma_f32_16x16x32_bf16 v[44:47], a[96:99], a[48:51], v[44:47]
  buffer_load_dwordx4 v205, s[36:39], s62 offen offset:1024 sc1 lds
  s_add_u32 m0, s65, 84992
  v_mfma_f32_16x16x32_bf16 v[44:47], a[92:95], a[28:31], v[44:47]
  ds_read_b64_tr_b16 a[114:115], v196 offset:8192
  v_lshrrev_b32 v13, 16, v13
  v_mfma_f32_16x16x32_bf16 v[40:43], a[92:95], a[24:27], v[40:43]
  v_mul_i32_i24 v14, -14, v13
  v_add3_u32 v12, v12, v14, s49
  v_mfma_f32_16x16x32_bf16 v[40:43], a[96:99], a[44:47], v[40:43]
  buffer_load_dword v206, s[36:39], s62 offen sc1 lds
  s_mov_b32 s61, 4325376
  v_mfma_f32_16x16x32_bf16 v[40:43], a[100:103], a[64:67], v[40:43]
  s_add_u32 m0, s63, 86016
  ds_read_b64_tr_b16 a[80:81], v197 offset:0
  v_mfma_f32_16x16x32_bf16 v[36:39], a[100:103], a[60:63], v[36:39]
  ds_read_b64_tr_b16 a[82:83], v197 offset:6144
  v_mfma_f32_16x16x32_bf16 v[36:39], a[96:99], a[40:43], v[36:39]
  buffer_load_dwordx4 v202, s[8:11], s61 offen offset:0 lds
  v_add_u32 v14, -14, v12
  v_mfma_f32_16x16x32_bf16 v[36:39], a[92:95], a[20:23], v[36:39]
  s_waitcnt lgkmcnt(2)
  ds_read_b64_tr_b16 a[84:85], v197 offset:1024
  v_min_u32 v12, v12, v14
  v_mfma_f32_16x16x32_bf16 v[52:55], a[40:43], a[104:107], v[52:55]
  v_mul_u32_u24 v13, 7168, v13
  v_lshl_add_u32 v12, v12, 4, v13
  v_mfma_f32_16x16x32_bf16 v[52:55], a[60:63], a[108:111], v[52:55]
  ds_read_b64_tr_b16 a[86:87], v197 offset:7168
  v_add_u32 v8, s48, v12
  v_mfma_f32_16x16x32_bf16 v[52:55], a[0:3], a[112:115], v[52:55]
  s_waitcnt vmcnt(13)
  s_barrier
  buffer_load_dwordx4 v203, s[8:11], s61 offen offset:1024 lds
  v_mfma_f32_16x16x32_bf16 v[56:59], a[4:7], a[112:115], v[56:59]
  ds_read_b64_tr_b16 a[88:89], v197 offset:2048
  v_mfma_f32_16x16x32_bf16 v[56:59], a[64:67], a[108:111], v[56:59]
  v_mfma_f32_16x16x32_bf16 v[56:59], a[44:47], a[104:107], v[56:59]
  buffer_load_dwordx4 v204, s[8:11], s61 offen offset:2048 lds
  v_mfma_f32_16x16x32_bf16 v[60:63], a[48:51], a[104:107], v[60:63]
  s_mov_b32 s62, 49152
  ds_read_b64_tr_b16 a[90:91], v197 offset:8192
  s_add_u32 m0, s64, 98304
  v_mfma_f32_16x16x32_bf16 v[60:63], a[68:71], a[108:111], v[60:63]
  s_sub_u32 s48, s48, 1024
  ds_read_b128 a[20:23], v207 offset:33792
  v_add_u32 v12, 384, v10
  v_mfma_f32_16x16x32_bf16 v[60:63], a[8:11], a[112:115], v[60:63]
  ds_read_b64_tr_b16 a[92:93], v196 offset:21504
  v_mul_u32_u24 v13, 4682, v12
  v_mfma_f32_16x16x32_bf16 v[64:67], a[12:15], a[112:115], v[64:67]
  ds_read_b128 a[24:27], v207 offset:34816
  v_lshrrev_b32 v13, 16, v13
  v_mfma_f32_16x16x32_bf16 v[64:67], a[72:75], a[108:111], v[64:67]
  buffer_load_dwordx4 v205, s[36:39], s62 offen offset:0 sc1 lds
  v_mul_i32_i24 v14, -14, v13
  v_mfma_f32_16x16x32_bf16 v[64:67], a[52:55], a[104:107], v[64:67]
  ds_read_b64_tr_b16 a[94:95], v196 offset:27648
  v_add3_u32 v12, v12, v14, s49
  v_mfma_f32_16x16x32_bf16 v[120:123], a[56:59], a[104:107], v[120:123]
  ds_read_b128 a[28:31], v207 offset:35840
  v_mfma_f32_16x16x32_bf16 v[120:123], a[76:79], a[108:111], v[120:123]
  ds_read_b64_tr_b16 a[96:97], v196 offset:22528
  v_mfma_f32_16x16x32_bf16 v[120:123], a[16:19], a[112:115], v[120:123]
  s_waitcnt lgkmcnt(6)
  ds_read_b128 a[32:35], v207 offset:36864
  v_mfma_f32_16x16x32_bf16 v[80:83], a[52:55], a[80:83], v[80:83]
  buffer_load_dwordx4 v205, s[36:39], s62 offen offset:1024 sc1 lds
  s_add_u32 m0, s65, 106496
  v_mfma_f32_16x16x32_bf16 v[80:83], a[72:75], a[84:87], v[80:83]
  ds_read_b64_tr_b16 a[98:99], v196 offset:28672
  v_add_u32 v14, -14, v12
  v_mfma_f32_16x16x32_bf16 v[80:83], a[12:15], a[88:91], v[80:83]
  ds_read_b128 a[36:39], v210 offset:41984
  v_min_u32 v12, v12, v14
  v_mfma_f32_16x16x32_bf16 v[76:79], a[8:11], a[88:91], v[76:79]
  ds_read_b64_tr_b16 a[100:101], v196 offset:23552
  v_mul_u32_u24 v13, 7168, v13
  v_mfma_f32_16x16x32_bf16 v[76:79], a[68:71], a[84:87], v[76:79]
  buffer_load_dword v206, s[36:39], s62 offen sc1 lds
  s_mov_b32 s61, 4524032
  v_mfma_f32_16x16x32_bf16 v[76:79], a[48:51], a[80:83], v[76:79]
  s_add_u32 m0, s63, 107520
  ds_read_b64_tr_b16 a[102:103], v196 offset:29696
  v_lshl_add_u32 v12, v12, 4, v13
  v_mfma_f32_16x16x32_bf16 v[72:75], a[44:47], a[80:83], v[72:75]
  ds_read_b64_tr_b16 a[104:105], v197 offset:21504
  v_add_u32 v9, s48, v12
  v_mfma_f32_16x16x32_bf16 v[72:75], a[64:67], a[84:87], v[72:75]
  buffer_load_dwordx4 v202, s[8:11], s61 offen offset:0 lds
  v_mfma_f32_16x16x32_bf16 v[72:75], a[4:7], a[88:91], v[72:75]
  s_sub_u32 s48, s48, 1024
  ds_read_b64_tr_b16 a[106:107], v197 offset:27648
  v_mfma_f32_16x16x32_bf16 v[68:71], a[0:3], a[88:91], v[68:71]
  ds_read_b64_tr_b16 a[108:109], v197 offset:22528
  v_mfma_f32_16x16x32_bf16 v[68:71], a[60:63], a[84:87], v[68:71]
  s_and_b32 s48, s58, 1
  buffer_load_dwordx4 v203, s[8:11], s61 offen offset:1024 lds
  s_lshl_b32 s48, s48, 7
  v_mfma_f32_16x16x32_bf16 v[68:71], a[40:43], a[80:83], v[68:71]
  s_waitcnt vmcnt(14) lgkmcnt(3)
  s_barrier
  ds_read_b64_tr_b16 a[110:111], v197 offset:28672
  v_mfma_f32_16x16x32_bf16 v[84:87], a[92:95], a[60:63], v[84:87]
  s_and_b32 s49, s58, 6
  ds_read_b64_tr_b16 a[112:113], v197 offset:23552
  s_add_u32 s48, s48, s49
  v_mfma_f32_16x16x32_bf16 v[84:87], a[96:99], a[0:3], v[84:87]
  v_mfma_f32_16x16x32_bf16 v[84:87], a[100:103], a[20:23], v[84:87]
  buffer_load_dwordx4 v204, s[8:11], s61 offen offset:2048 lds
  s_mov_b32 s62, 51200
  v_mfma_f32_16x16x32_bf16 v[88:91], a[100:103], a[24:27], v[88:91]
  s_add_u32 m0, s64, 119808
  ds_read_b64_tr_b16 a[114:115], v197 offset:29696
  v_mfma_f32_16x16x32_bf16 v[88:91], a[96:99], a[4:7], v[88:91]
  ds_read_b128 a[40:43], v207 offset:55296
  v_bfe_u32 v12, v10, 1, 4
  v_mfma_f32_16x16x32_bf16 v[88:91], a[92:95], a[64:67], v[88:91]
  ds_read_b64_tr_b16 a[80:81], v196 offset:43008
  v_and_b32 v13, 1, v10
  v_mfma_f32_16x16x32_bf16 v[92:95], a[92:95], a[68:71], v[92:95]
  ds_read_b128 a[44:47], v207 offset:56320
  v_lshl_add_u32 v12, v12, 3, v13
  v_mfma_f32_16x16x32_bf16 v[92:95], a[96:99], a[8:11], v[92:95]
  buffer_load_dwordx4 v205, s[36:39], s62 offen offset:0 sc1 lds
  v_add_lshl_u32 v251, v12, s48, 7
  v_mfma_f32_16x16x32_bf16 v[92:95], a[100:103], a[28:31], v[92:95]
  ds_read_b64_tr_b16 a[82:83], v196 offset:49152
  v_mfma_f32_16x16x32_bf16 v[96:99], a[100:103], a[32:35], v[96:99]
  ds_read_b128 a[48:51], v207 offset:57344
  v_mfma_f32_16x16x32_bf16 v[96:99], a[96:99], a[12:15], v[96:99]
  ds_read_b64_tr_b16 a[84:85], v196 offset:44032
  v_mfma_f32_16x16x32_bf16 v[96:99], a[92:95], a[72:75], v[96:99]
  s_waitcnt lgkmcnt(6)
  ds_read_b128 a[52:55], v207 offset:58368
  v_add_u32 v251, 98304, v251
  v_mfma_f32_16x16x32_bf16 v[112:115], a[104:107], a[72:75], v[112:115]
  buffer_load_dwordx4 v205, s[36:39], s62 offen offset:1024 sc1 lds
  s_add_u32 m0, s65, 128000
  v_mfma_f32_16x16x32_bf16 v[112:115], a[108:111], a[12:15], v[112:115]
  ds_read_b128 a[56:59], v210 offset:63488
  v_and_b32 v12, 7, v10
  v_mfma_f32_16x16x32_bf16 v[112:115], a[112:115], a[32:35], v[112:115]
  ds_read_b64_tr_b16 a[86:87], v196 offset:50176
  v_lshlrev_b32 v12, 5, v12
  v_mfma_f32_16x16x32_bf16 v[108:111], a[112:115], a[28:31], v[108:111]
  s_and_b32 s48, s2, 31
  buffer_load_dword v206, s[36:39], s62 offen sc1 lds
  s_mov_b32 s61, 4722688
  v_mfma_f32_16x16x32_bf16 v[108:111], a[108:111], a[8:11], v[108:111]
  s_add_u32 m0, s63, 129024
  ds_read_b64_tr_b16 a[88:89], v196 offset:45056
  v_add_lshl_u32 v12, v12, s48, 7
  v_mfma_f32_16x16x32_bf16 v[108:111], a[104:107], a[68:71], v[108:111]
  ds_read_b64_tr_b16 a[90:91], v196 offset:51200
  v_cmp_gt_u32 vcc, 32, v10
  v_mfma_f32_16x16x32_bf16 v[104:107], a[104:107], a[64:67], v[104:107]
  s_nop 1
  buffer_load_dwordx4 v202, s[8:11], s61 offen offset:0 lds
  v_cndmask_b32 v251, v12, v251, vcc
  v_mfma_f32_16x16x32_bf16 v[104:107], a[108:111], a[4:7], v[104:107]
  ds_read_b64_tr_b16 a[92:93], v197 offset:43008
  v_mfma_f32_16x16x32_bf16 v[104:107], a[112:115], a[24:27], v[104:107]
  v_mfma_f32_16x16x32_bf16 v[100:103], a[112:115], a[20:23], v[100:103]
  buffer_load_dwordx4 v203, s[8:11], s61 offen offset:1024 lds
  v_mfma_f32_16x16x32_bf16 v[100:103], a[108:111], a[0:3], v[100:103]
  ds_read_b64_tr_b16 a[94:95], v197 offset:49152
  v_mfma_f32_16x16x32_bf16 v[100:103], a[104:107], a[60:63], v[100:103]
  s_waitcnt lgkmcnt(2)
  ds_read_b64_tr_b16 a[96:97], v197 offset:44032
  v_mfma_f32_16x16x32_bf16 v[20:23], a[80:83], a[0:3], v[20:23]
  v_mfma_f32_16x16x32_bf16 v[20:23], a[84:87], a[20:23], v[20:23]
  buffer_load_dwordx4 v204, s[8:11], s61 offen offset:2048 lds
  v_mfma_f32_16x16x32_bf16 v[20:23], a[88:91], a[40:43], v[20:23]
  s_waitcnt vmcnt(15)
  s_barrier
  ds_read_b64_tr_b16 a[98:99], v197 offset:50176
  v_mfma_f32_16x16x32_bf16 v[24:27], a[88:91], a[44:47], v[24:27]
  s_mov_b32 s62, 53248
  s_add_u32 m0, s64, 141312
  ds_read_b64_tr_b16 a[100:101], v197 offset:45056
  v_mfma_f32_16x16x32_bf16 v[24:27], a[84:87], a[24:27], v[24:27]
  v_mfma_f32_16x16x32_bf16 v[24:27], a[80:83], a[4:7], v[24:27]
  buffer_load_dwordx4 v205, s[36:39], s62 offen offset:0 sc1 lds
  v_mfma_f32_16x16x32_bf16 v[28:31], a[80:83], a[8:11], v[28:31]
  ds_read_b64_tr_b16 a[102:103], v197 offset:51200
  v_mfma_f32_16x16x32_bf16 v[28:31], a[84:87], a[28:31], v[28:31]
  ds_read_b128 a[60:63], v208 offset:12288
  v_mfma_f32_16x16x32_bf16 v[28:31], a[88:91], a[48:51], v[28:31]
  ds_read_b64_tr_b16 a[104:105], v198 offset:0
  v_mfma_f32_16x16x32_bf16 v[32:35], a[88:91], a[52:55], v[32:35]
  ds_read_b128 a[64:67], v208 offset:13312
  v_mfma_f32_16x16x32_bf16 v[32:35], a[84:87], a[32:35], v[32:35]
  buffer_load_dwordx4 v205, s[36:39], s62 offen offset:1024 sc1 lds
  s_add_u32 m0, s65, 149504
  v_mfma_f32_16x16x32_bf16 v[32:35], a[80:83], a[12:15], v[32:35]
  ds_read_b64_tr_b16 a[106:107], v198 offset:6144
  v_mfma_f32_16x16x32_bf16 v[116:119], a[80:83], a[16:19], v[116:119]
  ds_read_b128 a[68:71], v208 offset:14336
  v_mfma_f32_16x16x32_bf16 v[116:119], a[84:87], a[36:39], v[116:119]
  ds_read_b64_tr_b16 a[108:109], v198 offset:1024
  v_mfma_f32_16x16x32_bf16 v[116:119], a[88:91], a[56:59], v[116:119]
  s_waitcnt lgkmcnt(6)
  ds_read_b128 a[72:75], v208 offset:15360
  v_mfma_f32_16x16x32_bf16 v[48:51], a[92:95], a[12:15], v[48:51]
  buffer_load_dword v206, s[36:39], s62 offen sc1 lds
  s_mov_b32 s61, 4915200
  v_mfma_f32_16x16x32_bf16 v[48:51], a[96:99], a[32:35], v[48:51]
  s_add_u32 m0, s63, 0
  ds_read_b128 a[76:79], v211 offset:20480
  v_mfma_f32_16x16x32_bf16 v[48:51], a[100:103], a[52:55], v[48:51]
  ds_read_b64_tr_b16 a[110:111], v198 offset:7168
  v_mfma_f32_16x16x32_bf16 v[44:47], a[100:103], a[48:51], v[44:47]
  buffer_load_dwordx4 v202, s[8:11], s61 offen offset:0 lds
  v_mfma_f32_16x16x32_bf16 v[44:47], a[96:99], a[28:31], v[44:47]
  ds_read_b64_tr_b16 a[112:113], v198 offset:2048
  v_mfma_f32_16x16x32_bf16 v[44:47], a[92:95], a[8:11], v[44:47]
  ds_read_b64_tr_b16 a[114:115], v198 offset:8192
  v_mfma_f32_16x16x32_bf16 v[40:43], a[92:95], a[4:7], v[40:43]
  buffer_load_dwordx4 v203, s[8:11], s61 offen offset:1024 lds
  v_mfma_f32_16x16x32_bf16 v[40:43], a[96:99], a[24:27], v[40:43]
  ds_read_b64_tr_b16 a[80:81], v199 offset:0
  v_mfma_f32_16x16x32_bf16 v[40:43], a[100:103], a[44:47], v[40:43]
  v_mfma_f32_16x16x32_bf16 v[36:39], a[100:103], a[40:43], v[36:39]
  buffer_load_dwordx4 v204, s[8:11], s61 offen offset:2048 lds
  v_mfma_f32_16x16x32_bf16 v[36:39], a[96:99], a[20:23], v[36:39]
  s_mov_b32 s62, 55296
  ds_read_b64_tr_b16 a[82:83], v199 offset:6144
  s_add_u32 m0, s64, 12288
  v_mfma_f32_16x16x32_bf16 v[36:39], a[92:95], a[0:3], v[36:39]
  s_waitcnt lgkmcnt(2)
  ds_read_b64_tr_b16 a[84:85], v199 offset:1024
  v_mfma_f32_16x16x32_bf16 v[52:55], a[20:23], a[104:107], v[52:55]
  v_mfma_f32_16x16x32_bf16 v[52:55], a[40:43], a[108:111], v[52:55]
  buffer_load_dwordx4 v205, s[36:39], s62 offen offset:0 sc1 lds
  v_mfma_f32_16x16x32_bf16 v[52:55], a[60:63], a[112:115], v[52:55]
  s_waitcnt vmcnt(10)
  s_barrier
  ds_read_b64_tr_b16 a[86:87], v199 offset:7168
  v_mfma_f32_16x16x32_bf16 v[56:59], a[64:67], a[112:115], v[56:59]
  ds_read_b64_tr_b16 a[88:89], v199 offset:2048
  v_mfma_f32_16x16x32_bf16 v[56:59], a[44:47], a[108:111], v[56:59]
  buffer_load_dwordx4 v205, s[36:39], s62 offen offset:1024 sc1 lds
  v_mfma_f32_16x16x32_bf16 v[56:59], a[24:27], a[104:107], v[56:59]
  s_add_u32 m0, s65, 20480
  ds_read_b64_tr_b16 a[90:91], v199 offset:8192
  v_mfma_f32_16x16x32_bf16 v[60:63], a[28:31], a[104:107], v[60:63]
  ds_read_b128 a[0:3], v208 offset:33792
  v_mfma_f32_16x16x32_bf16 v[60:63], a[48:51], a[108:111], v[60:63]
  ds_read_b64_tr_b16 a[92:93], v198 offset:21504
  v_mfma_f32_16x16x32_bf16 v[60:63], a[68:71], a[112:115], v[60:63]
  ds_read_b128 a[4:7], v208 offset:34816
  v_mfma_f32_16x16x32_bf16 v[64:67], a[72:75], a[112:115], v[64:67]
  buffer_load_dword v206, s[36:39], s62 offen sc1 lds
  s_mov_b32 s61, 5113856
  v_mfma_f32_16x16x32_bf16 v[64:67], a[52:55], a[108:111], v[64:67]
  s_add_u32 m0, s63, 21504
  ds_read_b64_tr_b16 a[94:95], v198 offset:27648
  v_mfma_f32_16x16x32_bf16 v[64:67], a[32:35], a[104:107], v[64:67]
  ds_read_b128 a[8:11], v208 offset:35840
  v_mfma_f32_16x16x32_bf16 v[120:123], a[36:39], a[104:107], v[120:123]
  ds_read_b64_tr_b16 a[96:97], v198 offset:22528
  v_mfma_f32_16x16x32_bf16 v[120:123], a[56:59], a[108:111], v[120:123]
  ds_read_b128 a[12:15], v208 offset:36864
  v_mfma_f32_16x16x32_bf16 v[120:123], a[76:79], a[112:115], v[120:123]
  s_waitcnt lgkmcnt(7)
  buffer_load_dwordx4 v202, s[8:11], s61 offen offset:0 lds
  v_mfma_f32_16x16x32_bf16 v[80:83], a[32:35], a[80:83], v[80:83]
  ds_read_b64_tr_b16 a[98:99], v198 offset:28672
  v_mfma_f32_16x16x32_bf16 v[80:83], a[52:55], a[84:87], v[80:83]
  ds_read_b128 a[16:19], v211 offset:41984
  v_mfma_f32_16x16x32_bf16 v[80:83], a[72:75], a[88:91], v[80:83]
  ds_read_b64_tr_b16 a[100:101], v198 offset:23552
  v_mfma_f32_16x16x32_bf16 v[76:79], a[68:71], a[88:91], v[76:79]
  buffer_load_dwordx4 v203, s[8:11], s61 offen offset:1024 lds
  v_mfma_f32_16x16x32_bf16 v[76:79], a[48:51], a[84:87], v[76:79]
  ds_read_b64_tr_b16 a[102:103], v198 offset:29696
  v_mfma_f32_16x16x32_bf16 v[76:79], a[28:31], a[80:83], v[76:79]
  ds_read_b64_tr_b16 a[104:105], v199 offset:21504
  v_mfma_f32_16x16x32_bf16 v[72:75], a[24:27], a[80:83], v[72:75]
  buffer_load_dwordx4 v204, s[8:11], s61 offen offset:2048 lds
  s_mov_b32 s62, 57344
  v_mfma_f32_16x16x32_bf16 v[72:75], a[44:47], a[84:87], v[72:75]
  s_add_u32 m0, s64, 33792
  ds_read_b64_tr_b16 a[106:107], v199 offset:27648
  v_mfma_f32_16x16x32_bf16 v[72:75], a[64:67], a[88:91], v[72:75]
  s_lshr_b32 s68, s2, 3
  s_lshl2_add_u32 s68, s68, s44
  s_bfe_u32 s69, s2, 0x20001
  v_mfma_f32_16x16x32_bf16 v[68:71], a[60:63], a[88:91], v[68:71]
  s_lshl_b32 s69, s69, 7
  s_add_u32 s69, s69, s68
  s_lshl_b32 s69, s69, 13
  v_mfma_f32_16x16x32_bf16 v[68:71], a[40:43], a[84:87], v[68:71]
  s_lshl_b32 s68, s68, 14
  s_bitcmp1_b32 s2, 0
  s_cselect_b32 s68, s68, 1073741824
Ha0_1:
  s_cbranch_execz Ha0_2
  v_mfma_f32_16x16x32_bf16 v[68:71], a[20:23], a[80:83], v[68:71]
  s_waitcnt lgkmcnt(2)
  s_cselect_b32 s69, s69, 1073741824
  ds_read_b64_tr_b16 a[108:109], v199 offset:22528
  v_mfma_f32_16x16x32_bf16 v[84:87], a[92:95], a[40:43], v[84:87]
  buffer_load_dwordx4 v205, s[36:39], s62 offen offset:0 sc1 lds
  v_and_b32 v214, 15, v10
  v_mfma_f32_16x16x32_bf16 v[84:87], a[96:99], a[60:63], v[84:87]
  ds_read_b64_tr_b16 a[110:111], v199 offset:28672
  v_lshlrev_b32 v214, 10, v214
  v_mfma_f32_16x16x32_bf16 v[84:87], a[100:103], a[0:3], v[84:87]
  ds_read_b64_tr_b16 a[112:113], v199 offset:23552
  v_mfma_f32_16x16x32_bf16 v[88:91], a[100:103], a[4:7], v[88:91]
  buffer_load_dwordx4 v205, s[36:39], s62 offen offset:1024 sc1 lds
  s_add_u32 m0, s65, 41984
  v_mfma_f32_16x16x32_bf16 v[88:91], a[96:99], a[64:67], v[88:91]
  ds_read_b64_tr_b16 a[114:115], v199 offset:29696
  v_mfma_f32_16x16x32_bf16 v[88:91], a[92:95], a[44:47], v[88:91]
  ds_read_b128 a[20:23], v208 offset:55296
  v_mfma_f32_16x16x32_bf16 v[92:95], a[92:95], a[48:51], v[92:95]
  buffer_load_dword v206, s[36:39], s62 offen sc1 lds
  s_mov_b32 s61, 5312512
  v_mfma_f32_16x16x32_bf16 v[92:95], a[96:99], a[68:71], v[92:95]
  s_add_u32 m0, s63, 43008
  ds_read_b64_tr_b16 a[80:81], v198 offset:43008
  v_mfma_f32_16x16x32_bf16 v[92:95], a[100:103], a[8:11], v[92:95]
  ds_read_b128 a[24:27], v208 offset:56320
  v_mfma_f32_16x16x32_bf16 v[96:99], a[100:103], a[12:15], v[96:99]
  ds_read_b64_tr_b16 a[82:83], v198 offset:49152
  v_mfma_f32_16x16x32_bf16 v[96:99], a[96:99], a[72:75], v[96:99]
  ds_read_b128 a[28:31], v208 offset:57344
  v_mfma_f32_16x16x32_bf16 v[96:99], a[92:95], a[52:55], v[96:99]
  s_waitcnt lgkmcnt(5)
  buffer_load_dwordx4 v202, s[8:11], s61 offen offset:0 lds
  v_mfma_f32_16x16x32_bf16 v[112:115], a[104:107], a[52:55], v[112:115]
  ds_read_b64_tr_b16 a[84:85], v198 offset:44032
  v_mfma_f32_16x16x32_bf16 v[112:115], a[108:111], a[72:75], v[112:115]
  ds_read_b128 a[32:35], v208 offset:58368
  v_mfma_f32_16x16x32_bf16 v[112:115], a[112:115], a[12:15], v[112:115]
  ds_read_b128 a[36:39], v211 offset:63488
  v_mfma_f32_16x16x32_bf16 v[108:111], a[112:115], a[8:11], v[108:111]
  ds_read_b64_tr_b16 a[86:87], v198 offset:50176
  v_mfma_f32_16x16x32_bf16 v[108:111], a[108:111], a[68:71], v[108:111]
  buffer_load_dwordx4 v203, s[8:11], s61 offen offset:1024 lds
  v_mfma_f32_16x16x32_bf16 v[108:111], a[104:107], a[48:51], v[108:111]
  ds_read_b64_tr_b16 a[88:89], v198 offset:45056
  v_mfma_f32_16x16x32_bf16 v[104:107], a[104:107], a[44:47], v[104:107]
  ds_read_b64_tr_b16 a[90:91], v198 offset:51200
  v_mfma_f32_16x16x32_bf16 v[104:107], a[108:111], a[64:67], v[104:107]
  buffer_load_dwordx4 v204, s[8:11], s61 offen offset:2048 lds
  s_mov_b32 s62, 59392
  v_mfma_f32_16x16x32_bf16 v[104:107], a[112:115], a[4:7], v[104:107]
  s_add_u32 m0, s64, 55296
  ds_read_b64_tr_b16 a[92:93], v199 offset:43008
  v_mfma_f32_16x16x32_bf16 v[100:103], a[112:115], a[0:3], v[100:103]
  ds_read_b64_tr_b16 a[94:95], v199 offset:49152
  v_mfma_f32_16x16x32_bf16 v[100:103], a[108:111], a[60:63], v[100:103]
  buffer_load_dwordx4 v205, s[36:39], s62 offen offset:0 sc1 lds
  v_mfma_f32_16x16x32_bf16 v[100:103], a[104:107], a[40:43], v[100:103]
  s_waitcnt lgkmcnt(2)
  ds_read_b64_tr_b16 a[96:97], v199 offset:44032
  v_mfma_f32_16x16x32_bf16 v[20:23], a[80:83], a[60:63], v[20:23]
  v_mfma_f32_16x16x32_bf16 v[20:23], a[84:87], a[0:3], v[20:23]
  buffer_load_dwordx4 v205, s[36:39], s62 offen offset:1024 sc1 lds
  s_add_u32 m0, s65, 63488
  v_mfma_f32_16x16x32_bf16 v[20:23], a[88:91], a[20:23], v[20:23]
  s_waitcnt vmcnt(11)
  s_barrier
  ds_read_b64_tr_b16 a[98:99], v199 offset:50176
  v_mfma_f32_16x16x32_bf16 v[24:27], a[88:91], a[24:27], v[24:27]
  ds_read_b64_tr_b16 a[100:101], v199 offset:45056
  v_mfma_f32_16x16x32_bf16 v[24:27], a[84:87], a[4:7], v[24:27]
  buffer_load_dword a252, v214, s[12:15], s68 offen offset:384
  v_and_b32 v214, 0x1fff, v214
  v_mfma_f32_16x16x32_bf16 v[24:27], a[80:83], a[64:67], v[24:27]
  ds_read_b64_tr_b16 a[102:103], v199 offset:51200
  v_mfma_f32_16x16x32_bf16 v[28:31], a[80:83], a[68:71], v[28:31]
  ds_read_b128 a[40:43], v209 offset:12288
  v_mfma_f32_16x16x32_bf16 v[28:31], a[84:87], a[8:11], v[28:31]
  buffer_load_dword v206, s[36:39], s62 offen sc1 lds
  s_mov_b32 s61, 5505024
  v_mfma_f32_16x16x32_bf16 v[28:31], a[88:91], a[28:31], v[28:31]
  s_add_u32 m0, s63, 64512
  ds_read_b64_tr_b16 a[104:105], v200 offset:0
  v_mfma_f32_16x16x32_bf16 v[32:35], a[88:91], a[32:35], v[32:35]
  ds_read_b128 a[44:47], v209 offset:13312
  v_mfma_f32_16x16x32_bf16 v[32:35], a[84:87], a[12:15], v[32:35]
  buffer_load_dword a252, v214, s[4:7], s69 offen offset:384
  v_mfma_f32_16x16x32_bf16 v[32:35], a[80:83], a[72:75], v[32:35]
  ds_read_b64_tr_b16 a[106:107], v200 offset:6144
  v_mfma_f32_16x16x32_bf16 v[116:119], a[80:83], a[76:79], v[116:119]
  ds_read_b128 a[48:51], v209 offset:14336
  v_mfma_f32_16x16x32_bf16 v[116:119], a[84:87], a[16:19], v[116:119]
  buffer_load_dwordx4 v202, s[8:11], s61 offen offset:0 lds
  v_mfma_f32_16x16x32_bf16 v[116:119], a[88:91], a[36:39], v[116:119]
  s_waitcnt lgkmcnt(5)
  ds_read_b64_tr_b16 a[108:109], v200 offset:1024
  v_mfma_f32_16x16x32_bf16 v[48:51], a[92:95], a[72:75], v[48:51]
  ds_read_b128 a[52:55], v209 offset:15360
  v_mfma_f32_16x16x32_bf16 v[48:51], a[96:99], a[12:15], v[48:51]
  buffer_load_dwordx4 v203, s[8:11], s61 offen offset:1024 lds
  v_mfma_f32_16x16x32_bf16 v[48:51], a[100:103], a[32:35], v[48:51]
  ds_read_b128 a[56:59], v212 offset:20480
  v_mfma_f32_16x16x32_bf16 v[44:47], a[100:103], a[28:31], v[44:47]
  ds_read_b64_tr_b16 a[110:111], v200 offset:7168
  v_mfma_f32_16x16x32_bf16 v[44:47], a[96:99], a[8:11], v[44:47]
  buffer_load_dwordx4 v204, s[8:11], s61 offen offset:2048 lds
  s_mov_b32 s62, 61440
  v_mfma_f32_16x16x32_bf16 v[44:47], a[92:95], a[68:71], v[44:47]
  s_add_u32 m0, s64, 76800
  ds_read_b64_tr_b16 a[112:113], v200 offset:2048
  v_mfma_f32_16x16x32_bf16 v[40:43], a[92:95], a[64:67], v[40:43]
  ds_read_b64_tr_b16 a[114:115], v200 offset:8192
  v_mfma_f32_16x16x32_bf16 v[40:43], a[96:99], a[4:7], v[40:43]
  buffer_load_dwordx4 v205, s[36:39], s62 offen offset:0 sc1 lds
  v_mfma_f32_16x16x32_bf16 v[40:43], a[100:103], a[24:27], v[40:43]
  ds_read_b64_tr_b16 a[80:81], v201 offset:0
  v_mfma_f32_16x16x32_bf16 v[36:39], a[100:103], a[20:23], v[36:39]
  ds_read_b64_tr_b16 a[82:83], v201 offset:6144
  v_mfma_f32_16x16x32_bf16 v[36:39], a[96:99], a[0:3], v[36:39]
  buffer_load_dwordx4 v205, s[36:39], s62 offen offset:1024 sc1 lds
  s_add_u32 m0, s65, 84992
  v_mfma_f32_16x16x32_bf16 v[36:39], a[92:95], a[60:63], v[36:39]
  s_waitcnt lgkmcnt(2)
  ds_read_b64_tr_b16 a[84:85], v201 offset:1024
  v_mfma_f32_16x16x32_bf16 v[52:55], a[0:3], a[104:107], v[52:55]
  v_mfma_f32_16x16x32_bf16 v[52:55], a[20:23], a[108:111], v[52:55]
  buffer_load_dword v206, s[36:39], s62 offen sc1 lds
  s_mov_b32 s61, 5703680
  v_mfma_f32_16x16x32_bf16 v[52:55], a[40:43], a[112:115], v[52:55]
  s_add_u32 m0, s63, 86016
  ds_read_b64_tr_b16 a[86:87], v201 offset:7168
  v_mfma_f32_16x16x32_bf16 v[56:59], a[44:47], a[112:115], v[56:59]
  ds_read_b64_tr_b16 a[88:89], v201 offset:2048
  v_mfma_f32_16x16x32_bf16 v[56:59], a[24:27], a[108:111], v[56:59]
  buffer_load_dwordx4 v202, s[8:11], s61 offen offset:0 lds
  v_mfma_f32_16x16x32_bf16 v[56:59], a[4:7], a[104:107], v[56:59]
  ds_read_b64_tr_b16 a[90:91], v201 offset:8192
  v_mfma_f32_16x16x32_bf16 v[60:63], a[8:11], a[104:107], v[60:63]
  ds_read_b128 a[60:63], v207 offset:12288
  v_mfma_f32_16x16x32_bf16 v[60:63], a[28:31], a[108:111], v[60:63]
  buffer_load_dwordx4 v203, s[8:11], s61 offen offset:1024 lds
  v_mfma_f32_16x16x32_bf16 v[60:63], a[48:51], a[112:115], v[60:63]
  ds_read_b64_tr_b16 a[92:93], v196 offset:0
  v_mfma_f32_16x16x32_bf16 v[64:67], a[52:55], a[112:115], v[64:67]
  ds_read_b128 a[64:67], v207 offset:13312
  v_mfma_f32_16x16x32_bf16 v[64:67], a[32:35], a[108:111], v[64:67]
  ds_read_b64_tr_b16 a[94:95], v196 offset:6144
  v_mfma_f32_16x16x32_bf16 v[64:67], a[12:15], a[104:107], v[64:67]
  ds_read_b128 a[68:71], v207 offset:14336
  v_mfma_f32_16x16x32_bf16 v[120:123], a[16:19], a[104:107], v[120:123]
  buffer_load_dwordx4 v204, s[8:11], s61 offen offset:2048 lds
  s_mov_b32 s62, 63488
  v_mfma_f32_16x16x32_bf16 v[120:123], a[36:39], a[108:111], v[120:123]
  s_add_u32 m0, s64, 98304
  ds_read_b64_tr_b16 a[96:97], v196 offset:1024
  v_mfma_f32_16x16x32_bf16 v[120:123], a[56:59], a[112:115], v[120:123]
  s_waitcnt lgkmcnt(6)
  ds_read_b128 a[72:75], v207 offset:15360
  v_mfma_f32_16x16x32_bf16 v[80:83], a[12:15], a[80:83], v[80:83]
  ds_read_b64_tr_b16 a[98:99], v196 offset:7168
  v_mfma_f32_16x16x32_bf16 v[80:83], a[32:35], a[84:87], v[80:83]
  ds_read_b128 a[76:79], v210 offset:20480
  v_mfma_f32_16x16x32_bf16 v[80:83], a[52:55], a[88:91], v[80:83]
  buffer_load_dwordx4 v205, s[36:39], s62 offen offset:0 sc1 lds
  v_mfma_f32_16x16x32_bf16 v[76:79], a[48:51], a[88:91], v[76:79]
  ds_read_b64_tr_b16 a[100:101], v196 offset:2048
  v_mfma_f32_16x16x32_bf16 v[76:79], a[28:31], a[84:87], v[76:79]
  ds_read_b64_tr_b16 a[102:103], v196 offset:8192
  v_mfma_f32_16x16x32_bf16 v[76:79], a[8:11], a[80:83], v[76:79]
  buffer_load_dwordx4 v205, s[36:39], s62 offen offset:1024 sc1 lds
  s_add_u32 m0, s65, 106496
  v_mfma_f32_16x16x32_bf16 v[72:75], a[4:7], a[80:83], v[72:75]
  ds_read_b64_tr_b16 a[104:105], v197 offset:0
  v_mfma_f32_16x16x32_bf16 v[72:75], a[24:27], a[84:87], v[72:75]
  ds_read_b64_tr_b16 a[106:107], v197 offset:6144
  v_mfma_f32_16x16x32_bf16 v[72:75], a[44:47], a[88:91], v[72:75]
  buffer_load_dword v206, s[36:39], s62 offen sc1 lds
  v_mfma_f32_16x16x32_bf16 v[68:71], a[40:43], a[88:91], v[68:71]
  ds_read_b64_tr_b16 a[108:109], v197 offset:1024
  v_mfma_f32_16x16x32_bf16 v[68:71], a[20:23], a[84:87], v[68:71]
  s_mov_b32 s61, 5902336
  s_add_u32 m0, s63, 107520
  ds_read_b64_tr_b16 a[110:111], v197 offset:7168
  v_mfma_f32_16x16x32_bf16 v[68:71], a[0:3], a[80:83], v[68:71]
  s_waitcnt vmcnt(13) lgkmcnt(4)
  s_barrier
  v_mfma_f32_16x16x32_bf16 v[84:87], a[92:95], a[20:23], v[84:87]
  ds_read_b64_tr_b16 a[112:113], v197 offset:2048
  v_mfma_f32_16x16x32_bf16 v[84:87], a[96:99], a[40:43], v[84:87]
  buffer_load_dwordx4 v202, s[8:11], s61 offen offset:0 lds
  v_mfma_f32_16x16x32_bf16 v[84:87], a[100:103], a[60:63], v[84:87]
  ds_read_b64_tr_b16 a[114:115], v197 offset:8192
  v_mfma_f32_16x16x32_bf16 v[88:91], a[100:103], a[64:67], v[88:91]
  ds_read_b128 a[0:3], v207 offset:33792
  v_mfma_f32_16x16x32_bf16 v[88:91], a[96:99], a[44:47], v[88:91]
  buffer_load_dwordx4 v203, s[8:11], s61 offen offset:1024 lds
  v_mfma_f32_16x16x32_bf16 v[88:91], a[92:95], a[24:27], v[88:91]
  s_mov_b32 s61, 6094848
  ds_read_b64_tr_b16 a[80:81], v196 offset:21504
  s_add_u32 m0, s63, 129024
  v_mfma_f32_16x16x32_bf16 v[92:95], a[92:95], a[28:31], v[92:95]
  ds_read_b128 a[4:7], v207 offset:34816
  v_mfma_f32_16x16x32_bf16 v[92:95], a[96:99], a[48:51], v[92:95]
  ds_read_b64_tr_b16 a[82:83], v196 offset:27648
  v_mfma_f32_16x16x32_bf16 v[92:95], a[100:103], a[68:71], v[92:95]
  ds_read_b128 a[8:11], v207 offset:35840
  v_mfma_f32_16x16x32_bf16 v[96:99], a[100:103], a[72:75], v[96:99]
  buffer_load_dwordx4 v202, s[8:11], s61 offen offset:0 lds
  s_nop 0
  v_mfma_f32_16x16x32_bf16 v[96:99], a[96:99], a[52:55], v[96:99]
  ds_read_b64_tr_b16 a[84:85], v196 offset:22528
  v_mfma_f32_16x16x32_bf16 v[96:99], a[92:95], a[32:35], v[96:99]
  s_waitcnt lgkmcnt(6)
  ds_read_b128 a[12:15], v207 offset:36864
  v_mfma_f32_16x16x32_bf16 v[112:115], a[104:107], a[32:35], v[112:115]
  ds_read_b128 a[16:19], v210 offset:41984
  v_mfma_f32_16x16x32_bf16 v[112:115], a[108:111], a[52:55], v[112:115]
  ds_read_b64_tr_b16 a[86:87], v196 offset:28672
  v_mfma_f32_16x16x32_bf16 v[112:115], a[112:115], a[72:75], v[112:115]
  buffer_load_dwordx4 v[152:155], v176, s[28:31], s51 offen nt
  s_add_u32 s51, s51, 12288
  v_mfma_f32_16x16x32_bf16 v[108:111], a[112:115], a[68:71], v[108:111]
  ds_read_b64_tr_b16 a[88:89], v196 offset:23552
  v_mfma_f32_16x16x32_bf16 v[108:111], a[108:111], a[48:51], v[108:111]
  ds_read_b64_tr_b16 a[90:91], v196 offset:29696
  v_mfma_f32_16x16x32_bf16 v[108:111], a[104:107], a[28:31], v[108:111]
  buffer_load_dwordx4 v[156:159], v176, s[28:31], s51 offen nt
  s_add_u32 s51, s51, 12288
  v_mfma_f32_16x16x32_bf16 v[104:107], a[104:107], a[24:27], v[104:107]
  v_mfma_f32_16x16x32_bf16 v[104:107], a[108:111], a[44:47], v[104:107]
  ds_read_b64_tr_b16 a[92:93], v197 offset:21504
  v_mfma_f32_16x16x32_bf16 v[104:107], a[112:115], a[64:67], v[104:107]
  buffer_load_dwordx4 v[160:163], v176, s[28:31], s51 offen nt
  s_add_u32 s51, s51, 12288
  v_mfma_f32_16x16x32_bf16 v[100:103], a[112:115], a[60:63], v[100:103]
  ds_read_b64_tr_b16 a[94:95], v197 offset:27648
  v_mfma_f32_16x16x32_bf16 v[100:103], a[108:111], a[40:43], v[100:103]
  v_mfma_f32_16x16x32_bf16 v[100:103], a[104:107], a[20:23], v[100:103]
  s_waitcnt lgkmcnt(2)
  ds_read_b64_tr_b16 a[96:97], v197 offset:22528
  v_mfma_f32_16x16x32_bf16 v[20:23], a[80:83], a[40:43], v[20:23]
  buffer_load_dwordx4 v[164:167], v176, s[28:31], s51 offen nt
  v_lshrrev_b32 v215, 2, v10
  v_mfma_f32_16x16x32_bf16 v[20:23], a[84:87], a[60:63], v[20:23]
  ds_read_b64_tr_b16 a[98:99], v197 offset:28672
  v_min_u32 v215, (XEND-G3S)/4096, v215
  v_mfma_f32_16x16x32_bf16 v[20:23], a[88:91], a[0:3], v[20:23]
  v_and_b32 v213, 3, v10
  v_lshlrev_b32 v213, 7, v213
  v_mfma_f32_16x16x32_bf16 v[24:27], a[88:91], a[4:7], v[24:27]
  ds_read_b64_tr_b16 a[100:101], v197 offset:23552
  v_lshl_add_u32 v215, v215, 12, v213
  v_mfma_f32_16x16x32_bf16 v[24:27], a[84:87], a[64:67], v[24:27]
  s_add_u32 s94, s92, AL-adaLN_cond__sliding_local_dilated__swiglu_ffn__prompt_kernel+((G3S-AL+4095)/4096)*4096
  s_addc_u32 s95, s93, 0
  global_load_dword a252, v215, s[94:95]
  v_mfma_f32_16x16x32_bf16 v[24:27], a[80:83], a[44:47], v[24:27]
  s_lshl_b32 s66, s2, 7
  s_add_u32 s66, s66, 5242880
  s_cmp_eq_u32 s44, 2
  v_mfma_f32_16x16x32_bf16 v[28:31], a[80:83], a[48:51], v[28:31]
  s_cselect_b32 s66, s66, 1073741824
  ds_read_b64_tr_b16 a[102:103], v197 offset:29696
  v_and_b32 v215, 7, v10
  v_mfma_f32_16x16x32_bf16 v[28:31], a[84:87], a[68:71], v[28:31]
  ds_read_b128 a[20:23], v207 offset:55296
  v_lshlrev_b32 v215, 15, v215
  v_mfma_f32_16x16x32_bf16 v[28:31], a[88:91], a[8:11], v[28:31]
  ds_read_b64_tr_b16 a[104:105], v196 offset:43008
  v_mfma_f32_16x16x32_bf16 v[32:35], a[88:91], a[12:15], v[32:35]
  ds_read_b128 a[24:27], v207 offset:56320
  v_mfma_f32_16x16x32_bf16 v[32:35], a[84:87], a[72:75], v[32:35]
  buffer_load_dword a252, v215, s[36:39], s66 offen sc1
  s_and_b32 s66, s44, 1
  v_mfma_f32_16x16x32_bf16 v[32:35], a[80:83], a[52:55], v[32:35]
  s_lshl1_add_u32 s66, s2, s66
  s_mul_i32 s66, s66, 35
  ds_read_b64_tr_b16 a[106:107], v196 offset:49152
  v_mfma_f32_16x16x32_bf16 v[116:119], a[80:83], a[56:59], v[116:119]
  ds_read_b128 a[28:31], v207 offset:57344
  v_min_u32 v215, 34, v10
  v_mfma_f32_16x16x32_bf16 v[116:119], a[84:87], a[76:79], v[116:119]
  ds_read_b64_tr_b16 a[108:109], v196 offset:44032
  v_add_u32 v215, s66, v215
  v_mfma_f32_16x16x32_bf16 v[116:119], a[88:91], a[16:19], v[116:119]
  s_waitcnt lgkmcnt(6)
  ds_read_b128 a[32:35], v207 offset:58368
  v_lshrrev_b32 v213, 8, v215
  v_mfma_f32_16x16x32_bf16 v[48:51], a[92:95], a[52:55], v[48:51]
  ds_read_b128 a[36:39], v210 offset:63488
  v_mul_u32_u24 v213, 9363, v213
  v_mfma_f32_16x16x32_bf16 v[48:51], a[96:99], a[72:75], v[48:51]
  ds_read_b64_tr_b16 a[110:111], v196 offset:50176
  v_lshrrev_b32 v213, 16, v213
  v_mfma_f32_16x16x32_bf16 v[48:51], a[100:103], a[12:15], v[48:51]
  ds_read_b64_tr_b16 a[112:113], v196 offset:45056
  v_mul_u32_u24 v213, 1792, v213
  v_mfma_f32_16x16x32_bf16 v[44:47], a[100:103], a[8:11], v[44:47]
  ds_read_b64_tr_b16 a[114:115], v196 offset:51200
  v_add_lshl_u32 v215, v215, v213, 7
  v_mfma_f32_16x16x32_bf16 v[44:47], a[96:99], a[68:71], v[44:47]
  buffer_load_dword a252, v215, s[16:19], 0 offen
  v_mfma_f32_16x16x32_bf16 v[44:47], a[92:95], a[48:51], v[44:47]
  v_mfma_f32_16x16x32_bf16 v[40:43], a[92:95], a[44:47], v[40:43]
  v_mfma_f32_16x16x32_bf16 v[40:43], a[96:99], a[64:67], v[40:43]
  ds_read_b64_tr_b16 a[80:81], v197 offset:43008
  v_mfma_f32_16x16x32_bf16 v[40:43], a[100:103], a[4:7], v[40:43]
  v_mfma_f32_16x16x32_bf16 v[36:39], a[100:103], a[0:3], v[36:39]
  ds_read_b64_tr_b16 a[82:83], v197 offset:49152
  v_mfma_f32_16x16x32_bf16 v[36:39], a[96:99], a[60:63], v[36:39]
  v_mfma_f32_16x16x32_bf16 v[36:39], a[92:95], a[40:43], v[36:39]
  s_waitcnt lgkmcnt(2)
  ds_read_b64_tr_b16 a[84:85], v197 offset:44032
  v_mfma_f32_16x16x32_bf16 v[52:55], a[60:63], a[104:107], v[52:55]
  v_mfma_f32_16x16x32_bf16 v[52:55], a[0:3], a[108:111], v[52:55]
  ds_read_b64_tr_b16 a[86:87], v197 offset:50176
  v_mfma_f32_16x16x32_bf16 v[52:55], a[20:23], a[112:115], v[52:55]
  s_waitcnt vmcnt(10)
  s_barrier
  v_mfma_f32_16x16x32_bf16 v[56:59], a[24:27], a[112:115], v[56:59]
  ds_read_b64_tr_b16 a[88:89], v197 offset:45056
  v_mfma_f32_16x16x32_bf16 v[56:59], a[4:7], a[108:111], v[56:59]
  v_mfma_f32_16x16x32_bf16 v[56:59], a[64:67], a[104:107], v[56:59]
  ds_read_b64_tr_b16 a[90:91], v197 offset:51200
  v_mfma_f32_16x16x32_bf16 v[60:63], a[68:71], a[104:107], v[60:63]
  ds_read_b128 a[40:43], v208 offset:12288
  v_mfma_f32_16x16x32_bf16 v[60:63], a[8:11], a[108:111], v[60:63]
  ds_read_b64_tr_b16 a[92:93], v198 offset:0
  v_mfma_f32_16x16x32_bf16 v[60:63], a[28:31], a[112:115], v[60:63]
  ds_read_b128 a[44:47], v208 offset:13312
  v_mfma_f32_16x16x32_bf16 v[64:67], a[32:35], a[112:115], v[64:67]
  ds_read_b64_tr_b16 a[94:95], v198 offset:6144
  v_mfma_f32_16x16x32_bf16 v[64:67], a[12:15], a[108:111], v[64:67]
  ds_read_b128 a[48:51], v208 offset:14336
  v_mfma_f32_16x16x32_bf16 v[64:67], a[72:75], a[104:107], v[64:67]
  ds_read_b64_tr_b16 a[96:97], v198 offset:1024
  v_mfma_f32_16x16x32_bf16 v[120:123], a[76:79], a[104:107], v[120:123]
  ds_read_b128 a[52:55], v208 offset:15360
  v_mfma_f32_16x16x32_bf16 v[120:123], a[16:19], a[108:111], v[120:123]
  ds_read_b64_tr_b16 a[98:99], v198 offset:7168
  v_mfma_f32_16x16x32_bf16 v[120:123], a[36:39], a[112:115], v[120:123]
  s_waitcnt lgkmcnt(8)
  ds_read_b128 a[56:59], v211 offset:20480
  v_mfma_f32_16x16x32_bf16 v[80:83], a[72:75], a[80:83], v[80:83]
  ds_read_b64_tr_b16 a[100:101], v198 offset:2048
  v_mfma_f32_16x16x32_bf16 v[80:83], a[12:15], a[84:87], v[80:83]
  v_mfma_f32_16x16x32_bf16 v[80:83], a[32:35], a[88:91], v[80:83]
  ds_read_b64_tr_b16 a[102:103], v198 offset:8192
  v_mfma_f32_16x16x32_bf16 v[76:79], a[28:31], a[88:91], v[76:79]
  v_mfma_f32_16x16x32_bf16 v[76:79], a[8:11], a[84:87], v[76:79]
  ds_read_b64_tr_b16 a[104:105], v199 offset:0
  v_mfma_f32_16x16x32_bf16 v[76:79], a[68:71], a[80:83], v[76:79]
  v_mfma_f32_16x16x32_bf16 v[72:75], a[64:67], a[80:83], v[72:75]
  ds_read_b64_tr_b16 a[106:107], v199 offset:6144
  v_mfma_f32_16x16x32_bf16 v[72:75], a[4:7], a[84:87], v[72:75]
  v_mfma_f32_16x16x32_bf16 v[72:75], a[24:27], a[88:91], v[72:75]
  ds_read_b64_tr_b16 a[108:109], v199 offset:1024
  v_mfma_f32_16x16x32_bf16 v[68:71], a[20:23], a[88:91], v[68:71]
  v_mfma_f32_16x16x32_bf16 v[68:71], a[0:3], a[84:87], v[68:71]
  ds_read_b64_tr_b16 a[110:111], v199 offset:7168
  v_mfma_f32_16x16x32_bf16 v[68:71], a[60:63], a[80:83], v[68:71]
  s_waitcnt lgkmcnt(4)
  v_mfma_f32_16x16x32_bf16 v[84:87], a[92:95], a[0:3], v[84:87]
  ds_read_b64_tr_b16 a[112:113], v199 offset:2048
  v_mfma_f32_16x16x32_bf16 v[84:87], a[96:99], a[20:23], v[84:87]
  v_mfma_f32_16x16x32_bf16 v[84:87], a[100:103], a[40:43], v[84:87]
  ds_read_b64_tr_b16 a[114:115], v199 offset:8192
  v_mfma_f32_16x16x32_bf16 v[88:91], a[100:103], a[44:47], v[88:91]
  ds_read_b128 a[60:63], v208 offset:33792
  v_mfma_f32_16x16x32_bf16 v[88:91], a[96:99], a[24:27], v[88:91]
  ds_read_b64_tr_b16 a[80:81], v198 offset:21504
  v_mfma_f32_16x16x32_bf16 v[88:91], a[92:95], a[4:7], v[88:91]
  ds_read_b128 a[64:67], v208 offset:34816
  v_mfma_f32_16x16x32_bf16 v[92:95], a[92:95], a[8:11], v[92:95]
  ds_read_b64_tr_b16 a[82:83], v198 offset:27648
  v_mfma_f32_16x16x32_bf16 v[92:95], a[96:99], a[28:31], v[92:95]
  ds_read_b128 a[68:71], v208 offset:35840
  v_mfma_f32_16x16x32_bf16 v[92:95], a[100:103], a[48:51], v[92:95]
  ds_read_b64_tr_b16 a[84:85], v198 offset:22528
  v_mfma_f32_16x16x32_bf16 v[96:99], a[100:103], a[52:55], v[96:99]
  ds_read_b128 a[72:75], v208 offset:36864
  v_mfma_f32_16x16x32_bf16 v[96:99], a[96:99], a[32:35], v[96:99]
  ds_read_b128 a[76:79], v211 offset:41984
  v_mfma_f32_16x16x32_bf16 v[96:99], a[92:95], a[12:15], v[96:99]
  s_waitcnt lgkmcnt(8)
  ds_read_b64_tr_b16 a[86:87], v198 offset:28672
  v_mfma_f32_16x16x32_bf16 v[112:115], a[104:107], a[12:15], v[112:115]
  v_mfma_f32_16x16x32_bf16 v[112:115], a[108:111], a[32:35], v[112:115]
  ds_read_b64_tr_b16 a[88:89], v198 offset:23552
  v_mfma_f32_16x16x32_bf16 v[112:115], a[112:115], a[52:55], v[112:115]
  v_mfma_f32_16x16x32_bf16 v[108:111], a[112:115], a[48:51], v[108:111]
  ds_read_b64_tr_b16 a[90:91], v198 offset:29696
  v_mfma_f32_16x16x32_bf16 v[108:111], a[108:111], a[28:31], v[108:111]
  v_mfma_f32_16x16x32_bf16 v[108:111], a[104:107], a[8:11], v[108:111]
  v_mfma_f32_16x16x32_bf16 v[104:107], a[104:107], a[4:7], v[104:107]
  v_mfma_f32_16x16x32_bf16 v[104:107], a[108:111], a[24:27], v[104:107]
  ds_read_b64_tr_b16 a[92:93], v199 offset:21504
  v_mfma_f32_16x16x32_bf16 v[104:107], a[112:115], a[44:47], v[104:107]
  v_mfma_f32_16x16x32_bf16 v[100:103], a[112:115], a[40:43], v[100:103]
  ds_read_b64_tr_b16 a[94:95], v199 offset:27648
  v_mfma_f32_16x16x32_bf16 v[100:103], a[108:111], a[20:23], v[100:103]
  v_mfma_f32_16x16x32_bf16 v[100:103], a[104:107], a[0:3], v[100:103]
  s_waitcnt lgkmcnt(2)
  ds_read_b64_tr_b16 a[96:97], v199 offset:22528
  v_mfma_f32_16x16x32_bf16 v[20:23], a[80:83], a[20:23], v[20:23]
  v_mfma_f32_16x16x32_bf16 v[20:23], a[84:87], a[40:43], v[20:23]
  ds_read_b64_tr_b16 a[98:99], v199 offset:28672
  v_mfma_f32_16x16x32_bf16 v[20:23], a[88:91], a[60:63], v[20:23]
  s_waitcnt vmcnt(7)
  s_barrier
  v_mfma_f32_16x16x32_bf16 v[24:27], a[88:91], a[64:67], v[24:27]
  ds_read_b64_tr_b16 a[100:101], v199 offset:23552
  v_mfma_f32_16x16x32_bf16 v[24:27], a[84:87], a[44:47], v[24:27]
  v_mfma_f32_16x16x32_bf16 v[24:27], a[80:83], a[24:27], v[24:27]
  ds_read_b64_tr_b16 a[102:103], v199 offset:29696
  v_mfma_f32_16x16x32_bf16 v[28:31], a[80:83], a[28:31], v[28:31]
  v_mfma_f32_16x16x32_bf16 v[28:31], a[84:87], a[48:51], v[28:31]
  ds_read_b64_tr_b16 a[104:105], v198 offset:43008
  v_mfma_f32_16x16x32_bf16 v[28:31], a[88:91], a[68:71], v[28:31]
  v_mfma_f32_16x16x32_bf16 v[32:35], a[88:91], a[72:75], v[32:35]
  ds_read_b64_tr_b16 a[106:107], v198 offset:49152
  v_mfma_f32_16x16x32_bf16 v[32:35], a[84:87], a[52:55], v[32:35]
  s_xor_b32 s50, s76, 524288
  s_add_u32 m0, s70, 0
  v_mfma_f32_16x16x32_bf16 v[32:35], a[80:83], a[32:35], v[32:35]
  v_mfma_f32_16x16x32_bf16 v[116:119], a[80:83], a[36:39], v[116:119]
  ds_read_b64_tr_b16 a[108:109], v198 offset:44032
  v_mfma_f32_16x16x32_bf16 v[116:119], a[84:87], a[56:59], v[116:119]
  v_mfma_f32_16x16x32_bf16 v[116:119], a[88:91], a[76:79], v[116:119]
  s_waitcnt lgkmcnt(3)
  buffer_load_dwordx4 v216, s[12:15], s50 offen offset:0 lds
  v_mfma_f32_16x16x32_bf16 v[48:51], a[92:95], a[32:35], v[48:51]
  ds_read_b64_tr_b16 a[110:111], v198 offset:50176
  v_mfma_f32_16x16x32_bf16 v[48:51], a[96:99], a[52:55], v[48:51]
  v_mfma_f32_16x16x32_bf16 v[48:51], a[100:103], a[72:75], v[48:51]
  ds_read_b64_tr_b16 a[112:113], v199 offset:43008
  v_mfma_f32_16x16x32_bf16 v[44:47], a[100:103], a[68:71], v[44:47]
  buffer_load_dwordx4 v217, s[12:15], s50 offen offset:1024 lds
  v_mfma_f32_16x16x32_bf16 v[44:47], a[96:99], a[48:51], v[44:47]
  ds_read_b64_tr_b16 a[114:115], v199 offset:49152
  v_mfma_f32_16x16x32_bf16 v[44:47], a[92:95], a[28:31], v[44:47]
  v_mfma_f32_16x16x32_bf16 v[40:43], a[92:95], a[24:27], v[40:43]
  ds_read_b64_tr_b16 a[80:81], v199 offset:44032
  v_mfma_f32_16x16x32_bf16 v[40:43], a[96:99], a[44:47], v[40:43]
  buffer_load_dwordx4 v218, s[12:15], s50 offen offset:2048 lds
  v_cvt_pk_bf16_f32 v116, v116, v117
  v_mfma_f32_16x16x32_bf16 v[40:43], a[100:103], a[64:67], v[40:43]
  ds_read_b64_tr_b16 a[82:83], v199 offset:50176
  v_cvt_pk_bf16_f32 v117, v118, v119
  v_mfma_f32_16x16x32_bf16 v[36:39], a[100:103], a[60:63], v[36:39]
  ds_write_b64 v224, v[116:117]
  v_cvt_pk_bf16_f32 v32, v32, v33
  v_mfma_f32_16x16x32_bf16 v[36:39], a[96:99], a[40:43], v[36:39]
  ds_read_b64_tr_b16 a[84:85], v200 offset:0
  v_cvt_pk_bf16_f32 v33, v34, v35
  v_mfma_f32_16x16x32_bf16 v[36:39], a[92:95], a[20:23], v[36:39]
  s_waitcnt lgkmcnt(6)
  buffer_load_dwordx4 v219, s[12:15], s50 offen offset:3072 lds
  v_cvt_pk_bf16_f32 v34, v48, v49
  v_mfma_f32_16x16x32_bf16 v[52:55], a[40:43], a[104:107], v[52:55]
  ds_read_b64_tr_b16 a[86:87], v200 offset:6144
  v_cvt_pk_bf16_f32 v35, v50, v51
  v_mfma_f32_16x16x32_bf16 v[52:55], a[60:63], a[108:111], v[52:55]
  ds_write_b64 v222, v[32:33]
  v_mfma_f32_16x16x32_bf16 v[56:59], a[64:67], a[108:111], v[56:59]
  ds_read_b64_tr_b16 a[88:89], v201 offset:0
  v_mfma_f32_16x16x32_bf16 v[56:59], a[44:47], a[104:107], v[56:59]
  ds_write_b64 v223, v[34:35]
  v_cvt_pk_bf16_f32 v28, v28, v29
  v_mfma_f32_16x16x32_bf16 v[60:63], a[48:51], a[104:107], v[60:63]
  ds_read_b64_tr_b16 a[90:91], v201 offset:6144
  v_cvt_pk_bf16_f32 v29, v30, v31
  v_mfma_f32_16x16x32_bf16 v[60:63], a[68:71], a[108:111], v[60:63]
  v_cvt_pk_bf16_f32 v30, v44, v45
  v_cvt_pk_bf16_f32 v31, v46, v47
  v_mfma_f32_16x16x32_bf16 v[64:67], a[72:75], a[108:111], v[64:67]
  v_cvt_pk_bf16_f32 v24, v24, v25
  v_cvt_pk_bf16_f32 v25, v26, v27
  v_mfma_f32_16x16x32_bf16 v[64:67], a[52:55], a[104:107], v[64:67]
  v_cvt_pk_bf16_f32 v26, v40, v41
  v_cvt_pk_bf16_f32 v27, v42, v43
  v_mfma_f32_16x16x32_bf16 v[120:123], a[56:59], a[104:107], v[120:123]
  v_cvt_pk_bf16_f32 v20, v20, v21
  v_cvt_pk_bf16_f32 v21, v22, v23
  v_mfma_f32_16x16x32_bf16 v[120:123], a[76:79], a[108:111], v[120:123]
  s_waitcnt lgkmcnt(7)
  v_cvt_pk_bf16_f32 v22, v36, v37
  v_cvt_pk_bf16_f32 v23, v38, v39
  v_mfma_f32_16x16x32_bf16 v[80:83], a[52:55], a[112:115], v[80:83]
  v_cvt_pk_bf16_f32 v55, v54, v55
  v_cvt_pk_bf16_f32 v54, v52, v53
  v_mfma_f32_16x16x32_bf16 v[80:83], a[72:75], a[80:83], v[80:83]
  v_cvt_pk_bf16_f32 v56, v56, v57
  v_cvt_pk_bf16_f32 v57, v58, v59
  v_mfma_f32_16x16x32_bf16 v[76:79], a[68:71], a[80:83], v[76:79]
  v_cvt_pk_bf16_f32 v58, v60, v61
  v_cvt_pk_bf16_f32 v59, v62, v63
  v_mfma_f32_16x16x32_bf16 v[76:79], a[48:51], a[112:115], v[76:79]
  v_mfma_f32_16x16x32_bf16 v[72:75], a[44:47], a[112:115], v[72:75]
  v_cvt_pk_bf16_f32 v60, v64, v65
  v_cvt_pk_bf16_f32 v61, v66, v67
  v_mfma_f32_16x16x32_bf16 v[72:75], a[64:67], a[80:83], v[72:75]
  v_mfma_f32_16x16x32_bf16 v[68:71], a[60:63], a[80:83], v[68:71]
  v_cvt_pk_bf16_f32 v120, v120, v121
  v_cvt_pk_bf16_f32 v121, v122, v123
  v_mfma_f32_16x16x32_bf16 v[68:71], a[40:43], a[112:115], v[68:71]
  s_waitcnt lgkmcnt(4)
  ds_write_b64 v222, v[60:61] offset:1024
  v_mfma_f32_16x16x32_bf16 v[84:87], a[84:87], a[60:63], v[84:87]
  ds_write_b64 v224, v[120:121] offset:1024
  v_mfma_f32_16x16x32_bf16 v[88:91], a[84:87], a[64:67], v[88:91]
  v_mfma_f32_16x16x32_bf16 v[92:95], a[84:87], a[68:71], v[92:95]
  v_mfma_f32_16x16x32_bf16 v[96:99], a[84:87], a[72:75], v[96:99]
  s_waitcnt lgkmcnt(2)
  v_mfma_f32_16x16x32_bf16 v[112:115], a[88:91], a[72:75], v[112:115]
  v_mfma_f32_16x16x32_bf16 v[108:111], a[88:91], a[68:71], v[108:111]
  v_mfma_f32_16x16x32_bf16 v[104:107], a[88:91], a[64:67], v[104:107]
  v_cvt_pk_bf16_f32 v71, v70, v71
  v_cvt_pk_bf16_f32 v70, v68, v69
  v_mfma_f32_16x16x32_bf16 v[100:103], a[88:91], a[60:63], v[100:103]
  v_cvt_pk_bf16_f32 v72, v72, v73
  v_cvt_pk_bf16_f32 v73, v74, v75
  v_cvt_pk_bf16_f32 v74, v76, v77
  v_cvt_pk_bf16_f32 v75, v78, v79
  v_cvt_pk_bf16_f32 v76, v80, v81
  v_cvt_pk_bf16_f32 v77, v82, v83
  ds_write_b64 v223, v[76:77] offset:1024
  s_waitcnt lgkmcnt(0)
  s_barrier
  ds_read_b64 v[124:125], v225
  ds_read_b64 v[126:127], v226
  ds_read_b64 v[52:53], v227 offset:1024
  ds_read_b64 v[68:69], v227 offset:1032
  v_cvt_pk_bf16_f32 v96, v96, v97
  v_cvt_pk_bf16_f32 v97, v98, v99
Ha1_1:
  s_cbranch_execz Ra
  v_cvt_pk_bf16_f32 v98, v112, v113
  v_cvt_pk_bf16_f32 v99, v114, v115
  v_cvt_pk_bf16_f32 v92, v92, v93
  v_cvt_pk_bf16_f32 v93, v94, v95
  v_cvt_pk_bf16_f32 v94, v108, v109
  v_cvt_pk_bf16_f32 v95, v110, v111
  v_mfma_f32_16x16x32_bf16 v[112:115], v[32:35], v[96:99], 0
  v_mfma_f32_16x16x32_bf16 v[48:51], v[28:31], v[96:99], 0
  v_cvt_pk_bf16_f32 v88, v88, v89
  v_cvt_pk_bf16_f32 v89, v90, v91
  v_cvt_pk_bf16_f32 v90, v104, v105
  v_cvt_pk_bf16_f32 v91, v106, v107
  v_mfma_f32_16x16x32_bf16 v[108:111], v[28:31], v[92:95], 0
  v_mfma_f32_16x16x32_bf16 v[44:47], v[24:27], v[92:95], 0
  v_cvt_pk_bf16_f32 v84, v84, v85
  v_cvt_pk_bf16_f32 v85, v86, v87
  v_cvt_pk_bf16_f32 v86, v100, v101
  v_cvt_pk_bf16_f32 v87, v102, v103
  v_mfma_f32_16x16x32_bf16 v[104:107], v[24:27], v[88:91], 0
  v_mfma_f32_16x16x32_bf16 v[40:43], v[20:23], v[88:91], 0
  s_cmp_eq_u32 s57, 0
  s_cselect_b64 s[66:67], s[80:81], 0
  s_cselect_b64 s[68:69], s[82:83], 0
  s_waitcnt lgkmcnt(2)
  v_mfma_f32_16x16x32_bf16 v[100:103], v[20:23], v[84:87], 0
  v_mfma_f32_16x16x32_bf16 v[36:39], v[124:127], v[84:87], 0
  s_cmp_eq_u32 s59, 0
  s_cbranch_scc1 F_sw
  v_swap_b32 v54, v70
  v_swap_b32 v55, v71
  v_swap_b32 v56, v72
  v_swap_b32 v57, v73
  v_swap_b32 v58, v74
  v_swap_b32 v59, v75
  v_swap_b32 v60, v76
  v_swap_b32 v61, v77
F_sw:
  v_mov_b32 v12, 0xcfa8965f
  s_xor_b32 s50, s76, 0
  s_add_u32 m0, s70, 81920
  s_nop 0
  buffer_load_dwordx4 v216, s[12:15], s50 offen offset:0 lds
  v_mov_b32 v14, 0x3e8293ee
  v_cndmask_b32 v194, v112, v113, s[78:79]
  v_cndmask_b32 v195, v114, v115, s[78:79]
  v_cndmask_b32 v192, v48, v49, s[78:79]
  v_cndmask_b32 v193, v50, v51, s[78:79]
  v_cndmask_b32 v190, v108, v109, s[78:79]
  v_cndmask_b32 v191, v110, v111, s[78:79]
  v_cndmask_b32 v188, v44, v45, s[78:79]
  v_cndmask_b32 v189, v46, v47, s[78:79]
  v_cndmask_b32 v186, v104, v105, s[78:79]
  v_cndmask_b32 v187, v106, v107, s[78:79]
  v_cndmask_b32 v184, v40, v41, s[78:79]
  buffer_load_dwordx4 v217, s[12:15], s50 offen offset:1024 lds
  v_cndmask_b32 v185, v42, v43, s[78:79]
  v_cndmask_b32 v182, v100, v101, s[78:79]
  v_cndmask_b32 v183, v102, v103, s[78:79]
  v_cndmask_b32 v180, v36, v37, s[78:79]
  v_cndmask_b32 v181, v38, v39, s[78:79]
  v_cndmask_b32 v192, v194, v192, s[80:81]
  v_cndmask_b32 v193, v195, v193, s[82:83]
  v_cndmask_b32 v188, v190, v188, s[80:81]
  v_cndmask_b32 v189, v191, v189, s[82:83]
  v_cndmask_b32 v184, v186, v184, s[80:81]
  v_cndmask_b32 v185, v187, v185, s[82:83]
  v_cndmask_b32 v180, v182, v180, s[80:81]
  buffer_load_dwordx4 v218, s[12:15], s50 offen offset:2048 lds
  v_cndmask_b32 v181, v183, v181, s[82:83]
  v_cndmask_b32 v180, v180, v12, s[66:67]
  v_cndmask_b32 v181, v181, v12, s[68:69]
  v_max_f32 v194, v192, v193
  v_max_f32 v195, v192, v193
  v_max_f32 v190, v188, v189
  v_max_f32 v191, v188, v189
  v_max_f32 v186, v184, v185
  v_max_f32 v187, v184, v185
  v_max_f32 v182, v180, v181
  v_max_f32 v183, v180, v181
  v_permlane16_swap_b32 v194, v195
  buffer_load_dwordx4 v219, s[12:15], s50 offen offset:3072 lds
  v_permlane16_swap_b32 v190, v191
  v_permlane16_swap_b32 v186, v187
  v_permlane16_swap_b32 v182, v183
  v_max_f32 v194, v194, v195
  v_max_f32 v190, v190, v191
  v_max_f32 v186, v186, v187
  v_max_f32 v182, v182, v183
  v_mov_b32 v195, v194
  v_mov_b32 v191, v190
  v_mov_b32 v187, v186
  v_mov_b32 v183, v182
  v_permlane32_swap_b32 v194, v195
  s_xor_b32 s50, s76, 262144
  s_add_u32 m0, s70, 98304
  s_nop 0
  buffer_load_dwordx4 v216, s[12:15], s50 offen offset:0 lds
  v_permlane32_swap_b32 v190, v191
  v_permlane32_swap_b32 v186, v187
  v_permlane32_swap_b32 v182, v183
  v_max_f32 v194, v194, v195
  v_max_f32 v190, v190, v191
  v_max_f32 v186, v186, v187
  v_max_f32 v182, v182, v183
  v_mul_f32 v194, 0xbe8293ee, v194
  v_mul_f32 v190, 0xbe8293ee, v190
  v_mul_f32 v186, 0xbe8293ee, v186
  v_mul_f32 v182, 0xbe8293ee, v182
  v_pk_fma_f32 v[192:193], v[192:193], v[14:15], v[194:195] op_sel_hi:[1,0,0]
  buffer_load_dwordx4 v217, s[12:15], s50 offen offset:1024 lds
  v_pk_fma_f32 v[188:189], v[188:189], v[14:15], v[190:191] op_sel_hi:[1,0,0]
  v_pk_fma_f32 v[184:185], v[184:185], v[14:15], v[186:187] op_sel_hi:[1,0,0]
  v_pk_fma_f32 v[180:181], v[180:181], v[14:15], v[182:183] op_sel_hi:[1,0,0]
  v_exp_f32 v192, v192
  v_exp_f32 v193, v193
  v_exp_f32 v188, v188
  v_exp_f32 v189, v189
  v_exp_f32 v184, v184
  v_exp_f32 v185, v185
  v_exp_f32 v180, v180
  v_exp_f32 v181, v181
  v_add_f32 v194, v192, v193
  buffer_load_dwordx4 v218, s[12:15], s50 offen offset:2048 lds
  v_add_f32 v195, v192, v193
  v_add_f32 v190, v188, v189
  v_add_f32 v191, v188, v189
  v_add_f32 v186, v184, v185
  v_add_f32 v187, v184, v185
  v_add_f32 v182, v180, v181
  v_add_f32 v183, v180, v181
  v_permlane16_swap_b32 v194, v195
  v_permlane16_swap_b32 v190, v191
  v_permlane16_swap_b32 v186, v187
  v_permlane16_swap_b32 v182, v183
  v_add_f32 v194, v194, v195
  buffer_load_dwordx4 v219, s[12:15], s50 offen offset:3072 lds
  v_add_f32 v190, v190, v191
  v_add_f32 v186, v186, v187
  v_add_f32 v182, v182, v183
  v_mov_b32 v195, v194
  v_mov_b32 v191, v190
  v_mov_b32 v187, v186
  v_mov_b32 v183, v182
  v_permlane32_swap_b32 v194, v195
  v_permlane32_swap_b32 v190, v191
  v_permlane32_swap_b32 v186, v187
  v_permlane32_swap_b32 v182, v183
  v_add_f32 v194, v194, v195
  s_xor_b32 s50, s76, 786432
  s_add_u32 m0, s70, 16384
  s_nop 0
  buffer_load_dwordx4 v216, s[12:15], s50 offen offset:0 lds
  v_add_f32 v190, v190, v191
  v_add_f32 v186, v186, v187
  v_add_f32 v182, v182, v183
  v_rcp_f32 v194, v194
  v_rcp_f32 v190, v190
  v_rcp_f32 v186, v186
  v_rcp_f32 v182, v182
  v_pk_mul_f32 v[192:193], v[192:193], v[194:195] op_sel_hi:[1,0]
  v_pk_mul_f32 v[188:189], v[188:189], v[190:191] op_sel_hi:[1,0]
  v_pk_mul_f32 v[184:185], v[184:185], v[186:187] op_sel_hi:[1,0]
  v_pk_mul_f32 v[180:181], v[180:181], v[182:183] op_sel_hi:[1,0]
  v_cvt_pk_bf16_f32 v192, v192, v193
  buffer_load_dwordx4 v217, s[12:15], s50 offen offset:1024 lds
  v_cvt_pk_bf16_f32 v188, v188, v189
  v_cvt_pk_bf16_f32 v184, v184, v185
  v_cvt_pk_bf16_f32 v180, v180, v181
  s_waitcnt lgkmcnt(0)
  v_perm_b32 v48, v192, v192, v228
  v_perm_b32 v49, v192, v192, v229
  v_perm_b32 v50, v192, v192, v230
  v_perm_b32 v51, v192, v192, v231
  v_perm_b32 v44, v188, v188, v228
  v_perm_b32 v45, v188, v188, v229
  v_perm_b32 v46, v188, v188, v230
  v_perm_b32 v47, v188, v188, v231
  v_mfma_f32_16x16x32_bf16 v[32:35], v[58:61], v[48:51], 0
  v_mfma_f32_16x16x32_bf16 v[96:99], v[74:77], v[48:51], 0
  v_perm_b32 v40, v184, v184, v228
  v_perm_b32 v41, v184, v184, v229
  v_perm_b32 v42, v184, v184, v230
  v_perm_b32 v43, v184, v184, v231
  v_mfma_f32_16x16x32_bf16 v[28:31], v[56:59], v[44:47], 0
  v_mfma_f32_16x16x32_bf16 v[92:95], v[72:75], v[44:47], 0
  v_perm_b32 v36, v180, v180, v228
  v_perm_b32 v37, v180, v180, v229
  v_perm_b32 v38, v180, v180, v230
  v_perm_b32 v39, v180, v180, v231
  v_mfma_f32_16x16x32_bf16 v[24:27], v[54:57], v[40:43], 0
  v_mfma_f32_16x16x32_bf16 v[88:91], v[70:73], v[40:43], 0
  s_nop 0
  v_mfma_f32_16x16x32_bf16 v[20:23], v[52:55], v[36:39], 0
  v_mfma_f32_16x16x32_bf16 v[84:87], v[68:71], v[36:39], 0
  v_cvt_pk_bf16_f32 v192, v32, v33
  v_cvt_pk_bf16_f32 v193, v34, v35
  v_cvt_pk_bf16_f32 v194, v96, v97
  v_cvt_pk_bf16_f32 v195, v98, v99
  buffer_store_dwordx4 v[192:195], v0, s[36:39], s72 offen offset:1024 sc1
  v_cvt_pk_bf16_f32 v188, v28, v29
  v_cvt_pk_bf16_f32 v189, v30, v31
  v_cvt_pk_bf16_f32 v190, v92, v93
  v_cvt_pk_bf16_f32 v191, v94, v95
  buffer_store_dwordx4 v[188:191], v0, s[36:39], s72 offen offset:0 sc1
  v_cvt_pk_bf16_f32 v184, v24, v25
  v_cvt_pk_bf16_f32 v185, v26, v27
  v_cvt_pk_bf16_f32 v186, v88, v89
  v_cvt_pk_bf16_f32 v187, v90, v91
  buffer_store_dwordx4 v[184:187], v0, s[36:39], s71 offen offset:1024 sc1
  v_cvt_pk_bf16_f32 v180, v20, v21
  v_cvt_pk_bf16_f32 v181, v22, v23
  v_cvt_pk_bf16_f32 v182, v84, v85
  v_cvt_pk_bf16_f32 v183, v86, v87
  buffer_store_dwordx4 v[180:183], v0, s[36:39], s71 offen offset:0 sc1
  s_waitcnt vmcnt(21)
  v_lshlrev_b32 v60, 16, v136
  v_and_b32 v61, 0xffff0000, v136
  v_lshlrev_b32 v62, 16, v137
  v_and_b32 v63, 0xffff0000, v137
  v_pk_mul_f32 v[52:53], v[60:61], v[168:169] op_sel_hi:[1,0]
  v_pk_mul_f32 v[54:55], v[62:63], v[168:169] op_sel_hi:[1,0]
  v_lshlrev_b32 v60, 16, v138
  v_and_b32 v61, 0xffff0000, v138
  v_lshlrev_b32 v62, 16, v139
  v_and_b32 v63, 0xffff0000, v139
  v_pk_mul_f32 v[56:57], v[60:61], v[168:169] op_sel_hi:[1,0]
  v_pk_mul_f32 v[58:59], v[62:63], v[168:169] op_sel_hi:[1,0]
  buffer_load_dwordx4 v218, s[12:15], s50 offen offset:2048 lds
  v_lshlrev_b32 v60, 16, v140
  v_and_b32 v61, 0xffff0000, v140
  v_lshlrev_b32 v62, 16, v141
  v_and_b32 v63, 0xffff0000, v141
  v_pk_fma_f32 v[52:53], v[60:61], v[168:169], v[52:53] op_sel:[0,1,0] op_sel_hi:[1,1,1]
  v_pk_fma_f32 v[54:55], v[62:63], v[168:169], v[54:55] op_sel:[0,1,0] op_sel_hi:[1,1,1]
  v_lshlrev_b32 v60, 16, v142
  v_and_b32 v61, 0xffff0000, v142
  v_lshlrev_b32 v62, 16, v143
  v_and_b32 v63, 0xffff0000, v143
  v_pk_fma_f32 v[56:57], v[60:61], v[168:169], v[56:57] op_sel:[0,1,0] op_sel_hi:[1,1,1]
  v_pk_fma_f32 v[58:59], v[62:63], v[168:169], v[58:59] op_sel:[0,1,0] op_sel_hi:[1,1,1]
  buffer_load_dwordx4 v219, s[12:15], s50 offen offset:3072 lds
  v_lshlrev_b32 v60, 16, v144
  v_and_b32 v61, 0xffff0000, v144
  v_lshlrev_b32 v62, 16, v145
  v_and_b32 v63, 0xffff0000, v145
  v_pk_fma_f32 v[52:53], v[60:61], v[170:171], v[52:53] op_sel:[0,0,0] op_sel_hi:[1,0,1]
  v_pk_fma_f32 v[54:55], v[62:63], v[170:171], v[54:55] op_sel:[0,0,0] op_sel_hi:[1,0,1]
  v_lshlrev_b32 v60, 16, v146
  v_and_b32 v61, 0xffff0000, v146
  v_lshlrev_b32 v62, 16, v147
  v_and_b32 v63, 0xffff0000, v147
  v_pk_fma_f32 v[56:57], v[60:61], v[170:171], v[56:57] op_sel:[0,0,0] op_sel_hi:[1,0,1]
  v_pk_fma_f32 v[58:59], v[62:63], v[170:171], v[58:59] op_sel:[0,0,0] op_sel_hi:[1,0,1]
  s_xor_b32 s50, s76, 1048576
  s_add_u32 m0, s70, 32768
  s_nop 0
  buffer_load_dwordx4 v216, s[12:15], s50 offen offset:0 lds
  v_lshlrev_b32 v60, 16, v148
  v_and_b32 v61, 0xffff0000, v148
  v_lshlrev_b32 v62, 16, v149
  v_and_b32 v63, 0xffff0000, v149
  v_pk_fma_f32 v[52:53], v[60:61], v[170:171], v[52:53] op_sel:[0,1,0] op_sel_hi:[1,1,1]
  v_pk_fma_f32 v[54:55], v[62:63], v[170:171], v[54:55] op_sel:[0,1,0] op_sel_hi:[1,1,1]
  v_lshlrev_b32 v60, 16, v150
  v_and_b32 v61, 0xffff0000, v150
  v_lshlrev_b32 v62, 16, v151
  v_and_b32 v63, 0xffff0000, v151
  v_pk_fma_f32 v[56:57], v[60:61], v[170:171], v[56:57] op_sel:[0,1,0] op_sel_hi:[1,1,1]
  v_pk_fma_f32 v[58:59], v[62:63], v[170:171], v[58:59] op_sel:[0,1,0] op_sel_hi:[1,1,1]
  buffer_load_dwordx4 v217, s[12:15], s50 offen offset:1024 lds
  v_lshlrev_b32 v60, 16, v152
  v_and_b32 v61, 0xffff0000, v152
  v_lshlrev_b32 v62, 16, v153
  v_and_b32 v63, 0xffff0000, v153
  v_pk_fma_f32 v[52:53], v[60:61], v[172:173], v[52:53] op_sel:[0,0,0] op_sel_hi:[1,0,1]
  v_pk_fma_f32 v[54:55], v[62:63], v[172:173], v[54:55] op_sel:[0,0,0] op_sel_hi:[1,0,1]
  v_lshlrev_b32 v60, 16, v154
  v_and_b32 v61, 0xffff0000, v154
  v_lshlrev_b32 v62, 16, v155
  v_and_b32 v63, 0xffff0000, v155
  v_pk_fma_f32 v[56:57], v[60:61], v[172:173], v[56:57] op_sel:[0,0,0] op_sel_hi:[1,0,1]
  v_pk_fma_f32 v[58:59], v[62:63], v[172:173], v[58:59] op_sel:[0,0,0] op_sel_hi:[1,0,1]
  buffer_load_dwordx4 v218, s[12:15], s50 offen offset:2048 lds
  v_lshlrev_b32 v60, 16, v156
  v_and_b32 v61, 0xffff0000, v156
  v_lshlrev_b32 v62, 16, v157
  v_and_b32 v63, 0xffff0000, v157
  v_pk_fma_f32 v[52:53], v[60:61], v[172:173], v[52:53] op_sel:[0,1,0] op_sel_hi:[1,1,1]
  v_pk_fma_f32 v[54:55], v[62:63], v[172:173], v[54:55] op_sel:[0,1,0] op_sel_hi:[1,1,1]
  v_lshlrev_b32 v60, 16, v158
  v_and_b32 v61, 0xffff0000, v158
  v_lshlrev_b32 v62, 16, v159
  v_and_b32 v63, 0xffff0000, v159
  v_pk_fma_f32 v[56:57], v[60:61], v[172:173], v[56:57] op_sel:[0,1,0] op_sel_hi:[1,1,1]
  v_pk_fma_f32 v[58:59], v[62:63], v[172:173], v[58:59] op_sel:[0,1,0] op_sel_hi:[1,1,1]
  buffer_load_dwordx4 v219, s[12:15], s50 offen offset:3072 lds
  v_lshlrev_b32 v60, 16, v160
  v_and_b32 v61, 0xffff0000, v160
  v_lshlrev_b32 v62, 16, v161
  v_and_b32 v63, 0xffff0000, v161
  v_pk_fma_f32 v[52:53], v[60:61], v[174:175], v[52:53] op_sel:[0,0,0] op_sel_hi:[1,0,1]
  v_pk_fma_f32 v[54:55], v[62:63], v[174:175], v[54:55] op_sel:[0,0,0] op_sel_hi:[1,0,1]
  v_lshlrev_b32 v60, 16, v162
  v_and_b32 v61, 0xffff0000, v162
  v_lshlrev_b32 v62, 16, v163
  v_and_b32 v63, 0xffff0000, v163
  v_pk_fma_f32 v[56:57], v[60:61], v[174:175], v[56:57] op_sel:[0,0,0] op_sel_hi:[1,0,1]
  v_pk_fma_f32 v[58:59], v[62:63], v[174:175], v[58:59] op_sel:[0,0,0] op_sel_hi:[1,0,1]
  v_lshlrev_b32 v60, 16, v164
  v_and_b32 v61, 0xffff0000, v164
  v_lshlrev_b32 v62, 16, v165
  v_and_b32 v63, 0xffff0000, v165
  v_pk_fma_f32 v[52:53], v[60:61], v[174:175], v[52:53] op_sel:[0,1,0] op_sel_hi:[1,1,1]
  v_pk_fma_f32 v[54:55], v[62:63], v[174:175], v[54:55] op_sel:[0,1,0] op_sel_hi:[1,1,1]
  v_lshlrev_b32 v60, 16, v166
  v_and_b32 v61, 0xffff0000, v166
  v_lshlrev_b32 v62, 16, v167
  v_and_b32 v63, 0xffff0000, v167
  v_pk_fma_f32 v[56:57], v[60:61], v[174:175], v[56:57] op_sel:[0,1,0] op_sel_hi:[1,1,1]
  v_pk_fma_f32 v[58:59], v[62:63], v[174:175], v[58:59] op_sel:[0,1,0] op_sel_hi:[1,1,1]
  s_nop 0
  v_permlane32_swap_b32 v52, v56
  v_permlane32_swap_b32 v53, v57
  v_permlane32_swap_b32 v54, v58
  v_permlane32_swap_b32 v55, v59
  v_add_f32 v52, v52, v56
  v_add_f32 v53, v53, v57
  v_add_f32 v54, v54, v58
  v_add_f32 v55, v55, v59
  s_nop 0
  v_permlane16_swap_b32 v52, v54
  v_permlane16_swap_b32 v53, v55
  v_add_f32 v52, v52, v54
  v_add_f32 v53, v53, v55
  v_add_u32 v60, 162816, v178
  v_add_f32_dpp v52, v52, v52 row_ror:8 row_mask:0xf bank_mask:0xf
  v_add_f32_dpp v53, v53, v53 row_ror:8 row_mask:0xf bank_mask:0xf
  ds_write_b64 v177, v[52:53]
  v_mov_b32 v12, s3
  s_waitcnt vmcnt(6) lgkmcnt(0)
  s_barrier
  s_mov_b64 exec, 1
  buffer_store_dword v12, v0, s[36:39], s45 offen sc1
  s_mov_b64 exec, -1
  ds_read_b32 v52, v60 offset:0
  ds_read_b32 v53, v60 offset:256
  ds_read_b32 v54, v60 offset:512
  ds_read_b32 v55, v60 offset:768
  s_cmp_eq_u32 s44, 1
  s_cselect_b32 s49, s56, 1073741824
  s_lshl_b32 s45, s2, 7
  s_add_u32 s45, s45, 5341184
  s_cmp_eq_u32 s44, 0
  s_cselect_b32 s45, s45, 1073741824
  s_waitcnt lgkmcnt(0)
  v_add_f32 v52, v52, v53
  v_add_f32 v54, v54, v55
  v_add_f32 v52, v52, v54
  buffer_store_dword v52, v178, s[36:39], s49 offen sc1
  s_xor_b32 s50, s76, 1310720
  s_add_u32 m0, s70, 49152
  s_nop 0
  buffer_load_dwordx4 v216, s[12:15], s50 offen offset:0 lds
  buffer_load_dwordx4 v217, s[12:15], s50 offen offset:1024 lds
  buffer_load_dwordx4 v218, s[12:15], s50 offen offset:2048 lds
  buffer_load_dwordx4 v219, s[12:15], s50 offen offset:3072 lds
  s_xor_b32 s50, s76, 1572864
  s_add_u32 m0, s70, 65536
  s_nop 0
  buffer_load_dwordx4 v216, s[12:15], s50 offen offset:0 lds
  buffer_load_dwordx4 v217, s[12:15], s50 offen offset:1024 lds
  buffer_load_dwordx4 v218, s[12:15], s50 offen offset:2048 lds
  buffer_load_dwordx4 v219, s[12:15], s50 offen offset:3072 lds
  s_xor_b32 s50, s76, 1835008
  s_add_u32 m0, s70, 114688
  s_nop 0
  buffer_load_dwordx4 v216, s[12:15], s50 offen offset:0 lds
  buffer_load_dwordx4 v217, s[12:15], s50 offen offset:1024 lds
  buffer_load_dwordx4 v218, s[12:15], s50 offen offset:2048 lds
  buffer_load_dwordx4 v219, s[12:15], s50 offen offset:3072 lds
  s_add_u32 m0, s70, 131072
  s_nop 0
  buffer_load_dwordx4 v220, s[4:7], s55 offen offset:0 lds
  buffer_load_dwordx4 v221, s[4:7], s55 offen offset:1024 lds
  s_add_u32 m0, s70, 133120
  s_add_u32 s48, s55, 32768
  buffer_load_dwordx4 v220, s[4:7], s48 offen offset:0 lds
  buffer_load_dwordx4 v221, s[4:7], s48 offen offset:1024 lds
  ds_read_b64_tr_b16 a[176:177], v236 offset:16384
  ds_read_b64_tr_b16 a[178:179], v236 offset:18432
  ds_read_b64_tr_b16 a[180:181], v236 offset:20480
  ds_read_b64_tr_b16 a[182:183], v236 offset:22528
  ds_read_b64_tr_b16 a[184:185], v237 offset:16384
  ds_read_b64_tr_b16 a[186:187], v237 offset:18432
  ds_read_b64_tr_b16 a[188:189], v237 offset:20480
  ds_read_b64_tr_b16 a[190:191], v237 offset:22528
  ds_read_b64_tr_b16 a[192:193], v238 offset:16384
  ds_read_b64_tr_b16 a[194:195], v238 offset:18432
  ds_read_b64_tr_b16 a[196:197], v238 offset:20480
  ds_read_b64_tr_b16 a[198:199], v238 offset:22528
  ds_read_b64_tr_b16 a[200:201], v239 offset:16384
  ds_read_b64_tr_b16 a[202:203], v239 offset:18432
  ds_read_b64_tr_b16 a[204:205], v239 offset:20480
  ds_read_b64_tr_b16 a[206:207], v239 offset:22528
  ds_read_b64_tr_b16 a[208:209], v236 offset:24576
  ds_read_b64_tr_b16 a[210:211], v236 offset:26624
  ds_read_b64_tr_b16 a[212:213], v236 offset:28672
  ds_read_b64_tr_b16 a[214:215], v236 offset:30720
  ds_read_b64_tr_b16 a[216:217], v237 offset:24576
  ds_read_b64_tr_b16 a[218:219], v237 offset:26624
  ds_read_b64_tr_b16 a[220:221], v237 offset:28672
  ds_read_b64_tr_b16 a[222:223], v237 offset:30720
  ds_read_b64_tr_b16 a[224:225], v238 offset:24576
  ds_read_b64_tr_b16 a[226:227], v238 offset:26624
  ds_read_b64_tr_b16 a[228:229], v238 offset:28672
  ds_read_b64_tr_b16 a[230:231], v238 offset:30720
  s_lshr_b32 s76, s76, 5
  s_mov_b64 exec, 0
  s_cmp_eq_u32 s44, 1
  s_cbranch_scc1 Hc0
  s_cmp_eq_u32 s44, 2
  s_cbranch_scc1 Hc1
  s_cmp_eq_u32 s44, 3
  s_cbranch_scc1 Hc2
Rc:
  s_mov_b64 exec, -1
  s_cmp_lg_u32 s44, 0
  s_cbranch_scc1 SM4x
  s_mov_b32 s46, 60000
  s_mov_b32 s47, 5242880
SM4:
  buffer_load_dword v13, v250, s[36:39], s47 offen sc1
  s_sub_u32 s46, s46, 1
  s_cmp_eq_u32 s46, 0
  s_waitcnt vmcnt(0)
  s_cbranch_scc1 SM4x
  v_cmp_ne_u32 vcc, s3, v13
  s_nop 4
  s_cbranch_vccnz SM4
SM4x:
  s_waitcnt vmcnt(0)
  s_barrier
  buffer_load_dwordx4 a[0:3], v244, s[36:39], s76 offen offset:0 sc1
  buffer_load_dwordx4 a[8:11], v244, s[36:39], s76 offen offset:2048 sc1
  buffer_load_dwordx4 a[4:7], v244, s[36:39], s76 offen offset:1024 sc1
  buffer_load_dwordx4 a[12:15], v244, s[36:39], s76 offen offset:3072 sc1
  s_xor_b32 s50, s76, 4096
  buffer_load_dwordx4 a[16:19], v244, s[36:39], s50 offen offset:0 sc1
  buffer_load_dwordx4 a[20:23], v244, s[36:39], s50 offen offset:1024 sc1
  buffer_load_dwordx4 a[24:27], v244, s[36:39], s50 offen offset:2048 sc1
  buffer_load_dwordx4 a[28:31], v244, s[36:39], s50 offen offset:3072 sc1
  ds_read_b64 v[116:117], v240 offset:0
  ds_read_b64 v[118:119], v241 offset:0
  ds_read_b64 v[120:121], v242 offset:0
  ds_read_b64 v[122:123], v243 offset:0
  ds_read_b64 v[124:125], v240 offset:2048
  ds_read_b64 v[126:127], v241 offset:2048
  ds_read_b64 v[128:129], v242 offset:2048
  ds_read_b64 v[130:131], v243 offset:2048
  v_lshrrev_b32 v14, 4, v10
  v_cmp_eq_u32 vcc, 2, v14
  s_add_u32 s51, s73, 65536
  v_mov_b32 v12, s3
  v_cndmask_b32 v14, 0, 1.0, vcc
  s_waitcnt lgkmcnt(0)
  v_lshlrev_b32 v52, 16, v116
  v_and_b32 v53, 0xffff0000, v116
  v_lshlrev_b32 v54, 16, v117
  v_and_b32 v55, 0xffff0000, v117
  v_lshlrev_b32 v56, 16, v118
  v_and_b32 v57, 0xffff0000, v118
  v_lshlrev_b32 v58, 16, v119
  v_and_b32 v59, 0xffff0000, v119
  v_lshlrev_b32 v60, 16, v120
  v_and_b32 v61, 0xffff0000, v120
  v_lshlrev_b32 v62, 16, v121
  v_and_b32 v63, 0xffff0000, v121
  v_lshlrev_b32 v64, 16, v122
  v_and_b32 v65, 0xffff0000, v122
  v_lshlrev_b32 v66, 16, v123
  v_and_b32 v67, 0xffff0000, v123
  v_lshlrev_b32 v68, 16, v124
  v_and_b32 v69, 0xffff0000, v124
  v_lshlrev_b32 v70, 16, v125
  v_and_b32 v71, 0xffff0000, v125
  v_lshlrev_b32 v72, 16, v126
  v_and_b32 v73, 0xffff0000, v126
  v_lshlrev_b32 v74, 16, v127
  v_and_b32 v75, 0xffff0000, v127
  v_lshlrev_b32 v76, 16, v128
  v_and_b32 v77, 0xffff0000, v128
  v_lshlrev_b32 v78, 16, v129
  v_and_b32 v79, 0xffff0000, v129
  v_lshlrev_b32 v80, 16, v130
  v_and_b32 v81, 0xffff0000, v130
  v_lshlrev_b32 v82, 16, v131
  v_and_b32 v83, 0xffff0000, v131
  s_waitcnt vmcnt(7) lgkmcnt(15)
  v_mfma_f32_16x16x32_bf16 v[20:23], a[176:179], a[0:3], 0
  s_waitcnt vmcnt(6)
  s_xor_b32 s50, s76, 8192
  buffer_load_dwordx4 a[32:35], v244, s[36:39], s50 offen offset:0 sc1
  v_mfma_f32_16x16x32_bf16 v[20:23], a[180:183], a[8:11], v[20:23]
  s_waitcnt vmcnt(5)
  v_mfma_f32_16x16x32_bf16 v[24:27], a[180:183], a[12:15], 0
  s_waitcnt vmcnt(6)
  buffer_load_dwordx4 a[36:39], v244, s[36:39], s50 offen offset:1024 sc1
  v_mfma_f32_16x16x32_bf16 v[24:27], a[176:179], a[4:7], v[24:27]
  s_waitcnt lgkmcnt(15)
  ds_read_b64_tr_b16 a[176:177], v239 offset:24576
  ds_read_b64_tr_b16 a[178:179], v239 offset:26624
  v_mfma_f32_16x16x32_bf16 v[32:35], a[184:187], a[4:7], 0
  ds_read_b64_tr_b16 a[180:181], v239 offset:28672
  ds_read_b64_tr_b16 a[182:183], v239 offset:30720
  v_mfma_f32_16x16x32_bf16 v[32:35], a[188:191], a[12:15], v[32:35]
  buffer_load_dwordx4 a[40:43], v244, s[36:39], s50 offen offset:2048 sc1
  v_mfma_f32_16x16x32_bf16 v[28:31], a[188:191], a[8:11], 0
  buffer_load_dwordx4 a[44:47], v244, s[36:39], s50 offen offset:3072 sc1
  v_mfma_f32_16x16x32_bf16 v[28:31], a[184:187], a[0:3], v[28:31]
  s_waitcnt lgkmcnt(15)
  s_xor_b32 s50, s76, 12288
  ds_read_b64_tr_b16 a[184:185], v236 offset:32768
  v_mfma_f32_16x16x32_bf16 v[36:39], a[192:195], a[0:3], 0
  ds_read_b64_tr_b16 a[186:187], v236 offset:34816
  ds_read_b64_tr_b16 a[188:189], v236 offset:36864
  v_mfma_f32_16x16x32_bf16 v[36:39], a[196:199], a[8:11], v[36:39]
  ds_read_b64_tr_b16 a[190:191], v236 offset:38912
  buffer_load_dwordx4 a[48:51], v244, s[36:39], s50 offen offset:0 sc1
  v_mfma_f32_16x16x32_bf16 v[40:43], a[196:199], a[12:15], 0
  buffer_load_dwordx4 a[52:55], v244, s[36:39], s50 offen offset:1024 sc1
  v_mfma_f32_16x16x32_bf16 v[40:43], a[192:195], a[4:7], v[40:43]
  s_waitcnt lgkmcnt(15)
  ds_read_b64_tr_b16 a[192:193], v237 offset:32768
  ds_read_b64_tr_b16 a[194:195], v237 offset:34816
  v_mfma_f32_16x16x32_bf16 v[48:51], a[200:203], a[4:7], 0
  s_mov_b32 s49, 0
  ds_read_b64_tr_b16 a[196:197], v237 offset:36864
  ds_read_b64_tr_b16 a[198:199], v237 offset:38912
  v_mfma_f32_16x16x32_bf16 v[48:51], a[204:207], a[12:15], v[48:51]
  buffer_load_dwordx4 a[56:59], v244, s[36:39], s50 offen offset:2048 sc1
  buffer_load_dwordx4 v[156:159], v249, s[36:39], s49 offen sc1
  v_mfma_f32_16x16x32_bf16 v[44:47], a[204:207], a[8:11], 0
  s_mov_b32 s49, 24576
  buffer_load_dwordx4 v[160:163], v249, s[36:39], s49 offen sc1
  s_mov_b32 s49, 49152
  v_mfma_f32_16x16x32_bf16 v[44:47], a[200:203], a[0:3], v[44:47]
  s_waitcnt vmcnt(9) lgkmcnt(15)
  buffer_load_dwordx4 v[164:167], v249, s[36:39], s49 offen sc1
  s_mov_b32 s49, 73728
  v_mfma_f32_16x16x32_bf16 v[20:23], a[208:211], a[16:19], v[20:23]
  buffer_load_dwordx4 v[168:171], v249, s[36:39], s49 offen sc1
  buffer_load_dwordx4 a[60:63], v244, s[36:39], s50 offen offset:3072 sc1
  v_mfma_f32_16x16x32_bf16 v[20:23], a[212:215], a[24:27], v[20:23]
  s_xor_b32 s50, s76, 16384
  ds_read_b64_tr_b16 a[200:201], v238 offset:32768
  ds_read_b64_tr_b16 a[202:203], v238 offset:34816
  v_mfma_f32_16x16x32_bf16 v[24:27], a[212:215], a[28:31], v[24:27]
  ds_read_b64_tr_b16 a[204:205], v238 offset:36864
  ds_read_b64_tr_b16 a[206:207], v238 offset:38912
  v_mfma_f32_16x16x32_bf16 v[24:27], a[208:211], a[20:23], v[24:27]
  s_waitcnt lgkmcnt(15)
  buffer_load_dwordx4 a[64:67], v244, s[36:39], s50 offen offset:0 sc1
  buffer_load_dwordx4 a[68:71], v244, s[36:39], s50 offen offset:1024 sc1
  v_mfma_f32_16x16x32_bf16 v[32:35], a[216:219], a[20:23], v[32:35]
  ds_read_b64_tr_b16 a[208:209], v239 offset:32768
  ds_read_b64_tr_b16 a[210:211], v239 offset:34816
  v_mfma_f32_16x16x32_bf16 v[32:35], a[220:223], a[28:31], v[32:35]
  ds_read_b64_tr_b16 a[212:213], v239 offset:36864
  ds_read_b64_tr_b16 a[214:215], v239 offset:38912
  v_mfma_f32_16x16x32_bf16 v[28:31], a[220:223], a[24:27], v[28:31]
  buffer_load_dwordx4 a[72:75], v244, s[36:39], s50 offen offset:2048 sc1
  buffer_load_dwordx4 a[76:79], v244, s[36:39], s50 offen offset:3072 sc1
  v_mfma_f32_16x16x32_bf16 v[28:31], a[216:219], a[16:19], v[28:31]
  s_waitcnt lgkmcnt(15)
  s_xor_b32 s50, s76, 20480
  ds_read_b64_tr_b16 a[216:217], v236 offset:40960
  v_mfma_f32_16x16x32_bf16 v[36:39], a[224:227], a[16:19], v[36:39]
  ds_read_b64_tr_b16 a[218:219], v236 offset:43008
  ds_read_b64_tr_b16 a[220:221], v236 offset:45056
  v_mfma_f32_16x16x32_bf16 v[36:39], a[228:231], a[24:27], v[36:39]
  ds_read_b64_tr_b16 a[222:223], v236 offset:47104
  buffer_load_dwordx4 a[80:83], v244, s[36:39], s50 offen offset:0 sc1
  v_mfma_f32_16x16x32_bf16 v[40:43], a[228:231], a[28:31], v[40:43]
  buffer_load_dwordx4 a[84:87], v244, s[36:39], s50 offen offset:1024 sc1
  v_mfma_f32_16x16x32_bf16 v[40:43], a[224:227], a[20:23], v[40:43]
  s_waitcnt lgkmcnt(15)
  ds_read_b64_tr_b16 a[224:225], v237 offset:40960
  ds_read_b64_tr_b16 a[226:227], v237 offset:43008
  v_mfma_f32_16x16x32_bf16 v[48:51], a[176:179], a[20:23], v[48:51]
  ds_read_b64_tr_b16 a[228:229], v237 offset:45056
  ds_read_b64_tr_b16 a[230:231], v237 offset:47104
  v_mfma_f32_16x16x32_bf16 v[48:51], a[180:183], a[28:31], v[48:51]
  buffer_load_dwordx4 a[88:91], v244, s[36:39], s50 offen offset:2048 sc1
  v_mfma_f32_16x16x32_bf16 v[44:47], a[180:183], a[24:27], v[44:47]
  buffer_load_dwordx4 a[92:95], v244, s[36:39], s50 offen offset:3072 sc1
  v_mfma_f32_16x16x32_bf16 v[44:47], a[176:179], a[16:19], v[44:47]
  s_waitcnt vmcnt(16) lgkmcnt(15)
  s_xor_b32 s50, s76, 24576
  ds_read_b64_tr_b16 a[176:177], v238 offset:40960
  v_mfma_f32_16x16x32_bf16 v[20:23], a[184:187], a[32:35], v[20:23]
  ds_read_b64_tr_b16 a[178:179], v238 offset:43008
  ds_read_b64_tr_b16 a[180:181], v238 offset:45056
  v_mfma_f32_16x16x32_bf16 v[20:23], a[188:191], a[40:43], v[20:23]
  buffer_load_dwordx4 a[96:99], v244, s[36:39], s50 offen offset:0 sc1
  ds_read_b64_tr_b16 a[182:183], v238 offset:47104
  v_mfma_f32_16x16x32_bf16 v[24:27], a[188:191], a[44:47], v[24:27]
  buffer_load_dwordx4 a[100:103], v244, s[36:39], s50 offen offset:1024 sc1
  v_mfma_f32_16x16x32_bf16 v[24:27], a[184:187], a[36:39], v[24:27]
  s_waitcnt lgkmcnt(15)
  ds_read_b64_tr_b16 a[184:185], v239 offset:40960
  ds_read_b64_tr_b16 a[186:187], v239 offset:43008
  v_mfma_f32_16x16x32_bf16 v[32:35], a[192:195], a[36:39], v[32:35]
  ds_read_b64_tr_b16 a[188:189], v239 offset:45056
  buffer_load_dwordx4 a[104:107], v244, s[36:39], s50 offen offset:2048 sc1
  v_mfma_f32_16x16x32_bf16 v[32:35], a[196:199], a[44:47], v[32:35]
Ha2_1:
  s_cbranch_execz Ra
  ds_read_b64_tr_b16 a[190:191], v239 offset:47104
  v_mfma_f32_16x16x32_bf16 v[28:31], a[196:199], a[40:43], v[28:31]
  buffer_load_dwordx4 a[108:111], v244, s[36:39], s50 offen offset:3072 sc1
  v_mfma_f32_16x16x32_bf16 v[28:31], a[192:195], a[32:35], v[28:31]
  s_waitcnt lgkmcnt(15)
  s_xor_b32 s50, s76, 28672
  ds_read_b64_tr_b16 a[192:193], v232 offset:0
  v_mfma_f32_16x16x32_bf16 v[36:39], a[200:203], a[32:35], v[36:39]
  ds_read_b64_tr_b16 a[194:195], v232 offset:2048
  ds_read_b64_tr_b16 a[196:197], v232 offset:4096
  v_mfma_f32_16x16x32_bf16 v[36:39], a[204:207], a[40:43], v[36:39]
  buffer_load_dwordx4 a[112:115], v244, s[36:39], s50 offen offset:0 sc1
  ds_read_b64_tr_b16 a[198:199], v232 offset:6144
  v_mfma_f32_16x16x32_bf16 v[40:43], a[204:207], a[44:47], v[40:43]
  buffer_load_dwordx4 a[116:119], v244, s[36:39], s50 offen offset:1024 sc1
  v_mfma_f32_16x16x32_bf16 v[40:43], a[200:203], a[36:39], v[40:43]
  s_waitcnt lgkmcnt(15)
  ds_read_b64_tr_b16 a[200:201], v233 offset:0
  ds_read_b64_tr_b16 a[202:203], v233 offset:2048
  v_mfma_f32_16x16x32_bf16 v[48:51], a[208:211], a[36:39], v[48:51]
  ds_read_b64_tr_b16 a[204:205], v233 offset:4096
  buffer_load_dwordx4 a[120:123], v244, s[36:39], s50 offen offset:2048 sc1
  v_mfma_f32_16x16x32_bf16 v[48:51], a[212:215], a[44:47], v[48:51]
  ds_read_b64_tr_b16 a[206:207], v233 offset:6144
  v_mfma_f32_16x16x32_bf16 v[44:47], a[212:215], a[40:43], v[44:47]
  buffer_load_dwordx4 a[124:127], v244, s[36:39], s50 offen offset:3072 sc1
  v_mfma_f32_16x16x32_bf16 v[44:47], a[208:211], a[32:35], v[44:47]
  s_waitcnt vmcnt(16) lgkmcnt(15)
  ds_read_b64_tr_b16 a[208:209], v234 offset:0
  ds_read_b64_tr_b16 a[210:211], v234 offset:2048
  v_mfma_f32_16x16x32_bf16 v[20:23], a[216:219], a[48:51], v[20:23]
  s_xor_b32 s50, s76, 32768
  ds_read_b64_tr_b16 a[212:213], v234 offset:4096
  ds_read_b64_tr_b16 a[214:215], v234 offset:6144
  v_mfma_f32_16x16x32_bf16 v[20:23], a[220:223], a[56:59], v[20:23]
  buffer_load_dwordx4 a[128:131], v244, s[36:39], s50 offen offset:0 sc1
  v_mfma_f32_16x16x32_bf16 v[24:27], a[220:223], a[60:63], v[24:27]
  v_mfma_f32_16x16x32_bf16 v[24:27], a[216:219], a[52:55], v[24:27]
  s_waitcnt lgkmcnt(15)
  ds_read_b64_tr_b16 a[216:217], v235 offset:0
  ds_read_b64_tr_b16 a[218:219], v235 offset:2048
  v_mfma_f32_16x16x32_bf16 v[32:35], a[224:227], a[52:55], v[32:35]
  ds_read_b64_tr_b16 a[220:221], v235 offset:4096
  ds_read_b64_tr_b16 a[222:223], v235 offset:6144
  v_mfma_f32_16x16x32_bf16 v[32:35], a[228:231], a[60:63], v[32:35]
  buffer_load_dwordx4 a[132:135], v244, s[36:39], s50 offen offset:1024 sc1
  v_mfma_f32_16x16x32_bf16 v[28:31], a[228:231], a[56:59], v[28:31]
  v_mfma_f32_16x16x32_bf16 v[28:31], a[224:227], a[48:51], v[28:31]
  s_waitcnt lgkmcnt(15)
  ds_read_b64_tr_b16 a[224:225], v232 offset:8192
  ds_read_b64_tr_b16 a[226:227], v232 offset:10240
  v_mfma_f32_16x16x32_bf16 v[36:39], a[176:179], a[48:51], v[36:39]
  ds_read_b64_tr_b16 a[228:229], v232 offset:12288
  ds_read_b64_tr_b16 a[230:231], v232 offset:14336
  v_mfma_f32_16x16x32_bf16 v[36:39], a[180:183], a[56:59], v[36:39]
  buffer_load_dwordx4 a[136:139], v244, s[36:39], s50 offen offset:2048 sc1
  v_mfma_f32_16x16x32_bf16 v[40:43], a[180:183], a[60:63], v[40:43]
  v_mfma_f32_16x16x32_bf16 v[40:43], a[176:179], a[52:55], v[40:43]
  s_waitcnt lgkmcnt(15)
  ds_read_b64_tr_b16 a[176:177], v233 offset:8192
  ds_read_b64_tr_b16 a[178:179], v233 offset:10240
  v_mfma_f32_16x16x32_bf16 v[48:51], a[184:187], a[52:55], v[48:51]
  ds_read_b64_tr_b16 a[180:181], v233 offset:12288
  v_mfma_f32_16x16x32_bf16 v[48:51], a[188:191], a[60:63], v[48:51]
  buffer_load_dwordx4 a[140:143], v244, s[36:39], s50 offen offset:3072 sc1
  ds_read_b64_tr_b16 a[182:183], v233 offset:14336
  v_mfma_f32_16x16x32_bf16 v[44:47], a[188:191], a[56:59], v[44:47]
  v_mfma_f32_16x16x32_bf16 v[44:47], a[184:187], a[48:51], v[44:47]
  s_waitcnt vmcnt(16) lgkmcnt(15)
  ds_read_b64_tr_b16 a[184:185], v234 offset:8192
  ds_read_b64_tr_b16 a[186:187], v234 offset:10240
  v_mfma_f32_16x16x32_bf16 v[20:23], a[192:195], a[64:67], v[20:23]
  s_xor_b32 s50, s76, 36864
  ds_read_b64_tr_b16 a[188:189], v234 offset:12288
  v_mfma_f32_16x16x32_bf16 v[20:23], a[196:199], a[72:75], v[20:23]
  buffer_load_dwordx4 a[144:147], v244, s[36:39], s50 offen offset:0 sc1
  ds_read_b64_tr_b16 a[190:191], v234 offset:14336
  v_mfma_f32_16x16x32_bf16 v[24:27], a[196:199], a[76:79], v[24:27]
  v_mfma_f32_16x16x32_bf16 v[24:27], a[192:195], a[68:71], v[24:27]
  s_waitcnt lgkmcnt(15)
  ds_read_b64_tr_b16 a[192:193], v235 offset:8192
  ds_read_b64_tr_b16 a[194:195], v235 offset:10240
  v_mfma_f32_16x16x32_bf16 v[32:35], a[200:203], a[68:71], v[32:35]
  ds_read_b64_tr_b16 a[196:197], v235 offset:12288
  v_mfma_f32_16x16x32_bf16 v[32:35], a[204:207], a[76:79], v[32:35]
  buffer_load_dwordx4 a[148:151], v244, s[36:39], s50 offen offset:1024 sc1
  ds_read_b64_tr_b16 a[198:199], v235 offset:14336
  v_mfma_f32_16x16x32_bf16 v[28:31], a[204:207], a[72:75], v[28:31]
  v_mfma_f32_16x16x32_bf16 v[28:31], a[200:203], a[64:67], v[28:31]
  s_waitcnt lgkmcnt(15)
  ds_read_b64_tr_b16 a[200:201], v232 offset:16384
  ds_read_b64_tr_b16 a[202:203], v232 offset:18432
  v_mfma_f32_16x16x32_bf16 v[36:39], a[208:211], a[64:67], v[36:39]
  ds_read_b64_tr_b16 a[204:205], v232 offset:20480
  v_mfma_f32_16x16x32_bf16 v[36:39], a[212:215], a[72:75], v[36:39]
  buffer_load_dwordx4 a[152:155], v244, s[36:39], s50 offen offset:2048 sc1
  ds_read_b64_tr_b16 a[206:207], v232 offset:22528
  v_mfma_f32_16x16x32_bf16 v[40:43], a[212:215], a[76:79], v[40:43]
  v_mfma_f32_16x16x32_bf16 v[40:43], a[208:211], a[68:71], v[40:43]
  s_waitcnt lgkmcnt(15)
  ds_read_b64_tr_b16 a[208:209], v233 offset:16384
  ds_read_b64_tr_b16 a[210:211], v233 offset:18432
  v_mfma_f32_16x16x32_bf16 v[48:51], a[216:219], a[68:71], v[48:51]
  ds_read_b64_tr_b16 a[212:213], v233 offset:20480
  v_mfma_f32_16x16x32_bf16 v[48:51], a[220:223], a[76:79], v[48:51]
  buffer_load_dwordx4 a[156:159], v244, s[36:39], s50 offen offset:3072 sc1
  ds_read_b64_tr_b16 a[214:215], v233 offset:22528
  v_mfma_f32_16x16x32_bf16 v[44:47], a[220:223], a[72:75], v[44:47]
  v_mfma_f32_16x16x32_bf16 v[44:47], a[216:219], a[64:67], v[44:47]
  s_waitcnt vmcnt(16) lgkmcnt(15)
  ds_read_b64_tr_b16 a[216:217], v234 offset:16384
  ds_read_b64_tr_b16 a[218:219], v234 offset:18432
  v_mfma_f32_16x16x32_bf16 v[20:23], a[224:227], a[80:83], v[20:23]
  s_xor_b32 s50, s76, 40960
  ds_read_b64_tr_b16 a[220:221], v234 offset:20480
  v_mfma_f32_16x16x32_bf16 v[20:23], a[228:231], a[88:91], v[20:23]
  buffer_load_dwordx4 a[160:163], v244, s[36:39], s50 offen offset:0 sc1
  ds_read_b64_tr_b16 a[222:223], v234 offset:22528
  v_mfma_f32_16x16x32_bf16 v[24:27], a[228:231], a[92:95], v[24:27]
  v_mfma_f32_16x16x32_bf16 v[24:27], a[224:227], a[84:87], v[24:27]
  s_waitcnt lgkmcnt(15)
  ds_read_b64_tr_b16 a[224:225], v235 offset:16384
  ds_read_b64_tr_b16 a[226:227], v235 offset:18432
  v_mfma_f32_16x16x32_bf16 v[32:35], a[176:179], a[84:87], v[32:35]
  ds_read_b64_tr_b16 a[228:229], v235 offset:20480
  v_mfma_f32_16x16x32_bf16 v[32:35], a[180:183], a[92:95], v[32:35]
  buffer_load_dwordx4 a[164:167], v244, s[36:39], s50 offen offset:1024 sc1
  ds_read_b64_tr_b16 a[230:231], v235 offset:22528
  v_mfma_f32_16x16x32_bf16 v[28:31], a[180:183], a[88:91], v[28:31]
  v_mfma_f32_16x16x32_bf16 v[28:31], a[176:179], a[80:83], v[28:31]
  s_waitcnt lgkmcnt(15)
  ds_read_b64_tr_b16 a[176:177], v232 offset:24576
  ds_read_b64_tr_b16 a[178:179], v232 offset:26624
  v_mfma_f32_16x16x32_bf16 v[36:39], a[184:187], a[80:83], v[36:39]
  s_waitcnt vmcnt(27)
  v_max_u32 v15, v156, v157
  v_max3_u32 v15, v15, v158, v159
  v_mfma_f32_16x16x32_bf16 v[36:39], a[188:191], a[88:91], v[36:39]
  buffer_load_dwordx4 a[168:171], v244, s[36:39], s50 offen offset:2048 sc1
  ds_read_b64_tr_b16 a[180:181], v232 offset:28672
  v_mfma_f32_16x16x32_bf16 v[40:43], a[188:191], a[92:95], v[40:43]
  ds_read_b64_tr_b16 a[182:183], v232 offset:30720
  v_max3_u32 v15, v15, v160, v161
  v_mfma_f32_16x16x32_bf16 v[40:43], a[184:187], a[84:87], v[40:43]
  s_waitcnt lgkmcnt(15)
  ds_read_b64_tr_b16 a[184:185], v233 offset:24576
  v_max3_u32 v15, v15, v162, v163
  v_mfma_f32_16x16x32_bf16 v[48:51], a[192:195], a[84:87], v[48:51]
  ds_read_b64_tr_b16 a[186:187], v233 offset:26624
  v_max3_u32 v15, v15, v164, v165
  v_mfma_f32_16x16x32_bf16 v[48:51], a[196:199], a[92:95], v[48:51]
  buffer_load_dwordx4 a[172:175], v244, s[36:39], s50 offen offset:3072 sc1
  ds_read_b64_tr_b16 a[188:189], v233 offset:28672
  v_mfma_f32_16x16x32_bf16 v[44:47], a[196:199], a[88:91], v[44:47]
  ds_read_b64_tr_b16 a[190:191], v233 offset:30720
  v_max3_u32 v15, v15, v166, v167
  v_mfma_f32_16x16x32_bf16 v[44:47], a[192:195], a[80:83], v[44:47]
  s_waitcnt vmcnt(16) lgkmcnt(15)
  ds_read_b64_tr_b16 a[192:193], v234 offset:24576
  v_max3_u32 v15, v15, v168, v169
  v_mfma_f32_16x16x32_bf16 v[20:23], a[200:203], a[96:99], v[20:23]
  s_xor_b32 s50, s76, 45056
  ds_read_b64_tr_b16 a[194:195], v234 offset:26624
  v_max3_u32 v15, v15, v170, v171
  v_mfma_f32_16x16x32_bf16 v[20:23], a[204:207], a[104:107], v[20:23]
  buffer_load_dwordx4 a[0:3], v244, s[36:39], s50 offen offset:0 sc1
  ds_read_b64_tr_b16 a[196:197], v234 offset:28672
  v_mfma_f32_16x16x32_bf16 v[24:27], a[204:207], a[108:111], v[24:27]
  ds_read_b64_tr_b16 a[198:199], v234 offset:30720
  v_mfma_f32_16x16x32_bf16 v[24:27], a[200:203], a[100:103], v[24:27]
  s_waitcnt lgkmcnt(15)
  ds_read_b64_tr_b16 a[200:201], v235 offset:24576
  v_mfma_f32_16x16x32_bf16 v[32:35], a[208:211], a[100:103], v[32:35]
  ds_read_b64_tr_b16 a[202:203], v235 offset:26624
  v_mfma_f32_16x16x32_bf16 v[32:35], a[212:215], a[108:111], v[32:35]
  buffer_load_dwordx4 a[4:7], v244, s[36:39], s50 offen offset:1024 sc1
  ds_read_b64_tr_b16 a[204:205], v235 offset:28672
  v_mfma_f32_16x16x32_bf16 v[28:31], a[212:215], a[104:107], v[28:31]
  ds_read_b64_tr_b16 a[206:207], v235 offset:30720
  v_mfma_f32_16x16x32_bf16 v[28:31], a[208:211], a[96:99], v[28:31]
  s_waitcnt lgkmcnt(15)
  ds_read_b64_tr_b16 a[208:209], v232 offset:32768
  v_mfma_f32_16x16x32_bf16 v[36:39], a[216:219], a[96:99], v[36:39]
  ds_read_b64_tr_b16 a[210:211], v232 offset:34816
  v_mfma_f32_16x16x32_bf16 v[36:39], a[220:223], a[104:107], v[36:39]
  buffer_load_dwordx4 a[8:11], v244, s[36:39], s50 offen offset:2048 sc1
  ds_read_b64_tr_b16 a[212:213], v232 offset:36864
  v_mfma_f32_16x16x32_bf16 v[40:43], a[220:223], a[108:111], v[40:43]
  v_cmp_eq_u32 vcc, -1, v15
  s_nop 4
  s_cbranch_vccnz CK5s
CK5x:
  v_mfma_f32_16x16x32_bf16 v[40:43], a[216:219], a[100:103], v[40:43]
  s_waitcnt lgkmcnt(15)
  ds_read_b64_tr_b16 a[214:215], v232 offset:38912
  ds_read_b64_tr_b16 a[216:217], v233 offset:32768
  v_mfma_f32_16x16x32_bf16 v[48:51], a[224:227], a[100:103], v[48:51]
  ds_read_b64_tr_b16 a[218:219], v233 offset:34816
  v_add_f32 v156, v156, v164
  v_mfma_f32_16x16x32_bf16 v[48:51], a[228:231], a[108:111], v[48:51]
  buffer_load_dwordx4 a[12:15], v244, s[36:39], s50 offen offset:3072 sc1
  ds_read_b64_tr_b16 a[220:221], v233 offset:36864
  v_mfma_f32_16x16x32_bf16 v[44:47], a[228:231], a[104:107], v[44:47]
  ds_read_b64_tr_b16 a[222:223], v233 offset:38912
  v_add_f32 v157, v157, v165
  v_add_f32 v158, v158, v166
  v_add_f32 v159, v159, v167
  v_mfma_f32_16x16x32_bf16 v[44:47], a[224:227], a[96:99], v[44:47]
  s_waitcnt vmcnt(16) lgkmcnt(15)
  ds_read_b64_tr_b16 a[224:225], v232 offset:40960
  v_add_f32 v160, v160, v168
  v_add_f32 v161, v161, v169
  v_add_f32 v162, v162, v170
  v_mfma_f32_16x16x32_bf16 v[20:23], a[176:179], a[112:115], v[20:23]
  s_xor_b32 s50, s76, 49152
  ds_read_b64_tr_b16 a[226:227], v232 offset:43008
  v_add_f32 v163, v163, v171
  v_add_f32 v156, v156, v160
  v_add_f32 v157, v157, v161
  v_mfma_f32_16x16x32_bf16 v[20:23], a[180:183], a[120:123], v[20:23]
  buffer_load_dwordx4 a[16:19], v244, s[36:39], s50 offen offset:0 sc1
  ds_read_b64_tr_b16 a[228:229], v232 offset:45056
  v_add_f32 v158, v158, v162
  v_add_f32 v159, v159, v163
  v_mfma_f32_16x16x32_bf16 v[24:27], a[180:183], a[124:127], v[24:27]
  ds_read_b64_tr_b16 a[230:231], v232 offset:47104
  v_cvt_pk_bf16_f32 v160, v156, v157
  v_lshlrev_b32 v156, 16, v160
  v_and_b32 v157, 0xffff0000, v160
  v_mfma_f32_16x16x32_bf16 v[24:27], a[176:179], a[116:119], v[24:27]
  s_waitcnt lgkmcnt(15)
  ds_read_b64_tr_b16 a[176:177], v233 offset:40960
  v_cvt_pk_bf16_f32 v161, v158, v159
  v_lshlrev_b32 v158, 16, v161
  v_and_b32 v159, 0xffff0000, v161
  v_mfma_f32_16x16x32_bf16 v[32:35], a[184:187], a[116:119], v[32:35]
  ds_read_b64_tr_b16 a[178:179], v233 offset:43008
  v_add_f32 v156, v14, v156
  v_add_f32 v157, v14, v157
  v_add_f32 v158, v14, v158
  v_mfma_f32_16x16x32_bf16 v[32:35], a[188:191], a[124:127], v[32:35]
  buffer_load_dwordx4 a[20:23], v244, s[36:39], s50 offen offset:1024 sc1
  v_add_f32 v159, v14, v159
  v_cvt_pk_bf16_f32 v160, v156, v157
  v_lshlrev_b32 v156, 16, v160
  v_mfma_f32_16x16x32_bf16 v[28:31], a[188:191], a[120:123], v[28:31]
  ds_read_b64_tr_b16 a[180:181], v233 offset:45056
  v_and_b32 v157, 0xffff0000, v160
  v_cvt_pk_bf16_f32 v161, v158, v159
  v_lshlrev_b32 v158, 16, v161
  v_mfma_f32_16x16x32_bf16 v[28:31], a[184:187], a[112:115], v[28:31]
  s_waitcnt lgkmcnt(15)
  ds_read_b64_tr_b16 a[182:183], v233 offset:47104
  v_and_b32 v159, 0xffff0000, v161
  v_mfma_f32_16x16x32_bf16 v[36:39], a[192:195], a[112:115], v[36:39]
  ds_write_b128 v247, v[156:159]
  ds_read_b128 v[84:87], v245 offset:0
  v_mfma_f32_16x16x32_bf16 v[36:39], a[196:199], a[120:123], v[36:39]
  ds_read_b128 v[100:103], v245 offset:512
  ds_read_b128 v[88:91], v245 offset:64
  v_mfma_f32_16x16x32_bf16 v[40:43], a[196:199], a[124:127], v[40:43]
  ds_read_b128 v[104:107], v245 offset:576
  ds_read_b128 v[92:95], v245 offset:128
  v_mfma_f32_16x16x32_bf16 v[40:43], a[192:195], a[116:119], v[40:43]
  s_waitcnt lgkmcnt(15)
  ds_read_b128 v[108:111], v245 offset:640
  ds_read_b128 v[96:99], v245 offset:192
  v_mfma_f32_16x16x32_bf16 v[48:51], a[200:203], a[116:119], v[48:51]
  ds_read_b128 v[112:115], v245 offset:704
  ds_read_b128 v[116:119], v246 offset:512
  v_mfma_f32_16x16x32_bf16 v[48:51], a[204:207], a[124:127], v[48:51]
  ds_read_b128 v[120:123], v246 offset:576
  ds_read_b128 v[124:127], v246 offset:640
  v_mfma_f32_16x16x32_bf16 v[44:47], a[204:207], a[120:123], v[44:47]
  ds_read_b128 v[128:131], v246 offset:704
  ds_read_b64_tr_b16 a[184:185], v232 offset:49152
  v_accvgpr_write_b32 a248, v156
  v_accvgpr_write_b32 a249, v157
  v_mfma_f32_16x16x32_bf16 v[44:47], a[200:203], a[112:115], v[44:47]
  s_waitcnt vmcnt(14) lgkmcnt(15)
  buffer_load_dwordx4 a[24:27], v244, s[36:39], s50 offen offset:2048 sc1
  ds_read_b64_tr_b16 a[186:187], v232 offset:51200
  v_accvgpr_write_b32 a250, v158
  v_accvgpr_write_b32 a251, v159
  v_mfma_f32_16x16x32_bf16 v[20:23], a[208:211], a[128:131], v[20:23]
  ds_read_b64_tr_b16 a[188:189], v232 offset:53248
  ds_read_b64_tr_b16 a[190:191], v232 offset:55296
  v_mfma_f32_16x16x32_bf16 v[20:23], a[212:215], a[136:139], v[20:23]
  ds_read_b64_tr_b16 a[192:193], v233 offset:49152
  buffer_load_dwordx4 a[28:31], v244, s[36:39], s50 offen offset:3072 sc1
  s_xor_b32 s50, s76, 53248
  v_mfma_f32_16x16x32_bf16 v[24:27], a[212:215], a[140:143], v[24:27]
  ds_read_b64_tr_b16 a[194:195], v233 offset:51200
  ds_read_b64_tr_b16 a[196:197], v233 offset:53248
  v_mfma_f32_16x16x32_bf16 v[24:27], a[208:211], a[132:135], v[24:27]
  s_waitcnt lgkmcnt(15)
  ds_read_b64_tr_b16 a[198:199], v233 offset:55296
  ds_read_b64_tr_b16 a[200:201], v232 offset:57344
  v_mfma_f32_16x16x32_bf16 v[32:35], a[216:219], a[132:135], v[32:35]
  buffer_load_dwordx4 a[32:35], v244, s[36:39], s50 offen offset:0 sc1
  ds_read_b64_tr_b16 a[202:203], v232 offset:59392
  v_mfma_f32_16x16x32_bf16 v[32:35], a[220:223], a[140:143], v[32:35]
  ds_read_b64_tr_b16 a[204:205], v232 offset:61440
  buffer_load_dwordx4 a[36:39], v244, s[36:39], s50 offen offset:1024 sc1
  v_mfma_f32_16x16x32_bf16 v[28:31], a[220:223], a[136:139], v[28:31]
  ds_read_b64_tr_b16 a[206:207], v232 offset:63488
  ds_read_b64_tr_b16 a[208:209], v233 offset:57344
  v_mfma_f32_16x16x32_bf16 v[28:31], a[216:219], a[128:131], v[28:31]
  s_waitcnt vmcnt(14) lgkmcnt(15)
  buffer_load_dwordx4 a[40:43], v244, s[36:39], s50 offen offset:2048 sc1
  ds_read_b64_tr_b16 a[210:211], v233 offset:59392
  v_mfma_f32_16x16x32_bf16 v[20:23], a[224:227], a[144:147], v[20:23]
  ds_read_b64_tr_b16 a[212:213], v233 offset:61440
  buffer_load_dwordx4 a[44:47], v244, s[36:39], s50 offen offset:3072 sc1
  s_xor_b32 s50, s76, 57344
  v_mfma_f32_16x16x32_bf16 v[20:23], a[228:231], a[152:155], v[20:23]
  s_waitcnt lgkmcnt(15)
  ds_read_b64_tr_b16 a[214:215], v233 offset:63488
  ds_read_b64_tr_b16 a[216:217], v236 offset:0
  v_cvt_pk_bf16_f32 v148, v116, v117
  v_cvt_pk_bf16_f32 v149, v118, v119
  v_mfma_f32_16x16x32_bf16 v[24:27], a[228:231], a[156:159], v[24:27]
  buffer_load_dwordx4 a[48:51], v244, s[36:39], s50 offen offset:0 sc1
  ds_read_b64_tr_b16 a[218:219], v236 offset:2048
  v_cvt_pk_bf16_f32 v150, v120, v121
  v_cvt_pk_bf16_f32 v151, v122, v123
  v_mfma_f32_16x16x32_bf16 v[24:27], a[224:227], a[148:151], v[24:27]
  s_waitcnt lgkmcnt(15)
  ds_read_b64_tr_b16 a[220:221], v236 offset:4096
  buffer_load_dwordx4 a[52:55], v244, s[36:39], s50 offen offset:1024 sc1
  v_cvt_pk_bf16_f32 v152, v124, v125
  v_cvt_pk_bf16_f32 v153, v126, v127
  v_mfma_f32_16x16x32_bf16 v[32:35], a[176:179], a[148:151], v[32:35]
  ds_read_b64_tr_b16 a[222:223], v236 offset:6144
  ds_read_b64_tr_b16 a[224:225], v237 offset:0
  v_cvt_pk_bf16_f32 v154, v128, v129
  v_cvt_pk_bf16_f32 v155, v130, v131
  v_mfma_f32_16x16x32_bf16 v[32:35], a[180:183], a[156:159], v[32:35]
  buffer_load_dwordx4 a[56:59], v244, s[36:39], s50 offen offset:2048 sc1
  ds_read_b64_tr_b16 a[226:227], v237 offset:2048
  v_mfma_f32_16x16x32_bf16 v[28:31], a[180:183], a[152:155], v[28:31]
  ds_read_b64_tr_b16 a[228:229], v237 offset:4096
  v_mfma_f32_16x16x32_bf16 v[28:31], a[176:179], a[144:147], v[28:31]
  s_waitcnt vmcnt(15) lgkmcnt(15)
  buffer_load_dwordx4 a[60:63], v244, s[36:39], s50 offen offset:3072 sc1
  ds_read_b64_tr_b16 a[230:231], v237 offset:6144
  v_mfma_f32_16x16x32_bf16 v[20:23], a[184:187], a[160:163], v[20:23]
  s_xor_b32 s50, s76, 61440
  ds_read_b64_tr_b16 a[176:177], v236 offset:8192
  v_mfma_f32_16x16x32_bf16 v[20:23], a[188:191], a[168:171], v[20:23]
  buffer_load_dwordx4 a[64:67], v244, s[36:39], s50 offen offset:0 sc1
  ds_read_b64_tr_b16 a[178:179], v236 offset:10240
  v_mfma_f32_16x16x32_bf16 v[24:27], a[188:191], a[172:175], v[24:27]
  ds_read_b64_tr_b16 a[180:181], v236 offset:12288
  v_mfma_f32_16x16x32_bf16 v[24:27], a[184:187], a[164:167], v[24:27]
  s_waitcnt lgkmcnt(15)
  buffer_load_dwordx4 a[68:71], v244, s[36:39], s50 offen offset:1024 sc1
  v_mfma_f32_16x16x32_bf16 v[32:35], a[192:195], a[164:167], v[32:35]
  ds_read_b64_tr_b16 a[182:183], v236 offset:14336
  v_mfma_f32_16x16x32_bf16 v[32:35], a[196:199], a[172:175], v[32:35]
  buffer_load_dwordx4 a[72:75], v244, s[36:39], s50 offen offset:2048 sc1
  ds_read_b64_tr_b16 a[184:185], v237 offset:8192
  v_mfma_f32_16x16x32_bf16 v[28:31], a[196:199], a[168:171], v[28:31]
  ds_read_b64_tr_b16 a[186:187], v237 offset:10240
  v_mfma_f32_16x16x32_bf16 v[28:31], a[192:195], a[160:163], v[28:31]
  s_waitcnt vmcnt(15) lgkmcnt(15)
  buffer_load_dwordx4 a[76:79], v244, s[36:39], s50 offen offset:3072 sc1
  ds_read_b64_tr_b16 a[188:189], v237 offset:12288
  v_mfma_f32_16x16x32_bf16 v[20:23], a[200:203], a[0:3], v[20:23]
  ds_read_b64_tr_b16 a[190:191], v237 offset:14336
  v_mfma_f32_16x16x32_bf16 v[20:23], a[204:207], a[8:11], v[20:23]
  ds_read_b64_tr_b16 a[192:193], v236 offset:49152
  v_mfma_f32_16x16x32_bf16 v[24:27], a[204:207], a[12:15], v[24:27]
  ds_read_b64_tr_b16 a[194:195], v236 offset:51200
  v_mfma_f32_16x16x32_bf16 v[24:27], a[200:203], a[4:7], v[24:27]
  s_waitcnt lgkmcnt(15)
  ds_read_b64_tr_b16 a[196:197], v236 offset:53248
  v_mfma_f32_16x16x32_bf16 v[32:35], a[208:211], a[4:7], v[32:35]
  ds_read_b64_tr_b16 a[198:199], v236 offset:55296
  v_mfma_f32_16x16x32_bf16 v[32:35], a[212:215], a[12:15], v[32:35]
  ds_read_b64_tr_b16 a[200:201], v237 offset:49152
  v_mfma_f32_16x16x32_bf16 v[28:31], a[212:215], a[8:11], v[28:31]
  ds_read_b64_tr_b16 a[202:203], v237 offset:51200
  v_mfma_f32_16x16x32_bf16 v[28:31], a[208:211], a[0:3], v[28:31]
  s_waitcnt vmcnt(12) lgkmcnt(15)
  ds_read_b64_tr_b16 a[204:205], v237 offset:53248
  v_mfma_f32_16x16x32_bf16 v[20:23], a[216:219], a[16:19], v[20:23]
  ds_read_b64_tr_b16 a[206:207], v237 offset:55296
  v_mfma_f32_16x16x32_bf16 v[20:23], a[220:223], a[24:27], v[20:23]
  ds_read_b64_tr_b16 a[208:209], v236 offset:57344
  v_mfma_f32_16x16x32_bf16 v[24:27], a[220:223], a[28:31], v[24:27]
  ds_read_b64_tr_b16 a[210:211], v236 offset:59392
  v_mfma_f32_16x16x32_bf16 v[24:27], a[216:219], a[20:23], v[24:27]
  s_waitcnt lgkmcnt(15)
  ds_read_b64_tr_b16 a[212:213], v236 offset:61440
  v_mfma_f32_16x16x32_bf16 v[32:35], a[224:227], a[20:23], v[32:35]
  ds_read_b64_tr_b16 a[214:215], v236 offset:63488
  v_mfma_f32_16x16x32_bf16 v[32:35], a[228:231], a[28:31], v[32:35]
  ds_read_b64_tr_b16 a[216:217], v237 offset:57344
  v_mfma_f32_16x16x32_bf16 v[28:31], a[228:231], a[24:27], v[28:31]
  ds_read_b64_tr_b16 a[218:219], v237 offset:59392
  v_mfma_f32_16x16x32_bf16 v[28:31], a[224:227], a[16:19], v[28:31]
  s_waitcnt vmcnt(8) lgkmcnt(15)
  ds_read_b64_tr_b16 a[220:221], v237 offset:61440
  v_mfma_f32_16x16x32_bf16 v[20:23], a[176:179], a[32:35], v[20:23]
  ds_read_b64_tr_b16 a[222:223], v237 offset:63488
  v_mfma_f32_16x16x32_bf16 v[20:23], a[180:183], a[40:43], v[20:23]
  ds_read_b64_tr_b16 a[224:225], v234 offset:32768
  v_mfma_f32_16x16x32_bf16 v[24:27], a[180:183], a[44:47], v[24:27]
  ds_read_b64_tr_b16 a[226:227], v234 offset:34816
  v_mfma_f32_16x16x32_bf16 v[24:27], a[176:179], a[36:39], v[24:27]
  s_waitcnt lgkmcnt(15)
  ds_read_b64_tr_b16 a[228:229], v234 offset:36864
  v_mfma_f32_16x16x32_bf16 v[32:35], a[184:187], a[36:39], v[32:35]
  ds_read_b64_tr_b16 a[230:231], v234 offset:38912
  v_mfma_f32_16x16x32_bf16 v[32:35], a[188:191], a[44:47], v[32:35]
  ds_read_b64_tr_b16 a[176:177], v235 offset:32768
  v_mfma_f32_16x16x32_bf16 v[28:31], a[188:191], a[40:43], v[28:31]
  ds_read_b64_tr_b16 a[178:179], v235 offset:34816
  v_mfma_f32_16x16x32_bf16 v[28:31], a[184:187], a[32:35], v[28:31]
  s_waitcnt vmcnt(4) lgkmcnt(15)
  ds_read_b64_tr_b16 a[180:181], v235 offset:36864
  v_mfma_f32_16x16x32_bf16 v[20:23], a[192:195], a[48:51], v[20:23]
  v_mfma_f32_16x16x32_bf16 v[20:23], a[196:199], a[56:59], v[20:23]
  ds_read_b64_tr_b16 a[182:183], v235 offset:38912
  v_mfma_f32_16x16x32_bf16 v[24:27], a[196:199], a[60:63], v[24:27]
  ds_read_b64_tr_b16 a[184:185], v234 offset:40960
  v_mfma_f32_16x16x32_bf16 v[24:27], a[192:195], a[52:55], v[24:27]
  s_waitcnt lgkmcnt(15)
  ds_read_b64_tr_b16 a[186:187], v234 offset:43008
  v_mfma_f32_16x16x32_bf16 v[32:35], a[200:203], a[52:55], v[32:35]
  ds_read_b64_tr_b16 a[188:189], v234 offset:45056
  v_mfma_f32_16x16x32_bf16 v[32:35], a[204:207], a[60:63], v[32:35]
  ds_read_b64_tr_b16 a[190:191], v234 offset:47104
  v_mfma_f32_16x16x32_bf16 v[28:31], a[204:207], a[56:59], v[28:31]
  ds_read_b64_tr_b16 a[192:193], v235 offset:40960
  v_mfma_f32_16x16x32_bf16 v[28:31], a[200:203], a[48:51], v[28:31]
  s_waitcnt vmcnt(0) lgkmcnt(15)
  ds_read_b64_tr_b16 a[194:195], v235 offset:43008
  v_mfma_f32_16x16x32_bf16 v[20:23], a[208:211], a[64:67], v[20:23]
  ds_read_b64_tr_b16 a[196:197], v235 offset:45056
  v_mfma_f32_16x16x32_bf16 v[20:23], a[212:215], a[72:75], v[20:23]
  ds_read_b64_tr_b16 a[198:199], v235 offset:47104
  v_mfma_f32_16x16x32_bf16 v[24:27], a[212:215], a[76:79], v[24:27]
  ds_read_b64_tr_b16 a[200:201], v234 offset:49152
  v_mfma_f32_16x16x32_bf16 v[24:27], a[208:211], a[68:71], v[24:27]
  s_waitcnt lgkmcnt(15)
  ds_read_b64_tr_b16 a[202:203], v234 offset:51200
  v_mfma_f32_16x16x32_bf16 v[32:35], a[216:219], a[68:71], v[32:35]
  ds_read_b64_tr_b16 a[204:205], v234 offset:53248
  v_mfma_f32_16x16x32_bf16 v[32:35], a[220:223], a[76:79], v[32:35]
  ds_read_b64_tr_b16 a[206:207], v234 offset:55296
  v_mfma_f32_16x16x32_bf16 v[28:31], a[220:223], a[72:75], v[28:31]
  ds_read_b64_tr_b16 a[208:209], v235 offset:49152
  v_mfma_f32_16x16x32_bf16 v[28:31], a[216:219], a[64:67], v[28:31]
  s_waitcnt lgkmcnt(15)
  ds_read_b64_tr_b16 a[210:211], v235 offset:51200
  v_mfma_f32_16x16x32_bf16 v[36:39], a[224:227], a[128:131], v[36:39]
  s_waitcnt lgkmcnt(15)
  s_nop 3
  v_pk_fma_f32 v[68:69], v[84:85], v[24:25], v[68:69]
  v_pk_fma_f32 v[70:71], v[86:87], v[26:27], v[70:71]
  v_pk_fma_f32 v[72:73], v[88:89], v[32:33], v[72:73]
  v_pk_fma_f32 v[74:75], v[90:91], v[34:35], v[74:75]
  v_pk_mul_f32 v[24:25], v[68:69], v[100:101]
  v_pk_mul_f32 v[26:27], v[70:71], v[102:103]
  v_pk_mul_f32 v[32:33], v[72:73], v[104:105]
  v_pk_mul_f32 v[34:35], v[74:75], v[106:107]
  v_cvt_pk_bf16_f32 v140, v24, v25
  v_cvt_pk_bf16_f32 v141, v26, v27
  v_cvt_pk_bf16_f32 v142, v32, v33
  v_cvt_pk_bf16_f32 v143, v34, v35
  buffer_store_dwordx4 v[140:143], v0, s[36:39], s73 offen offset:1024 sc1
  v_pk_fma_f32 v[52:53], v[84:85], v[20:21], v[52:53]
  v_pk_fma_f32 v[54:55], v[86:87], v[22:23], v[54:55]
  v_pk_fma_f32 v[56:57], v[88:89], v[28:29], v[56:57]
  v_pk_fma_f32 v[58:59], v[90:91], v[30:31], v[58:59]
  v_pk_mul_f32 v[20:21], v[52:53], v[100:101]
  v_pk_mul_f32 v[22:23], v[54:55], v[102:103]
  v_pk_mul_f32 v[28:29], v[56:57], v[104:105]
  v_pk_mul_f32 v[30:31], v[58:59], v[106:107]
  v_cvt_pk_bf16_f32 v132, v20, v21
  v_cvt_pk_bf16_f32 v133, v22, v23
  v_cvt_pk_bf16_f32 v134, v28, v29
  v_cvt_pk_bf16_f32 v135, v30, v31
  buffer_store_dwordx4 v[132:135], v0, s[36:39], s73 offen offset:0 sc1
  ds_read_b64_tr_b16 a[212:213], v235 offset:53248
  v_mfma_f32_16x16x32_bf16 v[36:39], a[228:231], a[136:139], v[36:39]
  ds_read_b64_tr_b16 a[214:215], v235 offset:55296
  v_mfma_f32_16x16x32_bf16 v[40:43], a[228:231], a[140:143], v[40:43]
  ds_read_b64_tr_b16 a[216:217], v234 offset:57344
  v_mfma_f32_16x16x32_bf16 v[40:43], a[224:227], a[132:135], v[40:43]
  s_waitcnt lgkmcnt(15)
  ds_read_b64_tr_b16 a[218:219], v234 offset:59392
  v_mfma_f32_16x16x32_bf16 v[48:51], a[176:179], a[132:135], v[48:51]
  ds_read_b64_tr_b16 a[220:221], v234 offset:61440
  v_mfma_f32_16x16x32_bf16 v[48:51], a[180:183], a[140:143], v[48:51]
  ds_read_b64_tr_b16 a[222:223], v234 offset:63488
  v_mfma_f32_16x16x32_bf16 v[44:47], a[180:183], a[136:139], v[44:47]
  ds_read_b64_tr_b16 a[224:225], v235 offset:57344
  v_mfma_f32_16x16x32_bf16 v[44:47], a[176:179], a[128:131], v[44:47]
  s_waitcnt lgkmcnt(15)
  ds_read_b64_tr_b16 a[226:227], v235 offset:59392
  v_mfma_f32_16x16x32_bf16 v[36:39], a[184:187], a[144:147], v[36:39]
  ds_read_b64_tr_b16 a[228:229], v235 offset:61440
  buffer_store_dwordx4 v[148:151], v0, s[36:39], s75 offen sc1
  v_mfma_f32_16x16x32_bf16 v[36:39], a[188:191], a[152:155], v[36:39]
  s_add_u32 s75, s75, 16384
  buffer_store_dwordx4 v[152:155], v0, s[36:39], s75 offen sc1
  ds_read_b64_tr_b16 a[230:231], v235 offset:63488
  v_mfma_f32_16x16x32_bf16 v[40:43], a[188:191], a[156:159], v[40:43]
  ds_read_b64_tr_b16 a[176:177], v238 offset:0
  v_mfma_f32_16x16x32_bf16 v[40:43], a[184:187], a[148:151], v[40:43]
  s_waitcnt lgkmcnt(15)
  ds_read_b64_tr_b16 a[178:179], v238 offset:2048
  v_mfma_f32_16x16x32_bf16 v[48:51], a[192:195], a[148:151], v[48:51]
  ds_read_b64_tr_b16 a[180:181], v238 offset:4096
  v_mfma_f32_16x16x32_bf16 v[48:51], a[196:199], a[156:159], v[48:51]
  ds_read_b64_tr_b16 a[182:183], v238 offset:6144
  v_mfma_f32_16x16x32_bf16 v[44:47], a[196:199], a[152:155], v[44:47]
  v_mfma_f32_16x16x32_bf16 v[44:47], a[192:195], a[144:147], v[44:47]
  s_waitcnt lgkmcnt(15)
  ds_read_b64_tr_b16 a[184:185], v239 offset:0
  v_mfma_f32_16x16x32_bf16 v[36:39], a[200:203], a[160:163], v[36:39]
  ds_read_b64_tr_b16 a[186:187], v239 offset:2048
  v_mfma_f32_16x16x32_bf16 v[36:39], a[204:207], a[168:171], v[36:39]
  ds_read_b64_tr_b16 a[188:189], v239 offset:4096
  v_mfma_f32_16x16x32_bf16 v[40:43], a[204:207], a[172:175], v[40:43]
  ds_read_b64_tr_b16 a[190:191], v239 offset:6144
  v_mfma_f32_16x16x32_bf16 v[40:43], a[200:203], a[164:167], v[40:43]
  s_waitcnt lgkmcnt(15)
  ds_read_b64_tr_b16 a[192:193], v238 offset:8192
  v_mfma_f32_16x16x32_bf16 v[48:51], a[208:211], a[164:167], v[48:51]
  ds_read_b64_tr_b16 a[194:195], v238 offset:10240
  v_mfma_f32_16x16x32_bf16 v[48:51], a[212:215], a[172:175], v[48:51]
  ds_read_b64_tr_b16 a[196:197], v238 offset:12288
  v_mfma_f32_16x16x32_bf16 v[44:47], a[212:215], a[168:171], v[44:47]
  ds_read_b64_tr_b16 a[198:199], v238 offset:14336
  v_mfma_f32_16x16x32_bf16 v[44:47], a[208:211], a[160:163], v[44:47]
  s_waitcnt lgkmcnt(15)
  ds_read_b64_tr_b16 a[200:201], v239 offset:8192
  v_mfma_f32_16x16x32_bf16 v[36:39], a[216:219], a[0:3], v[36:39]
  ds_read_b64_tr_b16 a[202:203], v239 offset:10240
  v_mfma_f32_16x16x32_bf16 v[36:39], a[220:223], a[8:11], v[36:39]
  ds_read_b64_tr_b16 a[204:205], v239 offset:12288
  v_mfma_f32_16x16x32_bf16 v[40:43], a[220:223], a[12:15], v[40:43]
  ds_read_b64_tr_b16 a[206:207], v239 offset:14336
  v_mfma_f32_16x16x32_bf16 v[40:43], a[216:219], a[4:7], v[40:43]
  s_waitcnt lgkmcnt(15)
  s_bfe_u32 s56, s84, 0x30000
  s_lshl_b32 s56, s56, 2
  v_mfma_f32_16x16x32_bf16 v[48:51], a[224:227], a[4:7], v[48:51]
  s_bitcmp1_b32 s84, 3
  s_addc_u32 s56, s56, 0
  s_mul_i32 s56, s56, 229376
  v_mfma_f32_16x16x32_bf16 v[48:51], a[228:231], a[12:15], v[48:51]
Ha0_2:
  s_cbranch_execz Ra
  s_waitcnt vmcnt(2)
  s_barrier
  s_add_u32 m0, s77, 86016
  v_mfma_f32_16x16x32_bf16 v[44:47], a[228:231], a[8:11], v[44:47]
  s_mov_b64 exec, 1
  buffer_store_dword v12, v0, s[36:39], s45 offen sc1
  s_mov_b64 exec, -1
  v_mfma_f32_16x16x32_bf16 v[44:47], a[224:227], a[0:3], v[44:47]
  s_waitcnt lgkmcnt(12)
  ds_read_b64_tr_b16 a[208:209], v238 offset:49152
  ds_read_b64_tr_b16 a[210:211], v238 offset:51200
  v_mfma_f32_16x16x32_bf16 v[36:39], a[176:179], a[16:19], v[36:39]
  s_add_u32 s45, s45, -32768
  ds_read_b64_tr_b16 a[212:213], v238 offset:53248
  ds_read_b64_tr_b16 a[214:215], v238 offset:55296
  v_mfma_f32_16x16x32_bf16 v[36:39], a[180:183], a[24:27], v[36:39]
  ds_read_b64_tr_b16 a[216:217], v239 offset:49152
  buffer_load_dwordx4 v3, s[16:19], s56 offen offset:0 lds
  v_mfma_f32_16x16x32_bf16 v[40:43], a[180:183], a[28:31], v[40:43]
  ds_read_b64_tr_b16 a[218:219], v239 offset:51200
  ds_read_b64_tr_b16 a[220:221], v239 offset:53248
  v_mfma_f32_16x16x32_bf16 v[40:43], a[176:179], a[20:23], v[40:43]
  s_waitcnt lgkmcnt(15)
  ds_read_b64_tr_b16 a[222:223], v239 offset:55296
  buffer_load_dwordx4 v4, s[16:19], s56 offen offset:1024 lds
  v_mfma_f32_16x16x32_bf16 v[48:51], a[184:187], a[20:23], v[48:51]
  ds_read_b64_tr_b16 a[224:225], v238 offset:57344
  ds_read_b64_tr_b16 a[226:227], v238 offset:59392
  v_mfma_f32_16x16x32_bf16 v[48:51], a[188:191], a[28:31], v[48:51]
  ds_read_b64_tr_b16 a[228:229], v238 offset:61440
  v_mfma_f32_16x16x32_bf16 v[44:47], a[188:191], a[24:27], v[44:47]
  buffer_load_dwordx4 v5, s[16:19], s56 offen offset:2048 lds
  ds_read_b64_tr_b16 a[230:231], v238 offset:63488
  v_mfma_f32_16x16x32_bf16 v[44:47], a[184:187], a[16:19], v[44:47]
  s_waitcnt lgkmcnt(15)
  ds_read_b64_tr_b16 a[176:177], v239 offset:57344
  v_mfma_f32_16x16x32_bf16 v[36:39], a[192:195], a[32:35], v[36:39]
  ds_read_b64_tr_b16 a[178:179], v239 offset:59392
  v_mfma_f32_16x16x32_bf16 v[36:39], a[196:199], a[40:43], v[36:39]
  buffer_load_dwordx4 v6, s[16:19], s56 offen offset:3072 lds
  s_add_u32 m0, s77, 90112
  v_mfma_f32_16x16x32_bf16 v[40:43], a[196:199], a[44:47], v[40:43]
  ds_read_b64_tr_b16 a[180:181], v239 offset:61440
  ds_read_b64_tr_b16 a[182:183], v239 offset:63488
  v_mfma_f32_16x16x32_bf16 v[40:43], a[192:195], a[36:39], v[40:43]
  s_waitcnt lgkmcnt(15)
  v_mfma_f32_16x16x32_bf16 v[48:51], a[200:203], a[36:39], v[48:51]
  buffer_load_dwordx4 v7, s[16:19], s56 offen offset:0 lds
  v_mfma_f32_16x16x32_bf16 v[48:51], a[204:207], a[44:47], v[48:51]
  v_mfma_f32_16x16x32_bf16 v[44:47], a[204:207], a[40:43], v[44:47]
  v_mfma_f32_16x16x32_bf16 v[44:47], a[200:203], a[32:35], v[44:47]
  s_waitcnt lgkmcnt(12)
  buffer_load_dwordx4 v8, s[16:19], s56 offen offset:1024 lds
  v_mfma_f32_16x16x32_bf16 v[36:39], a[208:211], a[48:51], v[36:39]
  v_mfma_f32_16x16x32_bf16 v[36:39], a[212:215], a[56:59], v[36:39]
  v_mfma_f32_16x16x32_bf16 v[40:43], a[212:215], a[60:63], v[40:43]
  buffer_load_dwordx4 v9, s[16:19], s56 offen offset:2048 lds
  s_bfe_u32 s56, s84, 0x30004
  v_mfma_f32_16x16x32_bf16 v[40:43], a[208:211], a[52:55], v[40:43]
  s_waitcnt lgkmcnt(8)
  s_lshl_b32 s56, s56, 2
  s_bitcmp1_b32 s84, 7
  v_mfma_f32_16x16x32_bf16 v[48:51], a[216:219], a[52:55], v[48:51]
  s_addc_u32 s56, s56, 0
  s_mul_i32 s56, s56, 229376
  s_add_u32 m0, s77, 0
  v_mfma_f32_16x16x32_bf16 v[48:51], a[220:223], a[60:63], v[48:51]
  buffer_load_dwordx4 v3, s[16:19], s56 offen offset:0 lds
  v_mfma_f32_16x16x32_bf16 v[44:47], a[220:223], a[56:59], v[44:47]
  v_mfma_f32_16x16x32_bf16 v[44:47], a[216:219], a[48:51], v[44:47]
  s_waitcnt lgkmcnt(4)
  v_mfma_f32_16x16x32_bf16 v[36:39], a[224:227], a[64:67], v[36:39]
  buffer_load_dwordx4 v4, s[16:19], s56 offen offset:1024 lds
  v_mfma_f32_16x16x32_bf16 v[36:39], a[228:231], a[72:75], v[36:39]
  v_mfma_f32_16x16x32_bf16 v[40:43], a[228:231], a[76:79], v[40:43]
  v_mfma_f32_16x16x32_bf16 v[40:43], a[224:227], a[68:71], v[40:43]
  s_waitcnt lgkmcnt(0)
  buffer_load_dwordx4 v5, s[16:19], s56 offen offset:2048 lds
  v_mfma_f32_16x16x32_bf16 v[48:51], a[176:179], a[68:71], v[48:51]
  v_mfma_f32_16x16x32_bf16 v[48:51], a[180:183], a[76:79], v[48:51]
  v_mfma_f32_16x16x32_bf16 v[44:47], a[180:183], a[72:75], v[44:47]
  v_mfma_f32_16x16x32_bf16 v[44:47], a[176:179], a[64:67], v[44:47]
  s_bfe_u32 s57, s84, 0x40000
  s_lshl_b32 s57, s57, 13
  s_add_u32 s57, s57, s86
  s_nop 0
  v_pk_fma_f32 v[76:77], v[92:93], v[40:41], v[76:77]
  v_pk_fma_f32 v[78:79], v[94:95], v[42:43], v[78:79]
  v_pk_fma_f32 v[80:81], v[96:97], v[48:49], v[80:81]
  v_pk_fma_f32 v[82:83], v[98:99], v[50:51], v[82:83]
  buffer_load_dwordx4 v6, s[16:19], s56 offen offset:3072 lds
  v_pk_mul_f32 v[40:41], v[76:77], v[108:109]
  v_pk_mul_f32 v[42:43], v[78:79], v[110:111]
  v_pk_mul_f32 v[48:49], v[80:81], v[112:113]
  v_pk_mul_f32 v[50:51], v[82:83], v[114:115]
  s_add_u32 m0, s77, 4096
  s_nop 0
  buffer_load_dwordx4 v7, s[16:19], s56 offen offset:0 lds
  v_cvt_pk_bf16_f32 v144, v40, v41
  v_cvt_pk_bf16_f32 v145, v42, v43
  v_cvt_pk_bf16_f32 v146, v48, v49
  v_cvt_pk_bf16_f32 v147, v50, v51
  buffer_load_dwordx4 v8, s[16:19], s56 offen offset:1024 lds
  v_pk_fma_f32 v[60:61], v[92:93], v[36:37], v[60:61]
  v_pk_fma_f32 v[62:63], v[94:95], v[38:39], v[62:63]
  v_pk_fma_f32 v[64:65], v[96:97], v[44:45], v[64:65]
  v_pk_fma_f32 v[66:67], v[98:99], v[46:47], v[66:67]
  buffer_load_dwordx4 v9, s[16:19], s56 offen offset:2048 lds
  v_pk_mul_f32 v[36:37], v[60:61], v[108:109]
  v_pk_mul_f32 v[38:39], v[62:63], v[110:111]
  v_pk_mul_f32 v[44:45], v[64:65], v[112:113]
  v_pk_mul_f32 v[46:47], v[66:67], v[114:115]
  v_cvt_pk_bf16_f32 v136, v36, v37
  v_cvt_pk_bf16_f32 v137, v38, v39
  v_cvt_pk_bf16_f32 v138, v44, v45
  v_cvt_pk_bf16_f32 v139, v46, v47
  s_lshl2_add_u32 s48, s2, s44
  s_cmp_eq_u32 s48, 1
  s_cbranch_scc1 CKSs
CKSx:
  s_mov_b64 exec, 0
  s_cmp_eq_u32 s44, 1
  s_cbranch_scc1 Hb0
  s_cmp_eq_u32 s44, 2
  s_cbranch_scc1 Hb1
  s_cmp_eq_u32 s44, 3
  s_cbranch_scc1 Hb2
Rb:
  s_mov_b64 exec, -1
G3S:
  s_cmp_lg_u32 s44, 0
  s_cbranch_scc1 SM6x
  s_mov_b32 s46, 60000
  s_mov_b32 s47, 5242880
SM6:
  buffer_load_dword v13, v251, s[36:39], s47 offen sc1
  s_sub_u32 s46, s46, 1
  s_cmp_eq_u32 s46, 0
  s_waitcnt vmcnt(0)
  s_cbranch_scc1 SM6x
  v_cmp_ne_u32 vcc, s3, v13
  s_nop 4
  s_cbranch_vccnz SM6
SM6x:
  s_waitcnt vmcnt(7)
  s_barrier
  buffer_load_dwordx4 a[0:3], v0, s[36:39], s57 offen offset:0 sc1
  buffer_load_dwordx4 a[4:7], v0, s[36:39], s57 offen offset:1024 sc1
  buffer_load_dwordx4 a[8:11], v0, s[36:39], s57 offen offset:2048 sc1
  buffer_load_dwordx4 a[12:15], v0, s[36:39], s57 offen offset:3072 sc1
  s_add_u32 s57, s57, 4096
  buffer_load_dwordx4 a[16:19], v0, s[36:39], s57 offen offset:0 sc1
  buffer_load_dwordx4 a[20:23], v0, s[36:39], s57 offen offset:1024 sc1
  buffer_load_dwordx4 a[24:27], v0, s[36:39], s57 offen offset:2048 sc1
  buffer_load_dwordx4 a[28:31], v0, s[36:39], s57 offen offset:3072 sc1
  buffer_store_dwordx4 v[144:147], v0, s[36:39], s51 offen offset:1024 sc1
  buffer_store_dwordx4 v[136:139], v0, s[36:39], s51 offen offset:0 sc1
  v_pk_mul_f32 v[30:31], v[52:53], v[52:53]
  v_pk_mul_f32 v[34:35], v[68:69], v[68:69]
  v_pk_fma_f32 v[30:31], v[54:55], v[54:55], v[30:31]
  v_pk_add_f32 v[28:29], v[54:55], v[52:53]
  v_pk_fma_f32 v[34:35], v[70:71], v[70:71], v[34:35]
  v_pk_add_f32 v[32:33], v[70:71], v[68:69]
  v_pk_fma_f32 v[30:31], v[56:57], v[56:57], v[30:31]
  v_pk_add_f32 v[28:29], v[56:57], v[28:29]
  v_pk_fma_f32 v[34:35], v[72:73], v[72:73], v[34:35]
  v_pk_add_f32 v[32:33], v[72:73], v[32:33]
  v_pk_fma_f32 v[30:31], v[58:59], v[58:59], v[30:31]
  v_pk_add_f32 v[28:29], v[58:59], v[28:29]
  v_pk_fma_f32 v[34:35], v[74:75], v[74:75], v[34:35]
  v_pk_add_f32 v[32:33], v[74:75], v[32:33]
  v_pk_fma_f32 v[30:31], v[60:61], v[60:61], v[30:31]
  v_pk_add_f32 v[28:29], v[60:61], v[28:29]
  v_pk_fma_f32 v[34:35], v[76:77], v[76:77], v[34:35]
  v_pk_add_f32 v[32:33], v[76:77], v[32:33]
  v_pk_fma_f32 v[30:31], v[62:63], v[62:63], v[30:31]
  v_pk_add_f32 v[28:29], v[62:63], v[28:29]
  v_pk_fma_f32 v[34:35], v[78:79], v[78:79], v[34:35]
  v_pk_add_f32 v[32:33], v[78:79], v[32:33]
  v_pk_fma_f32 v[30:31], v[64:65], v[64:65], v[30:31]
  v_pk_add_f32 v[28:29], v[64:65], v[28:29]
  v_pk_fma_f32 v[34:35], v[80:81], v[80:81], v[34:35]
  v_pk_add_f32 v[32:33], v[80:81], v[32:33]
  v_pk_fma_f32 v[30:31], v[66:67], v[66:67], v[30:31]
  v_pk_add_f32 v[28:29], v[66:67], v[28:29]
  v_pk_fma_f32 v[34:35], v[82:83], v[82:83], v[34:35]
  v_pk_add_f32 v[32:33], v[82:83], v[32:33]
  v_add_f32 v20, v28, v29
  v_add_f32 v21, v30, v31
  v_add_f32 v22, v32, v33
  v_add_f32 v23, v34, v35
  v_mov_b32 v24, v20
  v_mov_b32 v25, v21
  v_mov_b32 v26, v22
  v_mov_b32 v27, v23
  v_permlane16_swap_b32 v20, v24
  v_permlane16_swap_b32 v21, v25
  v_permlane16_swap_b32 v22, v26
  v_permlane16_swap_b32 v23, v27
  v_pk_add_f32 v[20:21], v[20:21], v[24:25]
  v_pk_add_f32 v[22:23], v[22:23], v[26:27]
  v_mov_b32 v24, v20
  v_mov_b32 v25, v21
  v_mov_b32 v26, v22
  v_mov_b32 v27, v23
  v_permlane32_swap_b32 v20, v24
  v_permlane32_swap_b32 v21, v25
  v_permlane32_swap_b32 v22, v26
  v_permlane32_swap_b32 v23, v27
  v_pk_add_f32 v[20:21], v[20:21], v[24:25]
  v_pk_add_f32 v[22:23], v[22:23], v[26:27]
  s_mov_b64 exec, 0xffff
  buffer_store_dwordx4 v[20:23], v0, s[36:39], s74 offen sc1
  s_mov_b64 exec, -1
  v_cvt_pk_bf16_f32 v116, v52, v53
  v_cvt_pk_bf16_f32 v117, v54, v55
  v_cvt_pk_bf16_f32 v118, v56, v57
  v_cvt_pk_bf16_f32 v119, v58, v59
  v_cvt_pk_bf16_f32 v120, v60, v61
  v_cvt_pk_bf16_f32 v121, v62, v63
  v_cvt_pk_bf16_f32 v122, v64, v65
  v_cvt_pk_bf16_f32 v123, v66, v67
  v_cvt_pk_bf16_f32 v124, v68, v69
  v_cvt_pk_bf16_f32 v125, v70, v71
  v_cvt_pk_bf16_f32 v126, v72, v73
  v_cvt_pk_bf16_f32 v127, v74, v75
  v_cvt_pk_bf16_f32 v128, v76, v77
  v_cvt_pk_bf16_f32 v129, v78, v79
  v_cvt_pk_bf16_f32 v130, v80, v81
  v_cvt_pk_bf16_f32 v131, v82, v83
  v_accvgpr_write_b32 a232, v116
  v_accvgpr_write_b32 a233, v117
  v_accvgpr_write_b32 a234, v118
  v_accvgpr_write_b32 a235, v119
  v_accvgpr_write_b32 a236, v120
  v_accvgpr_write_b32 a237, v121
  v_accvgpr_write_b32 a238, v122
  v_accvgpr_write_b32 a239, v123
  v_accvgpr_write_b32 a240, v124
  v_accvgpr_write_b32 a241, v125
  v_accvgpr_write_b32 a242, v126
  v_accvgpr_write_b32 a243, v127
  v_accvgpr_write_b32 a244, v128
  v_accvgpr_write_b32 a245, v129
  v_accvgpr_write_b32 a246, v130
  v_accvgpr_write_b32 a247, v131
  v_and_b32 v30, 0x7fff, v251
  ds_read_b64_tr_b16 a[128:129], v2 offset:28672
  ds_read_b64_tr_b16 a[130:131], v2 offset:32256
  ds_read_b64_tr_b16 a[132:133], v2 offset:28704
  ds_read_b64_tr_b16 a[134:135], v2 offset:32288
  ds_read_b64_tr_b16 a[136:137], v2 offset:28736
  ds_read_b64_tr_b16 a[138:139], v2 offset:32320
  ds_read_b64_tr_b16 a[140:141], v2 offset:28768
  ds_read_b64_tr_b16 a[142:143], v2 offset:32352
  ds_read_b64_tr_b16 a[144:145], v2 offset:28800
  ds_read_b64_tr_b16 a[146:147], v2 offset:32384
  ds_read_b64_tr_b16 a[148:149], v2 offset:28832
  ds_read_b64_tr_b16 a[150:151], v2 offset:32416
  ds_read_b64_tr_b16 a[152:153], v2 offset:35840
  ds_read_b64_tr_b16 a[154:155], v2 offset:39424
  ds_read_b64_tr_b16 a[156:157], v2 offset:35872
  ds_read_b64_tr_b16 a[158:159], v2 offset:39456
  s_waitcnt vmcnt(10) lgkmcnt(12)
  v_mfma_f32_16x16x32_bf16 v[32:35], a[128:131], a[0:3], 0
  s_waitcnt vmcnt(9)
  s_bfe_u32 s57, s84, 0x40004
  s_lshl_b32 s57, s57, 13
  v_mfma_f32_16x16x32_bf16 v[36:39], a[128:131], a[4:7], 0
  s_waitcnt vmcnt(8)
  s_add_u32 s57, s57, s86
  buffer_load_dwordx4 a[32:35], v0, s[36:39], s57 offen offset:0 sc1
  v_mfma_f32_16x16x32_bf16 v[40:43], a[128:131], a[8:11], 0
  s_waitcnt vmcnt(8)
  ds_read_b64_tr_b16 a[160:161], v2 offset:35904
  v_mfma_f32_16x16x32_bf16 v[44:47], a[128:131], a[12:15], 0
  ds_read_b64_tr_b16 a[162:163], v2 offset:39488
  v_mfma_f32_16x16x32_bf16 v[60:63], a[132:135], a[12:15], 0
  ds_read_b64_tr_b16 a[164:165], v2 offset:35936
  v_mfma_f32_16x16x32_bf16 v[56:59], a[132:135], a[8:11], 0
  v_mfma_f32_16x16x32_bf16 v[52:55], a[132:135], a[4:7], 0
  buffer_load_dwordx4 a[36:39], v0, s[36:39], s57 offen offset:1024 sc1
  v_mfma_f32_16x16x32_bf16 v[48:51], a[132:135], a[0:3], 0
  s_waitcnt lgkmcnt(11)
  ds_read_b64_tr_b16 a[166:167], v2 offset:39520
  v_mfma_f32_16x16x32_bf16 v[64:67], a[136:139], a[0:3], 0
  ds_read_b64_tr_b16 a[168:169], v2 offset:35968
  v_mfma_f32_16x16x32_bf16 v[68:71], a[136:139], a[4:7], 0
  v_mfma_f32_16x16x32_bf16 v[72:75], a[136:139], a[8:11], 0
  s_mov_b32 s68, 5308416
  ds_read_b64_tr_b16 a[170:171], v2 offset:39552
  v_mfma_f32_16x16x32_bf16 v[76:79], a[136:139], a[12:15], 0
  buffer_load_dwordx4 a[40:43], v0, s[36:39], s57 offen offset:2048 sc1
  v_mfma_f32_16x16x32_bf16 v[92:95], a[140:143], a[12:15], 0
  ds_read_b64_tr_b16 a[172:173], v2 offset:36000
  v_mfma_f32_16x16x32_bf16 v[88:91], a[140:143], a[8:11], 0
  v_mfma_f32_16x16x32_bf16 v[84:87], a[140:143], a[4:7], 0
  ds_read_b64_tr_b16 a[174:175], v2 offset:39584
  v_mfma_f32_16x16x32_bf16 v[80:83], a[140:143], a[0:3], 0
  s_waitcnt lgkmcnt(12)
  v_mfma_f32_16x16x32_bf16 v[96:99], a[144:147], a[0:3], 0
  buffer_load_dwordx4 a[44:47], v0, s[36:39], s57 offen offset:3072 sc1
  s_bfe_u32 s56, s84, 0x30008
  v_mfma_f32_16x16x32_bf16 v[100:103], a[144:147], a[4:7], 0
  s_lshl_b32 s56, s56, 2
  s_bitcmp1_b32 s84, 11
  s_addc_u32 s56, s56, 0
  v_mfma_f32_16x16x32_bf16 v[104:107], a[144:147], a[8:11], 0
  s_mul_i32 s56, s56, 229376
  s_add_u32 m0, s77, 28672
  ds_read_b64_tr_b16 a[128:129], v2 offset:28864
  v_mfma_f32_16x16x32_bf16 v[108:111], a[144:147], a[12:15], 0
  ds_read_b64_tr_b16 a[130:131], v2 offset:32448
  v_mfma_f32_16x16x32_bf16 v[124:127], a[148:151], a[12:15], 0
  ds_read_b64_tr_b16 a[132:133], v2 offset:36032
  v_mfma_f32_16x16x32_bf16 v[120:123], a[148:151], a[8:11], 0
  buffer_load_dwordx4 v3, s[16:19], s56 offen offset:0 lds
  s_add_u32 s57, s57, 4096
  v_mfma_f32_16x16x32_bf16 v[116:119], a[148:151], a[4:7], 0
  ds_read_b64_tr_b16 a[134:135], v2 offset:39616
  v_mfma_f32_16x16x32_bf16 v[112:115], a[148:151], a[0:3], 0
  s_waitcnt vmcnt(8) lgkmcnt(12)
  v_mfma_f32_16x16x32_bf16 v[32:35], a[152:155], a[16:19], v[32:35]
  ds_read_b64_tr_b16 a[136:137], v2 offset:43008
  v_mfma_f32_16x16x32_bf16 v[36:39], a[152:155], a[20:23], v[36:39]
  v_mfma_f32_16x16x32_bf16 v[40:43], a[152:155], a[24:27], v[40:43]
  buffer_load_dwordx4 a[48:51], v0, s[36:39], s57 offen offset:0 sc1
  v_mfma_f32_16x16x32_bf16 v[44:47], a[152:155], a[28:31], v[44:47]
  ds_read_b64_tr_b16 a[138:139], v2 offset:46592
  v_mfma_f32_16x16x32_bf16 v[60:63], a[156:159], a[28:31], v[60:63]
  ds_read_b64_tr_b16 a[140:141], v2 offset:50176
  v_mfma_f32_16x16x32_bf16 v[56:59], a[156:159], a[24:27], v[56:59]
  v_mfma_f32_16x16x32_bf16 v[52:55], a[156:159], a[20:23], v[52:55]
  ds_read_b64_tr_b16 a[142:143], v2 offset:53760
  v_mfma_f32_16x16x32_bf16 v[48:51], a[156:159], a[16:19], v[48:51]
  s_waitcnt lgkmcnt(12)
  buffer_load_dwordx4 v4, s[16:19], s56 offen offset:1024 lds
  v_mfma_f32_16x16x32_bf16 v[64:67], a[160:163], a[16:19], v[64:67]
  ds_read_b64_tr_b16 a[144:145], v2 offset:43040
  v_mfma_f32_16x16x32_bf16 v[68:71], a[160:163], a[20:23], v[68:71]
  v_mfma_f32_16x16x32_bf16 v[72:75], a[160:163], a[24:27], v[72:75]
  ds_read_b64_tr_b16 a[146:147], v2 offset:46624
  v_mfma_f32_16x16x32_bf16 v[76:79], a[160:163], a[28:31], v[76:79]
  v_mfma_f32_16x16x32_bf16 v[92:95], a[164:167], a[28:31], v[92:95]
  buffer_load_dwordx4 a[52:55], v0, s[36:39], s57 offen offset:1024 sc1
  v_mfma_f32_16x16x32_bf16 v[88:91], a[164:167], a[24:27], v[88:91]
  ds_read_b64_tr_b16 a[148:149], v2 offset:50208
  v_mfma_f32_16x16x32_bf16 v[84:87], a[164:167], a[20:23], v[84:87]
  ds_read_b64_tr_b16 a[150:151], v2 offset:53792
  v_mfma_f32_16x16x32_bf16 v[80:83], a[164:167], a[16:19], v[80:83]
  s_waitcnt lgkmcnt(12)
  v_mfma_f32_16x16x32_bf16 v[96:99], a[168:171], a[16:19], v[96:99]
  s_bfe_u32 s59, s84, 0x40018
  s_lshl4_add_u32 s59, s58, s59
  s_lshl_b32 s59, s59, 11
  v_mfma_f32_16x16x32_bf16 v[100:103], a[168:171], a[20:23], v[100:103]
  s_add_u32 s59, s59, 5767168
  buffer_load_dwordx4 v5, s[16:19], s56 offen offset:2048 lds
  s_lshr_b32 s78, s44, 1
  v_mfma_f32_16x16x32_bf16 v[104:107], a[168:171], a[24:27], v[104:107]
  s_mul_i32 s78, s78, 14336
  ds_read_b64_tr_b16 a[152:153], v2 offset:43072
  s_and_b32 s79, s44, 1
  v_mfma_f32_16x16x32_bf16 v[108:111], a[168:171], a[28:31], v[108:111]
  s_lshl_b32 s79, s79, 7
  ds_read_b64_tr_b16 a[154:155], v2 offset:46656
  s_add_u32 s78, s78, s79
  v_mfma_f32_16x16x32_bf16 v[124:127], a[172:175], a[28:31], v[124:127]
  ds_read_b64_tr_b16 a[156:157], v2 offset:50240
  v_add_u32 v31, s78, v1
  v_mfma_f32_16x16x32_bf16 v[120:123], a[172:175], a[24:27], v[120:123]
  s_lshl_b32 s61, s2, 15
  s_lshl1_add_u32 s61, s70, s61
  s_xor_b32 s63, s61, 32768
  v_mfma_f32_16x16x32_bf16 v[116:119], a[172:175], a[20:23], v[116:119]
  s_add_u32 s61, s61, 41943040
  buffer_load_dwordx4 a[56:59], v0, s[36:39], s57 offen offset:2048 sc1
  s_add_u32 s62, s61, 4096
  v_mfma_f32_16x16x32_bf16 v[112:115], a[172:175], a[16:19], v[112:115]
  s_waitcnt lgkmcnt(7)
  ds_read_b64_tr_b16 a[158:159], v2 offset:53824
  s_add_u32 s63, s63, 41943040
  v_mfma_f32_16x16x32_bf16 v[128:131], a[128:131], a[0:3], 0
  s_add_u32 s64, s63, 4096
  ds_read_b64_tr_b16 a[160:161], v2 offset:43104
  v_mfma_f32_16x16x32_bf16 v[128:131], a[132:135], a[16:19], v[128:131]
  v_mfma_f32_16x16x32_bf16 v[132:135], a[132:135], a[20:23], 0
  ds_read_b64_tr_b16 a[162:163], v2 offset:46688
  v_mfma_f32_16x16x32_bf16 v[132:135], a[128:131], a[4:7], v[132:135]
  buffer_load_dwordx4 v6, s[16:19], s56 offen offset:3072 lds
  v_mfma_f32_16x16x32_bf16 v[136:139], a[128:131], a[8:11], 0
  ds_read_b64_tr_b16 a[164:165], v2 offset:50272
  v_mfma_f32_16x16x32_bf16 v[136:139], a[132:135], a[24:27], v[136:139]
  v_mfma_f32_16x16x32_bf16 v[140:143], a[132:135], a[28:31], 0
  ds_read_b64_tr_b16 a[166:167], v2 offset:53856
  v_mfma_f32_16x16x32_bf16 v[140:143], a[128:131], a[12:15], v[140:143]
  v_mfma_f32_16x16x32_bf16 v[156:159], a[136:139], a[12:15], 0
  buffer_load_dwordx4 a[60:63], v0, s[36:39], s57 offen offset:3072 sc1
  s_add_u32 m0, s77, 32768
  v_mfma_f32_16x16x32_bf16 v[156:159], a[140:143], a[28:31], v[156:159]
  ds_read_b64_tr_b16 a[168:169], v2 offset:43136
  v_mfma_f32_16x16x32_bf16 v[152:155], a[140:143], a[24:27], 0
  ds_read_b64_tr_b16 a[170:171], v2 offset:46720
  v_mfma_f32_16x16x32_bf16 v[152:155], a[136:139], a[8:11], v[152:155]
  v_mfma_f32_16x16x32_bf16 v[148:151], a[136:139], a[4:7], 0
  ds_read_b64_tr_b16 a[172:173], v2 offset:50304
  v_mfma_f32_16x16x32_bf16 v[148:151], a[140:143], a[20:23], v[148:151]
  buffer_load_dwordx4 v7, s[16:19], s56 offen offset:0 lds
  s_bfe_u32 s57, s84, 0x40008
  v_mfma_f32_16x16x32_bf16 v[144:147], a[140:143], a[16:19], 0
  s_lshl_b32 s57, s57, 13
  s_add_u32 s57, s57, s86
  ds_read_b64_tr_b16 a[174:175], v2 offset:53888
  v_mfma_f32_16x16x32_bf16 v[144:147], a[136:139], a[0:3], v[144:147]
  s_waitcnt lgkmcnt(8)
  v_mfma_f32_16x16x32_bf16 v[160:163], a[144:147], a[0:3], 0
  ds_read_b64_tr_b16 a[128:129], v2 offset:43168
  v_mfma_f32_16x16x32_bf16 v[160:163], a[148:151], a[16:19], v[160:163]
  s_waitcnt vmcnt(13)
  s_barrier
  v_mfma_f32_16x16x32_bf16 v[164:167], a[148:151], a[20:23], 0
  buffer_load_dwordx4 a[64:67], v0, s[36:39], s57 offen offset:0 sc1
  v_mfma_f32_16x16x32_bf16 v[164:167], a[144:147], a[4:7], v[164:167]
  s_mov_b64 exec, 1
  buffer_store_dword v12, v0, s[36:39], s45 offen sc1
  s_mov_b64 exec, -1
  v_mfma_f32_16x16x32_bf16 v[168:171], a[144:147], a[8:11], 0
  ds_read_b64_tr_b16 a[130:131], v2 offset:46752
  v_mfma_f32_16x16x32_bf16 v[168:171], a[148:151], a[24:27], v[168:171]
  ds_read_b64_tr_b16 a[132:133], v2 offset:50336
  v_mfma_f32_16x16x32_bf16 v[172:175], a[148:151], a[28:31], 0
  ds_read_b64_tr_b16 a[134:135], v2 offset:53920
  v_mfma_f32_16x16x32_bf16 v[172:175], a[144:147], a[12:15], v[172:175]
  s_waitcnt vmcnt(26)
  s_barrier
  buffer_load_dwordx4 v8, s[16:19], s56 offen offset:1024 lds
  v_mfma_f32_16x16x32_bf16 v[188:191], a[152:155], a[12:15], 0
  ds_read_b64_tr_b16 a[136:137], v2 offset:43200
  v_mfma_f32_16x16x32_bf16 v[188:191], a[156:159], a[28:31], v[188:191]
  v_mfma_f32_16x16x32_bf16 v[184:187], a[156:159], a[24:27], 0
  ds_read_b64_tr_b16 a[138:139], v2 offset:46784
  v_mfma_f32_16x16x32_bf16 v[184:187], a[152:155], a[8:11], v[184:187]
  v_mfma_f32_16x16x32_bf16 v[180:183], a[152:155], a[4:7], 0
  buffer_load_dwordx4 a[68:71], v0, s[36:39], s57 offen offset:1024 sc1
  v_mfma_f32_16x16x32_bf16 v[180:183], a[156:159], a[20:23], v[180:183]
  ds_read_b64_tr_b16 a[140:141], v2 offset:50368
  v_mfma_f32_16x16x32_bf16 v[176:179], a[156:159], a[16:19], 0
  ds_read_b64_tr_b16 a[142:143], v2 offset:53952
  v_mfma_f32_16x16x32_bf16 v[176:179], a[152:155], a[0:3], v[176:179]
  s_waitcnt lgkmcnt(8)
  v_mfma_f32_16x16x32_bf16 v[192:195], a[160:163], a[0:3], 0
  ds_read_b64_tr_b16 a[144:145], v1 offset:0
  v_mfma_f32_16x16x32_bf16 v[192:195], a[164:167], a[16:19], v[192:195]
  v_mfma_f32_16x16x32_bf16 v[196:199], a[164:167], a[20:23], 0
  ds_read_b64_tr_b16 a[146:147], v1 offset:3584
  v_mfma_f32_16x16x32_bf16 v[196:199], a[160:163], a[4:7], v[196:199]
  v_mfma_f32_16x16x32_bf16 v[200:203], a[160:163], a[8:11], 0
  ds_read_b64_tr_b16 a[148:149], v1 offset:7168
  v_mfma_f32_16x16x32_bf16 v[200:203], a[164:167], a[24:27], v[200:203]
  v_mfma_f32_16x16x32_bf16 v[204:207], a[164:167], a[28:31], 0
  buffer_load_dwordx4 v9, s[16:19], s56 offen offset:2048 lds
  v_mfma_f32_16x16x32_bf16 v[204:207], a[160:163], a[12:15], v[204:207]
  ds_read_b64_tr_b16 a[150:151], v1 offset:10752
  v_mfma_f32_16x16x32_bf16 v[220:223], a[168:171], a[12:15], 0
  ds_read_b64_tr_b16 a[152:153], v1 offset:32
  v_mfma_f32_16x16x32_bf16 v[220:223], a[172:175], a[28:31], v[220:223]
  v_mfma_f32_16x16x32_bf16 v[216:219], a[172:175], a[24:27], 0
  ds_read_b64_tr_b16 a[154:155], v1 offset:3616
  v_mfma_f32_16x16x32_bf16 v[216:219], a[168:171], a[8:11], v[216:219]
  buffer_load_dwordx4 a[72:75], v0, s[36:39], s57 offen offset:2048 sc1
  v_mfma_f32_16x16x32_bf16 v[212:215], a[168:171], a[4:7], 0
  ds_read_b64_tr_b16 a[156:157], v1 offset:7200
  v_mfma_f32_16x16x32_bf16 v[212:215], a[172:175], a[20:23], v[212:215]
  v_mfma_f32_16x16x32_bf16 v[208:211], a[172:175], a[16:19], 0
  ds_read_b64_tr_b16 a[158:159], v1 offset:10784
  v_mfma_f32_16x16x32_bf16 v[208:211], a[168:171], a[0:3], v[208:211]
  s_waitcnt lgkmcnt(8)
  v_mfma_f32_16x16x32_bf16 v[224:227], a[128:131], a[0:3], 0
  ds_read_b64_tr_b16 a[160:161], v1 offset:64
  v_mfma_f32_16x16x32_bf16 v[224:227], a[132:135], a[16:19], v[224:227]
  v_mfma_f32_16x16x32_bf16 v[228:231], a[132:135], a[20:23], 0
  ds_read_b64_tr_b16 a[162:163], v1 offset:3648
  v_mfma_f32_16x16x32_bf16 v[228:231], a[128:131], a[4:7], v[228:231]
  v_mfma_f32_16x16x32_bf16 v[232:235], a[128:131], a[8:11], 0
  ds_read_b64_tr_b16 a[164:165], v1 offset:7232
  v_mfma_f32_16x16x32_bf16 v[232:235], a[132:135], a[24:27], v[232:235]
  buffer_load_dwordx4 a[76:79], v0, s[36:39], s57 offen offset:3072 sc1
  v_mfma_f32_16x16x32_bf16 v[236:239], a[132:135], a[28:31], 0
  ds_read_b64_tr_b16 a[166:167], v1 offset:10816
  v_mfma_f32_16x16x32_bf16 v[236:239], a[128:131], a[12:15], v[236:239]
  v_mfma_f32_16x16x32_bf16 v[252:255], a[136:139], a[12:15], 0
  ds_read_b64_tr_b16 a[168:169], v1 offset:96
  v_mfma_f32_16x16x32_bf16 v[252:255], a[140:143], a[28:31], v[252:255]
  s_bfe_u32 s56, s84, 0x3000c
  s_lshl_b32 s56, s56, 2
  s_bitcmp1_b32 s84, 15
  v_mfma_f32_16x16x32_bf16 v[248:251], a[140:143], a[24:27], 0
  s_addc_u32 s56, s56, 0
  s_mul_i32 s56, s56, 229376
  s_add_u32 m0, s77, 57344
  v_mfma_f32_16x16x32_bf16 v[248:251], a[136:139], a[8:11], v[248:251]
  ds_read_b64_tr_b16 a[170:171], v1 offset:3680
  v_mfma_f32_16x16x32_bf16 v[244:247], a[136:139], a[4:7], 0
  ds_read_b64_tr_b16 a[172:173], v1 offset:7264
  v_mfma_f32_16x16x32_bf16 v[244:247], a[140:143], a[20:23], v[244:247]
  buffer_load_dwordx4 v3, s[16:19], s56 offen offset:0 lds
  v_mfma_f32_16x16x32_bf16 v[240:243], a[140:143], a[16:19], 0
  ds_read_b64_tr_b16 a[174:175], v1 offset:10848
  v_mfma_f32_16x16x32_bf16 v[240:243], a[136:139], a[0:3], v[240:243]
  s_waitcnt vmcnt(9) lgkmcnt(8)
  v_mfma_f32_16x16x32_bf16 v[32:35], a[144:147], a[32:35], v[32:35]
  s_add_u32 s57, s57, 4096
  ds_read_b64_tr_b16 a[128:129], v1 offset:128
  v_mfma_f32_16x16x32_bf16 v[32:35], a[148:151], a[48:51], v[32:35]
  v_mfma_f32_16x16x32_bf16 v[36:39], a[148:151], a[52:55], v[36:39]
  ds_read_b64_tr_b16 a[130:131], v1 offset:3712
  v_mfma_f32_16x16x32_bf16 v[36:39], a[144:147], a[36:39], v[36:39]
  v_mfma_f32_16x16x32_bf16 v[40:43], a[144:147], a[40:43], v[40:43]
  buffer_load_dwordx4 a[80:83], v0, s[36:39], s57 offen offset:0 sc1
  v_mfma_f32_16x16x32_bf16 v[40:43], a[148:151], a[56:59], v[40:43]
  ds_read_b64_tr_b16 a[132:133], v1 offset:7296
  v_mfma_f32_16x16x32_bf16 v[44:47], a[148:151], a[60:63], v[44:47]
  ds_read_b64_tr_b16 a[134:135], v1 offset:10880
  v_mfma_f32_16x16x32_bf16 v[44:47], a[144:147], a[44:47], v[44:47]
  v_mfma_f32_16x16x32_bf16 v[60:63], a[152:155], a[44:47], v[60:63]
  ds_read_b64_tr_b16 a[136:137], v1 offset:160
  v_mfma_f32_16x16x32_bf16 v[60:63], a[156:159], a[60:63], v[60:63]
  v_mfma_f32_16x16x32_bf16 v[56:59], a[156:159], a[56:59], v[56:59]
  ds_read_b64_tr_b16 a[138:139], v1 offset:3744
  v_mfma_f32_16x16x32_bf16 v[56:59], a[152:155], a[40:43], v[56:59]
  buffer_load_dwordx4 v4, s[16:19], s56 offen offset:1024 lds
  v_mfma_f32_16x16x32_bf16 v[52:55], a[152:155], a[36:39], v[52:55]
  ds_read_b64_tr_b16 a[140:141], v1 offset:7328
  v_mfma_f32_16x16x32_bf16 v[52:55], a[156:159], a[52:55], v[52:55]
  v_mfma_f32_16x16x32_bf16 v[48:51], a[156:159], a[48:51], v[48:51]
  ds_read_b64_tr_b16 a[142:143], v1 offset:10912
  v_mfma_f32_16x16x32_bf16 v[48:51], a[152:155], a[32:35], v[48:51]
  s_waitcnt lgkmcnt(8)
  v_mfma_f32_16x16x32_bf16 v[64:67], a[160:163], a[32:35], v[64:67]
  ds_read_b64_tr_b16 a[144:145], v1 offset:192
  v_mfma_f32_16x16x32_bf16 v[64:67], a[164:167], a[48:51], v[64:67]
  v_mfma_f32_16x16x32_bf16 v[68:71], a[164:167], a[52:55], v[68:71]
  ds_read_b64_tr_b16 a[146:147], v1 offset:3776
  v_mfma_f32_16x16x32_bf16 v[68:71], a[160:163], a[36:39], v[68:71]
  buffer_load_dwordx4 a[84:87], v0, s[36:39], s57 offen offset:1024 sc1
  v_mfma_f32_16x16x32_bf16 v[72:75], a[160:163], a[40:43], v[72:75]
  ds_read_b64_tr_b16 a[148:149], v1 offset:7360
  v_mfma_f32_16x16x32_bf16 v[72:75], a[164:167], a[56:59], v[72:75]
  v_mfma_f32_16x16x32_bf16 v[76:79], a[164:167], a[60:63], v[76:79]
  ds_read_b64_tr_b16 a[150:151], v1 offset:10944
  v_mfma_f32_16x16x32_bf16 v[76:79], a[160:163], a[44:47], v[76:79]
  v_mfma_f32_16x16x32_bf16 v[92:95], a[168:171], a[44:47], v[92:95]
  ds_read_b64_tr_b16 a[152:153], v1 offset:14336
  v_mfma_f32_16x16x32_bf16 v[92:95], a[172:175], a[60:63], v[92:95]
  v_mfma_f32_16x16x32_bf16 v[88:91], a[172:175], a[56:59], v[88:91]
  buffer_load_dwordx4 v5, s[16:19], s56 offen offset:2048 lds
  v_mfma_f32_16x16x32_bf16 v[88:91], a[168:171], a[40:43], v[88:91]
  ds_read_b64_tr_b16 a[154:155], v1 offset:17920
  v_mfma_f32_16x16x32_bf16 v[84:87], a[168:171], a[36:39], v[84:87]
  ds_read_b64_tr_b16 a[156:157], v1 offset:21504
  v_mfma_f32_16x16x32_bf16 v[84:87], a[172:175], a[52:55], v[84:87]
  v_mfma_f32_16x16x32_bf16 v[80:83], a[172:175], a[48:51], v[80:83]
  ds_read_b64_tr_b16 a[158:159], v1 offset:25088
  v_mfma_f32_16x16x32_bf16 v[80:83], a[168:171], a[32:35], v[80:83]
  s_waitcnt lgkmcnt(8)
  v_mfma_f32_16x16x32_bf16 v[96:99], a[128:131], a[32:35], v[96:99]
Hc0:
  s_cbranch_execz Hc0_1
  ds_read_b64_tr_b16 a[160:161], v1 offset:14368
  v_mfma_f32_16x16x32_bf16 v[96:99], a[132:135], a[48:51], v[96:99]
  v_mfma_f32_16x16x32_bf16 v[100:103], a[132:135], a[52:55], v[100:103]
  buffer_load_dwordx4 a[88:91], v0, s[36:39], s57 offen offset:2048 sc1
  v_mfma_f32_16x16x32_bf16 v[100:103], a[128:131], a[36:39], v[100:103]
  ds_read_b64_tr_b16 a[162:163], v1 offset:17952
  v_mfma_f32_16x16x32_bf16 v[104:107], a[128:131], a[40:43], v[104:107]
  ds_read_b64_tr_b16 a[164:165], v1 offset:21536
  v_mfma_f32_16x16x32_bf16 v[104:107], a[132:135], a[56:59], v[104:107]
  v_mfma_f32_16x16x32_bf16 v[108:111], a[132:135], a[60:63], v[108:111]
  ds_read_b64_tr_b16 a[166:167], v1 offset:25120
  v_mfma_f32_16x16x32_bf16 v[108:111], a[128:131], a[44:47], v[108:111]
  v_mfma_f32_16x16x32_bf16 v[124:127], a[136:139], a[44:47], v[124:127]
  ds_read_b64_tr_b16 a[168:169], v1 offset:14400
  v_mfma_f32_16x16x32_bf16 v[124:127], a[140:143], a[60:63], v[124:127]
  buffer_load_dwordx4 v6, s[16:19], s56 offen offset:3072 lds
  v_mfma_f32_16x16x32_bf16 v[120:123], a[140:143], a[56:59], v[120:123]
  ds_read_b64_tr_b16 a[170:171], v1 offset:17984
  v_mfma_f32_16x16x32_bf16 v[120:123], a[136:139], a[40:43], v[120:123]
  v_mfma_f32_16x16x32_bf16 v[116:119], a[136:139], a[36:39], v[116:119]
  ds_read_b64_tr_b16 a[172:173], v1 offset:21568
  v_mfma_f32_16x16x32_bf16 v[116:119], a[140:143], a[52:55], v[116:119]
  v_mfma_f32_16x16x32_bf16 v[112:115], a[140:143], a[48:51], v[112:115]
  ds_read_b64_tr_b16 a[174:175], v1 offset:25152
  v_mfma_f32_16x16x32_bf16 v[112:115], a[136:139], a[32:35], v[112:115]
  s_waitcnt lgkmcnt(8)
  v_mfma_f32_16x16x32_bf16 v[128:131], a[144:147], a[32:35], v[128:131]
  ds_read_b64_tr_b16 a[128:129], v1 offset:14432
  v_mfma_f32_16x16x32_bf16 v[128:131], a[148:151], a[48:51], v[128:131]
  buffer_load_dwordx4 a[92:95], v0, s[36:39], s57 offen offset:3072 sc1
  v_mfma_f32_16x16x32_bf16 v[132:135], a[148:151], a[52:55], v[132:135]
  ds_read_b64_tr_b16 a[130:131], v1 offset:18016
  v_mfma_f32_16x16x32_bf16 v[132:135], a[144:147], a[36:39], v[132:135]
  v_mfma_f32_16x16x32_bf16 v[136:139], a[144:147], a[40:43], v[136:139]
  s_add_u32 m0, s77, 61440
  ds_read_b64_tr_b16 a[132:133], v1 offset:21600
  v_mfma_f32_16x16x32_bf16 v[136:139], a[148:151], a[56:59], v[136:139]
  v_mfma_f32_16x16x32_bf16 v[140:143], a[148:151], a[60:63], v[140:143]
  ds_read_b64_tr_b16 a[134:135], v1 offset:25184
  v_mfma_f32_16x16x32_bf16 v[140:143], a[144:147], a[44:47], v[140:143]
  v_mfma_f32_16x16x32_bf16 v[156:159], a[152:155], a[44:47], v[156:159]
  buffer_load_dwordx4 v7, s[16:19], s56 offen offset:0 lds
  s_bfe_u32 s57, s84, 0x4000c
  v_mfma_f32_16x16x32_bf16 v[156:159], a[156:159], a[60:63], v[156:159]
  s_lshl_b32 s57, s57, 13
  s_add_u32 s57, s57, s86
  ds_read_b64_tr_b16 a[136:137], v1 offset:14464
  v_mfma_f32_16x16x32_bf16 v[152:155], a[156:159], a[56:59], v[152:155]
  ds_read_b64_tr_b16 a[138:139], v1 offset:18048
  v_mfma_f32_16x16x32_bf16 v[152:155], a[152:155], a[40:43], v[152:155]
  v_mfma_f32_16x16x32_bf16 v[148:151], a[152:155], a[36:39], v[148:151]
  ds_read_b64_tr_b16 a[140:141], v1 offset:21632
  v_mfma_f32_16x16x32_bf16 v[148:151], a[156:159], a[52:55], v[148:151]
  buffer_load_dwordx4 a[96:99], v0, s[36:39], s57 offen offset:0 sc1
  v_mfma_f32_16x16x32_bf16 v[144:147], a[156:159], a[48:51], v[144:147]
  ds_read_b64_tr_b16 a[142:143], v1 offset:25216
  v_mfma_f32_16x16x32_bf16 v[144:147], a[152:155], a[32:35], v[144:147]
  s_waitcnt lgkmcnt(8)
  v_mfma_f32_16x16x32_bf16 v[160:163], a[160:163], a[32:35], v[160:163]
  ds_read_b64_tr_b16 a[144:145], v1 offset:14496
  v_mfma_f32_16x16x32_bf16 v[160:163], a[164:167], a[48:51], v[160:163]
  v_mfma_f32_16x16x32_bf16 v[164:167], a[164:167], a[52:55], v[164:167]
  ds_read_b64_tr_b16 a[146:147], v1 offset:18080
  v_mfma_f32_16x16x32_bf16 v[164:167], a[160:163], a[36:39], v[164:167]
  v_mfma_f32_16x16x32_bf16 v[168:171], a[160:163], a[40:43], v[168:171]
  ds_read_b64_tr_b16 a[148:149], v1 offset:21664
  v_mfma_f32_16x16x32_bf16 v[168:171], a[164:167], a[56:59], v[168:171]
  v_mfma_f32_16x16x32_bf16 v[172:175], a[164:167], a[60:63], v[172:175]
  ds_read_b64_tr_b16 a[150:151], v1 offset:25248
  v_mfma_f32_16x16x32_bf16 v[172:175], a[160:163], a[44:47], v[172:175]
  s_waitcnt vmcnt(12)
  s_barrier
  buffer_load_dwordx4 v8, s[16:19], s56 offen offset:1024 lds
  v_mfma_f32_16x16x32_bf16 v[188:191], a[168:171], a[44:47], v[188:191]
  ds_read_b64_tr_b16 a[152:153], v1 offset:14528
  v_mfma_f32_16x16x32_bf16 v[188:191], a[172:175], a[60:63], v[188:191]
  v_mfma_f32_16x16x32_bf16 v[184:187], a[172:175], a[56:59], v[184:187]
  ds_read_b64_tr_b16 a[154:155], v1 offset:18112
  v_mfma_f32_16x16x32_bf16 v[184:187], a[168:171], a[40:43], v[184:187]
  v_mfma_f32_16x16x32_bf16 v[180:183], a[168:171], a[36:39], v[180:183]
  buffer_load_dwordx4 a[100:103], v0, s[36:39], s57 offen offset:1024 sc1
  v_mfma_f32_16x16x32_bf16 v[180:183], a[172:175], a[52:55], v[180:183]
  ds_read_b64_tr_b16 a[156:157], v1 offset:21696
  v_mfma_f32_16x16x32_bf16 v[176:179], a[172:175], a[48:51], v[176:179]
  ds_read_b64_tr_b16 a[158:159], v1 offset:25280
  v_mfma_f32_16x16x32_bf16 v[176:179], a[168:171], a[32:35], v[176:179]
  s_waitcnt lgkmcnt(8)
  v_mfma_f32_16x16x32_bf16 v[192:195], a[128:131], a[32:35], v[192:195]
  ds_read_b64_tr_b16 a[160:161], v1 offset:28672
  v_mfma_f32_16x16x32_bf16 v[192:195], a[132:135], a[48:51], v[192:195]
  v_mfma_f32_16x16x32_bf16 v[196:199], a[132:135], a[52:55], v[196:199]
  ds_read_b64_tr_b16 a[162:163], v1 offset:32256
  v_mfma_f32_16x16x32_bf16 v[196:199], a[128:131], a[36:39], v[196:199]
  v_mfma_f32_16x16x32_bf16 v[200:203], a[128:131], a[40:43], v[200:203]
  ds_read_b64_tr_b16 a[164:165], v1 offset:35840
  v_mfma_f32_16x16x32_bf16 v[200:203], a[132:135], a[56:59], v[200:203]
  v_mfma_f32_16x16x32_bf16 v[204:207], a[132:135], a[60:63], v[204:207]
  buffer_load_dwordx4 v9, s[16:19], s56 offen offset:2048 lds
  v_mfma_f32_16x16x32_bf16 v[204:207], a[128:131], a[44:47], v[204:207]
  ds_read_b64_tr_b16 a[166:167], v1 offset:39424
  v_mfma_f32_16x16x32_bf16 v[220:223], a[136:139], a[44:47], v[220:223]
  ds_read_b64_tr_b16 a[168:169], v1 offset:28704
  v_mfma_f32_16x16x32_bf16 v[220:223], a[140:143], a[60:63], v[220:223]
  v_mfma_f32_16x16x32_bf16 v[216:219], a[140:143], a[56:59], v[216:219]
  ds_read_b64_tr_b16 a[170:171], v1 offset:32288
  v_mfma_f32_16x16x32_bf16 v[216:219], a[136:139], a[40:43], v[216:219]
  buffer_load_dwordx4 a[104:107], v0, s[36:39], s57 offen offset:2048 sc1
  v_mfma_f32_16x16x32_bf16 v[212:215], a[136:139], a[36:39], v[212:215]
  ds_read_b64_tr_b16 a[172:173], v1 offset:35872
  v_mfma_f32_16x16x32_bf16 v[212:215], a[140:143], a[52:55], v[212:215]
  v_mfma_f32_16x16x32_bf16 v[208:211], a[140:143], a[48:51], v[208:211]
  ds_read_b64_tr_b16 a[174:175], v1 offset:39456
  v_mfma_f32_16x16x32_bf16 v[208:211], a[136:139], a[32:35], v[208:211]
  s_waitcnt lgkmcnt(8)
  v_mfma_f32_16x16x32_bf16 v[224:227], a[144:147], a[32:35], v[224:227]
  ds_read_b64_tr_b16 a[128:129], v1 offset:28736
  v_mfma_f32_16x16x32_bf16 v[224:227], a[148:151], a[48:51], v[224:227]
  v_mfma_f32_16x16x32_bf16 v[228:231], a[148:151], a[52:55], v[228:231]
  ds_read_b64_tr_b16 a[130:131], v1 offset:32320
  v_mfma_f32_16x16x32_bf16 v[228:231], a[144:147], a[36:39], v[228:231]
  v_mfma_f32_16x16x32_bf16 v[232:235], a[144:147], a[40:43], v[232:235]
  ds_read_b64_tr_b16 a[132:133], v1 offset:35904
  v_mfma_f32_16x16x32_bf16 v[232:235], a[148:151], a[56:59], v[232:235]
  buffer_load_dwordx4 a[108:111], v0, s[36:39], s57 offen offset:3072 sc1
  v_mfma_f32_16x16x32_bf16 v[236:239], a[148:151], a[60:63], v[236:239]
  ds_read_b64_tr_b16 a[134:135], v1 offset:39488
  v_mfma_f32_16x16x32_bf16 v[236:239], a[144:147], a[44:47], v[236:239]
  v_mfma_f32_16x16x32_bf16 v[252:255], a[152:155], a[44:47], v[252:255]
  ds_read_b64_tr_b16 a[136:137], v1 offset:28768
  v_mfma_f32_16x16x32_bf16 v[252:255], a[156:159], a[60:63], v[252:255]
  s_bfe_u32 s56, s84, 0x30010
  s_lshl_b32 s56, s56, 2
  s_bitcmp1_b32 s84, 19
  v_mfma_f32_16x16x32_bf16 v[248:251], a[156:159], a[56:59], v[248:251]
  s_addc_u32 s56, s56, 0
  s_mul_i32 s56, s56, 229376
  s_add_u32 m0, s77, 86016
  v_mfma_f32_16x16x32_bf16 v[248:251], a[152:155], a[40:43], v[248:251]
  ds_read_b64_tr_b16 a[138:139], v1 offset:32352
  v_mfma_f32_16x16x32_bf16 v[244:247], a[152:155], a[36:39], v[244:247]
  ds_read_b64_tr_b16 a[140:141], v1 offset:35936
  v_mfma_f32_16x16x32_bf16 v[244:247], a[156:159], a[52:55], v[244:247]
  buffer_load_dwordx4 v3, s[16:19], s56 offen offset:0 lds
  v_mfma_f32_16x16x32_bf16 v[240:243], a[156:159], a[48:51], v[240:243]
  ds_read_b64_tr_b16 a[142:143], v1 offset:39520
  v_mfma_f32_16x16x32_bf16 v[240:243], a[152:155], a[32:35], v[240:243]
  s_waitcnt vmcnt(8) lgkmcnt(8)
  v_mfma_f32_16x16x32_bf16 v[32:35], a[160:163], a[64:67], v[32:35]
  s_add_u32 s57, s57, 4096
  ds_read_b64_tr_b16 a[144:145], v1 offset:28800
  v_mfma_f32_16x16x32_bf16 v[32:35], a[164:167], a[80:83], v[32:35]
  v_mfma_f32_16x16x32_bf16 v[36:39], a[164:167], a[84:87], v[36:39]
  ds_read_b64_tr_b16 a[146:147], v1 offset:32384
  v_mfma_f32_16x16x32_bf16 v[36:39], a[160:163], a[68:71], v[36:39]
  v_mfma_f32_16x16x32_bf16 v[40:43], a[160:163], a[72:75], v[40:43]
  buffer_load_dwordx4 a[112:115], v0, s[36:39], s57 offen offset:0 sc1
  v_mfma_f32_16x16x32_bf16 v[40:43], a[164:167], a[88:91], v[40:43]
  ds_read_b64_tr_b16 a[148:149], v1 offset:35968
  v_mfma_f32_16x16x32_bf16 v[44:47], a[164:167], a[92:95], v[44:47]
  ds_read_b64_tr_b16 a[150:151], v1 offset:39552
  v_mfma_f32_16x16x32_bf16 v[44:47], a[160:163], a[76:79], v[44:47]
  v_mfma_f32_16x16x32_bf16 v[60:63], a[168:171], a[76:79], v[60:63]
  ds_read_b64_tr_b16 a[152:153], v1 offset:28832
  v_mfma_f32_16x16x32_bf16 v[60:63], a[172:175], a[92:95], v[60:63]
  v_mfma_f32_16x16x32_bf16 v[56:59], a[172:175], a[88:91], v[56:59]
  ds_read_b64_tr_b16 a[154:155], v1 offset:32416
  v_mfma_f32_16x16x32_bf16 v[56:59], a[168:171], a[72:75], v[56:59]
  buffer_load_dwordx4 v4, s[16:19], s56 offen offset:1024 lds
  v_mfma_f32_16x16x32_bf16 v[52:55], a[168:171], a[68:71], v[52:55]
  ds_read_b64_tr_b16 a[156:157], v1 offset:36000
  v_mfma_f32_16x16x32_bf16 v[52:55], a[172:175], a[84:87], v[52:55]
  v_mfma_f32_16x16x32_bf16 v[48:51], a[172:175], a[80:83], v[48:51]
  ds_read_b64_tr_b16 a[158:159], v1 offset:39584
  v_mfma_f32_16x16x32_bf16 v[48:51], a[168:171], a[64:67], v[48:51]
  s_waitcnt lgkmcnt(8)
  v_mfma_f32_16x16x32_bf16 v[64:67], a[128:131], a[64:67], v[64:67]
  ds_read_b64_tr_b16 a[160:161], v1 offset:28864
  v_mfma_f32_16x16x32_bf16 v[64:67], a[132:135], a[80:83], v[64:67]
  v_mfma_f32_16x16x32_bf16 v[68:71], a[132:135], a[84:87], v[68:71]
  ds_read_b64_tr_b16 a[162:163], v1 offset:32448
  v_mfma_f32_16x16x32_bf16 v[68:71], a[128:131], a[68:71], v[68:71]
  buffer_load_dwordx4 a[116:119], v0, s[36:39], s57 offen offset:1024 sc1
  v_mfma_f32_16x16x32_bf16 v[72:75], a[128:131], a[72:75], v[72:75]
  ds_read_b64_tr_b16 a[164:165], v1 offset:36032
  v_mfma_f32_16x16x32_bf16 v[72:75], a[132:135], a[88:91], v[72:75]
  v_mfma_f32_16x16x32_bf16 v[76:79], a[132:135], a[92:95], v[76:79]
  ds_read_b64_tr_b16 a[166:167], v1 offset:39616
  v_mfma_f32_16x16x32_bf16 v[76:79], a[128:131], a[76:79], v[76:79]
  v_mfma_f32_16x16x32_bf16 v[92:95], a[136:139], a[76:79], v[92:95]
  ds_read_b64_tr_b16 a[168:169], v1 offset:43008
  v_mfma_f32_16x16x32_bf16 v[92:95], a[140:143], a[92:95], v[92:95]
  v_mfma_f32_16x16x32_bf16 v[88:91], a[140:143], a[88:91], v[88:91]
  buffer_load_dwordx4 v5, s[16:19], s56 offen offset:2048 lds
  v_mfma_f32_16x16x32_bf16 v[88:91], a[136:139], a[72:75], v[88:91]
  ds_read_b64_tr_b16 a[170:171], v1 offset:46592
  v_mfma_f32_16x16x32_bf16 v[84:87], a[136:139], a[68:71], v[84:87]
  ds_read_b64_tr_b16 a[172:173], v1 offset:50176
  v_mfma_f32_16x16x32_bf16 v[84:87], a[140:143], a[84:87], v[84:87]
  v_mfma_f32_16x16x32_bf16 v[80:83], a[140:143], a[80:83], v[80:83]
  ds_read_b64_tr_b16 a[174:175], v1 offset:53760
  v_mfma_f32_16x16x32_bf16 v[80:83], a[136:139], a[64:67], v[80:83]
  s_waitcnt lgkmcnt(8)
  v_mfma_f32_16x16x32_bf16 v[96:99], a[144:147], a[64:67], v[96:99]
  ds_read_b64_tr_b16 a[128:129], v1 offset:43040
  v_mfma_f32_16x16x32_bf16 v[96:99], a[148:151], a[80:83], v[96:99]
  v_mfma_f32_16x16x32_bf16 v[100:103], a[148:151], a[84:87], v[100:103]
  buffer_load_dwordx4 a[120:123], v0, s[36:39], s57 offen offset:2048 sc1
  v_mfma_f32_16x16x32_bf16 v[100:103], a[144:147], a[68:71], v[100:103]
  ds_read_b64_tr_b16 a[130:131], v1 offset:46624
  v_mfma_f32_16x16x32_bf16 v[104:107], a[144:147], a[72:75], v[104:107]
  ds_read_b64_tr_b16 a[132:133], v1 offset:50208
  v_mfma_f32_16x16x32_bf16 v[104:107], a[148:151], a[88:91], v[104:107]
  v_mfma_f32_16x16x32_bf16 v[108:111], a[148:151], a[92:95], v[108:111]
  ds_read_b64_tr_b16 a[134:135], v1 offset:53792
  v_mfma_f32_16x16x32_bf16 v[108:111], a[144:147], a[76:79], v[108:111]
  v_mfma_f32_16x16x32_bf16 v[124:127], a[152:155], a[76:79], v[124:127]
  ds_read_b64_tr_b16 a[136:137], v1 offset:43072
  v_mfma_f32_16x16x32_bf16 v[124:127], a[156:159], a[92:95], v[124:127]
  buffer_load_dwordx4 v6, s[16:19], s56 offen offset:3072 lds
  v_mfma_f32_16x16x32_bf16 v[120:123], a[156:159], a[88:91], v[120:123]
  ds_read_b64_tr_b16 a[138:139], v1 offset:46656
  v_mfma_f32_16x16x32_bf16 v[120:123], a[152:155], a[72:75], v[120:123]
  v_mfma_f32_16x16x32_bf16 v[116:119], a[152:155], a[68:71], v[116:119]
  ds_read_b64_tr_b16 a[140:141], v1 offset:50240
  v_mfma_f32_16x16x32_bf16 v[116:119], a[156:159], a[84:87], v[116:119]
  v_mfma_f32_16x16x32_bf16 v[112:115], a[156:159], a[80:83], v[112:115]
  ds_read_b64_tr_b16 a[142:143], v1 offset:53824
  v_mfma_f32_16x16x32_bf16 v[112:115], a[152:155], a[64:67], v[112:115]
  s_waitcnt lgkmcnt(8)
  v_mfma_f32_16x16x32_bf16 v[128:131], a[160:163], a[64:67], v[128:131]
  ds_read_b64_tr_b16 a[144:145], v1 offset:43104
  v_mfma_f32_16x16x32_bf16 v[128:131], a[164:167], a[80:83], v[128:131]
  buffer_load_dwordx4 a[124:127], v0, s[36:39], s57 offen offset:3072 sc1
  v_mfma_f32_16x16x32_bf16 v[132:135], a[164:167], a[84:87], v[132:135]
  ds_read_b64_tr_b16 a[146:147], v1 offset:46688
  v_mfma_f32_16x16x32_bf16 v[132:135], a[160:163], a[68:71], v[132:135]
  v_mfma_f32_16x16x32_bf16 v[136:139], a[160:163], a[72:75], v[136:139]
  s_add_u32 m0, s77, 90112
  ds_read_b64_tr_b16 a[148:149], v1 offset:50272
  v_mfma_f32_16x16x32_bf16 v[136:139], a[164:167], a[88:91], v[136:139]
  v_mfma_f32_16x16x32_bf16 v[140:143], a[164:167], a[92:95], v[140:143]
  ds_read_b64_tr_b16 a[150:151], v1 offset:53856
  v_mfma_f32_16x16x32_bf16 v[140:143], a[160:163], a[76:79], v[140:143]
  v_mfma_f32_16x16x32_bf16 v[156:159], a[168:171], a[76:79], v[156:159]
  buffer_load_dwordx4 v7, s[16:19], s56 offen offset:0 lds
  s_bfe_u32 s57, s84, 0x40010
  v_mfma_f32_16x16x32_bf16 v[156:159], a[172:175], a[92:95], v[156:159]
  s_lshl_b32 s57, s57, 13
  s_add_u32 s57, s57, s86
  ds_read_b64_tr_b16 a[152:153], v1 offset:43136
  v_mfma_f32_16x16x32_bf16 v[152:155], a[172:175], a[88:91], v[152:155]
  ds_read_b64_tr_b16 a[154:155], v1 offset:46720
  v_mfma_f32_16x16x32_bf16 v[152:155], a[168:171], a[72:75], v[152:155]
  v_mfma_f32_16x16x32_bf16 v[148:151], a[168:171], a[68:71], v[148:151]
  ds_read_b64_tr_b16 a[156:157], v1 offset:50304
  v_mfma_f32_16x16x32_bf16 v[148:151], a[172:175], a[84:87], v[148:151]
  buffer_load_dwordx4 a[0:3], v0, s[36:39], s57 offen offset:0 sc1
  v_mfma_f32_16x16x32_bf16 v[144:147], a[172:175], a[80:83], v[144:147]
  ds_read_b64_tr_b16 a[158:159], v1 offset:53888
  v_mfma_f32_16x16x32_bf16 v[144:147], a[168:171], a[64:67], v[144:147]
  s_waitcnt lgkmcnt(8)
  v_mfma_f32_16x16x32_bf16 v[160:163], a[128:131], a[64:67], v[160:163]
  ds_read_b64_tr_b16 a[160:161], v1 offset:43168
  v_mfma_f32_16x16x32_bf16 v[160:163], a[132:135], a[80:83], v[160:163]
  v_mfma_f32_16x16x32_bf16 v[164:167], a[132:135], a[84:87], v[164:167]
  ds_read_b64_tr_b16 a[162:163], v1 offset:46752
  v_mfma_f32_16x16x32_bf16 v[164:167], a[128:131], a[68:71], v[164:167]
  v_mfma_f32_16x16x32_bf16 v[168:171], a[128:131], a[72:75], v[168:171]
  ds_read_b64_tr_b16 a[164:165], v1 offset:50336
  v_mfma_f32_16x16x32_bf16 v[168:171], a[132:135], a[88:91], v[168:171]
  v_mfma_f32_16x16x32_bf16 v[172:175], a[132:135], a[92:95], v[172:175]
  ds_read_b64_tr_b16 a[166:167], v1 offset:53920
  v_mfma_f32_16x16x32_bf16 v[172:175], a[128:131], a[76:79], v[172:175]
  s_waitcnt vmcnt(12)
  s_barrier
  buffer_load_dwordx4 v8, s[16:19], s56 offen offset:1024 lds
  v_mfma_f32_16x16x32_bf16 v[188:191], a[136:139], a[76:79], v[188:191]
  ds_read_b64_tr_b16 a[168:169], v1 offset:43200
  v_mfma_f32_16x16x32_bf16 v[188:191], a[140:143], a[92:95], v[188:191]
  v_mfma_f32_16x16x32_bf16 v[184:187], a[140:143], a[88:91], v[184:187]
  ds_read_b64_tr_b16 a[170:171], v1 offset:46784
  v_mfma_f32_16x16x32_bf16 v[184:187], a[136:139], a[72:75], v[184:187]
  v_mfma_f32_16x16x32_bf16 v[180:183], a[136:139], a[68:71], v[180:183]
  buffer_load_dwordx4 a[4:7], v0, s[36:39], s57 offen offset:1024 sc1
  v_mfma_f32_16x16x32_bf16 v[180:183], a[140:143], a[84:87], v[180:183]
  ds_read_b64_tr_b16 a[172:173], v1 offset:50368
  v_mfma_f32_16x16x32_bf16 v[176:179], a[140:143], a[80:83], v[176:179]
  ds_read_b64_tr_b16 a[174:175], v1 offset:53952
  v_mfma_f32_16x16x32_bf16 v[176:179], a[136:139], a[64:67], v[176:179]
  s_waitcnt lgkmcnt(8)
  v_mfma_f32_16x16x32_bf16 v[192:195], a[144:147], a[64:67], v[192:195]
  ds_read_b64_tr_b16 a[128:129], v2 offset:0
  v_mfma_f32_16x16x32_bf16 v[192:195], a[148:151], a[80:83], v[192:195]
  v_mfma_f32_16x16x32_bf16 v[196:199], a[148:151], a[84:87], v[196:199]
  ds_read_b64_tr_b16 a[130:131], v2 offset:3584
  v_mfma_f32_16x16x32_bf16 v[196:199], a[144:147], a[68:71], v[196:199]
  v_mfma_f32_16x16x32_bf16 v[200:203], a[144:147], a[72:75], v[200:203]
  ds_read_b64_tr_b16 a[132:133], v2 offset:7168
  v_mfma_f32_16x16x32_bf16 v[200:203], a[148:151], a[88:91], v[200:203]
  v_mfma_f32_16x16x32_bf16 v[204:207], a[148:151], a[92:95], v[204:207]
  buffer_load_dwordx4 v9, s[16:19], s56 offen offset:2048 lds
  v_mfma_f32_16x16x32_bf16 v[204:207], a[144:147], a[76:79], v[204:207]
  ds_read_b64_tr_b16 a[134:135], v2 offset:10752
  v_mfma_f32_16x16x32_bf16 v[220:223], a[152:155], a[76:79], v[220:223]
  ds_read_b64_tr_b16 a[136:137], v2 offset:32
  v_mfma_f32_16x16x32_bf16 v[220:223], a[156:159], a[92:95], v[220:223]
  v_mfma_f32_16x16x32_bf16 v[216:219], a[156:159], a[88:91], v[216:219]
  ds_read_b64_tr_b16 a[138:139], v2 offset:3616
  v_mfma_f32_16x16x32_bf16 v[216:219], a[152:155], a[72:75], v[216:219]
  buffer_load_dwordx4 a[8:11], v0, s[36:39], s57 offen offset:2048 sc1
  v_mfma_f32_16x16x32_bf16 v[212:215], a[152:155], a[68:71], v[212:215]
  ds_read_b64_tr_b16 a[140:141], v2 offset:7200
  v_mfma_f32_16x16x32_bf16 v[212:215], a[156:159], a[84:87], v[212:215]
  v_mfma_f32_16x16x32_bf16 v[208:211], a[156:159], a[80:83], v[208:211]
  ds_read_b64_tr_b16 a[142:143], v2 offset:10784
  v_mfma_f32_16x16x32_bf16 v[208:211], a[152:155], a[64:67], v[208:211]
  s_waitcnt lgkmcnt(8)
  v_mfma_f32_16x16x32_bf16 v[224:227], a[160:163], a[64:67], v[224:227]
  buffer_load_dword v29, v30, s[36:39], s68 offen sc1
  v_mfma_f32_16x16x32_bf16 v[224:227], a[164:167], a[80:83], v[224:227]
  ds_read_b64_tr_b16 a[144:145], v2 offset:64
  v_mfma_f32_16x16x32_bf16 v[228:231], a[164:167], a[84:87], v[228:231]
  ds_read_b64_tr_b16 a[146:147], v2 offset:3648
  v_mfma_f32_16x16x32_bf16 v[228:231], a[160:163], a[68:71], v[228:231]
  v_mfma_f32_16x16x32_bf16 v[232:235], a[160:163], a[72:75], v[232:235]
  ds_read_b64_tr_b16 a[148:149], v2 offset:7232
  v_mfma_f32_16x16x32_bf16 v[232:235], a[164:167], a[88:91], v[232:235]
  buffer_load_dwordx4 a[12:15], v0, s[36:39], s57 offen offset:3072 sc1
  v_mfma_f32_16x16x32_bf16 v[236:239], a[164:167], a[92:95], v[236:239]
  ds_read_b64_tr_b16 a[150:151], v2 offset:10816
  v_mfma_f32_16x16x32_bf16 v[236:239], a[160:163], a[76:79], v[236:239]
  v_mfma_f32_16x16x32_bf16 v[252:255], a[168:171], a[76:79], v[252:255]
  ds_read_b64_tr_b16 a[152:153], v2 offset:96
  v_mfma_f32_16x16x32_bf16 v[252:255], a[172:175], a[92:95], v[252:255]
  s_bfe_u32 s56, s84, 0x30014
  s_lshl_b32 s56, s56, 2
  s_bitcmp1_b32 s84, 23
  v_mfma_f32_16x16x32_bf16 v[248:251], a[172:175], a[88:91], v[248:251]
  s_addc_u32 s56, s56, 0
  s_mul_i32 s56, s56, 229376
  s_add_u32 m0, s77, 0
  v_mfma_f32_16x16x32_bf16 v[248:251], a[168:171], a[72:75], v[248:251]
  ds_read_b64_tr_b16 a[154:155], v2 offset:3680
  v_mfma_f32_16x16x32_bf16 v[244:247], a[168:171], a[68:71], v[244:247]
  ds_read_b64_tr_b16 a[156:157], v2 offset:7264
  v_mfma_f32_16x16x32_bf16 v[244:247], a[172:175], a[84:87], v[244:247]
  buffer_load_dwordx4 v3, s[16:19], s56 offen offset:0 lds
  v_mfma_f32_16x16x32_bf16 v[240:243], a[172:175], a[80:83], v[240:243]
  ds_read_b64_tr_b16 a[158:159], v2 offset:10848
  v_mfma_f32_16x16x32_bf16 v[240:243], a[168:171], a[64:67], v[240:243]
  s_waitcnt vmcnt(9) lgkmcnt(8)
  v_mfma_f32_16x16x32_bf16 v[32:35], a[128:131], a[96:99], v[32:35]
  s_add_u32 s57, s57, 4096
  ds_read_b64_tr_b16 a[160:161], v2 offset:128
  v_mfma_f32_16x16x32_bf16 v[32:35], a[132:135], a[112:115], v[32:35]
  v_mfma_f32_16x16x32_bf16 v[36:39], a[132:135], a[116:119], v[36:39]
  ds_read_b64_tr_b16 a[162:163], v2 offset:3712
  v_mfma_f32_16x16x32_bf16 v[36:39], a[128:131], a[100:103], v[36:39]
  v_mfma_f32_16x16x32_bf16 v[40:43], a[128:131], a[104:107], v[40:43]
  buffer_load_dwordx4 a[16:19], v0, s[36:39], s57 offen offset:0 sc1
  v_mfma_f32_16x16x32_bf16 v[40:43], a[132:135], a[120:123], v[40:43]
  ds_read_b64_tr_b16 a[164:165], v2 offset:7296
  v_mfma_f32_16x16x32_bf16 v[44:47], a[132:135], a[124:127], v[44:47]
  ds_read_b64_tr_b16 a[166:167], v2 offset:10880
  v_mfma_f32_16x16x32_bf16 v[44:47], a[128:131], a[108:111], v[44:47]
  v_mfma_f32_16x16x32_bf16 v[60:63], a[136:139], a[108:111], v[60:63]
  ds_read_b64_tr_b16 a[168:169], v2 offset:160
  v_mfma_f32_16x16x32_bf16 v[60:63], a[140:143], a[124:127], v[60:63]
  v_mfma_f32_16x16x32_bf16 v[56:59], a[140:143], a[120:123], v[56:59]
  ds_read_b64_tr_b16 a[170:171], v2 offset:3744
  v_mfma_f32_16x16x32_bf16 v[56:59], a[136:139], a[104:107], v[56:59]
  buffer_load_dwordx4 v4, s[16:19], s56 offen offset:1024 lds
  v_mfma_f32_16x16x32_bf16 v[52:55], a[136:139], a[100:103], v[52:55]
  ds_read_b64_tr_b16 a[172:173], v2 offset:7328
  v_mfma_f32_16x16x32_bf16 v[52:55], a[140:143], a[116:119], v[52:55]
  v_mfma_f32_16x16x32_bf16 v[48:51], a[140:143], a[112:115], v[48:51]
  ds_read_b64_tr_b16 a[174:175], v2 offset:10912
  v_mfma_f32_16x16x32_bf16 v[48:51], a[136:139], a[96:99], v[48:51]
  s_waitcnt lgkmcnt(8)
  v_mfma_f32_16x16x32_bf16 v[64:67], a[144:147], a[96:99], v[64:67]
  ds_read_b64_tr_b16 a[128:129], v2 offset:192
  v_mfma_f32_16x16x32_bf16 v[64:67], a[148:151], a[112:115], v[64:67]
  v_mfma_f32_16x16x32_bf16 v[68:71], a[148:151], a[116:119], v[68:71]
  ds_read_b64_tr_b16 a[130:131], v2 offset:3776
  v_mfma_f32_16x16x32_bf16 v[68:71], a[144:147], a[100:103], v[68:71]
  buffer_load_dwordx4 a[20:23], v0, s[36:39], s57 offen offset:1024 sc1
  v_mfma_f32_16x16x32_bf16 v[72:75], a[144:147], a[104:107], v[72:75]
  ds_read_b64_tr_b16 a[132:133], v2 offset:7360
  v_mfma_f32_16x16x32_bf16 v[72:75], a[148:151], a[120:123], v[72:75]
  v_mfma_f32_16x16x32_bf16 v[76:79], a[148:151], a[124:127], v[76:79]
  ds_read_b64_tr_b16 a[134:135], v2 offset:10944
  v_mfma_f32_16x16x32_bf16 v[76:79], a[144:147], a[108:111], v[76:79]
  v_mfma_f32_16x16x32_bf16 v[92:95], a[152:155], a[108:111], v[92:95]
  ds_read_b64_tr_b16 a[136:137], v2 offset:14336
  v_mfma_f32_16x16x32_bf16 v[92:95], a[156:159], a[124:127], v[92:95]
  v_mfma_f32_16x16x32_bf16 v[88:91], a[156:159], a[120:123], v[88:91]
  buffer_load_dwordx4 v5, s[16:19], s56 offen offset:2048 lds
  v_mfma_f32_16x16x32_bf16 v[88:91], a[152:155], a[104:107], v[88:91]
  ds_read_b64_tr_b16 a[138:139], v2 offset:17920
  v_mfma_f32_16x16x32_bf16 v[84:87], a[152:155], a[100:103], v[84:87]
  ds_read_b64_tr_b16 a[140:141], v2 offset:21504
  v_mfma_f32_16x16x32_bf16 v[84:87], a[156:159], a[116:119], v[84:87]
  v_mfma_f32_16x16x32_bf16 v[80:83], a[156:159], a[112:115], v[80:83]
  ds_read_b64_tr_b16 a[142:143], v2 offset:25088
  v_mfma_f32_16x16x32_bf16 v[80:83], a[152:155], a[96:99], v[80:83]
  s_waitcnt lgkmcnt(8)
  v_mfma_f32_16x16x32_bf16 v[96:99], a[160:163], a[96:99], v[96:99]
  ds_read_b64_tr_b16 a[144:145], v2 offset:14368
  v_mfma_f32_16x16x32_bf16 v[96:99], a[164:167], a[112:115], v[96:99]
  v_mfma_f32_16x16x32_bf16 v[100:103], a[164:167], a[116:119], v[100:103]
  buffer_load_dwordx4 a[24:27], v0, s[36:39], s57 offen offset:2048 sc1
  v_mfma_f32_16x16x32_bf16 v[100:103], a[160:163], a[100:103], v[100:103]
  ds_read_b64_tr_b16 a[146:147], v2 offset:17952
  v_mfma_f32_16x16x32_bf16 v[104:107], a[160:163], a[104:107], v[104:107]
  ds_read_b64_tr_b16 a[148:149], v2 offset:21536
  v_mfma_f32_16x16x32_bf16 v[104:107], a[164:167], a[120:123], v[104:107]
  v_mfma_f32_16x16x32_bf16 v[108:111], a[164:167], a[124:127], v[108:111]
  ds_read_b64_tr_b16 a[150:151], v2 offset:25120
  v_mfma_f32_16x16x32_bf16 v[108:111], a[160:163], a[108:111], v[108:111]
  v_mfma_f32_16x16x32_bf16 v[124:127], a[168:171], a[108:111], v[124:127]
  ds_read_b64_tr_b16 a[152:153], v2 offset:14400
  v_mfma_f32_16x16x32_bf16 v[124:127], a[172:175], a[124:127], v[124:127]
  buffer_load_dwordx4 v6, s[16:19], s56 offen offset:3072 lds
  v_mfma_f32_16x16x32_bf16 v[120:123], a[172:175], a[120:123], v[120:123]
  ds_read_b64_tr_b16 a[154:155], v2 offset:17984
  v_mfma_f32_16x16x32_bf16 v[120:123], a[168:171], a[104:107], v[120:123]
  v_mfma_f32_16x16x32_bf16 v[116:119], a[168:171], a[100:103], v[116:119]
  ds_read_b64_tr_b16 a[156:157], v2 offset:21568
  v_mfma_f32_16x16x32_bf16 v[116:119], a[172:175], a[116:119], v[116:119]
  v_mfma_f32_16x16x32_bf16 v[112:115], a[172:175], a[112:115], v[112:115]
  ds_read_b64_tr_b16 a[158:159], v2 offset:25152
  v_mfma_f32_16x16x32_bf16 v[112:115], a[168:171], a[96:99], v[112:115]
  s_waitcnt lgkmcnt(8)
  v_mfma_f32_16x16x32_bf16 v[128:131], a[128:131], a[96:99], v[128:131]
  ds_read_b64_tr_b16 a[160:161], v2 offset:14432
  v_mfma_f32_16x16x32_bf16 v[128:131], a[132:135], a[112:115], v[128:131]
  buffer_load_dwordx4 a[28:31], v0, s[36:39], s57 offen offset:3072 sc1
  v_mfma_f32_16x16x32_bf16 v[132:135], a[132:135], a[116:119], v[132:135]
  s_waitcnt vmcnt(9)
  v_cmp_ne_u32 vcc, s3, v29
  s_nop 4
  s_cbranch_vccnz CK7s
CK7x:
  v_mfma_f32_16x16x32_bf16 v[132:135], a[128:131], a[100:103], v[132:135]
  ds_read_b64_tr_b16 a[162:163], v2 offset:18016
  v_mfma_f32_16x16x32_bf16 v[136:139], a[128:131], a[104:107], v[136:139]
  s_add_u32 m0, s77, 4096
  ds_read_b64_tr_b16 a[164:165], v2 offset:21600
  v_mfma_f32_16x16x32_bf16 v[136:139], a[132:135], a[120:123], v[136:139]
  v_mfma_f32_16x16x32_bf16 v[140:143], a[132:135], a[124:127], v[140:143]
  ds_read_b64_tr_b16 a[166:167], v2 offset:25184
  v_mfma_f32_16x16x32_bf16 v[140:143], a[128:131], a[108:111], v[140:143]
  v_mfma_f32_16x16x32_bf16 v[156:159], a[136:139], a[108:111], v[156:159]
  buffer_load_dwordx4 v7, s[16:19], s56 offen offset:0 lds
  s_bfe_u32 s57, s84, 0x40014
  v_mfma_f32_16x16x32_bf16 v[156:159], a[140:143], a[124:127], v[156:159]
  s_lshl_b32 s57, s57, 13
  s_add_u32 s57, s57, s86
  ds_read_b64_tr_b16 a[168:169], v2 offset:14464
  v_mfma_f32_16x16x32_bf16 v[152:155], a[140:143], a[120:123], v[152:155]
  ds_read_b64_tr_b16 a[170:171], v2 offset:18048
  v_mfma_f32_16x16x32_bf16 v[152:155], a[136:139], a[104:107], v[152:155]
  v_mfma_f32_16x16x32_bf16 v[148:151], a[136:139], a[100:103], v[148:151]
  ds_read_b64_tr_b16 a[172:173], v2 offset:21632
  v_mfma_f32_16x16x32_bf16 v[148:151], a[140:143], a[116:119], v[148:151]
  buffer_load_dwordx4 a[32:35], v0, s[36:39], s57 offen offset:0 sc1
  v_mfma_f32_16x16x32_bf16 v[144:147], a[140:143], a[112:115], v[144:147]
  ds_read_b64_tr_b16 a[174:175], v2 offset:25216
  v_mfma_f32_16x16x32_bf16 v[144:147], a[136:139], a[96:99], v[144:147]
  s_waitcnt lgkmcnt(8)
  v_mfma_f32_16x16x32_bf16 v[160:163], a[144:147], a[96:99], v[160:163]
  ds_read_b64_tr_b16 a[128:129], v2 offset:14496
  v_mfma_f32_16x16x32_bf16 v[160:163], a[148:151], a[112:115], v[160:163]
  v_mfma_f32_16x16x32_bf16 v[164:167], a[148:151], a[116:119], v[164:167]
  ds_read_b64_tr_b16 a[130:131], v2 offset:18080
  v_mfma_f32_16x16x32_bf16 v[164:167], a[144:147], a[100:103], v[164:167]
  v_mfma_f32_16x16x32_bf16 v[168:171], a[144:147], a[104:107], v[168:171]
  ds_read_b64_tr_b16 a[132:133], v2 offset:21664
  v_mfma_f32_16x16x32_bf16 v[168:171], a[148:151], a[120:123], v[168:171]
  v_mfma_f32_16x16x32_bf16 v[172:175], a[148:151], a[124:127], v[172:175]
  ds_read_b64_tr_b16 a[134:135], v2 offset:25248
  v_mfma_f32_16x16x32_bf16 v[172:175], a[144:147], a[108:111], v[172:175]
  s_waitcnt vmcnt(13)
  s_barrier
  buffer_load_dwordx4 v8, s[16:19], s56 offen offset:1024 lds
  v_mfma_f32_16x16x32_bf16 v[188:191], a[152:155], a[108:111], v[188:191]
  ds_read_b64_tr_b16 a[136:137], v2 offset:14528
  v_mfma_f32_16x16x32_bf16 v[188:191], a[156:159], a[124:127], v[188:191]
  v_mfma_f32_16x16x32_bf16 v[184:187], a[156:159], a[120:123], v[184:187]
  ds_read_b64_tr_b16 a[138:139], v2 offset:18112
  v_mfma_f32_16x16x32_bf16 v[184:187], a[152:155], a[104:107], v[184:187]
  v_mfma_f32_16x16x32_bf16 v[180:183], a[152:155], a[100:103], v[180:183]
  buffer_load_dwordx4 a[36:39], v0, s[36:39], s57 offen offset:1024 sc1
  v_mfma_f32_16x16x32_bf16 v[180:183], a[156:159], a[116:119], v[180:183]
  ds_read_b64_tr_b16 a[140:141], v2 offset:21696
  v_mfma_f32_16x16x32_bf16 v[176:179], a[156:159], a[112:115], v[176:179]
  ds_read_b64_tr_b16 a[142:143], v2 offset:25280
  v_mfma_f32_16x16x32_bf16 v[176:179], a[152:155], a[96:99], v[176:179]
  s_waitcnt lgkmcnt(8)
  v_mfma_f32_16x16x32_bf16 v[192:195], a[160:163], a[96:99], v[192:195]
  ds_read_b64_tr_b16 a[144:145], v2 offset:28672
  v_mfma_f32_16x16x32_bf16 v[192:195], a[164:167], a[112:115], v[192:195]
  v_mfma_f32_16x16x32_bf16 v[196:199], a[164:167], a[116:119], v[196:199]
  ds_read_b64_tr_b16 a[146:147], v2 offset:32256
  v_mfma_f32_16x16x32_bf16 v[196:199], a[160:163], a[100:103], v[196:199]
  v_mfma_f32_16x16x32_bf16 v[200:203], a[160:163], a[104:107], v[200:203]
  ds_read_b64_tr_b16 a[148:149], v2 offset:35840
  v_mfma_f32_16x16x32_bf16 v[200:203], a[164:167], a[120:123], v[200:203]
  v_mfma_f32_16x16x32_bf16 v[204:207], a[164:167], a[124:127], v[204:207]
  buffer_load_dwordx4 v9, s[16:19], s56 offen offset:2048 lds
  v_mfma_f32_16x16x32_bf16 v[204:207], a[160:163], a[108:111], v[204:207]
  ds_read_b64_tr_b16 a[150:151], v2 offset:39424
  v_mfma_f32_16x16x32_bf16 v[220:223], a[168:171], a[108:111], v[220:223]
  ds_read_b64_tr_b16 a[152:153], v2 offset:28704
  v_mfma_f32_16x16x32_bf16 v[220:223], a[172:175], a[124:127], v[220:223]
  v_mfma_f32_16x16x32_bf16 v[216:219], a[172:175], a[120:123], v[216:219]
  ds_read_b64_tr_b16 a[154:155], v2 offset:32288
  v_mfma_f32_16x16x32_bf16 v[216:219], a[168:171], a[104:107], v[216:219]
  buffer_load_dwordx4 a[40:43], v0, s[36:39], s57 offen offset:2048 sc1
  v_mfma_f32_16x16x32_bf16 v[212:215], a[168:171], a[100:103], v[212:215]
  ds_read_b64_tr_b16 a[156:157], v2 offset:35872
  v_mfma_f32_16x16x32_bf16 v[212:215], a[172:175], a[116:119], v[212:215]
  v_mfma_f32_16x16x32_bf16 v[208:211], a[172:175], a[112:115], v[208:211]
  ds_read_b64_tr_b16 a[158:159], v2 offset:39456
  v_mfma_f32_16x16x32_bf16 v[208:211], a[168:171], a[96:99], v[208:211]
  s_waitcnt lgkmcnt(8)
  v_mfma_f32_16x16x32_bf16 v[224:227], a[128:131], a[96:99], v[224:227]
  ds_read_b64_tr_b16 a[160:161], v2 offset:28736
  v_mfma_f32_16x16x32_bf16 v[224:227], a[132:135], a[112:115], v[224:227]
  v_mfma_f32_16x16x32_bf16 v[228:231], a[132:135], a[116:119], v[228:231]
Hc1:
  s_cbranch_execz Hc1_1
  ds_read_b64_tr_b16 a[162:163], v2 offset:32320
  v_mfma_f32_16x16x32_bf16 v[228:231], a[128:131], a[100:103], v[228:231]
  v_mfma_f32_16x16x32_bf16 v[232:235], a[128:131], a[104:107], v[232:235]
  ds_read_b64_tr_b16 a[164:165], v2 offset:35904
  v_mfma_f32_16x16x32_bf16 v[232:235], a[132:135], a[120:123], v[232:235]
  buffer_load_dwordx4 a[44:47], v0, s[36:39], s57 offen offset:3072 sc1
  v_mfma_f32_16x16x32_bf16 v[236:239], a[132:135], a[124:127], v[236:239]
  ds_read_b64_tr_b16 a[166:167], v2 offset:39488
  v_mfma_f32_16x16x32_bf16 v[236:239], a[128:131], a[108:111], v[236:239]
  v_mfma_f32_16x16x32_bf16 v[252:255], a[136:139], a[108:111], v[252:255]
  ds_read_b64_tr_b16 a[168:169], v2 offset:28768
  v_mfma_f32_16x16x32_bf16 v[252:255], a[140:143], a[124:127], v[252:255]
  s_bfe_u32 s56, s84, 0x30018
  s_lshl_b32 s56, s56, 2
  s_bitcmp1_b32 s84, 27
  v_mfma_f32_16x16x32_bf16 v[248:251], a[140:143], a[120:123], v[248:251]
  s_addc_u32 s56, s56, 0
  s_mul_i32 s56, s56, 229376
  s_add_u32 m0, s77, 28672
  v_mfma_f32_16x16x32_bf16 v[248:251], a[136:139], a[104:107], v[248:251]
  ds_read_b64_tr_b16 a[170:171], v2 offset:32352
  v_mfma_f32_16x16x32_bf16 v[244:247], a[136:139], a[100:103], v[244:247]
  ds_read_b64_tr_b16 a[172:173], v2 offset:35936
  v_mfma_f32_16x16x32_bf16 v[244:247], a[140:143], a[116:119], v[244:247]
  buffer_load_dwordx4 v3, s[16:19], s56 offen offset:0 lds
  v_mfma_f32_16x16x32_bf16 v[240:243], a[140:143], a[112:115], v[240:243]
  ds_read_b64_tr_b16 a[174:175], v2 offset:39520
  v_mfma_f32_16x16x32_bf16 v[240:243], a[136:139], a[96:99], v[240:243]
  s_waitcnt vmcnt(8) lgkmcnt(8)
  v_mfma_f32_16x16x32_bf16 v[32:35], a[144:147], a[0:3], v[32:35]
  s_add_u32 s57, s57, 4096
  ds_read_b64_tr_b16 a[128:129], v2 offset:28800
  v_mfma_f32_16x16x32_bf16 v[32:35], a[148:151], a[16:19], v[32:35]
  v_mfma_f32_16x16x32_bf16 v[36:39], a[148:151], a[20:23], v[36:39]
  ds_read_b64_tr_b16 a[130:131], v2 offset:32384
  v_mfma_f32_16x16x32_bf16 v[36:39], a[144:147], a[4:7], v[36:39]
  v_mfma_f32_16x16x32_bf16 v[40:43], a[144:147], a[8:11], v[40:43]
  buffer_load_dwordx4 a[48:51], v0, s[36:39], s57 offen offset:0 sc1
  v_mfma_f32_16x16x32_bf16 v[40:43], a[148:151], a[24:27], v[40:43]
  ds_read_b64_tr_b16 a[132:133], v2 offset:35968
  v_mfma_f32_16x16x32_bf16 v[44:47], a[148:151], a[28:31], v[44:47]
  ds_read_b64_tr_b16 a[134:135], v2 offset:39552
  v_mfma_f32_16x16x32_bf16 v[44:47], a[144:147], a[12:15], v[44:47]
  v_mfma_f32_16x16x32_bf16 v[60:63], a[152:155], a[12:15], v[60:63]
  ds_read_b64_tr_b16 a[136:137], v2 offset:28832
  v_mfma_f32_16x16x32_bf16 v[60:63], a[156:159], a[28:31], v[60:63]
  v_mfma_f32_16x16x32_bf16 v[56:59], a[156:159], a[24:27], v[56:59]
  ds_read_b64_tr_b16 a[138:139], v2 offset:32416
  v_mfma_f32_16x16x32_bf16 v[56:59], a[152:155], a[8:11], v[56:59]
  buffer_load_dwordx4 v4, s[16:19], s56 offen offset:1024 lds
  v_mfma_f32_16x16x32_bf16 v[52:55], a[152:155], a[4:7], v[52:55]
  ds_read_b64_tr_b16 a[140:141], v2 offset:36000
  v_mfma_f32_16x16x32_bf16 v[52:55], a[156:159], a[20:23], v[52:55]
  v_mfma_f32_16x16x32_bf16 v[48:51], a[156:159], a[16:19], v[48:51]
  ds_read_b64_tr_b16 a[142:143], v2 offset:39584
  v_mfma_f32_16x16x32_bf16 v[48:51], a[152:155], a[0:3], v[48:51]
  s_waitcnt lgkmcnt(8)
  v_mfma_f32_16x16x32_bf16 v[64:67], a[160:163], a[0:3], v[64:67]
  ds_read_b64_tr_b16 a[144:145], v2 offset:28864
  v_mfma_f32_16x16x32_bf16 v[64:67], a[164:167], a[16:19], v[64:67]
  v_mfma_f32_16x16x32_bf16 v[68:71], a[164:167], a[20:23], v[68:71]
  ds_read_b64_tr_b16 a[146:147], v2 offset:32448
  v_mfma_f32_16x16x32_bf16 v[68:71], a[160:163], a[4:7], v[68:71]
  buffer_load_dwordx4 a[52:55], v0, s[36:39], s57 offen offset:1024 sc1
  v_mfma_f32_16x16x32_bf16 v[72:75], a[160:163], a[8:11], v[72:75]
  ds_read_b64_tr_b16 a[148:149], v2 offset:36032
  v_mfma_f32_16x16x32_bf16 v[72:75], a[164:167], a[24:27], v[72:75]
  v_mfma_f32_16x16x32_bf16 v[76:79], a[164:167], a[28:31], v[76:79]
  ds_read_b64_tr_b16 a[150:151], v2 offset:39616
  v_mfma_f32_16x16x32_bf16 v[76:79], a[160:163], a[12:15], v[76:79]
  v_mfma_f32_16x16x32_bf16 v[92:95], a[168:171], a[12:15], v[92:95]
  ds_read_b64_tr_b16 a[152:153], v2 offset:43008
  v_mfma_f32_16x16x32_bf16 v[92:95], a[172:175], a[28:31], v[92:95]
  v_mfma_f32_16x16x32_bf16 v[88:91], a[172:175], a[24:27], v[88:91]
  buffer_load_dwordx4 v5, s[16:19], s56 offen offset:2048 lds
  v_mfma_f32_16x16x32_bf16 v[88:91], a[168:171], a[8:11], v[88:91]
  ds_read_b64_tr_b16 a[154:155], v2 offset:46592
  v_mfma_f32_16x16x32_bf16 v[84:87], a[168:171], a[4:7], v[84:87]
  ds_read_b64_tr_b16 a[156:157], v2 offset:50176
  v_mfma_f32_16x16x32_bf16 v[84:87], a[172:175], a[20:23], v[84:87]
  v_mfma_f32_16x16x32_bf16 v[80:83], a[172:175], a[16:19], v[80:83]
  ds_read_b64_tr_b16 a[158:159], v2 offset:53760
  v_mfma_f32_16x16x32_bf16 v[80:83], a[168:171], a[0:3], v[80:83]
  s_waitcnt lgkmcnt(8)
  v_mfma_f32_16x16x32_bf16 v[96:99], a[128:131], a[0:3], v[96:99]
  ds_read_b64_tr_b16 a[160:161], v2 offset:43040
  v_mfma_f32_16x16x32_bf16 v[96:99], a[132:135], a[16:19], v[96:99]
  v_mfma_f32_16x16x32_bf16 v[100:103], a[132:135], a[20:23], v[100:103]
  buffer_load_dwordx4 a[56:59], v0, s[36:39], s57 offen offset:2048 sc1
  v_mfma_f32_16x16x32_bf16 v[100:103], a[128:131], a[4:7], v[100:103]
  ds_read_b64_tr_b16 a[162:163], v2 offset:46624
  v_mfma_f32_16x16x32_bf16 v[104:107], a[128:131], a[8:11], v[104:107]
  ds_read_b64_tr_b16 a[164:165], v2 offset:50208
  v_mfma_f32_16x16x32_bf16 v[104:107], a[132:135], a[24:27], v[104:107]
  v_mfma_f32_16x16x32_bf16 v[108:111], a[132:135], a[28:31], v[108:111]
  ds_read_b64_tr_b16 a[166:167], v2 offset:53792
  v_mfma_f32_16x16x32_bf16 v[108:111], a[128:131], a[12:15], v[108:111]
  v_mfma_f32_16x16x32_bf16 v[124:127], a[136:139], a[12:15], v[124:127]
  ds_read_b64_tr_b16 a[168:169], v2 offset:43072
  v_mfma_f32_16x16x32_bf16 v[124:127], a[140:143], a[28:31], v[124:127]
  buffer_load_dwordx4 v6, s[16:19], s56 offen offset:3072 lds
  v_mfma_f32_16x16x32_bf16 v[120:123], a[140:143], a[24:27], v[120:123]
  ds_read_b64_tr_b16 a[170:171], v2 offset:46656
  v_mfma_f32_16x16x32_bf16 v[120:123], a[136:139], a[8:11], v[120:123]
  v_mfma_f32_16x16x32_bf16 v[116:119], a[136:139], a[4:7], v[116:119]
  ds_read_b64_tr_b16 a[172:173], v2 offset:50240
  v_mfma_f32_16x16x32_bf16 v[116:119], a[140:143], a[20:23], v[116:119]
  v_mfma_f32_16x16x32_bf16 v[112:115], a[140:143], a[16:19], v[112:115]
  ds_read_b64_tr_b16 a[174:175], v2 offset:53824
  v_mfma_f32_16x16x32_bf16 v[112:115], a[136:139], a[0:3], v[112:115]
  s_waitcnt lgkmcnt(8)
  v_mfma_f32_16x16x32_bf16 v[128:131], a[144:147], a[0:3], v[128:131]
  ds_read_b64_tr_b16 a[128:129], v2 offset:43104
  v_mfma_f32_16x16x32_bf16 v[128:131], a[148:151], a[16:19], v[128:131]
  buffer_load_dwordx4 a[60:63], v0, s[36:39], s57 offen offset:3072 sc1
  v_mfma_f32_16x16x32_bf16 v[132:135], a[148:151], a[20:23], v[132:135]
  ds_read_b64_tr_b16 a[130:131], v2 offset:46688
  v_mfma_f32_16x16x32_bf16 v[132:135], a[144:147], a[4:7], v[132:135]
  v_mfma_f32_16x16x32_bf16 v[136:139], a[144:147], a[8:11], v[136:139]
  s_add_u32 m0, s77, 32768
  ds_read_b64_tr_b16 a[132:133], v2 offset:50272
  v_mfma_f32_16x16x32_bf16 v[136:139], a[148:151], a[24:27], v[136:139]
  v_mfma_f32_16x16x32_bf16 v[140:143], a[148:151], a[28:31], v[140:143]
  ds_read_b64_tr_b16 a[134:135], v2 offset:53856
  v_mfma_f32_16x16x32_bf16 v[140:143], a[144:147], a[12:15], v[140:143]
  v_mfma_f32_16x16x32_bf16 v[156:159], a[152:155], a[12:15], v[156:159]
  buffer_load_dwordx4 v7, s[16:19], s56 offen offset:0 lds
  s_bfe_u32 s57, s84, 0x40018
  v_mfma_f32_16x16x32_bf16 v[156:159], a[156:159], a[28:31], v[156:159]
  s_lshl_b32 s57, s57, 13
  s_add_u32 s57, s57, s86
  ds_read_b64_tr_b16 a[136:137], v2 offset:43136
  v_mfma_f32_16x16x32_bf16 v[152:155], a[156:159], a[24:27], v[152:155]
  ds_read_b64_tr_b16 a[138:139], v2 offset:46720
  v_mfma_f32_16x16x32_bf16 v[152:155], a[152:155], a[8:11], v[152:155]
  v_mfma_f32_16x16x32_bf16 v[148:151], a[152:155], a[4:7], v[148:151]
  ds_read_b64_tr_b16 a[140:141], v2 offset:50304
  v_mfma_f32_16x16x32_bf16 v[148:151], a[156:159], a[20:23], v[148:151]
  buffer_load_dwordx4 a[64:67], v0, s[36:39], s57 offen offset:0 sc1
  v_mfma_f32_16x16x32_bf16 v[144:147], a[156:159], a[16:19], v[144:147]
  ds_read_b64_tr_b16 a[142:143], v2 offset:53888
  v_mfma_f32_16x16x32_bf16 v[144:147], a[152:155], a[0:3], v[144:147]
  s_waitcnt lgkmcnt(8)
  v_mfma_f32_16x16x32_bf16 v[160:163], a[160:163], a[0:3], v[160:163]
  ds_read_b64_tr_b16 a[144:145], v2 offset:43168
  v_mfma_f32_16x16x32_bf16 v[160:163], a[164:167], a[16:19], v[160:163]
  v_mfma_f32_16x16x32_bf16 v[164:167], a[164:167], a[20:23], v[164:167]
  ds_read_b64_tr_b16 a[146:147], v2 offset:46752
  v_mfma_f32_16x16x32_bf16 v[164:167], a[160:163], a[4:7], v[164:167]
  v_mfma_f32_16x16x32_bf16 v[168:171], a[160:163], a[8:11], v[168:171]
  ds_read_b64_tr_b16 a[148:149], v2 offset:50336
  v_mfma_f32_16x16x32_bf16 v[168:171], a[164:167], a[24:27], v[168:171]
  v_mfma_f32_16x16x32_bf16 v[172:175], a[164:167], a[28:31], v[172:175]
  ds_read_b64_tr_b16 a[150:151], v2 offset:53920
  v_mfma_f32_16x16x32_bf16 v[172:175], a[160:163], a[12:15], v[172:175]
  s_waitcnt vmcnt(12)
  s_barrier
  buffer_load_dwordx4 v8, s[16:19], s56 offen offset:1024 lds
  v_mfma_f32_16x16x32_bf16 v[188:191], a[168:171], a[12:15], v[188:191]
  ds_read_b64_tr_b16 a[152:153], v2 offset:43200
  v_mfma_f32_16x16x32_bf16 v[188:191], a[172:175], a[28:31], v[188:191]
  v_mfma_f32_16x16x32_bf16 v[184:187], a[172:175], a[24:27], v[184:187]
  ds_read_b64_tr_b16 a[154:155], v2 offset:46784
  v_mfma_f32_16x16x32_bf16 v[184:187], a[168:171], a[8:11], v[184:187]
  v_mfma_f32_16x16x32_bf16 v[180:183], a[168:171], a[4:7], v[180:183]
  buffer_load_dwordx4 a[68:71], v0, s[36:39], s57 offen offset:1024 sc1
  v_mfma_f32_16x16x32_bf16 v[180:183], a[172:175], a[20:23], v[180:183]
  ds_read_b64_tr_b16 a[156:157], v2 offset:50368
  v_mfma_f32_16x16x32_bf16 v[176:179], a[172:175], a[16:19], v[176:179]
  ds_read_b64_tr_b16 a[158:159], v2 offset:53952
  v_mfma_f32_16x16x32_bf16 v[176:179], a[168:171], a[0:3], v[176:179]
  s_waitcnt lgkmcnt(8)
  v_mfma_f32_16x16x32_bf16 v[192:195], a[128:131], a[0:3], v[192:195]
  ds_read_b64_tr_b16 a[160:161], v1 offset:0
  v_mfma_f32_16x16x32_bf16 v[192:195], a[132:135], a[16:19], v[192:195]
  v_mfma_f32_16x16x32_bf16 v[196:199], a[132:135], a[20:23], v[196:199]
  ds_read_b64_tr_b16 a[162:163], v1 offset:3584
  v_mfma_f32_16x16x32_bf16 v[196:199], a[128:131], a[4:7], v[196:199]
  v_mfma_f32_16x16x32_bf16 v[200:203], a[128:131], a[8:11], v[200:203]
  ds_read_b64_tr_b16 a[164:165], v1 offset:7168
  v_mfma_f32_16x16x32_bf16 v[200:203], a[132:135], a[24:27], v[200:203]
  v_mfma_f32_16x16x32_bf16 v[204:207], a[132:135], a[28:31], v[204:207]
  buffer_load_dwordx4 v9, s[16:19], s56 offen offset:2048 lds
  v_mfma_f32_16x16x32_bf16 v[204:207], a[128:131], a[12:15], v[204:207]
  ds_read_b64_tr_b16 a[166:167], v1 offset:10752
  v_mfma_f32_16x16x32_bf16 v[220:223], a[136:139], a[12:15], v[220:223]
  ds_read_b64_tr_b16 a[168:169], v1 offset:32
  v_mfma_f32_16x16x32_bf16 v[220:223], a[140:143], a[28:31], v[220:223]
  v_mfma_f32_16x16x32_bf16 v[216:219], a[140:143], a[24:27], v[216:219]
  ds_read_b64_tr_b16 a[170:171], v1 offset:3616
  v_mfma_f32_16x16x32_bf16 v[216:219], a[136:139], a[8:11], v[216:219]
  buffer_load_dwordx4 a[72:75], v0, s[36:39], s57 offen offset:2048 sc1
  v_mfma_f32_16x16x32_bf16 v[212:215], a[136:139], a[4:7], v[212:215]
  ds_read_b64_tr_b16 a[172:173], v1 offset:7200
  v_mfma_f32_16x16x32_bf16 v[212:215], a[140:143], a[20:23], v[212:215]
  v_mfma_f32_16x16x32_bf16 v[208:211], a[140:143], a[16:19], v[208:211]
  ds_read_b64_tr_b16 a[174:175], v1 offset:10784
  v_mfma_f32_16x16x32_bf16 v[208:211], a[136:139], a[0:3], v[208:211]
  s_waitcnt lgkmcnt(8)
  v_mfma_f32_16x16x32_bf16 v[224:227], a[144:147], a[0:3], v[224:227]
  ds_read_b64_tr_b16 a[128:129], v1 offset:64
  v_mfma_f32_16x16x32_bf16 v[224:227], a[148:151], a[16:19], v[224:227]
  v_mfma_f32_16x16x32_bf16 v[228:231], a[148:151], a[20:23], v[228:231]
  ds_read_b64_tr_b16 a[130:131], v1 offset:3648
  v_mfma_f32_16x16x32_bf16 v[228:231], a[144:147], a[4:7], v[228:231]
  v_mfma_f32_16x16x32_bf16 v[232:235], a[144:147], a[8:11], v[232:235]
  ds_read_b64_tr_b16 a[132:133], v1 offset:7232
  v_mfma_f32_16x16x32_bf16 v[232:235], a[148:151], a[24:27], v[232:235]
  buffer_load_dwordx4 a[76:79], v0, s[36:39], s57 offen offset:3072 sc1
  v_mfma_f32_16x16x32_bf16 v[236:239], a[148:151], a[28:31], v[236:239]
  ds_read_b64_tr_b16 a[134:135], v1 offset:10816
  v_mfma_f32_16x16x32_bf16 v[236:239], a[144:147], a[12:15], v[236:239]
  v_mfma_f32_16x16x32_bf16 v[252:255], a[152:155], a[12:15], v[252:255]
  ds_read_b64_tr_b16 a[136:137], v1 offset:96
  v_mfma_f32_16x16x32_bf16 v[252:255], a[156:159], a[28:31], v[252:255]
  s_bfe_u32 s56, s84, 0x3001c
  s_lshl_b32 s56, s56, 2
  s_bitcmp1_b32 s84, 31
  v_mfma_f32_16x16x32_bf16 v[248:251], a[156:159], a[24:27], v[248:251]
  s_addc_u32 s56, s56, 0
  s_mul_i32 s56, s56, 229376
  s_add_u32 m0, s77, 57344
  v_mfma_f32_16x16x32_bf16 v[248:251], a[152:155], a[8:11], v[248:251]
  buffer_load_dwordx4 a[208:211], v0, s[36:39], s59 offen offset:0 sc1
  v_add_u32 v31, 28672, v31
  v_mfma_f32_16x16x32_bf16 v[244:247], a[152:155], a[4:7], v[244:247]
  ds_read_b64_tr_b16 a[138:139], v1 offset:3680
  v_mfma_f32_16x16x32_bf16 v[244:247], a[156:159], a[20:23], v[244:247]
  ds_read_b64_tr_b16 a[140:141], v1 offset:7264
  v_mfma_f32_16x16x32_bf16 v[240:243], a[156:159], a[16:19], v[240:243]
  ds_read_b64_tr_b16 a[142:143], v1 offset:10848
  v_mfma_f32_16x16x32_bf16 v[240:243], a[152:155], a[0:3], v[240:243]
  s_waitcnt vmcnt(8) lgkmcnt(8)
  v_mfma_f32_16x16x32_bf16 v[32:35], a[160:163], a[32:35], v[32:35]
  buffer_load_dwordx4 a[212:215], v0, s[36:39], s59 offen offset:1024 sc1
  v_mfma_f32_16x16x32_bf16 v[32:35], a[164:167], a[48:51], v[32:35]
  ds_read_b64_tr_b16 a[144:145], v1 offset:128
  v_mfma_f32_16x16x32_bf16 v[36:39], a[164:167], a[52:55], v[36:39]
  ds_read_b64_tr_b16 a[146:147], v1 offset:3712
  v_mfma_f32_16x16x32_bf16 v[36:39], a[160:163], a[36:39], v[36:39]
  v_mfma_f32_16x16x32_bf16 v[40:43], a[160:163], a[40:43], v[40:43]
  ds_read_b64_tr_b16 a[148:149], v1 offset:7296
  v_mfma_f32_16x16x32_bf16 v[40:43], a[164:167], a[56:59], v[40:43]
  buffer_load_dwordx4 v3, s[16:19], s56 offen offset:0 lds
  s_add_u32 s57, s57, 4096
  v_mfma_f32_16x16x32_bf16 v[44:47], a[164:167], a[60:63], v[44:47]
  ds_read_b64_tr_b16 a[150:151], v1 offset:10880
  v_mfma_f32_16x16x32_bf16 v[44:47], a[160:163], a[44:47], v[44:47]
  v_mfma_f32_16x16x32_bf16 v[60:63], a[168:171], a[44:47], v[60:63]
  ds_read_b64_tr_b16 a[152:153], v1 offset:160
  v_mfma_f32_16x16x32_bf16 v[60:63], a[172:175], a[60:63], v[60:63]
  v_mfma_f32_16x16x32_bf16 v[56:59], a[172:175], a[56:59], v[56:59]
  buffer_load_dwordx4 a[80:83], v0, s[36:39], s57 offen offset:0 sc1
  v_mfma_f32_16x16x32_bf16 v[56:59], a[168:171], a[40:43], v[56:59]
  ds_read_b64_tr_b16 a[154:155], v1 offset:3744
  v_mfma_f32_16x16x32_bf16 v[52:55], a[168:171], a[36:39], v[52:55]
  ds_read_b64_tr_b16 a[156:157], v1 offset:7328
  v_mfma_f32_16x16x32_bf16 v[52:55], a[172:175], a[52:55], v[52:55]
  v_mfma_f32_16x16x32_bf16 v[48:51], a[172:175], a[48:51], v[48:51]
  ds_read_b64_tr_b16 a[158:159], v1 offset:10912
  v_mfma_f32_16x16x32_bf16 v[48:51], a[168:171], a[32:35], v[48:51]
  s_waitcnt lgkmcnt(8)
  buffer_load_dwordx4 v4, s[16:19], s56 offen offset:1024 lds
  v_mfma_f32_16x16x32_bf16 v[64:67], a[128:131], a[32:35], v[64:67]
  ds_read_b64_tr_b16 a[160:161], v1 offset:192
  v_mfma_f32_16x16x32_bf16 v[64:67], a[132:135], a[48:51], v[64:67]
  v_mfma_f32_16x16x32_bf16 v[68:71], a[132:135], a[52:55], v[68:71]
  ds_read_b64_tr_b16 a[162:163], v1 offset:3776
  v_mfma_f32_16x16x32_bf16 v[68:71], a[128:131], a[36:39], v[68:71]
  v_mfma_f32_16x16x32_bf16 v[72:75], a[128:131], a[40:43], v[72:75]
  buffer_load_dwordx4 a[84:87], v0, s[36:39], s57 offen offset:1024 sc1
  v_mfma_f32_16x16x32_bf16 v[72:75], a[132:135], a[56:59], v[72:75]
  ds_read_b64_tr_b16 a[164:165], v1 offset:7360
  v_mfma_f32_16x16x32_bf16 v[76:79], a[132:135], a[60:63], v[76:79]
  ds_read_b64_tr_b16 a[166:167], v1 offset:10944
  v_mfma_f32_16x16x32_bf16 v[76:79], a[128:131], a[44:47], v[76:79]
  v_mfma_f32_16x16x32_bf16 v[92:95], a[136:139], a[44:47], v[92:95]
  ds_read_b64_tr_b16 a[168:169], v1 offset:14336
  v_mfma_f32_16x16x32_bf16 v[92:95], a[140:143], a[60:63], v[92:95]
  v_mfma_f32_16x16x32_bf16 v[88:91], a[140:143], a[56:59], v[88:91]
  buffer_load_dwordx4 v5, s[16:19], s56 offen offset:2048 lds
  v_mfma_f32_16x16x32_bf16 v[88:91], a[136:139], a[40:43], v[88:91]
  ds_read_b64_tr_b16 a[170:171], v1 offset:17920
  v_mfma_f32_16x16x32_bf16 v[84:87], a[136:139], a[36:39], v[84:87]
  ds_read_b64_tr_b16 a[172:173], v1 offset:21504
  v_mfma_f32_16x16x32_bf16 v[84:87], a[140:143], a[52:55], v[84:87]
  v_mfma_f32_16x16x32_bf16 v[80:83], a[140:143], a[48:51], v[80:83]
  ds_read_b64_tr_b16 a[174:175], v1 offset:25088
  v_mfma_f32_16x16x32_bf16 v[80:83], a[136:139], a[32:35], v[80:83]
  s_waitcnt lgkmcnt(8)
  v_mfma_f32_16x16x32_bf16 v[96:99], a[144:147], a[32:35], v[96:99]
  ds_read_b64_tr_b16 a[128:129], v1 offset:14368
  v_mfma_f32_16x16x32_bf16 v[96:99], a[148:151], a[48:51], v[96:99]
  v_mfma_f32_16x16x32_bf16 v[100:103], a[148:151], a[52:55], v[100:103]
  buffer_load_dwordx4 a[88:91], v0, s[36:39], s57 offen offset:2048 sc1
  v_mfma_f32_16x16x32_bf16 v[100:103], a[144:147], a[36:39], v[100:103]
  ds_read_b64_tr_b16 a[130:131], v1 offset:17952
  v_mfma_f32_16x16x32_bf16 v[104:107], a[144:147], a[40:43], v[104:107]
  ds_read_b64_tr_b16 a[132:133], v1 offset:21536
  v_mfma_f32_16x16x32_bf16 v[104:107], a[148:151], a[56:59], v[104:107]
  v_mfma_f32_16x16x32_bf16 v[108:111], a[148:151], a[60:63], v[108:111]
  ds_read_b64_tr_b16 a[134:135], v1 offset:25120
  v_mfma_f32_16x16x32_bf16 v[108:111], a[144:147], a[44:47], v[108:111]
  v_mfma_f32_16x16x32_bf16 v[124:127], a[152:155], a[44:47], v[124:127]
  ds_read_b64_tr_b16 a[136:137], v1 offset:14400
  v_mfma_f32_16x16x32_bf16 v[124:127], a[156:159], a[60:63], v[124:127]
  buffer_load_dwordx4 v6, s[16:19], s56 offen offset:3072 lds
  v_mfma_f32_16x16x32_bf16 v[120:123], a[156:159], a[56:59], v[120:123]
  ds_read_b64_tr_b16 a[138:139], v1 offset:17984
  v_mfma_f32_16x16x32_bf16 v[120:123], a[152:155], a[40:43], v[120:123]
  v_mfma_f32_16x16x32_bf16 v[116:119], a[152:155], a[36:39], v[116:119]
  ds_read_b64_tr_b16 a[140:141], v1 offset:21568
  v_mfma_f32_16x16x32_bf16 v[116:119], a[156:159], a[52:55], v[116:119]
  v_mfma_f32_16x16x32_bf16 v[112:115], a[156:159], a[48:51], v[112:115]
  ds_read_b64_tr_b16 a[142:143], v1 offset:25152
  v_mfma_f32_16x16x32_bf16 v[112:115], a[152:155], a[32:35], v[112:115]
  s_waitcnt lgkmcnt(8)
  v_mfma_f32_16x16x32_bf16 v[128:131], a[160:163], a[32:35], v[128:131]
  ds_read_b64_tr_b16 a[144:145], v1 offset:14432
  v_mfma_f32_16x16x32_bf16 v[128:131], a[164:167], a[48:51], v[128:131]
  buffer_load_dwordx4 a[92:95], v0, s[36:39], s57 offen offset:3072 sc1
  v_mfma_f32_16x16x32_bf16 v[132:135], a[164:167], a[52:55], v[132:135]
  ds_read_b64_tr_b16 a[146:147], v1 offset:18016
  v_mfma_f32_16x16x32_bf16 v[132:135], a[160:163], a[36:39], v[132:135]
  v_mfma_f32_16x16x32_bf16 v[136:139], a[160:163], a[40:43], v[136:139]
  s_add_u32 m0, s77, 61440
  ds_read_b64_tr_b16 a[148:149], v1 offset:21600
  v_mfma_f32_16x16x32_bf16 v[136:139], a[164:167], a[56:59], v[136:139]
  v_mfma_f32_16x16x32_bf16 v[140:143], a[164:167], a[60:63], v[140:143]
  ds_read_b64_tr_b16 a[150:151], v1 offset:25184
  v_mfma_f32_16x16x32_bf16 v[140:143], a[160:163], a[44:47], v[140:143]
  v_mfma_f32_16x16x32_bf16 v[156:159], a[168:171], a[44:47], v[156:159]
  buffer_load_dwordx4 v7, s[16:19], s56 offen offset:0 lds
  s_bfe_u32 s57, s84, 0x4001c
  v_mfma_f32_16x16x32_bf16 v[156:159], a[172:175], a[60:63], v[156:159]
  s_lshl_b32 s57, s57, 13
  s_add_u32 s57, s57, s86
  ds_read_b64_tr_b16 a[152:153], v1 offset:14464
  v_mfma_f32_16x16x32_bf16 v[152:155], a[172:175], a[56:59], v[152:155]
  ds_read_b64_tr_b16 a[154:155], v1 offset:18048
  v_mfma_f32_16x16x32_bf16 v[152:155], a[168:171], a[40:43], v[152:155]
  v_mfma_f32_16x16x32_bf16 v[148:151], a[168:171], a[36:39], v[148:151]
  ds_read_b64_tr_b16 a[156:157], v1 offset:21632
  v_mfma_f32_16x16x32_bf16 v[148:151], a[172:175], a[52:55], v[148:151]
  buffer_load_dwordx4 a[96:99], v0, s[36:39], s57 offen offset:0 sc1
  v_mfma_f32_16x16x32_bf16 v[144:147], a[172:175], a[48:51], v[144:147]
  ds_read_b64_tr_b16 a[158:159], v1 offset:25216
  v_mfma_f32_16x16x32_bf16 v[144:147], a[168:171], a[32:35], v[144:147]
  s_waitcnt lgkmcnt(8)
  v_mfma_f32_16x16x32_bf16 v[160:163], a[128:131], a[32:35], v[160:163]
  ds_read_b64_tr_b16 a[160:161], v1 offset:14496
  v_mfma_f32_16x16x32_bf16 v[160:163], a[132:135], a[48:51], v[160:163]
  v_mfma_f32_16x16x32_bf16 v[164:167], a[132:135], a[52:55], v[164:167]
  ds_read_b64_tr_b16 a[162:163], v1 offset:18080
  v_mfma_f32_16x16x32_bf16 v[164:167], a[128:131], a[36:39], v[164:167]
  v_mfma_f32_16x16x32_bf16 v[168:171], a[128:131], a[40:43], v[168:171]
  ds_read_b64_tr_b16 a[164:165], v1 offset:21664
  v_mfma_f32_16x16x32_bf16 v[168:171], a[132:135], a[56:59], v[168:171]
  v_mfma_f32_16x16x32_bf16 v[172:175], a[132:135], a[60:63], v[172:175]
  ds_read_b64_tr_b16 a[166:167], v1 offset:25248
  v_mfma_f32_16x16x32_bf16 v[172:175], a[128:131], a[44:47], v[172:175]
  s_waitcnt vmcnt(14)
  s_barrier
  buffer_load_dwordx4 v8, s[16:19], s56 offen offset:1024 lds
  v_mfma_f32_16x16x32_bf16 v[188:191], a[136:139], a[44:47], v[188:191]
  ds_read_b64_tr_b16 a[168:169], v1 offset:14528
  v_mfma_f32_16x16x32_bf16 v[188:191], a[140:143], a[60:63], v[188:191]
  v_mfma_f32_16x16x32_bf16 v[184:187], a[140:143], a[56:59], v[184:187]
  ds_read_b64_tr_b16 a[170:171], v1 offset:18112
  v_mfma_f32_16x16x32_bf16 v[184:187], a[136:139], a[40:43], v[184:187]
  v_mfma_f32_16x16x32_bf16 v[180:183], a[136:139], a[36:39], v[180:183]
  buffer_load_dwordx4 a[100:103], v0, s[36:39], s57 offen offset:1024 sc1
  v_mfma_f32_16x16x32_bf16 v[180:183], a[140:143], a[52:55], v[180:183]
  ds_read_b64_tr_b16 a[172:173], v1 offset:21696
  v_mfma_f32_16x16x32_bf16 v[176:179], a[140:143], a[48:51], v[176:179]
  ds_read_b64_tr_b16 a[174:175], v1 offset:25280
  v_mfma_f32_16x16x32_bf16 v[176:179], a[136:139], a[32:35], v[176:179]
  s_waitcnt lgkmcnt(8)
  v_mfma_f32_16x16x32_bf16 v[192:195], a[144:147], a[32:35], v[192:195]
  ds_read_b64_tr_b16 a[128:129], v1 offset:28672
  v_mfma_f32_16x16x32_bf16 v[192:195], a[148:151], a[48:51], v[192:195]
  v_mfma_f32_16x16x32_bf16 v[196:199], a[148:151], a[52:55], v[196:199]
  ds_read_b64_tr_b16 a[130:131], v1 offset:32256
  v_mfma_f32_16x16x32_bf16 v[196:199], a[144:147], a[36:39], v[196:199]
  v_mfma_f32_16x16x32_bf16 v[200:203], a[144:147], a[40:43], v[200:203]
  ds_read_b64_tr_b16 a[132:133], v1 offset:35840
  v_mfma_f32_16x16x32_bf16 v[200:203], a[148:151], a[56:59], v[200:203]
  ds_read_b64_tr_b16 a[176:177], v31 offset:0
  v_mfma_f32_16x16x32_bf16 v[204:207], a[148:151], a[60:63], v[204:207]
  buffer_load_dwordx4 v9, s[16:19], s56 offen offset:2048 lds
  v_mfma_f32_16x16x32_bf16 v[204:207], a[144:147], a[44:47], v[204:207]
  ds_read_b64_tr_b16 a[134:135], v1 offset:39424
  v_mfma_f32_16x16x32_bf16 v[220:223], a[152:155], a[44:47], v[220:223]
  ds_read_b64_tr_b16 a[136:137], v1 offset:28704
  v_mfma_f32_16x16x32_bf16 v[220:223], a[156:159], a[60:63], v[220:223]
  ds_read_b64_tr_b16 a[178:179], v31 offset:3584
  v_mfma_f32_16x16x32_bf16 v[216:219], a[156:159], a[56:59], v[216:219]
  ds_read_b64_tr_b16 a[138:139], v1 offset:32288
  v_mfma_f32_16x16x32_bf16 v[216:219], a[152:155], a[40:43], v[216:219]
  buffer_load_dwordx4 a[104:107], v0, s[36:39], s57 offen offset:2048 sc1
  v_mfma_f32_16x16x32_bf16 v[212:215], a[152:155], a[36:39], v[212:215]
  ds_read_b64_tr_b16 a[140:141], v1 offset:35872
  v_mfma_f32_16x16x32_bf16 v[212:215], a[156:159], a[52:55], v[212:215]
  ds_read_b64_tr_b16 a[180:181], v31 offset:7168
  v_mfma_f32_16x16x32_bf16 v[208:211], a[156:159], a[48:51], v[208:211]
  ds_read_b64_tr_b16 a[142:143], v1 offset:39456
  v_mfma_f32_16x16x32_bf16 v[208:211], a[152:155], a[32:35], v[208:211]
  s_waitcnt lgkmcnt(11)
  ds_read_b64_tr_b16 a[182:183], v31 offset:10752
  v_mfma_f32_16x16x32_bf16 v[224:227], a[160:163], a[32:35], v[224:227]
  ds_read_b64_tr_b16 a[144:145], v1 offset:28736
  v_mfma_f32_16x16x32_bf16 v[224:227], a[164:167], a[48:51], v[224:227]
  ds_read_b64_tr_b16 a[184:185], v31 offset:32
  v_mfma_f32_16x16x32_bf16 v[228:231], a[164:167], a[52:55], v[228:231]
  ds_read_b64_tr_b16 a[146:147], v1 offset:32320
  v_mfma_f32_16x16x32_bf16 v[228:231], a[160:163], a[36:39], v[228:231]
  ds_read_b64_tr_b16 a[186:187], v31 offset:3616
  v_mfma_f32_16x16x32_bf16 v[232:235], a[160:163], a[40:43], v[232:235]
  ds_read_b64_tr_b16 a[148:149], v1 offset:35904
  v_mfma_f32_16x16x32_bf16 v[232:235], a[164:167], a[56:59], v[232:235]
  buffer_load_dwordx4 a[108:111], v0, s[36:39], s57 offen offset:3072 sc1
  v_mfma_f32_16x16x32_bf16 v[236:239], a[164:167], a[60:63], v[236:239]
  ds_read_b64_tr_b16 a[150:151], v1 offset:39488
  v_mfma_f32_16x16x32_bf16 v[236:239], a[160:163], a[44:47], v[236:239]
  ds_read_b64_tr_b16 a[188:189], v31 offset:7200
  v_mfma_f32_16x16x32_bf16 v[252:255], a[168:171], a[44:47], v[252:255]
  ds_read_b64_tr_b16 a[152:153], v1 offset:28768
  v_mfma_f32_16x16x32_bf16 v[252:255], a[172:175], a[60:63], v[252:255]
  s_bfe_u32 s56, s85, 0x30000
  s_lshl_b32 s56, s56, 2
  s_bitcmp1_b32 s85, 3
  v_mfma_f32_16x16x32_bf16 v[248:251], a[172:175], a[56:59], v[248:251]
  s_addc_u32 s56, s56, 0
  s_mul_i32 s56, s56, 229376
  s_add_u32 m0, s77, 86016
  v_mfma_f32_16x16x32_bf16 v[248:251], a[168:171], a[40:43], v[248:251]
  ds_read_b64_tr_b16 a[154:155], v1 offset:32352
  v_mfma_f32_16x16x32_bf16 v[244:247], a[168:171], a[36:39], v[244:247]
  ds_read_b64_tr_b16 a[156:157], v1 offset:35936
  v_mfma_f32_16x16x32_bf16 v[244:247], a[172:175], a[52:55], v[244:247]
  buffer_load_dwordx4 v3, s[16:19], s56 offen offset:0 lds
  v_mfma_f32_16x16x32_bf16 v[240:243], a[172:175], a[48:51], v[240:243]
  ds_read_b64_tr_b16 a[158:159], v1 offset:39520
  v_mfma_f32_16x16x32_bf16 v[240:243], a[168:171], a[32:35], v[240:243]
  s_waitcnt vmcnt(8) lgkmcnt(12)
  ds_read_b64_tr_b16 a[190:191], v31 offset:10784
  v_mfma_f32_16x16x32_bf16 v[32:35], a[128:131], a[64:67], v[32:35]
  s_add_u32 s57, s57, 4096
  ds_read_b64_tr_b16 a[192:193], v31 offset:64
  v_mfma_f32_16x16x32_bf16 v[32:35], a[132:135], a[80:83], v[32:35]
  ds_read_b64_tr_b16 a[194:195], v31 offset:3648
  v_mfma_f32_16x16x32_bf16 v[36:39], a[132:135], a[84:87], v[36:39]
  ds_read_b64_tr_b16 a[196:197], v31 offset:7232
  v_mfma_f32_16x16x32_bf16 v[36:39], a[128:131], a[68:71], v[36:39]
  ds_read_b64_tr_b16 a[198:199], v31 offset:10816
  v_mfma_f32_16x16x32_bf16 v[40:43], a[128:131], a[72:75], v[40:43]
  buffer_load_dwordx4 a[112:115], v0, s[36:39], s57 offen offset:0 sc1
  v_mfma_f32_16x16x32_bf16 v[40:43], a[132:135], a[88:91], v[40:43]
  ds_read_b64_tr_b16 a[200:201], v31 offset:96
  v_mfma_f32_16x16x32_bf16 v[44:47], a[132:135], a[92:95], v[44:47]
  ds_read_b64_tr_b16 a[202:203], v31 offset:3680
  v_mfma_f32_16x16x32_bf16 v[44:47], a[128:131], a[76:79], v[44:47]
  ds_read_b64_tr_b16 a[204:205], v31 offset:7264
  v_mfma_f32_16x16x32_bf16 v[60:63], a[136:139], a[76:79], v[60:63]
  ds_read_b64_tr_b16 a[160:161], v1 offset:28800
  v_mfma_f32_16x16x32_bf16 v[60:63], a[140:143], a[92:95], v[60:63]
  ds_read_b64_tr_b16 a[206:207], v31 offset:10848
  v_mfma_f32_16x16x32_bf16 v[56:59], a[140:143], a[88:91], v[56:59]
  ds_read_b64_tr_b16 a[162:163], v1 offset:32384
  v_mfma_f32_16x16x32_bf16 v[56:59], a[136:139], a[72:75], v[56:59]
  buffer_load_dwordx4 v4, s[16:19], s56 offen offset:1024 lds
  v_mfma_f32_16x16x32_bf16 v[52:55], a[136:139], a[68:71], v[52:55]
  ds_read_b64_tr_b16 a[164:165], v1 offset:35968
  v_mfma_f32_16x16x32_bf16 v[52:55], a[140:143], a[84:87], v[52:55]
  v_mfma_f32_16x16x32_bf16 v[48:51], a[140:143], a[80:83], v[48:51]
  ds_read_b64_tr_b16 a[166:167], v1 offset:39552
  v_mfma_f32_16x16x32_bf16 v[48:51], a[136:139], a[64:67], v[48:51]
  s_waitcnt lgkmcnt(13)
  v_mfma_f32_16x16x32_bf16 v[64:67], a[144:147], a[64:67], v[64:67]
  ds_read_b64_tr_b16 a[168:169], v1 offset:28832
  v_mfma_f32_16x16x32_bf16 v[64:67], a[148:151], a[80:83], v[64:67]
  v_mfma_f32_16x16x32_bf16 v[68:71], a[148:151], a[84:87], v[68:71]
  ds_read_b64_tr_b16 a[170:171], v1 offset:32416
  v_mfma_f32_16x16x32_bf16 v[68:71], a[144:147], a[68:71], v[68:71]
  buffer_load_dwordx4 a[116:119], v0, s[36:39], s57 offen offset:1024 sc1
  v_mfma_f32_16x16x32_bf16 v[72:75], a[144:147], a[72:75], v[72:75]
  ds_read_b64_tr_b16 a[172:173], v1 offset:36000
  v_mfma_f32_16x16x32_bf16 v[72:75], a[148:151], a[88:91], v[72:75]
  v_mfma_f32_16x16x32_bf16 v[76:79], a[148:151], a[92:95], v[76:79]
  ds_read_b64_tr_b16 a[174:175], v1 offset:39584
  v_mfma_f32_16x16x32_bf16 v[76:79], a[144:147], a[76:79], v[76:79]
  v_mfma_f32_16x16x32_bf16 v[92:95], a[152:155], a[76:79], v[92:95]
  ds_read_b64_tr_b16 a[128:129], v1 offset:28864
  v_mfma_f32_16x16x32_bf16 v[92:95], a[156:159], a[92:95], v[92:95]
  v_mfma_f32_16x16x32_bf16 v[88:91], a[156:159], a[88:91], v[88:91]
  buffer_load_dwordx4 v5, s[16:19], s56 offen offset:2048 lds
  v_mfma_f32_16x16x32_bf16 v[88:91], a[152:155], a[72:75], v[88:91]
  ds_read_b64_tr_b16 a[130:131], v1 offset:32448
  v_mfma_f32_16x16x32_bf16 v[84:87], a[152:155], a[68:71], v[84:87]
  ds_read_b64_tr_b16 a[132:133], v1 offset:36032
  v_mfma_f32_16x16x32_bf16 v[84:87], a[156:159], a[84:87], v[84:87]
  v_mfma_f32_16x16x32_bf16 v[80:83], a[156:159], a[80:83], v[80:83]
  ds_read_b64_tr_b16 a[134:135], v1 offset:39616
  v_mfma_f32_16x16x32_bf16 v[80:83], a[152:155], a[64:67], v[80:83]
  s_waitcnt vmcnt(20) lgkmcnt(11)
  v_mfma_f32_16x16x32_bf16 a[216:219], a[176:179], a[208:211], 0
  ds_read_b64_tr_b16 a[136:137], v1 offset:43008
  v_mfma_f32_16x16x32_bf16 a[216:219], a[180:183], a[212:215], a[216:219]
  v_mfma_f32_16x16x32_bf16 a[220:223], a[184:187], a[208:211], 0
  buffer_load_dwordx4 a[120:123], v0, s[36:39], s57 offen offset:2048 sc1
  v_mfma_f32_16x16x32_bf16 a[220:223], a[188:191], a[212:215], a[220:223]
  ds_read_b64_tr_b16 a[138:139], v1 offset:46592
  v_mfma_f32_16x16x32_bf16 a[224:227], a[192:195], a[208:211], 0
  ds_read_b64_tr_b16 a[140:141], v1 offset:50176
  v_mfma_f32_16x16x32_bf16 a[224:227], a[196:199], a[212:215], a[224:227]
  v_mfma_f32_16x16x32_bf16 a[228:231], a[200:203], a[208:211], 0
  ds_read_b64_tr_b16 a[142:143], v1 offset:53760
  v_mfma_f32_16x16x32_bf16 a[228:231], a[204:207], a[212:215], a[228:231]
  s_waitcnt lgkmcnt(8)
  v_mfma_f32_16x16x32_bf16 v[96:99], a[160:163], a[64:67], v[96:99]
  ds_read_b64_tr_b16 a[144:145], v1 offset:43040
  v_mfma_f32_16x16x32_bf16 v[96:99], a[164:167], a[80:83], v[96:99]
  buffer_load_dwordx4 v6, s[16:19], s56 offen offset:3072 lds
  v_mfma_f32_16x16x32_bf16 v[100:103], a[164:167], a[84:87], v[100:103]
  s_lshl2_add_u32 s78, s58, s44
  ds_read_b64_tr_b16 a[146:147], v1 offset:46624
  s_lshl_b32 s78, s78, 13
  v_mfma_f32_16x16x32_bf16 v[100:103], a[160:163], a[68:71], v[100:103]
  s_add_u32 s78, s78, 262144
  s_add_u32 s79, s78, 4096
  v_mfma_f32_16x16x32_bf16 v[104:107], a[160:163], a[72:75], v[104:107]
Hc2:
  s_cbranch_execz Hc2_1
  ds_read_b64_tr_b16 a[148:149], v1 offset:50208
  v_mfma_f32_16x16x32_bf16 v[104:107], a[164:167], a[88:91], v[104:107]
  v_mfma_f32_16x16x32_bf16 v[108:111], a[164:167], a[92:95], v[108:111]
  ds_read_b64_tr_b16 a[150:151], v1 offset:53792
  v_mfma_f32_16x16x32_bf16 v[108:111], a[160:163], a[76:79], v[108:111]
  buffer_load_dwordx4 a[176:179], v0, s[36:39], s78 offen offset:0 sc1
  v_mfma_f32_16x16x32_bf16 v[124:127], a[168:171], a[76:79], v[124:127]
  ds_read_b64_tr_b16 a[152:153], v1 offset:43072
  v_mfma_f32_16x16x32_bf16 v[124:127], a[172:175], a[92:95], v[124:127]
  v_mfma_f32_16x16x32_bf16 v[120:123], a[172:175], a[88:91], v[120:123]
  ds_read_b64_tr_b16 a[154:155], v1 offset:46656
  v_mfma_f32_16x16x32_bf16 v[120:123], a[168:171], a[72:75], v[120:123]
  v_mfma_f32_16x16x32_bf16 v[116:119], a[168:171], a[68:71], v[116:119]
  buffer_load_dwordx4 a[124:127], v0, s[36:39], s57 offen offset:3072 sc1
  s_add_u32 m0, s77, 90112
  v_mfma_f32_16x16x32_bf16 v[116:119], a[172:175], a[84:87], v[116:119]
  ds_read_b64_tr_b16 a[156:157], v1 offset:50240
  v_mfma_f32_16x16x32_bf16 v[112:115], a[172:175], a[80:83], v[112:115]
  ds_read_b64_tr_b16 a[158:159], v1 offset:53824
  v_mfma_f32_16x16x32_bf16 v[112:115], a[168:171], a[64:67], v[112:115]
  s_waitcnt lgkmcnt(8)
  v_mfma_f32_16x16x32_bf16 v[128:131], a[128:131], a[64:67], v[128:131]
  ds_read_b64_tr_b16 a[160:161], v1 offset:43104
  v_mfma_f32_16x16x32_bf16 v[128:131], a[132:135], a[80:83], v[128:131]
  buffer_load_dwordx4 v7, s[16:19], s56 offen offset:0 lds
  s_bfe_u32 s57, s85, 0x40000
  v_mfma_f32_16x16x32_bf16 v[132:135], a[132:135], a[84:87], v[132:135]
  s_lshl_b32 s57, s57, 13
  s_add_u32 s57, s57, s86
  ds_read_b64_tr_b16 a[162:163], v1 offset:46688
  v_mfma_f32_16x16x32_bf16 v[132:135], a[128:131], a[68:71], v[132:135]
  v_mfma_f32_16x16x32_bf16 v[136:139], a[128:131], a[72:75], v[136:139]
  ds_read_b64_tr_b16 a[164:165], v1 offset:50272
  v_mfma_f32_16x16x32_bf16 v[136:139], a[132:135], a[88:91], v[136:139]
  v_mfma_f32_16x16x32_bf16 v[140:143], a[132:135], a[92:95], v[140:143]
  buffer_load_dwordx4 a[0:3], v0, s[36:39], s57 offen offset:0 sc1
  v_mfma_f32_16x16x32_bf16 v[140:143], a[128:131], a[76:79], v[140:143]
  ds_read_b64_tr_b16 a[166:167], v1 offset:53856
  v_mfma_f32_16x16x32_bf16 v[156:159], a[136:139], a[76:79], v[156:159]
  ds_read_b64_tr_b16 a[168:169], v1 offset:43136
  v_mfma_f32_16x16x32_bf16 v[156:159], a[140:143], a[92:95], v[156:159]
  v_mfma_f32_16x16x32_bf16 v[152:155], a[140:143], a[88:91], v[152:155]
  ds_read_b64_tr_b16 a[170:171], v1 offset:46720
  v_mfma_f32_16x16x32_bf16 v[152:155], a[136:139], a[72:75], v[152:155]
  buffer_load_dwordx4 a[180:183], v0, s[36:39], s78 offen offset:1024 sc1
  v_mfma_f32_16x16x32_bf16 v[148:151], a[136:139], a[68:71], v[148:151]
  ds_read_b64_tr_b16 a[172:173], v1 offset:50304
  v_mfma_f32_16x16x32_bf16 v[148:151], a[140:143], a[84:87], v[148:151]
  v_mfma_f32_16x16x32_bf16 v[144:147], a[140:143], a[80:83], v[144:147]
  ds_read_b64_tr_b16 a[174:175], v1 offset:53888
  v_mfma_f32_16x16x32_bf16 v[144:147], a[136:139], a[64:67], v[144:147]
  s_waitcnt lgkmcnt(8)
  v_mfma_f32_16x16x32_bf16 v[160:163], a[144:147], a[64:67], v[160:163]
  buffer_load_dwordx4 v8, s[16:19], s56 offen offset:1024 lds
  v_mfma_f32_16x16x32_bf16 v[160:163], a[148:151], a[80:83], v[160:163]
  ds_read_b64_tr_b16 a[128:129], v1 offset:43168
  v_mfma_f32_16x16x32_bf16 v[164:167], a[148:151], a[84:87], v[164:167]
  ds_read_b64_tr_b16 a[130:131], v1 offset:46752
  v_mfma_f32_16x16x32_bf16 v[164:167], a[144:147], a[68:71], v[164:167]
  v_mfma_f32_16x16x32_bf16 v[168:171], a[144:147], a[72:75], v[168:171]
  ds_read_b64_tr_b16 a[132:133], v1 offset:50336
  v_mfma_f32_16x16x32_bf16 v[168:171], a[148:151], a[88:91], v[168:171]
  buffer_load_dwordx4 a[4:7], v0, s[36:39], s57 offen offset:1024 sc1
  v_mfma_f32_16x16x32_bf16 v[172:175], a[148:151], a[92:95], v[172:175]
  ds_read_b64_tr_b16 a[134:135], v1 offset:53920
  v_mfma_f32_16x16x32_bf16 v[172:175], a[144:147], a[76:79], v[172:175]
  s_waitcnt vmcnt(16)
  s_barrier
  v_mfma_f32_16x16x32_bf16 v[188:191], a[152:155], a[76:79], v[188:191]
  ds_read_b64_tr_b16 a[136:137], v1 offset:43200
  v_mfma_f32_16x16x32_bf16 v[188:191], a[156:159], a[92:95], v[188:191]
  v_mfma_f32_16x16x32_bf16 v[184:187], a[156:159], a[88:91], v[184:187]
  ds_read_b64_tr_b16 a[138:139], v1 offset:46784
  v_mfma_f32_16x16x32_bf16 v[184:187], a[152:155], a[72:75], v[184:187]
  buffer_load_dwordx4 a[184:187], v0, s[36:39], s78 offen offset:2048 sc1
  v_mfma_f32_16x16x32_bf16 v[180:183], a[152:155], a[68:71], v[180:183]
  ds_read_b64_tr_b16 a[140:141], v1 offset:50368
  v_mfma_f32_16x16x32_bf16 v[180:183], a[156:159], a[84:87], v[180:183]
  v_mfma_f32_16x16x32_bf16 v[176:179], a[156:159], a[80:83], v[176:179]
  ds_read_b64_tr_b16 a[142:143], v1 offset:53952
  v_mfma_f32_16x16x32_bf16 v[176:179], a[152:155], a[64:67], v[176:179]
  s_waitcnt lgkmcnt(8)
  v_mfma_f32_16x16x32_bf16 v[192:195], a[160:163], a[64:67], v[192:195]
  buffer_load_dwordx4 v9, s[16:19], s56 offen offset:2048 lds
  v_mfma_f32_16x16x32_bf16 v[192:195], a[164:167], a[80:83], v[192:195]
  ds_read_b64_tr_b16 a[144:145], v2 offset:0
  v_mfma_f32_16x16x32_bf16 v[196:199], a[164:167], a[84:87], v[196:199]
  ds_read_b64_tr_b16 a[146:147], v2 offset:3584
  v_mfma_f32_16x16x32_bf16 v[196:199], a[160:163], a[68:71], v[196:199]
  v_mfma_f32_16x16x32_bf16 v[200:203], a[160:163], a[72:75], v[200:203]
  ds_read_b64_tr_b16 a[148:149], v2 offset:7168
  v_mfma_f32_16x16x32_bf16 v[200:203], a[164:167], a[88:91], v[200:203]
  buffer_load_dwordx4 a[8:11], v0, s[36:39], s57 offen offset:2048 sc1
  v_mfma_f32_16x16x32_bf16 v[204:207], a[164:167], a[92:95], v[204:207]
  ds_read_b64_tr_b16 a[150:151], v2 offset:10752
  v_mfma_f32_16x16x32_bf16 v[204:207], a[160:163], a[76:79], v[204:207]
  v_mfma_f32_16x16x32_bf16 v[220:223], a[168:171], a[76:79], v[220:223]
  ds_read_b64_tr_b16 a[152:153], v2 offset:32
  v_mfma_f32_16x16x32_bf16 v[220:223], a[172:175], a[92:95], v[220:223]
  buffer_load_dwordx4 a[188:191], v0, s[36:39], s78 offen offset:3072 sc1
  v_mfma_f32_16x16x32_bf16 v[216:219], a[172:175], a[88:91], v[216:219]
  ds_read_b64_tr_b16 a[154:155], v2 offset:3616
  v_mfma_f32_16x16x32_bf16 v[216:219], a[168:171], a[72:75], v[216:219]
  v_mfma_f32_16x16x32_bf16 v[212:215], a[168:171], a[68:71], v[212:215]
  ds_read_b64_tr_b16 a[156:157], v2 offset:7200
  v_mfma_f32_16x16x32_bf16 v[212:215], a[172:175], a[84:87], v[212:215]
  v_mfma_f32_16x16x32_bf16 v[208:211], a[172:175], a[80:83], v[208:211]
  buffer_load_dwordx4 a[12:15], v0, s[36:39], s57 offen offset:3072 sc1
  v_mfma_f32_16x16x32_bf16 v[208:211], a[168:171], a[64:67], v[208:211]
  s_waitcnt lgkmcnt(7)
  ds_read_b64_tr_b16 a[158:159], v2 offset:10784
  v_mfma_f32_16x16x32_bf16 v[224:227], a[128:131], a[64:67], v[224:227]
  ds_read_b64_tr_b16 a[160:161], v2 offset:64
  v_mfma_f32_16x16x32_bf16 v[224:227], a[132:135], a[80:83], v[224:227]
  s_bfe_u32 s56, s85, 0x30004
  s_lshl_b32 s56, s56, 2
  s_bitcmp1_b32 s85, 7
  v_mfma_f32_16x16x32_bf16 v[228:231], a[132:135], a[84:87], v[228:231]
  buffer_load_dwordx4 a[192:195], v0, s[36:39], s79 offen offset:0 sc1
  s_addc_u32 s56, s56, 0
  v_mfma_f32_16x16x32_bf16 v[228:231], a[128:131], a[68:71], v[228:231]
  s_mul_i32 s56, s56, 229376
  s_add_u32 m0, s77, 0
  ds_read_b64_tr_b16 a[162:163], v2 offset:3648
  v_mfma_f32_16x16x32_bf16 v[232:235], a[128:131], a[72:75], v[232:235]
  ds_read_b64_tr_b16 a[164:165], v2 offset:7232
  v_mfma_f32_16x16x32_bf16 v[232:235], a[132:135], a[88:91], v[232:235]
  v_mfma_f32_16x16x32_bf16 v[236:239], a[132:135], a[92:95], v[236:239]
  ds_read_b64_tr_b16 a[166:167], v2 offset:10816
  v_mfma_f32_16x16x32_bf16 v[236:239], a[128:131], a[76:79], v[236:239]
  buffer_load_dwordx4 v3, s[16:19], s56 offen offset:0 lds
  v_mfma_f32_16x16x32_bf16 v[252:255], a[136:139], a[76:79], v[252:255]
  ds_read_b64_tr_b16 a[168:169], v2 offset:96
  v_mfma_f32_16x16x32_bf16 v[252:255], a[140:143], a[92:95], v[252:255]
  v_mfma_f32_16x16x32_bf16 v[248:251], a[140:143], a[88:91], v[248:251]
  ds_read_b64_tr_b16 a[170:171], v2 offset:3680
  v_mfma_f32_16x16x32_bf16 v[248:251], a[136:139], a[72:75], v[248:251]
  buffer_load_dwordx4 a[196:199], v0, s[36:39], s79 offen offset:1024 sc1
  v_mfma_f32_16x16x32_bf16 v[244:247], a[136:139], a[68:71], v[244:247]
  ds_read_b64_tr_b16 a[172:173], v2 offset:7264
  v_mfma_f32_16x16x32_bf16 v[244:247], a[140:143], a[84:87], v[244:247]
  v_mfma_f32_16x16x32_bf16 v[240:243], a[140:143], a[80:83], v[240:243]
  ds_read_b64_tr_b16 a[174:175], v2 offset:10848
  v_mfma_f32_16x16x32_bf16 v[240:243], a[136:139], a[64:67], v[240:243]
  s_waitcnt vmcnt(13) lgkmcnt(8)
  v_mfma_f32_16x16x32_bf16 v[32:35], a[144:147], a[96:99], v[32:35]
  s_add_u32 s57, s57, 4096
  ds_read_b64_tr_b16 a[128:129], v2 offset:128
  v_mfma_f32_16x16x32_bf16 v[32:35], a[148:151], a[112:115], v[32:35]
  buffer_load_dwordx4 a[200:203], v0, s[36:39], s79 offen offset:2048 sc1
  v_mfma_f32_16x16x32_bf16 v[36:39], a[148:151], a[116:119], v[36:39]
  ds_read_b64_tr_b16 a[130:131], v2 offset:3712
  v_mfma_f32_16x16x32_bf16 v[36:39], a[144:147], a[100:103], v[36:39]
  v_mfma_f32_16x16x32_bf16 v[40:43], a[144:147], a[104:107], v[40:43]
  ds_read_b64_tr_b16 a[132:133], v2 offset:7296
  v_mfma_f32_16x16x32_bf16 v[40:43], a[148:151], a[120:123], v[40:43]
  v_mfma_f32_16x16x32_bf16 v[44:47], a[148:151], a[124:127], v[44:47]
  buffer_load_dwordx4 a[16:19], v0, s[36:39], s57 offen offset:0 sc1
  v_mfma_f32_16x16x32_bf16 v[44:47], a[144:147], a[108:111], v[44:47]
  ds_read_b64_tr_b16 a[134:135], v2 offset:10880
  v_mfma_f32_16x16x32_bf16 v[60:63], a[152:155], a[108:111], v[60:63]
  ds_read_b64_tr_b16 a[136:137], v2 offset:160
  v_mfma_f32_16x16x32_bf16 v[60:63], a[156:159], a[124:127], v[60:63]
  v_mfma_f32_16x16x32_bf16 v[56:59], a[156:159], a[120:123], v[56:59]
  ds_read_b64_tr_b16 a[138:139], v2 offset:3744
  v_mfma_f32_16x16x32_bf16 v[56:59], a[152:155], a[104:107], v[56:59]
  buffer_load_dwordx4 v4, s[16:19], s56 offen offset:1024 lds
  v_mfma_f32_16x16x32_bf16 v[52:55], a[152:155], a[100:103], v[52:55]
  ds_read_b64_tr_b16 a[140:141], v2 offset:7328
  v_mfma_f32_16x16x32_bf16 v[52:55], a[156:159], a[116:119], v[52:55]
  buffer_load_dwordx4 a[204:207], v0, s[36:39], s79 offen offset:3072 sc1
  v_mfma_f32_16x16x32_bf16 v[48:51], a[156:159], a[112:115], v[48:51]
  ds_read_b64_tr_b16 a[142:143], v2 offset:10912
  v_mfma_f32_16x16x32_bf16 v[48:51], a[152:155], a[96:99], v[48:51]
  s_waitcnt lgkmcnt(8)
  v_mfma_f32_16x16x32_bf16 v[64:67], a[160:163], a[96:99], v[64:67]
  ds_read_b64_tr_b16 a[144:145], v2 offset:192
  v_mfma_f32_16x16x32_bf16 v[64:67], a[164:167], a[112:115], v[64:67]
  v_mfma_f32_16x16x32_bf16 v[68:71], a[164:167], a[116:119], v[68:71]
  ds_read_b64_tr_b16 a[146:147], v2 offset:3776
  v_mfma_f32_16x16x32_bf16 v[68:71], a[160:163], a[100:103], v[68:71]
  buffer_load_dwordx4 a[20:23], v0, s[36:39], s57 offen offset:1024 sc1
  v_mfma_f32_16x16x32_bf16 v[72:75], a[160:163], a[104:107], v[72:75]
  ds_read_b64_tr_b16 a[148:149], v2 offset:7360
  v_mfma_f32_16x16x32_bf16 v[72:75], a[164:167], a[120:123], v[72:75]
  v_mfma_f32_16x16x32_bf16 v[76:79], a[164:167], a[124:127], v[76:79]
  ds_read_b64_tr_b16 a[150:151], v2 offset:10944
  v_mfma_f32_16x16x32_bf16 v[76:79], a[160:163], a[108:111], v[76:79]
  v_mfma_f32_16x16x32_bf16 v[92:95], a[168:171], a[108:111], v[92:95]
  ds_read_b64_tr_b16 a[152:153], v2 offset:14336
  v_mfma_f32_16x16x32_bf16 v[92:95], a[172:175], a[124:127], v[92:95]
  v_mfma_f32_16x16x32_bf16 v[88:91], a[172:175], a[120:123], v[88:91]
  buffer_load_dwordx4 v5, s[16:19], s56 offen offset:2048 lds
  v_mfma_f32_16x16x32_bf16 v[88:91], a[168:171], a[104:107], v[88:91]
  ds_read_b64_tr_b16 a[154:155], v2 offset:17920
  v_mfma_f32_16x16x32_bf16 v[84:87], a[168:171], a[100:103], v[84:87]
  ds_read_b64_tr_b16 a[156:157], v2 offset:21504
  v_mfma_f32_16x16x32_bf16 v[84:87], a[172:175], a[116:119], v[84:87]
  v_mfma_f32_16x16x32_bf16 v[80:83], a[172:175], a[112:115], v[80:83]
  ds_read_b64_tr_b16 a[158:159], v2 offset:25088
  v_mfma_f32_16x16x32_bf16 v[80:83], a[168:171], a[96:99], v[80:83]
  s_waitcnt lgkmcnt(8)
  v_mfma_f32_16x16x32_bf16 v[96:99], a[128:131], a[96:99], v[96:99]
  ds_read_b64_tr_b16 a[160:161], v2 offset:14368
  v_mfma_f32_16x16x32_bf16 v[96:99], a[132:135], a[112:115], v[96:99]
  v_mfma_f32_16x16x32_bf16 v[100:103], a[132:135], a[116:119], v[100:103]
  buffer_load_dwordx4 a[24:27], v0, s[36:39], s57 offen offset:2048 sc1
  v_mfma_f32_16x16x32_bf16 v[100:103], a[128:131], a[100:103], v[100:103]
  ds_read_b64_tr_b16 a[162:163], v2 offset:17952
  v_mfma_f32_16x16x32_bf16 v[104:107], a[128:131], a[104:107], v[104:107]
  ds_read_b64_tr_b16 a[164:165], v2 offset:21536
  v_mfma_f32_16x16x32_bf16 v[104:107], a[132:135], a[120:123], v[104:107]
  v_mfma_f32_16x16x32_bf16 v[108:111], a[132:135], a[124:127], v[108:111]
  ds_read_b64_tr_b16 a[166:167], v2 offset:25120
  v_mfma_f32_16x16x32_bf16 v[108:111], a[128:131], a[108:111], v[108:111]
  v_mfma_f32_16x16x32_bf16 v[124:127], a[136:139], a[108:111], v[124:127]
  ds_read_b64_tr_b16 a[168:169], v2 offset:14400
  v_mfma_f32_16x16x32_bf16 v[124:127], a[140:143], a[124:127], v[124:127]
  buffer_load_dwordx4 v6, s[16:19], s56 offen offset:3072 lds
  v_mfma_f32_16x16x32_bf16 v[120:123], a[140:143], a[120:123], v[120:123]
  ds_read_b64_tr_b16 a[170:171], v2 offset:17984
  v_mfma_f32_16x16x32_bf16 v[120:123], a[136:139], a[104:107], v[120:123]
  v_mfma_f32_16x16x32_bf16 v[116:119], a[136:139], a[100:103], v[116:119]
  ds_read_b64_tr_b16 a[172:173], v2 offset:21568
  v_mfma_f32_16x16x32_bf16 v[116:119], a[140:143], a[116:119], v[116:119]
  v_mfma_f32_16x16x32_bf16 v[112:115], a[140:143], a[112:115], v[112:115]
  ds_read_b64_tr_b16 a[174:175], v2 offset:25152
  v_mfma_f32_16x16x32_bf16 v[112:115], a[136:139], a[96:99], v[112:115]
  s_waitcnt lgkmcnt(8)
  v_mfma_f32_16x16x32_bf16 v[128:131], a[144:147], a[96:99], v[128:131]
  ds_read_b64_tr_b16 a[128:129], v2 offset:14432
  v_mfma_f32_16x16x32_bf16 v[128:131], a[148:151], a[112:115], v[128:131]
  buffer_load_dwordx4 a[28:31], v0, s[36:39], s57 offen offset:3072 sc1
  v_mfma_f32_16x16x32_bf16 v[132:135], a[148:151], a[116:119], v[132:135]
  ds_read_b64_tr_b16 a[130:131], v2 offset:18016
  v_mfma_f32_16x16x32_bf16 v[132:135], a[144:147], a[100:103], v[132:135]
  v_mfma_f32_16x16x32_bf16 v[136:139], a[144:147], a[104:107], v[136:139]
  s_add_u32 m0, s77, 4096
  ds_read_b64_tr_b16 a[132:133], v2 offset:21600
  v_mfma_f32_16x16x32_bf16 v[136:139], a[148:151], a[120:123], v[136:139]
  v_mfma_f32_16x16x32_bf16 v[140:143], a[148:151], a[124:127], v[140:143]
  ds_read_b64_tr_b16 a[134:135], v2 offset:25184
  v_mfma_f32_16x16x32_bf16 v[140:143], a[144:147], a[108:111], v[140:143]
  v_mfma_f32_16x16x32_bf16 v[156:159], a[152:155], a[108:111], v[156:159]
  buffer_load_dwordx4 v7, s[16:19], s56 offen offset:0 lds
  s_bfe_u32 s57, s85, 0x40004
  v_mfma_f32_16x16x32_bf16 v[156:159], a[156:159], a[124:127], v[156:159]
  s_lshl_b32 s57, s57, 13
  s_add_u32 s57, s57, s86
  ds_read_b64_tr_b16 a[136:137], v2 offset:14464
  v_mfma_f32_16x16x32_bf16 v[152:155], a[156:159], a[120:123], v[152:155]
  ds_read_b64_tr_b16 a[138:139], v2 offset:18048
  v_mfma_f32_16x16x32_bf16 v[152:155], a[152:155], a[104:107], v[152:155]
  v_mfma_f32_16x16x32_bf16 v[148:151], a[152:155], a[100:103], v[148:151]
  ds_read_b64_tr_b16 a[140:141], v2 offset:21632
  v_mfma_f32_16x16x32_bf16 v[148:151], a[156:159], a[116:119], v[148:151]
  buffer_load_dwordx4 a[32:35], v0, s[36:39], s57 offen offset:0 sc1
  v_mfma_f32_16x16x32_bf16 v[144:147], a[156:159], a[112:115], v[144:147]
  ds_read_b64_tr_b16 a[142:143], v2 offset:25216
  v_mfma_f32_16x16x32_bf16 v[144:147], a[152:155], a[96:99], v[144:147]
  s_waitcnt lgkmcnt(8)
  v_mfma_f32_16x16x32_bf16 v[160:163], a[160:163], a[96:99], v[160:163]
  s_waitcnt vmcnt(7)
  ds_read_b64_tr_b16 a[144:145], v2 offset:14496
  v_accvgpr_read_b32 v22, a176
  v_mfma_f32_16x16x32_bf16 v[160:163], a[164:167], a[112:115], v[160:163]
  v_accvgpr_read_b32 v23, a177
  v_accvgpr_read_b32 v24, a178
  v_mfma_f32_16x16x32_bf16 v[164:167], a[164:167], a[116:119], v[164:167]
  ds_read_b64_tr_b16 a[146:147], v2 offset:18080
  v_accvgpr_read_b32 v25, a179
  v_mfma_f32_16x16x32_bf16 v[164:167], a[160:163], a[100:103], v[164:167]
  v_accvgpr_read_b32 v26, a180
  v_accvgpr_read_b32 v27, a181
  v_mfma_f32_16x16x32_bf16 v[168:171], a[160:163], a[104:107], v[168:171]
  ds_read_b64_tr_b16 a[148:149], v2 offset:21664
  v_accvgpr_read_b32 v28, a182
  v_mfma_f32_16x16x32_bf16 v[168:171], a[164:167], a[120:123], v[168:171]
  v_accvgpr_read_b32 v29, a183
  v_add_f32 v22, v22, v26
  v_mfma_f32_16x16x32_bf16 v[172:175], a[164:167], a[124:127], v[172:175]
  ds_read_b64_tr_b16 a[150:151], v2 offset:25248
  v_add_f32 v23, v23, v27
  v_mfma_f32_16x16x32_bf16 v[172:175], a[160:163], a[108:111], v[172:175]
  s_waitcnt vmcnt(17)
  s_barrier
  buffer_load_dwordx4 v8, s[16:19], s56 offen offset:1024 lds
  v_add_f32 v24, v24, v28
  v_mfma_f32_16x16x32_bf16 v[188:191], a[168:171], a[108:111], v[188:191]
  ds_read_b64_tr_b16 a[152:153], v2 offset:14528
  v_add_f32 v25, v25, v29
  v_mfma_f32_16x16x32_bf16 v[188:191], a[172:175], a[124:127], v[188:191]
  v_accvgpr_read_b32 v26, a184
  v_accvgpr_read_b32 v27, a185
  v_mfma_f32_16x16x32_bf16 v[184:187], a[172:175], a[120:123], v[184:187]
  ds_read_b64_tr_b16 a[154:155], v2 offset:18112
  v_accvgpr_read_b32 v28, a186
  v_mfma_f32_16x16x32_bf16 v[184:187], a[168:171], a[104:107], v[184:187]
  v_accvgpr_read_b32 v29, a187
  v_add_f32 v22, v22, v26
  v_mfma_f32_16x16x32_bf16 v[180:183], a[168:171], a[100:103], v[180:183]
  buffer_load_dwordx4 a[36:39], v0, s[36:39], s57 offen offset:1024 sc1
  v_add_f32 v23, v23, v27
  v_mfma_f32_16x16x32_bf16 v[180:183], a[172:175], a[116:119], v[180:183]
  ds_read_b64_tr_b16 a[156:157], v2 offset:21696
  v_add_f32 v24, v24, v28
  v_mfma_f32_16x16x32_bf16 v[176:179], a[172:175], a[112:115], v[176:179]
  ds_read_b64_tr_b16 a[158:159], v2 offset:25280
  v_add_f32 v25, v25, v29
  v_mfma_f32_16x16x32_bf16 v[176:179], a[168:171], a[96:99], v[176:179]
  s_waitcnt lgkmcnt(8)
  v_accvgpr_read_b32 v26, a188
  v_accvgpr_read_b32 v27, a189
  v_mfma_f32_16x16x32_bf16 v[192:195], a[128:131], a[96:99], v[192:195]
  ds_read_b64_tr_b16 a[160:161], v2 offset:28672
  v_accvgpr_read_b32 v28, a190
  v_mfma_f32_16x16x32_bf16 v[192:195], a[132:135], a[112:115], v[192:195]
  v_accvgpr_read_b32 v29, a191
  v_add_f32 v22, v22, v26
  v_mfma_f32_16x16x32_bf16 v[196:199], a[132:135], a[116:119], v[196:199]
  ds_read_b64_tr_b16 a[162:163], v2 offset:32256
  v_add_f32 v23, v23, v27
  v_mfma_f32_16x16x32_bf16 v[196:199], a[128:131], a[100:103], v[196:199]
  v_add_f32 v24, v24, v28
  v_add_f32 v25, v25, v29
  v_mfma_f32_16x16x32_bf16 v[200:203], a[128:131], a[104:107], v[200:203]
  ds_read_b64_tr_b16 a[164:165], v2 offset:35840
  v_mov_b32 v26, v22
  v_mfma_f32_16x16x32_bf16 v[200:203], a[132:135], a[120:123], v[200:203]
  v_mov_b32 v27, v23
  v_mov_b32 v28, v24
  v_mfma_f32_16x16x32_bf16 v[204:207], a[132:135], a[124:127], v[204:207]
  buffer_load_dwordx4 v9, s[16:19], s56 offen offset:2048 lds
  v_mov_b32 v29, v25
  v_mfma_f32_16x16x32_bf16 v[204:207], a[128:131], a[108:111], v[204:207]
  ds_read_b64_tr_b16 a[166:167], v2 offset:39424
  v_permlane16_swap_b32 v22, v26
  v_mfma_f32_16x16x32_bf16 v[220:223], a[136:139], a[108:111], v[220:223]
  ds_read_b64_tr_b16 a[168:169], v2 offset:28704
  v_permlane16_swap_b32 v23, v27
  v_mfma_f32_16x16x32_bf16 v[220:223], a[140:143], a[124:127], v[220:223]
  v_permlane16_swap_b32 v24, v28
  v_permlane16_swap_b32 v25, v29
  v_mfma_f32_16x16x32_bf16 v[216:219], a[140:143], a[120:123], v[216:219]
  s_add_u32 s59, s59, 16384
  ds_read_b64_tr_b16 a[170:171], v2 offset:32288
  v_add_f32 v22, v22, v26
  v_mfma_f32_16x16x32_bf16 v[216:219], a[136:139], a[104:107], v[216:219]
  buffer_load_dwordx4 a[40:43], v0, s[36:39], s57 offen offset:2048 sc1
  v_add_f32 v23, v23, v27
  v_mfma_f32_16x16x32_bf16 v[212:215], a[136:139], a[100:103], v[212:215]
  ds_read_b64_tr_b16 a[172:173], v2 offset:35872
  v_add_f32 v24, v24, v28
  v_mfma_f32_16x16x32_bf16 v[212:215], a[140:143], a[116:119], v[212:215]
  v_add_f32 v25, v25, v29
  v_mov_b32 v26, v22
  v_mfma_f32_16x16x32_bf16 v[208:211], a[140:143], a[112:115], v[208:211]
  ds_read_b64_tr_b16 a[174:175], v2 offset:39456
  v_mov_b32 v27, v23
  v_mfma_f32_16x16x32_bf16 v[208:211], a[136:139], a[96:99], v[208:211]
  s_waitcnt lgkmcnt(8)
  v_mov_b32 v28, v24
  v_mov_b32 v29, v25
  v_mfma_f32_16x16x32_bf16 v[224:227], a[144:147], a[96:99], v[224:227]
  buffer_load_dwordx4 a[208:211], v0, s[36:39], s59 offen offset:0 sc1
  v_permlane32_swap_b32 v22, v26
  v_mfma_f32_16x16x32_bf16 v[224:227], a[148:151], a[112:115], v[224:227]
  ds_read_b64_tr_b16 a[128:129], v2 offset:28736
  v_permlane32_swap_b32 v23, v27
  v_mfma_f32_16x16x32_bf16 v[228:231], a[148:151], a[116:119], v[228:231]
  ds_read_b64_tr_b16 a[130:131], v2 offset:32320
  v_permlane32_swap_b32 v24, v28
  v_mfma_f32_16x16x32_bf16 v[228:231], a[144:147], a[100:103], v[228:231]
  v_permlane32_swap_b32 v25, v29
  v_add_f32 v22, v22, v26
  v_mfma_f32_16x16x32_bf16 v[232:235], a[144:147], a[104:107], v[232:235]
  ds_read_b64_tr_b16 a[132:133], v2 offset:35904
  v_add_f32 v23, v23, v27
  v_mfma_f32_16x16x32_bf16 v[232:235], a[148:151], a[120:123], v[232:235]
  buffer_load_dwordx4 a[212:215], v0, s[36:39], s59 offen offset:1024 sc1
  v_add_f32 v24, v24, v28
  v_mfma_f32_16x16x32_bf16 v[236:239], a[148:151], a[124:127], v[236:239]
  ds_read_b64_tr_b16 a[134:135], v2 offset:39488
  v_add_f32 v25, v25, v29
  v_mfma_f32_16x16x32_bf16 v[236:239], a[144:147], a[108:111], v[236:239]
  v_mul_f32 v22, 0x3a800000, v22
  v_mul_f32 v23, 0x3a800000, v23
  v_mfma_f32_16x16x32_bf16 v[252:255], a[152:155], a[108:111], v[252:255]
  ds_read_b64_tr_b16 a[136:137], v2 offset:28768
  v_fma_f32 v23, -v22, v22, v23
  v_mfma_f32_16x16x32_bf16 v[252:255], a[156:159], a[124:127], v[252:255]
  v_max_f32 v23, 0, v23
  v_cvt_pk_bf16_f32 v23, v23, v23
  v_mfma_f32_16x16x32_bf16 v[248:251], a[156:159], a[120:123], v[248:251]
  buffer_load_dwordx4 a[44:47], v0, s[36:39], s57 offen offset:3072 sc1
  s_bfe_u32 s56, s85, 0x30008
  v_mfma_f32_16x16x32_bf16 v[248:251], a[152:155], a[104:107], v[248:251]
  s_lshl_b32 s56, s56, 2
  s_bitcmp1_b32 s85, 11
  s_addc_u32 s56, s56, 0
  v_mfma_f32_16x16x32_bf16 v[244:247], a[152:155], a[100:103], v[244:247]
  s_mul_i32 s56, s56, 229376
  s_add_u32 m0, s77, 28672
  ds_read_b64_tr_b16 a[138:139], v2 offset:32352
  v_mfma_f32_16x16x32_bf16 v[244:247], a[156:159], a[116:119], v[244:247]
  ds_read_b64_tr_b16 a[140:141], v2 offset:35936
  v_lshlrev_b32 v23, 16, v23
  v_mfma_f32_16x16x32_bf16 v[240:243], a[156:159], a[112:115], v[240:243]
  ds_read_b64_tr_b16 a[142:143], v2 offset:39520
  v_add_f32 v23, 0x3727c5ac, v23
  v_mfma_f32_16x16x32_bf16 v[240:243], a[152:155], a[96:99], v[240:243]
  s_waitcnt vmcnt(9) lgkmcnt(8)
  buffer_load_dwordx4 v3, s[16:19], s56 offen offset:0 lds
  v_cvt_pk_bf16_f32 v23, v23, v23
  v_mfma_f32_16x16x32_bf16 v[32:35], a[160:163], a[0:3], v[32:35]
  s_add_u32 s57, s57, 4096
  ds_read_b64_tr_b16 a[144:145], v2 offset:28800
  v_lshlrev_b32 v23, 16, v23
  v_mfma_f32_16x16x32_bf16 v[32:35], a[164:167], a[16:19], v[32:35]
  s_barrier
  v_sqrt_f32 v23, v23
  v_mfma_f32_16x16x32_bf16 v[36:39], a[164:167], a[20:23], v[36:39]
  s_nop 0
  ds_read_b64_tr_b16 a[146:147], v2 offset:32384
  v_cvt_pk_bf16_f32 v12, -v22, v23
  v_mfma_f32_16x16x32_bf16 v[36:39], a[160:163], a[4:7], v[36:39]
  v_and_b32 v23, 0xffff0000, v12
  v_mfma_f32_16x16x32_bf16 v[40:43], a[160:163], a[8:11], v[40:43]
  buffer_load_dwordx4 a[48:51], v0, s[36:39], s57 offen offset:0 sc1
  v_mfma_f32_16x16x32_bf16 v[40:43], a[164:167], a[24:27], v[40:43]
  ds_read_b64_tr_b16 a[148:149], v2 offset:35968
  v_mfma_f32_16x16x32_bf16 v[44:47], a[164:167], a[28:31], v[44:47]
  ds_read_b64_tr_b16 a[150:151], v2 offset:39552
  v_mfma_f32_16x16x32_bf16 v[44:47], a[160:163], a[12:15], v[44:47]
  v_rcp_f32 v10, v23
  v_mfma_f32_16x16x32_bf16 v[60:63], a[168:171], a[12:15], v[60:63]
  ds_read_b64_tr_b16 a[152:153], v2 offset:28832
  v_mul_f32 v11, v23, v23
  v_mfma_f32_16x16x32_bf16 v[60:63], a[172:175], a[28:31], v[60:63]
  v_mul_f32 v10, 0xbfb8aa3b, v10
  v_mul_f32 v24, 0x3a800000, v24
  v_mfma_f32_16x16x32_bf16 v[56:59], a[172:175], a[24:27], v[56:59]
  ds_read_b64_tr_b16 a[154:155], v2 offset:32416
  v_mul_f32 v25, 0x3a800000, v25
  v_mfma_f32_16x16x32_bf16 v[56:59], a[168:171], a[8:11], v[56:59]
  buffer_load_dwordx4 v4, s[16:19], s56 offen offset:1024 lds
  v_fma_f32 v25, -v24, v24, v25
  v_mfma_f32_16x16x32_bf16 v[52:55], a[168:171], a[4:7], v[52:55]
  ds_read_b64_tr_b16 a[156:157], v2 offset:36000
  v_max_f32 v25, 0, v25
  v_mfma_f32_16x16x32_bf16 v[52:55], a[172:175], a[20:23], v[52:55]
  v_cvt_pk_bf16_f32 v25, v25, v25
  v_lshlrev_b32 v25, 16, v25
  v_mfma_f32_16x16x32_bf16 v[48:51], a[172:175], a[16:19], v[48:51]
  ds_read_b64_tr_b16 a[158:159], v2 offset:39584
  v_add_f32 v25, 0x3727c5ac, v25
  v_mfma_f32_16x16x32_bf16 v[48:51], a[168:171], a[0:3], v[48:51]
  s_waitcnt lgkmcnt(8)
  v_cvt_pk_bf16_f32 v25, v25, v25
  v_lshlrev_b32 v25, 16, v25
  v_mfma_f32_16x16x32_bf16 v[64:67], a[128:131], a[0:3], v[64:67]
  ds_read_b64_tr_b16 a[160:161], v2 offset:28864
  v_mfma_f32_16x16x32_bf16 v[64:67], a[132:135], a[16:19], v[64:67]
  v_sqrt_f32 v25, v25
  v_mfma_f32_16x16x32_bf16 v[68:71], a[132:135], a[20:23], v[68:71]
  s_nop 0
  ds_read_b64_tr_b16 a[162:163], v2 offset:32448
  v_cvt_pk_bf16_f32 v15, -v24, v25
  v_mfma_f32_16x16x32_bf16 v[68:71], a[128:131], a[4:7], v[68:71]
  buffer_load_dwordx4 a[52:55], v0, s[36:39], s57 offen offset:1024 sc1
  v_and_b32 v25, 0xffff0000, v15
  v_mfma_f32_16x16x32_bf16 v[72:75], a[128:131], a[8:11], v[72:75]
  ds_read_b64_tr_b16 a[164:165], v2 offset:36032
  v_mfma_f32_16x16x32_bf16 v[72:75], a[132:135], a[24:27], v[72:75]
  v_rcp_f32 v13, v25
  v_mfma_f32_16x16x32_bf16 v[76:79], a[132:135], a[28:31], v[76:79]
  ds_read_b64_tr_b16 a[166:167], v2 offset:39616
  v_mul_f32 v14, v25, v25
  v_mfma_f32_16x16x32_bf16 v[76:79], a[128:131], a[12:15], v[76:79]
  v_mul_f32 v13, 0xbfb8aa3b, v13
  v_accvgpr_read_b32 v22, a192
  v_mfma_f32_16x16x32_bf16 v[92:95], a[136:139], a[12:15], v[92:95]
  ds_read_b64_tr_b16 a[168:169], v2 offset:43008
  v_accvgpr_read_b32 v23, a193
  v_mfma_f32_16x16x32_bf16 v[92:95], a[140:143], a[28:31], v[92:95]
  v_accvgpr_read_b32 v24, a194
  v_accvgpr_read_b32 v25, a195
  v_mfma_f32_16x16x32_bf16 v[88:91], a[140:143], a[24:27], v[88:91]
  buffer_load_dwordx4 v5, s[16:19], s56 offen offset:2048 lds
  v_accvgpr_read_b32 v26, a196
  v_mfma_f32_16x16x32_bf16 v[88:91], a[136:139], a[8:11], v[88:91]
  ds_read_b64_tr_b16 a[170:171], v2 offset:46592
  v_accvgpr_read_b32 v27, a197
  v_mfma_f32_16x16x32_bf16 v[84:87], a[136:139], a[4:7], v[84:87]
  ds_read_b64_tr_b16 a[172:173], v2 offset:50176
  v_accvgpr_read_b32 v28, a198
  v_mfma_f32_16x16x32_bf16 v[84:87], a[140:143], a[20:23], v[84:87]
  v_accvgpr_read_b32 v29, a199
  v_add_f32 v22, v22, v26
  v_mfma_f32_16x16x32_bf16 v[80:83], a[140:143], a[16:19], v[80:83]
  ds_read_b64_tr_b16 a[174:175], v2 offset:53760
  v_add_f32 v23, v23, v27
  v_mfma_f32_16x16x32_bf16 v[80:83], a[136:139], a[0:3], v[80:83]
  s_waitcnt lgkmcnt(8)
  v_add_f32 v24, v24, v28
  v_add_f32 v25, v25, v29
  v_mfma_f32_16x16x32_bf16 v[96:99], a[144:147], a[0:3], v[96:99]
  ds_read_b64_tr_b16 a[128:129], v2 offset:43040
  v_accvgpr_read_b32 v26, a200
  v_mfma_f32_16x16x32_bf16 v[96:99], a[148:151], a[16:19], v[96:99]
  v_accvgpr_read_b32 v27, a201
  v_accvgpr_read_b32 v28, a202
  v_mfma_f32_16x16x32_bf16 v[100:103], a[148:151], a[20:23], v[100:103]
  buffer_load_dwordx4 a[56:59], v0, s[36:39], s57 offen offset:2048 sc1
  v_accvgpr_read_b32 v29, a203
  v_mfma_f32_16x16x32_bf16 v[100:103], a[144:147], a[4:7], v[100:103]
  ds_read_b64_tr_b16 a[130:131], v2 offset:46624
  v_add_f32 v22, v22, v26
  v_mfma_f32_16x16x32_bf16 v[104:107], a[144:147], a[8:11], v[104:107]
  ds_read_b64_tr_b16 a[132:133], v2 offset:50208
  v_add_f32 v23, v23, v27
  v_mfma_f32_16x16x32_bf16 v[104:107], a[148:151], a[24:27], v[104:107]
  v_add_f32 v24, v24, v28
  v_add_f32 v25, v25, v29
  v_mfma_f32_16x16x32_bf16 v[108:111], a[148:151], a[28:31], v[108:111]
  ds_read_b64_tr_b16 a[134:135], v2 offset:53792
  v_accvgpr_read_b32 v26, a204
  v_mfma_f32_16x16x32_bf16 v[108:111], a[144:147], a[12:15], v[108:111]
  v_accvgpr_read_b32 v27, a205
  v_accvgpr_read_b32 v28, a206
  v_mfma_f32_16x16x32_bf16 v[124:127], a[152:155], a[12:15], v[124:127]
  ds_read_b64_tr_b16 a[136:137], v2 offset:43072
  v_accvgpr_read_b32 v29, a207
  v_mfma_f32_16x16x32_bf16 v[124:127], a[156:159], a[28:31], v[124:127]
  buffer_load_dwordx4 v6, s[16:19], s56 offen offset:3072 lds
  v_add_f32 v22, v22, v26
  v_mfma_f32_16x16x32_bf16 v[120:123], a[156:159], a[24:27], v[120:123]
  ds_read_b64_tr_b16 a[138:139], v2 offset:46656
  v_add_f32 v23, v23, v27
  v_mfma_f32_16x16x32_bf16 v[120:123], a[152:155], a[8:11], v[120:123]
  v_add_f32 v24, v24, v28
  v_add_f32 v25, v25, v29
  v_mfma_f32_16x16x32_bf16 v[116:119], a[152:155], a[4:7], v[116:119]
  ds_read_b64_tr_b16 a[140:141], v2 offset:50240
  v_mov_b32 v26, v22
  v_mfma_f32_16x16x32_bf16 v[116:119], a[156:159], a[20:23], v[116:119]
  v_mov_b32 v27, v23
  v_mov_b32 v28, v24
  v_mfma_f32_16x16x32_bf16 v[112:115], a[156:159], a[16:19], v[112:115]
  ds_read_b64_tr_b16 a[142:143], v2 offset:53824
  v_mov_b32 v29, v25
  v_mfma_f32_16x16x32_bf16 v[112:115], a[152:155], a[0:3], v[112:115]
  s_waitcnt lgkmcnt(8)
  v_permlane16_swap_b32 v22, v26
  v_permlane16_swap_b32 v23, v27
  v_mfma_f32_16x16x32_bf16 v[128:131], a[160:163], a[0:3], v[128:131]
  ds_read_b64_tr_b16 a[144:145], v2 offset:43104
  v_permlane16_swap_b32 v24, v28
  v_mfma_f32_16x16x32_bf16 v[128:131], a[164:167], a[16:19], v[128:131]
  buffer_load_dwordx4 a[60:63], v0, s[36:39], s57 offen offset:3072 sc1
  v_permlane16_swap_b32 v25, v29
  v_mfma_f32_16x16x32_bf16 v[132:135], a[164:167], a[20:23], v[132:135]
  s_add_u32 m0, s77, 32768
  ds_read_b64_tr_b16 a[146:147], v2 offset:46688
  v_add_f32 v22, v22, v26
  v_mfma_f32_16x16x32_bf16 v[132:135], a[160:163], a[4:7], v[132:135]
Hc0_1:
  s_cbranch_execz Hc0_2
  v_add_f32 v23, v23, v27
  v_add_f32 v24, v24, v28
  v_mfma_f32_16x16x32_bf16 v[136:139], a[160:163], a[8:11], v[136:139]
  ds_read_b64_tr_b16 a[148:149], v2 offset:50272
  v_add_f32 v25, v25, v29
  v_mfma_f32_16x16x32_bf16 v[136:139], a[164:167], a[24:27], v[136:139]
  v_mov_b32 v26, v22
  v_mov_b32 v27, v23
  v_mfma_f32_16x16x32_bf16 v[140:143], a[164:167], a[28:31], v[140:143]
  buffer_load_dwordx4 v7, s[16:19], s56 offen offset:0 lds
  s_bfe_u32 s57, s85, 0x40008
  v_mfma_f32_16x16x32_bf16 v[140:143], a[160:163], a[12:15], v[140:143]
  s_lshl_b32 s57, s57, 13
  s_add_u32 s57, s57, s86
  ds_read_b64_tr_b16 a[150:151], v2 offset:53856
  v_mfma_f32_16x16x32_bf16 v[156:159], a[168:171], a[12:15], v[156:159]
  ds_read_b64_tr_b16 a[152:153], v2 offset:43136
  v_mov_b32 v28, v24
  v_mfma_f32_16x16x32_bf16 v[156:159], a[172:175], a[28:31], v[156:159]
  v_mov_b32 v29, v25
  v_permlane32_swap_b32 v22, v26
  v_mfma_f32_16x16x32_bf16 v[152:155], a[172:175], a[24:27], v[152:155]
  ds_read_b64_tr_b16 a[154:155], v2 offset:46720
  v_permlane32_swap_b32 v23, v27
  v_mfma_f32_16x16x32_bf16 v[152:155], a[168:171], a[8:11], v[152:155]
  buffer_load_dwordx4 a[64:67], v0, s[36:39], s57 offen offset:0 sc1
  v_permlane32_swap_b32 v24, v28
  v_mfma_f32_16x16x32_bf16 v[148:151], a[168:171], a[4:7], v[148:151]
  ds_read_b64_tr_b16 a[156:157], v2 offset:50304
  v_permlane32_swap_b32 v25, v29
  v_mfma_f32_16x16x32_bf16 v[148:151], a[172:175], a[20:23], v[148:151]
  v_add_f32 v22, v22, v26
  v_add_f32 v23, v23, v27
  v_mfma_f32_16x16x32_bf16 v[144:147], a[172:175], a[16:19], v[144:147]
  ds_read_b64_tr_b16 a[158:159], v2 offset:53888
  v_add_f32 v24, v24, v28
  v_mfma_f32_16x16x32_bf16 v[144:147], a[168:171], a[0:3], v[144:147]
  s_waitcnt lgkmcnt(8)
  v_add_f32 v25, v25, v29
  v_mul_f32 v22, 0x3a800000, v22
  v_mfma_f32_16x16x32_bf16 v[160:163], a[128:131], a[0:3], v[160:163]
  ds_read_b64_tr_b16 a[160:161], v2 offset:43168
  v_mul_f32 v23, 0x3a800000, v23
  v_mfma_f32_16x16x32_bf16 v[160:163], a[132:135], a[16:19], v[160:163]
  v_fma_f32 v23, -v22, v22, v23
  v_max_f32 v23, 0, v23
  v_mfma_f32_16x16x32_bf16 v[164:167], a[132:135], a[20:23], v[164:167]
  buffer_load_dwordx4 v8, s[16:19], s56 offen offset:1024 lds
  v_cvt_pk_bf16_f32 v23, v23, v23
  v_mfma_f32_16x16x32_bf16 v[164:167], a[128:131], a[4:7], v[164:167]
  ds_read_b64_tr_b16 a[162:163], v2 offset:46752
  v_lshlrev_b32 v23, 16, v23
  v_mfma_f32_16x16x32_bf16 v[168:171], a[128:131], a[8:11], v[168:171]
  ds_read_b64_tr_b16 a[164:165], v2 offset:50336
  v_add_f32 v23, 0x3727c5ac, v23
  v_mfma_f32_16x16x32_bf16 v[168:171], a[132:135], a[24:27], v[168:171]
  v_cvt_pk_bf16_f32 v23, v23, v23
  v_lshlrev_b32 v23, 16, v23
  v_mfma_f32_16x16x32_bf16 v[172:175], a[132:135], a[28:31], v[172:175]
  ds_read_b64_tr_b16 a[166:167], v2 offset:53920
  v_mfma_f32_16x16x32_bf16 v[172:175], a[128:131], a[12:15], v[172:175]
  s_waitcnt vmcnt(15)
  s_barrier
  buffer_load_dwordx4 a[68:71], v0, s[36:39], s57 offen offset:1024 sc1
  v_mfma_f32_16x16x32_bf16 v[188:191], a[136:139], a[12:15], v[188:191]
  ds_read_b64_tr_b16 a[168:169], v2 offset:43200
  v_mfma_f32_16x16x32_bf16 v[188:191], a[140:143], a[28:31], v[188:191]
  v_sqrt_f32 v23, v23
  v_mfma_f32_16x16x32_bf16 v[184:187], a[140:143], a[24:27], v[184:187]
  s_nop 0
  ds_read_b64_tr_b16 a[170:171], v2 offset:46784
  v_cvt_pk_bf16_f32 v18, -v22, v23
  v_mfma_f32_16x16x32_bf16 v[184:187], a[136:139], a[8:11], v[184:187]
  v_and_b32 v23, 0xffff0000, v18
  v_mfma_f32_16x16x32_bf16 v[180:183], a[136:139], a[4:7], v[180:183]
  ds_read_b64_tr_b16 a[172:173], v2 offset:50368
  v_mfma_f32_16x16x32_bf16 v[180:183], a[140:143], a[20:23], v[180:183]
  v_rcp_f32 v16, v23
  v_mfma_f32_16x16x32_bf16 v[176:179], a[140:143], a[16:19], v[176:179]
  buffer_load_dwordx4 v9, s[16:19], s56 offen offset:2048 lds
  v_mul_f32 v17, v23, v23
  v_mfma_f32_16x16x32_bf16 v[176:179], a[136:139], a[0:3], v[176:179]
  s_waitcnt lgkmcnt(7)
  ds_read_b64_tr_b16 a[174:175], v2 offset:53952
  v_mul_f32 v16, 0xbfb8aa3b, v16
  v_mfma_f32_16x16x32_bf16 v[192:195], a[144:147], a[0:3], v[192:195]
  ds_read_b64_tr_b16 a[128:129], v1 offset:0
  v_mul_f32 v24, 0x3a800000, v24
  v_mfma_f32_16x16x32_bf16 v[192:195], a[148:151], a[16:19], v[192:195]
  v_mul_f32 v25, 0x3a800000, v25
  v_fma_f32 v25, -v24, v24, v25
  v_mfma_f32_16x16x32_bf16 v[196:199], a[148:151], a[20:23], v[196:199]
  ds_read_b64_tr_b16 a[130:131], v1 offset:3584
  v_max_f32 v25, 0, v25
  v_mfma_f32_16x16x32_bf16 v[196:199], a[144:147], a[4:7], v[196:199]
  v_cvt_pk_bf16_f32 v25, v25, v25
  v_lshlrev_b32 v25, 16, v25
  v_mfma_f32_16x16x32_bf16 v[200:203], a[144:147], a[8:11], v[200:203]
  ds_read_b64_tr_b16 a[132:133], v1 offset:7168
  v_add_f32 v25, 0x3727c5ac, v25
  v_mfma_f32_16x16x32_bf16 v[200:203], a[148:151], a[24:27], v[200:203]
  v_cvt_pk_bf16_f32 v25, v25, v25
  v_lshlrev_b32 v25, 16, v25
  v_mfma_f32_16x16x32_bf16 v[204:207], a[148:151], a[28:31], v[204:207]
  buffer_load_dwordx4 a[72:75], v0, s[36:39], s57 offen offset:2048 sc1
  v_mfma_f32_16x16x32_bf16 v[204:207], a[144:147], a[12:15], v[204:207]
  ds_read_b64_tr_b16 a[134:135], v1 offset:10752
  v_mfma_f32_16x16x32_bf16 v[220:223], a[152:155], a[12:15], v[220:223]
  ds_read_b64_tr_b16 a[136:137], v1 offset:32
  v_mfma_f32_16x16x32_bf16 v[220:223], a[156:159], a[28:31], v[220:223]
  v_sqrt_f32 v25, v25
  v_mfma_f32_16x16x32_bf16 v[216:219], a[156:159], a[24:27], v[216:219]
  s_nop 0
  ds_read_b64_tr_b16 a[138:139], v1 offset:3616
  v_cvt_pk_bf16_f32 v21, -v24, v25
  v_mfma_f32_16x16x32_bf16 v[216:219], a[152:155], a[8:11], v[216:219]
  v_and_b32 v25, 0xffff0000, v21
  v_mfma_f32_16x16x32_bf16 v[212:215], a[152:155], a[4:7], v[212:215]
  s_bfe_u32 s56, s85, 0x3000c
  s_lshl_b32 s56, s56, 2
  s_bitcmp1_b32 s85, 15
  v_mfma_f32_16x16x32_bf16 v[212:215], a[156:159], a[20:23], v[212:215]
  s_addc_u32 s56, s56, 0
  s_mul_i32 s56, s56, 229376
  s_add_u32 m0, s77, 57344
  v_mfma_f32_16x16x32_bf16 v[208:211], a[156:159], a[16:19], v[208:211]
  ds_read_b64_tr_b16 a[140:141], v1 offset:7200
  v_mfma_f32_16x16x32_bf16 v[208:211], a[152:155], a[0:3], v[208:211]
  s_waitcnt lgkmcnt(7)
  ds_read_b64_tr_b16 a[142:143], v1 offset:10784
  v_mfma_f32_16x16x32_bf16 v[224:227], a[160:163], a[0:3], v[224:227]
  buffer_load_dwordx4 v3, s[16:19], s56 offen offset:0 lds
  v_mfma_f32_16x16x32_bf16 v[224:227], a[164:167], a[16:19], v[224:227]
  v_rcp_f32 v19, v25
  v_mfma_f32_16x16x32_bf16 v[228:231], a[164:167], a[20:23], v[228:231]
  v_mul_f32 v20, v25, v25
  v_mul_f32 v19, 0xbfb8aa3b, v19
  v_mfma_f32_16x16x32_bf16 v[228:231], a[160:163], a[4:7], v[228:231]
  v_add_u32 v31, -28672, v31
  v_mfma_f32_16x16x32_bf16 v[232:235], a[160:163], a[8:11], v[232:235]
  ds_read_b64_tr_b16 a[176:177], v31 offset:0
  v_mfma_f32_16x16x32_bf16 v[232:235], a[164:167], a[24:27], v[232:235]
  buffer_load_dwordx4 a[76:79], v0, s[36:39], s57 offen offset:3072 sc1
  v_mfma_f32_16x16x32_bf16 v[236:239], a[164:167], a[28:31], v[236:239]
  ds_read_b64_tr_b16 a[178:179], v31 offset:3584
  v_mfma_f32_16x16x32_bf16 v[236:239], a[160:163], a[12:15], v[236:239]
  ds_read_b64_tr_b16 a[180:181], v31 offset:7168
  v_mfma_f32_16x16x32_bf16 v[252:255], a[168:171], a[12:15], v[252:255]
  ds_read_b64_tr_b16 a[144:145], v1 offset:64
  v_mfma_f32_16x16x32_bf16 v[252:255], a[172:175], a[28:31], v[252:255]
  ds_read_b64_tr_b16 a[182:183], v31 offset:10752
  v_mfma_f32_16x16x32_bf16 v[248:251], a[172:175], a[24:27], v[248:251]
  ds_read_b64_tr_b16 a[146:147], v1 offset:3648
  v_mfma_f32_16x16x32_bf16 v[248:251], a[168:171], a[8:11], v[248:251]
  ds_read_b64_tr_b16 a[184:185], v31 offset:32
  v_mfma_f32_16x16x32_bf16 v[244:247], a[168:171], a[4:7], v[244:247]
  buffer_load_dwordx4 v4, s[16:19], s56 offen offset:1024 lds
  v_mfma_f32_16x16x32_bf16 v[244:247], a[172:175], a[20:23], v[244:247]
  ds_read_b64_tr_b16 a[148:149], v1 offset:7232
  v_mfma_f32_16x16x32_bf16 v[240:243], a[172:175], a[16:19], v[240:243]
  s_add_u32 s57, s57, 4096
  ds_read_b64_tr_b16 a[150:151], v1 offset:10816
  v_mfma_f32_16x16x32_bf16 v[240:243], a[168:171], a[0:3], v[240:243]
  s_waitcnt vmcnt(9) lgkmcnt(9)
  ds_read_b64_tr_b16 a[186:187], v31 offset:3616
  v_mfma_f32_16x16x32_bf16 v[32:35], a[128:131], a[32:35], v[32:35]
  ds_read_b64_tr_b16 a[152:153], v1 offset:96
  v_mfma_f32_16x16x32_bf16 v[32:35], a[132:135], a[48:51], v[32:35]
  s_barrier
  ds_read_b64_tr_b16 a[188:189], v31 offset:7200
  v_mfma_f32_16x16x32_bf16 v[36:39], a[132:135], a[52:55], v[36:39]
  buffer_load_dwordx4 a[80:83], v0, s[36:39], s57 offen offset:0 sc1
  v_mfma_f32_16x16x32_bf16 v[36:39], a[128:131], a[36:39], v[36:39]
  ds_read_b64_tr_b16 a[154:155], v1 offset:3680
  v_mfma_f32_16x16x32_bf16 v[40:43], a[128:131], a[40:43], v[40:43]
  ds_read_b64_tr_b16 a[156:157], v1 offset:7264
  v_mfma_f32_16x16x32_bf16 v[40:43], a[132:135], a[56:59], v[40:43]
  ds_read_b64_tr_b16 a[190:191], v31 offset:10784
  v_mfma_f32_16x16x32_bf16 v[44:47], a[132:135], a[60:63], v[44:47]
  ds_read_b64_tr_b16 a[192:193], v31 offset:64
  ds_read_b64_tr_b16 a[194:195], v31 offset:3648
  ds_read_b64_tr_b16 a[196:197], v31 offset:7232
  ds_read_b64_tr_b16 a[198:199], v31 offset:10816
  ds_read_b64_tr_b16 a[200:201], v31 offset:96
  ds_read_b64_tr_b16 a[202:203], v31 offset:3680
  ds_read_b64_tr_b16 a[204:205], v31 offset:7264
  ds_read_b64_tr_b16 a[206:207], v31 offset:10848
  v_mfma_f32_16x16x32_bf16 v[44:47], a[128:131], a[44:47], v[44:47]
  ds_read_b64_tr_b16 a[158:159], v1 offset:10848
  v_lshrrev_b32 v22, 4, v0
  v_mfma_f32_16x16x32_bf16 v[60:63], a[136:139], a[44:47], v[60:63]
  buffer_load_dwordx4 v5, s[16:19], s56 offen offset:2048 lds
  v_and_b32 v23, 14, v22
  v_mfma_f32_16x16x32_bf16 v[60:63], a[140:143], a[60:63], v[60:63]
  ds_read_b64_tr_b16 a[160:161], v1 offset:128
  v_lshlrev_b32 v23, 27, v23
  v_mfma_f32_16x16x32_bf16 v[56:59], a[140:143], a[56:59], v[56:59]
  ds_read_b64_tr_b16 a[162:163], v1 offset:3712
  v_and_b32 v24, 1, v22
  v_mfma_f32_16x16x32_bf16 v[56:59], a[136:139], a[40:43], v[56:59]
  v_lshl_add_u32 v23, v24, 9, v23
  v_and_b32 v22, 0x30, v22
  v_mfma_f32_16x16x32_bf16 v[52:55], a[136:139], a[36:39], v[52:55]
  ds_read_b64_tr_b16 a[164:165], v1 offset:7296
  v_add_u32 v22, v22, v23
  v_mfma_f32_16x16x32_bf16 v[52:55], a[140:143], a[52:55], v[52:55]
  s_lshl3_add_u32 s78, s60, s58
  buffer_load_dwordx4 a[84:87], v0, s[36:39], s57 offen offset:1024 sc1
  s_lshr_b32 s79, s44, 1
  v_mfma_f32_16x16x32_bf16 v[48:51], a[140:143], a[48:51], v[48:51]
  s_lshl1_add_u32 s78, s78, s79
  ds_read_b64_tr_b16 a[166:167], v1 offset:10880
  s_and_b32 s79, s44, 1
  v_mfma_f32_16x16x32_bf16 v[48:51], a[136:139], a[32:35], v[48:51]
  s_waitcnt vmcnt(21) lgkmcnt(5)
  s_lshl2_add_u32 s78, s78, s79
  s_lshl_b32 s78, s78, 8
  v_mfma_f32_16x16x32_bf16 a[216:219], a[176:179], a[208:211], a[216:219]
  s_add_u32 s78, s78, 524288
  ds_read_b64_tr_b16 a[168:169], v1 offset:160
  v_mfma_f32_16x16x32_bf16 a[216:219], a[180:183], a[212:215], a[216:219]
  v_mfma_f32_16x16x32_bf16 a[220:223], a[184:187], a[208:211], a[220:223]
  ds_read_b64_tr_b16 a[170:171], v1 offset:3744
  v_mfma_f32_16x16x32_bf16 a[220:223], a[188:191], a[212:215], a[220:223]
  v_mfma_f32_16x16x32_bf16 a[224:227], a[192:195], a[208:211], a[224:227]
  buffer_load_dwordx4 v6, s[16:19], s56 offen offset:3072 lds
  v_mfma_f32_16x16x32_bf16 a[224:227], a[196:199], a[212:215], a[224:227]
  ds_read_b64_tr_b16 a[172:173], v1 offset:7328
  v_mfma_f32_16x16x32_bf16 a[228:231], a[200:203], a[208:211], a[228:231]
  ds_read_b64_tr_b16 a[174:175], v1 offset:10912
  v_mfma_f32_16x16x32_bf16 a[228:231], a[204:207], a[212:215], a[228:231]
  s_waitcnt lgkmcnt(8)
  v_mfma_f32_16x16x32_bf16 v[64:67], a[144:147], a[32:35], v[64:67]
  ds_read_b64_tr_b16 a[128:129], v1 offset:192
  v_mfma_f32_16x16x32_bf16 v[64:67], a[148:151], a[48:51], v[64:67]
  buffer_load_dwordx4 a[88:91], v0, s[36:39], s57 offen offset:2048 sc1
  v_mfma_f32_16x16x32_bf16 v[68:71], a[148:151], a[52:55], v[68:71]
  ds_read_b64_tr_b16 a[130:131], v1 offset:3776
  v_mfma_f32_16x16x32_bf16 v[68:71], a[144:147], a[36:39], v[68:71]
  s_add_u32 m0, s77, 61440
  v_mfma_f32_16x16x32_bf16 v[72:75], a[144:147], a[40:43], v[72:75]
  ds_read_b64_tr_b16 a[132:133], v1 offset:7360
  v_mfma_f32_16x16x32_bf16 v[72:75], a[148:151], a[56:59], v[72:75]
  v_mfma_f32_16x16x32_bf16 v[76:79], a[148:151], a[60:63], v[76:79]
  ds_read_b64_tr_b16 a[134:135], v1 offset:10944
  v_mfma_f32_16x16x32_bf16 v[76:79], a[144:147], a[44:47], v[76:79]
  buffer_load_dwordx4 v7, s[16:19], s56 offen offset:0 lds
  v_mfma_f32_16x16x32_bf16 v[92:95], a[152:155], a[44:47], v[92:95]
  ds_read_b64_tr_b16 a[136:137], v1 offset:14336
  v_mfma_f32_16x16x32_bf16 v[92:95], a[156:159], a[60:63], v[92:95]
  v_mfma_f32_16x16x32_bf16 v[88:91], a[156:159], a[56:59], v[88:91]
  ds_read_b64_tr_b16 a[138:139], v1 offset:17920
  v_mfma_f32_16x16x32_bf16 v[88:91], a[152:155], a[40:43], v[88:91]
  v_mfma_f32_16x16x32_bf16 v[84:87], a[152:155], a[36:39], v[84:87]
  buffer_load_dwordx4 a[92:95], v0, s[36:39], s57 offen offset:3072 sc1
  s_bfe_u32 s57, s85, 0x4000c
  v_mfma_f32_16x16x32_bf16 v[84:87], a[156:159], a[52:55], v[84:87]
  s_lshl_b32 s57, s57, 13
  s_add_u32 s57, s57, s86
  ds_read_b64_tr_b16 a[140:141], v1 offset:21504
  v_mfma_f32_16x16x32_bf16 v[80:83], a[156:159], a[48:51], v[80:83]
  ds_read_b64_tr_b16 a[142:143], v1 offset:25088
  v_mfma_f32_16x16x32_bf16 v[80:83], a[152:155], a[32:35], v[80:83]
  s_waitcnt lgkmcnt(8)
  v_mfma_f32_16x16x32_bf16 v[96:99], a[160:163], a[32:35], v[96:99]
  ds_read_b64_tr_b16 a[144:145], v1 offset:14368
  v_mfma_f32_16x16x32_bf16 v[96:99], a[164:167], a[48:51], v[96:99]
  buffer_load_dwordx4 a[96:99], v0, s[36:39], s57 offen offset:0 sc1
  v_mfma_f32_16x16x32_bf16 v[100:103], a[164:167], a[52:55], v[100:103]
  buffer_store_dwordx4 a[216:219], v22, s[36:39], s78 offen offset:0 sc1
  v_mfma_f32_16x16x32_bf16 v[100:103], a[160:163], a[36:39], v[100:103]
  ds_read_b64_tr_b16 a[146:147], v1 offset:17952
  v_mfma_f32_16x16x32_bf16 v[104:107], a[160:163], a[40:43], v[104:107]
  ds_read_b64_tr_b16 a[148:149], v1 offset:21536
  v_mfma_f32_16x16x32_bf16 v[104:107], a[164:167], a[56:59], v[104:107]
  v_mfma_f32_16x16x32_bf16 v[108:111], a[164:167], a[60:63], v[108:111]
  buffer_store_dwordx4 a[220:223], v22, s[36:39], s78 offen offset:64 sc1
  v_mfma_f32_16x16x32_bf16 v[108:111], a[160:163], a[44:47], v[108:111]
  ds_read_b64_tr_b16 a[150:151], v1 offset:25120
  v_mfma_f32_16x16x32_bf16 v[124:127], a[168:171], a[44:47], v[124:127]
  ds_read_b64_tr_b16 a[152:153], v1 offset:14400
  v_mfma_f32_16x16x32_bf16 v[124:127], a[172:175], a[60:63], v[124:127]
  v_mfma_f32_16x16x32_bf16 v[120:123], a[172:175], a[56:59], v[120:123]
  buffer_store_dwordx4 a[224:227], v22, s[36:39], s78 offen offset:128 sc1
  v_mfma_f32_16x16x32_bf16 v[120:123], a[168:171], a[40:43], v[120:123]
  ds_read_b64_tr_b16 a[154:155], v1 offset:17984
  v_mfma_f32_16x16x32_bf16 v[116:119], a[168:171], a[36:39], v[116:119]
  ds_read_b64_tr_b16 a[156:157], v1 offset:21568
  v_mfma_f32_16x16x32_bf16 v[116:119], a[172:175], a[52:55], v[116:119]
  v_mfma_f32_16x16x32_bf16 v[112:115], a[172:175], a[48:51], v[112:115]
  buffer_store_dwordx4 a[228:231], v22, s[36:39], s78 offen offset:192 sc1
  s_lshl_b32 s79, s60, 14
  v_mfma_f32_16x16x32_bf16 v[112:115], a[168:171], a[32:35], v[112:115]
  s_waitcnt lgkmcnt(7)
  ds_read_b64_tr_b16 a[158:159], v1 offset:25152
  s_lshl_b32 s80, s44, 9
  v_mfma_f32_16x16x32_bf16 v[128:131], a[128:131], a[32:35], v[128:131]
  s_add_u32 s79, s79, s80
  ds_read_b64_tr_b16 a[160:161], v1 offset:14432
  s_add_u32 s79, s79, 524288
  v_mfma_f32_16x16x32_bf16 v[128:131], a[132:135], a[48:51], v[128:131]
  s_lshr_b32 s80, s44, 1
  s_lshl_b32 s80, s80, 8
  s_and_b32 s65, s44, 1
  v_mfma_f32_16x16x32_bf16 v[132:135], a[132:135], a[52:55], v[132:135]
  s_add_u32 s80, s80, s65
  ds_read_b64_tr_b16 a[162:163], v1 offset:18016
  s_lshl3_add_u32 s80, s80, 159744
  v_mfma_f32_16x16x32_bf16 v[132:135], a[128:131], a[36:39], v[132:135]
  buffer_load_dwordx4 v8, s[16:19], s56 offen offset:1024 lds
  v_and_b32 v24, 0x1f0, v0
  v_mfma_f32_16x16x32_bf16 v[136:139], a[128:131], a[40:43], v[136:139]
  ds_read_b64_tr_b16 a[164:165], v1 offset:21600
  v_min_u32 v24, 432, v24
  v_mfma_f32_16x16x32_bf16 v[136:139], a[132:135], a[56:59], v[136:139]
  v_and_b32 v26, 0x200, v0
  v_lshl_add_u32 v25, v26, 4, v24
  v_mfma_f32_16x16x32_bf16 v[140:143], a[132:135], a[60:63], v[140:143]
  ds_read_b64_tr_b16 a[166:167], v1 offset:25184
  v_lshrrev_b32 v26, 4, v26
  v_mfma_f32_16x16x32_bf16 v[140:143], a[128:131], a[44:47], v[140:143]
  v_lshl_add_u32 v24, v24, 2, v26
  v_add_u32 v24, s80, v24
  v_mfma_f32_16x16x32_bf16 v[156:159], a[136:139], a[44:47], v[156:159]
  s_lshl2_add_u32 s65, s58, s44
  buffer_load_dwordx4 a[100:103], v0, s[36:39], s57 offen offset:1024 sc1
  s_lshl_b32 s65, s65, 19
  v_mfma_f32_16x16x32_bf16 v[156:159], a[140:143], a[60:63], v[156:159]
  s_mul_i32 s66, s60, 7
  ds_read_b64_tr_b16 a[168:169], v1 offset:14464
  s_and_b32 s80, s60, 1
  v_mfma_f32_16x16x32_bf16 v[152:155], a[140:143], a[56:59], v[152:155]
  s_add_u32 s66, s66, s80
  ds_read_b64_tr_b16 a[170:171], v1 offset:18048
  s_lshl_b32 s66, s66, 10
  v_mfma_f32_16x16x32_bf16 v[152:155], a[136:139], a[40:43], v[152:155]
  s_add_u32 s65, s65, s66
  s_add_u32 s67, s65, 19922944
  s_mul_i32 s80, s80, 7680
  v_mfma_f32_16x16x32_bf16 v[148:151], a[136:139], a[36:39], v[148:151]
  s_sub_u32 s65, s67, s80
  ds_read_b64_tr_b16 a[172:173], v1 offset:21632
  s_add_u32 s65, s65, 6144
  v_mfma_f32_16x16x32_bf16 v[148:151], a[140:143], a[52:55], v[148:151]
  s_add_u32 s66, s65, 262144
  buffer_load_dwordx4 v9, s[16:19], s56 offen offset:2048 lds
  s_lshl_b32 s45, s2, 7
  v_mfma_f32_16x16x32_bf16 v[144:147], a[140:143], a[48:51], v[144:147]
  s_add_u32 s45, s45, 5373952
  ds_read_b64_tr_b16 a[174:175], v1 offset:25216
  s_cmp_eq_u32 s44, 0
  v_mfma_f32_16x16x32_bf16 v[144:147], a[136:139], a[32:35], v[144:147]
  s_waitcnt lgkmcnt(8)
  s_cselect_b32 s45, s45, 1073741824
  s_add_u32 s78, s79, 4096
  v_mfma_f32_16x16x32_bf16 v[160:163], a[144:147], a[32:35], v[160:163]
  ds_read_b64_tr_b16 a[128:129], v1 offset:14496
  v_mfma_f32_16x16x32_bf16 v[160:163], a[148:151], a[48:51], v[160:163]
  v_mfma_f32_16x16x32_bf16 v[164:167], a[148:151], a[52:55], v[164:167]
  buffer_load_dwordx4 a[104:107], v0, s[36:39], s57 offen offset:2048 sc1
  v_mfma_f32_16x16x32_bf16 v[164:167], a[144:147], a[36:39], v[164:167]
  ds_read_b64_tr_b16 a[130:131], v1 offset:18080
  v_mfma_f32_16x16x32_bf16 v[168:171], a[144:147], a[40:43], v[168:171]
  ds_read_b64_tr_b16 a[132:133], v1 offset:21664
  v_mfma_f32_16x16x32_bf16 v[168:171], a[148:151], a[56:59], v[168:171]
  v_mfma_f32_16x16x32_bf16 v[172:175], a[148:151], a[60:63], v[172:175]
  ds_read_b64_tr_b16 a[134:135], v1 offset:25248
  v_mfma_f32_16x16x32_bf16 v[172:175], a[144:147], a[44:47], v[172:175]
  s_waitcnt vmcnt(20)
  s_barrier
  buffer_load_dwordx4 a[108:111], v0, s[36:39], s57 offen offset:3072 sc1
  s_bfe_u32 s56, s85, 0x30010
  v_mfma_f32_16x16x32_bf16 v[188:191], a[152:155], a[44:47], v[188:191]
  s_lshl_b32 s56, s56, 2
  s_bitcmp1_b32 s85, 19
  s_addc_u32 s56, s56, 0
  v_mfma_f32_16x16x32_bf16 v[188:191], a[156:159], a[60:63], v[188:191]
  s_mul_i32 s56, s56, 229376
  s_add_u32 m0, s77, 86016
  ds_read_b64_tr_b16 a[136:137], v1 offset:14528
  v_mfma_f32_16x16x32_bf16 v[184:187], a[156:159], a[56:59], v[184:187]
  ds_read_b64_tr_b16 a[138:139], v1 offset:18112
  v_mfma_f32_16x16x32_bf16 v[184:187], a[152:155], a[40:43], v[184:187]
  v_mfma_f32_16x16x32_bf16 v[180:183], a[152:155], a[36:39], v[180:183]
  buffer_load_dwordx4 v3, s[16:19], s56 offen offset:0 lds
  s_add_u32 s57, s57, 4096
  v_mfma_f32_16x16x32_bf16 v[180:183], a[156:159], a[52:55], v[180:183]
  ds_read_b64_tr_b16 a[140:141], v1 offset:21696
  v_mfma_f32_16x16x32_bf16 v[176:179], a[156:159], a[48:51], v[176:179]
  ds_read_b64_tr_b16 a[142:143], v1 offset:25280
  v_mfma_f32_16x16x32_bf16 v[176:179], a[152:155], a[32:35], v[176:179]
  s_waitcnt lgkmcnt(8)
  v_mfma_f32_16x16x32_bf16 v[192:195], a[160:163], a[32:35], v[192:195]
  ds_read_b64_tr_b16 a[144:145], v1 offset:28672
  v_mfma_f32_16x16x32_bf16 v[192:195], a[164:167], a[48:51], v[192:195]
  buffer_load_dwordx4 a[112:115], v0, s[36:39], s57 offen offset:0 sc1
  v_mfma_f32_16x16x32_bf16 v[196:199], a[164:167], a[52:55], v[196:199]
  ds_read_b64_tr_b16 a[146:147], v1 offset:32256
  v_mfma_f32_16x16x32_bf16 v[196:199], a[160:163], a[36:39], v[196:199]
  v_mfma_f32_16x16x32_bf16 v[200:203], a[160:163], a[40:43], v[200:203]
  ds_read_b64_tr_b16 a[148:149], v1 offset:35840
  v_mfma_f32_16x16x32_bf16 v[200:203], a[164:167], a[56:59], v[200:203]
  v_mfma_f32_16x16x32_bf16 v[204:207], a[164:167], a[60:63], v[204:207]
  buffer_load_dwordx4 v4, s[16:19], s56 offen offset:1024 lds
  v_mfma_f32_16x16x32_bf16 v[204:207], a[160:163], a[44:47], v[204:207]
  ds_read_b64_tr_b16 a[150:151], v1 offset:39424
  v_mfma_f32_16x16x32_bf16 v[220:223], a[168:171], a[44:47], v[220:223]
  ds_read_b64_tr_b16 a[152:153], v1 offset:28704
  v_mfma_f32_16x16x32_bf16 v[220:223], a[172:175], a[60:63], v[220:223]
  v_mfma_f32_16x16x32_bf16 v[216:219], a[172:175], a[56:59], v[216:219]
  ds_read_b64_tr_b16 a[154:155], v1 offset:32288
  v_mfma_f32_16x16x32_bf16 v[216:219], a[168:171], a[40:43], v[216:219]
  buffer_load_dwordx4 a[116:119], v0, s[36:39], s57 offen offset:1024 sc1
  v_mfma_f32_16x16x32_bf16 v[212:215], a[168:171], a[36:39], v[212:215]
  ds_read_b64_tr_b16 a[156:157], v1 offset:35872
  v_mfma_f32_16x16x32_bf16 v[212:215], a[172:175], a[52:55], v[212:215]
  v_mfma_f32_16x16x32_bf16 v[208:211], a[172:175], a[48:51], v[208:211]
  ds_read_b64_tr_b16 a[158:159], v1 offset:39456
  v_mfma_f32_16x16x32_bf16 v[208:211], a[168:171], a[32:35], v[208:211]
  s_waitcnt lgkmcnt(8)
  v_mfma_f32_16x16x32_bf16 v[224:227], a[128:131], a[32:35], v[224:227]
  buffer_load_dwordx4 a[120:123], v0, s[36:39], s57 offen offset:2048 sc1
  v_mfma_f32_16x16x32_bf16 v[224:227], a[132:135], a[48:51], v[224:227]
  ds_read_b64_tr_b16 a[160:161], v1 offset:28736
  v_mfma_f32_16x16x32_bf16 v[228:231], a[132:135], a[52:55], v[228:231]
  ds_read_b64_tr_b16 a[162:163], v1 offset:32320
  v_mfma_f32_16x16x32_bf16 v[228:231], a[128:131], a[36:39], v[228:231]
  v_mfma_f32_16x16x32_bf16 v[232:235], a[128:131], a[40:43], v[232:235]
  ds_read_b64_tr_b16 a[164:165], v1 offset:35904
  v_mfma_f32_16x16x32_bf16 v[232:235], a[132:135], a[56:59], v[232:235]
  buffer_load_dwordx4 v5, s[16:19], s56 offen offset:2048 lds
  v_mfma_f32_16x16x32_bf16 v[236:239], a[132:135], a[60:63], v[236:239]
  ds_read_b64_tr_b16 a[166:167], v1 offset:39488
  v_mfma_f32_16x16x32_bf16 v[236:239], a[128:131], a[44:47], v[236:239]
  v_mfma_f32_16x16x32_bf16 v[252:255], a[136:139], a[44:47], v[252:255]
  ds_read_b64_tr_b16 a[168:169], v1 offset:28768
  v_mfma_f32_16x16x32_bf16 v[252:255], a[140:143], a[60:63], v[252:255]
  v_mfma_f32_16x16x32_bf16 v[248:251], a[140:143], a[56:59], v[248:251]
  buffer_load_dwordx4 a[124:127], v0, s[36:39], s57 offen offset:3072 sc1
  v_mfma_f32_16x16x32_bf16 v[248:251], a[136:139], a[40:43], v[248:251]
  ds_read_b64_tr_b16 a[170:171], v1 offset:32352
  v_mfma_f32_16x16x32_bf16 v[244:247], a[136:139], a[36:39], v[244:247]
  ds_read_b64_tr_b16 a[172:173], v1 offset:35936
  v_mfma_f32_16x16x32_bf16 v[244:247], a[140:143], a[52:55], v[244:247]
  v_mfma_f32_16x16x32_bf16 v[240:243], a[140:143], a[48:51], v[240:243]
  ds_read_b64_tr_b16 a[174:175], v1 offset:39520
  v_mfma_f32_16x16x32_bf16 v[240:243], a[136:139], a[32:35], v[240:243]
  s_waitcnt vmcnt(17) lgkmcnt(8)
  buffer_load_dwordx4 v6, s[16:19], s56 offen offset:3072 lds
  s_bfe_u32 s57, s85, 0x40010
  v_mfma_f32_16x16x32_bf16 v[32:35], a[144:147], a[64:67], v[32:35]
  s_lshl_b32 s57, s57, 13
  s_add_u32 s57, s57, s86
  ds_read_b64_tr_b16 a[128:129], v1 offset:28800
  v_mfma_f32_16x16x32_bf16 v[32:35], a[148:151], a[80:83], v[32:35]
  s_barrier
  v_mfma_f32_16x16x32_bf16 v[36:39], a[148:151], a[84:87], v[36:39]
  ds_read_b64_tr_b16 a[130:131], v1 offset:32384
  v_mfma_f32_16x16x32_bf16 v[36:39], a[144:147], a[68:71], v[36:39]
  v_mfma_f32_16x16x32_bf16 v[40:43], a[144:147], a[72:75], v[40:43]
  buffer_load_dwordx4 a[0:3], v0, s[36:39], s57 offen offset:0 sc1
  v_mfma_f32_16x16x32_bf16 v[40:43], a[148:151], a[88:91], v[40:43]
  s_add_u32 m0, s77, 90112
  ds_read_b64_tr_b16 a[132:133], v1 offset:35968
  v_mfma_f32_16x16x32_bf16 v[44:47], a[148:151], a[92:95], v[44:47]
  ds_read_b64_tr_b16 a[134:135], v1 offset:39552
  v_mfma_f32_16x16x32_bf16 v[44:47], a[144:147], a[76:79], v[44:47]
  v_mfma_f32_16x16x32_bf16 v[60:63], a[152:155], a[76:79], v[60:63]
  ds_read_b64_tr_b16 a[136:137], v1 offset:28832
  v_mfma_f32_16x16x32_bf16 v[60:63], a[156:159], a[92:95], v[60:63]
  buffer_load_dwordx4 v7, s[16:19], s56 offen offset:0 lds
  v_mfma_f32_16x16x32_bf16 v[56:59], a[156:159], a[88:91], v[56:59]
  ds_read_b64_tr_b16 a[138:139], v1 offset:32416
  v_mfma_f32_16x16x32_bf16 v[56:59], a[152:155], a[72:75], v[56:59]
  v_mfma_f32_16x16x32_bf16 v[52:55], a[152:155], a[68:71], v[52:55]
  ds_read_b64_tr_b16 a[140:141], v1 offset:36000
  v_mfma_f32_16x16x32_bf16 v[52:55], a[156:159], a[84:87], v[52:55]
  v_mfma_f32_16x16x32_bf16 v[48:51], a[156:159], a[80:83], v[48:51]
  buffer_load_dwordx4 a[4:7], v0, s[36:39], s57 offen offset:1024 sc1
  v_mfma_f32_16x16x32_bf16 v[48:51], a[152:155], a[64:67], v[48:51]
  s_waitcnt lgkmcnt(7)
  ds_read_b64_tr_b16 a[142:143], v1 offset:39584
  v_mfma_f32_16x16x32_bf16 v[64:67], a[160:163], a[64:67], v[64:67]
  ds_read_b64_tr_b16 a[144:145], v1 offset:28864
  v_mfma_f32_16x16x32_bf16 v[64:67], a[164:167], a[80:83], v[64:67]
  v_mfma_f32_16x16x32_bf16 v[68:71], a[164:167], a[84:87], v[68:71]
  ds_read_b64_tr_b16 a[146:147], v1 offset:32448
  v_mfma_f32_16x16x32_bf16 v[68:71], a[160:163], a[68:71], v[68:71]
  v_mfma_f32_16x16x32_bf16 v[72:75], a[160:163], a[72:75], v[72:75]
  buffer_load_dwordx4 a[8:11], v0, s[36:39], s57 offen offset:2048 sc1
  v_mfma_f32_16x16x32_bf16 v[72:75], a[164:167], a[88:91], v[72:75]
  ds_read_b64_tr_b16 a[148:149], v1 offset:36032
  v_mfma_f32_16x16x32_bf16 v[76:79], a[164:167], a[92:95], v[76:79]
  ds_read_b64_tr_b16 a[150:151], v1 offset:39616
  v_mfma_f32_16x16x32_bf16 v[76:79], a[160:163], a[76:79], v[76:79]
  v_mfma_f32_16x16x32_bf16 v[92:95], a[168:171], a[76:79], v[92:95]
  ds_read_b64_tr_b16 a[152:153], v1 offset:43008
  v_mfma_f32_16x16x32_bf16 v[92:95], a[172:175], a[92:95], v[92:95]
  buffer_load_dwordx4 v8, s[16:19], s56 offen offset:1024 lds
  v_mfma_f32_16x16x32_bf16 v[88:91], a[172:175], a[88:91], v[88:91]
  ds_read_b64_tr_b16 a[154:155], v1 offset:46592
  v_mfma_f32_16x16x32_bf16 v[88:91], a[168:171], a[72:75], v[88:91]
  v_mfma_f32_16x16x32_bf16 v[84:87], a[168:171], a[68:71], v[84:87]
  ds_read_b64_tr_b16 a[156:157], v1 offset:50176
  v_mfma_f32_16x16x32_bf16 v[84:87], a[172:175], a[84:87], v[84:87]
  v_mfma_f32_16x16x32_bf16 v[80:83], a[172:175], a[80:83], v[80:83]
  buffer_load_dwordx4 a[12:15], v0, s[36:39], s57 offen offset:3072 sc1
  v_mfma_f32_16x16x32_bf16 v[80:83], a[168:171], a[64:67], v[80:83]
  s_waitcnt lgkmcnt(7)
  ds_read_b64_tr_b16 a[158:159], v1 offset:53760
  v_mfma_f32_16x16x32_bf16 v[96:99], a[128:131], a[64:67], v[96:99]
  ds_read_b64_tr_b16 a[160:161], v1 offset:43040
  v_mfma_f32_16x16x32_bf16 v[96:99], a[132:135], a[80:83], v[96:99]
  v_mfma_f32_16x16x32_bf16 v[100:103], a[132:135], a[84:87], v[100:103]
  ds_read_b64_tr_b16 a[162:163], v1 offset:46624
  v_mfma_f32_16x16x32_bf16 v[100:103], a[128:131], a[68:71], v[100:103]
  buffer_load_dwordx4 v9, s[16:19], s56 offen offset:2048 lds
  v_mfma_f32_16x16x32_bf16 v[104:107], a[128:131], a[72:75], v[104:107]
  s_add_u32 s57, s57, 4096
  ds_read_b64_tr_b16 a[164:165], v1 offset:50208
  v_mfma_f32_16x16x32_bf16 v[104:107], a[132:135], a[88:91], v[104:107]
  v_mfma_f32_16x16x32_bf16 v[108:111], a[132:135], a[92:95], v[108:111]
  ds_read_b64_tr_b16 a[166:167], v1 offset:53792
  v_mfma_f32_16x16x32_bf16 v[108:111], a[128:131], a[76:79], v[108:111]
  v_mfma_f32_16x16x32_bf16 v[124:127], a[136:139], a[76:79], v[124:127]
  buffer_load_dwordx4 a[16:19], v0, s[36:39], s57 offen offset:0 sc1
  v_mfma_f32_16x16x32_bf16 v[124:127], a[140:143], a[92:95], v[124:127]
  ds_read_b64_tr_b16 a[168:169], v1 offset:43072
  v_mfma_f32_16x16x32_bf16 v[120:123], a[140:143], a[88:91], v[120:123]
  ds_read_b64_tr_b16 a[170:171], v1 offset:46656
  v_mfma_f32_16x16x32_bf16 v[120:123], a[136:139], a[72:75], v[120:123]
  v_mfma_f32_16x16x32_bf16 v[116:119], a[136:139], a[68:71], v[116:119]
  ds_read_b64_tr_b16 a[172:173], v1 offset:50240
  v_mfma_f32_16x16x32_bf16 v[116:119], a[140:143], a[84:87], v[116:119]
  v_mfma_f32_16x16x32_bf16 v[112:115], a[140:143], a[80:83], v[112:115]
  ds_read_b64_tr_b16 a[174:175], v1 offset:53824
  v_mfma_f32_16x16x32_bf16 v[112:115], a[136:139], a[64:67], v[112:115]
  s_waitcnt lgkmcnt(8)
  v_mfma_f32_16x16x32_bf16 v[128:131], a[144:147], a[64:67], v[128:131]
  ds_read_b64_tr_b16 a[128:129], v1 offset:43104
  v_mfma_f32_16x16x32_bf16 v[128:131], a[148:151], a[80:83], v[128:131]
  v_mfma_f32_16x16x32_bf16 v[132:135], a[148:151], a[84:87], v[132:135]
  buffer_load_dwordx4 a[20:23], v0, s[36:39], s57 offen offset:1024 sc1
  s_bfe_u32 s56, s85, 0x30014
  v_mfma_f32_16x16x32_bf16 v[132:135], a[144:147], a[68:71], v[132:135]
  s_lshl_b32 s56, s56, 2
  s_bitcmp1_b32 s85, 23
  s_addc_u32 s56, s56, 0
  v_mfma_f32_16x16x32_bf16 v[136:139], a[144:147], a[72:75], v[136:139]
  s_mul_i32 s56, s56, 229376
  s_add_u32 m0, s77, 0
  ds_read_b64_tr_b16 a[130:131], v1 offset:46688
  v_mfma_f32_16x16x32_bf16 v[136:139], a[148:151], a[88:91], v[136:139]
  ds_read_b64_tr_b16 a[132:133], v1 offset:50272
  v_mfma_f32_16x16x32_bf16 v[140:143], a[148:151], a[92:95], v[140:143]
  ds_read_b64_tr_b16 a[134:135], v1 offset:53856
  v_mfma_f32_16x16x32_bf16 v[140:143], a[144:147], a[76:79], v[140:143]
Hc1_1:
  s_cbranch_execz Hc1_2
  buffer_load_dwordx4 v3, s[16:19], s56 offen offset:0 lds
  v_mfma_f32_16x16x32_bf16 v[156:159], a[152:155], a[76:79], v[156:159]
  ds_read_b64_tr_b16 a[136:137], v1 offset:43136
  v_mfma_f32_16x16x32_bf16 v[156:159], a[156:159], a[92:95], v[156:159]
  v_mfma_f32_16x16x32_bf16 v[152:155], a[156:159], a[88:91], v[152:155]
  ds_read_b64_tr_b16 a[138:139], v1 offset:46720
  v_mfma_f32_16x16x32_bf16 v[152:155], a[152:155], a[72:75], v[152:155]
  v_mfma_f32_16x16x32_bf16 v[148:151], a[152:155], a[68:71], v[148:151]
  buffer_load_dwordx4 a[24:27], v0, s[36:39], s57 offen offset:2048 sc1
  v_mfma_f32_16x16x32_bf16 v[148:151], a[156:159], a[84:87], v[148:151]
  ds_read_b64_tr_b16 a[140:141], v1 offset:50304
  v_mfma_f32_16x16x32_bf16 v[144:147], a[156:159], a[80:83], v[144:147]
  ds_read_b64_tr_b16 a[142:143], v1 offset:53888
  v_mfma_f32_16x16x32_bf16 v[144:147], a[152:155], a[64:67], v[144:147]
  s_waitcnt lgkmcnt(8)
  v_mfma_f32_16x16x32_bf16 v[160:163], a[160:163], a[64:67], v[160:163]
  ds_read_b64_tr_b16 a[144:145], v1 offset:43168
  v_mfma_f32_16x16x32_bf16 v[160:163], a[164:167], a[80:83], v[160:163]
  buffer_load_dwordx4 v4, s[16:19], s56 offen offset:1024 lds
  v_mfma_f32_16x16x32_bf16 v[164:167], a[164:167], a[84:87], v[164:167]
  ds_read_b64_tr_b16 a[146:147], v1 offset:46752
  v_mfma_f32_16x16x32_bf16 v[164:167], a[160:163], a[68:71], v[164:167]
  v_mfma_f32_16x16x32_bf16 v[168:171], a[160:163], a[72:75], v[168:171]
  ds_read_b64_tr_b16 a[148:149], v1 offset:50336
  v_mfma_f32_16x16x32_bf16 v[168:171], a[164:167], a[88:91], v[168:171]
  v_mfma_f32_16x16x32_bf16 v[172:175], a[164:167], a[92:95], v[172:175]
  buffer_load_dwordx4 a[28:31], v0, s[36:39], s57 offen offset:3072 sc1
  v_mfma_f32_16x16x32_bf16 v[172:175], a[160:163], a[76:79], v[172:175]
  s_waitcnt vmcnt(23)
  s_barrier
  ds_read_b64_tr_b16 a[150:151], v1 offset:53920
  v_mfma_f32_16x16x32_bf16 v[188:191], a[168:171], a[76:79], v[188:191]
  ds_read_b64_tr_b16 a[152:153], v1 offset:43200
  v_mfma_f32_16x16x32_bf16 v[188:191], a[172:175], a[92:95], v[188:191]
  v_mfma_f32_16x16x32_bf16 v[184:187], a[172:175], a[88:91], v[184:187]
  ds_read_b64_tr_b16 a[154:155], v1 offset:46784
  v_mfma_f32_16x16x32_bf16 v[184:187], a[168:171], a[72:75], v[184:187]
  buffer_load_dwordx4 v5, s[16:19], s56 offen offset:2048 lds
  s_bfe_u32 s57, s85, 0x40014
  v_mfma_f32_16x16x32_bf16 v[180:183], a[168:171], a[68:71], v[180:183]
  s_lshl_b32 s57, s57, 13
  s_add_u32 s57, s57, s86
  ds_read_b64_tr_b16 a[156:157], v1 offset:50368
  v_mfma_f32_16x16x32_bf16 v[180:183], a[172:175], a[84:87], v[180:183]
  v_mfma_f32_16x16x32_bf16 v[176:179], a[172:175], a[80:83], v[176:179]
  ds_read_b64_tr_b16 a[158:159], v1 offset:53952
  v_mfma_f32_16x16x32_bf16 v[176:179], a[168:171], a[64:67], v[176:179]
  s_waitcnt lgkmcnt(8)
  v_mfma_f32_16x16x32_bf16 v[192:195], a[128:131], a[64:67], v[192:195]
  buffer_load_dwordx4 a[32:35], v0, s[36:39], s57 offen offset:0 sc1
  v_mfma_f32_16x16x32_bf16 v[192:195], a[132:135], a[80:83], v[192:195]
  ds_read_b64_tr_b16 a[160:161], v2 offset:0
  v_mfma_f32_16x16x32_bf16 v[196:199], a[132:135], a[84:87], v[196:199]
  ds_read_b64_tr_b16 a[162:163], v2 offset:3584
  v_mfma_f32_16x16x32_bf16 v[196:199], a[128:131], a[68:71], v[196:199]
  v_mfma_f32_16x16x32_bf16 v[200:203], a[128:131], a[72:75], v[200:203]
  ds_read_b64_tr_b16 a[164:165], v2 offset:7168
  v_mfma_f32_16x16x32_bf16 v[200:203], a[132:135], a[88:91], v[200:203]
  buffer_load_dwordx4 a[36:39], v0, s[36:39], s57 offen offset:1024 sc1
  v_mfma_f32_16x16x32_bf16 v[204:207], a[132:135], a[92:95], v[204:207]
  ds_read_b64_tr_b16 a[166:167], v2 offset:10752
  v_mfma_f32_16x16x32_bf16 v[204:207], a[128:131], a[76:79], v[204:207]
  v_mfma_f32_16x16x32_bf16 v[220:223], a[136:139], a[76:79], v[220:223]
  ds_read_b64_tr_b16 a[168:169], v2 offset:32
  v_mfma_f32_16x16x32_bf16 v[220:223], a[140:143], a[92:95], v[220:223]
  v_mfma_f32_16x16x32_bf16 v[216:219], a[140:143], a[88:91], v[216:219]
  buffer_load_dwordx4 v6, s[16:19], s56 offen offset:3072 lds
  v_mfma_f32_16x16x32_bf16 v[216:219], a[136:139], a[72:75], v[216:219]
  ds_read_b64_tr_b16 a[170:171], v2 offset:3616
  v_mfma_f32_16x16x32_bf16 v[212:215], a[136:139], a[68:71], v[212:215]
  ds_read_b64_tr_b16 a[172:173], v2 offset:7200
  v_mfma_f32_16x16x32_bf16 v[212:215], a[140:143], a[84:87], v[212:215]
  v_mfma_f32_16x16x32_bf16 v[208:211], a[140:143], a[80:83], v[208:211]
  ds_read_b64_tr_b16 a[174:175], v2 offset:10784
  v_mfma_f32_16x16x32_bf16 v[208:211], a[136:139], a[64:67], v[208:211]
  s_waitcnt lgkmcnt(8)
  buffer_load_dwordx4 a[40:43], v0, s[36:39], s57 offen offset:2048 sc1
  s_add_u32 m0, s77, 4096
  v_mfma_f32_16x16x32_bf16 v[224:227], a[144:147], a[64:67], v[224:227]
  ds_read_b64_tr_b16 a[128:129], v2 offset:64
  v_mfma_f32_16x16x32_bf16 v[224:227], a[148:151], a[80:83], v[224:227]
  v_mfma_f32_16x16x32_bf16 v[228:231], a[148:151], a[84:87], v[228:231]
  ds_read_b64_tr_b16 a[130:131], v2 offset:3648
  v_mfma_f32_16x16x32_bf16 v[228:231], a[144:147], a[68:71], v[228:231]
  v_mfma_f32_16x16x32_bf16 v[232:235], a[144:147], a[72:75], v[232:235]
  buffer_load_dwordx4 v7, s[16:19], s56 offen offset:0 lds
  v_mfma_f32_16x16x32_bf16 v[232:235], a[148:151], a[88:91], v[232:235]
  ds_read_b64_tr_b16 a[132:133], v2 offset:7232
  v_mfma_f32_16x16x32_bf16 v[236:239], a[148:151], a[92:95], v[236:239]
  ds_read_b64_tr_b16 a[134:135], v2 offset:10816
  v_mfma_f32_16x16x32_bf16 v[236:239], a[144:147], a[76:79], v[236:239]
  v_mfma_f32_16x16x32_bf16 v[252:255], a[152:155], a[76:79], v[252:255]
  ds_read_b64_tr_b16 a[136:137], v2 offset:96
  v_mfma_f32_16x16x32_bf16 v[252:255], a[156:159], a[92:95], v[252:255]
  buffer_load_dwordx4 a[44:47], v0, s[36:39], s57 offen offset:3072 sc1
  v_mfma_f32_16x16x32_bf16 v[248:251], a[156:159], a[88:91], v[248:251]
  ds_read_b64_tr_b16 a[138:139], v2 offset:3680
  v_mfma_f32_16x16x32_bf16 v[248:251], a[152:155], a[72:75], v[248:251]
  v_mfma_f32_16x16x32_bf16 v[244:247], a[152:155], a[68:71], v[244:247]
  ds_read_b64_tr_b16 a[140:141], v2 offset:7264
  v_mfma_f32_16x16x32_bf16 v[244:247], a[156:159], a[84:87], v[244:247]
  v_mfma_f32_16x16x32_bf16 v[240:243], a[156:159], a[80:83], v[240:243]
  ds_read_b64_tr_b16 a[142:143], v2 offset:10848
  v_mfma_f32_16x16x32_bf16 v[240:243], a[152:155], a[64:67], v[240:243]
  s_waitcnt vmcnt(21) lgkmcnt(8)
  buffer_load_dwordx4 v8, s[16:19], s56 offen offset:1024 lds
  s_add_u32 s57, s57, 4096
  v_mfma_f32_16x16x32_bf16 v[32:35], a[160:163], a[96:99], v[32:35]
  ds_read_b64_tr_b16 a[144:145], v2 offset:128
  v_mfma_f32_16x16x32_bf16 v[32:35], a[164:167], a[112:115], v[32:35]
  s_barrier
  v_mfma_f32_16x16x32_bf16 v[36:39], a[164:167], a[116:119], v[36:39]
  ds_read_b64_tr_b16 a[146:147], v2 offset:3712
  v_mfma_f32_16x16x32_bf16 v[36:39], a[160:163], a[100:103], v[36:39]
  v_mfma_f32_16x16x32_bf16 v[40:43], a[160:163], a[104:107], v[40:43]
  buffer_load_dwordx4 a[48:51], v0, s[36:39], s57 offen offset:0 sc1
  v_mfma_f32_16x16x32_bf16 v[40:43], a[164:167], a[120:123], v[40:43]
  ds_read_b64_tr_b16 a[148:149], v2 offset:7296
  v_mfma_f32_16x16x32_bf16 v[44:47], a[164:167], a[124:127], v[44:47]
  ds_read_b64_tr_b16 a[150:151], v2 offset:10880
  v_mfma_f32_16x16x32_bf16 v[44:47], a[160:163], a[108:111], v[44:47]
  v_mfma_f32_16x16x32_bf16 v[60:63], a[168:171], a[108:111], v[60:63]
  ds_read_b64_tr_b16 a[152:153], v2 offset:160
  v_mfma_f32_16x16x32_bf16 v[60:63], a[172:175], a[124:127], v[60:63]
  v_mfma_f32_16x16x32_bf16 v[56:59], a[172:175], a[120:123], v[56:59]
  ds_read_b64_tr_b16 a[154:155], v2 offset:3744
  v_mfma_f32_16x16x32_bf16 v[56:59], a[168:171], a[104:107], v[56:59]
  buffer_load_dwordx4 v9, s[16:19], s56 offen offset:2048 lds
  v_mfma_f32_16x16x32_bf16 v[52:55], a[168:171], a[100:103], v[52:55]
  ds_read_b64_tr_b16 a[156:157], v2 offset:7328
  v_mfma_f32_16x16x32_bf16 v[52:55], a[172:175], a[116:119], v[52:55]
  v_mfma_f32_16x16x32_bf16 v[48:51], a[172:175], a[112:115], v[48:51]
  ds_read_b64_tr_b16 a[158:159], v2 offset:10912
  v_mfma_f32_16x16x32_bf16 v[48:51], a[168:171], a[96:99], v[48:51]
  s_waitcnt lgkmcnt(8)
  v_mfma_f32_16x16x32_bf16 v[64:67], a[128:131], a[96:99], v[64:67]
  buffer_load_dwordx4 a[52:55], v0, s[36:39], s57 offen offset:1024 sc1
  v_mfma_f32_16x16x32_bf16 v[64:67], a[132:135], a[112:115], v[64:67]
  ds_read_b64_tr_b16 a[160:161], v2 offset:192
  v_mfma_f32_16x16x32_bf16 v[68:71], a[132:135], a[116:119], v[68:71]
  ds_read_b64_tr_b16 a[162:163], v2 offset:3776
  v_mfma_f32_16x16x32_bf16 v[68:71], a[128:131], a[100:103], v[68:71]
  v_mfma_f32_16x16x32_bf16 v[72:75], a[128:131], a[104:107], v[72:75]
  ds_read_b64_tr_b16 a[164:165], v2 offset:7360
  v_mfma_f32_16x16x32_bf16 v[72:75], a[132:135], a[120:123], v[72:75]
  v_mfma_f32_16x16x32_bf16 v[76:79], a[132:135], a[124:127], v[76:79]
  buffer_load_dwordx4 a[56:59], v0, s[36:39], s57 offen offset:2048 sc1
  v_mfma_f32_16x16x32_bf16 v[76:79], a[128:131], a[108:111], v[76:79]
  ds_read_b64_tr_b16 a[166:167], v2 offset:10944
  v_mfma_f32_16x16x32_bf16 v[92:95], a[136:139], a[108:111], v[92:95]
  s_bfe_u32 s56, s85, 0x30018
  s_lshl_b32 s56, s56, 2
  s_bitcmp1_b32 s85, 27
  v_mfma_f32_16x16x32_bf16 v[92:95], a[140:143], a[124:127], v[92:95]
  s_addc_u32 s56, s56, 0
  s_mul_i32 s56, s56, 229376
  s_add_u32 m0, s77, 28672
  v_mfma_f32_16x16x32_bf16 v[88:91], a[140:143], a[120:123], v[88:91]
  ds_read_b64_tr_b16 a[168:169], v2 offset:14336
  v_mfma_f32_16x16x32_bf16 v[88:91], a[136:139], a[104:107], v[88:91]
  ds_read_b64_tr_b16 a[170:171], v2 offset:17920
  v_mfma_f32_16x16x32_bf16 v[84:87], a[136:139], a[100:103], v[84:87]
  buffer_load_dwordx4 v3, s[16:19], s56 offen offset:0 lds
  v_mfma_f32_16x16x32_bf16 v[84:87], a[140:143], a[116:119], v[84:87]
  ds_read_b64_tr_b16 a[172:173], v2 offset:21504
  v_mfma_f32_16x16x32_bf16 v[80:83], a[140:143], a[112:115], v[80:83]
  ds_read_b64_tr_b16 a[174:175], v2 offset:25088
  v_mfma_f32_16x16x32_bf16 v[80:83], a[136:139], a[96:99], v[80:83]
  s_waitcnt lgkmcnt(8)
  v_mfma_f32_16x16x32_bf16 v[96:99], a[144:147], a[96:99], v[96:99]
  ds_read_b64_tr_b16 a[128:129], v2 offset:14368
  v_mfma_f32_16x16x32_bf16 v[96:99], a[148:151], a[112:115], v[96:99]
  buffer_load_dwordx4 a[60:63], v0, s[36:39], s57 offen offset:3072 sc1
  s_bfe_u32 s57, s85, 0x40018
  v_mfma_f32_16x16x32_bf16 v[100:103], a[148:151], a[116:119], v[100:103]
  s_lshl_b32 s57, s57, 13
  s_add_u32 s57, s57, s86
  ds_read_b64_tr_b16 a[130:131], v2 offset:17952
  v_mfma_f32_16x16x32_bf16 v[100:103], a[144:147], a[100:103], v[100:103]
  v_mfma_f32_16x16x32_bf16 v[104:107], a[144:147], a[104:107], v[104:107]
  buffer_load_dwordx4 a[208:211], v25, s[36:39], s79 offen offset:0 sc1
  v_mfma_f32_16x16x32_bf16 v[104:107], a[148:151], a[120:123], v[104:107]
  ds_read_b64_tr_b16 a[132:133], v2 offset:21536
  v_mfma_f32_16x16x32_bf16 v[108:111], a[148:151], a[124:127], v[108:111]
  ds_read_b64_tr_b16 a[134:135], v2 offset:25120
  v_mfma_f32_16x16x32_bf16 v[108:111], a[144:147], a[108:111], v[108:111]
  v_mfma_f32_16x16x32_bf16 v[124:127], a[152:155], a[108:111], v[124:127]
  ds_read_b64_tr_b16 a[136:137], v2 offset:14400
  v_mfma_f32_16x16x32_bf16 v[124:127], a[156:159], a[124:127], v[124:127]
  buffer_load_dwordx4 a[212:215], v25, s[36:39], s79 offen offset:2048 sc1
  v_mfma_f32_16x16x32_bf16 v[120:123], a[156:159], a[120:123], v[120:123]
  ds_read_b64_tr_b16 a[138:139], v2 offset:17984
  v_mfma_f32_16x16x32_bf16 v[120:123], a[152:155], a[104:107], v[120:123]
  v_mfma_f32_16x16x32_bf16 v[116:119], a[152:155], a[100:103], v[116:119]
  ds_read_b64_tr_b16 a[140:141], v2 offset:21568
  v_mfma_f32_16x16x32_bf16 v[116:119], a[156:159], a[116:119], v[116:119]
  v_mfma_f32_16x16x32_bf16 v[112:115], a[156:159], a[112:115], v[112:115]
  buffer_load_dwordx4 a[216:219], v25, s[36:39], s78 offen offset:0 sc1
  v_mfma_f32_16x16x32_bf16 v[112:115], a[152:155], a[96:99], v[112:115]
  s_waitcnt lgkmcnt(7)
  ds_read_b64_tr_b16 a[142:143], v2 offset:25152
  v_mfma_f32_16x16x32_bf16 v[128:131], a[160:163], a[96:99], v[128:131]
  ds_read_b64_tr_b16 a[144:145], v2 offset:14432
  v_mfma_f32_16x16x32_bf16 v[128:131], a[164:167], a[112:115], v[128:131]
  v_mfma_f32_16x16x32_bf16 v[132:135], a[164:167], a[116:119], v[132:135]
  ds_read_b64_tr_b16 a[146:147], v2 offset:18016
  v_mfma_f32_16x16x32_bf16 v[132:135], a[160:163], a[100:103], v[132:135]
  buffer_load_dwordx4 a[220:223], v25, s[36:39], s78 offen offset:2048 sc1
  v_mfma_f32_16x16x32_bf16 v[136:139], a[160:163], a[104:107], v[136:139]
  ds_read_b64_tr_b16 a[148:149], v2 offset:21600
  v_mfma_f32_16x16x32_bf16 v[136:139], a[164:167], a[120:123], v[136:139]
  v_mfma_f32_16x16x32_bf16 v[140:143], a[164:167], a[124:127], v[140:143]
  ds_read_b64_tr_b16 a[150:151], v2 offset:25184
  v_mfma_f32_16x16x32_bf16 v[140:143], a[160:163], a[108:111], v[140:143]
  v_mfma_f32_16x16x32_bf16 v[156:159], a[168:171], a[108:111], v[156:159]
  buffer_load_dwordx4 a[64:67], v0, s[36:39], s57 offen offset:0 sc1
  v_mfma_f32_16x16x32_bf16 v[156:159], a[172:175], a[124:127], v[156:159]
  ds_read_b64_tr_b16 a[152:153], v2 offset:14464
  v_mfma_f32_16x16x32_bf16 v[152:155], a[172:175], a[120:123], v[152:155]
  ds_read_b64_tr_b16 a[154:155], v2 offset:18048
  v_mfma_f32_16x16x32_bf16 v[152:155], a[168:171], a[104:107], v[152:155]
  v_mfma_f32_16x16x32_bf16 v[148:151], a[168:171], a[100:103], v[148:151]
  ds_read_b64_tr_b16 a[156:157], v2 offset:21632
  v_mfma_f32_16x16x32_bf16 v[148:151], a[172:175], a[116:119], v[148:151]
  buffer_load_dwordx4 v4, s[16:19], s56 offen offset:1024 lds
  v_mfma_f32_16x16x32_bf16 v[144:147], a[172:175], a[112:115], v[144:147]
  ds_read_b64_tr_b16 a[158:159], v2 offset:25216
  v_mfma_f32_16x16x32_bf16 v[144:147], a[168:171], a[96:99], v[144:147]
  s_waitcnt lgkmcnt(8)
  v_mfma_f32_16x16x32_bf16 v[160:163], a[128:131], a[96:99], v[160:163]
  ds_read_b64_tr_b16 a[160:161], v2 offset:14496
  v_mfma_f32_16x16x32_bf16 v[160:163], a[132:135], a[112:115], v[160:163]
  v_mfma_f32_16x16x32_bf16 v[164:167], a[132:135], a[116:119], v[164:167]
  buffer_load_dwordx4 a[68:71], v0, s[36:39], s57 offen offset:1024 sc1
  v_mfma_f32_16x16x32_bf16 v[164:167], a[128:131], a[100:103], v[164:167]
  ds_read_b64_tr_b16 a[162:163], v2 offset:18080
  v_mfma_f32_16x16x32_bf16 v[168:171], a[128:131], a[104:107], v[168:171]
  ds_read_b64_tr_b16 a[164:165], v2 offset:21664
  v_mfma_f32_16x16x32_bf16 v[168:171], a[132:135], a[120:123], v[168:171]
  v_mfma_f32_16x16x32_bf16 v[172:175], a[132:135], a[124:127], v[172:175]
  ds_read_b64_tr_b16 a[166:167], v2 offset:25248
  v_mfma_f32_16x16x32_bf16 v[172:175], a[128:131], a[108:111], v[172:175]
  s_waitcnt vmcnt(27)
  s_barrier
  buffer_load_dwordx4 v5, s[16:19], s56 offen offset:2048 lds
  v_mfma_f32_16x16x32_bf16 v[188:191], a[136:139], a[108:111], v[188:191]
  ds_read_b64_tr_b16 a[168:169], v2 offset:14528
  v_mfma_f32_16x16x32_bf16 v[188:191], a[140:143], a[124:127], v[188:191]
  v_mfma_f32_16x16x32_bf16 v[184:187], a[140:143], a[120:123], v[184:187]
  ds_read_b64_tr_b16 a[170:171], v2 offset:18112
  v_mfma_f32_16x16x32_bf16 v[184:187], a[136:139], a[104:107], v[184:187]
  v_mfma_f32_16x16x32_bf16 v[180:183], a[136:139], a[100:103], v[180:183]
  buffer_load_dwordx4 a[72:75], v0, s[36:39], s57 offen offset:2048 sc1
  v_mfma_f32_16x16x32_bf16 v[180:183], a[140:143], a[116:119], v[180:183]
  ds_read_b64_tr_b16 a[172:173], v2 offset:21696
  v_mfma_f32_16x16x32_bf16 v[176:179], a[140:143], a[112:115], v[176:179]
  ds_read_b64_tr_b16 a[174:175], v2 offset:25280
  v_mfma_f32_16x16x32_bf16 v[176:179], a[136:139], a[96:99], v[176:179]
  s_waitcnt lgkmcnt(8)
  v_mfma_f32_16x16x32_bf16 v[192:195], a[144:147], a[96:99], v[192:195]
  ds_read_b64_tr_b16 a[128:129], v2 offset:28672
  v_mfma_f32_16x16x32_bf16 v[192:195], a[148:151], a[112:115], v[192:195]
  buffer_load_dwordx4 v6, s[16:19], s56 offen offset:3072 lds
  v_mfma_f32_16x16x32_bf16 v[196:199], a[148:151], a[116:119], v[196:199]
  ds_read_b64_tr_b16 a[130:131], v2 offset:32256
  v_mfma_f32_16x16x32_bf16 v[196:199], a[144:147], a[100:103], v[196:199]
  v_mfma_f32_16x16x32_bf16 v[200:203], a[144:147], a[104:107], v[200:203]
  ds_read_b64_tr_b16 a[132:133], v2 offset:35840
  v_mfma_f32_16x16x32_bf16 v[200:203], a[148:151], a[120:123], v[200:203]
  v_mfma_f32_16x16x32_bf16 v[204:207], a[148:151], a[124:127], v[204:207]
  buffer_load_dwordx4 a[76:79], v0, s[36:39], s57 offen offset:3072 sc1
  s_add_u32 m0, s77, 32768
  v_mfma_f32_16x16x32_bf16 v[204:207], a[144:147], a[108:111], v[204:207]
  ds_read_b64_tr_b16 a[134:135], v2 offset:39424
  v_mfma_f32_16x16x32_bf16 v[220:223], a[152:155], a[108:111], v[220:223]
  ds_read_b64_tr_b16 a[136:137], v2 offset:28704
  v_mfma_f32_16x16x32_bf16 v[220:223], a[156:159], a[124:127], v[220:223]
  v_mfma_f32_16x16x32_bf16 v[216:219], a[156:159], a[120:123], v[216:219]
  ds_read_b64_tr_b16 a[138:139], v2 offset:32288
  v_mfma_f32_16x16x32_bf16 v[216:219], a[152:155], a[104:107], v[216:219]
  buffer_load_dwordx4 v7, s[16:19], s56 offen offset:0 lds
  s_add_u32 s57, s57, 4096
  v_mfma_f32_16x16x32_bf16 v[212:215], a[152:155], a[100:103], v[212:215]
  ds_read_b64_tr_b16 a[140:141], v2 offset:35872
  v_mfma_f32_16x16x32_bf16 v[212:215], a[156:159], a[116:119], v[212:215]
  v_mfma_f32_16x16x32_bf16 v[208:211], a[156:159], a[112:115], v[208:211]
  ds_read_b64_tr_b16 a[142:143], v2 offset:39456
  v_mfma_f32_16x16x32_bf16 v[208:211], a[152:155], a[96:99], v[208:211]
  s_waitcnt lgkmcnt(8)
  v_mfma_f32_16x16x32_bf16 v[224:227], a[160:163], a[96:99], v[224:227]
  buffer_load_dwordx4 a[80:83], v0, s[36:39], s57 offen offset:0 sc1
  v_mfma_f32_16x16x32_bf16 v[224:227], a[164:167], a[112:115], v[224:227]
  ds_read_b64_tr_b16 a[144:145], v2 offset:28736
  v_mfma_f32_16x16x32_bf16 v[228:231], a[164:167], a[116:119], v[228:231]
  ds_read_b64_tr_b16 a[146:147], v2 offset:32320
  v_mfma_f32_16x16x32_bf16 v[228:231], a[160:163], a[100:103], v[228:231]
  v_mfma_f32_16x16x32_bf16 v[232:235], a[160:163], a[104:107], v[232:235]
  ds_read_b64_tr_b16 a[148:149], v2 offset:35904
  v_mfma_f32_16x16x32_bf16 v[232:235], a[164:167], a[120:123], v[232:235]
  buffer_load_dwordx4 a[84:87], v0, s[36:39], s57 offen offset:1024 sc1
  v_mfma_f32_16x16x32_bf16 v[236:239], a[164:167], a[124:127], v[236:239]
  ds_read_b64_tr_b16 a[150:151], v2 offset:39488
  v_mfma_f32_16x16x32_bf16 v[236:239], a[160:163], a[108:111], v[236:239]
  v_mfma_f32_16x16x32_bf16 v[252:255], a[168:171], a[108:111], v[252:255]
  ds_read_b64_tr_b16 a[152:153], v2 offset:28768
  v_mfma_f32_16x16x32_bf16 v[252:255], a[172:175], a[124:127], v[252:255]
  v_mfma_f32_16x16x32_bf16 v[248:251], a[172:175], a[120:123], v[248:251]
  buffer_load_dwordx4 v8, s[16:19], s56 offen offset:1024 lds
  v_mfma_f32_16x16x32_bf16 v[248:251], a[168:171], a[104:107], v[248:251]
  ds_read_b64_tr_b16 a[154:155], v2 offset:32352
  v_mfma_f32_16x16x32_bf16 v[244:247], a[168:171], a[100:103], v[244:247]
  ds_read_b64_tr_b16 a[156:157], v2 offset:35936
  v_mfma_f32_16x16x32_bf16 v[244:247], a[172:175], a[116:119], v[244:247]
  v_mfma_f32_16x16x32_bf16 v[240:243], a[172:175], a[112:115], v[240:243]
  ds_read_b64_tr_b16 a[158:159], v2 offset:39520
  v_mfma_f32_16x16x32_bf16 v[240:243], a[168:171], a[96:99], v[240:243]
  s_waitcnt vmcnt(29) lgkmcnt(8)
  buffer_load_dwordx4 a[88:91], v0, s[36:39], s57 offen offset:2048 sc1
  v_mfma_f32_16x16x32_bf16 v[32:35], a[128:131], a[0:3], v[32:35]
  ds_read_b64_tr_b16 a[160:161], v2 offset:28800
  v_mfma_f32_16x16x32_bf16 v[32:35], a[132:135], a[16:19], v[32:35]
  s_waitcnt vmcnt(20)
  s_barrier
  v_mfma_f32_16x16x32_bf16 v[36:39], a[132:135], a[20:23], v[36:39]
  ds_read_b64_tr_b16 a[162:163], v2 offset:32384
  v_mfma_f32_16x16x32_bf16 v[36:39], a[128:131], a[4:7], v[36:39]
  v_mfma_f32_16x16x32_bf16 v[40:43], a[128:131], a[8:11], v[40:43]
  buffer_load_dwordx4 v9, s[16:19], s56 offen offset:2048 lds
  v_mfma_f32_16x16x32_bf16 v[40:43], a[132:135], a[24:27], v[40:43]
  ds_read_b64_tr_b16 a[164:165], v2 offset:35968
  v_mfma_f32_16x16x32_bf16 v[44:47], a[132:135], a[28:31], v[44:47]
  ds_read_b64_tr_b16 a[166:167], v2 offset:39552
  v_mfma_f32_16x16x32_bf16 v[44:47], a[128:131], a[12:15], v[44:47]
  v_mfma_f32_16x16x32_bf16 v[60:63], a[136:139], a[12:15], v[60:63]
  ds_read_b64_tr_b16 a[168:169], v2 offset:28832
  v_mfma_f32_16x16x32_bf16 v[60:63], a[140:143], a[28:31], v[60:63]
  buffer_load_dwordx4 a[92:95], v0, s[36:39], s57 offen offset:3072 sc1
  s_bfe_u32 s56, s85, 0x3001c
  v_mfma_f32_16x16x32_bf16 v[56:59], a[140:143], a[24:27], v[56:59]
  s_lshl_b32 s56, s56, 2
  s_bitcmp1_b32 s85, 31
  s_addc_u32 s56, s56, 0
  v_mfma_f32_16x16x32_bf16 v[56:59], a[136:139], a[8:11], v[56:59]
  s_mul_i32 s56, s56, 229376
  s_add_u32 m0, s77, 57344
  ds_read_b64_tr_b16 a[170:171], v2 offset:32416
  v_mfma_f32_16x16x32_bf16 v[52:55], a[136:139], a[4:7], v[52:55]
  ds_read_b64_tr_b16 a[172:173], v2 offset:36000
  v_mfma_f32_16x16x32_bf16 v[52:55], a[140:143], a[20:23], v[52:55]
  s_waitcnt vmcnt(14)
  v_accvgpr_read_b32 v26, a208
  v_accvgpr_read_b32 v27, a209
  v_mfma_f32_16x16x32_bf16 v[48:51], a[140:143], a[16:19], v[48:51]
  buffer_load_dwordx4 v3, s[16:19], s56 offen offset:0 lds
  v_accvgpr_read_b32 v28, a210
  v_mfma_f32_16x16x32_bf16 v[48:51], a[136:139], a[0:3], v[48:51]
  s_waitcnt lgkmcnt(7)
  ds_read_b64_tr_b16 a[174:175], v2 offset:39584
  v_accvgpr_read_b32 v29, a211
  v_mfma_f32_16x16x32_bf16 v[64:67], a[144:147], a[0:3], v[64:67]
  ds_read_b64_tr_b16 a[128:129], v2 offset:28864
  v_max_u32 v31, v26, v27
  v_mfma_f32_16x16x32_bf16 v[64:67], a[148:151], a[16:19], v[64:67]
  v_max3_u32 v31, v31, v28, v29
  v_accvgpr_read_b32 v22, a212
  v_mfma_f32_16x16x32_bf16 v[68:71], a[148:151], a[20:23], v[68:71]
  ds_read_b64_tr_b16 a[130:131], v2 offset:32448
  v_accvgpr_read_b32 v23, a213
  v_mfma_f32_16x16x32_bf16 v[68:71], a[144:147], a[4:7], v[68:71]
  buffer_load_dwordx4 v4, s[16:19], s56 offen offset:1024 lds
  v_max3_u32 v31, v31, v22, v23
  v_mfma_f32_16x16x32_bf16 v[72:75], a[144:147], a[8:11], v[72:75]
  ds_read_b64_tr_b16 a[132:133], v2 offset:36032
  v_add_f32 v26, v26, v22
  v_mfma_f32_16x16x32_bf16 v[72:75], a[148:151], a[24:27], v[72:75]
  v_add_f32 v27, v27, v23
  v_accvgpr_read_b32 v22, a214
  v_mfma_f32_16x16x32_bf16 v[76:79], a[148:151], a[28:31], v[76:79]
  ds_read_b64_tr_b16 a[134:135], v2 offset:39616
  v_accvgpr_read_b32 v23, a215
  v_mfma_f32_16x16x32_bf16 v[76:79], a[144:147], a[12:15], v[76:79]
  v_max3_u32 v31, v31, v22, v23
  v_add_f32 v28, v28, v22
  v_mfma_f32_16x16x32_bf16 v[92:95], a[152:155], a[12:15], v[92:95]
  buffer_load_dwordx4 v5, s[16:19], s56 offen offset:2048 lds
  v_add_f32 v29, v29, v23
  v_mfma_f32_16x16x32_bf16 v[92:95], a[156:159], a[28:31], v[92:95]
  ds_read_b64_tr_b16 a[136:137], v2 offset:43008
  v_accvgpr_read_b32 v22, a216
  v_mfma_f32_16x16x32_bf16 v[88:91], a[156:159], a[24:27], v[88:91]
  ds_read_b64_tr_b16 a[138:139], v2 offset:46592
  v_accvgpr_read_b32 v23, a217
  v_mfma_f32_16x16x32_bf16 v[88:91], a[152:155], a[8:11], v[88:91]
  v_max3_u32 v31, v31, v22, v23
  v_add_f32 v26, v26, v22
  v_mfma_f32_16x16x32_bf16 v[84:87], a[152:155], a[4:7], v[84:87]
  ds_read_b64_tr_b16 a[140:141], v2 offset:50176
  v_add_f32 v27, v27, v23
  v_mfma_f32_16x16x32_bf16 v[84:87], a[156:159], a[20:23], v[84:87]
  buffer_load_dwordx4 v6, s[16:19], s56 offen offset:3072 lds
  s_add_u32 m0, s77, 61440
  v_mfma_f32_16x16x32_bf16 v[80:83], a[156:159], a[16:19], v[80:83]
  ds_read_b64_tr_b16 a[142:143], v2 offset:53760
  v_accvgpr_read_b32 v22, a218
  v_mfma_f32_16x16x32_bf16 v[80:83], a[152:155], a[0:3], v[80:83]
  s_waitcnt lgkmcnt(8)
  v_accvgpr_read_b32 v23, a219
  v_max3_u32 v31, v31, v22, v23
  v_mfma_f32_16x16x32_bf16 v[96:99], a[160:163], a[0:3], v[96:99]
  ds_read_b64_tr_b16 a[144:145], v2 offset:43040
  v_add_f32 v28, v28, v22
  v_mfma_f32_16x16x32_bf16 v[96:99], a[164:167], a[16:19], v[96:99]
  v_add_f32 v29, v29, v23
  v_accvgpr_read_b32 v22, a220
  v_mfma_f32_16x16x32_bf16 v[100:103], a[164:167], a[20:23], v[100:103]
  buffer_load_dwordx4 v7, s[16:19], s56 offen offset:0 lds
  v_accvgpr_read_b32 v23, a221
  v_mfma_f32_16x16x32_bf16 v[100:103], a[160:163], a[4:7], v[100:103]
  ds_read_b64_tr_b16 a[146:147], v2 offset:46624
  v_max3_u32 v31, v31, v22, v23
  v_mfma_f32_16x16x32_bf16 v[104:107], a[160:163], a[8:11], v[104:107]
  ds_read_b64_tr_b16 a[148:149], v2 offset:50208
  v_add_f32 v26, v26, v22
  v_mfma_f32_16x16x32_bf16 v[104:107], a[164:167], a[24:27], v[104:107]
  v_add_f32 v27, v27, v23
  v_accvgpr_read_b32 v22, a222
  v_mfma_f32_16x16x32_bf16 v[108:111], a[164:167], a[28:31], v[108:111]
  ds_read_b64_tr_b16 a[150:151], v2 offset:53792
  v_accvgpr_read_b32 v23, a223
  v_mfma_f32_16x16x32_bf16 v[108:111], a[160:163], a[12:15], v[108:111]
  buffer_load_dwordx4 v8, s[16:19], s56 offen offset:1024 lds
  v_max3_u32 v31, v31, v22, v23
  v_mfma_f32_16x16x32_bf16 v[124:127], a[168:171], a[12:15], v[124:127]
  ds_read_b64_tr_b16 a[152:153], v2 offset:43072
  v_add_f32 v28, v28, v22
  v_mfma_f32_16x16x32_bf16 v[124:127], a[172:175], a[28:31], v[124:127]
  v_add_f32 v29, v29, v23
  v_mfma_f32_16x16x32_bf16 v[120:123], a[172:175], a[24:27], v[120:123]
  ds_read_b64_tr_b16 a[154:155], v2 offset:46656
  v_mfma_f32_16x16x32_bf16 v[120:123], a[168:171], a[8:11], v[120:123]
  v_cmp_eq_u32 vcc, -1, v31
  s_nop 4
  s_cbranch_vccnz CK8s
CK8x:
  v_mfma_f32_16x16x32_bf16 v[116:119], a[168:171], a[4:7], v[116:119]
  s_nop 0
  buffer_load_dwordx4 v9, s[16:19], s56 offen offset:2048 lds
  s_bfe_u32 s57, s85, 0x4001c
  v_mfma_f32_16x16x32_bf16 v[116:119], a[172:175], a[20:23], v[116:119]
  s_lshl_b32 s57, s57, 13
  s_add_u32 s57, s57, s86
  ds_read_b64_tr_b16 a[156:157], v2 offset:50240
  v_mfma_f32_16x16x32_bf16 v[112:115], a[172:175], a[16:19], v[112:115]
  ds_read_b64_tr_b16 a[158:159], v2 offset:53824
  v_permlane32_swap_b32 v26, v28
  v_mfma_f32_16x16x32_bf16 v[112:115], a[168:171], a[0:3], v[112:115]
  s_waitcnt lgkmcnt(8)
  v_permlane32_swap_b32 v27, v29
  v_add_f32 v26, v26, v28
  v_mfma_f32_16x16x32_bf16 v[128:131], a[128:131], a[0:3], v[128:131]
  ds_read_b64_tr_b16 a[160:161], v2 offset:43104
  v_add_f32 v27, v27, v29
  v_mfma_f32_16x16x32_bf16 v[128:131], a[132:135], a[16:19], v[128:131]
  buffer_load_dwordx4 a[96:99], v0, s[36:39], s57 offen offset:0 sc1
  v_cvt_pk_bf16_f32 v25, v26, v26
  v_mfma_f32_16x16x32_bf16 v[132:135], a[132:135], a[20:23], v[132:135]
  ds_read_b64_tr_b16 a[162:163], v2 offset:46688
  v_lshlrev_b32 v25, 16, v25
  v_mfma_f32_16x16x32_bf16 v[132:135], a[128:131], a[4:7], v[132:135]
  v_sub_f32 v30, v26, v25
  v_cvt_pk_bf16_f32 v22, v26, v30
  v_mfma_f32_16x16x32_bf16 v[136:139], a[128:131], a[8:11], v[136:139]
  ds_read_b64_tr_b16 a[164:165], v2 offset:50272
  v_and_b32 v25, 0xffff0000, v22
  v_mfma_f32_16x16x32_bf16 v[136:139], a[132:135], a[24:27], v[136:139]
  v_sub_f32 v30, v30, v25
  v_cvt_pk_bf16_f32 v23, v30, 0
  v_mfma_f32_16x16x32_bf16 v[140:143], a[132:135], a[28:31], v[140:143]
  buffer_load_dwordx4 a[100:103], v0, s[36:39], s57 offen offset:1024 sc1
  v_mfma_f32_16x16x32_bf16 v[140:143], a[128:131], a[12:15], v[140:143]
  ds_read_b64_tr_b16 a[166:167], v2 offset:53856
  v_mfma_f32_16x16x32_bf16 v[156:159], a[136:139], a[12:15], v[156:159]
  ds_read_b64_tr_b16 a[168:169], v2 offset:43136
  v_mfma_f32_16x16x32_bf16 v[156:159], a[140:143], a[28:31], v[156:159]
  ds_write_b64 v24, v[22:23] offset:0
  v_cvt_pk_bf16_f32 v25, v27, v27
  v_mfma_f32_16x16x32_bf16 v[152:155], a[140:143], a[24:27], v[152:155]
  ds_read_b64_tr_b16 a[170:171], v2 offset:46720
  v_lshlrev_b32 v25, 16, v25
  v_mfma_f32_16x16x32_bf16 v[152:155], a[136:139], a[8:11], v[152:155]
  buffer_load_dwordx4 a[104:107], v0, s[36:39], s57 offen offset:2048 sc1
  v_sub_f32 v30, v27, v25
  v_mfma_f32_16x16x32_bf16 v[148:151], a[136:139], a[4:7], v[148:151]
  ds_read_b64_tr_b16 a[172:173], v2 offset:50304
  v_cvt_pk_bf16_f32 v28, v27, v30
  v_mfma_f32_16x16x32_bf16 v[148:151], a[140:143], a[20:23], v[148:151]
  v_and_b32 v25, 0xffff0000, v28
  v_sub_f32 v30, v30, v25
  v_mfma_f32_16x16x32_bf16 v[144:147], a[140:143], a[16:19], v[144:147]
  ds_read_b64_tr_b16 a[174:175], v2 offset:53888
  v_cvt_pk_bf16_f32 v29, v30, 0
  v_mfma_f32_16x16x32_bf16 v[144:147], a[136:139], a[0:3], v[144:147]
  s_waitcnt lgkmcnt(9)
  ds_write_b64 v24, v[28:29] offset:16
  v_mfma_f32_16x16x32_bf16 v[160:163], a[144:147], a[0:3], v[160:163]
  buffer_load_dwordx4 a[108:111], v0, s[36:39], s57 offen offset:3072 sc1
  s_add_u32 s57, s57, 4096
  v_mfma_f32_16x16x32_bf16 v[160:163], a[148:151], a[16:19], v[160:163]
  ds_read_b64_tr_b16 a[128:129], v2 offset:43168
  v_mfma_f32_16x16x32_bf16 v[164:167], a[148:151], a[20:23], v[164:167]
  ds_read_b64_tr_b16 a[130:131], v2 offset:46752
  v_mfma_f32_16x16x32_bf16 v[164:167], a[144:147], a[4:7], v[164:167]
  v_mfma_f32_16x16x32_bf16 v[168:171], a[144:147], a[8:11], v[168:171]
  ds_read_b64_tr_b16 a[132:133], v2 offset:50336
  v_mfma_f32_16x16x32_bf16 v[168:171], a[148:151], a[24:27], v[168:171]
  buffer_load_dwordx4 a[112:115], v0, s[36:39], s57 offen offset:0 sc1
  v_mfma_f32_16x16x32_bf16 v[172:175], a[148:151], a[28:31], v[172:175]
  ds_read_b64_tr_b16 a[134:135], v2 offset:53920
  v_mfma_f32_16x16x32_bf16 v[172:175], a[144:147], a[12:15], v[172:175]
  v_mfma_f32_16x16x32_bf16 v[188:191], a[152:155], a[12:15], v[188:191]
  ds_read_b64_tr_b16 a[136:137], v2 offset:43200
  v_mfma_f32_16x16x32_bf16 v[188:191], a[156:159], a[28:31], v[188:191]
  v_mfma_f32_16x16x32_bf16 v[184:187], a[156:159], a[24:27], v[184:187]
  buffer_load_dwordx4 a[116:119], v0, s[36:39], s57 offen offset:1024 sc1
  v_mfma_f32_16x16x32_bf16 v[184:187], a[152:155], a[8:11], v[184:187]
  ds_read_b64_tr_b16 a[138:139], v2 offset:46784
  v_mfma_f32_16x16x32_bf16 v[180:183], a[152:155], a[4:7], v[180:183]
  ds_read_b64_tr_b16 a[140:141], v2 offset:50368
  v_mfma_f32_16x16x32_bf16 v[180:183], a[156:159], a[20:23], v[180:183]
  v_mfma_f32_16x16x32_bf16 v[176:179], a[156:159], a[16:19], v[176:179]
  ds_read_b64_tr_b16 a[142:143], v2 offset:53952
  v_mfma_f32_16x16x32_bf16 v[176:179], a[152:155], a[0:3], v[176:179]
  s_waitcnt lgkmcnt(9)
  buffer_load_dwordx4 a[120:123], v0, s[36:39], s57 offen offset:2048 sc1
  v_mfma_f32_16x16x32_bf16 v[192:195], a[160:163], a[0:3], v[192:195]
  ds_read_b64_tr_b16 a[144:145], v1 offset:192
  v_mfma_f32_16x16x32_bf16 v[192:195], a[164:167], a[16:19], v[192:195]
  v_mfma_f32_16x16x32_bf16 v[196:199], a[164:167], a[20:23], v[196:199]
  s_lshl_b32 s68, s44, 8
  ds_read_b64_tr_b16 a[146:147], v1 offset:3776
  s_add_u32 s68, s68, s2
  v_mfma_f32_16x16x32_bf16 v[196:199], a[160:163], a[4:7], v[196:199]
  s_mul_i32 s68, s68, 7168
  v_mfma_f32_16x16x32_bf16 v[200:203], a[160:163], a[8:11], v[200:203]
  buffer_load_dwordx4 a[124:127], v0, s[36:39], s57 offen offset:3072 sc1
  v_mfma_f32_16x16x32_bf16 v[200:203], a[164:167], a[24:27], v[200:203]
Hc2_1:
  s_cbranch_execz Rc
  ds_read_b64_tr_b16 a[148:149], v1 offset:7360
  v_mfma_f32_16x16x32_bf16 v[204:207], a[164:167], a[28:31], v[204:207]
  ds_read_b64_tr_b16 a[150:151], v1 offset:10944
  v_mfma_f32_16x16x32_bf16 v[204:207], a[160:163], a[12:15], v[204:207]
  s_waitcnt vmcnt(16)
  s_barrier
  v_mfma_f32_16x16x32_bf16 v[220:223], a[168:171], a[12:15], v[220:223]
  ds_read_b64_tr_b16 a[152:153], v1 offset:14528
  v_mfma_f32_16x16x32_bf16 v[220:223], a[172:175], a[28:31], v[220:223]
  v_mfma_f32_16x16x32_bf16 v[216:219], a[172:175], a[24:27], v[216:219]
  ds_read_b64_tr_b16 a[154:155], v1 offset:18112
  v_mfma_f32_16x16x32_bf16 v[216:219], a[168:171], a[8:11], v[216:219]
  v_mfma_f32_16x16x32_bf16 v[212:215], a[168:171], a[4:7], v[212:215]
  ds_read_b64_tr_b16 a[156:157], v1 offset:21696
  v_mfma_f32_16x16x32_bf16 v[212:215], a[172:175], a[20:23], v[212:215]
  v_mfma_f32_16x16x32_bf16 v[208:211], a[172:175], a[16:19], v[208:211]
  ds_read_b64_tr_b16 a[158:159], v1 offset:25280
  v_mfma_f32_16x16x32_bf16 v[208:211], a[168:171], a[0:3], v[208:211]
  s_waitcnt lgkmcnt(8)
  v_mfma_f32_16x16x32_bf16 v[224:227], a[128:131], a[0:3], v[224:227]
  ds_read_b64_tr_b16 a[160:161], v1 offset:28864
  v_mfma_f32_16x16x32_bf16 v[224:227], a[132:135], a[16:19], v[224:227]
  v_mfma_f32_16x16x32_bf16 v[228:231], a[132:135], a[20:23], v[228:231]
  ds_read_b64_tr_b16 a[162:163], v1 offset:32448
  v_mfma_f32_16x16x32_bf16 v[228:231], a[128:131], a[4:7], v[228:231]
  v_mfma_f32_16x16x32_bf16 v[232:235], a[128:131], a[8:11], v[232:235]
  ds_read_b64_tr_b16 a[164:165], v1 offset:36032
  v_mfma_f32_16x16x32_bf16 v[232:235], a[132:135], a[24:27], v[232:235]
  v_mfma_f32_16x16x32_bf16 v[236:239], a[132:135], a[28:31], v[236:239]
  ds_read_b64_tr_b16 a[166:167], v1 offset:39616
  v_mfma_f32_16x16x32_bf16 v[236:239], a[128:131], a[12:15], v[236:239]
  v_mfma_f32_16x16x32_bf16 v[252:255], a[136:139], a[12:15], v[252:255]
  ds_read_b64_tr_b16 a[168:169], v1 offset:43200
  v_mfma_f32_16x16x32_bf16 v[252:255], a[140:143], a[28:31], v[252:255]
  v_mfma_f32_16x16x32_bf16 v[248:251], a[140:143], a[24:27], v[248:251]
  ds_read_b64_tr_b16 a[170:171], v1 offset:46784
  v_mfma_f32_16x16x32_bf16 v[248:251], a[136:139], a[8:11], v[248:251]
  v_mfma_f32_16x16x32_bf16 v[244:247], a[136:139], a[4:7], v[244:247]
  ds_read_b64_tr_b16 a[172:173], v1 offset:50368
  v_mfma_f32_16x16x32_bf16 v[244:247], a[140:143], a[20:23], v[244:247]
  v_mfma_f32_16x16x32_bf16 v[240:243], a[140:143], a[16:19], v[240:243]
  ds_read_b64_tr_b16 a[174:175], v1 offset:53952
  v_mfma_f32_16x16x32_bf16 v[240:243], a[136:139], a[0:3], v[240:243]
  s_waitcnt vmcnt(33) lgkmcnt(8)
  v_mfma_f32_16x16x32_bf16 v[128:131], a[144:147], a[32:35], v[128:131]
  v_lshrrev_b32 v8, 1, v0
  v_and_b32 v31, 0xf0, v0
  v_mfma_f32_16x16x32_bf16 v[128:131], a[148:151], a[48:51], v[128:131]
  s_waitcnt vmcnt(8)
  s_barrier
  v_add_u32 v31, 159744, v31
  v_mfma_f32_16x16x32_bf16 v[132:135], a[148:151], a[52:55], v[132:135]
  v_cmp_gt_u32 vcc, 0x100, v0
  s_mov_b32 s78, 0x01000100
  v_mfma_f32_16x16x32_bf16 v[132:135], a[144:147], a[36:39], v[132:135]
  s_mov_b32 s79, 0x03020302
  v_min_u32 v3, 880, v0
  v_lshlrev_b32 v3, 3, v3
  v_mfma_f32_16x16x32_bf16 v[136:139], a[144:147], a[40:43], v[136:139]
  buffer_load_dword a252, v3, s[24:27], s68 offen
  v_cndmask_b32 v12, 0, v12, vcc
  v_mfma_f32_16x16x32_bf16 v[136:139], a[148:151], a[56:59], v[136:139]
  v_perm_b32 v22, v12, v12, s78
  v_and_b32 v23, 0xffff, v12
  v_mfma_f32_16x16x32_bf16 v[140:143], a[148:151], a[60:63], v[140:143]
  v_perm_b32 v24, v12, v12, s79
  v_lshrrev_b32 v25, 16, v12
  v_mfma_f32_16x16x32_bf16 v[140:143], a[144:147], a[44:47], v[140:143]
  v_accvgpr_write_b32 a0, v22
  v_accvgpr_write_b32 a1, v23
  v_mfma_f32_16x16x32_bf16 v[252:255], a[152:155], a[44:47], v[252:255]
  ds_read_b64_tr_b16 a[128:129], v2 offset:192
  v_accvgpr_write_b32 a2, v24
  v_mfma_f32_16x16x32_bf16 v[252:255], a[156:159], a[60:63], v[252:255]
  v_accvgpr_write_b32 a3, v25
  v_cndmask_b32 v15, 0, v15, vcc
  v_mfma_f32_16x16x32_bf16 v[248:251], a[156:159], a[56:59], v[248:251]
  ds_read_b64_tr_b16 a[130:131], v2 offset:3776
  v_perm_b32 v26, v15, v15, s78
  v_mfma_f32_16x16x32_bf16 v[248:251], a[152:155], a[40:43], v[248:251]
  v_and_b32 v27, 0xffff, v15
  v_perm_b32 v28, v15, v15, s79
  v_mfma_f32_16x16x32_bf16 v[244:247], a[152:155], a[36:39], v[244:247]
  ds_read_b64_tr_b16 a[132:133], v2 offset:7360
  v_lshrrev_b32 v29, 16, v15
  v_mfma_f32_16x16x32_bf16 v[244:247], a[156:159], a[52:55], v[244:247]
  ds_read_b128 a[16:19], v31 offset:1536
  v_accvgpr_write_b32 a4, v26
  v_mfma_f32_16x16x32_bf16 v[240:243], a[156:159], a[48:51], v[240:243]
  ds_read_b128 a[20:23], v31 offset:3584
  v_accvgpr_write_b32 a5, v27
  v_mfma_f32_16x16x32_bf16 v[240:243], a[152:155], a[32:35], v[240:243]
  s_waitcnt vmcnt(16) lgkmcnt(5)
  ds_read_b64_tr_b16 a[134:135], v2 offset:10944
  v_accvgpr_write_b32 a6, v28
  v_mfma_f32_16x16x32_bf16 v[128:131], a[160:163], a[64:67], v[128:131]
  ds_read_b64_tr_b16 a[136:137], v2 offset:14528
  v_accvgpr_write_b32 a7, v29
  v_mfma_f32_16x16x32_bf16 v[128:131], a[164:167], a[80:83], v[128:131]
  v_cndmask_b32 v18, 0, v18, vcc
  v_perm_b32 v22, v18, v18, s78
  v_mfma_f32_16x16x32_bf16 v[132:135], a[164:167], a[84:87], v[132:135]
  ds_read_b64_tr_b16 a[138:139], v2 offset:18112
  v_and_b32 v23, 0xffff, v18
  v_mfma_f32_16x16x32_bf16 v[132:135], a[160:163], a[68:71], v[132:135]
  v_perm_b32 v24, v18, v18, s79
  v_lshrrev_b32 v25, 16, v18
  v_mfma_f32_16x16x32_bf16 v[136:139], a[160:163], a[72:75], v[136:139]
  ds_read_b64_tr_b16 a[140:141], v2 offset:21696
  v_accvgpr_write_b32 a8, v22
  v_mfma_f32_16x16x32_bf16 v[136:139], a[164:167], a[88:91], v[136:139]
  v_accvgpr_write_b32 a9, v23
  v_accvgpr_write_b32 a10, v24
  v_mfma_f32_16x16x32_bf16 v[140:143], a[164:167], a[92:95], v[140:143]
  ds_read_b64_tr_b16 a[142:143], v2 offset:25280
  v_accvgpr_write_b32 a11, v25
  v_mfma_f32_16x16x32_bf16 v[140:143], a[160:163], a[76:79], v[140:143]
  v_cndmask_b32 v21, 0, v21, vcc
  v_perm_b32 v26, v21, v21, s78
  v_mfma_f32_16x16x32_bf16 v[252:255], a[168:171], a[76:79], v[252:255]
  ds_read_b64_tr_b16 a[144:145], v1 offset:0
  v_and_b32 v27, 0xffff, v21
  v_mfma_f32_16x16x32_bf16 v[252:255], a[172:175], a[92:95], v[252:255]
  v_perm_b32 v28, v21, v21, s79
  v_lshrrev_b32 v29, 16, v21
  v_mfma_f32_16x16x32_bf16 v[248:251], a[172:175], a[88:91], v[248:251]
  ds_read_b64_tr_b16 a[146:147], v1 offset:3584
  v_accvgpr_write_b32 a12, v26
  v_mfma_f32_16x16x32_bf16 v[248:251], a[168:171], a[72:75], v[248:251]
  v_accvgpr_write_b32 a13, v27
  v_accvgpr_write_b32 a14, v28
  v_mfma_f32_16x16x32_bf16 v[244:247], a[168:171], a[68:71], v[244:247]
  v_accvgpr_write_b32 a15, v29
  v_mfma_f32_16x16x32_bf16 v[244:247], a[172:175], a[84:87], v[244:247]
  ds_read_b64_tr_b16 a[148:149], v1 offset:7168
  v_mfma_f32_16x16x32_bf16 v[240:243], a[172:175], a[80:83], v[240:243]
  ds_read_b64_tr_b16 a[150:151], v1 offset:10752
  v_mov_b32 v9, s3
  v_mfma_f32_16x16x32_bf16 v[240:243], a[168:171], a[64:67], v[240:243]
  s_waitcnt lgkmcnt(9)
  v_mfma_f32_16x16x32_bf16 v[128:131], a[16:19], a[0:3], v[128:131]
  v_mfma_f32_16x16x32_bf16 v[132:135], a[16:19], a[4:7], v[132:135]
  v_mfma_f32_16x16x32_bf16 v[136:139], a[16:19], a[8:11], v[136:139]
  v_mfma_f32_16x16x32_bf16 v[140:143], a[16:19], a[12:15], v[140:143]
  v_mfma_f32_16x16x32_bf16 v[240:243], a[20:23], a[0:3], v[240:243]
  v_mfma_f32_16x16x32_bf16 v[244:247], a[20:23], a[4:7], v[244:247]
  v_mfma_f32_16x16x32_bf16 v[248:251], a[20:23], a[8:11], v[248:251]
  v_mfma_f32_16x16x32_bf16 v[252:255], a[20:23], a[12:15], v[252:255]
  s_waitcnt vmcnt(1) lgkmcnt(4)
  v_mfma_f32_16x16x32_bf16 v[128:131], a[128:131], a[96:99], v[128:131]
  ds_read_b128 a[24:27], v31 offset:0
  v_mfma_f32_16x16x32_bf16 v[128:131], a[132:135], a[112:115], v[128:131]
  ds_read_b64_tr_b16 a[152:153], v1 offset:14336
  v_mfma_f32_16x16x32_bf16 v[132:135], a[132:135], a[116:119], v[132:135]
  ds_read_b128 a[28:31], v31 offset:2048
  v_mfma_f32_16x16x32_bf16 v[132:135], a[128:131], a[100:103], v[132:135]
  ds_read_b64_tr_b16 a[154:155], v1 offset:17920
  v_mfma_f32_16x16x32_bf16 v[136:139], a[128:131], a[104:107], v[136:139]
  ds_read_b64_tr_b16 a[156:157], v1 offset:21504
  v_mfma_f32_16x16x32_bf16 v[136:139], a[132:135], a[120:123], v[136:139]
  v_mfma_f32_16x16x32_bf16 v[140:143], a[132:135], a[124:127], v[140:143]
  ds_read_b64_tr_b16 a[158:159], v1 offset:25088
  v_mfma_f32_16x16x32_bf16 v[140:143], a[128:131], a[108:111], v[140:143]
  v_mfma_f32_16x16x32_bf16 v[252:255], a[136:139], a[108:111], v[252:255]
  ds_read_b64_tr_b16 a[160:161], v1 offset:28672
  v_mul_f32 v22, v10, v128
  v_mul_f32 v23, v10, v129
  v_mul_f32 v24, v10, v130
  v_mfma_f32_16x16x32_bf16 v[252:255], a[140:143], a[124:127], v[252:255]
  v_mul_f32 v25, v10, v131
  v_exp_f32 v22, v22
  v_mul_f32 v26, v13, v132
  v_mfma_f32_16x16x32_bf16 v[248:251], a[140:143], a[120:123], v[248:251]
  ds_read_b64_tr_b16 a[162:163], v1 offset:32256
  v_exp_f32 v23, v23
  v_mul_f32 v27, v13, v133
  v_mfma_f32_16x16x32_bf16 v[248:251], a[136:139], a[104:107], v[248:251]
  v_exp_f32 v24, v24
  v_mul_f32 v28, v13, v134
  v_mfma_f32_16x16x32_bf16 v[244:247], a[136:139], a[100:103], v[244:247]
  ds_read_b64_tr_b16 a[164:165], v1 offset:35840
  v_exp_f32 v25, v25
  v_mul_f32 v29, v13, v135
  v_mfma_f32_16x16x32_bf16 v[244:247], a[140:143], a[116:119], v[244:247]
  v_exp_f32 v26, v26
  v_fma_f32 v22, v22, v11, v11
  v_mfma_f32_16x16x32_bf16 v[240:243], a[140:143], a[112:115], v[240:243]
  ds_read_b64_tr_b16 a[166:167], v1 offset:39424
  v_exp_f32 v27, v27
  v_fma_f32 v23, v23, v11, v11
  v_mfma_f32_16x16x32_bf16 v[240:243], a[136:139], a[96:99], v[240:243]
  s_waitcnt lgkmcnt(4)
  v_exp_f32 v28, v28
  v_fma_f32 v24, v24, v11, v11
  v_mfma_f32_16x16x32_bf16 v[32:35], a[144:147], a[32:35], v[32:35]
  ds_read_b64_tr_b16 a[168:169], v1 offset:43008
  v_exp_f32 v29, v29
  v_fma_f32 v25, v25, v11, v11
  v_mfma_f32_16x16x32_bf16 v[32:35], a[148:151], a[48:51], v[32:35]
  v_rcp_f32 v22, v22
  v_fma_f32 v26, v26, v14, v14
  v_mfma_f32_16x16x32_bf16 v[36:39], a[148:151], a[52:55], v[36:39]
  ds_read_b64_tr_b16 a[170:171], v1 offset:46592
  v_rcp_f32 v23, v23
  v_fma_f32 v27, v27, v14, v14
  v_mfma_f32_16x16x32_bf16 v[36:39], a[144:147], a[36:39], v[36:39]
  v_rcp_f32 v24, v24
  v_fma_f32 v28, v28, v14, v14
  v_mfma_f32_16x16x32_bf16 v[40:43], a[144:147], a[40:43], v[40:43]
  ds_read_b64_tr_b16 a[172:173], v1 offset:50176
  v_rcp_f32 v25, v25
  v_fma_f32 v29, v29, v14, v14
  v_mfma_f32_16x16x32_bf16 v[40:43], a[148:151], a[56:59], v[40:43]
  v_rcp_f32 v26, v26
  v_mul_f32 v240, v128, v240
  v_mfma_f32_16x16x32_bf16 v[44:47], a[148:151], a[60:63], v[44:47]
  ds_read_b64_tr_b16 a[174:175], v1 offset:53760
  v_rcp_f32 v27, v27
  v_mul_f32 v241, v129, v241
  v_mfma_f32_16x16x32_bf16 v[44:47], a[144:147], a[44:47], v[44:47]
  s_waitcnt lgkmcnt(11)
  v_rcp_f32 v28, v28
  v_mul_f32 v242, v130, v242
  v_mfma_f32_16x16x32_bf16 v[32:35], a[24:27], a[0:3], v[32:35]
  ds_read_b64_tr_b16 a[128:129], v2 offset:0
  v_rcp_f32 v29, v29
  v_mul_f32 v243, v131, v243
  v_mfma_f32_16x16x32_bf16 v[36:39], a[24:27], a[4:7], v[36:39]
  v_mul_f32 v240, v240, v22
  v_mul_f32 v241, v241, v23
  v_mul_f32 v242, v242, v24
  v_mul_f32 v243, v243, v25
  v_mfma_f32_16x16x32_bf16 v[40:43], a[24:27], a[8:11], v[40:43]
  ds_read_b64_tr_b16 a[130:131], v2 offset:3584
  v_mul_f32 v22, v16, v136
  v_mul_f32 v23, v16, v137
  v_mul_f32 v24, v16, v138
  v_mfma_f32_16x16x32_bf16 v[44:47], a[24:27], a[12:15], v[44:47]
  v_mul_f32 v25, v16, v139
  v_exp_f32 v22, v22
  v_mul_f32 v244, v132, v244
  v_mfma_f32_16x16x32_bf16 v[144:147], a[28:31], a[0:3], v[144:147]
  ds_read_b64_tr_b16 a[132:133], v2 offset:7168
  v_exp_f32 v23, v23
  v_mul_f32 v245, v133, v245
  v_mfma_f32_16x16x32_bf16 v[148:151], a[28:31], a[4:7], v[148:151]
  v_exp_f32 v24, v24
  v_mul_f32 v246, v134, v246
  v_mfma_f32_16x16x32_bf16 v[152:155], a[28:31], a[8:11], v[152:155]
  ds_read_b64_tr_b16 a[134:135], v2 offset:10752
  v_exp_f32 v25, v25
  v_mul_f32 v247, v135, v247
  v_mfma_f32_16x16x32_bf16 v[156:159], a[28:31], a[12:15], v[156:159]
  v_mul_f32 v244, v244, v26
  v_mul_f32 v245, v245, v27
  v_mul_f32 v246, v246, v28
  v_mul_f32 v247, v247, v29
  v_mfma_f32_16x16x32_bf16 v[156:159], a[152:155], a[44:47], v[156:159]
  ds_read_b64_tr_b16 a[136:137], v2 offset:14336
  v_cvt_pk_bf16_f32 v128, v240, v241
  v_cvt_pk_bf16_f32 v129, v242, v243
  v_mfma_f32_16x16x32_bf16 v[156:159], a[156:159], a[60:63], v[156:159]
  buffer_store_dwordx2 v[128:129], v8, s[36:39], s65 offen offset:0 sc1
  v_mul_f32 v26, v19, v140
  v_mul_f32 v27, v19, v141
  v_mul_f32 v28, v19, v142
  v_mfma_f32_16x16x32_bf16 v[152:155], a[156:159], a[56:59], v[152:155]
  ds_read_b64_tr_b16 a[138:139], v2 offset:17920
  v_mul_f32 v29, v19, v143
  v_exp_f32 v26, v26
  v_mfma_f32_16x16x32_bf16 v[152:155], a[152:155], a[40:43], v[152:155]
  v_fma_f32 v22, v22, v17, v17
  v_exp_f32 v27, v27
  v_fma_f32 v23, v23, v17, v17
  v_mfma_f32_16x16x32_bf16 v[148:151], a[152:155], a[36:39], v[148:151]
  ds_read_b64_tr_b16 a[140:141], v2 offset:21504
  v_exp_f32 v28, v28
  v_fma_f32 v24, v24, v17, v17
  v_mfma_f32_16x16x32_bf16 v[148:151], a[156:159], a[52:55], v[148:151]
  v_exp_f32 v29, v29
  v_fma_f32 v25, v25, v17, v17
  v_cvt_pk_bf16_f32 v132, v244, v245
  v_mfma_f32_16x16x32_bf16 v[144:147], a[156:159], a[48:51], v[144:147]
  ds_read_b64_tr_b16 a[142:143], v2 offset:25088
  v_cvt_pk_bf16_f32 v133, v246, v247
  v_mfma_f32_16x16x32_bf16 v[144:147], a[152:155], a[32:35], v[144:147]
  s_waitcnt lgkmcnt(8)
  buffer_store_dwordx2 v[132:133], v8, s[36:39], s65 offen offset:1024 sc1
  v_rcp_f32 v22, v22
  v_fma_f32 v26, v26, v20, v20
  v_mfma_f32_16x16x32_bf16 v[32:35], a[160:163], a[64:67], v[32:35]
  ds_read_b64_tr_b16 a[144:145], v1 offset:32
  v_rcp_f32 v23, v23
  v_fma_f32 v27, v27, v20, v20
  v_mfma_f32_16x16x32_bf16 v[32:35], a[164:167], a[80:83], v[32:35]
  v_rcp_f32 v24, v24
  v_fma_f32 v28, v28, v20, v20
  v_mfma_f32_16x16x32_bf16 v[36:39], a[164:167], a[84:87], v[36:39]
  ds_read_b64_tr_b16 a[146:147], v1 offset:3616
  v_rcp_f32 v25, v25
  v_fma_f32 v29, v29, v20, v20
  v_mfma_f32_16x16x32_bf16 v[36:39], a[160:163], a[68:71], v[36:39]
  v_rcp_f32 v26, v26
  v_mul_f32 v248, v136, v248
  v_mfma_f32_16x16x32_bf16 v[40:43], a[160:163], a[72:75], v[40:43]
  ds_read_b64_tr_b16 a[148:149], v1 offset:7200
  v_rcp_f32 v27, v27
  v_mul_f32 v249, v137, v249
  v_mfma_f32_16x16x32_bf16 v[40:43], a[164:167], a[88:91], v[40:43]
  v_rcp_f32 v28, v28
  v_mul_f32 v250, v138, v250
  v_mfma_f32_16x16x32_bf16 v[44:47], a[164:167], a[92:95], v[44:47]
  ds_read_b64_tr_b16 a[150:151], v1 offset:10784
  v_rcp_f32 v29, v29
  v_mul_f32 v251, v139, v251
  v_mfma_f32_16x16x32_bf16 v[44:47], a[160:163], a[76:79], v[44:47]
  v_mul_f32 v248, v248, v22
  v_mul_f32 v249, v249, v23
  v_mul_f32 v250, v250, v24
  v_mul_f32 v251, v251, v25
  v_mfma_f32_16x16x32_bf16 v[156:159], a[168:171], a[76:79], v[156:159]
  v_mul_f32 v252, v140, v252
  v_mul_f32 v253, v141, v253
  v_mul_f32 v254, v142, v254
  v_mul_f32 v255, v143, v255
  v_mfma_f32_16x16x32_bf16 v[156:159], a[172:175], a[92:95], v[156:159]
  v_cvt_pk_bf16_f32 v136, v248, v249
  v_cvt_pk_bf16_f32 v137, v250, v251
  v_mfma_f32_16x16x32_bf16 v[152:155], a[172:175], a[88:91], v[152:155]
  buffer_store_dwordx2 v[136:137], v8, s[36:39], s66 offen offset:0 sc1
  v_mul_f32 v252, v252, v26
  v_mul_f32 v253, v253, v27
  v_mul_f32 v254, v254, v28
  v_mfma_f32_16x16x32_bf16 v[152:155], a[168:171], a[72:75], v[152:155]
  v_mul_f32 v255, v255, v29
  v_cvt_pk_bf16_f32 v140, v252, v253
  v_cvt_pk_bf16_f32 v141, v254, v255
  v_mfma_f32_16x16x32_bf16 v[148:151], a[168:171], a[68:71], v[148:151]
  buffer_store_dwordx2 v[140:141], v8, s[36:39], s66 offen offset:1024 sc1
  s_mov_b32 s65, s67
  s_add_u32 s66, s67, 262144
  v_mfma_f32_16x16x32_bf16 v[148:151], a[172:175], a[84:87], v[148:151]
  v_lshrrev_b32 v128, 4, v0
  s_lshr_b32 s90, s54, 2
  s_mul_i32 s90, s90, 2
  s_add_u32 s87, s52, s54
  v_mfma_f32_16x16x32_bf16 v[144:147], a[172:175], a[80:83], v[144:147]
  s_add_u32 s87, s87, s90
  s_and_b32 s87, s87, 3
  s_and_b32 s90, s2, 1
  s_lshl_b32 s89, s53, 7
  s_lshl3_add_u32 s89, s70, s89
  v_mfma_f32_16x16x32_bf16 v[144:147], a[168:171], a[64:67], v[144:147]
  s_waitcnt lgkmcnt(4)
  s_mul_i32 s88, s90, 3670016
  s_add_u32 s89, s89, s88
  s_lshr_b32 s88, s44, 1
  s_mul_i32 s88, s88, 196608
  v_mfma_f32_16x16x32_bf16 v[32:35], a[128:131], a[96:99], v[32:35]
  ds_read_b128 a[16:19], v31 offset:256
  v_bfe_u32 v129, v128, 4, 2
  v_bfe_u32 v130, v128, 1, 2
  v_xor_b32 v129, v129, v130
  v_mfma_f32_16x16x32_bf16 v[32:35], a[132:135], a[112:115], v[32:35]
  ds_read_b64_tr_b16 a[152:153], v1 offset:14368
  v_lshlrev_b32 v129, 5, v129
  v_and_b32 v130, 1, v128
  v_lshl_add_u32 v129, v130, 4, v129
  v_mfma_f32_16x16x32_bf16 v[36:39], a[132:135], a[116:119], v[36:39]
  ds_read_b128 a[20:23], v31 offset:2304
  v_lshrrev_b32 v130, 3, v128
  v_lshlrev_b32 v130, 11, v130
  s_sub_u32 s24, s24, 2048
  v_mfma_f32_16x16x32_bf16 v[36:39], a[128:131], a[100:103], v[36:39]
  s_subb_u32 s25, s25, 0
  s_mov_b32 s26, 7342080
  ds_read_b64_tr_b16 a[154:155], v1 offset:17952
  v_add3_u32 v129, v129, v130, s89
  v_add_u32 v133, 2048, v129
  v_mfma_f32_16x16x32_bf16 v[40:43], a[128:131], a[104:107], v[40:43]
  ds_read_b64_tr_b16 a[156:157], v1 offset:21536
  v_add_u32 v134, 17408, v129
  v_xor_b32 v135, 128, v129
  v_add_u32 v136, 15360, v135
  v_mfma_f32_16x16x32_bf16 v[40:43], a[132:135], a[120:123], v[40:43]
  v_and_b32 v129, 7, v128
  v_lshrrev_b32 v131, 4, v128
  v_xor_b32 v129, v129, v131
  v_lshl_add_u32 v252, v129, 4, v130
  v_mfma_f32_16x16x32_bf16 v[44:47], a[132:135], a[124:127], v[44:47]
  ds_read_b64_tr_b16 a[158:159], v1 offset:25120
  v_xor_b32 v253, 64, v252
  v_add_u32 v253, 16384, v253
  s_lshl2_add_u32 s89, s52, s44
  v_mfma_f32_16x16x32_bf16 v[44:47], a[128:131], a[108:111], v[44:47]
  s_lshl_b32 s89, s89, 18
  s_mul_i32 s91, s90, 114688
  s_add_u32 s89, s89, s91
  s_add_u32 s89, s89, 19922944
  v_add_u32 v137, s89, v0
  v_mfma_f32_16x16x32_bf16 v[156:159], a[136:139], a[108:111], v[156:159]
  ds_read_b64_tr_b16 a[160:161], v1 offset:28704
  v_add_u32 v7, s89, v8
  v_bfe_u32 v129, v128, 3, 2
  v_lshlrev_b32 v129, 5, v129
  v_mfma_f32_16x16x32_bf16 v[156:159], a[140:143], a[124:127], v[156:159]
  v_and_b32 v130, 3, v128
  v_lshl_add_u32 v129, v130, 3, v129
  v_lshrrev_b32 v130, 2, v128
  v_lshl_add_u32 v240, v130, 7, v129
  v_mfma_f32_16x16x32_bf16 v[152:155], a[140:143], a[120:123], v[152:155]
  ds_read_b64_tr_b16 a[162:163], v1 offset:32288
  v_xor_b32 v241, 32, v240
  v_xor_b32 v242, 64, v240
  v_xor_b32 v243, 96, v240
  v_mfma_f32_16x16x32_bf16 v[152:155], a[136:139], a[104:107], v[152:155]
  v_xor_b32 v244, 65536, v240
  v_xor_b32 v245, 65568, v240
  v_xor_b32 v246, 65600, v240
  v_xor_b32 v247, 65632, v240
  v_mfma_f32_16x16x32_bf16 v[148:151], a[136:139], a[100:103], v[148:151]
  ds_read_b64_tr_b16 a[164:165], v1 offset:35872
  v_xor_b32 v248, 131072, v240
  v_xor_b32 v249, 131104, v240
  v_xor_b32 v250, 131136, v240
  v_mfma_f32_16x16x32_bf16 v[148:151], a[140:143], a[116:119], v[148:151]
  v_xor_b32 v251, 131168, v240
  s_lshr_b32 s89, s52, 1
  s_lshl_b32 s89, s89, 5
  s_lshl2_add_u32 s89, s90, s89
  v_mfma_f32_16x16x32_bf16 v[144:147], a[140:143], a[112:115], v[144:147]
  ds_read_b64_tr_b16 a[166:167], v1 offset:39456
  v_and_b32 v129, 3, v128
  v_bfe_u32 v130, v128, 2, 2
  v_lshl_add_u32 v129, v129, 3, v130
  v_mfma_f32_16x16x32_bf16 v[144:147], a[136:139], a[96:99], v[144:147]
  s_waitcnt lgkmcnt(4)
  v_add_lshl_u32 v138, v129, s89, 7
  s_mov_b32 s91, 5373952
  v_mul_f32 v22, v10, v32
  v_mul_f32 v23, v10, v33
  v_mfma_f32_16x16x32_bf16 v[48:51], a[144:147], a[32:35], v[48:51]
  ds_read_b64_tr_b16 a[168:169], v1 offset:43040
  v_mul_f32 v24, v10, v34
  v_mul_f32 v25, v10, v35
  v_mfma_f32_16x16x32_bf16 v[48:51], a[148:151], a[48:51], v[48:51]
  v_exp_f32 v22, v22
  v_mul_f32 v26, v13, v36
  v_mfma_f32_16x16x32_bf16 v[52:55], a[148:151], a[52:55], v[52:55]
  ds_read_b64_tr_b16 a[170:171], v1 offset:46624
  v_exp_f32 v23, v23
  v_mul_f32 v27, v13, v37
  v_mfma_f32_16x16x32_bf16 v[52:55], a[144:147], a[36:39], v[52:55]
  v_exp_f32 v24, v24
  v_mul_f32 v28, v13, v38
  v_mfma_f32_16x16x32_bf16 v[56:59], a[144:147], a[40:43], v[56:59]
  ds_read_b64_tr_b16 a[172:173], v1 offset:50208
  v_exp_f32 v25, v25
  v_mul_f32 v29, v13, v39
  v_mfma_f32_16x16x32_bf16 v[56:59], a[148:151], a[56:59], v[56:59]
  v_exp_f32 v26, v26
  v_fma_f32 v22, v22, v11, v11
  v_mfma_f32_16x16x32_bf16 v[60:63], a[148:151], a[60:63], v[60:63]
  ds_read_b64_tr_b16 a[174:175], v1 offset:53792
  v_exp_f32 v27, v27
  v_fma_f32 v23, v23, v11, v11
  v_mfma_f32_16x16x32_bf16 v[60:63], a[144:147], a[44:47], v[60:63]
  s_waitcnt lgkmcnt(11)
  v_exp_f32 v28, v28
  v_fma_f32 v24, v24, v11, v11
  v_mfma_f32_16x16x32_bf16 v[48:51], a[16:19], a[0:3], v[48:51]
  ds_read_b64_tr_b16 a[128:129], v2 offset:32
  v_exp_f32 v29, v29
  v_fma_f32 v25, v25, v11, v11
  v_mfma_f32_16x16x32_bf16 v[52:55], a[16:19], a[4:7], v[52:55]
  v_rcp_f32 v22, v22
  v_fma_f32 v26, v26, v14, v14
  v_mfma_f32_16x16x32_bf16 v[56:59], a[16:19], a[8:11], v[56:59]
  ds_read_b64_tr_b16 a[130:131], v2 offset:3616
  v_rcp_f32 v23, v23
  v_fma_f32 v27, v27, v14, v14
  v_mfma_f32_16x16x32_bf16 v[60:63], a[16:19], a[12:15], v[60:63]
  v_rcp_f32 v24, v24
  v_fma_f32 v28, v28, v14, v14
  v_mfma_f32_16x16x32_bf16 v[160:163], a[20:23], a[0:3], v[160:163]
  ds_read_b64_tr_b16 a[132:133], v2 offset:7200
  v_rcp_f32 v25, v25
  v_fma_f32 v29, v29, v14, v14
  v_mfma_f32_16x16x32_bf16 v[164:167], a[20:23], a[4:7], v[164:167]
  v_rcp_f32 v26, v26
  v_mul_f32 v144, v32, v144
  v_mfma_f32_16x16x32_bf16 v[168:171], a[20:23], a[8:11], v[168:171]
  ds_read_b64_tr_b16 a[134:135], v2 offset:10784
  v_rcp_f32 v27, v27
  v_mul_f32 v145, v33, v145
  v_mfma_f32_16x16x32_bf16 v[172:175], a[20:23], a[12:15], v[172:175]
  v_rcp_f32 v28, v28
  v_mul_f32 v146, v34, v146
  v_mfma_f32_16x16x32_bf16 v[172:175], a[152:155], a[44:47], v[172:175]
  ds_read_b64_tr_b16 a[136:137], v2 offset:14368
  v_rcp_f32 v29, v29
  v_mul_f32 v147, v35, v147
  v_mul_f32 v144, v144, v22
  v_mfma_f32_16x16x32_bf16 v[172:175], a[156:159], a[60:63], v[172:175]
  v_mul_f32 v145, v145, v23
  v_mul_f32 v146, v146, v24
  v_mul_f32 v147, v147, v25
  v_mul_f32 v22, v16, v40
  v_mfma_f32_16x16x32_bf16 v[168:171], a[156:159], a[56:59], v[168:171]
  ds_read_b64_tr_b16 a[138:139], v2 offset:17952
  v_mul_f32 v23, v16, v41
  v_mul_f32 v24, v16, v42
  v_mul_f32 v25, v16, v43
  v_mfma_f32_16x16x32_bf16 v[168:171], a[152:155], a[40:43], v[168:171]
  v_exp_f32 v22, v22
  v_mul_f32 v148, v36, v148
  v_mfma_f32_16x16x32_bf16 v[164:167], a[152:155], a[36:39], v[164:167]
  ds_read_b64_tr_b16 a[140:141], v2 offset:21536
  v_exp_f32 v23, v23
  v_mul_f32 v149, v37, v149
  v_mfma_f32_16x16x32_bf16 v[164:167], a[156:159], a[52:55], v[164:167]
  v_exp_f32 v24, v24
  v_mul_f32 v150, v38, v150
  v_mfma_f32_16x16x32_bf16 v[160:163], a[156:159], a[48:51], v[160:163]
  ds_read_b64_tr_b16 a[142:143], v2 offset:25120
  v_exp_f32 v25, v25
  v_mul_f32 v151, v39, v151
  v_mfma_f32_16x16x32_bf16 v[160:163], a[152:155], a[32:35], v[160:163]
  s_waitcnt lgkmcnt(8)
  v_mul_f32 v148, v148, v26
  v_mul_f32 v149, v149, v27
  v_mul_f32 v150, v150, v28
  v_mul_f32 v151, v151, v29
  v_mfma_f32_16x16x32_bf16 v[48:51], a[160:163], a[64:67], v[48:51]
  ds_read_b64_tr_b16 a[144:145], v1 offset:64
  v_cvt_pk_bf16_f32 v32, v144, v145
  v_cvt_pk_bf16_f32 v33, v146, v147
  v_mul_f32 v26, v19, v44
  v_mfma_f32_16x16x32_bf16 v[48:51], a[164:167], a[80:83], v[48:51]
  v_mul_f32 v27, v19, v45
  v_mul_f32 v28, v19, v46
  v_mul_f32 v29, v19, v47
  v_mfma_f32_16x16x32_bf16 v[52:55], a[164:167], a[84:87], v[52:55]
  ds_read_b64_tr_b16 a[146:147], v1 offset:3648
  v_exp_f32 v26, v26
  v_fma_f32 v22, v22, v17, v17
  v_mfma_f32_16x16x32_bf16 v[52:55], a[160:163], a[68:71], v[52:55]
  v_exp_f32 v27, v27
  v_fma_f32 v23, v23, v17, v17
  v_mfma_f32_16x16x32_bf16 v[56:59], a[160:163], a[72:75], v[56:59]
  ds_read_b64_tr_b16 a[148:149], v1 offset:7232
  v_exp_f32 v28, v28
  v_fma_f32 v24, v24, v17, v17
  v_mfma_f32_16x16x32_bf16 v[56:59], a[164:167], a[88:91], v[56:59]
  v_exp_f32 v29, v29
  v_fma_f32 v25, v25, v17, v17
  v_cvt_pk_bf16_f32 v36, v148, v149
  v_mfma_f32_16x16x32_bf16 v[60:63], a[164:167], a[92:95], v[60:63]
  ds_read_b64_tr_b16 a[150:151], v1 offset:10816
  v_cvt_pk_bf16_f32 v37, v150, v151
  v_rcp_f32 v22, v22
  v_mfma_f32_16x16x32_bf16 v[60:63], a[160:163], a[76:79], v[60:63]
  v_fma_f32 v26, v26, v20, v20
  v_rcp_f32 v23, v23
  v_fma_f32 v27, v27, v20, v20
  v_mfma_f32_16x16x32_bf16 v[172:175], a[168:171], a[76:79], v[172:175]
  v_rcp_f32 v24, v24
  v_fma_f32 v28, v28, v20, v20
  v_mfma_f32_16x16x32_bf16 v[172:175], a[172:175], a[92:95], v[172:175]
  v_rcp_f32 v25, v25
  v_fma_f32 v29, v29, v20, v20
  v_mfma_f32_16x16x32_bf16 v[168:171], a[172:175], a[88:91], v[168:171]
  v_rcp_f32 v26, v26
  v_mul_f32 v152, v40, v152
  v_mfma_f32_16x16x32_bf16 v[168:171], a[168:171], a[72:75], v[168:171]
  v_rcp_f32 v27, v27
  v_mul_f32 v153, v41, v153
  v_mfma_f32_16x16x32_bf16 v[164:167], a[168:171], a[68:71], v[164:167]
  v_rcp_f32 v28, v28
  v_mul_f32 v154, v42, v154
  v_mfma_f32_16x16x32_bf16 v[164:167], a[172:175], a[84:87], v[164:167]
  v_rcp_f32 v29, v29
  v_mul_f32 v155, v43, v155
  v_mul_f32 v152, v152, v22
  v_mfma_f32_16x16x32_bf16 v[160:163], a[172:175], a[80:83], v[160:163]
  v_mul_f32 v153, v153, v23
  v_mul_f32 v154, v154, v24
  v_mul_f32 v155, v155, v25
  v_mul_f32 v156, v44, v156
  v_mfma_f32_16x16x32_bf16 v[160:163], a[168:171], a[64:67], v[160:163]
  s_waitcnt lgkmcnt(4)
  v_mul_f32 v157, v45, v157
  v_mul_f32 v158, v46, v158
  v_mul_f32 v159, v47, v159
  v_cvt_pk_bf16_f32 v40, v152, v153
  v_mfma_f32_16x16x32_bf16 v[48:51], a[128:131], a[96:99], v[48:51]
  ds_read_b128 a[24:27], v31 offset:512
  v_cvt_pk_bf16_f32 v41, v154, v155
  v_mul_f32 v156, v156, v26
  v_mul_f32 v157, v157, v27
  v_mfma_f32_16x16x32_bf16 v[48:51], a[132:135], a[112:115], v[48:51]
  ds_read_b64_tr_b16 a[152:153], v1 offset:14400
  v_mul_f32 v158, v158, v28
  v_mul_f32 v159, v159, v29
  v_cvt_pk_bf16_f32 v44, v156, v157
  v_mfma_f32_16x16x32_bf16 v[52:55], a[132:135], a[116:119], v[52:55]
  ds_read_b128 a[28:31], v31 offset:2560
  v_cvt_pk_bf16_f32 v45, v158, v159
  v_mfma_f32_16x16x32_bf16 v[52:55], a[128:131], a[100:103], v[52:55]
  s_waitcnt vmcnt(0)
  s_barrier
  ds_read_b64_tr_b16 a[154:155], v1 offset:17984
  v_mfma_f32_16x16x32_bf16 v[56:59], a[128:131], a[104:107], v[56:59]
  s_mov_b64 exec, 1
  buffer_store_dword v9, v0, s[36:39], s45 offen sc1
  s_mov_b64 exec, -1
  s_add_u32 s45, s45, 32768
  v_mfma_f32_16x16x32_bf16 v[56:59], a[132:135], a[120:123], v[56:59]
  ds_read_b64_tr_b16 a[156:157], v1 offset:21568
  v_mfma_f32_16x16x32_bf16 v[60:63], a[132:135], a[124:127], v[60:63]
  ds_read_b64_tr_b16 a[158:159], v1 offset:25152
  v_mfma_f32_16x16x32_bf16 v[60:63], a[128:131], a[108:111], v[60:63]
  v_mfma_f32_16x16x32_bf16 v[172:175], a[136:139], a[108:111], v[172:175]
  ds_read_b64_tr_b16 a[160:161], v1 offset:28736
  v_mul_f32 v22, v10, v48
  v_mul_f32 v23, v10, v49
  v_mul_f32 v24, v10, v50
  v_mfma_f32_16x16x32_bf16 v[172:175], a[140:143], a[124:127], v[172:175]
Hc0_2:
  s_cbranch_execz Rc
  v_mul_f32 v25, v10, v51
  v_exp_f32 v22, v22
  v_mul_f32 v26, v13, v52
  v_mfma_f32_16x16x32_bf16 v[168:171], a[140:143], a[120:123], v[168:171]
  ds_read_b64_tr_b16 a[162:163], v1 offset:32320
  v_exp_f32 v23, v23
  v_mul_f32 v27, v13, v53
  v_mfma_f32_16x16x32_bf16 v[168:171], a[136:139], a[104:107], v[168:171]
  v_exp_f32 v24, v24
  v_mul_f32 v28, v13, v54
  v_mfma_f32_16x16x32_bf16 v[164:167], a[136:139], a[100:103], v[164:167]
  ds_read_b64_tr_b16 a[164:165], v1 offset:35904
  v_exp_f32 v25, v25
  v_mul_f32 v29, v13, v55
  v_mfma_f32_16x16x32_bf16 v[164:167], a[140:143], a[116:119], v[164:167]
  v_exp_f32 v26, v26
  v_fma_f32 v22, v22, v11, v11
  v_mfma_f32_16x16x32_bf16 v[160:163], a[140:143], a[112:115], v[160:163]
  ds_read_b64_tr_b16 a[166:167], v1 offset:39488
  v_exp_f32 v27, v27
  v_fma_f32 v23, v23, v11, v11
  v_mfma_f32_16x16x32_bf16 v[160:163], a[136:139], a[96:99], v[160:163]
  s_waitcnt lgkmcnt(4)
  v_exp_f32 v28, v28
  v_fma_f32 v24, v24, v11, v11
  v_mfma_f32_16x16x32_bf16 v[64:67], a[144:147], a[32:35], v[64:67]
  ds_read_b64_tr_b16 a[168:169], v1 offset:43072
  v_exp_f32 v29, v29
  v_fma_f32 v25, v25, v11, v11
  v_mfma_f32_16x16x32_bf16 v[64:67], a[148:151], a[48:51], v[64:67]
  v_rcp_f32 v22, v22
  v_fma_f32 v26, v26, v14, v14
  v_mfma_f32_16x16x32_bf16 v[68:71], a[148:151], a[52:55], v[68:71]
  ds_read_b64_tr_b16 a[170:171], v1 offset:46656
  v_rcp_f32 v23, v23
  v_fma_f32 v27, v27, v14, v14
  v_mfma_f32_16x16x32_bf16 v[68:71], a[144:147], a[36:39], v[68:71]
  v_rcp_f32 v24, v24
  v_fma_f32 v28, v28, v14, v14
  v_mfma_f32_16x16x32_bf16 v[72:75], a[144:147], a[40:43], v[72:75]
  ds_read_b64_tr_b16 a[172:173], v1 offset:50240
  v_rcp_f32 v25, v25
  v_fma_f32 v29, v29, v14, v14
  v_mfma_f32_16x16x32_bf16 v[72:75], a[148:151], a[56:59], v[72:75]
  v_rcp_f32 v26, v26
  v_mul_f32 v160, v48, v160
  v_mfma_f32_16x16x32_bf16 v[76:79], a[148:151], a[60:63], v[76:79]
  ds_read_b64_tr_b16 a[174:175], v1 offset:53824
  v_rcp_f32 v27, v27
  v_mul_f32 v161, v49, v161
  v_mfma_f32_16x16x32_bf16 v[76:79], a[144:147], a[44:47], v[76:79]
  s_waitcnt lgkmcnt(11)
  v_rcp_f32 v28, v28
  v_mul_f32 v162, v50, v162
  v_mfma_f32_16x16x32_bf16 v[64:67], a[24:27], a[0:3], v[64:67]
  ds_read_b64_tr_b16 a[128:129], v2 offset:64
  v_rcp_f32 v29, v29
  v_mul_f32 v163, v51, v163
  v_mfma_f32_16x16x32_bf16 v[68:71], a[24:27], a[4:7], v[68:71]
  v_mul_f32 v160, v160, v22
  v_mul_f32 v161, v161, v23
  v_mul_f32 v162, v162, v24
  v_mul_f32 v163, v163, v25
  v_mfma_f32_16x16x32_bf16 v[72:75], a[24:27], a[8:11], v[72:75]
  ds_read_b64_tr_b16 a[130:131], v2 offset:3648
  v_mul_f32 v22, v16, v56
  v_mul_f32 v23, v16, v57
  v_mul_f32 v24, v16, v58
  v_mfma_f32_16x16x32_bf16 v[76:79], a[24:27], a[12:15], v[76:79]
  v_mul_f32 v25, v16, v59
  v_exp_f32 v22, v22
  v_mul_f32 v164, v52, v164
  v_mfma_f32_16x16x32_bf16 v[176:179], a[28:31], a[0:3], v[176:179]
  ds_read_b64_tr_b16 a[132:133], v2 offset:7232
  v_exp_f32 v23, v23
  v_mul_f32 v165, v53, v165
  v_mfma_f32_16x16x32_bf16 v[180:183], a[28:31], a[4:7], v[180:183]
  v_exp_f32 v24, v24
  v_mul_f32 v166, v54, v166
  v_mfma_f32_16x16x32_bf16 v[184:187], a[28:31], a[8:11], v[184:187]
  ds_read_b64_tr_b16 a[134:135], v2 offset:10816
  v_exp_f32 v25, v25
  v_mul_f32 v167, v55, v167
  v_mfma_f32_16x16x32_bf16 v[188:191], a[28:31], a[12:15], v[188:191]
  v_mul_f32 v164, v164, v26
  v_mul_f32 v165, v165, v27
  v_mul_f32 v166, v166, v28
  v_mul_f32 v167, v167, v29
  v_mfma_f32_16x16x32_bf16 v[188:191], a[152:155], a[44:47], v[188:191]
  ds_read_b64_tr_b16 a[136:137], v2 offset:14400
  v_cvt_pk_bf16_f32 v34, v160, v161
  v_cvt_pk_bf16_f32 v35, v162, v163
  v_mfma_f32_16x16x32_bf16 v[188:191], a[156:159], a[60:63], v[188:191]
  buffer_store_dwordx4 v[32:35], v0, s[36:39], s65 offen offset:0 sc1
  v_mul_f32 v26, v19, v60
  v_mul_f32 v27, v19, v61
  v_mul_f32 v28, v19, v62
  v_mfma_f32_16x16x32_bf16 v[184:187], a[156:159], a[56:59], v[184:187]
  s_mov_b32 s69, 3
  s_lshl_b32 s50, s69, 16
  s_lshl1_add_u32 s50, s88, s50
  s_add_u32 m0, s70, 94208
  ds_read_b64_tr_b16 a[138:139], v2 offset:17984
  v_mfma_f32_16x16x32_bf16 v[184:187], a[152:155], a[40:43], v[184:187]
  v_mul_f32 v29, v19, v63
  v_exp_f32 v26, v26
  v_fma_f32 v22, v22, v17, v17
  v_mfma_f32_16x16x32_bf16 v[180:183], a[152:155], a[36:39], v[180:183]
  ds_read_b64_tr_b16 a[140:141], v2 offset:21568
  v_exp_f32 v27, v27
  v_fma_f32 v23, v23, v17, v17
  v_mfma_f32_16x16x32_bf16 v[180:183], a[156:159], a[52:55], v[180:183]
  v_exp_f32 v28, v28
  v_fma_f32 v24, v24, v17, v17
  v_mfma_f32_16x16x32_bf16 v[176:179], a[156:159], a[48:51], v[176:179]
  buffer_load_dwordx4 v133, s[24:27], s50 offen offset:0 lds
  v_exp_f32 v29, v29
  v_fma_f32 v25, v25, v17, v17
  v_mfma_f32_16x16x32_bf16 v[176:179], a[152:155], a[32:35], v[176:179]
  s_waitcnt lgkmcnt(7)
  ds_read_b64_tr_b16 a[142:143], v2 offset:25152
  v_cvt_pk_bf16_f32 v38, v164, v165
  v_cvt_pk_bf16_f32 v39, v166, v167
  v_mfma_f32_16x16x32_bf16 v[64:67], a[160:163], a[64:67], v[64:67]
  ds_read_b64_tr_b16 a[144:145], v1 offset:96
  v_mfma_f32_16x16x32_bf16 v[64:67], a[164:167], a[80:83], v[64:67]
  buffer_store_dwordx4 v[36:39], v0, s[36:39], s65 offen offset:1024 sc1
  v_rcp_f32 v22, v22
  v_fma_f32 v26, v26, v20, v20
  v_mfma_f32_16x16x32_bf16 v[68:71], a[164:167], a[84:87], v[68:71]
  ds_read_b64_tr_b16 a[146:147], v1 offset:3680
  v_rcp_f32 v23, v23
  v_fma_f32 v27, v27, v20, v20
  v_mfma_f32_16x16x32_bf16 v[68:71], a[160:163], a[68:71], v[68:71]
  buffer_load_dwordx4 v134, s[24:27], s50 offen offset:1024 lds
  v_rcp_f32 v24, v24
  v_fma_f32 v28, v28, v20, v20
  v_mfma_f32_16x16x32_bf16 v[72:75], a[160:163], a[72:75], v[72:75]
  ds_read_b64_tr_b16 a[148:149], v1 offset:7264
  v_rcp_f32 v25, v25
  v_fma_f32 v29, v29, v20, v20
  v_mfma_f32_16x16x32_bf16 v[72:75], a[164:167], a[88:91], v[72:75]
  v_rcp_f32 v26, v26
  v_mul_f32 v168, v56, v168
  v_mfma_f32_16x16x32_bf16 v[76:79], a[164:167], a[92:95], v[76:79]
  buffer_load_dwordx4 v135, s[24:27], s50 offen offset:2048 lds
  v_rcp_f32 v27, v27
  v_mul_f32 v169, v57, v169
  v_mfma_f32_16x16x32_bf16 v[76:79], a[160:163], a[76:79], v[76:79]
  ds_read_b64_tr_b16 a[150:151], v1 offset:10848
  v_rcp_f32 v28, v28
  v_mul_f32 v170, v58, v170
  v_mfma_f32_16x16x32_bf16 v[188:191], a[168:171], a[76:79], v[188:191]
  v_rcp_f32 v29, v29
  v_mul_f32 v171, v59, v171
  v_mul_f32 v168, v168, v22
  v_mfma_f32_16x16x32_bf16 v[188:191], a[172:175], a[92:95], v[188:191]
  v_mul_f32 v169, v169, v23
  v_mul_f32 v170, v170, v24
  v_mul_f32 v171, v171, v25
  v_mul_f32 v172, v60, v172
  v_mfma_f32_16x16x32_bf16 v[184:187], a[172:175], a[88:91], v[184:187]
  buffer_load_dwordx4 v136, s[24:27], s50 offen offset:3072 lds
  s_mov_b32 s71, 17
  s_lshl_b32 s50, s71, 16
  s_lshl1_add_u32 s50, s88, s50
  v_mfma_f32_16x16x32_bf16 v[184:187], a[168:171], a[72:75], v[184:187]
  s_add_u32 m0, s70, 110592
  v_mul_f32 v173, v61, v173
  v_mul_f32 v174, v62, v174
  v_mul_f32 v175, v63, v175
  v_cvt_pk_bf16_f32 v42, v168, v169
  v_mfma_f32_16x16x32_bf16 v[180:183], a[168:171], a[68:71], v[180:183]
  v_cvt_pk_bf16_f32 v43, v170, v171
  v_mfma_f32_16x16x32_bf16 v[180:183], a[172:175], a[84:87], v[180:183]
  buffer_store_dwordx4 v[40:43], v0, s[36:39], s66 offen offset:0 sc1
  v_mul_f32 v172, v172, v26
  v_mul_f32 v173, v173, v27
  v_mul_f32 v174, v174, v28
  v_mfma_f32_16x16x32_bf16 v[176:179], a[172:175], a[80:83], v[176:179]
  v_mul_f32 v175, v175, v29
  v_cvt_pk_bf16_f32 v46, v172, v173
  v_cvt_pk_bf16_f32 v47, v174, v175
  v_mfma_f32_16x16x32_bf16 v[176:179], a[168:171], a[64:67], v[176:179]
  s_waitcnt lgkmcnt(4)
  buffer_load_dwordx4 v133, s[24:27], s50 offen offset:0 lds
  v_mfma_f32_16x16x32_bf16 v[64:67], a[128:131], a[96:99], v[64:67]
  ds_read_b128 a[16:19], v31 offset:768
  v_mfma_f32_16x16x32_bf16 v[64:67], a[132:135], a[112:115], v[64:67]
  ds_read_b64_tr_b16 a[152:153], v1 offset:14432
  v_mfma_f32_16x16x32_bf16 v[68:71], a[132:135], a[116:119], v[68:71]
  ds_read_b128 a[20:23], v31 offset:2816
  v_mfma_f32_16x16x32_bf16 v[68:71], a[128:131], a[100:103], v[68:71]
  buffer_load_dwordx4 v134, s[24:27], s50 offen offset:1024 lds
  v_mfma_f32_16x16x32_bf16 v[72:75], a[128:131], a[104:107], v[72:75]
  ds_read_b64_tr_b16 a[154:155], v1 offset:18016
  v_mfma_f32_16x16x32_bf16 v[72:75], a[132:135], a[120:123], v[72:75]
  ds_read_b64_tr_b16 a[156:157], v1 offset:21600
  v_mfma_f32_16x16x32_bf16 v[76:79], a[132:135], a[124:127], v[76:79]
  buffer_store_dwordx4 v[44:47], v0, s[36:39], s66 offen offset:1024 sc1
  s_add_u32 s65, s65, 2048
  s_add_u32 s66, s66, 2048
  v_mfma_f32_16x16x32_bf16 v[76:79], a[128:131], a[108:111], v[76:79]
  ds_read_b64_tr_b16 a[158:159], v1 offset:25184
  v_mfma_f32_16x16x32_bf16 v[188:191], a[136:139], a[108:111], v[188:191]
  buffer_load_dwordx4 v135, s[24:27], s50 offen offset:2048 lds
  v_mul_f32 v22, v10, v64
  v_mul_f32 v23, v10, v65
  v_mul_f32 v24, v10, v66
  v_mfma_f32_16x16x32_bf16 v[188:191], a[140:143], a[124:127], v[188:191]
  ds_read_b64_tr_b16 a[160:161], v1 offset:28768
  v_mul_f32 v25, v10, v67
  v_exp_f32 v22, v22
  v_mfma_f32_16x16x32_bf16 v[184:187], a[140:143], a[120:123], v[184:187]
  buffer_load_dwordx4 v136, s[24:27], s50 offen offset:3072 lds
  s_mov_b32 s72, 31
  s_lshl_b32 s50, s72, 16
  s_lshl1_add_u32 s50, s88, s50
  v_mfma_f32_16x16x32_bf16 v[184:187], a[136:139], a[104:107], v[184:187]
  s_add_u32 m0, s70, 126976
  ds_read_b64_tr_b16 a[162:163], v1 offset:32352
  v_mul_f32 v26, v13, v68
  v_exp_f32 v23, v23
  v_mfma_f32_16x16x32_bf16 v[180:183], a[136:139], a[100:103], v[180:183]
  ds_read_b64_tr_b16 a[164:165], v1 offset:35936
  v_mul_f32 v27, v13, v69
  v_exp_f32 v24, v24
  v_mfma_f32_16x16x32_bf16 v[180:183], a[140:143], a[116:119], v[180:183]
  v_mul_f32 v28, v13, v70
  v_exp_f32 v25, v25
  v_mul_f32 v29, v13, v71
  v_mfma_f32_16x16x32_bf16 v[176:179], a[140:143], a[112:115], v[176:179]
  buffer_load_dwordx4 v133, s[24:27], s50 offen offset:0 lds
  v_exp_f32 v26, v26
  v_fma_f32 v22, v22, v11, v11
  v_mfma_f32_16x16x32_bf16 v[176:179], a[136:139], a[96:99], v[176:179]
  s_waitcnt lgkmcnt(3)
  ds_read_b64_tr_b16 a[166:167], v1 offset:39520
  v_exp_f32 v27, v27
  v_fma_f32 v23, v23, v11, v11
  v_mfma_f32_16x16x32_bf16 v[80:83], a[144:147], a[32:35], v[80:83]
  ds_read_b64_tr_b16 a[168:169], v1 offset:43104
  v_exp_f32 v28, v28
  v_fma_f32 v24, v24, v11, v11
  v_mfma_f32_16x16x32_bf16 v[80:83], a[148:151], a[48:51], v[80:83]
  v_exp_f32 v29, v29
  v_fma_f32 v25, v25, v11, v11
  v_mfma_f32_16x16x32_bf16 v[84:87], a[148:151], a[52:55], v[84:87]
  buffer_load_dwordx4 v134, s[24:27], s50 offen offset:1024 lds
  v_rcp_f32 v22, v22
  v_fma_f32 v26, v26, v14, v14
  v_mfma_f32_16x16x32_bf16 v[84:87], a[144:147], a[36:39], v[84:87]
  ds_read_b64_tr_b16 a[170:171], v1 offset:46688
  v_rcp_f32 v23, v23
  v_fma_f32 v27, v27, v14, v14
  v_mfma_f32_16x16x32_bf16 v[88:91], a[144:147], a[40:43], v[88:91]
  ds_read_b64_tr_b16 a[172:173], v1 offset:50272
  v_rcp_f32 v24, v24
  v_fma_f32 v28, v28, v14, v14
  v_mfma_f32_16x16x32_bf16 v[88:91], a[148:151], a[56:59], v[88:91]
  v_rcp_f32 v25, v25
  v_fma_f32 v29, v29, v14, v14
  v_mfma_f32_16x16x32_bf16 v[92:95], a[148:151], a[60:63], v[92:95]
  buffer_load_dwordx4 v135, s[24:27], s50 offen offset:2048 lds
  v_rcp_f32 v26, v26
  v_mul_f32 v176, v64, v176
  v_mfma_f32_16x16x32_bf16 v[92:95], a[144:147], a[44:47], v[92:95]
  s_waitcnt lgkmcnt(10)
  ds_read_b64_tr_b16 a[174:175], v1 offset:53856
  v_rcp_f32 v27, v27
  v_mul_f32 v177, v65, v177
  v_mfma_f32_16x16x32_bf16 v[80:83], a[16:19], a[0:3], v[80:83]
  ds_read_b64_tr_b16 a[128:129], v2 offset:96
  v_rcp_f32 v28, v28
  v_mul_f32 v178, v66, v178
  v_mfma_f32_16x16x32_bf16 v[84:87], a[16:19], a[4:7], v[84:87]
  v_rcp_f32 v29, v29
  v_mul_f32 v179, v67, v179
  v_mul_f32 v176, v176, v22
  v_mfma_f32_16x16x32_bf16 v[88:91], a[16:19], a[8:11], v[88:91]
  buffer_load_dwordx4 v136, s[24:27], s50 offen offset:3072 lds
  s_mov_b32 s73, 45
  s_lshl_b32 s50, s73, 16
  s_lshl1_add_u32 s50, s88, s50
  v_mfma_f32_16x16x32_bf16 v[92:95], a[16:19], a[12:15], v[92:95]
  s_add_u32 m0, s70, 143360
  ds_read_b64_tr_b16 a[130:131], v2 offset:3680
  v_mul_f32 v177, v177, v23
  v_mul_f32 v178, v178, v24
  v_mul_f32 v179, v179, v25
  v_mfma_f32_16x16x32_bf16 v[192:195], a[20:23], a[0:3], v[192:195]
  ds_read_b64_tr_b16 a[132:133], v2 offset:7264
  v_mul_f32 v22, v16, v72
  v_mul_f32 v23, v16, v73
  v_mul_f32 v24, v16, v74
  v_mfma_f32_16x16x32_bf16 v[196:199], a[20:23], a[4:7], v[196:199]
  v_mul_f32 v25, v16, v75
  v_exp_f32 v22, v22
  v_mul_f32 v180, v68, v180
  v_mfma_f32_16x16x32_bf16 v[200:203], a[20:23], a[8:11], v[200:203]
  buffer_load_dwordx4 v133, s[24:27], s50 offen offset:0 lds
  v_exp_f32 v23, v23
  v_mul_f32 v181, v69, v181
  v_mfma_f32_16x16x32_bf16 v[204:207], a[20:23], a[12:15], v[204:207]
  ds_read_b64_tr_b16 a[134:135], v2 offset:10848
  v_exp_f32 v24, v24
  v_mul_f32 v182, v70, v182
  v_mfma_f32_16x16x32_bf16 v[204:207], a[152:155], a[44:47], v[204:207]
  ds_read_b64_tr_b16 a[136:137], v2 offset:14432
  v_exp_f32 v25, v25
  v_mul_f32 v183, v71, v183
  v_mfma_f32_16x16x32_bf16 v[204:207], a[156:159], a[60:63], v[204:207]
  v_mul_f32 v180, v180, v26
  v_mul_f32 v181, v181, v27
  v_mul_f32 v182, v182, v28
  v_mul_f32 v183, v183, v29
  v_mfma_f32_16x16x32_bf16 v[200:203], a[156:159], a[56:59], v[200:203]
  buffer_load_dwordx4 v134, s[24:27], s50 offen offset:1024 lds
  v_cvt_pk_bf16_f32 v64, v176, v177
  v_cvt_pk_bf16_f32 v65, v178, v179
  v_mul_f32 v26, v19, v76
  v_mfma_f32_16x16x32_bf16 v[200:203], a[152:155], a[40:43], v[200:203]
  ds_read_b64_tr_b16 a[138:139], v2 offset:18016
  v_mul_f32 v27, v19, v77
  v_mul_f32 v28, v19, v78
  v_mul_f32 v29, v19, v79
  v_mfma_f32_16x16x32_bf16 v[196:199], a[152:155], a[36:39], v[196:199]
  ds_read_b64_tr_b16 a[140:141], v2 offset:21600
  v_exp_f32 v26, v26
  v_fma_f32 v22, v22, v17, v17
  v_mfma_f32_16x16x32_bf16 v[196:199], a[156:159], a[52:55], v[196:199]
  v_exp_f32 v27, v27
  v_fma_f32 v23, v23, v17, v17
  v_mfma_f32_16x16x32_bf16 v[192:195], a[156:159], a[48:51], v[192:195]
  buffer_load_dwordx4 v135, s[24:27], s50 offen offset:2048 lds
  v_exp_f32 v28, v28
  v_fma_f32 v24, v24, v17, v17
  v_mfma_f32_16x16x32_bf16 v[192:195], a[152:155], a[32:35], v[192:195]
  s_waitcnt lgkmcnt(7)
  ds_read_b64_tr_b16 a[142:143], v2 offset:25184
  v_exp_f32 v29, v29
  v_fma_f32 v25, v25, v17, v17
  v_mfma_f32_16x16x32_bf16 v[80:83], a[160:163], a[64:67], v[80:83]
  ds_read_b64_tr_b16 a[144:145], v1 offset:128
  v_cvt_pk_bf16_f32 v68, v180, v181
  v_cvt_pk_bf16_f32 v69, v182, v183
  v_mfma_f32_16x16x32_bf16 v[80:83], a[164:167], a[80:83], v[80:83]
  v_rcp_f32 v22, v22
  v_fma_f32 v26, v26, v20, v20
  v_mfma_f32_16x16x32_bf16 v[84:87], a[164:167], a[84:87], v[84:87]
  buffer_load_dwordx4 v136, s[24:27], s50 offen offset:3072 lds
  v_rcp_f32 v23, v23
  v_fma_f32 v27, v27, v20, v20
  v_mfma_f32_16x16x32_bf16 v[84:87], a[160:163], a[68:71], v[84:87]
  ds_read_b64_tr_b16 a[146:147], v1 offset:3712
  v_rcp_f32 v24, v24
  v_fma_f32 v28, v28, v20, v20
  v_mfma_f32_16x16x32_bf16 v[88:91], a[160:163], a[72:75], v[88:91]
  ds_read_b64_tr_b16 a[148:149], v1 offset:7296
  v_rcp_f32 v25, v25
  v_fma_f32 v29, v29, v20, v20
  v_mfma_f32_16x16x32_bf16 v[88:91], a[164:167], a[88:91], v[88:91]
  v_rcp_f32 v26, v26
  v_mul_f32 v184, v72, v184
  v_mfma_f32_16x16x32_bf16 v[92:95], a[164:167], a[92:95], v[92:95]
  ds_read_b64_tr_b16 a[150:151], v1 offset:10880
  v_rcp_f32 v27, v27
  v_mul_f32 v185, v73, v185
  v_mfma_f32_16x16x32_bf16 v[92:95], a[160:163], a[76:79], v[92:95]
  v_rcp_f32 v28, v28
  v_mul_f32 v186, v74, v186
  v_mfma_f32_16x16x32_bf16 v[204:207], a[168:171], a[76:79], v[204:207]
  v_rcp_f32 v29, v29
  v_mul_f32 v187, v75, v187
  v_mul_f32 v184, v184, v22
  v_mfma_f32_16x16x32_bf16 v[204:207], a[172:175], a[92:95], v[204:207]
  v_mul_f32 v185, v185, v23
  v_mul_f32 v186, v186, v24
  v_mul_f32 v187, v187, v25
  v_mul_f32 v188, v76, v188
  v_mfma_f32_16x16x32_bf16 v[200:203], a[172:175], a[88:91], v[200:203]
  v_mul_f32 v189, v77, v189
  v_mul_f32 v190, v78, v190
  v_mul_f32 v191, v79, v191
  v_cvt_pk_bf16_f32 v72, v184, v185
  v_mfma_f32_16x16x32_bf16 v[200:203], a[168:171], a[72:75], v[200:203]
  v_cvt_pk_bf16_f32 v73, v186, v187
  v_mul_f32 v188, v188, v26
  v_mul_f32 v189, v189, v27
  v_mul_f32 v190, v190, v28
  v_mfma_f32_16x16x32_bf16 v[196:199], a[168:171], a[68:71], v[196:199]
  v_mul_f32 v191, v191, v29
  v_cvt_pk_bf16_f32 v76, v188, v189
  v_cvt_pk_bf16_f32 v77, v190, v191
  v_mfma_f32_16x16x32_bf16 v[196:199], a[172:175], a[84:87], v[196:199]
  v_mfma_f32_16x16x32_bf16 v[192:195], a[172:175], a[80:83], v[192:195]
  buffer_load_dword v139, v138, s[36:39], s91 offen sc1
  v_mfma_f32_16x16x32_bf16 v[192:195], a[168:171], a[64:67], v[192:195]
  s_waitcnt lgkmcnt(4)
  v_mfma_f32_16x16x32_bf16 v[80:83], a[128:131], a[96:99], v[80:83]
  ds_read_b128 a[24:27], v31 offset:1024
  v_mfma_f32_16x16x32_bf16 v[80:83], a[132:135], a[112:115], v[80:83]
  ds_read_b64_tr_b16 a[152:153], v1 offset:14464
  v_mfma_f32_16x16x32_bf16 v[84:87], a[132:135], a[116:119], v[84:87]
  ds_read_b128 a[28:31], v31 offset:3072
  v_mfma_f32_16x16x32_bf16 v[84:87], a[128:131], a[100:103], v[84:87]
  ds_read_b64_tr_b16 a[154:155], v1 offset:18048
  v_mfma_f32_16x16x32_bf16 v[88:91], a[128:131], a[104:107], v[88:91]
  ds_read_b64_tr_b16 a[156:157], v1 offset:21632
  v_mfma_f32_16x16x32_bf16 v[88:91], a[132:135], a[120:123], v[88:91]
  v_mfma_f32_16x16x32_bf16 v[92:95], a[132:135], a[124:127], v[92:95]
  ds_read_b64_tr_b16 a[158:159], v1 offset:25216
  v_mfma_f32_16x16x32_bf16 v[92:95], a[128:131], a[108:111], v[92:95]
  v_mfma_f32_16x16x32_bf16 v[204:207], a[136:139], a[108:111], v[204:207]
  ds_read_b64_tr_b16 a[160:161], v1 offset:28800
  v_mul_f32 v22, v10, v80
  v_mul_f32 v23, v10, v81
  v_mul_f32 v24, v10, v82
  v_mfma_f32_16x16x32_bf16 v[204:207], a[140:143], a[124:127], v[204:207]
  v_mul_f32 v25, v10, v83
  v_exp_f32 v22, v22
  v_mul_f32 v26, v13, v84
  v_mfma_f32_16x16x32_bf16 v[200:203], a[140:143], a[120:123], v[200:203]
  ds_read_b64_tr_b16 a[162:163], v1 offset:32384
  v_exp_f32 v23, v23
  v_mul_f32 v27, v13, v85
  v_mfma_f32_16x16x32_bf16 v[200:203], a[136:139], a[104:107], v[200:203]
  s_waitcnt vmcnt(11)
  s_barrier
  v_exp_f32 v24, v24
  v_mul_f32 v28, v13, v86
  v_mfma_f32_16x16x32_bf16 v[196:199], a[136:139], a[100:103], v[196:199]
  s_mov_b64 exec, 1
  buffer_store_dword v9, v0, s[36:39], s45 offen sc1
  s_mov_b64 exec, -1
  s_add_u32 s45, s45, 32768
  v_mfma_f32_16x16x32_bf16 v[196:199], a[140:143], a[116:119], v[196:199]
  ds_read_b64_tr_b16 a[164:165], v1 offset:35968
  v_exp_f32 v25, v25
  v_mul_f32 v29, v13, v87
  v_mfma_f32_16x16x32_bf16 v[192:195], a[140:143], a[112:115], v[192:195]
  ds_read_b64_tr_b16 a[166:167], v1 offset:39552
  v_exp_f32 v26, v26
  v_fma_f32 v22, v22, v11, v11
  v_mfma_f32_16x16x32_bf16 v[192:195], a[136:139], a[96:99], v[192:195]
  s_waitcnt lgkmcnt(4)
  v_exp_f32 v27, v27
  v_fma_f32 v23, v23, v11, v11
  v_mfma_f32_16x16x32_bf16 v[96:99], a[144:147], a[32:35], v[96:99]
  ds_read_b64_tr_b16 a[168:169], v1 offset:43136
  v_exp_f32 v28, v28
  v_fma_f32 v24, v24, v11, v11
  v_mfma_f32_16x16x32_bf16 v[96:99], a[148:151], a[48:51], v[96:99]
  v_exp_f32 v29, v29
  v_fma_f32 v25, v25, v11, v11
  v_mfma_f32_16x16x32_bf16 v[100:103], a[148:151], a[52:55], v[100:103]
  ds_read_b64_tr_b16 a[170:171], v1 offset:46720
  v_rcp_f32 v22, v22
  v_fma_f32 v26, v26, v14, v14
  v_mfma_f32_16x16x32_bf16 v[100:103], a[144:147], a[36:39], v[100:103]
  v_rcp_f32 v23, v23
  v_fma_f32 v27, v27, v14, v14
  v_mfma_f32_16x16x32_bf16 v[104:107], a[144:147], a[40:43], v[104:107]
  ds_read_b64_tr_b16 a[172:173], v1 offset:50304
  v_rcp_f32 v24, v24
  v_fma_f32 v28, v28, v14, v14
  v_mfma_f32_16x16x32_bf16 v[104:107], a[148:151], a[56:59], v[104:107]
  v_rcp_f32 v25, v25
  v_fma_f32 v29, v29, v14, v14
  v_mfma_f32_16x16x32_bf16 v[108:111], a[148:151], a[60:63], v[108:111]
  ds_read_b64_tr_b16 a[174:175], v1 offset:53888
  v_rcp_f32 v26, v26
  v_mul_f32 v192, v80, v192
  v_mfma_f32_16x16x32_bf16 v[108:111], a[144:147], a[44:47], v[108:111]
  s_waitcnt lgkmcnt(11)
  v_rcp_f32 v27, v27
  v_mul_f32 v193, v81, v193
  v_mfma_f32_16x16x32_bf16 v[96:99], a[24:27], a[0:3], v[96:99]
  ds_read_b64_tr_b16 a[128:129], v2 offset:128
  v_rcp_f32 v28, v28
  v_mul_f32 v194, v82, v194
  v_mfma_f32_16x16x32_bf16 v[100:103], a[24:27], a[4:7], v[100:103]
  v_rcp_f32 v29, v29
  v_mul_f32 v195, v83, v195
  v_mul_f32 v192, v192, v22
  v_mfma_f32_16x16x32_bf16 v[104:107], a[24:27], a[8:11], v[104:107]
  ds_read_b64_tr_b16 a[130:131], v2 offset:3712
  v_mul_f32 v193, v193, v23
  v_mul_f32 v194, v194, v24
  v_mul_f32 v195, v195, v25
  v_mfma_f32_16x16x32_bf16 v[108:111], a[24:27], a[12:15], v[108:111]
  v_mul_f32 v22, v16, v88
  v_mul_f32 v23, v16, v89
  v_mul_f32 v24, v16, v90
  v_mul_f32 v25, v16, v91
  v_mfma_f32_16x16x32_bf16 v[208:211], a[28:31], a[0:3], v[208:211]
  ds_read_b64_tr_b16 a[132:133], v2 offset:7296
  v_exp_f32 v22, v22
  v_mul_f32 v196, v84, v196
  v_mfma_f32_16x16x32_bf16 v[212:215], a[28:31], a[4:7], v[212:215]
  v_exp_f32 v23, v23
  v_mul_f32 v197, v85, v197
  v_mfma_f32_16x16x32_bf16 v[216:219], a[28:31], a[8:11], v[216:219]
  s_waitcnt vmcnt(1)
  v_cmp_ne_u32 vcc, s3, v139
  s_nop 4
  s_cbranch_vccnz CK9s
CK9x:
  v_mfma_f32_16x16x32_bf16 v[220:223], a[28:31], a[12:15], v[220:223]
  s_lshl_b32 s51, s69, 11
  s_add_u32 s91, s91, 32768
  ds_read_b64_tr_b16 a[134:135], v2 offset:10880
  v_exp_f32 v24, v24
  v_mfma_f32_16x16x32_bf16 v[220:223], a[152:155], a[44:47], v[220:223]
  buffer_load_dwordx2 a[216:217], v7, s[36:39], s51 offen offset:0 sc1
  v_mul_f32 v198, v86, v198
  v_exp_f32 v25, v25
  v_mfma_f32_16x16x32_bf16 v[220:223], a[156:159], a[60:63], v[220:223]
  ds_read_b64_tr_b16 a[136:137], v2 offset:14464
  v_mul_f32 v199, v87, v199
  v_mul_f32 v196, v196, v26
  v_mul_f32 v197, v197, v27
  v_mfma_f32_16x16x32_bf16 v[216:219], a[156:159], a[56:59], v[216:219]
  buffer_load_dwordx2 a[218:219], v7, s[36:39], s51 offen offset:512 sc1
  v_mul_f32 v198, v198, v28
  v_mul_f32 v199, v199, v29
  v_cvt_pk_bf16_f32 v66, v192, v193
  v_mfma_f32_16x16x32_bf16 v[216:219], a[152:155], a[40:43], v[216:219]
  ds_read_b64_tr_b16 a[138:139], v2 offset:18048
  v_cvt_pk_bf16_f32 v67, v194, v195
  v_mfma_f32_16x16x32_bf16 v[212:215], a[152:155], a[36:39], v[212:215]
  buffer_load_dwordx2 a[220:221], v7, s[36:39], s51 offen offset:1024 sc1
  v_mfma_f32_16x16x32_bf16 v[212:215], a[156:159], a[52:55], v[212:215]
  ds_read_b64_tr_b16 a[140:141], v2 offset:21632
  v_mfma_f32_16x16x32_bf16 v[208:211], a[156:159], a[48:51], v[208:211]
  buffer_load_dwordx2 a[222:223], v7, s[36:39], s51 offen offset:1536 sc1
  s_add_u32 s51, s51, 12288
  v_mfma_f32_16x16x32_bf16 v[208:211], a[152:155], a[32:35], v[208:211]
  s_waitcnt lgkmcnt(7)
  ds_read_b64_tr_b16 a[142:143], v2 offset:25216
  v_mfma_f32_16x16x32_bf16 v[96:99], a[160:163], a[64:67], v[96:99]
  buffer_load_dwordx2 a[224:225], v7, s[36:39], s51 offen offset:2048 sc1
  v_mfma_f32_16x16x32_bf16 v[96:99], a[164:167], a[80:83], v[96:99]
  ds_read_b64_tr_b16 a[144:145], v1 offset:160
  v_mfma_f32_16x16x32_bf16 v[100:103], a[164:167], a[84:87], v[100:103]
  buffer_load_dwordx2 a[226:227], v7, s[36:39], s51 offen offset:2560 sc1
  v_mfma_f32_16x16x32_bf16 v[100:103], a[160:163], a[68:71], v[100:103]
  ds_read_b64_tr_b16 a[146:147], v1 offset:3744
  v_mfma_f32_16x16x32_bf16 v[104:107], a[160:163], a[72:75], v[104:107]
  buffer_load_dwordx2 a[228:229], v7, s[36:39], s51 offen offset:3072 sc1
  v_mfma_f32_16x16x32_bf16 v[104:107], a[164:167], a[88:91], v[104:107]
  ds_read_b64_tr_b16 a[148:149], v1 offset:7328
  v_mfma_f32_16x16x32_bf16 v[108:111], a[164:167], a[92:95], v[108:111]
  buffer_load_dwordx2 a[230:231], v7, s[36:39], s51 offen offset:3584 sc1
  s_lshl_b32 s51, s71, 11
  v_mfma_f32_16x16x32_bf16 v[108:111], a[160:163], a[76:79], v[108:111]
  ds_read_b64_tr_b16 a[150:151], v1 offset:10912
  v_mfma_f32_16x16x32_bf16 v[220:223], a[168:171], a[76:79], v[220:223]
  buffer_load_dwordx2 v[176:177], v7, s[36:39], s51 offen offset:0 sc1
  v_mfma_f32_16x16x32_bf16 v[220:223], a[172:175], a[92:95], v[220:223]
  v_mfma_f32_16x16x32_bf16 v[216:219], a[172:175], a[88:91], v[216:219]
  buffer_load_dwordx2 v[178:179], v7, s[36:39], s51 offen offset:512 sc1
  v_mfma_f32_16x16x32_bf16 v[216:219], a[168:171], a[72:75], v[216:219]
  v_mfma_f32_16x16x32_bf16 v[212:215], a[168:171], a[68:71], v[212:215]
  buffer_load_dwordx2 v[180:181], v7, s[36:39], s51 offen offset:1024 sc1
  v_mfma_f32_16x16x32_bf16 v[212:215], a[172:175], a[84:87], v[212:215]
  v_mfma_f32_16x16x32_bf16 v[208:211], a[172:175], a[80:83], v[208:211]
  buffer_load_dwordx2 v[182:183], v7, s[36:39], s51 offen offset:1536 sc1
  s_add_u32 s51, s51, 12288
  v_mfma_f32_16x16x32_bf16 v[208:211], a[168:171], a[64:67], v[208:211]
  s_waitcnt lgkmcnt(4)
  v_mfma_f32_16x16x32_bf16 v[96:99], a[128:131], a[96:99], v[96:99]
  buffer_load_dwordx2 v[184:185], v7, s[36:39], s51 offen offset:2048 sc1
  v_mfma_f32_16x16x32_bf16 v[96:99], a[132:135], a[112:115], v[96:99]
  ds_read_b128 a[16:19], v31 offset:1280
  v_mfma_f32_16x16x32_bf16 v[100:103], a[132:135], a[116:119], v[100:103]
  buffer_load_dwordx2 v[186:187], v7, s[36:39], s51 offen offset:2560 sc1
  v_mfma_f32_16x16x32_bf16 v[100:103], a[128:131], a[100:103], v[100:103]
  ds_read_b64_tr_b16 a[152:153], v1 offset:14496
  v_mfma_f32_16x16x32_bf16 v[104:107], a[128:131], a[104:107], v[104:107]
  buffer_load_dwordx2 v[188:189], v7, s[36:39], s51 offen offset:3072 sc1
  v_mfma_f32_16x16x32_bf16 v[104:107], a[132:135], a[120:123], v[104:107]
  ds_read_b128 a[20:23], v31 offset:3328
  v_mfma_f32_16x16x32_bf16 v[108:111], a[132:135], a[124:127], v[108:111]
  buffer_load_dwordx2 v[190:191], v7, s[36:39], s51 offen offset:3584 sc1
  v_mfma_f32_16x16x32_bf16 v[108:111], a[128:131], a[108:111], v[108:111]
  ds_read_b64_tr_b16 a[154:155], v1 offset:18080
  v_mfma_f32_16x16x32_bf16 v[220:223], a[136:139], a[108:111], v[220:223]
  ds_read_b64_tr_b16 a[156:157], v1 offset:21664
  v_mfma_f32_16x16x32_bf16 v[220:223], a[140:143], a[124:127], v[220:223]
  ds_read_b64_tr_b16 a[158:159], v1 offset:25248
  v_mfma_f32_16x16x32_bf16 v[216:219], a[140:143], a[120:123], v[216:219]
  ds_read_b64_tr_b16 a[160:161], v1 offset:28832
  v_mfma_f32_16x16x32_bf16 v[216:219], a[136:139], a[104:107], v[216:219]
  ds_read_b64_tr_b16 a[162:163], v1 offset:32416
  v_mfma_f32_16x16x32_bf16 v[212:215], a[136:139], a[100:103], v[212:215]
  ds_read_b64_tr_b16 a[164:165], v1 offset:36000
  v_mfma_f32_16x16x32_bf16 v[212:215], a[140:143], a[116:119], v[212:215]
  buffer_store_dwordx4 v[64:67], v0, s[36:39], s65 offen offset:0 sc1
  v_mul_f32 v26, v19, v92
  v_mul_f32 v27, v19, v93
  v_mul_f32 v28, v19, v94
  v_mfma_f32_16x16x32_bf16 v[208:211], a[140:143], a[112:115], v[208:211]
  ds_read_b64_tr_b16 a[166:167], v1 offset:39584
  v_mul_f32 v29, v19, v95
  v_exp_f32 v26, v26
  v_mfma_f32_16x16x32_bf16 v[208:211], a[136:139], a[96:99], v[208:211]
  s_waitcnt lgkmcnt(4)
  v_fma_f32 v22, v22, v17, v17
  v_exp_f32 v27, v27
  v_fma_f32 v23, v23, v17, v17
  v_mfma_f32_16x16x32_bf16 v[112:115], a[144:147], a[32:35], v[112:115]
  ds_read_b64_tr_b16 a[168:169], v1 offset:43168
  v_exp_f32 v28, v28
  v_fma_f32 v24, v24, v17, v17
  v_mfma_f32_16x16x32_bf16 v[112:115], a[148:151], a[48:51], v[112:115]
  v_exp_f32 v29, v29
  v_fma_f32 v25, v25, v17, v17
  v_cvt_pk_bf16_f32 v70, v196, v197
  v_mfma_f32_16x16x32_bf16 v[116:119], a[148:151], a[52:55], v[116:119]
  ds_read_b64_tr_b16 a[170:171], v1 offset:46752
  v_cvt_pk_bf16_f32 v71, v198, v199
  v_mfma_f32_16x16x32_bf16 v[116:119], a[144:147], a[36:39], v[116:119]
  buffer_store_dwordx4 v[68:71], v0, s[36:39], s65 offen offset:1024 sc1
  v_rcp_f32 v22, v22
  v_fma_f32 v26, v26, v20, v20
  v_mfma_f32_16x16x32_bf16 v[120:123], a[144:147], a[40:43], v[120:123]
  ds_read_b64_tr_b16 a[172:173], v1 offset:50336
  v_rcp_f32 v23, v23
  v_fma_f32 v27, v27, v20, v20
  v_mfma_f32_16x16x32_bf16 v[120:123], a[148:151], a[56:59], v[120:123]
  v_rcp_f32 v24, v24
  v_fma_f32 v28, v28, v20, v20
  v_mfma_f32_16x16x32_bf16 v[124:127], a[148:151], a[60:63], v[124:127]
  ds_read_b64_tr_b16 a[174:175], v1 offset:53920
  v_rcp_f32 v25, v25
  v_fma_f32 v29, v29, v20, v20
  v_mfma_f32_16x16x32_bf16 v[124:127], a[144:147], a[44:47], v[124:127]
  s_waitcnt lgkmcnt(11)
  v_rcp_f32 v26, v26
  v_mul_f32 v200, v88, v200
  v_mfma_f32_16x16x32_bf16 v[112:115], a[16:19], a[0:3], v[112:115]
Hc1_2:
  s_cbranch_execz Rc
  v_rcp_f32 v27, v27
  v_mul_f32 v201, v89, v201
  v_rcp_f32 v28, v28
  v_mul_f32 v202, v90, v202
  v_rcp_f32 v29, v29
  v_mul_f32 v203, v91, v203
  v_mul_f32 v200, v200, v22
  v_mul_f32 v201, v201, v23
  v_mul_f32 v202, v202, v24
  v_mul_f32 v203, v203, v25
  v_mul_f32 v204, v92, v204
  v_mul_f32 v205, v93, v205
  v_mul_f32 v206, v94, v206
  v_mul_f32 v207, v95, v207
  v_cvt_pk_bf16_f32 v74, v200, v201
  v_cvt_pk_bf16_f32 v75, v202, v203
  buffer_store_dwordx4 v[72:75], v0, s[36:39], s66 offen offset:0 sc1
  v_mul_f32 v204, v204, v26
  v_mul_f32 v205, v205, v27
  v_mul_f32 v206, v206, v28
  v_mul_f32 v207, v207, v29
  v_cvt_pk_bf16_f32 v78, v204, v205
  v_cvt_pk_bf16_f32 v79, v206, v207
  buffer_store_dwordx4 v[76:79], v0, s[36:39], s66 offen offset:1024 sc1
  v_mfma_f32_16x16x32_bf16 v[116:119], a[16:19], a[4:7], v[116:119]
  s_lshl_b32 s51, s72, 11
  ds_read_b64_tr_b16 a[128:129], v2 offset:160
  s_add_u32 s65, s65, 2048
  s_add_u32 s66, s66, 2048
  v_mul_f32 v22, v10, v96
  v_mfma_f32_16x16x32_bf16 v[120:123], a[16:19], a[8:11], v[120:123]
  buffer_load_dwordx2 v[64:65], v7, s[36:39], s51 offen offset:0 sc1
  v_mul_f32 v23, v10, v97
  v_mul_f32 v24, v10, v98
  v_mul_f32 v25, v10, v99
  v_mfma_f32_16x16x32_bf16 v[124:127], a[16:19], a[12:15], v[124:127]
  ds_read_b64_tr_b16 a[130:131], v2 offset:3744
  v_exp_f32 v22, v22
  v_mul_f32 v26, v13, v100
  v_mfma_f32_16x16x32_bf16 v[224:227], a[20:23], a[0:3], v[224:227]
  buffer_load_dwordx2 v[66:67], v7, s[36:39], s51 offen offset:512 sc1
  v_exp_f32 v23, v23
  v_mul_f32 v27, v13, v101
  v_mfma_f32_16x16x32_bf16 v[228:231], a[20:23], a[4:7], v[228:231]
  ds_read_b64_tr_b16 a[132:133], v2 offset:7328
  v_exp_f32 v24, v24
  v_mul_f32 v28, v13, v102
  v_mfma_f32_16x16x32_bf16 v[232:235], a[20:23], a[8:11], v[232:235]
  buffer_load_dwordx2 v[68:69], v7, s[36:39], s51 offen offset:1024 sc1
  v_exp_f32 v25, v25
  v_mul_f32 v29, v13, v103
  v_mfma_f32_16x16x32_bf16 v[236:239], a[20:23], a[12:15], v[236:239]
  ds_read_b64_tr_b16 a[134:135], v2 offset:10912
  v_exp_f32 v26, v26
  v_fma_f32 v22, v22, v11, v11
  v_mfma_f32_16x16x32_bf16 v[236:239], a[152:155], a[44:47], v[236:239]
  buffer_load_dwordx2 v[70:71], v7, s[36:39], s51 offen offset:1536 sc1
  s_add_u32 s51, s51, 12288
  v_exp_f32 v27, v27
  v_mfma_f32_16x16x32_bf16 v[236:239], a[156:159], a[60:63], v[236:239]
  ds_read_b64_tr_b16 a[136:137], v2 offset:14496
  v_fma_f32 v23, v23, v11, v11
  v_exp_f32 v28, v28
  v_mfma_f32_16x16x32_bf16 v[232:235], a[156:159], a[56:59], v[232:235]
  buffer_load_dwordx2 v[72:73], v7, s[36:39], s51 offen offset:2048 sc1
  v_fma_f32 v24, v24, v11, v11
  v_exp_f32 v29, v29
  v_mfma_f32_16x16x32_bf16 v[232:235], a[152:155], a[40:43], v[232:235]
  ds_read_b64_tr_b16 a[138:139], v2 offset:18080
  v_fma_f32 v25, v25, v11, v11
  v_rcp_f32 v22, v22
  v_mfma_f32_16x16x32_bf16 v[228:231], a[152:155], a[36:39], v[228:231]
  buffer_load_dword v139, v138, s[36:39], s91 offen sc1
  v_fma_f32 v26, v26, v14, v14
  v_rcp_f32 v23, v23
  v_mfma_f32_16x16x32_bf16 v[228:231], a[156:159], a[52:55], v[228:231]
  ds_read_b64_tr_b16 a[140:141], v2 offset:21664
  v_fma_f32 v27, v27, v14, v14
  v_rcp_f32 v24, v24
  v_mfma_f32_16x16x32_bf16 v[224:227], a[156:159], a[48:51], v[224:227]
  buffer_load_dwordx2 v[74:75], v7, s[36:39], s51 offen offset:2560 sc1
  v_fma_f32 v28, v28, v14, v14
  v_rcp_f32 v25, v25
  v_mfma_f32_16x16x32_bf16 v[224:227], a[152:155], a[32:35], v[224:227]
  s_waitcnt lgkmcnt(7)
  ds_read_b64_tr_b16 a[142:143], v2 offset:25248
  v_fma_f32 v29, v29, v14, v14
  v_rcp_f32 v26, v26
  v_mfma_f32_16x16x32_bf16 v[112:115], a[160:163], a[64:67], v[112:115]
  buffer_load_dwordx2 v[76:77], v7, s[36:39], s51 offen offset:3072 sc1
  v_mul_f32 v208, v96, v208
  v_rcp_f32 v27, v27
  v_mfma_f32_16x16x32_bf16 v[112:115], a[164:167], a[80:83], v[112:115]
  v_mul_f32 v209, v97, v209
  v_rcp_f32 v28, v28
  v_mul_f32 v210, v98, v210
  v_mfma_f32_16x16x32_bf16 v[116:119], a[164:167], a[84:87], v[116:119]
  buffer_load_dwordx2 v[78:79], v7, s[36:39], s51 offen offset:3584 sc1
  s_lshl_b32 s51, s73, 11
  v_rcp_f32 v29, v29
  v_mfma_f32_16x16x32_bf16 v[116:119], a[160:163], a[68:71], v[116:119]
  v_mul_f32 v211, v99, v211
  v_mul_f32 v208, v208, v22
  v_mul_f32 v209, v209, v23
  v_mul_f32 v210, v210, v24
  v_mfma_f32_16x16x32_bf16 v[120:123], a[160:163], a[72:75], v[120:123]
  buffer_load_dwordx2 v[80:81], v7, s[36:39], s51 offen offset:0 sc1
  v_mul_f32 v211, v211, v25
  v_mul_f32 v22, v16, v104
  v_mul_f32 v23, v16, v105
  v_mfma_f32_16x16x32_bf16 v[120:123], a[164:167], a[88:91], v[120:123]
  v_mul_f32 v24, v16, v106
  v_mul_f32 v25, v16, v107
  v_exp_f32 v22, v22
  v_mfma_f32_16x16x32_bf16 v[124:127], a[164:167], a[92:95], v[124:127]
  buffer_load_dwordx2 v[82:83], v7, s[36:39], s51 offen offset:512 sc1
  v_mul_f32 v212, v100, v212
  v_exp_f32 v23, v23
  v_mfma_f32_16x16x32_bf16 v[124:127], a[160:163], a[76:79], v[124:127]
  s_waitcnt vmcnt(33)
  s_barrier
  v_mul_f32 v213, v101, v213
  v_exp_f32 v24, v24
  v_mfma_f32_16x16x32_bf16 v[236:239], a[168:171], a[76:79], v[236:239]
  buffer_load_dwordx2 v[84:85], v7, s[36:39], s51 offen offset:1024 sc1
  v_mul_f32 v214, v102, v214
  v_exp_f32 v25, v25
  v_mfma_f32_16x16x32_bf16 v[236:239], a[172:175], a[92:95], v[236:239]
  v_mul_f32 v215, v103, v215
  v_mul_f32 v212, v212, v26
  v_mul_f32 v213, v213, v27
  v_mul_f32 v214, v214, v28
  v_mfma_f32_16x16x32_bf16 v[232:235], a[172:175], a[88:91], v[232:235]
  buffer_load_dwordx2 v[86:87], v7, s[36:39], s51 offen offset:1536 sc1
  s_add_u32 s51, s51, 12288
  v_mul_f32 v215, v215, v29
  v_cvt_pk_bf16_f32 v96, v208, v209
  v_mfma_f32_16x16x32_bf16 v[232:235], a[168:171], a[72:75], v[232:235]
  v_cvt_pk_bf16_f32 v97, v210, v211
  v_mul_f32 v26, v19, v108
  v_mul_f32 v27, v19, v109
  v_mul_f32 v28, v19, v110
  v_mfma_f32_16x16x32_bf16 v[228:231], a[168:171], a[68:71], v[228:231]
  buffer_load_dwordx2 v[88:89], v7, s[36:39], s51 offen offset:2048 sc1
  v_mul_f32 v29, v19, v111
  v_exp_f32 v26, v26
  v_mfma_f32_16x16x32_bf16 v[228:231], a[172:175], a[84:87], v[228:231]
  v_fma_f32 v22, v22, v17, v17
  v_exp_f32 v27, v27
  v_fma_f32 v23, v23, v17, v17
  v_mfma_f32_16x16x32_bf16 v[224:227], a[172:175], a[80:83], v[224:227]
  buffer_load_dwordx2 v[90:91], v7, s[36:39], s51 offen offset:2560 sc1
  v_exp_f32 v28, v28
  v_fma_f32 v24, v24, v17, v17
  v_mfma_f32_16x16x32_bf16 v[224:227], a[168:171], a[64:67], v[224:227]
  s_waitcnt lgkmcnt(0)
  v_exp_f32 v29, v29
  v_fma_f32 v25, v25, v17, v17
  v_cvt_pk_bf16_f32 v100, v212, v213
  v_mfma_f32_16x16x32_bf16 v[112:115], a[128:131], a[96:99], v[112:115]
  s_barrier
  buffer_load_dwordx2 v[92:93], v7, s[36:39], s51 offen offset:3072 sc1
  ds_read_b64_tr_b16 a[176:177], v244 offset:28672
  v_cvt_pk_bf16_f32 v101, v214, v215
  v_mfma_f32_16x16x32_bf16 v[112:115], a[132:135], a[112:115], v[112:115]
  ds_read_b64_tr_b16 a[178:179], v244 offset:32768
  v_rcp_f32 v22, v22
  v_fma_f32 v26, v26, v20, v20
  v_mfma_f32_16x16x32_bf16 v[116:119], a[132:135], a[116:119], v[116:119]
  buffer_load_dwordx2 v[94:95], v7, s[36:39], s51 offen offset:3584 sc1
  ds_read_b64_tr_b16 a[180:181], v244 offset:36864
  v_rcp_f32 v23, v23
  v_mfma_f32_16x16x32_bf16 v[116:119], a[128:131], a[100:103], v[116:119]
G3M:
  ds_read_b64_tr_b16 a[182:183], v244 offset:40960
  v_fma_f32 v27, v27, v20, v20
  v_rcp_f32 v24, v24
  v_mfma_f32_16x16x32_bf16 v[120:123], a[128:131], a[104:107], v[120:123]
  ds_read_b64_tr_b16 a[184:185], v245 offset:28672
  v_fma_f32 v28, v28, v20, v20
  v_rcp_f32 v25, v25
  v_mfma_f32_16x16x32_bf16 v[120:123], a[132:135], a[120:123], v[120:123]
  ds_read_b64_tr_b16 a[186:187], v245 offset:32768
  v_fma_f32 v29, v29, v20, v20
  v_rcp_f32 v26, v26
  v_mfma_f32_16x16x32_bf16 v[124:127], a[132:135], a[124:127], v[124:127]
  ds_read_b64_tr_b16 a[188:189], v245 offset:36864
  v_mul_f32 v216, v104, v216
  v_rcp_f32 v27, v27
  v_mfma_f32_16x16x32_bf16 v[124:127], a[128:131], a[108:111], v[124:127]
  ds_read_b64_tr_b16 a[190:191], v245 offset:40960
  v_mul_f32 v217, v105, v217
  v_rcp_f32 v28, v28
  v_mfma_f32_16x16x32_bf16 v[236:239], a[136:139], a[108:111], v[236:239]
  ds_read_b64_tr_b16 a[192:193], v246 offset:28672
  v_mul_f32 v218, v106, v218
  v_rcp_f32 v29, v29
  v_mfma_f32_16x16x32_bf16 v[236:239], a[140:143], a[124:127], v[236:239]
  ds_read_b64_tr_b16 a[194:195], v246 offset:32768
  v_mul_f32 v219, v107, v219
  v_mul_f32 v216, v216, v22
  v_mul_f32 v217, v217, v23
  v_mfma_f32_16x16x32_bf16 v[232:235], a[140:143], a[120:123], v[232:235]
  ds_read_b64_tr_b16 a[196:197], v246 offset:36864
  v_mul_f32 v218, v218, v24
  v_mul_f32 v219, v219, v25
  v_mul_f32 v220, v108, v220
  v_mfma_f32_16x16x32_bf16 v[232:235], a[136:139], a[104:107], v[232:235]
  ds_read_b64_tr_b16 a[198:199], v246 offset:40960
  v_mul_f32 v221, v109, v221
  v_mul_f32 v222, v110, v222
  v_mul_f32 v223, v111, v223
  v_mfma_f32_16x16x32_bf16 v[228:231], a[136:139], a[100:103], v[228:231]
  ds_read_b64_tr_b16 a[200:201], v247 offset:28672
  v_cvt_pk_bf16_f32 v104, v216, v217
  v_cvt_pk_bf16_f32 v105, v218, v219
  v_mul_f32 v220, v220, v26
  v_mfma_f32_16x16x32_bf16 v[228:231], a[140:143], a[116:119], v[228:231]
  ds_read_b64_tr_b16 a[202:203], v247 offset:32768
  v_mul_f32 v221, v221, v27
  v_mul_f32 v222, v222, v28
  v_mul_f32 v223, v223, v29
  v_mfma_f32_16x16x32_bf16 v[224:227], a[140:143], a[112:115], v[224:227]
  ds_read_b64_tr_b16 a[204:205], v247 offset:36864
  v_cvt_pk_bf16_f32 v108, v220, v221
  v_cvt_pk_bf16_f32 v109, v222, v223
  v_mul_f32 v22, v10, v112
  v_mfma_f32_16x16x32_bf16 v[224:227], a[136:139], a[96:99], v[224:227]
  s_waitcnt vmcnt(29) lgkmcnt(11)
  ds_read_b64_tr_b16 a[206:207], v247 offset:40960
  v_mul_f32 v23, v10, v113
  v_mul_f32 v24, v10, v114
  v_mul_f32 v25, v10, v115
  v_mfma_f32_16x16x32_bf16 v[32:35], a[176:179], a[216:219], 0
  s_cmp_eq_u32 s87, 0
  s_cselect_b32 s74, 14, 0
  s_lshl_b32 s50, s74, 16
  s_add_u32 s50, s50, s88
  s_add_u32 m0, s70, 12288
  v_mfma_f32_16x16x32_bf16 v[32:35], a[180:183], a[224:227], v[32:35]
  ds_read_b64_tr_b16 a[208:209], v244 offset:30720
  ds_read_b64_tr_b16 a[210:211], v244 offset:34816
  v_exp_f32 v22, v22
  v_mfma_f32_16x16x32_bf16 v[36:39], a[180:183], a[228:231], 0
  ds_read_b64_tr_b16 a[212:213], v244 offset:38912
  v_mul_f32 v26, v13, v116
  v_exp_f32 v23, v23
  v_mfma_f32_16x16x32_bf16 v[36:39], a[176:179], a[220:223], v[36:39]
  s_waitcnt lgkmcnt(11)
  ds_read_b64_tr_b16 a[214:215], v244 offset:43008
  v_mul_f32 v27, v13, v117
  v_exp_f32 v24, v24
  v_mfma_f32_16x16x32_bf16 v[44:47], a[184:187], a[220:223], 0
  s_waitcnt vmcnt(11)
  v_cmp_ne_u32 vcc, s3, v139
  s_nop 4
  s_cbranch_vccnz CK10s
CK10x:
  v_mfma_f32_16x16x32_bf16 v[44:47], a[188:191], a[228:231], v[44:47]
  s_add_u32 s91, s91, 32768
  buffer_load_dwordx4 v133, s[24:27], s50 offen offset:0 lds
  s_lshl_b32 s51, s74, 11
  ds_read_b64_tr_b16 a[176:177], v245 offset:30720
  v_mul_f32 v28, v13, v118
  v_mfma_f32_16x16x32_bf16 v[40:43], a[188:191], a[224:227], 0
  ds_read_b64_tr_b16 a[178:179], v245 offset:34816
  ds_read_b64_tr_b16 a[180:181], v245 offset:38912
  v_exp_f32 v25, v25
  v_mfma_f32_16x16x32_bf16 v[40:43], a[184:187], a[216:219], v[40:43]
  s_waitcnt lgkmcnt(11)
  buffer_load_dwordx4 a[48:51], v137, s[36:39], s51 offen offset:0 sc1
  ds_read_b64_tr_b16 a[182:183], v245 offset:43008
  v_mul_f32 v29, v13, v119
  v_mfma_f32_16x16x32_bf16 v[48:51], a[192:195], a[216:219], 0
  ds_read_b64_tr_b16 a[184:185], v246 offset:30720
  v_exp_f32 v26, v26
  v_fma_f32 v22, v22, v11, v11
  v_mfma_f32_16x16x32_bf16 v[48:51], a[196:199], a[224:227], v[48:51]
  ds_read_b64_tr_b16 a[186:187], v246 offset:34816
  v_exp_f32 v27, v27
  v_fma_f32 v23, v23, v11, v11
  v_mfma_f32_16x16x32_bf16 v[52:55], a[196:199], a[228:231], 0
  ds_read_b64_tr_b16 a[188:189], v246 offset:38912
  v_exp_f32 v28, v28
  v_fma_f32 v24, v24, v11, v11
  v_mfma_f32_16x16x32_bf16 v[52:55], a[192:195], a[220:223], v[52:55]
  s_waitcnt lgkmcnt(11)
  buffer_load_dwordx4 v134, s[24:27], s50 offen offset:1024 lds
  ds_read_b64_tr_b16 a[190:191], v246 offset:43008
  v_exp_f32 v29, v29
  v_mfma_f32_16x16x32_bf16 v[60:63], a[200:203], a[220:223], 0
  ds_read_b64_tr_b16 a[192:193], v247 offset:30720
  v_fma_f32 v25, v25, v11, v11
  v_rcp_f32 v22, v22
  v_mfma_f32_16x16x32_bf16 v[60:63], a[204:207], a[228:231], v[60:63]
  ds_read_b64_tr_b16 a[194:195], v247 offset:34816
  v_fma_f32 v26, v26, v14, v14
  v_rcp_f32 v23, v23
  v_mfma_f32_16x16x32_bf16 v[56:59], a[204:207], a[224:227], 0
  ds_read_b64_tr_b16 a[196:197], v247 offset:38912
  v_fma_f32 v27, v27, v14, v14
  v_rcp_f32 v24, v24
  v_mfma_f32_16x16x32_bf16 v[56:59], a[200:203], a[216:219], v[56:59]
  s_waitcnt lgkmcnt(11)
  buffer_load_dwordx4 a[52:55], v137, s[36:39], s51 offen offset:1024 sc1
  ds_read_b64_tr_b16 a[198:199], v247 offset:43008
  v_fma_f32 v28, v28, v14, v14
  v_mfma_f32_16x16x32_bf16 v[144:147], a[208:211], a[216:219], 0
  ds_read_b64_tr_b16 a[200:201], v244 offset:45056
  v_rcp_f32 v25, v25
  v_fma_f32 v29, v29, v14, v14
  v_mfma_f32_16x16x32_bf16 v[144:147], a[212:215], a[224:227], v[144:147]
  ds_read_b64_tr_b16 a[202:203], v244 offset:49152
  v_rcp_f32 v26, v26
  v_mul_f32 v224, v112, v224
  v_mfma_f32_16x16x32_bf16 v[148:151], a[212:215], a[228:231], 0
  ds_read_b64_tr_b16 a[204:205], v244 offset:53248
  v_rcp_f32 v27, v27
  v_mul_f32 v225, v113, v225
  v_mfma_f32_16x16x32_bf16 v[148:151], a[208:211], a[220:223], v[148:151]
  s_waitcnt lgkmcnt(11)
  buffer_load_dwordx4 v135, s[24:27], s50 offen offset:2048 lds
  s_add_u32 s51, s51, 6144
  ds_read_b64_tr_b16 a[206:207], v244 offset:57344
  v_mfma_f32_16x16x32_bf16 v[156:159], a[176:179], a[220:223], 0
  ds_read_b64_tr_b16 a[208:209], v245 offset:45056
  v_rcp_f32 v28, v28
  v_mul_f32 v226, v114, v226
  v_mfma_f32_16x16x32_bf16 v[156:159], a[180:183], a[228:231], v[156:159]
  ds_read_b64_tr_b16 a[210:211], v245 offset:49152
  v_rcp_f32 v29, v29
  v_mul_f32 v227, v115, v227
  v_mfma_f32_16x16x32_bf16 v[152:155], a[180:183], a[224:227], 0
  ds_read_b64_tr_b16 a[212:213], v245 offset:53248
  v_mul_f32 v224, v224, v22
  v_mul_f32 v225, v225, v23
  v_mul_f32 v226, v226, v24
  v_mfma_f32_16x16x32_bf16 v[152:155], a[176:179], a[216:219], v[152:155]
  s_waitcnt lgkmcnt(11)
  buffer_load_dwordx4 a[56:59], v137, s[36:39], s51 offen offset:2048 sc1
  ds_read_b64_tr_b16 a[214:215], v245 offset:57344
  v_mul_f32 v227, v227, v25
  v_mul_f32 v22, v16, v120
  v_mfma_f32_16x16x32_bf16 v[160:163], a[184:187], a[216:219], 0
  ds_read_b64_tr_b16 a[176:177], v246 offset:45056
  v_mul_f32 v23, v16, v121
  v_mul_f32 v24, v16, v122
  v_mul_f32 v25, v16, v123
  v_mfma_f32_16x16x32_bf16 v[160:163], a[188:191], a[224:227], v[160:163]
  ds_read_b64_tr_b16 a[178:179], v246 offset:49152
  v_exp_f32 v22, v22
  v_mul_f32 v228, v116, v228
  v_mfma_f32_16x16x32_bf16 v[164:167], a[188:191], a[228:231], 0
  ds_read_b64_tr_b16 a[180:181], v246 offset:53248
  v_exp_f32 v23, v23
  v_mul_f32 v229, v117, v229
  v_mfma_f32_16x16x32_bf16 v[164:167], a[184:187], a[220:223], v[164:167]
  s_waitcnt lgkmcnt(11)
  buffer_load_dwordx4 v136, s[24:27], s50 offen offset:3072 lds
  ds_read_b64_tr_b16 a[182:183], v246 offset:57344
  v_exp_f32 v24, v24
  v_mfma_f32_16x16x32_bf16 v[172:175], a[192:195], a[220:223], 0
  ds_read_b64_tr_b16 a[184:185], v247 offset:45056
  v_mul_f32 v230, v118, v230
  v_exp_f32 v25, v25
  v_mfma_f32_16x16x32_bf16 v[172:175], a[196:199], a[228:231], v[172:175]
  ds_read_b64_tr_b16 a[186:187], v247 offset:49152
  v_mul_f32 v231, v119, v231
  v_mul_f32 v228, v228, v26
  v_mul_f32 v229, v229, v27
  v_mfma_f32_16x16x32_bf16 v[168:171], a[196:199], a[224:227], 0
  ds_read_b64_tr_b16 a[188:189], v247 offset:53248
  v_mul_f32 v230, v230, v28
  v_mul_f32 v231, v231, v29
  v_cvt_pk_bf16_f32 v98, v224, v225
  v_mfma_f32_16x16x32_bf16 v[168:171], a[192:195], a[216:219], v[168:171]
  s_waitcnt vmcnt(28) lgkmcnt(11)
  buffer_load_dwordx4 a[60:63], v137, s[36:39], s51 offen offset:3072 sc1
  s_cmp_eq_u32 s87, 1
  s_cselect_b32 s75, 21, 7
  s_lshl_b32 s50, s75, 16
  v_mfma_f32_16x16x32_bf16 v[32:35], a[200:203], v[176:179], v[32:35]
  s_add_u32 s50, s50, s88
  s_add_u32 m0, s70, 28672
  ds_read_b64_tr_b16 a[190:191], v247 offset:57344
  ds_read_b64_tr_b16 a[192:193], v244 offset:47104
  v_cvt_pk_bf16_f32 v99, v226, v227
  v_mfma_f32_16x16x32_bf16 v[32:35], a[204:207], v[184:187], v[32:35]
  ds_read_b64_tr_b16 a[194:195], v244 offset:51200
  buffer_store_dwordx4 v[96:99], v0, s[36:39], s65 offen offset:0 sc1
  v_mul_f32 v26, v19, v124
  v_mul_f32 v27, v19, v125
  v_mfma_f32_16x16x32_bf16 v[36:39], a[204:207], v[188:191], v[36:39]
  ds_read_b64_tr_b16 a[196:197], v244 offset:55296
  v_mul_f32 v28, v19, v126
  v_mul_f32 v29, v19, v127
  v_mfma_f32_16x16x32_bf16 v[36:39], a[200:203], v[180:183], v[36:39]
  s_waitcnt lgkmcnt(11)
  buffer_load_dwordx4 v133, s[24:27], s50 offen offset:0 lds
  s_lshl_b32 s51, s75, 11
  ds_read_b64_tr_b16 a[198:199], v244 offset:59392
  v_mfma_f32_16x16x32_bf16 v[44:47], a[208:211], v[180:183], v[44:47]
  ds_read_b64_tr_b16 a[200:201], v245 offset:47104
  v_exp_f32 v26, v26
  v_fma_f32 v22, v22, v17, v17
  v_mfma_f32_16x16x32_bf16 v[44:47], a[212:215], v[188:191], v[44:47]
  ds_read_b64_tr_b16 a[202:203], v245 offset:51200
  v_exp_f32 v27, v27
  v_fma_f32 v23, v23, v17, v17
  v_mfma_f32_16x16x32_bf16 v[40:43], a[212:215], v[184:187], v[40:43]
  ds_read_b64_tr_b16 a[204:205], v245 offset:55296
  v_exp_f32 v28, v28
  v_fma_f32 v24, v24, v17, v17
  v_mfma_f32_16x16x32_bf16 v[40:43], a[208:211], v[176:179], v[40:43]
  s_waitcnt lgkmcnt(11)
  buffer_load_dwordx4 a[64:67], v137, s[36:39], s51 offen offset:0 sc1
  ds_read_b64_tr_b16 a[206:207], v245 offset:59392
  v_exp_f32 v29, v29
  v_mfma_f32_16x16x32_bf16 v[48:51], a[176:179], v[176:179], v[48:51]
  ds_read_b64_tr_b16 a[208:209], v246 offset:47104
  v_fma_f32 v25, v25, v17, v17
  v_cvt_pk_bf16_f32 v102, v228, v229
  v_cvt_pk_bf16_f32 v103, v230, v231
  v_mfma_f32_16x16x32_bf16 v[48:51], a[180:183], v[184:187], v[48:51]
  ds_read_b64_tr_b16 a[210:211], v246 offset:51200
  buffer_store_dwordx4 v[100:103], v0, s[36:39], s65 offen offset:1024 sc1
  v_rcp_f32 v22, v22
  v_mfma_f32_16x16x32_bf16 v[52:55], a[180:183], v[188:191], v[52:55]
  ds_read_b64_tr_b16 a[212:213], v246 offset:55296
  v_fma_f32 v26, v26, v20, v20
  v_rcp_f32 v23, v23
  v_mfma_f32_16x16x32_bf16 v[52:55], a[176:179], v[180:183], v[52:55]
  s_waitcnt lgkmcnt(11)
  buffer_load_dwordx4 v134, s[24:27], s50 offen offset:1024 lds
  ds_read_b64_tr_b16 a[214:215], v246 offset:59392
  v_fma_f32 v27, v27, v20, v20
  v_mfma_f32_16x16x32_bf16 v[60:63], a[184:187], v[180:183], v[60:63]
  ds_read_b64_tr_b16 a[176:177], v247 offset:47104
  v_rcp_f32 v24, v24
  v_fma_f32 v28, v28, v20, v20
  v_mfma_f32_16x16x32_bf16 v[60:63], a[188:191], v[188:191], v[60:63]
  ds_read_b64_tr_b16 a[178:179], v247 offset:51200
  v_rcp_f32 v25, v25
  v_fma_f32 v29, v29, v20, v20
  v_mfma_f32_16x16x32_bf16 v[56:59], a[188:191], v[184:187], v[56:59]
  ds_read_b64_tr_b16 a[180:181], v247 offset:55296
  v_rcp_f32 v26, v26
  v_mul_f32 v232, v120, v232
  v_mfma_f32_16x16x32_bf16 v[56:59], a[184:187], v[176:179], v[56:59]
  s_waitcnt lgkmcnt(11)
  buffer_load_dwordx4 a[68:71], v137, s[36:39], s51 offen offset:1024 sc1
  ds_read_b64_tr_b16 a[182:183], v247 offset:59392
  v_rcp_f32 v27, v27
  v_mfma_f32_16x16x32_bf16 v[144:147], a[192:195], v[176:179], v[144:147]
  ds_read_b64_tr_b16 a[184:185], v244 offset:61440
  v_mul_f32 v233, v121, v233
  v_rcp_f32 v28, v28
  v_mfma_f32_16x16x32_bf16 v[144:147], a[196:199], v[184:187], v[144:147]
  ds_read_b64_tr_b16 a[186:187], v248 offset:0
  v_mul_f32 v234, v122, v234
  v_rcp_f32 v29, v29
  v_mfma_f32_16x16x32_bf16 v[148:151], a[196:199], v[188:191], v[148:151]
  ds_read_b64_tr_b16 a[188:189], v248 offset:4096
  v_mul_f32 v235, v123, v235
  v_mul_f32 v232, v232, v22
  v_mul_f32 v233, v233, v23
  v_mfma_f32_16x16x32_bf16 v[148:151], a[192:195], v[180:183], v[148:151]
  s_waitcnt lgkmcnt(11)
  buffer_load_dwordx4 v135, s[24:27], s50 offen offset:2048 lds
  s_add_u32 s51, s51, 6144
  ds_read_b64_tr_b16 a[190:191], v248 offset:8192
  v_mul_f32 v234, v234, v24
  v_mfma_f32_16x16x32_bf16 v[156:159], a[200:203], v[180:183], v[156:159]
  ds_read_b64_tr_b16 a[192:193], v245 offset:61440
  v_mul_f32 v235, v235, v25
  v_mul_f32 v236, v124, v236
  v_mul_f32 v237, v125, v237
  v_mfma_f32_16x16x32_bf16 v[156:159], a[204:207], v[188:191], v[156:159]
  ds_read_b64_tr_b16 a[194:195], v249 offset:0
  v_mul_f32 v238, v126, v238
  v_mul_f32 v239, v127, v239
  v_cvt_pk_bf16_f32 v106, v232, v233
  v_mfma_f32_16x16x32_bf16 v[152:155], a[204:207], v[184:187], v[152:155]
  ds_read_b64_tr_b16 a[196:197], v249 offset:4096
  v_cvt_pk_bf16_f32 v107, v234, v235
  v_mfma_f32_16x16x32_bf16 v[152:155], a[200:203], v[176:179], v[152:155]
  s_waitcnt lgkmcnt(11)
  buffer_load_dwordx4 a[72:75], v137, s[36:39], s51 offen offset:2048 sc1
  ds_read_b64_tr_b16 a[198:199], v249 offset:8192
  v_mfma_f32_16x16x32_bf16 v[160:163], a[208:211], v[176:179], v[160:163]
  ds_read_b64_tr_b16 a[200:201], v246 offset:61440
  v_mfma_f32_16x16x32_bf16 v[160:163], a[212:215], v[184:187], v[160:163]
  ds_read_b64_tr_b16 a[202:203], v250 offset:0
  buffer_store_dwordx4 v[104:107], v0, s[36:39], s66 offen offset:0 sc1
  v_mul_f32 v236, v236, v26
  v_mul_f32 v237, v237, v27
  v_mfma_f32_16x16x32_bf16 v[164:167], a[212:215], v[188:191], v[164:167]
  v_mul_f32 v238, v238, v28
  v_mul_f32 v239, v239, v29
  v_cvt_pk_bf16_f32 v110, v236, v237
  v_cvt_pk_bf16_f32 v111, v238, v239
  buffer_store_dwordx4 v[108:111], v0, s[36:39], s66 offen offset:1024 sc1
  v_mfma_f32_16x16x32_bf16 v[164:167], a[208:211], v[180:183], v[164:167]
  s_waitcnt lgkmcnt(10)
  ds_read_b64_tr_b16 a[204:205], v250 offset:4096
  ds_read_b64_tr_b16 a[206:207], v250 offset:8192
  v_mfma_f32_16x16x32_bf16 v[172:175], a[176:179], v[180:183], v[172:175]
  ds_read_b64_tr_b16 a[208:209], v247 offset:61440
  v_mfma_f32_16x16x32_bf16 v[172:175], a[180:183], v[188:191], v[172:175]
  buffer_load_dwordx4 v136, s[24:27], s50 offen offset:3072 lds
  ds_read_b64_tr_b16 a[210:211], v251 offset:0
  v_mfma_f32_16x16x32_bf16 v[168:171], a[180:183], v[184:187], v[168:171]
  ds_read_b64_tr_b16 a[212:213], v251 offset:4096
  v_mfma_f32_16x16x32_bf16 v[168:171], a[176:179], v[176:179], v[168:171]
  s_waitcnt vmcnt(27) lgkmcnt(11)
  ds_read_b64_tr_b16 a[214:215], v251 offset:8192
  v_mfma_f32_16x16x32_bf16 v[32:35], a[184:187], v[64:67], v[32:35]
  buffer_load_dwordx4 a[76:79], v137, s[36:39], s51 offen offset:3072 sc1
  s_cmp_eq_u32 s87, 0
  v_mfma_f32_16x16x32_bf16 v[32:35], a[188:191], v[72:75], v[32:35]
  s_cselect_b32 s76, 0, 14
  s_cmp_eq_u32 s87, 2
  s_cselect_b32 s76, 28, s76
  v_mfma_f32_16x16x32_bf16 v[36:39], a[188:191], v[76:79], v[36:39]
  s_lshl_b32 s50, s76, 16
  s_add_u32 s50, s50, s88
  s_add_u32 m0, s70, 45056
  v_mfma_f32_16x16x32_bf16 v[36:39], a[184:187], v[68:71], v[36:39]
  s_waitcnt lgkmcnt(8)
  ds_read_b64_tr_b16 a[176:177], v244 offset:63488
  ds_read_b64_tr_b16 a[178:179], v248 offset:2048
  v_mfma_f32_16x16x32_bf16 v[44:47], a[192:195], v[68:71], v[44:47]
  buffer_load_dwordx4 v133, s[24:27], s50 offen offset:0 lds
  s_lshl_b32 s51, s76, 11
  v_mfma_f32_16x16x32_bf16 v[44:47], a[196:199], v[76:79], v[44:47]
  ds_read_b64_tr_b16 a[180:181], v248 offset:6144
  ds_read_b64_tr_b16 a[182:183], v248 offset:10240
  v_mfma_f32_16x16x32_bf16 v[40:43], a[196:199], v[72:75], v[40:43]
  ds_read_b64_tr_b16 a[184:185], v245 offset:63488
  ds_read_b64_tr_b16 a[186:187], v249 offset:2048
  v_mfma_f32_16x16x32_bf16 v[40:43], a[192:195], v[64:67], v[40:43]
  s_waitcnt lgkmcnt(10)
  buffer_load_dwordx4 a[80:83], v137, s[36:39], s51 offen offset:0 sc1
  ds_read_b64_tr_b16 a[188:189], v249 offset:6144
  v_mfma_f32_16x16x32_bf16 v[48:51], a[200:203], v[64:67], v[48:51]
  ds_read_b64_tr_b16 a[190:191], v249 offset:10240
  ds_read_b64_tr_b16 a[192:193], v246 offset:63488
  v_mfma_f32_16x16x32_bf16 v[48:51], a[204:207], v[72:75], v[48:51]
  ds_read_b64_tr_b16 a[194:195], v250 offset:2048
  v_mfma_f32_16x16x32_bf16 v[52:55], a[204:207], v[76:79], v[52:55]
  buffer_load_dwordx4 v134, s[24:27], s50 offen offset:1024 lds
  ds_read_b64_tr_b16 a[196:197], v250 offset:6144
  v_mfma_f32_16x16x32_bf16 v[52:55], a[200:203], v[68:71], v[52:55]
  s_waitcnt lgkmcnt(11)
  ds_read_b64_tr_b16 a[198:199], v250 offset:10240
  v_mfma_f32_16x16x32_bf16 v[60:63], a[208:211], v[68:71], v[60:63]
  ds_read_b64_tr_b16 a[200:201], v247 offset:63488
  v_mfma_f32_16x16x32_bf16 v[60:63], a[212:215], v[76:79], v[60:63]
  ds_read_b64_tr_b16 a[202:203], v251 offset:2048
  v_mfma_f32_16x16x32_bf16 v[56:59], a[212:215], v[72:75], v[56:59]
  buffer_load_dwordx4 a[84:87], v137, s[36:39], s51 offen offset:1024 sc1
  ds_read_b64_tr_b16 a[204:205], v251 offset:6144
  v_mfma_f32_16x16x32_bf16 v[56:59], a[208:211], v[64:67], v[56:59]
  s_waitcnt lgkmcnt(11)
  ds_read_b64_tr_b16 a[206:207], v251 offset:10240
  v_mfma_f32_16x16x32_bf16 v[144:147], a[176:179], v[64:67], v[144:147]
  ds_read_b64_tr_b16 a[208:209], v248 offset:12288
  v_mfma_f32_16x16x32_bf16 v[144:147], a[180:183], v[72:75], v[144:147]
  ds_read_b64_tr_b16 a[210:211], v248 offset:16384
  v_mfma_f32_16x16x32_bf16 v[148:151], a[180:183], v[76:79], v[148:151]
  buffer_load_dwordx4 v135, s[24:27], s50 offen offset:2048 lds
  s_add_u32 s51, s51, 6144
  v_mfma_f32_16x16x32_bf16 v[148:151], a[176:179], v[68:71], v[148:151]
  s_waitcnt lgkmcnt(10)
  ds_read_b64_tr_b16 a[212:213], v248 offset:20480
  ds_read_b64_tr_b16 a[214:215], v248 offset:24576
  v_mfma_f32_16x16x32_bf16 v[156:159], a[184:187], v[68:71], v[156:159]
  ds_read_b64_tr_b16 a[176:177], v249 offset:12288
  v_mfma_f32_16x16x32_bf16 v[156:159], a[188:191], v[76:79], v[156:159]
  ds_read_b64_tr_b16 a[178:179], v249 offset:16384
  v_mfma_f32_16x16x32_bf16 v[152:155], a[188:191], v[72:75], v[152:155]
  buffer_load_dwordx4 a[88:91], v137, s[36:39], s51 offen offset:2048 sc1
  ds_read_b64_tr_b16 a[180:181], v249 offset:20480
  v_mfma_f32_16x16x32_bf16 v[152:155], a[184:187], v[64:67], v[152:155]
  s_waitcnt lgkmcnt(11)
  ds_read_b64_tr_b16 a[182:183], v249 offset:24576
  v_mfma_f32_16x16x32_bf16 v[160:163], a[192:195], v[64:67], v[160:163]
  ds_read_b64_tr_b16 a[184:185], v250 offset:12288
  v_mfma_f32_16x16x32_bf16 v[160:163], a[196:199], v[72:75], v[160:163]
  ds_read_b64_tr_b16 a[186:187], v250 offset:16384
  v_mfma_f32_16x16x32_bf16 v[164:167], a[196:199], v[76:79], v[164:167]
  buffer_load_dwordx4 v136, s[24:27], s50 offen offset:3072 lds
  ds_read_b64_tr_b16 a[188:189], v250 offset:20480
  v_mfma_f32_16x16x32_bf16 v[164:167], a[192:195], v[68:71], v[164:167]
  s_waitcnt lgkmcnt(11)
  ds_read_b64_tr_b16 a[190:191], v250 offset:24576
  v_mfma_f32_16x16x32_bf16 v[172:175], a[200:203], v[68:71], v[172:175]
  ds_read_b64_tr_b16 a[192:193], v251 offset:12288
  v_mfma_f32_16x16x32_bf16 v[172:175], a[204:207], v[76:79], v[172:175]
  ds_read_b64_tr_b16 a[194:195], v251 offset:16384
  v_mfma_f32_16x16x32_bf16 v[168:171], a[204:207], v[72:75], v[168:171]
  buffer_load_dwordx4 a[92:95], v137, s[36:39], s51 offen offset:3072 sc1
  s_cmp_eq_u32 s87, 1
  v_mfma_f32_16x16x32_bf16 v[168:171], a[200:203], v[64:67], v[168:171]
  s_waitcnt vmcnt(28) lgkmcnt(10)
  s_cselect_b32 s81, 7, 21
  s_cmp_eq_u32 s87, 3
  v_mfma_f32_16x16x32_bf16 v[32:35], a[208:211], v[80:83], v[32:35]
  s_cselect_b32 s81, 35, s81
  s_lshl_b32 s50, s81, 16
  s_add_u32 s50, s50, s88
  v_mfma_f32_16x16x32_bf16 v[32:35], a[212:215], v[88:91], v[32:35]
  s_add_u32 m0, s70, 61440
  ds_read_b64_tr_b16 a[196:197], v251 offset:20480
  ds_read_b64_tr_b16 a[198:199], v251 offset:24576
  v_mfma_f32_16x16x32_bf16 v[36:39], a[212:215], v[92:95], v[36:39]
  ds_read_b64_tr_b16 a[200:201], v248 offset:14336
  ds_read_b64_tr_b16 a[202:203], v248 offset:18432
  v_mfma_f32_16x16x32_bf16 v[36:39], a[208:211], v[84:87], v[36:39]
  s_waitcnt lgkmcnt(10)
  buffer_load_dwordx4 v133, s[24:27], s50 offen offset:0 lds
  s_lshl_b32 s51, s81, 11
  v_mfma_f32_16x16x32_bf16 v[44:47], a[176:179], v[84:87], v[44:47]
  ds_read_b64_tr_b16 a[204:205], v248 offset:22528
  ds_read_b64_tr_b16 a[206:207], v248 offset:26624
  v_mfma_f32_16x16x32_bf16 v[44:47], a[180:183], v[92:95], v[44:47]
  ds_read_b64_tr_b16 a[208:209], v249 offset:14336
  ds_read_b64_tr_b16 a[210:211], v249 offset:18432
  v_mfma_f32_16x16x32_bf16 v[40:43], a[180:183], v[88:91], v[40:43]
  s_waitcnt vmcnt(11)
  buffer_load_dwordx4 a[96:99], v137, s[36:39], s51 offen offset:0 sc1
  ds_read_b64_tr_b16 a[212:213], v249 offset:22528
  v_mfma_f32_16x16x32_bf16 v[40:43], a[176:179], v[80:83], v[40:43]
  s_waitcnt vmcnt(23) lgkmcnt(11)
  s_barrier
Hb0:
  s_cbranch_execz Hb0_1
  ds_read_b64_tr_b16 a[214:215], v249 offset:26624
  v_mfma_f32_16x16x32_bf16 v[48:51], a[184:187], v[80:83], v[48:51]
  s_mov_b64 exec, 1
  buffer_store_dword v9, v0, s[36:39], s45 offen sc1
  s_mov_b64 exec, -1
  v_mfma_f32_16x16x32_bf16 v[48:51], a[188:191], v[88:91], v[48:51]
  s_add_u32 s45, s45, 32768
  ds_read_b64_tr_b16 a[176:177], v250 offset:14336
  ds_read_b64_tr_b16 a[178:179], v250 offset:18432
  v_mfma_f32_16x16x32_bf16 v[52:55], a[188:191], v[92:95], v[52:55]
  buffer_load_dwordx4 v134, s[24:27], s50 offen offset:1024 lds
  ds_read_b64_tr_b16 a[180:181], v250 offset:22528
  v_mfma_f32_16x16x32_bf16 v[52:55], a[184:187], v[84:87], v[52:55]
  s_waitcnt lgkmcnt(11)
  ds_read_b64_tr_b16 a[182:183], v250 offset:26624
  v_mfma_f32_16x16x32_bf16 v[60:63], a[192:195], v[84:87], v[60:63]
  ds_read_b64_tr_b16 a[184:185], v251 offset:14336
  v_mfma_f32_16x16x32_bf16 v[60:63], a[196:199], v[92:95], v[60:63]
  ds_read_b64_tr_b16 a[186:187], v251 offset:18432
  v_mfma_f32_16x16x32_bf16 v[56:59], a[196:199], v[88:91], v[56:59]
  buffer_load_dwordx4 a[100:103], v137, s[36:39], s51 offen offset:1024 sc1
  ds_read_b64_tr_b16 a[188:189], v251 offset:22528
  v_mfma_f32_16x16x32_bf16 v[56:59], a[192:195], v[80:83], v[56:59]
  s_waitcnt lgkmcnt(11)
  ds_read_b64_tr_b16 a[190:191], v251 offset:26624
  v_mfma_f32_16x16x32_bf16 v[144:147], a[200:203], v[80:83], v[144:147]
  ds_read_b64_tr_b16 a[192:193], v240 offset:12288
  v_mfma_f32_16x16x32_bf16 v[144:147], a[204:207], v[88:91], v[144:147]
  ds_read_b64_tr_b16 a[194:195], v240 offset:16384
  v_mfma_f32_16x16x32_bf16 v[148:151], a[204:207], v[92:95], v[148:151]
  buffer_load_dwordx4 v135, s[24:27], s50 offen offset:2048 lds
  s_add_u32 s51, s51, 6144
  v_mfma_f32_16x16x32_bf16 v[148:151], a[200:203], v[84:87], v[148:151]
  s_waitcnt lgkmcnt(10)
  ds_read_b64_tr_b16 a[196:197], v240 offset:20480
  ds_read_b64_tr_b16 a[198:199], v240 offset:24576
  v_mfma_f32_16x16x32_bf16 v[156:159], a[208:211], v[84:87], v[156:159]
  ds_read_b64_tr_b16 a[200:201], v241 offset:12288
  v_mfma_f32_16x16x32_bf16 v[156:159], a[212:215], v[92:95], v[156:159]
  ds_read_b64_tr_b16 a[202:203], v241 offset:16384
  v_mfma_f32_16x16x32_bf16 v[152:155], a[212:215], v[88:91], v[152:155]
  buffer_load_dwordx4 a[104:107], v137, s[36:39], s51 offen offset:2048 sc1
  ds_read_b64_tr_b16 a[204:205], v241 offset:20480
  v_mfma_f32_16x16x32_bf16 v[152:155], a[208:211], v[80:83], v[152:155]
  s_waitcnt lgkmcnt(11)
  ds_read_b64_tr_b16 a[206:207], v241 offset:24576
  v_mfma_f32_16x16x32_bf16 v[160:163], a[176:179], v[80:83], v[160:163]
  ds_read_b64_tr_b16 a[208:209], v242 offset:12288
  v_mfma_f32_16x16x32_bf16 v[160:163], a[180:183], v[88:91], v[160:163]
  buffer_load_dwordx4 v136, s[24:27], s50 offen offset:3072 lds
  ds_read_b64_tr_b16 a[210:211], v242 offset:16384
  v_mfma_f32_16x16x32_bf16 v[164:167], a[180:183], v[92:95], v[164:167]
  ds_read_b64_tr_b16 a[212:213], v242 offset:20480
  v_mfma_f32_16x16x32_bf16 v[164:167], a[176:179], v[84:87], v[164:167]
  s_waitcnt lgkmcnt(11)
  ds_read_b64_tr_b16 a[214:215], v242 offset:24576
  v_mfma_f32_16x16x32_bf16 v[172:175], a[184:187], v[84:87], v[172:175]
  ds_read_b64_tr_b16 a[176:177], v243 offset:12288
  v_mfma_f32_16x16x32_bf16 v[172:175], a[188:191], v[92:95], v[172:175]
  buffer_load_dwordx4 a[108:111], v137, s[36:39], s51 offen offset:3072 sc1
  s_cmp_eq_u32 s87, 0
  v_mfma_f32_16x16x32_bf16 v[168:171], a[188:191], v[88:91], v[168:171]
  s_cselect_b32 s82, 42, 28
  s_cmp_eq_u32 s87, 2
  s_cselect_b32 s82, 14, s82
  v_mfma_f32_16x16x32_bf16 v[168:171], a[184:187], v[80:83], v[168:171]
  s_waitcnt vmcnt(29) lgkmcnt(9)
  s_lshl_b32 s50, s82, 16
  s_add_u32 s50, s50, s88
  v_mfma_f32_16x16x32_bf16 v[32:35], a[192:195], a[48:51], v[32:35]
  s_add_u32 m0, s70, 77824
  ds_read_b64_tr_b16 a[178:179], v243 offset:16384
  ds_read_b64_tr_b16 a[180:181], v243 offset:20480
  v_mfma_f32_16x16x32_bf16 v[32:35], a[196:199], a[56:59], v[32:35]
  ds_read_b64_tr_b16 a[182:183], v243 offset:24576
  ds_read_b64_tr_b16 a[184:185], v240 offset:14336
  v_mfma_f32_16x16x32_bf16 v[36:39], a[196:199], a[60:63], v[36:39]
  buffer_load_dwordx4 v133, s[24:27], s50 offen offset:0 lds
  s_lshl_b32 s51, s82, 11
  v_mfma_f32_16x16x32_bf16 v[36:39], a[192:195], a[52:55], v[36:39]
  s_waitcnt lgkmcnt(9)
  ds_read_b64_tr_b16 a[186:187], v240 offset:18432
  ds_read_b64_tr_b16 a[188:189], v240 offset:22528
  v_mfma_f32_16x16x32_bf16 v[44:47], a[200:203], a[52:55], v[44:47]
  ds_read_b64_tr_b16 a[190:191], v240 offset:26624
  ds_read_b64_tr_b16 a[192:193], v241 offset:14336
  v_mfma_f32_16x16x32_bf16 v[44:47], a[204:207], a[60:63], v[44:47]
  buffer_load_dwordx4 a[112:115], v137, s[36:39], s51 offen offset:0 sc1
  ds_read_b64_tr_b16 a[194:195], v241 offset:18432
  v_mfma_f32_16x16x32_bf16 v[40:43], a[204:207], a[56:59], v[40:43]
  ds_read_b64_tr_b16 a[196:197], v241 offset:22528
  v_mfma_f32_16x16x32_bf16 v[40:43], a[200:203], a[48:51], v[40:43]
  s_waitcnt vmcnt(20) lgkmcnt(11)
  s_barrier
  ds_read_b64_tr_b16 a[198:199], v241 offset:26624
  v_mfma_f32_16x16x32_bf16 v[48:51], a[208:211], a[48:51], v[48:51]
  ds_read_b64_tr_b16 a[200:201], v242 offset:14336
  v_mfma_f32_16x16x32_bf16 v[48:51], a[212:215], a[56:59], v[48:51]
  buffer_load_dwordx4 v134, s[24:27], s50 offen offset:1024 lds
  ds_read_b64_tr_b16 a[202:203], v242 offset:18432
  v_mfma_f32_16x16x32_bf16 v[52:55], a[212:215], a[60:63], v[52:55]
  ds_read_b64_tr_b16 a[204:205], v242 offset:22528
  v_mfma_f32_16x16x32_bf16 v[52:55], a[208:211], a[52:55], v[52:55]
  s_waitcnt lgkmcnt(11)
  ds_read_b64_tr_b16 a[206:207], v242 offset:26624
  v_mfma_f32_16x16x32_bf16 v[60:63], a[176:179], a[52:55], v[60:63]
  ds_read_b64_tr_b16 a[208:209], v243 offset:14336
  v_mfma_f32_16x16x32_bf16 v[60:63], a[180:183], a[60:63], v[60:63]
  buffer_load_dwordx4 a[116:119], v137, s[36:39], s51 offen offset:1024 sc1
  ds_read_b64_tr_b16 a[210:211], v243 offset:18432
  v_mfma_f32_16x16x32_bf16 v[56:59], a[180:183], a[56:59], v[56:59]
  ds_read_b64_tr_b16 a[212:213], v243 offset:22528
  v_mfma_f32_16x16x32_bf16 v[56:59], a[176:179], a[48:51], v[56:59]
  s_waitcnt lgkmcnt(11)
  ds_read_b64_tr_b16 a[214:215], v243 offset:26624
  v_mfma_f32_16x16x32_bf16 v[144:147], a[184:187], a[48:51], v[144:147]
  ds_read_b64_tr_b16 a[176:177], v240 offset:28672
  v_mfma_f32_16x16x32_bf16 v[144:147], a[188:191], a[56:59], v[144:147]
  buffer_load_dwordx4 v135, s[24:27], s50 offen offset:2048 lds
  s_add_u32 s51, s51, 6144
  v_mfma_f32_16x16x32_bf16 v[148:151], a[188:191], a[60:63], v[148:151]
  ds_read_b64_tr_b16 a[178:179], v240 offset:32768
  ds_read_b64_tr_b16 a[180:181], v240 offset:36864
  v_mfma_f32_16x16x32_bf16 v[148:151], a[184:187], a[52:55], v[148:151]
  s_waitcnt lgkmcnt(11)
  ds_read_b64_tr_b16 a[182:183], v240 offset:40960
  v_mfma_f32_16x16x32_bf16 v[156:159], a[192:195], a[52:55], v[156:159]
  ds_read_b64_tr_b16 a[184:185], v241 offset:28672
  v_mfma_f32_16x16x32_bf16 v[156:159], a[196:199], a[60:63], v[156:159]
  buffer_load_dwordx4 a[120:123], v137, s[36:39], s51 offen offset:2048 sc1
  ds_read_b64_tr_b16 a[186:187], v241 offset:32768
  v_mfma_f32_16x16x32_bf16 v[152:155], a[196:199], a[56:59], v[152:155]
  s_add_u32 s78, s70, 126976
  ds_read_b64_tr_b16 a[188:189], v241 offset:36864
  v_and_b32 v129, 15, v128
  v_mfma_f32_16x16x32_bf16 v[152:155], a[192:195], a[48:51], v[152:155]
  s_waitcnt lgkmcnt(11)
  ds_read_b64_tr_b16 a[190:191], v241 offset:40960
  v_lshrrev_b32 v131, 1, v129
  v_mfma_f32_16x16x32_bf16 v[160:163], a[200:203], a[48:51], v[160:163]
  ds_read_b64_tr_b16 a[192:193], v242 offset:28672
  v_lshrrev_b32 v130, 5, v128
  v_mfma_f32_16x16x32_bf16 v[160:163], a[204:207], a[56:59], v[160:163]
  buffer_load_dwordx4 v136, s[24:27], s50 offen offset:3072 lds
  ds_read_b64_tr_b16 a[194:195], v242 offset:32768
  v_mfma_f32_16x16x32_bf16 v[164:167], a[204:207], a[60:63], v[164:167]
  ds_read_b64_tr_b16 a[196:197], v242 offset:36864
  v_xor_b32 v131, v131, v130
  v_mfma_f32_16x16x32_bf16 v[164:167], a[200:203], a[52:55], v[164:167]
  s_waitcnt lgkmcnt(11)
  ds_read_b64_tr_b16 a[198:199], v242 offset:40960
  v_lshlrev_b32 v131, 4, v131
  v_mfma_f32_16x16x32_bf16 v[172:175], a[208:211], a[52:55], v[172:175]
  ds_read_b64_tr_b16 a[200:201], v243 offset:28672
  v_lshl_add_u32 v131, v129, 7, v131
  v_mfma_f32_16x16x32_bf16 v[172:175], a[212:215], a[60:63], v[172:175]
  buffer_load_dwordx4 a[124:127], v137, s[36:39], s51 offen offset:3072 sc1
  s_cmp_eq_u32 s87, 1
  v_mfma_f32_16x16x32_bf16 v[168:171], a[212:215], a[56:59], v[168:171]
  s_cselect_b32 s83, 49, 35
  s_cmp_eq_u32 s87, 3
  s_cselect_b32 s83, 21, s83
  v_mfma_f32_16x16x32_bf16 v[168:171], a[208:211], a[48:51], v[168:171]
  s_waitcnt vmcnt(25) lgkmcnt(9)
  s_lshl_b32 s50, s83, 16
  s_add_u32 s50, s50, s88
  v_mfma_f32_16x16x32_bf16 v[32:35], a[176:179], a[64:67], v[32:35]
  s_add_u32 m0, s70, 94208
  ds_read_b64_tr_b16 a[202:203], v243 offset:32768
  ds_read_b64_tr_b16 a[204:205], v243 offset:36864
  v_mfma_f32_16x16x32_bf16 v[32:35], a[180:183], a[72:75], v[32:35]
  ds_read_b64_tr_b16 a[206:207], v243 offset:40960
  ds_read_b64_tr_b16 a[208:209], v240 offset:30720
  v_mfma_f32_16x16x32_bf16 v[36:39], a[180:183], a[76:79], v[36:39]
  buffer_load_dwordx4 v133, s[24:27], s50 offen offset:0 lds
  s_lshl_b32 s51, s83, 11
  v_mfma_f32_16x16x32_bf16 v[36:39], a[176:179], a[68:71], v[36:39]
  s_waitcnt lgkmcnt(9)
  ds_read_b64_tr_b16 a[210:211], v240 offset:34816
  ds_read_b64_tr_b16 a[212:213], v240 offset:38912
  v_mfma_f32_16x16x32_bf16 v[44:47], a[184:187], a[68:71], v[44:47]
  ds_read_b64_tr_b16 a[214:215], v240 offset:43008
  ds_read_b64_tr_b16 a[176:177], v241 offset:30720
  v_mfma_f32_16x16x32_bf16 v[44:47], a[188:191], a[76:79], v[44:47]
  buffer_load_dwordx4 a[128:131], v137, s[36:39], s51 offen offset:0 sc1
  ds_read_b64_tr_b16 a[178:179], v241 offset:34816
  v_mfma_f32_16x16x32_bf16 v[40:43], a[188:191], a[72:75], v[40:43]
  ds_read_b64_tr_b16 a[180:181], v241 offset:38912
  v_bfe_u32 v130, v128, 4, 1
  v_mfma_f32_16x16x32_bf16 v[40:43], a[184:187], a[64:67], v[40:43]
  s_waitcnt vmcnt(20) lgkmcnt(11)
  s_barrier
  ds_read_b64_tr_b16 a[182:183], v241 offset:43008
  v_mfma_f32_16x16x32_bf16 v[48:51], a[192:195], a[64:67], v[48:51]
  ds_read_b64_tr_b16 a[184:185], v242 offset:30720
  v_lshl_add_u32 v131, v130, 3, v131
  v_mfma_f32_16x16x32_bf16 v[48:51], a[196:199], a[72:75], v[48:51]
  buffer_load_dwordx4 v134, s[24:27], s50 offen offset:1024 lds
  ds_read_b64_tr_b16 a[186:187], v242 offset:34816
  v_mfma_f32_16x16x32_bf16 v[52:55], a[196:199], a[76:79], v[52:55]
  ds_read_b64_tr_b16 a[188:189], v242 offset:38912
  v_add_u32 v140, s78, v131
  v_mfma_f32_16x16x32_bf16 v[52:55], a[192:195], a[68:71], v[52:55]
  s_waitcnt lgkmcnt(11)
  ds_read_b64_tr_b16 a[190:191], v242 offset:43008
  v_xor_b32 v141, 32, v140
  v_mfma_f32_16x16x32_bf16 v[60:63], a[200:203], a[68:71], v[60:63]
  ds_read_b64_tr_b16 a[192:193], v243 offset:30720
  v_xor_b32 v142, 64, v140
  v_mfma_f32_16x16x32_bf16 v[60:63], a[204:207], a[76:79], v[60:63]
  buffer_load_dwordx4 a[132:135], v137, s[36:39], s51 offen offset:1024 sc1
  ds_read_b64_tr_b16 a[194:195], v243 offset:34816
  v_mfma_f32_16x16x32_bf16 v[56:59], a[204:207], a[72:75], v[56:59]
  ds_read_b64_tr_b16 a[196:197], v243 offset:38912
  v_xor_b32 v143, 96, v140
  v_mfma_f32_16x16x32_bf16 v[56:59], a[200:203], a[64:67], v[56:59]
  s_waitcnt lgkmcnt(11)
  ds_read_b64_tr_b16 a[198:199], v243 offset:43008
  v_add_u32 v254, s78, v0
  v_mfma_f32_16x16x32_bf16 v[144:147], a[208:211], a[64:67], v[144:147]
  s_lshl_b32 s78, s44, 10
  buffer_load_dwordx4 v135, s[24:27], s50 offen offset:2048 lds
  s_add_u32 s51, s51, 6144
  v_mfma_f32_16x16x32_bf16 v[144:147], a[212:215], a[72:75], v[144:147]
  s_add_u32 s78, s78, 0
  ds_read_b64_tr_b16 a[200:201], v240 offset:45056
  ds_read_b64_tr_b16 a[202:203], v240 offset:49152
  v_mfma_f32_16x16x32_bf16 v[148:151], a[212:215], a[76:79], v[148:151]
  ds_read_b64_tr_b16 a[204:205], v240 offset:53248
  v_add_u32 v129, s78, v0
  v_mfma_f32_16x16x32_bf16 v[148:151], a[208:211], a[68:71], v[148:151]
  s_waitcnt lgkmcnt(11)
  ds_read_b64_tr_b16 a[206:207], v240 offset:57344
  v_lshrrev_b32 v130, 4, v128
  v_mfma_f32_16x16x32_bf16 v[156:159], a[176:179], a[68:71], v[156:159]
  buffer_load_dwordx4 a[136:139], v137, s[36:39], s51 offen offset:2048 sc1
  ds_read_b64_tr_b16 a[208:209], v241 offset:45056
  v_mfma_f32_16x16x32_bf16 v[156:159], a[180:183], a[76:79], v[156:159]
  ds_read_b64_tr_b16 a[210:211], v241 offset:49152
  v_lshl_add_u32 v130, v130, 4, s78
  v_mfma_f32_16x16x32_bf16 v[152:155], a[180:183], a[72:75], v[152:155]
  ds_read_b64_tr_b16 a[212:213], v241 offset:53248
  ds_write_b128 v129, a[248:251]
  v_mfma_f32_16x16x32_bf16 v[152:155], a[176:179], a[64:67], v[152:155]
  s_waitcnt lgkmcnt(12)
  ds_read_b64_tr_b16 a[214:215], v241 offset:57344
  ds_read_b128 v[176:179], v130 offset:768
  v_mfma_f32_16x16x32_bf16 v[160:163], a[184:187], a[64:67], v[160:163]
  buffer_load_dwordx4 v136, s[24:27], s50 offen offset:3072 lds
  ds_read_b64_tr_b16 a[176:177], v242 offset:45056
  v_mfma_f32_16x16x32_bf16 v[160:163], a[188:191], a[72:75], v[160:163]
  ds_read_b64_tr_b16 a[178:179], v242 offset:49152
  ds_read_b128 v[180:183], v130 offset:832
  v_mfma_f32_16x16x32_bf16 v[164:167], a[188:191], a[76:79], v[164:167]
  ds_read_b64_tr_b16 a[180:181], v242 offset:53248
  ds_read_b128 v[184:187], v130 offset:896
  v_mfma_f32_16x16x32_bf16 v[164:167], a[184:187], a[68:71], v[164:167]
  s_waitcnt lgkmcnt(15)
  ds_read_b64_tr_b16 a[182:183], v242 offset:57344
  ds_read_b128 v[188:191], v130 offset:960
  v_mfma_f32_16x16x32_bf16 v[172:175], a[192:195], a[68:71], v[172:175]
  buffer_load_dwordx4 a[140:143], v137, s[36:39], s51 offen offset:3072 sc1
  s_cmp_eq_u32 s87, 0
  v_mfma_f32_16x16x32_bf16 v[172:175], a[196:199], a[76:79], v[172:175]
  s_cselect_b32 s69, 28, 42
  s_lshl_b32 s50, s69, 16
  s_add_u32 s50, s50, s88
  v_mfma_f32_16x16x32_bf16 v[168:171], a[196:199], a[72:75], v[168:171]
  s_add_u32 m0, s70, 110592
  ds_read_b64_tr_b16 a[184:185], v243 offset:45056
  ds_read_b64_tr_b16 a[186:187], v243 offset:49152
  v_mfma_f32_16x16x32_bf16 v[168:171], a[192:195], a[64:67], v[168:171]
  s_waitcnt vmcnt(25) lgkmcnt(15)
  ds_read_b64_tr_b16 a[188:189], v243 offset:53248
  ds_read_b64_tr_b16 a[190:191], v243 offset:57344
  v_mfma_f32_16x16x32_bf16 v[32:35], a[200:203], a[80:83], v[32:35]
  buffer_load_dwordx4 v133, s[24:27], s50 offen offset:0 lds
  s_lshl_b32 s51, s69, 11
  v_mfma_f32_16x16x32_bf16 v[32:35], a[204:207], a[88:91], v[32:35]
  ds_read_b64_tr_b16 a[192:193], v240 offset:47104
  ds_read_b64_tr_b16 a[194:195], v240 offset:51200
  v_mfma_f32_16x16x32_bf16 v[36:39], a[204:207], a[92:95], v[36:39]
  ds_read_b64_tr_b16 a[196:197], v240 offset:55296
  v_accvgpr_read_b32 v131, a232
  v_mfma_f32_16x16x32_bf16 v[36:39], a[200:203], a[84:87], v[36:39]
  s_waitcnt lgkmcnt(15)
  ds_read_b64_tr_b16 a[198:199], v240 offset:59392
  v_lshlrev_b32 v64, 16, v131
  v_mfma_f32_16x16x32_bf16 v[44:47], a[208:211], a[84:87], v[44:47]
  buffer_load_dwordx4 a[216:219], v137, s[36:39], s51 offen offset:0 sc1
  ds_read_b64_tr_b16 a[200:201], v241 offset:47104
  v_mfma_f32_16x16x32_bf16 v[44:47], a[212:215], a[92:95], v[44:47]
  ds_read_b64_tr_b16 a[202:203], v241 offset:51200
  v_and_b32 v65, 0xffff0000, v131
  v_mfma_f32_16x16x32_bf16 v[40:43], a[212:215], a[88:91], v[40:43]
  ds_read_b64_tr_b16 a[204:205], v241 offset:55296
  v_accvgpr_read_b32 v131, a233
  v_mfma_f32_16x16x32_bf16 v[40:43], a[208:211], a[80:83], v[40:43]
  s_waitcnt vmcnt(19) lgkmcnt(12)
  s_barrier
  ds_read_b64_tr_b16 a[206:207], v241 offset:59392
  v_mfma_f32_16x16x32_bf16 v[48:51], a[176:179], a[80:83], v[48:51]
  buffer_load_dwordx4 v134, s[24:27], s50 offen offset:1024 lds
  ds_read_b64_tr_b16 a[208:209], v242 offset:47104
  v_mfma_f32_16x16x32_bf16 v[48:51], a[180:183], a[88:91], v[48:51]
  ds_read_b64_tr_b16 a[210:211], v242 offset:51200
  v_lshlrev_b32 v66, 16, v131
  v_mfma_f32_16x16x32_bf16 v[52:55], a[180:183], a[92:95], v[52:55]
  ds_read_b64_tr_b16 a[212:213], v242 offset:55296
  v_and_b32 v67, 0xffff0000, v131
  v_mfma_f32_16x16x32_bf16 v[52:55], a[176:179], a[84:87], v[52:55]
  s_waitcnt lgkmcnt(11)
  ds_read_b64_tr_b16 a[214:215], v242 offset:59392
  v_accvgpr_read_b32 v131, a234
  v_mfma_f32_16x16x32_bf16 v[60:63], a[184:187], a[84:87], v[60:63]
  buffer_load_dwordx4 a[220:223], v137, s[36:39], s51 offen offset:1024 sc1
  ds_read_b64_tr_b16 a[176:177], v243 offset:47104
  v_mfma_f32_16x16x32_bf16 v[60:63], a[188:191], a[92:95], v[60:63]
  ds_read_b64_tr_b16 a[178:179], v243 offset:51200
  v_lshlrev_b32 v68, 16, v131
  v_mfma_f32_16x16x32_bf16 v[56:59], a[188:191], a[88:91], v[56:59]
  ds_read_b64_tr_b16 a[180:181], v243 offset:55296
  v_and_b32 v69, 0xffff0000, v131
  v_mfma_f32_16x16x32_bf16 v[56:59], a[184:187], a[80:83], v[56:59]
  s_waitcnt lgkmcnt(11)
  buffer_load_dword v139, v138, s[36:39], s91 offen sc1
  ds_read_b64_tr_b16 a[182:183], v243 offset:59392
  v_mfma_f32_16x16x32_bf16 v[144:147], a[192:195], a[80:83], v[144:147]
  ds_read_b64_tr_b16 a[184:185], v240 offset:61440
  v_accvgpr_read_b32 v131, a235
  v_mfma_f32_16x16x32_bf16 v[144:147], a[196:199], a[88:91], v[144:147]
  ds_read_b64_tr_b16 a[186:187], v244 offset:0
  v_lshlrev_b32 v70, 16, v131
  v_mfma_f32_16x16x32_bf16 v[148:151], a[196:199], a[92:95], v[148:151]
  buffer_load_dwordx4 v135, s[24:27], s50 offen offset:2048 lds
  s_add_u32 s51, s51, 6144
  v_mfma_f32_16x16x32_bf16 v[148:151], a[192:195], a[84:87], v[148:151]
  s_waitcnt lgkmcnt(10)
  ds_read_b64_tr_b16 a[188:189], v244 offset:4096
  ds_read_b64_tr_b16 a[190:191], v244 offset:8192
  v_mfma_f32_16x16x32_bf16 v[156:159], a[200:203], a[84:87], v[156:159]
  ds_read_b64_tr_b16 a[192:193], v241 offset:61440
  v_and_b32 v71, 0xffff0000, v131
  v_mfma_f32_16x16x32_bf16 v[156:159], a[204:207], a[92:95], v[156:159]
  buffer_load_dwordx4 a[224:227], v137, s[36:39], s51 offen offset:2048 sc1
  ds_read_b64_tr_b16 a[194:195], v245 offset:0
  v_mfma_f32_16x16x32_bf16 v[152:155], a[204:207], a[88:91], v[152:155]
  ds_read_b64_tr_b16 a[196:197], v245 offset:4096
  v_accvgpr_read_b32 v131, a236
  v_mfma_f32_16x16x32_bf16 v[152:155], a[200:203], a[80:83], v[152:155]
  s_waitcnt lgkmcnt(11)
  ds_read_b64_tr_b16 a[198:199], v245 offset:8192
  v_lshlrev_b32 v72, 16, v131
  v_mfma_f32_16x16x32_bf16 v[160:163], a[208:211], a[80:83], v[160:163]
  buffer_load_dwordx4 v136, s[24:27], s50 offen offset:3072 lds
  ds_read_b64_tr_b16 a[200:201], v242 offset:61440
  v_mfma_f32_16x16x32_bf16 v[160:163], a[212:215], a[88:91], v[160:163]
  ds_read_b64_tr_b16 a[202:203], v246 offset:0
  v_and_b32 v73, 0xffff0000, v131
  v_mfma_f32_16x16x32_bf16 v[164:167], a[212:215], a[92:95], v[164:167]
  ds_read_b64_tr_b16 a[204:205], v246 offset:4096
  v_accvgpr_read_b32 v131, a237
  v_mfma_f32_16x16x32_bf16 v[164:167], a[208:211], a[84:87], v[164:167]
  s_waitcnt lgkmcnt(11)
  ds_read_b64_tr_b16 a[206:207], v246 offset:8192
  v_lshlrev_b32 v74, 16, v131
  v_mfma_f32_16x16x32_bf16 v[172:175], a[176:179], a[84:87], v[172:175]
  buffer_load_dwordx4 a[228:231], v137, s[36:39], s51 offen offset:3072 sc1
  s_cmp_eq_u32 s87, 1
  v_mfma_f32_16x16x32_bf16 v[172:175], a[180:183], a[92:95], v[172:175]
  s_cselect_b32 s71, 35, 49
  s_lshl_b32 s50, s71, 16
  s_add_u32 s50, s50, s88
  v_mfma_f32_16x16x32_bf16 v[168:171], a[180:183], a[88:91], v[168:171]
  s_add_u32 m0, s70, 126976
  ds_read_b64_tr_b16 a[208:209], v243 offset:61440
  ds_read_b64_tr_b16 a[210:211], v247 offset:0
  v_mfma_f32_16x16x32_bf16 v[168:171], a[176:179], a[80:83], v[168:171]
  s_waitcnt vmcnt(25) lgkmcnt(10)
  ds_read_b64_tr_b16 a[212:213], v247 offset:4096
  ds_read_b64_tr_b16 a[214:215], v247 offset:8192
  v_mfma_f32_16x16x32_bf16 v[32:35], a[184:187], a[96:99], v[32:35]
  buffer_load_dwordx4 v133, s[24:27], s50 offen offset:0 lds
  s_lshl_b32 s51, s71, 11
  v_mfma_f32_16x16x32_bf16 v[32:35], a[188:191], a[104:107], v[32:35]
  ds_read_b64_tr_b16 a[176:177], v240 offset:63488
  ds_read_b64_tr_b16 a[178:179], v244 offset:2048
  v_mfma_f32_16x16x32_bf16 v[36:39], a[188:191], a[108:111], v[36:39]
  ds_read_b64_tr_b16 a[180:181], v244 offset:6144
  v_and_b32 v75, 0xffff0000, v131
  v_mfma_f32_16x16x32_bf16 v[36:39], a[184:187], a[100:103], v[36:39]
  s_waitcnt lgkmcnt(11)
  ds_read_b64_tr_b16 a[182:183], v244 offset:10240
  v_accvgpr_read_b32 v131, a238
  v_mfma_f32_16x16x32_bf16 v[44:47], a[192:195], a[100:103], v[44:47]
  buffer_load_dwordx4 a[0:3], v137, s[36:39], s51 offen offset:0 sc1
  ds_read_b64_tr_b16 a[184:185], v241 offset:63488
  v_mfma_f32_16x16x32_bf16 v[44:47], a[196:199], a[108:111], v[44:47]
  ds_read_b64_tr_b16 a[186:187], v245 offset:2048
  v_lshlrev_b32 v76, 16, v131
  v_mfma_f32_16x16x32_bf16 v[40:43], a[196:199], a[104:107], v[40:43]
  ds_read_b64_tr_b16 a[188:189], v245 offset:6144
  v_and_b32 v77, 0xffff0000, v131
  v_mfma_f32_16x16x32_bf16 v[40:43], a[192:195], a[96:99], v[40:43]
  s_waitcnt vmcnt(20) lgkmcnt(11)
  s_barrier
  ds_read_b64_tr_b16 a[190:191], v245 offset:10240
  v_mfma_f32_16x16x32_bf16 v[48:51], a[200:203], a[96:99], v[48:51]
  buffer_load_dwordx4 v134, s[24:27], s50 offen offset:1024 lds
  ds_read_b64_tr_b16 a[192:193], v242 offset:63488
  v_mfma_f32_16x16x32_bf16 v[48:51], a[204:207], a[104:107], v[48:51]
  ds_read_b64_tr_b16 a[194:195], v246 offset:2048
  v_accvgpr_read_b32 v131, a239
  v_mfma_f32_16x16x32_bf16 v[52:55], a[204:207], a[108:111], v[52:55]
  ds_read_b64_tr_b16 a[196:197], v246 offset:6144
  v_lshlrev_b32 v78, 16, v131
  v_mfma_f32_16x16x32_bf16 v[52:55], a[200:203], a[100:103], v[52:55]
  s_waitcnt lgkmcnt(11)
  buffer_load_dwordx4 a[4:7], v137, s[36:39], s51 offen offset:1024 sc1
  ds_read_b64_tr_b16 a[198:199], v246 offset:10240
  v_mfma_f32_16x16x32_bf16 v[60:63], a[208:211], a[100:103], v[60:63]
  ds_read_b64_tr_b16 a[200:201], v243 offset:63488
  v_and_b32 v79, 0xffff0000, v131
  v_mfma_f32_16x16x32_bf16 v[60:63], a[212:215], a[108:111], v[60:63]
  ds_read_b64_tr_b16 a[202:203], v247 offset:2048
  v_accvgpr_read_b32 v131, a240
  v_mfma_f32_16x16x32_bf16 v[56:59], a[212:215], a[104:107], v[56:59]
  ds_read_b64_tr_b16 a[204:205], v247 offset:6144
  v_lshlrev_b32 v80, 16, v131
  v_mfma_f32_16x16x32_bf16 v[56:59], a[208:211], a[96:99], v[56:59]
  s_waitcnt lgkmcnt(11)
  buffer_load_dwordx4 v135, s[24:27], s50 offen offset:2048 lds
  s_add_u32 s51, s51, 6144
  v_mfma_f32_16x16x32_bf16 v[144:147], a[176:179], a[96:99], v[144:147]
  ds_read_b64_tr_b16 a[206:207], v247 offset:10240
  ds_read_b64_tr_b16 a[208:209], v244 offset:12288
  v_mfma_f32_16x16x32_bf16 v[144:147], a[180:183], a[104:107], v[144:147]
  ds_read_b64_tr_b16 a[210:211], v244 offset:16384
  v_and_b32 v81, 0xffff0000, v131
  v_mfma_f32_16x16x32_bf16 v[148:151], a[180:183], a[108:111], v[148:151]
  ds_read_b64_tr_b16 a[212:213], v244 offset:20480
  v_accvgpr_read_b32 v131, a241
  v_mfma_f32_16x16x32_bf16 v[148:151], a[176:179], a[100:103], v[148:151]
  s_waitcnt lgkmcnt(11)
  buffer_load_dwordx4 a[8:11], v137, s[36:39], s51 offen offset:2048 sc1
  ds_read_b64_tr_b16 a[214:215], v244 offset:24576
  v_mfma_f32_16x16x32_bf16 v[156:159], a[184:187], a[100:103], v[156:159]
  ds_read_b64_tr_b16 a[176:177], v245 offset:12288
  v_lshlrev_b32 v82, 16, v131
  v_mfma_f32_16x16x32_bf16 v[156:159], a[188:191], a[108:111], v[156:159]
  ds_read_b64_tr_b16 a[178:179], v245 offset:16384
  v_and_b32 v83, 0xffff0000, v131
  v_mfma_f32_16x16x32_bf16 v[152:155], a[188:191], a[104:107], v[152:155]
  ds_read_b64_tr_b16 a[180:181], v245 offset:20480
  v_accvgpr_read_b32 v131, a242
  v_mfma_f32_16x16x32_bf16 v[152:155], a[184:187], a[96:99], v[152:155]
  s_waitcnt lgkmcnt(11)
  buffer_load_dwordx4 v136, s[24:27], s50 offen offset:3072 lds
  ds_read_b64_tr_b16 a[182:183], v245 offset:24576
  v_mfma_f32_16x16x32_bf16 v[160:163], a[192:195], a[96:99], v[160:163]
  ds_read_b64_tr_b16 a[184:185], v246 offset:12288
  v_lshlrev_b32 v84, 16, v131
  v_mfma_f32_16x16x32_bf16 v[160:163], a[196:199], a[104:107], v[160:163]
  ds_read_b64_tr_b16 a[186:187], v246 offset:16384
  v_and_b32 v85, 0xffff0000, v131
  v_mfma_f32_16x16x32_bf16 v[164:167], a[196:199], a[108:111], v[164:167]
  ds_read_b64_tr_b16 a[188:189], v246 offset:20480
  v_accvgpr_read_b32 v131, a243
  v_mfma_f32_16x16x32_bf16 v[164:167], a[192:195], a[100:103], v[164:167]
  s_waitcnt lgkmcnt(11)
  buffer_load_dwordx4 a[12:15], v137, s[36:39], s51 offen offset:3072 sc1
  s_cmp_eq_u32 s87, 0
  v_mfma_f32_16x16x32_bf16 v[172:175], a[200:203], a[100:103], v[172:175]
  s_cselect_b32 s72, 8, 1
  s_lshl_b32 s50, s72, 16
  s_add_u32 m0, s70, 143360
  v_mfma_f32_16x16x32_bf16 v[172:175], a[204:207], a[108:111], v[172:175]
  ds_read_b64_tr_b16 a[190:191], v246 offset:24576
  ds_read_b64_tr_b16 a[192:193], v247 offset:12288
  v_mfma_f32_16x16x32_bf16 v[168:171], a[204:207], a[104:107], v[168:171]
  ds_read_b64_tr_b16 a[194:195], v247 offset:16384
  ds_read_b64_tr_b16 a[196:197], v247 offset:20480
  v_mfma_f32_16x16x32_bf16 v[168:171], a[200:203], a[96:99], v[168:171]
  s_waitcnt vmcnt(25) lgkmcnt(11)
  buffer_load_dwordx4 v133, s[24:27], s50 offen offset:0 lds
  ds_read_b64_tr_b16 a[198:199], v247 offset:24576
  v_mfma_f32_16x16x32_bf16 v[32:35], a[208:211], a[112:115], v[32:35]
  s_waitcnt vmcnt(13)
  v_cmp_ne_u32 vcc, s3, v139
  s_nop 4
  s_cbranch_vccnz CK11s
CK11x:
  v_mfma_f32_16x16x32_bf16 v[32:35], a[212:215], a[120:123], v[32:35]
  s_lshl_b32 s51, s72, 11
  s_add_u32 s91, s91, 32768
  ds_read_b64_tr_b16 a[200:201], v244 offset:14336
  v_mfma_f32_16x16x32_bf16 v[36:39], a[212:215], a[124:127], v[36:39]
  ds_read_b64_tr_b16 a[202:203], v244 offset:18432
  ds_read_b64_tr_b16 a[204:205], v244 offset:22528
  v_mfma_f32_16x16x32_bf16 v[36:39], a[208:211], a[116:119], v[36:39]
  s_waitcnt lgkmcnt(11)
  buffer_load_dwordx4 a[16:19], v137, s[36:39], s51 offen offset:0 sc1
  ds_read_b64_tr_b16 a[206:207], v244 offset:26624
  v_mfma_f32_16x16x32_bf16 v[44:47], a[176:179], a[116:119], v[44:47]
  ds_read_b64_tr_b16 a[208:209], v245 offset:14336
  v_lshlrev_b32 v86, 16, v131
  v_mfma_f32_16x16x32_bf16 v[44:47], a[180:183], a[124:127], v[44:47]
  ds_read_b64_tr_b16 a[210:211], v245 offset:18432
  v_and_b32 v87, 0xffff0000, v131
  v_mfma_f32_16x16x32_bf16 v[40:43], a[180:183], a[120:123], v[40:43]
  ds_read_b64_tr_b16 a[212:213], v245 offset:22528
  v_accvgpr_read_b32 v131, a244
  v_mfma_f32_16x16x32_bf16 v[40:43], a[176:179], a[112:115], v[40:43]
  s_waitcnt vmcnt(20) lgkmcnt(11)
  s_barrier
  buffer_load_dwordx4 v134, s[24:27], s50 offen offset:1024 lds
  v_mfma_f32_16x16x32_bf16 v[48:51], a[184:187], a[112:115], v[48:51]
  ds_read_b64_tr_b16 a[214:215], v245 offset:26624
  ds_read_b64_tr_b16 a[176:177], v246 offset:14336
  v_mfma_f32_16x16x32_bf16 v[48:51], a[188:191], a[120:123], v[48:51]
  ds_read_b64_tr_b16 a[178:179], v246 offset:18432
  v_lshlrev_b32 v88, 16, v131
  v_mfma_f32_16x16x32_bf16 v[52:55], a[188:191], a[124:127], v[52:55]
  ds_read_b64_tr_b16 a[180:181], v246 offset:22528
  v_and_b32 v89, 0xffff0000, v131
  v_mfma_f32_16x16x32_bf16 v[52:55], a[184:187], a[116:119], v[52:55]
  s_waitcnt lgkmcnt(11)
  buffer_load_dwordx4 a[20:23], v137, s[36:39], s51 offen offset:1024 sc1
  ds_read_b64_tr_b16 a[182:183], v246 offset:26624
  v_mfma_f32_16x16x32_bf16 v[60:63], a[192:195], a[116:119], v[60:63]
  ds_read_b64_tr_b16 a[184:185], v247 offset:14336
  v_accvgpr_read_b32 v131, a245
  v_mfma_f32_16x16x32_bf16 v[60:63], a[196:199], a[124:127], v[60:63]
  ds_read_b64_tr_b16 a[186:187], v247 offset:18432
  v_lshlrev_b32 v90, 16, v131
  v_mfma_f32_16x16x32_bf16 v[56:59], a[196:199], a[120:123], v[56:59]
  ds_read_b64_tr_b16 a[188:189], v247 offset:22528
  v_and_b32 v91, 0xffff0000, v131
  v_mfma_f32_16x16x32_bf16 v[56:59], a[192:195], a[112:115], v[56:59]
  s_waitcnt lgkmcnt(11)
  buffer_load_dwordx4 v135, s[24:27], s50 offen offset:2048 lds
  ds_read_b64_tr_b16 a[190:191], v247 offset:26624
  v_mfma_f32_16x16x32_bf16 v[144:147], a[200:203], a[112:115], v[144:147]
  ds_read_b64_tr_b16 a[192:193], v244 offset:28672
  v_accvgpr_read_b32 v131, a246
  v_mfma_f32_16x16x32_bf16 v[144:147], a[204:207], a[120:123], v[144:147]
  ds_read_b64_tr_b16 a[194:195], v244 offset:32768
  v_lshlrev_b32 v92, 16, v131
  v_mfma_f32_16x16x32_bf16 v[148:151], a[204:207], a[124:127], v[148:151]
  ds_read_b64_tr_b16 a[196:197], v244 offset:36864
  v_and_b32 v93, 0xffff0000, v131
  v_mfma_f32_16x16x32_bf16 v[148:151], a[200:203], a[116:119], v[148:151]
  s_waitcnt lgkmcnt(11)
  buffer_load_dwordx4 a[24:27], v137, s[36:39], s51 offen offset:2048 sc1
  ds_read_b64_tr_b16 a[198:199], v244 offset:40960
  v_mfma_f32_16x16x32_bf16 v[156:159], a[208:211], a[116:119], v[156:159]
  ds_read_b64_tr_b16 a[200:201], v245 offset:28672
  v_accvgpr_read_b32 v131, a247
  v_mfma_f32_16x16x32_bf16 v[156:159], a[212:215], a[124:127], v[156:159]
  ds_read_b64_tr_b16 a[202:203], v245 offset:32768
  v_lshlrev_b32 v94, 16, v131
  v_mfma_f32_16x16x32_bf16 v[152:155], a[212:215], a[120:123], v[152:155]
  ds_read_b64_tr_b16 a[204:205], v245 offset:36864
  v_and_b32 v95, 0xffff0000, v131
  v_mfma_f32_16x16x32_bf16 v[152:155], a[208:211], a[112:115], v[152:155]
  s_waitcnt lgkmcnt(11)
  buffer_load_dwordx4 v136, s[24:27], s50 offen offset:3072 lds
  ds_read_b64_tr_b16 a[206:207], v245 offset:40960
  v_mfma_f32_16x16x32_bf16 v[160:163], a[176:179], a[112:115], v[160:163]
Hb1:
  s_cbranch_execz Hb1_1
  s_add_u32 s49, s55, 32768
  ds_read_b64_tr_b16 a[208:209], v246 offset:28672
  s_lshl_b32 s78, s2, 5
  v_mfma_f32_16x16x32_bf16 v[160:163], a[180:183], a[120:123], v[160:163]
  s_add_u32 s78, s78, s44
  ds_read_b64_tr_b16 a[210:211], v246 offset:32768
  s_lshl2_add_u32 s78, s78, 5472256
  v_mfma_f32_16x16x32_bf16 v[164:167], a[180:183], a[124:127], v[164:167]
  s_xor_b32 s79, s78, 128
  ds_read_b64_tr_b16 a[212:213], v246 offset:36864
  v_mov_b32 v132, 0
  v_mfma_f32_16x16x32_bf16 v[164:167], a[176:179], a[116:119], v[164:167]
  s_waitcnt lgkmcnt(11)
  buffer_load_dwordx4 a[28:31], v137, s[36:39], s51 offen offset:3072 sc1
  s_cmp_eq_u32 s87, 1
  v_mfma_f32_16x16x32_bf16 v[172:175], a[184:187], a[116:119], v[172:175]
  s_cselect_b32 s73, 12, 5
  s_lshl_b32 s50, s73, 16
  s_add_u32 m0, s70, 12288
  v_mfma_f32_16x16x32_bf16 v[172:175], a[188:191], a[124:127], v[172:175]
  ds_read_b64_tr_b16 a[214:215], v246 offset:40960
  ds_read_b64_tr_b16 a[176:177], v247 offset:28672
  v_mfma_f32_16x16x32_bf16 v[168:171], a[188:191], a[120:123], v[168:171]
  ds_read_b64_tr_b16 a[178:179], v247 offset:32768
  ds_read_b64_tr_b16 a[180:181], v247 offset:36864
  v_mfma_f32_16x16x32_bf16 v[168:171], a[184:187], a[112:115], v[168:171]
  s_waitcnt vmcnt(25) lgkmcnt(11)
  buffer_load_dwordx4 v133, s[24:27], s50 offen offset:0 lds
  s_lshl_b32 s51, s73, 11
  v_mfma_f32_16x16x32_bf16 v[32:35], a[192:195], a[128:131], v[32:35]
  ds_read_b64_tr_b16 a[182:183], v247 offset:40960
  ds_read_b64_tr_b16 a[184:185], v244 offset:30720
  v_mfma_f32_16x16x32_bf16 v[32:35], a[196:199], a[136:139], v[32:35]
  ds_read_b64_tr_b16 a[186:187], v244 offset:34816
  v_mfma_f32_16x16x32_bf16 v[36:39], a[196:199], a[140:143], v[36:39]
  buffer_load_dwordx4 a[32:35], v137, s[36:39], s51 offen offset:0 sc1
  ds_read_b64_tr_b16 a[188:189], v244 offset:38912
  v_mfma_f32_16x16x32_bf16 v[36:39], a[192:195], a[132:135], v[36:39]
  s_waitcnt lgkmcnt(11)
  ds_read_b64_tr_b16 a[190:191], v244 offset:43008
  v_mfma_f32_16x16x32_bf16 v[44:47], a[200:203], a[132:135], v[44:47]
  ds_read_b64_tr_b16 a[192:193], v245 offset:30720
  v_mfma_f32_16x16x32_bf16 v[44:47], a[204:207], a[140:143], v[44:47]
  ds_read_b64_tr_b16 a[194:195], v245 offset:34816
  v_mfma_f32_16x16x32_bf16 v[40:43], a[204:207], a[136:139], v[40:43]
  buffer_load_dwordx4 v134, s[24:27], s50 offen offset:1024 lds
  ds_read_b64_tr_b16 a[196:197], v245 offset:38912
  v_mfma_f32_16x16x32_bf16 v[40:43], a[200:203], a[128:131], v[40:43]
  s_waitcnt vmcnt(20) lgkmcnt(11)
  s_barrier
  ds_read_b64_tr_b16 a[198:199], v245 offset:43008
  v_mfma_f32_16x16x32_bf16 v[48:51], a[208:211], a[128:131], v[48:51]
  ds_read_b64_tr_b16 a[200:201], v246 offset:30720
  v_mfma_f32_16x16x32_bf16 v[48:51], a[212:215], a[136:139], v[48:51]
  ds_read_b64_tr_b16 a[202:203], v246 offset:34816
  v_mfma_f32_16x16x32_bf16 v[52:55], a[212:215], a[140:143], v[52:55]
  buffer_load_dwordx4 a[36:39], v137, s[36:39], s51 offen offset:1024 sc1
  ds_read_b64_tr_b16 a[204:205], v246 offset:38912
  v_mfma_f32_16x16x32_bf16 v[52:55], a[208:211], a[132:135], v[52:55]
  s_waitcnt lgkmcnt(11)
  ds_read_b64_tr_b16 a[206:207], v246 offset:43008
  v_mfma_f32_16x16x32_bf16 v[60:63], a[176:179], a[132:135], v[60:63]
  ds_read_b64_tr_b16 a[208:209], v247 offset:30720
  v_mfma_f32_16x16x32_bf16 v[60:63], a[180:183], a[140:143], v[60:63]
  ds_read_b64_tr_b16 a[210:211], v247 offset:34816
  v_mfma_f32_16x16x32_bf16 v[56:59], a[180:183], a[136:139], v[56:59]
  buffer_load_dwordx4 v135, s[24:27], s50 offen offset:2048 lds
  ds_read_b64_tr_b16 a[212:213], v247 offset:38912
  v_mfma_f32_16x16x32_bf16 v[56:59], a[176:179], a[128:131], v[56:59]
  s_waitcnt lgkmcnt(11)
  ds_read_b64_tr_b16 a[214:215], v247 offset:43008
  v_mfma_f32_16x16x32_bf16 v[144:147], a[184:187], a[128:131], v[144:147]
  ds_read_b64_tr_b16 a[176:177], v244 offset:45056
  v_mfma_f32_16x16x32_bf16 v[144:147], a[188:191], a[136:139], v[144:147]
  ds_read_b64_tr_b16 a[178:179], v244 offset:49152
  v_mfma_f32_16x16x32_bf16 v[148:151], a[188:191], a[140:143], v[148:151]
  buffer_load_dwordx4 a[40:43], v137, s[36:39], s51 offen offset:2048 sc1
  ds_read_b64_tr_b16 a[180:181], v244 offset:53248
  v_mfma_f32_16x16x32_bf16 v[148:151], a[184:187], a[132:135], v[148:151]
  s_waitcnt lgkmcnt(11)
  ds_read_b64_tr_b16 a[182:183], v244 offset:57344
  v_mfma_f32_16x16x32_bf16 v[156:159], a[192:195], a[132:135], v[156:159]
  ds_read_b64_tr_b16 a[184:185], v245 offset:45056
  v_mfma_f32_16x16x32_bf16 v[156:159], a[196:199], a[140:143], v[156:159]
  ds_read_b64_tr_b16 a[186:187], v245 offset:49152
  v_mfma_f32_16x16x32_bf16 v[152:155], a[196:199], a[136:139], v[152:155]
  buffer_load_dwordx4 v136, s[24:27], s50 offen offset:3072 lds
  ds_read_b64_tr_b16 a[188:189], v245 offset:53248
  v_mfma_f32_16x16x32_bf16 v[152:155], a[192:195], a[128:131], v[152:155]
  s_waitcnt lgkmcnt(11)
  ds_read_b64_tr_b16 a[190:191], v245 offset:57344
  v_mfma_f32_16x16x32_bf16 v[160:163], a[200:203], a[128:131], v[160:163]
  ds_read_b64_tr_b16 a[192:193], v246 offset:45056
  v_mfma_f32_16x16x32_bf16 v[160:163], a[204:207], a[136:139], v[160:163]
  ds_read_b64_tr_b16 a[194:195], v246 offset:49152
  v_mfma_f32_16x16x32_bf16 v[164:167], a[204:207], a[140:143], v[164:167]
  buffer_load_dwordx4 a[44:47], v137, s[36:39], s51 offen offset:3072 sc1
  s_cmp_eq_u32 s87, 0
  v_mfma_f32_16x16x32_bf16 v[164:167], a[200:203], a[132:135], v[164:167]
  s_waitcnt lgkmcnt(10)
  s_cselect_b32 s74, 1, 8
  s_cmp_eq_u32 s87, 2
  v_mfma_f32_16x16x32_bf16 v[172:175], a[208:211], a[132:135], v[172:175]
  s_cselect_b32 s74, 15, s74
  s_lshl_b32 s50, s74, 16
  s_add_u32 m0, s70, 28672
  v_mfma_f32_16x16x32_bf16 v[172:175], a[212:215], a[140:143], v[172:175]
  ds_read_b64_tr_b16 a[196:197], v246 offset:53248
  ds_read_b64_tr_b16 a[198:199], v246 offset:57344
  v_mfma_f32_16x16x32_bf16 v[168:171], a[212:215], a[136:139], v[168:171]
  ds_read_b64_tr_b16 a[200:201], v247 offset:45056
  ds_read_b64_tr_b16 a[202:203], v247 offset:49152
  v_mfma_f32_16x16x32_bf16 v[168:171], a[208:211], a[128:131], v[168:171]
  s_waitcnt vmcnt(24) lgkmcnt(10)
  buffer_load_dwordx4 v133, s[24:27], s50 offen offset:0 lds
  s_lshl_b32 s51, s74, 11
  v_mfma_f32_16x16x32_bf16 v[32:35], a[176:179], a[216:219], v[32:35]
  ds_read_b64_tr_b16 a[204:205], v247 offset:53248
  ds_read_b64_tr_b16 a[206:207], v247 offset:57344
  v_mfma_f32_16x16x32_bf16 v[32:35], a[180:183], a[224:227], v[32:35]
  ds_read_b64_tr_b16 a[208:209], v244 offset:47104
  ds_read_b64_tr_b16 a[210:211], v244 offset:51200
  v_mfma_f32_16x16x32_bf16 v[36:39], a[180:183], a[228:231], v[36:39]
  buffer_load_dwordx4 a[48:51], v137, s[36:39], s51 offen offset:0 sc1
  ds_read_b64_tr_b16 a[212:213], v244 offset:55296
  v_mfma_f32_16x16x32_bf16 v[36:39], a[176:179], a[220:223], v[36:39]
  s_waitcnt lgkmcnt(11)
  ds_read_b64_tr_b16 a[214:215], v244 offset:59392
  v_mfma_f32_16x16x32_bf16 v[44:47], a[184:187], a[220:223], v[44:47]
  ds_read_b64_tr_b16 a[176:177], v245 offset:47104
  v_mfma_f32_16x16x32_bf16 v[44:47], a[188:191], a[228:231], v[44:47]
  ds_read_b64_tr_b16 a[178:179], v245 offset:51200
  v_mfma_f32_16x16x32_bf16 v[40:43], a[188:191], a[224:227], v[40:43]
  buffer_load_dwordx4 v134, s[24:27], s50 offen offset:1024 lds
  ds_read_b64_tr_b16 a[180:181], v245 offset:55296
  v_mfma_f32_16x16x32_bf16 v[40:43], a[184:187], a[216:219], v[40:43]
  s_waitcnt vmcnt(20) lgkmcnt(11)
  s_barrier
  ds_read_b64_tr_b16 a[182:183], v245 offset:59392
  v_mfma_f32_16x16x32_bf16 v[48:51], a[192:195], a[216:219], v[48:51]
  ds_read_b64_tr_b16 a[184:185], v246 offset:47104
  v_mfma_f32_16x16x32_bf16 v[48:51], a[196:199], a[224:227], v[48:51]
  ds_read_b64_tr_b16 a[186:187], v246 offset:51200
  v_mfma_f32_16x16x32_bf16 v[52:55], a[196:199], a[228:231], v[52:55]
  buffer_load_dwordx4 a[52:55], v137, s[36:39], s51 offen offset:1024 sc1
  ds_read_b64_tr_b16 a[188:189], v246 offset:55296
  v_mfma_f32_16x16x32_bf16 v[52:55], a[192:195], a[220:223], v[52:55]
  s_waitcnt lgkmcnt(11)
  ds_read_b64_tr_b16 a[190:191], v246 offset:59392
  v_mfma_f32_16x16x32_bf16 v[60:63], a[200:203], a[220:223], v[60:63]
  ds_read_b64_tr_b16 a[192:193], v247 offset:47104
  v_mfma_f32_16x16x32_bf16 v[60:63], a[204:207], a[228:231], v[60:63]
  ds_read_b64_tr_b16 a[194:195], v247 offset:51200
  v_mfma_f32_16x16x32_bf16 v[56:59], a[204:207], a[224:227], v[56:59]
  buffer_load_dwordx4 v135, s[24:27], s50 offen offset:2048 lds
  ds_read_b64_tr_b16 a[196:197], v247 offset:55296
  v_mfma_f32_16x16x32_bf16 v[56:59], a[200:203], a[216:219], v[56:59]
  s_waitcnt lgkmcnt(11)
  ds_read_b64_tr_b16 a[198:199], v247 offset:59392
  v_mfma_f32_16x16x32_bf16 v[144:147], a[208:211], a[216:219], v[144:147]
  ds_read_b64_tr_b16 a[200:201], v244 offset:61440
  v_mfma_f32_16x16x32_bf16 v[144:147], a[212:215], a[224:227], v[144:147]
  ds_read_b64_tr_b16 a[202:203], v248 offset:0
  v_mfma_f32_16x16x32_bf16 v[148:151], a[212:215], a[228:231], v[148:151]
  buffer_load_dwordx4 a[56:59], v137, s[36:39], s51 offen offset:2048 sc1
  ds_read_b64_tr_b16 a[204:205], v248 offset:4096
  v_mfma_f32_16x16x32_bf16 v[148:151], a[208:211], a[220:223], v[148:151]
  s_waitcnt lgkmcnt(11)
  ds_read_b64_tr_b16 a[206:207], v248 offset:8192
  v_mfma_f32_16x16x32_bf16 v[156:159], a[176:179], a[220:223], v[156:159]
  ds_read_b64_tr_b16 a[208:209], v245 offset:61440
  v_mfma_f32_16x16x32_bf16 v[156:159], a[180:183], a[228:231], v[156:159]
  ds_read_b64_tr_b16 a[210:211], v249 offset:0
  v_mfma_f32_16x16x32_bf16 v[152:155], a[180:183], a[224:227], v[152:155]
  buffer_load_dwordx4 v136, s[24:27], s50 offen offset:3072 lds
  ds_read_b64_tr_b16 a[212:213], v249 offset:4096
  v_mfma_f32_16x16x32_bf16 v[152:155], a[176:179], a[216:219], v[152:155]
  s_waitcnt lgkmcnt(11)
  ds_read_b64_tr_b16 a[214:215], v249 offset:8192
  v_mfma_f32_16x16x32_bf16 v[160:163], a[184:187], a[216:219], v[160:163]
  ds_read_b64_tr_b16 a[176:177], v246 offset:61440
  v_mfma_f32_16x16x32_bf16 v[160:163], a[188:191], a[224:227], v[160:163]
  ds_read_b64_tr_b16 a[178:179], v250 offset:0
  v_mfma_f32_16x16x32_bf16 v[164:167], a[188:191], a[228:231], v[164:167]
  buffer_load_dwordx4 a[60:63], v137, s[36:39], s51 offen offset:3072 sc1
  s_cmp_eq_u32 s87, 1
  v_mfma_f32_16x16x32_bf16 v[164:167], a[184:187], a[220:223], v[164:167]
  s_waitcnt lgkmcnt(10)
  s_cselect_b32 s75, 5, 12
  s_cmp_eq_u32 s87, 3
  v_mfma_f32_16x16x32_bf16 v[172:175], a[192:195], a[220:223], v[172:175]
  s_cselect_b32 s75, 19, s75
  s_lshl_b32 s50, s75, 16
  s_add_u32 m0, s70, 45056
  v_mfma_f32_16x16x32_bf16 v[172:175], a[196:199], a[228:231], v[172:175]
  ds_read_b64_tr_b16 a[180:181], v250 offset:4096
  ds_read_b64_tr_b16 a[182:183], v250 offset:8192
  v_mfma_f32_16x16x32_bf16 v[168:171], a[196:199], a[224:227], v[168:171]
  ds_read_b64_tr_b16 a[184:185], v247 offset:61440
  buffer_load_dwordx4 v133, s[24:27], s50 offen offset:0 lds
  v_mfma_f32_16x16x32_bf16 v[168:171], a[192:195], a[216:219], v[168:171]
  s_waitcnt vmcnt(25) lgkmcnt(9)
  s_lshl_b32 s51, s75, 11
  ds_read_b64_tr_b16 a[186:187], v251 offset:0
  v_mfma_f32_16x16x32_bf16 v[32:35], a[200:203], a[0:3], v[32:35]
  ds_read_b64_tr_b16 a[188:189], v251 offset:4096
  ds_read_b64_tr_b16 a[190:191], v251 offset:8192
  v_mfma_f32_16x16x32_bf16 v[32:35], a[204:207], a[8:11], v[32:35]
  ds_read_b64_tr_b16 a[192:193], v244 offset:63488
  buffer_load_dwordx4 a[64:67], v137, s[36:39], s51 offen offset:0 sc1
  v_mfma_f32_16x16x32_bf16 v[36:39], a[204:207], a[12:15], v[36:39]
  ds_read_b64_tr_b16 a[194:195], v248 offset:2048
  ds_read_b64_tr_b16 a[196:197], v248 offset:6144
  v_mfma_f32_16x16x32_bf16 v[36:39], a[200:203], a[4:7], v[36:39]
  s_waitcnt lgkmcnt(11)
  ds_read_b64_tr_b16 a[198:199], v248 offset:10240
  v_mfma_f32_16x16x32_bf16 v[44:47], a[208:211], a[4:7], v[44:47]
  ds_read_b64_tr_b16 a[200:201], v245 offset:63488
  v_mfma_f32_16x16x32_bf16 v[44:47], a[212:215], a[12:15], v[44:47]
  buffer_load_dwordx4 v134, s[24:27], s50 offen offset:1024 lds
  ds_read_b64_tr_b16 a[202:203], v249 offset:2048
  v_mfma_f32_16x16x32_bf16 v[40:43], a[212:215], a[8:11], v[40:43]
  ds_read_b64_tr_b16 a[204:205], v249 offset:6144
  v_mfma_f32_16x16x32_bf16 v[40:43], a[208:211], a[0:3], v[40:43]
  s_waitcnt vmcnt(20) lgkmcnt(11)
  s_barrier
  ds_read_b64_tr_b16 a[206:207], v249 offset:10240
  v_mfma_f32_16x16x32_bf16 v[48:51], a[176:179], a[0:3], v[48:51]
  ds_read_b64_tr_b16 a[208:209], v246 offset:63488
  v_mfma_f32_16x16x32_bf16 v[48:51], a[180:183], a[8:11], v[48:51]
  buffer_load_dwordx4 a[68:71], v137, s[36:39], s51 offen offset:1024 sc1
  ds_read_b64_tr_b16 a[210:211], v250 offset:2048
  v_mfma_f32_16x16x32_bf16 v[52:55], a[180:183], a[12:15], v[52:55]
  ds_read_b64_tr_b16 a[212:213], v250 offset:6144
  v_mfma_f32_16x16x32_bf16 v[52:55], a[176:179], a[4:7], v[52:55]
  s_waitcnt lgkmcnt(11)
  ds_read_b64_tr_b16 a[214:215], v250 offset:10240
  v_mfma_f32_16x16x32_bf16 v[60:63], a[184:187], a[4:7], v[60:63]
  ds_read_b64_tr_b16 a[176:177], v247 offset:63488
  v_mfma_f32_16x16x32_bf16 v[60:63], a[188:191], a[12:15], v[60:63]
  buffer_load_dwordx4 v135, s[24:27], s50 offen offset:2048 lds
  ds_read_b64_tr_b16 a[178:179], v251 offset:2048
  v_mfma_f32_16x16x32_bf16 v[56:59], a[188:191], a[8:11], v[56:59]
  ds_read_b64_tr_b16 a[180:181], v251 offset:6144
  v_mfma_f32_16x16x32_bf16 v[56:59], a[184:187], a[0:3], v[56:59]
  s_waitcnt lgkmcnt(11)
  ds_read_b64_tr_b16 a[182:183], v251 offset:10240
  v_mfma_f32_16x16x32_bf16 v[144:147], a[192:195], a[0:3], v[144:147]
  ds_read_b64_tr_b16 a[184:185], v248 offset:12288
  v_mfma_f32_16x16x32_bf16 v[144:147], a[196:199], a[8:11], v[144:147]
  buffer_load_dwordx4 a[72:75], v137, s[36:39], s51 offen offset:2048 sc1
  ds_read_b64_tr_b16 a[186:187], v248 offset:16384
  v_mfma_f32_16x16x32_bf16 v[148:151], a[196:199], a[12:15], v[148:151]
  ds_read_b64_tr_b16 a[188:189], v248 offset:20480
  v_mfma_f32_16x16x32_bf16 v[148:151], a[192:195], a[4:7], v[148:151]
  s_waitcnt lgkmcnt(11)
  ds_read_b64_tr_b16 a[190:191], v248 offset:24576
  v_mfma_f32_16x16x32_bf16 v[156:159], a[200:203], a[4:7], v[156:159]
  ds_read_b64_tr_b16 a[192:193], v249 offset:12288
  v_mfma_f32_16x16x32_bf16 v[156:159], a[204:207], a[12:15], v[156:159]
  buffer_load_dwordx4 v136, s[24:27], s50 offen offset:3072 lds
  ds_read_b64_tr_b16 a[194:195], v249 offset:16384
  v_mfma_f32_16x16x32_bf16 v[152:155], a[204:207], a[8:11], v[152:155]
  ds_read_b64_tr_b16 a[196:197], v249 offset:20480
  v_mfma_f32_16x16x32_bf16 v[152:155], a[200:203], a[0:3], v[152:155]
  s_waitcnt lgkmcnt(11)
  ds_read_b64_tr_b16 a[198:199], v249 offset:24576
  v_mfma_f32_16x16x32_bf16 v[160:163], a[208:211], a[0:3], v[160:163]
  ds_read_b64_tr_b16 a[200:201], v250 offset:12288
  v_mfma_f32_16x16x32_bf16 v[160:163], a[212:215], a[8:11], v[160:163]
  buffer_load_dwordx4 a[76:79], v137, s[36:39], s51 offen offset:3072 sc1
  s_cmp_eq_u32 s87, 0
  v_mfma_f32_16x16x32_bf16 v[164:167], a[212:215], a[12:15], v[164:167]
  s_cselect_b32 s76, 22, 15
  s_cmp_eq_u32 s87, 2
  s_cselect_b32 s76, 8, s76
  v_mfma_f32_16x16x32_bf16 v[164:167], a[208:211], a[4:7], v[164:167]
  s_waitcnt lgkmcnt(9)
  s_lshl_b32 s50, s76, 16
  s_add_u32 m0, s70, 61440
  v_mfma_f32_16x16x32_bf16 v[172:175], a[176:179], a[4:7], v[172:175]
  ds_read_b64_tr_b16 a[202:203], v250 offset:16384
  ds_read_b64_tr_b16 a[204:205], v250 offset:20480
  v_mfma_f32_16x16x32_bf16 v[172:175], a[180:183], a[12:15], v[172:175]
  ds_read_b64_tr_b16 a[206:207], v250 offset:24576
  ds_read_b64_tr_b16 a[208:209], v251 offset:12288
  v_mfma_f32_16x16x32_bf16 v[168:171], a[180:183], a[8:11], v[168:171]
  buffer_load_dwordx4 v133, s[24:27], s50 offen offset:0 lds
  s_lshl_b32 s51, s76, 11
  v_mfma_f32_16x16x32_bf16 v[168:171], a[176:179], a[0:3], v[168:171]
  s_waitcnt vmcnt(25) lgkmcnt(9)
  ds_read_b64_tr_b16 a[210:211], v251 offset:16384
  ds_read_b64_tr_b16 a[212:213], v251 offset:20480
  v_mfma_f32_16x16x32_bf16 v[32:35], a[184:187], a[16:19], v[32:35]
  ds_read_b64_tr_b16 a[214:215], v251 offset:24576
  ds_read_b64_tr_b16 a[176:177], v248 offset:14336
  v_mfma_f32_16x16x32_bf16 v[32:35], a[188:191], a[24:27], v[32:35]
  buffer_load_dwordx4 a[80:83], v137, s[36:39], s51 offen offset:0 sc1
  ds_read_b64_tr_b16 a[178:179], v248 offset:18432
  v_mfma_f32_16x16x32_bf16 v[36:39], a[188:191], a[28:31], v[36:39]
  ds_read_b64_tr_b16 a[180:181], v248 offset:22528
  v_mfma_f32_16x16x32_bf16 v[36:39], a[184:187], a[20:23], v[36:39]
  s_waitcnt lgkmcnt(11)
  ds_read_b64_tr_b16 a[182:183], v248 offset:26624
  v_mfma_f32_16x16x32_bf16 v[44:47], a[192:195], a[20:23], v[44:47]
  ds_read_b64_tr_b16 a[184:185], v249 offset:14336
  v_mfma_f32_16x16x32_bf16 v[44:47], a[196:199], a[28:31], v[44:47]
  buffer_load_dwordx4 v134, s[24:27], s50 offen offset:1024 lds
  ds_read_b64_tr_b16 a[186:187], v249 offset:18432
  v_mfma_f32_16x16x32_bf16 v[40:43], a[196:199], a[24:27], v[40:43]
  ds_read_b64_tr_b16 a[188:189], v249 offset:22528
  v_mfma_f32_16x16x32_bf16 v[40:43], a[192:195], a[16:19], v[40:43]
  s_waitcnt vmcnt(20) lgkmcnt(11)
  s_barrier
  ds_read_b64_tr_b16 a[190:191], v249 offset:26624
  v_mfma_f32_16x16x32_bf16 v[48:51], a[200:203], a[16:19], v[48:51]
  ds_read_b64_tr_b16 a[192:193], v250 offset:14336
  v_mfma_f32_16x16x32_bf16 v[48:51], a[204:207], a[24:27], v[48:51]
  buffer_load_dwordx4 a[84:87], v137, s[36:39], s51 offen offset:1024 sc1
  ds_read_b64_tr_b16 a[194:195], v250 offset:18432
  v_mfma_f32_16x16x32_bf16 v[52:55], a[204:207], a[28:31], v[52:55]
  ds_read_b64_tr_b16 a[196:197], v250 offset:22528
  v_mfma_f32_16x16x32_bf16 v[52:55], a[200:203], a[20:23], v[52:55]
  s_waitcnt lgkmcnt(11)
  ds_read_b64_tr_b16 a[198:199], v250 offset:26624
  v_mfma_f32_16x16x32_bf16 v[60:63], a[208:211], a[20:23], v[60:63]
  ds_read_b64_tr_b16 a[200:201], v251 offset:14336
  v_mfma_f32_16x16x32_bf16 v[60:63], a[212:215], a[28:31], v[60:63]
  buffer_load_dwordx4 v135, s[24:27], s50 offen offset:2048 lds
  ds_read_b64_tr_b16 a[202:203], v251 offset:18432
  v_mfma_f32_16x16x32_bf16 v[56:59], a[212:215], a[24:27], v[56:59]
  ds_read_b64_tr_b16 a[204:205], v251 offset:22528
  v_mfma_f32_16x16x32_bf16 v[56:59], a[208:211], a[16:19], v[56:59]
  s_waitcnt lgkmcnt(11)
  ds_read_b64_tr_b16 a[206:207], v251 offset:26624
  v_mfma_f32_16x16x32_bf16 v[144:147], a[176:179], a[16:19], v[144:147]
  ds_read_b64_tr_b16 a[208:209], v240 offset:12288
  v_mfma_f32_16x16x32_bf16 v[144:147], a[180:183], a[24:27], v[144:147]
  buffer_load_dwordx4 a[88:91], v137, s[36:39], s51 offen offset:2048 sc1
  ds_read_b64_tr_b16 a[210:211], v240 offset:16384
  v_mfma_f32_16x16x32_bf16 v[148:151], a[180:183], a[28:31], v[148:151]
  ds_read_b64_tr_b16 a[212:213], v240 offset:20480
  v_mfma_f32_16x16x32_bf16 v[148:151], a[176:179], a[20:23], v[148:151]
  s_waitcnt lgkmcnt(11)
  ds_read_b64_tr_b16 a[214:215], v240 offset:24576
  v_mfma_f32_16x16x32_bf16 v[156:159], a[184:187], a[20:23], v[156:159]
  ds_read_b64_tr_b16 a[176:177], v241 offset:12288
  v_mfma_f32_16x16x32_bf16 v[156:159], a[188:191], a[28:31], v[156:159]
  buffer_load_dwordx4 v136, s[24:27], s50 offen offset:3072 lds
  ds_read_b64_tr_b16 a[178:179], v241 offset:16384
  v_mfma_f32_16x16x32_bf16 v[152:155], a[188:191], a[24:27], v[152:155]
  ds_read_b64_tr_b16 a[180:181], v241 offset:20480
  v_mfma_f32_16x16x32_bf16 v[152:155], a[184:187], a[16:19], v[152:155]
  s_waitcnt lgkmcnt(11)
  ds_read_b64_tr_b16 a[182:183], v241 offset:24576
  v_mfma_f32_16x16x32_bf16 v[160:163], a[192:195], a[16:19], v[160:163]
  buffer_load_dwordx4 a[92:95], v137, s[36:39], s51 offen offset:3072 sc1
  s_cmp_eq_u32 s87, 1
  v_mfma_f32_16x16x32_bf16 v[160:163], a[196:199], a[24:27], v[160:163]
  s_cselect_b32 s81, 26, 19
  s_cmp_eq_u32 s87, 3
  s_cselect_b32 s81, 12, s81
  v_mfma_f32_16x16x32_bf16 v[164:167], a[196:199], a[28:31], v[164:167]
  s_lshl_b32 s50, s81, 16
  s_add_u32 m0, s70, 77824
  ds_read_b64_tr_b16 a[184:185], v242 offset:12288
  v_mfma_f32_16x16x32_bf16 v[164:167], a[192:195], a[20:23], v[164:167]
  s_waitcnt lgkmcnt(9)
  ds_read_b64_tr_b16 a[186:187], v242 offset:16384
  ds_read_b64_tr_b16 a[188:189], v242 offset:20480
  v_mfma_f32_16x16x32_bf16 v[172:175], a[200:203], a[20:23], v[172:175]
  ds_read_b64_tr_b16 a[190:191], v242 offset:24576
  buffer_load_dwordx4 v133, s[24:27], s50 offen offset:0 lds
  v_mfma_f32_16x16x32_bf16 v[172:175], a[204:207], a[28:31], v[172:175]
  s_lshl_b32 s51, s81, 11
  ds_read_b64_tr_b16 a[192:193], v243 offset:12288
  ds_read_b64_tr_b16 a[194:195], v243 offset:16384
  v_mfma_f32_16x16x32_bf16 v[168:171], a[204:207], a[24:27], v[168:171]
  ds_read_b64_tr_b16 a[196:197], v243 offset:20480
  v_mfma_f32_16x16x32_bf16 v[168:171], a[200:203], a[16:19], v[168:171]
  s_waitcnt vmcnt(25) lgkmcnt(11)
  ds_read_b64_tr_b16 a[198:199], v243 offset:24576
  v_mfma_f32_16x16x32_bf16 v[32:35], a[208:211], a[32:35], v[32:35]
  buffer_load_dwordx4 a[96:99], v137, s[36:39], s51 offen offset:0 sc1
  ds_read_b64_tr_b16 a[200:201], v240 offset:14336
  v_mfma_f32_16x16x32_bf16 v[32:35], a[212:215], a[40:43], v[32:35]
  ds_read_b64_tr_b16 a[202:203], v240 offset:18432
  v_mfma_f32_16x16x32_bf16 v[36:39], a[212:215], a[44:47], v[36:39]
  ds_read_b64_tr_b16 a[204:205], v240 offset:22528
  v_mfma_f32_16x16x32_bf16 v[36:39], a[208:211], a[36:39], v[36:39]
  s_waitcnt lgkmcnt(11)
  ds_read_b64_tr_b16 a[206:207], v240 offset:26624
  v_mfma_f32_16x16x32_bf16 v[44:47], a[176:179], a[36:39], v[44:47]
  buffer_load_dwordx4 v134, s[24:27], s50 offen offset:1024 lds
  ds_read_b64_tr_b16 a[208:209], v241 offset:14336
  v_mfma_f32_16x16x32_bf16 v[44:47], a[180:183], a[44:47], v[44:47]
  ds_read_b64_tr_b16 a[210:211], v241 offset:18432
  v_mfma_f32_16x16x32_bf16 v[40:43], a[180:183], a[40:43], v[40:43]
  ds_read_b64_tr_b16 a[212:213], v241 offset:22528
  v_mfma_f32_16x16x32_bf16 v[40:43], a[176:179], a[32:35], v[40:43]
  s_waitcnt vmcnt(20) lgkmcnt(11)
  s_barrier
  ds_read_b64_tr_b16 a[214:215], v241 offset:26624
  v_mfma_f32_16x16x32_bf16 v[48:51], a[184:187], a[32:35], v[48:51]
  buffer_load_dwordx4 a[100:103], v137, s[36:39], s51 offen offset:1024 sc1
  ds_read_b64_tr_b16 a[176:177], v242 offset:14336
  v_mfma_f32_16x16x32_bf16 v[48:51], a[188:191], a[40:43], v[48:51]
  ds_read_b64_tr_b16 a[178:179], v242 offset:18432
  v_mfma_f32_16x16x32_bf16 v[52:55], a[188:191], a[44:47], v[52:55]
  ds_read_b64_tr_b16 a[180:181], v242 offset:22528
  v_mfma_f32_16x16x32_bf16 v[52:55], a[184:187], a[36:39], v[52:55]
  s_waitcnt lgkmcnt(11)
  ds_read_b64_tr_b16 a[182:183], v242 offset:26624
  v_mfma_f32_16x16x32_bf16 v[60:63], a[192:195], a[36:39], v[60:63]
  buffer_load_dwordx4 v135, s[24:27], s50 offen offset:2048 lds
  ds_read_b64_tr_b16 a[184:185], v243 offset:14336
  v_mfma_f32_16x16x32_bf16 v[60:63], a[196:199], a[44:47], v[60:63]
  ds_read_b64_tr_b16 a[186:187], v243 offset:18432
  v_mfma_f32_16x16x32_bf16 v[56:59], a[196:199], a[40:43], v[56:59]
  ds_read_b64_tr_b16 a[188:189], v243 offset:22528
  v_mfma_f32_16x16x32_bf16 v[56:59], a[192:195], a[32:35], v[56:59]
  s_waitcnt lgkmcnt(11)
  ds_read_b64_tr_b16 a[190:191], v243 offset:26624
  v_mfma_f32_16x16x32_bf16 v[144:147], a[200:203], a[32:35], v[144:147]
  buffer_load_dwordx4 a[104:107], v137, s[36:39], s51 offen offset:2048 sc1
  ds_read_b64_tr_b16 a[192:193], v240 offset:28672
  v_mfma_f32_16x16x32_bf16 v[144:147], a[204:207], a[40:43], v[144:147]
  ds_read_b64_tr_b16 a[194:195], v240 offset:32768
  v_mfma_f32_16x16x32_bf16 v[148:151], a[204:207], a[44:47], v[148:151]
  ds_read_b64_tr_b16 a[196:197], v240 offset:36864
  v_mfma_f32_16x16x32_bf16 v[148:151], a[200:203], a[36:39], v[148:151]
  s_waitcnt lgkmcnt(11)
  ds_read_b64_tr_b16 a[198:199], v240 offset:40960
  v_mfma_f32_16x16x32_bf16 v[156:159], a[208:211], a[36:39], v[156:159]
  buffer_load_dwordx4 v136, s[24:27], s50 offen offset:3072 lds
  ds_read_b64_tr_b16 a[200:201], v241 offset:28672
  v_mfma_f32_16x16x32_bf16 v[156:159], a[212:215], a[44:47], v[156:159]
  ds_read_b64_tr_b16 a[202:203], v241 offset:32768
  v_mfma_f32_16x16x32_bf16 v[152:155], a[212:215], a[40:43], v[152:155]
  ds_read_b64_tr_b16 a[204:205], v241 offset:36864
  v_mfma_f32_16x16x32_bf16 v[152:155], a[208:211], a[32:35], v[152:155]
  s_waitcnt lgkmcnt(11)
  ds_read_b64_tr_b16 a[206:207], v241 offset:40960
  v_mfma_f32_16x16x32_bf16 v[160:163], a[176:179], a[32:35], v[160:163]
  buffer_load_dwordx4 a[108:111], v137, s[36:39], s51 offen offset:3072 sc1
  s_cmp_eq_u32 s87, 0
  v_mfma_f32_16x16x32_bf16 v[160:163], a[180:183], a[40:43], v[160:163]
  s_cselect_b32 s82, 15, 22
  s_cmp_eq_u32 s87, 2
  s_cselect_b32 s82, 29, s82
  v_mfma_f32_16x16x32_bf16 v[164:167], a[180:183], a[44:47], v[164:167]
  s_lshl_b32 s50, s82, 16
  s_add_u32 m0, s70, 94208
  ds_read_b64_tr_b16 a[208:209], v242 offset:28672
  v_mfma_f32_16x16x32_bf16 v[164:167], a[176:179], a[36:39], v[164:167]
  s_waitcnt lgkmcnt(9)
  ds_read_b64_tr_b16 a[210:211], v242 offset:32768
  ds_read_b64_tr_b16 a[212:213], v242 offset:36864
  v_mfma_f32_16x16x32_bf16 v[172:175], a[184:187], a[36:39], v[172:175]
  ds_read_b64_tr_b16 a[214:215], v242 offset:40960
  buffer_load_dwordx4 v133, s[24:27], s50 offen offset:0 lds
  v_mfma_f32_16x16x32_bf16 v[172:175], a[188:191], a[44:47], v[172:175]
  s_lshl_b32 s51, s82, 11
  ds_read_b64_tr_b16 a[176:177], v243 offset:28672
  ds_read_b64_tr_b16 a[178:179], v243 offset:32768
  v_mfma_f32_16x16x32_bf16 v[168:171], a[188:191], a[40:43], v[168:171]
  ds_read_b64_tr_b16 a[180:181], v243 offset:36864
  v_mfma_f32_16x16x32_bf16 v[168:171], a[184:187], a[32:35], v[168:171]
  s_waitcnt vmcnt(25) lgkmcnt(11)
  ds_read_b64_tr_b16 a[182:183], v243 offset:40960
  v_mfma_f32_16x16x32_bf16 v[32:35], a[192:195], a[48:51], v[32:35]
  buffer_load_dwordx4 a[112:115], v137, s[36:39], s51 offen offset:0 sc1
  ds_read_b64_tr_b16 a[184:185], v240 offset:30720
  v_mfma_f32_16x16x32_bf16 v[32:35], a[196:199], a[56:59], v[32:35]
  ds_read_b64_tr_b16 a[186:187], v240 offset:34816
  v_mfma_f32_16x16x32_bf16 v[36:39], a[196:199], a[60:63], v[36:39]
  ds_read_b64_tr_b16 a[188:189], v240 offset:38912
  v_mfma_f32_16x16x32_bf16 v[36:39], a[192:195], a[52:55], v[36:39]
  s_waitcnt lgkmcnt(11)
  ds_read_b64_tr_b16 a[190:191], v240 offset:43008
  v_mfma_f32_16x16x32_bf16 v[44:47], a[200:203], a[52:55], v[44:47]
  buffer_load_dwordx4 v134, s[24:27], s50 offen offset:1024 lds
  ds_read_b64_tr_b16 a[192:193], v241 offset:30720
  v_mfma_f32_16x16x32_bf16 v[44:47], a[204:207], a[60:63], v[44:47]
  ds_read_b64_tr_b16 a[194:195], v241 offset:34816
  v_mfma_f32_16x16x32_bf16 v[40:43], a[204:207], a[56:59], v[40:43]
  ds_read_b64_tr_b16 a[196:197], v241 offset:38912
  v_mfma_f32_16x16x32_bf16 v[40:43], a[200:203], a[48:51], v[40:43]
  s_waitcnt vmcnt(20) lgkmcnt(11)
  s_barrier
  ds_read_b64_tr_b16 a[198:199], v241 offset:43008
  v_mfma_f32_16x16x32_bf16 v[48:51], a[208:211], a[48:51], v[48:51]
  buffer_load_dwordx4 a[116:119], v137, s[36:39], s51 offen offset:1024 sc1
  ds_read_b64_tr_b16 a[200:201], v242 offset:30720
  v_mfma_f32_16x16x32_bf16 v[48:51], a[212:215], a[56:59], v[48:51]
  ds_read_b64_tr_b16 a[202:203], v242 offset:34816
  v_mfma_f32_16x16x32_bf16 v[52:55], a[212:215], a[60:63], v[52:55]
  ds_read_b64_tr_b16 a[204:205], v242 offset:38912
  v_mfma_f32_16x16x32_bf16 v[52:55], a[208:211], a[52:55], v[52:55]
  s_waitcnt lgkmcnt(11)
  ds_read_b64_tr_b16 a[206:207], v242 offset:43008
  v_mfma_f32_16x16x32_bf16 v[60:63], a[176:179], a[52:55], v[60:63]
  buffer_load_dwordx4 v135, s[24:27], s50 offen offset:2048 lds
  ds_read_b64_tr_b16 a[208:209], v243 offset:30720
  v_mfma_f32_16x16x32_bf16 v[60:63], a[180:183], a[60:63], v[60:63]
  ds_read_b64_tr_b16 a[210:211], v243 offset:34816
  v_mfma_f32_16x16x32_bf16 v[56:59], a[180:183], a[56:59], v[56:59]
  ds_read_b64_tr_b16 a[212:213], v243 offset:38912
  v_mfma_f32_16x16x32_bf16 v[56:59], a[176:179], a[48:51], v[56:59]
  s_waitcnt lgkmcnt(11)
  buffer_load_dwordx4 a[120:123], v137, s[36:39], s51 offen offset:2048 sc1
  ds_read_b64_tr_b16 a[214:215], v243 offset:43008
  v_mfma_f32_16x16x32_bf16 v[144:147], a[184:187], a[48:51], v[144:147]
  ds_read_b64_tr_b16 a[176:177], v240 offset:45056
  v_mfma_f32_16x16x32_bf16 v[144:147], a[188:191], a[56:59], v[144:147]
  ds_read_b64_tr_b16 a[178:179], v240 offset:49152
  v_mfma_f32_16x16x32_bf16 v[148:151], a[188:191], a[60:63], v[148:151]
  ds_read_b64_tr_b16 a[180:181], v240 offset:53248
  v_mfma_f32_16x16x32_bf16 v[148:151], a[184:187], a[52:55], v[148:151]
  s_waitcnt lgkmcnt(11)
  buffer_load_dwordx4 v136, s[24:27], s50 offen offset:3072 lds
  ds_read_b64_tr_b16 a[182:183], v240 offset:57344
  v_mfma_f32_16x16x32_bf16 v[156:159], a[192:195], a[52:55], v[156:159]
  ds_read_b64_tr_b16 a[184:185], v241 offset:45056
  v_mfma_f32_16x16x32_bf16 v[156:159], a[196:199], a[60:63], v[156:159]
  ds_read_b64_tr_b16 a[186:187], v241 offset:49152
  v_mfma_f32_16x16x32_bf16 v[152:155], a[196:199], a[56:59], v[152:155]
  ds_read_b64_tr_b16 a[188:189], v241 offset:53248
  v_mfma_f32_16x16x32_bf16 v[152:155], a[192:195], a[48:51], v[152:155]
  s_waitcnt lgkmcnt(11)
  buffer_load_dwordx4 a[124:127], v137, s[36:39], s51 offen offset:3072 sc1
  s_cmp_eq_u32 s87, 1
  v_mfma_f32_16x16x32_bf16 v[160:163], a[200:203], a[48:51], v[160:163]
  s_cselect_b32 s83, 19, 26
  s_cmp_eq_u32 s87, 3
  s_cselect_b32 s83, 33, s83
  v_mfma_f32_16x16x32_bf16 v[160:163], a[204:207], a[56:59], v[160:163]
  s_lshl_b32 s50, s83, 16
  s_add_u32 m0, s70, 110592
  ds_read_b64_tr_b16 a[190:191], v241 offset:57344
  v_mfma_f32_16x16x32_bf16 v[164:167], a[204:207], a[60:63], v[164:167]
  ds_read_b64_tr_b16 a[192:193], v242 offset:45056
  ds_read_b64_tr_b16 a[194:195], v242 offset:49152
  v_mfma_f32_16x16x32_bf16 v[164:167], a[200:203], a[52:55], v[164:167]
  s_waitcnt lgkmcnt(10)
  ds_read_b64_tr_b16 a[196:197], v242 offset:53248
  buffer_load_dwordx4 v133, s[24:27], s50 offen offset:0 lds
  v_mfma_f32_16x16x32_bf16 v[172:175], a[208:211], a[52:55], v[172:175]
  s_lshl_b32 s51, s83, 11
  ds_read_b64_tr_b16 a[198:199], v242 offset:57344
  ds_read_b64_tr_b16 a[200:201], v243 offset:45056
  v_mfma_f32_16x16x32_bf16 v[172:175], a[212:215], a[60:63], v[172:175]
  ds_read_b64_tr_b16 a[202:203], v243 offset:49152
  v_mfma_f32_16x16x32_bf16 v[168:171], a[212:215], a[56:59], v[168:171]
  ds_read_b64_tr_b16 a[204:205], v243 offset:53248
  v_mfma_f32_16x16x32_bf16 v[168:171], a[208:211], a[48:51], v[168:171]
  s_waitcnt vmcnt(25) lgkmcnt(11)
  buffer_load_dwordx4 a[128:131], v137, s[36:39], s51 offen offset:0 sc1
  ds_read_b64_tr_b16 a[206:207], v243 offset:57344
  v_mfma_f32_16x16x32_bf16 v[32:35], a[176:179], a[64:67], v[32:35]
Hb2:
  s_cbranch_execz Rb
  ds_read_b64_tr_b16 a[208:209], v240 offset:47104
  v_mfma_f32_16x16x32_bf16 v[32:35], a[180:183], a[72:75], v[32:35]
  ds_read_b64_tr_b16 a[210:211], v240 offset:51200
  v_mfma_f32_16x16x32_bf16 v[36:39], a[180:183], a[76:79], v[36:39]
  ds_read_b64_tr_b16 a[212:213], v240 offset:55296
  v_mfma_f32_16x16x32_bf16 v[36:39], a[176:179], a[68:71], v[36:39]
  s_waitcnt lgkmcnt(11)
  buffer_load_dwordx4 v134, s[24:27], s50 offen offset:1024 lds
  ds_read_b64_tr_b16 a[214:215], v240 offset:59392
  v_mfma_f32_16x16x32_bf16 v[44:47], a[184:187], a[68:71], v[44:47]
  ds_read_b64_tr_b16 a[176:177], v241 offset:47104
  v_mfma_f32_16x16x32_bf16 v[44:47], a[188:191], a[76:79], v[44:47]
  ds_read_b64_tr_b16 a[178:179], v241 offset:51200
  v_mfma_f32_16x16x32_bf16 v[40:43], a[188:191], a[72:75], v[40:43]
  ds_read_b64_tr_b16 a[180:181], v241 offset:55296
  v_mfma_f32_16x16x32_bf16 v[40:43], a[184:187], a[64:67], v[40:43]
  s_waitcnt vmcnt(20) lgkmcnt(11)
  s_barrier
  buffer_load_dwordx4 a[132:135], v137, s[36:39], s51 offen offset:1024 sc1
  v_mfma_f32_16x16x32_bf16 v[48:51], a[192:195], a[64:67], v[48:51]
  ds_read_b64_tr_b16 a[182:183], v241 offset:59392
  ds_read_b64_tr_b16 a[184:185], v242 offset:47104
  v_mfma_f32_16x16x32_bf16 v[48:51], a[196:199], a[72:75], v[48:51]
  ds_read_b64_tr_b16 a[186:187], v242 offset:51200
  v_mfma_f32_16x16x32_bf16 v[52:55], a[196:199], a[76:79], v[52:55]
  ds_read_b64_tr_b16 a[188:189], v242 offset:55296
  v_mfma_f32_16x16x32_bf16 v[52:55], a[192:195], a[68:71], v[52:55]
  s_waitcnt lgkmcnt(11)
  buffer_load_dwordx4 v135, s[24:27], s50 offen offset:2048 lds
  ds_read_b64_tr_b16 a[190:191], v242 offset:59392
  v_mfma_f32_16x16x32_bf16 v[60:63], a[200:203], a[68:71], v[60:63]
  ds_read_b64_tr_b16 a[192:193], v243 offset:47104
  v_mfma_f32_16x16x32_bf16 v[60:63], a[204:207], a[76:79], v[60:63]
  ds_read_b64_tr_b16 a[194:195], v243 offset:51200
  v_mfma_f32_16x16x32_bf16 v[56:59], a[204:207], a[72:75], v[56:59]
  ds_read_b64_tr_b16 a[196:197], v243 offset:55296
  v_mfma_f32_16x16x32_bf16 v[56:59], a[200:203], a[64:67], v[56:59]
  s_waitcnt lgkmcnt(11)
  buffer_load_dwordx4 a[136:139], v137, s[36:39], s51 offen offset:2048 sc1
  ds_read_b64_tr_b16 a[198:199], v243 offset:59392
  v_mfma_f32_16x16x32_bf16 v[144:147], a[208:211], a[64:67], v[144:147]
  ds_read_b64_tr_b16 a[200:201], v240 offset:61440
  v_mfma_f32_16x16x32_bf16 v[144:147], a[212:215], a[72:75], v[144:147]
  ds_read_b64_tr_b16 a[202:203], v244 offset:0
  v_mfma_f32_16x16x32_bf16 v[148:151], a[212:215], a[76:79], v[148:151]
  ds_read_b64_tr_b16 a[204:205], v244 offset:4096
  v_mfma_f32_16x16x32_bf16 v[148:151], a[208:211], a[68:71], v[148:151]
  s_waitcnt lgkmcnt(11)
  buffer_load_dwordx4 v136, s[24:27], s50 offen offset:3072 lds
  ds_read_b64_tr_b16 a[206:207], v244 offset:8192
  v_mfma_f32_16x16x32_bf16 v[156:159], a[176:179], a[68:71], v[156:159]
  ds_read_b64_tr_b16 a[208:209], v241 offset:61440
  v_mfma_f32_16x16x32_bf16 v[156:159], a[180:183], a[76:79], v[156:159]
  ds_read_b64_tr_b16 a[210:211], v245 offset:0
  v_mfma_f32_16x16x32_bf16 v[152:155], a[180:183], a[72:75], v[152:155]
  ds_read_b64_tr_b16 a[212:213], v245 offset:4096
  v_mfma_f32_16x16x32_bf16 v[152:155], a[176:179], a[64:67], v[152:155]
  s_waitcnt lgkmcnt(11)
  buffer_load_dwordx4 a[140:143], v137, s[36:39], s51 offen offset:3072 sc1
  s_cmp_eq_u32 s87, 0
  v_mfma_f32_16x16x32_bf16 v[160:163], a[184:187], a[64:67], v[160:163]
  s_cselect_b32 s69, 36, 29
  s_cmp_eq_u32 s87, 2
  s_cselect_b32 s69, 22, s69
  v_mfma_f32_16x16x32_bf16 v[160:163], a[188:191], a[72:75], v[160:163]
  s_lshl_b32 s51, s69, 11
  ds_read_b64_tr_b16 a[214:215], v245 offset:8192
  ds_read_b64_tr_b16 a[176:177], v242 offset:61440
  v_mfma_f32_16x16x32_bf16 v[164:167], a[188:191], a[76:79], v[164:167]
  ds_read_b64_tr_b16 a[178:179], v246 offset:0
  ds_read_b64_tr_b16 a[180:181], v246 offset:4096
  v_mfma_f32_16x16x32_bf16 v[164:167], a[184:187], a[68:71], v[164:167]
  s_waitcnt lgkmcnt(11)
  buffer_load_dwordx4 a[216:219], v137, s[36:39], s51 offen offset:0 sc1
  ds_read_b64_tr_b16 a[182:183], v246 offset:8192
  v_mfma_f32_16x16x32_bf16 v[172:175], a[192:195], a[68:71], v[172:175]
  ds_read_b64_tr_b16 a[184:185], v243 offset:61440
  v_mfma_f32_16x16x32_bf16 v[172:175], a[196:199], a[76:79], v[172:175]
  ds_read_b64_tr_b16 a[186:187], v247 offset:0
  v_mfma_f32_16x16x32_bf16 v[168:171], a[196:199], a[72:75], v[168:171]
  ds_read_b64_tr_b16 a[188:189], v247 offset:4096
  v_mfma_f32_16x16x32_bf16 v[168:171], a[192:195], a[64:67], v[168:171]
  s_waitcnt vmcnt(25) lgkmcnt(11)
  buffer_load_dwordx4 a[220:223], v137, s[36:39], s51 offen offset:1024 sc1
  s_lshl_b32 s50, s69, 16
  v_mfma_f32_16x16x32_bf16 v[32:35], a[200:203], a[80:83], v[32:35]
  s_add_u32 m0, s70, 126976
  ds_read_b64_tr_b16 a[190:191], v247 offset:8192
  ds_read_b64_tr_b16 a[192:193], v240 offset:63488
  v_mfma_f32_16x16x32_bf16 v[32:35], a[204:207], a[88:91], v[32:35]
  ds_read_b64_tr_b16 a[194:195], v244 offset:2048
  v_mfma_f32_16x16x32_bf16 v[36:39], a[204:207], a[92:95], v[36:39]
  ds_read_b64_tr_b16 a[196:197], v244 offset:6144
  v_mfma_f32_16x16x32_bf16 v[36:39], a[200:203], a[84:87], v[36:39]
  s_waitcnt lgkmcnt(11)
  buffer_load_dwordx4 v135, s[24:27], s50 offen offset:2048 lds
  ds_read_b64_tr_b16 a[198:199], v244 offset:10240
  v_mfma_f32_16x16x32_bf16 v[44:47], a[208:211], a[84:87], v[44:47]
  ds_read_b64_tr_b16 a[200:201], v241 offset:63488
  v_mfma_f32_16x16x32_bf16 v[44:47], a[212:215], a[92:95], v[44:47]
  ds_read_b64_tr_b16 a[202:203], v245 offset:2048
  v_mfma_f32_16x16x32_bf16 v[40:43], a[212:215], a[88:91], v[40:43]
  ds_read_b64_tr_b16 a[204:205], v245 offset:6144
  v_mfma_f32_16x16x32_bf16 v[40:43], a[208:211], a[80:83], v[40:43]
  s_waitcnt vmcnt(20) lgkmcnt(11)
  s_barrier
  buffer_load_dwordx4 a[224:227], v137, s[36:39], s51 offen offset:2048 sc1
  v_mfma_f32_16x16x32_bf16 v[48:51], a[176:179], a[80:83], v[48:51]
  ds_read_b64_tr_b16 a[206:207], v245 offset:10240
  ds_read_b64_tr_b16 a[208:209], v242 offset:63488
  v_mfma_f32_16x16x32_bf16 v[48:51], a[180:183], a[88:91], v[48:51]
  ds_read_b64_tr_b16 a[210:211], v246 offset:2048
  v_mfma_f32_16x16x32_bf16 v[52:55], a[180:183], a[92:95], v[52:55]
  buffer_load_dwordx4 v136, s[24:27], s50 offen offset:3072 lds
  ds_read_b64_tr_b16 a[212:213], v246 offset:6144
  v_mfma_f32_16x16x32_bf16 v[52:55], a[176:179], a[84:87], v[52:55]
  s_waitcnt lgkmcnt(11)
  ds_read_b64_tr_b16 a[214:215], v246 offset:10240
  v_mfma_f32_16x16x32_bf16 v[60:63], a[184:187], a[84:87], v[60:63]
  ds_read_b64_tr_b16 a[176:177], v243 offset:63488
  v_mfma_f32_16x16x32_bf16 v[60:63], a[188:191], a[92:95], v[60:63]
  ds_read_b64_tr_b16 a[178:179], v247 offset:2048
  v_mfma_f32_16x16x32_bf16 v[56:59], a[188:191], a[88:91], v[56:59]
  buffer_load_dwordx4 a[228:231], v137, s[36:39], s51 offen offset:3072 sc1
  s_cmp_eq_u32 s87, 1
  v_mfma_f32_16x16x32_bf16 v[56:59], a[184:187], a[80:83], v[56:59]
  s_waitcnt lgkmcnt(10)
  s_cselect_b32 s71, 40, 33
  s_cmp_eq_u32 s87, 3
  v_mfma_f32_16x16x32_bf16 v[144:147], a[192:195], a[80:83], v[144:147]
  s_cselect_b32 s71, 26, s71
  s_lshl_b32 s51, s71, 11
  ds_read_b64_tr_b16 a[180:181], v247 offset:6144
  v_mfma_f32_16x16x32_bf16 v[144:147], a[196:199], a[88:91], v[144:147]
  ds_read_b64_tr_b16 a[182:183], v247 offset:10240
  ds_read_b64_tr_b16 a[184:185], v244 offset:12288
  v_mfma_f32_16x16x32_bf16 v[148:151], a[196:199], a[92:95], v[148:151]
  ds_read_b64_tr_b16 a[186:187], v244 offset:16384
  buffer_load_dwordx4 a[0:3], v137, s[36:39], s51 offen offset:0 sc1
  v_mfma_f32_16x16x32_bf16 v[148:151], a[192:195], a[84:87], v[148:151]
  s_waitcnt lgkmcnt(10)
  ds_read_b64_tr_b16 a[188:189], v244 offset:20480
  ds_read_b64_tr_b16 a[190:191], v244 offset:24576
  v_mfma_f32_16x16x32_bf16 v[156:159], a[200:203], a[84:87], v[156:159]
  ds_read_b64_tr_b16 a[192:193], v245 offset:12288
  v_mfma_f32_16x16x32_bf16 v[156:159], a[204:207], a[92:95], v[156:159]
  ds_read_b64_tr_b16 a[194:195], v245 offset:16384
  v_mfma_f32_16x16x32_bf16 v[152:155], a[204:207], a[88:91], v[152:155]
  buffer_load_dwordx4 a[4:7], v137, s[36:39], s51 offen offset:1024 sc1
  s_lshl_b32 s50, s71, 16
  v_mfma_f32_16x16x32_bf16 v[152:155], a[200:203], a[80:83], v[152:155]
  s_waitcnt lgkmcnt(10)
  s_add_u32 m0, s70, 143360
  ds_read_b64_tr_b16 a[196:197], v245 offset:20480
  v_mfma_f32_16x16x32_bf16 v[160:163], a[208:211], a[80:83], v[160:163]
  ds_read_b64_tr_b16 a[198:199], v245 offset:24576
  ds_read_b64_tr_b16 a[200:201], v246 offset:12288
  v_mfma_f32_16x16x32_bf16 v[160:163], a[212:215], a[88:91], v[160:163]
  ds_read_b64_tr_b16 a[202:203], v246 offset:16384
  v_mfma_f32_16x16x32_bf16 v[164:167], a[212:215], a[92:95], v[164:167]
  buffer_load_dwordx4 v135, s[24:27], s50 offen offset:2048 lds
  ds_read_b64_tr_b16 a[204:205], v246 offset:20480
  v_mfma_f32_16x16x32_bf16 v[164:167], a[208:211], a[84:87], v[164:167]
  s_waitcnt lgkmcnt(11)
  ds_read_b64_tr_b16 a[206:207], v246 offset:24576
  v_mfma_f32_16x16x32_bf16 v[172:175], a[176:179], a[84:87], v[172:175]
  ds_read_b64_tr_b16 a[208:209], v247 offset:12288
  v_mfma_f32_16x16x32_bf16 v[172:175], a[180:183], a[92:95], v[172:175]
  ds_read_b64_tr_b16 a[210:211], v247 offset:16384
  v_mfma_f32_16x16x32_bf16 v[168:171], a[180:183], a[88:91], v[168:171]
  buffer_load_dwordx4 a[8:11], v137, s[36:39], s51 offen offset:2048 sc1
  ds_read_b64_tr_b16 a[212:213], v247 offset:20480
  v_mfma_f32_16x16x32_bf16 v[168:171], a[176:179], a[80:83], v[168:171]
  s_waitcnt vmcnt(26) lgkmcnt(11)
  ds_read_b64_tr_b16 a[214:215], v247 offset:24576
  v_mfma_f32_16x16x32_bf16 v[32:35], a[184:187], a[96:99], v[32:35]
  ds_read_b64_tr_b16 a[176:177], v244 offset:14336
  v_mfma_f32_16x16x32_bf16 v[32:35], a[188:191], a[104:107], v[32:35]
  ds_read_b64_tr_b16 a[178:179], v244 offset:18432
  v_mfma_f32_16x16x32_bf16 v[36:39], a[188:191], a[108:111], v[36:39]
  buffer_load_dwordx4 v136, s[24:27], s50 offen offset:3072 lds
  ds_read_b64_tr_b16 a[180:181], v244 offset:22528
  v_mfma_f32_16x16x32_bf16 v[36:39], a[184:187], a[100:103], v[36:39]
  s_waitcnt lgkmcnt(11)
  ds_read_b64_tr_b16 a[182:183], v244 offset:26624
  v_mfma_f32_16x16x32_bf16 v[44:47], a[192:195], a[100:103], v[44:47]
  ds_read_b64_tr_b16 a[184:185], v245 offset:14336
  v_mfma_f32_16x16x32_bf16 v[44:47], a[196:199], a[108:111], v[44:47]
  ds_read_b64_tr_b16 a[186:187], v245 offset:18432
  v_mfma_f32_16x16x32_bf16 v[40:43], a[196:199], a[104:107], v[40:43]
  buffer_load_dwordx4 a[12:15], v137, s[36:39], s51 offen offset:3072 sc1
  s_cmp_eq_u32 s87, 0
  v_mfma_f32_16x16x32_bf16 v[40:43], a[192:195], a[96:99], v[40:43]
  s_waitcnt vmcnt(21) lgkmcnt(10)
  s_barrier
  s_cselect_b32 s72, 29, 36
  v_mfma_f32_16x16x32_bf16 v[48:51], a[200:203], a[96:99], v[48:51]
  s_cmp_eq_u32 s87, 2
  s_cselect_b32 s72, 43, s72
  s_lshl_b32 s51, s72, 11
  v_mfma_f32_16x16x32_bf16 v[48:51], a[204:207], a[104:107], v[48:51]
  ds_read_b64_tr_b16 a[188:189], v245 offset:22528
  ds_read_b64_tr_b16 a[190:191], v245 offset:26624
  v_mfma_f32_16x16x32_bf16 v[52:55], a[204:207], a[108:111], v[52:55]
  ds_read_b64_tr_b16 a[192:193], v246 offset:14336
  ds_read_b64_tr_b16 a[194:195], v246 offset:18432
  v_mfma_f32_16x16x32_bf16 v[52:55], a[200:203], a[100:103], v[52:55]
  s_waitcnt lgkmcnt(10)
  buffer_load_dwordx4 a[16:19], v137, s[36:39], s51 offen offset:0 sc1
  ds_read_b64_tr_b16 a[196:197], v246 offset:22528
  v_mfma_f32_16x16x32_bf16 v[60:63], a[208:211], a[100:103], v[60:63]
  ds_read_b64_tr_b16 a[198:199], v246 offset:26624
  ds_read_b64_tr_b16 a[200:201], v247 offset:14336
  v_mfma_f32_16x16x32_bf16 v[60:63], a[212:215], a[108:111], v[60:63]
  ds_read_b64_tr_b16 a[202:203], v247 offset:18432
  v_mfma_f32_16x16x32_bf16 v[56:59], a[212:215], a[104:107], v[56:59]
  buffer_load_dwordx4 a[20:23], v137, s[36:39], s51 offen offset:1024 sc1
  s_lshl_b32 s50, s72, 16
  v_mfma_f32_16x16x32_bf16 v[56:59], a[208:211], a[96:99], v[56:59]
  s_waitcnt lgkmcnt(10)
  s_add_u32 m0, s70, 12288
  ds_read_b64_tr_b16 a[204:205], v247 offset:22528
  v_mfma_f32_16x16x32_bf16 v[144:147], a[176:179], a[96:99], v[144:147]
  ds_read_b64_tr_b16 a[206:207], v247 offset:26624
  ds_read_b64_tr_b16 a[208:209], v244 offset:28672
  v_mfma_f32_16x16x32_bf16 v[144:147], a[180:183], a[104:107], v[144:147]
  ds_read_b64_tr_b16 a[210:211], v244 offset:32768
  v_mfma_f32_16x16x32_bf16 v[148:151], a[180:183], a[108:111], v[148:151]
  buffer_load_dwordx4 v135, s[24:27], s50 offen offset:2048 lds
  ds_read_b64_tr_b16 a[212:213], v244 offset:36864
  v_mfma_f32_16x16x32_bf16 v[148:151], a[176:179], a[100:103], v[148:151]
  s_waitcnt lgkmcnt(11)
  ds_read_b64_tr_b16 a[214:215], v244 offset:40960
  v_mfma_f32_16x16x32_bf16 v[156:159], a[184:187], a[100:103], v[156:159]
  ds_read_b64_tr_b16 a[176:177], v245 offset:28672
  v_mfma_f32_16x16x32_bf16 v[156:159], a[188:191], a[108:111], v[156:159]
  ds_read_b64_tr_b16 a[178:179], v245 offset:32768
  v_mfma_f32_16x16x32_bf16 v[152:155], a[188:191], a[104:107], v[152:155]
  buffer_load_dwordx4 a[24:27], v137, s[36:39], s51 offen offset:2048 sc1
  ds_read_b64_tr_b16 a[180:181], v245 offset:36864
  v_mfma_f32_16x16x32_bf16 v[152:155], a[184:187], a[96:99], v[152:155]
  s_waitcnt lgkmcnt(11)
  ds_read_b64_tr_b16 a[182:183], v245 offset:40960
  v_mfma_f32_16x16x32_bf16 v[160:163], a[192:195], a[96:99], v[160:163]
  ds_read_b64_tr_b16 a[184:185], v246 offset:28672
  v_mfma_f32_16x16x32_bf16 v[160:163], a[196:199], a[104:107], v[160:163]
  ds_read_b64_tr_b16 a[186:187], v246 offset:32768
  v_mfma_f32_16x16x32_bf16 v[164:167], a[196:199], a[108:111], v[164:167]
  buffer_load_dwordx4 v136, s[24:27], s50 offen offset:3072 lds
  ds_read_b64_tr_b16 a[188:189], v246 offset:36864
  v_mfma_f32_16x16x32_bf16 v[164:167], a[192:195], a[100:103], v[164:167]
  s_waitcnt lgkmcnt(11)
  ds_read_b64_tr_b16 a[190:191], v246 offset:40960
  v_mfma_f32_16x16x32_bf16 v[172:175], a[200:203], a[100:103], v[172:175]
  ds_read_b64_tr_b16 a[192:193], v247 offset:28672
  v_mfma_f32_16x16x32_bf16 v[172:175], a[204:207], a[108:111], v[172:175]
  ds_read_b64_tr_b16 a[194:195], v247 offset:32768
  v_mfma_f32_16x16x32_bf16 v[168:171], a[204:207], a[104:107], v[168:171]
  buffer_load_dwordx4 a[28:31], v137, s[36:39], s51 offen offset:3072 sc1
  s_cmp_eq_u32 s87, 1
  v_mfma_f32_16x16x32_bf16 v[168:171], a[200:203], a[96:99], v[168:171]
  s_waitcnt vmcnt(26) lgkmcnt(10)
  s_cselect_b32 s73, 33, 40
  s_cmp_eq_u32 s87, 3
  v_mfma_f32_16x16x32_bf16 v[32:35], a[208:211], a[112:115], v[32:35]
  s_cselect_b32 s73, 47, s73
  s_lshl_b32 s51, s73, 11
  ds_read_b64_tr_b16 a[196:197], v247 offset:36864
  v_mfma_f32_16x16x32_bf16 v[32:35], a[212:215], a[120:123], v[32:35]
  ds_read_b64_tr_b16 a[198:199], v247 offset:40960
  ds_read_b64_tr_b16 a[200:201], v244 offset:30720
  v_mfma_f32_16x16x32_bf16 v[36:39], a[212:215], a[124:127], v[36:39]
  buffer_load_dwordx4 a[32:35], v137, s[36:39], s51 offen offset:0 sc1
  ds_read_b64_tr_b16 a[202:203], v244 offset:34816
  v_mfma_f32_16x16x32_bf16 v[36:39], a[208:211], a[116:119], v[36:39]
  s_waitcnt lgkmcnt(10)
  ds_read_b64_tr_b16 a[204:205], v244 offset:38912
  ds_read_b64_tr_b16 a[206:207], v244 offset:43008
  v_mfma_f32_16x16x32_bf16 v[44:47], a[176:179], a[116:119], v[44:47]
  ds_read_b64_tr_b16 a[208:209], v245 offset:30720
  v_mfma_f32_16x16x32_bf16 v[44:47], a[180:183], a[124:127], v[44:47]
  buffer_load_dwordx4 a[36:39], v137, s[36:39], s51 offen offset:1024 sc1
  s_lshl_b32 s50, s73, 16
  v_mfma_f32_16x16x32_bf16 v[40:43], a[180:183], a[120:123], v[40:43]
  s_add_u32 m0, s70, 28672
  ds_read_b64_tr_b16 a[210:211], v245 offset:34816
  ds_read_b64_tr_b16 a[212:213], v245 offset:38912
  v_mfma_f32_16x16x32_bf16 v[40:43], a[176:179], a[112:115], v[40:43]
  s_waitcnt vmcnt(21) lgkmcnt(11)
  s_barrier
  ds_read_b64_tr_b16 a[214:215], v245 offset:43008
  v_mfma_f32_16x16x32_bf16 v[48:51], a[184:187], a[112:115], v[48:51]
  ds_read_b64_tr_b16 a[176:177], v246 offset:30720
  v_mfma_f32_16x16x32_bf16 v[48:51], a[188:191], a[120:123], v[48:51]
  buffer_load_dwordx4 v135, s[24:27], s50 offen offset:2048 lds
  ds_read_b64_tr_b16 a[178:179], v246 offset:34816
  v_mfma_f32_16x16x32_bf16 v[52:55], a[188:191], a[124:127], v[52:55]
  ds_read_b64_tr_b16 a[180:181], v246 offset:38912
  v_mfma_f32_16x16x32_bf16 v[52:55], a[184:187], a[116:119], v[52:55]
  s_waitcnt lgkmcnt(11)
  ds_read_b64_tr_b16 a[182:183], v246 offset:43008
  v_mfma_f32_16x16x32_bf16 v[60:63], a[192:195], a[116:119], v[60:63]
  ds_read_b64_tr_b16 a[184:185], v247 offset:30720
  v_mfma_f32_16x16x32_bf16 v[60:63], a[196:199], a[124:127], v[60:63]
  buffer_load_dwordx4 a[40:43], v137, s[36:39], s51 offen offset:2048 sc1
  ds_read_b64_tr_b16 a[186:187], v247 offset:34816
  v_mfma_f32_16x16x32_bf16 v[56:59], a[196:199], a[120:123], v[56:59]
  ds_read_b64_tr_b16 a[188:189], v247 offset:38912
  v_mfma_f32_16x16x32_bf16 v[56:59], a[192:195], a[112:115], v[56:59]
  s_waitcnt lgkmcnt(11)
  ds_read_b64_tr_b16 a[190:191], v247 offset:43008
  v_mfma_f32_16x16x32_bf16 v[144:147], a[200:203], a[112:115], v[144:147]
  ds_read_b64_tr_b16 a[192:193], v244 offset:45056
  v_mfma_f32_16x16x32_bf16 v[144:147], a[204:207], a[120:123], v[144:147]
  buffer_load_dwordx4 v136, s[24:27], s50 offen offset:3072 lds
  ds_read_b64_tr_b16 a[194:195], v244 offset:49152
  v_mfma_f32_16x16x32_bf16 v[148:151], a[204:207], a[124:127], v[148:151]
  ds_read_b64_tr_b16 a[196:197], v244 offset:53248
  v_mfma_f32_16x16x32_bf16 v[148:151], a[200:203], a[116:119], v[148:151]
  s_waitcnt lgkmcnt(11)
  ds_read_b64_tr_b16 a[198:199], v244 offset:57344
  v_mfma_f32_16x16x32_bf16 v[156:159], a[208:211], a[116:119], v[156:159]
  ds_read_b64_tr_b16 a[200:201], v245 offset:45056
  v_mfma_f32_16x16x32_bf16 v[156:159], a[212:215], a[124:127], v[156:159]
  buffer_load_dwordx4 a[44:47], v137, s[36:39], s51 offen offset:3072 sc1
  s_cmp_eq_u32 s87, 0
  v_mfma_f32_16x16x32_bf16 v[152:155], a[212:215], a[120:123], v[152:155]
  s_cselect_b32 s74, 50, 43
  s_cmp_eq_u32 s87, 2
  s_cselect_b32 s74, 36, s74
  v_mfma_f32_16x16x32_bf16 v[152:155], a[208:211], a[112:115], v[152:155]
  s_waitcnt lgkmcnt(9)
  s_lshl_b32 s51, s74, 11
  ds_read_b64_tr_b16 a[202:203], v245 offset:49152
  v_mfma_f32_16x16x32_bf16 v[160:163], a[176:179], a[112:115], v[160:163]
  ds_read_b64_tr_b16 a[204:205], v245 offset:53248
  ds_read_b64_tr_b16 a[206:207], v245 offset:57344
  v_mfma_f32_16x16x32_bf16 v[160:163], a[180:183], a[120:123], v[160:163]
  ds_read_b64_tr_b16 a[208:209], v246 offset:45056
  buffer_load_dwordx4 a[48:51], v137, s[36:39], s51 offen offset:0 sc1
  v_mfma_f32_16x16x32_bf16 v[164:167], a[180:183], a[124:127], v[164:167]
  ds_read_b64_tr_b16 a[210:211], v246 offset:49152
  ds_read_b64_tr_b16 a[212:213], v246 offset:53248
  v_mfma_f32_16x16x32_bf16 v[164:167], a[176:179], a[116:119], v[164:167]
  s_waitcnt lgkmcnt(11)
  ds_read_b64_tr_b16 a[214:215], v246 offset:57344
  v_mfma_f32_16x16x32_bf16 v[172:175], a[184:187], a[116:119], v[172:175]
  ds_read_b64_tr_b16 a[176:177], v247 offset:45056
  v_mfma_f32_16x16x32_bf16 v[172:175], a[188:191], a[124:127], v[172:175]
  buffer_load_dwordx4 a[52:55], v137, s[36:39], s51 offen offset:1024 sc1
  s_lshl_b32 s50, s74, 16
  v_mfma_f32_16x16x32_bf16 v[168:171], a[188:191], a[120:123], v[168:171]
  s_add_u32 m0, s70, 45056
  ds_read_b64_tr_b16 a[178:179], v247 offset:49152
  ds_read_b64_tr_b16 a[180:181], v247 offset:53248
  v_mfma_f32_16x16x32_bf16 v[168:171], a[184:187], a[112:115], v[168:171]
  s_waitcnt vmcnt(26) lgkmcnt(11)
  ds_read_b64_tr_b16 a[182:183], v247 offset:57344
  v_mfma_f32_16x16x32_bf16 v[32:35], a[192:195], a[128:131], v[32:35]
  ds_read_b64_tr_b16 a[184:185], v244 offset:47104
  v_mfma_f32_16x16x32_bf16 v[32:35], a[196:199], a[136:139], v[32:35]
  buffer_load_dwordx4 v135, s[24:27], s50 offen offset:2048 lds
  ds_read_b64_tr_b16 a[186:187], v244 offset:51200
  v_mfma_f32_16x16x32_bf16 v[36:39], a[196:199], a[140:143], v[36:39]
  ds_read_b64_tr_b16 a[188:189], v244 offset:55296
  v_mfma_f32_16x16x32_bf16 v[36:39], a[192:195], a[132:135], v[36:39]
  s_waitcnt lgkmcnt(11)
  ds_read_b64_tr_b16 a[190:191], v244 offset:59392
  v_mfma_f32_16x16x32_bf16 v[44:47], a[200:203], a[132:135], v[44:47]
  ds_read_b64_tr_b16 a[192:193], v245 offset:47104
  v_mfma_f32_16x16x32_bf16 v[44:47], a[204:207], a[140:143], v[44:47]
  buffer_load_dwordx4 a[56:59], v137, s[36:39], s51 offen offset:2048 sc1
  ds_read_b64_tr_b16 a[194:195], v245 offset:51200
  v_mfma_f32_16x16x32_bf16 v[40:43], a[204:207], a[136:139], v[40:43]
  ds_read_b64_tr_b16 a[196:197], v245 offset:55296
  v_mfma_f32_16x16x32_bf16 v[40:43], a[200:203], a[128:131], v[40:43]
  s_waitcnt vmcnt(23) lgkmcnt(11)
  s_barrier
  ds_read_b64_tr_b16 a[198:199], v245 offset:59392
  v_mfma_f32_16x16x32_bf16 v[48:51], a[208:211], a[128:131], v[48:51]
  ds_read_b64_tr_b16 a[200:201], v246 offset:47104
  v_mfma_f32_16x16x32_bf16 v[48:51], a[212:215], a[136:139], v[48:51]
  buffer_load_dwordx4 v136, s[24:27], s50 offen offset:3072 lds
  ds_read_b64_tr_b16 a[202:203], v246 offset:51200
  v_mfma_f32_16x16x32_bf16 v[52:55], a[212:215], a[140:143], v[52:55]
  ds_read_b64_tr_b16 a[204:205], v246 offset:55296
  v_mfma_f32_16x16x32_bf16 v[52:55], a[208:211], a[132:135], v[52:55]
  s_waitcnt lgkmcnt(11)
  ds_read_b64_tr_b16 a[206:207], v246 offset:59392
  v_mfma_f32_16x16x32_bf16 v[60:63], a[176:179], a[132:135], v[60:63]
  ds_read_b64_tr_b16 a[208:209], v247 offset:47104
  v_mfma_f32_16x16x32_bf16 v[60:63], a[180:183], a[140:143], v[60:63]
  buffer_load_dwordx4 a[60:63], v137, s[36:39], s51 offen offset:3072 sc1
  s_cmp_eq_u32 s87, 1
  v_mfma_f32_16x16x32_bf16 v[56:59], a[180:183], a[136:139], v[56:59]
  s_cselect_b32 s75, 54, 47
  s_cmp_eq_u32 s87, 3
  s_cselect_b32 s75, 40, s75
  v_mfma_f32_16x16x32_bf16 v[56:59], a[176:179], a[128:131], v[56:59]
  s_waitcnt lgkmcnt(9)
  s_lshl_b32 s51, s75, 11
  ds_read_b64_tr_b16 a[210:211], v247 offset:51200
  v_mfma_f32_16x16x32_bf16 v[144:147], a[184:187], a[128:131], v[144:147]
  ds_read_b64_tr_b16 a[212:213], v247 offset:55296
  ds_read_b64_tr_b16 a[214:215], v247 offset:59392
  v_mfma_f32_16x16x32_bf16 v[144:147], a[188:191], a[136:139], v[144:147]
  ds_read_b64_tr_b16 a[176:177], v244 offset:63488
  buffer_load_dwordx4 a[64:67], v137, s[36:39], s51 offen offset:0 sc1
  v_mfma_f32_16x16x32_bf16 v[148:151], a[188:191], a[140:143], v[148:151]
  ds_read_b64_tr_b16 a[178:179], v248 offset:2048
  ds_read_b64_tr_b16 a[180:181], v248 offset:6144
  v_mfma_f32_16x16x32_bf16 v[148:151], a[184:187], a[132:135], v[148:151]
  s_waitcnt lgkmcnt(11)
  ds_read_b64_tr_b16 a[182:183], v248 offset:10240
  v_mfma_f32_16x16x32_bf16 v[156:159], a[192:195], a[132:135], v[156:159]
  ds_read_b64_tr_b16 a[184:185], v245 offset:63488
  v_mfma_f32_16x16x32_bf16 v[156:159], a[196:199], a[140:143], v[156:159]
  buffer_load_dwordx4 a[68:71], v137, s[36:39], s51 offen offset:1024 sc1
  s_lshl_b32 s50, s75, 16
  v_mfma_f32_16x16x32_bf16 v[152:155], a[196:199], a[136:139], v[152:155]
  s_add_u32 m0, s70, 61440
  ds_read_b64_tr_b16 a[186:187], v249 offset:2048
  ds_read_b64_tr_b16 a[188:189], v249 offset:6144
  v_mfma_f32_16x16x32_bf16 v[152:155], a[192:195], a[128:131], v[152:155]
  s_waitcnt vmcnt(21) lgkmcnt(11)
  s_barrier
  ds_read_b64_tr_b16 a[190:191], v249 offset:10240
  v_mfma_f32_16x16x32_bf16 v[160:163], a[200:203], a[128:131], v[160:163]
  ds_read_b64_tr_b16 a[192:193], v246 offset:63488
  v_mfma_f32_16x16x32_bf16 v[160:163], a[204:207], a[136:139], v[160:163]
  buffer_load_dwordx4 v135, s[24:27], s50 offen offset:2048 lds
  ds_read_b64_tr_b16 a[194:195], v250 offset:2048
  v_mfma_f32_16x16x32_bf16 v[164:167], a[204:207], a[140:143], v[164:167]
  ds_read_b64_tr_b16 a[196:197], v250 offset:6144
  v_mfma_f32_16x16x32_bf16 v[164:167], a[200:203], a[132:135], v[164:167]
  s_waitcnt lgkmcnt(11)
  ds_read_b64_tr_b16 a[198:199], v250 offset:10240
  v_mfma_f32_16x16x32_bf16 v[172:175], a[208:211], a[132:135], v[172:175]
  buffer_load_dwordx4 a[72:75], v137, s[36:39], s51 offen offset:2048 sc1
  ds_read_b64_tr_b16 a[200:201], v247 offset:63488
  v_mfma_f32_16x16x32_bf16 v[172:175], a[212:215], a[140:143], v[172:175]
  ds_read_b64_tr_b16 a[202:203], v251 offset:2048
  v_mfma_f32_16x16x32_bf16 v[168:171], a[212:215], a[136:139], v[168:171]
  ds_read_b64_tr_b16 a[204:205], v251 offset:6144
  v_mfma_f32_16x16x32_bf16 v[168:171], a[208:211], a[128:131], v[168:171]
  s_waitcnt vmcnt(28) lgkmcnt(11)
  ds_read_b64_tr_b16 a[206:207], v251 offset:10240
  v_mfma_f32_16x16x32_bf16 v[144:147], a[176:179], a[216:219], v[144:147]
  buffer_load_dwordx4 v136, s[24:27], s50 offen offset:3072 lds
  ds_read_b64_tr_b16 a[208:209], v248 offset:14336
  v_mfma_f32_16x16x32_bf16 v[144:147], a[180:183], a[224:227], v[144:147]
  ds_read_b64_tr_b16 a[210:211], v248 offset:18432
  v_mfma_f32_16x16x32_bf16 v[148:151], a[180:183], a[228:231], v[148:151]
  ds_read_b64_tr_b16 a[212:213], v248 offset:22528
  v_mfma_f32_16x16x32_bf16 v[148:151], a[176:179], a[220:223], v[148:151]
  s_waitcnt lgkmcnt(11)
  ds_read_b64_tr_b16 a[214:215], v248 offset:26624
  v_mfma_f32_16x16x32_bf16 v[156:159], a[184:187], a[220:223], v[156:159]
  buffer_load_dwordx4 a[76:79], v137, s[36:39], s51 offen offset:3072 sc1
  s_cmp_eq_u32 s87, 0
  v_mfma_f32_16x16x32_bf16 v[156:159], a[188:191], a[228:231], v[156:159]
  s_cselect_b32 s76, 43, 50
  s_lshl_b32 s51, s76, 11
  ds_read_b64_tr_b16 a[176:177], v249 offset:14336
  v_mfma_f32_16x16x32_bf16 v[152:155], a[188:191], a[224:227], v[152:155]
  ds_read_b64_tr_b16 a[178:179], v249 offset:18432
  ds_read_b64_tr_b16 a[180:181], v249 offset:22528
  v_mfma_f32_16x16x32_bf16 v[152:155], a[184:187], a[216:219], v[152:155]
  s_waitcnt vmcnt(19) lgkmcnt(11)
  s_barrier
  ds_read_b64_tr_b16 a[182:183], v249 offset:26624
  v_mfma_f32_16x16x32_bf16 v[160:163], a[192:195], a[216:219], v[160:163]
  buffer_load_dwordx4 a[80:83], v137, s[36:39], s51 offen offset:0 sc1
  ds_read_b64_tr_b16 a[184:185], v250 offset:14336
  v_mfma_f32_16x16x32_bf16 v[160:163], a[196:199], a[224:227], v[160:163]
  ds_read_b64_tr_b16 a[186:187], v250 offset:18432
  v_mfma_f32_16x16x32_bf16 v[164:167], a[196:199], a[228:231], v[164:167]
  ds_read_b64_tr_b16 a[188:189], v250 offset:22528
  v_mfma_f32_16x16x32_bf16 v[164:167], a[192:195], a[220:223], v[164:167]
  s_waitcnt lgkmcnt(11)
  ds_read_b64_tr_b16 a[190:191], v250 offset:26624
  v_mfma_f32_16x16x32_bf16 v[172:175], a[200:203], a[220:223], v[172:175]
  buffer_load_dwordx4 a[84:87], v137, s[36:39], s51 offen offset:1024 sc1
  s_lshl_b32 s50, s76, 16
  v_mfma_f32_16x16x32_bf16 v[172:175], a[204:207], a[228:231], v[172:175]
  s_add_u32 m0, s70, 77824
  ds_read_b64_tr_b16 a[192:193], v251 offset:14336
  ds_read_b64_tr_b16 a[194:195], v251 offset:18432
  v_mfma_f32_16x16x32_bf16 v[168:171], a[204:207], a[224:227], v[168:171]
  ds_read_b64_tr_b16 a[196:197], v251 offset:22528
  v_mfma_f32_16x16x32_bf16 v[168:171], a[200:203], a[216:219], v[168:171]
  s_waitcnt vmcnt(26) lgkmcnt(11)
  ds_read_b64_tr_b16 a[198:199], v251 offset:26624
  v_mfma_f32_16x16x32_bf16 v[144:147], a[208:211], a[0:3], v[144:147]
  buffer_load_dwordx4 v135, s[24:27], s50 offen offset:2048 lds
  ds_read_b64_tr_b16 a[200:201], v240 offset:14336
  v_mfma_f32_16x16x32_bf16 v[144:147], a[212:215], a[8:11], v[144:147]
  ds_read_b64_tr_b16 a[202:203], v240 offset:18432
  v_mfma_f32_16x16x32_bf16 v[148:151], a[212:215], a[12:15], v[148:151]
  ds_read_b64_tr_b16 a[204:205], v240 offset:22528
  v_mfma_f32_16x16x32_bf16 v[148:151], a[208:211], a[4:7], v[148:151]
  s_waitcnt lgkmcnt(11)
  ds_read_b64_tr_b16 a[206:207], v240 offset:26624
  v_mfma_f32_16x16x32_bf16 v[156:159], a[176:179], a[4:7], v[156:159]
  buffer_load_dwordx4 a[88:91], v137, s[36:39], s51 offen offset:2048 sc1
  ds_read_b64_tr_b16 a[208:209], v241 offset:14336
  v_mfma_f32_16x16x32_bf16 v[156:159], a[180:183], a[12:15], v[156:159]
  ds_read_b64_tr_b16 a[210:211], v241 offset:18432
  v_mfma_f32_16x16x32_bf16 v[152:155], a[180:183], a[8:11], v[152:155]
  ds_read_b64_tr_b16 a[212:213], v241 offset:22528
  v_mfma_f32_16x16x32_bf16 v[152:155], a[176:179], a[0:3], v[152:155]
  s_waitcnt vmcnt(17) lgkmcnt(11)
  s_barrier
  ds_read_b64_tr_b16 a[214:215], v241 offset:26624
  v_mfma_f32_16x16x32_bf16 v[160:163], a[184:187], a[0:3], v[160:163]
  buffer_load_dwordx4 v136, s[24:27], s50 offen offset:3072 lds
  ds_read_b64_tr_b16 a[176:177], v242 offset:14336
  v_mfma_f32_16x16x32_bf16 v[160:163], a[188:191], a[8:11], v[160:163]
  ds_read_b64_tr_b16 a[178:179], v242 offset:18432
  v_mfma_f32_16x16x32_bf16 v[164:167], a[188:191], a[12:15], v[164:167]
  ds_read_b64_tr_b16 a[180:181], v242 offset:22528
  v_mfma_f32_16x16x32_bf16 v[164:167], a[184:187], a[4:7], v[164:167]
  s_waitcnt lgkmcnt(11)
  ds_read_b64_tr_b16 a[182:183], v242 offset:26624
  v_mfma_f32_16x16x32_bf16 v[172:175], a[192:195], a[4:7], v[172:175]
  buffer_load_dwordx4 a[92:95], v137, s[36:39], s51 offen offset:3072 sc1
  s_cmp_eq_u32 s87, 1
  v_mfma_f32_16x16x32_bf16 v[172:175], a[196:199], a[12:15], v[172:175]
  s_cselect_b32 s81, 47, 54
  s_lshl_b32 s51, s81, 11
  ds_read_b64_tr_b16 a[184:185], v243 offset:14336
  v_mfma_f32_16x16x32_bf16 v[168:171], a[196:199], a[8:11], v[168:171]
  ds_read_b64_tr_b16 a[186:187], v243 offset:18432
  ds_read_b64_tr_b16 a[188:189], v243 offset:22528
  v_mfma_f32_16x16x32_bf16 v[168:171], a[192:195], a[0:3], v[168:171]
  s_waitcnt vmcnt(24) lgkmcnt(11)
  ds_read_b64_tr_b16 a[190:191], v243 offset:26624
  v_mfma_f32_16x16x32_bf16 v[144:147], a[200:203], a[16:19], v[144:147]
  buffer_load_dwordx4 a[96:99], v137, s[36:39], s51 offen offset:0 sc1
  ds_read_b64_tr_b16 a[192:193], v240 offset:30720
  v_mfma_f32_16x16x32_bf16 v[144:147], a[204:207], a[24:27], v[144:147]
  ds_read_b64_tr_b16 a[194:195], v240 offset:34816
  v_mfma_f32_16x16x32_bf16 v[148:151], a[204:207], a[28:31], v[148:151]
  ds_read_b64_tr_b16 a[196:197], v240 offset:38912
  v_mfma_f32_16x16x32_bf16 v[148:151], a[200:203], a[20:23], v[148:151]
  s_waitcnt lgkmcnt(11)
  ds_read_b64_tr_b16 a[198:199], v240 offset:43008
  v_mfma_f32_16x16x32_bf16 v[156:159], a[208:211], a[20:23], v[156:159]
  buffer_load_dwordx4 a[100:103], v137, s[36:39], s51 offen offset:1024 sc1
  s_lshl_b32 s50, s81, 16
  v_mfma_f32_16x16x32_bf16 v[156:159], a[212:215], a[28:31], v[156:159]
  s_add_u32 m0, s70, 94208
  ds_read_b64_tr_b16 a[200:201], v241 offset:30720
  ds_read_b64_tr_b16 a[202:203], v241 offset:34816
  v_mfma_f32_16x16x32_bf16 v[152:155], a[212:215], a[24:27], v[152:155]
  ds_read_b64_tr_b16 a[204:205], v241 offset:38912
  v_mfma_f32_16x16x32_bf16 v[152:155], a[208:211], a[16:19], v[152:155]
  s_waitcnt vmcnt(15) lgkmcnt(11)
  s_barrier
  ds_read_b64_tr_b16 a[206:207], v241 offset:43008
  v_mfma_f32_16x16x32_bf16 v[160:163], a[176:179], a[16:19], v[160:163]
Hb0_1:
  s_cbranch_execz Rb
  buffer_load_dwordx4 v135, s[24:27], s50 offen offset:2048 lds
  ds_read_b64_tr_b16 a[208:209], v242 offset:30720
  v_mfma_f32_16x16x32_bf16 v[160:163], a[180:183], a[24:27], v[160:163]
  ds_read_b64_tr_b16 a[210:211], v242 offset:34816
  v_mfma_f32_16x16x32_bf16 v[164:167], a[180:183], a[28:31], v[164:167]
  ds_read_b64_tr_b16 a[212:213], v242 offset:38912
  v_mfma_f32_16x16x32_bf16 v[164:167], a[176:179], a[20:23], v[164:167]
  s_waitcnt lgkmcnt(11)
  ds_read_b64_tr_b16 a[214:215], v242 offset:43008
  v_mfma_f32_16x16x32_bf16 v[172:175], a[184:187], a[20:23], v[172:175]
  buffer_load_dwordx4 a[104:107], v137, s[36:39], s51 offen offset:2048 sc1
  ds_read_b64_tr_b16 a[176:177], v243 offset:30720
  v_mfma_f32_16x16x32_bf16 v[172:175], a[188:191], a[28:31], v[172:175]
  ds_read_b64_tr_b16 a[178:179], v243 offset:34816
  v_mfma_f32_16x16x32_bf16 v[168:171], a[188:191], a[24:27], v[168:171]
  ds_read_b64_tr_b16 a[180:181], v243 offset:38912
  v_mfma_f32_16x16x32_bf16 v[168:171], a[184:187], a[16:19], v[168:171]
  s_waitcnt vmcnt(22) lgkmcnt(11)
  ds_read_b64_tr_b16 a[182:183], v243 offset:43008
  v_mfma_f32_16x16x32_bf16 v[144:147], a[192:195], a[32:35], v[144:147]
  buffer_load_dwordx4 v136, s[24:27], s50 offen offset:3072 lds
  ds_read_b64_tr_b16 a[184:185], v240 offset:47104
  v_mfma_f32_16x16x32_bf16 v[144:147], a[196:199], a[40:43], v[144:147]
  ds_read_b64_tr_b16 a[186:187], v240 offset:51200
  v_mfma_f32_16x16x32_bf16 v[148:151], a[196:199], a[44:47], v[148:151]
  ds_read_b64_tr_b16 a[188:189], v240 offset:55296
  v_mfma_f32_16x16x32_bf16 v[148:151], a[192:195], a[36:39], v[148:151]
  s_waitcnt lgkmcnt(11)
  ds_read_b64_tr_b16 a[190:191], v240 offset:59392
  v_mfma_f32_16x16x32_bf16 v[156:159], a[200:203], a[36:39], v[156:159]
  buffer_load_dwordx4 a[108:111], v137, s[36:39], s51 offen offset:3072 sc1
  s_lshl_b32 s50, s69, 16
  v_mfma_f32_16x16x32_bf16 v[156:159], a[204:207], a[44:47], v[156:159]
  s_add_u32 m0, s70, 126976
  ds_read_b64_tr_b16 a[192:193], v241 offset:47104
  ds_read_b64_tr_b16 a[194:195], v241 offset:51200
  v_mfma_f32_16x16x32_bf16 v[152:155], a[204:207], a[40:43], v[152:155]
  ds_read_b64_tr_b16 a[196:197], v241 offset:55296
  v_mfma_f32_16x16x32_bf16 v[152:155], a[200:203], a[32:35], v[152:155]
  s_waitcnt vmcnt(13) lgkmcnt(11)
  s_barrier
  ds_read_b64_tr_b16 a[198:199], v241 offset:59392
  v_mfma_f32_16x16x32_bf16 v[160:163], a[208:211], a[32:35], v[160:163]
  buffer_load_dwordx4 v133, s[24:27], s50 offen offset:0 lds
  ds_read_b64_tr_b16 a[200:201], v242 offset:47104
  v_mfma_f32_16x16x32_bf16 v[160:163], a[212:215], a[40:43], v[160:163]
  ds_read_b64_tr_b16 a[202:203], v242 offset:51200
  v_mfma_f32_16x16x32_bf16 v[164:167], a[212:215], a[44:47], v[164:167]
  ds_read_b64_tr_b16 a[204:205], v242 offset:55296
  v_mfma_f32_16x16x32_bf16 v[164:167], a[208:211], a[36:39], v[164:167]
  s_waitcnt lgkmcnt(11)
  ds_read_b64_tr_b16 a[206:207], v242 offset:59392
  v_mfma_f32_16x16x32_bf16 v[172:175], a[176:179], a[36:39], v[172:175]
  buffer_load_dwordx4 v134, s[24:27], s50 offen offset:1024 lds
  s_lshl_b32 s50, s71, 16
  v_mfma_f32_16x16x32_bf16 v[172:175], a[180:183], a[44:47], v[172:175]
  s_add_u32 m0, s70, 143360
  ds_read_b64_tr_b16 a[208:209], v243 offset:47104
  ds_read_b64_tr_b16 a[210:211], v243 offset:51200
  v_mfma_f32_16x16x32_bf16 v[168:171], a[180:183], a[40:43], v[168:171]
  ds_read_b64_tr_b16 a[212:213], v243 offset:55296
  v_mfma_f32_16x16x32_bf16 v[168:171], a[176:179], a[32:35], v[168:171]
  s_waitcnt vmcnt(20) lgkmcnt(11)
  ds_read_b64_tr_b16 a[214:215], v243 offset:59392
  v_mfma_f32_16x16x32_bf16 v[144:147], a[184:187], a[48:51], v[144:147]
  buffer_load_dwordx4 v133, s[24:27], s50 offen offset:0 lds
  ds_read_b64_tr_b16 a[176:177], v240 offset:63488
  v_mfma_f32_16x16x32_bf16 v[144:147], a[188:191], a[56:59], v[144:147]
  ds_read_b64_tr_b16 a[178:179], v244 offset:2048
  v_mfma_f32_16x16x32_bf16 v[148:151], a[188:191], a[60:63], v[148:151]
  ds_read_b64_tr_b16 a[180:181], v244 offset:6144
  v_mfma_f32_16x16x32_bf16 v[148:151], a[184:187], a[52:55], v[148:151]
  s_waitcnt lgkmcnt(11)
  ds_read_b64_tr_b16 a[182:183], v244 offset:10240
  v_mfma_f32_16x16x32_bf16 v[156:159], a[192:195], a[52:55], v[156:159]
  buffer_load_dwordx4 v134, s[24:27], s50 offen offset:1024 lds
  s_lshl_b32 s50, s72, 16
  v_mfma_f32_16x16x32_bf16 v[156:159], a[196:199], a[60:63], v[156:159]
  s_add_u32 m0, s70, 12288
  ds_read_b64_tr_b16 a[184:185], v241 offset:63488
  ds_read_b64_tr_b16 a[186:187], v245 offset:2048
  v_mfma_f32_16x16x32_bf16 v[152:155], a[196:199], a[56:59], v[152:155]
  ds_read_b64_tr_b16 a[188:189], v245 offset:6144
  v_mfma_f32_16x16x32_bf16 v[152:155], a[192:195], a[48:51], v[152:155]
  s_waitcnt vmcnt(11) lgkmcnt(11)
  s_barrier
  ds_read_b64_tr_b16 a[190:191], v245 offset:10240
  v_mfma_f32_16x16x32_bf16 v[160:163], a[200:203], a[48:51], v[160:163]
  buffer_load_dwordx4 v133, s[24:27], s50 offen offset:0 lds
  ds_read_b64_tr_b16 a[192:193], v242 offset:63488
  v_mfma_f32_16x16x32_bf16 v[160:163], a[204:207], a[56:59], v[160:163]
  ds_read_b64_tr_b16 a[194:195], v246 offset:2048
  v_mfma_f32_16x16x32_bf16 v[164:167], a[204:207], a[60:63], v[164:167]
  ds_read_b64_tr_b16 a[196:197], v246 offset:6144
  v_mfma_f32_16x16x32_bf16 v[164:167], a[200:203], a[52:55], v[164:167]
  s_waitcnt lgkmcnt(11)
  ds_read_b64_tr_b16 a[198:199], v246 offset:10240
  v_mfma_f32_16x16x32_bf16 v[172:175], a[208:211], a[52:55], v[172:175]
  buffer_load_dwordx4 v134, s[24:27], s50 offen offset:1024 lds
  s_lshl_b32 s50, s73, 16
  v_mfma_f32_16x16x32_bf16 v[172:175], a[212:215], a[60:63], v[172:175]
  s_add_u32 m0, s70, 28672
  ds_read_b64_tr_b16 a[200:201], v243 offset:63488
  ds_read_b64_tr_b16 a[202:203], v247 offset:2048
  v_mfma_f32_16x16x32_bf16 v[168:171], a[212:215], a[56:59], v[168:171]
  ds_read_b64_tr_b16 a[204:205], v247 offset:6144
  v_mfma_f32_16x16x32_bf16 v[168:171], a[208:211], a[48:51], v[168:171]
  s_waitcnt vmcnt(18) lgkmcnt(11)
  ds_read_b64_tr_b16 a[206:207], v247 offset:10240
  v_mfma_f32_16x16x32_bf16 v[144:147], a[176:179], a[64:67], v[144:147]
  buffer_load_dwordx4 v133, s[24:27], s50 offen offset:0 lds
  ds_read_b64_tr_b16 a[208:209], v244 offset:14336
  v_mfma_f32_16x16x32_bf16 v[144:147], a[180:183], a[72:75], v[144:147]
  ds_read_b64_tr_b16 a[210:211], v244 offset:18432
  v_mfma_f32_16x16x32_bf16 v[148:151], a[180:183], a[76:79], v[148:151]
  ds_read_b64_tr_b16 a[212:213], v244 offset:22528
  v_mfma_f32_16x16x32_bf16 v[148:151], a[176:179], a[68:71], v[148:151]
  s_waitcnt lgkmcnt(11)
  ds_read_b64_tr_b16 a[214:215], v244 offset:26624
  v_mfma_f32_16x16x32_bf16 v[156:159], a[184:187], a[68:71], v[156:159]
  buffer_load_dwordx4 v134, s[24:27], s50 offen offset:1024 lds
  s_lshl_b32 s50, s74, 16
  v_mfma_f32_16x16x32_bf16 v[156:159], a[188:191], a[76:79], v[156:159]
  s_add_u32 m0, s70, 45056
  ds_read_b64_tr_b16 a[176:177], v245 offset:14336
  ds_read_b64_tr_b16 a[178:179], v245 offset:18432
  v_mfma_f32_16x16x32_bf16 v[152:155], a[188:191], a[72:75], v[152:155]
  ds_read_b64_tr_b16 a[180:181], v245 offset:22528
  v_mfma_f32_16x16x32_bf16 v[152:155], a[184:187], a[64:67], v[152:155]
  s_waitcnt vmcnt(9) lgkmcnt(11)
  s_barrier
  ds_read_b64_tr_b16 a[182:183], v245 offset:26624
  v_mfma_f32_16x16x32_bf16 v[160:163], a[192:195], a[64:67], v[160:163]
  buffer_load_dwordx4 v133, s[24:27], s50 offen offset:0 lds
  ds_read_b64_tr_b16 a[184:185], v246 offset:14336
  v_mfma_f32_16x16x32_bf16 v[160:163], a[196:199], a[72:75], v[160:163]
  ds_read_b64_tr_b16 a[186:187], v246 offset:18432
  v_mfma_f32_16x16x32_bf16 v[164:167], a[196:199], a[76:79], v[164:167]
  ds_read_b64_tr_b16 a[188:189], v246 offset:22528
  v_mfma_f32_16x16x32_bf16 v[164:167], a[192:195], a[68:71], v[164:167]
  s_waitcnt lgkmcnt(11)
  ds_read_b64_tr_b16 a[190:191], v246 offset:26624
  v_mfma_f32_16x16x32_bf16 v[172:175], a[200:203], a[68:71], v[172:175]
  buffer_load_dwordx4 v134, s[24:27], s50 offen offset:1024 lds
  s_lshl_b32 s50, s75, 16
  v_mfma_f32_16x16x32_bf16 v[172:175], a[204:207], a[76:79], v[172:175]
  s_add_u32 m0, s70, 61440
  ds_read_b64_tr_b16 a[192:193], v247 offset:14336
  ds_read_b64_tr_b16 a[194:195], v247 offset:18432
  v_mfma_f32_16x16x32_bf16 v[168:171], a[204:207], a[72:75], v[168:171]
  ds_read_b64_tr_b16 a[196:197], v247 offset:22528
  v_mfma_f32_16x16x32_bf16 v[168:171], a[200:203], a[64:67], v[168:171]
  s_waitcnt vmcnt(16) lgkmcnt(11)
  ds_read_b64_tr_b16 a[198:199], v247 offset:26624
  v_mfma_f32_16x16x32_bf16 v[144:147], a[208:211], a[80:83], v[144:147]
  buffer_load_dwordx4 v133, s[24:27], s50 offen offset:0 lds
  ds_read_b64_tr_b16 a[200:201], v244 offset:30720
  v_mfma_f32_16x16x32_bf16 v[144:147], a[212:215], a[88:91], v[144:147]
  ds_read_b64_tr_b16 a[202:203], v244 offset:34816
  v_mfma_f32_16x16x32_bf16 v[148:151], a[212:215], a[92:95], v[148:151]
  ds_read_b64_tr_b16 a[204:205], v244 offset:38912
  v_mfma_f32_16x16x32_bf16 v[148:151], a[208:211], a[84:87], v[148:151]
  s_waitcnt lgkmcnt(11)
  ds_read_b64_tr_b16 a[206:207], v244 offset:43008
  v_mfma_f32_16x16x32_bf16 v[156:159], a[176:179], a[84:87], v[156:159]
  buffer_load_dwordx4 v134, s[24:27], s50 offen offset:1024 lds
  s_lshl_b32 s50, s76, 16
  v_mfma_f32_16x16x32_bf16 v[156:159], a[180:183], a[92:95], v[156:159]
  s_add_u32 m0, s70, 77824
  ds_read_b64_tr_b16 a[208:209], v245 offset:30720
  ds_read_b64_tr_b16 a[210:211], v245 offset:34816
  v_mfma_f32_16x16x32_bf16 v[152:155], a[180:183], a[88:91], v[152:155]
  ds_read_b64_tr_b16 a[212:213], v245 offset:38912
  v_mfma_f32_16x16x32_bf16 v[152:155], a[176:179], a[80:83], v[152:155]
  s_waitcnt vmcnt(10) lgkmcnt(11)
  s_barrier
  ds_read_b64_tr_b16 a[214:215], v245 offset:43008
  v_mfma_f32_16x16x32_bf16 v[160:163], a[184:187], a[80:83], v[160:163]
  buffer_load_dwordx4 v133, s[24:27], s50 offen offset:0 lds
  ds_read_b64_tr_b16 a[176:177], v246 offset:30720
  v_mfma_f32_16x16x32_bf16 v[160:163], a[188:191], a[88:91], v[160:163]
  ds_read_b64_tr_b16 a[178:179], v246 offset:34816
  v_mfma_f32_16x16x32_bf16 v[164:167], a[188:191], a[92:95], v[164:167]
  ds_read_b64_tr_b16 a[180:181], v246 offset:38912
  v_mfma_f32_16x16x32_bf16 v[164:167], a[184:187], a[84:87], v[164:167]
  s_waitcnt lgkmcnt(11)
  ds_read_b64_tr_b16 a[182:183], v246 offset:43008
  v_mfma_f32_16x16x32_bf16 v[172:175], a[192:195], a[84:87], v[172:175]
  buffer_load_dwordx4 v134, s[24:27], s50 offen offset:1024 lds
  s_lshl_b32 s50, s81, 16
  v_mfma_f32_16x16x32_bf16 v[172:175], a[196:199], a[92:95], v[172:175]
  s_add_u32 m0, s70, 94208
  ds_read_b64_tr_b16 a[184:185], v247 offset:30720
  ds_read_b64_tr_b16 a[186:187], v247 offset:34816
  v_mfma_f32_16x16x32_bf16 v[168:171], a[196:199], a[88:91], v[168:171]
  ds_read_b64_tr_b16 a[188:189], v247 offset:38912
  v_mfma_f32_16x16x32_bf16 v[168:171], a[192:195], a[80:83], v[168:171]
  s_waitcnt vmcnt(14) lgkmcnt(11)
  ds_read_b64_tr_b16 a[190:191], v247 offset:43008
  v_mfma_f32_16x16x32_bf16 v[144:147], a[200:203], a[96:99], v[144:147]
  buffer_load_dwordx4 v133, s[24:27], s50 offen offset:0 lds
  ds_read_b64_tr_b16 a[192:193], v244 offset:61440
  v_mfma_f32_16x16x32_bf16 v[144:147], a[204:207], a[104:107], v[144:147]
  ds_read_b64_tr_b16 a[194:195], v248 offset:0
  v_mfma_f32_16x16x32_bf16 v[148:151], a[204:207], a[108:111], v[148:151]
  ds_read_b64_tr_b16 a[196:197], v248 offset:4096
  v_mfma_f32_16x16x32_bf16 v[148:151], a[200:203], a[100:103], v[148:151]
  s_waitcnt lgkmcnt(11)
  ds_read_b64_tr_b16 a[198:199], v248 offset:8192
  v_mfma_f32_16x16x32_bf16 v[156:159], a[208:211], a[100:103], v[156:159]
  buffer_load_dwordx4 v134, s[24:27], s50 offen offset:1024 lds
  ds_read_b64_tr_b16 a[200:201], v245 offset:61440
  v_mfma_f32_16x16x32_bf16 v[156:159], a[212:215], a[108:111], v[156:159]
  ds_read_b64_tr_b16 a[202:203], v249 offset:0
  v_mfma_f32_16x16x32_bf16 v[152:155], a[212:215], a[104:107], v[152:155]
  ds_read_b64_tr_b16 a[204:205], v249 offset:4096
  v_mfma_f32_16x16x32_bf16 v[152:155], a[208:211], a[96:99], v[152:155]
  s_waitcnt vmcnt(12) lgkmcnt(11)
  s_barrier
  ds_read_b64_tr_b16 a[206:207], v249 offset:8192
  v_mfma_f32_16x16x32_bf16 v[160:163], a[176:179], a[96:99], v[160:163]
  ds_read_b64_tr_b16 a[208:209], v246 offset:61440
  buffer_store_dwordx4 v[144:147], v0, s[36:39], s61 offen offset:0 sc1
  v_mfma_f32_16x16x32_bf16 v[160:163], a[180:183], a[104:107], v[160:163]
  buffer_store_dwordx4 v[148:151], v0, s[36:39], s61 offen offset:1024 sc1
  ds_read_b64_tr_b16 a[210:211], v250 offset:0
  v_mfma_f32_16x16x32_bf16 v[164:167], a[180:183], a[108:111], v[164:167]
  ds_read_b64_tr_b16 a[212:213], v250 offset:4096
  v_mfma_f32_16x16x32_bf16 v[164:167], a[176:179], a[100:103], v[164:167]
  s_waitcnt lgkmcnt(11)
  ds_read_b64_tr_b16 a[214:215], v250 offset:8192
  v_mfma_f32_16x16x32_bf16 v[172:175], a[184:187], a[100:103], v[172:175]
  ds_read_b64_tr_b16 a[176:177], v247 offset:61440
  buffer_store_dwordx4 v[152:155], v0, s[36:39], s61 offen offset:2048 sc1
  v_mfma_f32_16x16x32_bf16 v[172:175], a[188:191], a[108:111], v[172:175]
  buffer_store_dwordx4 v[156:159], v0, s[36:39], s61 offen offset:3072 sc1
  ds_read_b64_tr_b16 a[178:179], v251 offset:0
  v_mfma_f32_16x16x32_bf16 v[168:171], a[188:191], a[104:107], v[168:171]
  ds_read_b64_tr_b16 a[180:181], v251 offset:4096
  v_mfma_f32_16x16x32_bf16 v[168:171], a[184:187], a[96:99], v[168:171]
  s_waitcnt lgkmcnt(11)
  ds_read_b64_tr_b16 a[182:183], v251 offset:8192
  v_mfma_f32_16x16x32_bf16 v[32:35], a[192:195], a[216:219], v[32:35]
  ds_read_b64_tr_b16 a[184:185], v248 offset:12288
  buffer_store_dwordx4 v[160:163], v0, s[36:39], s62 offen offset:0 sc1
  v_mfma_f32_16x16x32_bf16 v[32:35], a[196:199], a[224:227], v[32:35]
  buffer_store_dwordx4 v[164:167], v0, s[36:39], s62 offen offset:1024 sc1
  ds_read_b64_tr_b16 a[186:187], v248 offset:16384
  v_mfma_f32_16x16x32_bf16 v[36:39], a[196:199], a[228:231], v[36:39]
  ds_read_b64_tr_b16 a[188:189], v248 offset:20480
  v_mfma_f32_16x16x32_bf16 v[36:39], a[192:195], a[220:223], v[36:39]
  s_waitcnt lgkmcnt(11)
  ds_read_b64_tr_b16 a[190:191], v248 offset:24576
  v_mfma_f32_16x16x32_bf16 v[44:47], a[200:203], a[220:223], v[44:47]
  ds_read_b64_tr_b16 a[192:193], v249 offset:12288
  buffer_store_dwordx4 v[168:171], v0, s[36:39], s62 offen offset:2048 sc1
  v_mfma_f32_16x16x32_bf16 v[44:47], a[204:207], a[228:231], v[44:47]
  buffer_store_dwordx4 v[172:175], v0, s[36:39], s62 offen offset:3072 sc1
  ds_read_b64_tr_b16 a[194:195], v249 offset:16384
  v_mfma_f32_16x16x32_bf16 v[40:43], a[204:207], a[224:227], v[40:43]
  ds_read_b64_tr_b16 a[196:197], v249 offset:20480
  v_mfma_f32_16x16x32_bf16 v[40:43], a[200:203], a[216:219], v[40:43]
  s_waitcnt vmcnt(18) lgkmcnt(11)
  s_barrier
  ds_read_b64_tr_b16 a[198:199], v249 offset:24576
  v_mfma_f32_16x16x32_bf16 v[48:51], a[208:211], a[216:219], v[48:51]
  ds_read_b64_tr_b16 a[200:201], v250 offset:12288
  v_mfma_f32_16x16x32_bf16 v[48:51], a[212:215], a[224:227], v[48:51]
  ds_read_b64_tr_b16 a[202:203], v250 offset:16384
  v_mfma_f32_16x16x32_bf16 v[52:55], a[212:215], a[228:231], v[52:55]
  ds_read_b64_tr_b16 a[204:205], v250 offset:20480
  v_mfma_f32_16x16x32_bf16 v[52:55], a[208:211], a[220:223], v[52:55]
  s_waitcnt lgkmcnt(11)
  ds_read_b64_tr_b16 a[206:207], v250 offset:24576
  v_mfma_f32_16x16x32_bf16 v[60:63], a[176:179], a[220:223], v[60:63]
  ds_read_b64_tr_b16 a[208:209], v251 offset:12288
  v_mfma_f32_16x16x32_bf16 v[60:63], a[180:183], a[228:231], v[60:63]
  ds_read_b64_tr_b16 a[210:211], v251 offset:16384
  v_mfma_f32_16x16x32_bf16 v[56:59], a[180:183], a[224:227], v[56:59]
  ds_read_b64_tr_b16 a[212:213], v251 offset:20480
  v_mfma_f32_16x16x32_bf16 v[56:59], a[176:179], a[216:219], v[56:59]
  s_waitcnt lgkmcnt(11)
  ds_read_b64_tr_b16 a[214:215], v251 offset:24576
  v_mfma_f32_16x16x32_bf16 v[32:35], a[184:187], a[0:3], v[32:35]
  ds_read_b64_tr_b16 a[176:177], v240 offset:12288
  v_mfma_f32_16x16x32_bf16 v[32:35], a[188:191], a[8:11], v[32:35]
  ds_read_b64_tr_b16 a[178:179], v240 offset:16384
  buffer_load_dword v139, v132, s[36:39], s79 offen sc1
  v_mfma_f32_16x16x32_bf16 v[36:39], a[188:191], a[12:15], v[36:39]
  ds_read_b64_tr_b16 a[180:181], v240 offset:20480
  v_mfma_f32_16x16x32_bf16 v[36:39], a[184:187], a[4:7], v[36:39]
  s_waitcnt lgkmcnt(11)
  ds_read_b64_tr_b16 a[182:183], v240 offset:24576
  v_mfma_f32_16x16x32_bf16 v[44:47], a[192:195], a[4:7], v[44:47]
  ds_read_b64_tr_b16 a[184:185], v241 offset:12288
  v_mfma_f32_16x16x32_bf16 v[44:47], a[196:199], a[12:15], v[44:47]
  ds_read_b64_tr_b16 a[186:187], v241 offset:16384
  v_mfma_f32_16x16x32_bf16 v[40:43], a[196:199], a[8:11], v[40:43]
  ds_read_b64_tr_b16 a[188:189], v241 offset:20480
  v_mfma_f32_16x16x32_bf16 v[40:43], a[192:195], a[0:3], v[40:43]
  s_waitcnt vmcnt(17) lgkmcnt(11)
  s_barrier
  ds_read_b64_tr_b16 a[190:191], v241 offset:24576
  v_mfma_f32_16x16x32_bf16 v[48:51], a[200:203], a[0:3], v[48:51]
  ds_read_b64_tr_b16 a[192:193], v242 offset:12288
  v_mfma_f32_16x16x32_bf16 v[48:51], a[204:207], a[8:11], v[48:51]
  ds_read_b64_tr_b16 a[194:195], v242 offset:16384
  v_mfma_f32_16x16x32_bf16 v[52:55], a[204:207], a[12:15], v[52:55]
  ds_read_b64_tr_b16 a[196:197], v242 offset:20480
  v_mfma_f32_16x16x32_bf16 v[52:55], a[200:203], a[4:7], v[52:55]
  s_waitcnt lgkmcnt(11)
  ds_read_b64_tr_b16 a[198:199], v242 offset:24576
  v_mfma_f32_16x16x32_bf16 v[60:63], a[208:211], a[4:7], v[60:63]
  ds_read_b64_tr_b16 a[200:201], v243 offset:12288
  v_mfma_f32_16x16x32_bf16 v[60:63], a[212:215], a[12:15], v[60:63]
  ds_read_b64_tr_b16 a[202:203], v243 offset:16384
  v_mfma_f32_16x16x32_bf16 v[56:59], a[212:215], a[8:11], v[56:59]
  ds_read_b64_tr_b16 a[204:205], v243 offset:20480
  v_mfma_f32_16x16x32_bf16 v[56:59], a[208:211], a[0:3], v[56:59]
  s_waitcnt lgkmcnt(11)
  ds_read_b64_tr_b16 a[206:207], v243 offset:24576
  v_mfma_f32_16x16x32_bf16 v[32:35], a[176:179], a[16:19], v[32:35]
  ds_read_b64_tr_b16 a[208:209], v240 offset:28672
  v_mfma_f32_16x16x32_bf16 v[32:35], a[180:183], a[24:27], v[32:35]
  ds_read_b64_tr_b16 a[210:211], v240 offset:32768
  v_mfma_f32_16x16x32_bf16 v[36:39], a[180:183], a[28:31], v[36:39]
  ds_read_b64_tr_b16 a[212:213], v240 offset:36864
  v_mfma_f32_16x16x32_bf16 v[36:39], a[176:179], a[20:23], v[36:39]
  s_waitcnt lgkmcnt(11)
  ds_read_b64_tr_b16 a[214:215], v240 offset:40960
  v_mfma_f32_16x16x32_bf16 v[44:47], a[184:187], a[20:23], v[44:47]
  ds_read_b64_tr_b16 a[176:177], v241 offset:28672
  v_mfma_f32_16x16x32_bf16 v[44:47], a[188:191], a[28:31], v[44:47]
  ds_read_b64_tr_b16 a[178:179], v241 offset:32768
  v_mfma_f32_16x16x32_bf16 v[40:43], a[188:191], a[24:27], v[40:43]
  ds_read_b64_tr_b16 a[180:181], v241 offset:36864
  v_mfma_f32_16x16x32_bf16 v[40:43], a[184:187], a[16:19], v[40:43]
  s_waitcnt vmcnt(15) lgkmcnt(11)
  s_barrier
  ds_read_b64_tr_b16 a[182:183], v241 offset:40960
  v_mfma_f32_16x16x32_bf16 v[48:51], a[192:195], a[16:19], v[48:51]
  ds_read_b64_tr_b16 a[184:185], v242 offset:28672
  v_mfma_f32_16x16x32_bf16 v[48:51], a[196:199], a[24:27], v[48:51]
  ds_read_b64_tr_b16 a[186:187], v242 offset:32768
  v_mfma_f32_16x16x32_bf16 v[52:55], a[196:199], a[28:31], v[52:55]
  ds_read_b64_tr_b16 a[188:189], v242 offset:36864
  v_mfma_f32_16x16x32_bf16 v[52:55], a[192:195], a[20:23], v[52:55]
  s_waitcnt lgkmcnt(11)
  ds_read_b64_tr_b16 a[190:191], v242 offset:40960
  v_mfma_f32_16x16x32_bf16 v[60:63], a[200:203], a[20:23], v[60:63]
  ds_read_b64_tr_b16 a[192:193], v243 offset:28672
  v_mfma_f32_16x16x32_bf16 v[60:63], a[204:207], a[28:31], v[60:63]
  ds_read_b64_tr_b16 a[194:195], v243 offset:32768
  v_mfma_f32_16x16x32_bf16 v[56:59], a[204:207], a[24:27], v[56:59]
  ds_read_b64_tr_b16 a[196:197], v243 offset:36864
  v_mfma_f32_16x16x32_bf16 v[56:59], a[200:203], a[16:19], v[56:59]
  s_waitcnt lgkmcnt(11)
  ds_read_b64_tr_b16 a[198:199], v243 offset:40960
  v_mfma_f32_16x16x32_bf16 v[32:35], a[208:211], a[32:35], v[32:35]
  ds_read_b64_tr_b16 a[200:201], v240 offset:45056
  v_mfma_f32_16x16x32_bf16 v[32:35], a[212:215], a[40:43], v[32:35]
  ds_read_b64_tr_b16 a[202:203], v240 offset:49152
  v_mfma_f32_16x16x32_bf16 v[36:39], a[212:215], a[44:47], v[36:39]
  ds_read_b64_tr_b16 a[204:205], v240 offset:53248
  v_mfma_f32_16x16x32_bf16 v[36:39], a[208:211], a[36:39], v[36:39]
  s_waitcnt lgkmcnt(11)
  ds_read_b64_tr_b16 a[206:207], v240 offset:57344
  v_mfma_f32_16x16x32_bf16 v[44:47], a[176:179], a[36:39], v[44:47]
  ds_read_b64_tr_b16 a[208:209], v241 offset:45056
  v_mfma_f32_16x16x32_bf16 v[44:47], a[180:183], a[44:47], v[44:47]
  ds_read_b64_tr_b16 a[210:211], v241 offset:49152
  v_mfma_f32_16x16x32_bf16 v[40:43], a[180:183], a[40:43], v[40:43]
  ds_read_b64_tr_b16 a[212:213], v241 offset:53248
  v_mfma_f32_16x16x32_bf16 v[40:43], a[176:179], a[32:35], v[40:43]
  s_waitcnt vmcnt(13) lgkmcnt(11)
  s_barrier
  ds_read_b64_tr_b16 a[214:215], v241 offset:57344
  v_mfma_f32_16x16x32_bf16 v[48:51], a[184:187], a[32:35], v[48:51]
  ds_read_b64_tr_b16 a[176:177], v242 offset:45056
  v_mfma_f32_16x16x32_bf16 v[48:51], a[188:191], a[40:43], v[48:51]
  ds_read_b64_tr_b16 a[178:179], v242 offset:49152
  v_mfma_f32_16x16x32_bf16 v[52:55], a[188:191], a[44:47], v[52:55]
  s_waitcnt vmcnt(0)
  ds_read_b64_tr_b16 a[180:181], v242 offset:53248
  s_mov_b64 exec, 1
  buffer_store_dword v9, v0, s[36:39], s78 offen sc1
  s_mov_b64 exec, -1
  v_mfma_f32_16x16x32_bf16 v[52:55], a[184:187], a[36:39], v[52:55]
  s_waitcnt lgkmcnt(11)
  ds_read_b64_tr_b16 a[182:183], v242 offset:57344
  v_readfirstlane_b32 s80, v139
  v_mfma_f32_16x16x32_bf16 v[60:63], a[192:195], a[36:39], v[60:63]
  s_nop 0
  ds_read_b64_tr_b16 a[184:185], v243 offset:45056
  s_cmp_eq_u32 s80, s3
  v_mfma_f32_16x16x32_bf16 v[60:63], a[196:199], a[44:47], v[60:63]
  s_cselect_b32 s89, s63, 1073741824
  ds_read_b64_tr_b16 a[186:187], v243 offset:49152
  s_cselect_b32 s90, s64, 1073741824
  v_mfma_f32_16x16x32_bf16 v[56:59], a[196:199], a[40:43], v[56:59]
  ds_read_b64_tr_b16 a[188:189], v243 offset:53248
  buffer_load_dwordx4 v[96:99], v0, s[36:39], s89 offen offset:0 sc1
  v_mfma_f32_16x16x32_bf16 v[56:59], a[192:195], a[32:35], v[56:59]
  s_waitcnt lgkmcnt(11)
  ds_read_b64_tr_b16 a[190:191], v243 offset:57344
  v_mfma_f32_16x16x32_bf16 v[32:35], a[200:203], a[48:51], v[32:35]
  ds_read_b64_tr_b16 a[192:193], v240 offset:61440
  v_mfma_f32_16x16x32_bf16 v[32:35], a[204:207], a[56:59], v[32:35]
  ds_read_b64_tr_b16 a[194:195], v244 offset:0
  buffer_load_dwordx4 v[100:103], v0, s[36:39], s89 offen offset:1024 sc1
  v_mfma_f32_16x16x32_bf16 v[36:39], a[204:207], a[60:63], v[36:39]
  ds_read_b64_tr_b16 a[196:197], v244 offset:4096
  v_mfma_f32_16x16x32_bf16 v[36:39], a[200:203], a[52:55], v[36:39]
  s_waitcnt lgkmcnt(11)
  ds_read_b64_tr_b16 a[198:199], v244 offset:8192
  v_mfma_f32_16x16x32_bf16 v[44:47], a[208:211], a[52:55], v[44:47]
  ds_read_b64_tr_b16 a[200:201], v241 offset:61440
  buffer_load_dwordx4 v[104:107], v0, s[36:39], s89 offen offset:2048 sc1
  v_mfma_f32_16x16x32_bf16 v[44:47], a[212:215], a[60:63], v[44:47]
  ds_read_b64_tr_b16 a[202:203], v245 offset:0
  v_mfma_f32_16x16x32_bf16 v[40:43], a[212:215], a[56:59], v[40:43]
  ds_read_b64_tr_b16 a[204:205], v245 offset:4096
  v_mfma_f32_16x16x32_bf16 v[40:43], a[208:211], a[48:51], v[40:43]
  s_waitcnt vmcnt(15) lgkmcnt(11)
  s_barrier
  ds_read_b64_tr_b16 a[206:207], v245 offset:8192
  v_mfma_f32_16x16x32_bf16 v[48:51], a[176:179], a[48:51], v[48:51]
  ds_read_b64_tr_b16 a[208:209], v242 offset:61440
  buffer_load_dwordx4 v[108:111], v0, s[36:39], s89 offen offset:3072 sc1
  v_mfma_f32_16x16x32_bf16 v[48:51], a[180:183], a[56:59], v[48:51]
  ds_read_b64_tr_b16 a[210:211], v246 offset:0
  v_mfma_f32_16x16x32_bf16 v[52:55], a[180:183], a[60:63], v[52:55]
  ds_read_b64_tr_b16 a[212:213], v246 offset:4096
  v_mfma_f32_16x16x32_bf16 v[52:55], a[176:179], a[52:55], v[52:55]
  s_waitcnt lgkmcnt(11)
  ds_read_b64_tr_b16 a[214:215], v246 offset:8192
  buffer_load_dwordx4 v[112:115], v0, s[36:39], s90 offen offset:0 sc1
  v_mfma_f32_16x16x32_bf16 v[60:63], a[184:187], a[52:55], v[60:63]
  ds_read_b64_tr_b16 a[176:177], v243 offset:61440
  v_mfma_f32_16x16x32_bf16 v[60:63], a[188:191], a[60:63], v[60:63]
  ds_read_b64_tr_b16 a[178:179], v247 offset:0
  v_mfma_f32_16x16x32_bf16 v[56:59], a[188:191], a[56:59], v[56:59]
  ds_read_b64_tr_b16 a[180:181], v247 offset:4096
  buffer_load_dwordx4 v[116:119], v0, s[36:39], s90 offen offset:1024 sc1
  v_mfma_f32_16x16x32_bf16 v[56:59], a[184:187], a[48:51], v[56:59]
  s_waitcnt lgkmcnt(11)
  ds_read_b64_tr_b16 a[182:183], v247 offset:8192
  v_mfma_f32_16x16x32_bf16 v[32:35], a[192:195], a[64:67], v[32:35]
  ds_read_b64_tr_b16 a[184:185], v244 offset:12288
  v_mfma_f32_16x16x32_bf16 v[32:35], a[196:199], a[72:75], v[32:35]
  ds_read_b64_tr_b16 a[186:187], v244 offset:16384
  buffer_load_dwordx4 v[120:123], v0, s[36:39], s90 offen offset:2048 sc1
  v_mfma_f32_16x16x32_bf16 v[36:39], a[196:199], a[76:79], v[36:39]
  ds_read_b64_tr_b16 a[188:189], v244 offset:20480
  v_mfma_f32_16x16x32_bf16 v[36:39], a[192:195], a[68:71], v[36:39]
  s_waitcnt lgkmcnt(11)
  ds_read_b64_tr_b16 a[190:191], v244 offset:24576
  v_mfma_f32_16x16x32_bf16 v[44:47], a[200:203], a[68:71], v[44:47]
  ds_read_b64_tr_b16 a[192:193], v245 offset:12288
  buffer_load_dwordx4 v[124:127], v0, s[36:39], s90 offen offset:3072 sc1
  v_mfma_f32_16x16x32_bf16 v[44:47], a[204:207], a[76:79], v[44:47]
  ds_read_b64_tr_b16 a[194:195], v245 offset:16384
  v_mfma_f32_16x16x32_bf16 v[40:43], a[204:207], a[72:75], v[40:43]
  ds_read_b64_tr_b16 a[196:197], v245 offset:20480
  v_mfma_f32_16x16x32_bf16 v[40:43], a[200:203], a[64:67], v[40:43]
  s_waitcnt vmcnt(18) lgkmcnt(11)
  s_barrier
  ds_read_b64_tr_b16 a[198:199], v245 offset:24576
  v_mfma_f32_16x16x32_bf16 v[48:51], a[208:211], a[64:67], v[48:51]
  ds_read_b64_tr_b16 a[200:201], v246 offset:12288
  v_mfma_f32_16x16x32_bf16 v[48:51], a[212:215], a[72:75], v[48:51]
  ds_read_b64_tr_b16 a[202:203], v246 offset:16384
  v_mfma_f32_16x16x32_bf16 v[52:55], a[212:215], a[76:79], v[52:55]
  ds_read_b64_tr_b16 a[204:205], v246 offset:20480
  v_mfma_f32_16x16x32_bf16 v[52:55], a[208:211], a[68:71], v[52:55]
  s_waitcnt lgkmcnt(11)
  ds_read_b64_tr_b16 a[206:207], v246 offset:24576
  v_mfma_f32_16x16x32_bf16 v[60:63], a[176:179], a[68:71], v[60:63]
  ds_read_b64_tr_b16 a[208:209], v247 offset:12288
  v_mfma_f32_16x16x32_bf16 v[60:63], a[180:183], a[76:79], v[60:63]
  ds_read_b64_tr_b16 a[210:211], v247 offset:16384
  v_mfma_f32_16x16x32_bf16 v[56:59], a[180:183], a[72:75], v[56:59]
  ds_read_b64_tr_b16 a[212:213], v247 offset:20480
  v_mfma_f32_16x16x32_bf16 v[56:59], a[176:179], a[64:67], v[56:59]
  s_waitcnt lgkmcnt(11)
  ds_read_b64_tr_b16 a[214:215], v247 offset:24576
  v_mfma_f32_16x16x32_bf16 v[32:35], a[184:187], a[80:83], v[32:35]
  ds_read_b64_tr_b16 a[176:177], v244 offset:28672
  v_mfma_f32_16x16x32_bf16 v[32:35], a[188:191], a[88:91], v[32:35]
  ds_read_b64_tr_b16 a[178:179], v244 offset:32768
  v_mfma_f32_16x16x32_bf16 v[36:39], a[188:191], a[92:95], v[36:39]
  ds_read_b64_tr_b16 a[180:181], v244 offset:36864
  v_mfma_f32_16x16x32_bf16 v[36:39], a[184:187], a[84:87], v[36:39]
  s_waitcnt lgkmcnt(11)
  ds_read_b64_tr_b16 a[182:183], v244 offset:40960
  v_mfma_f32_16x16x32_bf16 v[44:47], a[192:195], a[84:87], v[44:47]
  ds_read_b64_tr_b16 a[184:185], v245 offset:28672
  v_mfma_f32_16x16x32_bf16 v[44:47], a[196:199], a[92:95], v[44:47]
  ds_read_b64_tr_b16 a[186:187], v245 offset:32768
  v_mfma_f32_16x16x32_bf16 v[40:43], a[196:199], a[88:91], v[40:43]
  ds_read_b64_tr_b16 a[188:189], v245 offset:36864
  v_mfma_f32_16x16x32_bf16 v[40:43], a[192:195], a[80:83], v[40:43]
  s_waitcnt lgkmcnt(11)
  ds_read_b64_tr_b16 a[190:191], v245 offset:40960
  v_mfma_f32_16x16x32_bf16 v[48:51], a[200:203], a[80:83], v[48:51]
  ds_read_b64_tr_b16 a[192:193], v246 offset:28672
  v_mfma_f32_16x16x32_bf16 v[48:51], a[204:207], a[88:91], v[48:51]
  ds_read_b64_tr_b16 a[194:195], v246 offset:32768
  v_mfma_f32_16x16x32_bf16 v[52:55], a[204:207], a[92:95], v[52:55]
  ds_read_b64_tr_b16 a[196:197], v246 offset:36864
  v_mfma_f32_16x16x32_bf16 v[52:55], a[200:203], a[84:87], v[52:55]
  s_waitcnt lgkmcnt(11)
  ds_read_b64_tr_b16 a[198:199], v246 offset:40960
  v_mfma_f32_16x16x32_bf16 v[60:63], a[208:211], a[84:87], v[60:63]
  ds_read_b64_tr_b16 a[200:201], v247 offset:28672
  v_mfma_f32_16x16x32_bf16 v[60:63], a[212:215], a[92:95], v[60:63]
  ds_read_b64_tr_b16 a[202:203], v247 offset:32768
  v_mfma_f32_16x16x32_bf16 v[56:59], a[212:215], a[88:91], v[56:59]
  ds_read_b64_tr_b16 a[204:205], v247 offset:36864
  v_mfma_f32_16x16x32_bf16 v[56:59], a[208:211], a[80:83], v[56:59]
  s_waitcnt lgkmcnt(11)
  ds_read_b64_tr_b16 a[206:207], v247 offset:40960
  v_mfma_f32_16x16x32_bf16 v[32:35], a[176:179], a[96:99], v[32:35]
  buffer_load_dword v139, v132, s[36:39], s79 offen sc1
  v_mfma_f32_16x16x32_bf16 v[32:35], a[180:183], a[104:107], v[32:35]
  v_mfma_f32_16x16x32_bf16 v[36:39], a[180:183], a[108:111], v[36:39]
  v_mfma_f32_16x16x32_bf16 v[36:39], a[176:179], a[100:103], v[36:39]
  s_waitcnt lgkmcnt(8)
  v_mfma_f32_16x16x32_bf16 v[44:47], a[184:187], a[100:103], v[44:47]
  v_mfma_f32_16x16x32_bf16 v[44:47], a[188:191], a[108:111], v[44:47]
  v_mfma_f32_16x16x32_bf16 v[40:43], a[188:191], a[104:107], v[40:43]
  v_mfma_f32_16x16x32_bf16 v[40:43], a[184:187], a[96:99], v[40:43]
  s_waitcnt lgkmcnt(4)
  v_mfma_f32_16x16x32_bf16 v[48:51], a[192:195], a[96:99], v[48:51]
  v_mfma_f32_16x16x32_bf16 v[48:51], a[196:199], a[104:107], v[48:51]
  v_mfma_f32_16x16x32_bf16 v[52:55], a[196:199], a[108:111], v[52:55]
  v_mfma_f32_16x16x32_bf16 v[52:55], a[192:195], a[100:103], v[52:55]
  s_waitcnt lgkmcnt(0)
  v_mfma_f32_16x16x32_bf16 v[60:63], a[200:203], a[100:103], v[60:63]
  v_mfma_f32_16x16x32_bf16 v[60:63], a[204:207], a[108:111], v[60:63]
  v_mfma_f32_16x16x32_bf16 v[56:59], a[204:207], a[104:107], v[56:59]
  v_mfma_f32_16x16x32_bf16 v[56:59], a[200:203], a[96:99], v[56:59]
  s_cmp_eq_u32 s80, s3
  s_cbranch_scc0 CKXs
CKXx:
  v_pk_fma_f32 v[64:65], v[176:177], v[32:33], v[64:65]
  v_pk_fma_f32 v[66:67], v[178:179], v[34:35], v[66:67]
  v_pk_fma_f32 v[80:81], v[176:177], v[36:37], v[80:81]
  v_pk_fma_f32 v[82:83], v[178:179], v[38:39], v[82:83]
  v_pk_fma_f32 v[68:69], v[180:181], v[40:41], v[68:69]
  v_pk_fma_f32 v[70:71], v[182:183], v[42:43], v[70:71]
  v_pk_fma_f32 v[84:85], v[180:181], v[44:45], v[84:85]
  v_pk_fma_f32 v[86:87], v[182:183], v[46:47], v[86:87]
  v_pk_fma_f32 v[72:73], v[184:185], v[48:49], v[72:73]
  v_pk_fma_f32 v[74:75], v[186:187], v[50:51], v[74:75]
  v_pk_fma_f32 v[88:89], v[184:185], v[52:53], v[88:89]
Hb1_1:
  s_cbranch_execz Rb
  v_pk_fma_f32 v[90:91], v[186:187], v[54:55], v[90:91]
  v_pk_fma_f32 v[76:77], v[188:189], v[56:57], v[76:77]
  v_pk_fma_f32 v[78:79], v[190:191], v[58:59], v[78:79]
  v_pk_fma_f32 v[92:93], v[188:189], v[60:61], v[92:93]
  v_pk_fma_f32 v[94:95], v[190:191], v[62:63], v[94:95]
  s_waitcnt vmcnt(8)
  v_pk_fma_f32 v[64:65], v[176:177], v[96:97], v[64:65]
  v_pk_fma_f32 v[66:67], v[178:179], v[98:99], v[66:67]
  v_cvt_pk_bf16_f32 v192, v64, v65
  v_cvt_pk_bf16_f32 v193, v66, v67
  ds_write_b64 v140, v[192:193] offset:0
  s_waitcnt vmcnt(7)
  v_pk_fma_f32 v[80:81], v[176:177], v[100:101], v[80:81]
  v_pk_fma_f32 v[82:83], v[178:179], v[102:103], v[82:83]
  v_cvt_pk_bf16_f32 v200, v80, v81
  v_cvt_pk_bf16_f32 v201, v82, v83
  ds_write_b64 v140, v[200:201] offset:2048
  s_waitcnt vmcnt(6)
  v_pk_fma_f32 v[68:69], v[180:181], v[104:105], v[68:69]
  v_pk_fma_f32 v[70:71], v[182:183], v[106:107], v[70:71]
  v_cvt_pk_bf16_f32 v194, v68, v69
  v_cvt_pk_bf16_f32 v195, v70, v71
  ds_write_b64 v141, v[194:195] offset:0
  s_waitcnt vmcnt(5)
  v_pk_fma_f32 v[84:85], v[180:181], v[108:109], v[84:85]
  v_pk_fma_f32 v[86:87], v[182:183], v[110:111], v[86:87]
  v_cvt_pk_bf16_f32 v202, v84, v85
  v_cvt_pk_bf16_f32 v203, v86, v87
  ds_write_b64 v141, v[202:203] offset:2048
  s_waitcnt vmcnt(4)
  v_pk_fma_f32 v[72:73], v[184:185], v[112:113], v[72:73]
  v_pk_fma_f32 v[74:75], v[186:187], v[114:115], v[74:75]
  v_cvt_pk_bf16_f32 v196, v72, v73
  v_cvt_pk_bf16_f32 v197, v74, v75
  ds_write_b64 v142, v[196:197] offset:0
  s_waitcnt vmcnt(3)
  v_pk_fma_f32 v[88:89], v[184:185], v[116:117], v[88:89]
  v_pk_fma_f32 v[90:91], v[186:187], v[118:119], v[90:91]
  v_cvt_pk_bf16_f32 v204, v88, v89
  v_cvt_pk_bf16_f32 v205, v90, v91
  ds_write_b64 v142, v[204:205] offset:2048
  s_waitcnt vmcnt(2)
  v_pk_fma_f32 v[76:77], v[188:189], v[120:121], v[76:77]
  v_pk_fma_f32 v[78:79], v[190:191], v[122:123], v[78:79]
  v_cvt_pk_bf16_f32 v198, v76, v77
  v_cvt_pk_bf16_f32 v199, v78, v79
  ds_write_b64 v143, v[198:199] offset:0
  s_waitcnt vmcnt(1)
  v_pk_fma_f32 v[92:93], v[188:189], v[124:125], v[92:93]
  v_pk_fma_f32 v[94:95], v[190:191], v[126:127], v[94:95]
  v_cvt_pk_bf16_f32 v206, v92, v93
  v_cvt_pk_bf16_f32 v207, v94, v95
  ds_write_b64 v143, v[206:207] offset:2048
  ds_read_b128 v[64:67], v254 offset:0
  ds_read_b128 v[68:71], v254 offset:1024
  ds_read_b128 v[72:75], v254 offset:2048
  ds_read_b128 v[76:79], v254 offset:3072
  s_waitcnt lgkmcnt(3)
  buffer_store_dwordx4 v[64:67], v252, s[32:35], s55 offen
  s_waitcnt lgkmcnt(2)
  buffer_store_dwordx4 v[68:71], v253, s[32:35], s55 offen
  s_waitcnt lgkmcnt(1)
  buffer_store_dwordx4 v[72:75], v252, s[32:35], s49 offen
  s_waitcnt lgkmcnt(0)
  buffer_store_dwordx4 v[76:79], v253, s[32:35], s49 offen
XEND:
  s_endpgm
CK3s:
  s_mov_b32 s46, 60000
CK3:
  buffer_load_dword v19, v215, s[36:39], s66 offen sc1
  s_sub_u32 s46, s46, 1
  s_cmp_eq_u32 s46, 0
  s_waitcnt vmcnt(0)
  s_cbranch_scc1 CK3y
  v_cmp_ne_u32 vcc, s3, v19
  s_nop 4
  s_cbranch_vccnz CK3
CK3y:
  s_mov_b64 exec, -1
  s_branch CK3x
CK5s:
  s_mov_b32 s46, 30000
CK5:
  s_mov_b32 s49, 0
  buffer_load_dwordx4 v[156:159], v249, s[36:39], s49 offen sc1
  s_mov_b32 s49, 24576
  buffer_load_dwordx4 v[160:163], v249, s[36:39], s49 offen sc1
  s_mov_b32 s49, 49152
  buffer_load_dwordx4 v[164:167], v249, s[36:39], s49 offen sc1
  s_mov_b32 s49, 73728
  buffer_load_dwordx4 v[168:171], v249, s[36:39], s49 offen sc1
  s_sub_u32 s46, s46, 1
  s_waitcnt vmcnt(0)
  v_max_u32 v15, v156, v157
  v_max3_u32 v15, v15, v158, v159
  v_max3_u32 v15, v15, v160, v161
  v_max3_u32 v15, v15, v162, v163
  v_max3_u32 v15, v15, v164, v165
  v_max3_u32 v15, v15, v166, v167
  v_max3_u32 v15, v15, v168, v169
  v_max3_u32 v15, v15, v170, v171
  s_cmp_eq_u32 s46, 0
  s_cbranch_scc1 CK5x
  v_cmp_eq_u32 vcc, -1, v15
  s_nop 4
  s_cbranch_vccnz CK5
  s_branch CK5x
CKSs:
  s_mov_b32 s46, 30000
  v_lshlrev_b32 v14, 3, v0
CKS:
  s_mov_b32 s48, 5242880
  buffer_load_dword v16, v14, s[36:39], s48 offen sc1
  s_mov_b32 s48, 5251072
  buffer_load_dword v17, v14, s[36:39], s48 offen sc1
  s_mov_b32 s48, 5259264
  buffer_load_dword v18, v14, s[36:39], s48 offen sc1
  s_mov_b32 s48, 5267456
  buffer_load_dword v19, v14, s[36:39], s48 offen sc1
  s_sub_u32 s46, s46, 1
  s_cmp_eq_u32 s46, 0
  s_waitcnt vmcnt(0)
  s_cbranch_scc1 CKSy
  v_xor_b32 v15, s3, v16
  v_bitop3_b32 v15, v15, v17, s3 bitop3:0xf6
  v_bitop3_b32 v15, v15, v18, s3 bitop3:0xf6
  v_bitop3_b32 v15, v15, v19, s3 bitop3:0xf6
  v_cmp_ne_u32 vcc, 0, v15
  s_nop 4
  s_cbranch_vccnz CKS
CKSy:
  s_mov_b32 s48, 5505024
  s_mov_b64 exec, 1
  buffer_store_dword v12, v0, s[36:39], s48 offen sc1
  s_mov_b64 exec, -1
  s_branch CKSx
CK7s:
  s_mov_b32 s46, 60000
CK7:
  buffer_load_dword v29, v30, s[36:39], s68 offen sc1
  s_sub_u32 s46, s46, 1
  s_cmp_eq_u32 s46, 0
  s_waitcnt vmcnt(0)
  s_cbranch_scc1 CK7y
  v_cmp_ne_u32 vcc, s3, v29
  s_nop 4
  s_cbranch_vccnz CK7
CK7y:
  s_mov_b64 exec, -1
  s_branch CK7x
CK8s:
  s_mov_b32 s46, 30000
CK8:
  buffer_load_dwordx4 a[208:211], v25, s[36:39], s79 offen offset:0 sc1
  buffer_load_dwordx4 a[212:215], v25, s[36:39], s79 offen offset:2048 sc1
  buffer_load_dwordx4 a[216:219], v25, s[36:39], s78 offen offset:0 sc1
  buffer_load_dwordx4 a[220:223], v25, s[36:39], s78 offen offset:2048 sc1
  s_sub_u32 s46, s46, 1
  s_waitcnt vmcnt(0)
  v_accvgpr_read_b32 v26, a208
  v_accvgpr_read_b32 v27, a209
  v_accvgpr_read_b32 v28, a210
  v_accvgpr_read_b32 v29, a211
  v_max_u32 v31, v26, v27
  v_max3_u32 v31, v31, v28, v29
  v_accvgpr_read_b32 v22, a212
  v_accvgpr_read_b32 v23, a213
  v_max3_u32 v31, v31, v22, v23
  v_add_f32 v26, v26, v22
  v_add_f32 v27, v27, v23
  v_accvgpr_read_b32 v22, a214
  v_accvgpr_read_b32 v23, a215
  v_max3_u32 v31, v31, v22, v23
  v_add_f32 v28, v28, v22
  v_add_f32 v29, v29, v23
  v_accvgpr_read_b32 v22, a216
  v_accvgpr_read_b32 v23, a217
  v_max3_u32 v31, v31, v22, v23
  v_add_f32 v26, v26, v22
  v_add_f32 v27, v27, v23
  v_accvgpr_read_b32 v22, a218
  v_accvgpr_read_b32 v23, a219
  v_max3_u32 v31, v31, v22, v23
  v_add_f32 v28, v28, v22
  v_add_f32 v29, v29, v23
  v_accvgpr_read_b32 v22, a220
  v_accvgpr_read_b32 v23, a221
  v_max3_u32 v31, v31, v22, v23
  v_add_f32 v26, v26, v22
  v_add_f32 v27, v27, v23
  v_accvgpr_read_b32 v22, a222
  v_accvgpr_read_b32 v23, a223
  v_max3_u32 v31, v31, v22, v23
  v_add_f32 v28, v28, v22
  v_add_f32 v29, v29, v23
  s_cmp_eq_u32 s46, 0
  s_cbranch_scc1 CK8x
  v_cmp_eq_u32 vcc, -1, v31
  s_nop 4
  s_cbranch_vccnz CK8
  s_branch CK8x
CK9s:
  s_mov_b32 s46, 60000
CK9:
  buffer_load_dword v139, v138, s[36:39], s91 offen sc1
  s_sub_u32 s46, s46, 1
  s_cmp_eq_u32 s46, 0
  s_waitcnt vmcnt(0)
  s_cbranch_scc1 CK9y
  v_cmp_ne_u32 vcc, s3, v139
  s_nop 4
  s_cbranch_vccnz CK9
CK9y:
  s_mov_b64 exec, -1
  s_branch CK9x
CK10s:
  s_mov_b32 s46, 60000
CK10:
  buffer_load_dword v139, v138, s[36:39], s91 offen sc1
  s_sub_u32 s46, s46, 1
  s_cmp_eq_u32 s46, 0
  s_waitcnt vmcnt(0)
  s_cbranch_scc1 CK10y
  v_cmp_ne_u32 vcc, s3, v139
  s_nop 4
  s_cbranch_vccnz CK10
CK10y:
  s_mov_b64 exec, -1
  s_branch CK10x
CK11s:
  s_mov_b32 s46, 60000
CK11:
  buffer_load_dword v139, v138, s[36:39], s91 offen sc1
  s_sub_u32 s46, s46, 1
  s_cmp_eq_u32 s46, 0
  s_waitcnt vmcnt(0)
  s_cbranch_scc1 CK11y
  v_cmp_ne_u32 vcc, s3, v139
  s_nop 4
  s_cbranch_vccnz CK11
CK11y:
  s_mov_b64 exec, -1
  s_branch CK11x
CKXs:
  s_mov_b32 s46, 60000
  s_branch CKXw
CKX:
  buffer_load_dword v139, v132, s[36:39], s79 offen sc1
CKXw:
  s_sub_u32 s46, s46, 1
  s_cmp_eq_u32 s46, 0
  s_waitcnt vmcnt(0)
  s_cbranch_scc1 CKXy
  v_cmp_ne_u32 vcc, s3, v139
  s_nop 4
  s_cbranch_vccnz CKX
CKXy:
  buffer_load_dwordx4 v[96:99], v0, s[36:39], s63 offen offset:0 sc1
  buffer_load_dwordx4 v[100:103], v0, s[36:39], s63 offen offset:1024 sc1
  buffer_load_dwordx4 v[104:107], v0, s[36:39], s63 offen offset:2048 sc1
  buffer_load_dwordx4 v[108:111], v0, s[36:39], s63 offen offset:3072 sc1
  buffer_load_dwordx4 v[112:115], v0, s[36:39], s64 offen offset:0 sc1
  buffer_load_dwordx4 v[116:119], v0, s[36:39], s64 offen offset:1024 sc1
  buffer_load_dwordx4 v[120:123], v0, s[36:39], s64 offen offset:2048 sc1
  buffer_load_dwordx4 v[124:127], v0, s[36:39], s64 offen offset:3072 sc1
  buffer_load_dword v139, v132, s[36:39], s79 offen sc1
  s_branch CKXx
code_end:
.fill 2048, 4, 0xBF800000
.section .rodata,"a"
.p2align 6
.amdhsa_kernel adaLN_cond__sliding_local_dilated__swiglu_ffn__prompt_kernel
  .amdhsa_next_free_vgpr 512
  .amdhsa_next_free_sgpr 102
  .amdhsa_accum_offset 256
  .amdhsa_group_segment_fixed_size 0
  .amdhsa_kernarg_size 96
  .amdhsa_user_sgpr_count 2
  .amdhsa_user_sgpr_kernarg_segment_ptr 1
  .amdhsa_system_sgpr_workgroup_id_x 1
  .amdhsa_float_denorm_mode_32 3
.end_amdhsa_kernel
```
